```python
import torch

def _softmax(x, axis=-1):
    return torch.softmax(x, dim=axis)

def _gelu(x):
    return torch.nn.functional.gelu(x, approximate='tanh')

def _silu(x):
    return torch.nn.functional.silu(x)

def _sigmoid(x):
    return torch.sigmoid(x)

def _layernorm(x, axis=-1, eps=1e-05):
    m = x.mean(dim=axis, keepdim=True)
    v = x.var(dim=axis, keepdim=True, unbiased=False)
    return (x - m) / torch.sqrt(v + eps)

def _scatter_add(tgt, idx, src, axis=0):
    return tgt.clone().index_add_(axis, idx, src)

def _segment_sum(src, seg, n):
    out = torch.zeros((n,) + src.shape[1:], dtype=src.dtype)
    return out.index_add_(0, seg, src)

def _pad(x, pw):
    flat = tuple((v for pair in reversed(pw) for v in pair))
    return torch.nn.functional.pad(x, flat)
kernel_name = 'interleave_layers__sliding_local_dilated__mixer_gmlp__prompt'

def setup_inputs():

    _w = lambda a: (lambda t: t.to(torch.bfloat16) if t.is_floating_point() else t)(torch.as_tensor(a))

    def _A_setup():
        B, S, D = (1, 2048, 576)
        return {'x': _w((lambda *s: torch.randn(*s, dtype=torch.bfloat16) * 0.05)(B, S, D)), 'wqkv': _w((lambda *s: torch.randn(*s, dtype=torch.bfloat16) * 0.05)(D, 3 * D)), 'wo': _w((lambda *s: torch.randn(*s, dtype=torch.bfloat16) * 0.05)(D, D))}
    _A_in = _A_setup()

    def _B_setup():
        B, S, D, F = (1, 2048, 576, 4608)
        Fh = F // 2
        return {'x': _w((lambda *s: torch.randn(*s, dtype=torch.bfloat16) * 0.05)(B, S, D)), 'w_in': _w((lambda *s: torch.randn(*s, dtype=torch.bfloat16) * 0.2)(D, 2 * Fh)), 'w_sp': _w(0.01 * (lambda *s: torch.randn(*s, dtype=torch.bfloat16) * 0.2)(S, S)), 'b_sp': _w(1.0 + 0.01 * (lambda *s: torch.randn(*s, dtype=torch.bfloat16) * 0.05)(S)), 'w_out': _w((lambda *s: torch.randn(*s, dtype=torch.bfloat16) * 0.05)(Fh, D))}
    _B_in = _B_setup()
    return {'A_x': _A_in['x'], 'A_wqkv': _A_in['wqkv'], 'A_wo': _A_in['wo'], 'B_x': _B_in['x'], 'B_w_in': _B_in['w_in'], 'B_w_sp': _B_in['w_sp'], 'B_b_sp': _B_in['b_sp'], 'B_w_out': _B_in['w_out']}

def reference(A_x, A_wqkv, A_wo, B_x, B_w_in, B_w_sp, B_b_sp, B_w_out):

    def _A_ref(x, wqkv, wo):
        B, S, D = x.shape
        H = 32
        Dh = D // H
        W, dil = (8, 2)
        qkv = (lambda x, *d: x.permute(*d))((x @ wqkv).reshape(B, S, 3, H, Dh), 2, 0, 3, 1, 4)
        q, k, v = (qkv[0], qkv[1], qkv[2])
        scale = Dh ** (-0.5)
        pos = torch.arange(S)
        off = torch.arange(W) * dil
        idx = pos[:, None] - off[None, :]
        mask = idx >= 0
        idx_c = torch.where(mask, idx, 0).reshape(-1)
        kg = k[:, :, idx_c, :].reshape(B, H, S, W, Dh)
        vg = v[:, :, idx_c, :].reshape(B, H, S, W, Dh)
        logits = torch.einsum('bhsd,bhswd->bhsw', q, kg) * scale
        logits = torch.where(mask[None, None, :, :], logits, -1000000000.0)
        attn = _softmax(logits, axis=-1)
        o = torch.einsum('bhsw,bhswd->bhsd', attn, vg)
        return (lambda x, *d: x.permute(*d))(o, 0, 2, 1, 3).reshape(B, S, D) @ wo

    def _B_ref(x, w_in, w_sp, b_sp, w_out):
        B, S, D = x.shape
        F = w_in.shape[-1]
        Fh = F // 2
        z = _gelu(torch.einsum('bsd,df->bsf', x, w_in))
        z1 = z[..., :Fh].clone()
        z2 = _layernorm(z[..., Fh:], axis=-1)
        g = torch.einsum('ts,bsf->btf', w_sp, z2) + b_sp[None, :, None]
        return torch.einsum('bsf,fd->bsd', z1 * g, w_out)
    x = A_x
    x = x + _A_ref(_layernorm(x, axis=-1), A_wqkv, A_wo)
    x = x + _B_ref(_layernorm(x, axis=-1), B_w_in, B_w_sp, B_b_sp, B_w_out)
    x = x + _A_ref(_layernorm(x, axis=-1), A_wqkv, A_wo)
    x = x + _B_ref(_layernorm(x, axis=-1), B_w_in, B_w_sp, B_b_sp, B_w_out)
    return x
```

```asm
; @launch kernel=ln1_0_kernel grid=(2048,1,1) block=(64,1,1) lds=0
; @launch kernel=qkv_kernel grid=(3456,1,1) block=(64,1,1) lds=0
; @launch kernel=attn_kernel grid=(1024,1,1) block=(64,1,1) lds=0
; @launch kernel=wo_0_kernel grid=(1152,1,1) block=(64,1,1) lds=0
; @launch kernel=ln2_kernel grid=(2048,1,1) block=(64,1,1) lds=0
; @launch kernel=win_kernel grid=(9216,1,1) block=(64,1,1) lds=0
; @launch kernel=ln3_kernel grid=(2048,1,1) block=(64,1,1) lds=0
; @launch kernel=sp_kernel grid=(4608,1,1) block=(64,1,1) lds=0
; @launch kernel=wout_0_kernel grid=(1152,1,1) block=(64,1,1) lds=0
; @launch kernel=ln1_1_kernel grid=(2048,1,1) block=(64,1,1) lds=0
; @launch kernel=qkv_kernel grid=(3456,1,1) block=(64,1,1) lds=0
; @launch kernel=attn_kernel grid=(1024,1,1) block=(64,1,1) lds=0
; @launch kernel=wo_1_kernel grid=(1152,1,1) block=(64,1,1) lds=0
; @launch kernel=ln2_kernel grid=(2048,1,1) block=(64,1,1) lds=0
; @launch kernel=win_kernel grid=(9216,1,1) block=(64,1,1) lds=0
; @launch kernel=ln3_kernel grid=(2048,1,1) block=(64,1,1) lds=0
; @launch kernel=sp_kernel grid=(4608,1,1) block=(64,1,1) lds=0
; @launch kernel=wout_1_kernel grid=(1152,1,1) block=(64,1,1) lds=0
.amdgcn_target "amdgcn-amd-amdhsa--gfx950"
.text
.globl ln1_0_kernel
.p2align 8
.type ln1_0_kernel,@function
ln1_0_kernel:
s_cmp_ge_u32 s2, 2048
s_cbranch_scc1 L_ln1_0_kernel_end
s_load_dwordx2 s[4:5], s[0:1], 0
s_waitcnt lgkmcnt(0)
s_mov_b32 s6, 2359296
s_mov_b32 s7, 0x20000
s_load_dwordx2 s[8:9], s[0:1], 80
s_waitcnt lgkmcnt(0)
s_add_u32 s8, s8, 0
s_addc_u32 s9, s9, 0
s_mov_b32 s10, 2359296
s_mov_b32 s11, 0x20000
s_mul_i32 s12, s2, 1152
s_add_u32 s12, s12, 0
s_mul_i32 s13, s2, 1152
v_lshlrev_b32 v1, 1, v0
v_add_u32 v2, s12, v1
v_add_u32 v3, s13, v1
buffer_load_ushort v10, v2, s[4:7], 0 offen offset:0
buffer_load_ushort v11, v2, s[4:7], 0 offen offset:128
buffer_load_ushort v12, v2, s[4:7], 0 offen offset:256
buffer_load_ushort v13, v2, s[4:7], 0 offen offset:384
buffer_load_ushort v14, v2, s[4:7], 0 offen offset:512
buffer_load_ushort v15, v2, s[4:7], 0 offen offset:640
buffer_load_ushort v16, v2, s[4:7], 0 offen offset:768
buffer_load_ushort v17, v2, s[4:7], 0 offen offset:896
buffer_load_ushort v18, v2, s[4:7], 0 offen offset:1024
s_waitcnt vmcnt(0)
v_mov_b32 v4, 0
v_lshlrev_b32 v10, 16, v10
v_add_f32 v4, v4, v10
v_lshlrev_b32 v11, 16, v11
v_add_f32 v4, v4, v11
v_lshlrev_b32 v12, 16, v12
v_add_f32 v4, v4, v12
v_lshlrev_b32 v13, 16, v13
v_add_f32 v4, v4, v13
v_lshlrev_b32 v14, 16, v14
v_add_f32 v4, v4, v14
v_lshlrev_b32 v15, 16, v15
v_add_f32 v4, v4, v15
v_lshlrev_b32 v16, 16, v16
v_add_f32 v4, v4, v16
v_lshlrev_b32 v17, 16, v17
v_add_f32 v4, v4, v17
v_lshlrev_b32 v18, 16, v18
v_add_f32 v4, v4, v18
s_nop 1
v_add_f32_dpp v4, v4, v4 row_shr:1 row_mask:0xf bank_mask:0xf bound_ctrl:0
s_nop 1
v_add_f32_dpp v4, v4, v4 row_shr:2 row_mask:0xf bank_mask:0xf bound_ctrl:0
s_nop 1
v_add_f32_dpp v4, v4, v4 row_shr:4 row_mask:0xf bank_mask:0xf bound_ctrl:0
s_nop 1
v_add_f32_dpp v4, v4, v4 row_shr:8 row_mask:0xf bank_mask:0xf bound_ctrl:0
s_nop 1
v_add_f32_dpp v4, v4, v4 row_bcast:15 row_mask:0xa bank_mask:0xf
s_nop 1
v_add_f32_dpp v4, v4, v4 row_bcast:31 row_mask:0xc bank_mask:0xf
s_nop 1
v_readlane_b32 s16, v4, 63
s_nop 3
v_mov_b32 v6, s16
v_mul_f32 v6, 0x3ae38e39, v6
v_mov_b32 v4, 0
v_sub_f32 v5, v10, v6
v_fmac_f32 v4, v5, v5
v_sub_f32 v5, v11, v6
v_fmac_f32 v4, v5, v5
v_sub_f32 v5, v12, v6
v_fmac_f32 v4, v5, v5
v_sub_f32 v5, v13, v6
v_fmac_f32 v4, v5, v5
v_sub_f32 v5, v14, v6
v_fmac_f32 v4, v5, v5
v_sub_f32 v5, v15, v6
v_fmac_f32 v4, v5, v5
v_sub_f32 v5, v16, v6
v_fmac_f32 v4, v5, v5
v_sub_f32 v5, v17, v6
v_fmac_f32 v4, v5, v5
v_sub_f32 v5, v18, v6
v_fmac_f32 v4, v5, v5
s_nop 1
v_add_f32_dpp v4, v4, v4 row_shr:1 row_mask:0xf bank_mask:0xf bound_ctrl:0
s_nop 1
v_add_f32_dpp v4, v4, v4 row_shr:2 row_mask:0xf bank_mask:0xf bound_ctrl:0
s_nop 1
v_add_f32_dpp v4, v4, v4 row_shr:4 row_mask:0xf bank_mask:0xf bound_ctrl:0
s_nop 1
v_add_f32_dpp v4, v4, v4 row_shr:8 row_mask:0xf bank_mask:0xf bound_ctrl:0
s_nop 1
v_add_f32_dpp v4, v4, v4 row_bcast:15 row_mask:0xa bank_mask:0xf
s_nop 1
v_add_f32_dpp v4, v4, v4 row_bcast:31 row_mask:0xc bank_mask:0xf
s_nop 1
v_readlane_b32 s17, v4, 63
s_nop 3
v_mov_b32 v7, s17
v_mul_f32 v7, 0x3ae38e39, v7
v_add_f32 v7, 0x3727c5ac, v7
v_sqrt_f32 v7, v7
s_nop 1
v_rcp_f32 v7, v7
s_nop 1
v_sub_f32 v5, v10, v6
v_mul_f32 v5, v5, v7
v_cvt_pk_bf16_f32 v10, v5, v5
v_sub_f32 v5, v11, v6
v_mul_f32 v5, v5, v7
v_cvt_pk_bf16_f32 v11, v5, v5
v_sub_f32 v5, v12, v6
v_mul_f32 v5, v5, v7
v_cvt_pk_bf16_f32 v12, v5, v5
v_sub_f32 v5, v13, v6
v_mul_f32 v5, v5, v7
v_cvt_pk_bf16_f32 v13, v5, v5
v_sub_f32 v5, v14, v6
v_mul_f32 v5, v5, v7
v_cvt_pk_bf16_f32 v14, v5, v5
v_sub_f32 v5, v15, v6
v_mul_f32 v5, v5, v7
v_cvt_pk_bf16_f32 v15, v5, v5
v_sub_f32 v5, v16, v6
v_mul_f32 v5, v5, v7
v_cvt_pk_bf16_f32 v16, v5, v5
v_sub_f32 v5, v17, v6
v_mul_f32 v5, v5, v7
v_cvt_pk_bf16_f32 v17, v5, v5
v_sub_f32 v5, v18, v6
v_mul_f32 v5, v5, v7
v_cvt_pk_bf16_f32 v18, v5, v5
buffer_store_short v10, v3, s[8:11], 0 offen offset:0
buffer_store_short v11, v3, s[8:11], 0 offen offset:128
buffer_store_short v12, v3, s[8:11], 0 offen offset:256
buffer_store_short v13, v3, s[8:11], 0 offen offset:384
buffer_store_short v14, v3, s[8:11], 0 offen offset:512
buffer_store_short v15, v3, s[8:11], 0 offen offset:640
buffer_store_short v16, v3, s[8:11], 0 offen offset:768
buffer_store_short v17, v3, s[8:11], 0 offen offset:896
buffer_store_short v18, v3, s[8:11], 0 offen offset:1024
L_ln1_0_kernel_end:
s_endpgm
.globl qkv_kernel
.p2align 8
.type qkv_kernel,@function
qkv_kernel:
s_cmp_ge_u32 s2, 3456
s_cbranch_scc1 L_qkv_kernel_end
s_load_dwordx2 s[4:5], s[0:1], 80
s_waitcnt lgkmcnt(0)
s_add_u32 s4, s4, 0
s_addc_u32 s5, s5, 0
s_mov_b32 s6, 2359296
s_mov_b32 s7, 0x20000
s_load_dwordx2 s[8:9], s[0:1], 8
s_waitcnt lgkmcnt(0)
s_mov_b32 s10, 1990656
s_mov_b32 s11, 0x20000
s_load_dwordx2 s[12:13], s[0:1], 80
s_waitcnt lgkmcnt(0)
s_add_u32 s12, s12, 2359296
s_addc_u32 s13, s13, 0
s_mov_b32 s14, 7077888
s_mov_b32 s15, 0x20000
s_and_b32 s24, s2, 63
s_lshr_b32 s25, s2, 6
s_lshl_b32 s24, s24, 5
s_lshl_b32 s25, s25, 5
v_and_b32 v1, 31, v0
v_lshrrev_b32 v2, 5, v0
v_add_u32 v3, s24, v1
s_mov_b32 s26, 1152
v_mul_lo_u32 v4, v3, s26
v_lshlrev_b32 v5, 4, v2
v_add_u32 v4, v4, v5
v_add_u32 v5, s25, v1
v_lshlrev_b32 v5, 1, v5
s_mov_b32 s26, 27648
v_mul_lo_u32 v6, v2, s26
v_add_u32 v5, v5, v6
v_mov_b32 v32, 0
v_mov_b32 v33, 0
v_mov_b32 v34, 0
v_mov_b32 v35, 0
v_mov_b32 v36, 0
v_mov_b32 v37, 0
v_mov_b32 v38, 0
v_mov_b32 v39, 0
v_mov_b32 v40, 0
v_mov_b32 v41, 0
v_mov_b32 v42, 0
v_mov_b32 v43, 0
v_mov_b32 v44, 0
v_mov_b32 v45, 0
v_mov_b32 v46, 0
v_mov_b32 v47, 0
s_mov_b32 s27, 0
s_mov_b32 s28, 0
s_mov_b32 s29, 0
L_qkv_kernel_k:
buffer_load_dwordx4 v[8:11], v4, s[4:7], s28 offen
s_add_u32 s30, s29, 0
buffer_load_ushort v20, v5, s[8:11], s30 offen
s_add_u32 s30, s29, 3456
buffer_load_ushort v21, v5, s[8:11], s30 offen
s_add_u32 s30, s29, 6912
buffer_load_ushort v22, v5, s[8:11], s30 offen
s_add_u32 s30, s29, 10368
buffer_load_ushort v23, v5, s[8:11], s30 offen
s_add_u32 s30, s29, 13824
buffer_load_ushort v24, v5, s[8:11], s30 offen
s_add_u32 s30, s29, 17280
buffer_load_ushort v25, v5, s[8:11], s30 offen
s_add_u32 s30, s29, 20736
buffer_load_ushort v26, v5, s[8:11], s30 offen
s_add_u32 s30, s29, 24192
buffer_load_ushort v27, v5, s[8:11], s30 offen
s_waitcnt vmcnt(0)
v_lshl_or_b32 v12, v21, 16, v20
v_lshl_or_b32 v13, v23, 16, v22
v_lshl_or_b32 v14, v25, 16, v24
v_lshl_or_b32 v15, v27, 16, v26
s_nop 1
v_mfma_f32_32x32x16_bf16 v[32:47], v[12:15], v[8:11], v[32:47]
s_add_u32 s28, s28, 32
s_add_u32 s29, s29, 55296
s_add_u32 s27, s27, 16
s_cmp_lt_u32 s27, 576
s_cbranch_scc1 L_qkv_kernel_k
s_nop 15
s_mov_b32 s26, 3456
v_mul_lo_u32 v6, v3, s26
v_lshlrev_b32 v7, 3, v2
v_add_u32 v6, v6, v7
s_lshl_b32 s26, s25, 1
v_add_u32 v6, s26, v6
v_cvt_pk_bf16_f32 v48, v32, v33
v_cvt_pk_bf16_f32 v49, v34, v35
buffer_store_dwordx2 v[48:49], v6, s[12:15], 0 offen offset:0
v_cvt_pk_bf16_f32 v50, v36, v37
v_cvt_pk_bf16_f32 v51, v38, v39
buffer_store_dwordx2 v[50:51], v6, s[12:15], 0 offen offset:16
v_cvt_pk_bf16_f32 v52, v40, v41
v_cvt_pk_bf16_f32 v53, v42, v43
buffer_store_dwordx2 v[52:53], v6, s[12:15], 0 offen offset:32
v_cvt_pk_bf16_f32 v54, v44, v45
v_cvt_pk_bf16_f32 v55, v46, v47
buffer_store_dwordx2 v[54:55], v6, s[12:15], 0 offen offset:48
L_qkv_kernel_end:
s_endpgm
.globl attn_kernel
.p2align 8
.type attn_kernel,@function
attn_kernel:
s_cmp_ge_u32 s2, 1024
s_cbranch_scc1 L_attn_kernel_end
s_load_dwordx2 s[4:5], s[0:1], 80
s_waitcnt lgkmcnt(0)
s_add_u32 s4, s4, 2359296
s_addc_u32 s5, s5, 0
s_mov_b32 s6, 7077888
s_mov_b32 s7, 0x20000
s_load_dwordx2 s[8:9], s[0:1], 80
s_waitcnt lgkmcnt(0)
s_add_u32 s8, s8, 9437184
s_addc_u32 s9, s9, 0
s_mov_b32 s10, 2359296
s_mov_b32 s11, 0x20000
v_and_b32 v1, 31, v0
v_lshrrev_b32 v2, 5, v0
s_lshl_b32 s12, s2, 1
v_add_u32 v2, s12, v2
v_mul_u32_u24 v3, 36, v1
v_mul_u32_u24 v4, 3456, v2
v_add_u32 v4, v4, v3
buffer_load_dword v10, v4, s[4:7], 0 offen offset:0
buffer_load_dword v11, v4, s[4:7], 0 offen offset:4
buffer_load_dword v12, v4, s[4:7], 0 offen offset:8
buffer_load_dword v13, v4, s[4:7], 0 offen offset:12
buffer_load_dword v14, v4, s[4:7], 0 offen offset:16
buffer_load_dword v15, v4, s[4:7], 0 offen offset:20
buffer_load_dword v16, v4, s[4:7], 0 offen offset:24
buffer_load_dword v17, v4, s[4:7], 0 offen offset:28
buffer_load_dword v18, v4, s[4:7], 0 offen offset:32
s_waitcnt vmcnt(0)
v_lshlrev_b32 v20, 16, v10
v_and_b32 v21, 0xffff0000, v10
v_lshlrev_b32 v22, 16, v11
v_and_b32 v23, 0xffff0000, v11
v_lshlrev_b32 v24, 16, v12
v_and_b32 v25, 0xffff0000, v12
v_lshlrev_b32 v26, 16, v13
v_and_b32 v27, 0xffff0000, v13
v_lshlrev_b32 v28, 16, v14
v_and_b32 v29, 0xffff0000, v14
v_lshlrev_b32 v30, 16, v15
v_and_b32 v31, 0xffff0000, v15
v_lshlrev_b32 v32, 16, v16
v_and_b32 v33, 0xffff0000, v16
v_lshlrev_b32 v34, 16, v17
v_and_b32 v35, 0xffff0000, v17
v_lshlrev_b32 v36, 16, v18
v_and_b32 v37, 0xffff0000, v18
v_subrev_u32 v5, 0, v2
v_max_i32 v6, 0, v5
v_mul_u32_u24 v6, 3456, v6
v_add_u32 v6, v6, v3
buffer_load_dword v10, v6, s[4:7], 0 offen offset:1152
buffer_load_dword v11, v6, s[4:7], 0 offen offset:1156
buffer_load_dword v12, v6, s[4:7], 0 offen offset:1160
buffer_load_dword v13, v6, s[4:7], 0 offen offset:1164
buffer_load_dword v14, v6, s[4:7], 0 offen offset:1168
buffer_load_dword v15, v6, s[4:7], 0 offen offset:1172
buffer_load_dword v16, v6, s[4:7], 0 offen offset:1176
buffer_load_dword v17, v6, s[4:7], 0 offen offset:1180
buffer_load_dword v18, v6, s[4:7], 0 offen offset:1184
s_waitcnt vmcnt(0)
v_mov_b32 v40, 0
v_lshlrev_b32 v7, 16, v10
v_fmac_f32 v40, v7, v20
v_and_b32 v7, 0xffff0000, v10
v_fmac_f32 v40, v7, v21
v_lshlrev_b32 v7, 16, v11
v_fmac_f32 v40, v7, v22
v_and_b32 v7, 0xffff0000, v11
v_fmac_f32 v40, v7, v23
v_lshlrev_b32 v7, 16, v12
v_fmac_f32 v40, v7, v24
v_and_b32 v7, 0xffff0000, v12
v_fmac_f32 v40, v7, v25
v_lshlrev_b32 v7, 16, v13
v_fmac_f32 v40, v7, v26
v_and_b32 v7, 0xffff0000, v13
v_fmac_f32 v40, v7, v27
v_lshlrev_b32 v7, 16, v14
v_fmac_f32 v40, v7, v28
v_and_b32 v7, 0xffff0000, v14
v_fmac_f32 v40, v7, v29
v_lshlrev_b32 v7, 16, v15
v_fmac_f32 v40, v7, v30
v_and_b32 v7, 0xffff0000, v15
v_fmac_f32 v40, v7, v31
v_lshlrev_b32 v7, 16, v16
v_fmac_f32 v40, v7, v32
v_and_b32 v7, 0xffff0000, v16
v_fmac_f32 v40, v7, v33
v_lshlrev_b32 v7, 16, v17
v_fmac_f32 v40, v7, v34
v_and_b32 v7, 0xffff0000, v17
v_fmac_f32 v40, v7, v35
v_lshlrev_b32 v7, 16, v18
v_fmac_f32 v40, v7, v36
v_and_b32 v7, 0xffff0000, v18
v_fmac_f32 v40, v7, v37
v_mul_f32 v40, 0x3eae1a93, v40
v_cmp_gt_i32 vcc, 0, v5
v_mov_b32 v7, 0xce6e6b28
s_nop 1
v_cndmask_b32 v40, v40, v7, vcc
v_subrev_u32 v5, 2, v2
v_max_i32 v6, 0, v5
v_mul_u32_u24 v6, 3456, v6
v_add_u32 v6, v6, v3
buffer_load_dword v10, v6, s[4:7], 0 offen offset:1152
buffer_load_dword v11, v6, s[4:7], 0 offen offset:1156
buffer_load_dword v12, v6, s[4:7], 0 offen offset:1160
buffer_load_dword v13, v6, s[4:7], 0 offen offset:1164
buffer_load_dword v14, v6, s[4:7], 0 offen offset:1168
buffer_load_dword v15, v6, s[4:7], 0 offen offset:1172
buffer_load_dword v16, v6, s[4:7], 0 offen offset:1176
buffer_load_dword v17, v6, s[4:7], 0 offen offset:1180
buffer_load_dword v18, v6, s[4:7], 0 offen offset:1184
s_waitcnt vmcnt(0)
v_mov_b32 v41, 0
v_lshlrev_b32 v7, 16, v10
v_fmac_f32 v41, v7, v20
v_and_b32 v7, 0xffff0000, v10
v_fmac_f32 v41, v7, v21
v_lshlrev_b32 v7, 16, v11
v_fmac_f32 v41, v7, v22
v_and_b32 v7, 0xffff0000, v11
v_fmac_f32 v41, v7, v23
v_lshlrev_b32 v7, 16, v12
v_fmac_f32 v41, v7, v24
v_and_b32 v7, 0xffff0000, v12
v_fmac_f32 v41, v7, v25
v_lshlrev_b32 v7, 16, v13
v_fmac_f32 v41, v7, v26
v_and_b32 v7, 0xffff0000, v13
v_fmac_f32 v41, v7, v27
v_lshlrev_b32 v7, 16, v14
v_fmac_f32 v41, v7, v28
v_and_b32 v7, 0xffff0000, v14
v_fmac_f32 v41, v7, v29
v_lshlrev_b32 v7, 16, v15
v_fmac_f32 v41, v7, v30
v_and_b32 v7, 0xffff0000, v15
v_fmac_f32 v41, v7, v31
v_lshlrev_b32 v7, 16, v16
v_fmac_f32 v41, v7, v32
v_and_b32 v7, 0xffff0000, v16
v_fmac_f32 v41, v7, v33
v_lshlrev_b32 v7, 16, v17
v_fmac_f32 v41, v7, v34
v_and_b32 v7, 0xffff0000, v17
v_fmac_f32 v41, v7, v35
v_lshlrev_b32 v7, 16, v18
v_fmac_f32 v41, v7, v36
v_and_b32 v7, 0xffff0000, v18
v_fmac_f32 v41, v7, v37
v_mul_f32 v41, 0x3eae1a93, v41
v_cmp_gt_i32 vcc, 0, v5
v_mov_b32 v7, 0xce6e6b28
s_nop 1
v_cndmask_b32 v41, v41, v7, vcc
v_subrev_u32 v5, 4, v2
v_max_i32 v6, 0, v5
v_mul_u32_u24 v6, 3456, v6
v_add_u32 v6, v6, v3
buffer_load_dword v10, v6, s[4:7], 0 offen offset:1152
buffer_load_dword v11, v6, s[4:7], 0 offen offset:1156
buffer_load_dword v12, v6, s[4:7], 0 offen offset:1160
buffer_load_dword v13, v6, s[4:7], 0 offen offset:1164
buffer_load_dword v14, v6, s[4:7], 0 offen offset:1168
buffer_load_dword v15, v6, s[4:7], 0 offen offset:1172
buffer_load_dword v16, v6, s[4:7], 0 offen offset:1176
buffer_load_dword v17, v6, s[4:7], 0 offen offset:1180
buffer_load_dword v18, v6, s[4:7], 0 offen offset:1184
s_waitcnt vmcnt(0)
v_mov_b32 v42, 0
v_lshlrev_b32 v7, 16, v10
v_fmac_f32 v42, v7, v20
v_and_b32 v7, 0xffff0000, v10
v_fmac_f32 v42, v7, v21
v_lshlrev_b32 v7, 16, v11
v_fmac_f32 v42, v7, v22
v_and_b32 v7, 0xffff0000, v11
v_fmac_f32 v42, v7, v23
v_lshlrev_b32 v7, 16, v12
v_fmac_f32 v42, v7, v24
v_and_b32 v7, 0xffff0000, v12
v_fmac_f32 v42, v7, v25
v_lshlrev_b32 v7, 16, v13
v_fmac_f32 v42, v7, v26
v_and_b32 v7, 0xffff0000, v13
v_fmac_f32 v42, v7, v27
v_lshlrev_b32 v7, 16, v14
v_fmac_f32 v42, v7, v28
v_and_b32 v7, 0xffff0000, v14
v_fmac_f32 v42, v7, v29
v_lshlrev_b32 v7, 16, v15
v_fmac_f32 v42, v7, v30
v_and_b32 v7, 0xffff0000, v15
v_fmac_f32 v42, v7, v31
v_lshlrev_b32 v7, 16, v16
v_fmac_f32 v42, v7, v32
v_and_b32 v7, 0xffff0000, v16
v_fmac_f32 v42, v7, v33
v_lshlrev_b32 v7, 16, v17
v_fmac_f32 v42, v7, v34
v_and_b32 v7, 0xffff0000, v17
v_fmac_f32 v42, v7, v35
v_lshlrev_b32 v7, 16, v18
v_fmac_f32 v42, v7, v36
v_and_b32 v7, 0xffff0000, v18
v_fmac_f32 v42, v7, v37
v_mul_f32 v42, 0x3eae1a93, v42
v_cmp_gt_i32 vcc, 0, v5
v_mov_b32 v7, 0xce6e6b28
s_nop 1
v_cndmask_b32 v42, v42, v7, vcc
v_subrev_u32 v5, 6, v2
v_max_i32 v6, 0, v5
v_mul_u32_u24 v6, 3456, v6
v_add_u32 v6, v6, v3
buffer_load_dword v10, v6, s[4:7], 0 offen offset:1152
buffer_load_dword v11, v6, s[4:7], 0 offen offset:1156
buffer_load_dword v12, v6, s[4:7], 0 offen offset:1160
buffer_load_dword v13, v6, s[4:7], 0 offen offset:1164
buffer_load_dword v14, v6, s[4:7], 0 offen offset:1168
buffer_load_dword v15, v6, s[4:7], 0 offen offset:1172
buffer_load_dword v16, v6, s[4:7], 0 offen offset:1176
buffer_load_dword v17, v6, s[4:7], 0 offen offset:1180
buffer_load_dword v18, v6, s[4:7], 0 offen offset:1184
s_waitcnt vmcnt(0)
v_mov_b32 v43, 0
v_lshlrev_b32 v7, 16, v10
v_fmac_f32 v43, v7, v20
v_and_b32 v7, 0xffff0000, v10
v_fmac_f32 v43, v7, v21
v_lshlrev_b32 v7, 16, v11
v_fmac_f32 v43, v7, v22
v_and_b32 v7, 0xffff0000, v11
v_fmac_f32 v43, v7, v23
v_lshlrev_b32 v7, 16, v12
v_fmac_f32 v43, v7, v24
v_and_b32 v7, 0xffff0000, v12
v_fmac_f32 v43, v7, v25
v_lshlrev_b32 v7, 16, v13
v_fmac_f32 v43, v7, v26
v_and_b32 v7, 0xffff0000, v13
v_fmac_f32 v43, v7, v27
v_lshlrev_b32 v7, 16, v14
v_fmac_f32 v43, v7, v28
v_and_b32 v7, 0xffff0000, v14
v_fmac_f32 v43, v7, v29
v_lshlrev_b32 v7, 16, v15
v_fmac_f32 v43, v7, v30
v_and_b32 v7, 0xffff0000, v15
v_fmac_f32 v43, v7, v31
v_lshlrev_b32 v7, 16, v16
v_fmac_f32 v43, v7, v32
v_and_b32 v7, 0xffff0000, v16
v_fmac_f32 v43, v7, v33
v_lshlrev_b32 v7, 16, v17
v_fmac_f32 v43, v7, v34
v_and_b32 v7, 0xffff0000, v17
v_fmac_f32 v43, v7, v35
v_lshlrev_b32 v7, 16, v18
v_fmac_f32 v43, v7, v36
v_and_b32 v7, 0xffff0000, v18
v_fmac_f32 v43, v7, v37
v_mul_f32 v43, 0x3eae1a93, v43
v_cmp_gt_i32 vcc, 0, v5
v_mov_b32 v7, 0xce6e6b28
s_nop 1
v_cndmask_b32 v43, v43, v7, vcc
v_subrev_u32 v5, 8, v2
v_max_i32 v6, 0, v5
v_mul_u32_u24 v6, 3456, v6
v_add_u32 v6, v6, v3
buffer_load_dword v10, v6, s[4:7], 0 offen offset:1152
buffer_load_dword v11, v6, s[4:7], 0 offen offset:1156
buffer_load_dword v12, v6, s[4:7], 0 offen offset:1160
buffer_load_dword v13, v6, s[4:7], 0 offen offset:1164
buffer_load_dword v14, v6, s[4:7], 0 offen offset:1168
buffer_load_dword v15, v6, s[4:7], 0 offen offset:1172
buffer_load_dword v16, v6, s[4:7], 0 offen offset:1176
buffer_load_dword v17, v6, s[4:7], 0 offen offset:1180
buffer_load_dword v18, v6, s[4:7], 0 offen offset:1184
s_waitcnt vmcnt(0)
v_mov_b32 v44, 0
v_lshlrev_b32 v7, 16, v10
v_fmac_f32 v44, v7, v20
v_and_b32 v7, 0xffff0000, v10
v_fmac_f32 v44, v7, v21
v_lshlrev_b32 v7, 16, v11
v_fmac_f32 v44, v7, v22
v_and_b32 v7, 0xffff0000, v11
v_fmac_f32 v44, v7, v23
v_lshlrev_b32 v7, 16, v12
v_fmac_f32 v44, v7, v24
v_and_b32 v7, 0xffff0000, v12
v_fmac_f32 v44, v7, v25
v_lshlrev_b32 v7, 16, v13
v_fmac_f32 v44, v7, v26
v_and_b32 v7, 0xffff0000, v13
v_fmac_f32 v44, v7, v27
v_lshlrev_b32 v7, 16, v14
v_fmac_f32 v44, v7, v28
v_and_b32 v7, 0xffff0000, v14
v_fmac_f32 v44, v7, v29
v_lshlrev_b32 v7, 16, v15
v_fmac_f32 v44, v7, v30
v_and_b32 v7, 0xffff0000, v15
v_fmac_f32 v44, v7, v31
v_lshlrev_b32 v7, 16, v16
v_fmac_f32 v44, v7, v32
v_and_b32 v7, 0xffff0000, v16
v_fmac_f32 v44, v7, v33
v_lshlrev_b32 v7, 16, v17
v_fmac_f32 v44, v7, v34
v_and_b32 v7, 0xffff0000, v17
v_fmac_f32 v44, v7, v35
v_lshlrev_b32 v7, 16, v18
v_fmac_f32 v44, v7, v36
v_and_b32 v7, 0xffff0000, v18
v_fmac_f32 v44, v7, v37
v_mul_f32 v44, 0x3eae1a93, v44
v_cmp_gt_i32 vcc, 0, v5
v_mov_b32 v7, 0xce6e6b28
s_nop 1
v_cndmask_b32 v44, v44, v7, vcc
v_subrev_u32 v5, 10, v2
v_max_i32 v6, 0, v5
v_mul_u32_u24 v6, 3456, v6
v_add_u32 v6, v6, v3
buffer_load_dword v10, v6, s[4:7], 0 offen offset:1152
buffer_load_dword v11, v6, s[4:7], 0 offen offset:1156
buffer_load_dword v12, v6, s[4:7], 0 offen offset:1160
buffer_load_dword v13, v6, s[4:7], 0 offen offset:1164
buffer_load_dword v14, v6, s[4:7], 0 offen offset:1168
buffer_load_dword v15, v6, s[4:7], 0 offen offset:1172
buffer_load_dword v16, v6, s[4:7], 0 offen offset:1176
buffer_load_dword v17, v6, s[4:7], 0 offen offset:1180
buffer_load_dword v18, v6, s[4:7], 0 offen offset:1184
s_waitcnt vmcnt(0)
v_mov_b32 v45, 0
v_lshlrev_b32 v7, 16, v10
v_fmac_f32 v45, v7, v20
v_and_b32 v7, 0xffff0000, v10
v_fmac_f32 v45, v7, v21
v_lshlrev_b32 v7, 16, v11
v_fmac_f32 v45, v7, v22
v_and_b32 v7, 0xffff0000, v11
v_fmac_f32 v45, v7, v23
v_lshlrev_b32 v7, 16, v12
v_fmac_f32 v45, v7, v24
v_and_b32 v7, 0xffff0000, v12
v_fmac_f32 v45, v7, v25
v_lshlrev_b32 v7, 16, v13
v_fmac_f32 v45, v7, v26
v_and_b32 v7, 0xffff0000, v13
v_fmac_f32 v45, v7, v27
v_lshlrev_b32 v7, 16, v14
v_fmac_f32 v45, v7, v28
v_and_b32 v7, 0xffff0000, v14
v_fmac_f32 v45, v7, v29
v_lshlrev_b32 v7, 16, v15
v_fmac_f32 v45, v7, v30
v_and_b32 v7, 0xffff0000, v15
v_fmac_f32 v45, v7, v31
v_lshlrev_b32 v7, 16, v16
v_fmac_f32 v45, v7, v32
v_and_b32 v7, 0xffff0000, v16
v_fmac_f32 v45, v7, v33
v_lshlrev_b32 v7, 16, v17
v_fmac_f32 v45, v7, v34
v_and_b32 v7, 0xffff0000, v17
v_fmac_f32 v45, v7, v35
v_lshlrev_b32 v7, 16, v18
v_fmac_f32 v45, v7, v36
v_and_b32 v7, 0xffff0000, v18
v_fmac_f32 v45, v7, v37
v_mul_f32 v45, 0x3eae1a93, v45
v_cmp_gt_i32 vcc, 0, v5
v_mov_b32 v7, 0xce6e6b28
s_nop 1
v_cndmask_b32 v45, v45, v7, vcc
v_subrev_u32 v5, 12, v2
v_max_i32 v6, 0, v5
v_mul_u32_u24 v6, 3456, v6
v_add_u32 v6, v6, v3
buffer_load_dword v10, v6, s[4:7], 0 offen offset:1152
buffer_load_dword v11, v6, s[4:7], 0 offen offset:1156
buffer_load_dword v12, v6, s[4:7], 0 offen offset:1160
buffer_load_dword v13, v6, s[4:7], 0 offen offset:1164
buffer_load_dword v14, v6, s[4:7], 0 offen offset:1168
buffer_load_dword v15, v6, s[4:7], 0 offen offset:1172
buffer_load_dword v16, v6, s[4:7], 0 offen offset:1176
buffer_load_dword v17, v6, s[4:7], 0 offen offset:1180
buffer_load_dword v18, v6, s[4:7], 0 offen offset:1184
s_waitcnt vmcnt(0)
v_mov_b32 v46, 0
v_lshlrev_b32 v7, 16, v10
v_fmac_f32 v46, v7, v20
v_and_b32 v7, 0xffff0000, v10
v_fmac_f32 v46, v7, v21
v_lshlrev_b32 v7, 16, v11
v_fmac_f32 v46, v7, v22
v_and_b32 v7, 0xffff0000, v11
v_fmac_f32 v46, v7, v23
v_lshlrev_b32 v7, 16, v12
v_fmac_f32 v46, v7, v24
v_and_b32 v7, 0xffff0000, v12
v_fmac_f32 v46, v7, v25
v_lshlrev_b32 v7, 16, v13
v_fmac_f32 v46, v7, v26
v_and_b32 v7, 0xffff0000, v13
v_fmac_f32 v46, v7, v27
v_lshlrev_b32 v7, 16, v14
v_fmac_f32 v46, v7, v28
v_and_b32 v7, 0xffff0000, v14
v_fmac_f32 v46, v7, v29
v_lshlrev_b32 v7, 16, v15
v_fmac_f32 v46, v7, v30
v_and_b32 v7, 0xffff0000, v15
v_fmac_f32 v46, v7, v31
v_lshlrev_b32 v7, 16, v16
v_fmac_f32 v46, v7, v32
v_and_b32 v7, 0xffff0000, v16
v_fmac_f32 v46, v7, v33
v_lshlrev_b32 v7, 16, v17
v_fmac_f32 v46, v7, v34
v_and_b32 v7, 0xffff0000, v17
v_fmac_f32 v46, v7, v35
v_lshlrev_b32 v7, 16, v18
v_fmac_f32 v46, v7, v36
v_and_b32 v7, 0xffff0000, v18
v_fmac_f32 v46, v7, v37
v_mul_f32 v46, 0x3eae1a93, v46
v_cmp_gt_i32 vcc, 0, v5
v_mov_b32 v7, 0xce6e6b28
s_nop 1
v_cndmask_b32 v46, v46, v7, vcc
v_subrev_u32 v5, 14, v2
v_max_i32 v6, 0, v5
v_mul_u32_u24 v6, 3456, v6
v_add_u32 v6, v6, v3
buffer_load_dword v10, v6, s[4:7], 0 offen offset:1152
buffer_load_dword v11, v6, s[4:7], 0 offen offset:1156
buffer_load_dword v12, v6, s[4:7], 0 offen offset:1160
buffer_load_dword v13, v6, s[4:7], 0 offen offset:1164
buffer_load_dword v14, v6, s[4:7], 0 offen offset:1168
buffer_load_dword v15, v6, s[4:7], 0 offen offset:1172
buffer_load_dword v16, v6, s[4:7], 0 offen offset:1176
buffer_load_dword v17, v6, s[4:7], 0 offen offset:1180
buffer_load_dword v18, v6, s[4:7], 0 offen offset:1184
s_waitcnt vmcnt(0)
v_mov_b32 v47, 0
v_lshlrev_b32 v7, 16, v10
v_fmac_f32 v47, v7, v20
v_and_b32 v7, 0xffff0000, v10
v_fmac_f32 v47, v7, v21
v_lshlrev_b32 v7, 16, v11
v_fmac_f32 v47, v7, v22
v_and_b32 v7, 0xffff0000, v11
v_fmac_f32 v47, v7, v23
v_lshlrev_b32 v7, 16, v12
v_fmac_f32 v47, v7, v24
v_and_b32 v7, 0xffff0000, v12
v_fmac_f32 v47, v7, v25
v_lshlrev_b32 v7, 16, v13
v_fmac_f32 v47, v7, v26
v_and_b32 v7, 0xffff0000, v13
v_fmac_f32 v47, v7, v27
v_lshlrev_b32 v7, 16, v14
v_fmac_f32 v47, v7, v28
v_and_b32 v7, 0xffff0000, v14
v_fmac_f32 v47, v7, v29
v_lshlrev_b32 v7, 16, v15
v_fmac_f32 v47, v7, v30
v_and_b32 v7, 0xffff0000, v15
v_fmac_f32 v47, v7, v31
v_lshlrev_b32 v7, 16, v16
v_fmac_f32 v47, v7, v32
v_and_b32 v7, 0xffff0000, v16
v_fmac_f32 v47, v7, v33
v_lshlrev_b32 v7, 16, v17
v_fmac_f32 v47, v7, v34
v_and_b32 v7, 0xffff0000, v17
v_fmac_f32 v47, v7, v35
v_lshlrev_b32 v7, 16, v18
v_fmac_f32 v47, v7, v36
v_and_b32 v7, 0xffff0000, v18
v_fmac_f32 v47, v7, v37
v_mul_f32 v47, 0x3eae1a93, v47
v_cmp_gt_i32 vcc, 0, v5
v_mov_b32 v7, 0xce6e6b28
s_nop 1
v_cndmask_b32 v47, v47, v7, vcc
v_max3_f32 v8, v40, v41, v42
v_max3_f32 v8, v8, v43, v44
v_max3_f32 v8, v8, v45, v46
v_max_f32 v8, v8, v47
v_mov_b32 v9, 0
v_sub_f32 v40, v40, v8
v_exp_f32 v40, v40
s_nop 0
v_add_f32 v9, v9, v40
v_sub_f32 v41, v41, v8
v_exp_f32 v41, v41
s_nop 0
v_add_f32 v9, v9, v41
v_sub_f32 v42, v42, v8
v_exp_f32 v42, v42
s_nop 0
v_add_f32 v9, v9, v42
v_sub_f32 v43, v43, v8
v_exp_f32 v43, v43
s_nop 0
v_add_f32 v9, v9, v43
v_sub_f32 v44, v44, v8
v_exp_f32 v44, v44
s_nop 0
v_add_f32 v9, v9, v44
v_sub_f32 v45, v45, v8
v_exp_f32 v45, v45
s_nop 0
v_add_f32 v9, v9, v45
v_sub_f32 v46, v46, v8
v_exp_f32 v46, v46
s_nop 0
v_add_f32 v9, v9, v46
v_sub_f32 v47, v47, v8
v_exp_f32 v47, v47
s_nop 0
v_add_f32 v9, v9, v47
v_rcp_f32 v9, v9
s_nop 0
v_mul_f32 v40, v40, v9
v_mul_f32 v41, v41, v9
v_mul_f32 v42, v42, v9
v_mul_f32 v43, v43, v9
v_mul_f32 v44, v44, v9
v_mul_f32 v45, v45, v9
v_mul_f32 v46, v46, v9
v_mul_f32 v47, v47, v9
v_mov_b32 v20, 0
v_mov_b32 v21, 0
v_mov_b32 v22, 0
v_mov_b32 v23, 0
v_mov_b32 v24, 0
v_mov_b32 v25, 0
v_mov_b32 v26, 0
v_mov_b32 v27, 0
v_mov_b32 v28, 0
v_mov_b32 v29, 0
v_mov_b32 v30, 0
v_mov_b32 v31, 0
v_mov_b32 v32, 0
v_mov_b32 v33, 0
v_mov_b32 v34, 0
v_mov_b32 v35, 0
v_mov_b32 v36, 0
v_mov_b32 v37, 0
v_subrev_u32 v5, 0, v2
v_max_i32 v6, 0, v5
v_mul_u32_u24 v6, 3456, v6
v_add_u32 v6, v6, v3
buffer_load_dword v10, v6, s[4:7], 0 offen offset:2304
buffer_load_dword v11, v6, s[4:7], 0 offen offset:2308
buffer_load_dword v12, v6, s[4:7], 0 offen offset:2312
buffer_load_dword v13, v6, s[4:7], 0 offen offset:2316
buffer_load_dword v14, v6, s[4:7], 0 offen offset:2320
buffer_load_dword v15, v6, s[4:7], 0 offen offset:2324
buffer_load_dword v16, v6, s[4:7], 0 offen offset:2328
buffer_load_dword v17, v6, s[4:7], 0 offen offset:2332
buffer_load_dword v18, v6, s[4:7], 0 offen offset:2336
s_waitcnt vmcnt(0)
v_lshlrev_b32 v7, 16, v10
v_fmac_f32 v20, v7, v40
v_and_b32 v7, 0xffff0000, v10
v_fmac_f32 v21, v7, v40
v_lshlrev_b32 v7, 16, v11
v_fmac_f32 v22, v7, v40
v_and_b32 v7, 0xffff0000, v11
v_fmac_f32 v23, v7, v40
v_lshlrev_b32 v7, 16, v12
v_fmac_f32 v24, v7, v40
v_and_b32 v7, 0xffff0000, v12
v_fmac_f32 v25, v7, v40
v_lshlrev_b32 v7, 16, v13
v_fmac_f32 v26, v7, v40
v_and_b32 v7, 0xffff0000, v13
v_fmac_f32 v27, v7, v40
v_lshlrev_b32 v7, 16, v14
v_fmac_f32 v28, v7, v40
v_and_b32 v7, 0xffff0000, v14
v_fmac_f32 v29, v7, v40
v_lshlrev_b32 v7, 16, v15
v_fmac_f32 v30, v7, v40
v_and_b32 v7, 0xffff0000, v15
v_fmac_f32 v31, v7, v40
v_lshlrev_b32 v7, 16, v16
v_fmac_f32 v32, v7, v40
v_and_b32 v7, 0xffff0000, v16
v_fmac_f32 v33, v7, v40
v_lshlrev_b32 v7, 16, v17
v_fmac_f32 v34, v7, v40
v_and_b32 v7, 0xffff0000, v17
v_fmac_f32 v35, v7, v40
v_lshlrev_b32 v7, 16, v18
v_fmac_f32 v36, v7, v40
v_and_b32 v7, 0xffff0000, v18
v_fmac_f32 v37, v7, v40
v_subrev_u32 v5, 2, v2
v_max_i32 v6, 0, v5
v_mul_u32_u24 v6, 3456, v6
v_add_u32 v6, v6, v3
buffer_load_dword v10, v6, s[4:7], 0 offen offset:2304
buffer_load_dword v11, v6, s[4:7], 0 offen offset:2308
buffer_load_dword v12, v6, s[4:7], 0 offen offset:2312
buffer_load_dword v13, v6, s[4:7], 0 offen offset:2316
buffer_load_dword v14, v6, s[4:7], 0 offen offset:2320
buffer_load_dword v15, v6, s[4:7], 0 offen offset:2324
buffer_load_dword v16, v6, s[4:7], 0 offen offset:2328
buffer_load_dword v17, v6, s[4:7], 0 offen offset:2332
buffer_load_dword v18, v6, s[4:7], 0 offen offset:2336
s_waitcnt vmcnt(0)
v_lshlrev_b32 v7, 16, v10
v_fmac_f32 v20, v7, v41
v_and_b32 v7, 0xffff0000, v10
v_fmac_f32 v21, v7, v41
v_lshlrev_b32 v7, 16, v11
v_fmac_f32 v22, v7, v41
v_and_b32 v7, 0xffff0000, v11
v_fmac_f32 v23, v7, v41
v_lshlrev_b32 v7, 16, v12
v_fmac_f32 v24, v7, v41
v_and_b32 v7, 0xffff0000, v12
v_fmac_f32 v25, v7, v41
v_lshlrev_b32 v7, 16, v13
v_fmac_f32 v26, v7, v41
v_and_b32 v7, 0xffff0000, v13
v_fmac_f32 v27, v7, v41
v_lshlrev_b32 v7, 16, v14
v_fmac_f32 v28, v7, v41
v_and_b32 v7, 0xffff0000, v14
v_fmac_f32 v29, v7, v41
v_lshlrev_b32 v7, 16, v15
v_fmac_f32 v30, v7, v41
v_and_b32 v7, 0xffff0000, v15
v_fmac_f32 v31, v7, v41
v_lshlrev_b32 v7, 16, v16
v_fmac_f32 v32, v7, v41
v_and_b32 v7, 0xffff0000, v16
v_fmac_f32 v33, v7, v41
v_lshlrev_b32 v7, 16, v17
v_fmac_f32 v34, v7, v41
v_and_b32 v7, 0xffff0000, v17
v_fmac_f32 v35, v7, v41
v_lshlrev_b32 v7, 16, v18
v_fmac_f32 v36, v7, v41
v_and_b32 v7, 0xffff0000, v18
v_fmac_f32 v37, v7, v41
v_subrev_u32 v5, 4, v2
v_max_i32 v6, 0, v5
v_mul_u32_u24 v6, 3456, v6
v_add_u32 v6, v6, v3
buffer_load_dword v10, v6, s[4:7], 0 offen offset:2304
buffer_load_dword v11, v6, s[4:7], 0 offen offset:2308
buffer_load_dword v12, v6, s[4:7], 0 offen offset:2312
buffer_load_dword v13, v6, s[4:7], 0 offen offset:2316
buffer_load_dword v14, v6, s[4:7], 0 offen offset:2320
buffer_load_dword v15, v6, s[4:7], 0 offen offset:2324
buffer_load_dword v16, v6, s[4:7], 0 offen offset:2328
buffer_load_dword v17, v6, s[4:7], 0 offen offset:2332
buffer_load_dword v18, v6, s[4:7], 0 offen offset:2336
s_waitcnt vmcnt(0)
v_lshlrev_b32 v7, 16, v10
v_fmac_f32 v20, v7, v42
v_and_b32 v7, 0xffff0000, v10
v_fmac_f32 v21, v7, v42
v_lshlrev_b32 v7, 16, v11
v_fmac_f32 v22, v7, v42
v_and_b32 v7, 0xffff0000, v11
v_fmac_f32 v23, v7, v42
v_lshlrev_b32 v7, 16, v12
v_fmac_f32 v24, v7, v42
v_and_b32 v7, 0xffff0000, v12
v_fmac_f32 v25, v7, v42
v_lshlrev_b32 v7, 16, v13
v_fmac_f32 v26, v7, v42
v_and_b32 v7, 0xffff0000, v13
v_fmac_f32 v27, v7, v42
v_lshlrev_b32 v7, 16, v14
v_fmac_f32 v28, v7, v42
v_and_b32 v7, 0xffff0000, v14
v_fmac_f32 v29, v7, v42
v_lshlrev_b32 v7, 16, v15
v_fmac_f32 v30, v7, v42
v_and_b32 v7, 0xffff0000, v15
v_fmac_f32 v31, v7, v42
v_lshlrev_b32 v7, 16, v16
v_fmac_f32 v32, v7, v42
v_and_b32 v7, 0xffff0000, v16
v_fmac_f32 v33, v7, v42
v_lshlrev_b32 v7, 16, v17
v_fmac_f32 v34, v7, v42
v_and_b32 v7, 0xffff0000, v17
v_fmac_f32 v35, v7, v42
v_lshlrev_b32 v7, 16, v18
v_fmac_f32 v36, v7, v42
v_and_b32 v7, 0xffff0000, v18
v_fmac_f32 v37, v7, v42
v_subrev_u32 v5, 6, v2
v_max_i32 v6, 0, v5
v_mul_u32_u24 v6, 3456, v6
v_add_u32 v6, v6, v3
buffer_load_dword v10, v6, s[4:7], 0 offen offset:2304
buffer_load_dword v11, v6, s[4:7], 0 offen offset:2308
buffer_load_dword v12, v6, s[4:7], 0 offen offset:2312
buffer_load_dword v13, v6, s[4:7], 0 offen offset:2316
buffer_load_dword v14, v6, s[4:7], 0 offen offset:2320
buffer_load_dword v15, v6, s[4:7], 0 offen offset:2324
buffer_load_dword v16, v6, s[4:7], 0 offen offset:2328
buffer_load_dword v17, v6, s[4:7], 0 offen offset:2332
buffer_load_dword v18, v6, s[4:7], 0 offen offset:2336
s_waitcnt vmcnt(0)
v_lshlrev_b32 v7, 16, v10
v_fmac_f32 v20, v7, v43
v_and_b32 v7, 0xffff0000, v10
v_fmac_f32 v21, v7, v43
v_lshlrev_b32 v7, 16, v11
v_fmac_f32 v22, v7, v43
v_and_b32 v7, 0xffff0000, v11
v_fmac_f32 v23, v7, v43
v_lshlrev_b32 v7, 16, v12
v_fmac_f32 v24, v7, v43
v_and_b32 v7, 0xffff0000, v12
v_fmac_f32 v25, v7, v43
v_lshlrev_b32 v7, 16, v13
v_fmac_f32 v26, v7, v43
v_and_b32 v7, 0xffff0000, v13
v_fmac_f32 v27, v7, v43
v_lshlrev_b32 v7, 16, v14
v_fmac_f32 v28, v7, v43
v_and_b32 v7, 0xffff0000, v14
v_fmac_f32 v29, v7, v43
v_lshlrev_b32 v7, 16, v15
v_fmac_f32 v30, v7, v43
v_and_b32 v7, 0xffff0000, v15
v_fmac_f32 v31, v7, v43
v_lshlrev_b32 v7, 16, v16
v_fmac_f32 v32, v7, v43
v_and_b32 v7, 0xffff0000, v16
v_fmac_f32 v33, v7, v43
v_lshlrev_b32 v7, 16, v17
v_fmac_f32 v34, v7, v43
v_and_b32 v7, 0xffff0000, v17
v_fmac_f32 v35, v7, v43
v_lshlrev_b32 v7, 16, v18
v_fmac_f32 v36, v7, v43
v_and_b32 v7, 0xffff0000, v18
v_fmac_f32 v37, v7, v43
v_subrev_u32 v5, 8, v2
v_max_i32 v6, 0, v5
v_mul_u32_u24 v6, 3456, v6
v_add_u32 v6, v6, v3
buffer_load_dword v10, v6, s[4:7], 0 offen offset:2304
buffer_load_dword v11, v6, s[4:7], 0 offen offset:2308
buffer_load_dword v12, v6, s[4:7], 0 offen offset:2312
buffer_load_dword v13, v6, s[4:7], 0 offen offset:2316
buffer_load_dword v14, v6, s[4:7], 0 offen offset:2320
buffer_load_dword v15, v6, s[4:7], 0 offen offset:2324
buffer_load_dword v16, v6, s[4:7], 0 offen offset:2328
buffer_load_dword v17, v6, s[4:7], 0 offen offset:2332
buffer_load_dword v18, v6, s[4:7], 0 offen offset:2336
s_waitcnt vmcnt(0)
v_lshlrev_b32 v7, 16, v10
v_fmac_f32 v20, v7, v44
v_and_b32 v7, 0xffff0000, v10
v_fmac_f32 v21, v7, v44
v_lshlrev_b32 v7, 16, v11
v_fmac_f32 v22, v7, v44
v_and_b32 v7, 0xffff0000, v11
v_fmac_f32 v23, v7, v44
v_lshlrev_b32 v7, 16, v12
v_fmac_f32 v24, v7, v44
v_and_b32 v7, 0xffff0000, v12
v_fmac_f32 v25, v7, v44
v_lshlrev_b32 v7, 16, v13
v_fmac_f32 v26, v7, v44
v_and_b32 v7, 0xffff0000, v13
v_fmac_f32 v27, v7, v44
v_lshlrev_b32 v7, 16, v14
v_fmac_f32 v28, v7, v44
v_and_b32 v7, 0xffff0000, v14
v_fmac_f32 v29, v7, v44
v_lshlrev_b32 v7, 16, v15
v_fmac_f32 v30, v7, v44
v_and_b32 v7, 0xffff0000, v15
v_fmac_f32 v31, v7, v44
v_lshlrev_b32 v7, 16, v16
v_fmac_f32 v32, v7, v44
v_and_b32 v7, 0xffff0000, v16
v_fmac_f32 v33, v7, v44
v_lshlrev_b32 v7, 16, v17
v_fmac_f32 v34, v7, v44
v_and_b32 v7, 0xffff0000, v17
v_fmac_f32 v35, v7, v44
v_lshlrev_b32 v7, 16, v18
v_fmac_f32 v36, v7, v44
v_and_b32 v7, 0xffff0000, v18
v_fmac_f32 v37, v7, v44
v_subrev_u32 v5, 10, v2
v_max_i32 v6, 0, v5
v_mul_u32_u24 v6, 3456, v6
v_add_u32 v6, v6, v3
buffer_load_dword v10, v6, s[4:7], 0 offen offset:2304
buffer_load_dword v11, v6, s[4:7], 0 offen offset:2308
buffer_load_dword v12, v6, s[4:7], 0 offen offset:2312
buffer_load_dword v13, v6, s[4:7], 0 offen offset:2316
buffer_load_dword v14, v6, s[4:7], 0 offen offset:2320
buffer_load_dword v15, v6, s[4:7], 0 offen offset:2324
buffer_load_dword v16, v6, s[4:7], 0 offen offset:2328
buffer_load_dword v17, v6, s[4:7], 0 offen offset:2332
buffer_load_dword v18, v6, s[4:7], 0 offen offset:2336
s_waitcnt vmcnt(0)
v_lshlrev_b32 v7, 16, v10
v_fmac_f32 v20, v7, v45
v_and_b32 v7, 0xffff0000, v10
v_fmac_f32 v21, v7, v45
v_lshlrev_b32 v7, 16, v11
v_fmac_f32 v22, v7, v45
v_and_b32 v7, 0xffff0000, v11
v_fmac_f32 v23, v7, v45
v_lshlrev_b32 v7, 16, v12
v_fmac_f32 v24, v7, v45
v_and_b32 v7, 0xffff0000, v12
v_fmac_f32 v25, v7, v45
v_lshlrev_b32 v7, 16, v13
v_fmac_f32 v26, v7, v45
v_and_b32 v7, 0xffff0000, v13
v_fmac_f32 v27, v7, v45
v_lshlrev_b32 v7, 16, v14
v_fmac_f32 v28, v7, v45
v_and_b32 v7, 0xffff0000, v14
v_fmac_f32 v29, v7, v45
v_lshlrev_b32 v7, 16, v15
v_fmac_f32 v30, v7, v45
v_and_b32 v7, 0xffff0000, v15
v_fmac_f32 v31, v7, v45
v_lshlrev_b32 v7, 16, v16
v_fmac_f32 v32, v7, v45
v_and_b32 v7, 0xffff0000, v16
v_fmac_f32 v33, v7, v45
v_lshlrev_b32 v7, 16, v17
v_fmac_f32 v34, v7, v45
v_and_b32 v7, 0xffff0000, v17
v_fmac_f32 v35, v7, v45
v_lshlrev_b32 v7, 16, v18
v_fmac_f32 v36, v7, v45
v_and_b32 v7, 0xffff0000, v18
v_fmac_f32 v37, v7, v45
v_subrev_u32 v5, 12, v2
v_max_i32 v6, 0, v5
v_mul_u32_u24 v6, 3456, v6
v_add_u32 v6, v6, v3
buffer_load_dword v10, v6, s[4:7], 0 offen offset:2304
buffer_load_dword v11, v6, s[4:7], 0 offen offset:2308
buffer_load_dword v12, v6, s[4:7], 0 offen offset:2312
buffer_load_dword v13, v6, s[4:7], 0 offen offset:2316
buffer_load_dword v14, v6, s[4:7], 0 offen offset:2320
buffer_load_dword v15, v6, s[4:7], 0 offen offset:2324
buffer_load_dword v16, v6, s[4:7], 0 offen offset:2328
buffer_load_dword v17, v6, s[4:7], 0 offen offset:2332
buffer_load_dword v18, v6, s[4:7], 0 offen offset:2336
s_waitcnt vmcnt(0)
v_lshlrev_b32 v7, 16, v10
v_fmac_f32 v20, v7, v46
v_and_b32 v7, 0xffff0000, v10
v_fmac_f32 v21, v7, v46
v_lshlrev_b32 v7, 16, v11
v_fmac_f32 v22, v7, v46
v_and_b32 v7, 0xffff0000, v11
v_fmac_f32 v23, v7, v46
v_lshlrev_b32 v7, 16, v12
v_fmac_f32 v24, v7, v46
v_and_b32 v7, 0xffff0000, v12
v_fmac_f32 v25, v7, v46
v_lshlrev_b32 v7, 16, v13
v_fmac_f32 v26, v7, v46
v_and_b32 v7, 0xffff0000, v13
v_fmac_f32 v27, v7, v46
v_lshlrev_b32 v7, 16, v14
v_fmac_f32 v28, v7, v46
v_and_b32 v7, 0xffff0000, v14
v_fmac_f32 v29, v7, v46
v_lshlrev_b32 v7, 16, v15
v_fmac_f32 v30, v7, v46
v_and_b32 v7, 0xffff0000, v15
v_fmac_f32 v31, v7, v46
v_lshlrev_b32 v7, 16, v16
v_fmac_f32 v32, v7, v46
v_and_b32 v7, 0xffff0000, v16
v_fmac_f32 v33, v7, v46
v_lshlrev_b32 v7, 16, v17
v_fmac_f32 v34, v7, v46
v_and_b32 v7, 0xffff0000, v17
v_fmac_f32 v35, v7, v46
v_lshlrev_b32 v7, 16, v18
v_fmac_f32 v36, v7, v46
v_and_b32 v7, 0xffff0000, v18
v_fmac_f32 v37, v7, v46
v_subrev_u32 v5, 14, v2
v_max_i32 v6, 0, v5
v_mul_u32_u24 v6, 3456, v6
v_add_u32 v6, v6, v3
buffer_load_dword v10, v6, s[4:7], 0 offen offset:2304
buffer_load_dword v11, v6, s[4:7], 0 offen offset:2308
buffer_load_dword v12, v6, s[4:7], 0 offen offset:2312
buffer_load_dword v13, v6, s[4:7], 0 offen offset:2316
buffer_load_dword v14, v6, s[4:7], 0 offen offset:2320
buffer_load_dword v15, v6, s[4:7], 0 offen offset:2324
buffer_load_dword v16, v6, s[4:7], 0 offen offset:2328
buffer_load_dword v17, v6, s[4:7], 0 offen offset:2332
buffer_load_dword v18, v6, s[4:7], 0 offen offset:2336
s_waitcnt vmcnt(0)
v_lshlrev_b32 v7, 16, v10
v_fmac_f32 v20, v7, v47
v_and_b32 v7, 0xffff0000, v10
v_fmac_f32 v21, v7, v47
v_lshlrev_b32 v7, 16, v11
v_fmac_f32 v22, v7, v47
v_and_b32 v7, 0xffff0000, v11
v_fmac_f32 v23, v7, v47
v_lshlrev_b32 v7, 16, v12
v_fmac_f32 v24, v7, v47
v_and_b32 v7, 0xffff0000, v12
v_fmac_f32 v25, v7, v47
v_lshlrev_b32 v7, 16, v13
v_fmac_f32 v26, v7, v47
v_and_b32 v7, 0xffff0000, v13
v_fmac_f32 v27, v7, v47
v_lshlrev_b32 v7, 16, v14
v_fmac_f32 v28, v7, v47
v_and_b32 v7, 0xffff0000, v14
v_fmac_f32 v29, v7, v47
v_lshlrev_b32 v7, 16, v15
v_fmac_f32 v30, v7, v47
v_and_b32 v7, 0xffff0000, v15
v_fmac_f32 v31, v7, v47
v_lshlrev_b32 v7, 16, v16
v_fmac_f32 v32, v7, v47
v_and_b32 v7, 0xffff0000, v16
v_fmac_f32 v33, v7, v47
v_lshlrev_b32 v7, 16, v17
v_fmac_f32 v34, v7, v47
v_and_b32 v7, 0xffff0000, v17
v_fmac_f32 v35, v7, v47
v_lshlrev_b32 v7, 16, v18
v_fmac_f32 v36, v7, v47
v_and_b32 v7, 0xffff0000, v18
v_fmac_f32 v37, v7, v47
v_mul_u32_u24 v4, 1152, v2
v_add_u32 v4, v4, v3
v_cvt_pk_bf16_f32 v10, v20, v21
buffer_store_dword v10, v4, s[8:11], 0 offen offset:0
v_cvt_pk_bf16_f32 v11, v22, v23
buffer_store_dword v11, v4, s[8:11], 0 offen offset:4
v_cvt_pk_bf16_f32 v12, v24, v25
buffer_store_dword v12, v4, s[8:11], 0 offen offset:8
v_cvt_pk_bf16_f32 v13, v26, v27
buffer_store_dword v13, v4, s[8:11], 0 offen offset:12
v_cvt_pk_bf16_f32 v14, v28, v29
buffer_store_dword v14, v4, s[8:11], 0 offen offset:16
v_cvt_pk_bf16_f32 v15, v30, v31
buffer_store_dword v15, v4, s[8:11], 0 offen offset:20
v_cvt_pk_bf16_f32 v16, v32, v33
buffer_store_dword v16, v4, s[8:11], 0 offen offset:24
v_cvt_pk_bf16_f32 v17, v34, v35
buffer_store_dword v17, v4, s[8:11], 0 offen offset:28
v_cvt_pk_bf16_f32 v18, v36, v37
buffer_store_dword v18, v4, s[8:11], 0 offen offset:32
L_attn_kernel_end:
s_endpgm
.globl wo_0_kernel
.p2align 8
.type wo_0_kernel,@function
wo_0_kernel:
s_cmp_ge_u32 s2, 1152
s_cbranch_scc1 L_wo_0_kernel_end
s_load_dwordx2 s[4:5], s[0:1], 80
s_waitcnt lgkmcnt(0)
s_add_u32 s4, s4, 9437184
s_addc_u32 s5, s5, 0
s_mov_b32 s6, 2359296
s_mov_b32 s7, 0x20000
s_load_dwordx2 s[8:9], s[0:1], 16
s_waitcnt lgkmcnt(0)
s_mov_b32 s10, 663552
s_mov_b32 s11, 0x20000
s_load_dwordx2 s[12:13], s[0:1], 80
s_waitcnt lgkmcnt(0)
s_add_u32 s12, s12, 11796480
s_addc_u32 s13, s13, 0
s_mov_b32 s14, 2359296
s_mov_b32 s15, 0x20000
s_load_dwordx2 s[16:17], s[0:1], 0
s_waitcnt lgkmcnt(0)
s_mov_b32 s18, 2359296
s_mov_b32 s19, 0x20000
s_and_b32 s24, s2, 63
s_lshr_b32 s25, s2, 6
s_lshl_b32 s24, s24, 5
s_lshl_b32 s25, s25, 5
v_and_b32 v1, 31, v0
v_lshrrev_b32 v2, 5, v0
v_add_u32 v3, s24, v1
s_mov_b32 s26, 1152
v_mul_lo_u32 v4, v3, s26
v_lshlrev_b32 v5, 4, v2
v_add_u32 v4, v4, v5
v_add_u32 v5, s25, v1
v_lshlrev_b32 v5, 1, v5
s_mov_b32 s26, 9216
v_mul_lo_u32 v6, v2, s26
v_add_u32 v5, v5, v6
v_mov_b32 v32, 0
v_mov_b32 v33, 0
v_mov_b32 v34, 0
v_mov_b32 v35, 0
v_mov_b32 v36, 0
v_mov_b32 v37, 0
v_mov_b32 v38, 0
v_mov_b32 v39, 0
v_mov_b32 v40, 0
v_mov_b32 v41, 0
v_mov_b32 v42, 0
v_mov_b32 v43, 0
v_mov_b32 v44, 0
v_mov_b32 v45, 0
v_mov_b32 v46, 0
v_mov_b32 v47, 0
s_mov_b32 s27, 0
s_mov_b32 s28, 0
s_mov_b32 s29, 0
L_wo_0_kernel_k:
buffer_load_dwordx4 v[8:11], v4, s[4:7], s28 offen
s_add_u32 s30, s29, 0
buffer_load_ushort v20, v5, s[8:11], s30 offen
s_add_u32 s30, s29, 1152
buffer_load_ushort v21, v5, s[8:11], s30 offen
s_add_u32 s30, s29, 2304
buffer_load_ushort v22, v5, s[8:11], s30 offen
s_add_u32 s30, s29, 3456
buffer_load_ushort v23, v5, s[8:11], s30 offen
s_add_u32 s30, s29, 4608
buffer_load_ushort v24, v5, s[8:11], s30 offen
s_add_u32 s30, s29, 5760
buffer_load_ushort v25, v5, s[8:11], s30 offen
s_add_u32 s30, s29, 6912
buffer_load_ushort v26, v5, s[8:11], s30 offen
s_add_u32 s30, s29, 8064
buffer_load_ushort v27, v5, s[8:11], s30 offen
s_waitcnt vmcnt(0)
v_lshl_or_b32 v12, v21, 16, v20
v_lshl_or_b32 v13, v23, 16, v22
v_lshl_or_b32 v14, v25, 16, v24
v_lshl_or_b32 v15, v27, 16, v26
s_nop 1
v_mfma_f32_32x32x16_bf16 v[32:47], v[12:15], v[8:11], v[32:47]
s_add_u32 s28, s28, 32
s_add_u32 s29, s29, 18432
s_add_u32 s27, s27, 16
s_cmp_lt_u32 s27, 576
s_cbranch_scc1 L_wo_0_kernel_k
s_nop 15
s_mov_b32 s26, 1152
v_mul_lo_u32 v6, v3, s26
v_lshlrev_b32 v7, 3, v2
v_add_u32 v6, v6, v7
s_lshl_b32 s26, s25, 1
v_add_u32 v6, s26, v6
s_mov_b32 s26, 1152
v_mul_lo_u32 v16, v3, s26
v_add_u32 v16, v16, v7
s_lshl_b32 s26, s25, 1
v_add_u32 v16, s26, v16
buffer_load_dwordx2 v[20:21], v16, s[16:19], 0 offen offset:0
buffer_load_dwordx2 v[22:23], v16, s[16:19], 0 offen offset:16
buffer_load_dwordx2 v[24:25], v16, s[16:19], 0 offen offset:32
buffer_load_dwordx2 v[26:27], v16, s[16:19], 0 offen offset:48
s_waitcnt vmcnt(0)
v_lshlrev_b32 v18, 16, v20
v_add_f32 v32, v32, v18
v_and_b32 v18, 0xffff0000, v20
v_add_f32 v33, v33, v18
v_lshlrev_b32 v18, 16, v21
v_add_f32 v34, v34, v18
v_and_b32 v18, 0xffff0000, v21
v_add_f32 v35, v35, v18
v_lshlrev_b32 v18, 16, v22
v_add_f32 v36, v36, v18
v_and_b32 v18, 0xffff0000, v22
v_add_f32 v37, v37, v18
v_lshlrev_b32 v18, 16, v23
v_add_f32 v38, v38, v18
v_and_b32 v18, 0xffff0000, v23
v_add_f32 v39, v39, v18
v_lshlrev_b32 v18, 16, v24
v_add_f32 v40, v40, v18
v_and_b32 v18, 0xffff0000, v24
v_add_f32 v41, v41, v18
v_lshlrev_b32 v18, 16, v25
v_add_f32 v42, v42, v18
v_and_b32 v18, 0xffff0000, v25
v_add_f32 v43, v43, v18
v_lshlrev_b32 v18, 16, v26
v_add_f32 v44, v44, v18
v_and_b32 v18, 0xffff0000, v26
v_add_f32 v45, v45, v18
v_lshlrev_b32 v18, 16, v27
v_add_f32 v46, v46, v18
v_and_b32 v18, 0xffff0000, v27
v_add_f32 v47, v47, v18
v_cvt_pk_bf16_f32 v48, v32, v33
v_cvt_pk_bf16_f32 v49, v34, v35
buffer_store_dwordx2 v[48:49], v6, s[12:15], 0 offen offset:0
v_cvt_pk_bf16_f32 v50, v36, v37
v_cvt_pk_bf16_f32 v51, v38, v39
buffer_store_dwordx2 v[50:51], v6, s[12:15], 0 offen offset:16
v_cvt_pk_bf16_f32 v52, v40, v41
v_cvt_pk_bf16_f32 v53, v42, v43
buffer_store_dwordx2 v[52:53], v6, s[12:15], 0 offen offset:32
v_cvt_pk_bf16_f32 v54, v44, v45
v_cvt_pk_bf16_f32 v55, v46, v47
buffer_store_dwordx2 v[54:55], v6, s[12:15], 0 offen offset:48
L_wo_0_kernel_end:
s_endpgm
.globl ln2_kernel
.p2align 8
.type ln2_kernel,@function
ln2_kernel:
s_cmp_ge_u32 s2, 2048
s_cbranch_scc1 L_ln2_kernel_end
s_load_dwordx2 s[4:5], s[0:1], 80
s_waitcnt lgkmcnt(0)
s_add_u32 s4, s4, 11796480
s_addc_u32 s5, s5, 0
s_mov_b32 s6, 2359296
s_mov_b32 s7, 0x20000
s_load_dwordx2 s[8:9], s[0:1], 80
s_waitcnt lgkmcnt(0)
s_add_u32 s8, s8, 0
s_addc_u32 s9, s9, 0
s_mov_b32 s10, 2359296
s_mov_b32 s11, 0x20000
s_mul_i32 s12, s2, 1152
s_add_u32 s12, s12, 0
s_mul_i32 s13, s2, 1152
v_lshlrev_b32 v1, 1, v0
v_add_u32 v2, s12, v1
v_add_u32 v3, s13, v1
buffer_load_ushort v10, v2, s[4:7], 0 offen offset:0
buffer_load_ushort v11, v2, s[4:7], 0 offen offset:128
buffer_load_ushort v12, v2, s[4:7], 0 offen offset:256
buffer_load_ushort v13, v2, s[4:7], 0 offen offset:384
buffer_load_ushort v14, v2, s[4:7], 0 offen offset:512
buffer_load_ushort v15, v2, s[4:7], 0 offen offset:640
buffer_load_ushort v16, v2, s[4:7], 0 offen offset:768
buffer_load_ushort v17, v2, s[4:7], 0 offen offset:896
buffer_load_ushort v18, v2, s[4:7], 0 offen offset:1024
s_waitcnt vmcnt(0)
v_mov_b32 v4, 0
v_lshlrev_b32 v10, 16, v10
v_add_f32 v4, v4, v10
v_lshlrev_b32 v11, 16, v11
v_add_f32 v4, v4, v11
v_lshlrev_b32 v12, 16, v12
v_add_f32 v4, v4, v12
v_lshlrev_b32 v13, 16, v13
v_add_f32 v4, v4, v13
v_lshlrev_b32 v14, 16, v14
v_add_f32 v4, v4, v14
v_lshlrev_b32 v15, 16, v15
v_add_f32 v4, v4, v15
v_lshlrev_b32 v16, 16, v16
v_add_f32 v4, v4, v16
v_lshlrev_b32 v17, 16, v17
v_add_f32 v4, v4, v17
v_lshlrev_b32 v18, 16, v18
v_add_f32 v4, v4, v18
s_nop 1
v_add_f32_dpp v4, v4, v4 row_shr:1 row_mask:0xf bank_mask:0xf bound_ctrl:0
s_nop 1
v_add_f32_dpp v4, v4, v4 row_shr:2 row_mask:0xf bank_mask:0xf bound_ctrl:0
s_nop 1
v_add_f32_dpp v4, v4, v4 row_shr:4 row_mask:0xf bank_mask:0xf bound_ctrl:0
s_nop 1
v_add_f32_dpp v4, v4, v4 row_shr:8 row_mask:0xf bank_mask:0xf bound_ctrl:0
s_nop 1
v_add_f32_dpp v4, v4, v4 row_bcast:15 row_mask:0xa bank_mask:0xf
s_nop 1
v_add_f32_dpp v4, v4, v4 row_bcast:31 row_mask:0xc bank_mask:0xf
s_nop 1
v_readlane_b32 s16, v4, 63
s_nop 3
v_mov_b32 v6, s16
v_mul_f32 v6, 0x3ae38e39, v6
v_mov_b32 v4, 0
v_sub_f32 v5, v10, v6
v_fmac_f32 v4, v5, v5
v_sub_f32 v5, v11, v6
v_fmac_f32 v4, v5, v5
v_sub_f32 v5, v12, v6
v_fmac_f32 v4, v5, v5
v_sub_f32 v5, v13, v6
v_fmac_f32 v4, v5, v5
v_sub_f32 v5, v14, v6
v_fmac_f32 v4, v5, v5
v_sub_f32 v5, v15, v6
v_fmac_f32 v4, v5, v5
v_sub_f32 v5, v16, v6
v_fmac_f32 v4, v5, v5
v_sub_f32 v5, v17, v6
v_fmac_f32 v4, v5, v5
v_sub_f32 v5, v18, v6
v_fmac_f32 v4, v5, v5
s_nop 1
v_add_f32_dpp v4, v4, v4 row_shr:1 row_mask:0xf bank_mask:0xf bound_ctrl:0
s_nop 1
v_add_f32_dpp v4, v4, v4 row_shr:2 row_mask:0xf bank_mask:0xf bound_ctrl:0
s_nop 1
v_add_f32_dpp v4, v4, v4 row_shr:4 row_mask:0xf bank_mask:0xf bound_ctrl:0
s_nop 1
v_add_f32_dpp v4, v4, v4 row_shr:8 row_mask:0xf bank_mask:0xf bound_ctrl:0
s_nop 1
v_add_f32_dpp v4, v4, v4 row_bcast:15 row_mask:0xa bank_mask:0xf
s_nop 1
v_add_f32_dpp v4, v4, v4 row_bcast:31 row_mask:0xc bank_mask:0xf
s_nop 1
v_readlane_b32 s17, v4, 63
s_nop 3
v_mov_b32 v7, s17
v_mul_f32 v7, 0x3ae38e39, v7
v_add_f32 v7, 0x3727c5ac, v7
v_sqrt_f32 v7, v7
s_nop 1
v_rcp_f32 v7, v7
s_nop 1
v_sub_f32 v5, v10, v6
v_mul_f32 v5, v5, v7
v_cvt_pk_bf16_f32 v10, v5, v5
v_sub_f32 v5, v11, v6
v_mul_f32 v5, v5, v7
v_cvt_pk_bf16_f32 v11, v5, v5
v_sub_f32 v5, v12, v6
v_mul_f32 v5, v5, v7
v_cvt_pk_bf16_f32 v12, v5, v5
v_sub_f32 v5, v13, v6
v_mul_f32 v5, v5, v7
v_cvt_pk_bf16_f32 v13, v5, v5
v_sub_f32 v5, v14, v6
v_mul_f32 v5, v5, v7
v_cvt_pk_bf16_f32 v14, v5, v5
v_sub_f32 v5, v15, v6
v_mul_f32 v5, v5, v7
v_cvt_pk_bf16_f32 v15, v5, v5
v_sub_f32 v5, v16, v6
v_mul_f32 v5, v5, v7
v_cvt_pk_bf16_f32 v16, v5, v5
v_sub_f32 v5, v17, v6
v_mul_f32 v5, v5, v7
v_cvt_pk_bf16_f32 v17, v5, v5
v_sub_f32 v5, v18, v6
v_mul_f32 v5, v5, v7
v_cvt_pk_bf16_f32 v18, v5, v5
buffer_store_short v10, v3, s[8:11], 0 offen offset:0
buffer_store_short v11, v3, s[8:11], 0 offen offset:128
buffer_store_short v12, v3, s[8:11], 0 offen offset:256
buffer_store_short v13, v3, s[8:11], 0 offen offset:384
buffer_store_short v14, v3, s[8:11], 0 offen offset:512
buffer_store_short v15, v3, s[8:11], 0 offen offset:640
buffer_store_short v16, v3, s[8:11], 0 offen offset:768
buffer_store_short v17, v3, s[8:11], 0 offen offset:896
buffer_store_short v18, v3, s[8:11], 0 offen offset:1024
L_ln2_kernel_end:
s_endpgm
.globl win_kernel
.p2align 8
.type win_kernel,@function
win_kernel:
s_cmp_ge_u32 s2, 9216
s_cbranch_scc1 L_win_kernel_end
s_load_dwordx2 s[4:5], s[0:1], 80
s_waitcnt lgkmcnt(0)
s_add_u32 s4, s4, 0
s_addc_u32 s5, s5, 0
s_mov_b32 s6, 2359296
s_mov_b32 s7, 0x20000
s_load_dwordx2 s[8:9], s[0:1], 32
s_waitcnt lgkmcnt(0)
s_mov_b32 s10, 5308416
s_mov_b32 s11, 0x20000
s_load_dwordx2 s[12:13], s[0:1], 80
s_waitcnt lgkmcnt(0)
s_add_u32 s12, s12, 14155776
s_addc_u32 s13, s13, 0
s_mov_b32 s14, 18874368
s_mov_b32 s15, 0x20000
s_and_b32 s24, s2, 63
s_lshr_b32 s25, s2, 6
s_lshl_b32 s24, s24, 5
s_lshl_b32 s25, s25, 5
v_and_b32 v1, 31, v0
v_lshrrev_b32 v2, 5, v0
v_add_u32 v3, s24, v1
s_mov_b32 s26, 1152
v_mul_lo_u32 v4, v3, s26
v_lshlrev_b32 v5, 4, v2
v_add_u32 v4, v4, v5
v_add_u32 v5, s25, v1
v_lshlrev_b32 v5, 1, v5
s_mov_b32 s26, 73728
v_mul_lo_u32 v6, v2, s26
v_add_u32 v5, v5, v6
v_mov_b32 v32, 0
v_mov_b32 v33, 0
v_mov_b32 v34, 0
v_mov_b32 v35, 0
v_mov_b32 v36, 0
v_mov_b32 v37, 0
v_mov_b32 v38, 0
v_mov_b32 v39, 0
v_mov_b32 v40, 0
v_mov_b32 v41, 0
v_mov_b32 v42, 0
v_mov_b32 v43, 0
v_mov_b32 v44, 0
v_mov_b32 v45, 0
v_mov_b32 v46, 0
v_mov_b32 v47, 0
s_mov_b32 s27, 0
s_mov_b32 s28, 0
s_mov_b32 s29, 0
L_win_kernel_k:
buffer_load_dwordx4 v[8:11], v4, s[4:7], s28 offen
s_add_u32 s30, s29, 0
buffer_load_ushort v20, v5, s[8:11], s30 offen
s_add_u32 s30, s29, 9216
buffer_load_ushort v21, v5, s[8:11], s30 offen
s_add_u32 s30, s29, 18432
buffer_load_ushort v22, v5, s[8:11], s30 offen
s_add_u32 s30, s29, 27648
buffer_load_ushort v23, v5, s[8:11], s30 offen
s_add_u32 s30, s29, 36864
buffer_load_ushort v24, v5, s[8:11], s30 offen
s_add_u32 s30, s29, 46080
buffer_load_ushort v25, v5, s[8:11], s30 offen
s_add_u32 s30, s29, 55296
buffer_load_ushort v26, v5, s[8:11], s30 offen
s_add_u32 s30, s29, 64512
buffer_load_ushort v27, v5, s[8:11], s30 offen
s_waitcnt vmcnt(0)
v_lshl_or_b32 v12, v21, 16, v20
v_lshl_or_b32 v13, v23, 16, v22
v_lshl_or_b32 v14, v25, 16, v24
v_lshl_or_b32 v15, v27, 16, v26
s_nop 1
v_mfma_f32_32x32x16_bf16 v[32:47], v[12:15], v[8:11], v[32:47]
s_add_u32 s28, s28, 32
s_add_u32 s29, s29, 147456
s_add_u32 s27, s27, 16
s_cmp_lt_u32 s27, 576
s_cbranch_scc1 L_win_kernel_k
s_nop 15
s_mov_b32 s26, 9216
v_mul_lo_u32 v6, v3, s26
v_lshlrev_b32 v7, 3, v2
v_add_u32 v6, v6, v7
s_lshl_b32 s26, s25, 1
v_add_u32 v6, s26, v6
s_mov_b32 s26, 0xbdd2d3e8
v_mov_b32 v19, 0xc0135761
v_mul_f32 v18, v32, v32
v_fma_f32 v18, v18, s26, v19
v_mul_f32 v18, v18, v32
v_exp_f32 v18, v18
s_nop 0
v_add_f32 v18, 1.0, v18
v_rcp_f32 v18, v18
s_nop 0
v_mul_f32 v32, v32, v18
v_mul_f32 v18, v33, v33
v_fma_f32 v18, v18, s26, v19
v_mul_f32 v18, v18, v33
v_exp_f32 v18, v18
s_nop 0
v_add_f32 v18, 1.0, v18
v_rcp_f32 v18, v18
s_nop 0
v_mul_f32 v33, v33, v18
v_mul_f32 v18, v34, v34
v_fma_f32 v18, v18, s26, v19
v_mul_f32 v18, v18, v34
v_exp_f32 v18, v18
s_nop 0
v_add_f32 v18, 1.0, v18
v_rcp_f32 v18, v18
s_nop 0
v_mul_f32 v34, v34, v18
v_mul_f32 v18, v35, v35
v_fma_f32 v18, v18, s26, v19
v_mul_f32 v18, v18, v35
v_exp_f32 v18, v18
s_nop 0
v_add_f32 v18, 1.0, v18
v_rcp_f32 v18, v18
s_nop 0
v_mul_f32 v35, v35, v18
v_mul_f32 v18, v36, v36
v_fma_f32 v18, v18, s26, v19
v_mul_f32 v18, v18, v36
v_exp_f32 v18, v18
s_nop 0
v_add_f32 v18, 1.0, v18
v_rcp_f32 v18, v18
s_nop 0
v_mul_f32 v36, v36, v18
v_mul_f32 v18, v37, v37
v_fma_f32 v18, v18, s26, v19
v_mul_f32 v18, v18, v37
v_exp_f32 v18, v18
s_nop 0
v_add_f32 v18, 1.0, v18
v_rcp_f32 v18, v18
s_nop 0
v_mul_f32 v37, v37, v18
v_mul_f32 v18, v38, v38
v_fma_f32 v18, v18, s26, v19
v_mul_f32 v18, v18, v38
v_exp_f32 v18, v18
s_nop 0
v_add_f32 v18, 1.0, v18
v_rcp_f32 v18, v18
s_nop 0
v_mul_f32 v38, v38, v18
v_mul_f32 v18, v39, v39
v_fma_f32 v18, v18, s26, v19
v_mul_f32 v18, v18, v39
v_exp_f32 v18, v18
s_nop 0
v_add_f32 v18, 1.0, v18
v_rcp_f32 v18, v18
s_nop 0
v_mul_f32 v39, v39, v18
v_mul_f32 v18, v40, v40
v_fma_f32 v18, v18, s26, v19
v_mul_f32 v18, v18, v40
v_exp_f32 v18, v18
s_nop 0
v_add_f32 v18, 1.0, v18
v_rcp_f32 v18, v18
s_nop 0
v_mul_f32 v40, v40, v18
v_mul_f32 v18, v41, v41
v_fma_f32 v18, v18, s26, v19
v_mul_f32 v18, v18, v41
v_exp_f32 v18, v18
s_nop 0
v_add_f32 v18, 1.0, v18
v_rcp_f32 v18, v18
s_nop 0
v_mul_f32 v41, v41, v18
v_mul_f32 v18, v42, v42
v_fma_f32 v18, v18, s26, v19
v_mul_f32 v18, v18, v42
v_exp_f32 v18, v18
s_nop 0
v_add_f32 v18, 1.0, v18
v_rcp_f32 v18, v18
s_nop 0
v_mul_f32 v42, v42, v18
v_mul_f32 v18, v43, v43
v_fma_f32 v18, v18, s26, v19
v_mul_f32 v18, v18, v43
v_exp_f32 v18, v18
s_nop 0
v_add_f32 v18, 1.0, v18
v_rcp_f32 v18, v18
s_nop 0
v_mul_f32 v43, v43, v18
v_mul_f32 v18, v44, v44
v_fma_f32 v18, v18, s26, v19
v_mul_f32 v18, v18, v44
v_exp_f32 v18, v18
s_nop 0
v_add_f32 v18, 1.0, v18
v_rcp_f32 v18, v18
s_nop 0
v_mul_f32 v44, v44, v18
v_mul_f32 v18, v45, v45
v_fma_f32 v18, v18, s26, v19
v_mul_f32 v18, v18, v45
v_exp_f32 v18, v18
s_nop 0
v_add_f32 v18, 1.0, v18
v_rcp_f32 v18, v18
s_nop 0
v_mul_f32 v45, v45, v18
v_mul_f32 v18, v46, v46
v_fma_f32 v18, v18, s26, v19
v_mul_f32 v18, v18, v46
v_exp_f32 v18, v18
s_nop 0
v_add_f32 v18, 1.0, v18
v_rcp_f32 v18, v18
s_nop 0
v_mul_f32 v46, v46, v18
v_mul_f32 v18, v47, v47
v_fma_f32 v18, v18, s26, v19
v_mul_f32 v18, v18, v47
v_exp_f32 v18, v18
s_nop 0
v_add_f32 v18, 1.0, v18
v_rcp_f32 v18, v18
s_nop 0
v_mul_f32 v47, v47, v18
v_cvt_pk_bf16_f32 v48, v32, v33
v_cvt_pk_bf16_f32 v49, v34, v35
buffer_store_dwordx2 v[48:49], v6, s[12:15], 0 offen offset:0
v_cvt_pk_bf16_f32 v50, v36, v37
v_cvt_pk_bf16_f32 v51, v38, v39
buffer_store_dwordx2 v[50:51], v6, s[12:15], 0 offen offset:16
v_cvt_pk_bf16_f32 v52, v40, v41
v_cvt_pk_bf16_f32 v53, v42, v43
buffer_store_dwordx2 v[52:53], v6, s[12:15], 0 offen offset:32
v_cvt_pk_bf16_f32 v54, v44, v45
v_cvt_pk_bf16_f32 v55, v46, v47
buffer_store_dwordx2 v[54:55], v6, s[12:15], 0 offen offset:48
L_win_kernel_end:
s_endpgm
.globl ln3_kernel
.p2align 8
.type ln3_kernel,@function
ln3_kernel:
s_cmp_ge_u32 s2, 2048
s_cbranch_scc1 L_ln3_kernel_end
s_load_dwordx2 s[4:5], s[0:1], 80
s_waitcnt lgkmcnt(0)
s_add_u32 s4, s4, 14155776
s_addc_u32 s5, s5, 0
s_mov_b32 s6, 18874368
s_mov_b32 s7, 0x20000
s_load_dwordx2 s[8:9], s[0:1], 80
s_waitcnt lgkmcnt(0)
s_add_u32 s8, s8, 33030144
s_addc_u32 s9, s9, 0
s_mov_b32 s10, 9437184
s_mov_b32 s11, 0x20000
s_mul_i32 s12, s2, 9216
s_add_u32 s12, s12, 4608
s_mul_i32 s13, s2, 4608
v_lshlrev_b32 v1, 1, v0
v_add_u32 v2, s12, v1
v_add_u32 v3, s13, v1
buffer_load_ushort v10, v2, s[4:7], 0 offen offset:0
buffer_load_ushort v11, v2, s[4:7], 0 offen offset:128
buffer_load_ushort v12, v2, s[4:7], 0 offen offset:256
buffer_load_ushort v13, v2, s[4:7], 0 offen offset:384
buffer_load_ushort v14, v2, s[4:7], 0 offen offset:512
buffer_load_ushort v15, v2, s[4:7], 0 offen offset:640
buffer_load_ushort v16, v2, s[4:7], 0 offen offset:768
buffer_load_ushort v17, v2, s[4:7], 0 offen offset:896
buffer_load_ushort v18, v2, s[4:7], 0 offen offset:1024
buffer_load_ushort v19, v2, s[4:7], 0 offen offset:1152
buffer_load_ushort v20, v2, s[4:7], 0 offen offset:1280
buffer_load_ushort v21, v2, s[4:7], 0 offen offset:1408
buffer_load_ushort v22, v2, s[4:7], 0 offen offset:1536
buffer_load_ushort v23, v2, s[4:7], 0 offen offset:1664
buffer_load_ushort v24, v2, s[4:7], 0 offen offset:1792
buffer_load_ushort v25, v2, s[4:7], 0 offen offset:1920
buffer_load_ushort v26, v2, s[4:7], 0 offen offset:2048
buffer_load_ushort v27, v2, s[4:7], 0 offen offset:2176
buffer_load_ushort v28, v2, s[4:7], 0 offen offset:2304
buffer_load_ushort v29, v2, s[4:7], 0 offen offset:2432
buffer_load_ushort v30, v2, s[4:7], 0 offen offset:2560
buffer_load_ushort v31, v2, s[4:7], 0 offen offset:2688
buffer_load_ushort v32, v2, s[4:7], 0 offen offset:2816
buffer_load_ushort v33, v2, s[4:7], 0 offen offset:2944
buffer_load_ushort v34, v2, s[4:7], 0 offen offset:3072
buffer_load_ushort v35, v2, s[4:7], 0 offen offset:3200
buffer_load_ushort v36, v2, s[4:7], 0 offen offset:3328
buffer_load_ushort v37, v2, s[4:7], 0 offen offset:3456
buffer_load_ushort v38, v2, s[4:7], 0 offen offset:3584
buffer_load_ushort v39, v2, s[4:7], 0 offen offset:3712
buffer_load_ushort v40, v2, s[4:7], 0 offen offset:3840
buffer_load_ushort v41, v2, s[4:7], 0 offen offset:3968
s_mov_b32 s14, 4096
buffer_load_ushort v42, v2, s[4:7], s14 offen
s_mov_b32 s14, 4224
buffer_load_ushort v43, v2, s[4:7], s14 offen
s_mov_b32 s14, 4352
buffer_load_ushort v44, v2, s[4:7], s14 offen
s_mov_b32 s14, 4480
buffer_load_ushort v45, v2, s[4:7], s14 offen
s_waitcnt vmcnt(0)
v_mov_b32 v4, 0
v_lshlrev_b32 v10, 16, v10
v_add_f32 v4, v4, v10
v_lshlrev_b32 v11, 16, v11
v_add_f32 v4, v4, v11
v_lshlrev_b32 v12, 16, v12
v_add_f32 v4, v4, v12
v_lshlrev_b32 v13, 16, v13
v_add_f32 v4, v4, v13
v_lshlrev_b32 v14, 16, v14
v_add_f32 v4, v4, v14
v_lshlrev_b32 v15, 16, v15
v_add_f32 v4, v4, v15
v_lshlrev_b32 v16, 16, v16
v_add_f32 v4, v4, v16
v_lshlrev_b32 v17, 16, v17
v_add_f32 v4, v4, v17
v_lshlrev_b32 v18, 16, v18
v_add_f32 v4, v4, v18
v_lshlrev_b32 v19, 16, v19
v_add_f32 v4, v4, v19
v_lshlrev_b32 v20, 16, v20
v_add_f32 v4, v4, v20
v_lshlrev_b32 v21, 16, v21
v_add_f32 v4, v4, v21
v_lshlrev_b32 v22, 16, v22
v_add_f32 v4, v4, v22
v_lshlrev_b32 v23, 16, v23
v_add_f32 v4, v4, v23
v_lshlrev_b32 v24, 16, v24
v_add_f32 v4, v4, v24
v_lshlrev_b32 v25, 16, v25
v_add_f32 v4, v4, v25
v_lshlrev_b32 v26, 16, v26
v_add_f32 v4, v4, v26
v_lshlrev_b32 v27, 16, v27
v_add_f32 v4, v4, v27
v_lshlrev_b32 v28, 16, v28
v_add_f32 v4, v4, v28
v_lshlrev_b32 v29, 16, v29
v_add_f32 v4, v4, v29
v_lshlrev_b32 v30, 16, v30
v_add_f32 v4, v4, v30
v_lshlrev_b32 v31, 16, v31
v_add_f32 v4, v4, v31
v_lshlrev_b32 v32, 16, v32
v_add_f32 v4, v4, v32
v_lshlrev_b32 v33, 16, v33
v_add_f32 v4, v4, v33
v_lshlrev_b32 v34, 16, v34
v_add_f32 v4, v4, v34
v_lshlrev_b32 v35, 16, v35
v_add_f32 v4, v4, v35
v_lshlrev_b32 v36, 16, v36
v_add_f32 v4, v4, v36
v_lshlrev_b32 v37, 16, v37
v_add_f32 v4, v4, v37
v_lshlrev_b32 v38, 16, v38
v_add_f32 v4, v4, v38
v_lshlrev_b32 v39, 16, v39
v_add_f32 v4, v4, v39
v_lshlrev_b32 v40, 16, v40
v_add_f32 v4, v4, v40
v_lshlrev_b32 v41, 16, v41
v_add_f32 v4, v4, v41
v_lshlrev_b32 v42, 16, v42
v_add_f32 v4, v4, v42
v_lshlrev_b32 v43, 16, v43
v_add_f32 v4, v4, v43
v_lshlrev_b32 v44, 16, v44
v_add_f32 v4, v4, v44
v_lshlrev_b32 v45, 16, v45
v_add_f32 v4, v4, v45
s_nop 1
v_add_f32_dpp v4, v4, v4 row_shr:1 row_mask:0xf bank_mask:0xf bound_ctrl:0
s_nop 1
v_add_f32_dpp v4, v4, v4 row_shr:2 row_mask:0xf bank_mask:0xf bound_ctrl:0
s_nop 1
v_add_f32_dpp v4, v4, v4 row_shr:4 row_mask:0xf bank_mask:0xf bound_ctrl:0
s_nop 1
v_add_f32_dpp v4, v4, v4 row_shr:8 row_mask:0xf bank_mask:0xf bound_ctrl:0
s_nop 1
v_add_f32_dpp v4, v4, v4 row_bcast:15 row_mask:0xa bank_mask:0xf
s_nop 1
v_add_f32_dpp v4, v4, v4 row_bcast:31 row_mask:0xc bank_mask:0xf
s_nop 1
v_readlane_b32 s16, v4, 63
s_nop 3
v_mov_b32 v6, s16
v_mul_f32 v6, 0x39e38e39, v6
v_mov_b32 v4, 0
v_sub_f32 v5, v10, v6
v_fmac_f32 v4, v5, v5
v_sub_f32 v5, v11, v6
v_fmac_f32 v4, v5, v5
v_sub_f32 v5, v12, v6
v_fmac_f32 v4, v5, v5
v_sub_f32 v5, v13, v6
v_fmac_f32 v4, v5, v5
v_sub_f32 v5, v14, v6
v_fmac_f32 v4, v5, v5
v_sub_f32 v5, v15, v6
v_fmac_f32 v4, v5, v5
v_sub_f32 v5, v16, v6
v_fmac_f32 v4, v5, v5
v_sub_f32 v5, v17, v6
v_fmac_f32 v4, v5, v5
v_sub_f32 v5, v18, v6
v_fmac_f32 v4, v5, v5
v_sub_f32 v5, v19, v6
v_fmac_f32 v4, v5, v5
v_sub_f32 v5, v20, v6
v_fmac_f32 v4, v5, v5
v_sub_f32 v5, v21, v6
v_fmac_f32 v4, v5, v5
v_sub_f32 v5, v22, v6
v_fmac_f32 v4, v5, v5
v_sub_f32 v5, v23, v6
v_fmac_f32 v4, v5, v5
v_sub_f32 v5, v24, v6
v_fmac_f32 v4, v5, v5
v_sub_f32 v5, v25, v6
v_fmac_f32 v4, v5, v5
v_sub_f32 v5, v26, v6
v_fmac_f32 v4, v5, v5
v_sub_f32 v5, v27, v6
v_fmac_f32 v4, v5, v5
v_sub_f32 v5, v28, v6
v_fmac_f32 v4, v5, v5
v_sub_f32 v5, v29, v6
v_fmac_f32 v4, v5, v5
v_sub_f32 v5, v30, v6
v_fmac_f32 v4, v5, v5
v_sub_f32 v5, v31, v6
v_fmac_f32 v4, v5, v5
v_sub_f32 v5, v32, v6
v_fmac_f32 v4, v5, v5
v_sub_f32 v5, v33, v6
v_fmac_f32 v4, v5, v5
v_sub_f32 v5, v34, v6
v_fmac_f32 v4, v5, v5
v_sub_f32 v5, v35, v6
v_fmac_f32 v4, v5, v5
v_sub_f32 v5, v36, v6
v_fmac_f32 v4, v5, v5
v_sub_f32 v5, v37, v6
v_fmac_f32 v4, v5, v5
v_sub_f32 v5, v38, v6
v_fmac_f32 v4, v5, v5
v_sub_f32 v5, v39, v6
v_fmac_f32 v4, v5, v5
v_sub_f32 v5, v40, v6
v_fmac_f32 v4, v5, v5
v_sub_f32 v5, v41, v6
v_fmac_f32 v4, v5, v5
v_sub_f32 v5, v42, v6
v_fmac_f32 v4, v5, v5
v_sub_f32 v5, v43, v6
v_fmac_f32 v4, v5, v5
v_sub_f32 v5, v44, v6
v_fmac_f32 v4, v5, v5
v_sub_f32 v5, v45, v6
v_fmac_f32 v4, v5, v5
s_nop 1
v_add_f32_dpp v4, v4, v4 row_shr:1 row_mask:0xf bank_mask:0xf bound_ctrl:0
s_nop 1
v_add_f32_dpp v4, v4, v4 row_shr:2 row_mask:0xf bank_mask:0xf bound_ctrl:0
s_nop 1
v_add_f32_dpp v4, v4, v4 row_shr:4 row_mask:0xf bank_mask:0xf bound_ctrl:0
s_nop 1
v_add_f32_dpp v4, v4, v4 row_shr:8 row_mask:0xf bank_mask:0xf bound_ctrl:0
s_nop 1
v_add_f32_dpp v4, v4, v4 row_bcast:15 row_mask:0xa bank_mask:0xf
s_nop 1
v_add_f32_dpp v4, v4, v4 row_bcast:31 row_mask:0xc bank_mask:0xf
s_nop 1
v_readlane_b32 s17, v4, 63
s_nop 3
v_mov_b32 v7, s17
v_mul_f32 v7, 0x39e38e39, v7
v_add_f32 v7, 0x3727c5ac, v7
v_sqrt_f32 v7, v7
s_nop 1
v_rcp_f32 v7, v7
s_nop 1
v_sub_f32 v5, v10, v6
v_mul_f32 v5, v5, v7
v_cvt_pk_bf16_f32 v10, v5, v5
v_sub_f32 v5, v11, v6
v_mul_f32 v5, v5, v7
v_cvt_pk_bf16_f32 v11, v5, v5
v_sub_f32 v5, v12, v6
v_mul_f32 v5, v5, v7
v_cvt_pk_bf16_f32 v12, v5, v5
v_sub_f32 v5, v13, v6
v_mul_f32 v5, v5, v7
v_cvt_pk_bf16_f32 v13, v5, v5
v_sub_f32 v5, v14, v6
v_mul_f32 v5, v5, v7
v_cvt_pk_bf16_f32 v14, v5, v5
v_sub_f32 v5, v15, v6
v_mul_f32 v5, v5, v7
v_cvt_pk_bf16_f32 v15, v5, v5
v_sub_f32 v5, v16, v6
v_mul_f32 v5, v5, v7
v_cvt_pk_bf16_f32 v16, v5, v5
v_sub_f32 v5, v17, v6
v_mul_f32 v5, v5, v7
v_cvt_pk_bf16_f32 v17, v5, v5
v_sub_f32 v5, v18, v6
v_mul_f32 v5, v5, v7
v_cvt_pk_bf16_f32 v18, v5, v5
v_sub_f32 v5, v19, v6
v_mul_f32 v5, v5, v7
v_cvt_pk_bf16_f32 v19, v5, v5
v_sub_f32 v5, v20, v6
v_mul_f32 v5, v5, v7
v_cvt_pk_bf16_f32 v20, v5, v5
v_sub_f32 v5, v21, v6
v_mul_f32 v5, v5, v7
v_cvt_pk_bf16_f32 v21, v5, v5
v_sub_f32 v5, v22, v6
v_mul_f32 v5, v5, v7
v_cvt_pk_bf16_f32 v22, v5, v5
v_sub_f32 v5, v23, v6
v_mul_f32 v5, v5, v7
v_cvt_pk_bf16_f32 v23, v5, v5
v_sub_f32 v5, v24, v6
v_mul_f32 v5, v5, v7
v_cvt_pk_bf16_f32 v24, v5, v5
v_sub_f32 v5, v25, v6
v_mul_f32 v5, v5, v7
v_cvt_pk_bf16_f32 v25, v5, v5
v_sub_f32 v5, v26, v6
v_mul_f32 v5, v5, v7
v_cvt_pk_bf16_f32 v26, v5, v5
v_sub_f32 v5, v27, v6
v_mul_f32 v5, v5, v7
v_cvt_pk_bf16_f32 v27, v5, v5
v_sub_f32 v5, v28, v6
v_mul_f32 v5, v5, v7
v_cvt_pk_bf16_f32 v28, v5, v5
v_sub_f32 v5, v29, v6
v_mul_f32 v5, v5, v7
v_cvt_pk_bf16_f32 v29, v5, v5
v_sub_f32 v5, v30, v6
v_mul_f32 v5, v5, v7
v_cvt_pk_bf16_f32 v30, v5, v5
v_sub_f32 v5, v31, v6
v_mul_f32 v5, v5, v7
v_cvt_pk_bf16_f32 v31, v5, v5
v_sub_f32 v5, v32, v6
v_mul_f32 v5, v5, v7
v_cvt_pk_bf16_f32 v32, v5, v5
v_sub_f32 v5, v33, v6
v_mul_f32 v5, v5, v7
v_cvt_pk_bf16_f32 v33, v5, v5
v_sub_f32 v5, v34, v6
v_mul_f32 v5, v5, v7
v_cvt_pk_bf16_f32 v34, v5, v5
v_sub_f32 v5, v35, v6
v_mul_f32 v5, v5, v7
v_cvt_pk_bf16_f32 v35, v5, v5
v_sub_f32 v5, v36, v6
v_mul_f32 v5, v5, v7
v_cvt_pk_bf16_f32 v36, v5, v5
v_sub_f32 v5, v37, v6
v_mul_f32 v5, v5, v7
v_cvt_pk_bf16_f32 v37, v5, v5
v_sub_f32 v5, v38, v6
v_mul_f32 v5, v5, v7
v_cvt_pk_bf16_f32 v38, v5, v5
v_sub_f32 v5, v39, v6
v_mul_f32 v5, v5, v7
v_cvt_pk_bf16_f32 v39, v5, v5
v_sub_f32 v5, v40, v6
v_mul_f32 v5, v5, v7
v_cvt_pk_bf16_f32 v40, v5, v5
v_sub_f32 v5, v41, v6
v_mul_f32 v5, v5, v7
v_cvt_pk_bf16_f32 v41, v5, v5
v_sub_f32 v5, v42, v6
v_mul_f32 v5, v5, v7
v_cvt_pk_bf16_f32 v42, v5, v5
v_sub_f32 v5, v43, v6
v_mul_f32 v5, v5, v7
v_cvt_pk_bf16_f32 v43, v5, v5
v_sub_f32 v5, v44, v6
v_mul_f32 v5, v5, v7
v_cvt_pk_bf16_f32 v44, v5, v5
v_sub_f32 v5, v45, v6
v_mul_f32 v5, v5, v7
v_cvt_pk_bf16_f32 v45, v5, v5
buffer_store_short v10, v3, s[8:11], 0 offen offset:0
buffer_store_short v11, v3, s[8:11], 0 offen offset:128
buffer_store_short v12, v3, s[8:11], 0 offen offset:256
buffer_store_short v13, v3, s[8:11], 0 offen offset:384
buffer_store_short v14, v3, s[8:11], 0 offen offset:512
buffer_store_short v15, v3, s[8:11], 0 offen offset:640
buffer_store_short v16, v3, s[8:11], 0 offen offset:768
buffer_store_short v17, v3, s[8:11], 0 offen offset:896
buffer_store_short v18, v3, s[8:11], 0 offen offset:1024
buffer_store_short v19, v3, s[8:11], 0 offen offset:1152
buffer_store_short v20, v3, s[8:11], 0 offen offset:1280
buffer_store_short v21, v3, s[8:11], 0 offen offset:1408
buffer_store_short v22, v3, s[8:11], 0 offen offset:1536
buffer_store_short v23, v3, s[8:11], 0 offen offset:1664
buffer_store_short v24, v3, s[8:11], 0 offen offset:1792
buffer_store_short v25, v3, s[8:11], 0 offen offset:1920
buffer_store_short v26, v3, s[8:11], 0 offen offset:2048
buffer_store_short v27, v3, s[8:11], 0 offen offset:2176
buffer_store_short v28, v3, s[8:11], 0 offen offset:2304
buffer_store_short v29, v3, s[8:11], 0 offen offset:2432
buffer_store_short v30, v3, s[8:11], 0 offen offset:2560
buffer_store_short v31, v3, s[8:11], 0 offen offset:2688
buffer_store_short v32, v3, s[8:11], 0 offen offset:2816
buffer_store_short v33, v3, s[8:11], 0 offen offset:2944
buffer_store_short v34, v3, s[8:11], 0 offen offset:3072
buffer_store_short v35, v3, s[8:11], 0 offen offset:3200
buffer_store_short v36, v3, s[8:11], 0 offen offset:3328
buffer_store_short v37, v3, s[8:11], 0 offen offset:3456
buffer_store_short v38, v3, s[8:11], 0 offen offset:3584
buffer_store_short v39, v3, s[8:11], 0 offen offset:3712
buffer_store_short v40, v3, s[8:11], 0 offen offset:3840
buffer_store_short v41, v3, s[8:11], 0 offen offset:3968
s_mov_b32 s14, 4096
buffer_store_short v42, v3, s[8:11], s14 offen
s_mov_b32 s14, 4224
buffer_store_short v43, v3, s[8:11], s14 offen
s_mov_b32 s14, 4352
buffer_store_short v44, v3, s[8:11], s14 offen
s_mov_b32 s14, 4480
buffer_store_short v45, v3, s[8:11], s14 offen
L_ln3_kernel_end:
s_endpgm
.globl sp_kernel
.p2align 8
.type sp_kernel,@function
sp_kernel:
s_cmp_ge_u32 s2, 4608
s_cbranch_scc1 L_sp_kernel_end
s_load_dwordx2 s[4:5], s[0:1], 40
s_waitcnt lgkmcnt(0)
s_mov_b32 s6, 8388608
s_mov_b32 s7, 0x20000
s_load_dwordx2 s[8:9], s[0:1], 80
s_waitcnt lgkmcnt(0)
s_add_u32 s8, s8, 33030144
s_addc_u32 s9, s9, 0
s_mov_b32 s10, 9437184
s_mov_b32 s11, 0x20000
s_load_dwordx2 s[12:13], s[0:1], 80
s_waitcnt lgkmcnt(0)
s_add_u32 s12, s12, 42467328
s_addc_u32 s13, s13, 0
s_mov_b32 s14, 9437184
s_mov_b32 s15, 0x20000
s_load_dwordx2 s[16:17], s[0:1], 80
s_waitcnt lgkmcnt(0)
s_add_u32 s16, s16, 14155776
s_addc_u32 s17, s17, 0
s_mov_b32 s18, 18874368
s_mov_b32 s19, 0x20000
s_load_dwordx2 s[20:21], s[0:1], 48
s_waitcnt lgkmcnt(0)
s_mov_b32 s22, 4096
s_mov_b32 s23, 0x20000
s_and_b32 s24, s2, 63
s_lshr_b32 s25, s2, 6
s_lshl_b32 s24, s24, 5
s_lshl_b32 s25, s25, 5
v_and_b32 v1, 31, v0
v_lshrrev_b32 v2, 5, v0
v_add_u32 v3, s24, v1
s_mov_b32 s26, 4096
v_mul_lo_u32 v4, v3, s26
v_lshlrev_b32 v5, 4, v2
v_add_u32 v4, v4, v5
v_add_u32 v5, s25, v1
v_lshlrev_b32 v5, 1, v5
s_mov_b32 s26, 36864
v_mul_lo_u32 v6, v2, s26
v_add_u32 v5, v5, v6
v_mov_b32 v32, 0
v_mov_b32 v33, 0
v_mov_b32 v34, 0
v_mov_b32 v35, 0
v_mov_b32 v36, 0
v_mov_b32 v37, 0
v_mov_b32 v38, 0
v_mov_b32 v39, 0
v_mov_b32 v40, 0
v_mov_b32 v41, 0
v_mov_b32 v42, 0
v_mov_b32 v43, 0
v_mov_b32 v44, 0
v_mov_b32 v45, 0
v_mov_b32 v46, 0
v_mov_b32 v47, 0
s_mov_b32 s27, 0
s_mov_b32 s28, 0
s_mov_b32 s29, 0
L_sp_kernel_k:
buffer_load_dwordx4 v[8:11], v4, s[4:7], s28 offen
s_add_u32 s30, s29, 0
buffer_load_ushort v20, v5, s[8:11], s30 offen
s_add_u32 s30, s29, 4608
buffer_load_ushort v21, v5, s[8:11], s30 offen
s_add_u32 s30, s29, 9216
buffer_load_ushort v22, v5, s[8:11], s30 offen
s_add_u32 s30, s29, 13824
buffer_load_ushort v23, v5, s[8:11], s30 offen
s_add_u32 s30, s29, 18432
buffer_load_ushort v24, v5, s[8:11], s30 offen
s_add_u32 s30, s29, 23040
buffer_load_ushort v25, v5, s[8:11], s30 offen
s_add_u32 s30, s29, 27648
buffer_load_ushort v26, v5, s[8:11], s30 offen
s_add_u32 s30, s29, 32256
buffer_load_ushort v27, v5, s[8:11], s30 offen
s_waitcnt vmcnt(0)
v_lshl_or_b32 v12, v21, 16, v20
v_lshl_or_b32 v13, v23, 16, v22
v_lshl_or_b32 v14, v25, 16, v24
v_lshl_or_b32 v15, v27, 16, v26
s_nop 1
v_mfma_f32_32x32x16_bf16 v[32:47], v[12:15], v[8:11], v[32:47]
s_add_u32 s28, s28, 32
s_add_u32 s29, s29, 73728
s_add_u32 s27, s27, 16
s_cmp_lt_u32 s27, 2048
s_cbranch_scc1 L_sp_kernel_k
s_nop 15
s_mov_b32 s26, 4608
v_mul_lo_u32 v6, v3, s26
v_lshlrev_b32 v7, 3, v2
v_add_u32 v6, v6, v7
s_lshl_b32 s26, s25, 1
v_add_u32 v6, s26, v6
s_mov_b32 s26, 9216
v_mul_lo_u32 v16, v3, s26
v_add_u32 v16, v16, v7
s_lshl_b32 s26, s25, 1
v_add_u32 v16, s26, v16
buffer_load_dwordx2 v[20:21], v16, s[16:19], 0 offen offset:0
buffer_load_dwordx2 v[22:23], v16, s[16:19], 0 offen offset:16
buffer_load_dwordx2 v[24:25], v16, s[16:19], 0 offen offset:32
buffer_load_dwordx2 v[26:27], v16, s[16:19], 0 offen offset:48
v_lshlrev_b32 v17, 1, v3
buffer_load_ushort v17, v17, s[20:23], 0 offen
s_waitcnt vmcnt(0)
v_lshlrev_b32 v17, 16, v17
v_lshlrev_b32 v18, 16, v20
v_add_f32 v32, v32, v17
v_mul_f32 v32, v32, v18
v_and_b32 v18, 0xffff0000, v20
v_add_f32 v33, v33, v17
v_mul_f32 v33, v33, v18
v_lshlrev_b32 v18, 16, v21
v_add_f32 v34, v34, v17
v_mul_f32 v34, v34, v18
v_and_b32 v18, 0xffff0000, v21
v_add_f32 v35, v35, v17
v_mul_f32 v35, v35, v18
v_lshlrev_b32 v18, 16, v22
v_add_f32 v36, v36, v17
v_mul_f32 v36, v36, v18
v_and_b32 v18, 0xffff0000, v22
v_add_f32 v37, v37, v17
v_mul_f32 v37, v37, v18
v_lshlrev_b32 v18, 16, v23
v_add_f32 v38, v38, v17
v_mul_f32 v38, v38, v18
v_and_b32 v18, 0xffff0000, v23
v_add_f32 v39, v39, v17
v_mul_f32 v39, v39, v18
v_lshlrev_b32 v18, 16, v24
v_add_f32 v40, v40, v17
v_mul_f32 v40, v40, v18
v_and_b32 v18, 0xffff0000, v24
v_add_f32 v41, v41, v17
v_mul_f32 v41, v41, v18
v_lshlrev_b32 v18, 16, v25
v_add_f32 v42, v42, v17
v_mul_f32 v42, v42, v18
v_and_b32 v18, 0xffff0000, v25
v_add_f32 v43, v43, v17
v_mul_f32 v43, v43, v18
v_lshlrev_b32 v18, 16, v26
v_add_f32 v44, v44, v17
v_mul_f32 v44, v44, v18
v_and_b32 v18, 0xffff0000, v26
v_add_f32 v45, v45, v17
v_mul_f32 v45, v45, v18
v_lshlrev_b32 v18, 16, v27
v_add_f32 v46, v46, v17
v_mul_f32 v46, v46, v18
v_and_b32 v18, 0xffff0000, v27
v_add_f32 v47, v47, v17
v_mul_f32 v47, v47, v18
v_cvt_pk_bf16_f32 v48, v32, v33
v_cvt_pk_bf16_f32 v49, v34, v35
buffer_store_dwordx2 v[48:49], v6, s[12:15], 0 offen offset:0
v_cvt_pk_bf16_f32 v50, v36, v37
v_cvt_pk_bf16_f32 v51, v38, v39
buffer_store_dwordx2 v[50:51], v6, s[12:15], 0 offen offset:16
v_cvt_pk_bf16_f32 v52, v40, v41
v_cvt_pk_bf16_f32 v53, v42, v43
buffer_store_dwordx2 v[52:53], v6, s[12:15], 0 offen offset:32
v_cvt_pk_bf16_f32 v54, v44, v45
v_cvt_pk_bf16_f32 v55, v46, v47
buffer_store_dwordx2 v[54:55], v6, s[12:15], 0 offen offset:48
L_sp_kernel_end:
s_endpgm
.globl wout_0_kernel
.p2align 8
.type wout_0_kernel,@function
wout_0_kernel:
s_cmp_ge_u32 s2, 1152
s_cbranch_scc1 L_wout_0_kernel_end
s_load_dwordx2 s[4:5], s[0:1], 80
s_waitcnt lgkmcnt(0)
s_add_u32 s4, s4, 42467328
s_addc_u32 s5, s5, 0
s_mov_b32 s6, 9437184
s_mov_b32 s7, 0x20000
s_load_dwordx2 s[8:9], s[0:1], 56
s_waitcnt lgkmcnt(0)
s_mov_b32 s10, 2654208
s_mov_b32 s11, 0x20000
s_load_dwordx2 s[12:13], s[0:1], 80
s_waitcnt lgkmcnt(0)
s_add_u32 s12, s12, 51904512
s_addc_u32 s13, s13, 0
s_mov_b32 s14, 2359296
s_mov_b32 s15, 0x20000
s_load_dwordx2 s[16:17], s[0:1], 80
s_waitcnt lgkmcnt(0)
s_add_u32 s16, s16, 11796480
s_addc_u32 s17, s17, 0
s_mov_b32 s18, 2359296
s_mov_b32 s19, 0x20000
s_and_b32 s24, s2, 63
s_lshr_b32 s25, s2, 6
s_lshl_b32 s24, s24, 5
s_lshl_b32 s25, s25, 5
v_and_b32 v1, 31, v0
v_lshrrev_b32 v2, 5, v0
v_add_u32 v3, s24, v1
s_mov_b32 s26, 4608
v_mul_lo_u32 v4, v3, s26
v_lshlrev_b32 v5, 4, v2
v_add_u32 v4, v4, v5
v_add_u32 v5, s25, v1
v_lshlrev_b32 v5, 1, v5
s_mov_b32 s26, 9216
v_mul_lo_u32 v6, v2, s26
v_add_u32 v5, v5, v6
v_mov_b32 v32, 0
v_mov_b32 v33, 0
v_mov_b32 v34, 0
v_mov_b32 v35, 0
v_mov_b32 v36, 0
v_mov_b32 v37, 0
v_mov_b32 v38, 0
v_mov_b32 v39, 0
v_mov_b32 v40, 0
v_mov_b32 v41, 0
v_mov_b32 v42, 0
v_mov_b32 v43, 0
v_mov_b32 v44, 0
v_mov_b32 v45, 0
v_mov_b32 v46, 0
v_mov_b32 v47, 0
s_mov_b32 s27, 0
s_mov_b32 s28, 0
s_mov_b32 s29, 0
L_wout_0_kernel_k:
buffer_load_dwordx4 v[8:11], v4, s[4:7], s28 offen
s_add_u32 s30, s29, 0
buffer_load_ushort v20, v5, s[8:11], s30 offen
s_add_u32 s30, s29, 1152
buffer_load_ushort v21, v5, s[8:11], s30 offen
s_add_u32 s30, s29, 2304
buffer_load_ushort v22, v5, s[8:11], s30 offen
s_add_u32 s30, s29, 3456
buffer_load_ushort v23, v5, s[8:11], s30 offen
s_add_u32 s30, s29, 4608
buffer_load_ushort v24, v5, s[8:11], s30 offen
s_add_u32 s30, s29, 5760
buffer_load_ushort v25, v5, s[8:11], s30 offen
s_add_u32 s30, s29, 6912
buffer_load_ushort v26, v5, s[8:11], s30 offen
s_add_u32 s30, s29, 8064
buffer_load_ushort v27, v5, s[8:11], s30 offen
s_waitcnt vmcnt(0)
v_lshl_or_b32 v12, v21, 16, v20
v_lshl_or_b32 v13, v23, 16, v22
v_lshl_or_b32 v14, v25, 16, v24
v_lshl_or_b32 v15, v27, 16, v26
s_nop 1
v_mfma_f32_32x32x16_bf16 v[32:47], v[12:15], v[8:11], v[32:47]
s_add_u32 s28, s28, 32
s_add_u32 s29, s29, 18432
s_add_u32 s27, s27, 16
s_cmp_lt_u32 s27, 2304
s_cbranch_scc1 L_wout_0_kernel_k
s_nop 15
s_mov_b32 s26, 1152
v_mul_lo_u32 v6, v3, s26
v_lshlrev_b32 v7, 3, v2
v_add_u32 v6, v6, v7
s_lshl_b32 s26, s25, 1
v_add_u32 v6, s26, v6
s_mov_b32 s26, 1152
v_mul_lo_u32 v16, v3, s26
v_add_u32 v16, v16, v7
s_lshl_b32 s26, s25, 1
v_add_u32 v16, s26, v16
buffer_load_dwordx2 v[20:21], v16, s[16:19], 0 offen offset:0
buffer_load_dwordx2 v[22:23], v16, s[16:19], 0 offen offset:16
buffer_load_dwordx2 v[24:25], v16, s[16:19], 0 offen offset:32
buffer_load_dwordx2 v[26:27], v16, s[16:19], 0 offen offset:48
s_waitcnt vmcnt(0)
v_lshlrev_b32 v18, 16, v20
v_add_f32 v32, v32, v18
v_and_b32 v18, 0xffff0000, v20
v_add_f32 v33, v33, v18
v_lshlrev_b32 v18, 16, v21
v_add_f32 v34, v34, v18
v_and_b32 v18, 0xffff0000, v21
v_add_f32 v35, v35, v18
v_lshlrev_b32 v18, 16, v22
v_add_f32 v36, v36, v18
v_and_b32 v18, 0xffff0000, v22
v_add_f32 v37, v37, v18
v_lshlrev_b32 v18, 16, v23
v_add_f32 v38, v38, v18
v_and_b32 v18, 0xffff0000, v23
v_add_f32 v39, v39, v18
v_lshlrev_b32 v18, 16, v24
v_add_f32 v40, v40, v18
v_and_b32 v18, 0xffff0000, v24
v_add_f32 v41, v41, v18
v_lshlrev_b32 v18, 16, v25
v_add_f32 v42, v42, v18
v_and_b32 v18, 0xffff0000, v25
v_add_f32 v43, v43, v18
v_lshlrev_b32 v18, 16, v26
v_add_f32 v44, v44, v18
v_and_b32 v18, 0xffff0000, v26
v_add_f32 v45, v45, v18
v_lshlrev_b32 v18, 16, v27
v_add_f32 v46, v46, v18
v_and_b32 v18, 0xffff0000, v27
v_add_f32 v47, v47, v18
v_cvt_pk_bf16_f32 v48, v32, v33
v_cvt_pk_bf16_f32 v49, v34, v35
buffer_store_dwordx2 v[48:49], v6, s[12:15], 0 offen offset:0
v_cvt_pk_bf16_f32 v50, v36, v37
v_cvt_pk_bf16_f32 v51, v38, v39
buffer_store_dwordx2 v[50:51], v6, s[12:15], 0 offen offset:16
v_cvt_pk_bf16_f32 v52, v40, v41
v_cvt_pk_bf16_f32 v53, v42, v43
buffer_store_dwordx2 v[52:53], v6, s[12:15], 0 offen offset:32
v_cvt_pk_bf16_f32 v54, v44, v45
v_cvt_pk_bf16_f32 v55, v46, v47
buffer_store_dwordx2 v[54:55], v6, s[12:15], 0 offen offset:48
L_wout_0_kernel_end:
s_endpgm
.globl ln1_1_kernel
.p2align 8
.type ln1_1_kernel,@function
ln1_1_kernel:
s_cmp_ge_u32 s2, 2048
s_cbranch_scc1 L_ln1_1_kernel_end
s_load_dwordx2 s[4:5], s[0:1], 80
s_waitcnt lgkmcnt(0)
s_add_u32 s4, s4, 51904512
s_addc_u32 s5, s5, 0
s_mov_b32 s6, 2359296
s_mov_b32 s7, 0x20000
s_load_dwordx2 s[8:9], s[0:1], 80
s_waitcnt lgkmcnt(0)
s_add_u32 s8, s8, 0
s_addc_u32 s9, s9, 0
s_mov_b32 s10, 2359296
s_mov_b32 s11, 0x20000
s_mul_i32 s12, s2, 1152
s_add_u32 s12, s12, 0
s_mul_i32 s13, s2, 1152
v_lshlrev_b32 v1, 1, v0
v_add_u32 v2, s12, v1
v_add_u32 v3, s13, v1
buffer_load_ushort v10, v2, s[4:7], 0 offen offset:0
buffer_load_ushort v11, v2, s[4:7], 0 offen offset:128
buffer_load_ushort v12, v2, s[4:7], 0 offen offset:256
buffer_load_ushort v13, v2, s[4:7], 0 offen offset:384
buffer_load_ushort v14, v2, s[4:7], 0 offen offset:512
buffer_load_ushort v15, v2, s[4:7], 0 offen offset:640
buffer_load_ushort v16, v2, s[4:7], 0 offen offset:768
buffer_load_ushort v17, v2, s[4:7], 0 offen offset:896
buffer_load_ushort v18, v2, s[4:7], 0 offen offset:1024
s_waitcnt vmcnt(0)
v_mov_b32 v4, 0
v_lshlrev_b32 v10, 16, v10
v_add_f32 v4, v4, v10
v_lshlrev_b32 v11, 16, v11
v_add_f32 v4, v4, v11
v_lshlrev_b32 v12, 16, v12
v_add_f32 v4, v4, v12
v_lshlrev_b32 v13, 16, v13
v_add_f32 v4, v4, v13
v_lshlrev_b32 v14, 16, v14
v_add_f32 v4, v4, v14
v_lshlrev_b32 v15, 16, v15
v_add_f32 v4, v4, v15
v_lshlrev_b32 v16, 16, v16
v_add_f32 v4, v4, v16
v_lshlrev_b32 v17, 16, v17
v_add_f32 v4, v4, v17
v_lshlrev_b32 v18, 16, v18
v_add_f32 v4, v4, v18
s_nop 1
v_add_f32_dpp v4, v4, v4 row_shr:1 row_mask:0xf bank_mask:0xf bound_ctrl:0
s_nop 1
v_add_f32_dpp v4, v4, v4 row_shr:2 row_mask:0xf bank_mask:0xf bound_ctrl:0
s_nop 1
v_add_f32_dpp v4, v4, v4 row_shr:4 row_mask:0xf bank_mask:0xf bound_ctrl:0
s_nop 1
v_add_f32_dpp v4, v4, v4 row_shr:8 row_mask:0xf bank_mask:0xf bound_ctrl:0
s_nop 1
v_add_f32_dpp v4, v4, v4 row_bcast:15 row_mask:0xa bank_mask:0xf
s_nop 1
v_add_f32_dpp v4, v4, v4 row_bcast:31 row_mask:0xc bank_mask:0xf
s_nop 1
v_readlane_b32 s16, v4, 63
s_nop 3
v_mov_b32 v6, s16
v_mul_f32 v6, 0x3ae38e39, v6
v_mov_b32 v4, 0
v_sub_f32 v5, v10, v6
v_fmac_f32 v4, v5, v5
v_sub_f32 v5, v11, v6
v_fmac_f32 v4, v5, v5
v_sub_f32 v5, v12, v6
v_fmac_f32 v4, v5, v5
v_sub_f32 v5, v13, v6
v_fmac_f32 v4, v5, v5
v_sub_f32 v5, v14, v6
v_fmac_f32 v4, v5, v5
v_sub_f32 v5, v15, v6
v_fmac_f32 v4, v5, v5
v_sub_f32 v5, v16, v6
v_fmac_f32 v4, v5, v5
v_sub_f32 v5, v17, v6
v_fmac_f32 v4, v5, v5
v_sub_f32 v5, v18, v6
v_fmac_f32 v4, v5, v5
s_nop 1
v_add_f32_dpp v4, v4, v4 row_shr:1 row_mask:0xf bank_mask:0xf bound_ctrl:0
s_nop 1
v_add_f32_dpp v4, v4, v4 row_shr:2 row_mask:0xf bank_mask:0xf bound_ctrl:0
s_nop 1
v_add_f32_dpp v4, v4, v4 row_shr:4 row_mask:0xf bank_mask:0xf bound_ctrl:0
s_nop 1
v_add_f32_dpp v4, v4, v4 row_shr:8 row_mask:0xf bank_mask:0xf bound_ctrl:0
s_nop 1
v_add_f32_dpp v4, v4, v4 row_bcast:15 row_mask:0xa bank_mask:0xf
s_nop 1
v_add_f32_dpp v4, v4, v4 row_bcast:31 row_mask:0xc bank_mask:0xf
s_nop 1
v_readlane_b32 s17, v4, 63
s_nop 3
v_mov_b32 v7, s17
v_mul_f32 v7, 0x3ae38e39, v7
v_add_f32 v7, 0x3727c5ac, v7
v_sqrt_f32 v7, v7
s_nop 1
v_rcp_f32 v7, v7
s_nop 1
v_sub_f32 v5, v10, v6
v_mul_f32 v5, v5, v7
v_cvt_pk_bf16_f32 v10, v5, v5
v_sub_f32 v5, v11, v6
v_mul_f32 v5, v5, v7
v_cvt_pk_bf16_f32 v11, v5, v5
v_sub_f32 v5, v12, v6
v_mul_f32 v5, v5, v7
v_cvt_pk_bf16_f32 v12, v5, v5
v_sub_f32 v5, v13, v6
v_mul_f32 v5, v5, v7
v_cvt_pk_bf16_f32 v13, v5, v5
v_sub_f32 v5, v14, v6
v_mul_f32 v5, v5, v7
v_cvt_pk_bf16_f32 v14, v5, v5
v_sub_f32 v5, v15, v6
v_mul_f32 v5, v5, v7
v_cvt_pk_bf16_f32 v15, v5, v5
v_sub_f32 v5, v16, v6
v_mul_f32 v5, v5, v7
v_cvt_pk_bf16_f32 v16, v5, v5
v_sub_f32 v5, v17, v6
v_mul_f32 v5, v5, v7
v_cvt_pk_bf16_f32 v17, v5, v5
v_sub_f32 v5, v18, v6
v_mul_f32 v5, v5, v7
v_cvt_pk_bf16_f32 v18, v5, v5
buffer_store_short v10, v3, s[8:11], 0 offen offset:0
buffer_store_short v11, v3, s[8:11], 0 offen offset:128
buffer_store_short v12, v3, s[8:11], 0 offen offset:256
buffer_store_short v13, v3, s[8:11], 0 offen offset:384
buffer_store_short v14, v3, s[8:11], 0 offen offset:512
buffer_store_short v15, v3, s[8:11], 0 offen offset:640
buffer_store_short v16, v3, s[8:11], 0 offen offset:768
buffer_store_short v17, v3, s[8:11], 0 offen offset:896
buffer_store_short v18, v3, s[8:11], 0 offen offset:1024
L_ln1_1_kernel_end:
s_endpgm
.globl wo_1_kernel
.p2align 8
.type wo_1_kernel,@function
wo_1_kernel:
s_cmp_ge_u32 s2, 1152
s_cbranch_scc1 L_wo_1_kernel_end
s_load_dwordx2 s[4:5], s[0:1], 80
s_waitcnt lgkmcnt(0)
s_add_u32 s4, s4, 9437184
s_addc_u32 s5, s5, 0
s_mov_b32 s6, 2359296
s_mov_b32 s7, 0x20000
s_load_dwordx2 s[8:9], s[0:1], 16
s_waitcnt lgkmcnt(0)
s_mov_b32 s10, 663552
s_mov_b32 s11, 0x20000
s_load_dwordx2 s[12:13], s[0:1], 80
s_waitcnt lgkmcnt(0)
s_add_u32 s12, s12, 11796480
s_addc_u32 s13, s13, 0
s_mov_b32 s14, 2359296
s_mov_b32 s15, 0x20000
s_load_dwordx2 s[16:17], s[0:1], 80
s_waitcnt lgkmcnt(0)
s_add_u32 s16, s16, 51904512
s_addc_u32 s17, s17, 0
s_mov_b32 s18, 2359296
s_mov_b32 s19, 0x20000
s_and_b32 s24, s2, 63
s_lshr_b32 s25, s2, 6
s_lshl_b32 s24, s24, 5
s_lshl_b32 s25, s25, 5
v_and_b32 v1, 31, v0
v_lshrrev_b32 v2, 5, v0
v_add_u32 v3, s24, v1
s_mov_b32 s26, 1152
v_mul_lo_u32 v4, v3, s26
v_lshlrev_b32 v5, 4, v2
v_add_u32 v4, v4, v5
v_add_u32 v5, s25, v1
v_lshlrev_b32 v5, 1, v5
s_mov_b32 s26, 9216
v_mul_lo_u32 v6, v2, s26
v_add_u32 v5, v5, v6
v_mov_b32 v32, 0
v_mov_b32 v33, 0
v_mov_b32 v34, 0
v_mov_b32 v35, 0
v_mov_b32 v36, 0
v_mov_b32 v37, 0
v_mov_b32 v38, 0
v_mov_b32 v39, 0
v_mov_b32 v40, 0
v_mov_b32 v41, 0
v_mov_b32 v42, 0
v_mov_b32 v43, 0
v_mov_b32 v44, 0
v_mov_b32 v45, 0
v_mov_b32 v46, 0
v_mov_b32 v47, 0
s_mov_b32 s27, 0
s_mov_b32 s28, 0
s_mov_b32 s29, 0
L_wo_1_kernel_k:
buffer_load_dwordx4 v[8:11], v4, s[4:7], s28 offen
s_add_u32 s30, s29, 0
buffer_load_ushort v20, v5, s[8:11], s30 offen
s_add_u32 s30, s29, 1152
buffer_load_ushort v21, v5, s[8:11], s30 offen
s_add_u32 s30, s29, 2304
buffer_load_ushort v22, v5, s[8:11], s30 offen
s_add_u32 s30, s29, 3456
buffer_load_ushort v23, v5, s[8:11], s30 offen
s_add_u32 s30, s29, 4608
buffer_load_ushort v24, v5, s[8:11], s30 offen
s_add_u32 s30, s29, 5760
buffer_load_ushort v25, v5, s[8:11], s30 offen
s_add_u32 s30, s29, 6912
buffer_load_ushort v26, v5, s[8:11], s30 offen
s_add_u32 s30, s29, 8064
buffer_load_ushort v27, v5, s[8:11], s30 offen
s_waitcnt vmcnt(0)
v_lshl_or_b32 v12, v21, 16, v20
v_lshl_or_b32 v13, v23, 16, v22
v_lshl_or_b32 v14, v25, 16, v24
v_lshl_or_b32 v15, v27, 16, v26
s_nop 1
v_mfma_f32_32x32x16_bf16 v[32:47], v[12:15], v[8:11], v[32:47]
s_add_u32 s28, s28, 32
s_add_u32 s29, s29, 18432
s_add_u32 s27, s27, 16
s_cmp_lt_u32 s27, 576
s_cbranch_scc1 L_wo_1_kernel_k
s_nop 15
s_mov_b32 s26, 1152
v_mul_lo_u32 v6, v3, s26
v_lshlrev_b32 v7, 3, v2
v_add_u32 v6, v6, v7
s_lshl_b32 s26, s25, 1
v_add_u32 v6, s26, v6
s_mov_b32 s26, 1152
v_mul_lo_u32 v16, v3, s26
v_add_u32 v16, v16, v7
s_lshl_b32 s26, s25, 1
v_add_u32 v16, s26, v16
buffer_load_dwordx2 v[20:21], v16, s[16:19], 0 offen offset:0
buffer_load_dwordx2 v[22:23], v16, s[16:19], 0 offen offset:16
buffer_load_dwordx2 v[24:25], v16, s[16:19], 0 offen offset:32
buffer_load_dwordx2 v[26:27], v16, s[16:19], 0 offen offset:48
s_waitcnt vmcnt(0)
v_lshlrev_b32 v18, 16, v20
v_add_f32 v32, v32, v18
v_and_b32 v18, 0xffff0000, v20
v_add_f32 v33, v33, v18
v_lshlrev_b32 v18, 16, v21
v_add_f32 v34, v34, v18
v_and_b32 v18, 0xffff0000, v21
v_add_f32 v35, v35, v18
v_lshlrev_b32 v18, 16, v22
v_add_f32 v36, v36, v18
v_and_b32 v18, 0xffff0000, v22
v_add_f32 v37, v37, v18
v_lshlrev_b32 v18, 16, v23
v_add_f32 v38, v38, v18
v_and_b32 v18, 0xffff0000, v23
v_add_f32 v39, v39, v18
v_lshlrev_b32 v18, 16, v24
v_add_f32 v40, v40, v18
v_and_b32 v18, 0xffff0000, v24
v_add_f32 v41, v41, v18
v_lshlrev_b32 v18, 16, v25
v_add_f32 v42, v42, v18
v_and_b32 v18, 0xffff0000, v25
v_add_f32 v43, v43, v18
v_lshlrev_b32 v18, 16, v26
v_add_f32 v44, v44, v18
v_and_b32 v18, 0xffff0000, v26
v_add_f32 v45, v45, v18
v_lshlrev_b32 v18, 16, v27
v_add_f32 v46, v46, v18
v_and_b32 v18, 0xffff0000, v27
v_add_f32 v47, v47, v18
v_cvt_pk_bf16_f32 v48, v32, v33
v_cvt_pk_bf16_f32 v49, v34, v35
buffer_store_dwordx2 v[48:49], v6, s[12:15], 0 offen offset:0
v_cvt_pk_bf16_f32 v50, v36, v37
v_cvt_pk_bf16_f32 v51, v38, v39
buffer_store_dwordx2 v[50:51], v6, s[12:15], 0 offen offset:16
v_cvt_pk_bf16_f32 v52, v40, v41
v_cvt_pk_bf16_f32 v53, v42, v43
buffer_store_dwordx2 v[52:53], v6, s[12:15], 0 offen offset:32
v_cvt_pk_bf16_f32 v54, v44, v45
v_cvt_pk_bf16_f32 v55, v46, v47
buffer_store_dwordx2 v[54:55], v6, s[12:15], 0 offen offset:48
L_wo_1_kernel_end:
s_endpgm
.globl wout_1_kernel
.p2align 8
.type wout_1_kernel,@function
wout_1_kernel:
s_cmp_ge_u32 s2, 1152
s_cbranch_scc1 L_wout_1_kernel_end
s_load_dwordx2 s[4:5], s[0:1], 80
s_waitcnt lgkmcnt(0)
s_add_u32 s4, s4, 42467328
s_addc_u32 s5, s5, 0
s_mov_b32 s6, 9437184
s_mov_b32 s7, 0x20000
s_load_dwordx2 s[8:9], s[0:1], 56
s_waitcnt lgkmcnt(0)
s_mov_b32 s10, 2654208
s_mov_b32 s11, 0x20000
s_load_dwordx2 s[12:13], s[0:1], 64
s_waitcnt lgkmcnt(0)
s_mov_b32 s14, 2359296
s_mov_b32 s15, 0x20000
s_load_dwordx2 s[16:17], s[0:1], 80
s_waitcnt lgkmcnt(0)
s_add_u32 s16, s16, 11796480
s_addc_u32 s17, s17, 0
s_mov_b32 s18, 2359296
s_mov_b32 s19, 0x20000
s_and_b32 s24, s2, 63
s_lshr_b32 s25, s2, 6
s_lshl_b32 s24, s24, 5
s_lshl_b32 s25, s25, 5
v_and_b32 v1, 31, v0
v_lshrrev_b32 v2, 5, v0
v_add_u32 v3, s24, v1
s_mov_b32 s26, 4608
v_mul_lo_u32 v4, v3, s26
v_lshlrev_b32 v5, 4, v2
v_add_u32 v4, v4, v5
v_add_u32 v5, s25, v1
v_lshlrev_b32 v5, 1, v5
s_mov_b32 s26, 9216
v_mul_lo_u32 v6, v2, s26
v_add_u32 v5, v5, v6
v_mov_b32 v32, 0
v_mov_b32 v33, 0
v_mov_b32 v34, 0
v_mov_b32 v35, 0
v_mov_b32 v36, 0
v_mov_b32 v37, 0
v_mov_b32 v38, 0
v_mov_b32 v39, 0
v_mov_b32 v40, 0
v_mov_b32 v41, 0
v_mov_b32 v42, 0
v_mov_b32 v43, 0
v_mov_b32 v44, 0
v_mov_b32 v45, 0
v_mov_b32 v46, 0
v_mov_b32 v47, 0
s_mov_b32 s27, 0
s_mov_b32 s28, 0
s_mov_b32 s29, 0
L_wout_1_kernel_k:
buffer_load_dwordx4 v[8:11], v4, s[4:7], s28 offen
s_add_u32 s30, s29, 0
buffer_load_ushort v20, v5, s[8:11], s30 offen
s_add_u32 s30, s29, 1152
buffer_load_ushort v21, v5, s[8:11], s30 offen
s_add_u32 s30, s29, 2304
buffer_load_ushort v22, v5, s[8:11], s30 offen
s_add_u32 s30, s29, 3456
buffer_load_ushort v23, v5, s[8:11], s30 offen
s_add_u32 s30, s29, 4608
buffer_load_ushort v24, v5, s[8:11], s30 offen
s_add_u32 s30, s29, 5760
buffer_load_ushort v25, v5, s[8:11], s30 offen
s_add_u32 s30, s29, 6912
buffer_load_ushort v26, v5, s[8:11], s30 offen
s_add_u32 s30, s29, 8064
buffer_load_ushort v27, v5, s[8:11], s30 offen
s_waitcnt vmcnt(0)
v_lshl_or_b32 v12, v21, 16, v20
v_lshl_or_b32 v13, v23, 16, v22
v_lshl_or_b32 v14, v25, 16, v24
v_lshl_or_b32 v15, v27, 16, v26
s_nop 1
v_mfma_f32_32x32x16_bf16 v[32:47], v[12:15], v[8:11], v[32:47]
s_add_u32 s28, s28, 32
s_add_u32 s29, s29, 18432
s_add_u32 s27, s27, 16
s_cmp_lt_u32 s27, 2304
s_cbranch_scc1 L_wout_1_kernel_k
s_nop 15
s_mov_b32 s26, 1152
v_mul_lo_u32 v6, v3, s26
v_lshlrev_b32 v7, 3, v2
v_add_u32 v6, v6, v7
s_lshl_b32 s26, s25, 1
v_add_u32 v6, s26, v6
s_mov_b32 s26, 1152
v_mul_lo_u32 v16, v3, s26
v_add_u32 v16, v16, v7
s_lshl_b32 s26, s25, 1
v_add_u32 v16, s26, v16
buffer_load_dwordx2 v[20:21], v16, s[16:19], 0 offen offset:0
buffer_load_dwordx2 v[22:23], v16, s[16:19], 0 offen offset:16
buffer_load_dwordx2 v[24:25], v16, s[16:19], 0 offen offset:32
buffer_load_dwordx2 v[26:27], v16, s[16:19], 0 offen offset:48
s_waitcnt vmcnt(0)
v_lshlrev_b32 v18, 16, v20
v_add_f32 v32, v32, v18
v_and_b32 v18, 0xffff0000, v20
v_add_f32 v33, v33, v18
v_lshlrev_b32 v18, 16, v21
v_add_f32 v34, v34, v18
v_and_b32 v18, 0xffff0000, v21
v_add_f32 v35, v35, v18
v_lshlrev_b32 v18, 16, v22
v_add_f32 v36, v36, v18
v_and_b32 v18, 0xffff0000, v22
v_add_f32 v37, v37, v18
v_lshlrev_b32 v18, 16, v23
v_add_f32 v38, v38, v18
v_and_b32 v18, 0xffff0000, v23
v_add_f32 v39, v39, v18
v_lshlrev_b32 v18, 16, v24
v_add_f32 v40, v40, v18
v_and_b32 v18, 0xffff0000, v24
v_add_f32 v41, v41, v18
v_lshlrev_b32 v18, 16, v25
v_add_f32 v42, v42, v18
v_and_b32 v18, 0xffff0000, v25
v_add_f32 v43, v43, v18
v_lshlrev_b32 v18, 16, v26
v_add_f32 v44, v44, v18
v_and_b32 v18, 0xffff0000, v26
v_add_f32 v45, v45, v18
v_lshlrev_b32 v18, 16, v27
v_add_f32 v46, v46, v18
v_and_b32 v18, 0xffff0000, v27
v_add_f32 v47, v47, v18
v_cvt_pk_bf16_f32 v48, v32, v33
v_cvt_pk_bf16_f32 v49, v34, v35
buffer_store_dwordx2 v[48:49], v6, s[12:15], 0 offen offset:0
v_cvt_pk_bf16_f32 v50, v36, v37
v_cvt_pk_bf16_f32 v51, v38, v39
buffer_store_dwordx2 v[50:51], v6, s[12:15], 0 offen offset:16
v_cvt_pk_bf16_f32 v52, v40, v41
v_cvt_pk_bf16_f32 v53, v42, v43
buffer_store_dwordx2 v[52:53], v6, s[12:15], 0 offen offset:32
v_cvt_pk_bf16_f32 v54, v44, v45
v_cvt_pk_bf16_f32 v55, v46, v47
buffer_store_dwordx2 v[54:55], v6, s[12:15], 0 offen offset:48
L_wout_1_kernel_end:
s_endpgm
.section .rodata,"a"
.p2align 6
.amdhsa_kernel ln1_0_kernel
  .amdhsa_next_free_vgpr 128
  .amdhsa_next_free_sgpr 64
  .amdhsa_accum_offset 128
  .amdhsa_group_segment_fixed_size 0
  .amdhsa_kernarg_size 88
  .amdhsa_user_sgpr_count 2
  .amdhsa_user_sgpr_kernarg_segment_ptr 1
  .amdhsa_system_sgpr_workgroup_id_x 1
  .amdhsa_float_denorm_mode_32 3
.end_amdhsa_kernel
.p2align 6
.amdhsa_kernel qkv_kernel
  .amdhsa_next_free_vgpr 64
  .amdhsa_next_free_sgpr 64
  .amdhsa_accum_offset 64
  .amdhsa_group_segment_fixed_size 0
  .amdhsa_kernarg_size 88
  .amdhsa_user_sgpr_count 2
  .amdhsa_user_sgpr_kernarg_segment_ptr 1
  .amdhsa_system_sgpr_workgroup_id_x 1
  .amdhsa_float_denorm_mode_32 3
.end_amdhsa_kernel
.p2align 6
.amdhsa_kernel attn_kernel
  .amdhsa_next_free_vgpr 64
  .amdhsa_next_free_sgpr 64
  .amdhsa_accum_offset 64
  .amdhsa_group_segment_fixed_size 0
  .amdhsa_kernarg_size 88
  .amdhsa_user_sgpr_count 2
  .amdhsa_user_sgpr_kernarg_segment_ptr 1
  .amdhsa_system_sgpr_workgroup_id_x 1
  .amdhsa_float_denorm_mode_32 3
.end_amdhsa_kernel
.p2align 6
.amdhsa_kernel wo_0_kernel
  .amdhsa_next_free_vgpr 64
  .amdhsa_next_free_sgpr 64
  .amdhsa_accum_offset 64
  .amdhsa_group_segment_fixed_size 0
  .amdhsa_kernarg_size 88
  .amdhsa_user_sgpr_count 2
  .amdhsa_user_sgpr_kernarg_segment_ptr 1
  .amdhsa_system_sgpr_workgroup_id_x 1
  .amdhsa_float_denorm_mode_32 3
.end_amdhsa_kernel
.p2align 6
.amdhsa_kernel ln2_kernel
  .amdhsa_next_free_vgpr 128
  .amdhsa_next_free_sgpr 64
  .amdhsa_accum_offset 128
  .amdhsa_group_segment_fixed_size 0
  .amdhsa_kernarg_size 88
  .amdhsa_user_sgpr_count 2
  .amdhsa_user_sgpr_kernarg_segment_ptr 1
  .amdhsa_system_sgpr_workgroup_id_x 1
  .amdhsa_float_denorm_mode_32 3
.end_amdhsa_kernel
.p2align 6
.amdhsa_kernel win_kernel
  .amdhsa_next_free_vgpr 64
  .amdhsa_next_free_sgpr 64
  .amdhsa_accum_offset 64
  .amdhsa_group_segment_fixed_size 0
  .amdhsa_kernarg_size 88
  .amdhsa_user_sgpr_count 2
  .amdhsa_user_sgpr_kernarg_segment_ptr 1
  .amdhsa_system_sgpr_workgroup_id_x 1
  .amdhsa_float_denorm_mode_32 3
.end_amdhsa_kernel
.p2align 6
.amdhsa_kernel ln3_kernel
  .amdhsa_next_free_vgpr 128
  .amdhsa_next_free_sgpr 64
  .amdhsa_accum_offset 128
  .amdhsa_group_segment_fixed_size 0
  .amdhsa_kernarg_size 88
  .amdhsa_user_sgpr_count 2
  .amdhsa_user_sgpr_kernarg_segment_ptr 1
  .amdhsa_system_sgpr_workgroup_id_x 1
  .amdhsa_float_denorm_mode_32 3
.end_amdhsa_kernel
.p2align 6
.amdhsa_kernel sp_kernel
  .amdhsa_next_free_vgpr 64
  .amdhsa_next_free_sgpr 64
  .amdhsa_accum_offset 64
  .amdhsa_group_segment_fixed_size 0
  .amdhsa_kernarg_size 88
  .amdhsa_user_sgpr_count 2
  .amdhsa_user_sgpr_kernarg_segment_ptr 1
  .amdhsa_system_sgpr_workgroup_id_x 1
  .amdhsa_float_denorm_mode_32 3
.end_amdhsa_kernel
.p2align 6
.amdhsa_kernel wout_0_kernel
  .amdhsa_next_free_vgpr 64
  .amdhsa_next_free_sgpr 64
  .amdhsa_accum_offset 64
  .amdhsa_group_segment_fixed_size 0
  .amdhsa_kernarg_size 88
  .amdhsa_user_sgpr_count 2
  .amdhsa_user_sgpr_kernarg_segment_ptr 1
  .amdhsa_system_sgpr_workgroup_id_x 1
  .amdhsa_float_denorm_mode_32 3
.end_amdhsa_kernel
.p2align 6
.amdhsa_kernel ln1_1_kernel
  .amdhsa_next_free_vgpr 128
  .amdhsa_next_free_sgpr 64
  .amdhsa_accum_offset 128
  .amdhsa_group_segment_fixed_size 0
  .amdhsa_kernarg_size 88
  .amdhsa_user_sgpr_count 2
  .amdhsa_user_sgpr_kernarg_segment_ptr 1
  .amdhsa_system_sgpr_workgroup_id_x 1
  .amdhsa_float_denorm_mode_32 3
.end_amdhsa_kernel
.p2align 6
.amdhsa_kernel wo_1_kernel
  .amdhsa_next_free_vgpr 64
  .amdhsa_next_free_sgpr 64
  .amdhsa_accum_offset 64
  .amdhsa_group_segment_fixed_size 0
  .amdhsa_kernarg_size 88
  .amdhsa_user_sgpr_count 2
  .amdhsa_user_sgpr_kernarg_segment_ptr 1
  .amdhsa_system_sgpr_workgroup_id_x 1
  .amdhsa_float_denorm_mode_32 3
.end_amdhsa_kernel
.p2align 6
.amdhsa_kernel wout_1_kernel
  .amdhsa_next_free_vgpr 64
  .amdhsa_next_free_sgpr 64
  .amdhsa_accum_offset 64
  .amdhsa_group_segment_fixed_size 0
  .amdhsa_kernarg_size 88
  .amdhsa_user_sgpr_count 2
  .amdhsa_user_sgpr_kernarg_segment_ptr 1
  .amdhsa_system_sgpr_workgroup_id_x 1
  .amdhsa_float_denorm_mode_32 3
.end_amdhsa_kernel
```

```asm
; @launch kernel=prep_kernel grid=(704,1,1) block=(256,1,1) lds=20480
; @launch kernel=main_kernel grid=(256,1,1) block=(256,1,1) lds=163840
.amdgcn_target "amdgcn-amd-amdhsa--gfx950"
.text
.globl prep_kernel
.p2align 8
.type prep_kernel,@function
prep_kernel:
s_cmp_ge_u32 s2, 704
s_cbranch_scc1 L_prep_end
s_load_dwordx2 s[4:5], s[0:1], 80
v_lshrrev_b32 v4, 6, v0
v_and_b32 v1, 63, v0
v_readfirstlane_b32 s12, v4
v_and_b32 v2, 15, v1
v_lshrrev_b32 v3, 4, v1
s_mov_b32 s6, 64176128
s_mov_b32 s7, 0x20000
s_mov_b32 s11, 0x20000
s_cmp_lt_u32 s2, 128
s_cbranch_scc1 L_prep_x
s_cmp_lt_u32 s2, 236
s_cbranch_scc1 L_prep_w1
s_cmp_lt_u32 s2, 272
s_cbranch_scc1 L_prep_w2
s_cmp_lt_u32 s2, 560
s_cbranch_scc1 L_prep_w3
s_load_dwordx2 s[8:9], s[0:1], 56
s_mov_b32 s10, 2654208
s_sub_u32 s13, s2, 560
s_and_b32 s14, s13, 15
s_lshr_b32 s15, s13, 4
s_mul_i32 s16, s14, 165888
s_lshl_b32 s17, s15, 7
s_add_u32 s16, s16, s17
s_mul_i32 s17, s12, 9216
s_add_u32 s16, s16, s17
v_lshrrev_b32 v4, 3, v1
v_mul_u32_u24 v7, 1152, v4
v_and_b32 v4, 7, v1
v_lshl_add_u32 v7, v4, 4, v7
s_lshl_b32 s18, s12, 10
s_waitcnt lgkmcnt(0)
s_add_u32 s19, s18, 0
s_mov_b32 m0, s19
s_add_u32 s17, s16, 0
buffer_load_dwordx4 v7, s[8:11], s17 offen lds
s_add_u32 s19, s18, 4096
s_mov_b32 m0, s19
s_add_u32 s17, s16, 36864
buffer_load_dwordx4 v7, s[8:11], s17 offen lds
s_add_u32 s19, s18, 8192
s_mov_b32 m0, s19
s_add_u32 s17, s16, 73728
buffer_load_dwordx4 v7, s[8:11], s17 offen lds
s_add_u32 s19, s18, 12288
s_mov_b32 m0, s19
s_add_u32 s17, s16, 110592
buffer_load_dwordx4 v7, s[8:11], s17 offen lds
s_add_u32 s19, s18, 16384
s_mov_b32 m0, s19
s_add_u32 s17, s16, 147456
s_cmp_lt_u32 s12, 2
s_cselect_b32 s17, s17, 1073741824
buffer_load_dwordx4 v7, s[8:11], s17 offen lds
v_lshrrev_b32 v4, 2, v2
v_lshl_add_u32 v4, v3, 3, v4
v_lshlrev_b32 v10, 7, v4
v_and_b32 v4, 3, v2
v_lshl_add_u32 v10, v4, 3, v10
s_lshl_b32 s17, s12, 5
v_add_u32 v10, s17, v10
s_lshl_b32 s17, s15, 6
s_lshl_b32 s19, s12, 4
s_add_u32 s17, s17, s19
v_add_u32 v4, s17, v2
v_mul_u32_u24 v5, 911, v4
v_lshrrev_b32 v5, 16, v5
v_mul_u32_u24 v6, 72, v5
v_sub_u32 v4, v4, v6
s_mov_b32 s17, 331776
v_mul_lo_u32 v8, v5, s17
s_mul_i32 s17, s14, 18
v_add_u32 v5, s17, v3
v_and_b32 v6, 3, v5
v_lshrrev_b32 v5, 2, v5
v_mul_u32_u24 v5, 4608, v5
v_add_u32 v8, v8, v5
v_add_u32 v8, 8241152, v8
v_lshrrev_b32 v14, 5, v4
v_lshlrev_b32 v14, 11, v14
v_bfe_u32 v15, v4, 2, 1
v_lshl_add_u32 v14, v15, 10, v14
v_bfe_u32 v15, v4, 3, 2
v_lshl_add_u32 v14, v15, 6, v14
v_and_b32 v15, 3, v4
v_lshl_add_u32 v14, v15, 4, v14
v_lshl_add_u32 v14, v6, 8, v14
v_lshlrev_b32 v15, 4, v4
v_add_u32 v15, 3072, v15
v_lshl_add_u32 v15, v6, 7, v15
v_cmp_gt_u32 vcc, 64, v4
s_nop 1
v_cndmask_b32 v14, v15, v14, vcc
v_add_u32 v8, v8, v14
s_waitcnt vmcnt(0)
s_barrier
ds_read_b64_tr_b16 v[16:17], v10 offset:0
ds_read_b64_tr_b16 v[18:19], v10 offset:512
ds_read_b64_tr_b16 v[20:21], v10 offset:4096
ds_read_b64_tr_b16 v[22:23], v10 offset:4608
ds_read_b64_tr_b16 v[24:25], v10 offset:8192
ds_read_b64_tr_b16 v[26:27], v10 offset:8704
ds_read_b64_tr_b16 v[28:29], v10 offset:12288
ds_read_b64_tr_b16 v[30:31], v10 offset:12800
ds_read_b64_tr_b16 v[32:33], v10 offset:16384
ds_read_b64_tr_b16 v[34:35], v10 offset:16896
v_cmp_gt_u32 vcc, 2, v3
v_mov_b32 v4, 1073741824
v_mov_b32 v11, 0
v_cndmask_b32 v4, v4, v8, vcc
s_mov_b32 s17, 0
s_waitcnt lgkmcnt(8)
buffer_store_dwordx4 v[16:19], v8, s[4:7], s17 offen
s_mov_b32 s17, 4608
s_waitcnt lgkmcnt(6)
buffer_store_dwordx4 v[20:23], v8, s[4:7], s17 offen
s_mov_b32 s17, 9216
s_waitcnt lgkmcnt(4)
buffer_store_dwordx4 v[24:27], v8, s[4:7], s17 offen
s_mov_b32 s17, 13824
s_waitcnt lgkmcnt(2)
buffer_store_dwordx4 v[28:31], v8, s[4:7], s17 offen
s_mov_b32 s17, 18432
s_waitcnt lgkmcnt(0)
buffer_store_dwordx4 v[32:35], v4, s[4:7], s17 offen
s_branch L_prep_tail
L_prep_w3:
s_load_dwordx2 s[8:9], s[0:1], 32
s_mov_b32 s10, 5308416
s_sub_u32 s13, s2, 272
s_and_b32 s14, s13, 3
s_lshr_b32 s15, s13, 2
s_mul_i32 s16, s14, 1327104
s_lshl_b32 s17, s15, 7
s_add_u32 s16, s16, s17
s_mul_i32 s17, s12, 73728
s_add_u32 s16, s16, s17
v_lshrrev_b32 v4, 3, v1
v_mul_u32_u24 v7, 9216, v4
v_and_b32 v4, 7, v1
v_lshl_add_u32 v7, v4, 4, v7
s_lshl_b32 s18, s12, 10
s_waitcnt lgkmcnt(0)
s_add_u32 s19, s18, 0
s_mov_b32 m0, s19
s_add_u32 s17, s16, 0
buffer_load_dwordx4 v7, s[8:11], s17 offen lds
s_add_u32 s19, s18, 4096
s_mov_b32 m0, s19
s_add_u32 s17, s16, 294912
buffer_load_dwordx4 v7, s[8:11], s17 offen lds
s_add_u32 s19, s18, 8192
s_mov_b32 m0, s19
s_add_u32 s17, s16, 589824
buffer_load_dwordx4 v7, s[8:11], s17 offen lds
s_add_u32 s19, s18, 12288
s_mov_b32 m0, s19
s_add_u32 s17, s16, 884736
buffer_load_dwordx4 v7, s[8:11], s17 offen lds
s_add_u32 s19, s18, 16384
s_mov_b32 m0, s19
s_add_u32 s17, s16, 1179648
s_cmp_lt_u32 s12, 2
s_cselect_b32 s17, s17, 1073741824
buffer_load_dwordx4 v7, s[8:11], s17 offen lds
v_lshrrev_b32 v4, 2, v2
v_lshl_add_u32 v4, v3, 3, v4
v_lshlrev_b32 v10, 7, v4
v_and_b32 v4, 3, v2
v_lshl_add_u32 v10, v4, 3, v10
s_lshl_b32 s17, s12, 5
v_add_u32 v10, s17, v10
s_lshl_b32 s20, s15, 6
s_lshl_b32 s19, s12, 4
s_add_u32 s20, s20, s19
s_cmp_ge_u32 s20, 2304
s_cselect_b32 s21, 1, 0
s_cselect_b32 s19, 2304, 0
s_sub_u32 s20, s20, s19
s_mul_i32 s22, s20, 1821
s_lshr_b32 s22, s22, 19
s_mul_i32 s19, s22, 288
s_sub_u32 s20, s20, s19
s_lshr_b32 s23, s20, 5
s_bfe_u32 s24, s20, 0x10004
s_lshl_b32 s22, s22, 1
s_cmp_ge_u32 s20, 144
s_addc_u32 s22, s22, 0
s_cmp_gt_u32 s23, 4
s_cselect_b32 s19, 5, 0
s_sub_u32 s25, s23, s19
s_cmp_eq_u32 s21, 0
s_cselect_b32 s19, 5, 0
s_add_u32 s25, s25, s19
s_cmp_eq_u32 s23, 4
s_cselect_b32 s25, 4, s25
s_mul_i32 s22, s22, 9
s_add_u32 s22, s22, s25
s_mul_i32 s22, s22, 37888
s_add_u32 s22, s22, 2785280
v_and_b32 v4, 3, v2
v_bfe_u32 v5, v2, 2, 1
v_bfe_u32 v6, v2, 3, 1
s_cmp_eq_u32 s23, 4
s_cbranch_scc1 L_prep_w3m
s_cmp_eq_u32 s21, 0
s_cbranch_scc1 L_prep_w3a
s_lshl_b32 s19, s24, 4
v_add_u32 v4, s19, v2
s_branch L_prep_w3j
L_prep_w3a:
v_lshl_add_u32 v4, v5, 4, v4
v_lshl_add_u32 v4, v6, 3, v4
s_lshl_b32 s19, s24, 2
v_add_u32 v4, s19, v4
s_branch L_prep_w3j
L_prep_w3m:
v_lshl_add_u32 v4, v5, 3, v4
v_lshl_add_u32 v4, v6, 2, v4
s_xor_b32 s19, s21, 1
s_lshl_b32 s19, s19, 4
v_add_u32 v4, s19, v4
L_prep_w3j:
v_lshlrev_b32 v4, 4, v4
v_add_u32 v4, s22, v4
s_mul_i32 s17, s14, 9216
v_lshl_add_u32 v8, v3, 9, v4
v_add_u32 v8, s17, v8
s_lshr_b32 s17, s14, 1
s_lshl_b32 s17, s17, 9
s_and_b32 s19, s14, 1
s_lshl_b32 s19, s19, 3
s_add_u32 s17, s17, s19
s_add_u32 s17, s17, 36864
v_add_u32 v9, s17, v4
s_waitcnt vmcnt(0)
s_barrier
ds_read_b64_tr_b16 v[16:17], v10 offset:0
ds_read_b64_tr_b16 v[18:19], v10 offset:512
ds_read_b64_tr_b16 v[20:21], v10 offset:4096
ds_read_b64_tr_b16 v[22:23], v10 offset:4608
ds_read_b64_tr_b16 v[24:25], v10 offset:8192
ds_read_b64_tr_b16 v[26:27], v10 offset:8704
ds_read_b64_tr_b16 v[28:29], v10 offset:12288
ds_read_b64_tr_b16 v[30:31], v10 offset:12800
ds_read_b64_tr_b16 v[32:33], v10 offset:16384
ds_read_b64_tr_b16 v[34:35], v10 offset:16896
v_cmp_gt_u32 vcc, 2, v3
v_mov_b32 v4, 1073741824
v_mov_b32 v11, 0
v_cndmask_b32 v4, v4, v8, vcc
s_mov_b32 s17, 0
s_waitcnt lgkmcnt(8)
buffer_store_dwordx4 v[16:19], v8, s[4:7], s17 offen
s_mov_b32 s17, 2048
s_waitcnt lgkmcnt(6)
buffer_store_dwordx4 v[20:23], v8, s[4:7], s17 offen
s_mov_b32 s17, 4096
s_waitcnt lgkmcnt(4)
buffer_store_dwordx4 v[24:27], v8, s[4:7], s17 offen
s_mov_b32 s17, 6144
s_waitcnt lgkmcnt(2)
buffer_store_dwordx4 v[28:31], v8, s[4:7], s17 offen
s_mov_b32 s17, 8192
s_waitcnt lgkmcnt(0)
buffer_store_dwordx4 v[32:35], v4, s[4:7], s17 offen
v_mov_b32 v5, 0x3f803f80
v_dot2c_f32_bf16 v11, v16, v5
v_dot2c_f32_bf16 v11, v17, v5
v_dot2c_f32_bf16 v11, v18, v5
v_dot2c_f32_bf16 v11, v19, v5
v_dot2c_f32_bf16 v11, v20, v5
v_dot2c_f32_bf16 v11, v21, v5
v_dot2c_f32_bf16 v11, v22, v5
v_dot2c_f32_bf16 v11, v23, v5
v_dot2c_f32_bf16 v11, v24, v5
v_dot2c_f32_bf16 v11, v25, v5
v_dot2c_f32_bf16 v11, v26, v5
v_dot2c_f32_bf16 v11, v27, v5
v_dot2c_f32_bf16 v11, v28, v5
v_dot2c_f32_bf16 v11, v29, v5
v_dot2c_f32_bf16 v11, v30, v5
v_dot2c_f32_bf16 v11, v31, v5
v_dot2c_f32_bf16 v11, v32, v5
v_dot2c_f32_bf16 v11, v33, v5
v_dot2c_f32_bf16 v11, v34, v5
v_dot2c_f32_bf16 v11, v35, v5
s_nop 2
v_mov_b32 v5, v11
s_nop 1
v_permlane32_swap_b32 v11, v5
v_add_f32 v11, v11, v5
v_mov_b32 v5, v11
s_nop 1
v_permlane16_swap_b32 v11, v5
v_add_f32 v11, v11, v5
v_cvt_pk_bf16_f32 v14, v11, v11
v_and_b32 v5, 0xffff0000, v14
v_sub_f32 v5, v11, v5
v_cvt_pk_bf16_f32 v15, v5, v5
v_cmp_eq_u32 vcc, 0, v3
v_mov_b32 v4, 1073741824
s_nop 0
v_cndmask_b32 v4, v4, v9, vcc
buffer_store_dwordx2 v[14:15], v4, s[4:7], 0 offen
s_branch L_prep_tail
L_prep_w2:
s_load_dwordx2 s[8:9], s[0:1], 16
s_mov_b32 s10, 663552
s_sub_u32 s13, s2, 236
s_and_b32 s14, s13, 3
s_lshr_b32 s15, s13, 2
s_mul_i32 s16, s14, 165888
s_lshl_b32 s17, s15, 7
s_add_u32 s16, s16, s17
s_mul_i32 s17, s12, 9216
s_add_u32 s16, s16, s17
v_lshrrev_b32 v4, 3, v1
v_mul_u32_u24 v7, 1152, v4
v_and_b32 v4, 7, v1
v_lshl_add_u32 v7, v4, 4, v7
s_lshl_b32 s18, s12, 10
s_waitcnt lgkmcnt(0)
s_add_u32 s19, s18, 0
s_mov_b32 m0, s19
s_add_u32 s17, s16, 0
buffer_load_dwordx4 v7, s[8:11], s17 offen lds
s_add_u32 s19, s18, 4096
s_mov_b32 m0, s19
s_add_u32 s17, s16, 36864
buffer_load_dwordx4 v7, s[8:11], s17 offen lds
s_add_u32 s19, s18, 8192
s_mov_b32 m0, s19
s_add_u32 s17, s16, 73728
buffer_load_dwordx4 v7, s[8:11], s17 offen lds
s_add_u32 s19, s18, 12288
s_mov_b32 m0, s19
s_add_u32 s17, s16, 110592
buffer_load_dwordx4 v7, s[8:11], s17 offen lds
s_add_u32 s19, s18, 16384
s_mov_b32 m0, s19
s_add_u32 s17, s16, 147456
s_cmp_lt_u32 s12, 2
s_cselect_b32 s17, s17, 1073741824
buffer_load_dwordx4 v7, s[8:11], s17 offen lds
v_lshrrev_b32 v14, 2, v2
v_and_b32 v15, 3, v2
v_lshlrev_b32 v15, 3, v15
s_lshl_b32 s17, s12, 5
v_add_u32 v15, s17, v15
v_add_u32 v4, 0, v3
v_cmp_le_u32 vcc, 9, v4
v_subrev_u32 v5, 9, v4
s_nop 0
v_cndmask_b32 v4, v4, v5, vcc
v_cndmask_b32 v6, 0, 1, vcc
v_mul_u32_u24 v6, 72, v6
v_lshrrev_b32 v5, 2, v4
v_mul_u32_u24 v5, 36, v5
v_and_b32 v13, 3, v4
v_lshl_add_u32 v5, v13, 2, v5
v_add_u32 v5, v5, v14
v_lshrrev_b32 v13, 1, v14
v_mul_u32_u24 v13, 18, v13
v_and_b32 v50, 1, v14
v_add3_u32 v13, v13, v50, 16
v_cmp_eq_u32 vcc, 8, v4
v_mov_b32 v50, 18
s_nop 0
v_cndmask_b32 v5, v5, v13, vcc
v_cndmask_b32 v50, v50, 36, vcc
v_add_u32 v5, v5, v6
v_add_u32 v50, v50, v5
v_min_u32 v5, 159, v5
v_min_u32 v50, 159, v50
v_lshl_add_u32 v40, v5, 7, v15
v_lshl_add_u32 v41, v50, 7, v15
v_add_u32 v4, 4, v3
v_cmp_le_u32 vcc, 9, v4
v_subrev_u32 v5, 9, v4
s_nop 0
v_cndmask_b32 v4, v4, v5, vcc
v_cndmask_b32 v6, 0, 1, vcc
v_mul_u32_u24 v6, 72, v6
v_lshrrev_b32 v5, 2, v4
v_mul_u32_u24 v5, 36, v5
v_and_b32 v13, 3, v4
v_lshl_add_u32 v5, v13, 2, v5
v_add_u32 v5, v5, v14
v_lshrrev_b32 v13, 1, v14
v_mul_u32_u24 v13, 18, v13
v_and_b32 v50, 1, v14
v_add3_u32 v13, v13, v50, 16
v_cmp_eq_u32 vcc, 8, v4
v_mov_b32 v50, 18
s_nop 0
v_cndmask_b32 v5, v5, v13, vcc
v_cndmask_b32 v50, v50, 36, vcc
v_add_u32 v5, v5, v6
v_add_u32 v50, v50, v5
v_min_u32 v5, 159, v5
v_min_u32 v50, 159, v50
v_lshl_add_u32 v42, v5, 7, v15
v_lshl_add_u32 v43, v50, 7, v15
v_add_u32 v4, 8, v3
v_cmp_le_u32 vcc, 9, v4
v_subrev_u32 v5, 9, v4
s_nop 0
v_cndmask_b32 v4, v4, v5, vcc
v_cndmask_b32 v6, 0, 1, vcc
v_mul_u32_u24 v6, 72, v6
v_lshrrev_b32 v5, 2, v4
v_mul_u32_u24 v5, 36, v5
v_and_b32 v13, 3, v4
v_lshl_add_u32 v5, v13, 2, v5
v_add_u32 v5, v5, v14
v_lshrrev_b32 v13, 1, v14
v_mul_u32_u24 v13, 18, v13
v_and_b32 v50, 1, v14
v_add3_u32 v13, v13, v50, 16
v_cmp_eq_u32 vcc, 8, v4
v_mov_b32 v50, 18
s_nop 0
v_cndmask_b32 v5, v5, v13, vcc
v_cndmask_b32 v50, v50, 36, vcc
v_add_u32 v5, v5, v6
v_add_u32 v50, v50, v5
v_min_u32 v5, 159, v5
v_min_u32 v50, 159, v50
v_lshl_add_u32 v44, v5, 7, v15
v_lshl_add_u32 v45, v50, 7, v15
v_add_u32 v4, 12, v3
v_cmp_le_u32 vcc, 9, v4
v_subrev_u32 v5, 9, v4
s_nop 0
v_cndmask_b32 v4, v4, v5, vcc
v_cndmask_b32 v6, 0, 1, vcc
v_mul_u32_u24 v6, 72, v6
v_lshrrev_b32 v5, 2, v4
v_mul_u32_u24 v5, 36, v5
v_and_b32 v13, 3, v4
v_lshl_add_u32 v5, v13, 2, v5
v_add_u32 v5, v5, v14
v_lshrrev_b32 v13, 1, v14
v_mul_u32_u24 v13, 18, v13
v_and_b32 v50, 1, v14
v_add3_u32 v13, v13, v50, 16
v_cmp_eq_u32 vcc, 8, v4
v_mov_b32 v50, 18
s_nop 0
v_cndmask_b32 v5, v5, v13, vcc
v_cndmask_b32 v50, v50, 36, vcc
v_add_u32 v5, v5, v6
v_add_u32 v50, v50, v5
v_min_u32 v5, 159, v5
v_min_u32 v50, 159, v50
v_lshl_add_u32 v46, v5, 7, v15
v_lshl_add_u32 v47, v50, 7, v15
v_add_u32 v4, 16, v3
v_cmp_le_u32 vcc, 9, v4
v_subrev_u32 v5, 9, v4
s_nop 0
v_cndmask_b32 v4, v4, v5, vcc
v_cndmask_b32 v6, 0, 1, vcc
v_mul_u32_u24 v6, 72, v6
v_lshrrev_b32 v5, 2, v4
v_mul_u32_u24 v5, 36, v5
v_and_b32 v13, 3, v4
v_lshl_add_u32 v5, v13, 2, v5
v_add_u32 v5, v5, v14
v_lshrrev_b32 v13, 1, v14
v_mul_u32_u24 v13, 18, v13
v_and_b32 v50, 1, v14
v_add3_u32 v13, v13, v50, 16
v_cmp_eq_u32 vcc, 8, v4
v_mov_b32 v50, 18
s_nop 0
v_cndmask_b32 v5, v5, v13, vcc
v_cndmask_b32 v50, v50, 36, vcc
v_add_u32 v5, v5, v6
v_add_u32 v50, v50, v5
v_min_u32 v5, 159, v5
v_min_u32 v50, 159, v50
v_lshl_add_u32 v48, v5, 7, v15
v_lshl_add_u32 v49, v50, 7, v15
s_lshl_b32 s17, s15, 6
s_lshl_b32 s19, s12, 4
s_add_u32 s17, s17, s19
v_add_u32 v4, s17, v2
v_mul_u32_u24 v5, 911, v4
v_lshrrev_b32 v5, 16, v5
v_mul_u32_u24 v6, 72, v5
v_sub_u32 v4, v4, v6
s_mov_b32 s17, 82944
v_mul_lo_u32 v8, v5, s17
s_mul_i32 s17, s14, 18
v_add_u32 v5, s17, v3
v_and_b32 v6, 3, v5
v_lshrrev_b32 v5, 2, v5
v_mul_u32_u24 v5, 4608, v5
v_add_u32 v8, v8, v5
v_add_u32 v8, 2121728, v8
v_lshrrev_b32 v14, 5, v4
v_lshlrev_b32 v14, 11, v14
v_bfe_u32 v15, v4, 2, 1
v_lshl_add_u32 v14, v15, 10, v14
v_bfe_u32 v15, v4, 3, 2
v_lshl_add_u32 v14, v15, 6, v14
v_and_b32 v15, 3, v4
v_lshl_add_u32 v14, v15, 4, v14
v_lshl_add_u32 v14, v6, 8, v14
v_lshlrev_b32 v15, 4, v4
v_add_u32 v15, 3072, v15
v_lshl_add_u32 v15, v6, 7, v15
v_cmp_gt_u32 vcc, 64, v4
s_nop 1
v_cndmask_b32 v14, v15, v14, vcc
v_add_u32 v8, v8, v14
s_waitcnt vmcnt(0)
s_barrier
ds_read_b64_tr_b16 v[16:17], v40
ds_read_b64_tr_b16 v[18:19], v41
ds_read_b64_tr_b16 v[20:21], v42
ds_read_b64_tr_b16 v[22:23], v43
ds_read_b64_tr_b16 v[24:25], v44
ds_read_b64_tr_b16 v[26:27], v45
ds_read_b64_tr_b16 v[28:29], v46
ds_read_b64_tr_b16 v[30:31], v47
ds_read_b64_tr_b16 v[32:33], v48
ds_read_b64_tr_b16 v[34:35], v49
v_cmp_gt_u32 vcc, 2, v3
v_mov_b32 v4, 1073741824
v_mov_b32 v11, 0
v_cndmask_b32 v4, v4, v8, vcc
s_mov_b32 s17, 0
s_waitcnt lgkmcnt(8)
buffer_store_dwordx4 v[16:19], v8, s[4:7], s17 offen
s_mov_b32 s17, 4608
s_waitcnt lgkmcnt(6)
buffer_store_dwordx4 v[20:23], v8, s[4:7], s17 offen
s_mov_b32 s17, 9216
s_waitcnt lgkmcnt(4)
buffer_store_dwordx4 v[24:27], v8, s[4:7], s17 offen
s_mov_b32 s17, 13824
s_waitcnt lgkmcnt(2)
buffer_store_dwordx4 v[28:31], v8, s[4:7], s17 offen
s_mov_b32 s17, 18432
s_waitcnt lgkmcnt(0)
buffer_store_dwordx4 v[32:35], v4, s[4:7], s17 offen
s_branch L_prep_tail
L_prep_w1:
s_load_dwordx2 s[8:9], s[0:1], 8
s_mov_b32 s10, 1990656
s_sub_u32 s13, s2, 128
s_and_b32 s14, s13, 3
s_lshr_b32 s15, s13, 2
s_mul_i32 s16, s14, 497664
s_lshl_b32 s17, s15, 7
s_add_u32 s16, s16, s17
s_mul_i32 s17, s12, 27648
s_add_u32 s16, s16, s17
v_lshrrev_b32 v4, 3, v1
v_mul_u32_u24 v7, 3456, v4
v_and_b32 v4, 7, v1
v_lshl_add_u32 v7, v4, 4, v7
s_lshl_b32 s18, s12, 10
s_waitcnt lgkmcnt(0)
s_add_u32 s19, s18, 0
s_mov_b32 m0, s19
s_add_u32 s17, s16, 0
buffer_load_dwordx4 v7, s[8:11], s17 offen lds
s_add_u32 s19, s18, 4096
s_mov_b32 m0, s19
s_add_u32 s17, s16, 110592
buffer_load_dwordx4 v7, s[8:11], s17 offen lds
s_add_u32 s19, s18, 8192
s_mov_b32 m0, s19
s_add_u32 s17, s16, 221184
buffer_load_dwordx4 v7, s[8:11], s17 offen lds
s_add_u32 s19, s18, 12288
s_mov_b32 m0, s19
s_add_u32 s17, s16, 331776
buffer_load_dwordx4 v7, s[8:11], s17 offen lds
s_add_u32 s19, s18, 16384
s_mov_b32 m0, s19
s_add_u32 s17, s16, 442368
s_cmp_lt_u32 s12, 2
s_cselect_b32 s17, s17, 1073741824
buffer_load_dwordx4 v7, s[8:11], s17 offen lds
v_lshrrev_b32 v4, 2, v2
v_lshl_add_u32 v4, v3, 3, v4
v_lshlrev_b32 v10, 7, v4
v_and_b32 v4, 3, v2
v_lshl_add_u32 v10, v4, 3, v10
s_lshl_b32 s17, s12, 5
v_add_u32 v10, s17, v10
s_mul_i32 s20, s15, 29
s_lshr_b32 s20, s20, 8
s_mul_i32 s19, s20, 9
s_sub_u32 s19, s15, s19
s_lshl_b32 s19, s19, 6
s_lshl_b32 s17, s12, 4
s_add_u32 s19, s19, s17
v_add_u32 v4, s19, v2
v_mul_u32_u24 v5, 911, v4
v_lshrrev_b32 v5, 14, v5
v_mul_u32_u24 v6, 18, v5
v_sub_u32 v4, v4, v6
v_and_b32 v6, 1, v5
v_lshrrev_b32 v5, 1, v5
s_mov_b32 s17, 132608
v_mul_lo_u32 v5, v5, s17
s_cmp_eq_u32 s20, 0
s_cselect_b32 s21, 5, 0
s_cselect_b32 s22, 8, 4
s_cmp_eq_u32 s20, 2
s_cselect_b32 s21, 2, s21
s_cselect_b32 s22, 0, s22
s_sub_u32 s22, s22, 16
v_add_u32 v14, s21, v6
v_lshl_add_u32 v15, v6, 1, v4
v_add_u32 v15, s22, v15
v_cmp_gt_u32 vcc, 16, v4
s_nop 1
v_cndmask_b32 v14, 4, v14, vcc
v_cndmask_b32 v15, v15, v4, vcc
v_lshl_add_u32 v8, v14, 10, v5
v_lshl_add_u32 v8, v15, 4, v8
v_lshl_add_u32 v9, v14, 9, v5
v_lshl_add_u32 v9, v15, 3, v9
s_lshl_b32 s17, s14, 7
s_add_u32 s17, s17, 129024
v_add_u32 v9, s17, v9
s_mul_i32 s17, s14, 18
v_add_u32 v5, s17, v3
v_and_b32 v6, 3, v5
v_lshrrev_b32 v5, 2, v5
v_mul_u32_u24 v5, 7168, v5
v_add_u32 v8, v8, v5
v_lshl_add_u32 v8, v6, 8, v8
s_waitcnt vmcnt(0)
s_barrier
ds_read_b64_tr_b16 v[16:17], v10 offset:0
ds_read_b64_tr_b16 v[18:19], v10 offset:512
ds_read_b64_tr_b16 v[20:21], v10 offset:4096
ds_read_b64_tr_b16 v[22:23], v10 offset:4608
ds_read_b64_tr_b16 v[24:25], v10 offset:8192
ds_read_b64_tr_b16 v[26:27], v10 offset:8704
ds_read_b64_tr_b16 v[28:29], v10 offset:12288
ds_read_b64_tr_b16 v[30:31], v10 offset:12800
ds_read_b64_tr_b16 v[32:33], v10 offset:16384
ds_read_b64_tr_b16 v[34:35], v10 offset:16896
v_cmp_gt_u32 vcc, 2, v3
v_mov_b32 v4, 1073741824
v_mov_b32 v11, 0
v_cndmask_b32 v4, v4, v8, vcc
s_mov_b32 s17, 0
s_waitcnt lgkmcnt(8)
buffer_store_dwordx4 v[16:19], v8, s[4:7], s17 offen
s_mov_b32 s17, 7168
s_waitcnt lgkmcnt(6)
buffer_store_dwordx4 v[20:23], v8, s[4:7], s17 offen
s_mov_b32 s17, 14336
s_waitcnt lgkmcnt(4)
buffer_store_dwordx4 v[24:27], v8, s[4:7], s17 offen
s_mov_b32 s17, 21504
s_waitcnt lgkmcnt(2)
buffer_store_dwordx4 v[28:31], v8, s[4:7], s17 offen
s_mov_b32 s17, 28672
s_waitcnt lgkmcnt(0)
buffer_store_dwordx4 v[32:35], v4, s[4:7], s17 offen
v_mov_b32 v5, 0x3f803f80
v_dot2c_f32_bf16 v11, v16, v5
v_dot2c_f32_bf16 v11, v17, v5
v_dot2c_f32_bf16 v11, v18, v5
v_dot2c_f32_bf16 v11, v19, v5
v_dot2c_f32_bf16 v11, v20, v5
v_dot2c_f32_bf16 v11, v21, v5
v_dot2c_f32_bf16 v11, v22, v5
v_dot2c_f32_bf16 v11, v23, v5
v_dot2c_f32_bf16 v11, v24, v5
v_dot2c_f32_bf16 v11, v25, v5
v_dot2c_f32_bf16 v11, v26, v5
v_dot2c_f32_bf16 v11, v27, v5
v_dot2c_f32_bf16 v11, v28, v5
v_dot2c_f32_bf16 v11, v29, v5
v_dot2c_f32_bf16 v11, v30, v5
v_dot2c_f32_bf16 v11, v31, v5
v_dot2c_f32_bf16 v11, v32, v5
v_dot2c_f32_bf16 v11, v33, v5
v_dot2c_f32_bf16 v11, v34, v5
v_dot2c_f32_bf16 v11, v35, v5
s_nop 2
v_mov_b32 v5, v11
s_nop 1
v_permlane32_swap_b32 v11, v5
v_add_f32 v11, v11, v5
v_mov_b32 v5, v11
s_nop 1
v_permlane16_swap_b32 v11, v5
v_add_f32 v11, v11, v5
v_cvt_pk_bf16_f32 v14, v11, v11
v_and_b32 v5, 0xffff0000, v14
v_sub_f32 v5, v11, v5
v_cvt_pk_bf16_f32 v15, v5, v5
v_cmp_eq_u32 vcc, 0, v3
v_mov_b32 v4, 1073741824
s_nop 0
v_cndmask_b32 v4, v4, v9, vcc
buffer_store_dwordx2 v[14:15], v4, s[4:7], 0 offen
s_branch L_prep_tail
L_prep_x:
s_load_dwordx2 s[8:9], s[0:1], 0
s_mov_b32 s10, 2359296
s_mul_i32 s16, s12, 18
v_add_u32 v4, s16, v3
v_mul_u32_u24 v7, 1152, v2
v_lshl_add_u32 v7, v4, 4, v7
s_mul_i32 s16, s2, 18432
v_lshlrev_b32 v8, 8, v4
v_lshl_add_u32 v8, v2, 4, v8
s_add_u32 s17, s16, 10895360
v_cmp_gt_u32 vcc, 2, v3
v_mov_b32 v4, 1073741824
v_mov_b32 v11, 0
v_cndmask_b32 v5, v4, v7, vcc
v_cndmask_b32 v6, v4, v8, vcc
v_add_u32 v6, 4096, v6
v_mov_b32 v12, 0
v_mov_b32 v13, 0x3f803f80
s_waitcnt lgkmcnt(0)
buffer_load_dwordx4 v[16:19], v7, s[8:11], s16 offen offset:0
buffer_load_dwordx4 v[20:23], v7, s[8:11], s16 offen offset:64
buffer_load_dwordx4 v[24:27], v7, s[8:11], s16 offen offset:128
buffer_load_dwordx4 v[28:31], v7, s[8:11], s16 offen offset:192
buffer_load_dwordx4 v[32:35], v5, s[8:11], s16 offen offset:256
s_waitcnt vmcnt(4)
buffer_store_dwordx4 v[16:19], v8, s[4:7], s17 offen offset:0
s_waitcnt vmcnt(4)
buffer_store_dwordx4 v[20:23], v8, s[4:7], s17 offen offset:1024
s_waitcnt vmcnt(4)
buffer_store_dwordx4 v[24:27], v8, s[4:7], s17 offen offset:2048
s_waitcnt vmcnt(4)
buffer_store_dwordx4 v[28:31], v8, s[4:7], s17 offen offset:3072
s_waitcnt vmcnt(4)
buffer_store_dwordx4 v[32:35], v6, s[4:7], s17 offen offset:0
v_dot2c_f32_bf16 v11, v16, v13
v_dot2c_f32_bf16 v11, v17, v13
v_dot2c_f32_bf16 v11, v18, v13
v_dot2c_f32_bf16 v11, v19, v13
v_dot2c_f32_bf16 v11, v20, v13
v_dot2c_f32_bf16 v11, v21, v13
v_dot2c_f32_bf16 v11, v22, v13
v_dot2c_f32_bf16 v11, v23, v13
v_dot2c_f32_bf16 v11, v24, v13
v_dot2c_f32_bf16 v11, v25, v13
v_dot2c_f32_bf16 v11, v26, v13
v_dot2c_f32_bf16 v11, v27, v13
v_dot2c_f32_bf16 v11, v28, v13
v_dot2c_f32_bf16 v11, v29, v13
v_dot2c_f32_bf16 v11, v30, v13
v_dot2c_f32_bf16 v11, v31, v13
v_dot2c_f32_bf16 v11, v32, v13
v_dot2c_f32_bf16 v11, v33, v13
v_dot2c_f32_bf16 v11, v34, v13
v_dot2c_f32_bf16 v11, v35, v13
v_dot2c_f32_bf16 v12, v16, v16
v_dot2c_f32_bf16 v12, v17, v17
v_dot2c_f32_bf16 v12, v18, v18
v_dot2c_f32_bf16 v12, v19, v19
v_dot2c_f32_bf16 v12, v20, v20
v_dot2c_f32_bf16 v12, v21, v21
v_dot2c_f32_bf16 v12, v22, v22
v_dot2c_f32_bf16 v12, v23, v23
v_dot2c_f32_bf16 v12, v24, v24
v_dot2c_f32_bf16 v12, v25, v25
v_dot2c_f32_bf16 v12, v26, v26
v_dot2c_f32_bf16 v12, v27, v27
v_dot2c_f32_bf16 v12, v28, v28
v_dot2c_f32_bf16 v12, v29, v29
v_dot2c_f32_bf16 v12, v30, v30
v_dot2c_f32_bf16 v12, v31, v31
v_dot2c_f32_bf16 v12, v32, v32
v_dot2c_f32_bf16 v12, v33, v33
v_dot2c_f32_bf16 v12, v34, v34
v_dot2c_f32_bf16 v12, v35, v35
v_mov_b32 v5, v11
s_nop 1
v_permlane32_swap_b32 v11, v5
v_add_f32 v11, v11, v5
v_mov_b32 v5, v11
s_nop 1
v_permlane16_swap_b32 v11, v5
v_add_f32 v11, v11, v5
v_mov_b32 v5, v12
s_nop 1
v_permlane32_swap_b32 v12, v5
v_add_f32 v12, v12, v5
v_mov_b32 v5, v12
s_nop 1
v_permlane16_swap_b32 v12, v5
v_add_f32 v12, v12, v5
v_cmp_eq_u32 vcc, 0, v3
s_lshl_b32 s16, s2, 7
s_lshl_b32 s17, s12, 14
s_add_u32 s16, s16, s17
s_add_u32 s16, s16, 13254656
v_cndmask_b32 v14, 0, v11, vcc
v_cndmask_b32 v15, 0, v12, vcc
v_lshlrev_b32 v5, 3, v2
v_lshl_add_u32 v5, v3, 16, v5
v_cmp_gt_u32 vcc, 2, v3
s_nop 1
v_cndmask_b32 v5, v4, v5, vcc
buffer_store_dwordx2 v[14:15], v5, s[4:7], s16 offen
L_prep_tail:
s_sub_u32 s16, s2, 272
s_cmp_lt_u32 s16, 208
s_cbranch_scc0 L_prep_t2
s_cmp_ge_u32 s16, 104
s_cselect_b32 s17, 26640384, 0
s_cselect_b32 s18, 104, 0
s_sub_u32 s16, s16, s18
s_cmp_lt_u32 s16, 64
s_cselect_b32 s18, 3212836864, 0
s_lshl_b32 s16, s16, 12
s_add_u32 s16, s16, s17
s_add_u32 s16, s16, 37109760
v_mov_b32 v52, s18
v_mov_b32 v53, s18
v_mov_b32 v54, s18
v_mov_b32 v55, s18
v_lshlrev_b32 v51, 4, v0
buffer_store_dwordx4 v[52:55], v51, s[4:7], s16 offen
L_prep_t2:
s_cmp_lt_u32 s2, 256
s_cbranch_scc0 L_prep_end
s_getpc_b64 s[20:21]
L_prep_pc:
s_add_u32 s20, s20, main_kernel-L_prep_pc
s_addc_u32 s21, s21, 0
s_mov_b32 s22, 41656
s_mov_b32 s23, 0x20000
s_lshr_b32 s16, s2, 3
s_mul_i32 s16, s16, 1408
v_lshlrev_b32 v51, 4, v0
v_cmp_gt_u32 vcc, 1408, v51
v_mov_b32 v56, 1073741824
s_nop 0
v_cndmask_b32 v51, v56, v51, vcc
buffer_load_dwordx4 v[56:59], v51, s[20:23], s16 offen
L_prep_end:
s_endpgm
.globl main_kernel
.p2align 8
.type main_kernel,@function
main_kernel:
s_cmp_ge_u32 s2, 256
s_cbranch_scc1 L_main_end
s_load_dwordx2 s[4:5], s[0:1], 80
s_load_dwordx2 s[12:13], s[0:1], 40
s_load_dwordx2 s[16:17], s[0:1], 64
s_load_dwordx2 s[20:21], s[0:1], 48
v_lshrrev_b32 v6, 6, v0
v_and_b32 v0, 63, v0
v_readfirstlane_b32 s24, v6
v_lshlrev_b32 v1, 4, v0
v_and_b32 v2, 15, v0
v_lshrrev_b32 v3, 4, v0
v_mov_b32 v4, 1
v_mov_b32 v5, 0
s_mov_b32 s56, 0
s_mov_b32 s29, 0
s_mov_b32 s6, 64241664
s_mov_b32 s7, 0x20000
s_mov_b32 s10, 53280768
s_mov_b32 s11, 0x20000
s_mov_b32 s14, 8388608
s_mov_b32 s15, 0x20000
s_mov_b32 s18, 2359296
s_mov_b32 s19, 0x20000
s_mov_b32 s22, 4096
s_mov_b32 s23, 0x20000
s_and_b32 s30, s2, 7
s_lshr_b32 s31, s2, 3
s_lshr_b32 s32, s31, 2
s_and_b32 s33, s31, 3
s_lshr_b32 s25, s30, 2
s_lshl_b32 s25, s25, 3
s_add_u32 s25, s25, s32
s_and_b32 s26, s30, 3
s_lshl_b32 s26, s26, 2
s_add_u32 s26, s26, s33
s_lshr_b32 s27, s30, 1
s_lshl_b32 s27, s27, 3
s_add_u32 s27, s27, s32
s_and_b32 s28, s30, 1
s_lshl_b32 s28, s28, 2
s_add_u32 s28, s28, s33
s_waitcnt lgkmcnt(0)
s_add_u32 s8, s4, 10895360
s_addc_u32 s9, s5, 0
s_waitcnt lgkmcnt(0)
s_memrealtime s[58:59]
s_waitcnt lgkmcnt(0)
s_mov_b32 m0, s56
s_nop 0
v_writelane_b32 v5, s58, m0
s_add_u32 s56, s56, 1
s_mul_i32 s30, s26, 132608
s_mul_i32 s38, s24, 33792
s_add_u32 s39, s38, s30
s_add_u32 m0, s38, 0
s_nop 0
buffer_load_dwordx4 v1, s[4:7], s39 offen offset:0  lds
buffer_load_dwordx4 v1, s[4:7], s39 offen offset:1024  lds
buffer_load_dwordx4 v1, s[4:7], s39 offen offset:2048  lds
buffer_load_dwordx4 v1, s[4:7], s39 offen offset:3072  lds
s_add_u32 m0, m0, 4096
s_add_u32 s39, s39, 4096
buffer_load_dwordx4 v1, s[4:7], s39 offen offset:0  lds
buffer_load_dwordx4 v1, s[4:7], s39 offen offset:1024  lds
buffer_load_dwordx4 v1, s[4:7], s39 offen offset:2048  lds
buffer_load_dwordx4 v1, s[4:7], s39 offen offset:3072  lds
s_add_u32 m0, m0, 4096
s_add_u32 s39, s39, 4096
buffer_load_dwordx4 v1, s[4:7], s39 offen offset:0  lds
buffer_load_dwordx4 v1, s[4:7], s39 offen offset:1024  lds
buffer_load_dwordx4 v1, s[4:7], s39 offen offset:2048  lds
buffer_load_dwordx4 v1, s[4:7], s39 offen offset:3072  lds
s_add_u32 m0, m0, 4096
s_add_u32 s39, s39, 4096
buffer_load_dwordx4 v1, s[4:7], s39 offen offset:0  lds
buffer_load_dwordx4 v1, s[4:7], s39 offen offset:1024  lds
buffer_load_dwordx4 v1, s[4:7], s39 offen offset:2048  lds
buffer_load_dwordx4 v1, s[4:7], s39 offen offset:3072  lds
s_add_u32 m0, m0, 4096
s_add_u32 s39, s39, 4096
buffer_load_dwordx4 v1, s[4:7], s39 offen offset:0  lds
buffer_load_dwordx4 v1, s[4:7], s39 offen offset:1024  lds
buffer_load_dwordx4 v1, s[4:7], s39 offen offset:2048  lds
buffer_load_dwordx4 v1, s[4:7], s39 offen offset:3072  lds
s_add_u32 m0, m0, 4096
s_add_u32 s39, s39, 4096
buffer_load_dwordx4 v1, s[4:7], s39 offen offset:0  lds
buffer_load_dwordx4 v1, s[4:7], s39 offen offset:1024  lds
buffer_load_dwordx4 v1, s[4:7], s39 offen offset:2048  lds
buffer_load_dwordx4 v1, s[4:7], s39 offen offset:3072  lds
s_add_u32 m0, m0, 4096
s_add_u32 s39, s39, 4096
buffer_load_dwordx4 v1, s[4:7], s39 offen offset:0  lds
buffer_load_dwordx4 v1, s[4:7], s39 offen offset:1024  lds
buffer_load_dwordx4 v1, s[4:7], s39 offen offset:2048  lds
buffer_load_dwordx4 v1, s[4:7], s39 offen offset:3072  lds
s_add_u32 m0, m0, 4096
s_add_u32 s39, s39, 4096
buffer_load_dwordx4 v1, s[4:7], s39 offen offset:0  lds
buffer_load_dwordx4 v1, s[4:7], s39 offen offset:1024  lds
buffer_load_dwordx4 v1, s[4:7], s39 offen offset:2048  lds
buffer_load_dwordx4 v1, s[4:7], s39 offen offset:3072  lds
s_add_u32 m0, m0, 4096
s_add_u32 s39, s39, 4096
buffer_load_dwordx4 v1, s[4:7], s39 offen offset:0  lds
s_lshl_b32 s30, s27, 2
s_add_u32 s30, s30, s24
s_mul_i32 s30, s30, 18432
s_mul_i32 s31, s28, 2304
s_add_u32 s30, s30, s31
s_add_u32 s30, s30, 0
v_and_b32 v6, 1, v3
v_lshlrev_b32 v6, 3, v6
v_lshl_add_u32 v6, v2, 4, v6
buffer_load_dwordx4 v[108:111], v1, s[8:11], s30 offen
buffer_load_dwordx4 v[112:115], v1, s[8:11], s30 offen offset:1024
buffer_load_dwordx2 v[116:117], v6, s[8:11], s30 offen offset:2048
v_and_b32 v6, 1, v2
v_cmp_eq_u32 s[40:41], 1, v6
v_lshl_add_u32 v6, v3, 2, v6
v_cmp_le_u32 s[42:43], v6, v2
v_add_u32 v6, 2, v6
v_cmp_le_u32 s[44:45], v6, v2
v_cmp_eq_u32 s[46:47], 0, v3
v_cmp_eq_u32 s[48:49], 2, v3
v_cmp_gt_u32 s[50:51], 2, v3
v_mov_b32 v6, 0x0c0c0100
v_mov_b32 v7, 0x01000c0c
v_cndmask_b32 v6, v6, v7, s[40:41]
v_mov_b32 v8, 0x0c0c0c0c
v_cndmask_b32 v10, v6, v8, s[42:43]
v_cndmask_b32 v12, v8, v6, s[42:43]
v_mov_b32 v6, 0x0c0c0302
v_mov_b32 v7, 0x03020c0c
v_cndmask_b32 v6, v6, v7, s[40:41]
v_cndmask_b32 v11, v6, v8, s[44:45]
v_cndmask_b32 v13, v8, v6, s[44:45]
s_waitcnt vmcnt(0)
v_lshlrev_b32 v16, 16, v108
v_and_b32 v17, 0xffff0000, v108
v_lshlrev_b32 v18, 16, v109
v_and_b32 v19, 0xffff0000, v109
v_lshlrev_b32 v20, 16, v110
v_and_b32 v21, 0xffff0000, v110
v_lshlrev_b32 v22, 16, v111
v_and_b32 v23, 0xffff0000, v111
v_lshlrev_b32 v24, 16, v112
v_and_b32 v25, 0xffff0000, v112
v_lshlrev_b32 v26, 16, v113
v_and_b32 v27, 0xffff0000, v113
v_lshlrev_b32 v28, 16, v114
v_and_b32 v29, 0xffff0000, v114
v_lshlrev_b32 v30, 16, v115
v_and_b32 v31, 0xffff0000, v115
v_lshlrev_b32 v32, 16, v116
v_and_b32 v33, 0xffff0000, v116
v_lshlrev_b32 v34, 16, v117
v_and_b32 v35, 0xffff0000, v117
s_lshl_b32 s80, s25, 4
s_add_u32 s80, s80, s26
s_lshl_b32 s81, s27, 3
s_add_u32 s81, s81, s28
L_layer:
s_waitcnt lgkmcnt(0)
s_memrealtime s[58:59]
s_waitcnt lgkmcnt(0)
s_mov_b32 m0, s56
s_nop 0
v_writelane_b32 v5, s58, m0
s_add_u32 s56, s56, 1
s_lshl_b32 s60, s25, 3
s_sub_u32 s61, s60, 1
s_max_i32 s61, s61, 0
s_lshl_b32 s30, s24, 1
s_add_u32 s60, s60, s30
s_mul_i32 s30, s61, 18432
s_add_u32 s30, s30, 0
s_mul_i32 s38, s24, 5120
s_add_u32 s39, s38, s30
s_add_u32 m0, s38, 135168
s_nop 0
buffer_load_dwordx4 v1, s[8:11], s39 offen offset:0 sc1 lds
buffer_load_dwordx4 v1, s[8:11], s39 offen offset:1024 sc1 lds
buffer_load_dwordx4 v1, s[8:11], s39 offen offset:2048 sc1 lds
buffer_load_dwordx4 v1, s[8:11], s39 offen offset:3072 sc1 lds
s_add_u32 m0, m0, 4096
s_add_u32 s39, s39, 4096
buffer_load_dwordx4 v1, s[8:11], s39 offen offset:0 sc1 lds
s_sub_u32 s30, s60, 2
v_add_u32 v6, s30, v3
v_max_i32 v6, 0, v6
v_mov_b32 v7, s61
v_cndmask_b32 v6, v6, v7, s[46:47]
v_lshl_add_u32 v6, v6, 4, v2
v_lshlrev_b32 v6, 3, v6
s_mov_b32 s30, 2359296
buffer_load_dwordx2 v[100:101], v6, s[8:11], s30 offen sc1
s_mov_b32 s30, 2375680
buffer_load_dwordx2 v[102:103], v6, s[8:11], s30 offen sc1
s_mov_b32 s30, 2392064
buffer_load_dwordx2 v[104:105], v6, s[8:11], s30 offen sc1
s_mov_b32 s30, 2408448
buffer_load_dwordx2 v[106:107], v6, s[8:11], s30 offen sc1
s_mov_b32 s30, 2424832
buffer_load_dwordx2 v[108:109], v6, s[8:11], s30 offen sc1
s_mov_b32 s30, 2441216
buffer_load_dwordx2 v[110:111], v6, s[8:11], s30 offen sc1
s_mov_b32 s30, 2457600
buffer_load_dwordx2 v[112:113], v6, s[8:11], s30 offen sc1
s_mov_b32 s30, 2473984
buffer_load_dwordx2 v[114:115], v6, s[8:11], s30 offen sc1
s_mul_i32 s30, s60, 18432
s_add_u32 s30, s30, 0
v_add_u32 v127, 18432, v1
buffer_load_dwordx4 a[0:3], v1, s[8:11], s30 offen offset:0 sc1
buffer_load_dwordx4 a[4:7], v127, s[8:11], s30 offen offset:0 sc1
buffer_load_dwordx4 a[8:11], v1, s[8:11], s30 offen offset:1024 sc1
buffer_load_dwordx4 a[12:15], v127, s[8:11], s30 offen offset:1024 sc1
buffer_load_dwordx4 a[16:19], v1, s[8:11], s30 offen offset:2048 sc1
buffer_load_dwordx4 a[20:23], v127, s[8:11], s30 offen offset:2048 sc1
buffer_load_dwordx4 a[24:27], v1, s[8:11], s30 offen offset:3072 sc1
buffer_load_dwordx4 a[28:31], v127, s[8:11], s30 offen offset:3072 sc1
s_add_u32 s30, s30, 4096
buffer_load_dwordx4 a[32:35], v1, s[8:11], s30 offen offset:0 sc1
buffer_load_dwordx4 a[36:39], v127, s[8:11], s30 offen offset:0 sc1
buffer_load_dwordx4 a[40:43], v1, s[8:11], s30 offen offset:1024 sc1
buffer_load_dwordx4 a[44:47], v127, s[8:11], s30 offen offset:1024 sc1
buffer_load_dwordx4 a[48:51], v1, s[8:11], s30 offen offset:2048 sc1
buffer_load_dwordx4 a[52:55], v127, s[8:11], s30 offen offset:2048 sc1
buffer_load_dwordx4 a[56:59], v1, s[8:11], s30 offen offset:3072 sc1
buffer_load_dwordx4 a[60:63], v127, s[8:11], s30 offen offset:3072 sc1
s_add_u32 s30, s30, 4096
buffer_load_dwordx4 a[64:67], v1, s[8:11], s30 offen offset:0 sc1
buffer_load_dwordx4 a[68:71], v127, s[8:11], s30 offen offset:0 sc1
buffer_load_dwordx4 a[72:75], v1, s[8:11], s30 offen offset:1024 sc1
buffer_load_dwordx4 a[76:79], v127, s[8:11], s30 offen offset:1024 sc1
buffer_load_dwordx4 a[80:83], v1, s[8:11], s30 offen offset:2048 sc1
buffer_load_dwordx4 a[84:87], v127, s[8:11], s30 offen offset:2048 sc1
buffer_load_dwordx4 a[88:91], v1, s[8:11], s30 offen offset:3072 sc1
buffer_load_dwordx4 a[92:95], v127, s[8:11], s30 offen offset:3072 sc1
s_add_u32 s30, s30, 4096
buffer_load_dwordx4 a[96:99], v1, s[8:11], s30 offen offset:0 sc1
buffer_load_dwordx4 a[100:103], v127, s[8:11], s30 offen offset:0 sc1
buffer_load_dwordx4 a[104:107], v1, s[8:11], s30 offen offset:1024 sc1
buffer_load_dwordx4 a[108:111], v127, s[8:11], s30 offen offset:1024 sc1
buffer_load_dwordx4 a[112:115], v1, s[8:11], s30 offen offset:2048 sc1
buffer_load_dwordx4 a[116:119], v127, s[8:11], s30 offen offset:2048 sc1
buffer_load_dwordx4 a[120:123], v1, s[8:11], s30 offen offset:3072 sc1
buffer_load_dwordx4 a[124:127], v127, s[8:11], s30 offen offset:3072 sc1
s_add_u32 s30, s30, 4096
buffer_load_dwordx4 a[128:131], v1, s[8:11], s30 offen offset:0 sc1
buffer_load_dwordx4 a[132:135], v127, s[8:11], s30 offen offset:0 sc1
buffer_load_dwordx4 a[136:139], v1, s[8:11], s30 offen offset:1024 sc1
buffer_load_dwordx4 a[140:143], v127, s[8:11], s30 offen offset:1024 sc1
s_lshl_b32 s30, s24, 10
v_add_u32 v125, s30, v1
v_add_u32 v126, 135168, v1
v_lshrrev_b32 v128, 1, v1
v_add_u32 v128, 129024, v128
s_lshl_b32 s30, s24, 9
v_add_u32 v129, s30, v128
v_add_u32 v8, 64512, v1
s_waitcnt vmcnt(44)
s_barrier
ds_read_b128 a[144:147], v1 offset:0
ds_read_b128 a[148:151], v1 offset:1024
ds_read_b128 a[152:155], v1 offset:2048
ds_read_b128 a[156:159], v1 offset:3072
ds_read_b128 a[160:163], v1 offset:4096
ds_read_b128 a[164:167], v1 offset:5120
ds_read_b128 a[168:171], v1 offset:6144
ds_read_b128 a[172:175], v125 offset:0
ds_read_b128 a[176:179], v126 offset:0
s_waitcnt lgkmcnt(0)
s_waitcnt vmcnt(34)
v_mfma_f32_16x16x32_bf16 v[36:39], a[144:147], a[0:3], 0
ds_read_b128 a[180:183], v1 offset:7168
v_mfma_f32_16x16x32_bf16 v[64:67], a[144:147], a[4:7], 0
ds_read_b128 a[184:187], v1 offset:8192
v_mfma_f32_16x16x32_bf16 v[40:43], a[148:151], a[0:3], 0
ds_read_b128 a[188:191], v1 offset:9216
v_mfma_f32_16x16x32_bf16 v[68:71], a[148:151], a[4:7], 0
ds_read_b128 a[192:195], v1 offset:10240
v_mfma_f32_16x16x32_bf16 v[44:47], a[152:155], a[0:3], 0
ds_read_b128 a[196:199], v1 offset:11264
v_mfma_f32_16x16x32_bf16 v[72:75], a[152:155], a[4:7], 0
ds_read_b128 a[200:203], v1 offset:12288
v_mfma_f32_16x16x32_bf16 v[48:51], a[156:159], a[0:3], 0
ds_read_b128 a[204:207], v1 offset:13312
v_mfma_f32_16x16x32_bf16 v[76:79], a[156:159], a[4:7], 0
ds_read_b128 a[208:211], v125 offset:7168
v_mfma_f32_16x16x32_bf16 v[52:55], a[160:163], a[0:3], 0
ds_read_b128 a[212:215], v126 offset:1024
v_mfma_f32_16x16x32_bf16 v[80:83], a[160:163], a[4:7], 0
v_mfma_f32_16x16x32_bf16 v[56:59], a[164:167], a[0:3], 0
v_mfma_f32_16x16x32_bf16 v[84:87], a[164:167], a[4:7], 0
v_mfma_f32_16x16x32_bf16 v[60:63], a[168:171], a[0:3], 0
v_mfma_f32_16x16x32_bf16 v[88:91], a[168:171], a[4:7], 0
v_mfma_f32_16x16x32_bf16 v[92:95], a[172:175], a[176:179], 0
v_mfma_f32_16x16x32_bf16 v[96:99], a[160:163], a[176:179], 0
s_waitcnt lgkmcnt(0)
s_waitcnt vmcnt(32)
v_mfma_f32_16x16x32_bf16 v[36:39], a[180:183], a[8:11], v[36:39]
ds_read_b128 a[144:147], v1 offset:14336
v_mfma_f32_16x16x32_bf16 v[64:67], a[180:183], a[12:15], v[64:67]
ds_read_b128 a[148:151], v1 offset:15360
v_mfma_f32_16x16x32_bf16 v[40:43], a[184:187], a[8:11], v[40:43]
ds_read_b128 a[152:155], v1 offset:16384
v_mfma_f32_16x16x32_bf16 v[68:71], a[184:187], a[12:15], v[68:71]
ds_read_b128 a[156:159], v1 offset:17408
v_mfma_f32_16x16x32_bf16 v[44:47], a[188:191], a[8:11], v[44:47]
ds_read_b128 a[160:163], v1 offset:18432
v_mfma_f32_16x16x32_bf16 v[72:75], a[188:191], a[12:15], v[72:75]
ds_read_b128 a[164:167], v1 offset:19456
v_mfma_f32_16x16x32_bf16 v[48:51], a[192:195], a[8:11], v[48:51]
ds_read_b128 a[168:171], v1 offset:20480
v_mfma_f32_16x16x32_bf16 v[76:79], a[192:195], a[12:15], v[76:79]
ds_read_b128 a[172:175], v125 offset:14336
v_mfma_f32_16x16x32_bf16 v[52:55], a[196:199], a[8:11], v[52:55]
ds_read_b128 a[176:179], v126 offset:2048
v_mfma_f32_16x16x32_bf16 v[80:83], a[196:199], a[12:15], v[80:83]
v_mfma_f32_16x16x32_bf16 v[56:59], a[200:203], a[8:11], v[56:59]
v_mfma_f32_16x16x32_bf16 v[84:87], a[200:203], a[12:15], v[84:87]
v_mfma_f32_16x16x32_bf16 v[60:63], a[204:207], a[8:11], v[60:63]
v_mfma_f32_16x16x32_bf16 v[88:91], a[204:207], a[12:15], v[88:91]
v_mfma_f32_16x16x32_bf16 v[92:95], a[208:211], a[212:215], v[92:95]
v_mfma_f32_16x16x32_bf16 v[96:99], a[196:199], a[212:215], v[96:99]
s_waitcnt lgkmcnt(0)
s_waitcnt vmcnt(30)
v_mfma_f32_16x16x32_bf16 v[36:39], a[144:147], a[16:19], v[36:39]
ds_read_b128 a[180:183], v1 offset:21504
v_mfma_f32_16x16x32_bf16 v[64:67], a[144:147], a[20:23], v[64:67]
ds_read_b128 a[184:187], v1 offset:22528
v_mfma_f32_16x16x32_bf16 v[40:43], a[148:151], a[16:19], v[40:43]
ds_read_b128 a[188:191], v1 offset:23552
v_mfma_f32_16x16x32_bf16 v[68:71], a[148:151], a[20:23], v[68:71]
ds_read_b128 a[192:195], v1 offset:24576
v_mfma_f32_16x16x32_bf16 v[44:47], a[152:155], a[16:19], v[44:47]
ds_read_b128 a[196:199], v1 offset:25600
v_mfma_f32_16x16x32_bf16 v[72:75], a[152:155], a[20:23], v[72:75]
ds_read_b128 a[200:203], v1 offset:26624
v_mfma_f32_16x16x32_bf16 v[48:51], a[156:159], a[16:19], v[48:51]
ds_read_b128 a[204:207], v1 offset:27648
v_mfma_f32_16x16x32_bf16 v[76:79], a[156:159], a[20:23], v[76:79]
ds_read_b128 a[208:211], v125 offset:21504
v_mfma_f32_16x16x32_bf16 v[52:55], a[160:163], a[16:19], v[52:55]
ds_read_b128 a[212:215], v126 offset:3072
v_mfma_f32_16x16x32_bf16 v[80:83], a[160:163], a[20:23], v[80:83]
v_add_f32 v130, v100, v102
v_add_f32 v131, v101, v103
v_mfma_f32_16x16x32_bf16 v[56:59], a[164:167], a[16:19], v[56:59]
v_add_f32 v130, v130, v104
v_add_f32 v131, v131, v105
v_mfma_f32_16x16x32_bf16 v[84:87], a[164:167], a[20:23], v[84:87]
v_add_f32 v130, v130, v106
v_add_f32 v131, v131, v107
v_mfma_f32_16x16x32_bf16 v[60:63], a[168:171], a[16:19], v[60:63]
v_add_f32 v130, v130, v108
v_add_f32 v131, v131, v109
v_mfma_f32_16x16x32_bf16 v[88:91], a[168:171], a[20:23], v[88:91]
v_add_f32 v130, v130, v110
v_add_f32 v131, v131, v111
v_mfma_f32_16x16x32_bf16 v[92:95], a[172:175], a[176:179], v[92:95]
v_add_f32 v130, v130, v112
v_add_f32 v131, v131, v113
v_mfma_f32_16x16x32_bf16 v[96:99], a[160:163], a[176:179], v[96:99]
v_add_f32 v130, v130, v114
v_add_f32 v131, v131, v115
s_waitcnt lgkmcnt(0)
s_waitcnt vmcnt(28)
v_mfma_f32_16x16x32_bf16 v[36:39], a[180:183], a[24:27], v[36:39]
ds_read_b128 a[144:147], v1 offset:28672
v_mfma_f32_16x16x32_bf16 v[64:67], a[180:183], a[28:31], v[64:67]
ds_read_b128 a[148:151], v1 offset:29696
v_mfma_f32_16x16x32_bf16 v[40:43], a[184:187], a[24:27], v[40:43]
ds_read_b128 a[152:155], v1 offset:30720
v_mfma_f32_16x16x32_bf16 v[68:71], a[184:187], a[28:31], v[68:71]
ds_read_b128 a[156:159], v1 offset:31744
v_mfma_f32_16x16x32_bf16 v[44:47], a[188:191], a[24:27], v[44:47]
ds_read_b128 a[160:163], v1 offset:32768
v_mfma_f32_16x16x32_bf16 v[72:75], a[188:191], a[28:31], v[72:75]
ds_read_b128 a[164:167], v1 offset:33792
v_mfma_f32_16x16x32_bf16 v[48:51], a[192:195], a[24:27], v[48:51]
ds_read_b128 a[168:171], v1 offset:34816
v_mfma_f32_16x16x32_bf16 v[76:79], a[192:195], a[28:31], v[76:79]
ds_read_b128 a[172:175], v125 offset:28672
v_mfma_f32_16x16x32_bf16 v[52:55], a[196:199], a[24:27], v[52:55]
ds_read_b128 a[176:179], v126 offset:4096
v_mfma_f32_16x16x32_bf16 v[80:83], a[196:199], a[28:31], v[80:83]
v_mul_f32 v130, 0x3ae38e39, v130
v_mul_f32 v6, v130, v130
v_mfma_f32_16x16x32_bf16 v[56:59], a[200:203], a[24:27], v[56:59]
v_mul_f32 v131, 0x3ae38e39, v131
v_sub_f32 v131, v131, v6
v_mfma_f32_16x16x32_bf16 v[84:87], a[200:203], a[28:31], v[84:87]
v_max_f32 v131, 0, v131
v_add_f32 v131, 0x3727c5ac, v131
v_mfma_f32_16x16x32_bf16 v[60:63], a[204:207], a[24:27], v[60:63]
v_rsq_f32 v132, v131
v_mfma_f32_16x16x32_bf16 v[88:91], a[204:207], a[28:31], v[88:91]
v_cvt_pk_bf16_f32 v6, -v130, -v130
v_and_b32 v6, 0xffff0000, v6
v_mfma_f32_16x16x32_bf16 v[92:95], a[208:211], a[212:215], v[92:95]
v_add_f32 v6, v130, v6
v_cvt_pk_bf16_f32 v133, -v130, -v6
v_mfma_f32_16x16x32_bf16 v[96:99], a[196:199], a[212:215], v[96:99]
v_lshlrev_b32 v124, 2, v2
v_and_b32 v6, 1, v2
v_lshl_add_u32 v6, v3, 2, v6
s_waitcnt lgkmcnt(0)
s_waitcnt vmcnt(26)
v_mfma_f32_16x16x32_bf16 v[36:39], a[144:147], a[32:35], v[36:39]
ds_read_b128 a[180:183], v1 offset:35840
v_mfma_f32_16x16x32_bf16 v[64:67], a[144:147], a[36:39], v[64:67]
ds_read_b128 a[184:187], v1 offset:36864
v_mfma_f32_16x16x32_bf16 v[40:43], a[148:151], a[32:35], v[40:43]
ds_read_b128 a[188:191], v1 offset:37888
v_mfma_f32_16x16x32_bf16 v[68:71], a[148:151], a[36:39], v[68:71]
ds_read_b128 a[192:195], v1 offset:38912
v_mfma_f32_16x16x32_bf16 v[44:47], a[152:155], a[32:35], v[44:47]
ds_read_b128 a[196:199], v1 offset:39936
v_mfma_f32_16x16x32_bf16 v[72:75], a[152:155], a[36:39], v[72:75]
ds_read_b128 a[200:203], v1 offset:40960
v_mfma_f32_16x16x32_bf16 v[48:51], a[156:159], a[32:35], v[48:51]
ds_read_b128 a[204:207], v1 offset:41984
v_mfma_f32_16x16x32_bf16 v[76:79], a[156:159], a[36:39], v[76:79]
ds_read_b128 a[208:211], v125 offset:35840
v_mfma_f32_16x16x32_bf16 v[52:55], a[160:163], a[32:35], v[52:55]
ds_read_b128 a[212:215], v126 offset:5120
v_mfma_f32_16x16x32_bf16 v[80:83], a[160:163], a[36:39], v[80:83]
v_lshlrev_b32 v6, 2, v6
v_add_u32 v122, 64, v6
v_mfma_f32_16x16x32_bf16 v[56:59], a[164:167], a[32:35], v[56:59]
v_add_u32 v7, 128, v6
v_cndmask_b32 v122, v122, v7, s[42:43]
v_mfma_f32_16x16x32_bf16 v[84:87], a[164:167], a[36:39], v[84:87]
v_add_u32 v123, 72, v6
v_add_u32 v7, 136, v6
v_mfma_f32_16x16x32_bf16 v[60:63], a[168:171], a[32:35], v[60:63]
v_cndmask_b32 v123, v123, v7, s[44:45]
v_mfma_f32_16x16x32_bf16 v[88:91], a[168:171], a[36:39], v[88:91]
v_mfma_f32_16x16x32_bf16 v[92:95], a[172:175], a[176:179], v[92:95]
v_mfma_f32_16x16x32_bf16 v[96:99], a[160:163], a[176:179], v[96:99]
s_waitcnt lgkmcnt(0)
s_waitcnt vmcnt(24)
v_mfma_f32_16x16x32_bf16 v[36:39], a[180:183], a[40:43], v[36:39]
ds_read_b128 a[144:147], v1 offset:43008
v_mfma_f32_16x16x32_bf16 v[64:67], a[180:183], a[44:47], v[64:67]
ds_read_b128 a[148:151], v1 offset:44032
v_mfma_f32_16x16x32_bf16 v[40:43], a[184:187], a[40:43], v[40:43]
ds_read_b128 a[152:155], v1 offset:45056
v_mfma_f32_16x16x32_bf16 v[68:71], a[184:187], a[44:47], v[68:71]
ds_read_b128 a[156:159], v1 offset:46080
v_mfma_f32_16x16x32_bf16 v[44:47], a[188:191], a[40:43], v[44:47]
ds_read_b128 a[160:163], v1 offset:47104
v_mfma_f32_16x16x32_bf16 v[72:75], a[188:191], a[44:47], v[72:75]
ds_read_b128 a[164:167], v1 offset:48128
v_mfma_f32_16x16x32_bf16 v[48:51], a[192:195], a[40:43], v[48:51]
ds_read_b128 a[168:171], v1 offset:49152
v_mfma_f32_16x16x32_bf16 v[76:79], a[192:195], a[44:47], v[76:79]
ds_read_b128 a[172:175], v125 offset:43008
v_mfma_f32_16x16x32_bf16 v[52:55], a[196:199], a[40:43], v[52:55]
ds_read_b128 a[176:179], v126 offset:6144
v_mfma_f32_16x16x32_bf16 v[80:83], a[196:199], a[44:47], v[80:83]
ds_bpermute_b32 v116, v124, v133 offset:128
ds_bpermute_b32 v118, v124, v133 offset:192
v_mfma_f32_16x16x32_bf16 v[56:59], a[200:203], a[40:43], v[56:59]
ds_bpermute_b32 v120, v124, v133
ds_bpermute_b32 v134, v124, v132 offset:128
v_mfma_f32_16x16x32_bf16 v[84:87], a[200:203], a[44:47], v[84:87]
ds_bpermute_b32 v135, v124, v132 offset:192
v_mfma_f32_16x16x32_bf16 v[60:63], a[204:207], a[40:43], v[60:63]
v_mfma_f32_16x16x32_bf16 v[88:91], a[204:207], a[44:47], v[88:91]
v_mfma_f32_16x16x32_bf16 v[92:95], a[208:211], a[212:215], v[92:95]
v_mfma_f32_16x16x32_bf16 v[96:99], a[196:199], a[212:215], v[96:99]
s_waitcnt lgkmcnt(0)
s_waitcnt vmcnt(22)
v_mfma_f32_16x16x32_bf16 v[36:39], a[144:147], a[48:51], v[36:39]
ds_read_b128 a[180:183], v1 offset:50176
v_mfma_f32_16x16x32_bf16 v[64:67], a[144:147], a[52:55], v[64:67]
ds_read_b128 a[184:187], v1 offset:51200
v_mfma_f32_16x16x32_bf16 v[40:43], a[148:151], a[48:51], v[40:43]
ds_read_b128 a[188:191], v1 offset:52224
v_mfma_f32_16x16x32_bf16 v[68:71], a[148:151], a[52:55], v[68:71]
ds_read_b128 a[192:195], v1 offset:53248
v_mfma_f32_16x16x32_bf16 v[44:47], a[152:155], a[48:51], v[44:47]
ds_read_b128 a[196:199], v1 offset:54272
v_mfma_f32_16x16x32_bf16 v[72:75], a[152:155], a[52:55], v[72:75]
ds_read_b128 a[200:203], v1 offset:55296
v_mfma_f32_16x16x32_bf16 v[48:51], a[156:159], a[48:51], v[48:51]
ds_read_b128 a[204:207], v1 offset:56320
v_mfma_f32_16x16x32_bf16 v[76:79], a[156:159], a[52:55], v[76:79]
ds_read_b128 a[208:211], v125 offset:50176
v_mfma_f32_16x16x32_bf16 v[52:55], a[160:163], a[48:51], v[52:55]
ds_read_b128 a[212:215], v126 offset:7168
v_mfma_f32_16x16x32_bf16 v[80:83], a[160:163], a[52:55], v[80:83]
ds_bpermute_b32 v136, v122, v132 offset:0
ds_bpermute_b32 v137, v123, v132 offset:0
v_mfma_f32_16x16x32_bf16 v[56:59], a[164:167], a[48:51], v[56:59]
ds_bpermute_b32 v138, v122, v132 offset:64
ds_bpermute_b32 v139, v123, v132 offset:64
v_mfma_f32_16x16x32_bf16 v[84:87], a[164:167], a[52:55], v[84:87]
v_mfma_f32_16x16x32_bf16 v[60:63], a[168:171], a[48:51], v[60:63]
v_mfma_f32_16x16x32_bf16 v[88:91], a[168:171], a[52:55], v[88:91]
v_mfma_f32_16x16x32_bf16 v[92:95], a[172:175], a[176:179], v[92:95]
v_mfma_f32_16x16x32_bf16 v[96:99], a[160:163], a[176:179], v[96:99]
s_waitcnt lgkmcnt(0)
s_waitcnt vmcnt(20)
v_mfma_f32_16x16x32_bf16 v[36:39], a[180:183], a[56:59], v[36:39]
ds_read_b128 a[144:147], v1 offset:57344
v_mfma_f32_16x16x32_bf16 v[64:67], a[180:183], a[60:63], v[64:67]
ds_read_b128 a[148:151], v1 offset:58368
v_mfma_f32_16x16x32_bf16 v[40:43], a[184:187], a[56:59], v[40:43]
ds_read_b128 a[152:155], v1 offset:59392
v_mfma_f32_16x16x32_bf16 v[68:71], a[184:187], a[60:63], v[68:71]
ds_read_b128 a[156:159], v1 offset:60416
v_mfma_f32_16x16x32_bf16 v[44:47], a[188:191], a[56:59], v[44:47]
ds_read_b128 a[160:163], v1 offset:61440
v_mfma_f32_16x16x32_bf16 v[72:75], a[188:191], a[60:63], v[72:75]
ds_read_b128 a[164:167], v1 offset:62464
v_mfma_f32_16x16x32_bf16 v[48:51], a[192:195], a[56:59], v[48:51]
ds_read_b128 a[168:171], v1 offset:63488
v_mfma_f32_16x16x32_bf16 v[76:79], a[192:195], a[60:63], v[76:79]
ds_read_b128 a[172:175], v125 offset:57344
v_mfma_f32_16x16x32_bf16 v[52:55], a[196:199], a[56:59], v[52:55]
ds_read_b128 a[176:179], v126 offset:8192
v_mfma_f32_16x16x32_bf16 v[80:83], a[196:199], a[60:63], v[80:83]
v_mov_b32 v117, v116
v_mov_b32 v119, v118
v_mfma_f32_16x16x32_bf16 v[56:59], a[200:203], a[56:59], v[56:59]
v_mov_b32 v121, v120
v_mul_f32 v134, 0x3eae1a93, v134
v_mfma_f32_16x16x32_bf16 v[84:87], a[200:203], a[60:63], v[84:87]
v_mul_f32 v135, 0x3eae1a93, v135
v_mul_f32 v140, v134, v136
v_mfma_f32_16x16x32_bf16 v[60:63], a[204:207], a[56:59], v[60:63]
v_mul_f32 v141, v134, v137
v_mul_f32 v142, v135, v138
v_mfma_f32_16x16x32_bf16 v[88:91], a[204:207], a[60:63], v[88:91]
v_mul_f32 v143, v135, v139
v_mfma_f32_16x16x32_bf16 v[92:95], a[208:211], a[212:215], v[92:95]
v_mfma_f32_16x16x32_bf16 v[96:99], a[196:199], a[212:215], v[96:99]
s_waitcnt lgkmcnt(0)
s_waitcnt vmcnt(18)
v_add_u32 v125, 64512, v125
v_mfma_f32_16x16x32_bf16 v[36:39], a[144:147], a[64:67], v[36:39]
ds_read_b128 a[180:183], v8 offset:0
v_mfma_f32_16x16x32_bf16 v[64:67], a[144:147], a[68:71], v[64:67]
ds_read_b128 a[184:187], v8 offset:1024
v_mfma_f32_16x16x32_bf16 v[40:43], a[148:151], a[64:67], v[40:43]
ds_read_b128 a[188:191], v8 offset:2048
v_mfma_f32_16x16x32_bf16 v[68:71], a[148:151], a[68:71], v[68:71]
ds_read_b128 a[192:195], v8 offset:3072
v_mfma_f32_16x16x32_bf16 v[44:47], a[152:155], a[64:67], v[44:47]
ds_read_b128 a[196:199], v8 offset:4096
v_mfma_f32_16x16x32_bf16 v[72:75], a[152:155], a[68:71], v[72:75]
ds_read_b128 a[200:203], v8 offset:5120
v_mfma_f32_16x16x32_bf16 v[48:51], a[156:159], a[64:67], v[48:51]
ds_read_b128 a[204:207], v8 offset:6144
v_mfma_f32_16x16x32_bf16 v[76:79], a[156:159], a[68:71], v[76:79]
ds_read_b128 a[208:211], v125 offset:0
v_mfma_f32_16x16x32_bf16 v[52:55], a[160:163], a[64:67], v[52:55]
ds_read_b128 a[212:215], v126 offset:9216
v_mfma_f32_16x16x32_bf16 v[80:83], a[160:163], a[68:71], v[80:83]
s_cmp_eq_u32 s60, 0
s_cselect_b32 s30, 0xf149f2ca, 0
v_mfma_f32_16x16x32_bf16 v[56:59], a[164:167], a[64:67], v[56:59]
v_mov_b32 v6, s30
v_cndmask_b32 v144, v6, 0, s[42:43]
v_mfma_f32_16x16x32_bf16 v[84:87], a[164:167], a[68:71], v[84:87]
v_cndmask_b32 v145, v6, 0, s[44:45]
v_mfma_f32_16x16x32_bf16 v[60:63], a[168:171], a[64:67], v[60:63]
v_mfma_f32_16x16x32_bf16 v[88:91], a[168:171], a[68:71], v[88:91]
v_mfma_f32_16x16x32_bf16 v[92:95], a[172:175], a[176:179], v[92:95]
v_mfma_f32_16x16x32_bf16 v[96:99], a[160:163], a[176:179], v[96:99]
s_waitcnt lgkmcnt(0)
s_waitcnt vmcnt(16)
v_mfma_f32_16x16x32_bf16 v[36:39], a[180:183], a[72:75], v[36:39]
ds_read_b128 a[144:147], v8 offset:7168
v_mfma_f32_16x16x32_bf16 v[64:67], a[180:183], a[76:79], v[64:67]
ds_read_b128 a[148:151], v8 offset:8192
v_mfma_f32_16x16x32_bf16 v[40:43], a[184:187], a[72:75], v[40:43]
ds_read_b128 a[152:155], v8 offset:9216
v_mfma_f32_16x16x32_bf16 v[68:71], a[184:187], a[76:79], v[68:71]
ds_read_b128 a[156:159], v8 offset:10240
v_mfma_f32_16x16x32_bf16 v[44:47], a[188:191], a[72:75], v[44:47]
ds_read_b128 a[160:163], v8 offset:11264
v_mfma_f32_16x16x32_bf16 v[72:75], a[188:191], a[76:79], v[72:75]
ds_read_b128 a[164:167], v8 offset:12288
v_mfma_f32_16x16x32_bf16 v[48:51], a[192:195], a[72:75], v[48:51]
ds_read_b128 a[168:171], v8 offset:13312
v_mfma_f32_16x16x32_bf16 v[76:79], a[192:195], a[76:79], v[76:79]
ds_read_b128 a[172:175], v125 offset:7168
v_mfma_f32_16x16x32_bf16 v[52:55], a[196:199], a[72:75], v[52:55]
ds_read_b128 a[176:179], v126 offset:10240
v_mfma_f32_16x16x32_bf16 v[80:83], a[196:199], a[76:79], v[80:83]
v_mfma_f32_16x16x32_bf16 v[56:59], a[200:203], a[72:75], v[56:59]
v_mfma_f32_16x16x32_bf16 v[84:87], a[200:203], a[76:79], v[84:87]
v_mfma_f32_16x16x32_bf16 v[60:63], a[204:207], a[72:75], v[60:63]
v_mfma_f32_16x16x32_bf16 v[88:91], a[204:207], a[76:79], v[88:91]
v_mfma_f32_16x16x32_bf16 v[92:95], a[208:211], a[212:215], v[92:95]
v_mfma_f32_16x16x32_bf16 v[96:99], a[196:199], a[212:215], v[96:99]
s_waitcnt lgkmcnt(0)
s_waitcnt vmcnt(14)
v_mfma_f32_16x16x32_bf16 v[36:39], a[144:147], a[80:83], v[36:39]
ds_read_b128 a[180:183], v8 offset:14336
v_mfma_f32_16x16x32_bf16 v[64:67], a[144:147], a[84:87], v[64:67]
ds_read_b128 a[184:187], v8 offset:15360
v_mfma_f32_16x16x32_bf16 v[40:43], a[148:151], a[80:83], v[40:43]
ds_read_b128 a[188:191], v8 offset:16384
v_mfma_f32_16x16x32_bf16 v[68:71], a[148:151], a[84:87], v[68:71]
ds_read_b128 a[192:195], v8 offset:17408
v_mfma_f32_16x16x32_bf16 v[44:47], a[152:155], a[80:83], v[44:47]
ds_read_b128 a[196:199], v8 offset:18432
v_mfma_f32_16x16x32_bf16 v[72:75], a[152:155], a[84:87], v[72:75]
ds_read_b128 a[200:203], v8 offset:19456
v_mfma_f32_16x16x32_bf16 v[48:51], a[156:159], a[80:83], v[48:51]
ds_read_b128 a[204:207], v8 offset:20480
v_mfma_f32_16x16x32_bf16 v[76:79], a[156:159], a[84:87], v[76:79]
ds_read_b128 a[208:211], v125 offset:14336
v_mfma_f32_16x16x32_bf16 v[52:55], a[160:163], a[80:83], v[52:55]
ds_read_b128 a[212:215], v126 offset:11264
v_mfma_f32_16x16x32_bf16 v[80:83], a[160:163], a[84:87], v[80:83]
v_mfma_f32_16x16x32_bf16 v[56:59], a[164:167], a[80:83], v[56:59]
v_mfma_f32_16x16x32_bf16 v[84:87], a[164:167], a[84:87], v[84:87]
v_mfma_f32_16x16x32_bf16 v[60:63], a[168:171], a[80:83], v[60:63]
v_mfma_f32_16x16x32_bf16 v[88:91], a[168:171], a[84:87], v[88:91]
v_mfma_f32_16x16x32_bf16 v[92:95], a[172:175], a[176:179], v[92:95]
v_mfma_f32_16x16x32_bf16 v[96:99], a[160:163], a[176:179], v[96:99]
s_waitcnt lgkmcnt(0)
s_waitcnt vmcnt(12)
v_mfma_f32_16x16x32_bf16 v[36:39], a[180:183], a[88:91], v[36:39]
ds_read_b128 a[144:147], v8 offset:21504
v_mfma_f32_16x16x32_bf16 v[64:67], a[180:183], a[92:95], v[64:67]
ds_read_b128 a[148:151], v8 offset:22528
v_mfma_f32_16x16x32_bf16 v[40:43], a[184:187], a[88:91], v[40:43]
ds_read_b128 a[152:155], v8 offset:23552
v_mfma_f32_16x16x32_bf16 v[68:71], a[184:187], a[92:95], v[68:71]
ds_read_b128 a[156:159], v8 offset:24576
v_mfma_f32_16x16x32_bf16 v[44:47], a[188:191], a[88:91], v[44:47]
ds_read_b128 a[160:163], v8 offset:25600
v_mfma_f32_16x16x32_bf16 v[72:75], a[188:191], a[92:95], v[72:75]
ds_read_b128 a[164:167], v8 offset:26624
v_mfma_f32_16x16x32_bf16 v[48:51], a[192:195], a[88:91], v[48:51]
ds_read_b128 a[168:171], v8 offset:27648
v_mfma_f32_16x16x32_bf16 v[76:79], a[192:195], a[92:95], v[76:79]
ds_read_b128 a[172:175], v125 offset:21504
v_mfma_f32_16x16x32_bf16 v[52:55], a[196:199], a[88:91], v[52:55]
ds_read_b128 a[176:179], v126 offset:12288
v_mfma_f32_16x16x32_bf16 v[80:83], a[196:199], a[92:95], v[80:83]
v_mfma_f32_16x16x32_bf16 v[56:59], a[200:203], a[88:91], v[56:59]
v_mfma_f32_16x16x32_bf16 v[84:87], a[200:203], a[92:95], v[84:87]
v_mfma_f32_16x16x32_bf16 v[60:63], a[204:207], a[88:91], v[60:63]
v_mfma_f32_16x16x32_bf16 v[88:91], a[204:207], a[92:95], v[88:91]
v_mfma_f32_16x16x32_bf16 v[92:95], a[208:211], a[212:215], v[92:95]
v_mfma_f32_16x16x32_bf16 v[96:99], a[196:199], a[212:215], v[96:99]
s_waitcnt lgkmcnt(0)
s_waitcnt vmcnt(10)
v_mfma_f32_16x16x32_bf16 v[36:39], a[144:147], a[96:99], v[36:39]
ds_read_b128 a[180:183], v8 offset:28672
v_mfma_f32_16x16x32_bf16 v[64:67], a[144:147], a[100:103], v[64:67]
ds_read_b128 a[184:187], v8 offset:29696
v_mfma_f32_16x16x32_bf16 v[40:43], a[148:151], a[96:99], v[40:43]
ds_read_b128 a[188:191], v8 offset:30720
v_mfma_f32_16x16x32_bf16 v[68:71], a[148:151], a[100:103], v[68:71]
ds_read_b128 a[192:195], v8 offset:31744
v_mfma_f32_16x16x32_bf16 v[44:47], a[152:155], a[96:99], v[44:47]
ds_read_b128 a[196:199], v8 offset:32768
v_mfma_f32_16x16x32_bf16 v[72:75], a[152:155], a[100:103], v[72:75]
ds_read_b128 a[200:203], v8 offset:33792
v_mfma_f32_16x16x32_bf16 v[48:51], a[156:159], a[96:99], v[48:51]
ds_read_b128 a[204:207], v8 offset:34816
v_mfma_f32_16x16x32_bf16 v[76:79], a[156:159], a[100:103], v[76:79]
ds_read_b128 a[208:211], v125 offset:28672
v_mfma_f32_16x16x32_bf16 v[52:55], a[160:163], a[96:99], v[52:55]
ds_read_b128 a[212:215], v126 offset:13312
v_mfma_f32_16x16x32_bf16 v[80:83], a[160:163], a[100:103], v[80:83]
v_mfma_f32_16x16x32_bf16 v[56:59], a[164:167], a[96:99], v[56:59]
v_mfma_f32_16x16x32_bf16 v[84:87], a[164:167], a[100:103], v[84:87]
v_mfma_f32_16x16x32_bf16 v[60:63], a[168:171], a[96:99], v[60:63]
v_mfma_f32_16x16x32_bf16 v[88:91], a[168:171], a[100:103], v[88:91]
v_mfma_f32_16x16x32_bf16 v[92:95], a[172:175], a[176:179], v[92:95]
v_mfma_f32_16x16x32_bf16 v[96:99], a[160:163], a[176:179], v[96:99]
s_waitcnt lgkmcnt(0)
s_waitcnt vmcnt(8)
v_mfma_f32_16x16x32_bf16 v[36:39], a[180:183], a[104:107], v[36:39]
ds_read_b128 a[144:147], v8 offset:35840
v_mfma_f32_16x16x32_bf16 v[64:67], a[180:183], a[108:111], v[64:67]
ds_read_b128 a[148:151], v8 offset:36864
v_mfma_f32_16x16x32_bf16 v[40:43], a[184:187], a[104:107], v[40:43]
ds_read_b128 a[152:155], v8 offset:37888
v_mfma_f32_16x16x32_bf16 v[68:71], a[184:187], a[108:111], v[68:71]
ds_read_b128 a[156:159], v8 offset:38912
v_mfma_f32_16x16x32_bf16 v[44:47], a[188:191], a[104:107], v[44:47]
ds_read_b128 a[160:163], v8 offset:39936
v_mfma_f32_16x16x32_bf16 v[72:75], a[188:191], a[108:111], v[72:75]
ds_read_b128 a[164:167], v8 offset:40960
v_mfma_f32_16x16x32_bf16 v[48:51], a[192:195], a[104:107], v[48:51]
ds_read_b128 a[168:171], v8 offset:41984
v_mfma_f32_16x16x32_bf16 v[76:79], a[192:195], a[108:111], v[76:79]
ds_read_b128 a[172:175], v125 offset:35840
v_mfma_f32_16x16x32_bf16 v[52:55], a[196:199], a[104:107], v[52:55]
ds_read_b128 a[176:179], v126 offset:14336
v_mfma_f32_16x16x32_bf16 v[80:83], a[196:199], a[108:111], v[80:83]
v_mfma_f32_16x16x32_bf16 v[56:59], a[200:203], a[104:107], v[56:59]
v_mfma_f32_16x16x32_bf16 v[84:87], a[200:203], a[108:111], v[84:87]
v_mfma_f32_16x16x32_bf16 v[60:63], a[204:207], a[104:107], v[60:63]
v_mfma_f32_16x16x32_bf16 v[88:91], a[204:207], a[108:111], v[88:91]
v_mfma_f32_16x16x32_bf16 v[92:95], a[208:211], a[212:215], v[92:95]
v_mfma_f32_16x16x32_bf16 v[96:99], a[196:199], a[212:215], v[96:99]
s_waitcnt lgkmcnt(0)
s_waitcnt vmcnt(6)
v_mfma_f32_16x16x32_bf16 v[36:39], a[144:147], a[112:115], v[36:39]
ds_read_b128 a[180:183], v8 offset:43008
v_mfma_f32_16x16x32_bf16 v[64:67], a[144:147], a[116:119], v[64:67]
ds_read_b128 a[184:187], v8 offset:44032
v_mfma_f32_16x16x32_bf16 v[40:43], a[148:151], a[112:115], v[40:43]
ds_read_b128 a[188:191], v8 offset:45056
v_mfma_f32_16x16x32_bf16 v[68:71], a[148:151], a[116:119], v[68:71]
ds_read_b128 a[192:195], v8 offset:46080
v_mfma_f32_16x16x32_bf16 v[44:47], a[152:155], a[112:115], v[44:47]
ds_read_b128 a[196:199], v8 offset:47104
v_mfma_f32_16x16x32_bf16 v[72:75], a[152:155], a[116:119], v[72:75]
ds_read_b128 a[200:203], v8 offset:48128
v_mfma_f32_16x16x32_bf16 v[48:51], a[156:159], a[112:115], v[48:51]
ds_read_b128 a[204:207], v8 offset:49152
v_mfma_f32_16x16x32_bf16 v[76:79], a[156:159], a[116:119], v[76:79]
ds_read_b128 a[208:211], v125 offset:43008
v_mfma_f32_16x16x32_bf16 v[52:55], a[160:163], a[112:115], v[52:55]
ds_read_b128 a[212:215], v126 offset:15360
v_mfma_f32_16x16x32_bf16 v[80:83], a[160:163], a[116:119], v[80:83]
v_mfma_f32_16x16x32_bf16 v[56:59], a[164:167], a[112:115], v[56:59]
v_mfma_f32_16x16x32_bf16 v[84:87], a[164:167], a[116:119], v[84:87]
v_mfma_f32_16x16x32_bf16 v[60:63], a[168:171], a[112:115], v[60:63]
v_mfma_f32_16x16x32_bf16 v[88:91], a[168:171], a[116:119], v[88:91]
v_mfma_f32_16x16x32_bf16 v[92:95], a[172:175], a[176:179], v[92:95]
v_mfma_f32_16x16x32_bf16 v[96:99], a[160:163], a[176:179], v[96:99]
s_waitcnt lgkmcnt(0)
s_waitcnt vmcnt(4)
v_mfma_f32_16x16x32_bf16 v[36:39], a[180:183], a[120:123], v[36:39]
ds_read_b128 a[144:147], v8 offset:50176
v_mfma_f32_16x16x32_bf16 v[64:67], a[180:183], a[124:127], v[64:67]
ds_read_b128 a[148:151], v8 offset:51200
v_mfma_f32_16x16x32_bf16 v[40:43], a[184:187], a[120:123], v[40:43]
ds_read_b128 a[152:155], v8 offset:52224
v_mfma_f32_16x16x32_bf16 v[68:71], a[184:187], a[124:127], v[68:71]
ds_read_b128 a[156:159], v8 offset:53248
v_mfma_f32_16x16x32_bf16 v[44:47], a[188:191], a[120:123], v[44:47]
ds_read_b128 a[160:163], v8 offset:54272
v_mfma_f32_16x16x32_bf16 v[72:75], a[188:191], a[124:127], v[72:75]
ds_read_b128 a[164:167], v8 offset:55296
v_mfma_f32_16x16x32_bf16 v[48:51], a[192:195], a[120:123], v[48:51]
ds_read_b128 a[168:171], v8 offset:56320
v_mfma_f32_16x16x32_bf16 v[76:79], a[192:195], a[124:127], v[76:79]
ds_read_b128 a[172:175], v125 offset:50176
v_mfma_f32_16x16x32_bf16 v[52:55], a[196:199], a[120:123], v[52:55]
ds_read_b128 a[176:179], v126 offset:16384
v_mfma_f32_16x16x32_bf16 v[80:83], a[196:199], a[124:127], v[80:83]
v_mfma_f32_16x16x32_bf16 v[56:59], a[200:203], a[120:123], v[56:59]
v_mfma_f32_16x16x32_bf16 v[84:87], a[200:203], a[124:127], v[84:87]
v_mfma_f32_16x16x32_bf16 v[60:63], a[204:207], a[120:123], v[60:63]
v_mfma_f32_16x16x32_bf16 v[88:91], a[204:207], a[124:127], v[88:91]
v_mfma_f32_16x16x32_bf16 v[92:95], a[208:211], a[212:215], v[92:95]
v_mfma_f32_16x16x32_bf16 v[96:99], a[196:199], a[212:215], v[96:99]
s_waitcnt lgkmcnt(0)
s_waitcnt vmcnt(2)
v_mfma_f32_16x16x32_bf16 v[36:39], a[144:147], a[128:131], v[36:39]
ds_read_b128 a[180:183], v8 offset:57344
v_mfma_f32_16x16x32_bf16 v[64:67], a[144:147], a[132:135], v[64:67]
ds_read_b128 a[184:187], v8 offset:58368
v_mfma_f32_16x16x32_bf16 v[40:43], a[148:151], a[128:131], v[40:43]
ds_read_b128 a[188:191], v8 offset:59392
v_mfma_f32_16x16x32_bf16 v[68:71], a[148:151], a[132:135], v[68:71]
ds_read_b128 a[192:195], v8 offset:60416
v_mfma_f32_16x16x32_bf16 v[44:47], a[152:155], a[128:131], v[44:47]
ds_read_b128 a[196:199], v8 offset:61440
v_mfma_f32_16x16x32_bf16 v[72:75], a[152:155], a[132:135], v[72:75]
ds_read_b128 a[200:203], v8 offset:62464
v_mfma_f32_16x16x32_bf16 v[48:51], a[156:159], a[128:131], v[48:51]
ds_read_b128 a[204:207], v8 offset:63488
v_mfma_f32_16x16x32_bf16 v[76:79], a[156:159], a[132:135], v[76:79]
ds_read_b128 a[208:211], v125 offset:57344
v_mfma_f32_16x16x32_bf16 v[52:55], a[160:163], a[128:131], v[52:55]
ds_read_b128 a[212:215], v126 offset:17408
v_mfma_f32_16x16x32_bf16 v[80:83], a[160:163], a[132:135], v[80:83]
v_mfma_f32_16x16x32_bf16 v[56:59], a[164:167], a[128:131], v[56:59]
v_mfma_f32_16x16x32_bf16 v[84:87], a[164:167], a[132:135], v[84:87]
v_mfma_f32_16x16x32_bf16 v[60:63], a[168:171], a[128:131], v[60:63]
v_mfma_f32_16x16x32_bf16 v[88:91], a[168:171], a[132:135], v[88:91]
v_mfma_f32_16x16x32_bf16 v[92:95], a[172:175], a[176:179], v[92:95]
v_mfma_f32_16x16x32_bf16 v[96:99], a[160:163], a[176:179], v[96:99]
s_waitcnt lgkmcnt(0)
s_waitcnt vmcnt(0)
v_mfma_f32_16x16x32_bf16 v[36:39], a[180:183], a[136:139], v[36:39]
ds_read_b64 a[216:217], v128 offset:0
v_mfma_f32_16x16x32_bf16 v[64:67], a[180:183], a[140:143], v[64:67]
ds_read_b64 a[218:219], v128 offset:512
v_mfma_f32_16x16x32_bf16 v[40:43], a[184:187], a[136:139], v[40:43]
ds_read_b64 a[220:221], v128 offset:1024
v_mfma_f32_16x16x32_bf16 v[68:71], a[184:187], a[140:143], v[68:71]
ds_read_b64 a[222:223], v128 offset:1536
v_mfma_f32_16x16x32_bf16 v[44:47], a[188:191], a[136:139], v[44:47]
ds_read_b64 a[224:225], v128 offset:2048
v_mfma_f32_16x16x32_bf16 v[72:75], a[188:191], a[140:143], v[72:75]
ds_read_b64 a[226:227], v128 offset:2560
v_mfma_f32_16x16x32_bf16 v[48:51], a[192:195], a[136:139], v[48:51]
ds_read_b64 a[228:229], v128 offset:3072
v_mfma_f32_16x16x32_bf16 v[76:79], a[192:195], a[140:143], v[76:79]
ds_read_b64 a[230:231], v129
v_mfma_f32_16x16x32_bf16 v[52:55], a[196:199], a[136:139], v[52:55]
v_mfma_f32_16x16x32_bf16 v[80:83], a[196:199], a[140:143], v[80:83]
v_mfma_f32_16x16x32_bf16 v[56:59], a[200:203], a[136:139], v[56:59]
v_mfma_f32_16x16x32_bf16 v[84:87], a[200:203], a[140:143], v[84:87]
v_mfma_f32_16x16x32_bf16 v[60:63], a[204:207], a[136:139], v[60:63]
v_mfma_f32_16x16x32_bf16 v[88:91], a[204:207], a[140:143], v[88:91]
v_mfma_f32_16x16x32_bf16 v[92:95], a[208:211], a[212:215], v[92:95]
v_mfma_f32_16x16x32_bf16 v[96:99], a[196:199], a[212:215], v[96:99]
s_waitcnt lgkmcnt(0)
v_mfma_f32_16x16x16_bf16 v[36:39], a[216:217], v[116:117], v[36:39]
v_mfma_f32_16x16x16_bf16 v[64:67], a[216:217], v[118:119], v[64:67]
v_mfma_f32_16x16x16_bf16 v[40:43], a[218:219], v[116:117], v[40:43]
v_mfma_f32_16x16x16_bf16 v[68:71], a[218:219], v[118:119], v[68:71]
v_mfma_f32_16x16x16_bf16 v[44:47], a[220:221], v[116:117], v[44:47]
v_mfma_f32_16x16x16_bf16 v[72:75], a[220:221], v[118:119], v[72:75]
v_mfma_f32_16x16x16_bf16 v[48:51], a[222:223], v[116:117], v[48:51]
v_mfma_f32_16x16x16_bf16 v[76:79], a[222:223], v[118:119], v[76:79]
v_mfma_f32_16x16x16_bf16 v[52:55], a[224:225], v[116:117], v[52:55]
v_mfma_f32_16x16x16_bf16 v[80:83], a[224:225], v[118:119], v[80:83]
v_mfma_f32_16x16x16_bf16 v[56:59], a[226:227], v[116:117], v[56:59]
v_mfma_f32_16x16x16_bf16 v[84:87], a[226:227], v[118:119], v[84:87]
v_mfma_f32_16x16x16_bf16 v[60:63], a[228:229], v[116:117], v[60:63]
v_mfma_f32_16x16x16_bf16 v[88:91], a[228:229], v[118:119], v[88:91]
v_mfma_f32_16x16x16_bf16 v[92:95], a[230:231], v[120:121], v[92:95]
v_mfma_f32_16x16x16_bf16 v[96:99], a[224:225], v[120:121], v[96:99]
s_waitcnt lgkmcnt(0)
s_memrealtime s[58:59]
s_waitcnt lgkmcnt(0)
s_mov_b32 m0, s56
s_nop 0
v_writelane_b32 v5, s58, m0
s_add_u32 s56, s56, 1
s_barrier
s_lshl_b32 s30, s24, 5
v_add_u32 v6, s30, v2
v_mul_u32_u24 v210, 176, v6
v_add_u32 v210, 135168, v210
v_lshl_add_u32 v208, v3, 3, v210
v_mul_u32_u24 v209, 176, v2
v_lshl_add_u32 v209, v3, 3, v209
v_add_u32 v209, 135168, v209
v_add_u32 v8, s30, v209
v_lshrrev_b32 v6, 2, v2
v_lshl_add_u32 v6, v3, 2, v6
v_add_u32 v6, s30, v6
v_mul_u32_u24 v211, 176, v6
v_and_b32 v6, 3, v2
v_lshl_add_u32 v211, v6, 3, v211
v_add_u32 v211, 135168, v211
v_cvt_pk_bf16_f32 v152, v36, v37
v_cvt_pk_bf16_f32 v153, v38, v39
ds_write_b64 v208, v[152:153] offset:2816
v_cvt_pk_bf16_f32 v156, v40, v41
v_cvt_pk_bf16_f32 v157, v42, v43
ds_write_b64 v208, v[156:157] offset:2848
v_cvt_pk_bf16_f32 v198, v44, v45
v_cvt_pk_bf16_f32 v199, v46, v47
ds_write_b64 v208, v[198:199] offset:2880
v_cvt_pk_bf16_f32 v200, v48, v49
v_cvt_pk_bf16_f32 v201, v50, v51
ds_write_b64 v208, v[200:201] offset:2912
v_cvt_pk_bf16_f32 v202, v52, v53
v_cvt_pk_bf16_f32 v203, v54, v55
ds_write_b64 v208, v[202:203] offset:2944
v_cvt_pk_bf16_f32 v164, v56, v57
v_cvt_pk_bf16_f32 v165, v58, v59
v_cvt_pk_bf16_f32 v170, v60, v61
v_cvt_pk_bf16_f32 v171, v62, v63
v_cndmask_b32 v166, 0, v202, s[48:49]
v_mov_b32 v167, 0
v_mov_b32 v168, 0
v_cndmask_b32 v169, 0, v203, s[48:49]
v_cvt_pk_bf16_f32 v158, v64, v65
v_cvt_pk_bf16_f32 v159, v66, v67
ds_write_b64 v208, v[158:159] offset:5632
v_cvt_pk_bf16_f32 v162, v68, v69
v_cvt_pk_bf16_f32 v163, v70, v71
ds_write_b64 v208, v[162:163] offset:5664
v_cvt_pk_bf16_f32 v198, v72, v73
v_cvt_pk_bf16_f32 v199, v74, v75
ds_write_b64 v208, v[198:199] offset:5696
v_cvt_pk_bf16_f32 v200, v76, v77
v_cvt_pk_bf16_f32 v201, v78, v79
ds_write_b64 v208, v[200:201] offset:5728
v_cvt_pk_bf16_f32 v202, v80, v81
v_cvt_pk_bf16_f32 v203, v82, v83
ds_write_b64 v208, v[202:203] offset:5760
v_cvt_pk_bf16_f32 v172, v84, v85
v_cvt_pk_bf16_f32 v173, v86, v87
v_cvt_pk_bf16_f32 v178, v88, v89
v_cvt_pk_bf16_f32 v179, v90, v91
v_cndmask_b32 v174, 0, v202, s[48:49]
v_mov_b32 v175, 0
v_mov_b32 v176, 0
v_cndmask_b32 v177, 0, v203, s[48:49]
v_cvt_pk_bf16_f32 v204, v92, v93
v_cvt_pk_bf16_f32 v205, v94, v95
ds_write_b64 v8, v[204:205]
v_cvt_pk_bf16_f32 v206, v96, v97
v_cvt_pk_bf16_f32 v207, v98, v99
ds_write_b64 v209, v[206:207] offset:128
s_waitcnt lgkmcnt(0)
s_barrier
ds_read_b64 v[146:147], v208
ds_read_b64 v[150:151], v208 offset:32
ds_read_b64 v[148:149], v210 offset:136
ds_read_b64 v[154:155], v210 offset:2952
ds_read_b64 v[160:161], v210 offset:5768
ds_read_b64_tr_b16 v[180:181], v211 offset:64
ds_read_b64_tr_b16 v[182:183], v211 offset:2880
ds_read_b64_tr_b16 v[184:185], v211 offset:5696
ds_read_b64_tr_b16 v[186:187], v211 offset:96
ds_read_b64_tr_b16 v[188:189], v211 offset:2912
ds_read_b64_tr_b16 v[190:191], v211 offset:5728
ds_read_b64_tr_b16 v[192:193], v211 offset:128
ds_read_b64_tr_b16 v[194:195], v211 offset:2944
ds_read_b64_tr_b16 v[196:197], v211 offset:5760
s_waitcnt lgkmcnt(9)
v_mfma_f32_16x16x32_bf16 v[36:39], v[146:149], v[164:167], 0
v_mfma_f32_16x16x32_bf16 v[40:43], v[152:155], v[164:167], 0
v_mfma_f32_16x16x32_bf16 v[44:47], v[148:151], v[168:171], 0
v_mfma_f32_16x16x32_bf16 v[48:51], v[154:157], v[168:171], 0
v_mfma_f32_16x16x32_bf16 v[52:55], v[152:155], v[172:175], 0
v_mfma_f32_16x16x32_bf16 v[56:59], v[158:161], v[172:175], 0
v_mfma_f32_16x16x32_bf16 v[60:63], v[154:157], v[176:179], 0
v_mfma_f32_16x16x32_bf16 v[64:67], v[160:163], v[176:179], 0
s_nop 1
v_cndmask_b32 v36, v36, v37, s[40:41]
v_cndmask_b32 v40, v40, v41, s[40:41]
v_cndmask_b32 v36, v36, v40, s[42:43]
v_fma_f32 v68, v36, v140, v144
v_cndmask_b32 v38, v38, v39, s[40:41]
v_cndmask_b32 v42, v42, v43, s[40:41]
v_cndmask_b32 v38, v38, v42, s[44:45]
v_fma_f32 v69, v38, v141, v145
v_max_f32 v76, v68, v69
v_cndmask_b32 v44, v44, v45, s[40:41]
v_cndmask_b32 v48, v48, v49, s[40:41]
v_cndmask_b32 v44, v44, v48, s[42:43]
v_fma_f32 v70, v44, v140, v144
v_cndmask_b32 v46, v46, v47, s[40:41]
v_cndmask_b32 v50, v50, v51, s[40:41]
v_cndmask_b32 v46, v46, v50, s[44:45]
v_fma_f32 v71, v46, v141, v145
v_max_f32 v77, v70, v71
v_cndmask_b32 v52, v52, v53, s[40:41]
v_cndmask_b32 v56, v56, v57, s[40:41]
v_cndmask_b32 v52, v52, v56, s[42:43]
v_mul_f32 v72, v52, v142
v_cndmask_b32 v54, v54, v55, s[40:41]
v_cndmask_b32 v58, v58, v59, s[40:41]
v_cndmask_b32 v54, v54, v58, s[44:45]
v_mul_f32 v73, v54, v143
v_max_f32 v78, v72, v73
v_cndmask_b32 v60, v60, v61, s[40:41]
v_cndmask_b32 v64, v64, v65, s[40:41]
v_cndmask_b32 v60, v60, v64, s[42:43]
v_mul_f32 v74, v60, v142
v_cndmask_b32 v62, v62, v63, s[40:41]
v_cndmask_b32 v66, v66, v67, s[40:41]
v_cndmask_b32 v62, v62, v66, s[44:45]
v_mul_f32 v75, v62, v143
v_max_f32 v79, v74, v75
s_nop 1
v_permlane32_swap_b32 v76, v77
v_permlane32_swap_b32 v78, v79
v_max_f32 v76, v76, v77
v_max_f32 v78, v78, v79
s_nop 1
v_permlane16_swap_b32 v76, v78
v_max_f32 v76, v76, v78
v_mov_b32 v78, v76
s_nop 1
v_permlane16_swap_b32 v76, v78
v_mov_b32 v77, v76
v_mov_b32 v79, v78
s_nop 0
v_permlane32_swap_b32 v76, v77
v_permlane32_swap_b32 v78, v79
v_sub_f32 v68, v68, v76
v_sub_f32 v69, v69, v76
v_sub_f32 v70, v70, v77
v_sub_f32 v71, v71, v77
v_sub_f32 v72, v72, v78
v_sub_f32 v73, v73, v78
v_sub_f32 v74, v74, v79
v_sub_f32 v75, v75, v79
v_exp_f32 v68, v68
v_exp_f32 v69, v69
v_exp_f32 v70, v70
v_exp_f32 v71, v71
v_exp_f32 v72, v72
v_exp_f32 v73, v73
v_exp_f32 v74, v74
v_exp_f32 v75, v75
v_add_f32 v76, v68, v69
v_add_f32 v77, v70, v71
v_add_f32 v78, v72, v73
v_add_f32 v79, v74, v75
v_mul_f32 v68, v68, v136
v_mul_f32 v69, v69, v137
v_mul_f32 v70, v70, v136
v_mul_f32 v71, v71, v137
v_mul_f32 v72, v72, v138
v_mul_f32 v73, v73, v139
v_mul_f32 v74, v74, v138
v_mul_f32 v75, v75, v139
s_nop 1
v_permlane32_swap_b32 v76, v77
v_permlane32_swap_b32 v78, v79
v_add_f32 v76, v76, v77
v_add_f32 v78, v78, v79
s_nop 1
v_permlane16_swap_b32 v76, v78
v_add_f32 v76, v76, v78
v_rcp_f32 v76, v76
s_nop 0
v_mov_b32 v78, v76
s_nop 1
v_permlane16_swap_b32 v76, v78
v_mov_b32 v77, v76
v_mov_b32 v79, v78
s_nop 0
v_permlane32_swap_b32 v76, v77
v_permlane32_swap_b32 v78, v79
v_mul_f32 v68, v68, v76
v_mul_f32 v69, v69, v76
v_mul_f32 v70, v70, v77
v_mul_f32 v71, v71, v77
v_mul_f32 v72, v72, v78
v_mul_f32 v73, v73, v78
v_mul_f32 v74, v74, v79
v_mul_f32 v75, v75, v79
v_cvt_pk_bf16_f32 v68, v68, v69
v_perm_b32 v84, v68, v68, v10
v_perm_b32 v85, v68, v68, v11
v_perm_b32 v86, v68, v68, v12
v_perm_b32 v87, v68, v68, v13
v_cvt_pk_bf16_f32 v70, v70, v71
v_perm_b32 v88, v70, v70, v10
v_perm_b32 v89, v70, v70, v11
v_perm_b32 v90, v70, v70, v12
v_perm_b32 v91, v70, v70, v13
v_cvt_pk_bf16_f32 v72, v72, v73
v_perm_b32 v92, v72, v72, v10
v_perm_b32 v93, v72, v72, v11
v_perm_b32 v94, v72, v72, v12
v_perm_b32 v95, v72, v72, v13
v_cvt_pk_bf16_f32 v74, v74, v75
v_perm_b32 v96, v74, v74, v10
v_perm_b32 v97, v74, v74, v11
v_perm_b32 v98, v74, v74, v12
v_perm_b32 v99, v74, v74, v13
s_waitcnt lgkmcnt(0)
v_mfma_f32_16x16x32_bf16 v[36:39], v[180:183], v[84:87], 0
v_mfma_f32_16x16x32_bf16 v[40:43], v[192:195], v[84:87], 0
v_mfma_f32_16x16x32_bf16 v[44:47], v[186:189], v[88:91], 0
v_mfma_f32_16x16x32_bf16 v[48:51], v[192:195], v[88:91], 0
v_mfma_f32_16x16x32_bf16 v[52:55], v[182:185], v[92:95], 0
v_mfma_f32_16x16x32_bf16 v[56:59], v[194:197], v[92:95], 0
v_mfma_f32_16x16x32_bf16 v[60:63], v[188:191], v[96:99], 0
v_mfma_f32_16x16x32_bf16 v[64:67], v[194:197], v[96:99], 0
s_lshr_b32 s30, s26, 1
s_mul_i32 s30, s30, 2304
s_mul_i32 s31, s60, 18432
s_add_u32 s30, s30, s31
s_add_u32 s30, s30, 2490368
s_and_b32 s32, s26, 1
s_lshl_b32 s31, s32, 10
s_add_u32 s31, s31, s30
s_lshl_b32 s32, s32, 3
s_add_u32 s32, s32, s30
v_mov_b32 v6, 1073741824
v_cndmask_b32 v6, v6, v1, s[46:47]
v_add_u32 v7, 18432, v6
v_cvt_pk_bf16_f32 v164, v36, v37
v_cvt_pk_bf16_f32 v165, v38, v39
v_cvt_pk_bf16_f32 v166, v44, v45
v_cvt_pk_bf16_f32 v167, v46, v47
v_cvt_pk_bf16_f32 v168, v40, v41
v_cvt_pk_bf16_f32 v169, v50, v51
buffer_store_dwordx4 v[164:167], v1, s[8:11], s31 offen sc1
buffer_store_dwordx2 v[168:169], v6, s[8:11], s32 offen offset:2048 sc1
v_cvt_pk_bf16_f32 v172, v52, v53
v_cvt_pk_bf16_f32 v173, v54, v55
v_cvt_pk_bf16_f32 v174, v60, v61
v_cvt_pk_bf16_f32 v175, v62, v63
v_cvt_pk_bf16_f32 v176, v56, v57
v_cvt_pk_bf16_f32 v177, v66, v67
buffer_store_dwordx4 v[172:175], v127, s[8:11], s31 offen sc1
buffer_store_dwordx2 v[176:177], v7, s[8:11], s32 offen offset:2048 sc1
s_waitcnt lgkmcnt(0)
s_memrealtime s[58:59]
s_waitcnt lgkmcnt(0)
s_mov_b32 m0, s56
s_nop 0
v_writelane_b32 v5, s58, m0
s_add_u32 s56, s56, 1
s_waitcnt vmcnt(0)
s_barrier
s_cmp_eq_u32 s24, 0
s_cbranch_scc0 L_sig_1
v_lshlrev_b32 v6, 3, v1
s_lshl_b32 s31, s25, 11
s_lshl_b32 s32, s26, 2
s_add_u32 s31, s31, s32
v_add_u32 v6, s31, v6
s_mov_b64 exec, 0xffff
s_mov_b32 s30, 26476544
buffer_store_dword v4, v6, s[8:11], s30 offen sc1
s_mov_b64 exec, -1
L_sig_1:
s_mul_i32 s30, s28, 82944
s_add_u32 s30, s30, 2121728
s_mul_i32 s38, s24, 21504
s_add_u32 s39, s38, s30
s_add_u32 m0, s38, 0
s_nop 0
buffer_load_dwordx4 v1, s[4:7], s39 offen offset:0  lds
buffer_load_dwordx4 v1, s[4:7], s39 offen offset:1024  lds
buffer_load_dwordx4 v1, s[4:7], s39 offen offset:2048  lds
buffer_load_dwordx4 v1, s[4:7], s39 offen offset:3072  lds
s_add_u32 m0, m0, 4096
s_add_u32 s39, s39, 4096
buffer_load_dwordx4 v1, s[4:7], s39 offen offset:0  lds
buffer_load_dwordx4 v1, s[4:7], s39 offen offset:1024  lds
buffer_load_dwordx4 v1, s[4:7], s39 offen offset:2048  lds
buffer_load_dwordx4 v1, s[4:7], s39 offen offset:3072  lds
s_add_u32 m0, m0, 4096
s_add_u32 s39, s39, 4096
buffer_load_dwordx4 v1, s[4:7], s39 offen offset:0  lds
buffer_load_dwordx4 v1, s[4:7], s39 offen offset:1024  lds
buffer_load_dwordx4 v1, s[4:7], s39 offen offset:2048  lds
buffer_load_dwordx4 v1, s[4:7], s39 offen offset:3072  lds
s_add_u32 m0, m0, 4096
s_add_u32 s39, s39, 4096
buffer_load_dwordx4 v1, s[4:7], s39 offen offset:0  lds
buffer_load_dwordx4 v1, s[4:7], s39 offen offset:1024  lds
buffer_load_dwordx4 v1, s[4:7], s39 offen offset:2048  lds
buffer_load_dwordx4 v1, s[4:7], s39 offen offset:3072  lds
s_add_u32 m0, m0, 4096
s_add_u32 s39, s39, 4096
buffer_load_dwordx4 v1, s[4:7], s39 offen offset:0  lds
buffer_load_dwordx4 v1, s[4:7], s39 offen offset:1024  lds
buffer_load_dwordx4 v1, s[4:7], s39 offen offset:2048  lds
buffer_load_dwordx4 v1, s[4:7], s39 offen offset:3072  lds
s_add_u32 m0, m0, 4096
s_add_u32 s39, s39, 4096
buffer_load_dwordx4 v1, s[4:7], s39 offen offset:0  lds
s_cmp_eq_u32 s24, 1
s_cbranch_scc0 L_polled_3
s_lshl_b32 s30, s81, 7
s_add_u32 s30, s30, 26476544
v_lshrrev_b32 v6, 2, v1
s_mov_b32 s31, 0
s_mov_b64 exec, 0xffff
L_poll_2:
buffer_load_dword v7, v6, s[8:11], s30 offen sc1
s_add_u32 s31, s31, 1
s_waitcnt vmcnt(0)
v_cmp_ne_u32 vcc, 1, v7
s_cmp_gt_u32 s31, 200000
s_cbranch_scc1 L_polled_3
s_cbranch_vccnz L_poll_2
L_polled_3:
s_mov_b64 exec, -1
s_waitcnt vmcnt(0)
s_barrier
s_waitcnt lgkmcnt(0)
s_memrealtime s[58:59]
s_waitcnt lgkmcnt(0)
s_mov_b32 m0, s56
s_nop 0
v_writelane_b32 v5, s58, m0
s_add_u32 s56, s56, 1
s_lshl_b32 s30, s27, 2
s_add_u32 s30, s30, s24
s_mul_i32 s30, s30, 18432
s_add_u32 s30, s30, 2490368
buffer_load_dwordx4 a[0:3], v1, s[8:11], s30 offen offset:0 sc1
buffer_load_dwordx4 a[4:7], v1, s[8:11], s30 offen offset:1024 sc1
buffer_load_dwordx4 a[8:11], v1, s[8:11], s30 offen offset:2048 sc1
buffer_load_dwordx4 a[12:15], v1, s[8:11], s30 offen offset:3072 sc1
s_add_u32 s30, s30, 4096
buffer_load_dwordx4 a[16:19], v1, s[8:11], s30 offen offset:0 sc1
buffer_load_dwordx4 a[20:23], v1, s[8:11], s30 offen offset:1024 sc1
buffer_load_dwordx4 a[24:27], v1, s[8:11], s30 offen offset:2048 sc1
buffer_load_dwordx4 a[28:31], v1, s[8:11], s30 offen offset:3072 sc1
s_add_u32 s30, s30, 4096
buffer_load_dwordx4 a[32:35], v1, s[8:11], s30 offen offset:0 sc1
buffer_load_dwordx4 a[36:39], v1, s[8:11], s30 offen offset:1024 sc1
buffer_load_dwordx4 a[40:43], v1, s[8:11], s30 offen offset:2048 sc1
buffer_load_dwordx4 a[44:47], v1, s[8:11], s30 offen offset:3072 sc1
s_add_u32 s30, s30, 4096
buffer_load_dwordx4 a[48:51], v1, s[8:11], s30 offen offset:0 sc1
buffer_load_dwordx4 a[52:55], v1, s[8:11], s30 offen offset:1024 sc1
buffer_load_dwordx4 a[56:59], v1, s[8:11], s30 offen offset:2048 sc1
buffer_load_dwordx4 a[60:63], v1, s[8:11], s30 offen offset:3072 sc1
s_add_u32 s30, s30, 4096
buffer_load_dwordx4 a[64:67], v1, s[8:11], s30 offen offset:0 sc1
buffer_load_dwordx4 a[68:71], v1, s[8:11], s30 offen offset:1024 sc1
v_and_b32 v108, 7, v2
v_lshlrev_b32 v108, 4, v108
v_lshl_add_u32 v108, v3, 7, v108
v_add_u32 v108, 4096, v108
v_add_u32 v109, 41472, v1
v_add_u32 v110, 41472, v108
ds_read_b128 a[72:75], v1 offset:0
ds_read_b128 a[76:79], v1 offset:1024
ds_read_b128 a[80:83], v1 offset:2048
ds_read_b128 a[84:87], v1 offset:3072
ds_read_b128 a[88:91], v108 offset:0
ds_read_b128 a[92:95], v1 offset:4608
ds_read_b128 a[96:99], v1 offset:5632
ds_read_b128 a[100:103], v1 offset:6656
ds_read_b128 a[104:107], v1 offset:7680
ds_read_b128 a[108:111], v108 offset:4608
s_waitcnt vmcnt(17)
s_waitcnt lgkmcnt(5)
v_mfma_f32_16x16x32_bf16 v[16:19], a[72:75], a[0:3], v[16:19]
ds_read_b128 a[112:115], v1 offset:9216
v_mfma_f32_16x16x32_bf16 v[20:23], a[76:79], a[0:3], v[20:23]
ds_read_b128 a[116:119], v1 offset:10240
v_mfma_f32_16x16x32_bf16 v[24:27], a[80:83], a[0:3], v[24:27]
ds_read_b128 a[120:123], v1 offset:11264
v_mfma_f32_16x16x32_bf16 v[28:31], a[84:87], a[0:3], v[28:31]
ds_read_b128 a[124:127], v1 offset:12288
v_mfma_f32_16x16x32_bf16 v[32:35], a[88:91], a[0:3], v[32:35]
ds_read_b128 a[128:131], v108 offset:9216
s_waitcnt vmcnt(16)
s_waitcnt lgkmcnt(5)
v_mfma_f32_16x16x32_bf16 v[16:19], a[92:95], a[4:7], v[16:19]
ds_read_b128 a[72:75], v1 offset:13824
v_mfma_f32_16x16x32_bf16 v[20:23], a[96:99], a[4:7], v[20:23]
ds_read_b128 a[76:79], v1 offset:14848
v_mfma_f32_16x16x32_bf16 v[24:27], a[100:103], a[4:7], v[24:27]
ds_read_b128 a[80:83], v1 offset:15872
v_mfma_f32_16x16x32_bf16 v[28:31], a[104:107], a[4:7], v[28:31]
ds_read_b128 a[84:87], v1 offset:16896
v_mfma_f32_16x16x32_bf16 v[32:35], a[108:111], a[4:7], v[32:35]
ds_read_b128 a[88:91], v108 offset:13824
s_waitcnt vmcnt(15)
s_waitcnt lgkmcnt(5)
v_mfma_f32_16x16x32_bf16 v[16:19], a[112:115], a[8:11], v[16:19]
ds_read_b128 a[92:95], v1 offset:18432
v_mfma_f32_16x16x32_bf16 v[20:23], a[116:119], a[8:11], v[20:23]
ds_read_b128 a[96:99], v1 offset:19456
v_mfma_f32_16x16x32_bf16 v[24:27], a[120:123], a[8:11], v[24:27]
ds_read_b128 a[100:103], v1 offset:20480
v_mfma_f32_16x16x32_bf16 v[28:31], a[124:127], a[8:11], v[28:31]
ds_read_b128 a[104:107], v1 offset:21504
v_mfma_f32_16x16x32_bf16 v[32:35], a[128:131], a[8:11], v[32:35]
ds_read_b128 a[108:111], v108 offset:18432
s_waitcnt vmcnt(14)
s_waitcnt lgkmcnt(5)
v_mfma_f32_16x16x32_bf16 v[16:19], a[72:75], a[12:15], v[16:19]
ds_read_b128 a[112:115], v1 offset:23040
v_mfma_f32_16x16x32_bf16 v[20:23], a[76:79], a[12:15], v[20:23]
ds_read_b128 a[116:119], v1 offset:24064
v_mfma_f32_16x16x32_bf16 v[24:27], a[80:83], a[12:15], v[24:27]
ds_read_b128 a[120:123], v1 offset:25088
v_mfma_f32_16x16x32_bf16 v[28:31], a[84:87], a[12:15], v[28:31]
ds_read_b128 a[124:127], v1 offset:26112
v_mfma_f32_16x16x32_bf16 v[32:35], a[88:91], a[12:15], v[32:35]
ds_read_b128 a[128:131], v108 offset:23040
s_waitcnt vmcnt(13)
s_waitcnt lgkmcnt(5)
v_mfma_f32_16x16x32_bf16 v[16:19], a[92:95], a[16:19], v[16:19]
ds_read_b128 a[72:75], v1 offset:27648
v_mfma_f32_16x16x32_bf16 v[20:23], a[96:99], a[16:19], v[20:23]
ds_read_b128 a[76:79], v1 offset:28672
v_mfma_f32_16x16x32_bf16 v[24:27], a[100:103], a[16:19], v[24:27]
ds_read_b128 a[80:83], v1 offset:29696
v_mfma_f32_16x16x32_bf16 v[28:31], a[104:107], a[16:19], v[28:31]
ds_read_b128 a[84:87], v1 offset:30720
v_mfma_f32_16x16x32_bf16 v[32:35], a[108:111], a[16:19], v[32:35]
ds_read_b128 a[88:91], v108 offset:27648
s_waitcnt vmcnt(12)
s_waitcnt lgkmcnt(5)
v_mfma_f32_16x16x32_bf16 v[16:19], a[112:115], a[20:23], v[16:19]
ds_read_b128 a[92:95], v1 offset:32256
v_mfma_f32_16x16x32_bf16 v[20:23], a[116:119], a[20:23], v[20:23]
ds_read_b128 a[96:99], v1 offset:33280
v_mfma_f32_16x16x32_bf16 v[24:27], a[120:123], a[20:23], v[24:27]
ds_read_b128 a[100:103], v1 offset:34304
v_mfma_f32_16x16x32_bf16 v[28:31], a[124:127], a[20:23], v[28:31]
ds_read_b128 a[104:107], v1 offset:35328
v_mfma_f32_16x16x32_bf16 v[32:35], a[128:131], a[20:23], v[32:35]
ds_read_b128 a[108:111], v108 offset:32256
s_waitcnt vmcnt(11)
s_waitcnt lgkmcnt(5)
v_mfma_f32_16x16x32_bf16 v[16:19], a[72:75], a[24:27], v[16:19]
ds_read_b128 a[112:115], v1 offset:36864
v_mfma_f32_16x16x32_bf16 v[20:23], a[76:79], a[24:27], v[20:23]
ds_read_b128 a[116:119], v1 offset:37888
v_mfma_f32_16x16x32_bf16 v[24:27], a[80:83], a[24:27], v[24:27]
ds_read_b128 a[120:123], v1 offset:38912
v_mfma_f32_16x16x32_bf16 v[28:31], a[84:87], a[24:27], v[28:31]
ds_read_b128 a[124:127], v1 offset:39936
v_mfma_f32_16x16x32_bf16 v[32:35], a[88:91], a[24:27], v[32:35]
ds_read_b128 a[128:131], v108 offset:36864
s_waitcnt vmcnt(10)
s_waitcnt lgkmcnt(5)
v_mfma_f32_16x16x32_bf16 v[16:19], a[92:95], a[28:31], v[16:19]
ds_read_b128 a[72:75], v109 offset:0
v_mfma_f32_16x16x32_bf16 v[20:23], a[96:99], a[28:31], v[20:23]
ds_read_b128 a[76:79], v109 offset:1024
v_mfma_f32_16x16x32_bf16 v[24:27], a[100:103], a[28:31], v[24:27]
ds_read_b128 a[80:83], v109 offset:2048
v_mfma_f32_16x16x32_bf16 v[28:31], a[104:107], a[28:31], v[28:31]
ds_read_b128 a[84:87], v109 offset:3072
v_mfma_f32_16x16x32_bf16 v[32:35], a[108:111], a[28:31], v[32:35]
ds_read_b128 a[88:91], v110 offset:0
s_waitcnt vmcnt(9)
s_waitcnt lgkmcnt(5)
v_mfma_f32_16x16x32_bf16 v[16:19], a[112:115], a[32:35], v[16:19]
ds_read_b128 a[92:95], v109 offset:4608
v_mfma_f32_16x16x32_bf16 v[20:23], a[116:119], a[32:35], v[20:23]
ds_read_b128 a[96:99], v109 offset:5632
v_mfma_f32_16x16x32_bf16 v[24:27], a[120:123], a[32:35], v[24:27]
ds_read_b128 a[100:103], v109 offset:6656
v_mfma_f32_16x16x32_bf16 v[28:31], a[124:127], a[32:35], v[28:31]
ds_read_b128 a[104:107], v109 offset:7680
v_mfma_f32_16x16x32_bf16 v[32:35], a[128:131], a[32:35], v[32:35]
ds_read_b128 a[108:111], v110 offset:4608
s_waitcnt vmcnt(8)
s_waitcnt lgkmcnt(5)
v_mfma_f32_16x16x32_bf16 v[16:19], a[72:75], a[36:39], v[16:19]
ds_read_b128 a[112:115], v109 offset:9216
v_mfma_f32_16x16x32_bf16 v[20:23], a[76:79], a[36:39], v[20:23]
ds_read_b128 a[116:119], v109 offset:10240
v_mfma_f32_16x16x32_bf16 v[24:27], a[80:83], a[36:39], v[24:27]
ds_read_b128 a[120:123], v109 offset:11264
v_mfma_f32_16x16x32_bf16 v[28:31], a[84:87], a[36:39], v[28:31]
ds_read_b128 a[124:127], v109 offset:12288
v_mfma_f32_16x16x32_bf16 v[32:35], a[88:91], a[36:39], v[32:35]
ds_read_b128 a[128:131], v110 offset:9216
s_waitcnt vmcnt(7)
s_waitcnt lgkmcnt(5)
v_mfma_f32_16x16x32_bf16 v[16:19], a[92:95], a[40:43], v[16:19]
ds_read_b128 a[72:75], v109 offset:13824
v_mfma_f32_16x16x32_bf16 v[20:23], a[96:99], a[40:43], v[20:23]
ds_read_b128 a[76:79], v109 offset:14848
v_mfma_f32_16x16x32_bf16 v[24:27], a[100:103], a[40:43], v[24:27]
ds_read_b128 a[80:83], v109 offset:15872
v_mfma_f32_16x16x32_bf16 v[28:31], a[104:107], a[40:43], v[28:31]
ds_read_b128 a[84:87], v109 offset:16896
v_mfma_f32_16x16x32_bf16 v[32:35], a[108:111], a[40:43], v[32:35]
ds_read_b128 a[88:91], v110 offset:13824
s_waitcnt vmcnt(6)
s_waitcnt lgkmcnt(5)
v_mfma_f32_16x16x32_bf16 v[16:19], a[112:115], a[44:47], v[16:19]
ds_read_b128 a[92:95], v109 offset:18432
v_mfma_f32_16x16x32_bf16 v[20:23], a[116:119], a[44:47], v[20:23]
ds_read_b128 a[96:99], v109 offset:19456
v_mfma_f32_16x16x32_bf16 v[24:27], a[120:123], a[44:47], v[24:27]
ds_read_b128 a[100:103], v109 offset:20480
v_mfma_f32_16x16x32_bf16 v[28:31], a[124:127], a[44:47], v[28:31]
ds_read_b128 a[104:107], v109 offset:21504
v_mfma_f32_16x16x32_bf16 v[32:35], a[128:131], a[44:47], v[32:35]
ds_read_b128 a[108:111], v110 offset:18432
s_waitcnt vmcnt(5)
s_waitcnt lgkmcnt(5)
v_mfma_f32_16x16x32_bf16 v[16:19], a[72:75], a[48:51], v[16:19]
ds_read_b128 a[112:115], v109 offset:23040
v_mfma_f32_16x16x32_bf16 v[20:23], a[76:79], a[48:51], v[20:23]
ds_read_b128 a[116:119], v109 offset:24064
v_mfma_f32_16x16x32_bf16 v[24:27], a[80:83], a[48:51], v[24:27]
ds_read_b128 a[120:123], v109 offset:25088
v_mfma_f32_16x16x32_bf16 v[28:31], a[84:87], a[48:51], v[28:31]
ds_read_b128 a[124:127], v109 offset:26112
v_mfma_f32_16x16x32_bf16 v[32:35], a[88:91], a[48:51], v[32:35]
ds_read_b128 a[128:131], v110 offset:23040
s_waitcnt vmcnt(4)
s_waitcnt lgkmcnt(5)
v_mfma_f32_16x16x32_bf16 v[16:19], a[92:95], a[52:55], v[16:19]
ds_read_b128 a[72:75], v109 offset:27648
v_mfma_f32_16x16x32_bf16 v[20:23], a[96:99], a[52:55], v[20:23]
ds_read_b128 a[76:79], v109 offset:28672
v_mfma_f32_16x16x32_bf16 v[24:27], a[100:103], a[52:55], v[24:27]
ds_read_b128 a[80:83], v109 offset:29696
v_mfma_f32_16x16x32_bf16 v[28:31], a[104:107], a[52:55], v[28:31]
ds_read_b128 a[84:87], v109 offset:30720
v_mfma_f32_16x16x32_bf16 v[32:35], a[108:111], a[52:55], v[32:35]
ds_read_b128 a[88:91], v110 offset:27648
s_waitcnt vmcnt(3)
s_waitcnt lgkmcnt(5)
v_mfma_f32_16x16x32_bf16 v[16:19], a[112:115], a[56:59], v[16:19]
ds_read_b128 a[92:95], v109 offset:32256
v_mfma_f32_16x16x32_bf16 v[20:23], a[116:119], a[56:59], v[20:23]
ds_read_b128 a[96:99], v109 offset:33280
v_mfma_f32_16x16x32_bf16 v[24:27], a[120:123], a[56:59], v[24:27]
ds_read_b128 a[100:103], v109 offset:34304
v_mfma_f32_16x16x32_bf16 v[28:31], a[124:127], a[56:59], v[28:31]
ds_read_b128 a[104:107], v109 offset:35328
v_mfma_f32_16x16x32_bf16 v[32:35], a[128:131], a[56:59], v[32:35]
ds_read_b128 a[108:111], v110 offset:32256
s_waitcnt vmcnt(2)
s_waitcnt lgkmcnt(5)
v_mfma_f32_16x16x32_bf16 v[16:19], a[72:75], a[60:63], v[16:19]
ds_read_b128 a[112:115], v109 offset:36864
v_mfma_f32_16x16x32_bf16 v[20:23], a[76:79], a[60:63], v[20:23]
ds_read_b128 a[116:119], v109 offset:37888
v_mfma_f32_16x16x32_bf16 v[24:27], a[80:83], a[60:63], v[24:27]
ds_read_b128 a[120:123], v109 offset:38912
v_mfma_f32_16x16x32_bf16 v[28:31], a[84:87], a[60:63], v[28:31]
ds_read_b128 a[124:127], v109 offset:39936
v_mfma_f32_16x16x32_bf16 v[32:35], a[88:91], a[60:63], v[32:35]
ds_read_b128 a[128:131], v110 offset:36864
s_waitcnt vmcnt(1)
s_waitcnt lgkmcnt(5)
v_mfma_f32_16x16x32_bf16 v[16:19], a[92:95], a[64:67], v[16:19]
v_mfma_f32_16x16x32_bf16 v[20:23], a[96:99], a[64:67], v[20:23]
v_mfma_f32_16x16x32_bf16 v[24:27], a[100:103], a[64:67], v[24:27]
v_mfma_f32_16x16x32_bf16 v[28:31], a[104:107], a[64:67], v[28:31]
v_mfma_f32_16x16x32_bf16 v[32:35], a[108:111], a[64:67], v[32:35]
s_waitcnt vmcnt(0)
s_waitcnt lgkmcnt(0)
v_mfma_f32_16x16x32_bf16 v[16:19], a[112:115], a[68:71], v[16:19]
v_mfma_f32_16x16x32_bf16 v[20:23], a[116:119], a[68:71], v[20:23]
v_mfma_f32_16x16x32_bf16 v[24:27], a[120:123], a[68:71], v[24:27]
v_mfma_f32_16x16x32_bf16 v[28:31], a[124:127], a[68:71], v[28:31]
v_mfma_f32_16x16x32_bf16 v[32:35], a[128:131], a[68:71], v[32:35]
s_waitcnt lgkmcnt(0)
s_memrealtime s[58:59]
s_waitcnt lgkmcnt(0)
s_mov_b32 m0, s56
s_nop 0
v_writelane_b32 v5, s58, m0
s_add_u32 s56, s56, 1
s_lshl_b32 s30, s27, 2
s_add_u32 s30, s30, s24
v_mov_b32 v126, 1073741824
s_lshr_b32 s31, s30, 1
s_mul_i32 s31, s31, 36864
s_and_b32 s32, s30, 1
s_lshl_b32 s32, s32, 8
s_add_u32 s31, s31, s32
s_mul_i32 s32, s28, 4608
s_add_u32 s31, s31, s32
s_add_u32 s31, s31, 4849664
v_lshlrev_b32 v128, 4, v2
v_lshl_add_u32 v128, v3, 9, v128
v_add_u32 v129, 4096, v128
v_cndmask_b32 v129, v126, v129, s[46:47]
v_cvt_pk_bf16_f32 v112, v16, v17
v_cvt_pk_bf16_f32 v113, v18, v19
v_cvt_pk_bf16_f32 v114, v20, v21
v_cvt_pk_bf16_f32 v115, v22, v23
v_cvt_pk_bf16_f32 v116, v24, v25
v_cvt_pk_bf16_f32 v117, v26, v27
v_cvt_pk_bf16_f32 v118, v28, v29
v_cvt_pk_bf16_f32 v119, v30, v31
v_cvt_pk_bf16_f32 v120, v32, v33
v_cvt_pk_bf16_f32 v121, v34, v35
buffer_store_dwordx4 v[112:115], v128, s[8:11], s31 offen sc1
buffer_store_dwordx4 v[116:119], v128, s[8:11], s31 offen offset:2048 sc1
v_permlane16_swap_b32 v120, v122
v_permlane16_swap_b32 v121, v123
buffer_store_dwordx4 v[120:123], v129, s[8:11], s31 offen sc1
v_add_f32 v124, v32, v33
v_mul_f32 v125, v32, v32
v_fmac_f32 v125, v33, v33
v_add_f32 v124, v124, v34
v_fmac_f32 v125, v34, v34
v_add_f32 v124, v124, v35
v_fmac_f32 v125, v35, v35
v_cndmask_b32 v124, 0, v124, s[50:51]
v_cndmask_b32 v125, 0, v125, s[50:51]
v_add_f32 v124, v124, v16
v_fmac_f32 v125, v16, v16
v_add_f32 v124, v124, v17
v_fmac_f32 v125, v17, v17
v_add_f32 v124, v124, v18
v_fmac_f32 v125, v18, v18
v_add_f32 v124, v124, v19
v_fmac_f32 v125, v19, v19
v_add_f32 v124, v124, v20
v_fmac_f32 v125, v20, v20
v_add_f32 v124, v124, v21
v_fmac_f32 v125, v21, v21
v_add_f32 v124, v124, v22
v_fmac_f32 v125, v22, v22
v_add_f32 v124, v124, v23
v_fmac_f32 v125, v23, v23
v_add_f32 v124, v124, v24
v_fmac_f32 v125, v24, v24
v_add_f32 v124, v124, v25
v_fmac_f32 v125, v25, v25
v_add_f32 v124, v124, v26
v_fmac_f32 v125, v26, v26
v_add_f32 v124, v124, v27
v_fmac_f32 v125, v27, v27
v_add_f32 v124, v124, v28
v_fmac_f32 v125, v28, v28
v_add_f32 v124, v124, v29
v_fmac_f32 v125, v29, v29
v_add_f32 v124, v124, v30
v_fmac_f32 v125, v30, v30
v_add_f32 v124, v124, v31
v_fmac_f32 v125, v31, v31
s_lshl_b32 s31, s30, 7
s_lshl_b32 s32, s28, 14
v_permlane32_swap_b32 v124, v125
v_add_f32 v124, v124, v125
v_mov_b32 v125, v124
s_add_u32 s31, s31, s32
s_add_u32 s31, s31, 7208960
v_permlane16_swap_b32 v124, v125
v_add_f32 v124, v124, v125
v_mov_b32 v125, v124
v_lshlrev_b32 v127, 3, v2
v_cndmask_b32 v126, v126, v127, s[46:47]
v_permlane32_swap_b32 v124, v125
buffer_store_dwordx2 v[124:125], v126, s[8:11], s31 offen sc1
s_waitcnt vmcnt(0)
s_barrier
s_cmp_eq_u32 s24, 0
s_cbranch_scc0 L_sig_4
v_lshlrev_b32 v6, 3, v1
s_lshr_b32 s31, s81, 4
s_lshl_b32 s31, s31, 11
s_and_b32 s32, s81, 15
s_lshl_b32 s32, s32, 2
s_add_u32 s31, s31, s32
v_add_u32 v6, s31, v6
s_mov_b64 exec, 0xffff
s_mov_b32 s30, 26509312
buffer_store_dword v4, v6, s[8:11], s30 offen sc1
s_mov_b64 exec, -1
L_sig_4:
s_mul_i32 s62, s26, 340992
s_add_u32 s62, s62, 2785280
s_mul_i32 s38, s24, 9216
s_add_u32 s39, s38, s62
s_add_u32 s39, s39, 0
s_add_u32 m0, s38, 0
s_nop 0
buffer_load_dwordx4 v1, s[4:7], s39 offen offset:0 lds
buffer_load_dwordx4 v1, s[4:7], s39 offen offset:1024 lds
buffer_load_dwordx4 v1, s[4:7], s39 offen offset:2048 lds
buffer_load_dwordx4 v1, s[4:7], s39 offen offset:3072 lds
s_add_u32 m0, m0, 4096
s_add_u32 s39, s39, 4096
buffer_load_dwordx4 v1, s[4:7], s39 offen offset:0 lds
buffer_load_dwordx4 v1, s[4:7], s39 offen offset:1024 lds
buffer_load_dwordx4 v1, s[4:7], s39 offen offset:2048 lds
buffer_load_dwordx4 v1, s[4:7], s39 offen offset:3072 lds
s_add_u32 m0, m0, 4096
s_add_u32 s39, s39, 4096
buffer_load_dwordx4 v1, s[4:7], s39 offen offset:0 lds
s_lshl_b32 s38, s24, 8
s_add_u32 s39, s38, s62
s_add_u32 s39, s39, 36864
s_add_u32 m0, s38, 36864
s_mov_b64 exec, 0xffff
buffer_load_dwordx4 v1, s[4:7], s39 offen lds
s_mov_b64 exec, -1
s_mul_i32 s38, s24, 9216
s_add_u32 s39, s38, s62
s_add_u32 s39, s39, 37888
s_add_u32 m0, s38, 37888
s_nop 0
buffer_load_dwordx4 v1, s[4:7], s39 offen offset:0 lds
buffer_load_dwordx4 v1, s[4:7], s39 offen offset:1024 lds
buffer_load_dwordx4 v1, s[4:7], s39 offen offset:2048 lds
buffer_load_dwordx4 v1, s[4:7], s39 offen offset:3072 lds
s_add_u32 m0, m0, 4096
s_add_u32 s39, s39, 4096
buffer_load_dwordx4 v1, s[4:7], s39 offen offset:0 lds
buffer_load_dwordx4 v1, s[4:7], s39 offen offset:1024 lds
buffer_load_dwordx4 v1, s[4:7], s39 offen offset:2048 lds
buffer_load_dwordx4 v1, s[4:7], s39 offen offset:3072 lds
s_add_u32 m0, m0, 4096
s_add_u32 s39, s39, 4096
buffer_load_dwordx4 v1, s[4:7], s39 offen offset:0 lds
s_lshl_b32 s38, s24, 8
s_add_u32 s39, s38, s62
s_add_u32 s39, s39, 74752
s_add_u32 m0, s38, 74752
s_mov_b64 exec, 0xffff
buffer_load_dwordx4 v1, s[4:7], s39 offen lds
s_mov_b64 exec, -1
s_mul_i32 s38, s24, 9216
s_add_u32 s39, s38, s62
s_add_u32 s39, s39, 75776
s_add_u32 m0, s38, 75776
s_nop 0
buffer_load_dwordx4 v1, s[4:7], s39 offen offset:0 lds
buffer_load_dwordx4 v1, s[4:7], s39 offen offset:1024 lds
buffer_load_dwordx4 v1, s[4:7], s39 offen offset:2048 lds
buffer_load_dwordx4 v1, s[4:7], s39 offen offset:3072 lds
s_add_u32 m0, m0, 4096
s_add_u32 s39, s39, 4096
buffer_load_dwordx4 v1, s[4:7], s39 offen offset:0 lds
buffer_load_dwordx4 v1, s[4:7], s39 offen offset:1024 lds
buffer_load_dwordx4 v1, s[4:7], s39 offen offset:2048 lds
buffer_load_dwordx4 v1, s[4:7], s39 offen offset:3072 lds
s_add_u32 m0, m0, 4096
s_add_u32 s39, s39, 4096
buffer_load_dwordx4 v1, s[4:7], s39 offen offset:0 lds
s_lshl_b32 s38, s24, 8
s_add_u32 s39, s38, s62
s_add_u32 s39, s39, 112640
s_add_u32 m0, s38, 112640
s_mov_b64 exec, 0xffff
buffer_load_dwordx4 v1, s[4:7], s39 offen lds
s_mov_b64 exec, -1
s_mul_i32 s38, s24, 9216
s_add_u32 s39, s38, s62
s_add_u32 s39, s39, 113664
s_add_u32 m0, s38, 113664
s_nop 0
buffer_load_dwordx4 v1, s[4:7], s39 offen offset:0 lds
buffer_load_dwordx4 v1, s[4:7], s39 offen offset:1024 lds
buffer_load_dwordx4 v1, s[4:7], s39 offen offset:2048 lds
buffer_load_dwordx4 v1, s[4:7], s39 offen offset:3072 lds
s_add_u32 m0, m0, 4096
s_add_u32 s39, s39, 4096
buffer_load_dwordx4 v1, s[4:7], s39 offen offset:0 lds
buffer_load_dwordx4 v1, s[4:7], s39 offen offset:1024 lds
buffer_load_dwordx4 v1, s[4:7], s39 offen offset:2048 lds
buffer_load_dwordx4 v1, s[4:7], s39 offen offset:3072 lds
s_add_u32 m0, m0, 4096
s_add_u32 s39, s39, 4096
buffer_load_dwordx4 v1, s[4:7], s39 offen offset:0 lds
s_lshl_b32 s38, s24, 8
s_add_u32 s39, s38, s62
s_add_u32 s39, s39, 150528
s_add_u32 m0, s38, 150528
s_mov_b64 exec, 0xffff
buffer_load_dwordx4 v1, s[4:7], s39 offen lds
s_mov_b64 exec, -1
s_cmp_eq_u32 s24, 1
s_cbranch_scc0 L_polled_6
s_lshl_b32 s30, s80, 7
s_add_u32 s30, s30, 26509312
v_lshrrev_b32 v6, 2, v1
s_mov_b32 s31, 0
s_mov_b64 exec, 0xffff
L_poll_5:
buffer_load_dword v7, v6, s[8:11], s30 offen sc1
s_add_u32 s31, s31, 1
s_waitcnt vmcnt(0)
v_cmp_ne_u32 vcc, 1, v7
s_cmp_gt_u32 s31, 200000
s_cbranch_scc1 L_polled_6
s_cbranch_vccnz L_poll_5
L_polled_6:
s_mov_b64 exec, -1
s_waitcnt vmcnt(0)
s_barrier
s_waitcnt lgkmcnt(0)
s_memrealtime s[58:59]
s_waitcnt lgkmcnt(0)
s_mov_b32 m0, s56
s_nop 0
v_writelane_b32 v5, s58, m0
s_add_u32 s56, s56, 1
s_lshl_b32 s60, s25, 2
s_add_u32 s60, s60, s24
v_lshrrev_b32 v6, 1, v1
v_and_b32 v6, 0xf8, v6
v_lshrrev_b32 v7, 1, v3
v_lshl_add_u32 v6, v7, 16, v6
s_lshl_b32 s30, s60, 8
s_add_u32 s30, s30, 7208960
buffer_load_dwordx2 v[212:213], v6, s[8:11], s30 offen sc1
s_add_u32 s30, s30, 16384
buffer_load_dwordx2 v[214:215], v6, s[8:11], s30 offen sc1
s_add_u32 s30, s30, 16384
buffer_load_dwordx2 v[216:217], v6, s[8:11], s30 offen sc1
s_add_u32 s30, s30, 16384
buffer_load_dwordx2 v[218:219], v6, s[8:11], s30 offen sc1
s_add_u32 s30, s30, 16384
s_mul_i32 s30, s60, 36864
s_add_u32 s30, s30, 4849664
buffer_load_dwordx4 a[0:3], v1, s[8:11], s30 offen offset:0 sc1
buffer_load_dwordx4 a[4:7], v1, s[8:11], s30 offen offset:1024 sc1
buffer_load_dwordx4 a[8:11], v1, s[8:11], s30 offen offset:2048 sc1
buffer_load_dwordx4 a[12:15], v1, s[8:11], s30 offen offset:3072 sc1
s_add_u32 s30, s30, 4096
buffer_load_dwordx4 a[16:19], v1, s[8:11], s30 offen offset:0 sc1
buffer_load_dwordx4 a[20:23], v1, s[8:11], s30 offen offset:1024 sc1
buffer_load_dwordx4 a[24:27], v1, s[8:11], s30 offen offset:2048 sc1
buffer_load_dwordx4 a[28:31], v1, s[8:11], s30 offen offset:3072 sc1
s_add_u32 s30, s30, 4096
buffer_load_dwordx4 a[32:35], v1, s[8:11], s30 offen offset:0 sc1
buffer_load_dwordx4 a[36:39], v1, s[8:11], s30 offen offset:1024 sc1
buffer_load_dwordx4 a[40:43], v1, s[8:11], s30 offen offset:2048 sc1
buffer_load_dwordx4 a[44:47], v1, s[8:11], s30 offen offset:3072 sc1
s_add_u32 s30, s30, 4096
buffer_load_dwordx4 a[48:51], v1, s[8:11], s30 offen offset:0 sc1
buffer_load_dwordx4 a[52:55], v1, s[8:11], s30 offen offset:1024 sc1
buffer_load_dwordx4 a[56:59], v1, s[8:11], s30 offen offset:2048 sc1
buffer_load_dwordx4 a[60:63], v1, s[8:11], s30 offen offset:3072 sc1
s_add_u32 s30, s30, 4096
buffer_load_dwordx4 a[64:67], v1, s[8:11], s30 offen offset:0 sc1
buffer_load_dwordx4 a[68:71], v1, s[8:11], s30 offen offset:1024 sc1
buffer_load_dwordx4 a[72:75], v1, s[8:11], s30 offen offset:2048 sc1
buffer_load_dwordx4 a[76:79], v1, s[8:11], s30 offen offset:3072 sc1
s_add_u32 s30, s30, 4096
buffer_load_dwordx4 a[80:83], v1, s[8:11], s30 offen offset:0 sc1
buffer_load_dwordx4 a[84:87], v1, s[8:11], s30 offen offset:1024 sc1
buffer_load_dwordx4 a[88:91], v1, s[8:11], s30 offen offset:2048 sc1
buffer_load_dwordx4 a[92:95], v1, s[8:11], s30 offen offset:3072 sc1
s_add_u32 s30, s30, 4096
buffer_load_dwordx4 a[96:99], v1, s[8:11], s30 offen offset:0 sc1
buffer_load_dwordx4 a[100:103], v1, s[8:11], s30 offen offset:1024 sc1
buffer_load_dwordx4 a[104:107], v1, s[8:11], s30 offen offset:2048 sc1
buffer_load_dwordx4 a[108:111], v1, s[8:11], s30 offen offset:3072 sc1
s_add_u32 s30, s30, 4096
buffer_load_dwordx4 a[112:115], v1, s[8:11], s30 offen offset:0 sc1
buffer_load_dwordx4 a[116:119], v1, s[8:11], s30 offen offset:1024 sc1
buffer_load_dwordx4 a[120:123], v1, s[8:11], s30 offen offset:2048 sc1
buffer_load_dwordx4 a[124:127], v1, s[8:11], s30 offen offset:3072 sc1
s_add_u32 s30, s30, 4096
buffer_load_dwordx4 a[128:131], v1, s[8:11], s30 offen offset:0 sc1
buffer_load_dwordx4 a[132:135], v1, s[8:11], s30 offen offset:1024 sc1
buffer_load_dwordx4 a[136:139], v1, s[8:11], s30 offen offset:2048 sc1
buffer_load_dwordx4 a[140:143], v1, s[8:11], s30 offen offset:3072 sc1
v_add_u32 v242, 0, v1
v_add_u32 v243, 37888, v1
v_add_u32 v244, 75776, v1
v_add_u32 v245, 113664, v1
ds_read_b128 a[144:147], v242 offset:0
ds_read_b128 a[148:151], v242 offset:1024
ds_read_b128 a[152:155], v242 offset:2048
ds_read_b128 a[156:159], v242 offset:3072
ds_read_b128 a[160:163], v242 offset:4096
s_waitcnt vmcnt(35)
s_waitcnt lgkmcnt(3)
v_mfma_f32_32x32x16_bf16 v[108:123], a[144:147], a[0:3], 0
ds_read_b128 a[164:167], v242 offset:5120
s_waitcnt vmcnt(34)
v_mfma_f32_32x32x16_bf16 v[108:123], a[148:151], a[4:7], v[108:123]
ds_read_b128 a[144:147], v242 offset:6144
s_waitcnt vmcnt(33)
s_waitcnt lgkmcnt(3)
v_mfma_f32_32x32x16_bf16 v[108:123], a[152:155], a[8:11], v[108:123]
ds_read_b128 a[148:151], v242 offset:7168
s_waitcnt vmcnt(32)
v_mfma_f32_32x32x16_bf16 v[108:123], a[156:159], a[12:15], v[108:123]
ds_read_b128 a[152:155], v242 offset:8192
s_waitcnt vmcnt(31)
s_waitcnt lgkmcnt(3)
v_mfma_f32_32x32x16_bf16 v[108:123], a[160:163], a[16:19], v[108:123]
ds_read_b128 a[156:159], v242 offset:9216
v_add_f32 v228, v212, v214
v_add_f32 v229, v213, v215
v_add_f32 v228, v228, v216
v_add_f32 v229, v229, v217
v_add_f32 v228, v228, v218
v_add_f32 v229, v229, v219
s_waitcnt vmcnt(30)
v_mfma_f32_32x32x16_bf16 v[108:123], a[164:167], a[20:23], v[108:123]
ds_read_b128 a[160:163], v242 offset:10240
v_mov_b32 v230, v228
s_waitcnt vmcnt(29)
s_waitcnt lgkmcnt(3)
v_mfma_f32_32x32x16_bf16 v[108:123], a[144:147], a[24:27], v[108:123]
ds_read_b128 a[164:167], v242 offset:11264
v_mov_b32 v231, v229
s_waitcnt vmcnt(28)
v_mfma_f32_32x32x16_bf16 v[108:123], a[148:151], a[28:31], v[108:123]
ds_read_b128 a[144:147], v242 offset:12288
v_mov_b32 v240, 0
v_mov_b32 v241, 0
s_waitcnt vmcnt(27)
s_waitcnt lgkmcnt(3)
v_mfma_f32_32x32x16_bf16 v[108:123], a[152:155], a[32:35], v[108:123]
ds_read_b128 a[148:151], v242 offset:13312
v_permlane32_swap_b32 v228, v230
s_waitcnt vmcnt(26)
v_mfma_f32_32x32x16_bf16 v[108:123], a[156:159], a[36:39], v[108:123]
ds_read_b128 a[152:155], v242 offset:14336
s_waitcnt vmcnt(25)
s_waitcnt lgkmcnt(3)
v_mfma_f32_32x32x16_bf16 v[108:123], a[160:163], a[40:43], v[108:123]
ds_read_b128 a[156:159], v242 offset:15360
v_permlane32_swap_b32 v229, v231
s_waitcnt vmcnt(24)
v_mfma_f32_32x32x16_bf16 v[108:123], a[164:167], a[44:47], v[108:123]
ds_read_b128 a[160:163], v242 offset:16384
v_add_f32 v228, v228, v230
s_waitcnt vmcnt(23)
s_waitcnt lgkmcnt(3)
v_mfma_f32_32x32x16_bf16 v[108:123], a[144:147], a[48:51], v[108:123]
ds_read_b128 a[164:167], v242 offset:17408
v_add_f32 v229, v229, v231
s_waitcnt vmcnt(22)
v_mfma_f32_32x32x16_bf16 v[108:123], a[148:151], a[52:55], v[108:123]
ds_read_b128 a[144:147], v242 offset:18432
v_mul_f32 v228, 0x3ae38e39, v228
s_waitcnt vmcnt(21)
s_waitcnt lgkmcnt(3)
v_mfma_f32_32x32x16_bf16 v[108:123], a[152:155], a[56:59], v[108:123]
ds_read_b128 a[148:151], v242 offset:19456
v_mul_f32 v230, v228, v228
s_waitcnt vmcnt(20)
v_mfma_f32_32x32x16_bf16 v[108:123], a[156:159], a[60:63], v[108:123]
ds_read_b128 a[152:155], v242 offset:20480
v_mul_f32 v229, 0x3ae38e39, v229
v_sub_f32 v229, v229, v230
s_waitcnt vmcnt(19)
s_waitcnt lgkmcnt(3)
v_mfma_f32_32x32x16_bf16 v[108:123], a[160:163], a[64:67], v[108:123]
ds_read_b128 a[156:159], v242 offset:21504
v_max_f32 v229, 0, v229
s_waitcnt vmcnt(18)
v_mfma_f32_32x32x16_bf16 v[108:123], a[164:167], a[68:71], v[108:123]
ds_read_b128 a[160:163], v242 offset:22528
v_add_f32 v229, 0x3727c5ac, v229
s_waitcnt vmcnt(17)
s_waitcnt lgkmcnt(3)
v_mfma_f32_32x32x16_bf16 v[108:123], a[144:147], a[72:75], v[108:123]
ds_read_b128 a[164:167], v242 offset:23552
v_rsq_f32 v236, v229
s_waitcnt vmcnt(16)
v_mfma_f32_32x32x16_bf16 v[108:123], a[148:151], a[76:79], v[108:123]
ds_read_b128 a[144:147], v242 offset:24576
v_sqrt_f32 v238, v229
s_waitcnt vmcnt(15)
s_waitcnt lgkmcnt(3)
v_mfma_f32_32x32x16_bf16 v[108:123], a[152:155], a[80:83], v[108:123]
ds_read_b128 a[148:151], v242 offset:25600
s_waitcnt vmcnt(14)
v_mfma_f32_32x32x16_bf16 v[108:123], a[156:159], a[84:87], v[108:123]
ds_read_b128 a[152:155], v242 offset:26624
v_cvt_pk_bf16_f32 v230, -v228, -v228
s_waitcnt vmcnt(13)
s_waitcnt lgkmcnt(3)
v_mfma_f32_32x32x16_bf16 v[108:123], a[160:163], a[88:91], v[108:123]
ds_read_b128 a[156:159], v242 offset:27648
v_and_b32 v230, 0xffff0000, v230
v_add_f32 v230, v228, v230
s_waitcnt vmcnt(12)
v_mfma_f32_32x32x16_bf16 v[108:123], a[164:167], a[92:95], v[108:123]
ds_read_b128 a[160:163], v242 offset:28672
v_cvt_pk_bf16_f32 v248, -v228, -v230
s_waitcnt vmcnt(11)
s_waitcnt lgkmcnt(3)
v_mfma_f32_32x32x16_bf16 v[108:123], a[144:147], a[96:99], v[108:123]
ds_read_b128 a[164:167], v242 offset:29696
v_mov_b32 v249, v248
s_waitcnt vmcnt(10)
v_mfma_f32_32x32x16_bf16 v[108:123], a[148:151], a[100:103], v[108:123]
ds_read_b128 a[144:147], v242 offset:30720
v_mov_b32 v250, v248
s_waitcnt vmcnt(9)
s_waitcnt lgkmcnt(3)
v_mfma_f32_32x32x16_bf16 v[108:123], a[152:155], a[104:107], v[108:123]
ds_read_b128 a[148:151], v242 offset:31744
v_mov_b32 v251, v248
v_mul_f32 v237, v236, v236
s_waitcnt vmcnt(8)
v_mfma_f32_32x32x16_bf16 v[108:123], a[156:159], a[108:111], v[108:123]
ds_read_b128 a[152:155], v242 offset:32768
v_mul_f32 v237, v237, v236
s_waitcnt vmcnt(7)
s_waitcnt lgkmcnt(3)
v_mfma_f32_32x32x16_bf16 v[108:123], a[160:163], a[112:115], v[108:123]
ds_read_b128 a[156:159], v242 offset:33792
v_mul_f32 v237, 0xbdd2d3e8, v237
s_waitcnt vmcnt(6)
v_mfma_f32_32x32x16_bf16 v[108:123], a[164:167], a[116:119], v[108:123]
ds_read_b128 a[160:163], v242 offset:34816
v_mul_f32 v236, 0xc0135761, v236
s_waitcnt vmcnt(5)
s_waitcnt lgkmcnt(3)
v_mfma_f32_32x32x16_bf16 v[108:123], a[144:147], a[120:123], v[108:123]
ds_read_b128 a[164:167], v242 offset:35840
s_waitcnt vmcnt(4)
v_mfma_f32_32x32x16_bf16 v[108:123], a[148:151], a[124:127], v[108:123]
ds_read_b128 a[144:147], v242 offset:36864
s_waitcnt vmcnt(3)
s_waitcnt lgkmcnt(3)
v_mfma_f32_32x32x16_bf16 v[108:123], a[152:155], a[128:131], v[108:123]
ds_read_b128 a[148:151], v243 offset:0
s_waitcnt vmcnt(2)
v_mfma_f32_32x32x16_bf16 v[108:123], a[156:159], a[132:135], v[108:123]
ds_read_b128 a[152:155], v243 offset:1024
s_waitcnt vmcnt(1)
s_waitcnt lgkmcnt(3)
v_mfma_f32_32x32x16_bf16 v[108:123], a[160:163], a[136:139], v[108:123]
ds_read_b128 a[156:159], v243 offset:2048
s_waitcnt vmcnt(0)
v_mfma_f32_32x32x16_bf16 v[108:123], a[164:167], a[140:143], v[108:123]
ds_read_b128 a[160:163], v243 offset:3072
s_waitcnt lgkmcnt(4)
v_mfma_f32_32x32x16_bf16 v[108:123], a[144:147], v[248:251], v[108:123]
ds_read_b128 a[164:167], v243 offset:4096
s_barrier
s_waitcnt lgkmcnt(3)
v_mfma_f32_32x32x16_bf16 v[124:139], a[148:151], a[0:3], 0
ds_read_b128 a[144:147], v243 offset:5120
s_mul_i32 s38, s24, 9216
s_add_u32 s39, s38, s62
s_add_u32 s39, s39, 151552
s_add_u32 m0, s38, 0
s_nop 0
buffer_load_dwordx4 v1, s[4:7], s39 offen offset:0 lds
v_mfma_f32_32x32x16_bf16 v[124:139], a[152:155], a[4:7], v[124:139]
ds_read_b128 a[148:151], v243 offset:6144
buffer_load_dwordx4 v1, s[4:7], s39 offen offset:1024 lds
buffer_load_dwordx4 v1, s[4:7], s39 offen offset:2048 lds
s_waitcnt lgkmcnt(3)
v_mfma_f32_32x32x16_bf16 v[124:139], a[156:159], a[8:11], v[124:139]
ds_read_b128 a[152:155], v243 offset:7168
v_mfma_f32_32x32x16_bf16 v[124:139], a[160:163], a[12:15], v[124:139]
ds_read_b128 a[156:159], v243 offset:8192
v_mul_f32 v228, v108, v108
v_mul_f32 v229, v109, v109
v_mul_f32 v230, v110, v110
v_mul_f32 v231, v111, v111
v_fma_f32 v228, v228, v237, v236
v_fma_f32 v229, v229, v237, v236
v_fma_f32 v230, v230, v237, v236
v_fma_f32 v231, v231, v237, v236
v_mul_f32 v228, v228, v108
v_mul_f32 v229, v229, v109
v_mul_f32 v230, v230, v110
v_mul_f32 v231, v231, v111
v_exp_f32 v228, v228
s_waitcnt lgkmcnt(3)
v_mfma_f32_32x32x16_bf16 v[124:139], a[164:167], a[16:19], v[124:139]
ds_read_b128 a[160:163], v243 offset:9216
v_exp_f32 v229, v229
v_exp_f32 v230, v230
v_exp_f32 v231, v231
v_mfma_f32_32x32x16_bf16 v[124:139], a[144:147], a[20:23], v[124:139]
ds_read_b128 a[164:167], v243 offset:10240
v_fma_f32 v228, v228, v238, v238
v_fma_f32 v229, v229, v238, v238
v_fma_f32 v230, v230, v238, v238
v_fma_f32 v231, v231, v238, v238
v_rcp_f32 v228, v228
s_waitcnt lgkmcnt(3)
v_mfma_f32_32x32x16_bf16 v[124:139], a[148:151], a[24:27], v[124:139]
ds_read_b128 a[144:147], v243 offset:11264
v_rcp_f32 v229, v229
v_rcp_f32 v230, v230
v_rcp_f32 v231, v231
v_mfma_f32_32x32x16_bf16 v[124:139], a[152:155], a[28:31], v[124:139]
ds_read_b128 a[148:151], v243 offset:12288
v_mul_f32 v140, v108, v228
v_mul_f32 v141, v109, v229
v_mul_f32 v142, v110, v230
v_mul_f32 v143, v111, v231
s_waitcnt lgkmcnt(3)
v_mfma_f32_32x32x16_bf16 v[124:139], a[156:159], a[32:35], v[124:139]
ds_read_b128 a[152:155], v243 offset:13312
v_add_f32 v240, v240, v140
v_fmac_f32 v241, v140, v140
v_add_f32 v240, v240, v141
v_fmac_f32 v241, v141, v141
v_add_f32 v240, v240, v142
v_fmac_f32 v241, v142, v142
v_mfma_f32_32x32x16_bf16 v[124:139], a[160:163], a[36:39], v[124:139]
ds_read_b128 a[156:159], v243 offset:14336
v_add_f32 v240, v240, v143
v_fmac_f32 v241, v143, v143
v_mul_f32 v232, v112, v112
v_mul_f32 v233, v113, v113
v_mul_f32 v234, v114, v114
v_mul_f32 v235, v115, v115
s_waitcnt lgkmcnt(3)
v_mfma_f32_32x32x16_bf16 v[124:139], a[164:167], a[40:43], v[124:139]
ds_read_b128 a[160:163], v243 offset:15360
buffer_load_dwordx4 v1, s[4:7], s39 offen offset:3072 lds
s_add_u32 m0, m0, 4096
s_add_u32 s39, s39, 4096
buffer_load_dwordx4 v1, s[4:7], s39 offen offset:0 lds
v_mfma_f32_32x32x16_bf16 v[124:139], a[144:147], a[44:47], v[124:139]
ds_read_b128 a[164:167], v243 offset:16384
buffer_load_dwordx4 v1, s[4:7], s39 offen offset:1024 lds
buffer_load_dwordx4 v1, s[4:7], s39 offen offset:2048 lds
buffer_load_dwordx4 v1, s[4:7], s39 offen offset:3072 lds
s_waitcnt lgkmcnt(3)
v_mfma_f32_32x32x16_bf16 v[124:139], a[148:151], a[48:51], v[124:139]
ds_read_b128 a[144:147], v243 offset:17408
s_add_u32 m0, m0, 4096
s_add_u32 s39, s39, 4096
buffer_load_dwordx4 v1, s[4:7], s39 offen offset:0 lds
s_lshl_b32 s38, s24, 8
s_add_u32 s39, s38, s62
v_mfma_f32_32x32x16_bf16 v[124:139], a[152:155], a[52:55], v[124:139]
ds_read_b128 a[148:151], v243 offset:18432
s_add_u32 s39, s39, 188416
s_add_u32 m0, s38, 36864
s_mov_b64 exec, 0xffff
buffer_load_dwordx4 v1, s[4:7], s39 offen lds
s_mov_b64 exec, -1
s_waitcnt lgkmcnt(3)
v_mfma_f32_32x32x16_bf16 v[124:139], a[156:159], a[56:59], v[124:139]
ds_read_b128 a[152:155], v243 offset:19456
v_fma_f32 v232, v232, v237, v236
v_fma_f32 v233, v233, v237, v236
v_fma_f32 v234, v234, v237, v236
v_fma_f32 v235, v235, v237, v236
v_mul_f32 v232, v232, v112
v_mfma_f32_32x32x16_bf16 v[124:139], a[160:163], a[60:63], v[124:139]
ds_read_b128 a[156:159], v243 offset:20480
v_mul_f32 v233, v233, v113
v_mul_f32 v234, v234, v114
v_mul_f32 v235, v235, v115
v_exp_f32 v232, v232
v_exp_f32 v233, v233
s_waitcnt lgkmcnt(3)
v_mfma_f32_32x32x16_bf16 v[124:139], a[164:167], a[64:67], v[124:139]
ds_read_b128 a[160:163], v243 offset:21504
v_exp_f32 v234, v234
v_exp_f32 v235, v235
v_fma_f32 v232, v232, v238, v238
v_mfma_f32_32x32x16_bf16 v[124:139], a[144:147], a[68:71], v[124:139]
ds_read_b128 a[164:167], v243 offset:22528
v_fma_f32 v233, v233, v238, v238
v_fma_f32 v234, v234, v238, v238
v_fma_f32 v235, v235, v238, v238
v_rcp_f32 v232, v232
v_rcp_f32 v233, v233
s_waitcnt lgkmcnt(3)
v_mfma_f32_32x32x16_bf16 v[124:139], a[148:151], a[72:75], v[124:139]
ds_read_b128 a[144:147], v243 offset:23552
v_rcp_f32 v234, v234
v_rcp_f32 v235, v235
v_mul_f32 v144, v112, v232
v_mfma_f32_32x32x16_bf16 v[124:139], a[152:155], a[76:79], v[124:139]
ds_read_b128 a[148:151], v243 offset:24576
v_mul_f32 v145, v113, v233
v_mul_f32 v146, v114, v234
v_mul_f32 v147, v115, v235
v_add_f32 v240, v240, v144
v_fmac_f32 v241, v144, v144
v_add_f32 v240, v240, v145
s_waitcnt lgkmcnt(3)
v_mfma_f32_32x32x16_bf16 v[124:139], a[156:159], a[80:83], v[124:139]
ds_read_b128 a[152:155], v243 offset:25600
v_fmac_f32 v241, v145, v145
v_add_f32 v240, v240, v146
v_fmac_f32 v241, v146, v146
v_add_f32 v240, v240, v147
v_fmac_f32 v241, v147, v147
v_mul_f32 v228, v116, v116
v_mfma_f32_32x32x16_bf16 v[124:139], a[160:163], a[84:87], v[124:139]
ds_read_b128 a[156:159], v243 offset:26624
v_mul_f32 v229, v117, v117
v_mul_f32 v230, v118, v118
v_mul_f32 v231, v119, v119
v_fma_f32 v228, v228, v237, v236
v_fma_f32 v229, v229, v237, v236
s_waitcnt lgkmcnt(3)
v_mfma_f32_32x32x16_bf16 v[124:139], a[164:167], a[88:91], v[124:139]
ds_read_b128 a[160:163], v243 offset:27648
v_fma_f32 v230, v230, v237, v236
v_fma_f32 v231, v231, v237, v236
v_mul_f32 v228, v228, v116
v_mul_f32 v229, v229, v117
v_mul_f32 v230, v230, v118
v_mul_f32 v231, v231, v119
v_mfma_f32_32x32x16_bf16 v[124:139], a[144:147], a[92:95], v[124:139]
ds_read_b128 a[164:167], v243 offset:28672
v_exp_f32 v228, v228
v_exp_f32 v229, v229
v_exp_f32 v230, v230
s_waitcnt lgkmcnt(3)
v_mfma_f32_32x32x16_bf16 v[124:139], a[148:151], a[96:99], v[124:139]
ds_read_b128 a[144:147], v243 offset:29696
v_exp_f32 v231, v231
v_fma_f32 v228, v228, v238, v238
v_fma_f32 v229, v229, v238, v238
v_fma_f32 v230, v230, v238, v238
v_fma_f32 v231, v231, v238, v238
v_mfma_f32_32x32x16_bf16 v[124:139], a[152:155], a[100:103], v[124:139]
ds_read_b128 a[148:151], v243 offset:30720
v_rcp_f32 v228, v228
v_rcp_f32 v229, v229
v_rcp_f32 v230, v230
s_waitcnt lgkmcnt(3)
v_mfma_f32_32x32x16_bf16 v[124:139], a[156:159], a[104:107], v[124:139]
ds_read_b128 a[152:155], v243 offset:31744
v_rcp_f32 v231, v231
v_mul_f32 v148, v116, v228
v_mul_f32 v149, v117, v229
v_mul_f32 v150, v118, v230
v_mul_f32 v151, v119, v231
v_mfma_f32_32x32x16_bf16 v[124:139], a[160:163], a[108:111], v[124:139]
ds_read_b128 a[156:159], v243 offset:32768
v_add_f32 v240, v240, v148
v_fmac_f32 v241, v148, v148
v_add_f32 v240, v240, v149
v_fmac_f32 v241, v149, v149
v_add_f32 v240, v240, v150
v_fmac_f32 v241, v150, v150
s_waitcnt lgkmcnt(3)
v_mfma_f32_32x32x16_bf16 v[124:139], a[164:167], a[112:115], v[124:139]
ds_read_b128 a[160:163], v243 offset:33792
v_add_f32 v240, v240, v151
v_fmac_f32 v241, v151, v151
v_mul_f32 v232, v120, v120
v_mul_f32 v233, v121, v121
v_mul_f32 v234, v122, v122
v_mfma_f32_32x32x16_bf16 v[124:139], a[144:147], a[116:119], v[124:139]
ds_read_b128 a[164:167], v243 offset:34816
v_mul_f32 v235, v123, v123
v_fma_f32 v232, v232, v237, v236
v_fma_f32 v233, v233, v237, v236
v_fma_f32 v234, v234, v237, v236
v_fma_f32 v235, v235, v237, v236
v_mul_f32 v232, v232, v120
s_waitcnt lgkmcnt(3)
v_mfma_f32_32x32x16_bf16 v[124:139], a[148:151], a[120:123], v[124:139]
ds_read_b128 a[144:147], v243 offset:35840
v_mul_f32 v233, v233, v121
v_mul_f32 v234, v234, v122
v_mul_f32 v235, v235, v123
v_exp_f32 v232, v232
v_exp_f32 v233, v233
v_mfma_f32_32x32x16_bf16 v[124:139], a[152:155], a[124:127], v[124:139]
ds_read_b128 a[148:151], v243 offset:36864
v_exp_f32 v234, v234
v_exp_f32 v235, v235
v_fma_f32 v232, v232, v238, v238
s_waitcnt lgkmcnt(3)
v_mfma_f32_32x32x16_bf16 v[124:139], a[156:159], a[128:131], v[124:139]
ds_read_b128 a[152:155], v244 offset:0
v_fma_f32 v233, v233, v238, v238
v_fma_f32 v234, v234, v238, v238
v_fma_f32 v235, v235, v238, v238
v_rcp_f32 v232, v232
v_rcp_f32 v233, v233
v_mfma_f32_32x32x16_bf16 v[124:139], a[160:163], a[132:135], v[124:139]
ds_read_b128 a[156:159], v244 offset:1024
v_rcp_f32 v234, v234
v_rcp_f32 v235, v235
v_mul_f32 v152, v120, v232
s_waitcnt lgkmcnt(3)
v_mfma_f32_32x32x16_bf16 v[124:139], a[164:167], a[136:139], v[124:139]
ds_read_b128 a[160:163], v244 offset:2048
v_mul_f32 v153, v121, v233
v_mul_f32 v154, v122, v234
v_mul_f32 v155, v123, v235
v_add_f32 v240, v240, v152
v_fmac_f32 v241, v152, v152
v_add_f32 v240, v240, v153
v_mfma_f32_32x32x16_bf16 v[124:139], a[144:147], a[140:143], v[124:139]
ds_read_b128 a[164:167], v244 offset:3072
v_fmac_f32 v241, v153, v153
v_add_f32 v240, v240, v154
v_fmac_f32 v241, v154, v154
v_add_f32 v240, v240, v155
v_fmac_f32 v241, v155, v155
s_waitcnt lgkmcnt(4)
v_mfma_f32_32x32x16_bf16 v[124:139], a[148:151], v[248:251], v[124:139]
ds_read_b128 a[144:147], v244 offset:4096
s_barrier
s_waitcnt lgkmcnt(3)
v_mfma_f32_32x32x16_bf16 v[108:123], a[152:155], a[0:3], 0
ds_read_b128 a[148:151], v244 offset:5120
s_mul_i32 s38, s24, 9216
s_add_u32 s39, s38, s62
s_add_u32 s39, s39, 189440
s_add_u32 m0, s38, 37888
s_nop 0
buffer_load_dwordx4 v1, s[4:7], s39 offen offset:0 lds
v_mfma_f32_32x32x16_bf16 v[108:123], a[156:159], a[4:7], v[108:123]
ds_read_b128 a[152:155], v244 offset:6144
buffer_load_dwordx4 v1, s[4:7], s39 offen offset:1024 lds
buffer_load_dwordx4 v1, s[4:7], s39 offen offset:2048 lds
s_waitcnt lgkmcnt(3)
v_mfma_f32_32x32x16_bf16 v[108:123], a[160:163], a[8:11], v[108:123]
ds_read_b128 a[156:159], v244 offset:7168
v_mfma_f32_32x32x16_bf16 v[108:123], a[164:167], a[12:15], v[108:123]
ds_read_b128 a[160:163], v244 offset:8192
v_mul_f32 v228, v124, v124
v_mul_f32 v229, v125, v125
v_mul_f32 v230, v126, v126
v_mul_f32 v231, v127, v127
v_fma_f32 v228, v228, v237, v236
v_fma_f32 v229, v229, v237, v236
v_fma_f32 v230, v230, v237, v236
v_fma_f32 v231, v231, v237, v236
v_mul_f32 v228, v228, v124
v_mul_f32 v229, v229, v125
v_mul_f32 v230, v230, v126
v_mul_f32 v231, v231, v127
v_exp_f32 v228, v228
s_waitcnt lgkmcnt(3)
v_mfma_f32_32x32x16_bf16 v[108:123], a[144:147], a[16:19], v[108:123]
ds_read_b128 a[164:167], v244 offset:9216
v_exp_f32 v229, v229
v_exp_f32 v230, v230
v_exp_f32 v231, v231
v_mfma_f32_32x32x16_bf16 v[108:123], a[148:151], a[20:23], v[108:123]
ds_read_b128 a[144:147], v244 offset:10240
v_fma_f32 v228, v228, v238, v238
v_fma_f32 v229, v229, v238, v238
v_fma_f32 v230, v230, v238, v238
v_fma_f32 v231, v231, v238, v238
v_rcp_f32 v228, v228
s_waitcnt lgkmcnt(3)
v_mfma_f32_32x32x16_bf16 v[108:123], a[152:155], a[24:27], v[108:123]
ds_read_b128 a[148:151], v244 offset:11264
v_rcp_f32 v229, v229
v_rcp_f32 v230, v230
v_rcp_f32 v231, v231
v_mfma_f32_32x32x16_bf16 v[108:123], a[156:159], a[28:31], v[108:123]
ds_read_b128 a[152:155], v244 offset:12288
v_mul_f32 v156, v124, v228
v_mul_f32 v157, v125, v229
v_mul_f32 v158, v126, v230
v_mul_f32 v159, v127, v231
s_waitcnt lgkmcnt(3)
v_mfma_f32_32x32x16_bf16 v[108:123], a[160:163], a[32:35], v[108:123]
ds_read_b128 a[156:159], v244 offset:13312
v_add_f32 v240, v240, v156
v_fmac_f32 v241, v156, v156
v_add_f32 v240, v240, v157
v_fmac_f32 v241, v157, v157
v_add_f32 v240, v240, v158
v_fmac_f32 v241, v158, v158
v_mfma_f32_32x32x16_bf16 v[108:123], a[164:167], a[36:39], v[108:123]
ds_read_b128 a[160:163], v244 offset:14336
v_add_f32 v240, v240, v159
v_fmac_f32 v241, v159, v159
v_mul_f32 v232, v128, v128
v_mul_f32 v233, v129, v129
v_mul_f32 v234, v130, v130
v_mul_f32 v235, v131, v131
s_waitcnt lgkmcnt(3)
v_mfma_f32_32x32x16_bf16 v[108:123], a[144:147], a[40:43], v[108:123]
ds_read_b128 a[164:167], v244 offset:15360
buffer_load_dwordx4 v1, s[4:7], s39 offen offset:3072 lds
s_add_u32 m0, m0, 4096
s_add_u32 s39, s39, 4096
buffer_load_dwordx4 v1, s[4:7], s39 offen offset:0 lds
v_mfma_f32_32x32x16_bf16 v[108:123], a[148:151], a[44:47], v[108:123]
ds_read_b128 a[144:147], v244 offset:16384
buffer_load_dwordx4 v1, s[4:7], s39 offen offset:1024 lds
buffer_load_dwordx4 v1, s[4:7], s39 offen offset:2048 lds
buffer_load_dwordx4 v1, s[4:7], s39 offen offset:3072 lds
s_waitcnt lgkmcnt(3)
v_mfma_f32_32x32x16_bf16 v[108:123], a[152:155], a[48:51], v[108:123]
ds_read_b128 a[148:151], v244 offset:17408
s_add_u32 m0, m0, 4096
s_add_u32 s39, s39, 4096
buffer_load_dwordx4 v1, s[4:7], s39 offen offset:0 lds
s_lshl_b32 s38, s24, 8
s_add_u32 s39, s38, s62
v_mfma_f32_32x32x16_bf16 v[108:123], a[156:159], a[52:55], v[108:123]
ds_read_b128 a[152:155], v244 offset:18432
s_add_u32 s39, s39, 226304
s_add_u32 m0, s38, 74752
s_mov_b64 exec, 0xffff
buffer_load_dwordx4 v1, s[4:7], s39 offen lds
s_mov_b64 exec, -1
s_waitcnt lgkmcnt(3)
v_mfma_f32_32x32x16_bf16 v[108:123], a[160:163], a[56:59], v[108:123]
ds_read_b128 a[156:159], v244 offset:19456
v_fma_f32 v232, v232, v237, v236
v_fma_f32 v233, v233, v237, v236
v_fma_f32 v234, v234, v237, v236
v_fma_f32 v235, v235, v237, v236
v_mul_f32 v232, v232, v128
v_mfma_f32_32x32x16_bf16 v[108:123], a[164:167], a[60:63], v[108:123]
ds_read_b128 a[160:163], v244 offset:20480
v_mul_f32 v233, v233, v129
v_mul_f32 v234, v234, v130
v_mul_f32 v235, v235, v131
v_exp_f32 v232, v232
v_exp_f32 v233, v233
s_waitcnt lgkmcnt(3)
v_mfma_f32_32x32x16_bf16 v[108:123], a[144:147], a[64:67], v[108:123]
ds_read_b128 a[164:167], v244 offset:21504
v_exp_f32 v234, v234
v_exp_f32 v235, v235
v_fma_f32 v232, v232, v238, v238
v_mfma_f32_32x32x16_bf16 v[108:123], a[148:151], a[68:71], v[108:123]
ds_read_b128 a[144:147], v244 offset:22528
v_fma_f32 v233, v233, v238, v238
v_fma_f32 v234, v234, v238, v238
v_fma_f32 v235, v235, v238, v238
v_rcp_f32 v232, v232
v_rcp_f32 v233, v233
s_waitcnt lgkmcnt(3)
v_mfma_f32_32x32x16_bf16 v[108:123], a[152:155], a[72:75], v[108:123]
ds_read_b128 a[148:151], v244 offset:23552
v_rcp_f32 v234, v234
v_rcp_f32 v235, v235
v_mul_f32 v160, v128, v232
v_mfma_f32_32x32x16_bf16 v[108:123], a[156:159], a[76:79], v[108:123]
ds_read_b128 a[152:155], v244 offset:24576
v_mul_f32 v161, v129, v233
v_mul_f32 v162, v130, v234
v_mul_f32 v163, v131, v235
v_add_f32 v240, v240, v160
v_fmac_f32 v241, v160, v160
v_add_f32 v240, v240, v161
s_waitcnt lgkmcnt(3)
v_mfma_f32_32x32x16_bf16 v[108:123], a[160:163], a[80:83], v[108:123]
ds_read_b128 a[156:159], v244 offset:25600
v_fmac_f32 v241, v161, v161
v_add_f32 v240, v240, v162
v_fmac_f32 v241, v162, v162
v_add_f32 v240, v240, v163
v_fmac_f32 v241, v163, v163
v_mul_f32 v228, v132, v132
v_mfma_f32_32x32x16_bf16 v[108:123], a[164:167], a[84:87], v[108:123]
ds_read_b128 a[160:163], v244 offset:26624
v_mul_f32 v229, v133, v133
v_mul_f32 v230, v134, v134
v_mul_f32 v231, v135, v135
v_fma_f32 v228, v228, v237, v236
v_fma_f32 v229, v229, v237, v236
s_waitcnt lgkmcnt(3)
v_mfma_f32_32x32x16_bf16 v[108:123], a[144:147], a[88:91], v[108:123]
ds_read_b128 a[164:167], v244 offset:27648
v_fma_f32 v230, v230, v237, v236
v_fma_f32 v231, v231, v237, v236
v_mul_f32 v228, v228, v132
v_mul_f32 v229, v229, v133
v_mul_f32 v230, v230, v134
v_mul_f32 v231, v231, v135
v_mfma_f32_32x32x16_bf16 v[108:123], a[148:151], a[92:95], v[108:123]
ds_read_b128 a[144:147], v244 offset:28672
v_exp_f32 v228, v228
v_exp_f32 v229, v229
v_exp_f32 v230, v230
s_waitcnt lgkmcnt(3)
v_mfma_f32_32x32x16_bf16 v[108:123], a[152:155], a[96:99], v[108:123]
ds_read_b128 a[148:151], v244 offset:29696
v_exp_f32 v231, v231
v_fma_f32 v228, v228, v238, v238
v_fma_f32 v229, v229, v238, v238
v_fma_f32 v230, v230, v238, v238
v_fma_f32 v231, v231, v238, v238
v_mfma_f32_32x32x16_bf16 v[108:123], a[156:159], a[100:103], v[108:123]
ds_read_b128 a[152:155], v244 offset:30720
v_rcp_f32 v228, v228
v_rcp_f32 v229, v229
v_rcp_f32 v230, v230
s_waitcnt lgkmcnt(3)
v_mfma_f32_32x32x16_bf16 v[108:123], a[160:163], a[104:107], v[108:123]
ds_read_b128 a[156:159], v244 offset:31744
v_rcp_f32 v231, v231
v_mul_f32 v164, v132, v228
v_mul_f32 v165, v133, v229
v_mul_f32 v166, v134, v230
v_mul_f32 v167, v135, v231
v_mfma_f32_32x32x16_bf16 v[108:123], a[164:167], a[108:111], v[108:123]
ds_read_b128 a[160:163], v244 offset:32768
v_add_f32 v240, v240, v164
v_fmac_f32 v241, v164, v164
v_add_f32 v240, v240, v165
v_fmac_f32 v241, v165, v165
v_add_f32 v240, v240, v166
v_fmac_f32 v241, v166, v166
s_waitcnt lgkmcnt(3)
v_mfma_f32_32x32x16_bf16 v[108:123], a[144:147], a[112:115], v[108:123]
ds_read_b128 a[164:167], v244 offset:33792
v_add_f32 v240, v240, v167
v_fmac_f32 v241, v167, v167
v_mul_f32 v232, v136, v136
v_mul_f32 v233, v137, v137
v_mul_f32 v234, v138, v138
v_mfma_f32_32x32x16_bf16 v[108:123], a[148:151], a[116:119], v[108:123]
ds_read_b128 a[144:147], v244 offset:34816
v_mul_f32 v235, v139, v139
v_fma_f32 v232, v232, v237, v236
v_fma_f32 v233, v233, v237, v236
v_fma_f32 v234, v234, v237, v236
v_fma_f32 v235, v235, v237, v236
v_mul_f32 v232, v232, v136
s_waitcnt lgkmcnt(3)
v_mfma_f32_32x32x16_bf16 v[108:123], a[152:155], a[120:123], v[108:123]
ds_read_b128 a[148:151], v244 offset:35840
v_mul_f32 v233, v233, v137
v_mul_f32 v234, v234, v138
v_mul_f32 v235, v235, v139
v_exp_f32 v232, v232
v_exp_f32 v233, v233
v_mfma_f32_32x32x16_bf16 v[108:123], a[156:159], a[124:127], v[108:123]
ds_read_b128 a[152:155], v244 offset:36864
v_exp_f32 v234, v234
v_exp_f32 v235, v235
v_fma_f32 v232, v232, v238, v238
s_waitcnt lgkmcnt(3)
v_mfma_f32_32x32x16_bf16 v[108:123], a[160:163], a[128:131], v[108:123]
ds_read_b128 a[156:159], v245 offset:0
v_fma_f32 v233, v233, v238, v238
v_fma_f32 v234, v234, v238, v238
v_fma_f32 v235, v235, v238, v238
v_rcp_f32 v232, v232
v_rcp_f32 v233, v233
v_mfma_f32_32x32x16_bf16 v[108:123], a[164:167], a[132:135], v[108:123]
ds_read_b128 a[160:163], v245 offset:1024
v_rcp_f32 v234, v234
v_rcp_f32 v235, v235
v_mul_f32 v168, v136, v232
s_waitcnt lgkmcnt(3)
v_mfma_f32_32x32x16_bf16 v[108:123], a[144:147], a[136:139], v[108:123]
ds_read_b128 a[164:167], v245 offset:2048
v_mul_f32 v169, v137, v233
v_mul_f32 v170, v138, v234
v_mul_f32 v171, v139, v235
v_add_f32 v240, v240, v168
v_fmac_f32 v241, v168, v168
v_add_f32 v240, v240, v169
v_mfma_f32_32x32x16_bf16 v[108:123], a[148:151], a[140:143], v[108:123]
ds_read_b128 a[144:147], v245 offset:3072
v_fmac_f32 v241, v169, v169
v_add_f32 v240, v240, v170
v_fmac_f32 v241, v170, v170
v_add_f32 v240, v240, v171
v_fmac_f32 v241, v171, v171
s_waitcnt lgkmcnt(4)
v_mfma_f32_32x32x16_bf16 v[108:123], a[152:155], v[248:251], v[108:123]
ds_read_b128 a[148:151], v245 offset:4096
s_waitcnt vmcnt(10)
s_barrier
s_waitcnt lgkmcnt(3)
v_mfma_f32_32x32x16_bf16 v[124:139], a[156:159], a[0:3], 0
ds_read_b128 a[152:155], v245 offset:5120
s_mul_i32 s38, s24, 9216
s_add_u32 s39, s38, s62
s_add_u32 s39, s39, 227328
s_add_u32 m0, s38, 75776
s_nop 0
buffer_load_dwordx4 v1, s[4:7], s39 offen offset:0 lds
v_mfma_f32_32x32x16_bf16 v[124:139], a[160:163], a[4:7], v[124:139]
ds_read_b128 a[156:159], v245 offset:6144
buffer_load_dwordx4 v1, s[4:7], s39 offen offset:1024 lds
buffer_load_dwordx4 v1, s[4:7], s39 offen offset:2048 lds
s_waitcnt lgkmcnt(3)
v_mfma_f32_32x32x16_bf16 v[124:139], a[164:167], a[8:11], v[124:139]
ds_read_b128 a[160:163], v245 offset:7168
v_mfma_f32_32x32x16_bf16 v[124:139], a[144:147], a[12:15], v[124:139]
ds_read_b128 a[164:167], v245 offset:8192
v_mul_f32 v228, v108, v108
v_mul_f32 v229, v109, v109
v_mul_f32 v230, v110, v110
v_mul_f32 v231, v111, v111
v_fma_f32 v228, v228, v237, v236
v_fma_f32 v229, v229, v237, v236
v_fma_f32 v230, v230, v237, v236
v_fma_f32 v231, v231, v237, v236
v_mul_f32 v228, v228, v108
v_mul_f32 v229, v229, v109
v_mul_f32 v230, v230, v110
v_mul_f32 v231, v231, v111
v_exp_f32 v228, v228
s_waitcnt lgkmcnt(3)
v_mfma_f32_32x32x16_bf16 v[124:139], a[148:151], a[16:19], v[124:139]
ds_read_b128 a[144:147], v245 offset:9216
v_exp_f32 v229, v229
v_exp_f32 v230, v230
v_exp_f32 v231, v231
v_mfma_f32_32x32x16_bf16 v[124:139], a[152:155], a[20:23], v[124:139]
ds_read_b128 a[148:151], v245 offset:10240
v_fma_f32 v228, v228, v238, v238
v_fma_f32 v229, v229, v238, v238
v_fma_f32 v230, v230, v238, v238
v_fma_f32 v231, v231, v238, v238
v_rcp_f32 v228, v228
s_waitcnt lgkmcnt(3)
v_mfma_f32_32x32x16_bf16 v[124:139], a[156:159], a[24:27], v[124:139]
ds_read_b128 a[152:155], v245 offset:11264
v_rcp_f32 v229, v229
v_rcp_f32 v230, v230
v_rcp_f32 v231, v231
v_mfma_f32_32x32x16_bf16 v[124:139], a[160:163], a[28:31], v[124:139]
ds_read_b128 a[156:159], v245 offset:12288
v_mul_f32 v172, v108, v228
v_mul_f32 v173, v109, v229
v_mul_f32 v174, v110, v230
v_mul_f32 v175, v111, v231
s_waitcnt lgkmcnt(3)
v_mfma_f32_32x32x16_bf16 v[124:139], a[164:167], a[32:35], v[124:139]
ds_read_b128 a[160:163], v245 offset:13312
v_add_f32 v240, v240, v172
v_fmac_f32 v241, v172, v172
v_add_f32 v240, v240, v173
v_fmac_f32 v241, v173, v173
v_add_f32 v240, v240, v174
v_fmac_f32 v241, v174, v174
v_mfma_f32_32x32x16_bf16 v[124:139], a[144:147], a[36:39], v[124:139]
ds_read_b128 a[164:167], v245 offset:14336
v_add_f32 v240, v240, v175
v_fmac_f32 v241, v175, v175
v_mul_f32 v232, v112, v112
v_mul_f32 v233, v113, v113
v_mul_f32 v234, v114, v114
v_mul_f32 v235, v115, v115
s_waitcnt lgkmcnt(3)
v_mfma_f32_32x32x16_bf16 v[124:139], a[148:151], a[40:43], v[124:139]
ds_read_b128 a[144:147], v245 offset:15360
buffer_load_dwordx4 v1, s[4:7], s39 offen offset:3072 lds
s_add_u32 m0, m0, 4096
s_add_u32 s39, s39, 4096
buffer_load_dwordx4 v1, s[4:7], s39 offen offset:0 lds
v_mfma_f32_32x32x16_bf16 v[124:139], a[152:155], a[44:47], v[124:139]
ds_read_b128 a[148:151], v245 offset:16384
buffer_load_dwordx4 v1, s[4:7], s39 offen offset:1024 lds
buffer_load_dwordx4 v1, s[4:7], s39 offen offset:2048 lds
buffer_load_dwordx4 v1, s[4:7], s39 offen offset:3072 lds
s_waitcnt lgkmcnt(3)
v_mfma_f32_32x32x16_bf16 v[124:139], a[156:159], a[48:51], v[124:139]
ds_read_b128 a[152:155], v245 offset:17408
s_add_u32 m0, m0, 4096
s_add_u32 s39, s39, 4096
buffer_load_dwordx4 v1, s[4:7], s39 offen offset:0 lds
s_lshl_b32 s38, s24, 8
s_add_u32 s39, s38, s62
v_mfma_f32_32x32x16_bf16 v[124:139], a[160:163], a[52:55], v[124:139]
ds_read_b128 a[156:159], v245 offset:18432
s_add_u32 s39, s39, 264192
s_add_u32 m0, s38, 112640
s_mov_b64 exec, 0xffff
buffer_load_dwordx4 v1, s[4:7], s39 offen lds
s_mov_b64 exec, -1
s_waitcnt lgkmcnt(3)
v_mfma_f32_32x32x16_bf16 v[124:139], a[164:167], a[56:59], v[124:139]
ds_read_b128 a[160:163], v245 offset:19456
v_fma_f32 v232, v232, v237, v236
v_fma_f32 v233, v233, v237, v236
v_fma_f32 v234, v234, v237, v236
v_fma_f32 v235, v235, v237, v236
v_mul_f32 v232, v232, v112
v_mfma_f32_32x32x16_bf16 v[124:139], a[144:147], a[60:63], v[124:139]
ds_read_b128 a[164:167], v245 offset:20480
v_mul_f32 v233, v233, v113
v_mul_f32 v234, v234, v114
v_mul_f32 v235, v235, v115
v_exp_f32 v232, v232
v_exp_f32 v233, v233
s_waitcnt lgkmcnt(3)
v_mfma_f32_32x32x16_bf16 v[124:139], a[148:151], a[64:67], v[124:139]
ds_read_b128 a[144:147], v245 offset:21504
v_exp_f32 v234, v234
v_exp_f32 v235, v235
v_fma_f32 v232, v232, v238, v238
v_mfma_f32_32x32x16_bf16 v[124:139], a[152:155], a[68:71], v[124:139]
ds_read_b128 a[148:151], v245 offset:22528
v_fma_f32 v233, v233, v238, v238
v_fma_f32 v234, v234, v238, v238
v_fma_f32 v235, v235, v238, v238
v_rcp_f32 v232, v232
v_rcp_f32 v233, v233
s_waitcnt lgkmcnt(3)
v_mfma_f32_32x32x16_bf16 v[124:139], a[156:159], a[72:75], v[124:139]
ds_read_b128 a[152:155], v245 offset:23552
v_rcp_f32 v234, v234
v_rcp_f32 v235, v235
v_mul_f32 v176, v112, v232
v_mfma_f32_32x32x16_bf16 v[124:139], a[160:163], a[76:79], v[124:139]
ds_read_b128 a[156:159], v245 offset:24576
v_mul_f32 v177, v113, v233
v_mul_f32 v178, v114, v234
v_mul_f32 v179, v115, v235
v_add_f32 v240, v240, v176
v_fmac_f32 v241, v176, v176
v_add_f32 v240, v240, v177
s_waitcnt lgkmcnt(3)
v_mfma_f32_32x32x16_bf16 v[124:139], a[164:167], a[80:83], v[124:139]
ds_read_b128 a[160:163], v245 offset:25600
v_fmac_f32 v241, v177, v177
v_add_f32 v240, v240, v178
v_fmac_f32 v241, v178, v178
v_add_f32 v240, v240, v179
v_fmac_f32 v241, v179, v179
v_mul_f32 v228, v116, v116
v_mfma_f32_32x32x16_bf16 v[124:139], a[144:147], a[84:87], v[124:139]
ds_read_b128 a[164:167], v245 offset:26624
v_mul_f32 v229, v117, v117
v_mul_f32 v230, v118, v118
v_mul_f32 v231, v119, v119
v_fma_f32 v228, v228, v237, v236
v_fma_f32 v229, v229, v237, v236
s_waitcnt lgkmcnt(3)
v_mfma_f32_32x32x16_bf16 v[124:139], a[148:151], a[88:91], v[124:139]
ds_read_b128 a[144:147], v245 offset:27648
v_fma_f32 v230, v230, v237, v236
v_fma_f32 v231, v231, v237, v236
v_mul_f32 v228, v228, v116
v_mul_f32 v229, v229, v117
v_mul_f32 v230, v230, v118
v_mul_f32 v231, v231, v119
v_mfma_f32_32x32x16_bf16 v[124:139], a[152:155], a[92:95], v[124:139]
ds_read_b128 a[148:151], v245 offset:28672
v_exp_f32 v228, v228
v_exp_f32 v229, v229
v_exp_f32 v230, v230
s_waitcnt lgkmcnt(3)
v_mfma_f32_32x32x16_bf16 v[124:139], a[156:159], a[96:99], v[124:139]
ds_read_b128 a[152:155], v245 offset:29696
v_exp_f32 v231, v231
v_fma_f32 v228, v228, v238, v238
v_fma_f32 v229, v229, v238, v238
v_fma_f32 v230, v230, v238, v238
v_fma_f32 v231, v231, v238, v238
v_mfma_f32_32x32x16_bf16 v[124:139], a[160:163], a[100:103], v[124:139]
ds_read_b128 a[156:159], v245 offset:30720
v_rcp_f32 v228, v228
v_rcp_f32 v229, v229
v_rcp_f32 v230, v230
s_waitcnt lgkmcnt(3)
v_mfma_f32_32x32x16_bf16 v[124:139], a[164:167], a[104:107], v[124:139]
ds_read_b128 a[160:163], v245 offset:31744
v_rcp_f32 v231, v231
v_mul_f32 v180, v116, v228
v_mul_f32 v181, v117, v229
v_mul_f32 v182, v118, v230
v_mul_f32 v183, v119, v231
v_mfma_f32_32x32x16_bf16 v[124:139], a[144:147], a[108:111], v[124:139]
ds_read_b128 a[164:167], v245 offset:32768
v_add_f32 v240, v240, v180
v_fmac_f32 v241, v180, v180
v_add_f32 v240, v240, v181
v_fmac_f32 v241, v181, v181
v_add_f32 v240, v240, v182
v_fmac_f32 v241, v182, v182
s_waitcnt lgkmcnt(3)
v_mfma_f32_32x32x16_bf16 v[124:139], a[148:151], a[112:115], v[124:139]
ds_read_b128 a[144:147], v245 offset:33792
v_add_f32 v240, v240, v183
v_fmac_f32 v241, v183, v183
v_mul_f32 v232, v120, v120
v_mul_f32 v233, v121, v121
v_mul_f32 v234, v122, v122
v_mfma_f32_32x32x16_bf16 v[124:139], a[152:155], a[116:119], v[124:139]
ds_read_b128 a[148:151], v245 offset:34816
v_mul_f32 v235, v123, v123
v_fma_f32 v232, v232, v237, v236
v_fma_f32 v233, v233, v237, v236
v_fma_f32 v234, v234, v237, v236
v_fma_f32 v235, v235, v237, v236
v_mul_f32 v232, v232, v120
s_waitcnt lgkmcnt(3)
v_mfma_f32_32x32x16_bf16 v[124:139], a[156:159], a[120:123], v[124:139]
ds_read_b128 a[152:155], v245 offset:35840
v_mul_f32 v233, v233, v121
v_mul_f32 v234, v234, v122
v_mul_f32 v235, v235, v123
v_exp_f32 v232, v232
v_exp_f32 v233, v233
v_mfma_f32_32x32x16_bf16 v[124:139], a[160:163], a[124:127], v[124:139]
ds_read_b128 a[156:159], v245 offset:36864
v_exp_f32 v234, v234
v_exp_f32 v235, v235
v_fma_f32 v232, v232, v238, v238
s_waitcnt lgkmcnt(3)
v_mfma_f32_32x32x16_bf16 v[124:139], a[164:167], a[128:131], v[124:139]
ds_read_b128 a[160:163], v242 offset:0
v_fma_f32 v233, v233, v238, v238
v_fma_f32 v234, v234, v238, v238
v_fma_f32 v235, v235, v238, v238
v_rcp_f32 v232, v232
v_rcp_f32 v233, v233
v_mfma_f32_32x32x16_bf16 v[124:139], a[144:147], a[132:135], v[124:139]
ds_read_b128 a[164:167], v242 offset:1024
v_rcp_f32 v234, v234
v_rcp_f32 v235, v235
v_mul_f32 v184, v120, v232
s_waitcnt lgkmcnt(3)
v_mfma_f32_32x32x16_bf16 v[124:139], a[148:151], a[136:139], v[124:139]
ds_read_b128 a[144:147], v242 offset:2048
v_mul_f32 v185, v121, v233
v_mul_f32 v186, v122, v234
v_mul_f32 v187, v123, v235
v_add_f32 v240, v240, v184
v_fmac_f32 v241, v184, v184
v_add_f32 v240, v240, v185
v_mfma_f32_32x32x16_bf16 v[124:139], a[152:155], a[140:143], v[124:139]
ds_read_b128 a[148:151], v242 offset:3072
v_fmac_f32 v241, v185, v185
v_add_f32 v240, v240, v186
v_fmac_f32 v241, v186, v186
v_add_f32 v240, v240, v187
v_fmac_f32 v241, v187, v187
s_waitcnt lgkmcnt(4)
v_mfma_f32_32x32x16_bf16 v[124:139], a[156:159], v[248:251], v[124:139]
ds_read_b128 a[152:155], v242 offset:4096
s_waitcnt vmcnt(10)
s_barrier
s_waitcnt lgkmcnt(3)
v_mfma_f32_32x32x16_bf16 v[108:123], a[160:163], a[0:3], 0
ds_read_b128 a[156:159], v242 offset:5120
s_mul_i32 s38, s24, 9216
s_add_u32 s39, s38, s62
s_add_u32 s39, s39, 265216
s_add_u32 m0, s38, 113664
s_nop 0
buffer_load_dwordx4 v1, s[4:7], s39 offen offset:0 lds
v_mfma_f32_32x32x16_bf16 v[108:123], a[164:167], a[4:7], v[108:123]
ds_read_b128 a[160:163], v242 offset:6144
buffer_load_dwordx4 v1, s[4:7], s39 offen offset:1024 lds
buffer_load_dwordx4 v1, s[4:7], s39 offen offset:2048 lds
s_waitcnt lgkmcnt(3)
v_mfma_f32_32x32x16_bf16 v[108:123], a[144:147], a[8:11], v[108:123]
ds_read_b128 a[164:167], v242 offset:7168
v_mfma_f32_32x32x16_bf16 v[108:123], a[148:151], a[12:15], v[108:123]
ds_read_b128 a[144:147], v242 offset:8192
v_mul_f32 v228, v124, v124
v_mul_f32 v229, v125, v125
v_mul_f32 v230, v126, v126
v_mul_f32 v231, v127, v127
v_fma_f32 v228, v228, v237, v236
v_fma_f32 v229, v229, v237, v236
v_fma_f32 v230, v230, v237, v236
v_fma_f32 v231, v231, v237, v236
v_mul_f32 v228, v228, v124
v_mul_f32 v229, v229, v125
v_mul_f32 v230, v230, v126
v_mul_f32 v231, v231, v127
v_exp_f32 v228, v228
s_waitcnt lgkmcnt(3)
v_mfma_f32_32x32x16_bf16 v[108:123], a[152:155], a[16:19], v[108:123]
ds_read_b128 a[148:151], v242 offset:9216
v_exp_f32 v229, v229
v_exp_f32 v230, v230
v_exp_f32 v231, v231
v_mfma_f32_32x32x16_bf16 v[108:123], a[156:159], a[20:23], v[108:123]
ds_read_b128 a[152:155], v242 offset:10240
v_fma_f32 v228, v228, v238, v238
v_fma_f32 v229, v229, v238, v238
v_fma_f32 v230, v230, v238, v238
v_fma_f32 v231, v231, v238, v238
v_rcp_f32 v228, v228
s_waitcnt lgkmcnt(3)
v_mfma_f32_32x32x16_bf16 v[108:123], a[160:163], a[24:27], v[108:123]
ds_read_b128 a[156:159], v242 offset:11264
v_rcp_f32 v229, v229
v_rcp_f32 v230, v230
v_rcp_f32 v231, v231
v_mfma_f32_32x32x16_bf16 v[108:123], a[164:167], a[28:31], v[108:123]
ds_read_b128 a[160:163], v242 offset:12288
v_mul_f32 v188, v124, v228
v_mul_f32 v189, v125, v229
v_mul_f32 v190, v126, v230
v_mul_f32 v191, v127, v231
s_waitcnt lgkmcnt(3)
v_mfma_f32_32x32x16_bf16 v[108:123], a[144:147], a[32:35], v[108:123]
ds_read_b128 a[164:167], v242 offset:13312
v_add_f32 v240, v240, v188
v_fmac_f32 v241, v188, v188
v_add_f32 v240, v240, v189
v_fmac_f32 v241, v189, v189
v_add_f32 v240, v240, v190
v_fmac_f32 v241, v190, v190
v_mfma_f32_32x32x16_bf16 v[108:123], a[148:151], a[36:39], v[108:123]
ds_read_b128 a[144:147], v242 offset:14336
v_add_f32 v240, v240, v191
v_fmac_f32 v241, v191, v191
v_mul_f32 v232, v128, v128
v_mul_f32 v233, v129, v129
v_mul_f32 v234, v130, v130
v_mul_f32 v235, v131, v131
s_waitcnt lgkmcnt(3)
v_mfma_f32_32x32x16_bf16 v[108:123], a[152:155], a[40:43], v[108:123]
ds_read_b128 a[148:151], v242 offset:15360
buffer_load_dwordx4 v1, s[4:7], s39 offen offset:3072 lds
s_add_u32 m0, m0, 4096
s_add_u32 s39, s39, 4096
buffer_load_dwordx4 v1, s[4:7], s39 offen offset:0 lds
v_mfma_f32_32x32x16_bf16 v[108:123], a[156:159], a[44:47], v[108:123]
ds_read_b128 a[152:155], v242 offset:16384
buffer_load_dwordx4 v1, s[4:7], s39 offen offset:1024 lds
buffer_load_dwordx4 v1, s[4:7], s39 offen offset:2048 lds
buffer_load_dwordx4 v1, s[4:7], s39 offen offset:3072 lds
s_waitcnt lgkmcnt(3)
v_mfma_f32_32x32x16_bf16 v[108:123], a[160:163], a[48:51], v[108:123]
ds_read_b128 a[156:159], v242 offset:17408
s_add_u32 m0, m0, 4096
s_add_u32 s39, s39, 4096
buffer_load_dwordx4 v1, s[4:7], s39 offen offset:0 lds
s_lshl_b32 s38, s24, 8
s_add_u32 s39, s38, s62
v_mfma_f32_32x32x16_bf16 v[108:123], a[164:167], a[52:55], v[108:123]
ds_read_b128 a[160:163], v242 offset:18432
s_add_u32 s39, s39, 302080
s_add_u32 m0, s38, 150528
s_mov_b64 exec, 0xffff
buffer_load_dwordx4 v1, s[4:7], s39 offen lds
s_mov_b64 exec, -1
s_waitcnt lgkmcnt(3)
v_mfma_f32_32x32x16_bf16 v[108:123], a[144:147], a[56:59], v[108:123]
ds_read_b128 a[164:167], v242 offset:19456
v_fma_f32 v232, v232, v237, v236
v_fma_f32 v233, v233, v237, v236
v_fma_f32 v234, v234, v237, v236
v_fma_f32 v235, v235, v237, v236
v_mul_f32 v232, v232, v128
v_mfma_f32_32x32x16_bf16 v[108:123], a[148:151], a[60:63], v[108:123]
ds_read_b128 a[144:147], v242 offset:20480
v_mul_f32 v233, v233, v129
v_mul_f32 v234, v234, v130
v_mul_f32 v235, v235, v131
v_exp_f32 v232, v232
v_exp_f32 v233, v233
s_waitcnt lgkmcnt(3)
v_mfma_f32_32x32x16_bf16 v[108:123], a[152:155], a[64:67], v[108:123]
ds_read_b128 a[148:151], v242 offset:21504
v_exp_f32 v234, v234
v_exp_f32 v235, v235
v_fma_f32 v232, v232, v238, v238
v_mfma_f32_32x32x16_bf16 v[108:123], a[156:159], a[68:71], v[108:123]
ds_read_b128 a[152:155], v242 offset:22528
v_fma_f32 v233, v233, v238, v238
v_fma_f32 v234, v234, v238, v238
v_fma_f32 v235, v235, v238, v238
v_rcp_f32 v232, v232
v_rcp_f32 v233, v233
s_waitcnt lgkmcnt(3)
v_mfma_f32_32x32x16_bf16 v[108:123], a[160:163], a[72:75], v[108:123]
ds_read_b128 a[156:159], v242 offset:23552
v_rcp_f32 v234, v234
v_rcp_f32 v235, v235
v_mul_f32 v192, v128, v232
v_mfma_f32_32x32x16_bf16 v[108:123], a[164:167], a[76:79], v[108:123]
ds_read_b128 a[160:163], v242 offset:24576
v_mul_f32 v193, v129, v233
v_mul_f32 v194, v130, v234
v_mul_f32 v195, v131, v235
v_add_f32 v240, v240, v192
v_fmac_f32 v241, v192, v192
v_add_f32 v240, v240, v193
s_waitcnt lgkmcnt(3)
v_mfma_f32_32x32x16_bf16 v[108:123], a[144:147], a[80:83], v[108:123]
ds_read_b128 a[164:167], v242 offset:25600
v_fmac_f32 v241, v193, v193
v_add_f32 v240, v240, v194
v_fmac_f32 v241, v194, v194
v_add_f32 v240, v240, v195
v_fmac_f32 v241, v195, v195
v_mul_f32 v228, v132, v132
v_mfma_f32_32x32x16_bf16 v[108:123], a[148:151], a[84:87], v[108:123]
ds_read_b128 a[144:147], v242 offset:26624
v_mul_f32 v229, v133, v133
v_mul_f32 v230, v134, v134
v_mul_f32 v231, v135, v135
v_fma_f32 v228, v228, v237, v236
v_fma_f32 v229, v229, v237, v236
s_waitcnt lgkmcnt(3)
v_mfma_f32_32x32x16_bf16 v[108:123], a[152:155], a[88:91], v[108:123]
ds_read_b128 a[148:151], v242 offset:27648
v_fma_f32 v230, v230, v237, v236
v_fma_f32 v231, v231, v237, v236
v_mul_f32 v228, v228, v132
v_mul_f32 v229, v229, v133
v_mul_f32 v230, v230, v134
v_mul_f32 v231, v231, v135
v_mfma_f32_32x32x16_bf16 v[108:123], a[156:159], a[92:95], v[108:123]
ds_read_b128 a[152:155], v242 offset:28672
v_exp_f32 v228, v228
v_exp_f32 v229, v229
v_exp_f32 v230, v230
s_waitcnt lgkmcnt(3)
v_mfma_f32_32x32x16_bf16 v[108:123], a[160:163], a[96:99], v[108:123]
ds_read_b128 a[156:159], v242 offset:29696
v_exp_f32 v231, v231
v_fma_f32 v228, v228, v238, v238
v_fma_f32 v229, v229, v238, v238
v_fma_f32 v230, v230, v238, v238
v_fma_f32 v231, v231, v238, v238
v_mfma_f32_32x32x16_bf16 v[108:123], a[164:167], a[100:103], v[108:123]
ds_read_b128 a[160:163], v242 offset:30720
v_rcp_f32 v228, v228
v_rcp_f32 v229, v229
v_rcp_f32 v230, v230
s_waitcnt lgkmcnt(3)
v_mfma_f32_32x32x16_bf16 v[108:123], a[144:147], a[104:107], v[108:123]
ds_read_b128 a[164:167], v242 offset:31744
v_rcp_f32 v231, v231
v_mul_f32 v196, v132, v228
v_mul_f32 v197, v133, v229
v_mul_f32 v198, v134, v230
v_mul_f32 v199, v135, v231
v_mfma_f32_32x32x16_bf16 v[108:123], a[148:151], a[108:111], v[108:123]
ds_read_b128 a[144:147], v242 offset:32768
v_add_f32 v240, v240, v196
v_fmac_f32 v241, v196, v196
v_add_f32 v240, v240, v197
v_fmac_f32 v241, v197, v197
v_add_f32 v240, v240, v198
v_fmac_f32 v241, v198, v198
s_waitcnt lgkmcnt(3)
v_mfma_f32_32x32x16_bf16 v[108:123], a[152:155], a[112:115], v[108:123]
ds_read_b128 a[148:151], v242 offset:33792
v_add_f32 v240, v240, v199
v_fmac_f32 v241, v199, v199
v_mul_f32 v232, v136, v136
v_mul_f32 v233, v137, v137
v_mul_f32 v234, v138, v138
v_mfma_f32_32x32x16_bf16 v[108:123], a[156:159], a[116:119], v[108:123]
ds_read_b128 a[152:155], v242 offset:34816
v_mul_f32 v235, v139, v139
v_fma_f32 v232, v232, v237, v236
v_fma_f32 v233, v233, v237, v236
v_fma_f32 v234, v234, v237, v236
v_fma_f32 v235, v235, v237, v236
v_mul_f32 v232, v232, v136
s_waitcnt lgkmcnt(3)
v_mfma_f32_32x32x16_bf16 v[108:123], a[160:163], a[120:123], v[108:123]
ds_read_b128 a[156:159], v242 offset:35840
v_mul_f32 v233, v233, v137
v_mul_f32 v234, v234, v138
v_mul_f32 v235, v235, v139
v_exp_f32 v232, v232
v_exp_f32 v233, v233
v_mfma_f32_32x32x16_bf16 v[108:123], a[164:167], a[124:127], v[108:123]
ds_read_b128 a[160:163], v242 offset:36864
v_exp_f32 v234, v234
v_exp_f32 v235, v235
v_fma_f32 v232, v232, v238, v238
s_waitcnt lgkmcnt(3)
v_mfma_f32_32x32x16_bf16 v[108:123], a[144:147], a[128:131], v[108:123]
ds_read_b128 a[164:167], v243 offset:0
v_fma_f32 v233, v233, v238, v238
v_fma_f32 v234, v234, v238, v238
v_fma_f32 v235, v235, v238, v238
v_rcp_f32 v232, v232
v_rcp_f32 v233, v233
v_mfma_f32_32x32x16_bf16 v[108:123], a[148:151], a[132:135], v[108:123]
ds_read_b128 a[144:147], v243 offset:1024
v_rcp_f32 v234, v234
v_rcp_f32 v235, v235
v_mul_f32 v200, v136, v232
s_waitcnt lgkmcnt(3)
v_mfma_f32_32x32x16_bf16 v[108:123], a[152:155], a[136:139], v[108:123]
ds_read_b128 a[148:151], v243 offset:2048
v_mul_f32 v201, v137, v233
v_mul_f32 v202, v138, v234
v_mul_f32 v203, v139, v235
v_add_f32 v240, v240, v200
v_fmac_f32 v241, v200, v200
v_add_f32 v240, v240, v201
v_mfma_f32_32x32x16_bf16 v[108:123], a[156:159], a[140:143], v[108:123]
ds_read_b128 a[152:155], v243 offset:3072
v_fmac_f32 v241, v201, v201
v_add_f32 v240, v240, v202
v_fmac_f32 v241, v202, v202
v_add_f32 v240, v240, v203
v_fmac_f32 v241, v203, v203
s_waitcnt lgkmcnt(4)
v_mfma_f32_32x32x16_bf16 v[108:123], a[160:163], v[248:251], v[108:123]
ds_read_b128 a[156:159], v243 offset:4096
s_waitcnt vmcnt(10)
s_barrier
s_waitcnt lgkmcnt(3)
v_mfma_f32_32x32x16_bf16 v[124:139], a[164:167], a[0:3], 0
ds_read_b128 a[160:163], v243 offset:5120
s_mul_i32 s38, s24, 9216
s_add_u32 s39, s38, s62
s_add_u32 s39, s39, 303104
s_add_u32 m0, s38, 0
s_nop 0
buffer_load_dwordx4 v1, s[4:7], s39 offen offset:0 lds
v_mfma_f32_32x32x16_bf16 v[124:139], a[144:147], a[4:7], v[124:139]
ds_read_b128 a[164:167], v243 offset:6144
buffer_load_dwordx4 v1, s[4:7], s39 offen offset:1024 lds
buffer_load_dwordx4 v1, s[4:7], s39 offen offset:2048 lds
s_waitcnt lgkmcnt(3)
v_mfma_f32_32x32x16_bf16 v[124:139], a[148:151], a[8:11], v[124:139]
ds_read_b128 a[144:147], v243 offset:7168
v_mfma_f32_32x32x16_bf16 v[124:139], a[152:155], a[12:15], v[124:139]
ds_read_b128 a[148:151], v243 offset:8192
v_mul_f32 v228, v108, v108
v_mul_f32 v229, v109, v109
v_mul_f32 v230, v110, v110
v_mul_f32 v231, v111, v111
v_fma_f32 v228, v228, v237, v236
v_fma_f32 v229, v229, v237, v236
v_fma_f32 v230, v230, v237, v236
v_fma_f32 v231, v231, v237, v236
v_mul_f32 v228, v228, v108
v_mul_f32 v229, v229, v109
v_mul_f32 v230, v230, v110
v_mul_f32 v231, v231, v111
v_exp_f32 v228, v228
s_waitcnt lgkmcnt(3)
v_mfma_f32_32x32x16_bf16 v[124:139], a[156:159], a[16:19], v[124:139]
ds_read_b128 a[152:155], v243 offset:9216
v_exp_f32 v229, v229
v_exp_f32 v230, v230
v_exp_f32 v231, v231
v_mfma_f32_32x32x16_bf16 v[124:139], a[160:163], a[20:23], v[124:139]
ds_read_b128 a[156:159], v243 offset:10240
v_fma_f32 v228, v228, v238, v238
v_fma_f32 v229, v229, v238, v238
v_fma_f32 v230, v230, v238, v238
v_fma_f32 v231, v231, v238, v238
v_rcp_f32 v228, v228
s_waitcnt lgkmcnt(3)
v_mfma_f32_32x32x16_bf16 v[124:139], a[164:167], a[24:27], v[124:139]
ds_read_b128 a[160:163], v243 offset:11264
v_rcp_f32 v229, v229
v_rcp_f32 v230, v230
v_rcp_f32 v231, v231
v_mfma_f32_32x32x16_bf16 v[124:139], a[144:147], a[28:31], v[124:139]
ds_read_b128 a[164:167], v243 offset:12288
v_mul_f32 v204, v108, v228
v_mul_f32 v205, v109, v229
v_mul_f32 v206, v110, v230
v_mul_f32 v207, v111, v231
v_add_f32 v240, v240, v204
v_fmac_f32 v241, v204, v204
s_waitcnt lgkmcnt(3)
v_mfma_f32_32x32x16_bf16 v[124:139], a[148:151], a[32:35], v[124:139]
ds_read_b128 a[144:147], v243 offset:13312
v_add_f32 v240, v240, v205
v_fmac_f32 v241, v205, v205
v_add_f32 v240, v240, v206
v_fmac_f32 v241, v206, v206
v_add_f32 v240, v240, v207
v_fmac_f32 v241, v207, v207
v_mfma_f32_32x32x16_bf16 v[124:139], a[152:155], a[36:39], v[124:139]
ds_read_b128 a[148:151], v243 offset:14336
v_mul_f32 v232, v112, v112
v_mul_f32 v233, v113, v113
v_mul_f32 v234, v114, v114
v_mul_f32 v235, v115, v115
v_fma_f32 v232, v232, v237, v236
v_fma_f32 v233, v233, v237, v236
s_waitcnt lgkmcnt(3)
v_mfma_f32_32x32x16_bf16 v[124:139], a[156:159], a[40:43], v[124:139]
ds_read_b128 a[152:155], v243 offset:15360
v_fma_f32 v234, v234, v237, v236
v_fma_f32 v235, v235, v237, v236
v_mul_f32 v232, v232, v112
v_mul_f32 v233, v233, v113
v_mul_f32 v234, v234, v114
v_mul_f32 v235, v235, v115
v_mfma_f32_32x32x16_bf16 v[124:139], a[160:163], a[44:47], v[124:139]
ds_read_b128 a[156:159], v243 offset:16384
v_exp_f32 v232, v232
v_exp_f32 v233, v233
v_exp_f32 v234, v234
s_waitcnt lgkmcnt(3)
v_mfma_f32_32x32x16_bf16 v[124:139], a[164:167], a[48:51], v[124:139]
ds_read_b128 a[160:163], v243 offset:17408
v_exp_f32 v235, v235
v_fma_f32 v232, v232, v238, v238
v_fma_f32 v233, v233, v238, v238
v_fma_f32 v234, v234, v238, v238
v_fma_f32 v235, v235, v238, v238
v_mfma_f32_32x32x16_bf16 v[124:139], a[144:147], a[52:55], v[124:139]
ds_read_b128 a[164:167], v243 offset:18432
v_rcp_f32 v232, v232
v_rcp_f32 v233, v233
v_rcp_f32 v234, v234
s_waitcnt lgkmcnt(3)
v_mfma_f32_32x32x16_bf16 v[124:139], a[148:151], a[56:59], v[124:139]
ds_read_b128 a[144:147], v243 offset:19456
v_rcp_f32 v235, v235
v_mul_f32 v208, v112, v232
v_mul_f32 v209, v113, v233
v_mul_f32 v210, v114, v234
v_mul_f32 v211, v115, v235
v_mfma_f32_32x32x16_bf16 v[124:139], a[152:155], a[60:63], v[124:139]
ds_read_b128 a[148:151], v243 offset:20480
v_add_f32 v240, v240, v208
v_fmac_f32 v241, v208, v208
v_add_f32 v240, v240, v209
v_fmac_f32 v241, v209, v209
v_add_f32 v240, v240, v210
v_fmac_f32 v241, v210, v210
s_waitcnt lgkmcnt(3)
v_mfma_f32_32x32x16_bf16 v[124:139], a[156:159], a[64:67], v[124:139]
ds_read_b128 a[152:155], v243 offset:21504
v_add_f32 v240, v240, v211
v_fmac_f32 v241, v211, v211
v_mov_b32 v212, v240
v_mov_b32 v213, v241
s_lshl_b32 s61, s25, 14
s_lshl_b32 s30, s24, 8
v_mfma_f32_32x32x16_bf16 v[124:139], a[160:163], a[68:71], v[124:139]
ds_read_b128 a[156:159], v243 offset:22528
v_permlane32_swap_b32 v240, v212
v_permlane32_swap_b32 v241, v213
v_add_f32 v240, v240, v212
v_add_f32 v241, v241, v213
s_waitcnt lgkmcnt(3)
v_mfma_f32_32x32x16_bf16 v[124:139], a[164:167], a[72:75], v[124:139]
ds_read_b128 a[160:163], v243 offset:23552
s_add_u32 s61, s61, s30
s_add_u32 s61, s61, 26214400
s_lshl_b32 s30, s26, 10
s_add_u32 s30, s30, s61
v_lshrrev_b32 v6, 1, v1
s_mov_b32 exec_hi, 0
buffer_store_dwordx2 v[240:241], v6, s[8:11], s30 offen sc1
s_mov_b64 exec, -1
v_mfma_f32_32x32x16_bf16 v[124:139], a[144:147], a[76:79], v[124:139]
ds_read_b128 a[164:167], v243 offset:24576
v_and_b32 v6, 0xf8, v6
v_lshrrev_b32 v7, 1, v3
v_lshl_add_u32 v6, v7, 13, v6
v_add_u32 v7, 4096, v6
s_waitcnt lgkmcnt(3)
v_mfma_f32_32x32x16_bf16 v[124:139], a[148:151], a[80:83], v[124:139]
ds_read_b128 a[144:147], v243 offset:25600
buffer_load_dwordx4 v1, s[4:7], s39 offen offset:3072 lds
s_add_u32 m0, m0, 4096
s_add_u32 s39, s39, 4096
buffer_load_dwordx4 v1, s[4:7], s39 offen offset:0 lds
v_mfma_f32_32x32x16_bf16 v[124:139], a[152:155], a[84:87], v[124:139]
ds_read_b128 a[148:151], v243 offset:26624
buffer_load_dwordx4 v1, s[4:7], s39 offen offset:1024 lds
buffer_load_dwordx4 v1, s[4:7], s39 offen offset:2048 lds
buffer_load_dwordx4 v1, s[4:7], s39 offen offset:3072 lds
s_waitcnt lgkmcnt(3)
v_mfma_f32_32x32x16_bf16 v[124:139], a[156:159], a[88:91], v[124:139]
ds_read_b128 a[152:155], v243 offset:27648
s_add_u32 m0, m0, 4096
s_add_u32 s39, s39, 4096
buffer_load_dwordx4 v1, s[4:7], s39 offen offset:0 lds
s_lshl_b32 s38, s24, 8
s_add_u32 s39, s38, s62
v_mfma_f32_32x32x16_bf16 v[124:139], a[160:163], a[92:95], v[124:139]
ds_read_b128 a[156:159], v243 offset:28672
s_add_u32 s39, s39, 339968
s_add_u32 m0, s38, 36864
s_mov_b64 exec, 0xffff
buffer_load_dwordx4 v1, s[4:7], s39 offen lds
s_mov_b64 exec, -1
s_waitcnt lgkmcnt(3)
v_mfma_f32_32x32x16_bf16 v[124:139], a[164:167], a[96:99], v[124:139]
ds_read_b128 a[160:163], v243 offset:29696
v_mul_f32 v228, v116, v116
v_mul_f32 v229, v117, v117
v_mul_f32 v230, v118, v118
v_mul_f32 v231, v119, v119
v_fma_f32 v228, v228, v237, v236
v_fma_f32 v229, v229, v237, v236
v_mfma_f32_32x32x16_bf16 v[124:139], a[144:147], a[100:103], v[124:139]
ds_read_b128 a[164:167], v243 offset:30720
v_fma_f32 v230, v230, v237, v236
v_fma_f32 v231, v231, v237, v236
v_mul_f32 v228, v228, v116
v_mul_f32 v229, v229, v117
v_mul_f32 v230, v230, v118
v_mul_f32 v231, v231, v119
s_waitcnt lgkmcnt(3)
v_mfma_f32_32x32x16_bf16 v[124:139], a[148:151], a[104:107], v[124:139]
ds_read_b128 a[144:147], v243 offset:31744
v_exp_f32 v228, v228
v_exp_f32 v229, v229
v_exp_f32 v230, v230
v_mfma_f32_32x32x16_bf16 v[124:139], a[152:155], a[108:111], v[124:139]
ds_read_b128 a[148:151], v243 offset:32768
v_exp_f32 v231, v231
v_fma_f32 v228, v228, v238, v238
v_fma_f32 v229, v229, v238, v238
v_fma_f32 v230, v230, v238, v238
v_fma_f32 v231, v231, v238, v238
s_waitcnt lgkmcnt(3)
v_mfma_f32_32x32x16_bf16 v[124:139], a[156:159], a[112:115], v[124:139]
ds_read_b128 a[152:155], v243 offset:33792
v_rcp_f32 v228, v228
v_rcp_f32 v229, v229
v_rcp_f32 v230, v230
v_mfma_f32_32x32x16_bf16 v[124:139], a[160:163], a[116:119], v[124:139]
ds_read_b128 a[156:159], v243 offset:34816
v_rcp_f32 v231, v231
v_mul_f32 v100, v116, v228
v_mul_f32 v101, v117, v229
v_mul_f32 v102, v118, v230
v_mul_f32 v103, v119, v231
s_waitcnt lgkmcnt(3)
v_mfma_f32_32x32x16_bf16 v[124:139], a[164:167], a[120:123], v[124:139]
ds_read_b128 a[160:163], v243 offset:35840
v_mul_f32 v232, v120, v120
v_mul_f32 v233, v121, v121
v_mul_f32 v234, v122, v122
v_mul_f32 v235, v123, v123
v_fma_f32 v232, v232, v237, v236
v_fma_f32 v233, v233, v237, v236
v_mfma_f32_32x32x16_bf16 v[124:139], a[144:147], a[124:127], v[124:139]
ds_read_b128 a[164:167], v243 offset:36864
v_fma_f32 v234, v234, v237, v236
v_fma_f32 v235, v235, v237, v236
v_mul_f32 v232, v232, v120
v_mul_f32 v233, v233, v121
v_mul_f32 v234, v234, v122
v_mul_f32 v235, v235, v123
s_waitcnt lgkmcnt(3)
v_mfma_f32_32x32x16_bf16 v[124:139], a[148:151], a[128:131], v[124:139]
ds_read_b128 a[144:147], v244 offset:0
v_exp_f32 v232, v232
v_exp_f32 v233, v233
v_exp_f32 v234, v234
v_mfma_f32_32x32x16_bf16 v[124:139], a[152:155], a[132:135], v[124:139]
ds_read_b128 a[148:151], v244 offset:1024
v_exp_f32 v235, v235
v_fma_f32 v232, v232, v238, v238
v_fma_f32 v233, v233, v238, v238
v_fma_f32 v234, v234, v238, v238
v_fma_f32 v235, v235, v238, v238
s_waitcnt lgkmcnt(3)
v_mfma_f32_32x32x16_bf16 v[124:139], a[156:159], a[136:139], v[124:139]
ds_read_b128 a[152:155], v244 offset:2048
v_rcp_f32 v232, v232
v_rcp_f32 v233, v233
v_rcp_f32 v234, v234
v_mfma_f32_32x32x16_bf16 v[124:139], a[160:163], a[140:143], v[124:139]
ds_read_b128 a[156:159], v244 offset:3072
v_rcp_f32 v235, v235
v_mul_f32 v104, v120, v232
v_mul_f32 v105, v121, v233
v_mul_f32 v106, v122, v234
v_mul_f32 v107, v123, v235
s_waitcnt lgkmcnt(4)
v_mfma_f32_32x32x16_bf16 v[124:139], a[164:167], v[248:251], v[124:139]
ds_read_b128 a[160:163], v244 offset:4096
s_waitcnt vmcnt(11)
s_barrier
s_waitcnt lgkmcnt(3)
v_mfma_f32_32x32x16_bf16 v[108:123], a[144:147], a[0:3], 0
ds_read_b128 a[164:167], v244 offset:5120
v_mfma_f32_32x32x16_bf16 v[108:123], a[148:151], a[4:7], v[108:123]
ds_read_b128 a[144:147], v244 offset:6144
s_waitcnt lgkmcnt(3)
v_mfma_f32_32x32x16_bf16 v[108:123], a[152:155], a[8:11], v[108:123]
ds_read_b128 a[148:151], v244 offset:7168
v_mfma_f32_32x32x16_bf16 v[108:123], a[156:159], a[12:15], v[108:123]
ds_read_b128 a[152:155], v244 offset:8192
v_mul_f32 v228, v124, v124
v_mul_f32 v229, v125, v125
v_mul_f32 v230, v126, v126
v_mul_f32 v231, v127, v127
v_fma_f32 v228, v228, v237, v236
v_fma_f32 v229, v229, v237, v236
v_fma_f32 v230, v230, v237, v236
v_fma_f32 v231, v231, v237, v236
v_mul_f32 v228, v228, v124
v_mul_f32 v229, v229, v125
v_mul_f32 v230, v230, v126
v_mul_f32 v231, v231, v127
v_exp_f32 v228, v228
v_exp_f32 v229, v229
v_exp_f32 v230, v230
s_waitcnt lgkmcnt(3)
v_mfma_f32_32x32x16_bf16 v[108:123], a[160:163], a[16:19], v[108:123]
ds_read_b128 a[156:159], v244 offset:9216
v_exp_f32 v231, v231
v_fma_f32 v228, v228, v238, v238
v_fma_f32 v229, v229, v238, v238
v_mfma_f32_32x32x16_bf16 v[108:123], a[164:167], a[20:23], v[108:123]
ds_read_b128 a[160:163], v244 offset:10240
v_fma_f32 v230, v230, v238, v238
v_fma_f32 v231, v231, v238, v238
v_rcp_f32 v228, v228
s_waitcnt lgkmcnt(3)
v_mfma_f32_32x32x16_bf16 v[108:123], a[144:147], a[24:27], v[108:123]
ds_read_b128 a[164:167], v244 offset:11264
v_rcp_f32 v229, v229
v_rcp_f32 v230, v230
v_mfma_f32_32x32x16_bf16 v[108:123], a[148:151], a[28:31], v[108:123]
ds_read_b128 a[144:147], v244 offset:12288
v_rcp_f32 v231, v231
v_mul_f32 v36, v124, v228
v_mul_f32 v37, v125, v229
s_waitcnt lgkmcnt(3)
v_mfma_f32_32x32x16_bf16 v[108:123], a[152:155], a[32:35], v[108:123]
ds_read_b128 a[148:151], v244 offset:13312
v_mul_f32 v38, v126, v230
v_mul_f32 v39, v127, v231
v_mul_f32 v232, v128, v128
v_mul_f32 v233, v129, v129
v_mfma_f32_32x32x16_bf16 v[108:123], a[156:159], a[36:39], v[108:123]
ds_read_b128 a[152:155], v244 offset:14336
v_mul_f32 v234, v130, v130
v_mul_f32 v235, v131, v131
v_fma_f32 v232, v232, v237, v236
v_fma_f32 v233, v233, v237, v236
v_fma_f32 v234, v234, v237, v236
s_waitcnt lgkmcnt(3)
v_mfma_f32_32x32x16_bf16 v[108:123], a[160:163], a[40:43], v[108:123]
ds_read_b128 a[156:159], v244 offset:15360
v_fma_f32 v235, v235, v237, v236
v_mul_f32 v232, v232, v128
v_mul_f32 v233, v233, v129
v_mul_f32 v234, v234, v130
v_mfma_f32_32x32x16_bf16 v[108:123], a[164:167], a[44:47], v[108:123]
ds_read_b128 a[160:163], v244 offset:16384
v_mul_f32 v235, v235, v131
v_exp_f32 v232, v232
v_exp_f32 v233, v233
s_waitcnt lgkmcnt(3)
v_mfma_f32_32x32x16_bf16 v[108:123], a[144:147], a[48:51], v[108:123]
ds_read_b128 a[164:167], v244 offset:17408
v_exp_f32 v234, v234
v_exp_f32 v235, v235
v_mfma_f32_32x32x16_bf16 v[108:123], a[148:151], a[52:55], v[108:123]
ds_read_b128 a[144:147], v244 offset:18432
v_fma_f32 v232, v232, v238, v238
v_fma_f32 v233, v233, v238, v238
v_fma_f32 v234, v234, v238, v238
v_fma_f32 v235, v235, v238, v238
s_waitcnt lgkmcnt(3)
v_mfma_f32_32x32x16_bf16 v[108:123], a[152:155], a[56:59], v[108:123]
ds_read_b128 a[148:151], v244 offset:19456
v_rcp_f32 v232, v232
v_rcp_f32 v233, v233
v_mfma_f32_32x32x16_bf16 v[108:123], a[156:159], a[60:63], v[108:123]
ds_read_b128 a[152:155], v244 offset:20480
v_rcp_f32 v234, v234
v_rcp_f32 v235, v235
s_waitcnt lgkmcnt(3)
v_mfma_f32_32x32x16_bf16 v[108:123], a[160:163], a[64:67], v[108:123]
ds_read_b128 a[156:159], v244 offset:21504
v_mul_f32 v40, v128, v232
v_mul_f32 v41, v129, v233
v_mul_f32 v42, v130, v234
v_mul_f32 v43, v131, v235
v_mfma_f32_32x32x16_bf16 v[108:123], a[164:167], a[68:71], v[108:123]
ds_read_b128 a[160:163], v244 offset:22528
v_mul_f32 v228, v132, v132
v_mul_f32 v229, v133, v133
v_mul_f32 v230, v134, v134
v_mul_f32 v231, v135, v135
s_waitcnt lgkmcnt(3)
v_mfma_f32_32x32x16_bf16 v[108:123], a[144:147], a[72:75], v[108:123]
ds_read_b128 a[164:167], v244 offset:23552
v_fma_f32 v228, v228, v237, v236
v_fma_f32 v229, v229, v237, v236
v_fma_f32 v230, v230, v237, v236
v_fma_f32 v231, v231, v237, v236
v_mul_f32 v228, v228, v132
v_mfma_f32_32x32x16_bf16 v[108:123], a[148:151], a[76:79], v[108:123]
ds_read_b128 a[144:147], v244 offset:24576
v_mul_f32 v229, v229, v133
v_mul_f32 v230, v230, v134
v_mul_f32 v231, v231, v135
v_exp_f32 v228, v228
s_waitcnt lgkmcnt(3)
v_mfma_f32_32x32x16_bf16 v[108:123], a[152:155], a[80:83], v[108:123]
ds_read_b128 a[148:151], v244 offset:25600
v_exp_f32 v229, v229
v_exp_f32 v230, v230
v_mfma_f32_32x32x16_bf16 v[108:123], a[156:159], a[84:87], v[108:123]
ds_read_b128 a[152:155], v244 offset:26624
v_exp_f32 v231, v231
v_fma_f32 v228, v228, v238, v238
s_waitcnt lgkmcnt(3)
v_mfma_f32_32x32x16_bf16 v[108:123], a[160:163], a[88:91], v[108:123]
ds_read_b128 a[156:159], v244 offset:27648
v_fma_f32 v229, v229, v238, v238
v_fma_f32 v230, v230, v238, v238
v_fma_f32 v231, v231, v238, v238
v_rcp_f32 v228, v228
v_mfma_f32_32x32x16_bf16 v[108:123], a[164:167], a[92:95], v[108:123]
ds_read_b128 a[160:163], v244 offset:28672
v_rcp_f32 v229, v229
v_rcp_f32 v230, v230
s_waitcnt lgkmcnt(3)
v_mfma_f32_32x32x16_bf16 v[108:123], a[144:147], a[96:99], v[108:123]
ds_read_b128 a[164:167], v244 offset:29696
v_rcp_f32 v231, v231
v_mul_f32 v44, v132, v228
v_mul_f32 v45, v133, v229
v_mfma_f32_32x32x16_bf16 v[108:123], a[148:151], a[100:103], v[108:123]
ds_read_b128 a[144:147], v244 offset:30720
v_mul_f32 v46, v134, v230
v_mul_f32 v47, v135, v231
v_mul_f32 v232, v136, v136
v_mul_f32 v233, v137, v137
s_waitcnt lgkmcnt(3)
v_mfma_f32_32x32x16_bf16 v[108:123], a[152:155], a[104:107], v[108:123]
ds_read_b128 a[148:151], v244 offset:31744
v_mul_f32 v234, v138, v138
v_mul_f32 v235, v139, v139
v_fma_f32 v232, v232, v237, v236
v_fma_f32 v233, v233, v237, v236
v_mfma_f32_32x32x16_bf16 v[108:123], a[156:159], a[108:111], v[108:123]
ds_read_b128 a[152:155], v244 offset:32768
v_fma_f32 v234, v234, v237, v236
v_fma_f32 v235, v235, v237, v236
v_mul_f32 v232, v232, v136
v_mul_f32 v233, v233, v137
v_mul_f32 v234, v234, v138
s_waitcnt lgkmcnt(3)
v_mfma_f32_32x32x16_bf16 v[108:123], a[160:163], a[112:115], v[108:123]
ds_read_b128 a[156:159], v244 offset:33792
v_mul_f32 v235, v235, v139
v_exp_f32 v232, v232
v_exp_f32 v233, v233
v_mfma_f32_32x32x16_bf16 v[108:123], a[164:167], a[116:119], v[108:123]
ds_read_b128 a[160:163], v244 offset:34816
v_exp_f32 v234, v234
v_exp_f32 v235, v235
s_waitcnt lgkmcnt(3)
v_mfma_f32_32x32x16_bf16 v[108:123], a[144:147], a[120:123], v[108:123]
ds_read_b128 a[164:167], v244 offset:35840
v_fma_f32 v232, v232, v238, v238
v_fma_f32 v233, v233, v238, v238
v_fma_f32 v234, v234, v238, v238
v_mfma_f32_32x32x16_bf16 v[108:123], a[148:151], a[124:127], v[108:123]
ds_read_b128 a[144:147], v244 offset:36864
v_fma_f32 v235, v235, v238, v238
v_rcp_f32 v232, v232
v_rcp_f32 v233, v233
s_waitcnt lgkmcnt(3)
v_mfma_f32_32x32x16_bf16 v[108:123], a[152:155], a[128:131], v[108:123]
ds_read_b128 a[148:151], v245 offset:0
v_rcp_f32 v234, v234
v_rcp_f32 v235, v235
v_mfma_f32_32x32x16_bf16 v[108:123], a[156:159], a[132:135], v[108:123]
ds_read_b128 a[152:155], v245 offset:1024
v_mul_f32 v48, v136, v232
v_mul_f32 v49, v137, v233
v_mul_f32 v50, v138, v234
v_mul_f32 v51, v139, v235
s_waitcnt lgkmcnt(3)
v_mfma_f32_32x32x16_bf16 v[108:123], a[160:163], a[136:139], v[108:123]
ds_read_b128 a[156:159], v245 offset:2048
v_permlane16_swap_b32 v100, v104
v_permlane16_swap_b32 v101, v105
v_mfma_f32_32x32x16_bf16 v[108:123], a[164:167], a[140:143], v[108:123]
ds_read_b128 a[160:163], v245 offset:3072
v_permlane16_swap_b32 v102, v106
v_permlane16_swap_b32 v103, v107
s_waitcnt lgkmcnt(4)
v_mfma_f32_32x32x16_bf16 v[108:123], a[144:147], v[248:251], v[108:123]
ds_read_b128 a[164:167], v245 offset:4096
s_waitcnt vmcnt(0)
s_barrier
s_waitcnt lgkmcnt(3)
v_mfma_f32_32x32x16_bf16 v[124:139], a[148:151], a[0:3], 0
ds_read_b128 a[144:147], v245 offset:5120
v_mfma_f32_32x32x16_bf16 v[124:139], a[152:155], a[4:7], v[124:139]
ds_read_b128 a[148:151], v245 offset:6144
s_waitcnt lgkmcnt(3)
v_mfma_f32_32x32x16_bf16 v[124:139], a[156:159], a[8:11], v[124:139]
ds_read_b128 a[152:155], v245 offset:7168
v_mfma_f32_32x32x16_bf16 v[124:139], a[160:163], a[12:15], v[124:139]
ds_read_b128 a[156:159], v245 offset:8192
v_mul_f32 v228, v108, v108
v_mul_f32 v229, v109, v109
v_mul_f32 v230, v110, v110
v_mul_f32 v231, v111, v111
v_fma_f32 v228, v228, v237, v236
v_fma_f32 v229, v229, v237, v236
v_fma_f32 v230, v230, v237, v236
v_fma_f32 v231, v231, v237, v236
v_mul_f32 v228, v228, v108
v_mul_f32 v229, v229, v109
v_mul_f32 v230, v230, v110
v_mul_f32 v231, v231, v111
v_exp_f32 v228, v228
v_exp_f32 v229, v229
v_exp_f32 v230, v230
s_waitcnt lgkmcnt(3)
v_mfma_f32_32x32x16_bf16 v[124:139], a[164:167], a[16:19], v[124:139]
ds_read_b128 a[160:163], v245 offset:9216
v_exp_f32 v231, v231
v_fma_f32 v228, v228, v238, v238
v_fma_f32 v229, v229, v238, v238
v_fma_f32 v230, v230, v238, v238
v_mfma_f32_32x32x16_bf16 v[124:139], a[144:147], a[20:23], v[124:139]
ds_read_b128 a[164:167], v245 offset:10240
v_fma_f32 v231, v231, v238, v238
v_rcp_f32 v228, v228
v_rcp_f32 v229, v229
s_waitcnt lgkmcnt(3)
v_mfma_f32_32x32x16_bf16 v[124:139], a[148:151], a[24:27], v[124:139]
ds_read_b128 a[144:147], v245 offset:11264
v_rcp_f32 v230, v230
v_rcp_f32 v231, v231
v_mfma_f32_32x32x16_bf16 v[124:139], a[152:155], a[28:31], v[124:139]
ds_read_b128 a[148:151], v245 offset:12288
v_mul_f32 v52, v108, v228
v_mul_f32 v53, v109, v229
v_mul_f32 v54, v110, v230
v_mul_f32 v55, v111, v231
s_waitcnt lgkmcnt(3)
v_mfma_f32_32x32x16_bf16 v[124:139], a[156:159], a[32:35], v[124:139]
ds_read_b128 a[152:155], v245 offset:13312
v_mul_f32 v232, v112, v112
v_mul_f32 v233, v113, v113
v_mul_f32 v234, v114, v114
v_mul_f32 v235, v115, v115
v_mfma_f32_32x32x16_bf16 v[124:139], a[160:163], a[36:39], v[124:139]
ds_read_b128 a[156:159], v245 offset:14336
v_fma_f32 v232, v232, v237, v236
v_fma_f32 v233, v233, v237, v236
v_fma_f32 v234, v234, v237, v236
v_fma_f32 v235, v235, v237, v236
v_mul_f32 v232, v232, v112
s_waitcnt lgkmcnt(3)
v_mfma_f32_32x32x16_bf16 v[124:139], a[164:167], a[40:43], v[124:139]
ds_read_b128 a[160:163], v245 offset:15360
v_mul_f32 v233, v233, v113
v_mul_f32 v234, v234, v114
v_mul_f32 v235, v235, v115
v_exp_f32 v232, v232
v_mfma_f32_32x32x16_bf16 v[124:139], a[144:147], a[44:47], v[124:139]
ds_read_b128 a[164:167], v245 offset:16384
v_exp_f32 v233, v233
v_exp_f32 v234, v234
s_waitcnt lgkmcnt(3)
v_mfma_f32_32x32x16_bf16 v[124:139], a[148:151], a[48:51], v[124:139]
ds_read_b128 a[144:147], v245 offset:17408
v_exp_f32 v235, v235
v_fma_f32 v232, v232, v238, v238
v_fma_f32 v233, v233, v238, v238
v_mfma_f32_32x32x16_bf16 v[124:139], a[152:155], a[52:55], v[124:139]
ds_read_b128 a[148:151], v245 offset:18432
v_fma_f32 v234, v234, v238, v238
v_fma_f32 v235, v235, v238, v238
v_rcp_f32 v232, v232
v_rcp_f32 v233, v233
s_waitcnt lgkmcnt(3)
v_mfma_f32_32x32x16_bf16 v[124:139], a[156:159], a[56:59], v[124:139]
ds_read_b128 a[152:155], v245 offset:19456
v_rcp_f32 v234, v234
v_rcp_f32 v235, v235
v_mfma_f32_32x32x16_bf16 v[124:139], a[160:163], a[60:63], v[124:139]
ds_read_b128 a[156:159], v245 offset:20480
v_mul_f32 v56, v112, v232
v_mul_f32 v57, v113, v233
v_mul_f32 v58, v114, v234
v_mul_f32 v59, v115, v235
s_waitcnt lgkmcnt(3)
v_mfma_f32_32x32x16_bf16 v[124:139], a[164:167], a[64:67], v[124:139]
ds_read_b128 a[160:163], v245 offset:21504
v_mul_f32 v228, v116, v116
v_mul_f32 v229, v117, v117
v_mul_f32 v230, v118, v118
v_mul_f32 v231, v119, v119
v_mfma_f32_32x32x16_bf16 v[124:139], a[144:147], a[68:71], v[124:139]
ds_read_b128 a[164:167], v245 offset:22528
v_fma_f32 v228, v228, v237, v236
v_fma_f32 v229, v229, v237, v236
v_fma_f32 v230, v230, v237, v236
v_fma_f32 v231, v231, v237, v236
s_waitcnt lgkmcnt(3)
v_mfma_f32_32x32x16_bf16 v[124:139], a[148:151], a[72:75], v[124:139]
ds_read_b128 a[144:147], v245 offset:23552
v_mul_f32 v228, v228, v116
v_mul_f32 v229, v229, v117
v_mul_f32 v230, v230, v118
v_mul_f32 v231, v231, v119
v_exp_f32 v228, v228
v_mfma_f32_32x32x16_bf16 v[124:139], a[152:155], a[76:79], v[124:139]
ds_read_b128 a[148:151], v245 offset:24576
v_exp_f32 v229, v229
v_exp_f32 v230, v230
s_waitcnt lgkmcnt(3)
v_mfma_f32_32x32x16_bf16 v[124:139], a[156:159], a[80:83], v[124:139]
ds_read_b128 a[152:155], v245 offset:25600
v_exp_f32 v231, v231
v_fma_f32 v228, v228, v238, v238
v_fma_f32 v229, v229, v238, v238
v_mfma_f32_32x32x16_bf16 v[124:139], a[160:163], a[84:87], v[124:139]
ds_read_b128 a[156:159], v245 offset:26624
v_fma_f32 v230, v230, v238, v238
v_fma_f32 v231, v231, v238, v238
v_rcp_f32 v228, v228
s_waitcnt lgkmcnt(3)
v_mfma_f32_32x32x16_bf16 v[124:139], a[164:167], a[88:91], v[124:139]
ds_read_b128 a[160:163], v245 offset:27648
v_rcp_f32 v229, v229
v_rcp_f32 v230, v230
v_rcp_f32 v231, v231
v_mfma_f32_32x32x16_bf16 v[124:139], a[144:147], a[92:95], v[124:139]
ds_read_b128 a[164:167], v245 offset:28672
v_mul_f32 v60, v116, v228
v_mul_f32 v61, v117, v229
v_mul_f32 v62, v118, v230
s_waitcnt lgkmcnt(3)
v_mfma_f32_32x32x16_bf16 v[124:139], a[148:151], a[96:99], v[124:139]
ds_read_b128 a[144:147], v245 offset:29696
v_mul_f32 v63, v119, v231
v_mul_f32 v232, v120, v120
v_mul_f32 v233, v121, v121
v_mul_f32 v234, v122, v122
v_mul_f32 v235, v123, v123
v_mfma_f32_32x32x16_bf16 v[124:139], a[152:155], a[100:103], v[124:139]
ds_read_b128 a[148:151], v245 offset:30720
v_fma_f32 v232, v232, v237, v236
v_fma_f32 v233, v233, v237, v236
v_fma_f32 v234, v234, v237, v236
v_fma_f32 v235, v235, v237, v236
s_waitcnt lgkmcnt(3)
v_mfma_f32_32x32x16_bf16 v[124:139], a[156:159], a[104:107], v[124:139]
ds_read_b128 a[152:155], v245 offset:31744
v_mul_f32 v232, v232, v120
v_mul_f32 v233, v233, v121
v_mul_f32 v234, v234, v122
v_mul_f32 v235, v235, v123
v_mfma_f32_32x32x16_bf16 v[124:139], a[160:163], a[108:111], v[124:139]
ds_read_b128 a[156:159], v245 offset:32768
v_exp_f32 v232, v232
v_exp_f32 v233, v233
v_exp_f32 v234, v234
s_waitcnt lgkmcnt(3)
v_mfma_f32_32x32x16_bf16 v[124:139], a[164:167], a[112:115], v[124:139]
ds_read_b128 a[160:163], v245 offset:33792
v_exp_f32 v235, v235
v_fma_f32 v232, v232, v238, v238
v_mfma_f32_32x32x16_bf16 v[124:139], a[144:147], a[116:119], v[124:139]
ds_read_b128 a[164:167], v245 offset:34816
v_fma_f32 v233, v233, v238, v238
v_fma_f32 v234, v234, v238, v238
v_fma_f32 v235, v235, v238, v238
v_rcp_f32 v232, v232
s_waitcnt lgkmcnt(3)
v_mfma_f32_32x32x16_bf16 v[124:139], a[148:151], a[120:123], v[124:139]
ds_read_b128 a[144:147], v245 offset:35840
v_rcp_f32 v233, v233
v_rcp_f32 v234, v234
v_mfma_f32_32x32x16_bf16 v[124:139], a[152:155], a[124:127], v[124:139]
ds_read_b128 a[148:151], v245 offset:36864
v_rcp_f32 v235, v235
v_mul_f32 v64, v120, v232
v_mul_f32 v65, v121, v233
v_mul_f32 v66, v122, v234
s_waitcnt lgkmcnt(3)
v_mfma_f32_32x32x16_bf16 v[124:139], a[156:159], a[128:131], v[124:139]
ds_read_b128 a[152:155], v242 offset:0
v_mul_f32 v67, v123, v235
v_permlane16_swap_b32 v36, v40
v_permlane16_swap_b32 v37, v41
v_mfma_f32_32x32x16_bf16 v[124:139], a[160:163], a[132:135], v[124:139]
ds_read_b128 a[156:159], v242 offset:1024
v_permlane16_swap_b32 v38, v42
v_permlane16_swap_b32 v39, v43
s_waitcnt lgkmcnt(3)
v_mfma_f32_32x32x16_bf16 v[124:139], a[164:167], a[136:139], v[124:139]
ds_read_b128 a[160:163], v242 offset:2048
v_permlane16_swap_b32 v44, v48
v_permlane16_swap_b32 v45, v49
v_mfma_f32_32x32x16_bf16 v[124:139], a[144:147], a[140:143], v[124:139]
ds_read_b128 a[164:167], v242 offset:3072
v_permlane16_swap_b32 v46, v50
v_permlane16_swap_b32 v47, v51
s_waitcnt lgkmcnt(4)
v_mfma_f32_32x32x16_bf16 v[124:139], a[148:151], v[248:251], v[124:139]
ds_read_b128 a[144:147], v242 offset:4096
s_barrier
s_waitcnt lgkmcnt(3)
v_mfma_f32_32x32x16_bf16 v[108:123], a[152:155], a[0:3], 0
ds_read_b128 a[148:151], v242 offset:5120
v_mfma_f32_32x32x16_bf16 v[108:123], a[156:159], a[4:7], v[108:123]
ds_read_b128 a[152:155], v242 offset:6144
s_waitcnt lgkmcnt(3)
v_mfma_f32_32x32x16_bf16 v[108:123], a[160:163], a[8:11], v[108:123]
ds_read_b128 a[156:159], v242 offset:7168
v_mfma_f32_32x32x16_bf16 v[108:123], a[164:167], a[12:15], v[108:123]
ds_read_b128 a[160:163], v242 offset:8192
v_mul_f32 v228, v124, v124
v_mul_f32 v229, v125, v125
v_mul_f32 v230, v126, v126
v_mul_f32 v231, v127, v127
v_fma_f32 v228, v228, v237, v236
v_fma_f32 v229, v229, v237, v236
v_fma_f32 v230, v230, v237, v236
v_fma_f32 v231, v231, v237, v236
v_mul_f32 v228, v228, v124
v_mul_f32 v229, v229, v125
v_mul_f32 v230, v230, v126
v_mul_f32 v231, v231, v127
v_exp_f32 v228, v228
v_exp_f32 v229, v229
v_exp_f32 v230, v230
v_exp_f32 v231, v231
s_waitcnt lgkmcnt(3)
v_mfma_f32_32x32x16_bf16 v[108:123], a[144:147], a[16:19], v[108:123]
ds_read_b128 a[164:167], v242 offset:9216
v_fma_f32 v228, v228, v238, v238
v_fma_f32 v229, v229, v238, v238
v_fma_f32 v230, v230, v238, v238
v_fma_f32 v231, v231, v238, v238
v_rcp_f32 v228, v228
v_mfma_f32_32x32x16_bf16 v[108:123], a[148:151], a[20:23], v[108:123]
ds_read_b128 a[144:147], v242 offset:10240
v_rcp_f32 v229, v229
v_rcp_f32 v230, v230
s_waitcnt lgkmcnt(3)
v_mfma_f32_32x32x16_bf16 v[108:123], a[152:155], a[24:27], v[108:123]
ds_read_b128 a[148:151], v242 offset:11264
v_rcp_f32 v231, v231
v_mul_f32 v68, v124, v228
v_mul_f32 v69, v125, v229
v_mul_f32 v70, v126, v230
v_mfma_f32_32x32x16_bf16 v[108:123], a[156:159], a[28:31], v[108:123]
ds_read_b128 a[152:155], v242 offset:12288
v_mul_f32 v71, v127, v231
v_mul_f32 v232, v128, v128
v_mul_f32 v233, v129, v129
v_mul_f32 v234, v130, v130
v_mul_f32 v235, v131, v131
s_waitcnt lgkmcnt(3)
v_mfma_f32_32x32x16_bf16 v[108:123], a[160:163], a[32:35], v[108:123]
ds_read_b128 a[156:159], v242 offset:13312
v_fma_f32 v232, v232, v237, v236
v_fma_f32 v233, v233, v237, v236
v_fma_f32 v234, v234, v237, v236
v_fma_f32 v235, v235, v237, v236
v_mfma_f32_32x32x16_bf16 v[108:123], a[164:167], a[36:39], v[108:123]
ds_read_b128 a[160:163], v242 offset:14336
v_mul_f32 v232, v232, v128
v_mul_f32 v233, v233, v129
v_mul_f32 v234, v234, v130
v_mul_f32 v235, v235, v131
v_exp_f32 v232, v232
s_waitcnt lgkmcnt(3)
v_mfma_f32_32x32x16_bf16 v[108:123], a[144:147], a[40:43], v[108:123]
ds_read_b128 a[164:167], v242 offset:15360
v_exp_f32 v233, v233
v_exp_f32 v234, v234
v_mfma_f32_32x32x16_bf16 v[108:123], a[148:151], a[44:47], v[108:123]
ds_read_b128 a[144:147], v242 offset:16384
v_exp_f32 v235, v235
v_fma_f32 v232, v232, v238, v238
v_fma_f32 v233, v233, v238, v238
v_fma_f32 v234, v234, v238, v238
s_waitcnt lgkmcnt(3)
v_mfma_f32_32x32x16_bf16 v[108:123], a[152:155], a[48:51], v[108:123]
ds_read_b128 a[148:151], v242 offset:17408
v_fma_f32 v235, v235, v238, v238
v_rcp_f32 v232, v232
v_rcp_f32 v233, v233
v_mfma_f32_32x32x16_bf16 v[108:123], a[156:159], a[52:55], v[108:123]
ds_read_b128 a[152:155], v242 offset:18432
v_rcp_f32 v234, v234
v_rcp_f32 v235, v235
v_mul_f32 v72, v128, v232
s_waitcnt lgkmcnt(3)
v_mfma_f32_32x32x16_bf16 v[108:123], a[160:163], a[56:59], v[108:123]
ds_read_b128 a[156:159], v242 offset:19456
v_mul_f32 v73, v129, v233
v_mul_f32 v74, v130, v234
v_mul_f32 v75, v131, v235
v_mul_f32 v228, v132, v132
v_mul_f32 v229, v133, v133
v_mfma_f32_32x32x16_bf16 v[108:123], a[164:167], a[60:63], v[108:123]
ds_read_b128 a[160:163], v242 offset:20480
v_mul_f32 v230, v134, v134
v_mul_f32 v231, v135, v135
v_fma_f32 v228, v228, v237, v236
v_fma_f32 v229, v229, v237, v236
v_fma_f32 v230, v230, v237, v236
s_waitcnt lgkmcnt(3)
v_mfma_f32_32x32x16_bf16 v[108:123], a[144:147], a[64:67], v[108:123]
ds_read_b128 a[164:167], v242 offset:21504
v_fma_f32 v231, v231, v237, v236
v_mul_f32 v228, v228, v132
v_mul_f32 v229, v229, v133
v_mul_f32 v230, v230, v134
v_mul_f32 v231, v231, v135
v_mfma_f32_32x32x16_bf16 v[108:123], a[148:151], a[68:71], v[108:123]
ds_read_b128 a[144:147], v242 offset:22528
v_exp_f32 v228, v228
v_exp_f32 v229, v229
s_waitcnt lgkmcnt(3)
v_mfma_f32_32x32x16_bf16 v[108:123], a[152:155], a[72:75], v[108:123]
ds_read_b128 a[148:151], v242 offset:23552
v_exp_f32 v230, v230
v_exp_f32 v231, v231
v_fma_f32 v228, v228, v238, v238
v_mfma_f32_32x32x16_bf16 v[108:123], a[156:159], a[76:79], v[108:123]
ds_read_b128 a[152:155], v242 offset:24576
v_fma_f32 v229, v229, v238, v238
v_fma_f32 v230, v230, v238, v238
v_fma_f32 v231, v231, v238, v238
v_rcp_f32 v228, v228
s_waitcnt lgkmcnt(3)
v_mfma_f32_32x32x16_bf16 v[108:123], a[160:163], a[80:83], v[108:123]
ds_read_b128 a[156:159], v242 offset:25600
v_rcp_f32 v229, v229
v_rcp_f32 v230, v230
v_rcp_f32 v231, v231
v_mfma_f32_32x32x16_bf16 v[108:123], a[164:167], a[84:87], v[108:123]
ds_read_b128 a[160:163], v242 offset:26624
v_mul_f32 v76, v132, v228
v_mul_f32 v77, v133, v229
v_mul_f32 v78, v134, v230
v_mul_f32 v79, v135, v231
s_waitcnt lgkmcnt(3)
v_mfma_f32_32x32x16_bf16 v[108:123], a[144:147], a[88:91], v[108:123]
ds_read_b128 a[164:167], v242 offset:27648
v_mul_f32 v232, v136, v136
v_mul_f32 v233, v137, v137
v_mul_f32 v234, v138, v138
v_mul_f32 v235, v139, v139
v_fma_f32 v232, v232, v237, v236
v_mfma_f32_32x32x16_bf16 v[108:123], a[148:151], a[92:95], v[108:123]
ds_read_b128 a[144:147], v242 offset:28672
v_fma_f32 v233, v233, v237, v236
v_fma_f32 v234, v234, v237, v236
v_fma_f32 v235, v235, v237, v236
v_mul_f32 v232, v232, v136
v_mul_f32 v233, v233, v137
s_waitcnt lgkmcnt(3)
v_mfma_f32_32x32x16_bf16 v[108:123], a[152:155], a[96:99], v[108:123]
ds_read_b128 a[148:151], v242 offset:29696
v_mul_f32 v234, v234, v138
v_mul_f32 v235, v235, v139
v_exp_f32 v232, v232
v_exp_f32 v233, v233
v_mfma_f32_32x32x16_bf16 v[108:123], a[156:159], a[100:103], v[108:123]
ds_read_b128 a[152:155], v242 offset:30720
v_exp_f32 v234, v234
v_exp_f32 v235, v235
s_waitcnt lgkmcnt(3)
v_mfma_f32_32x32x16_bf16 v[108:123], a[160:163], a[104:107], v[108:123]
ds_read_b128 a[156:159], v242 offset:31744
v_fma_f32 v232, v232, v238, v238
v_fma_f32 v233, v233, v238, v238
v_fma_f32 v234, v234, v238, v238
v_fma_f32 v235, v235, v238, v238
v_mfma_f32_32x32x16_bf16 v[108:123], a[164:167], a[108:111], v[108:123]
ds_read_b128 a[160:163], v242 offset:32768
v_rcp_f32 v232, v232
v_rcp_f32 v233, v233
v_rcp_f32 v234, v234
s_waitcnt lgkmcnt(3)
v_mfma_f32_32x32x16_bf16 v[108:123], a[144:147], a[112:115], v[108:123]
ds_read_b128 a[164:167], v242 offset:33792
v_rcp_f32 v235, v235
v_mul_f32 v80, v136, v232
v_mul_f32 v81, v137, v233
v_mfma_f32_32x32x16_bf16 v[108:123], a[148:151], a[116:119], v[108:123]
ds_read_b128 a[144:147], v242 offset:34816
v_mul_f32 v82, v138, v234
v_mul_f32 v83, v139, v235
v_permlane16_swap_b32 v52, v56
v_permlane16_swap_b32 v53, v57
s_waitcnt lgkmcnt(3)
v_mfma_f32_32x32x16_bf16 v[108:123], a[152:155], a[120:123], v[108:123]
ds_read_b128 a[148:151], v242 offset:35840
v_permlane16_swap_b32 v54, v58
v_permlane16_swap_b32 v55, v59
v_mfma_f32_32x32x16_bf16 v[108:123], a[156:159], a[124:127], v[108:123]
ds_read_b128 a[152:155], v242 offset:36864
v_permlane16_swap_b32 v60, v64
v_permlane16_swap_b32 v61, v65
v_permlane16_swap_b32 v62, v66
s_waitcnt lgkmcnt(3)
v_mfma_f32_32x32x16_bf16 v[108:123], a[160:163], a[128:131], v[108:123]
v_permlane16_swap_b32 v63, v67
buffer_load_dwordx2 v[212:213], v6, s[8:11], s61 offen offset:0 sc1
s_waitcnt lgkmcnt(3)
v_mfma_f32_32x32x16_bf16 v[108:123], a[164:167], a[132:135], v[108:123]
buffer_load_dwordx2 v[214:215], v6, s[8:11], s61 offen offset:1024 sc1
buffer_load_dwordx2 v[216:217], v6, s[8:11], s61 offen offset:2048 sc1
buffer_load_dwordx2 v[218:219], v6, s[8:11], s61 offen offset:3072 sc1
s_waitcnt lgkmcnt(1)
v_mfma_f32_32x32x16_bf16 v[108:123], a[144:147], a[136:139], v[108:123]
buffer_load_dwordx2 v[220:221], v7, s[8:11], s61 offen offset:0 sc1
buffer_load_dwordx2 v[222:223], v7, s[8:11], s61 offen offset:1024 sc1
s_waitcnt lgkmcnt(1)
v_mfma_f32_32x32x16_bf16 v[108:123], a[148:151], a[140:143], v[108:123]
buffer_load_dwordx2 v[224:225], v7, s[8:11], s61 offen offset:2048 sc1
buffer_load_dwordx2 v[226:227], v7, s[8:11], s61 offen offset:3072 sc1
s_waitcnt lgkmcnt(0)
v_mfma_f32_32x32x16_bf16 v[108:123], a[152:155], v[248:251], v[108:123]
s_waitcnt lgkmcnt(0)
s_memrealtime s[58:59]
s_waitcnt lgkmcnt(0)
s_mov_b32 m0, s56
s_nop 0
v_writelane_b32 v5, s58, m0
s_add_u32 s56, s56, 1
s_nop 7
v_permlane16_swap_b32 v68, v72
v_permlane16_swap_b32 v69, v73
v_permlane16_swap_b32 v70, v74
v_permlane16_swap_b32 v71, v75
v_permlane16_swap_b32 v76, v80
v_permlane16_swap_b32 v77, v81
v_permlane16_swap_b32 v78, v82
v_permlane16_swap_b32 v79, v83
v_mul_f32 v228, v108, v108
v_mul_f32 v229, v109, v109
v_mul_f32 v230, v110, v110
v_mul_f32 v231, v111, v111
v_fma_f32 v228, v228, v237, v236
v_fma_f32 v229, v229, v237, v236
v_fma_f32 v230, v230, v237, v236
v_fma_f32 v231, v231, v237, v236
v_mul_f32 v228, v228, v108
v_mul_f32 v229, v229, v109
v_mul_f32 v230, v230, v110
v_mul_f32 v231, v231, v111
v_exp_f32 v228, v228
v_exp_f32 v229, v229
v_exp_f32 v230, v230
v_exp_f32 v231, v231
v_fma_f32 v228, v228, v238, v238
v_fma_f32 v229, v229, v238, v238
v_fma_f32 v230, v230, v238, v238
v_fma_f32 v231, v231, v238, v238
v_rcp_f32 v228, v228
v_rcp_f32 v229, v229
v_rcp_f32 v230, v230
v_rcp_f32 v231, v231
v_mul_f32 v84, v108, v228
v_mul_f32 v85, v109, v229
v_mul_f32 v86, v110, v230
v_mul_f32 v87, v111, v231
v_mul_f32 v232, v112, v112
v_mul_f32 v233, v113, v113
v_mul_f32 v234, v114, v114
v_mul_f32 v235, v115, v115
v_fma_f32 v232, v232, v237, v236
v_fma_f32 v233, v233, v237, v236
v_fma_f32 v234, v234, v237, v236
v_fma_f32 v235, v235, v237, v236
v_mul_f32 v232, v232, v112
v_mul_f32 v233, v233, v113
v_mul_f32 v234, v234, v114
v_mul_f32 v235, v235, v115
v_exp_f32 v232, v232
v_exp_f32 v233, v233
v_exp_f32 v234, v234
v_exp_f32 v235, v235
v_fma_f32 v232, v232, v238, v238
v_fma_f32 v233, v233, v238, v238
v_fma_f32 v234, v234, v238, v238
v_fma_f32 v235, v235, v238, v238
v_rcp_f32 v232, v232
v_rcp_f32 v233, v233
v_rcp_f32 v234, v234
v_rcp_f32 v235, v235
v_mul_f32 v88, v112, v232
v_mul_f32 v89, v113, v233
v_mul_f32 v90, v114, v234
v_mul_f32 v91, v115, v235
v_mul_f32 v228, v116, v116
v_mul_f32 v229, v117, v117
v_mul_f32 v230, v118, v118
v_mul_f32 v231, v119, v119
v_fma_f32 v228, v228, v237, v236
v_fma_f32 v229, v229, v237, v236
v_fma_f32 v230, v230, v237, v236
v_fma_f32 v231, v231, v237, v236
v_mul_f32 v228, v228, v116
v_mul_f32 v229, v229, v117
v_mul_f32 v230, v230, v118
v_mul_f32 v231, v231, v119
v_exp_f32 v228, v228
v_exp_f32 v229, v229
v_exp_f32 v230, v230
v_exp_f32 v231, v231
v_fma_f32 v228, v228, v238, v238
v_fma_f32 v229, v229, v238, v238
v_fma_f32 v230, v230, v238, v238
v_fma_f32 v231, v231, v238, v238
v_rcp_f32 v228, v228
v_rcp_f32 v229, v229
v_rcp_f32 v230, v230
v_rcp_f32 v231, v231
v_mul_f32 v92, v116, v228
v_mul_f32 v93, v117, v229
v_mul_f32 v94, v118, v230
v_mul_f32 v95, v119, v231
v_mul_f32 v232, v120, v120
v_mul_f32 v233, v121, v121
v_mul_f32 v234, v122, v122
v_mul_f32 v235, v123, v123
v_fma_f32 v232, v232, v237, v236
v_fma_f32 v233, v233, v237, v236
v_fma_f32 v234, v234, v237, v236
v_fma_f32 v235, v235, v237, v236
v_mul_f32 v232, v232, v120
v_mul_f32 v233, v233, v121
v_mul_f32 v234, v234, v122
v_mul_f32 v235, v235, v123
v_exp_f32 v232, v232
v_exp_f32 v233, v233
v_exp_f32 v234, v234
v_exp_f32 v235, v235
v_fma_f32 v232, v232, v238, v238
v_fma_f32 v233, v233, v238, v238
v_fma_f32 v234, v234, v238, v238
v_fma_f32 v235, v235, v238, v238
v_rcp_f32 v232, v232
v_rcp_f32 v233, v233
v_rcp_f32 v234, v234
v_rcp_f32 v235, v235
v_mul_f32 v96, v120, v232
v_mul_f32 v97, v121, v233
v_mul_f32 v98, v122, v234
v_mul_f32 v99, v123, v235
s_mov_b32 s31, 0
s_waitcnt vmcnt(0)
L_stz_7:
v_cmp_eq_u32 vcc, 3212836864, v213
v_mov_b32 v230, 3212836864
s_mov_b64 s[34:35], vcc
v_cmp_eq_u32 s[32:33], v230, v215
s_nop 0
s_or_b64 s[34:35], s[34:35], s[32:33]
v_cmp_eq_u32 s[32:33], v230, v217
s_nop 0
s_or_b64 s[34:35], s[34:35], s[32:33]
v_cmp_eq_u32 s[32:33], v230, v219
s_nop 0
s_or_b64 s[34:35], s[34:35], s[32:33]
v_cmp_eq_u32 s[32:33], v230, v221
s_nop 0
s_or_b64 s[34:35], s[34:35], s[32:33]
v_cmp_eq_u32 s[32:33], v230, v223
s_nop 0
s_or_b64 s[34:35], s[34:35], s[32:33]
v_cmp_eq_u32 s[32:33], v230, v225
s_nop 0
s_or_b64 s[34:35], s[34:35], s[32:33]
v_cmp_eq_u32 s[32:33], v230, v227
s_nop 0
s_or_b64 s[34:35], s[34:35], s[32:33]
s_cbranch_scc0 L_stzok_8
s_add_u32 s31, s31, 1
s_cmp_gt_u32 s31, 200000
s_cbranch_scc1 L_stzok_8
buffer_load_dwordx2 v[212:213], v6, s[8:11], s61 offen offset:0 sc1
buffer_load_dwordx2 v[214:215], v6, s[8:11], s61 offen offset:1024 sc1
buffer_load_dwordx2 v[216:217], v6, s[8:11], s61 offen offset:2048 sc1
buffer_load_dwordx2 v[218:219], v6, s[8:11], s61 offen offset:3072 sc1
buffer_load_dwordx2 v[220:221], v7, s[8:11], s61 offen offset:0 sc1
buffer_load_dwordx2 v[222:223], v7, s[8:11], s61 offen offset:1024 sc1
buffer_load_dwordx2 v[224:225], v7, s[8:11], s61 offen offset:2048 sc1
buffer_load_dwordx2 v[226:227], v7, s[8:11], s61 offen offset:3072 sc1
s_waitcnt vmcnt(0)
s_branch L_stz_7
L_stzok_8:
v_permlane16_swap_b32 v84, v88
v_permlane16_swap_b32 v85, v89
v_permlane16_swap_b32 v86, v90
v_permlane16_swap_b32 v87, v91
v_permlane16_swap_b32 v92, v96
v_permlane16_swap_b32 v93, v97
v_permlane16_swap_b32 v94, v98
v_permlane16_swap_b32 v95, v99
v_add_f32 v228, v212, v214
v_add_f32 v229, v213, v215
v_add_f32 v228, v228, v216
v_add_f32 v229, v229, v217
v_add_f32 v228, v228, v218
v_add_f32 v229, v229, v219
v_add_f32 v228, v228, v220
v_add_f32 v229, v229, v221
v_add_f32 v228, v228, v222
v_add_f32 v229, v229, v223
v_add_f32 v228, v228, v224
v_add_f32 v229, v229, v225
v_add_f32 v228, v228, v226
v_add_f32 v229, v229, v227
v_mov_b32 v230, v228
v_mov_b32 v231, v229
s_mul_i32 s30, s24, 9728
s_add_u32 s30, s30, 124928
v_permlane32_swap_b32 v228, v230
v_permlane32_swap_b32 v229, v231
v_add_f32 v228, v228, v230
v_add_f32 v229, v229, v231
v_mul_f32 v228, 0x39e38e39, v228
v_mul_f32 v230, v228, v228
v_mul_f32 v229, 0x39e38e39, v229
v_sub_f32 v229, v229, v230
v_max_f32 v229, 0, v229
v_add_f32 v229, 0x3727c5ac, v229
v_rsq_f32 v230, v229
v_bfe_u32 v6, v1, 4, 5
v_mul_u32_u24 v212, 304, v6
v_add_u32 v212, s30, v212
v_lshrrev_b32 v6, 1, v3
v_lshl_add_u32 v7, v6, 4, v212
v_lshl_add_u32 v212, v6, 5, v212
v_mul_f32 v232, v228, v230
v_lshrrev_b32 v6, 2, v2
v_lshl_add_u32 v6, v3, 3, v6
v_mul_u32_u24 v213, 304, v6
v_and_b32 v6, 3, v2
v_lshl_add_u32 v213, v6, 3, v213
v_add_u32 v213, s30, v213
v_pk_fma_f32 v[140:141], v[140:141], v[230:231], v[232:233] op_sel_hi:[1,0,0] neg_lo:[0,0,1] neg_hi:[0,0,1]
v_pk_fma_f32 v[142:143], v[142:143], v[230:231], v[232:233] op_sel_hi:[1,0,0] neg_lo:[0,0,1] neg_hi:[0,0,1]
v_pk_fma_f32 v[144:145], v[144:145], v[230:231], v[232:233] op_sel_hi:[1,0,0] neg_lo:[0,0,1] neg_hi:[0,0,1]
v_pk_fma_f32 v[146:147], v[146:147], v[230:231], v[232:233] op_sel_hi:[1,0,0] neg_lo:[0,0,1] neg_hi:[0,0,1]
v_cvt_pk_bf16_f32 v108, v140, v141
v_cvt_pk_bf16_f32 v109, v142, v143
v_cvt_pk_bf16_f32 v110, v144, v145
v_cvt_pk_bf16_f32 v111, v146, v147
ds_write_b128 v212, v[108:111] offset:0
v_pk_fma_f32 v[148:149], v[148:149], v[230:231], v[232:233] op_sel_hi:[1,0,0] neg_lo:[0,0,1] neg_hi:[0,0,1]
v_pk_fma_f32 v[150:151], v[150:151], v[230:231], v[232:233] op_sel_hi:[1,0,0] neg_lo:[0,0,1] neg_hi:[0,0,1]
v_pk_fma_f32 v[152:153], v[152:153], v[230:231], v[232:233] op_sel_hi:[1,0,0] neg_lo:[0,0,1] neg_hi:[0,0,1]
v_pk_fma_f32 v[154:155], v[154:155], v[230:231], v[232:233] op_sel_hi:[1,0,0] neg_lo:[0,0,1] neg_hi:[0,0,1]
v_cvt_pk_bf16_f32 v112, v148, v149
v_cvt_pk_bf16_f32 v113, v150, v151
v_cvt_pk_bf16_f32 v114, v152, v153
v_cvt_pk_bf16_f32 v115, v154, v155
ds_write_b128 v212, v[112:115] offset:16
v_pk_fma_f32 v[156:157], v[156:157], v[230:231], v[232:233] op_sel_hi:[1,0,0] neg_lo:[0,0,1] neg_hi:[0,0,1]
v_pk_fma_f32 v[158:159], v[158:159], v[230:231], v[232:233] op_sel_hi:[1,0,0] neg_lo:[0,0,1] neg_hi:[0,0,1]
v_pk_fma_f32 v[160:161], v[160:161], v[230:231], v[232:233] op_sel_hi:[1,0,0] neg_lo:[0,0,1] neg_hi:[0,0,1]
v_pk_fma_f32 v[162:163], v[162:163], v[230:231], v[232:233] op_sel_hi:[1,0,0] neg_lo:[0,0,1] neg_hi:[0,0,1]
v_cvt_pk_bf16_f32 v116, v156, v157
v_cvt_pk_bf16_f32 v117, v158, v159
v_cvt_pk_bf16_f32 v118, v160, v161
v_cvt_pk_bf16_f32 v119, v162, v163
ds_write_b128 v212, v[116:119] offset:64
v_pk_fma_f32 v[164:165], v[164:165], v[230:231], v[232:233] op_sel_hi:[1,0,0] neg_lo:[0,0,1] neg_hi:[0,0,1]
v_pk_fma_f32 v[166:167], v[166:167], v[230:231], v[232:233] op_sel_hi:[1,0,0] neg_lo:[0,0,1] neg_hi:[0,0,1]
v_pk_fma_f32 v[168:169], v[168:169], v[230:231], v[232:233] op_sel_hi:[1,0,0] neg_lo:[0,0,1] neg_hi:[0,0,1]
v_pk_fma_f32 v[170:171], v[170:171], v[230:231], v[232:233] op_sel_hi:[1,0,0] neg_lo:[0,0,1] neg_hi:[0,0,1]
v_cvt_pk_bf16_f32 v120, v164, v165
v_cvt_pk_bf16_f32 v121, v166, v167
v_cvt_pk_bf16_f32 v122, v168, v169
v_cvt_pk_bf16_f32 v123, v170, v171
ds_write_b128 v212, v[120:123] offset:80
v_pk_fma_f32 v[172:173], v[172:173], v[230:231], v[232:233] op_sel_hi:[1,0,0] neg_lo:[0,0,1] neg_hi:[0,0,1]
v_pk_fma_f32 v[174:175], v[174:175], v[230:231], v[232:233] op_sel_hi:[1,0,0] neg_lo:[0,0,1] neg_hi:[0,0,1]
v_pk_fma_f32 v[176:177], v[176:177], v[230:231], v[232:233] op_sel_hi:[1,0,0] neg_lo:[0,0,1] neg_hi:[0,0,1]
v_pk_fma_f32 v[178:179], v[178:179], v[230:231], v[232:233] op_sel_hi:[1,0,0] neg_lo:[0,0,1] neg_hi:[0,0,1]
v_cvt_pk_bf16_f32 v124, v172, v173
v_cvt_pk_bf16_f32 v125, v174, v175
v_cvt_pk_bf16_f32 v126, v176, v177
v_cvt_pk_bf16_f32 v127, v178, v179
ds_write_b128 v212, v[124:127] offset:128
v_pk_fma_f32 v[180:181], v[180:181], v[230:231], v[232:233] op_sel_hi:[1,0,0] neg_lo:[0,0,1] neg_hi:[0,0,1]
v_pk_fma_f32 v[182:183], v[182:183], v[230:231], v[232:233] op_sel_hi:[1,0,0] neg_lo:[0,0,1] neg_hi:[0,0,1]
v_pk_fma_f32 v[184:185], v[184:185], v[230:231], v[232:233] op_sel_hi:[1,0,0] neg_lo:[0,0,1] neg_hi:[0,0,1]
v_pk_fma_f32 v[186:187], v[186:187], v[230:231], v[232:233] op_sel_hi:[1,0,0] neg_lo:[0,0,1] neg_hi:[0,0,1]
v_cvt_pk_bf16_f32 v128, v180, v181
v_cvt_pk_bf16_f32 v129, v182, v183
v_cvt_pk_bf16_f32 v130, v184, v185
v_cvt_pk_bf16_f32 v131, v186, v187
ds_write_b128 v212, v[128:131] offset:144
v_pk_fma_f32 v[188:189], v[188:189], v[230:231], v[232:233] op_sel_hi:[1,0,0] neg_lo:[0,0,1] neg_hi:[0,0,1]
v_pk_fma_f32 v[190:191], v[190:191], v[230:231], v[232:233] op_sel_hi:[1,0,0] neg_lo:[0,0,1] neg_hi:[0,0,1]
v_pk_fma_f32 v[192:193], v[192:193], v[230:231], v[232:233] op_sel_hi:[1,0,0] neg_lo:[0,0,1] neg_hi:[0,0,1]
v_pk_fma_f32 v[194:195], v[194:195], v[230:231], v[232:233] op_sel_hi:[1,0,0] neg_lo:[0,0,1] neg_hi:[0,0,1]
v_cvt_pk_bf16_f32 v132, v188, v189
v_cvt_pk_bf16_f32 v133, v190, v191
v_cvt_pk_bf16_f32 v134, v192, v193
v_cvt_pk_bf16_f32 v135, v194, v195
ds_write_b128 v212, v[132:135] offset:192
v_pk_fma_f32 v[196:197], v[196:197], v[230:231], v[232:233] op_sel_hi:[1,0,0] neg_lo:[0,0,1] neg_hi:[0,0,1]
v_pk_fma_f32 v[198:199], v[198:199], v[230:231], v[232:233] op_sel_hi:[1,0,0] neg_lo:[0,0,1] neg_hi:[0,0,1]
v_pk_fma_f32 v[200:201], v[200:201], v[230:231], v[232:233] op_sel_hi:[1,0,0] neg_lo:[0,0,1] neg_hi:[0,0,1]
v_pk_fma_f32 v[202:203], v[202:203], v[230:231], v[232:233] op_sel_hi:[1,0,0] neg_lo:[0,0,1] neg_hi:[0,0,1]
v_cvt_pk_bf16_f32 v136, v196, v197
v_cvt_pk_bf16_f32 v137, v198, v199
v_cvt_pk_bf16_f32 v138, v200, v201
v_cvt_pk_bf16_f32 v139, v202, v203
ds_write_b128 v212, v[136:139] offset:208
v_pk_fma_f32 v[204:205], v[204:205], v[230:231], v[232:233] op_sel_hi:[1,0,0] neg_lo:[0,0,1] neg_hi:[0,0,1]
v_pk_fma_f32 v[206:207], v[206:207], v[230:231], v[232:233] op_sel_hi:[1,0,0] neg_lo:[0,0,1] neg_hi:[0,0,1]
v_pk_fma_f32 v[208:209], v[208:209], v[230:231], v[232:233] op_sel_hi:[1,0,0] neg_lo:[0,0,1] neg_hi:[0,0,1]
v_pk_fma_f32 v[210:211], v[210:211], v[230:231], v[232:233] op_sel_hi:[1,0,0] neg_lo:[0,0,1] neg_hi:[0,0,1]
v_cvt_pk_bf16_f32 v108, v204, v205
v_cvt_pk_bf16_f32 v109, v206, v207
v_cvt_pk_bf16_f32 v110, v208, v209
v_cvt_pk_bf16_f32 v111, v210, v211
ds_write_b128 v7, v[108:111] offset:256
s_mul_i32 s30, s26, 589824
s_mul_i32 s31, s60, 9216
s_add_u32 s30, s30, s31
s_add_u32 s30, s30, 7340032
s_waitcnt lgkmcnt(0)
ds_read_b64_tr_b16 v[140:141], v213 offset:0
ds_read_b64_tr_b16 v[142:143], v213 offset:1216
ds_read_b64_tr_b16 v[144:145], v213 offset:32
ds_read_b64_tr_b16 v[146:147], v213 offset:1248
ds_read_b64_tr_b16 v[148:149], v213 offset:64
ds_read_b64_tr_b16 v[150:151], v213 offset:1280
ds_read_b64_tr_b16 v[152:153], v213 offset:96
ds_read_b64_tr_b16 v[154:155], v213 offset:1312
s_waitcnt lgkmcnt(6)
buffer_store_dwordx4 v[140:143], v1, s[8:11], s30 offen offset:0 sc1
ds_read_b64_tr_b16 v[156:157], v213 offset:128
ds_read_b64_tr_b16 v[158:159], v213 offset:1344
s_waitcnt lgkmcnt(6)
buffer_store_dwordx4 v[144:147], v1, s[8:11], s30 offen offset:1024 sc1
ds_read_b64_tr_b16 v[160:161], v213 offset:160
ds_read_b64_tr_b16 v[162:163], v213 offset:1376
s_waitcnt lgkmcnt(6)
buffer_store_dwordx4 v[148:151], v1, s[8:11], s30 offen offset:2048 sc1
ds_read_b64_tr_b16 v[164:165], v213 offset:192
ds_read_b64_tr_b16 v[166:167], v213 offset:1408
s_waitcnt lgkmcnt(6)
buffer_store_dwordx4 v[152:155], v1, s[8:11], s30 offen offset:3072 sc1
ds_read_b64_tr_b16 v[168:169], v213 offset:224
ds_read_b64_tr_b16 v[170:171], v213 offset:1440
s_add_u32 s30, s30, 4096
s_waitcnt lgkmcnt(6)
buffer_store_dwordx4 v[156:159], v1, s[8:11], s30 offen offset:0 sc1
ds_read_b64_tr_b16 v[172:173], v213 offset:256
ds_read_b64_tr_b16 v[174:175], v213 offset:1472
s_waitcnt lgkmcnt(6)
buffer_store_dwordx4 v[160:163], v1, s[8:11], s30 offen offset:1024 sc1
s_waitcnt lgkmcnt(4)
buffer_store_dwordx4 v[164:167], v1, s[8:11], s30 offen offset:2048 sc1
s_waitcnt lgkmcnt(2)
buffer_store_dwordx4 v[168:171], v1, s[8:11], s30 offen offset:3072 sc1
s_add_u32 s30, s30, 4096
s_waitcnt lgkmcnt(0)
buffer_store_dwordx4 v[172:175], v1, s[8:11], s30 offen offset:0 sc1
s_waitcnt vmcnt(0)
s_barrier
s_cmp_eq_u32 s24, 0
s_cbranch_scc0 L_sig_9
v_lshlrev_b32 v6, 7, v1
s_lshl_b32 s31, s26, 7
s_lshl_b32 s32, s25, 2
s_add_u32 s31, s31, s32
v_add_u32 v6, s31, v6
s_mov_b64 exec, 0xffff
s_mov_b32 s30, 26542080
buffer_store_dword v4, v6, s[8:11], s30 offen sc1
s_mov_b64 exec, -1
L_sig_9:
v_lshrrev_b32 v6, 7, v1
v_bfe_u32 v7, v1, 4, 3
v_lshrrev_b32 v8, 1, v6
v_xor_b32 v7, v7, v8
v_lshlrev_b32 v6, 12, v6
v_lshl_add_u32 v248, v7, 4, v6
v_xor_b32 v6, 64, v248
v_add_u32 v249, 31744, v6
v_add_u32 v250, 63488, v248
v_add_u32 v251, 95232, v6
s_lshl_b32 s64, s25, 19
s_lshl_b32 s30, s24, 17
s_add_u32 s64, s64, s30
s_lshl_b32 s71, s24, 12
s_mov_b32 s65, s71
s_mov_b32 m0, s65
s_add_u32 s65, s65, 16384
buffer_load_dwordx4 v248, s[12:15], s64 offen offset:0 lds
buffer_load_dwordx4 v249, s[12:15], s64 offen offset:1024 lds
buffer_load_dwordx4 v250, s[12:15], s64 offen offset:2048 lds
buffer_load_dwordx4 v251, s[12:15], s64 offen offset:3072 lds
s_add_u32 s64, s64, 128
s_cmp_ge_u32 s65, 98304
s_cselect_b32 s65, s71, s65
s_mov_b32 m0, s65
s_add_u32 s65, s65, 16384
buffer_load_dwordx4 v248, s[12:15], s64 offen offset:0 lds
buffer_load_dwordx4 v249, s[12:15], s64 offen offset:1024 lds
buffer_load_dwordx4 v250, s[12:15], s64 offen offset:2048 lds
buffer_load_dwordx4 v251, s[12:15], s64 offen offset:3072 lds
s_add_u32 s64, s64, 128
s_cmp_ge_u32 s65, 98304
s_cselect_b32 s65, s71, s65
s_mov_b32 m0, s65
s_add_u32 s65, s65, 16384
buffer_load_dwordx4 v248, s[12:15], s64 offen offset:0 lds
buffer_load_dwordx4 v249, s[12:15], s64 offen offset:1024 lds
buffer_load_dwordx4 v250, s[12:15], s64 offen offset:2048 lds
buffer_load_dwordx4 v251, s[12:15], s64 offen offset:3072 lds
s_add_u32 s64, s64, 128
s_cmp_ge_u32 s65, 98304
s_cselect_b32 s65, s71, s65
s_mov_b32 m0, s65
s_add_u32 s65, s65, 16384
buffer_load_dwordx4 v248, s[12:15], s64 offen offset:0 lds
buffer_load_dwordx4 v249, s[12:15], s64 offen offset:1024 lds
buffer_load_dwordx4 v250, s[12:15], s64 offen offset:2048 lds
buffer_load_dwordx4 v251, s[12:15], s64 offen offset:3072 lds
s_add_u32 s64, s64, 128
s_cmp_ge_u32 s65, 98304
s_cselect_b32 s65, s71, s65
s_mov_b32 m0, s65
s_add_u32 s65, s65, 16384
buffer_load_dwordx4 v248, s[12:15], s64 offen offset:0 lds
buffer_load_dwordx4 v249, s[12:15], s64 offen offset:1024 lds
buffer_load_dwordx4 v250, s[12:15], s64 offen offset:2048 lds
buffer_load_dwordx4 v251, s[12:15], s64 offen offset:3072 lds
s_add_u32 s64, s64, 128
s_cmp_ge_u32 s65, 98304
s_cselect_b32 s65, s71, s65
s_cmp_eq_u32 s24, 1
s_cbranch_scc0 L_polled_11
s_lshl_b32 s30, s80, 7
s_add_u32 s30, s30, 26542080
v_lshrrev_b32 v6, 2, v1
s_mov_b32 s31, 0
s_mov_b64 exec, 0xffff
L_poll_10:
buffer_load_dword v7, v6, s[8:11], s30 offen sc1
s_add_u32 s31, s31, 1
s_waitcnt vmcnt(0)
v_cmp_ne_u32 vcc, 1, v7
s_cmp_gt_u32 s31, 200000
s_cbranch_scc1 L_polled_11
s_cbranch_vccnz L_poll_10
L_polled_11:
s_mov_b64 exec, -1
s_waitcnt vmcnt(0)
s_barrier
s_waitcnt lgkmcnt(0)
s_memrealtime s[58:59]
s_waitcnt lgkmcnt(0)
s_mov_b32 m0, s56
s_nop 0
v_writelane_b32 v5, s58, m0
s_add_u32 s56, s56, 1
s_mul_i32 s66, s26, 589824
s_mul_i32 s30, s24, 4608
s_add_u32 s66, s66, s30
s_add_u32 s66, s66, 7340032
s_add_u32 s72, s30, 108544
s_mov_b32 s67, s72
s_lshl_b32 s31, s25, 8
s_lshl_b32 s32, s24, 6
s_add_u32 s31, s31, s32
v_lshlrev_b32 v6, 1, v2
buffer_load_ushort v180, v6, s[20:23], s31 offen
buffer_load_ushort v184, v6, s[20:23], s31 offen offset:32
s_mov_b32 m0, s67
s_add_u32 s30, s66, 4096
buffer_load_dwordx4 v1, s[8:11], s66 offen offset:0 sc1 lds
buffer_load_dwordx4 v1, s[8:11], s66 offen offset:1024 sc1 lds
buffer_load_dwordx4 v1, s[8:11], s66 offen offset:2048 sc1 lds
buffer_load_dwordx4 v1, s[8:11], s66 offen offset:3072 sc1 lds
s_add_u32 m0, s67, 4096
s_mov_b32 exec_hi, 0
buffer_load_dwordx4 v1, s[8:11], s30 offen sc1 lds
s_mov_b64 exec, -1
s_add_u32 s67, s67, 18432
s_add_u32 s66, s66, 18432
s_cmp_ge_u32 s67, 163840
s_cselect_b32 s67, s72, s67
s_mov_b32 m0, s67
s_add_u32 s30, s66, 4096
buffer_load_dwordx4 v1, s[8:11], s66 offen offset:0 sc1 lds
buffer_load_dwordx4 v1, s[8:11], s66 offen offset:1024 sc1 lds
buffer_load_dwordx4 v1, s[8:11], s66 offen offset:2048 sc1 lds
buffer_load_dwordx4 v1, s[8:11], s66 offen offset:3072 sc1 lds
s_add_u32 m0, s67, 4096
s_mov_b32 exec_hi, 0
buffer_load_dwordx4 v1, s[8:11], s30 offen sc1 lds
s_mov_b64 exec, -1
s_add_u32 s67, s67, 18432
s_add_u32 s66, s66, 18432
s_cmp_ge_u32 s67, 163840
s_cselect_b32 s67, s72, s67
s_mov_b32 m0, s67
s_add_u32 s30, s66, 4096
buffer_load_dwordx4 v1, s[8:11], s66 offen offset:0 sc1 lds
buffer_load_dwordx4 v1, s[8:11], s66 offen offset:1024 sc1 lds
buffer_load_dwordx4 v1, s[8:11], s66 offen offset:2048 sc1 lds
buffer_load_dwordx4 v1, s[8:11], s66 offen offset:3072 sc1 lds
s_add_u32 m0, s67, 4096
s_mov_b32 exec_hi, 0
buffer_load_dwordx4 v1, s[8:11], s30 offen sc1 lds
s_mov_b64 exec, -1
s_add_u32 s67, s67, 18432
s_add_u32 s66, s66, 18432
s_cmp_ge_u32 s67, 163840
s_cselect_b32 s67, s72, s67
s_mov_b32 m0, s65
s_add_u32 s65, s65, 16384
buffer_load_dwordx4 v248, s[12:15], s64 offen offset:0 lds
buffer_load_dwordx4 v249, s[12:15], s64 offen offset:1024 lds
buffer_load_dwordx4 v250, s[12:15], s64 offen offset:2048 lds
buffer_load_dwordx4 v251, s[12:15], s64 offen offset:3072 lds
s_add_u32 s64, s64, 128
s_cmp_ge_u32 s65, 98304
s_cselect_b32 s65, s71, s65
v_lshrrev_b32 v6, 1, v2
v_xor_b32 v6, v6, v3
v_lshlrev_b32 v6, 4, v6
v_lshl_add_u32 v6, v2, 7, v6
v_add_u32 v192, s71, v6
v_xor_b32 v193, 64, v192
v_mov_b32 v188, v192
v_mov_b32 v189, v193
v_add_u32 v190, 108544, v1
s_mov_b32 s69, 0
s_mov_b32 s70, 108544
s_mov_b32 s68, 0
s_waitcnt vmcnt(14)
s_barrier
ds_read_b128 a[36:39], v188 offset:0
ds_read_b128 a[40:43], v188 offset:2048
ds_read_b128 a[0:3], v190 offset:0
ds_read_b128 a[4:7], v190 offset:1024
ds_read_b128 a[8:11], v190 offset:2048
ds_read_b128 a[12:15], v190 offset:3072
ds_read_b128 a[16:19], v190 offset:4096
ds_read_b128 a[20:23], v190 offset:5120
ds_read_b128 a[24:27], v190 offset:6144
ds_read_b128 a[28:31], v190 offset:7168
ds_read_b128 a[32:35], v190 offset:8192
v_lshlrev_b32 v180, 16, v180
v_lshlrev_b32 v184, 16, v184
v_mov_b32 v108, v180
v_mov_b32 v109, v180
v_mov_b32 v110, v180
v_mov_b32 v111, v180
v_mov_b32 v112, v184
v_mov_b32 v113, v184
v_mov_b32 v114, v184
v_mov_b32 v115, v184
v_mov_b32 v116, v180
v_mov_b32 v117, v180
v_mov_b32 v118, v180
v_mov_b32 v119, v180
v_mov_b32 v120, v184
v_mov_b32 v121, v184
v_mov_b32 v122, v184
v_mov_b32 v123, v184
v_mov_b32 v124, v180
v_mov_b32 v125, v180
v_mov_b32 v126, v180
v_mov_b32 v127, v180
v_mov_b32 v128, v184
v_mov_b32 v129, v184
v_mov_b32 v130, v184
v_mov_b32 v131, v184
v_mov_b32 v132, v180
v_mov_b32 v133, v180
v_mov_b32 v134, v180
v_mov_b32 v135, v180
v_mov_b32 v136, v184
v_mov_b32 v137, v184
v_mov_b32 v138, v184
v_mov_b32 v139, v184
v_mov_b32 v140, v180
v_mov_b32 v141, v180
v_mov_b32 v142, v180
v_mov_b32 v143, v180
v_mov_b32 v144, v184
v_mov_b32 v145, v184
v_mov_b32 v146, v184
v_mov_b32 v147, v184
v_mov_b32 v148, v180
v_mov_b32 v149, v180
v_mov_b32 v150, v180
v_mov_b32 v151, v180
v_mov_b32 v152, v184
v_mov_b32 v153, v184
v_mov_b32 v154, v184
v_mov_b32 v155, v184
v_mov_b32 v156, v180
v_mov_b32 v157, v180
v_mov_b32 v158, v180
v_mov_b32 v159, v180
v_mov_b32 v160, v184
v_mov_b32 v161, v184
v_mov_b32 v162, v184
v_mov_b32 v163, v184
v_mov_b32 v164, v180
v_mov_b32 v165, v180
v_mov_b32 v166, v180
v_mov_b32 v167, v180
v_mov_b32 v168, v184
v_mov_b32 v169, v184
v_mov_b32 v170, v184
v_mov_b32 v171, v184
v_mov_b32 v172, v180
v_mov_b32 v173, v180
v_mov_b32 v174, v180
v_mov_b32 v175, v180
v_mov_b32 v176, v184
v_mov_b32 v177, v184
v_mov_b32 v178, v184
v_mov_b32 v179, v184
L_p4_12:
s_waitcnt lgkmcnt(0)
v_mfma_f32_16x16x32_bf16 v[108:111], a[0:3], a[36:39], v[108:111]
ds_read_b128 a[80:83], v189 offset:0
v_mfma_f32_16x16x32_bf16 v[112:115], a[0:3], a[40:43], v[112:115]
ds_read_b128 a[84:87], v189 offset:2048
v_mfma_f32_16x16x32_bf16 v[116:119], a[4:7], a[36:39], v[116:119]
ds_read_b128 a[44:47], v190 offset:9216
v_mfma_f32_16x16x32_bf16 v[120:123], a[4:7], a[40:43], v[120:123]
ds_read_b128 a[48:51], v190 offset:10240
v_mfma_f32_16x16x32_bf16 v[124:127], a[8:11], a[36:39], v[124:127]
ds_read_b128 a[52:55], v190 offset:11264
v_mfma_f32_16x16x32_bf16 v[128:131], a[8:11], a[40:43], v[128:131]
ds_read_b128 a[56:59], v190 offset:12288
v_mfma_f32_16x16x32_bf16 v[132:135], a[12:15], a[36:39], v[132:135]
ds_read_b128 a[60:63], v190 offset:13312
v_mfma_f32_16x16x32_bf16 v[136:139], a[12:15], a[40:43], v[136:139]
ds_read_b128 a[64:67], v190 offset:14336
v_mfma_f32_16x16x32_bf16 v[140:143], a[16:19], a[36:39], v[140:143]
ds_read_b128 a[68:71], v190 offset:15360
v_mfma_f32_16x16x32_bf16 v[144:147], a[16:19], a[40:43], v[144:147]
ds_read_b128 a[72:75], v190 offset:16384
v_mfma_f32_16x16x32_bf16 v[148:151], a[20:23], a[36:39], v[148:151]
ds_read_b128 a[76:79], v190 offset:17408
v_mfma_f32_16x16x32_bf16 v[152:155], a[20:23], a[40:43], v[152:155]
s_add_u32 s69, s69, 16384
s_cmp_ge_u32 s69, 98304
v_mfma_f32_16x16x32_bf16 v[156:159], a[24:27], a[36:39], v[156:159]
s_cselect_b32 s69, 0, s69
s_add_u32 s70, s70, 18432
v_mfma_f32_16x16x32_bf16 v[160:163], a[24:27], a[40:43], v[160:163]
s_cmp_ge_u32 s70, 163840
s_cselect_b32 s70, 108544, s70
v_mfma_f32_16x16x32_bf16 v[164:167], a[28:31], a[36:39], v[164:167]
v_add_u32 v188, s69, v192
v_add_u32 v189, s69, v193
v_mfma_f32_16x16x32_bf16 v[168:171], a[28:31], a[40:43], v[168:171]
v_add_u32 v190, s70, v1
v_mfma_f32_16x16x32_bf16 v[172:175], a[32:35], a[36:39], v[172:175]
v_mfma_f32_16x16x32_bf16 v[176:179], a[32:35], a[40:43], v[176:179]
s_waitcnt vmcnt(9) lgkmcnt(0)
s_barrier
v_mfma_f32_16x16x32_bf16 v[108:111], a[44:47], a[80:83], v[108:111]
ds_read_b128 a[36:39], v188 offset:0
s_mov_b32 m0, s67
v_mfma_f32_16x16x32_bf16 v[112:115], a[44:47], a[84:87], v[112:115]
ds_read_b128 a[40:43], v188 offset:2048
s_add_u32 s30, s66, 4096
v_mfma_f32_16x16x32_bf16 v[116:119], a[48:51], a[80:83], v[116:119]
ds_read_b128 a[0:3], v190 offset:0
buffer_load_dwordx4 v1, s[8:11], s66 offen offset:0 sc1 lds
v_mfma_f32_16x16x32_bf16 v[120:123], a[48:51], a[84:87], v[120:123]
ds_read_b128 a[4:7], v190 offset:1024
buffer_load_dwordx4 v1, s[8:11], s66 offen offset:1024 sc1 lds
v_mfma_f32_16x16x32_bf16 v[124:127], a[52:55], a[80:83], v[124:127]
ds_read_b128 a[8:11], v190 offset:2048
buffer_load_dwordx4 v1, s[8:11], s66 offen offset:2048 sc1 lds
v_mfma_f32_16x16x32_bf16 v[128:131], a[52:55], a[84:87], v[128:131]
ds_read_b128 a[12:15], v190 offset:3072
buffer_load_dwordx4 v1, s[8:11], s66 offen offset:3072 sc1 lds
v_mfma_f32_16x16x32_bf16 v[132:135], a[56:59], a[80:83], v[132:135]
ds_read_b128 a[16:19], v190 offset:4096
s_add_u32 m0, s67, 4096
v_mfma_f32_16x16x32_bf16 v[136:139], a[56:59], a[84:87], v[136:139]
ds_read_b128 a[20:23], v190 offset:5120
s_mov_b32 exec_hi, 0
buffer_load_dwordx4 v1, s[8:11], s30 offen sc1 lds
s_mov_b64 exec, -1
v_mfma_f32_16x16x32_bf16 v[140:143], a[60:63], a[80:83], v[140:143]
ds_read_b128 a[24:27], v190 offset:6144
s_add_u32 s67, s67, 18432
v_mfma_f32_16x16x32_bf16 v[144:147], a[60:63], a[84:87], v[144:147]
ds_read_b128 a[28:31], v190 offset:7168
s_add_u32 s66, s66, 18432
v_mfma_f32_16x16x32_bf16 v[148:151], a[64:67], a[80:83], v[148:151]
ds_read_b128 a[32:35], v190 offset:8192
s_cmp_ge_u32 s67, 163840
v_mfma_f32_16x16x32_bf16 v[152:155], a[64:67], a[84:87], v[152:155]
s_cselect_b32 s67, s72, s67
s_mov_b32 m0, s65
v_mfma_f32_16x16x32_bf16 v[156:159], a[68:71], a[80:83], v[156:159]
s_add_u32 s65, s65, 16384
buffer_load_dwordx4 v248, s[12:15], s64 offen offset:0 lds
v_mfma_f32_16x16x32_bf16 v[160:163], a[68:71], a[84:87], v[160:163]
buffer_load_dwordx4 v249, s[12:15], s64 offen offset:1024 lds
buffer_load_dwordx4 v250, s[12:15], s64 offen offset:2048 lds
v_mfma_f32_16x16x32_bf16 v[164:167], a[72:75], a[80:83], v[164:167]
buffer_load_dwordx4 v251, s[12:15], s64 offen offset:3072 lds
s_add_u32 s64, s64, 128
v_mfma_f32_16x16x32_bf16 v[168:171], a[72:75], a[84:87], v[168:171]
s_cmp_ge_u32 s65, 98304
s_cselect_b32 s65, s71, s65
v_mfma_f32_16x16x32_bf16 v[172:175], a[76:79], a[80:83], v[172:175]
v_mfma_f32_16x16x32_bf16 v[176:179], a[76:79], a[84:87], v[176:179]
s_add_u32 s68, s68, 1
s_cmp_lt_u32 s68, 26
s_cbranch_scc1 L_p4_12
L_p4_13:
s_waitcnt lgkmcnt(0)
v_mfma_f32_16x16x32_bf16 v[108:111], a[0:3], a[36:39], v[108:111]
ds_read_b128 a[80:83], v189 offset:0
v_mfma_f32_16x16x32_bf16 v[112:115], a[0:3], a[40:43], v[112:115]
ds_read_b128 a[84:87], v189 offset:2048
v_mfma_f32_16x16x32_bf16 v[116:119], a[4:7], a[36:39], v[116:119]
ds_read_b128 a[44:47], v190 offset:9216
v_mfma_f32_16x16x32_bf16 v[120:123], a[4:7], a[40:43], v[120:123]
ds_read_b128 a[48:51], v190 offset:10240
v_mfma_f32_16x16x32_bf16 v[124:127], a[8:11], a[36:39], v[124:127]
ds_read_b128 a[52:55], v190 offset:11264
v_mfma_f32_16x16x32_bf16 v[128:131], a[8:11], a[40:43], v[128:131]
ds_read_b128 a[56:59], v190 offset:12288
v_mfma_f32_16x16x32_bf16 v[132:135], a[12:15], a[36:39], v[132:135]
ds_read_b128 a[60:63], v190 offset:13312
v_mfma_f32_16x16x32_bf16 v[136:139], a[12:15], a[40:43], v[136:139]
ds_read_b128 a[64:67], v190 offset:14336
v_mfma_f32_16x16x32_bf16 v[140:143], a[16:19], a[36:39], v[140:143]
ds_read_b128 a[68:71], v190 offset:15360
v_mfma_f32_16x16x32_bf16 v[144:147], a[16:19], a[40:43], v[144:147]
ds_read_b128 a[72:75], v190 offset:16384
v_mfma_f32_16x16x32_bf16 v[148:151], a[20:23], a[36:39], v[148:151]
ds_read_b128 a[76:79], v190 offset:17408
v_mfma_f32_16x16x32_bf16 v[152:155], a[20:23], a[40:43], v[152:155]
s_add_u32 s69, s69, 16384
s_cmp_ge_u32 s69, 98304
v_mfma_f32_16x16x32_bf16 v[156:159], a[24:27], a[36:39], v[156:159]
s_cselect_b32 s69, 0, s69
s_add_u32 s70, s70, 18432
v_mfma_f32_16x16x32_bf16 v[160:163], a[24:27], a[40:43], v[160:163]
s_cmp_ge_u32 s70, 163840
s_cselect_b32 s70, 108544, s70
v_mfma_f32_16x16x32_bf16 v[164:167], a[28:31], a[36:39], v[164:167]
v_add_u32 v188, s69, v192
v_add_u32 v189, s69, v193
v_mfma_f32_16x16x32_bf16 v[168:171], a[28:31], a[40:43], v[168:171]
v_add_u32 v190, s70, v1
v_mfma_f32_16x16x32_bf16 v[172:175], a[32:35], a[36:39], v[172:175]
v_mfma_f32_16x16x32_bf16 v[176:179], a[32:35], a[40:43], v[176:179]
s_waitcnt vmcnt(5) lgkmcnt(0)
s_barrier
v_mfma_f32_16x16x32_bf16 v[108:111], a[44:47], a[80:83], v[108:111]
ds_read_b128 a[36:39], v188 offset:0
s_mov_b32 m0, s67
v_mfma_f32_16x16x32_bf16 v[112:115], a[44:47], a[84:87], v[112:115]
ds_read_b128 a[40:43], v188 offset:2048
s_add_u32 s30, s66, 4096
v_mfma_f32_16x16x32_bf16 v[116:119], a[48:51], a[80:83], v[116:119]
ds_read_b128 a[0:3], v190 offset:0
buffer_load_dwordx4 v1, s[8:11], s66 offen offset:0 sc1 lds
v_mfma_f32_16x16x32_bf16 v[120:123], a[48:51], a[84:87], v[120:123]
ds_read_b128 a[4:7], v190 offset:1024
buffer_load_dwordx4 v1, s[8:11], s66 offen offset:1024 sc1 lds
v_mfma_f32_16x16x32_bf16 v[124:127], a[52:55], a[80:83], v[124:127]
ds_read_b128 a[8:11], v190 offset:2048
buffer_load_dwordx4 v1, s[8:11], s66 offen offset:2048 sc1 lds
v_mfma_f32_16x16x32_bf16 v[128:131], a[52:55], a[84:87], v[128:131]
ds_read_b128 a[12:15], v190 offset:3072
buffer_load_dwordx4 v1, s[8:11], s66 offen offset:3072 sc1 lds
v_mfma_f32_16x16x32_bf16 v[132:135], a[56:59], a[80:83], v[132:135]
ds_read_b128 a[16:19], v190 offset:4096
s_add_u32 m0, s67, 4096
v_mfma_f32_16x16x32_bf16 v[136:139], a[56:59], a[84:87], v[136:139]
ds_read_b128 a[20:23], v190 offset:5120
s_mov_b32 exec_hi, 0
buffer_load_dwordx4 v1, s[8:11], s30 offen sc1 lds
s_mov_b64 exec, -1
v_mfma_f32_16x16x32_bf16 v[140:143], a[60:63], a[80:83], v[140:143]
ds_read_b128 a[24:27], v190 offset:6144
s_add_u32 s67, s67, 18432
v_mfma_f32_16x16x32_bf16 v[144:147], a[60:63], a[84:87], v[144:147]
ds_read_b128 a[28:31], v190 offset:7168
s_add_u32 s66, s66, 18432
v_mfma_f32_16x16x32_bf16 v[148:151], a[64:67], a[80:83], v[148:151]
ds_read_b128 a[32:35], v190 offset:8192
s_cmp_ge_u32 s67, 163840
v_mfma_f32_16x16x32_bf16 v[152:155], a[64:67], a[84:87], v[152:155]
s_cselect_b32 s67, s72, s67
v_mfma_f32_16x16x32_bf16 v[156:159], a[68:71], a[80:83], v[156:159]
v_mfma_f32_16x16x32_bf16 v[160:163], a[68:71], a[84:87], v[160:163]
v_mfma_f32_16x16x32_bf16 v[164:167], a[72:75], a[80:83], v[164:167]
v_mfma_f32_16x16x32_bf16 v[168:171], a[72:75], a[84:87], v[168:171]
v_mfma_f32_16x16x32_bf16 v[172:175], a[76:79], a[80:83], v[172:175]
v_mfma_f32_16x16x32_bf16 v[176:179], a[76:79], a[84:87], v[176:179]
s_add_u32 s68, s68, 1
s_cmp_lt_u32 s68, 29
s_cbranch_scc1 L_p4_13
s_waitcnt lgkmcnt(0)
v_mfma_f32_16x16x32_bf16 v[108:111], a[0:3], a[36:39], v[108:111]
ds_read_b128 a[80:83], v189 offset:0
v_mfma_f32_16x16x32_bf16 v[112:115], a[0:3], a[40:43], v[112:115]
ds_read_b128 a[84:87], v189 offset:2048
v_mfma_f32_16x16x32_bf16 v[116:119], a[4:7], a[36:39], v[116:119]
ds_read_b128 a[44:47], v190 offset:9216
v_mfma_f32_16x16x32_bf16 v[120:123], a[4:7], a[40:43], v[120:123]
ds_read_b128 a[48:51], v190 offset:10240
v_mfma_f32_16x16x32_bf16 v[124:127], a[8:11], a[36:39], v[124:127]
ds_read_b128 a[52:55], v190 offset:11264
v_mfma_f32_16x16x32_bf16 v[128:131], a[8:11], a[40:43], v[128:131]
ds_read_b128 a[56:59], v190 offset:12288
v_mfma_f32_16x16x32_bf16 v[132:135], a[12:15], a[36:39], v[132:135]
ds_read_b128 a[60:63], v190 offset:13312
v_mfma_f32_16x16x32_bf16 v[136:139], a[12:15], a[40:43], v[136:139]
ds_read_b128 a[64:67], v190 offset:14336
v_mfma_f32_16x16x32_bf16 v[140:143], a[16:19], a[36:39], v[140:143]
ds_read_b128 a[68:71], v190 offset:15360
v_mfma_f32_16x16x32_bf16 v[144:147], a[16:19], a[40:43], v[144:147]
ds_read_b128 a[72:75], v190 offset:16384
v_mfma_f32_16x16x32_bf16 v[148:151], a[20:23], a[36:39], v[148:151]
ds_read_b128 a[76:79], v190 offset:17408
v_mfma_f32_16x16x32_bf16 v[152:155], a[20:23], a[40:43], v[152:155]
s_add_u32 s69, s69, 16384
s_cmp_ge_u32 s69, 98304
v_mfma_f32_16x16x32_bf16 v[156:159], a[24:27], a[36:39], v[156:159]
s_cselect_b32 s69, 0, s69
s_add_u32 s70, s70, 18432
v_mfma_f32_16x16x32_bf16 v[160:163], a[24:27], a[40:43], v[160:163]
s_cmp_ge_u32 s70, 163840
s_cselect_b32 s70, 108544, s70
v_mfma_f32_16x16x32_bf16 v[164:167], a[28:31], a[36:39], v[164:167]
v_add_u32 v188, s69, v192
v_add_u32 v189, s69, v193
v_mfma_f32_16x16x32_bf16 v[168:171], a[28:31], a[40:43], v[168:171]
v_add_u32 v190, s70, v1
v_mfma_f32_16x16x32_bf16 v[172:175], a[32:35], a[36:39], v[172:175]
v_mfma_f32_16x16x32_bf16 v[176:179], a[32:35], a[40:43], v[176:179]
s_waitcnt vmcnt(5) lgkmcnt(0)
s_barrier
v_mfma_f32_16x16x32_bf16 v[108:111], a[44:47], a[80:83], v[108:111]
ds_read_b128 a[36:39], v188 offset:0
v_mfma_f32_16x16x32_bf16 v[112:115], a[44:47], a[84:87], v[112:115]
ds_read_b128 a[40:43], v188 offset:2048
v_mfma_f32_16x16x32_bf16 v[116:119], a[48:51], a[80:83], v[116:119]
ds_read_b128 a[0:3], v190 offset:0
v_mfma_f32_16x16x32_bf16 v[120:123], a[48:51], a[84:87], v[120:123]
ds_read_b128 a[4:7], v190 offset:1024
v_mfma_f32_16x16x32_bf16 v[124:127], a[52:55], a[80:83], v[124:127]
ds_read_b128 a[8:11], v190 offset:2048
v_mfma_f32_16x16x32_bf16 v[128:131], a[52:55], a[84:87], v[128:131]
ds_read_b128 a[12:15], v190 offset:3072
v_mfma_f32_16x16x32_bf16 v[132:135], a[56:59], a[80:83], v[132:135]
ds_read_b128 a[16:19], v190 offset:4096
v_mfma_f32_16x16x32_bf16 v[136:139], a[56:59], a[84:87], v[136:139]
ds_read_b128 a[20:23], v190 offset:5120
v_mfma_f32_16x16x32_bf16 v[140:143], a[60:63], a[80:83], v[140:143]
ds_read_b128 a[24:27], v190 offset:6144
v_mfma_f32_16x16x32_bf16 v[144:147], a[60:63], a[84:87], v[144:147]
ds_read_b128 a[28:31], v190 offset:7168
v_mfma_f32_16x16x32_bf16 v[148:151], a[64:67], a[80:83], v[148:151]
ds_read_b128 a[32:35], v190 offset:8192
v_mfma_f32_16x16x32_bf16 v[152:155], a[64:67], a[84:87], v[152:155]
v_mfma_f32_16x16x32_bf16 v[156:159], a[68:71], a[80:83], v[156:159]
v_mfma_f32_16x16x32_bf16 v[160:163], a[68:71], a[84:87], v[160:163]
v_mfma_f32_16x16x32_bf16 v[164:167], a[72:75], a[80:83], v[164:167]
v_mfma_f32_16x16x32_bf16 v[168:171], a[72:75], a[84:87], v[168:171]
v_mfma_f32_16x16x32_bf16 v[172:175], a[76:79], a[80:83], v[172:175]
v_mfma_f32_16x16x32_bf16 v[176:179], a[76:79], a[84:87], v[176:179]
s_waitcnt lgkmcnt(0)
v_mfma_f32_16x16x32_bf16 v[108:111], a[0:3], a[36:39], v[108:111]
ds_read_b128 a[80:83], v189 offset:0
v_mfma_f32_16x16x32_bf16 v[112:115], a[0:3], a[40:43], v[112:115]
ds_read_b128 a[84:87], v189 offset:2048
v_mfma_f32_16x16x32_bf16 v[116:119], a[4:7], a[36:39], v[116:119]
ds_read_b128 a[44:47], v190 offset:9216
v_mfma_f32_16x16x32_bf16 v[120:123], a[4:7], a[40:43], v[120:123]
ds_read_b128 a[48:51], v190 offset:10240
v_mfma_f32_16x16x32_bf16 v[124:127], a[8:11], a[36:39], v[124:127]
ds_read_b128 a[52:55], v190 offset:11264
v_mfma_f32_16x16x32_bf16 v[128:131], a[8:11], a[40:43], v[128:131]
ds_read_b128 a[56:59], v190 offset:12288
v_mfma_f32_16x16x32_bf16 v[132:135], a[12:15], a[36:39], v[132:135]
ds_read_b128 a[60:63], v190 offset:13312
v_mfma_f32_16x16x32_bf16 v[136:139], a[12:15], a[40:43], v[136:139]
ds_read_b128 a[64:67], v190 offset:14336
v_mfma_f32_16x16x32_bf16 v[140:143], a[16:19], a[36:39], v[140:143]
ds_read_b128 a[68:71], v190 offset:15360
v_mfma_f32_16x16x32_bf16 v[144:147], a[16:19], a[40:43], v[144:147]
ds_read_b128 a[72:75], v190 offset:16384
v_mfma_f32_16x16x32_bf16 v[148:151], a[20:23], a[36:39], v[148:151]
ds_read_b128 a[76:79], v190 offset:17408
v_mfma_f32_16x16x32_bf16 v[152:155], a[20:23], a[40:43], v[152:155]
s_add_u32 s69, s69, 16384
s_cmp_ge_u32 s69, 98304
v_mfma_f32_16x16x32_bf16 v[156:159], a[24:27], a[36:39], v[156:159]
s_cselect_b32 s69, 0, s69
s_add_u32 s70, s70, 18432
v_mfma_f32_16x16x32_bf16 v[160:163], a[24:27], a[40:43], v[160:163]
s_cmp_ge_u32 s70, 163840
s_cselect_b32 s70, 108544, s70
v_mfma_f32_16x16x32_bf16 v[164:167], a[28:31], a[36:39], v[164:167]
v_add_u32 v188, s69, v192
v_add_u32 v189, s69, v193
v_mfma_f32_16x16x32_bf16 v[168:171], a[28:31], a[40:43], v[168:171]
v_add_u32 v190, s70, v1
v_mfma_f32_16x16x32_bf16 v[172:175], a[32:35], a[36:39], v[172:175]
v_mfma_f32_16x16x32_bf16 v[176:179], a[32:35], a[40:43], v[176:179]
s_waitcnt vmcnt(0) lgkmcnt(0)
s_barrier
v_mfma_f32_16x16x32_bf16 v[108:111], a[44:47], a[80:83], v[108:111]
ds_read_b128 a[36:39], v188 offset:0
v_mfma_f32_16x16x32_bf16 v[112:115], a[44:47], a[84:87], v[112:115]
ds_read_b128 a[40:43], v188 offset:2048
v_mfma_f32_16x16x32_bf16 v[116:119], a[48:51], a[80:83], v[116:119]
ds_read_b128 a[0:3], v190 offset:0
v_mfma_f32_16x16x32_bf16 v[120:123], a[48:51], a[84:87], v[120:123]
ds_read_b128 a[4:7], v190 offset:1024
v_mfma_f32_16x16x32_bf16 v[124:127], a[52:55], a[80:83], v[124:127]
ds_read_b128 a[8:11], v190 offset:2048
v_mfma_f32_16x16x32_bf16 v[128:131], a[52:55], a[84:87], v[128:131]
ds_read_b128 a[12:15], v190 offset:3072
v_mfma_f32_16x16x32_bf16 v[132:135], a[56:59], a[80:83], v[132:135]
ds_read_b128 a[16:19], v190 offset:4096
v_mfma_f32_16x16x32_bf16 v[136:139], a[56:59], a[84:87], v[136:139]
ds_read_b128 a[20:23], v190 offset:5120
v_mfma_f32_16x16x32_bf16 v[140:143], a[60:63], a[80:83], v[140:143]
ds_read_b128 a[24:27], v190 offset:6144
v_mfma_f32_16x16x32_bf16 v[144:147], a[60:63], a[84:87], v[144:147]
ds_read_b128 a[28:31], v190 offset:7168
v_mfma_f32_16x16x32_bf16 v[148:151], a[64:67], a[80:83], v[148:151]
ds_read_b128 a[32:35], v190 offset:8192
v_mfma_f32_16x16x32_bf16 v[152:155], a[64:67], a[84:87], v[152:155]
v_mfma_f32_16x16x32_bf16 v[156:159], a[68:71], a[80:83], v[156:159]
v_mfma_f32_16x16x32_bf16 v[160:163], a[68:71], a[84:87], v[160:163]
v_mfma_f32_16x16x32_bf16 v[164:167], a[72:75], a[80:83], v[164:167]
v_mfma_f32_16x16x32_bf16 v[168:171], a[72:75], a[84:87], v[168:171]
v_mfma_f32_16x16x32_bf16 v[172:175], a[76:79], a[80:83], v[172:175]
v_mfma_f32_16x16x32_bf16 v[176:179], a[76:79], a[84:87], v[176:179]
s_waitcnt lgkmcnt(0)
v_mfma_f32_16x16x32_bf16 v[108:111], a[0:3], a[36:39], v[108:111]
ds_read_b128 a[80:83], v189 offset:0
v_mfma_f32_16x16x32_bf16 v[112:115], a[0:3], a[40:43], v[112:115]
ds_read_b128 a[84:87], v189 offset:2048
v_mfma_f32_16x16x32_bf16 v[116:119], a[4:7], a[36:39], v[116:119]
ds_read_b128 a[44:47], v190 offset:9216
v_mfma_f32_16x16x32_bf16 v[120:123], a[4:7], a[40:43], v[120:123]
ds_read_b128 a[48:51], v190 offset:10240
v_mfma_f32_16x16x32_bf16 v[124:127], a[8:11], a[36:39], v[124:127]
ds_read_b128 a[52:55], v190 offset:11264
v_mfma_f32_16x16x32_bf16 v[128:131], a[8:11], a[40:43], v[128:131]
ds_read_b128 a[56:59], v190 offset:12288
v_mfma_f32_16x16x32_bf16 v[132:135], a[12:15], a[36:39], v[132:135]
ds_read_b128 a[60:63], v190 offset:13312
v_mfma_f32_16x16x32_bf16 v[136:139], a[12:15], a[40:43], v[136:139]
ds_read_b128 a[64:67], v190 offset:14336
v_mfma_f32_16x16x32_bf16 v[140:143], a[16:19], a[36:39], v[140:143]
ds_read_b128 a[68:71], v190 offset:15360
v_mfma_f32_16x16x32_bf16 v[144:147], a[16:19], a[40:43], v[144:147]
ds_read_b128 a[72:75], v190 offset:16384
v_mfma_f32_16x16x32_bf16 v[148:151], a[20:23], a[36:39], v[148:151]
ds_read_b128 a[76:79], v190 offset:17408
v_mfma_f32_16x16x32_bf16 v[152:155], a[20:23], a[40:43], v[152:155]
s_add_u32 s69, s69, 16384
s_cmp_ge_u32 s69, 98304
v_mfma_f32_16x16x32_bf16 v[156:159], a[24:27], a[36:39], v[156:159]
s_cselect_b32 s69, 0, s69
s_add_u32 s70, s70, 18432
v_mfma_f32_16x16x32_bf16 v[160:163], a[24:27], a[40:43], v[160:163]
s_cmp_ge_u32 s70, 163840
s_cselect_b32 s70, 108544, s70
v_mfma_f32_16x16x32_bf16 v[164:167], a[28:31], a[36:39], v[164:167]
v_add_u32 v188, s69, v192
v_add_u32 v189, s69, v193
v_mfma_f32_16x16x32_bf16 v[168:171], a[28:31], a[40:43], v[168:171]
v_add_u32 v190, s70, v1
v_mfma_f32_16x16x32_bf16 v[172:175], a[32:35], a[36:39], v[172:175]
v_mfma_f32_16x16x32_bf16 v[176:179], a[32:35], a[40:43], v[176:179]
s_waitcnt vmcnt(0) lgkmcnt(0)
s_barrier
v_mfma_f32_16x16x32_bf16 v[108:111], a[44:47], a[80:83], v[108:111]
v_mfma_f32_16x16x32_bf16 v[112:115], a[44:47], a[84:87], v[112:115]
v_mfma_f32_16x16x32_bf16 v[116:119], a[48:51], a[80:83], v[116:119]
v_mfma_f32_16x16x32_bf16 v[120:123], a[48:51], a[84:87], v[120:123]
v_mfma_f32_16x16x32_bf16 v[124:127], a[52:55], a[80:83], v[124:127]
v_mfma_f32_16x16x32_bf16 v[128:131], a[52:55], a[84:87], v[128:131]
v_mfma_f32_16x16x32_bf16 v[132:135], a[56:59], a[80:83], v[132:135]
v_mfma_f32_16x16x32_bf16 v[136:139], a[56:59], a[84:87], v[136:139]
v_mfma_f32_16x16x32_bf16 v[140:143], a[60:63], a[80:83], v[140:143]
v_mfma_f32_16x16x32_bf16 v[144:147], a[60:63], a[84:87], v[144:147]
v_mfma_f32_16x16x32_bf16 v[148:151], a[64:67], a[80:83], v[148:151]
v_mfma_f32_16x16x32_bf16 v[152:155], a[64:67], a[84:87], v[152:155]
v_mfma_f32_16x16x32_bf16 v[156:159], a[68:71], a[80:83], v[156:159]
v_mfma_f32_16x16x32_bf16 v[160:163], a[68:71], a[84:87], v[160:163]
v_mfma_f32_16x16x32_bf16 v[164:167], a[72:75], a[80:83], v[164:167]
v_mfma_f32_16x16x32_bf16 v[168:171], a[72:75], a[84:87], v[168:171]
v_mfma_f32_16x16x32_bf16 v[172:175], a[76:79], a[80:83], v[172:175]
v_mfma_f32_16x16x32_bf16 v[176:179], a[76:79], a[84:87], v[176:179]
s_waitcnt lgkmcnt(0)
s_memrealtime s[58:59]
s_waitcnt lgkmcnt(0)
s_mov_b32 m0, s56
s_nop 0
v_writelane_b32 v5, s58, m0
s_add_u32 s56, s56, 1
s_lshl_b32 s30, s25, 3
s_lshl_b32 s31, s24, 1
s_add_u32 s30, s30, s31
s_mul_i32 s30, s30, 73728
s_add_u32 s30, s30, 16777216
s_mul_i32 s31, s26, 4608
s_add_u32 s30, s30, s31
s_and_b32 s32, s26, 1
s_lshl_b32 s31, s32, 9
s_add_u32 s31, s31, s30
s_xor_b32 s32, s32, 1
s_lshl_b32 s32, s32, 12
s_add_u32 s32, s32, s30
v_add_u32 v6, 73728, v1
v_and_b32 v7, 1, v3
v_mul_u32_u24 v7, 73728, v7
v_lshrrev_b32 v8, 1, v3
v_lshl_add_u32 v7, v8, 8, v7
v_lshl_add_u32 v7, v2, 4, v7
v_pk_mul_f32 v[108:109], v[108:109], v[36:37]
v_pk_mul_f32 v[110:111], v[110:111], v[38:39]
v_cvt_pk_bf16_f32 v196, v108, v109
v_cvt_pk_bf16_f32 v197, v110, v111
v_pk_mul_f32 v[116:117], v[116:117], v[44:45]
v_pk_mul_f32 v[118:119], v[118:119], v[46:47]
v_cvt_pk_bf16_f32 v198, v116, v117
v_cvt_pk_bf16_f32 v199, v118, v119
buffer_store_dwordx4 v[196:199], v1, s[8:11], s31 offen offset:0 sc1
v_pk_mul_f32 v[112:113], v[112:113], v[40:41]
v_pk_mul_f32 v[114:115], v[114:115], v[42:43]
v_cvt_pk_bf16_f32 v200, v112, v113
v_cvt_pk_bf16_f32 v201, v114, v115
v_pk_mul_f32 v[120:121], v[120:121], v[48:49]
v_pk_mul_f32 v[122:123], v[122:123], v[50:51]
v_cvt_pk_bf16_f32 v202, v120, v121
v_cvt_pk_bf16_f32 v203, v122, v123
buffer_store_dwordx4 v[200:203], v6, s[8:11], s31 offen offset:0 sc1
v_pk_mul_f32 v[124:125], v[124:125], v[52:53]
v_pk_mul_f32 v[126:127], v[126:127], v[54:55]
v_cvt_pk_bf16_f32 v204, v124, v125
v_cvt_pk_bf16_f32 v205, v126, v127
v_pk_mul_f32 v[132:133], v[132:133], v[60:61]
v_pk_mul_f32 v[134:135], v[134:135], v[62:63]
v_cvt_pk_bf16_f32 v206, v132, v133
v_cvt_pk_bf16_f32 v207, v134, v135
buffer_store_dwordx4 v[204:207], v1, s[8:11], s31 offen offset:1024 sc1
v_pk_mul_f32 v[128:129], v[128:129], v[56:57]
v_pk_mul_f32 v[130:131], v[130:131], v[58:59]
v_cvt_pk_bf16_f32 v208, v128, v129
v_cvt_pk_bf16_f32 v209, v130, v131
v_pk_mul_f32 v[136:137], v[136:137], v[64:65]
v_pk_mul_f32 v[138:139], v[138:139], v[66:67]
v_cvt_pk_bf16_f32 v210, v136, v137
v_cvt_pk_bf16_f32 v211, v138, v139
buffer_store_dwordx4 v[208:211], v6, s[8:11], s31 offen offset:1024 sc1
v_pk_mul_f32 v[140:141], v[140:141], v[68:69]
v_pk_mul_f32 v[142:143], v[142:143], v[70:71]
v_cvt_pk_bf16_f32 v212, v140, v141
v_cvt_pk_bf16_f32 v213, v142, v143
v_pk_mul_f32 v[148:149], v[148:149], v[76:77]
v_pk_mul_f32 v[150:151], v[150:151], v[78:79]
v_cvt_pk_bf16_f32 v214, v148, v149
v_cvt_pk_bf16_f32 v215, v150, v151
buffer_store_dwordx4 v[212:215], v1, s[8:11], s31 offen offset:2048 sc1
v_pk_mul_f32 v[144:145], v[144:145], v[72:73]
v_pk_mul_f32 v[146:147], v[146:147], v[74:75]
v_cvt_pk_bf16_f32 v216, v144, v145
v_cvt_pk_bf16_f32 v217, v146, v147
v_pk_mul_f32 v[152:153], v[152:153], v[80:81]
v_pk_mul_f32 v[154:155], v[154:155], v[82:83]
v_cvt_pk_bf16_f32 v218, v152, v153
v_cvt_pk_bf16_f32 v219, v154, v155
buffer_store_dwordx4 v[216:219], v6, s[8:11], s31 offen offset:2048 sc1
v_pk_mul_f32 v[156:157], v[156:157], v[84:85]
v_pk_mul_f32 v[158:159], v[158:159], v[86:87]
v_cvt_pk_bf16_f32 v220, v156, v157
v_cvt_pk_bf16_f32 v221, v158, v159
v_pk_mul_f32 v[164:165], v[164:165], v[92:93]
v_pk_mul_f32 v[166:167], v[166:167], v[94:95]
v_cvt_pk_bf16_f32 v222, v164, v165
v_cvt_pk_bf16_f32 v223, v166, v167
buffer_store_dwordx4 v[220:223], v1, s[8:11], s31 offen offset:3072 sc1
v_pk_mul_f32 v[160:161], v[160:161], v[88:89]
v_pk_mul_f32 v[162:163], v[162:163], v[90:91]
v_cvt_pk_bf16_f32 v224, v160, v161
v_cvt_pk_bf16_f32 v225, v162, v163
v_pk_mul_f32 v[168:169], v[168:169], v[96:97]
v_pk_mul_f32 v[170:171], v[170:171], v[98:99]
v_cvt_pk_bf16_f32 v226, v168, v169
v_cvt_pk_bf16_f32 v227, v170, v171
buffer_store_dwordx4 v[224:227], v6, s[8:11], s31 offen offset:3072 sc1
v_pk_mul_f32 v[172:173], v[172:173], v[100:101]
v_pk_mul_f32 v[174:175], v[174:175], v[102:103]
v_cvt_pk_bf16_f32 v228, v172, v173
v_cvt_pk_bf16_f32 v229, v174, v175
v_pk_mul_f32 v[176:177], v[176:177], v[104:105]
v_pk_mul_f32 v[178:179], v[178:179], v[106:107]
v_cvt_pk_bf16_f32 v230, v176, v177
v_cvt_pk_bf16_f32 v231, v178, v179
s_nop 0
v_permlane16_swap_b32 v228, v230
v_permlane16_swap_b32 v229, v231
buffer_store_dwordx4 v[228:231], v7, s[8:11], s32 offen sc1
s_waitcnt vmcnt(0)
s_barrier
s_cmp_eq_u32 s24, 0
s_cbranch_scc0 L_sig_14
v_lshlrev_b32 v6, 3, v1
s_lshl_b32 s31, s25, 11
s_lshl_b32 s32, s26, 2
s_add_u32 s31, s31, s32
v_add_u32 v6, s31, v6
s_mov_b64 exec, 0xffff
s_mov_b32 s30, 26574848
buffer_store_dword v4, v6, s[8:11], s30 offen sc1
s_mov_b64 exec, -1
L_sig_14:
s_mul_i32 s62, s28, 331776
s_add_u32 s62, s62, 8241152
s_add_u32 s37, s62, 0
s_mul_i32 s38, s24, 9216
s_add_u32 s39, s38, s37
s_add_u32 m0, s38, 0
s_nop 0
buffer_load_dwordx4 v1, s[4:7], s39 offen offset:0  lds
buffer_load_dwordx4 v1, s[4:7], s39 offen offset:1024  lds
buffer_load_dwordx4 v1, s[4:7], s39 offen offset:2048  lds
buffer_load_dwordx4 v1, s[4:7], s39 offen offset:3072  lds
s_add_u32 m0, m0, 4096
s_add_u32 s39, s39, 4096
buffer_load_dwordx4 v1, s[4:7], s39 offen offset:0  lds
buffer_load_dwordx4 v1, s[4:7], s39 offen offset:1024  lds
buffer_load_dwordx4 v1, s[4:7], s39 offen offset:2048  lds
buffer_load_dwordx4 v1, s[4:7], s39 offen offset:3072  lds
s_add_u32 m0, m0, 4096
s_add_u32 s39, s39, 4096
buffer_load_dwordx4 v1, s[4:7], s39 offen offset:0  lds
s_add_u32 s37, s62, 36864
s_mul_i32 s38, s24, 9216
s_add_u32 s39, s38, s37
s_add_u32 m0, s38, 36864
s_nop 0
buffer_load_dwordx4 v1, s[4:7], s39 offen offset:0  lds
buffer_load_dwordx4 v1, s[4:7], s39 offen offset:1024  lds
buffer_load_dwordx4 v1, s[4:7], s39 offen offset:2048  lds
buffer_load_dwordx4 v1, s[4:7], s39 offen offset:3072  lds
s_add_u32 m0, m0, 4096
s_add_u32 s39, s39, 4096
buffer_load_dwordx4 v1, s[4:7], s39 offen offset:0  lds
buffer_load_dwordx4 v1, s[4:7], s39 offen offset:1024  lds
buffer_load_dwordx4 v1, s[4:7], s39 offen offset:2048  lds
buffer_load_dwordx4 v1, s[4:7], s39 offen offset:3072  lds
s_add_u32 m0, m0, 4096
s_add_u32 s39, s39, 4096
buffer_load_dwordx4 v1, s[4:7], s39 offen offset:0  lds
s_add_u32 s37, s62, 73728
s_mul_i32 s38, s24, 9216
s_add_u32 s39, s38, s37
s_add_u32 m0, s38, 73728
s_nop 0
buffer_load_dwordx4 v1, s[4:7], s39 offen offset:0  lds
buffer_load_dwordx4 v1, s[4:7], s39 offen offset:1024  lds
buffer_load_dwordx4 v1, s[4:7], s39 offen offset:2048  lds
buffer_load_dwordx4 v1, s[4:7], s39 offen offset:3072  lds
s_add_u32 m0, m0, 4096
s_add_u32 s39, s39, 4096
buffer_load_dwordx4 v1, s[4:7], s39 offen offset:0  lds
buffer_load_dwordx4 v1, s[4:7], s39 offen offset:1024  lds
buffer_load_dwordx4 v1, s[4:7], s39 offen offset:2048  lds
buffer_load_dwordx4 v1, s[4:7], s39 offen offset:3072  lds
s_add_u32 m0, m0, 4096
s_add_u32 s39, s39, 4096
buffer_load_dwordx4 v1, s[4:7], s39 offen offset:0  lds
s_add_u32 s37, s62, 110592
s_mul_i32 s38, s24, 9216
s_add_u32 s39, s38, s37
s_add_u32 m0, s38, 110592
s_nop 0
buffer_load_dwordx4 v1, s[4:7], s39 offen offset:0  lds
buffer_load_dwordx4 v1, s[4:7], s39 offen offset:1024  lds
buffer_load_dwordx4 v1, s[4:7], s39 offen offset:2048  lds
buffer_load_dwordx4 v1, s[4:7], s39 offen offset:3072  lds
s_add_u32 m0, m0, 4096
s_add_u32 s39, s39, 4096
buffer_load_dwordx4 v1, s[4:7], s39 offen offset:0  lds
buffer_load_dwordx4 v1, s[4:7], s39 offen offset:1024  lds
buffer_load_dwordx4 v1, s[4:7], s39 offen offset:2048  lds
buffer_load_dwordx4 v1, s[4:7], s39 offen offset:3072  lds
s_add_u32 m0, m0, 4096
s_add_u32 s39, s39, 4096
buffer_load_dwordx4 v1, s[4:7], s39 offen offset:0  lds
s_cmp_eq_u32 s24, 1
s_cbranch_scc0 L_polled_16
s_lshl_b32 s30, s81, 7
s_add_u32 s30, s30, 26574848
v_lshrrev_b32 v6, 2, v1
s_mov_b32 s31, 0
s_mov_b64 exec, 0xffff
L_poll_15:
buffer_load_dword v7, v6, s[8:11], s30 offen sc1
s_add_u32 s31, s31, 1
s_waitcnt vmcnt(0)
v_cmp_ne_u32 vcc, 1, v7
s_cmp_gt_u32 s31, 200000
s_cbranch_scc1 L_polled_16
s_cbranch_vccnz L_poll_15
L_polled_16:
s_mov_b64 exec, -1
s_waitcnt vmcnt(0)
s_barrier
s_waitcnt lgkmcnt(0)
s_memrealtime s[58:59]
s_waitcnt lgkmcnt(0)
s_mov_b32 m0, s56
s_nop 0
v_writelane_b32 v5, s58, m0
s_add_u32 s56, s56, 1
s_lshl_b32 s60, s27, 2
s_add_u32 s60, s60, s24
s_mul_i32 s60, s60, 73728
s_add_u32 s60, s60, 16777216
buffer_load_dwordx4 a[0:3], v1, s[8:11], s60 offen offset:0 sc1
buffer_load_dwordx4 a[4:7], v1, s[8:11], s60 offen offset:1024 sc1
buffer_load_dwordx4 a[8:11], v1, s[8:11], s60 offen offset:2048 sc1
buffer_load_dwordx4 a[12:15], v1, s[8:11], s60 offen offset:3072 sc1
s_add_u32 s60, s60, 4096
buffer_load_dwordx4 a[16:19], v1, s[8:11], s60 offen offset:0 sc1
buffer_load_dwordx4 a[20:23], v1, s[8:11], s60 offen offset:1024 sc1
buffer_load_dwordx4 a[24:27], v1, s[8:11], s60 offen offset:2048 sc1
buffer_load_dwordx4 a[28:31], v1, s[8:11], s60 offen offset:3072 sc1
s_add_u32 s60, s60, 4096
buffer_load_dwordx4 a[32:35], v1, s[8:11], s60 offen offset:0 sc1
buffer_load_dwordx4 a[36:39], v1, s[8:11], s60 offen offset:1024 sc1
buffer_load_dwordx4 a[40:43], v1, s[8:11], s60 offen offset:2048 sc1
buffer_load_dwordx4 a[44:47], v1, s[8:11], s60 offen offset:3072 sc1
s_add_u32 s60, s60, 4096
buffer_load_dwordx4 a[48:51], v1, s[8:11], s60 offen offset:0 sc1
buffer_load_dwordx4 a[52:55], v1, s[8:11], s60 offen offset:1024 sc1
buffer_load_dwordx4 a[56:59], v1, s[8:11], s60 offen offset:2048 sc1
buffer_load_dwordx4 a[60:63], v1, s[8:11], s60 offen offset:3072 sc1
s_add_u32 s60, s60, 4096
buffer_load_dwordx4 a[64:67], v1, s[8:11], s60 offen offset:0 sc1
buffer_load_dwordx4 a[68:71], v1, s[8:11], s60 offen offset:1024 sc1
buffer_load_dwordx4 a[72:75], v1, s[8:11], s60 offen offset:2048 sc1
buffer_load_dwordx4 a[76:79], v1, s[8:11], s60 offen offset:3072 sc1
s_add_u32 s60, s60, 4096
buffer_load_dwordx4 a[80:83], v1, s[8:11], s60 offen offset:0 sc1
buffer_load_dwordx4 a[84:87], v1, s[8:11], s60 offen offset:1024 sc1
buffer_load_dwordx4 a[88:91], v1, s[8:11], s60 offen offset:2048 sc1
v_and_b32 v112, 7, v2
v_lshlrev_b32 v112, 4, v112
v_lshl_add_u32 v112, v3, 7, v112
v_add_u32 v112, 4096, v112
v_add_u32 v108, 0, v1
v_add_u32 v109, 36864, v1
v_add_u32 v113, 36864, v112
v_add_u32 v110, 73728, v1
v_add_u32 v114, 73728, v112
v_add_u32 v111, 110592, v1
v_add_u32 v115, 110592, v112
ds_read_b128 a[96:99], v108 offset:0
ds_read_b128 a[100:103], v108 offset:1024
ds_read_b128 a[104:107], v108 offset:2048
ds_read_b128 a[108:111], v108 offset:3072
ds_read_b128 a[112:115], v112 offset:0
ds_read_b128 a[116:119], v108 offset:4608
ds_read_b128 a[120:123], v108 offset:5632
ds_read_b128 a[124:127], v108 offset:6656
ds_read_b128 a[128:131], v108 offset:7680
ds_read_b128 a[132:135], v112 offset:4608
s_waitcnt vmcnt(22)
s_waitcnt lgkmcnt(5)
v_mfma_f32_16x16x32_bf16 v[16:19], a[96:99], a[0:3], v[16:19]
ds_read_b128 a[136:139], v108 offset:9216
buffer_load_dwordx4 a[92:95], v1, s[8:11], s60 offen offset:3072 sc1
v_mfma_f32_16x16x32_bf16 v[20:23], a[100:103], a[0:3], v[20:23]
ds_read_b128 a[140:143], v108 offset:10240
v_mfma_f32_16x16x32_bf16 v[24:27], a[104:107], a[0:3], v[24:27]
ds_read_b128 a[144:147], v108 offset:11264
v_mfma_f32_16x16x32_bf16 v[28:31], a[108:111], a[0:3], v[28:31]
ds_read_b128 a[148:151], v108 offset:12288
v_mfma_f32_16x16x32_bf16 v[32:35], a[112:115], a[0:3], v[32:35]
ds_read_b128 a[152:155], v112 offset:9216
s_waitcnt vmcnt(22)
s_waitcnt lgkmcnt(5)
v_mfma_f32_16x16x32_bf16 v[16:19], a[116:119], a[4:7], v[16:19]
ds_read_b128 a[96:99], v108 offset:13824
s_add_u32 s60, s60, 4096
buffer_load_dwordx4 a[0:3], v1, s[8:11], s60 offen offset:0 sc1
v_mfma_f32_16x16x32_bf16 v[20:23], a[120:123], a[4:7], v[20:23]
ds_read_b128 a[100:103], v108 offset:14848
v_mfma_f32_16x16x32_bf16 v[24:27], a[124:127], a[4:7], v[24:27]
ds_read_b128 a[104:107], v108 offset:15872
v_mfma_f32_16x16x32_bf16 v[28:31], a[128:131], a[4:7], v[28:31]
ds_read_b128 a[108:111], v108 offset:16896
v_mfma_f32_16x16x32_bf16 v[32:35], a[132:135], a[4:7], v[32:35]
ds_read_b128 a[112:115], v112 offset:13824
s_waitcnt vmcnt(22)
s_waitcnt lgkmcnt(5)
v_mfma_f32_16x16x32_bf16 v[16:19], a[136:139], a[8:11], v[16:19]
ds_read_b128 a[116:119], v108 offset:18432
buffer_load_dwordx4 a[4:7], v1, s[8:11], s60 offen offset:1024 sc1
v_mfma_f32_16x16x32_bf16 v[20:23], a[140:143], a[8:11], v[20:23]
ds_read_b128 a[120:123], v108 offset:19456
v_mfma_f32_16x16x32_bf16 v[24:27], a[144:147], a[8:11], v[24:27]
ds_read_b128 a[124:127], v108 offset:20480
v_mfma_f32_16x16x32_bf16 v[28:31], a[148:151], a[8:11], v[28:31]
ds_read_b128 a[128:131], v108 offset:21504
v_mfma_f32_16x16x32_bf16 v[32:35], a[152:155], a[8:11], v[32:35]
ds_read_b128 a[132:135], v112 offset:18432
s_waitcnt vmcnt(22)
s_waitcnt lgkmcnt(5)
v_mfma_f32_16x16x32_bf16 v[16:19], a[96:99], a[12:15], v[16:19]
ds_read_b128 a[136:139], v108 offset:23040
buffer_load_dwordx4 a[8:11], v1, s[8:11], s60 offen offset:2048 sc1
v_mfma_f32_16x16x32_bf16 v[20:23], a[100:103], a[12:15], v[20:23]
ds_read_b128 a[140:143], v108 offset:24064
v_mfma_f32_16x16x32_bf16 v[24:27], a[104:107], a[12:15], v[24:27]
ds_read_b128 a[144:147], v108 offset:25088
v_mfma_f32_16x16x32_bf16 v[28:31], a[108:111], a[12:15], v[28:31]
ds_read_b128 a[148:151], v108 offset:26112
v_mfma_f32_16x16x32_bf16 v[32:35], a[112:115], a[12:15], v[32:35]
ds_read_b128 a[152:155], v112 offset:23040
s_waitcnt vmcnt(22)
s_waitcnt lgkmcnt(5)
v_mfma_f32_16x16x32_bf16 v[16:19], a[116:119], a[16:19], v[16:19]
ds_read_b128 a[96:99], v108 offset:27648
buffer_load_dwordx4 a[12:15], v1, s[8:11], s60 offen offset:3072 sc1
v_mfma_f32_16x16x32_bf16 v[20:23], a[120:123], a[16:19], v[20:23]
ds_read_b128 a[100:103], v108 offset:28672
v_mfma_f32_16x16x32_bf16 v[24:27], a[124:127], a[16:19], v[24:27]
ds_read_b128 a[104:107], v108 offset:29696
v_mfma_f32_16x16x32_bf16 v[28:31], a[128:131], a[16:19], v[28:31]
ds_read_b128 a[108:111], v108 offset:30720
v_mfma_f32_16x16x32_bf16 v[32:35], a[132:135], a[16:19], v[32:35]
ds_read_b128 a[112:115], v112 offset:27648
s_waitcnt vmcnt(22)
s_waitcnt lgkmcnt(5)
v_mfma_f32_16x16x32_bf16 v[16:19], a[136:139], a[20:23], v[16:19]
ds_read_b128 a[116:119], v108 offset:32256
s_add_u32 s60, s60, 4096
buffer_load_dwordx4 a[16:19], v1, s[8:11], s60 offen offset:0 sc1
v_mfma_f32_16x16x32_bf16 v[20:23], a[140:143], a[20:23], v[20:23]
ds_read_b128 a[120:123], v108 offset:33280
v_mfma_f32_16x16x32_bf16 v[24:27], a[144:147], a[20:23], v[24:27]
ds_read_b128 a[124:127], v108 offset:34304
v_mfma_f32_16x16x32_bf16 v[28:31], a[148:151], a[20:23], v[28:31]
ds_read_b128 a[128:131], v108 offset:35328
v_mfma_f32_16x16x32_bf16 v[32:35], a[152:155], a[20:23], v[32:35]
ds_read_b128 a[132:135], v112 offset:32256
s_waitcnt vmcnt(22)
s_waitcnt lgkmcnt(5)
v_mfma_f32_16x16x32_bf16 v[16:19], a[96:99], a[24:27], v[16:19]
ds_read_b128 a[136:139], v109 offset:0
buffer_load_dwordx4 a[20:23], v1, s[8:11], s60 offen offset:1024 sc1
v_mfma_f32_16x16x32_bf16 v[20:23], a[100:103], a[24:27], v[20:23]
ds_read_b128 a[140:143], v109 offset:1024
v_mfma_f32_16x16x32_bf16 v[24:27], a[104:107], a[24:27], v[24:27]
ds_read_b128 a[144:147], v109 offset:2048
v_mfma_f32_16x16x32_bf16 v[28:31], a[108:111], a[24:27], v[28:31]
ds_read_b128 a[148:151], v109 offset:3072
v_mfma_f32_16x16x32_bf16 v[32:35], a[112:115], a[24:27], v[32:35]
ds_read_b128 a[152:155], v113 offset:0
s_waitcnt vmcnt(22)
s_waitcnt lgkmcnt(5)
v_mfma_f32_16x16x32_bf16 v[16:19], a[116:119], a[28:31], v[16:19]
ds_read_b128 a[96:99], v109 offset:4608
buffer_load_dwordx4 a[24:27], v1, s[8:11], s60 offen offset:2048 sc1
v_mfma_f32_16x16x32_bf16 v[20:23], a[120:123], a[28:31], v[20:23]
ds_read_b128 a[100:103], v109 offset:5632
v_mfma_f32_16x16x32_bf16 v[24:27], a[124:127], a[28:31], v[24:27]
ds_read_b128 a[104:107], v109 offset:6656
v_mfma_f32_16x16x32_bf16 v[28:31], a[128:131], a[28:31], v[28:31]
ds_read_b128 a[108:111], v109 offset:7680
v_mfma_f32_16x16x32_bf16 v[32:35], a[132:135], a[28:31], v[32:35]
ds_read_b128 a[112:115], v113 offset:4608
s_barrier
s_waitcnt vmcnt(22)
s_waitcnt lgkmcnt(5)
v_mfma_f32_16x16x32_bf16 v[16:19], a[136:139], a[32:35], v[16:19]
ds_read_b128 a[116:119], v109 offset:9216
buffer_load_dwordx4 a[28:31], v1, s[8:11], s60 offen offset:3072 sc1
v_mfma_f32_16x16x32_bf16 v[20:23], a[140:143], a[32:35], v[20:23]
ds_read_b128 a[120:123], v109 offset:10240
s_add_u32 s37, s62, 147456
v_mfma_f32_16x16x32_bf16 v[24:27], a[144:147], a[32:35], v[24:27]
ds_read_b128 a[124:127], v109 offset:11264
s_mul_i32 s38, s24, 9216
v_mfma_f32_16x16x32_bf16 v[28:31], a[148:151], a[32:35], v[28:31]
ds_read_b128 a[128:131], v109 offset:12288
s_add_u32 s39, s38, s37
v_mfma_f32_16x16x32_bf16 v[32:35], a[152:155], a[32:35], v[32:35]
ds_read_b128 a[132:135], v113 offset:9216
s_add_u32 m0, s38, 0
s_waitcnt vmcnt(22)
s_waitcnt lgkmcnt(5)
v_mfma_f32_16x16x32_bf16 v[16:19], a[96:99], a[36:39], v[16:19]
ds_read_b128 a[136:139], v109 offset:13824
s_add_u32 s60, s60, 4096
buffer_load_dwordx4 a[32:35], v1, s[8:11], s60 offen offset:0 sc1
v_mfma_f32_16x16x32_bf16 v[20:23], a[100:103], a[36:39], v[20:23]
ds_read_b128 a[140:143], v109 offset:14848
s_nop 0
v_mfma_f32_16x16x32_bf16 v[24:27], a[104:107], a[36:39], v[24:27]
ds_read_b128 a[144:147], v109 offset:15872
buffer_load_dwordx4 v1, s[4:7], s39 offen offset:0  lds
v_mfma_f32_16x16x32_bf16 v[28:31], a[108:111], a[36:39], v[28:31]
ds_read_b128 a[148:151], v109 offset:16896
buffer_load_dwordx4 v1, s[4:7], s39 offen offset:1024  lds
v_mfma_f32_16x16x32_bf16 v[32:35], a[112:115], a[36:39], v[32:35]
ds_read_b128 a[152:155], v113 offset:13824
buffer_load_dwordx4 v1, s[4:7], s39 offen offset:2048  lds
s_waitcnt vmcnt(25)
s_waitcnt lgkmcnt(5)
v_mfma_f32_16x16x32_bf16 v[16:19], a[116:119], a[40:43], v[16:19]
ds_read_b128 a[96:99], v109 offset:18432
buffer_load_dwordx4 a[36:39], v1, s[8:11], s60 offen offset:1024 sc1
v_mfma_f32_16x16x32_bf16 v[20:23], a[120:123], a[40:43], v[20:23]
ds_read_b128 a[100:103], v109 offset:19456
buffer_load_dwordx4 v1, s[4:7], s39 offen offset:3072  lds
v_mfma_f32_16x16x32_bf16 v[24:27], a[124:127], a[40:43], v[24:27]
ds_read_b128 a[104:107], v109 offset:20480
s_add_u32 m0, m0, 4096
v_mfma_f32_16x16x32_bf16 v[28:31], a[128:131], a[40:43], v[28:31]
ds_read_b128 a[108:111], v109 offset:21504
s_add_u32 s39, s39, 4096
v_mfma_f32_16x16x32_bf16 v[32:35], a[132:135], a[40:43], v[32:35]
ds_read_b128 a[112:115], v113 offset:18432
buffer_load_dwordx4 v1, s[4:7], s39 offen offset:0  lds
s_waitcnt vmcnt(27)
s_waitcnt lgkmcnt(5)
v_mfma_f32_16x16x32_bf16 v[16:19], a[136:139], a[44:47], v[16:19]
ds_read_b128 a[116:119], v109 offset:23040
buffer_load_dwordx4 a[40:43], v1, s[8:11], s60 offen offset:2048 sc1
v_mfma_f32_16x16x32_bf16 v[20:23], a[140:143], a[44:47], v[20:23]
ds_read_b128 a[120:123], v109 offset:24064
buffer_load_dwordx4 v1, s[4:7], s39 offen offset:1024  lds
v_mfma_f32_16x16x32_bf16 v[24:27], a[144:147], a[44:47], v[24:27]
ds_read_b128 a[124:127], v109 offset:25088
buffer_load_dwordx4 v1, s[4:7], s39 offen offset:2048  lds
v_mfma_f32_16x16x32_bf16 v[28:31], a[148:151], a[44:47], v[28:31]
ds_read_b128 a[128:131], v109 offset:26112
buffer_load_dwordx4 v1, s[4:7], s39 offen offset:3072  lds
v_mfma_f32_16x16x32_bf16 v[32:35], a[152:155], a[44:47], v[32:35]
ds_read_b128 a[132:135], v113 offset:23040
s_add_u32 m0, m0, 4096
s_waitcnt vmcnt(30)
s_waitcnt lgkmcnt(5)
v_mfma_f32_16x16x32_bf16 v[16:19], a[96:99], a[48:51], v[16:19]
ds_read_b128 a[136:139], v109 offset:27648
buffer_load_dwordx4 a[44:47], v1, s[8:11], s60 offen offset:3072 sc1
v_mfma_f32_16x16x32_bf16 v[20:23], a[100:103], a[48:51], v[20:23]
ds_read_b128 a[140:143], v109 offset:28672
s_add_u32 s39, s39, 4096
v_mfma_f32_16x16x32_bf16 v[24:27], a[104:107], a[48:51], v[24:27]
ds_read_b128 a[144:147], v109 offset:29696
buffer_load_dwordx4 v1, s[4:7], s39 offen offset:0  lds
v_mfma_f32_16x16x32_bf16 v[28:31], a[108:111], a[48:51], v[28:31]
ds_read_b128 a[148:151], v109 offset:30720
v_mfma_f32_16x16x32_bf16 v[32:35], a[112:115], a[48:51], v[32:35]
ds_read_b128 a[152:155], v113 offset:27648
s_waitcnt vmcnt(31)
s_waitcnt lgkmcnt(5)
v_mfma_f32_16x16x32_bf16 v[16:19], a[116:119], a[52:55], v[16:19]
ds_read_b128 a[96:99], v109 offset:32256
s_add_u32 s60, s60, 4096
buffer_load_dwordx4 a[48:51], v1, s[8:11], s60 offen offset:0 sc1
v_mfma_f32_16x16x32_bf16 v[20:23], a[120:123], a[52:55], v[20:23]
ds_read_b128 a[100:103], v109 offset:33280
v_mfma_f32_16x16x32_bf16 v[24:27], a[124:127], a[52:55], v[24:27]
ds_read_b128 a[104:107], v109 offset:34304
v_mfma_f32_16x16x32_bf16 v[28:31], a[128:131], a[52:55], v[28:31]
ds_read_b128 a[108:111], v109 offset:35328
v_mfma_f32_16x16x32_bf16 v[32:35], a[132:135], a[52:55], v[32:35]
ds_read_b128 a[112:115], v113 offset:32256
s_waitcnt vmcnt(31)
s_waitcnt lgkmcnt(5)
v_mfma_f32_16x16x32_bf16 v[16:19], a[136:139], a[56:59], v[16:19]
ds_read_b128 a[116:119], v110 offset:0
buffer_load_dwordx4 a[52:55], v1, s[8:11], s60 offen offset:1024 sc1
v_mfma_f32_16x16x32_bf16 v[20:23], a[140:143], a[56:59], v[20:23]
ds_read_b128 a[120:123], v110 offset:1024
v_mfma_f32_16x16x32_bf16 v[24:27], a[144:147], a[56:59], v[24:27]
ds_read_b128 a[124:127], v110 offset:2048
v_mfma_f32_16x16x32_bf16 v[28:31], a[148:151], a[56:59], v[28:31]
ds_read_b128 a[128:131], v110 offset:3072
v_mfma_f32_16x16x32_bf16 v[32:35], a[152:155], a[56:59], v[32:35]
ds_read_b128 a[132:135], v114 offset:0
s_waitcnt vmcnt(31)
s_waitcnt lgkmcnt(5)
v_mfma_f32_16x16x32_bf16 v[16:19], a[96:99], a[60:63], v[16:19]
ds_read_b128 a[136:139], v110 offset:4608
buffer_load_dwordx4 a[56:59], v1, s[8:11], s60 offen offset:2048 sc1
v_mfma_f32_16x16x32_bf16 v[20:23], a[100:103], a[60:63], v[20:23]
ds_read_b128 a[140:143], v110 offset:5632
v_mfma_f32_16x16x32_bf16 v[24:27], a[104:107], a[60:63], v[24:27]
ds_read_b128 a[144:147], v110 offset:6656
v_mfma_f32_16x16x32_bf16 v[28:31], a[108:111], a[60:63], v[28:31]
ds_read_b128 a[148:151], v110 offset:7680
v_mfma_f32_16x16x32_bf16 v[32:35], a[112:115], a[60:63], v[32:35]
ds_read_b128 a[152:155], v114 offset:4608
s_barrier
s_waitcnt vmcnt(31)
s_waitcnt lgkmcnt(5)
v_mfma_f32_16x16x32_bf16 v[16:19], a[116:119], a[64:67], v[16:19]
ds_read_b128 a[96:99], v110 offset:9216
buffer_load_dwordx4 a[60:63], v1, s[8:11], s60 offen offset:3072 sc1
v_mfma_f32_16x16x32_bf16 v[20:23], a[120:123], a[64:67], v[20:23]
ds_read_b128 a[100:103], v110 offset:10240
s_add_u32 s37, s62, 184320
v_mfma_f32_16x16x32_bf16 v[24:27], a[124:127], a[64:67], v[24:27]
ds_read_b128 a[104:107], v110 offset:11264
s_mul_i32 s38, s24, 9216
v_mfma_f32_16x16x32_bf16 v[28:31], a[128:131], a[64:67], v[28:31]
ds_read_b128 a[108:111], v110 offset:12288
s_add_u32 s39, s38, s37
v_mfma_f32_16x16x32_bf16 v[32:35], a[132:135], a[64:67], v[32:35]
ds_read_b128 a[112:115], v114 offset:9216
s_add_u32 m0, s38, 36864
s_waitcnt vmcnt(31)
s_waitcnt lgkmcnt(5)
v_mfma_f32_16x16x32_bf16 v[16:19], a[136:139], a[68:71], v[16:19]
ds_read_b128 a[116:119], v110 offset:13824
s_add_u32 s60, s60, 4096
buffer_load_dwordx4 a[64:67], v1, s[8:11], s60 offen offset:0 sc1
v_mfma_f32_16x16x32_bf16 v[20:23], a[140:143], a[68:71], v[20:23]
ds_read_b128 a[120:123], v110 offset:14848
s_nop 0
v_mfma_f32_16x16x32_bf16 v[24:27], a[144:147], a[68:71], v[24:27]
ds_read_b128 a[124:127], v110 offset:15872
buffer_load_dwordx4 v1, s[4:7], s39 offen offset:0  lds
v_mfma_f32_16x16x32_bf16 v[28:31], a[148:151], a[68:71], v[28:31]
ds_read_b128 a[128:131], v110 offset:16896
buffer_load_dwordx4 v1, s[4:7], s39 offen offset:1024  lds
v_mfma_f32_16x16x32_bf16 v[32:35], a[152:155], a[68:71], v[32:35]
ds_read_b128 a[132:135], v114 offset:13824
buffer_load_dwordx4 v1, s[4:7], s39 offen offset:2048  lds
s_waitcnt vmcnt(34)
s_waitcnt lgkmcnt(5)
v_mfma_f32_16x16x32_bf16 v[16:19], a[96:99], a[72:75], v[16:19]
ds_read_b128 a[136:139], v110 offset:18432
buffer_load_dwordx4 a[68:71], v1, s[8:11], s60 offen offset:1024 sc1
v_mfma_f32_16x16x32_bf16 v[20:23], a[100:103], a[72:75], v[20:23]
ds_read_b128 a[140:143], v110 offset:19456
buffer_load_dwordx4 v1, s[4:7], s39 offen offset:3072  lds
v_mfma_f32_16x16x32_bf16 v[24:27], a[104:107], a[72:75], v[24:27]
ds_read_b128 a[144:147], v110 offset:20480
s_add_u32 m0, m0, 4096
v_mfma_f32_16x16x32_bf16 v[28:31], a[108:111], a[72:75], v[28:31]
ds_read_b128 a[148:151], v110 offset:21504
s_add_u32 s39, s39, 4096
v_mfma_f32_16x16x32_bf16 v[32:35], a[112:115], a[72:75], v[32:35]
ds_read_b128 a[152:155], v114 offset:18432
buffer_load_dwordx4 v1, s[4:7], s39 offen offset:0  lds
s_waitcnt vmcnt(36)
s_waitcnt lgkmcnt(5)
v_mfma_f32_16x16x32_bf16 v[16:19], a[116:119], a[76:79], v[16:19]
ds_read_b128 a[96:99], v110 offset:23040
buffer_load_dwordx4 a[72:75], v1, s[8:11], s60 offen offset:2048 sc1
v_mfma_f32_16x16x32_bf16 v[20:23], a[120:123], a[76:79], v[20:23]
ds_read_b128 a[100:103], v110 offset:24064
buffer_load_dwordx4 v1, s[4:7], s39 offen offset:1024  lds
v_mfma_f32_16x16x32_bf16 v[24:27], a[124:127], a[76:79], v[24:27]
ds_read_b128 a[104:107], v110 offset:25088
buffer_load_dwordx4 v1, s[4:7], s39 offen offset:2048  lds
v_mfma_f32_16x16x32_bf16 v[28:31], a[128:131], a[76:79], v[28:31]
ds_read_b128 a[108:111], v110 offset:26112
buffer_load_dwordx4 v1, s[4:7], s39 offen offset:3072  lds
v_mfma_f32_16x16x32_bf16 v[32:35], a[132:135], a[76:79], v[32:35]
ds_read_b128 a[112:115], v114 offset:23040
s_add_u32 m0, m0, 4096
s_waitcnt vmcnt(39)
s_waitcnt lgkmcnt(5)
v_mfma_f32_16x16x32_bf16 v[16:19], a[136:139], a[80:83], v[16:19]
ds_read_b128 a[116:119], v110 offset:27648
buffer_load_dwordx4 a[76:79], v1, s[8:11], s60 offen offset:3072 sc1
v_mfma_f32_16x16x32_bf16 v[20:23], a[140:143], a[80:83], v[20:23]
ds_read_b128 a[120:123], v110 offset:28672
s_add_u32 s39, s39, 4096
v_mfma_f32_16x16x32_bf16 v[24:27], a[144:147], a[80:83], v[24:27]
ds_read_b128 a[124:127], v110 offset:29696
buffer_load_dwordx4 v1, s[4:7], s39 offen offset:0  lds
v_mfma_f32_16x16x32_bf16 v[28:31], a[148:151], a[80:83], v[28:31]
ds_read_b128 a[128:131], v110 offset:30720
v_mfma_f32_16x16x32_bf16 v[32:35], a[152:155], a[80:83], v[32:35]
ds_read_b128 a[132:135], v114 offset:27648
s_waitcnt vmcnt(40)
s_waitcnt lgkmcnt(5)
v_mfma_f32_16x16x32_bf16 v[16:19], a[96:99], a[84:87], v[16:19]
ds_read_b128 a[136:139], v110 offset:32256
s_add_u32 s60, s60, 4096
buffer_load_dwordx4 a[80:83], v1, s[8:11], s60 offen offset:0 sc1
v_mfma_f32_16x16x32_bf16 v[20:23], a[100:103], a[84:87], v[20:23]
ds_read_b128 a[140:143], v110 offset:33280
v_mfma_f32_16x16x32_bf16 v[24:27], a[104:107], a[84:87], v[24:27]
ds_read_b128 a[144:147], v110 offset:34304
v_mfma_f32_16x16x32_bf16 v[28:31], a[108:111], a[84:87], v[28:31]
ds_read_b128 a[148:151], v110 offset:35328
v_mfma_f32_16x16x32_bf16 v[32:35], a[112:115], a[84:87], v[32:35]
ds_read_b128 a[152:155], v114 offset:32256
s_waitcnt vmcnt(40)
s_waitcnt lgkmcnt(5)
v_mfma_f32_16x16x32_bf16 v[16:19], a[116:119], a[88:91], v[16:19]
ds_read_b128 a[96:99], v111 offset:0
buffer_load_dwordx4 a[84:87], v1, s[8:11], s60 offen offset:1024 sc1
v_mfma_f32_16x16x32_bf16 v[20:23], a[120:123], a[88:91], v[20:23]
ds_read_b128 a[100:103], v111 offset:1024
v_mfma_f32_16x16x32_bf16 v[24:27], a[124:127], a[88:91], v[24:27]
ds_read_b128 a[104:107], v111 offset:2048
v_mfma_f32_16x16x32_bf16 v[28:31], a[128:131], a[88:91], v[28:31]
ds_read_b128 a[108:111], v111 offset:3072
v_mfma_f32_16x16x32_bf16 v[32:35], a[132:135], a[88:91], v[32:35]
ds_read_b128 a[112:115], v115 offset:0
s_waitcnt vmcnt(40)
s_waitcnt lgkmcnt(5)
v_mfma_f32_16x16x32_bf16 v[16:19], a[136:139], a[92:95], v[16:19]
ds_read_b128 a[116:119], v111 offset:4608
buffer_load_dwordx4 a[88:91], v1, s[8:11], s60 offen offset:2048 sc1
v_mfma_f32_16x16x32_bf16 v[20:23], a[140:143], a[92:95], v[20:23]
ds_read_b128 a[120:123], v111 offset:5632
v_mfma_f32_16x16x32_bf16 v[24:27], a[144:147], a[92:95], v[24:27]
ds_read_b128 a[124:127], v111 offset:6656
v_mfma_f32_16x16x32_bf16 v[28:31], a[148:151], a[92:95], v[28:31]
ds_read_b128 a[128:131], v111 offset:7680
v_mfma_f32_16x16x32_bf16 v[32:35], a[152:155], a[92:95], v[32:35]
ds_read_b128 a[132:135], v115 offset:4608
s_waitcnt vmcnt(20)
s_barrier
s_waitcnt lgkmcnt(5)
v_mfma_f32_16x16x32_bf16 v[16:19], a[96:99], a[0:3], v[16:19]
ds_read_b128 a[136:139], v111 offset:9216
buffer_load_dwordx4 a[92:95], v1, s[8:11], s60 offen offset:3072 sc1
v_mfma_f32_16x16x32_bf16 v[20:23], a[100:103], a[0:3], v[20:23]
ds_read_b128 a[140:143], v111 offset:10240
s_add_u32 s37, s62, 221184
v_mfma_f32_16x16x32_bf16 v[24:27], a[104:107], a[0:3], v[24:27]
ds_read_b128 a[144:147], v111 offset:11264
s_mul_i32 s38, s24, 9216
v_mfma_f32_16x16x32_bf16 v[28:31], a[108:111], a[0:3], v[28:31]
ds_read_b128 a[148:151], v111 offset:12288
s_add_u32 s39, s38, s37
v_mfma_f32_16x16x32_bf16 v[32:35], a[112:115], a[0:3], v[32:35]
ds_read_b128 a[152:155], v115 offset:9216
s_add_u32 m0, s38, 73728
s_waitcnt lgkmcnt(5)
v_mfma_f32_16x16x32_bf16 v[16:19], a[116:119], a[4:7], v[16:19]
ds_read_b128 a[96:99], v111 offset:13824
s_add_u32 s60, s60, 4096
buffer_load_dwordx4 a[0:3], v1, s[8:11], s60 offen offset:0 sc1
v_mfma_f32_16x16x32_bf16 v[20:23], a[120:123], a[4:7], v[20:23]
ds_read_b128 a[100:103], v111 offset:14848
s_nop 0
v_mfma_f32_16x16x32_bf16 v[24:27], a[124:127], a[4:7], v[24:27]
ds_read_b128 a[104:107], v111 offset:15872
buffer_load_dwordx4 v1, s[4:7], s39 offen offset:0  lds
v_mfma_f32_16x16x32_bf16 v[28:31], a[128:131], a[4:7], v[28:31]
ds_read_b128 a[108:111], v111 offset:16896
buffer_load_dwordx4 v1, s[4:7], s39 offen offset:1024  lds
v_mfma_f32_16x16x32_bf16 v[32:35], a[132:135], a[4:7], v[32:35]
ds_read_b128 a[112:115], v115 offset:13824
buffer_load_dwordx4 v1, s[4:7], s39 offen offset:2048  lds
s_waitcnt lgkmcnt(5)
v_mfma_f32_16x16x32_bf16 v[16:19], a[136:139], a[8:11], v[16:19]
ds_read_b128 a[116:119], v111 offset:18432
buffer_load_dwordx4 a[4:7], v1, s[8:11], s60 offen offset:1024 sc1
v_mfma_f32_16x16x32_bf16 v[20:23], a[140:143], a[8:11], v[20:23]
ds_read_b128 a[120:123], v111 offset:19456
buffer_load_dwordx4 v1, s[4:7], s39 offen offset:3072  lds
v_mfma_f32_16x16x32_bf16 v[24:27], a[144:147], a[8:11], v[24:27]
ds_read_b128 a[124:127], v111 offset:20480
s_add_u32 m0, m0, 4096
v_mfma_f32_16x16x32_bf16 v[28:31], a[148:151], a[8:11], v[28:31]
ds_read_b128 a[128:131], v111 offset:21504
s_add_u32 s39, s39, 4096
v_mfma_f32_16x16x32_bf16 v[32:35], a[152:155], a[8:11], v[32:35]
ds_read_b128 a[132:135], v115 offset:18432
buffer_load_dwordx4 v1, s[4:7], s39 offen offset:0  lds
s_waitcnt lgkmcnt(5)
v_mfma_f32_16x16x32_bf16 v[16:19], a[96:99], a[12:15], v[16:19]
ds_read_b128 a[136:139], v111 offset:23040
buffer_load_dwordx4 a[8:11], v1, s[8:11], s60 offen offset:2048 sc1
v_mfma_f32_16x16x32_bf16 v[20:23], a[100:103], a[12:15], v[20:23]
ds_read_b128 a[140:143], v111 offset:24064
buffer_load_dwordx4 v1, s[4:7], s39 offen offset:1024  lds
v_mfma_f32_16x16x32_bf16 v[24:27], a[104:107], a[12:15], v[24:27]
ds_read_b128 a[144:147], v111 offset:25088
buffer_load_dwordx4 v1, s[4:7], s39 offen offset:2048  lds
v_mfma_f32_16x16x32_bf16 v[28:31], a[108:111], a[12:15], v[28:31]
ds_read_b128 a[148:151], v111 offset:26112
buffer_load_dwordx4 v1, s[4:7], s39 offen offset:3072  lds
v_mfma_f32_16x16x32_bf16 v[32:35], a[112:115], a[12:15], v[32:35]
ds_read_b128 a[152:155], v115 offset:23040
s_add_u32 m0, m0, 4096
s_waitcnt lgkmcnt(5)
v_mfma_f32_16x16x32_bf16 v[16:19], a[116:119], a[16:19], v[16:19]
ds_read_b128 a[96:99], v111 offset:27648
buffer_load_dwordx4 a[12:15], v1, s[8:11], s60 offen offset:3072 sc1
v_mfma_f32_16x16x32_bf16 v[20:23], a[120:123], a[16:19], v[20:23]
ds_read_b128 a[100:103], v111 offset:28672
s_add_u32 s39, s39, 4096
v_mfma_f32_16x16x32_bf16 v[24:27], a[124:127], a[16:19], v[24:27]
ds_read_b128 a[104:107], v111 offset:29696
buffer_load_dwordx4 v1, s[4:7], s39 offen offset:0  lds
v_mfma_f32_16x16x32_bf16 v[28:31], a[128:131], a[16:19], v[28:31]
ds_read_b128 a[108:111], v111 offset:30720
v_mfma_f32_16x16x32_bf16 v[32:35], a[132:135], a[16:19], v[32:35]
ds_read_b128 a[112:115], v115 offset:27648
s_waitcnt lgkmcnt(5)
v_mfma_f32_16x16x32_bf16 v[16:19], a[136:139], a[20:23], v[16:19]
ds_read_b128 a[116:119], v111 offset:32256
s_add_u32 s60, s60, 4096
buffer_load_dwordx4 a[16:19], v1, s[8:11], s60 offen offset:0 sc1
v_mfma_f32_16x16x32_bf16 v[20:23], a[140:143], a[20:23], v[20:23]
ds_read_b128 a[120:123], v111 offset:33280
v_mfma_f32_16x16x32_bf16 v[24:27], a[144:147], a[20:23], v[24:27]
ds_read_b128 a[124:127], v111 offset:34304
v_mfma_f32_16x16x32_bf16 v[28:31], a[148:151], a[20:23], v[28:31]
ds_read_b128 a[128:131], v111 offset:35328
v_mfma_f32_16x16x32_bf16 v[32:35], a[152:155], a[20:23], v[32:35]
ds_read_b128 a[132:135], v115 offset:32256
s_waitcnt lgkmcnt(5)
v_mfma_f32_16x16x32_bf16 v[16:19], a[96:99], a[24:27], v[16:19]
ds_read_b128 a[136:139], v108 offset:0
buffer_load_dwordx4 a[20:23], v1, s[8:11], s60 offen offset:1024 sc1
v_mfma_f32_16x16x32_bf16 v[20:23], a[100:103], a[24:27], v[20:23]
ds_read_b128 a[140:143], v108 offset:1024
v_mfma_f32_16x16x32_bf16 v[24:27], a[104:107], a[24:27], v[24:27]
ds_read_b128 a[144:147], v108 offset:2048
v_mfma_f32_16x16x32_bf16 v[28:31], a[108:111], a[24:27], v[28:31]
ds_read_b128 a[148:151], v108 offset:3072
v_mfma_f32_16x16x32_bf16 v[32:35], a[112:115], a[24:27], v[32:35]
ds_read_b128 a[152:155], v112 offset:0
s_waitcnt lgkmcnt(5)
v_mfma_f32_16x16x32_bf16 v[16:19], a[116:119], a[28:31], v[16:19]
ds_read_b128 a[96:99], v108 offset:4608
buffer_load_dwordx4 a[24:27], v1, s[8:11], s60 offen offset:2048 sc1
v_mfma_f32_16x16x32_bf16 v[20:23], a[120:123], a[28:31], v[20:23]
ds_read_b128 a[100:103], v108 offset:5632
v_mfma_f32_16x16x32_bf16 v[24:27], a[124:127], a[28:31], v[24:27]
ds_read_b128 a[104:107], v108 offset:6656
v_mfma_f32_16x16x32_bf16 v[28:31], a[128:131], a[28:31], v[28:31]
ds_read_b128 a[108:111], v108 offset:7680
v_mfma_f32_16x16x32_bf16 v[32:35], a[132:135], a[28:31], v[32:35]
ds_read_b128 a[112:115], v112 offset:4608
s_waitcnt vmcnt(20)
s_barrier
s_waitcnt lgkmcnt(5)
v_mfma_f32_16x16x32_bf16 v[16:19], a[136:139], a[32:35], v[16:19]
ds_read_b128 a[116:119], v108 offset:9216
buffer_load_dwordx4 a[28:31], v1, s[8:11], s60 offen offset:3072 sc1
v_mfma_f32_16x16x32_bf16 v[20:23], a[140:143], a[32:35], v[20:23]
ds_read_b128 a[120:123], v108 offset:10240
s_add_u32 s37, s62, 258048
v_mfma_f32_16x16x32_bf16 v[24:27], a[144:147], a[32:35], v[24:27]
ds_read_b128 a[124:127], v108 offset:11264
s_mul_i32 s38, s24, 9216
v_mfma_f32_16x16x32_bf16 v[28:31], a[148:151], a[32:35], v[28:31]
ds_read_b128 a[128:131], v108 offset:12288
s_add_u32 s39, s38, s37
v_mfma_f32_16x16x32_bf16 v[32:35], a[152:155], a[32:35], v[32:35]
ds_read_b128 a[132:135], v112 offset:9216
s_add_u32 m0, s38, 110592
s_waitcnt lgkmcnt(5)
v_mfma_f32_16x16x32_bf16 v[16:19], a[96:99], a[36:39], v[16:19]
ds_read_b128 a[136:139], v108 offset:13824
s_add_u32 s60, s60, 4096
buffer_load_dwordx4 a[32:35], v1, s[8:11], s60 offen offset:0 sc1
v_mfma_f32_16x16x32_bf16 v[20:23], a[100:103], a[36:39], v[20:23]
ds_read_b128 a[140:143], v108 offset:14848
s_nop 0
v_mfma_f32_16x16x32_bf16 v[24:27], a[104:107], a[36:39], v[24:27]
ds_read_b128 a[144:147], v108 offset:15872
buffer_load_dwordx4 v1, s[4:7], s39 offen offset:0  lds
v_mfma_f32_16x16x32_bf16 v[28:31], a[108:111], a[36:39], v[28:31]
ds_read_b128 a[148:151], v108 offset:16896
buffer_load_dwordx4 v1, s[4:7], s39 offen offset:1024  lds
v_mfma_f32_16x16x32_bf16 v[32:35], a[112:115], a[36:39], v[32:35]
ds_read_b128 a[152:155], v112 offset:13824
buffer_load_dwordx4 v1, s[4:7], s39 offen offset:2048  lds
s_waitcnt lgkmcnt(5)
v_mfma_f32_16x16x32_bf16 v[16:19], a[116:119], a[40:43], v[16:19]
ds_read_b128 a[96:99], v108 offset:18432
buffer_load_dwordx4 a[36:39], v1, s[8:11], s60 offen offset:1024 sc1
v_mfma_f32_16x16x32_bf16 v[20:23], a[120:123], a[40:43], v[20:23]
ds_read_b128 a[100:103], v108 offset:19456
buffer_load_dwordx4 v1, s[4:7], s39 offen offset:3072  lds
v_mfma_f32_16x16x32_bf16 v[24:27], a[124:127], a[40:43], v[24:27]
ds_read_b128 a[104:107], v108 offset:20480
s_add_u32 m0, m0, 4096
v_mfma_f32_16x16x32_bf16 v[28:31], a[128:131], a[40:43], v[28:31]
ds_read_b128 a[108:111], v108 offset:21504
s_add_u32 s39, s39, 4096
v_mfma_f32_16x16x32_bf16 v[32:35], a[132:135], a[40:43], v[32:35]
ds_read_b128 a[112:115], v112 offset:18432
buffer_load_dwordx4 v1, s[4:7], s39 offen offset:0  lds
s_waitcnt lgkmcnt(5)
v_mfma_f32_16x16x32_bf16 v[16:19], a[136:139], a[44:47], v[16:19]
ds_read_b128 a[116:119], v108 offset:23040
buffer_load_dwordx4 a[40:43], v1, s[8:11], s60 offen offset:2048 sc1
v_mfma_f32_16x16x32_bf16 v[20:23], a[140:143], a[44:47], v[20:23]
ds_read_b128 a[120:123], v108 offset:24064
buffer_load_dwordx4 v1, s[4:7], s39 offen offset:1024  lds
v_mfma_f32_16x16x32_bf16 v[24:27], a[144:147], a[44:47], v[24:27]
ds_read_b128 a[124:127], v108 offset:25088
buffer_load_dwordx4 v1, s[4:7], s39 offen offset:2048  lds
v_mfma_f32_16x16x32_bf16 v[28:31], a[148:151], a[44:47], v[28:31]
ds_read_b128 a[128:131], v108 offset:26112
buffer_load_dwordx4 v1, s[4:7], s39 offen offset:3072  lds
v_mfma_f32_16x16x32_bf16 v[32:35], a[152:155], a[44:47], v[32:35]
ds_read_b128 a[132:135], v112 offset:23040
s_add_u32 m0, m0, 4096
s_waitcnt lgkmcnt(5)
v_mfma_f32_16x16x32_bf16 v[16:19], a[96:99], a[48:51], v[16:19]
ds_read_b128 a[136:139], v108 offset:27648
buffer_load_dwordx4 a[44:47], v1, s[8:11], s60 offen offset:3072 sc1
v_mfma_f32_16x16x32_bf16 v[20:23], a[100:103], a[48:51], v[20:23]
ds_read_b128 a[140:143], v108 offset:28672
s_add_u32 s39, s39, 4096
v_mfma_f32_16x16x32_bf16 v[24:27], a[104:107], a[48:51], v[24:27]
ds_read_b128 a[144:147], v108 offset:29696
buffer_load_dwordx4 v1, s[4:7], s39 offen offset:0  lds
v_mfma_f32_16x16x32_bf16 v[28:31], a[108:111], a[48:51], v[28:31]
ds_read_b128 a[148:151], v108 offset:30720
v_mfma_f32_16x16x32_bf16 v[32:35], a[112:115], a[48:51], v[32:35]
ds_read_b128 a[152:155], v112 offset:27648
s_waitcnt lgkmcnt(5)
v_mfma_f32_16x16x32_bf16 v[16:19], a[116:119], a[52:55], v[16:19]
ds_read_b128 a[96:99], v108 offset:32256
s_add_u32 s60, s60, 4096
buffer_load_dwordx4 a[48:51], v1, s[8:11], s60 offen offset:0 sc1
v_mfma_f32_16x16x32_bf16 v[20:23], a[120:123], a[52:55], v[20:23]
ds_read_b128 a[100:103], v108 offset:33280
v_mfma_f32_16x16x32_bf16 v[24:27], a[124:127], a[52:55], v[24:27]
ds_read_b128 a[104:107], v108 offset:34304
v_mfma_f32_16x16x32_bf16 v[28:31], a[128:131], a[52:55], v[28:31]
ds_read_b128 a[108:111], v108 offset:35328
v_mfma_f32_16x16x32_bf16 v[32:35], a[132:135], a[52:55], v[32:35]
ds_read_b128 a[112:115], v112 offset:32256
s_waitcnt lgkmcnt(5)
v_mfma_f32_16x16x32_bf16 v[16:19], a[136:139], a[56:59], v[16:19]
ds_read_b128 a[116:119], v109 offset:0
buffer_load_dwordx4 a[52:55], v1, s[8:11], s60 offen offset:1024 sc1
v_mfma_f32_16x16x32_bf16 v[20:23], a[140:143], a[56:59], v[20:23]
ds_read_b128 a[120:123], v109 offset:1024
v_mfma_f32_16x16x32_bf16 v[24:27], a[144:147], a[56:59], v[24:27]
ds_read_b128 a[124:127], v109 offset:2048
v_mfma_f32_16x16x32_bf16 v[28:31], a[148:151], a[56:59], v[28:31]
ds_read_b128 a[128:131], v109 offset:3072
v_mfma_f32_16x16x32_bf16 v[32:35], a[152:155], a[56:59], v[32:35]
ds_read_b128 a[132:135], v113 offset:0
s_waitcnt lgkmcnt(5)
v_mfma_f32_16x16x32_bf16 v[16:19], a[96:99], a[60:63], v[16:19]
ds_read_b128 a[136:139], v109 offset:4608
buffer_load_dwordx4 a[56:59], v1, s[8:11], s60 offen offset:2048 sc1
v_mfma_f32_16x16x32_bf16 v[20:23], a[100:103], a[60:63], v[20:23]
ds_read_b128 a[140:143], v109 offset:5632
v_mfma_f32_16x16x32_bf16 v[24:27], a[104:107], a[60:63], v[24:27]
ds_read_b128 a[144:147], v109 offset:6656
v_mfma_f32_16x16x32_bf16 v[28:31], a[108:111], a[60:63], v[28:31]
ds_read_b128 a[148:151], v109 offset:7680
v_mfma_f32_16x16x32_bf16 v[32:35], a[112:115], a[60:63], v[32:35]
ds_read_b128 a[152:155], v113 offset:4608
s_waitcnt vmcnt(20)
s_barrier
s_waitcnt lgkmcnt(5)
v_mfma_f32_16x16x32_bf16 v[16:19], a[116:119], a[64:67], v[16:19]
ds_read_b128 a[96:99], v109 offset:9216
buffer_load_dwordx4 a[60:63], v1, s[8:11], s60 offen offset:3072 sc1
v_mfma_f32_16x16x32_bf16 v[20:23], a[120:123], a[64:67], v[20:23]
ds_read_b128 a[100:103], v109 offset:10240
s_add_u32 s37, s62, 294912
v_mfma_f32_16x16x32_bf16 v[24:27], a[124:127], a[64:67], v[24:27]
ds_read_b128 a[104:107], v109 offset:11264
s_mul_i32 s38, s24, 9216
v_mfma_f32_16x16x32_bf16 v[28:31], a[128:131], a[64:67], v[28:31]
ds_read_b128 a[108:111], v109 offset:12288
s_add_u32 s39, s38, s37
v_mfma_f32_16x16x32_bf16 v[32:35], a[132:135], a[64:67], v[32:35]
ds_read_b128 a[112:115], v113 offset:9216
s_add_u32 m0, s38, 0
s_waitcnt lgkmcnt(5)
v_mfma_f32_16x16x32_bf16 v[16:19], a[136:139], a[68:71], v[16:19]
ds_read_b128 a[116:119], v109 offset:13824
s_add_u32 s60, s60, 4096
buffer_load_dwordx4 a[64:67], v1, s[8:11], s60 offen offset:0 sc1
v_mfma_f32_16x16x32_bf16 v[20:23], a[140:143], a[68:71], v[20:23]
ds_read_b128 a[120:123], v109 offset:14848
s_nop 0
v_mfma_f32_16x16x32_bf16 v[24:27], a[144:147], a[68:71], v[24:27]
ds_read_b128 a[124:127], v109 offset:15872
buffer_load_dwordx4 v1, s[4:7], s39 offen offset:0  lds
v_mfma_f32_16x16x32_bf16 v[28:31], a[148:151], a[68:71], v[28:31]
ds_read_b128 a[128:131], v109 offset:16896
buffer_load_dwordx4 v1, s[4:7], s39 offen offset:1024  lds
v_mfma_f32_16x16x32_bf16 v[32:35], a[152:155], a[68:71], v[32:35]
ds_read_b128 a[132:135], v113 offset:13824
buffer_load_dwordx4 v1, s[4:7], s39 offen offset:2048  lds
s_waitcnt lgkmcnt(5)
v_mfma_f32_16x16x32_bf16 v[16:19], a[96:99], a[72:75], v[16:19]
ds_read_b128 a[136:139], v109 offset:18432
buffer_load_dwordx4 a[68:71], v1, s[8:11], s60 offen offset:1024 sc1
v_mfma_f32_16x16x32_bf16 v[20:23], a[100:103], a[72:75], v[20:23]
ds_read_b128 a[140:143], v109 offset:19456
buffer_load_dwordx4 v1, s[4:7], s39 offen offset:3072  lds
v_mfma_f32_16x16x32_bf16 v[24:27], a[104:107], a[72:75], v[24:27]
ds_read_b128 a[144:147], v109 offset:20480
s_add_u32 m0, m0, 4096
v_mfma_f32_16x16x32_bf16 v[28:31], a[108:111], a[72:75], v[28:31]
ds_read_b128 a[148:151], v109 offset:21504
s_add_u32 s39, s39, 4096
v_mfma_f32_16x16x32_bf16 v[32:35], a[112:115], a[72:75], v[32:35]
ds_read_b128 a[152:155], v113 offset:18432
buffer_load_dwordx4 v1, s[4:7], s39 offen offset:0  lds
s_waitcnt lgkmcnt(5)
v_mfma_f32_16x16x32_bf16 v[16:19], a[116:119], a[76:79], v[16:19]
ds_read_b128 a[96:99], v109 offset:23040
buffer_load_dwordx4 a[72:75], v1, s[8:11], s60 offen offset:2048 sc1
v_mfma_f32_16x16x32_bf16 v[20:23], a[120:123], a[76:79], v[20:23]
ds_read_b128 a[100:103], v109 offset:24064
buffer_load_dwordx4 v1, s[4:7], s39 offen offset:1024  lds
v_mfma_f32_16x16x32_bf16 v[24:27], a[124:127], a[76:79], v[24:27]
ds_read_b128 a[104:107], v109 offset:25088
buffer_load_dwordx4 v1, s[4:7], s39 offen offset:2048  lds
v_mfma_f32_16x16x32_bf16 v[28:31], a[128:131], a[76:79], v[28:31]
ds_read_b128 a[108:111], v109 offset:26112
buffer_load_dwordx4 v1, s[4:7], s39 offen offset:3072  lds
v_mfma_f32_16x16x32_bf16 v[32:35], a[132:135], a[76:79], v[32:35]
ds_read_b128 a[112:115], v113 offset:23040
s_add_u32 m0, m0, 4096
s_waitcnt lgkmcnt(5)
v_mfma_f32_16x16x32_bf16 v[16:19], a[136:139], a[80:83], v[16:19]
ds_read_b128 a[116:119], v109 offset:27648
buffer_load_dwordx4 a[76:79], v1, s[8:11], s60 offen offset:3072 sc1
v_mfma_f32_16x16x32_bf16 v[20:23], a[140:143], a[80:83], v[20:23]
ds_read_b128 a[120:123], v109 offset:28672
s_add_u32 s39, s39, 4096
v_mfma_f32_16x16x32_bf16 v[24:27], a[144:147], a[80:83], v[24:27]
ds_read_b128 a[124:127], v109 offset:29696
buffer_load_dwordx4 v1, s[4:7], s39 offen offset:0  lds
v_mfma_f32_16x16x32_bf16 v[28:31], a[148:151], a[80:83], v[28:31]
ds_read_b128 a[128:131], v109 offset:30720
v_mfma_f32_16x16x32_bf16 v[32:35], a[152:155], a[80:83], v[32:35]
ds_read_b128 a[132:135], v113 offset:27648
s_waitcnt lgkmcnt(5)
v_mfma_f32_16x16x32_bf16 v[16:19], a[96:99], a[84:87], v[16:19]
ds_read_b128 a[136:139], v109 offset:32256
s_add_u32 s60, s60, 4096
buffer_load_dwordx4 a[80:83], v1, s[8:11], s60 offen offset:0 sc1
v_mfma_f32_16x16x32_bf16 v[20:23], a[100:103], a[84:87], v[20:23]
ds_read_b128 a[140:143], v109 offset:33280
v_mfma_f32_16x16x32_bf16 v[24:27], a[104:107], a[84:87], v[24:27]
ds_read_b128 a[144:147], v109 offset:34304
v_mfma_f32_16x16x32_bf16 v[28:31], a[108:111], a[84:87], v[28:31]
ds_read_b128 a[148:151], v109 offset:35328
v_mfma_f32_16x16x32_bf16 v[32:35], a[112:115], a[84:87], v[32:35]
ds_read_b128 a[152:155], v113 offset:32256
s_waitcnt lgkmcnt(5)
v_mfma_f32_16x16x32_bf16 v[16:19], a[116:119], a[88:91], v[16:19]
ds_read_b128 a[96:99], v110 offset:0
buffer_load_dwordx4 a[84:87], v1, s[8:11], s60 offen offset:1024 sc1
v_mfma_f32_16x16x32_bf16 v[20:23], a[120:123], a[88:91], v[20:23]
ds_read_b128 a[100:103], v110 offset:1024
v_mfma_f32_16x16x32_bf16 v[24:27], a[124:127], a[88:91], v[24:27]
ds_read_b128 a[104:107], v110 offset:2048
v_mfma_f32_16x16x32_bf16 v[28:31], a[128:131], a[88:91], v[28:31]
ds_read_b128 a[108:111], v110 offset:3072
v_mfma_f32_16x16x32_bf16 v[32:35], a[132:135], a[88:91], v[32:35]
ds_read_b128 a[112:115], v114 offset:0
s_waitcnt lgkmcnt(5)
v_mfma_f32_16x16x32_bf16 v[16:19], a[136:139], a[92:95], v[16:19]
ds_read_b128 a[116:119], v110 offset:4608
buffer_load_dwordx4 a[88:91], v1, s[8:11], s60 offen offset:2048 sc1
v_mfma_f32_16x16x32_bf16 v[20:23], a[140:143], a[92:95], v[20:23]
ds_read_b128 a[120:123], v110 offset:5632
v_mfma_f32_16x16x32_bf16 v[24:27], a[144:147], a[92:95], v[24:27]
ds_read_b128 a[124:127], v110 offset:6656
v_mfma_f32_16x16x32_bf16 v[28:31], a[148:151], a[92:95], v[28:31]
ds_read_b128 a[128:131], v110 offset:7680
v_mfma_f32_16x16x32_bf16 v[32:35], a[152:155], a[92:95], v[32:35]
ds_read_b128 a[132:135], v114 offset:4608
s_waitcnt vmcnt(20)
s_barrier
s_waitcnt lgkmcnt(5)
v_mfma_f32_16x16x32_bf16 v[16:19], a[96:99], a[0:3], v[16:19]
ds_read_b128 a[136:139], v110 offset:9216
buffer_load_dwordx4 a[92:95], v1, s[8:11], s60 offen offset:3072 sc1
v_mfma_f32_16x16x32_bf16 v[20:23], a[100:103], a[0:3], v[20:23]
ds_read_b128 a[140:143], v110 offset:10240
v_mfma_f32_16x16x32_bf16 v[24:27], a[104:107], a[0:3], v[24:27]
ds_read_b128 a[144:147], v110 offset:11264
v_mfma_f32_16x16x32_bf16 v[28:31], a[108:111], a[0:3], v[28:31]
ds_read_b128 a[148:151], v110 offset:12288
v_mfma_f32_16x16x32_bf16 v[32:35], a[112:115], a[0:3], v[32:35]
ds_read_b128 a[152:155], v114 offset:9216
s_waitcnt lgkmcnt(5)
v_mfma_f32_16x16x32_bf16 v[16:19], a[116:119], a[4:7], v[16:19]
ds_read_b128 a[96:99], v110 offset:13824
v_mfma_f32_16x16x32_bf16 v[20:23], a[120:123], a[4:7], v[20:23]
ds_read_b128 a[100:103], v110 offset:14848
v_mfma_f32_16x16x32_bf16 v[24:27], a[124:127], a[4:7], v[24:27]
ds_read_b128 a[104:107], v110 offset:15872
v_mfma_f32_16x16x32_bf16 v[28:31], a[128:131], a[4:7], v[28:31]
ds_read_b128 a[108:111], v110 offset:16896
v_mfma_f32_16x16x32_bf16 v[32:35], a[132:135], a[4:7], v[32:35]
ds_read_b128 a[112:115], v114 offset:13824
s_waitcnt lgkmcnt(5)
v_mfma_f32_16x16x32_bf16 v[16:19], a[136:139], a[8:11], v[16:19]
ds_read_b128 a[116:119], v110 offset:18432
v_mfma_f32_16x16x32_bf16 v[20:23], a[140:143], a[8:11], v[20:23]
ds_read_b128 a[120:123], v110 offset:19456
v_mfma_f32_16x16x32_bf16 v[24:27], a[144:147], a[8:11], v[24:27]
ds_read_b128 a[124:127], v110 offset:20480
v_mfma_f32_16x16x32_bf16 v[28:31], a[148:151], a[8:11], v[28:31]
ds_read_b128 a[128:131], v110 offset:21504
v_mfma_f32_16x16x32_bf16 v[32:35], a[152:155], a[8:11], v[32:35]
ds_read_b128 a[132:135], v114 offset:18432
s_waitcnt lgkmcnt(5)
v_mfma_f32_16x16x32_bf16 v[16:19], a[96:99], a[12:15], v[16:19]
ds_read_b128 a[136:139], v110 offset:23040
v_mfma_f32_16x16x32_bf16 v[20:23], a[100:103], a[12:15], v[20:23]
ds_read_b128 a[140:143], v110 offset:24064
v_mfma_f32_16x16x32_bf16 v[24:27], a[104:107], a[12:15], v[24:27]
ds_read_b128 a[144:147], v110 offset:25088
v_mfma_f32_16x16x32_bf16 v[28:31], a[108:111], a[12:15], v[28:31]
ds_read_b128 a[148:151], v110 offset:26112
v_mfma_f32_16x16x32_bf16 v[32:35], a[112:115], a[12:15], v[32:35]
ds_read_b128 a[152:155], v114 offset:23040
s_waitcnt lgkmcnt(5)
v_mfma_f32_16x16x32_bf16 v[16:19], a[116:119], a[16:19], v[16:19]
ds_read_b128 a[96:99], v110 offset:27648
v_mfma_f32_16x16x32_bf16 v[20:23], a[120:123], a[16:19], v[20:23]
ds_read_b128 a[100:103], v110 offset:28672
v_mfma_f32_16x16x32_bf16 v[24:27], a[124:127], a[16:19], v[24:27]
ds_read_b128 a[104:107], v110 offset:29696
v_mfma_f32_16x16x32_bf16 v[28:31], a[128:131], a[16:19], v[28:31]
ds_read_b128 a[108:111], v110 offset:30720
v_mfma_f32_16x16x32_bf16 v[32:35], a[132:135], a[16:19], v[32:35]
ds_read_b128 a[112:115], v114 offset:27648
s_waitcnt lgkmcnt(5)
v_mfma_f32_16x16x32_bf16 v[16:19], a[136:139], a[20:23], v[16:19]
ds_read_b128 a[116:119], v110 offset:32256
v_mfma_f32_16x16x32_bf16 v[20:23], a[140:143], a[20:23], v[20:23]
ds_read_b128 a[120:123], v110 offset:33280
v_mfma_f32_16x16x32_bf16 v[24:27], a[144:147], a[20:23], v[24:27]
ds_read_b128 a[124:127], v110 offset:34304
v_mfma_f32_16x16x32_bf16 v[28:31], a[148:151], a[20:23], v[28:31]
ds_read_b128 a[128:131], v110 offset:35328
v_mfma_f32_16x16x32_bf16 v[32:35], a[152:155], a[20:23], v[32:35]
ds_read_b128 a[132:135], v114 offset:32256
s_waitcnt lgkmcnt(5)
v_mfma_f32_16x16x32_bf16 v[16:19], a[96:99], a[24:27], v[16:19]
ds_read_b128 a[136:139], v111 offset:0
v_mfma_f32_16x16x32_bf16 v[20:23], a[100:103], a[24:27], v[20:23]
ds_read_b128 a[140:143], v111 offset:1024
v_mfma_f32_16x16x32_bf16 v[24:27], a[104:107], a[24:27], v[24:27]
ds_read_b128 a[144:147], v111 offset:2048
v_mfma_f32_16x16x32_bf16 v[28:31], a[108:111], a[24:27], v[28:31]
ds_read_b128 a[148:151], v111 offset:3072
v_mfma_f32_16x16x32_bf16 v[32:35], a[112:115], a[24:27], v[32:35]
ds_read_b128 a[152:155], v115 offset:0
s_waitcnt lgkmcnt(5)
v_mfma_f32_16x16x32_bf16 v[16:19], a[116:119], a[28:31], v[16:19]
ds_read_b128 a[96:99], v111 offset:4608
v_mfma_f32_16x16x32_bf16 v[20:23], a[120:123], a[28:31], v[20:23]
ds_read_b128 a[100:103], v111 offset:5632
v_mfma_f32_16x16x32_bf16 v[24:27], a[124:127], a[28:31], v[24:27]
ds_read_b128 a[104:107], v111 offset:6656
v_mfma_f32_16x16x32_bf16 v[28:31], a[128:131], a[28:31], v[28:31]
ds_read_b128 a[108:111], v111 offset:7680
v_mfma_f32_16x16x32_bf16 v[32:35], a[132:135], a[28:31], v[32:35]
ds_read_b128 a[112:115], v115 offset:4608
s_waitcnt vmcnt(4)
s_barrier
s_waitcnt lgkmcnt(5)
v_mfma_f32_16x16x32_bf16 v[16:19], a[136:139], a[32:35], v[16:19]
ds_read_b128 a[116:119], v111 offset:9216
v_mfma_f32_16x16x32_bf16 v[20:23], a[140:143], a[32:35], v[20:23]
ds_read_b128 a[120:123], v111 offset:10240
v_mfma_f32_16x16x32_bf16 v[24:27], a[144:147], a[32:35], v[24:27]
ds_read_b128 a[124:127], v111 offset:11264
v_mfma_f32_16x16x32_bf16 v[28:31], a[148:151], a[32:35], v[28:31]
ds_read_b128 a[128:131], v111 offset:12288
v_mfma_f32_16x16x32_bf16 v[32:35], a[152:155], a[32:35], v[32:35]
ds_read_b128 a[132:135], v115 offset:9216
s_waitcnt lgkmcnt(5)
v_mfma_f32_16x16x32_bf16 v[16:19], a[96:99], a[36:39], v[16:19]
ds_read_b128 a[136:139], v111 offset:13824
v_mfma_f32_16x16x32_bf16 v[20:23], a[100:103], a[36:39], v[20:23]
ds_read_b128 a[140:143], v111 offset:14848
v_mfma_f32_16x16x32_bf16 v[24:27], a[104:107], a[36:39], v[24:27]
ds_read_b128 a[144:147], v111 offset:15872
v_mfma_f32_16x16x32_bf16 v[28:31], a[108:111], a[36:39], v[28:31]
ds_read_b128 a[148:151], v111 offset:16896
v_mfma_f32_16x16x32_bf16 v[32:35], a[112:115], a[36:39], v[32:35]
ds_read_b128 a[152:155], v115 offset:13824
s_waitcnt lgkmcnt(5)
v_mfma_f32_16x16x32_bf16 v[16:19], a[116:119], a[40:43], v[16:19]
ds_read_b128 a[96:99], v111 offset:18432
v_mfma_f32_16x16x32_bf16 v[20:23], a[120:123], a[40:43], v[20:23]
ds_read_b128 a[100:103], v111 offset:19456
v_mfma_f32_16x16x32_bf16 v[24:27], a[124:127], a[40:43], v[24:27]
ds_read_b128 a[104:107], v111 offset:20480
v_mfma_f32_16x16x32_bf16 v[28:31], a[128:131], a[40:43], v[28:31]
ds_read_b128 a[108:111], v111 offset:21504
v_mfma_f32_16x16x32_bf16 v[32:35], a[132:135], a[40:43], v[32:35]
ds_read_b128 a[112:115], v115 offset:18432
s_waitcnt lgkmcnt(5)
v_mfma_f32_16x16x32_bf16 v[16:19], a[136:139], a[44:47], v[16:19]
ds_read_b128 a[116:119], v111 offset:23040
v_mfma_f32_16x16x32_bf16 v[20:23], a[140:143], a[44:47], v[20:23]
ds_read_b128 a[120:123], v111 offset:24064
v_mfma_f32_16x16x32_bf16 v[24:27], a[144:147], a[44:47], v[24:27]
ds_read_b128 a[124:127], v111 offset:25088
v_mfma_f32_16x16x32_bf16 v[28:31], a[148:151], a[44:47], v[28:31]
ds_read_b128 a[128:131], v111 offset:26112
v_mfma_f32_16x16x32_bf16 v[32:35], a[152:155], a[44:47], v[32:35]
ds_read_b128 a[132:135], v115 offset:23040
s_waitcnt lgkmcnt(5)
v_mfma_f32_16x16x32_bf16 v[16:19], a[96:99], a[48:51], v[16:19]
ds_read_b128 a[136:139], v111 offset:27648
v_mfma_f32_16x16x32_bf16 v[20:23], a[100:103], a[48:51], v[20:23]
ds_read_b128 a[140:143], v111 offset:28672
v_mfma_f32_16x16x32_bf16 v[24:27], a[104:107], a[48:51], v[24:27]
ds_read_b128 a[144:147], v111 offset:29696
v_mfma_f32_16x16x32_bf16 v[28:31], a[108:111], a[48:51], v[28:31]
ds_read_b128 a[148:151], v111 offset:30720
v_mfma_f32_16x16x32_bf16 v[32:35], a[112:115], a[48:51], v[32:35]
ds_read_b128 a[152:155], v115 offset:27648
s_waitcnt lgkmcnt(5)
v_mfma_f32_16x16x32_bf16 v[16:19], a[116:119], a[52:55], v[16:19]
ds_read_b128 a[96:99], v111 offset:32256
v_mfma_f32_16x16x32_bf16 v[20:23], a[120:123], a[52:55], v[20:23]
ds_read_b128 a[100:103], v111 offset:33280
v_mfma_f32_16x16x32_bf16 v[24:27], a[124:127], a[52:55], v[24:27]
ds_read_b128 a[104:107], v111 offset:34304
v_mfma_f32_16x16x32_bf16 v[28:31], a[128:131], a[52:55], v[28:31]
ds_read_b128 a[108:111], v111 offset:35328
v_mfma_f32_16x16x32_bf16 v[32:35], a[132:135], a[52:55], v[32:35]
ds_read_b128 a[112:115], v115 offset:32256
s_waitcnt lgkmcnt(5)
v_mfma_f32_16x16x32_bf16 v[16:19], a[136:139], a[56:59], v[16:19]
ds_read_b128 a[116:119], v108 offset:0
v_mfma_f32_16x16x32_bf16 v[20:23], a[140:143], a[56:59], v[20:23]
ds_read_b128 a[120:123], v108 offset:1024
v_mfma_f32_16x16x32_bf16 v[24:27], a[144:147], a[56:59], v[24:27]
ds_read_b128 a[124:127], v108 offset:2048
v_mfma_f32_16x16x32_bf16 v[28:31], a[148:151], a[56:59], v[28:31]
ds_read_b128 a[128:131], v108 offset:3072
v_mfma_f32_16x16x32_bf16 v[32:35], a[152:155], a[56:59], v[32:35]
ds_read_b128 a[132:135], v112 offset:0
s_waitcnt lgkmcnt(5)
v_mfma_f32_16x16x32_bf16 v[16:19], a[96:99], a[60:63], v[16:19]
ds_read_b128 a[136:139], v108 offset:4608
v_mfma_f32_16x16x32_bf16 v[20:23], a[100:103], a[60:63], v[20:23]
ds_read_b128 a[140:143], v108 offset:5632
v_mfma_f32_16x16x32_bf16 v[24:27], a[104:107], a[60:63], v[24:27]
ds_read_b128 a[144:147], v108 offset:6656
v_mfma_f32_16x16x32_bf16 v[28:31], a[108:111], a[60:63], v[28:31]
ds_read_b128 a[148:151], v108 offset:7680
v_mfma_f32_16x16x32_bf16 v[32:35], a[112:115], a[60:63], v[32:35]
ds_read_b128 a[152:155], v112 offset:4608
s_waitcnt lgkmcnt(5)
v_mfma_f32_16x16x32_bf16 v[16:19], a[116:119], a[64:67], v[16:19]
ds_read_b128 a[96:99], v108 offset:9216
v_mfma_f32_16x16x32_bf16 v[20:23], a[120:123], a[64:67], v[20:23]
ds_read_b128 a[100:103], v108 offset:10240
v_mfma_f32_16x16x32_bf16 v[24:27], a[124:127], a[64:67], v[24:27]
ds_read_b128 a[104:107], v108 offset:11264
v_mfma_f32_16x16x32_bf16 v[28:31], a[128:131], a[64:67], v[28:31]
ds_read_b128 a[108:111], v108 offset:12288
v_mfma_f32_16x16x32_bf16 v[32:35], a[132:135], a[64:67], v[32:35]
ds_read_b128 a[112:115], v112 offset:9216
s_waitcnt lgkmcnt(5)
v_mfma_f32_16x16x32_bf16 v[16:19], a[136:139], a[68:71], v[16:19]
ds_read_b128 a[116:119], v108 offset:13824
v_mfma_f32_16x16x32_bf16 v[20:23], a[140:143], a[68:71], v[20:23]
ds_read_b128 a[120:123], v108 offset:14848
v_mfma_f32_16x16x32_bf16 v[24:27], a[144:147], a[68:71], v[24:27]
ds_read_b128 a[124:127], v108 offset:15872
v_mfma_f32_16x16x32_bf16 v[28:31], a[148:151], a[68:71], v[28:31]
ds_read_b128 a[128:131], v108 offset:16896
v_mfma_f32_16x16x32_bf16 v[32:35], a[152:155], a[68:71], v[32:35]
ds_read_b128 a[132:135], v112 offset:13824
s_waitcnt lgkmcnt(5)
v_mfma_f32_16x16x32_bf16 v[16:19], a[96:99], a[72:75], v[16:19]
ds_read_b128 a[136:139], v108 offset:18432
v_mfma_f32_16x16x32_bf16 v[20:23], a[100:103], a[72:75], v[20:23]
ds_read_b128 a[140:143], v108 offset:19456
v_mfma_f32_16x16x32_bf16 v[24:27], a[104:107], a[72:75], v[24:27]
ds_read_b128 a[144:147], v108 offset:20480
v_mfma_f32_16x16x32_bf16 v[28:31], a[108:111], a[72:75], v[28:31]
ds_read_b128 a[148:151], v108 offset:21504
v_mfma_f32_16x16x32_bf16 v[32:35], a[112:115], a[72:75], v[32:35]
ds_read_b128 a[152:155], v112 offset:18432
s_waitcnt lgkmcnt(5)
v_mfma_f32_16x16x32_bf16 v[16:19], a[116:119], a[76:79], v[16:19]
ds_read_b128 a[96:99], v108 offset:23040
v_mfma_f32_16x16x32_bf16 v[20:23], a[120:123], a[76:79], v[20:23]
ds_read_b128 a[100:103], v108 offset:24064
v_mfma_f32_16x16x32_bf16 v[24:27], a[124:127], a[76:79], v[24:27]
ds_read_b128 a[104:107], v108 offset:25088
v_mfma_f32_16x16x32_bf16 v[28:31], a[128:131], a[76:79], v[28:31]
ds_read_b128 a[108:111], v108 offset:26112
v_mfma_f32_16x16x32_bf16 v[32:35], a[132:135], a[76:79], v[32:35]
ds_read_b128 a[112:115], v112 offset:23040
s_waitcnt vmcnt(3)
s_waitcnt lgkmcnt(5)
v_mfma_f32_16x16x32_bf16 v[16:19], a[136:139], a[80:83], v[16:19]
ds_read_b128 a[116:119], v108 offset:27648
v_mfma_f32_16x16x32_bf16 v[20:23], a[140:143], a[80:83], v[20:23]
ds_read_b128 a[120:123], v108 offset:28672
v_mfma_f32_16x16x32_bf16 v[24:27], a[144:147], a[80:83], v[24:27]
ds_read_b128 a[124:127], v108 offset:29696
v_mfma_f32_16x16x32_bf16 v[28:31], a[148:151], a[80:83], v[28:31]
ds_read_b128 a[128:131], v108 offset:30720
v_mfma_f32_16x16x32_bf16 v[32:35], a[152:155], a[80:83], v[32:35]
ds_read_b128 a[132:135], v112 offset:27648
s_waitcnt vmcnt(2)
s_waitcnt lgkmcnt(5)
v_mfma_f32_16x16x32_bf16 v[16:19], a[96:99], a[84:87], v[16:19]
ds_read_b128 a[136:139], v108 offset:32256
v_mfma_f32_16x16x32_bf16 v[20:23], a[100:103], a[84:87], v[20:23]
ds_read_b128 a[140:143], v108 offset:33280
v_mfma_f32_16x16x32_bf16 v[24:27], a[104:107], a[84:87], v[24:27]
ds_read_b128 a[144:147], v108 offset:34304
v_mfma_f32_16x16x32_bf16 v[28:31], a[108:111], a[84:87], v[28:31]
ds_read_b128 a[148:151], v108 offset:35328
v_mfma_f32_16x16x32_bf16 v[32:35], a[112:115], a[84:87], v[32:35]
ds_read_b128 a[152:155], v112 offset:32256
s_waitcnt vmcnt(1)
s_waitcnt lgkmcnt(5)
v_mfma_f32_16x16x32_bf16 v[16:19], a[116:119], a[88:91], v[16:19]
v_mfma_f32_16x16x32_bf16 v[20:23], a[120:123], a[88:91], v[20:23]
v_mfma_f32_16x16x32_bf16 v[24:27], a[124:127], a[88:91], v[24:27]
v_mfma_f32_16x16x32_bf16 v[28:31], a[128:131], a[88:91], v[28:31]
v_mfma_f32_16x16x32_bf16 v[32:35], a[132:135], a[88:91], v[32:35]
s_waitcnt vmcnt(0)
s_waitcnt lgkmcnt(0)
v_mfma_f32_16x16x32_bf16 v[16:19], a[136:139], a[92:95], v[16:19]
v_mfma_f32_16x16x32_bf16 v[20:23], a[140:143], a[92:95], v[20:23]
v_mfma_f32_16x16x32_bf16 v[24:27], a[144:147], a[92:95], v[24:27]
v_mfma_f32_16x16x32_bf16 v[28:31], a[148:151], a[92:95], v[28:31]
v_mfma_f32_16x16x32_bf16 v[32:35], a[152:155], a[92:95], v[32:35]
s_waitcnt lgkmcnt(0)
s_memrealtime s[58:59]
s_waitcnt lgkmcnt(0)
s_mov_b32 m0, s56
s_nop 0
v_writelane_b32 v5, s58, m0
s_add_u32 s56, s56, 1
s_cmp_eq_u32 s29, 1
s_cbranch_scc1 L_last
s_lshl_b32 s30, s27, 2
s_add_u32 s30, s30, s24
v_mov_b32 v130, 1073741824
s_mul_i32 s31, s30, 18432
s_mul_i32 s32, s28, 2304
s_add_u32 s31, s31, s32
s_add_u32 s31, s31, 26640384
v_mov_b32 v132, v1
v_add_u32 v133, 2048, v132
v_cndmask_b32 v133, v130, v133, s[46:47]
v_cvt_pk_bf16_f32 v116, v16, v17
v_cvt_pk_bf16_f32 v117, v18, v19
v_cvt_pk_bf16_f32 v118, v20, v21
v_cvt_pk_bf16_f32 v119, v22, v23
v_cvt_pk_bf16_f32 v120, v24, v25
v_cvt_pk_bf16_f32 v121, v26, v27
v_cvt_pk_bf16_f32 v122, v28, v29
v_cvt_pk_bf16_f32 v123, v30, v31
v_cvt_pk_bf16_f32 v124, v32, v33
v_cvt_pk_bf16_f32 v125, v34, v35
buffer_store_dwordx4 v[116:119], v132, s[8:11], s31 offen sc1
buffer_store_dwordx4 v[120:123], v132, s[8:11], s31 offen offset:1024 sc1
v_permlane16_swap_b32 v124, v126
v_permlane16_swap_b32 v125, v127
buffer_store_dwordx4 v[124:127], v133, s[8:11], s31 offen sc1
v_add_f32 v128, v32, v33
v_mul_f32 v129, v32, v32
v_fmac_f32 v129, v33, v33
v_add_f32 v128, v128, v34
v_fmac_f32 v129, v34, v34
v_add_f32 v128, v128, v35
v_fmac_f32 v129, v35, v35
v_cndmask_b32 v128, 0, v128, s[50:51]
v_cndmask_b32 v129, 0, v129, s[50:51]
v_add_f32 v128, v128, v16
v_fmac_f32 v129, v16, v16
v_add_f32 v128, v128, v17
v_fmac_f32 v129, v17, v17
v_add_f32 v128, v128, v18
v_fmac_f32 v129, v18, v18
v_add_f32 v128, v128, v19
v_fmac_f32 v129, v19, v19
v_add_f32 v128, v128, v20
v_fmac_f32 v129, v20, v20
v_add_f32 v128, v128, v21
v_fmac_f32 v129, v21, v21
v_add_f32 v128, v128, v22
v_fmac_f32 v129, v22, v22
v_add_f32 v128, v128, v23
v_fmac_f32 v129, v23, v23
v_add_f32 v128, v128, v24
v_fmac_f32 v129, v24, v24
v_add_f32 v128, v128, v25
v_fmac_f32 v129, v25, v25
v_add_f32 v128, v128, v26
v_fmac_f32 v129, v26, v26
v_add_f32 v128, v128, v27
v_fmac_f32 v129, v27, v27
v_add_f32 v128, v128, v28
v_fmac_f32 v129, v28, v28
v_add_f32 v128, v128, v29
v_fmac_f32 v129, v29, v29
v_add_f32 v128, v128, v30
v_fmac_f32 v129, v30, v30
v_add_f32 v128, v128, v31
v_fmac_f32 v129, v31, v31
s_lshl_b32 s31, s30, 7
s_lshl_b32 s32, s28, 14
v_permlane32_swap_b32 v128, v129
v_add_f32 v128, v128, v129
v_mov_b32 v129, v128
s_add_u32 s31, s31, s32
s_add_u32 s31, s31, 28999680
v_permlane16_swap_b32 v128, v129
v_add_f32 v128, v128, v129
v_mov_b32 v129, v128
v_lshlrev_b32 v131, 3, v2
v_cndmask_b32 v130, v130, v131, s[46:47]
v_permlane32_swap_b32 v128, v129
buffer_store_dwordx2 v[128:129], v130, s[8:11], s31 offen sc1
s_and_b32 s33, s27, 1
s_cmp_lt_u32 s27, 31
s_cselect_b32 s33, s33, 0
s_cmp_eq_u32 s33, 1
s_cselect_b32 s34, -1, 0xffff
s_mov_b32 s35, 0
s_waitcnt vmcnt(0)
s_barrier
s_cmp_eq_u32 s24, 0
s_cbranch_scc0 L_sig_17
v_lshlrev_b32 v6, 3, v1
s_lshr_b32 s31, s81, 4
s_lshl_b32 s31, s31, 11
s_and_b32 s32, s81, 15
s_lshl_b32 s32, s32, 2
s_add_u32 s31, s31, s32
v_add_u32 v6, s31, v6
v_lshl_add_u32 v6, v3, 5, v6
s_mov_b64 exec, s[34:35]
s_mov_b32 s30, 26607616
buffer_store_dword v4, v6, s[8:11], s30 offen sc1
s_mov_b64 exec, -1
L_sig_17:
s_cmp_eq_u32 s29, 1
s_cbranch_scc1 L_main_fin
s_mul_i32 s30, s26, 132608
s_mul_i32 s38, s24, 33792
s_add_u32 s39, s38, s30
s_add_u32 m0, s38, 0
s_nop 0
buffer_load_dwordx4 v1, s[4:7], s39 offen offset:0  lds
buffer_load_dwordx4 v1, s[4:7], s39 offen offset:1024  lds
buffer_load_dwordx4 v1, s[4:7], s39 offen offset:2048  lds
buffer_load_dwordx4 v1, s[4:7], s39 offen offset:3072  lds
s_add_u32 m0, m0, 4096
s_add_u32 s39, s39, 4096
buffer_load_dwordx4 v1, s[4:7], s39 offen offset:0  lds
buffer_load_dwordx4 v1, s[4:7], s39 offen offset:1024  lds
buffer_load_dwordx4 v1, s[4:7], s39 offen offset:2048  lds
buffer_load_dwordx4 v1, s[4:7], s39 offen offset:3072  lds
s_add_u32 m0, m0, 4096
s_add_u32 s39, s39, 4096
buffer_load_dwordx4 v1, s[4:7], s39 offen offset:0  lds
buffer_load_dwordx4 v1, s[4:7], s39 offen offset:1024  lds
buffer_load_dwordx4 v1, s[4:7], s39 offen offset:2048  lds
buffer_load_dwordx4 v1, s[4:7], s39 offen offset:3072  lds
s_add_u32 m0, m0, 4096
s_add_u32 s39, s39, 4096
buffer_load_dwordx4 v1, s[4:7], s39 offen offset:0  lds
buffer_load_dwordx4 v1, s[4:7], s39 offen offset:1024  lds
buffer_load_dwordx4 v1, s[4:7], s39 offen offset:2048  lds
buffer_load_dwordx4 v1, s[4:7], s39 offen offset:3072  lds
s_add_u32 m0, m0, 4096
s_add_u32 s39, s39, 4096
buffer_load_dwordx4 v1, s[4:7], s39 offen offset:0  lds
buffer_load_dwordx4 v1, s[4:7], s39 offen offset:1024  lds
buffer_load_dwordx4 v1, s[4:7], s39 offen offset:2048  lds
buffer_load_dwordx4 v1, s[4:7], s39 offen offset:3072  lds
s_add_u32 m0, m0, 4096
s_add_u32 s39, s39, 4096
buffer_load_dwordx4 v1, s[4:7], s39 offen offset:0  lds
buffer_load_dwordx4 v1, s[4:7], s39 offen offset:1024  lds
buffer_load_dwordx4 v1, s[4:7], s39 offen offset:2048  lds
buffer_load_dwordx4 v1, s[4:7], s39 offen offset:3072  lds
s_add_u32 m0, m0, 4096
s_add_u32 s39, s39, 4096
buffer_load_dwordx4 v1, s[4:7], s39 offen offset:0  lds
buffer_load_dwordx4 v1, s[4:7], s39 offen offset:1024  lds
buffer_load_dwordx4 v1, s[4:7], s39 offen offset:2048  lds
buffer_load_dwordx4 v1, s[4:7], s39 offen offset:3072  lds
s_add_u32 m0, m0, 4096
s_add_u32 s39, s39, 4096
buffer_load_dwordx4 v1, s[4:7], s39 offen offset:0  lds
buffer_load_dwordx4 v1, s[4:7], s39 offen offset:1024  lds
buffer_load_dwordx4 v1, s[4:7], s39 offen offset:2048  lds
buffer_load_dwordx4 v1, s[4:7], s39 offen offset:3072  lds
s_add_u32 m0, m0, 4096
s_add_u32 s39, s39, 4096
buffer_load_dwordx4 v1, s[4:7], s39 offen offset:0  lds
s_mov_b32 s34, 0xffffff
s_cmp_eq_u32 s25, 0
s_cselect_b32 s34, 0xffff, s34
s_mov_b32 s35, 0
s_cmp_eq_u32 s24, 1
s_cbranch_scc0 L_polled_19
s_lshl_b32 s30, s80, 7
s_add_u32 s30, s30, 26607616
v_lshrrev_b32 v6, 2, v1
s_mov_b32 s31, 0
s_mov_b64 exec, s[34:35]
L_poll_18:
buffer_load_dword v7, v6, s[8:11], s30 offen sc1
s_add_u32 s31, s31, 1
s_waitcnt vmcnt(0)
v_cmp_ne_u32 vcc, 1, v7
s_cmp_gt_u32 s31, 200000
s_cbranch_scc1 L_polled_19
s_cbranch_vccnz L_poll_18
L_polled_19:
s_mov_b64 exec, -1
s_waitcnt vmcnt(0)
s_barrier
s_mov_b32 s29, 1
s_add_u32 s8, s8, 26640384
s_addc_u32 s9, s9, 0
s_mov_b32 s10, 26640384
s_branch L_layer
L_last:
s_lshl_b32 s30, s27, 2
s_add_u32 s30, s30, s24
v_mov_b32 v130, 1073741824
s_mul_i32 s31, s30, 18432
s_mul_i32 s32, s28, 144
s_add_u32 s31, s31, s32
v_mul_u32_u24 v132, 1152, v2
v_lshl_add_u32 v132, v3, 4, v132
v_add_u32 v133, 128, v132
v_cndmask_b32 v133, v130, v133, s[46:47]
v_cvt_pk_bf16_f32 v116, v16, v17
v_cvt_pk_bf16_f32 v117, v18, v19
v_cvt_pk_bf16_f32 v118, v20, v21
v_cvt_pk_bf16_f32 v119, v22, v23
v_cvt_pk_bf16_f32 v120, v24, v25
v_cvt_pk_bf16_f32 v121, v26, v27
v_cvt_pk_bf16_f32 v122, v28, v29
v_cvt_pk_bf16_f32 v123, v30, v31
v_cvt_pk_bf16_f32 v124, v32, v33
v_cvt_pk_bf16_f32 v125, v34, v35
buffer_store_dwordx4 v[116:119], v132, s[16:19], s31 offen
buffer_store_dwordx4 v[120:123], v132, s[16:19], s31 offen offset:64
v_permlane16_swap_b32 v124, v126
v_permlane16_swap_b32 v125, v127
buffer_store_dwordx4 v[124:127], v133, s[16:19], s31 offen
L_main_fin:
s_waitcnt vmcnt(0)
s_waitcnt lgkmcnt(0)
s_memrealtime s[58:59]
s_waitcnt lgkmcnt(0)
s_mov_b32 m0, s56
s_nop 0
v_writelane_b32 v5, s58, m0
s_add_u32 s56, s56, 1
s_cmp_eq_u32 s24, 0
s_cbranch_scc0 L_main_end
s_lshl_b32 s30, s2, 8
s_add_u32 s30, s30, 64176128
v_lshrrev_b32 v6, 2, v1
buffer_store_dword v5, v6, s[4:7], s30 offen
L_main_end:
s_endpgm
.section .rodata,"a"
.p2align 6
.amdhsa_kernel prep_kernel
  .amdhsa_next_free_vgpr 64
  .amdhsa_next_free_sgpr 40
  .amdhsa_accum_offset 64
  .amdhsa_group_segment_fixed_size 0
  .amdhsa_kernarg_size 88
  .amdhsa_user_sgpr_count 2
  .amdhsa_user_sgpr_kernarg_segment_ptr 1
  .amdhsa_system_sgpr_workgroup_id_x 1
  .amdhsa_float_denorm_mode_32 3
.end_amdhsa_kernel
.p2align 6
.amdhsa_kernel main_kernel
  .amdhsa_next_free_vgpr 512
  .amdhsa_next_free_sgpr 102
  .amdhsa_accum_offset 256
  .amdhsa_group_segment_fixed_size 0
  .amdhsa_kernarg_size 88
  .amdhsa_user_sgpr_count 2
  .amdhsa_user_sgpr_kernarg_segment_ptr 1
  .amdhsa_system_sgpr_workgroup_id_x 1
  .amdhsa_float_denorm_mode_32 3
.end_amdhsa_kernel
```

```asm
; @launch kernel=prep_kernel grid=(704,1,1) block=(256,1,1) lds=20480
; @launch kernel=main_kernel grid=(256,1,1) block=(256,1,1) lds=163840
.amdgcn_target "amdgcn-amd-amdhsa--gfx950"
.text
.globl prep_kernel
.p2align 8
.type prep_kernel,@function
prep_kernel:
s_cmp_ge_u32 s2, 704
s_cbranch_scc1 L_prep_end
s_load_dwordx2 s[4:5], s[0:1], 80
v_lshrrev_b32 v4, 6, v0
v_and_b32 v1, 63, v0
v_readfirstlane_b32 s12, v4
v_and_b32 v2, 15, v1
v_lshrrev_b32 v3, 4, v1
s_mov_b32 s6, 64176128
s_mov_b32 s7, 0x20000
s_mov_b32 s11, 0x20000
s_cmp_lt_u32 s2, 128
s_cbranch_scc1 L_prep_x
s_cmp_lt_u32 s2, 236
s_cbranch_scc1 L_prep_w1
s_cmp_lt_u32 s2, 272
s_cbranch_scc1 L_prep_w2
s_cmp_lt_u32 s2, 560
s_cbranch_scc1 L_prep_w3
s_load_dwordx2 s[8:9], s[0:1], 56
s_mov_b32 s10, 2654208
s_sub_u32 s13, s2, 560
s_and_b32 s14, s13, 15
s_lshr_b32 s15, s13, 4
s_mul_i32 s16, s14, 165888
s_lshl_b32 s17, s15, 7
s_add_u32 s16, s16, s17
s_mul_i32 s17, s12, 9216
s_add_u32 s16, s16, s17
v_lshrrev_b32 v4, 3, v1
v_mul_u32_u24 v7, 1152, v4
v_and_b32 v4, 7, v1
v_lshl_add_u32 v7, v4, 4, v7
s_lshl_b32 s18, s12, 10
s_waitcnt lgkmcnt(0)
s_add_u32 s19, s18, 0
s_mov_b32 m0, s19
s_add_u32 s17, s16, 0
buffer_load_dwordx4 v7, s[8:11], s17 offen lds
s_add_u32 s19, s18, 4096
s_mov_b32 m0, s19
s_add_u32 s17, s16, 36864
buffer_load_dwordx4 v7, s[8:11], s17 offen lds
s_add_u32 s19, s18, 8192
s_mov_b32 m0, s19
s_add_u32 s17, s16, 73728
buffer_load_dwordx4 v7, s[8:11], s17 offen lds
s_add_u32 s19, s18, 12288
s_mov_b32 m0, s19
s_add_u32 s17, s16, 110592
buffer_load_dwordx4 v7, s[8:11], s17 offen lds
s_add_u32 s19, s18, 16384
s_mov_b32 m0, s19
s_add_u32 s17, s16, 147456
s_cmp_lt_u32 s12, 2
s_cselect_b32 s17, s17, 1073741824
buffer_load_dwordx4 v7, s[8:11], s17 offen lds
v_lshrrev_b32 v4, 2, v2
v_lshl_add_u32 v4, v3, 3, v4
v_lshlrev_b32 v10, 7, v4
v_and_b32 v4, 3, v2
v_lshl_add_u32 v10, v4, 3, v10
s_lshl_b32 s17, s12, 5
v_add_u32 v10, s17, v10
s_lshl_b32 s17, s15, 6
s_lshl_b32 s19, s12, 4
s_add_u32 s17, s17, s19
v_add_u32 v4, s17, v2
v_mul_u32_u24 v5, 911, v4
v_lshrrev_b32 v5, 16, v5
v_mul_u32_u24 v6, 72, v5
v_sub_u32 v4, v4, v6
s_mov_b32 s17, 331776
v_mul_lo_u32 v8, v5, s17
s_mul_i32 s17, s14, 18
v_add_u32 v5, s17, v3
v_and_b32 v6, 3, v5
v_lshrrev_b32 v5, 2, v5
v_mul_u32_u24 v5, 4608, v5
v_add_u32 v8, v8, v5
v_add_u32 v8, 8241152, v8
v_lshrrev_b32 v14, 5, v4
v_lshlrev_b32 v14, 11, v14
v_bfe_u32 v15, v4, 2, 1
v_lshl_add_u32 v14, v15, 10, v14
v_bfe_u32 v15, v4, 3, 2
v_lshl_add_u32 v14, v15, 6, v14
v_and_b32 v15, 3, v4
v_lshl_add_u32 v14, v15, 4, v14
v_lshl_add_u32 v14, v6, 8, v14
v_lshlrev_b32 v15, 4, v4
v_add_u32 v15, 3072, v15
v_lshl_add_u32 v15, v6, 7, v15
v_cmp_gt_u32 vcc, 64, v4
s_nop 1
v_cndmask_b32 v14, v15, v14, vcc
v_add_u32 v8, v8, v14
s_waitcnt vmcnt(0)
s_barrier
ds_read_b64_tr_b16 v[16:17], v10 offset:0
ds_read_b64_tr_b16 v[18:19], v10 offset:512
ds_read_b64_tr_b16 v[20:21], v10 offset:4096
ds_read_b64_tr_b16 v[22:23], v10 offset:4608
ds_read_b64_tr_b16 v[24:25], v10 offset:8192
ds_read_b64_tr_b16 v[26:27], v10 offset:8704
ds_read_b64_tr_b16 v[28:29], v10 offset:12288
ds_read_b64_tr_b16 v[30:31], v10 offset:12800
ds_read_b64_tr_b16 v[32:33], v10 offset:16384
ds_read_b64_tr_b16 v[34:35], v10 offset:16896
v_cmp_gt_u32 vcc, 2, v3
v_mov_b32 v4, 1073741824
v_mov_b32 v11, 0
v_cndmask_b32 v4, v4, v8, vcc
s_mov_b32 s17, 0
s_waitcnt lgkmcnt(8)
buffer_store_dwordx4 v[16:19], v8, s[4:7], s17 offen
s_mov_b32 s17, 4608
s_waitcnt lgkmcnt(6)
buffer_store_dwordx4 v[20:23], v8, s[4:7], s17 offen
s_mov_b32 s17, 9216
s_waitcnt lgkmcnt(4)
buffer_store_dwordx4 v[24:27], v8, s[4:7], s17 offen
s_mov_b32 s17, 13824
s_waitcnt lgkmcnt(2)
buffer_store_dwordx4 v[28:31], v8, s[4:7], s17 offen
s_mov_b32 s17, 18432
s_waitcnt lgkmcnt(0)
buffer_store_dwordx4 v[32:35], v4, s[4:7], s17 offen
s_branch L_prep_tail
L_prep_w3:
s_load_dwordx2 s[8:9], s[0:1], 32
s_mov_b32 s10, 5308416
s_sub_u32 s13, s2, 272
s_and_b32 s14, s13, 3
s_lshr_b32 s15, s13, 2
s_mul_i32 s16, s14, 1327104
s_lshl_b32 s17, s15, 7
s_add_u32 s16, s16, s17
s_mul_i32 s17, s12, 73728
s_add_u32 s16, s16, s17
v_lshrrev_b32 v4, 3, v1
v_mul_u32_u24 v7, 9216, v4
v_and_b32 v4, 7, v1
v_lshl_add_u32 v7, v4, 4, v7
s_lshl_b32 s18, s12, 10
s_waitcnt lgkmcnt(0)
s_add_u32 s19, s18, 0
s_mov_b32 m0, s19
s_add_u32 s17, s16, 0
buffer_load_dwordx4 v7, s[8:11], s17 offen lds
s_add_u32 s19, s18, 4096
s_mov_b32 m0, s19
s_add_u32 s17, s16, 294912
buffer_load_dwordx4 v7, s[8:11], s17 offen lds
s_add_u32 s19, s18, 8192
s_mov_b32 m0, s19
s_add_u32 s17, s16, 589824
buffer_load_dwordx4 v7, s[8:11], s17 offen lds
s_add_u32 s19, s18, 12288
s_mov_b32 m0, s19
s_add_u32 s17, s16, 884736
buffer_load_dwordx4 v7, s[8:11], s17 offen lds
s_add_u32 s19, s18, 16384
s_mov_b32 m0, s19
s_add_u32 s17, s16, 1179648
s_cmp_lt_u32 s12, 2
s_cselect_b32 s17, s17, 1073741824
buffer_load_dwordx4 v7, s[8:11], s17 offen lds
v_lshrrev_b32 v4, 2, v2
v_lshl_add_u32 v4, v3, 3, v4
v_lshlrev_b32 v10, 7, v4
v_and_b32 v4, 3, v2
v_lshl_add_u32 v10, v4, 3, v10
s_lshl_b32 s17, s12, 5
v_add_u32 v10, s17, v10
s_lshl_b32 s20, s15, 6
s_lshl_b32 s19, s12, 4
s_add_u32 s20, s20, s19
s_cmp_ge_u32 s20, 2304
s_cselect_b32 s21, 1, 0
s_cselect_b32 s19, 2304, 0
s_sub_u32 s20, s20, s19
s_mul_i32 s22, s20, 1821
s_lshr_b32 s22, s22, 19
s_mul_i32 s19, s22, 288
s_sub_u32 s20, s20, s19
s_lshr_b32 s23, s20, 5
s_bfe_u32 s24, s20, 0x10004
s_lshl_b32 s22, s22, 1
s_cmp_ge_u32 s20, 144
s_addc_u32 s22, s22, 0
s_cmp_gt_u32 s23, 4
s_cselect_b32 s19, 5, 0
s_sub_u32 s25, s23, s19
s_cmp_eq_u32 s21, 0
s_cselect_b32 s19, 5, 0
s_add_u32 s25, s25, s19
s_cmp_eq_u32 s23, 4
s_cselect_b32 s25, 4, s25
s_mul_i32 s22, s22, 9
s_add_u32 s22, s22, s25
s_mul_i32 s22, s22, 37888
s_add_u32 s22, s22, 2785280
v_and_b32 v4, 3, v2
v_bfe_u32 v5, v2, 2, 1
v_bfe_u32 v6, v2, 3, 1
s_cmp_eq_u32 s23, 4
s_cbranch_scc1 L_prep_w3m
s_cmp_eq_u32 s21, 0
s_cbranch_scc1 L_prep_w3a
s_lshl_b32 s19, s24, 4
v_add_u32 v4, s19, v2
s_branch L_prep_w3j
L_prep_w3a:
v_lshl_add_u32 v4, v5, 4, v4
v_lshl_add_u32 v4, v6, 3, v4
s_lshl_b32 s19, s24, 2
v_add_u32 v4, s19, v4
s_branch L_prep_w3j
L_prep_w3m:
v_lshl_add_u32 v4, v5, 3, v4
v_lshl_add_u32 v4, v6, 2, v4
s_xor_b32 s19, s21, 1
s_lshl_b32 s19, s19, 4
v_add_u32 v4, s19, v4
L_prep_w3j:
v_lshlrev_b32 v4, 4, v4
v_add_u32 v4, s22, v4
s_mul_i32 s17, s14, 9216
v_lshl_add_u32 v8, v3, 9, v4
v_add_u32 v8, s17, v8
s_lshr_b32 s17, s14, 1
s_lshl_b32 s17, s17, 9
s_and_b32 s19, s14, 1
s_lshl_b32 s19, s19, 3
s_add_u32 s17, s17, s19
s_add_u32 s17, s17, 36864
v_add_u32 v9, s17, v4
s_waitcnt vmcnt(0)
s_barrier
ds_read_b64_tr_b16 v[16:17], v10 offset:0
ds_read_b64_tr_b16 v[18:19], v10 offset:512
ds_read_b64_tr_b16 v[20:21], v10 offset:4096
ds_read_b64_tr_b16 v[22:23], v10 offset:4608
ds_read_b64_tr_b16 v[24:25], v10 offset:8192
ds_read_b64_tr_b16 v[26:27], v10 offset:8704
ds_read_b64_tr_b16 v[28:29], v10 offset:12288
ds_read_b64_tr_b16 v[30:31], v10 offset:12800
ds_read_b64_tr_b16 v[32:33], v10 offset:16384
ds_read_b64_tr_b16 v[34:35], v10 offset:16896
v_cmp_gt_u32 vcc, 2, v3
v_mov_b32 v4, 1073741824
v_mov_b32 v11, 0
v_cndmask_b32 v4, v4, v8, vcc
s_mov_b32 s17, 0
s_waitcnt lgkmcnt(8)
buffer_store_dwordx4 v[16:19], v8, s[4:7], s17 offen
s_mov_b32 s17, 2048
s_waitcnt lgkmcnt(6)
buffer_store_dwordx4 v[20:23], v8, s[4:7], s17 offen
s_mov_b32 s17, 4096
s_waitcnt lgkmcnt(4)
buffer_store_dwordx4 v[24:27], v8, s[4:7], s17 offen
s_mov_b32 s17, 6144
s_waitcnt lgkmcnt(2)
buffer_store_dwordx4 v[28:31], v8, s[4:7], s17 offen
s_mov_b32 s17, 8192
s_waitcnt lgkmcnt(0)
buffer_store_dwordx4 v[32:35], v4, s[4:7], s17 offen
v_mov_b32 v5, 0x3f803f80
v_dot2c_f32_bf16 v11, v16, v5
v_dot2c_f32_bf16 v11, v17, v5
v_dot2c_f32_bf16 v11, v18, v5
v_dot2c_f32_bf16 v11, v19, v5
v_dot2c_f32_bf16 v11, v20, v5
v_dot2c_f32_bf16 v11, v21, v5
v_dot2c_f32_bf16 v11, v22, v5
v_dot2c_f32_bf16 v11, v23, v5
v_dot2c_f32_bf16 v11, v24, v5
v_dot2c_f32_bf16 v11, v25, v5
v_dot2c_f32_bf16 v11, v26, v5
v_dot2c_f32_bf16 v11, v27, v5
v_dot2c_f32_bf16 v11, v28, v5
v_dot2c_f32_bf16 v11, v29, v5
v_dot2c_f32_bf16 v11, v30, v5
v_dot2c_f32_bf16 v11, v31, v5
v_dot2c_f32_bf16 v11, v32, v5
v_dot2c_f32_bf16 v11, v33, v5
v_dot2c_f32_bf16 v11, v34, v5
v_dot2c_f32_bf16 v11, v35, v5
s_nop 2
v_mov_b32 v5, v11
s_nop 1
v_permlane32_swap_b32 v11, v5
v_add_f32 v11, v11, v5
v_mov_b32 v5, v11
s_nop 1
v_permlane16_swap_b32 v11, v5
v_add_f32 v11, v11, v5
v_cvt_pk_bf16_f32 v14, v11, v11
v_and_b32 v5, 0xffff0000, v14
v_sub_f32 v5, v11, v5
v_cvt_pk_bf16_f32 v15, v5, v5
v_cmp_eq_u32 vcc, 0, v3
v_mov_b32 v4, 1073741824
s_nop 0
v_cndmask_b32 v4, v4, v9, vcc
buffer_store_dwordx2 v[14:15], v4, s[4:7], 0 offen
s_branch L_prep_tail
L_prep_w2:
s_load_dwordx2 s[8:9], s[0:1], 16
s_mov_b32 s10, 663552
s_sub_u32 s13, s2, 236
s_and_b32 s14, s13, 3
s_lshr_b32 s15, s13, 2
s_mul_i32 s16, s14, 165888
s_lshl_b32 s17, s15, 7
s_add_u32 s16, s16, s17
s_mul_i32 s17, s12, 9216
s_add_u32 s16, s16, s17
v_lshrrev_b32 v4, 3, v1
v_mul_u32_u24 v7, 1152, v4
v_and_b32 v4, 7, v1
v_lshl_add_u32 v7, v4, 4, v7
s_lshl_b32 s18, s12, 10
s_waitcnt lgkmcnt(0)
s_add_u32 s19, s18, 0
s_mov_b32 m0, s19
s_add_u32 s17, s16, 0
buffer_load_dwordx4 v7, s[8:11], s17 offen lds
s_add_u32 s19, s18, 4096
s_mov_b32 m0, s19
s_add_u32 s17, s16, 36864
buffer_load_dwordx4 v7, s[8:11], s17 offen lds
s_add_u32 s19, s18, 8192
s_mov_b32 m0, s19
s_add_u32 s17, s16, 73728
buffer_load_dwordx4 v7, s[8:11], s17 offen lds
s_add_u32 s19, s18, 12288
s_mov_b32 m0, s19
s_add_u32 s17, s16, 110592
buffer_load_dwordx4 v7, s[8:11], s17 offen lds
s_add_u32 s19, s18, 16384
s_mov_b32 m0, s19
s_add_u32 s17, s16, 147456
s_cmp_lt_u32 s12, 2
s_cselect_b32 s17, s17, 1073741824
buffer_load_dwordx4 v7, s[8:11], s17 offen lds
v_lshrrev_b32 v14, 2, v2
v_and_b32 v15, 3, v2
v_lshlrev_b32 v15, 3, v15
s_lshl_b32 s17, s12, 5
v_add_u32 v15, s17, v15
v_add_u32 v4, 0, v3
v_cmp_le_u32 vcc, 9, v4
v_subrev_u32 v5, 9, v4
s_nop 0
v_cndmask_b32 v4, v4, v5, vcc
v_cndmask_b32 v6, 0, 1, vcc
v_mul_u32_u24 v6, 72, v6
v_lshrrev_b32 v5, 2, v4
v_mul_u32_u24 v5, 36, v5
v_and_b32 v13, 3, v4
v_lshl_add_u32 v5, v13, 2, v5
v_add_u32 v5, v5, v14
v_lshrrev_b32 v13, 1, v14
v_mul_u32_u24 v13, 18, v13
v_and_b32 v50, 1, v14
v_add3_u32 v13, v13, v50, 16
v_cmp_eq_u32 vcc, 8, v4
v_mov_b32 v50, 18
s_nop 0
v_cndmask_b32 v5, v5, v13, vcc
v_cndmask_b32 v50, v50, 36, vcc
v_add_u32 v5, v5, v6
v_add_u32 v50, v50, v5
v_min_u32 v5, 159, v5
v_min_u32 v50, 159, v50
v_lshl_add_u32 v40, v5, 7, v15
v_lshl_add_u32 v41, v50, 7, v15
v_add_u32 v4, 4, v3
v_cmp_le_u32 vcc, 9, v4
v_subrev_u32 v5, 9, v4
s_nop 0
v_cndmask_b32 v4, v4, v5, vcc
v_cndmask_b32 v6, 0, 1, vcc
v_mul_u32_u24 v6, 72, v6
v_lshrrev_b32 v5, 2, v4
v_mul_u32_u24 v5, 36, v5
v_and_b32 v13, 3, v4
v_lshl_add_u32 v5, v13, 2, v5
v_add_u32 v5, v5, v14
v_lshrrev_b32 v13, 1, v14
v_mul_u32_u24 v13, 18, v13
v_and_b32 v50, 1, v14
v_add3_u32 v13, v13, v50, 16
v_cmp_eq_u32 vcc, 8, v4
v_mov_b32 v50, 18
s_nop 0
v_cndmask_b32 v5, v5, v13, vcc
v_cndmask_b32 v50, v50, 36, vcc
v_add_u32 v5, v5, v6
v_add_u32 v50, v50, v5
v_min_u32 v5, 159, v5
v_min_u32 v50, 159, v50
v_lshl_add_u32 v42, v5, 7, v15
v_lshl_add_u32 v43, v50, 7, v15
v_add_u32 v4, 8, v3
v_cmp_le_u32 vcc, 9, v4
v_subrev_u32 v5, 9, v4
s_nop 0
v_cndmask_b32 v4, v4, v5, vcc
v_cndmask_b32 v6, 0, 1, vcc
v_mul_u32_u24 v6, 72, v6
v_lshrrev_b32 v5, 2, v4
v_mul_u32_u24 v5, 36, v5
v_and_b32 v13, 3, v4
v_lshl_add_u32 v5, v13, 2, v5
v_add_u32 v5, v5, v14
v_lshrrev_b32 v13, 1, v14
v_mul_u32_u24 v13, 18, v13
v_and_b32 v50, 1, v14
v_add3_u32 v13, v13, v50, 16
v_cmp_eq_u32 vcc, 8, v4
v_mov_b32 v50, 18
s_nop 0
v_cndmask_b32 v5, v5, v13, vcc
v_cndmask_b32 v50, v50, 36, vcc
v_add_u32 v5, v5, v6
v_add_u32 v50, v50, v5
v_min_u32 v5, 159, v5
v_min_u32 v50, 159, v50
v_lshl_add_u32 v44, v5, 7, v15
v_lshl_add_u32 v45, v50, 7, v15
v_add_u32 v4, 12, v3
v_cmp_le_u32 vcc, 9, v4
v_subrev_u32 v5, 9, v4
s_nop 0
v_cndmask_b32 v4, v4, v5, vcc
v_cndmask_b32 v6, 0, 1, vcc
v_mul_u32_u24 v6, 72, v6
v_lshrrev_b32 v5, 2, v4
v_mul_u32_u24 v5, 36, v5
v_and_b32 v13, 3, v4
v_lshl_add_u32 v5, v13, 2, v5
v_add_u32 v5, v5, v14
v_lshrrev_b32 v13, 1, v14
v_mul_u32_u24 v13, 18, v13
v_and_b32 v50, 1, v14
v_add3_u32 v13, v13, v50, 16
v_cmp_eq_u32 vcc, 8, v4
v_mov_b32 v50, 18
s_nop 0
v_cndmask_b32 v5, v5, v13, vcc
v_cndmask_b32 v50, v50, 36, vcc
v_add_u32 v5, v5, v6
v_add_u32 v50, v50, v5
v_min_u32 v5, 159, v5
v_min_u32 v50, 159, v50
v_lshl_add_u32 v46, v5, 7, v15
v_lshl_add_u32 v47, v50, 7, v15
v_add_u32 v4, 16, v3
v_cmp_le_u32 vcc, 9, v4
v_subrev_u32 v5, 9, v4
s_nop 0
v_cndmask_b32 v4, v4, v5, vcc
v_cndmask_b32 v6, 0, 1, vcc
v_mul_u32_u24 v6, 72, v6
v_lshrrev_b32 v5, 2, v4
v_mul_u32_u24 v5, 36, v5
v_and_b32 v13, 3, v4
v_lshl_add_u32 v5, v13, 2, v5
v_add_u32 v5, v5, v14
v_lshrrev_b32 v13, 1, v14
v_mul_u32_u24 v13, 18, v13
v_and_b32 v50, 1, v14
v_add3_u32 v13, v13, v50, 16
v_cmp_eq_u32 vcc, 8, v4
v_mov_b32 v50, 18
s_nop 0
v_cndmask_b32 v5, v5, v13, vcc
v_cndmask_b32 v50, v50, 36, vcc
v_add_u32 v5, v5, v6
v_add_u32 v50, v50, v5
v_min_u32 v5, 159, v5
v_min_u32 v50, 159, v50
v_lshl_add_u32 v48, v5, 7, v15
v_lshl_add_u32 v49, v50, 7, v15
s_lshl_b32 s17, s15, 6
s_lshl_b32 s19, s12, 4
s_add_u32 s17, s17, s19
v_add_u32 v4, s17, v2
v_mul_u32_u24 v5, 911, v4
v_lshrrev_b32 v5, 16, v5
v_mul_u32_u24 v6, 72, v5
v_sub_u32 v4, v4, v6
s_mov_b32 s17, 82944
v_mul_lo_u32 v8, v5, s17
s_mul_i32 s17, s14, 18
v_add_u32 v5, s17, v3
v_and_b32 v6, 3, v5
v_lshrrev_b32 v5, 2, v5
v_mul_u32_u24 v5, 4608, v5
v_add_u32 v8, v8, v5
v_add_u32 v8, 2121728, v8
v_lshrrev_b32 v14, 5, v4
v_lshlrev_b32 v14, 11, v14
v_bfe_u32 v15, v4, 2, 1
v_lshl_add_u32 v14, v15, 10, v14
v_bfe_u32 v15, v4, 3, 2
v_lshl_add_u32 v14, v15, 6, v14
v_and_b32 v15, 3, v4
v_lshl_add_u32 v14, v15, 4, v14
v_lshl_add_u32 v14, v6, 8, v14
v_lshlrev_b32 v15, 4, v4
v_add_u32 v15, 3072, v15
v_lshl_add_u32 v15, v6, 7, v15
v_cmp_gt_u32 vcc, 64, v4
s_nop 1
v_cndmask_b32 v14, v15, v14, vcc
v_add_u32 v8, v8, v14
s_waitcnt vmcnt(0)
s_barrier
ds_read_b64_tr_b16 v[16:17], v40
ds_read_b64_tr_b16 v[18:19], v41
ds_read_b64_tr_b16 v[20:21], v42
ds_read_b64_tr_b16 v[22:23], v43
ds_read_b64_tr_b16 v[24:25], v44
ds_read_b64_tr_b16 v[26:27], v45
ds_read_b64_tr_b16 v[28:29], v46
ds_read_b64_tr_b16 v[30:31], v47
ds_read_b64_tr_b16 v[32:33], v48
ds_read_b64_tr_b16 v[34:35], v49
v_cmp_gt_u32 vcc, 2, v3
v_mov_b32 v4, 1073741824
v_mov_b32 v11, 0
v_cndmask_b32 v4, v4, v8, vcc
s_mov_b32 s17, 0
s_waitcnt lgkmcnt(8)
buffer_store_dwordx4 v[16:19], v8, s[4:7], s17 offen
s_mov_b32 s17, 4608
s_waitcnt lgkmcnt(6)
buffer_store_dwordx4 v[20:23], v8, s[4:7], s17 offen
s_mov_b32 s17, 9216
s_waitcnt lgkmcnt(4)
buffer_store_dwordx4 v[24:27], v8, s[4:7], s17 offen
s_mov_b32 s17, 13824
s_waitcnt lgkmcnt(2)
buffer_store_dwordx4 v[28:31], v8, s[4:7], s17 offen
s_mov_b32 s17, 18432
s_waitcnt lgkmcnt(0)
buffer_store_dwordx4 v[32:35], v4, s[4:7], s17 offen
s_branch L_prep_tail
L_prep_w1:
s_load_dwordx2 s[8:9], s[0:1], 8
s_mov_b32 s10, 1990656
s_sub_u32 s13, s2, 128
s_and_b32 s14, s13, 3
s_lshr_b32 s15, s13, 2
s_mul_i32 s16, s14, 497664
s_lshl_b32 s17, s15, 7
s_add_u32 s16, s16, s17
s_mul_i32 s17, s12, 27648
s_add_u32 s16, s16, s17
v_lshrrev_b32 v4, 3, v1
v_mul_u32_u24 v7, 3456, v4
v_and_b32 v4, 7, v1
v_lshl_add_u32 v7, v4, 4, v7
s_lshl_b32 s18, s12, 10
s_waitcnt lgkmcnt(0)
s_add_u32 s19, s18, 0
s_mov_b32 m0, s19
s_add_u32 s17, s16, 0
buffer_load_dwordx4 v7, s[8:11], s17 offen lds
s_add_u32 s19, s18, 4096
s_mov_b32 m0, s19
s_add_u32 s17, s16, 110592
buffer_load_dwordx4 v7, s[8:11], s17 offen lds
s_add_u32 s19, s18, 8192
s_mov_b32 m0, s19
s_add_u32 s17, s16, 221184
buffer_load_dwordx4 v7, s[8:11], s17 offen lds
s_add_u32 s19, s18, 12288
s_mov_b32 m0, s19
s_add_u32 s17, s16, 331776
buffer_load_dwordx4 v7, s[8:11], s17 offen lds
s_add_u32 s19, s18, 16384
s_mov_b32 m0, s19
s_add_u32 s17, s16, 442368
s_cmp_lt_u32 s12, 2
s_cselect_b32 s17, s17, 1073741824
buffer_load_dwordx4 v7, s[8:11], s17 offen lds
v_lshrrev_b32 v4, 2, v2
v_lshl_add_u32 v4, v3, 3, v4
v_lshlrev_b32 v10, 7, v4
v_and_b32 v4, 3, v2
v_lshl_add_u32 v10, v4, 3, v10
s_lshl_b32 s17, s12, 5
v_add_u32 v10, s17, v10
s_mul_i32 s20, s15, 29
s_lshr_b32 s20, s20, 8
s_mul_i32 s19, s20, 9
s_sub_u32 s19, s15, s19
s_lshl_b32 s19, s19, 6
s_lshl_b32 s17, s12, 4
s_add_u32 s19, s19, s17
v_add_u32 v4, s19, v2
v_mul_u32_u24 v5, 911, v4
v_lshrrev_b32 v5, 14, v5
v_mul_u32_u24 v6, 18, v5
v_sub_u32 v4, v4, v6
v_and_b32 v6, 1, v5
v_lshrrev_b32 v5, 1, v5
s_mov_b32 s17, 132608
v_mul_lo_u32 v5, v5, s17
s_cmp_eq_u32 s20, 0
s_cselect_b32 s21, 5, 0
s_cselect_b32 s22, 8, 4
s_cmp_eq_u32 s20, 2
s_cselect_b32 s21, 2, s21
s_cselect_b32 s22, 0, s22
s_sub_u32 s22, s22, 16
v_add_u32 v14, s21, v6
v_lshl_add_u32 v15, v6, 1, v4
v_add_u32 v15, s22, v15
v_cmp_gt_u32 vcc, 16, v4
s_nop 1
v_cndmask_b32 v14, 4, v14, vcc
v_cndmask_b32 v15, v15, v4, vcc
v_lshl_add_u32 v8, v14, 10, v5
v_lshl_add_u32 v8, v15, 4, v8
v_lshl_add_u32 v9, v14, 9, v5
v_lshl_add_u32 v9, v15, 3, v9
s_lshl_b32 s17, s14, 7
s_add_u32 s17, s17, 129024
v_add_u32 v9, s17, v9
s_mul_i32 s17, s14, 18
v_add_u32 v5, s17, v3
v_and_b32 v6, 3, v5
v_lshrrev_b32 v5, 2, v5
v_mul_u32_u24 v5, 7168, v5
v_add_u32 v8, v8, v5
v_lshl_add_u32 v8, v6, 8, v8
s_waitcnt vmcnt(0)
s_barrier
ds_read_b64_tr_b16 v[16:17], v10 offset:0
ds_read_b64_tr_b16 v[18:19], v10 offset:512
ds_read_b64_tr_b16 v[20:21], v10 offset:4096
ds_read_b64_tr_b16 v[22:23], v10 offset:4608
ds_read_b64_tr_b16 v[24:25], v10 offset:8192
ds_read_b64_tr_b16 v[26:27], v10 offset:8704
ds_read_b64_tr_b16 v[28:29], v10 offset:12288
ds_read_b64_tr_b16 v[30:31], v10 offset:12800
ds_read_b64_tr_b16 v[32:33], v10 offset:16384
ds_read_b64_tr_b16 v[34:35], v10 offset:16896
v_cmp_gt_u32 vcc, 2, v3
v_mov_b32 v4, 1073741824
v_mov_b32 v11, 0
v_cndmask_b32 v4, v4, v8, vcc
s_mov_b32 s17, 0
s_waitcnt lgkmcnt(8)
buffer_store_dwordx4 v[16:19], v8, s[4:7], s17 offen
s_mov_b32 s17, 7168
s_waitcnt lgkmcnt(6)
buffer_store_dwordx4 v[20:23], v8, s[4:7], s17 offen
s_mov_b32 s17, 14336
s_waitcnt lgkmcnt(4)
buffer_store_dwordx4 v[24:27], v8, s[4:7], s17 offen
s_mov_b32 s17, 21504
s_waitcnt lgkmcnt(2)
buffer_store_dwordx4 v[28:31], v8, s[4:7], s17 offen
s_mov_b32 s17, 28672
s_waitcnt lgkmcnt(0)
buffer_store_dwordx4 v[32:35], v4, s[4:7], s17 offen
v_mov_b32 v5, 0x3f803f80
v_dot2c_f32_bf16 v11, v16, v5
v_dot2c_f32_bf16 v11, v17, v5
v_dot2c_f32_bf16 v11, v18, v5
v_dot2c_f32_bf16 v11, v19, v5
v_dot2c_f32_bf16 v11, v20, v5
v_dot2c_f32_bf16 v11, v21, v5
v_dot2c_f32_bf16 v11, v22, v5
v_dot2c_f32_bf16 v11, v23, v5
v_dot2c_f32_bf16 v11, v24, v5
v_dot2c_f32_bf16 v11, v25, v5
v_dot2c_f32_bf16 v11, v26, v5
v_dot2c_f32_bf16 v11, v27, v5
v_dot2c_f32_bf16 v11, v28, v5
v_dot2c_f32_bf16 v11, v29, v5
v_dot2c_f32_bf16 v11, v30, v5
v_dot2c_f32_bf16 v11, v31, v5
v_dot2c_f32_bf16 v11, v32, v5
v_dot2c_f32_bf16 v11, v33, v5
v_dot2c_f32_bf16 v11, v34, v5
v_dot2c_f32_bf16 v11, v35, v5
s_nop 2
v_mov_b32 v5, v11
s_nop 1
v_permlane32_swap_b32 v11, v5
v_add_f32 v11, v11, v5
v_mov_b32 v5, v11
s_nop 1
v_permlane16_swap_b32 v11, v5
v_add_f32 v11, v11, v5
v_cvt_pk_bf16_f32 v14, v11, v11
v_and_b32 v5, 0xffff0000, v14
v_sub_f32 v5, v11, v5
v_cvt_pk_bf16_f32 v15, v5, v5
v_cmp_eq_u32 vcc, 0, v3
v_mov_b32 v4, 1073741824
s_nop 0
v_cndmask_b32 v4, v4, v9, vcc
buffer_store_dwordx2 v[14:15], v4, s[4:7], 0 offen
s_branch L_prep_tail
L_prep_x:
s_load_dwordx2 s[8:9], s[0:1], 0
s_mov_b32 s10, 2359296
s_mul_i32 s16, s12, 18
v_add_u32 v4, s16, v3
v_mul_u32_u24 v7, 1152, v2
v_lshl_add_u32 v7, v4, 4, v7
s_mul_i32 s16, s2, 18432
v_lshlrev_b32 v8, 8, v4
v_lshl_add_u32 v8, v2, 4, v8
s_add_u32 s17, s16, 10895360
v_cmp_gt_u32 vcc, 2, v3
v_mov_b32 v4, 1073741824
v_mov_b32 v11, 0
v_cndmask_b32 v5, v4, v7, vcc
v_cndmask_b32 v6, v4, v8, vcc
v_add_u32 v6, 4096, v6
v_mov_b32 v12, 0
v_mov_b32 v13, 0x3f803f80
s_waitcnt lgkmcnt(0)
buffer_load_dwordx4 v[16:19], v7, s[8:11], s16 offen offset:0
buffer_load_dwordx4 v[20:23], v7, s[8:11], s16 offen offset:64
buffer_load_dwordx4 v[24:27], v7, s[8:11], s16 offen offset:128
buffer_load_dwordx4 v[28:31], v7, s[8:11], s16 offen offset:192
buffer_load_dwordx4 v[32:35], v5, s[8:11], s16 offen offset:256
s_waitcnt vmcnt(4)
buffer_store_dwordx4 v[16:19], v8, s[4:7], s17 offen offset:0
s_waitcnt vmcnt(4)
buffer_store_dwordx4 v[20:23], v8, s[4:7], s17 offen offset:1024
s_waitcnt vmcnt(4)
buffer_store_dwordx4 v[24:27], v8, s[4:7], s17 offen offset:2048
s_waitcnt vmcnt(4)
buffer_store_dwordx4 v[28:31], v8, s[4:7], s17 offen offset:3072
s_waitcnt vmcnt(4)
buffer_store_dwordx4 v[32:35], v6, s[4:7], s17 offen offset:0
v_dot2c_f32_bf16 v11, v16, v13
v_dot2c_f32_bf16 v11, v17, v13
v_dot2c_f32_bf16 v11, v18, v13
v_dot2c_f32_bf16 v11, v19, v13
v_dot2c_f32_bf16 v11, v20, v13
v_dot2c_f32_bf16 v11, v21, v13
v_dot2c_f32_bf16 v11, v22, v13
v_dot2c_f32_bf16 v11, v23, v13
v_dot2c_f32_bf16 v11, v24, v13
v_dot2c_f32_bf16 v11, v25, v13
v_dot2c_f32_bf16 v11, v26, v13
v_dot2c_f32_bf16 v11, v27, v13
v_dot2c_f32_bf16 v11, v28, v13
v_dot2c_f32_bf16 v11, v29, v13
v_dot2c_f32_bf16 v11, v30, v13
v_dot2c_f32_bf16 v11, v31, v13
v_dot2c_f32_bf16 v11, v32, v13
v_dot2c_f32_bf16 v11, v33, v13
v_dot2c_f32_bf16 v11, v34, v13
v_dot2c_f32_bf16 v11, v35, v13
v_dot2c_f32_bf16 v12, v16, v16
v_dot2c_f32_bf16 v12, v17, v17
v_dot2c_f32_bf16 v12, v18, v18
v_dot2c_f32_bf16 v12, v19, v19
v_dot2c_f32_bf16 v12, v20, v20
v_dot2c_f32_bf16 v12, v21, v21
v_dot2c_f32_bf16 v12, v22, v22
v_dot2c_f32_bf16 v12, v23, v23
v_dot2c_f32_bf16 v12, v24, v24
v_dot2c_f32_bf16 v12, v25, v25
v_dot2c_f32_bf16 v12, v26, v26
v_dot2c_f32_bf16 v12, v27, v27
v_dot2c_f32_bf16 v12, v28, v28
v_dot2c_f32_bf16 v12, v29, v29
v_dot2c_f32_bf16 v12, v30, v30
v_dot2c_f32_bf16 v12, v31, v31
v_dot2c_f32_bf16 v12, v32, v32
v_dot2c_f32_bf16 v12, v33, v33
v_dot2c_f32_bf16 v12, v34, v34
v_dot2c_f32_bf16 v12, v35, v35
v_mov_b32 v5, v11
s_nop 1
v_permlane32_swap_b32 v11, v5
v_add_f32 v11, v11, v5
v_mov_b32 v5, v11
s_nop 1
v_permlane16_swap_b32 v11, v5
v_add_f32 v11, v11, v5
v_mov_b32 v5, v12
s_nop 1
v_permlane32_swap_b32 v12, v5
v_add_f32 v12, v12, v5
v_mov_b32 v5, v12
s_nop 1
v_permlane16_swap_b32 v12, v5
v_add_f32 v12, v12, v5
v_cmp_eq_u32 vcc, 0, v3
s_lshl_b32 s16, s2, 7
s_lshl_b32 s17, s12, 14
s_add_u32 s16, s16, s17
s_add_u32 s16, s16, 13254656
v_cndmask_b32 v14, 0, v11, vcc
v_cndmask_b32 v15, 0, v12, vcc
v_lshlrev_b32 v5, 3, v2
v_lshl_add_u32 v5, v3, 16, v5
v_cmp_gt_u32 vcc, 2, v3
s_nop 1
v_cndmask_b32 v5, v4, v5, vcc
buffer_store_dwordx2 v[14:15], v5, s[4:7], s16 offen
L_prep_tail:
s_sub_u32 s16, s2, 272
s_cmp_lt_u32 s16, 208
s_cbranch_scc0 L_prep_t2
s_cmp_ge_u32 s16, 104
s_cselect_b32 s17, 26640384, 0
s_cselect_b32 s18, 104, 0
s_sub_u32 s16, s16, s18
s_cmp_lt_u32 s16, 64
s_cselect_b32 s18, 3212836864, 0
s_lshl_b32 s16, s16, 12
s_add_u32 s16, s16, s17
s_add_u32 s16, s16, 37109760
v_mov_b32 v52, s18
v_mov_b32 v53, s18
v_mov_b32 v54, s18
v_mov_b32 v55, s18
v_lshlrev_b32 v51, 4, v0
buffer_store_dwordx4 v[52:55], v51, s[4:7], s16 offen
L_prep_t2:
s_cmp_lt_u32 s2, 256
s_cbranch_scc0 L_prep_end
s_getpc_b64 s[20:21]
L_prep_pc:
s_add_u32 s20, s20, main_kernel-L_prep_pc
s_addc_u32 s21, s21, 0
s_mov_b32 s22, 41152
s_mov_b32 s23, 0x20000
s_lshr_b32 s16, s2, 3
s_mul_i32 s16, s16, 1408
v_lshlrev_b32 v51, 4, v0
v_cmp_gt_u32 vcc, 1408, v51
v_mov_b32 v56, 1073741824
s_nop 0
v_cndmask_b32 v51, v56, v51, vcc
buffer_load_dwordx4 v[56:59], v51, s[20:23], s16 offen
L_prep_end:
s_endpgm
.globl main_kernel
.p2align 8
.type main_kernel,@function
main_kernel:
s_cmp_ge_u32 s2, 256
s_cbranch_scc1 L_main_end
s_load_dwordx2 s[4:5], s[0:1], 80
s_load_dwordx2 s[12:13], s[0:1], 40
s_load_dwordx2 s[16:17], s[0:1], 64
s_load_dwordx2 s[20:21], s[0:1], 48
v_lshrrev_b32 v6, 6, v0
v_and_b32 v0, 63, v0
v_readfirstlane_b32 s24, v6
v_lshlrev_b32 v1, 4, v0
v_and_b32 v2, 15, v0
v_lshrrev_b32 v3, 4, v0
v_mov_b32 v4, 1
v_mov_b32 v5, 0
s_mov_b32 s56, 0
s_mov_b32 s29, 0
s_mov_b32 s6, 10895360
s_mov_b32 s7, 0x20000
s_mov_b32 s10, 53280768
s_mov_b32 s11, 0x20000
s_mov_b32 s14, 8388608
s_mov_b32 s15, 0x20000
s_mov_b32 s18, 2359296
s_mov_b32 s19, 0x20000
s_mov_b32 s22, 4096
s_mov_b32 s23, 0x20000
s_and_b32 s30, s2, 7
s_lshr_b32 s31, s2, 3
s_lshr_b32 s32, s31, 2
s_and_b32 s33, s31, 3
s_lshr_b32 s25, s30, 2
s_lshl_b32 s25, s25, 3
s_add_u32 s25, s25, s32
s_and_b32 s26, s30, 3
s_lshl_b32 s26, s26, 2
s_add_u32 s26, s26, s33
s_lshr_b32 s27, s30, 1
s_lshl_b32 s27, s27, 3
s_add_u32 s27, s27, s32
s_and_b32 s28, s30, 1
s_lshl_b32 s28, s28, 2
s_add_u32 s28, s28, s33
s_waitcnt lgkmcnt(0)
s_add_u32 s8, s4, 10895360
s_addc_u32 s9, s5, 0
s_mul_i32 s30, s26, 132608
s_mul_i32 s38, s24, 33792
s_add_u32 s39, s38, s30
s_add_u32 m0, s38, 0
s_nop 0
buffer_load_dwordx4 v1, s[4:7], s39 offen offset:0  lds
buffer_load_dwordx4 v1, s[4:7], s39 offen offset:1024  lds
buffer_load_dwordx4 v1, s[4:7], s39 offen offset:2048  lds
buffer_load_dwordx4 v1, s[4:7], s39 offen offset:3072  lds
s_add_u32 m0, m0, 4096
s_add_u32 s39, s39, 4096
buffer_load_dwordx4 v1, s[4:7], s39 offen offset:0  lds
buffer_load_dwordx4 v1, s[4:7], s39 offen offset:1024  lds
buffer_load_dwordx4 v1, s[4:7], s39 offen offset:2048  lds
buffer_load_dwordx4 v1, s[4:7], s39 offen offset:3072  lds
s_add_u32 m0, m0, 4096
s_add_u32 s39, s39, 4096
buffer_load_dwordx4 v1, s[4:7], s39 offen offset:0  lds
buffer_load_dwordx4 v1, s[4:7], s39 offen offset:1024  lds
buffer_load_dwordx4 v1, s[4:7], s39 offen offset:2048  lds
buffer_load_dwordx4 v1, s[4:7], s39 offen offset:3072  lds
s_add_u32 m0, m0, 4096
s_add_u32 s39, s39, 4096
buffer_load_dwordx4 v1, s[4:7], s39 offen offset:0  lds
buffer_load_dwordx4 v1, s[4:7], s39 offen offset:1024  lds
buffer_load_dwordx4 v1, s[4:7], s39 offen offset:2048  lds
buffer_load_dwordx4 v1, s[4:7], s39 offen offset:3072  lds
s_add_u32 m0, m0, 4096
s_add_u32 s39, s39, 4096
buffer_load_dwordx4 v1, s[4:7], s39 offen offset:0  lds
buffer_load_dwordx4 v1, s[4:7], s39 offen offset:1024  lds
buffer_load_dwordx4 v1, s[4:7], s39 offen offset:2048  lds
buffer_load_dwordx4 v1, s[4:7], s39 offen offset:3072  lds
s_add_u32 m0, m0, 4096
s_add_u32 s39, s39, 4096
buffer_load_dwordx4 v1, s[4:7], s39 offen offset:0  lds
buffer_load_dwordx4 v1, s[4:7], s39 offen offset:1024  lds
buffer_load_dwordx4 v1, s[4:7], s39 offen offset:2048  lds
buffer_load_dwordx4 v1, s[4:7], s39 offen offset:3072  lds
s_add_u32 m0, m0, 4096
s_add_u32 s39, s39, 4096
buffer_load_dwordx4 v1, s[4:7], s39 offen offset:0  lds
buffer_load_dwordx4 v1, s[4:7], s39 offen offset:1024  lds
buffer_load_dwordx4 v1, s[4:7], s39 offen offset:2048  lds
buffer_load_dwordx4 v1, s[4:7], s39 offen offset:3072  lds
s_add_u32 m0, m0, 4096
s_add_u32 s39, s39, 4096
buffer_load_dwordx4 v1, s[4:7], s39 offen offset:0  lds
buffer_load_dwordx4 v1, s[4:7], s39 offen offset:1024  lds
buffer_load_dwordx4 v1, s[4:7], s39 offen offset:2048  lds
buffer_load_dwordx4 v1, s[4:7], s39 offen offset:3072  lds
s_add_u32 m0, m0, 4096
s_add_u32 s39, s39, 4096
buffer_load_dwordx4 v1, s[4:7], s39 offen offset:0  lds
s_lshl_b32 s30, s27, 2
s_add_u32 s30, s30, s24
s_mul_i32 s30, s30, 18432
s_mul_i32 s31, s28, 2304
s_add_u32 s30, s30, s31
s_add_u32 s30, s30, 0
v_and_b32 v6, 1, v3
v_lshlrev_b32 v6, 3, v6
v_lshl_add_u32 v6, v2, 4, v6
buffer_load_dwordx4 v[108:111], v1, s[8:11], s30 offen
buffer_load_dwordx4 v[112:115], v1, s[8:11], s30 offen offset:1024
buffer_load_dwordx2 v[116:117], v6, s[8:11], s30 offen offset:2048
v_and_b32 v6, 1, v2
v_cmp_eq_u32 s[40:41], 1, v6
v_lshl_add_u32 v6, v3, 2, v6
v_cmp_le_u32 s[42:43], v6, v2
v_add_u32 v6, 2, v6
v_cmp_le_u32 s[44:45], v6, v2
v_cmp_eq_u32 s[46:47], 0, v3
v_cmp_eq_u32 s[48:49], 2, v3
v_cmp_gt_u32 s[50:51], 2, v3
v_mov_b32 v6, 0x0c0c0100
v_mov_b32 v7, 0x01000c0c
v_cndmask_b32 v6, v6, v7, s[40:41]
v_mov_b32 v8, 0x0c0c0c0c
v_cndmask_b32 v10, v6, v8, s[42:43]
v_cndmask_b32 v12, v8, v6, s[42:43]
v_mov_b32 v6, 0x0c0c0302
v_mov_b32 v7, 0x03020c0c
v_cndmask_b32 v6, v6, v7, s[40:41]
v_cndmask_b32 v11, v6, v8, s[44:45]
v_cndmask_b32 v13, v8, v6, s[44:45]
s_waitcnt vmcnt(0)
v_lshlrev_b32 v16, 16, v108
v_and_b32 v17, 0xffff0000, v108
v_lshlrev_b32 v18, 16, v109
v_and_b32 v19, 0xffff0000, v109
v_lshlrev_b32 v20, 16, v110
v_and_b32 v21, 0xffff0000, v110
v_lshlrev_b32 v22, 16, v111
v_and_b32 v23, 0xffff0000, v111
v_lshlrev_b32 v24, 16, v112
v_and_b32 v25, 0xffff0000, v112
v_lshlrev_b32 v26, 16, v113
v_and_b32 v27, 0xffff0000, v113
v_lshlrev_b32 v28, 16, v114
v_and_b32 v29, 0xffff0000, v114
v_lshlrev_b32 v30, 16, v115
v_and_b32 v31, 0xffff0000, v115
v_lshlrev_b32 v32, 16, v116
v_and_b32 v33, 0xffff0000, v116
v_lshlrev_b32 v34, 16, v117
v_and_b32 v35, 0xffff0000, v117
s_lshl_b32 s80, s25, 4
s_add_u32 s80, s80, s26
s_lshl_b32 s81, s27, 3
s_add_u32 s81, s81, s28
L_layer:
s_lshl_b32 s60, s25, 3
s_sub_u32 s61, s60, 1
s_max_i32 s61, s61, 0
s_lshl_b32 s30, s24, 1
s_add_u32 s60, s60, s30
s_mul_i32 s30, s61, 18432
s_add_u32 s30, s30, 0
s_mul_i32 s38, s24, 5120
s_add_u32 s39, s38, s30
s_add_u32 m0, s38, 135168
s_nop 0
buffer_load_dwordx4 v1, s[8:11], s39 offen offset:0 sc1 lds
buffer_load_dwordx4 v1, s[8:11], s39 offen offset:1024 sc1 lds
buffer_load_dwordx4 v1, s[8:11], s39 offen offset:2048 sc1 lds
buffer_load_dwordx4 v1, s[8:11], s39 offen offset:3072 sc1 lds
s_add_u32 m0, m0, 4096
s_add_u32 s39, s39, 4096
buffer_load_dwordx4 v1, s[8:11], s39 offen offset:0 sc1 lds
s_sub_u32 s30, s60, 2
v_add_u32 v6, s30, v3
v_max_i32 v6, 0, v6
v_mov_b32 v7, s61
v_cndmask_b32 v6, v6, v7, s[46:47]
v_lshl_add_u32 v6, v6, 4, v2
v_lshlrev_b32 v6, 3, v6
s_mov_b32 s30, 2359296
buffer_load_dwordx2 v[100:101], v6, s[8:11], s30 offen sc1
s_mov_b32 s30, 2375680
buffer_load_dwordx2 v[102:103], v6, s[8:11], s30 offen sc1
s_mov_b32 s30, 2392064
buffer_load_dwordx2 v[104:105], v6, s[8:11], s30 offen sc1
s_mov_b32 s30, 2408448
buffer_load_dwordx2 v[106:107], v6, s[8:11], s30 offen sc1
s_mov_b32 s30, 2424832
buffer_load_dwordx2 v[108:109], v6, s[8:11], s30 offen sc1
s_mov_b32 s30, 2441216
buffer_load_dwordx2 v[110:111], v6, s[8:11], s30 offen sc1
s_mov_b32 s30, 2457600
buffer_load_dwordx2 v[112:113], v6, s[8:11], s30 offen sc1
s_mov_b32 s30, 2473984
buffer_load_dwordx2 v[114:115], v6, s[8:11], s30 offen sc1
s_mul_i32 s30, s60, 18432
s_add_u32 s30, s30, 0
v_add_u32 v127, 18432, v1
buffer_load_dwordx4 a[0:3], v1, s[8:11], s30 offen offset:0 sc1
buffer_load_dwordx4 a[4:7], v127, s[8:11], s30 offen offset:0 sc1
buffer_load_dwordx4 a[8:11], v1, s[8:11], s30 offen offset:1024 sc1
buffer_load_dwordx4 a[12:15], v127, s[8:11], s30 offen offset:1024 sc1
buffer_load_dwordx4 a[16:19], v1, s[8:11], s30 offen offset:2048 sc1
buffer_load_dwordx4 a[20:23], v127, s[8:11], s30 offen offset:2048 sc1
buffer_load_dwordx4 a[24:27], v1, s[8:11], s30 offen offset:3072 sc1
buffer_load_dwordx4 a[28:31], v127, s[8:11], s30 offen offset:3072 sc1
s_add_u32 s30, s30, 4096
buffer_load_dwordx4 a[32:35], v1, s[8:11], s30 offen offset:0 sc1
buffer_load_dwordx4 a[36:39], v127, s[8:11], s30 offen offset:0 sc1
buffer_load_dwordx4 a[40:43], v1, s[8:11], s30 offen offset:1024 sc1
buffer_load_dwordx4 a[44:47], v127, s[8:11], s30 offen offset:1024 sc1
buffer_load_dwordx4 a[48:51], v1, s[8:11], s30 offen offset:2048 sc1
buffer_load_dwordx4 a[52:55], v127, s[8:11], s30 offen offset:2048 sc1
buffer_load_dwordx4 a[56:59], v1, s[8:11], s30 offen offset:3072 sc1
buffer_load_dwordx4 a[60:63], v127, s[8:11], s30 offen offset:3072 sc1
s_add_u32 s30, s30, 4096
buffer_load_dwordx4 a[64:67], v1, s[8:11], s30 offen offset:0 sc1
buffer_load_dwordx4 a[68:71], v127, s[8:11], s30 offen offset:0 sc1
buffer_load_dwordx4 a[72:75], v1, s[8:11], s30 offen offset:1024 sc1
buffer_load_dwordx4 a[76:79], v127, s[8:11], s30 offen offset:1024 sc1
buffer_load_dwordx4 a[80:83], v1, s[8:11], s30 offen offset:2048 sc1
buffer_load_dwordx4 a[84:87], v127, s[8:11], s30 offen offset:2048 sc1
buffer_load_dwordx4 a[88:91], v1, s[8:11], s30 offen offset:3072 sc1
buffer_load_dwordx4 a[92:95], v127, s[8:11], s30 offen offset:3072 sc1
s_add_u32 s30, s30, 4096
buffer_load_dwordx4 a[96:99], v1, s[8:11], s30 offen offset:0 sc1
buffer_load_dwordx4 a[100:103], v127, s[8:11], s30 offen offset:0 sc1
buffer_load_dwordx4 a[104:107], v1, s[8:11], s30 offen offset:1024 sc1
buffer_load_dwordx4 a[108:111], v127, s[8:11], s30 offen offset:1024 sc1
buffer_load_dwordx4 a[112:115], v1, s[8:11], s30 offen offset:2048 sc1
buffer_load_dwordx4 a[116:119], v127, s[8:11], s30 offen offset:2048 sc1
buffer_load_dwordx4 a[120:123], v1, s[8:11], s30 offen offset:3072 sc1
buffer_load_dwordx4 a[124:127], v127, s[8:11], s30 offen offset:3072 sc1
s_add_u32 s30, s30, 4096
buffer_load_dwordx4 a[128:131], v1, s[8:11], s30 offen offset:0 sc1
buffer_load_dwordx4 a[132:135], v127, s[8:11], s30 offen offset:0 sc1
buffer_load_dwordx4 a[136:139], v1, s[8:11], s30 offen offset:1024 sc1
buffer_load_dwordx4 a[140:143], v127, s[8:11], s30 offen offset:1024 sc1
s_lshl_b32 s30, s24, 10
v_add_u32 v125, s30, v1
v_add_u32 v126, 135168, v1
v_lshrrev_b32 v128, 1, v1
v_add_u32 v128, 129024, v128
s_lshl_b32 s30, s24, 9
v_add_u32 v129, s30, v128
v_add_u32 v8, 64512, v1
s_waitcnt vmcnt(44)
s_barrier
ds_read_b128 a[144:147], v1 offset:0
ds_read_b128 a[148:151], v1 offset:1024
ds_read_b128 a[152:155], v1 offset:2048
ds_read_b128 a[156:159], v1 offset:3072
ds_read_b128 a[160:163], v1 offset:4096
ds_read_b128 a[164:167], v1 offset:5120
ds_read_b128 a[168:171], v1 offset:6144
ds_read_b128 a[172:175], v125 offset:0
ds_read_b128 a[176:179], v126 offset:0
s_waitcnt lgkmcnt(0)
s_waitcnt vmcnt(34)
v_mfma_f32_16x16x32_bf16 v[36:39], a[144:147], a[0:3], 0
ds_read_b128 a[180:183], v1 offset:7168
v_mfma_f32_16x16x32_bf16 v[64:67], a[144:147], a[4:7], 0
ds_read_b128 a[184:187], v1 offset:8192
v_mfma_f32_16x16x32_bf16 v[40:43], a[148:151], a[0:3], 0
ds_read_b128 a[188:191], v1 offset:9216
v_mfma_f32_16x16x32_bf16 v[68:71], a[148:151], a[4:7], 0
ds_read_b128 a[192:195], v1 offset:10240
v_mfma_f32_16x16x32_bf16 v[44:47], a[152:155], a[0:3], 0
ds_read_b128 a[196:199], v1 offset:11264
v_mfma_f32_16x16x32_bf16 v[72:75], a[152:155], a[4:7], 0
ds_read_b128 a[200:203], v1 offset:12288
v_mfma_f32_16x16x32_bf16 v[48:51], a[156:159], a[0:3], 0
ds_read_b128 a[204:207], v1 offset:13312
v_mfma_f32_16x16x32_bf16 v[76:79], a[156:159], a[4:7], 0
ds_read_b128 a[208:211], v125 offset:7168
v_mfma_f32_16x16x32_bf16 v[52:55], a[160:163], a[0:3], 0
ds_read_b128 a[212:215], v126 offset:1024
v_mfma_f32_16x16x32_bf16 v[80:83], a[160:163], a[4:7], 0
v_mfma_f32_16x16x32_bf16 v[56:59], a[164:167], a[0:3], 0
v_mfma_f32_16x16x32_bf16 v[84:87], a[164:167], a[4:7], 0
v_mfma_f32_16x16x32_bf16 v[60:63], a[168:171], a[0:3], 0
v_mfma_f32_16x16x32_bf16 v[88:91], a[168:171], a[4:7], 0
v_mfma_f32_16x16x32_bf16 v[92:95], a[172:175], a[176:179], 0
v_mfma_f32_16x16x32_bf16 v[96:99], a[160:163], a[176:179], 0
s_waitcnt lgkmcnt(0)
s_waitcnt vmcnt(32)
v_mfma_f32_16x16x32_bf16 v[36:39], a[180:183], a[8:11], v[36:39]
ds_read_b128 a[144:147], v1 offset:14336
v_mfma_f32_16x16x32_bf16 v[64:67], a[180:183], a[12:15], v[64:67]
ds_read_b128 a[148:151], v1 offset:15360
v_mfma_f32_16x16x32_bf16 v[40:43], a[184:187], a[8:11], v[40:43]
ds_read_b128 a[152:155], v1 offset:16384
v_mfma_f32_16x16x32_bf16 v[68:71], a[184:187], a[12:15], v[68:71]
ds_read_b128 a[156:159], v1 offset:17408
v_mfma_f32_16x16x32_bf16 v[44:47], a[188:191], a[8:11], v[44:47]
ds_read_b128 a[160:163], v1 offset:18432
v_mfma_f32_16x16x32_bf16 v[72:75], a[188:191], a[12:15], v[72:75]
ds_read_b128 a[164:167], v1 offset:19456
v_mfma_f32_16x16x32_bf16 v[48:51], a[192:195], a[8:11], v[48:51]
ds_read_b128 a[168:171], v1 offset:20480
v_mfma_f32_16x16x32_bf16 v[76:79], a[192:195], a[12:15], v[76:79]
ds_read_b128 a[172:175], v125 offset:14336
v_mfma_f32_16x16x32_bf16 v[52:55], a[196:199], a[8:11], v[52:55]
ds_read_b128 a[176:179], v126 offset:2048
v_mfma_f32_16x16x32_bf16 v[80:83], a[196:199], a[12:15], v[80:83]
v_mfma_f32_16x16x32_bf16 v[56:59], a[200:203], a[8:11], v[56:59]
v_mfma_f32_16x16x32_bf16 v[84:87], a[200:203], a[12:15], v[84:87]
v_mfma_f32_16x16x32_bf16 v[60:63], a[204:207], a[8:11], v[60:63]
v_mfma_f32_16x16x32_bf16 v[88:91], a[204:207], a[12:15], v[88:91]
v_mfma_f32_16x16x32_bf16 v[92:95], a[208:211], a[212:215], v[92:95]
v_mfma_f32_16x16x32_bf16 v[96:99], a[196:199], a[212:215], v[96:99]
s_waitcnt lgkmcnt(0)
s_waitcnt vmcnt(30)
v_mfma_f32_16x16x32_bf16 v[36:39], a[144:147], a[16:19], v[36:39]
ds_read_b128 a[180:183], v1 offset:21504
v_mfma_f32_16x16x32_bf16 v[64:67], a[144:147], a[20:23], v[64:67]
ds_read_b128 a[184:187], v1 offset:22528
v_mfma_f32_16x16x32_bf16 v[40:43], a[148:151], a[16:19], v[40:43]
ds_read_b128 a[188:191], v1 offset:23552
v_mfma_f32_16x16x32_bf16 v[68:71], a[148:151], a[20:23], v[68:71]
ds_read_b128 a[192:195], v1 offset:24576
v_mfma_f32_16x16x32_bf16 v[44:47], a[152:155], a[16:19], v[44:47]
ds_read_b128 a[196:199], v1 offset:25600
v_mfma_f32_16x16x32_bf16 v[72:75], a[152:155], a[20:23], v[72:75]
ds_read_b128 a[200:203], v1 offset:26624
v_mfma_f32_16x16x32_bf16 v[48:51], a[156:159], a[16:19], v[48:51]
ds_read_b128 a[204:207], v1 offset:27648
v_mfma_f32_16x16x32_bf16 v[76:79], a[156:159], a[20:23], v[76:79]
ds_read_b128 a[208:211], v125 offset:21504
v_mfma_f32_16x16x32_bf16 v[52:55], a[160:163], a[16:19], v[52:55]
ds_read_b128 a[212:215], v126 offset:3072
v_mfma_f32_16x16x32_bf16 v[80:83], a[160:163], a[20:23], v[80:83]
v_add_f32 v130, v100, v102
v_add_f32 v131, v101, v103
v_mfma_f32_16x16x32_bf16 v[56:59], a[164:167], a[16:19], v[56:59]
v_add_f32 v130, v130, v104
v_add_f32 v131, v131, v105
v_mfma_f32_16x16x32_bf16 v[84:87], a[164:167], a[20:23], v[84:87]
v_add_f32 v130, v130, v106
v_add_f32 v131, v131, v107
v_mfma_f32_16x16x32_bf16 v[60:63], a[168:171], a[16:19], v[60:63]
v_add_f32 v130, v130, v108
v_add_f32 v131, v131, v109
v_mfma_f32_16x16x32_bf16 v[88:91], a[168:171], a[20:23], v[88:91]
v_add_f32 v130, v130, v110
v_add_f32 v131, v131, v111
v_mfma_f32_16x16x32_bf16 v[92:95], a[172:175], a[176:179], v[92:95]
v_add_f32 v130, v130, v112
v_add_f32 v131, v131, v113
v_mfma_f32_16x16x32_bf16 v[96:99], a[160:163], a[176:179], v[96:99]
v_add_f32 v130, v130, v114
v_add_f32 v131, v131, v115
s_waitcnt lgkmcnt(0)
s_waitcnt vmcnt(28)
v_mfma_f32_16x16x32_bf16 v[36:39], a[180:183], a[24:27], v[36:39]
ds_read_b128 a[144:147], v1 offset:28672
v_mfma_f32_16x16x32_bf16 v[64:67], a[180:183], a[28:31], v[64:67]
ds_read_b128 a[148:151], v1 offset:29696
v_mfma_f32_16x16x32_bf16 v[40:43], a[184:187], a[24:27], v[40:43]
ds_read_b128 a[152:155], v1 offset:30720
v_mfma_f32_16x16x32_bf16 v[68:71], a[184:187], a[28:31], v[68:71]
ds_read_b128 a[156:159], v1 offset:31744
v_mfma_f32_16x16x32_bf16 v[44:47], a[188:191], a[24:27], v[44:47]
ds_read_b128 a[160:163], v1 offset:32768
v_mfma_f32_16x16x32_bf16 v[72:75], a[188:191], a[28:31], v[72:75]
ds_read_b128 a[164:167], v1 offset:33792
v_mfma_f32_16x16x32_bf16 v[48:51], a[192:195], a[24:27], v[48:51]
ds_read_b128 a[168:171], v1 offset:34816
v_mfma_f32_16x16x32_bf16 v[76:79], a[192:195], a[28:31], v[76:79]
ds_read_b128 a[172:175], v125 offset:28672
v_mfma_f32_16x16x32_bf16 v[52:55], a[196:199], a[24:27], v[52:55]
ds_read_b128 a[176:179], v126 offset:4096
v_mfma_f32_16x16x32_bf16 v[80:83], a[196:199], a[28:31], v[80:83]
v_mul_f32 v130, 0x3ae38e39, v130
v_mul_f32 v6, v130, v130
v_mfma_f32_16x16x32_bf16 v[56:59], a[200:203], a[24:27], v[56:59]
v_mul_f32 v131, 0x3ae38e39, v131
v_sub_f32 v131, v131, v6
v_mfma_f32_16x16x32_bf16 v[84:87], a[200:203], a[28:31], v[84:87]
v_max_f32 v131, 0, v131
v_add_f32 v131, 0x3727c5ac, v131
v_mfma_f32_16x16x32_bf16 v[60:63], a[204:207], a[24:27], v[60:63]
v_rsq_f32 v132, v131
v_mfma_f32_16x16x32_bf16 v[88:91], a[204:207], a[28:31], v[88:91]
v_cvt_pk_bf16_f32 v6, -v130, -v130
v_and_b32 v6, 0xffff0000, v6
v_mfma_f32_16x16x32_bf16 v[92:95], a[208:211], a[212:215], v[92:95]
v_add_f32 v6, v130, v6
v_cvt_pk_bf16_f32 v133, -v130, -v6
v_mfma_f32_16x16x32_bf16 v[96:99], a[196:199], a[212:215], v[96:99]
v_lshlrev_b32 v124, 2, v2
v_and_b32 v6, 1, v2
v_lshl_add_u32 v6, v3, 2, v6
s_waitcnt lgkmcnt(0)
s_waitcnt vmcnt(26)
v_mfma_f32_16x16x32_bf16 v[36:39], a[144:147], a[32:35], v[36:39]
ds_read_b128 a[180:183], v1 offset:35840
v_mfma_f32_16x16x32_bf16 v[64:67], a[144:147], a[36:39], v[64:67]
ds_read_b128 a[184:187], v1 offset:36864
v_mfma_f32_16x16x32_bf16 v[40:43], a[148:151], a[32:35], v[40:43]
ds_read_b128 a[188:191], v1 offset:37888
v_mfma_f32_16x16x32_bf16 v[68:71], a[148:151], a[36:39], v[68:71]
ds_read_b128 a[192:195], v1 offset:38912
v_mfma_f32_16x16x32_bf16 v[44:47], a[152:155], a[32:35], v[44:47]
ds_read_b128 a[196:199], v1 offset:39936
v_mfma_f32_16x16x32_bf16 v[72:75], a[152:155], a[36:39], v[72:75]
ds_read_b128 a[200:203], v1 offset:40960
v_mfma_f32_16x16x32_bf16 v[48:51], a[156:159], a[32:35], v[48:51]
ds_read_b128 a[204:207], v1 offset:41984
v_mfma_f32_16x16x32_bf16 v[76:79], a[156:159], a[36:39], v[76:79]
ds_read_b128 a[208:211], v125 offset:35840
v_mfma_f32_16x16x32_bf16 v[52:55], a[160:163], a[32:35], v[52:55]
ds_read_b128 a[212:215], v126 offset:5120
v_mfma_f32_16x16x32_bf16 v[80:83], a[160:163], a[36:39], v[80:83]
v_lshlrev_b32 v6, 2, v6
v_add_u32 v122, 64, v6
v_mfma_f32_16x16x32_bf16 v[56:59], a[164:167], a[32:35], v[56:59]
v_add_u32 v7, 128, v6
v_cndmask_b32 v122, v122, v7, s[42:43]
v_mfma_f32_16x16x32_bf16 v[84:87], a[164:167], a[36:39], v[84:87]
v_add_u32 v123, 72, v6
v_add_u32 v7, 136, v6
v_mfma_f32_16x16x32_bf16 v[60:63], a[168:171], a[32:35], v[60:63]
v_cndmask_b32 v123, v123, v7, s[44:45]
v_mfma_f32_16x16x32_bf16 v[88:91], a[168:171], a[36:39], v[88:91]
v_mfma_f32_16x16x32_bf16 v[92:95], a[172:175], a[176:179], v[92:95]
v_mfma_f32_16x16x32_bf16 v[96:99], a[160:163], a[176:179], v[96:99]
s_waitcnt lgkmcnt(0)
s_waitcnt vmcnt(24)
v_mfma_f32_16x16x32_bf16 v[36:39], a[180:183], a[40:43], v[36:39]
ds_read_b128 a[144:147], v1 offset:43008
v_mfma_f32_16x16x32_bf16 v[64:67], a[180:183], a[44:47], v[64:67]
ds_read_b128 a[148:151], v1 offset:44032
v_mfma_f32_16x16x32_bf16 v[40:43], a[184:187], a[40:43], v[40:43]
ds_read_b128 a[152:155], v1 offset:45056
v_mfma_f32_16x16x32_bf16 v[68:71], a[184:187], a[44:47], v[68:71]
ds_read_b128 a[156:159], v1 offset:46080
v_mfma_f32_16x16x32_bf16 v[44:47], a[188:191], a[40:43], v[44:47]
ds_read_b128 a[160:163], v1 offset:47104
v_mfma_f32_16x16x32_bf16 v[72:75], a[188:191], a[44:47], v[72:75]
ds_read_b128 a[164:167], v1 offset:48128
v_mfma_f32_16x16x32_bf16 v[48:51], a[192:195], a[40:43], v[48:51]
ds_read_b128 a[168:171], v1 offset:49152
v_mfma_f32_16x16x32_bf16 v[76:79], a[192:195], a[44:47], v[76:79]
ds_read_b128 a[172:175], v125 offset:43008
v_mfma_f32_16x16x32_bf16 v[52:55], a[196:199], a[40:43], v[52:55]
ds_read_b128 a[176:179], v126 offset:6144
v_mfma_f32_16x16x32_bf16 v[80:83], a[196:199], a[44:47], v[80:83]
ds_bpermute_b32 v116, v124, v133 offset:128
ds_bpermute_b32 v118, v124, v133 offset:192
v_mfma_f32_16x16x32_bf16 v[56:59], a[200:203], a[40:43], v[56:59]
ds_bpermute_b32 v120, v124, v133
ds_bpermute_b32 v134, v124, v132 offset:128
v_mfma_f32_16x16x32_bf16 v[84:87], a[200:203], a[44:47], v[84:87]
ds_bpermute_b32 v135, v124, v132 offset:192
v_mfma_f32_16x16x32_bf16 v[60:63], a[204:207], a[40:43], v[60:63]
v_mfma_f32_16x16x32_bf16 v[88:91], a[204:207], a[44:47], v[88:91]
v_mfma_f32_16x16x32_bf16 v[92:95], a[208:211], a[212:215], v[92:95]
v_mfma_f32_16x16x32_bf16 v[96:99], a[196:199], a[212:215], v[96:99]
s_waitcnt lgkmcnt(0)
s_waitcnt vmcnt(22)
v_mfma_f32_16x16x32_bf16 v[36:39], a[144:147], a[48:51], v[36:39]
ds_read_b128 a[180:183], v1 offset:50176
v_mfma_f32_16x16x32_bf16 v[64:67], a[144:147], a[52:55], v[64:67]
ds_read_b128 a[184:187], v1 offset:51200
v_mfma_f32_16x16x32_bf16 v[40:43], a[148:151], a[48:51], v[40:43]
ds_read_b128 a[188:191], v1 offset:52224
v_mfma_f32_16x16x32_bf16 v[68:71], a[148:151], a[52:55], v[68:71]
ds_read_b128 a[192:195], v1 offset:53248
v_mfma_f32_16x16x32_bf16 v[44:47], a[152:155], a[48:51], v[44:47]
ds_read_b128 a[196:199], v1 offset:54272
v_mfma_f32_16x16x32_bf16 v[72:75], a[152:155], a[52:55], v[72:75]
ds_read_b128 a[200:203], v1 offset:55296
v_mfma_f32_16x16x32_bf16 v[48:51], a[156:159], a[48:51], v[48:51]
ds_read_b128 a[204:207], v1 offset:56320
v_mfma_f32_16x16x32_bf16 v[76:79], a[156:159], a[52:55], v[76:79]
ds_read_b128 a[208:211], v125 offset:50176
v_mfma_f32_16x16x32_bf16 v[52:55], a[160:163], a[48:51], v[52:55]
ds_read_b128 a[212:215], v126 offset:7168
v_mfma_f32_16x16x32_bf16 v[80:83], a[160:163], a[52:55], v[80:83]
ds_bpermute_b32 v136, v122, v132 offset:0
ds_bpermute_b32 v137, v123, v132 offset:0
v_mfma_f32_16x16x32_bf16 v[56:59], a[164:167], a[48:51], v[56:59]
ds_bpermute_b32 v138, v122, v132 offset:64
ds_bpermute_b32 v139, v123, v132 offset:64
v_mfma_f32_16x16x32_bf16 v[84:87], a[164:167], a[52:55], v[84:87]
v_mfma_f32_16x16x32_bf16 v[60:63], a[168:171], a[48:51], v[60:63]
v_mfma_f32_16x16x32_bf16 v[88:91], a[168:171], a[52:55], v[88:91]
v_mfma_f32_16x16x32_bf16 v[92:95], a[172:175], a[176:179], v[92:95]
v_mfma_f32_16x16x32_bf16 v[96:99], a[160:163], a[176:179], v[96:99]
s_waitcnt lgkmcnt(0)
s_waitcnt vmcnt(20)
v_mfma_f32_16x16x32_bf16 v[36:39], a[180:183], a[56:59], v[36:39]
ds_read_b128 a[144:147], v1 offset:57344
v_mfma_f32_16x16x32_bf16 v[64:67], a[180:183], a[60:63], v[64:67]
ds_read_b128 a[148:151], v1 offset:58368
v_mfma_f32_16x16x32_bf16 v[40:43], a[184:187], a[56:59], v[40:43]
ds_read_b128 a[152:155], v1 offset:59392
v_mfma_f32_16x16x32_bf16 v[68:71], a[184:187], a[60:63], v[68:71]
ds_read_b128 a[156:159], v1 offset:60416
v_mfma_f32_16x16x32_bf16 v[44:47], a[188:191], a[56:59], v[44:47]
ds_read_b128 a[160:163], v1 offset:61440
v_mfma_f32_16x16x32_bf16 v[72:75], a[188:191], a[60:63], v[72:75]
ds_read_b128 a[164:167], v1 offset:62464
v_mfma_f32_16x16x32_bf16 v[48:51], a[192:195], a[56:59], v[48:51]
ds_read_b128 a[168:171], v1 offset:63488
v_mfma_f32_16x16x32_bf16 v[76:79], a[192:195], a[60:63], v[76:79]
ds_read_b128 a[172:175], v125 offset:57344
v_mfma_f32_16x16x32_bf16 v[52:55], a[196:199], a[56:59], v[52:55]
ds_read_b128 a[176:179], v126 offset:8192
v_mfma_f32_16x16x32_bf16 v[80:83], a[196:199], a[60:63], v[80:83]
v_mov_b32 v117, v116
v_mov_b32 v119, v118
v_mfma_f32_16x16x32_bf16 v[56:59], a[200:203], a[56:59], v[56:59]
v_mov_b32 v121, v120
v_mul_f32 v134, 0x3eae1a93, v134
v_mfma_f32_16x16x32_bf16 v[84:87], a[200:203], a[60:63], v[84:87]
v_mul_f32 v135, 0x3eae1a93, v135
v_mul_f32 v140, v134, v136
v_mfma_f32_16x16x32_bf16 v[60:63], a[204:207], a[56:59], v[60:63]
v_mul_f32 v141, v134, v137
v_mul_f32 v142, v135, v138
v_mfma_f32_16x16x32_bf16 v[88:91], a[204:207], a[60:63], v[88:91]
v_mul_f32 v143, v135, v139
v_mfma_f32_16x16x32_bf16 v[92:95], a[208:211], a[212:215], v[92:95]
v_mfma_f32_16x16x32_bf16 v[96:99], a[196:199], a[212:215], v[96:99]
s_waitcnt lgkmcnt(0)
s_waitcnt vmcnt(18)
v_add_u32 v125, 64512, v125
v_mfma_f32_16x16x32_bf16 v[36:39], a[144:147], a[64:67], v[36:39]
ds_read_b128 a[180:183], v8 offset:0
v_mfma_f32_16x16x32_bf16 v[64:67], a[144:147], a[68:71], v[64:67]
ds_read_b128 a[184:187], v8 offset:1024
v_mfma_f32_16x16x32_bf16 v[40:43], a[148:151], a[64:67], v[40:43]
ds_read_b128 a[188:191], v8 offset:2048
v_mfma_f32_16x16x32_bf16 v[68:71], a[148:151], a[68:71], v[68:71]
ds_read_b128 a[192:195], v8 offset:3072
v_mfma_f32_16x16x32_bf16 v[44:47], a[152:155], a[64:67], v[44:47]
ds_read_b128 a[196:199], v8 offset:4096
v_mfma_f32_16x16x32_bf16 v[72:75], a[152:155], a[68:71], v[72:75]
ds_read_b128 a[200:203], v8 offset:5120
v_mfma_f32_16x16x32_bf16 v[48:51], a[156:159], a[64:67], v[48:51]
ds_read_b128 a[204:207], v8 offset:6144
v_mfma_f32_16x16x32_bf16 v[76:79], a[156:159], a[68:71], v[76:79]
ds_read_b128 a[208:211], v125 offset:0
v_mfma_f32_16x16x32_bf16 v[52:55], a[160:163], a[64:67], v[52:55]
ds_read_b128 a[212:215], v126 offset:9216
v_mfma_f32_16x16x32_bf16 v[80:83], a[160:163], a[68:71], v[80:83]
s_cmp_eq_u32 s60, 0
s_cselect_b32 s30, 0xf149f2ca, 0
v_mfma_f32_16x16x32_bf16 v[56:59], a[164:167], a[64:67], v[56:59]
v_mov_b32 v6, s30
v_cndmask_b32 v144, v6, 0, s[42:43]
v_mfma_f32_16x16x32_bf16 v[84:87], a[164:167], a[68:71], v[84:87]
v_cndmask_b32 v145, v6, 0, s[44:45]
v_mfma_f32_16x16x32_bf16 v[60:63], a[168:171], a[64:67], v[60:63]
v_mfma_f32_16x16x32_bf16 v[88:91], a[168:171], a[68:71], v[88:91]
v_mfma_f32_16x16x32_bf16 v[92:95], a[172:175], a[176:179], v[92:95]
v_mfma_f32_16x16x32_bf16 v[96:99], a[160:163], a[176:179], v[96:99]
s_waitcnt lgkmcnt(0)
s_waitcnt vmcnt(16)
v_mfma_f32_16x16x32_bf16 v[36:39], a[180:183], a[72:75], v[36:39]
ds_read_b128 a[144:147], v8 offset:7168
v_mfma_f32_16x16x32_bf16 v[64:67], a[180:183], a[76:79], v[64:67]
ds_read_b128 a[148:151], v8 offset:8192
v_mfma_f32_16x16x32_bf16 v[40:43], a[184:187], a[72:75], v[40:43]
ds_read_b128 a[152:155], v8 offset:9216
v_mfma_f32_16x16x32_bf16 v[68:71], a[184:187], a[76:79], v[68:71]
ds_read_b128 a[156:159], v8 offset:10240
v_mfma_f32_16x16x32_bf16 v[44:47], a[188:191], a[72:75], v[44:47]
ds_read_b128 a[160:163], v8 offset:11264
v_mfma_f32_16x16x32_bf16 v[72:75], a[188:191], a[76:79], v[72:75]
ds_read_b128 a[164:167], v8 offset:12288
v_mfma_f32_16x16x32_bf16 v[48:51], a[192:195], a[72:75], v[48:51]
ds_read_b128 a[168:171], v8 offset:13312
v_mfma_f32_16x16x32_bf16 v[76:79], a[192:195], a[76:79], v[76:79]
ds_read_b128 a[172:175], v125 offset:7168
v_mfma_f32_16x16x32_bf16 v[52:55], a[196:199], a[72:75], v[52:55]
ds_read_b128 a[176:179], v126 offset:10240
v_mfma_f32_16x16x32_bf16 v[80:83], a[196:199], a[76:79], v[80:83]
v_mfma_f32_16x16x32_bf16 v[56:59], a[200:203], a[72:75], v[56:59]
v_mfma_f32_16x16x32_bf16 v[84:87], a[200:203], a[76:79], v[84:87]
v_mfma_f32_16x16x32_bf16 v[60:63], a[204:207], a[72:75], v[60:63]
v_mfma_f32_16x16x32_bf16 v[88:91], a[204:207], a[76:79], v[88:91]
v_mfma_f32_16x16x32_bf16 v[92:95], a[208:211], a[212:215], v[92:95]
v_mfma_f32_16x16x32_bf16 v[96:99], a[196:199], a[212:215], v[96:99]
s_waitcnt lgkmcnt(0)
s_waitcnt vmcnt(14)
v_mfma_f32_16x16x32_bf16 v[36:39], a[144:147], a[80:83], v[36:39]
ds_read_b128 a[180:183], v8 offset:14336
v_mfma_f32_16x16x32_bf16 v[64:67], a[144:147], a[84:87], v[64:67]
ds_read_b128 a[184:187], v8 offset:15360
v_mfma_f32_16x16x32_bf16 v[40:43], a[148:151], a[80:83], v[40:43]
ds_read_b128 a[188:191], v8 offset:16384
v_mfma_f32_16x16x32_bf16 v[68:71], a[148:151], a[84:87], v[68:71]
ds_read_b128 a[192:195], v8 offset:17408
v_mfma_f32_16x16x32_bf16 v[44:47], a[152:155], a[80:83], v[44:47]
ds_read_b128 a[196:199], v8 offset:18432
v_mfma_f32_16x16x32_bf16 v[72:75], a[152:155], a[84:87], v[72:75]
ds_read_b128 a[200:203], v8 offset:19456
v_mfma_f32_16x16x32_bf16 v[48:51], a[156:159], a[80:83], v[48:51]
ds_read_b128 a[204:207], v8 offset:20480
v_mfma_f32_16x16x32_bf16 v[76:79], a[156:159], a[84:87], v[76:79]
ds_read_b128 a[208:211], v125 offset:14336
v_mfma_f32_16x16x32_bf16 v[52:55], a[160:163], a[80:83], v[52:55]
ds_read_b128 a[212:215], v126 offset:11264
v_mfma_f32_16x16x32_bf16 v[80:83], a[160:163], a[84:87], v[80:83]
v_mfma_f32_16x16x32_bf16 v[56:59], a[164:167], a[80:83], v[56:59]
v_mfma_f32_16x16x32_bf16 v[84:87], a[164:167], a[84:87], v[84:87]
v_mfma_f32_16x16x32_bf16 v[60:63], a[168:171], a[80:83], v[60:63]
v_mfma_f32_16x16x32_bf16 v[88:91], a[168:171], a[84:87], v[88:91]
v_mfma_f32_16x16x32_bf16 v[92:95], a[172:175], a[176:179], v[92:95]
v_mfma_f32_16x16x32_bf16 v[96:99], a[160:163], a[176:179], v[96:99]
s_waitcnt lgkmcnt(0)
s_waitcnt vmcnt(12)
v_mfma_f32_16x16x32_bf16 v[36:39], a[180:183], a[88:91], v[36:39]
ds_read_b128 a[144:147], v8 offset:21504
v_mfma_f32_16x16x32_bf16 v[64:67], a[180:183], a[92:95], v[64:67]
ds_read_b128 a[148:151], v8 offset:22528
v_mfma_f32_16x16x32_bf16 v[40:43], a[184:187], a[88:91], v[40:43]
ds_read_b128 a[152:155], v8 offset:23552
v_mfma_f32_16x16x32_bf16 v[68:71], a[184:187], a[92:95], v[68:71]
ds_read_b128 a[156:159], v8 offset:24576
v_mfma_f32_16x16x32_bf16 v[44:47], a[188:191], a[88:91], v[44:47]
ds_read_b128 a[160:163], v8 offset:25600
v_mfma_f32_16x16x32_bf16 v[72:75], a[188:191], a[92:95], v[72:75]
ds_read_b128 a[164:167], v8 offset:26624
v_mfma_f32_16x16x32_bf16 v[48:51], a[192:195], a[88:91], v[48:51]
ds_read_b128 a[168:171], v8 offset:27648
v_mfma_f32_16x16x32_bf16 v[76:79], a[192:195], a[92:95], v[76:79]
ds_read_b128 a[172:175], v125 offset:21504
v_mfma_f32_16x16x32_bf16 v[52:55], a[196:199], a[88:91], v[52:55]
ds_read_b128 a[176:179], v126 offset:12288
v_mfma_f32_16x16x32_bf16 v[80:83], a[196:199], a[92:95], v[80:83]
v_mfma_f32_16x16x32_bf16 v[56:59], a[200:203], a[88:91], v[56:59]
v_mfma_f32_16x16x32_bf16 v[84:87], a[200:203], a[92:95], v[84:87]
v_mfma_f32_16x16x32_bf16 v[60:63], a[204:207], a[88:91], v[60:63]
v_mfma_f32_16x16x32_bf16 v[88:91], a[204:207], a[92:95], v[88:91]
v_mfma_f32_16x16x32_bf16 v[92:95], a[208:211], a[212:215], v[92:95]
v_mfma_f32_16x16x32_bf16 v[96:99], a[196:199], a[212:215], v[96:99]
s_waitcnt lgkmcnt(0)
s_waitcnt vmcnt(10)
v_mfma_f32_16x16x32_bf16 v[36:39], a[144:147], a[96:99], v[36:39]
ds_read_b128 a[180:183], v8 offset:28672
v_mfma_f32_16x16x32_bf16 v[64:67], a[144:147], a[100:103], v[64:67]
ds_read_b128 a[184:187], v8 offset:29696
v_mfma_f32_16x16x32_bf16 v[40:43], a[148:151], a[96:99], v[40:43]
ds_read_b128 a[188:191], v8 offset:30720
v_mfma_f32_16x16x32_bf16 v[68:71], a[148:151], a[100:103], v[68:71]
ds_read_b128 a[192:195], v8 offset:31744
v_mfma_f32_16x16x32_bf16 v[44:47], a[152:155], a[96:99], v[44:47]
ds_read_b128 a[196:199], v8 offset:32768
v_mfma_f32_16x16x32_bf16 v[72:75], a[152:155], a[100:103], v[72:75]
ds_read_b128 a[200:203], v8 offset:33792
v_mfma_f32_16x16x32_bf16 v[48:51], a[156:159], a[96:99], v[48:51]
ds_read_b128 a[204:207], v8 offset:34816
v_mfma_f32_16x16x32_bf16 v[76:79], a[156:159], a[100:103], v[76:79]
ds_read_b128 a[208:211], v125 offset:28672
v_mfma_f32_16x16x32_bf16 v[52:55], a[160:163], a[96:99], v[52:55]
ds_read_b128 a[212:215], v126 offset:13312
v_mfma_f32_16x16x32_bf16 v[80:83], a[160:163], a[100:103], v[80:83]
v_mfma_f32_16x16x32_bf16 v[56:59], a[164:167], a[96:99], v[56:59]
v_mfma_f32_16x16x32_bf16 v[84:87], a[164:167], a[100:103], v[84:87]
v_mfma_f32_16x16x32_bf16 v[60:63], a[168:171], a[96:99], v[60:63]
v_mfma_f32_16x16x32_bf16 v[88:91], a[168:171], a[100:103], v[88:91]
v_mfma_f32_16x16x32_bf16 v[92:95], a[172:175], a[176:179], v[92:95]
v_mfma_f32_16x16x32_bf16 v[96:99], a[160:163], a[176:179], v[96:99]
s_waitcnt lgkmcnt(0)
s_waitcnt vmcnt(8)
v_mfma_f32_16x16x32_bf16 v[36:39], a[180:183], a[104:107], v[36:39]
ds_read_b128 a[144:147], v8 offset:35840
v_mfma_f32_16x16x32_bf16 v[64:67], a[180:183], a[108:111], v[64:67]
ds_read_b128 a[148:151], v8 offset:36864
v_mfma_f32_16x16x32_bf16 v[40:43], a[184:187], a[104:107], v[40:43]
ds_read_b128 a[152:155], v8 offset:37888
v_mfma_f32_16x16x32_bf16 v[68:71], a[184:187], a[108:111], v[68:71]
ds_read_b128 a[156:159], v8 offset:38912
v_mfma_f32_16x16x32_bf16 v[44:47], a[188:191], a[104:107], v[44:47]
ds_read_b128 a[160:163], v8 offset:39936
v_mfma_f32_16x16x32_bf16 v[72:75], a[188:191], a[108:111], v[72:75]
ds_read_b128 a[164:167], v8 offset:40960
v_mfma_f32_16x16x32_bf16 v[48:51], a[192:195], a[104:107], v[48:51]
ds_read_b128 a[168:171], v8 offset:41984
v_mfma_f32_16x16x32_bf16 v[76:79], a[192:195], a[108:111], v[76:79]
ds_read_b128 a[172:175], v125 offset:35840
v_mfma_f32_16x16x32_bf16 v[52:55], a[196:199], a[104:107], v[52:55]
ds_read_b128 a[176:179], v126 offset:14336
v_mfma_f32_16x16x32_bf16 v[80:83], a[196:199], a[108:111], v[80:83]
v_mfma_f32_16x16x32_bf16 v[56:59], a[200:203], a[104:107], v[56:59]
v_mfma_f32_16x16x32_bf16 v[84:87], a[200:203], a[108:111], v[84:87]
v_mfma_f32_16x16x32_bf16 v[60:63], a[204:207], a[104:107], v[60:63]
v_mfma_f32_16x16x32_bf16 v[88:91], a[204:207], a[108:111], v[88:91]
v_mfma_f32_16x16x32_bf16 v[92:95], a[208:211], a[212:215], v[92:95]
v_mfma_f32_16x16x32_bf16 v[96:99], a[196:199], a[212:215], v[96:99]
s_waitcnt lgkmcnt(0)
s_waitcnt vmcnt(6)
v_mfma_f32_16x16x32_bf16 v[36:39], a[144:147], a[112:115], v[36:39]
ds_read_b128 a[180:183], v8 offset:43008
v_mfma_f32_16x16x32_bf16 v[64:67], a[144:147], a[116:119], v[64:67]
ds_read_b128 a[184:187], v8 offset:44032
v_mfma_f32_16x16x32_bf16 v[40:43], a[148:151], a[112:115], v[40:43]
ds_read_b128 a[188:191], v8 offset:45056
v_mfma_f32_16x16x32_bf16 v[68:71], a[148:151], a[116:119], v[68:71]
ds_read_b128 a[192:195], v8 offset:46080
v_mfma_f32_16x16x32_bf16 v[44:47], a[152:155], a[112:115], v[44:47]
ds_read_b128 a[196:199], v8 offset:47104
v_mfma_f32_16x16x32_bf16 v[72:75], a[152:155], a[116:119], v[72:75]
ds_read_b128 a[200:203], v8 offset:48128
v_mfma_f32_16x16x32_bf16 v[48:51], a[156:159], a[112:115], v[48:51]
ds_read_b128 a[204:207], v8 offset:49152
v_mfma_f32_16x16x32_bf16 v[76:79], a[156:159], a[116:119], v[76:79]
ds_read_b128 a[208:211], v125 offset:43008
v_mfma_f32_16x16x32_bf16 v[52:55], a[160:163], a[112:115], v[52:55]
ds_read_b128 a[212:215], v126 offset:15360
v_mfma_f32_16x16x32_bf16 v[80:83], a[160:163], a[116:119], v[80:83]
v_mfma_f32_16x16x32_bf16 v[56:59], a[164:167], a[112:115], v[56:59]
v_mfma_f32_16x16x32_bf16 v[84:87], a[164:167], a[116:119], v[84:87]
v_mfma_f32_16x16x32_bf16 v[60:63], a[168:171], a[112:115], v[60:63]
v_mfma_f32_16x16x32_bf16 v[88:91], a[168:171], a[116:119], v[88:91]
v_mfma_f32_16x16x32_bf16 v[92:95], a[172:175], a[176:179], v[92:95]
v_mfma_f32_16x16x32_bf16 v[96:99], a[160:163], a[176:179], v[96:99]
s_waitcnt lgkmcnt(0)
s_waitcnt vmcnt(4)
v_mfma_f32_16x16x32_bf16 v[36:39], a[180:183], a[120:123], v[36:39]
ds_read_b128 a[144:147], v8 offset:50176
v_mfma_f32_16x16x32_bf16 v[64:67], a[180:183], a[124:127], v[64:67]
ds_read_b128 a[148:151], v8 offset:51200
v_mfma_f32_16x16x32_bf16 v[40:43], a[184:187], a[120:123], v[40:43]
ds_read_b128 a[152:155], v8 offset:52224
v_mfma_f32_16x16x32_bf16 v[68:71], a[184:187], a[124:127], v[68:71]
ds_read_b128 a[156:159], v8 offset:53248
v_mfma_f32_16x16x32_bf16 v[44:47], a[188:191], a[120:123], v[44:47]
ds_read_b128 a[160:163], v8 offset:54272
v_mfma_f32_16x16x32_bf16 v[72:75], a[188:191], a[124:127], v[72:75]
ds_read_b128 a[164:167], v8 offset:55296
v_mfma_f32_16x16x32_bf16 v[48:51], a[192:195], a[120:123], v[48:51]
ds_read_b128 a[168:171], v8 offset:56320
v_mfma_f32_16x16x32_bf16 v[76:79], a[192:195], a[124:127], v[76:79]
ds_read_b128 a[172:175], v125 offset:50176
v_mfma_f32_16x16x32_bf16 v[52:55], a[196:199], a[120:123], v[52:55]
ds_read_b128 a[176:179], v126 offset:16384
v_mfma_f32_16x16x32_bf16 v[80:83], a[196:199], a[124:127], v[80:83]
v_mfma_f32_16x16x32_bf16 v[56:59], a[200:203], a[120:123], v[56:59]
v_mfma_f32_16x16x32_bf16 v[84:87], a[200:203], a[124:127], v[84:87]
v_mfma_f32_16x16x32_bf16 v[60:63], a[204:207], a[120:123], v[60:63]
v_mfma_f32_16x16x32_bf16 v[88:91], a[204:207], a[124:127], v[88:91]
v_mfma_f32_16x16x32_bf16 v[92:95], a[208:211], a[212:215], v[92:95]
v_mfma_f32_16x16x32_bf16 v[96:99], a[196:199], a[212:215], v[96:99]
s_waitcnt lgkmcnt(0)
s_waitcnt vmcnt(2)
v_mfma_f32_16x16x32_bf16 v[36:39], a[144:147], a[128:131], v[36:39]
ds_read_b128 a[180:183], v8 offset:57344
v_mfma_f32_16x16x32_bf16 v[64:67], a[144:147], a[132:135], v[64:67]
ds_read_b128 a[184:187], v8 offset:58368
v_mfma_f32_16x16x32_bf16 v[40:43], a[148:151], a[128:131], v[40:43]
ds_read_b128 a[188:191], v8 offset:59392
v_mfma_f32_16x16x32_bf16 v[68:71], a[148:151], a[132:135], v[68:71]
ds_read_b128 a[192:195], v8 offset:60416
v_mfma_f32_16x16x32_bf16 v[44:47], a[152:155], a[128:131], v[44:47]
ds_read_b128 a[196:199], v8 offset:61440
v_mfma_f32_16x16x32_bf16 v[72:75], a[152:155], a[132:135], v[72:75]
ds_read_b128 a[200:203], v8 offset:62464
v_mfma_f32_16x16x32_bf16 v[48:51], a[156:159], a[128:131], v[48:51]
ds_read_b128 a[204:207], v8 offset:63488
v_mfma_f32_16x16x32_bf16 v[76:79], a[156:159], a[132:135], v[76:79]
ds_read_b128 a[208:211], v125 offset:57344
v_mfma_f32_16x16x32_bf16 v[52:55], a[160:163], a[128:131], v[52:55]
ds_read_b128 a[212:215], v126 offset:17408
v_mfma_f32_16x16x32_bf16 v[80:83], a[160:163], a[132:135], v[80:83]
v_mfma_f32_16x16x32_bf16 v[56:59], a[164:167], a[128:131], v[56:59]
v_mfma_f32_16x16x32_bf16 v[84:87], a[164:167], a[132:135], v[84:87]
v_mfma_f32_16x16x32_bf16 v[60:63], a[168:171], a[128:131], v[60:63]
v_mfma_f32_16x16x32_bf16 v[88:91], a[168:171], a[132:135], v[88:91]
v_mfma_f32_16x16x32_bf16 v[92:95], a[172:175], a[176:179], v[92:95]
v_mfma_f32_16x16x32_bf16 v[96:99], a[160:163], a[176:179], v[96:99]
s_waitcnt lgkmcnt(0)
s_waitcnt vmcnt(0)
v_mfma_f32_16x16x32_bf16 v[36:39], a[180:183], a[136:139], v[36:39]
ds_read_b64 a[216:217], v128 offset:0
v_mfma_f32_16x16x32_bf16 v[64:67], a[180:183], a[140:143], v[64:67]
ds_read_b64 a[218:219], v128 offset:512
v_mfma_f32_16x16x32_bf16 v[40:43], a[184:187], a[136:139], v[40:43]
ds_read_b64 a[220:221], v128 offset:1024
v_mfma_f32_16x16x32_bf16 v[68:71], a[184:187], a[140:143], v[68:71]
ds_read_b64 a[222:223], v128 offset:1536
v_mfma_f32_16x16x32_bf16 v[44:47], a[188:191], a[136:139], v[44:47]
ds_read_b64 a[224:225], v128 offset:2048
v_mfma_f32_16x16x32_bf16 v[72:75], a[188:191], a[140:143], v[72:75]
ds_read_b64 a[226:227], v128 offset:2560
v_mfma_f32_16x16x32_bf16 v[48:51], a[192:195], a[136:139], v[48:51]
ds_read_b64 a[228:229], v128 offset:3072
v_mfma_f32_16x16x32_bf16 v[76:79], a[192:195], a[140:143], v[76:79]
ds_read_b64 a[230:231], v129
v_mfma_f32_16x16x32_bf16 v[52:55], a[196:199], a[136:139], v[52:55]
v_mfma_f32_16x16x32_bf16 v[80:83], a[196:199], a[140:143], v[80:83]
v_mfma_f32_16x16x32_bf16 v[56:59], a[200:203], a[136:139], v[56:59]
v_mfma_f32_16x16x32_bf16 v[84:87], a[200:203], a[140:143], v[84:87]
v_mfma_f32_16x16x32_bf16 v[60:63], a[204:207], a[136:139], v[60:63]
v_mfma_f32_16x16x32_bf16 v[88:91], a[204:207], a[140:143], v[88:91]
v_mfma_f32_16x16x32_bf16 v[92:95], a[208:211], a[212:215], v[92:95]
v_mfma_f32_16x16x32_bf16 v[96:99], a[196:199], a[212:215], v[96:99]
s_waitcnt lgkmcnt(0)
v_mfma_f32_16x16x16_bf16 v[36:39], a[216:217], v[116:117], v[36:39]
v_mfma_f32_16x16x16_bf16 v[64:67], a[216:217], v[118:119], v[64:67]
v_mfma_f32_16x16x16_bf16 v[40:43], a[218:219], v[116:117], v[40:43]
v_mfma_f32_16x16x16_bf16 v[68:71], a[218:219], v[118:119], v[68:71]
v_mfma_f32_16x16x16_bf16 v[44:47], a[220:221], v[116:117], v[44:47]
v_mfma_f32_16x16x16_bf16 v[72:75], a[220:221], v[118:119], v[72:75]
v_mfma_f32_16x16x16_bf16 v[48:51], a[222:223], v[116:117], v[48:51]
v_mfma_f32_16x16x16_bf16 v[76:79], a[222:223], v[118:119], v[76:79]
v_mfma_f32_16x16x16_bf16 v[52:55], a[224:225], v[116:117], v[52:55]
v_mfma_f32_16x16x16_bf16 v[80:83], a[224:225], v[118:119], v[80:83]
v_mfma_f32_16x16x16_bf16 v[56:59], a[226:227], v[116:117], v[56:59]
v_mfma_f32_16x16x16_bf16 v[84:87], a[226:227], v[118:119], v[84:87]
v_mfma_f32_16x16x16_bf16 v[60:63], a[228:229], v[116:117], v[60:63]
v_mfma_f32_16x16x16_bf16 v[88:91], a[228:229], v[118:119], v[88:91]
v_mfma_f32_16x16x16_bf16 v[92:95], a[230:231], v[120:121], v[92:95]
v_mfma_f32_16x16x16_bf16 v[96:99], a[224:225], v[120:121], v[96:99]
s_barrier
s_lshl_b32 s30, s24, 5
v_add_u32 v6, s30, v2
v_mul_u32_u24 v210, 176, v6
v_add_u32 v210, 135168, v210
v_lshl_add_u32 v208, v3, 3, v210
v_mul_u32_u24 v209, 176, v2
v_lshl_add_u32 v209, v3, 3, v209
v_add_u32 v209, 135168, v209
v_add_u32 v8, s30, v209
v_lshrrev_b32 v6, 2, v2
v_lshl_add_u32 v6, v3, 2, v6
v_add_u32 v6, s30, v6
v_mul_u32_u24 v211, 176, v6
v_and_b32 v6, 3, v2
v_lshl_add_u32 v211, v6, 3, v211
v_add_u32 v211, 135168, v211
v_cvt_pk_bf16_f32 v152, v36, v37
v_cvt_pk_bf16_f32 v153, v38, v39
ds_write_b64 v208, v[152:153] offset:2816
v_cvt_pk_bf16_f32 v156, v40, v41
v_cvt_pk_bf16_f32 v157, v42, v43
ds_write_b64 v208, v[156:157] offset:2848
v_cvt_pk_bf16_f32 v198, v44, v45
v_cvt_pk_bf16_f32 v199, v46, v47
ds_write_b64 v208, v[198:199] offset:2880
v_cvt_pk_bf16_f32 v200, v48, v49
v_cvt_pk_bf16_f32 v201, v50, v51
ds_write_b64 v208, v[200:201] offset:2912
v_cvt_pk_bf16_f32 v202, v52, v53
v_cvt_pk_bf16_f32 v203, v54, v55
ds_write_b64 v208, v[202:203] offset:2944
v_cvt_pk_bf16_f32 v164, v56, v57
v_cvt_pk_bf16_f32 v165, v58, v59
v_cvt_pk_bf16_f32 v170, v60, v61
v_cvt_pk_bf16_f32 v171, v62, v63
v_cndmask_b32 v166, 0, v202, s[48:49]
v_mov_b32 v167, 0
v_mov_b32 v168, 0
v_cndmask_b32 v169, 0, v203, s[48:49]
v_cvt_pk_bf16_f32 v158, v64, v65
v_cvt_pk_bf16_f32 v159, v66, v67
ds_write_b64 v208, v[158:159] offset:5632
v_cvt_pk_bf16_f32 v162, v68, v69
v_cvt_pk_bf16_f32 v163, v70, v71
ds_write_b64 v208, v[162:163] offset:5664
v_cvt_pk_bf16_f32 v198, v72, v73
v_cvt_pk_bf16_f32 v199, v74, v75
ds_write_b64 v208, v[198:199] offset:5696
v_cvt_pk_bf16_f32 v200, v76, v77
v_cvt_pk_bf16_f32 v201, v78, v79
ds_write_b64 v208, v[200:201] offset:5728
v_cvt_pk_bf16_f32 v202, v80, v81
v_cvt_pk_bf16_f32 v203, v82, v83
ds_write_b64 v208, v[202:203] offset:5760
v_cvt_pk_bf16_f32 v172, v84, v85
v_cvt_pk_bf16_f32 v173, v86, v87
v_cvt_pk_bf16_f32 v178, v88, v89
v_cvt_pk_bf16_f32 v179, v90, v91
v_cndmask_b32 v174, 0, v202, s[48:49]
v_mov_b32 v175, 0
v_mov_b32 v176, 0
v_cndmask_b32 v177, 0, v203, s[48:49]
v_cvt_pk_bf16_f32 v204, v92, v93
v_cvt_pk_bf16_f32 v205, v94, v95
ds_write_b64 v8, v[204:205]
v_cvt_pk_bf16_f32 v206, v96, v97
v_cvt_pk_bf16_f32 v207, v98, v99
ds_write_b64 v209, v[206:207] offset:128
s_waitcnt lgkmcnt(0)
s_barrier
ds_read_b64 v[146:147], v208
ds_read_b64 v[150:151], v208 offset:32
ds_read_b64 v[148:149], v210 offset:136
ds_read_b64 v[154:155], v210 offset:2952
ds_read_b64 v[160:161], v210 offset:5768
ds_read_b64_tr_b16 v[180:181], v211 offset:64
ds_read_b64_tr_b16 v[182:183], v211 offset:2880
ds_read_b64_tr_b16 v[184:185], v211 offset:5696
ds_read_b64_tr_b16 v[186:187], v211 offset:96
ds_read_b64_tr_b16 v[188:189], v211 offset:2912
ds_read_b64_tr_b16 v[190:191], v211 offset:5728
ds_read_b64_tr_b16 v[192:193], v211 offset:128
ds_read_b64_tr_b16 v[194:195], v211 offset:2944
ds_read_b64_tr_b16 v[196:197], v211 offset:5760
s_waitcnt lgkmcnt(9)
v_mfma_f32_16x16x32_bf16 v[36:39], v[146:149], v[164:167], 0
v_mfma_f32_16x16x32_bf16 v[40:43], v[152:155], v[164:167], 0
v_mfma_f32_16x16x32_bf16 v[44:47], v[148:151], v[168:171], 0
v_mfma_f32_16x16x32_bf16 v[48:51], v[154:157], v[168:171], 0
v_mfma_f32_16x16x32_bf16 v[52:55], v[152:155], v[172:175], 0
v_mfma_f32_16x16x32_bf16 v[56:59], v[158:161], v[172:175], 0
v_mfma_f32_16x16x32_bf16 v[60:63], v[154:157], v[176:179], 0
v_mfma_f32_16x16x32_bf16 v[64:67], v[160:163], v[176:179], 0
s_nop 1
v_cndmask_b32 v36, v36, v37, s[40:41]
v_cndmask_b32 v40, v40, v41, s[40:41]
v_cndmask_b32 v36, v36, v40, s[42:43]
v_fma_f32 v68, v36, v140, v144
v_cndmask_b32 v38, v38, v39, s[40:41]
v_cndmask_b32 v42, v42, v43, s[40:41]
v_cndmask_b32 v38, v38, v42, s[44:45]
v_fma_f32 v69, v38, v141, v145
v_max_f32 v76, v68, v69
v_cndmask_b32 v44, v44, v45, s[40:41]
v_cndmask_b32 v48, v48, v49, s[40:41]
v_cndmask_b32 v44, v44, v48, s[42:43]
v_fma_f32 v70, v44, v140, v144
v_cndmask_b32 v46, v46, v47, s[40:41]
v_cndmask_b32 v50, v50, v51, s[40:41]
v_cndmask_b32 v46, v46, v50, s[44:45]
v_fma_f32 v71, v46, v141, v145
v_max_f32 v77, v70, v71
v_cndmask_b32 v52, v52, v53, s[40:41]
v_cndmask_b32 v56, v56, v57, s[40:41]
v_cndmask_b32 v52, v52, v56, s[42:43]
v_mul_f32 v72, v52, v142
v_cndmask_b32 v54, v54, v55, s[40:41]
v_cndmask_b32 v58, v58, v59, s[40:41]
v_cndmask_b32 v54, v54, v58, s[44:45]
v_mul_f32 v73, v54, v143
v_max_f32 v78, v72, v73
v_cndmask_b32 v60, v60, v61, s[40:41]
v_cndmask_b32 v64, v64, v65, s[40:41]
v_cndmask_b32 v60, v60, v64, s[42:43]
v_mul_f32 v74, v60, v142
v_cndmask_b32 v62, v62, v63, s[40:41]
v_cndmask_b32 v66, v66, v67, s[40:41]
v_cndmask_b32 v62, v62, v66, s[44:45]
v_mul_f32 v75, v62, v143
v_max_f32 v79, v74, v75
s_nop 1
v_permlane32_swap_b32 v76, v77
v_permlane32_swap_b32 v78, v79
v_max_f32 v76, v76, v77
v_max_f32 v78, v78, v79
s_nop 1
v_permlane16_swap_b32 v76, v78
v_max_f32 v76, v76, v78
v_mov_b32 v78, v76
s_nop 1
v_permlane16_swap_b32 v76, v78
v_mov_b32 v77, v76
v_mov_b32 v79, v78
s_nop 0
v_permlane32_swap_b32 v76, v77
v_permlane32_swap_b32 v78, v79
v_sub_f32 v68, v68, v76
v_sub_f32 v69, v69, v76
v_sub_f32 v70, v70, v77
v_sub_f32 v71, v71, v77
v_sub_f32 v72, v72, v78
v_sub_f32 v73, v73, v78
v_sub_f32 v74, v74, v79
v_sub_f32 v75, v75, v79
v_exp_f32 v68, v68
v_exp_f32 v69, v69
v_exp_f32 v70, v70
v_exp_f32 v71, v71
v_exp_f32 v72, v72
v_exp_f32 v73, v73
v_exp_f32 v74, v74
v_exp_f32 v75, v75
v_add_f32 v76, v68, v69
v_add_f32 v77, v70, v71
v_add_f32 v78, v72, v73
v_add_f32 v79, v74, v75
v_mul_f32 v68, v68, v136
v_mul_f32 v69, v69, v137
v_mul_f32 v70, v70, v136
v_mul_f32 v71, v71, v137
v_mul_f32 v72, v72, v138
v_mul_f32 v73, v73, v139
v_mul_f32 v74, v74, v138
v_mul_f32 v75, v75, v139
s_nop 1
v_permlane32_swap_b32 v76, v77
v_permlane32_swap_b32 v78, v79
v_add_f32 v76, v76, v77
v_add_f32 v78, v78, v79
s_nop 1
v_permlane16_swap_b32 v76, v78
v_add_f32 v76, v76, v78
v_rcp_f32 v76, v76
s_nop 0
v_mov_b32 v78, v76
s_nop 1
v_permlane16_swap_b32 v76, v78
v_mov_b32 v77, v76
v_mov_b32 v79, v78
s_nop 0
v_permlane32_swap_b32 v76, v77
v_permlane32_swap_b32 v78, v79
v_mul_f32 v68, v68, v76
v_mul_f32 v69, v69, v76
v_mul_f32 v70, v70, v77
v_mul_f32 v71, v71, v77
v_mul_f32 v72, v72, v78
v_mul_f32 v73, v73, v78
v_mul_f32 v74, v74, v79
v_mul_f32 v75, v75, v79
v_cvt_pk_bf16_f32 v68, v68, v69
v_perm_b32 v84, v68, v68, v10
v_perm_b32 v85, v68, v68, v11
v_perm_b32 v86, v68, v68, v12
v_perm_b32 v87, v68, v68, v13
v_cvt_pk_bf16_f32 v70, v70, v71
v_perm_b32 v88, v70, v70, v10
v_perm_b32 v89, v70, v70, v11
v_perm_b32 v90, v70, v70, v12
v_perm_b32 v91, v70, v70, v13
v_cvt_pk_bf16_f32 v72, v72, v73
v_perm_b32 v92, v72, v72, v10
v_perm_b32 v93, v72, v72, v11
v_perm_b32 v94, v72, v72, v12
v_perm_b32 v95, v72, v72, v13
v_cvt_pk_bf16_f32 v74, v74, v75
v_perm_b32 v96, v74, v74, v10
v_perm_b32 v97, v74, v74, v11
v_perm_b32 v98, v74, v74, v12
v_perm_b32 v99, v74, v74, v13
s_waitcnt lgkmcnt(0)
v_mfma_f32_16x16x32_bf16 v[36:39], v[180:183], v[84:87], 0
v_mfma_f32_16x16x32_bf16 v[40:43], v[192:195], v[84:87], 0
v_mfma_f32_16x16x32_bf16 v[44:47], v[186:189], v[88:91], 0
v_mfma_f32_16x16x32_bf16 v[48:51], v[192:195], v[88:91], 0
v_mfma_f32_16x16x32_bf16 v[52:55], v[182:185], v[92:95], 0
v_mfma_f32_16x16x32_bf16 v[56:59], v[194:197], v[92:95], 0
v_mfma_f32_16x16x32_bf16 v[60:63], v[188:191], v[96:99], 0
v_mfma_f32_16x16x32_bf16 v[64:67], v[194:197], v[96:99], 0
s_lshr_b32 s30, s26, 1
s_mul_i32 s30, s30, 2304
s_mul_i32 s31, s60, 18432
s_add_u32 s30, s30, s31
s_add_u32 s30, s30, 2490368
s_and_b32 s32, s26, 1
s_lshl_b32 s31, s32, 10
s_add_u32 s31, s31, s30
s_lshl_b32 s32, s32, 3
s_add_u32 s32, s32, s30
v_mov_b32 v6, 1073741824
v_cndmask_b32 v6, v6, v1, s[46:47]
v_add_u32 v7, 18432, v6
v_cvt_pk_bf16_f32 v164, v36, v37
v_cvt_pk_bf16_f32 v165, v38, v39
v_cvt_pk_bf16_f32 v166, v44, v45
v_cvt_pk_bf16_f32 v167, v46, v47
v_cvt_pk_bf16_f32 v168, v40, v41
v_cvt_pk_bf16_f32 v169, v50, v51
buffer_store_dwordx4 v[164:167], v1, s[8:11], s31 offen sc1
buffer_store_dwordx2 v[168:169], v6, s[8:11], s32 offen offset:2048 sc1
v_cvt_pk_bf16_f32 v172, v52, v53
v_cvt_pk_bf16_f32 v173, v54, v55
v_cvt_pk_bf16_f32 v174, v60, v61
v_cvt_pk_bf16_f32 v175, v62, v63
v_cvt_pk_bf16_f32 v176, v56, v57
v_cvt_pk_bf16_f32 v177, v66, v67
buffer_store_dwordx4 v[172:175], v127, s[8:11], s31 offen sc1
buffer_store_dwordx2 v[176:177], v7, s[8:11], s32 offen offset:2048 sc1
s_waitcnt vmcnt(0)
s_barrier
s_cmp_eq_u32 s24, 0
s_cbranch_scc0 L_sig_1
v_lshlrev_b32 v6, 3, v1
s_lshl_b32 s31, s25, 11
s_lshl_b32 s32, s26, 2
s_add_u32 s31, s31, s32
v_add_u32 v6, s31, v6
s_mov_b64 exec, 0xffff
s_mov_b32 s30, 26476544
buffer_store_dword v4, v6, s[8:11], s30 offen sc1
s_mov_b64 exec, -1
L_sig_1:
s_mul_i32 s30, s28, 82944
s_add_u32 s30, s30, 2121728
s_mul_i32 s38, s24, 21504
s_add_u32 s39, s38, s30
s_add_u32 m0, s38, 0
s_nop 0
buffer_load_dwordx4 v1, s[4:7], s39 offen offset:0  lds
buffer_load_dwordx4 v1, s[4:7], s39 offen offset:1024  lds
buffer_load_dwordx4 v1, s[4:7], s39 offen offset:2048  lds
buffer_load_dwordx4 v1, s[4:7], s39 offen offset:3072  lds
s_add_u32 m0, m0, 4096
s_add_u32 s39, s39, 4096
buffer_load_dwordx4 v1, s[4:7], s39 offen offset:0  lds
buffer_load_dwordx4 v1, s[4:7], s39 offen offset:1024  lds
buffer_load_dwordx4 v1, s[4:7], s39 offen offset:2048  lds
buffer_load_dwordx4 v1, s[4:7], s39 offen offset:3072  lds
s_add_u32 m0, m0, 4096
s_add_u32 s39, s39, 4096
buffer_load_dwordx4 v1, s[4:7], s39 offen offset:0  lds
buffer_load_dwordx4 v1, s[4:7], s39 offen offset:1024  lds
buffer_load_dwordx4 v1, s[4:7], s39 offen offset:2048  lds
buffer_load_dwordx4 v1, s[4:7], s39 offen offset:3072  lds
s_add_u32 m0, m0, 4096
s_add_u32 s39, s39, 4096
buffer_load_dwordx4 v1, s[4:7], s39 offen offset:0  lds
buffer_load_dwordx4 v1, s[4:7], s39 offen offset:1024  lds
buffer_load_dwordx4 v1, s[4:7], s39 offen offset:2048  lds
buffer_load_dwordx4 v1, s[4:7], s39 offen offset:3072  lds
s_add_u32 m0, m0, 4096
s_add_u32 s39, s39, 4096
buffer_load_dwordx4 v1, s[4:7], s39 offen offset:0  lds
buffer_load_dwordx4 v1, s[4:7], s39 offen offset:1024  lds
buffer_load_dwordx4 v1, s[4:7], s39 offen offset:2048  lds
buffer_load_dwordx4 v1, s[4:7], s39 offen offset:3072  lds
s_add_u32 m0, m0, 4096
s_add_u32 s39, s39, 4096
buffer_load_dwordx4 v1, s[4:7], s39 offen offset:0  lds
s_cmp_eq_u32 s24, 1
s_cbranch_scc0 L_polled_3
s_lshl_b32 s30, s81, 7
s_add_u32 s30, s30, 26476544
v_lshrrev_b32 v6, 2, v1
s_mov_b32 s31, 0
s_mov_b64 exec, 0xffff
L_poll_2:
buffer_load_dword v7, v6, s[8:11], s30 offen sc1
s_add_u32 s31, s31, 1
s_waitcnt vmcnt(0)
v_cmp_ne_u32 vcc, 1, v7
s_cmp_gt_u32 s31, 200000
s_cbranch_scc1 L_polled_3
s_cbranch_vccnz L_poll_2
L_polled_3:
s_mov_b64 exec, -1
s_waitcnt vmcnt(0)
s_barrier
s_lshl_b32 s30, s27, 2
s_add_u32 s30, s30, s24
s_mul_i32 s30, s30, 18432
s_add_u32 s30, s30, 2490368
buffer_load_dwordx4 a[0:3], v1, s[8:11], s30 offen offset:0 sc1
buffer_load_dwordx4 a[4:7], v1, s[8:11], s30 offen offset:1024 sc1
buffer_load_dwordx4 a[8:11], v1, s[8:11], s30 offen offset:2048 sc1
buffer_load_dwordx4 a[12:15], v1, s[8:11], s30 offen offset:3072 sc1
s_add_u32 s30, s30, 4096
buffer_load_dwordx4 a[16:19], v1, s[8:11], s30 offen offset:0 sc1
buffer_load_dwordx4 a[20:23], v1, s[8:11], s30 offen offset:1024 sc1
buffer_load_dwordx4 a[24:27], v1, s[8:11], s30 offen offset:2048 sc1
buffer_load_dwordx4 a[28:31], v1, s[8:11], s30 offen offset:3072 sc1
s_add_u32 s30, s30, 4096
buffer_load_dwordx4 a[32:35], v1, s[8:11], s30 offen offset:0 sc1
buffer_load_dwordx4 a[36:39], v1, s[8:11], s30 offen offset:1024 sc1
buffer_load_dwordx4 a[40:43], v1, s[8:11], s30 offen offset:2048 sc1
buffer_load_dwordx4 a[44:47], v1, s[8:11], s30 offen offset:3072 sc1
s_add_u32 s30, s30, 4096
buffer_load_dwordx4 a[48:51], v1, s[8:11], s30 offen offset:0 sc1
buffer_load_dwordx4 a[52:55], v1, s[8:11], s30 offen offset:1024 sc1
buffer_load_dwordx4 a[56:59], v1, s[8:11], s30 offen offset:2048 sc1
buffer_load_dwordx4 a[60:63], v1, s[8:11], s30 offen offset:3072 sc1
s_add_u32 s30, s30, 4096
buffer_load_dwordx4 a[64:67], v1, s[8:11], s30 offen offset:0 sc1
buffer_load_dwordx4 a[68:71], v1, s[8:11], s30 offen offset:1024 sc1
v_and_b32 v108, 7, v2
v_lshlrev_b32 v108, 4, v108
v_lshl_add_u32 v108, v3, 7, v108
v_add_u32 v108, 4096, v108
v_add_u32 v109, 41472, v1
v_add_u32 v110, 41472, v108
ds_read_b128 a[72:75], v1 offset:0
ds_read_b128 a[76:79], v1 offset:1024
ds_read_b128 a[80:83], v1 offset:2048
ds_read_b128 a[84:87], v1 offset:3072
ds_read_b128 a[88:91], v108 offset:0
ds_read_b128 a[92:95], v1 offset:4608
ds_read_b128 a[96:99], v1 offset:5632
ds_read_b128 a[100:103], v1 offset:6656
ds_read_b128 a[104:107], v1 offset:7680
ds_read_b128 a[108:111], v108 offset:4608
s_waitcnt vmcnt(17)
s_waitcnt lgkmcnt(5)
v_mfma_f32_16x16x32_bf16 v[16:19], a[72:75], a[0:3], v[16:19]
ds_read_b128 a[112:115], v1 offset:9216
v_mfma_f32_16x16x32_bf16 v[20:23], a[76:79], a[0:3], v[20:23]
ds_read_b128 a[116:119], v1 offset:10240
v_mfma_f32_16x16x32_bf16 v[24:27], a[80:83], a[0:3], v[24:27]
ds_read_b128 a[120:123], v1 offset:11264
v_mfma_f32_16x16x32_bf16 v[28:31], a[84:87], a[0:3], v[28:31]
ds_read_b128 a[124:127], v1 offset:12288
v_mfma_f32_16x16x32_bf16 v[32:35], a[88:91], a[0:3], v[32:35]
ds_read_b128 a[128:131], v108 offset:9216
s_waitcnt vmcnt(16)
s_waitcnt lgkmcnt(5)
v_mfma_f32_16x16x32_bf16 v[16:19], a[92:95], a[4:7], v[16:19]
ds_read_b128 a[72:75], v1 offset:13824
v_mfma_f32_16x16x32_bf16 v[20:23], a[96:99], a[4:7], v[20:23]
ds_read_b128 a[76:79], v1 offset:14848
v_mfma_f32_16x16x32_bf16 v[24:27], a[100:103], a[4:7], v[24:27]
ds_read_b128 a[80:83], v1 offset:15872
v_mfma_f32_16x16x32_bf16 v[28:31], a[104:107], a[4:7], v[28:31]
ds_read_b128 a[84:87], v1 offset:16896
v_mfma_f32_16x16x32_bf16 v[32:35], a[108:111], a[4:7], v[32:35]
ds_read_b128 a[88:91], v108 offset:13824
s_waitcnt vmcnt(15)
s_waitcnt lgkmcnt(5)
v_mfma_f32_16x16x32_bf16 v[16:19], a[112:115], a[8:11], v[16:19]
ds_read_b128 a[92:95], v1 offset:18432
v_mfma_f32_16x16x32_bf16 v[20:23], a[116:119], a[8:11], v[20:23]
ds_read_b128 a[96:99], v1 offset:19456
v_mfma_f32_16x16x32_bf16 v[24:27], a[120:123], a[8:11], v[24:27]
ds_read_b128 a[100:103], v1 offset:20480
v_mfma_f32_16x16x32_bf16 v[28:31], a[124:127], a[8:11], v[28:31]
ds_read_b128 a[104:107], v1 offset:21504
v_mfma_f32_16x16x32_bf16 v[32:35], a[128:131], a[8:11], v[32:35]
ds_read_b128 a[108:111], v108 offset:18432
s_waitcnt vmcnt(14)
s_waitcnt lgkmcnt(5)
v_mfma_f32_16x16x32_bf16 v[16:19], a[72:75], a[12:15], v[16:19]
ds_read_b128 a[112:115], v1 offset:23040
v_mfma_f32_16x16x32_bf16 v[20:23], a[76:79], a[12:15], v[20:23]
ds_read_b128 a[116:119], v1 offset:24064
v_mfma_f32_16x16x32_bf16 v[24:27], a[80:83], a[12:15], v[24:27]
ds_read_b128 a[120:123], v1 offset:25088
v_mfma_f32_16x16x32_bf16 v[28:31], a[84:87], a[12:15], v[28:31]
ds_read_b128 a[124:127], v1 offset:26112
v_mfma_f32_16x16x32_bf16 v[32:35], a[88:91], a[12:15], v[32:35]
ds_read_b128 a[128:131], v108 offset:23040
s_waitcnt vmcnt(13)
s_waitcnt lgkmcnt(5)
v_mfma_f32_16x16x32_bf16 v[16:19], a[92:95], a[16:19], v[16:19]
ds_read_b128 a[72:75], v1 offset:27648
v_mfma_f32_16x16x32_bf16 v[20:23], a[96:99], a[16:19], v[20:23]
ds_read_b128 a[76:79], v1 offset:28672
v_mfma_f32_16x16x32_bf16 v[24:27], a[100:103], a[16:19], v[24:27]
ds_read_b128 a[80:83], v1 offset:29696
v_mfma_f32_16x16x32_bf16 v[28:31], a[104:107], a[16:19], v[28:31]
ds_read_b128 a[84:87], v1 offset:30720
v_mfma_f32_16x16x32_bf16 v[32:35], a[108:111], a[16:19], v[32:35]
ds_read_b128 a[88:91], v108 offset:27648
s_waitcnt vmcnt(12)
s_waitcnt lgkmcnt(5)
v_mfma_f32_16x16x32_bf16 v[16:19], a[112:115], a[20:23], v[16:19]
ds_read_b128 a[92:95], v1 offset:32256
v_mfma_f32_16x16x32_bf16 v[20:23], a[116:119], a[20:23], v[20:23]
ds_read_b128 a[96:99], v1 offset:33280
v_mfma_f32_16x16x32_bf16 v[24:27], a[120:123], a[20:23], v[24:27]
ds_read_b128 a[100:103], v1 offset:34304
v_mfma_f32_16x16x32_bf16 v[28:31], a[124:127], a[20:23], v[28:31]
ds_read_b128 a[104:107], v1 offset:35328
v_mfma_f32_16x16x32_bf16 v[32:35], a[128:131], a[20:23], v[32:35]
ds_read_b128 a[108:111], v108 offset:32256
s_waitcnt vmcnt(11)
s_waitcnt lgkmcnt(5)
v_mfma_f32_16x16x32_bf16 v[16:19], a[72:75], a[24:27], v[16:19]
ds_read_b128 a[112:115], v1 offset:36864
v_mfma_f32_16x16x32_bf16 v[20:23], a[76:79], a[24:27], v[20:23]
ds_read_b128 a[116:119], v1 offset:37888
v_mfma_f32_16x16x32_bf16 v[24:27], a[80:83], a[24:27], v[24:27]
ds_read_b128 a[120:123], v1 offset:38912
v_mfma_f32_16x16x32_bf16 v[28:31], a[84:87], a[24:27], v[28:31]
ds_read_b128 a[124:127], v1 offset:39936
v_mfma_f32_16x16x32_bf16 v[32:35], a[88:91], a[24:27], v[32:35]
ds_read_b128 a[128:131], v108 offset:36864
s_waitcnt vmcnt(10)
s_waitcnt lgkmcnt(5)
v_mfma_f32_16x16x32_bf16 v[16:19], a[92:95], a[28:31], v[16:19]
ds_read_b128 a[72:75], v109 offset:0
v_mfma_f32_16x16x32_bf16 v[20:23], a[96:99], a[28:31], v[20:23]
ds_read_b128 a[76:79], v109 offset:1024
v_mfma_f32_16x16x32_bf16 v[24:27], a[100:103], a[28:31], v[24:27]
ds_read_b128 a[80:83], v109 offset:2048
v_mfma_f32_16x16x32_bf16 v[28:31], a[104:107], a[28:31], v[28:31]
ds_read_b128 a[84:87], v109 offset:3072
v_mfma_f32_16x16x32_bf16 v[32:35], a[108:111], a[28:31], v[32:35]
ds_read_b128 a[88:91], v110 offset:0
s_waitcnt vmcnt(9)
s_waitcnt lgkmcnt(5)
v_mfma_f32_16x16x32_bf16 v[16:19], a[112:115], a[32:35], v[16:19]
ds_read_b128 a[92:95], v109 offset:4608
v_mfma_f32_16x16x32_bf16 v[20:23], a[116:119], a[32:35], v[20:23]
ds_read_b128 a[96:99], v109 offset:5632
v_mfma_f32_16x16x32_bf16 v[24:27], a[120:123], a[32:35], v[24:27]
ds_read_b128 a[100:103], v109 offset:6656
v_mfma_f32_16x16x32_bf16 v[28:31], a[124:127], a[32:35], v[28:31]
ds_read_b128 a[104:107], v109 offset:7680
v_mfma_f32_16x16x32_bf16 v[32:35], a[128:131], a[32:35], v[32:35]
ds_read_b128 a[108:111], v110 offset:4608
s_waitcnt vmcnt(8)
s_waitcnt lgkmcnt(5)
v_mfma_f32_16x16x32_bf16 v[16:19], a[72:75], a[36:39], v[16:19]
ds_read_b128 a[112:115], v109 offset:9216
v_mfma_f32_16x16x32_bf16 v[20:23], a[76:79], a[36:39], v[20:23]
ds_read_b128 a[116:119], v109 offset:10240
v_mfma_f32_16x16x32_bf16 v[24:27], a[80:83], a[36:39], v[24:27]
ds_read_b128 a[120:123], v109 offset:11264
v_mfma_f32_16x16x32_bf16 v[28:31], a[84:87], a[36:39], v[28:31]
ds_read_b128 a[124:127], v109 offset:12288
v_mfma_f32_16x16x32_bf16 v[32:35], a[88:91], a[36:39], v[32:35]
ds_read_b128 a[128:131], v110 offset:9216
s_waitcnt vmcnt(7)
s_waitcnt lgkmcnt(5)
v_mfma_f32_16x16x32_bf16 v[16:19], a[92:95], a[40:43], v[16:19]
ds_read_b128 a[72:75], v109 offset:13824
v_mfma_f32_16x16x32_bf16 v[20:23], a[96:99], a[40:43], v[20:23]
ds_read_b128 a[76:79], v109 offset:14848
v_mfma_f32_16x16x32_bf16 v[24:27], a[100:103], a[40:43], v[24:27]
ds_read_b128 a[80:83], v109 offset:15872
v_mfma_f32_16x16x32_bf16 v[28:31], a[104:107], a[40:43], v[28:31]
ds_read_b128 a[84:87], v109 offset:16896
v_mfma_f32_16x16x32_bf16 v[32:35], a[108:111], a[40:43], v[32:35]
ds_read_b128 a[88:91], v110 offset:13824
s_waitcnt vmcnt(6)
s_waitcnt lgkmcnt(5)
v_mfma_f32_16x16x32_bf16 v[16:19], a[112:115], a[44:47], v[16:19]
ds_read_b128 a[92:95], v109 offset:18432
v_mfma_f32_16x16x32_bf16 v[20:23], a[116:119], a[44:47], v[20:23]
ds_read_b128 a[96:99], v109 offset:19456
v_mfma_f32_16x16x32_bf16 v[24:27], a[120:123], a[44:47], v[24:27]
ds_read_b128 a[100:103], v109 offset:20480
v_mfma_f32_16x16x32_bf16 v[28:31], a[124:127], a[44:47], v[28:31]
ds_read_b128 a[104:107], v109 offset:21504
v_mfma_f32_16x16x32_bf16 v[32:35], a[128:131], a[44:47], v[32:35]
ds_read_b128 a[108:111], v110 offset:18432
s_waitcnt vmcnt(5)
s_waitcnt lgkmcnt(5)
v_mfma_f32_16x16x32_bf16 v[16:19], a[72:75], a[48:51], v[16:19]
ds_read_b128 a[112:115], v109 offset:23040
v_mfma_f32_16x16x32_bf16 v[20:23], a[76:79], a[48:51], v[20:23]
ds_read_b128 a[116:119], v109 offset:24064
v_mfma_f32_16x16x32_bf16 v[24:27], a[80:83], a[48:51], v[24:27]
ds_read_b128 a[120:123], v109 offset:25088
v_mfma_f32_16x16x32_bf16 v[28:31], a[84:87], a[48:51], v[28:31]
ds_read_b128 a[124:127], v109 offset:26112
v_mfma_f32_16x16x32_bf16 v[32:35], a[88:91], a[48:51], v[32:35]
ds_read_b128 a[128:131], v110 offset:23040
s_waitcnt vmcnt(4)
s_waitcnt lgkmcnt(5)
v_mfma_f32_16x16x32_bf16 v[16:19], a[92:95], a[52:55], v[16:19]
ds_read_b128 a[72:75], v109 offset:27648
v_mfma_f32_16x16x32_bf16 v[20:23], a[96:99], a[52:55], v[20:23]
ds_read_b128 a[76:79], v109 offset:28672
v_mfma_f32_16x16x32_bf16 v[24:27], a[100:103], a[52:55], v[24:27]
ds_read_b128 a[80:83], v109 offset:29696
v_mfma_f32_16x16x32_bf16 v[28:31], a[104:107], a[52:55], v[28:31]
ds_read_b128 a[84:87], v109 offset:30720
v_mfma_f32_16x16x32_bf16 v[32:35], a[108:111], a[52:55], v[32:35]
ds_read_b128 a[88:91], v110 offset:27648
s_waitcnt vmcnt(3)
s_waitcnt lgkmcnt(5)
v_mfma_f32_16x16x32_bf16 v[16:19], a[112:115], a[56:59], v[16:19]
ds_read_b128 a[92:95], v109 offset:32256
v_mfma_f32_16x16x32_bf16 v[20:23], a[116:119], a[56:59], v[20:23]
ds_read_b128 a[96:99], v109 offset:33280
v_mfma_f32_16x16x32_bf16 v[24:27], a[120:123], a[56:59], v[24:27]
ds_read_b128 a[100:103], v109 offset:34304
v_mfma_f32_16x16x32_bf16 v[28:31], a[124:127], a[56:59], v[28:31]
ds_read_b128 a[104:107], v109 offset:35328
v_mfma_f32_16x16x32_bf16 v[32:35], a[128:131], a[56:59], v[32:35]
ds_read_b128 a[108:111], v110 offset:32256
s_waitcnt vmcnt(2)
s_waitcnt lgkmcnt(5)
v_mfma_f32_16x16x32_bf16 v[16:19], a[72:75], a[60:63], v[16:19]
ds_read_b128 a[112:115], v109 offset:36864
v_mfma_f32_16x16x32_bf16 v[20:23], a[76:79], a[60:63], v[20:23]
ds_read_b128 a[116:119], v109 offset:37888
v_mfma_f32_16x16x32_bf16 v[24:27], a[80:83], a[60:63], v[24:27]
ds_read_b128 a[120:123], v109 offset:38912
v_mfma_f32_16x16x32_bf16 v[28:31], a[84:87], a[60:63], v[28:31]
ds_read_b128 a[124:127], v109 offset:39936
v_mfma_f32_16x16x32_bf16 v[32:35], a[88:91], a[60:63], v[32:35]
ds_read_b128 a[128:131], v110 offset:36864
s_waitcnt vmcnt(1)
s_waitcnt lgkmcnt(5)
v_mfma_f32_16x16x32_bf16 v[16:19], a[92:95], a[64:67], v[16:19]
v_mfma_f32_16x16x32_bf16 v[20:23], a[96:99], a[64:67], v[20:23]
v_mfma_f32_16x16x32_bf16 v[24:27], a[100:103], a[64:67], v[24:27]
v_mfma_f32_16x16x32_bf16 v[28:31], a[104:107], a[64:67], v[28:31]
v_mfma_f32_16x16x32_bf16 v[32:35], a[108:111], a[64:67], v[32:35]
s_waitcnt vmcnt(0)
s_waitcnt lgkmcnt(0)
v_mfma_f32_16x16x32_bf16 v[16:19], a[112:115], a[68:71], v[16:19]
v_mfma_f32_16x16x32_bf16 v[20:23], a[116:119], a[68:71], v[20:23]
v_mfma_f32_16x16x32_bf16 v[24:27], a[120:123], a[68:71], v[24:27]
v_mfma_f32_16x16x32_bf16 v[28:31], a[124:127], a[68:71], v[28:31]
v_mfma_f32_16x16x32_bf16 v[32:35], a[128:131], a[68:71], v[32:35]
s_lshl_b32 s30, s27, 2
s_add_u32 s30, s30, s24
v_mov_b32 v126, 1073741824
s_lshr_b32 s31, s30, 1
s_mul_i32 s31, s31, 36864
s_and_b32 s32, s30, 1
s_lshl_b32 s32, s32, 8
s_add_u32 s31, s31, s32
s_mul_i32 s32, s28, 4608
s_add_u32 s31, s31, s32
s_add_u32 s31, s31, 4849664
v_lshlrev_b32 v128, 4, v2
v_lshl_add_u32 v128, v3, 9, v128
v_add_u32 v129, 4096, v128
v_cndmask_b32 v129, v126, v129, s[46:47]
v_cvt_pk_bf16_f32 v112, v16, v17
v_cvt_pk_bf16_f32 v113, v18, v19
v_cvt_pk_bf16_f32 v114, v20, v21
v_cvt_pk_bf16_f32 v115, v22, v23
v_cvt_pk_bf16_f32 v116, v24, v25
v_cvt_pk_bf16_f32 v117, v26, v27
v_cvt_pk_bf16_f32 v118, v28, v29
v_cvt_pk_bf16_f32 v119, v30, v31
v_cvt_pk_bf16_f32 v120, v32, v33
v_cvt_pk_bf16_f32 v121, v34, v35
buffer_store_dwordx4 v[112:115], v128, s[8:11], s31 offen sc1
buffer_store_dwordx4 v[116:119], v128, s[8:11], s31 offen offset:2048 sc1
v_permlane16_swap_b32 v120, v122
v_permlane16_swap_b32 v121, v123
buffer_store_dwordx4 v[120:123], v129, s[8:11], s31 offen sc1
v_add_f32 v124, v32, v33
v_mul_f32 v125, v32, v32
v_fmac_f32 v125, v33, v33
v_add_f32 v124, v124, v34
v_fmac_f32 v125, v34, v34
v_add_f32 v124, v124, v35
v_fmac_f32 v125, v35, v35
v_cndmask_b32 v124, 0, v124, s[50:51]
v_cndmask_b32 v125, 0, v125, s[50:51]
v_add_f32 v124, v124, v16
v_fmac_f32 v125, v16, v16
v_add_f32 v124, v124, v17
v_fmac_f32 v125, v17, v17
v_add_f32 v124, v124, v18
v_fmac_f32 v125, v18, v18
v_add_f32 v124, v124, v19
v_fmac_f32 v125, v19, v19
v_add_f32 v124, v124, v20
v_fmac_f32 v125, v20, v20
v_add_f32 v124, v124, v21
v_fmac_f32 v125, v21, v21
v_add_f32 v124, v124, v22
v_fmac_f32 v125, v22, v22
v_add_f32 v124, v124, v23
v_fmac_f32 v125, v23, v23
v_add_f32 v124, v124, v24
v_fmac_f32 v125, v24, v24
v_add_f32 v124, v124, v25
v_fmac_f32 v125, v25, v25
v_add_f32 v124, v124, v26
v_fmac_f32 v125, v26, v26
v_add_f32 v124, v124, v27
v_fmac_f32 v125, v27, v27
v_add_f32 v124, v124, v28
v_fmac_f32 v125, v28, v28
v_add_f32 v124, v124, v29
v_fmac_f32 v125, v29, v29
v_add_f32 v124, v124, v30
v_fmac_f32 v125, v30, v30
v_add_f32 v124, v124, v31
v_fmac_f32 v125, v31, v31
s_lshl_b32 s31, s30, 7
s_lshl_b32 s32, s28, 14
v_permlane32_swap_b32 v124, v125
v_add_f32 v124, v124, v125
v_mov_b32 v125, v124
s_add_u32 s31, s31, s32
s_add_u32 s31, s31, 7208960
v_permlane16_swap_b32 v124, v125
v_add_f32 v124, v124, v125
v_mov_b32 v125, v124
v_lshlrev_b32 v127, 3, v2
v_cndmask_b32 v126, v126, v127, s[46:47]
v_permlane32_swap_b32 v124, v125
buffer_store_dwordx2 v[124:125], v126, s[8:11], s31 offen sc1
s_waitcnt vmcnt(0)
s_barrier
s_cmp_eq_u32 s24, 0
s_cbranch_scc0 L_sig_4
v_lshlrev_b32 v6, 3, v1
s_lshr_b32 s31, s81, 4
s_lshl_b32 s31, s31, 11
s_and_b32 s32, s81, 15
s_lshl_b32 s32, s32, 2
s_add_u32 s31, s31, s32
v_add_u32 v6, s31, v6
s_mov_b64 exec, 0xffff
s_mov_b32 s30, 26509312
buffer_store_dword v4, v6, s[8:11], s30 offen sc1
s_mov_b64 exec, -1
L_sig_4:
s_mul_i32 s62, s26, 340992
s_add_u32 s62, s62, 2785280
s_mul_i32 s38, s24, 9216
s_add_u32 s39, s38, s62
s_add_u32 s39, s39, 0
s_add_u32 m0, s38, 0
s_nop 0
buffer_load_dwordx4 v1, s[4:7], s39 offen offset:0 lds
buffer_load_dwordx4 v1, s[4:7], s39 offen offset:1024 lds
buffer_load_dwordx4 v1, s[4:7], s39 offen offset:2048 lds
buffer_load_dwordx4 v1, s[4:7], s39 offen offset:3072 lds
s_add_u32 m0, m0, 4096
s_add_u32 s39, s39, 4096
buffer_load_dwordx4 v1, s[4:7], s39 offen offset:0 lds
buffer_load_dwordx4 v1, s[4:7], s39 offen offset:1024 lds
buffer_load_dwordx4 v1, s[4:7], s39 offen offset:2048 lds
buffer_load_dwordx4 v1, s[4:7], s39 offen offset:3072 lds
s_add_u32 m0, m0, 4096
s_add_u32 s39, s39, 4096
buffer_load_dwordx4 v1, s[4:7], s39 offen offset:0 lds
s_lshl_b32 s38, s24, 8
s_add_u32 s39, s38, s62
s_add_u32 s39, s39, 36864
s_add_u32 m0, s38, 36864
s_mov_b64 exec, 0xffff
buffer_load_dwordx4 v1, s[4:7], s39 offen lds
s_mov_b64 exec, -1
s_mul_i32 s38, s24, 9216
s_add_u32 s39, s38, s62
s_add_u32 s39, s39, 37888
s_add_u32 m0, s38, 37888
s_nop 0
buffer_load_dwordx4 v1, s[4:7], s39 offen offset:0 lds
buffer_load_dwordx4 v1, s[4:7], s39 offen offset:1024 lds
buffer_load_dwordx4 v1, s[4:7], s39 offen offset:2048 lds
buffer_load_dwordx4 v1, s[4:7], s39 offen offset:3072 lds
s_add_u32 m0, m0, 4096
s_add_u32 s39, s39, 4096
buffer_load_dwordx4 v1, s[4:7], s39 offen offset:0 lds
buffer_load_dwordx4 v1, s[4:7], s39 offen offset:1024 lds
buffer_load_dwordx4 v1, s[4:7], s39 offen offset:2048 lds
buffer_load_dwordx4 v1, s[4:7], s39 offen offset:3072 lds
s_add_u32 m0, m0, 4096
s_add_u32 s39, s39, 4096
buffer_load_dwordx4 v1, s[4:7], s39 offen offset:0 lds
s_lshl_b32 s38, s24, 8
s_add_u32 s39, s38, s62
s_add_u32 s39, s39, 74752
s_add_u32 m0, s38, 74752
s_mov_b64 exec, 0xffff
buffer_load_dwordx4 v1, s[4:7], s39 offen lds
s_mov_b64 exec, -1
s_mul_i32 s38, s24, 9216
s_add_u32 s39, s38, s62
s_add_u32 s39, s39, 75776
s_add_u32 m0, s38, 75776
s_nop 0
buffer_load_dwordx4 v1, s[4:7], s39 offen offset:0 lds
buffer_load_dwordx4 v1, s[4:7], s39 offen offset:1024 lds
buffer_load_dwordx4 v1, s[4:7], s39 offen offset:2048 lds
buffer_load_dwordx4 v1, s[4:7], s39 offen offset:3072 lds
s_add_u32 m0, m0, 4096
s_add_u32 s39, s39, 4096
buffer_load_dwordx4 v1, s[4:7], s39 offen offset:0 lds
buffer_load_dwordx4 v1, s[4:7], s39 offen offset:1024 lds
buffer_load_dwordx4 v1, s[4:7], s39 offen offset:2048 lds
buffer_load_dwordx4 v1, s[4:7], s39 offen offset:3072 lds
s_add_u32 m0, m0, 4096
s_add_u32 s39, s39, 4096
buffer_load_dwordx4 v1, s[4:7], s39 offen offset:0 lds
s_lshl_b32 s38, s24, 8
s_add_u32 s39, s38, s62
s_add_u32 s39, s39, 112640
s_add_u32 m0, s38, 112640
s_mov_b64 exec, 0xffff
buffer_load_dwordx4 v1, s[4:7], s39 offen lds
s_mov_b64 exec, -1
s_mul_i32 s38, s24, 9216
s_add_u32 s39, s38, s62
s_add_u32 s39, s39, 113664
s_add_u32 m0, s38, 113664
s_nop 0
buffer_load_dwordx4 v1, s[4:7], s39 offen offset:0 lds
buffer_load_dwordx4 v1, s[4:7], s39 offen offset:1024 lds
buffer_load_dwordx4 v1, s[4:7], s39 offen offset:2048 lds
buffer_load_dwordx4 v1, s[4:7], s39 offen offset:3072 lds
s_add_u32 m0, m0, 4096
s_add_u32 s39, s39, 4096
buffer_load_dwordx4 v1, s[4:7], s39 offen offset:0 lds
buffer_load_dwordx4 v1, s[4:7], s39 offen offset:1024 lds
buffer_load_dwordx4 v1, s[4:7], s39 offen offset:2048 lds
buffer_load_dwordx4 v1, s[4:7], s39 offen offset:3072 lds
s_add_u32 m0, m0, 4096
s_add_u32 s39, s39, 4096
buffer_load_dwordx4 v1, s[4:7], s39 offen offset:0 lds
s_lshl_b32 s38, s24, 8
s_add_u32 s39, s38, s62
s_add_u32 s39, s39, 150528
s_add_u32 m0, s38, 150528
s_mov_b64 exec, 0xffff
buffer_load_dwordx4 v1, s[4:7], s39 offen lds
s_mov_b64 exec, -1
s_cmp_eq_u32 s24, 1
s_cbranch_scc0 L_polled_6
s_lshl_b32 s30, s80, 7
s_add_u32 s30, s30, 26509312
v_lshrrev_b32 v6, 2, v1
s_mov_b32 s31, 0
s_mov_b64 exec, 0xffff
L_poll_5:
buffer_load_dword v7, v6, s[8:11], s30 offen sc1
s_add_u32 s31, s31, 1
s_waitcnt vmcnt(0)
v_cmp_ne_u32 vcc, 1, v7
s_cmp_gt_u32 s31, 200000
s_cbranch_scc1 L_polled_6
s_cbranch_vccnz L_poll_5
L_polled_6:
s_mov_b64 exec, -1
s_waitcnt vmcnt(0)
s_barrier
s_lshl_b32 s60, s25, 2
s_add_u32 s60, s60, s24
v_lshrrev_b32 v6, 1, v1
v_and_b32 v6, 0xf8, v6
v_lshrrev_b32 v7, 1, v3
v_lshl_add_u32 v6, v7, 16, v6
s_lshl_b32 s30, s60, 8
s_add_u32 s30, s30, 7208960
buffer_load_dwordx2 v[212:213], v6, s[8:11], s30 offen sc1
s_add_u32 s30, s30, 16384
buffer_load_dwordx2 v[214:215], v6, s[8:11], s30 offen sc1
s_add_u32 s30, s30, 16384
buffer_load_dwordx2 v[216:217], v6, s[8:11], s30 offen sc1
s_add_u32 s30, s30, 16384
buffer_load_dwordx2 v[218:219], v6, s[8:11], s30 offen sc1
s_add_u32 s30, s30, 16384
s_mul_i32 s30, s60, 36864
s_add_u32 s30, s30, 4849664
buffer_load_dwordx4 a[0:3], v1, s[8:11], s30 offen offset:0 sc1
buffer_load_dwordx4 a[4:7], v1, s[8:11], s30 offen offset:1024 sc1
buffer_load_dwordx4 a[8:11], v1, s[8:11], s30 offen offset:2048 sc1
buffer_load_dwordx4 a[12:15], v1, s[8:11], s30 offen offset:3072 sc1
s_add_u32 s30, s30, 4096
buffer_load_dwordx4 a[16:19], v1, s[8:11], s30 offen offset:0 sc1
buffer_load_dwordx4 a[20:23], v1, s[8:11], s30 offen offset:1024 sc1
buffer_load_dwordx4 a[24:27], v1, s[8:11], s30 offen offset:2048 sc1
buffer_load_dwordx4 a[28:31], v1, s[8:11], s30 offen offset:3072 sc1
s_add_u32 s30, s30, 4096
buffer_load_dwordx4 a[32:35], v1, s[8:11], s30 offen offset:0 sc1
buffer_load_dwordx4 a[36:39], v1, s[8:11], s30 offen offset:1024 sc1
buffer_load_dwordx4 a[40:43], v1, s[8:11], s30 offen offset:2048 sc1
buffer_load_dwordx4 a[44:47], v1, s[8:11], s30 offen offset:3072 sc1
s_add_u32 s30, s30, 4096
buffer_load_dwordx4 a[48:51], v1, s[8:11], s30 offen offset:0 sc1
buffer_load_dwordx4 a[52:55], v1, s[8:11], s30 offen offset:1024 sc1
buffer_load_dwordx4 a[56:59], v1, s[8:11], s30 offen offset:2048 sc1
buffer_load_dwordx4 a[60:63], v1, s[8:11], s30 offen offset:3072 sc1
s_add_u32 s30, s30, 4096
buffer_load_dwordx4 a[64:67], v1, s[8:11], s30 offen offset:0 sc1
buffer_load_dwordx4 a[68:71], v1, s[8:11], s30 offen offset:1024 sc1
buffer_load_dwordx4 a[72:75], v1, s[8:11], s30 offen offset:2048 sc1
buffer_load_dwordx4 a[76:79], v1, s[8:11], s30 offen offset:3072 sc1
s_add_u32 s30, s30, 4096
buffer_load_dwordx4 a[80:83], v1, s[8:11], s30 offen offset:0 sc1
buffer_load_dwordx4 a[84:87], v1, s[8:11], s30 offen offset:1024 sc1
buffer_load_dwordx4 a[88:91], v1, s[8:11], s30 offen offset:2048 sc1
buffer_load_dwordx4 a[92:95], v1, s[8:11], s30 offen offset:3072 sc1
s_add_u32 s30, s30, 4096
buffer_load_dwordx4 a[96:99], v1, s[8:11], s30 offen offset:0 sc1
buffer_load_dwordx4 a[100:103], v1, s[8:11], s30 offen offset:1024 sc1
buffer_load_dwordx4 a[104:107], v1, s[8:11], s30 offen offset:2048 sc1
buffer_load_dwordx4 a[108:111], v1, s[8:11], s30 offen offset:3072 sc1
s_add_u32 s30, s30, 4096
buffer_load_dwordx4 a[112:115], v1, s[8:11], s30 offen offset:0 sc1
buffer_load_dwordx4 a[116:119], v1, s[8:11], s30 offen offset:1024 sc1
buffer_load_dwordx4 a[120:123], v1, s[8:11], s30 offen offset:2048 sc1
buffer_load_dwordx4 a[124:127], v1, s[8:11], s30 offen offset:3072 sc1
s_add_u32 s30, s30, 4096
buffer_load_dwordx4 a[128:131], v1, s[8:11], s30 offen offset:0 sc1
buffer_load_dwordx4 a[132:135], v1, s[8:11], s30 offen offset:1024 sc1
buffer_load_dwordx4 a[136:139], v1, s[8:11], s30 offen offset:2048 sc1
buffer_load_dwordx4 a[140:143], v1, s[8:11], s30 offen offset:3072 sc1
v_add_u32 v242, 0, v1
v_add_u32 v243, 37888, v1
v_add_u32 v244, 75776, v1
v_add_u32 v245, 113664, v1
ds_read_b128 a[144:147], v242 offset:0
ds_read_b128 a[148:151], v242 offset:1024
ds_read_b128 a[152:155], v242 offset:2048
ds_read_b128 a[156:159], v242 offset:3072
ds_read_b128 a[160:163], v242 offset:4096
s_waitcnt vmcnt(35)
s_waitcnt lgkmcnt(3)
v_mfma_f32_32x32x16_bf16 v[108:123], a[144:147], a[0:3], 0
ds_read_b128 a[164:167], v242 offset:5120
s_waitcnt vmcnt(34)
v_mfma_f32_32x32x16_bf16 v[108:123], a[148:151], a[4:7], v[108:123]
ds_read_b128 a[144:147], v242 offset:6144
s_waitcnt vmcnt(33)
s_waitcnt lgkmcnt(3)
v_mfma_f32_32x32x16_bf16 v[108:123], a[152:155], a[8:11], v[108:123]
ds_read_b128 a[148:151], v242 offset:7168
s_waitcnt vmcnt(32)
v_mfma_f32_32x32x16_bf16 v[108:123], a[156:159], a[12:15], v[108:123]
ds_read_b128 a[152:155], v242 offset:8192
s_waitcnt vmcnt(31)
s_waitcnt lgkmcnt(3)
v_mfma_f32_32x32x16_bf16 v[108:123], a[160:163], a[16:19], v[108:123]
ds_read_b128 a[156:159], v242 offset:9216
v_add_f32 v228, v212, v214
v_add_f32 v229, v213, v215
v_add_f32 v228, v228, v216
v_add_f32 v229, v229, v217
v_add_f32 v228, v228, v218
v_add_f32 v229, v229, v219
s_waitcnt vmcnt(30)
v_mfma_f32_32x32x16_bf16 v[108:123], a[164:167], a[20:23], v[108:123]
ds_read_b128 a[160:163], v242 offset:10240
v_mov_b32 v230, v228
s_waitcnt vmcnt(29)
s_waitcnt lgkmcnt(3)
v_mfma_f32_32x32x16_bf16 v[108:123], a[144:147], a[24:27], v[108:123]
ds_read_b128 a[164:167], v242 offset:11264
v_mov_b32 v231, v229
s_waitcnt vmcnt(28)
v_mfma_f32_32x32x16_bf16 v[108:123], a[148:151], a[28:31], v[108:123]
ds_read_b128 a[144:147], v242 offset:12288
v_mov_b32 v240, 0
v_mov_b32 v241, 0
s_waitcnt vmcnt(27)
s_waitcnt lgkmcnt(3)
v_mfma_f32_32x32x16_bf16 v[108:123], a[152:155], a[32:35], v[108:123]
ds_read_b128 a[148:151], v242 offset:13312
v_permlane32_swap_b32 v228, v230
s_waitcnt vmcnt(26)
v_mfma_f32_32x32x16_bf16 v[108:123], a[156:159], a[36:39], v[108:123]
ds_read_b128 a[152:155], v242 offset:14336
s_waitcnt vmcnt(25)
s_waitcnt lgkmcnt(3)
v_mfma_f32_32x32x16_bf16 v[108:123], a[160:163], a[40:43], v[108:123]
ds_read_b128 a[156:159], v242 offset:15360
v_permlane32_swap_b32 v229, v231
s_waitcnt vmcnt(24)
v_mfma_f32_32x32x16_bf16 v[108:123], a[164:167], a[44:47], v[108:123]
ds_read_b128 a[160:163], v242 offset:16384
v_add_f32 v228, v228, v230
s_waitcnt vmcnt(23)
s_waitcnt lgkmcnt(3)
v_mfma_f32_32x32x16_bf16 v[108:123], a[144:147], a[48:51], v[108:123]
ds_read_b128 a[164:167], v242 offset:17408
v_add_f32 v229, v229, v231
s_waitcnt vmcnt(22)
v_mfma_f32_32x32x16_bf16 v[108:123], a[148:151], a[52:55], v[108:123]
ds_read_b128 a[144:147], v242 offset:18432
v_mul_f32 v228, 0x3ae38e39, v228
s_waitcnt vmcnt(21)
s_waitcnt lgkmcnt(3)
v_mfma_f32_32x32x16_bf16 v[108:123], a[152:155], a[56:59], v[108:123]
ds_read_b128 a[148:151], v242 offset:19456
v_mul_f32 v230, v228, v228
s_waitcnt vmcnt(20)
v_mfma_f32_32x32x16_bf16 v[108:123], a[156:159], a[60:63], v[108:123]
ds_read_b128 a[152:155], v242 offset:20480
v_mul_f32 v229, 0x3ae38e39, v229
v_sub_f32 v229, v229, v230
s_waitcnt vmcnt(19)
s_waitcnt lgkmcnt(3)
v_mfma_f32_32x32x16_bf16 v[108:123], a[160:163], a[64:67], v[108:123]
ds_read_b128 a[156:159], v242 offset:21504
v_max_f32 v229, 0, v229
s_waitcnt vmcnt(18)
v_mfma_f32_32x32x16_bf16 v[108:123], a[164:167], a[68:71], v[108:123]
ds_read_b128 a[160:163], v242 offset:22528
v_add_f32 v229, 0x3727c5ac, v229
s_waitcnt vmcnt(17)
s_waitcnt lgkmcnt(3)
v_mfma_f32_32x32x16_bf16 v[108:123], a[144:147], a[72:75], v[108:123]
ds_read_b128 a[164:167], v242 offset:23552
v_rsq_f32 v236, v229
s_waitcnt vmcnt(16)
v_mfma_f32_32x32x16_bf16 v[108:123], a[148:151], a[76:79], v[108:123]
ds_read_b128 a[144:147], v242 offset:24576
v_sqrt_f32 v238, v229
s_waitcnt vmcnt(15)
s_waitcnt lgkmcnt(3)
v_mfma_f32_32x32x16_bf16 v[108:123], a[152:155], a[80:83], v[108:123]
ds_read_b128 a[148:151], v242 offset:25600
s_waitcnt vmcnt(14)
v_mfma_f32_32x32x16_bf16 v[108:123], a[156:159], a[84:87], v[108:123]
ds_read_b128 a[152:155], v242 offset:26624
v_cvt_pk_bf16_f32 v230, -v228, -v228
s_waitcnt vmcnt(13)
s_waitcnt lgkmcnt(3)
v_mfma_f32_32x32x16_bf16 v[108:123], a[160:163], a[88:91], v[108:123]
ds_read_b128 a[156:159], v242 offset:27648
v_and_b32 v230, 0xffff0000, v230
v_add_f32 v230, v228, v230
s_waitcnt vmcnt(12)
v_mfma_f32_32x32x16_bf16 v[108:123], a[164:167], a[92:95], v[108:123]
ds_read_b128 a[160:163], v242 offset:28672
v_cvt_pk_bf16_f32 v248, -v228, -v230
s_waitcnt vmcnt(11)
s_waitcnt lgkmcnt(3)
v_mfma_f32_32x32x16_bf16 v[108:123], a[144:147], a[96:99], v[108:123]
ds_read_b128 a[164:167], v242 offset:29696
v_mov_b32 v249, v248
s_waitcnt vmcnt(10)
v_mfma_f32_32x32x16_bf16 v[108:123], a[148:151], a[100:103], v[108:123]
ds_read_b128 a[144:147], v242 offset:30720
v_mov_b32 v250, v248
s_waitcnt vmcnt(9)
s_waitcnt lgkmcnt(3)
v_mfma_f32_32x32x16_bf16 v[108:123], a[152:155], a[104:107], v[108:123]
ds_read_b128 a[148:151], v242 offset:31744
v_mov_b32 v251, v248
v_mul_f32 v237, v236, v236
s_waitcnt vmcnt(8)
v_mfma_f32_32x32x16_bf16 v[108:123], a[156:159], a[108:111], v[108:123]
ds_read_b128 a[152:155], v242 offset:32768
v_mul_f32 v237, v237, v236
s_waitcnt vmcnt(7)
s_waitcnt lgkmcnt(3)
v_mfma_f32_32x32x16_bf16 v[108:123], a[160:163], a[112:115], v[108:123]
ds_read_b128 a[156:159], v242 offset:33792
v_mul_f32 v237, 0xbdd2d3e8, v237
s_waitcnt vmcnt(6)
v_mfma_f32_32x32x16_bf16 v[108:123], a[164:167], a[116:119], v[108:123]
ds_read_b128 a[160:163], v242 offset:34816
v_mul_f32 v236, 0xc0135761, v236
s_waitcnt vmcnt(5)
s_waitcnt lgkmcnt(3)
v_mfma_f32_32x32x16_bf16 v[108:123], a[144:147], a[120:123], v[108:123]
ds_read_b128 a[164:167], v242 offset:35840
s_waitcnt vmcnt(4)
v_mfma_f32_32x32x16_bf16 v[108:123], a[148:151], a[124:127], v[108:123]
ds_read_b128 a[144:147], v242 offset:36864
s_waitcnt vmcnt(3)
s_waitcnt lgkmcnt(3)
v_mfma_f32_32x32x16_bf16 v[108:123], a[152:155], a[128:131], v[108:123]
ds_read_b128 a[148:151], v243 offset:0
s_waitcnt vmcnt(2)
v_mfma_f32_32x32x16_bf16 v[108:123], a[156:159], a[132:135], v[108:123]
ds_read_b128 a[152:155], v243 offset:1024
s_waitcnt vmcnt(1)
s_waitcnt lgkmcnt(3)
v_mfma_f32_32x32x16_bf16 v[108:123], a[160:163], a[136:139], v[108:123]
ds_read_b128 a[156:159], v243 offset:2048
s_waitcnt vmcnt(0)
v_mfma_f32_32x32x16_bf16 v[108:123], a[164:167], a[140:143], v[108:123]
ds_read_b128 a[160:163], v243 offset:3072
s_waitcnt lgkmcnt(4)
v_mfma_f32_32x32x16_bf16 v[108:123], a[144:147], v[248:251], v[108:123]
ds_read_b128 a[164:167], v243 offset:4096
s_barrier
s_waitcnt lgkmcnt(3)
v_mfma_f32_32x32x16_bf16 v[124:139], a[148:151], a[0:3], 0
ds_read_b128 a[144:147], v243 offset:5120
s_mul_i32 s38, s24, 9216
s_add_u32 s39, s38, s62
s_add_u32 s39, s39, 151552
s_add_u32 m0, s38, 0
s_nop 0
buffer_load_dwordx4 v1, s[4:7], s39 offen offset:0 lds
v_mfma_f32_32x32x16_bf16 v[124:139], a[152:155], a[4:7], v[124:139]
ds_read_b128 a[148:151], v243 offset:6144
buffer_load_dwordx4 v1, s[4:7], s39 offen offset:1024 lds
buffer_load_dwordx4 v1, s[4:7], s39 offen offset:2048 lds
s_waitcnt lgkmcnt(3)
v_mfma_f32_32x32x16_bf16 v[124:139], a[156:159], a[8:11], v[124:139]
ds_read_b128 a[152:155], v243 offset:7168
v_mfma_f32_32x32x16_bf16 v[124:139], a[160:163], a[12:15], v[124:139]
ds_read_b128 a[156:159], v243 offset:8192
v_mul_f32 v228, v108, v108
v_mul_f32 v229, v109, v109
v_mul_f32 v230, v110, v110
v_mul_f32 v231, v111, v111
v_fma_f32 v228, v228, v237, v236
v_fma_f32 v229, v229, v237, v236
v_fma_f32 v230, v230, v237, v236
v_fma_f32 v231, v231, v237, v236
v_mul_f32 v228, v228, v108
v_mul_f32 v229, v229, v109
v_mul_f32 v230, v230, v110
v_mul_f32 v231, v231, v111
v_exp_f32 v228, v228
s_waitcnt lgkmcnt(3)
v_mfma_f32_32x32x16_bf16 v[124:139], a[164:167], a[16:19], v[124:139]
ds_read_b128 a[160:163], v243 offset:9216
v_exp_f32 v229, v229
v_exp_f32 v230, v230
v_exp_f32 v231, v231
v_mfma_f32_32x32x16_bf16 v[124:139], a[144:147], a[20:23], v[124:139]
ds_read_b128 a[164:167], v243 offset:10240
v_fma_f32 v228, v228, v238, v238
v_fma_f32 v229, v229, v238, v238
v_fma_f32 v230, v230, v238, v238
v_fma_f32 v231, v231, v238, v238
v_rcp_f32 v228, v228
s_waitcnt lgkmcnt(3)
v_mfma_f32_32x32x16_bf16 v[124:139], a[148:151], a[24:27], v[124:139]
ds_read_b128 a[144:147], v243 offset:11264
v_rcp_f32 v229, v229
v_rcp_f32 v230, v230
v_rcp_f32 v231, v231
v_mfma_f32_32x32x16_bf16 v[124:139], a[152:155], a[28:31], v[124:139]
ds_read_b128 a[148:151], v243 offset:12288
v_mul_f32 v140, v108, v228
v_mul_f32 v141, v109, v229
v_mul_f32 v142, v110, v230
v_mul_f32 v143, v111, v231
s_waitcnt lgkmcnt(3)
v_mfma_f32_32x32x16_bf16 v[124:139], a[156:159], a[32:35], v[124:139]
ds_read_b128 a[152:155], v243 offset:13312
v_add_f32 v240, v240, v140
v_fmac_f32 v241, v140, v140
v_add_f32 v240, v240, v141
v_fmac_f32 v241, v141, v141
v_add_f32 v240, v240, v142
v_fmac_f32 v241, v142, v142
v_mfma_f32_32x32x16_bf16 v[124:139], a[160:163], a[36:39], v[124:139]
ds_read_b128 a[156:159], v243 offset:14336
v_add_f32 v240, v240, v143
v_fmac_f32 v241, v143, v143
v_mul_f32 v232, v112, v112
v_mul_f32 v233, v113, v113
v_mul_f32 v234, v114, v114
v_mul_f32 v235, v115, v115
s_waitcnt lgkmcnt(3)
v_mfma_f32_32x32x16_bf16 v[124:139], a[164:167], a[40:43], v[124:139]
ds_read_b128 a[160:163], v243 offset:15360
buffer_load_dwordx4 v1, s[4:7], s39 offen offset:3072 lds
s_add_u32 m0, m0, 4096
s_add_u32 s39, s39, 4096
buffer_load_dwordx4 v1, s[4:7], s39 offen offset:0 lds
v_mfma_f32_32x32x16_bf16 v[124:139], a[144:147], a[44:47], v[124:139]
ds_read_b128 a[164:167], v243 offset:16384
buffer_load_dwordx4 v1, s[4:7], s39 offen offset:1024 lds
buffer_load_dwordx4 v1, s[4:7], s39 offen offset:2048 lds
buffer_load_dwordx4 v1, s[4:7], s39 offen offset:3072 lds
s_waitcnt lgkmcnt(3)
v_mfma_f32_32x32x16_bf16 v[124:139], a[148:151], a[48:51], v[124:139]
ds_read_b128 a[144:147], v243 offset:17408
s_add_u32 m0, m0, 4096
s_add_u32 s39, s39, 4096
buffer_load_dwordx4 v1, s[4:7], s39 offen offset:0 lds
s_lshl_b32 s38, s24, 8
s_add_u32 s39, s38, s62
v_mfma_f32_32x32x16_bf16 v[124:139], a[152:155], a[52:55], v[124:139]
ds_read_b128 a[148:151], v243 offset:18432
s_add_u32 s39, s39, 188416
s_add_u32 m0, s38, 36864
s_mov_b64 exec, 0xffff
buffer_load_dwordx4 v1, s[4:7], s39 offen lds
s_mov_b64 exec, -1
s_waitcnt lgkmcnt(3)
v_mfma_f32_32x32x16_bf16 v[124:139], a[156:159], a[56:59], v[124:139]
ds_read_b128 a[152:155], v243 offset:19456
v_fma_f32 v232, v232, v237, v236
v_fma_f32 v233, v233, v237, v236
v_fma_f32 v234, v234, v237, v236
v_fma_f32 v235, v235, v237, v236
v_mul_f32 v232, v232, v112
v_mfma_f32_32x32x16_bf16 v[124:139], a[160:163], a[60:63], v[124:139]
ds_read_b128 a[156:159], v243 offset:20480
v_mul_f32 v233, v233, v113
v_mul_f32 v234, v234, v114
v_mul_f32 v235, v235, v115
v_exp_f32 v232, v232
v_exp_f32 v233, v233
s_waitcnt lgkmcnt(3)
v_mfma_f32_32x32x16_bf16 v[124:139], a[164:167], a[64:67], v[124:139]
ds_read_b128 a[160:163], v243 offset:21504
v_exp_f32 v234, v234
v_exp_f32 v235, v235
v_fma_f32 v232, v232, v238, v238
v_mfma_f32_32x32x16_bf16 v[124:139], a[144:147], a[68:71], v[124:139]
ds_read_b128 a[164:167], v243 offset:22528
v_fma_f32 v233, v233, v238, v238
v_fma_f32 v234, v234, v238, v238
v_fma_f32 v235, v235, v238, v238
v_rcp_f32 v232, v232
v_rcp_f32 v233, v233
s_waitcnt lgkmcnt(3)
v_mfma_f32_32x32x16_bf16 v[124:139], a[148:151], a[72:75], v[124:139]
ds_read_b128 a[144:147], v243 offset:23552
v_rcp_f32 v234, v234
v_rcp_f32 v235, v235
v_mul_f32 v144, v112, v232
v_mfma_f32_32x32x16_bf16 v[124:139], a[152:155], a[76:79], v[124:139]
ds_read_b128 a[148:151], v243 offset:24576
v_mul_f32 v145, v113, v233
v_mul_f32 v146, v114, v234
v_mul_f32 v147, v115, v235
v_add_f32 v240, v240, v144
v_fmac_f32 v241, v144, v144
v_add_f32 v240, v240, v145
s_waitcnt lgkmcnt(3)
v_mfma_f32_32x32x16_bf16 v[124:139], a[156:159], a[80:83], v[124:139]
ds_read_b128 a[152:155], v243 offset:25600
v_fmac_f32 v241, v145, v145
v_add_f32 v240, v240, v146
v_fmac_f32 v241, v146, v146
v_add_f32 v240, v240, v147
v_fmac_f32 v241, v147, v147
v_mul_f32 v228, v116, v116
v_mfma_f32_32x32x16_bf16 v[124:139], a[160:163], a[84:87], v[124:139]
ds_read_b128 a[156:159], v243 offset:26624
v_mul_f32 v229, v117, v117
v_mul_f32 v230, v118, v118
v_mul_f32 v231, v119, v119
v_fma_f32 v228, v228, v237, v236
v_fma_f32 v229, v229, v237, v236
s_waitcnt lgkmcnt(3)
v_mfma_f32_32x32x16_bf16 v[124:139], a[164:167], a[88:91], v[124:139]
ds_read_b128 a[160:163], v243 offset:27648
v_fma_f32 v230, v230, v237, v236
v_fma_f32 v231, v231, v237, v236
v_mul_f32 v228, v228, v116
v_mul_f32 v229, v229, v117
v_mul_f32 v230, v230, v118
v_mul_f32 v231, v231, v119
v_mfma_f32_32x32x16_bf16 v[124:139], a[144:147], a[92:95], v[124:139]
ds_read_b128 a[164:167], v243 offset:28672
v_exp_f32 v228, v228
v_exp_f32 v229, v229
v_exp_f32 v230, v230
s_waitcnt lgkmcnt(3)
v_mfma_f32_32x32x16_bf16 v[124:139], a[148:151], a[96:99], v[124:139]
ds_read_b128 a[144:147], v243 offset:29696
v_exp_f32 v231, v231
v_fma_f32 v228, v228, v238, v238
v_fma_f32 v229, v229, v238, v238
v_fma_f32 v230, v230, v238, v238
v_fma_f32 v231, v231, v238, v238
v_mfma_f32_32x32x16_bf16 v[124:139], a[152:155], a[100:103], v[124:139]
ds_read_b128 a[148:151], v243 offset:30720
v_rcp_f32 v228, v228
v_rcp_f32 v229, v229
v_rcp_f32 v230, v230
s_waitcnt lgkmcnt(3)
v_mfma_f32_32x32x16_bf16 v[124:139], a[156:159], a[104:107], v[124:139]
ds_read_b128 a[152:155], v243 offset:31744
v_rcp_f32 v231, v231
v_mul_f32 v148, v116, v228
v_mul_f32 v149, v117, v229
v_mul_f32 v150, v118, v230
v_mul_f32 v151, v119, v231
v_mfma_f32_32x32x16_bf16 v[124:139], a[160:163], a[108:111], v[124:139]
ds_read_b128 a[156:159], v243 offset:32768
v_add_f32 v240, v240, v148
v_fmac_f32 v241, v148, v148
v_add_f32 v240, v240, v149
v_fmac_f32 v241, v149, v149
v_add_f32 v240, v240, v150
v_fmac_f32 v241, v150, v150
s_waitcnt lgkmcnt(3)
v_mfma_f32_32x32x16_bf16 v[124:139], a[164:167], a[112:115], v[124:139]
ds_read_b128 a[160:163], v243 offset:33792
v_add_f32 v240, v240, v151
v_fmac_f32 v241, v151, v151
v_mul_f32 v232, v120, v120
v_mul_f32 v233, v121, v121
v_mul_f32 v234, v122, v122
v_mfma_f32_32x32x16_bf16 v[124:139], a[144:147], a[116:119], v[124:139]
ds_read_b128 a[164:167], v243 offset:34816
v_mul_f32 v235, v123, v123
v_fma_f32 v232, v232, v237, v236
v_fma_f32 v233, v233, v237, v236
v_fma_f32 v234, v234, v237, v236
v_fma_f32 v235, v235, v237, v236
v_mul_f32 v232, v232, v120
s_waitcnt lgkmcnt(3)
v_mfma_f32_32x32x16_bf16 v[124:139], a[148:151], a[120:123], v[124:139]
ds_read_b128 a[144:147], v243 offset:35840
v_mul_f32 v233, v233, v121
v_mul_f32 v234, v234, v122
v_mul_f32 v235, v235, v123
v_exp_f32 v232, v232
v_exp_f32 v233, v233
v_mfma_f32_32x32x16_bf16 v[124:139], a[152:155], a[124:127], v[124:139]
ds_read_b128 a[148:151], v243 offset:36864
v_exp_f32 v234, v234
v_exp_f32 v235, v235
v_fma_f32 v232, v232, v238, v238
s_waitcnt lgkmcnt(3)
v_mfma_f32_32x32x16_bf16 v[124:139], a[156:159], a[128:131], v[124:139]
ds_read_b128 a[152:155], v244 offset:0
v_fma_f32 v233, v233, v238, v238
v_fma_f32 v234, v234, v238, v238
v_fma_f32 v235, v235, v238, v238
v_rcp_f32 v232, v232
v_rcp_f32 v233, v233
v_mfma_f32_32x32x16_bf16 v[124:139], a[160:163], a[132:135], v[124:139]
ds_read_b128 a[156:159], v244 offset:1024
v_rcp_f32 v234, v234
v_rcp_f32 v235, v235
v_mul_f32 v152, v120, v232
s_waitcnt lgkmcnt(3)
v_mfma_f32_32x32x16_bf16 v[124:139], a[164:167], a[136:139], v[124:139]
ds_read_b128 a[160:163], v244 offset:2048
v_mul_f32 v153, v121, v233
v_mul_f32 v154, v122, v234
v_mul_f32 v155, v123, v235
v_add_f32 v240, v240, v152
v_fmac_f32 v241, v152, v152
v_add_f32 v240, v240, v153
v_mfma_f32_32x32x16_bf16 v[124:139], a[144:147], a[140:143], v[124:139]
ds_read_b128 a[164:167], v244 offset:3072
v_fmac_f32 v241, v153, v153
v_add_f32 v240, v240, v154
v_fmac_f32 v241, v154, v154
v_add_f32 v240, v240, v155
v_fmac_f32 v241, v155, v155
s_waitcnt lgkmcnt(4)
v_mfma_f32_32x32x16_bf16 v[124:139], a[148:151], v[248:251], v[124:139]
ds_read_b128 a[144:147], v244 offset:4096
s_barrier
s_waitcnt lgkmcnt(3)
v_mfma_f32_32x32x16_bf16 v[108:123], a[152:155], a[0:3], 0
ds_read_b128 a[148:151], v244 offset:5120
s_mul_i32 s38, s24, 9216
s_add_u32 s39, s38, s62
s_add_u32 s39, s39, 189440
s_add_u32 m0, s38, 37888
s_nop 0
buffer_load_dwordx4 v1, s[4:7], s39 offen offset:0 lds
v_mfma_f32_32x32x16_bf16 v[108:123], a[156:159], a[4:7], v[108:123]
ds_read_b128 a[152:155], v244 offset:6144
buffer_load_dwordx4 v1, s[4:7], s39 offen offset:1024 lds
buffer_load_dwordx4 v1, s[4:7], s39 offen offset:2048 lds
s_waitcnt lgkmcnt(3)
v_mfma_f32_32x32x16_bf16 v[108:123], a[160:163], a[8:11], v[108:123]
ds_read_b128 a[156:159], v244 offset:7168
v_mfma_f32_32x32x16_bf16 v[108:123], a[164:167], a[12:15], v[108:123]
ds_read_b128 a[160:163], v244 offset:8192
v_mul_f32 v228, v124, v124
v_mul_f32 v229, v125, v125
v_mul_f32 v230, v126, v126
v_mul_f32 v231, v127, v127
v_fma_f32 v228, v228, v237, v236
v_fma_f32 v229, v229, v237, v236
v_fma_f32 v230, v230, v237, v236
v_fma_f32 v231, v231, v237, v236
v_mul_f32 v228, v228, v124
v_mul_f32 v229, v229, v125
v_mul_f32 v230, v230, v126
v_mul_f32 v231, v231, v127
v_exp_f32 v228, v228
s_waitcnt lgkmcnt(3)
v_mfma_f32_32x32x16_bf16 v[108:123], a[144:147], a[16:19], v[108:123]
ds_read_b128 a[164:167], v244 offset:9216
v_exp_f32 v229, v229
v_exp_f32 v230, v230
v_exp_f32 v231, v231
v_mfma_f32_32x32x16_bf16 v[108:123], a[148:151], a[20:23], v[108:123]
ds_read_b128 a[144:147], v244 offset:10240
v_fma_f32 v228, v228, v238, v238
v_fma_f32 v229, v229, v238, v238
v_fma_f32 v230, v230, v238, v238
v_fma_f32 v231, v231, v238, v238
v_rcp_f32 v228, v228
s_waitcnt lgkmcnt(3)
v_mfma_f32_32x32x16_bf16 v[108:123], a[152:155], a[24:27], v[108:123]
ds_read_b128 a[148:151], v244 offset:11264
v_rcp_f32 v229, v229
v_rcp_f32 v230, v230
v_rcp_f32 v231, v231
v_mfma_f32_32x32x16_bf16 v[108:123], a[156:159], a[28:31], v[108:123]
ds_read_b128 a[152:155], v244 offset:12288
v_mul_f32 v156, v124, v228
v_mul_f32 v157, v125, v229
v_mul_f32 v158, v126, v230
v_mul_f32 v159, v127, v231
s_waitcnt lgkmcnt(3)
v_mfma_f32_32x32x16_bf16 v[108:123], a[160:163], a[32:35], v[108:123]
ds_read_b128 a[156:159], v244 offset:13312
v_add_f32 v240, v240, v156
v_fmac_f32 v241, v156, v156
v_add_f32 v240, v240, v157
v_fmac_f32 v241, v157, v157
v_add_f32 v240, v240, v158
v_fmac_f32 v241, v158, v158
v_mfma_f32_32x32x16_bf16 v[108:123], a[164:167], a[36:39], v[108:123]
ds_read_b128 a[160:163], v244 offset:14336
v_add_f32 v240, v240, v159
v_fmac_f32 v241, v159, v159
v_mul_f32 v232, v128, v128
v_mul_f32 v233, v129, v129
v_mul_f32 v234, v130, v130
v_mul_f32 v235, v131, v131
s_waitcnt lgkmcnt(3)
v_mfma_f32_32x32x16_bf16 v[108:123], a[144:147], a[40:43], v[108:123]
ds_read_b128 a[164:167], v244 offset:15360
buffer_load_dwordx4 v1, s[4:7], s39 offen offset:3072 lds
s_add_u32 m0, m0, 4096
s_add_u32 s39, s39, 4096
buffer_load_dwordx4 v1, s[4:7], s39 offen offset:0 lds
v_mfma_f32_32x32x16_bf16 v[108:123], a[148:151], a[44:47], v[108:123]
ds_read_b128 a[144:147], v244 offset:16384
buffer_load_dwordx4 v1, s[4:7], s39 offen offset:1024 lds
buffer_load_dwordx4 v1, s[4:7], s39 offen offset:2048 lds
buffer_load_dwordx4 v1, s[4:7], s39 offen offset:3072 lds
s_waitcnt lgkmcnt(3)
v_mfma_f32_32x32x16_bf16 v[108:123], a[152:155], a[48:51], v[108:123]
ds_read_b128 a[148:151], v244 offset:17408
s_add_u32 m0, m0, 4096
s_add_u32 s39, s39, 4096
buffer_load_dwordx4 v1, s[4:7], s39 offen offset:0 lds
s_lshl_b32 s38, s24, 8
s_add_u32 s39, s38, s62
v_mfma_f32_32x32x16_bf16 v[108:123], a[156:159], a[52:55], v[108:123]
ds_read_b128 a[152:155], v244 offset:18432
s_add_u32 s39, s39, 226304
s_add_u32 m0, s38, 74752
s_mov_b64 exec, 0xffff
buffer_load_dwordx4 v1, s[4:7], s39 offen lds
s_mov_b64 exec, -1
s_waitcnt lgkmcnt(3)
v_mfma_f32_32x32x16_bf16 v[108:123], a[160:163], a[56:59], v[108:123]
ds_read_b128 a[156:159], v244 offset:19456
v_fma_f32 v232, v232, v237, v236
v_fma_f32 v233, v233, v237, v236
v_fma_f32 v234, v234, v237, v236
v_fma_f32 v235, v235, v237, v236
v_mul_f32 v232, v232, v128
v_mfma_f32_32x32x16_bf16 v[108:123], a[164:167], a[60:63], v[108:123]
ds_read_b128 a[160:163], v244 offset:20480
v_mul_f32 v233, v233, v129
v_mul_f32 v234, v234, v130
v_mul_f32 v235, v235, v131
v_exp_f32 v232, v232
v_exp_f32 v233, v233
s_waitcnt lgkmcnt(3)
v_mfma_f32_32x32x16_bf16 v[108:123], a[144:147], a[64:67], v[108:123]
ds_read_b128 a[164:167], v244 offset:21504
v_exp_f32 v234, v234
v_exp_f32 v235, v235
v_fma_f32 v232, v232, v238, v238
v_mfma_f32_32x32x16_bf16 v[108:123], a[148:151], a[68:71], v[108:123]
ds_read_b128 a[144:147], v244 offset:22528
v_fma_f32 v233, v233, v238, v238
v_fma_f32 v234, v234, v238, v238
v_fma_f32 v235, v235, v238, v238
v_rcp_f32 v232, v232
v_rcp_f32 v233, v233
s_waitcnt lgkmcnt(3)
v_mfma_f32_32x32x16_bf16 v[108:123], a[152:155], a[72:75], v[108:123]
ds_read_b128 a[148:151], v244 offset:23552
v_rcp_f32 v234, v234
v_rcp_f32 v235, v235
v_mul_f32 v160, v128, v232
v_mfma_f32_32x32x16_bf16 v[108:123], a[156:159], a[76:79], v[108:123]
ds_read_b128 a[152:155], v244 offset:24576
v_mul_f32 v161, v129, v233
v_mul_f32 v162, v130, v234
v_mul_f32 v163, v131, v235
v_add_f32 v240, v240, v160
v_fmac_f32 v241, v160, v160
v_add_f32 v240, v240, v161
s_waitcnt lgkmcnt(3)
v_mfma_f32_32x32x16_bf16 v[108:123], a[160:163], a[80:83], v[108:123]
ds_read_b128 a[156:159], v244 offset:25600
v_fmac_f32 v241, v161, v161
v_add_f32 v240, v240, v162
v_fmac_f32 v241, v162, v162
v_add_f32 v240, v240, v163
v_fmac_f32 v241, v163, v163
v_mul_f32 v228, v132, v132
v_mfma_f32_32x32x16_bf16 v[108:123], a[164:167], a[84:87], v[108:123]
ds_read_b128 a[160:163], v244 offset:26624
v_mul_f32 v229, v133, v133
v_mul_f32 v230, v134, v134
v_mul_f32 v231, v135, v135
v_fma_f32 v228, v228, v237, v236
v_fma_f32 v229, v229, v237, v236
s_waitcnt lgkmcnt(3)
v_mfma_f32_32x32x16_bf16 v[108:123], a[144:147], a[88:91], v[108:123]
ds_read_b128 a[164:167], v244 offset:27648
v_fma_f32 v230, v230, v237, v236
v_fma_f32 v231, v231, v237, v236
v_mul_f32 v228, v228, v132
v_mul_f32 v229, v229, v133
v_mul_f32 v230, v230, v134
v_mul_f32 v231, v231, v135
v_mfma_f32_32x32x16_bf16 v[108:123], a[148:151], a[92:95], v[108:123]
ds_read_b128 a[144:147], v244 offset:28672
v_exp_f32 v228, v228
v_exp_f32 v229, v229
v_exp_f32 v230, v230
s_waitcnt lgkmcnt(3)
v_mfma_f32_32x32x16_bf16 v[108:123], a[152:155], a[96:99], v[108:123]
ds_read_b128 a[148:151], v244 offset:29696
v_exp_f32 v231, v231
v_fma_f32 v228, v228, v238, v238
v_fma_f32 v229, v229, v238, v238
v_fma_f32 v230, v230, v238, v238
v_fma_f32 v231, v231, v238, v238
v_mfma_f32_32x32x16_bf16 v[108:123], a[156:159], a[100:103], v[108:123]
ds_read_b128 a[152:155], v244 offset:30720
v_rcp_f32 v228, v228
v_rcp_f32 v229, v229
v_rcp_f32 v230, v230
s_waitcnt lgkmcnt(3)
v_mfma_f32_32x32x16_bf16 v[108:123], a[160:163], a[104:107], v[108:123]
ds_read_b128 a[156:159], v244 offset:31744
v_rcp_f32 v231, v231
v_mul_f32 v164, v132, v228
v_mul_f32 v165, v133, v229
v_mul_f32 v166, v134, v230
v_mul_f32 v167, v135, v231
v_mfma_f32_32x32x16_bf16 v[108:123], a[164:167], a[108:111], v[108:123]
ds_read_b128 a[160:163], v244 offset:32768
v_add_f32 v240, v240, v164
v_fmac_f32 v241, v164, v164
v_add_f32 v240, v240, v165
v_fmac_f32 v241, v165, v165
v_add_f32 v240, v240, v166
v_fmac_f32 v241, v166, v166
s_waitcnt lgkmcnt(3)
v_mfma_f32_32x32x16_bf16 v[108:123], a[144:147], a[112:115], v[108:123]
ds_read_b128 a[164:167], v244 offset:33792
v_add_f32 v240, v240, v167
v_fmac_f32 v241, v167, v167
v_mul_f32 v232, v136, v136
v_mul_f32 v233, v137, v137
v_mul_f32 v234, v138, v138
v_mfma_f32_32x32x16_bf16 v[108:123], a[148:151], a[116:119], v[108:123]
ds_read_b128 a[144:147], v244 offset:34816
v_mul_f32 v235, v139, v139
v_fma_f32 v232, v232, v237, v236
v_fma_f32 v233, v233, v237, v236
v_fma_f32 v234, v234, v237, v236
v_fma_f32 v235, v235, v237, v236
v_mul_f32 v232, v232, v136
s_waitcnt lgkmcnt(3)
v_mfma_f32_32x32x16_bf16 v[108:123], a[152:155], a[120:123], v[108:123]
ds_read_b128 a[148:151], v244 offset:35840
v_mul_f32 v233, v233, v137
v_mul_f32 v234, v234, v138
v_mul_f32 v235, v235, v139
v_exp_f32 v232, v232
v_exp_f32 v233, v233
v_mfma_f32_32x32x16_bf16 v[108:123], a[156:159], a[124:127], v[108:123]
ds_read_b128 a[152:155], v244 offset:36864
v_exp_f32 v234, v234
v_exp_f32 v235, v235
v_fma_f32 v232, v232, v238, v238
s_waitcnt lgkmcnt(3)
v_mfma_f32_32x32x16_bf16 v[108:123], a[160:163], a[128:131], v[108:123]
ds_read_b128 a[156:159], v245 offset:0
v_fma_f32 v233, v233, v238, v238
v_fma_f32 v234, v234, v238, v238
v_fma_f32 v235, v235, v238, v238
v_rcp_f32 v232, v232
v_rcp_f32 v233, v233
v_mfma_f32_32x32x16_bf16 v[108:123], a[164:167], a[132:135], v[108:123]
ds_read_b128 a[160:163], v245 offset:1024
v_rcp_f32 v234, v234
v_rcp_f32 v235, v235
v_mul_f32 v168, v136, v232
s_waitcnt lgkmcnt(3)
v_mfma_f32_32x32x16_bf16 v[108:123], a[144:147], a[136:139], v[108:123]
ds_read_b128 a[164:167], v245 offset:2048
v_mul_f32 v169, v137, v233
v_mul_f32 v170, v138, v234
v_mul_f32 v171, v139, v235
v_add_f32 v240, v240, v168
v_fmac_f32 v241, v168, v168
v_add_f32 v240, v240, v169
v_mfma_f32_32x32x16_bf16 v[108:123], a[148:151], a[140:143], v[108:123]
ds_read_b128 a[144:147], v245 offset:3072
v_fmac_f32 v241, v169, v169
v_add_f32 v240, v240, v170
v_fmac_f32 v241, v170, v170
v_add_f32 v240, v240, v171
v_fmac_f32 v241, v171, v171
s_waitcnt lgkmcnt(4)
v_mfma_f32_32x32x16_bf16 v[108:123], a[152:155], v[248:251], v[108:123]
ds_read_b128 a[148:151], v245 offset:4096
s_waitcnt vmcnt(10)
s_barrier
s_waitcnt lgkmcnt(3)
v_mfma_f32_32x32x16_bf16 v[124:139], a[156:159], a[0:3], 0
ds_read_b128 a[152:155], v245 offset:5120
s_mul_i32 s38, s24, 9216
s_add_u32 s39, s38, s62
s_add_u32 s39, s39, 227328
s_add_u32 m0, s38, 75776
s_nop 0
buffer_load_dwordx4 v1, s[4:7], s39 offen offset:0 lds
v_mfma_f32_32x32x16_bf16 v[124:139], a[160:163], a[4:7], v[124:139]
ds_read_b128 a[156:159], v245 offset:6144
buffer_load_dwordx4 v1, s[4:7], s39 offen offset:1024 lds
buffer_load_dwordx4 v1, s[4:7], s39 offen offset:2048 lds
s_waitcnt lgkmcnt(3)
v_mfma_f32_32x32x16_bf16 v[124:139], a[164:167], a[8:11], v[124:139]
ds_read_b128 a[160:163], v245 offset:7168
v_mfma_f32_32x32x16_bf16 v[124:139], a[144:147], a[12:15], v[124:139]
ds_read_b128 a[164:167], v245 offset:8192
v_mul_f32 v228, v108, v108
v_mul_f32 v229, v109, v109
v_mul_f32 v230, v110, v110
v_mul_f32 v231, v111, v111
v_fma_f32 v228, v228, v237, v236
v_fma_f32 v229, v229, v237, v236
v_fma_f32 v230, v230, v237, v236
v_fma_f32 v231, v231, v237, v236
v_mul_f32 v228, v228, v108
v_mul_f32 v229, v229, v109
v_mul_f32 v230, v230, v110
v_mul_f32 v231, v231, v111
v_exp_f32 v228, v228
s_waitcnt lgkmcnt(3)
v_mfma_f32_32x32x16_bf16 v[124:139], a[148:151], a[16:19], v[124:139]
ds_read_b128 a[144:147], v245 offset:9216
v_exp_f32 v229, v229
v_exp_f32 v230, v230
v_exp_f32 v231, v231
v_mfma_f32_32x32x16_bf16 v[124:139], a[152:155], a[20:23], v[124:139]
ds_read_b128 a[148:151], v245 offset:10240
v_fma_f32 v228, v228, v238, v238
v_fma_f32 v229, v229, v238, v238
v_fma_f32 v230, v230, v238, v238
v_fma_f32 v231, v231, v238, v238
v_rcp_f32 v228, v228
s_waitcnt lgkmcnt(3)
v_mfma_f32_32x32x16_bf16 v[124:139], a[156:159], a[24:27], v[124:139]
ds_read_b128 a[152:155], v245 offset:11264
v_rcp_f32 v229, v229
v_rcp_f32 v230, v230
v_rcp_f32 v231, v231
v_mfma_f32_32x32x16_bf16 v[124:139], a[160:163], a[28:31], v[124:139]
ds_read_b128 a[156:159], v245 offset:12288
v_mul_f32 v172, v108, v228
v_mul_f32 v173, v109, v229
v_mul_f32 v174, v110, v230
v_mul_f32 v175, v111, v231
s_waitcnt lgkmcnt(3)
v_mfma_f32_32x32x16_bf16 v[124:139], a[164:167], a[32:35], v[124:139]
ds_read_b128 a[160:163], v245 offset:13312
v_add_f32 v240, v240, v172
v_fmac_f32 v241, v172, v172
v_add_f32 v240, v240, v173
v_fmac_f32 v241, v173, v173
v_add_f32 v240, v240, v174
v_fmac_f32 v241, v174, v174
v_mfma_f32_32x32x16_bf16 v[124:139], a[144:147], a[36:39], v[124:139]
ds_read_b128 a[164:167], v245 offset:14336
v_add_f32 v240, v240, v175
v_fmac_f32 v241, v175, v175
v_mul_f32 v232, v112, v112
v_mul_f32 v233, v113, v113
v_mul_f32 v234, v114, v114
v_mul_f32 v235, v115, v115
s_waitcnt lgkmcnt(3)
v_mfma_f32_32x32x16_bf16 v[124:139], a[148:151], a[40:43], v[124:139]
ds_read_b128 a[144:147], v245 offset:15360
buffer_load_dwordx4 v1, s[4:7], s39 offen offset:3072 lds
s_add_u32 m0, m0, 4096
s_add_u32 s39, s39, 4096
buffer_load_dwordx4 v1, s[4:7], s39 offen offset:0 lds
v_mfma_f32_32x32x16_bf16 v[124:139], a[152:155], a[44:47], v[124:139]
ds_read_b128 a[148:151], v245 offset:16384
buffer_load_dwordx4 v1, s[4:7], s39 offen offset:1024 lds
buffer_load_dwordx4 v1, s[4:7], s39 offen offset:2048 lds
buffer_load_dwordx4 v1, s[4:7], s39 offen offset:3072 lds
s_waitcnt lgkmcnt(3)
v_mfma_f32_32x32x16_bf16 v[124:139], a[156:159], a[48:51], v[124:139]
ds_read_b128 a[152:155], v245 offset:17408
s_add_u32 m0, m0, 4096
s_add_u32 s39, s39, 4096
buffer_load_dwordx4 v1, s[4:7], s39 offen offset:0 lds
s_lshl_b32 s38, s24, 8
s_add_u32 s39, s38, s62
v_mfma_f32_32x32x16_bf16 v[124:139], a[160:163], a[52:55], v[124:139]
ds_read_b128 a[156:159], v245 offset:18432
s_add_u32 s39, s39, 264192
s_add_u32 m0, s38, 112640
s_mov_b64 exec, 0xffff
buffer_load_dwordx4 v1, s[4:7], s39 offen lds
s_mov_b64 exec, -1
s_waitcnt lgkmcnt(3)
v_mfma_f32_32x32x16_bf16 v[124:139], a[164:167], a[56:59], v[124:139]
ds_read_b128 a[160:163], v245 offset:19456
v_fma_f32 v232, v232, v237, v236
v_fma_f32 v233, v233, v237, v236
v_fma_f32 v234, v234, v237, v236
v_fma_f32 v235, v235, v237, v236
v_mul_f32 v232, v232, v112
v_mfma_f32_32x32x16_bf16 v[124:139], a[144:147], a[60:63], v[124:139]
ds_read_b128 a[164:167], v245 offset:20480
v_mul_f32 v233, v233, v113
v_mul_f32 v234, v234, v114
v_mul_f32 v235, v235, v115
v_exp_f32 v232, v232
v_exp_f32 v233, v233
s_waitcnt lgkmcnt(3)
v_mfma_f32_32x32x16_bf16 v[124:139], a[148:151], a[64:67], v[124:139]
ds_read_b128 a[144:147], v245 offset:21504
v_exp_f32 v234, v234
v_exp_f32 v235, v235
v_fma_f32 v232, v232, v238, v238
v_mfma_f32_32x32x16_bf16 v[124:139], a[152:155], a[68:71], v[124:139]
ds_read_b128 a[148:151], v245 offset:22528
v_fma_f32 v233, v233, v238, v238
v_fma_f32 v234, v234, v238, v238
v_fma_f32 v235, v235, v238, v238
v_rcp_f32 v232, v232
v_rcp_f32 v233, v233
s_waitcnt lgkmcnt(3)
v_mfma_f32_32x32x16_bf16 v[124:139], a[156:159], a[72:75], v[124:139]
ds_read_b128 a[152:155], v245 offset:23552
v_rcp_f32 v234, v234
v_rcp_f32 v235, v235
v_mul_f32 v176, v112, v232
v_mfma_f32_32x32x16_bf16 v[124:139], a[160:163], a[76:79], v[124:139]
ds_read_b128 a[156:159], v245 offset:24576
v_mul_f32 v177, v113, v233
v_mul_f32 v178, v114, v234
v_mul_f32 v179, v115, v235
v_add_f32 v240, v240, v176
v_fmac_f32 v241, v176, v176
v_add_f32 v240, v240, v177
s_waitcnt lgkmcnt(3)
v_mfma_f32_32x32x16_bf16 v[124:139], a[164:167], a[80:83], v[124:139]
ds_read_b128 a[160:163], v245 offset:25600
v_fmac_f32 v241, v177, v177
v_add_f32 v240, v240, v178
v_fmac_f32 v241, v178, v178
v_add_f32 v240, v240, v179
v_fmac_f32 v241, v179, v179
v_mul_f32 v228, v116, v116
v_mfma_f32_32x32x16_bf16 v[124:139], a[144:147], a[84:87], v[124:139]
ds_read_b128 a[164:167], v245 offset:26624
v_mul_f32 v229, v117, v117
v_mul_f32 v230, v118, v118
v_mul_f32 v231, v119, v119
v_fma_f32 v228, v228, v237, v236
v_fma_f32 v229, v229, v237, v236
s_waitcnt lgkmcnt(3)
v_mfma_f32_32x32x16_bf16 v[124:139], a[148:151], a[88:91], v[124:139]
ds_read_b128 a[144:147], v245 offset:27648
v_fma_f32 v230, v230, v237, v236
v_fma_f32 v231, v231, v237, v236
v_mul_f32 v228, v228, v116
v_mul_f32 v229, v229, v117
v_mul_f32 v230, v230, v118
v_mul_f32 v231, v231, v119
v_mfma_f32_32x32x16_bf16 v[124:139], a[152:155], a[92:95], v[124:139]
ds_read_b128 a[148:151], v245 offset:28672
v_exp_f32 v228, v228
v_exp_f32 v229, v229
v_exp_f32 v230, v230
s_waitcnt lgkmcnt(3)
v_mfma_f32_32x32x16_bf16 v[124:139], a[156:159], a[96:99], v[124:139]
ds_read_b128 a[152:155], v245 offset:29696
v_exp_f32 v231, v231
v_fma_f32 v228, v228, v238, v238
v_fma_f32 v229, v229, v238, v238
v_fma_f32 v230, v230, v238, v238
v_fma_f32 v231, v231, v238, v238
v_mfma_f32_32x32x16_bf16 v[124:139], a[160:163], a[100:103], v[124:139]
ds_read_b128 a[156:159], v245 offset:30720
v_rcp_f32 v228, v228
v_rcp_f32 v229, v229
v_rcp_f32 v230, v230
s_waitcnt lgkmcnt(3)
v_mfma_f32_32x32x16_bf16 v[124:139], a[164:167], a[104:107], v[124:139]
ds_read_b128 a[160:163], v245 offset:31744
v_rcp_f32 v231, v231
v_mul_f32 v180, v116, v228
v_mul_f32 v181, v117, v229
v_mul_f32 v182, v118, v230
v_mul_f32 v183, v119, v231
v_mfma_f32_32x32x16_bf16 v[124:139], a[144:147], a[108:111], v[124:139]
ds_read_b128 a[164:167], v245 offset:32768
v_add_f32 v240, v240, v180
v_fmac_f32 v241, v180, v180
v_add_f32 v240, v240, v181
v_fmac_f32 v241, v181, v181
v_add_f32 v240, v240, v182
v_fmac_f32 v241, v182, v182
s_waitcnt lgkmcnt(3)
v_mfma_f32_32x32x16_bf16 v[124:139], a[148:151], a[112:115], v[124:139]
ds_read_b128 a[144:147], v245 offset:33792
v_add_f32 v240, v240, v183
v_fmac_f32 v241, v183, v183
v_mul_f32 v232, v120, v120
v_mul_f32 v233, v121, v121
v_mul_f32 v234, v122, v122
v_mfma_f32_32x32x16_bf16 v[124:139], a[152:155], a[116:119], v[124:139]
ds_read_b128 a[148:151], v245 offset:34816
v_mul_f32 v235, v123, v123
v_fma_f32 v232, v232, v237, v236
v_fma_f32 v233, v233, v237, v236
v_fma_f32 v234, v234, v237, v236
v_fma_f32 v235, v235, v237, v236
v_mul_f32 v232, v232, v120
s_waitcnt lgkmcnt(3)
v_mfma_f32_32x32x16_bf16 v[124:139], a[156:159], a[120:123], v[124:139]
ds_read_b128 a[152:155], v245 offset:35840
v_mul_f32 v233, v233, v121
v_mul_f32 v234, v234, v122
v_mul_f32 v235, v235, v123
v_exp_f32 v232, v232
v_exp_f32 v233, v233
v_mfma_f32_32x32x16_bf16 v[124:139], a[160:163], a[124:127], v[124:139]
ds_read_b128 a[156:159], v245 offset:36864
v_exp_f32 v234, v234
v_exp_f32 v235, v235
v_fma_f32 v232, v232, v238, v238
s_waitcnt lgkmcnt(3)
v_mfma_f32_32x32x16_bf16 v[124:139], a[164:167], a[128:131], v[124:139]
ds_read_b128 a[160:163], v242 offset:0
v_fma_f32 v233, v233, v238, v238
v_fma_f32 v234, v234, v238, v238
v_fma_f32 v235, v235, v238, v238
v_rcp_f32 v232, v232
v_rcp_f32 v233, v233
v_mfma_f32_32x32x16_bf16 v[124:139], a[144:147], a[132:135], v[124:139]
ds_read_b128 a[164:167], v242 offset:1024
v_rcp_f32 v234, v234
v_rcp_f32 v235, v235
v_mul_f32 v184, v120, v232
s_waitcnt lgkmcnt(3)
v_mfma_f32_32x32x16_bf16 v[124:139], a[148:151], a[136:139], v[124:139]
ds_read_b128 a[144:147], v242 offset:2048
v_mul_f32 v185, v121, v233
v_mul_f32 v186, v122, v234
v_mul_f32 v187, v123, v235
v_add_f32 v240, v240, v184
v_fmac_f32 v241, v184, v184
v_add_f32 v240, v240, v185
v_mfma_f32_32x32x16_bf16 v[124:139], a[152:155], a[140:143], v[124:139]
ds_read_b128 a[148:151], v242 offset:3072
v_fmac_f32 v241, v185, v185
v_add_f32 v240, v240, v186
v_fmac_f32 v241, v186, v186
v_add_f32 v240, v240, v187
v_fmac_f32 v241, v187, v187
s_waitcnt lgkmcnt(4)
v_mfma_f32_32x32x16_bf16 v[124:139], a[156:159], v[248:251], v[124:139]
ds_read_b128 a[152:155], v242 offset:4096
s_waitcnt vmcnt(10)
s_barrier
s_waitcnt lgkmcnt(3)
v_mfma_f32_32x32x16_bf16 v[108:123], a[160:163], a[0:3], 0
ds_read_b128 a[156:159], v242 offset:5120
s_mul_i32 s38, s24, 9216
s_add_u32 s39, s38, s62
s_add_u32 s39, s39, 265216
s_add_u32 m0, s38, 113664
s_nop 0
buffer_load_dwordx4 v1, s[4:7], s39 offen offset:0 lds
v_mfma_f32_32x32x16_bf16 v[108:123], a[164:167], a[4:7], v[108:123]
ds_read_b128 a[160:163], v242 offset:6144
buffer_load_dwordx4 v1, s[4:7], s39 offen offset:1024 lds
buffer_load_dwordx4 v1, s[4:7], s39 offen offset:2048 lds
s_waitcnt lgkmcnt(3)
v_mfma_f32_32x32x16_bf16 v[108:123], a[144:147], a[8:11], v[108:123]
ds_read_b128 a[164:167], v242 offset:7168
v_mfma_f32_32x32x16_bf16 v[108:123], a[148:151], a[12:15], v[108:123]
ds_read_b128 a[144:147], v242 offset:8192
v_mul_f32 v228, v124, v124
v_mul_f32 v229, v125, v125
v_mul_f32 v230, v126, v126
v_mul_f32 v231, v127, v127
v_fma_f32 v228, v228, v237, v236
v_fma_f32 v229, v229, v237, v236
v_fma_f32 v230, v230, v237, v236
v_fma_f32 v231, v231, v237, v236
v_mul_f32 v228, v228, v124
v_mul_f32 v229, v229, v125
v_mul_f32 v230, v230, v126
v_mul_f32 v231, v231, v127
v_exp_f32 v228, v228
s_waitcnt lgkmcnt(3)
v_mfma_f32_32x32x16_bf16 v[108:123], a[152:155], a[16:19], v[108:123]
ds_read_b128 a[148:151], v242 offset:9216
v_exp_f32 v229, v229
v_exp_f32 v230, v230
v_exp_f32 v231, v231
v_mfma_f32_32x32x16_bf16 v[108:123], a[156:159], a[20:23], v[108:123]
ds_read_b128 a[152:155], v242 offset:10240
v_fma_f32 v228, v228, v238, v238
v_fma_f32 v229, v229, v238, v238
v_fma_f32 v230, v230, v238, v238
v_fma_f32 v231, v231, v238, v238
v_rcp_f32 v228, v228
s_waitcnt lgkmcnt(3)
v_mfma_f32_32x32x16_bf16 v[108:123], a[160:163], a[24:27], v[108:123]
ds_read_b128 a[156:159], v242 offset:11264
v_rcp_f32 v229, v229
v_rcp_f32 v230, v230
v_rcp_f32 v231, v231
v_mfma_f32_32x32x16_bf16 v[108:123], a[164:167], a[28:31], v[108:123]
ds_read_b128 a[160:163], v242 offset:12288
v_mul_f32 v188, v124, v228
v_mul_f32 v189, v125, v229
v_mul_f32 v190, v126, v230
v_mul_f32 v191, v127, v231
s_waitcnt lgkmcnt(3)
v_mfma_f32_32x32x16_bf16 v[108:123], a[144:147], a[32:35], v[108:123]
ds_read_b128 a[164:167], v242 offset:13312
v_add_f32 v240, v240, v188
v_fmac_f32 v241, v188, v188
v_add_f32 v240, v240, v189
v_fmac_f32 v241, v189, v189
v_add_f32 v240, v240, v190
v_fmac_f32 v241, v190, v190
v_mfma_f32_32x32x16_bf16 v[108:123], a[148:151], a[36:39], v[108:123]
ds_read_b128 a[144:147], v242 offset:14336
v_add_f32 v240, v240, v191
v_fmac_f32 v241, v191, v191
v_mul_f32 v232, v128, v128
v_mul_f32 v233, v129, v129
v_mul_f32 v234, v130, v130
v_mul_f32 v235, v131, v131
s_waitcnt lgkmcnt(3)
v_mfma_f32_32x32x16_bf16 v[108:123], a[152:155], a[40:43], v[108:123]
ds_read_b128 a[148:151], v242 offset:15360
buffer_load_dwordx4 v1, s[4:7], s39 offen offset:3072 lds
s_add_u32 m0, m0, 4096
s_add_u32 s39, s39, 4096
buffer_load_dwordx4 v1, s[4:7], s39 offen offset:0 lds
v_mfma_f32_32x32x16_bf16 v[108:123], a[156:159], a[44:47], v[108:123]
ds_read_b128 a[152:155], v242 offset:16384
buffer_load_dwordx4 v1, s[4:7], s39 offen offset:1024 lds
buffer_load_dwordx4 v1, s[4:7], s39 offen offset:2048 lds
buffer_load_dwordx4 v1, s[4:7], s39 offen offset:3072 lds
s_waitcnt lgkmcnt(3)
v_mfma_f32_32x32x16_bf16 v[108:123], a[160:163], a[48:51], v[108:123]
ds_read_b128 a[156:159], v242 offset:17408
s_add_u32 m0, m0, 4096
s_add_u32 s39, s39, 4096
buffer_load_dwordx4 v1, s[4:7], s39 offen offset:0 lds
s_lshl_b32 s38, s24, 8
s_add_u32 s39, s38, s62
v_mfma_f32_32x32x16_bf16 v[108:123], a[164:167], a[52:55], v[108:123]
ds_read_b128 a[160:163], v242 offset:18432
s_add_u32 s39, s39, 302080
s_add_u32 m0, s38, 150528
s_mov_b64 exec, 0xffff
buffer_load_dwordx4 v1, s[4:7], s39 offen lds
s_mov_b64 exec, -1
s_waitcnt lgkmcnt(3)
v_mfma_f32_32x32x16_bf16 v[108:123], a[144:147], a[56:59], v[108:123]
ds_read_b128 a[164:167], v242 offset:19456
v_fma_f32 v232, v232, v237, v236
v_fma_f32 v233, v233, v237, v236
v_fma_f32 v234, v234, v237, v236
v_fma_f32 v235, v235, v237, v236
v_mul_f32 v232, v232, v128
v_mfma_f32_32x32x16_bf16 v[108:123], a[148:151], a[60:63], v[108:123]
ds_read_b128 a[144:147], v242 offset:20480
v_mul_f32 v233, v233, v129
v_mul_f32 v234, v234, v130
v_mul_f32 v235, v235, v131
v_exp_f32 v232, v232
v_exp_f32 v233, v233
s_waitcnt lgkmcnt(3)
v_mfma_f32_32x32x16_bf16 v[108:123], a[152:155], a[64:67], v[108:123]
ds_read_b128 a[148:151], v242 offset:21504
v_exp_f32 v234, v234
v_exp_f32 v235, v235
v_fma_f32 v232, v232, v238, v238
v_mfma_f32_32x32x16_bf16 v[108:123], a[156:159], a[68:71], v[108:123]
ds_read_b128 a[152:155], v242 offset:22528
v_fma_f32 v233, v233, v238, v238
v_fma_f32 v234, v234, v238, v238
v_fma_f32 v235, v235, v238, v238
v_rcp_f32 v232, v232
v_rcp_f32 v233, v233
s_waitcnt lgkmcnt(3)
v_mfma_f32_32x32x16_bf16 v[108:123], a[160:163], a[72:75], v[108:123]
ds_read_b128 a[156:159], v242 offset:23552
v_rcp_f32 v234, v234
v_rcp_f32 v235, v235
v_mul_f32 v192, v128, v232
v_mfma_f32_32x32x16_bf16 v[108:123], a[164:167], a[76:79], v[108:123]
ds_read_b128 a[160:163], v242 offset:24576
v_mul_f32 v193, v129, v233
v_mul_f32 v194, v130, v234
v_mul_f32 v195, v131, v235
v_add_f32 v240, v240, v192
v_fmac_f32 v241, v192, v192
v_add_f32 v240, v240, v193
s_waitcnt lgkmcnt(3)
v_mfma_f32_32x32x16_bf16 v[108:123], a[144:147], a[80:83], v[108:123]
ds_read_b128 a[164:167], v242 offset:25600
v_fmac_f32 v241, v193, v193
v_add_f32 v240, v240, v194
v_fmac_f32 v241, v194, v194
v_add_f32 v240, v240, v195
v_fmac_f32 v241, v195, v195
v_mul_f32 v228, v132, v132
v_mfma_f32_32x32x16_bf16 v[108:123], a[148:151], a[84:87], v[108:123]
ds_read_b128 a[144:147], v242 offset:26624
v_mul_f32 v229, v133, v133
v_mul_f32 v230, v134, v134
v_mul_f32 v231, v135, v135
v_fma_f32 v228, v228, v237, v236
v_fma_f32 v229, v229, v237, v236
s_waitcnt lgkmcnt(3)
v_mfma_f32_32x32x16_bf16 v[108:123], a[152:155], a[88:91], v[108:123]
ds_read_b128 a[148:151], v242 offset:27648
v_fma_f32 v230, v230, v237, v236
v_fma_f32 v231, v231, v237, v236
v_mul_f32 v228, v228, v132
v_mul_f32 v229, v229, v133
v_mul_f32 v230, v230, v134
v_mul_f32 v231, v231, v135
v_mfma_f32_32x32x16_bf16 v[108:123], a[156:159], a[92:95], v[108:123]
ds_read_b128 a[152:155], v242 offset:28672
v_exp_f32 v228, v228
v_exp_f32 v229, v229
v_exp_f32 v230, v230
s_waitcnt lgkmcnt(3)
v_mfma_f32_32x32x16_bf16 v[108:123], a[160:163], a[96:99], v[108:123]
ds_read_b128 a[156:159], v242 offset:29696
v_exp_f32 v231, v231
v_fma_f32 v228, v228, v238, v238
v_fma_f32 v229, v229, v238, v238
v_fma_f32 v230, v230, v238, v238
v_fma_f32 v231, v231, v238, v238
v_mfma_f32_32x32x16_bf16 v[108:123], a[164:167], a[100:103], v[108:123]
ds_read_b128 a[160:163], v242 offset:30720
v_rcp_f32 v228, v228
v_rcp_f32 v229, v229
v_rcp_f32 v230, v230
s_waitcnt lgkmcnt(3)
v_mfma_f32_32x32x16_bf16 v[108:123], a[144:147], a[104:107], v[108:123]
ds_read_b128 a[164:167], v242 offset:31744
v_rcp_f32 v231, v231
v_mul_f32 v196, v132, v228
v_mul_f32 v197, v133, v229
v_mul_f32 v198, v134, v230
v_mul_f32 v199, v135, v231
v_mfma_f32_32x32x16_bf16 v[108:123], a[148:151], a[108:111], v[108:123]
ds_read_b128 a[144:147], v242 offset:32768
v_add_f32 v240, v240, v196
v_fmac_f32 v241, v196, v196
v_add_f32 v240, v240, v197
v_fmac_f32 v241, v197, v197
v_add_f32 v240, v240, v198
v_fmac_f32 v241, v198, v198
s_waitcnt lgkmcnt(3)
v_mfma_f32_32x32x16_bf16 v[108:123], a[152:155], a[112:115], v[108:123]
ds_read_b128 a[148:151], v242 offset:33792
v_add_f32 v240, v240, v199
v_fmac_f32 v241, v199, v199
v_mul_f32 v232, v136, v136
v_mul_f32 v233, v137, v137
v_mul_f32 v234, v138, v138
v_mfma_f32_32x32x16_bf16 v[108:123], a[156:159], a[116:119], v[108:123]
ds_read_b128 a[152:155], v242 offset:34816
v_mul_f32 v235, v139, v139
v_fma_f32 v232, v232, v237, v236
v_fma_f32 v233, v233, v237, v236
v_fma_f32 v234, v234, v237, v236
v_fma_f32 v235, v235, v237, v236
v_mul_f32 v232, v232, v136
s_waitcnt lgkmcnt(3)
v_mfma_f32_32x32x16_bf16 v[108:123], a[160:163], a[120:123], v[108:123]
ds_read_b128 a[156:159], v242 offset:35840
v_mul_f32 v233, v233, v137
v_mul_f32 v234, v234, v138
v_mul_f32 v235, v235, v139
v_exp_f32 v232, v232
v_exp_f32 v233, v233
v_mfma_f32_32x32x16_bf16 v[108:123], a[164:167], a[124:127], v[108:123]
ds_read_b128 a[160:163], v242 offset:36864
v_exp_f32 v234, v234
v_exp_f32 v235, v235
v_fma_f32 v232, v232, v238, v238
s_waitcnt lgkmcnt(3)
v_mfma_f32_32x32x16_bf16 v[108:123], a[144:147], a[128:131], v[108:123]
ds_read_b128 a[164:167], v243 offset:0
v_fma_f32 v233, v233, v238, v238
v_fma_f32 v234, v234, v238, v238
v_fma_f32 v235, v235, v238, v238
v_rcp_f32 v232, v232
v_rcp_f32 v233, v233
v_mfma_f32_32x32x16_bf16 v[108:123], a[148:151], a[132:135], v[108:123]
ds_read_b128 a[144:147], v243 offset:1024
v_rcp_f32 v234, v234
v_rcp_f32 v235, v235
v_mul_f32 v200, v136, v232
s_waitcnt lgkmcnt(3)
v_mfma_f32_32x32x16_bf16 v[108:123], a[152:155], a[136:139], v[108:123]
ds_read_b128 a[148:151], v243 offset:2048
v_mul_f32 v201, v137, v233
v_mul_f32 v202, v138, v234
v_mul_f32 v203, v139, v235
v_add_f32 v240, v240, v200
v_fmac_f32 v241, v200, v200
v_add_f32 v240, v240, v201
v_mfma_f32_32x32x16_bf16 v[108:123], a[156:159], a[140:143], v[108:123]
ds_read_b128 a[152:155], v243 offset:3072
v_fmac_f32 v241, v201, v201
v_add_f32 v240, v240, v202
v_fmac_f32 v241, v202, v202
v_add_f32 v240, v240, v203
v_fmac_f32 v241, v203, v203
s_waitcnt lgkmcnt(4)
v_mfma_f32_32x32x16_bf16 v[108:123], a[160:163], v[248:251], v[108:123]
ds_read_b128 a[156:159], v243 offset:4096
s_waitcnt vmcnt(10)
s_barrier
s_waitcnt lgkmcnt(3)
v_mfma_f32_32x32x16_bf16 v[124:139], a[164:167], a[0:3], 0
ds_read_b128 a[160:163], v243 offset:5120
s_mul_i32 s38, s24, 9216
s_add_u32 s39, s38, s62
s_add_u32 s39, s39, 303104
s_add_u32 m0, s38, 0
s_nop 0
buffer_load_dwordx4 v1, s[4:7], s39 offen offset:0 lds
v_mfma_f32_32x32x16_bf16 v[124:139], a[144:147], a[4:7], v[124:139]
ds_read_b128 a[164:167], v243 offset:6144
buffer_load_dwordx4 v1, s[4:7], s39 offen offset:1024 lds
buffer_load_dwordx4 v1, s[4:7], s39 offen offset:2048 lds
s_waitcnt lgkmcnt(3)
v_mfma_f32_32x32x16_bf16 v[124:139], a[148:151], a[8:11], v[124:139]
ds_read_b128 a[144:147], v243 offset:7168
v_mfma_f32_32x32x16_bf16 v[124:139], a[152:155], a[12:15], v[124:139]
ds_read_b128 a[148:151], v243 offset:8192
v_mul_f32 v228, v108, v108
v_mul_f32 v229, v109, v109
v_mul_f32 v230, v110, v110
v_mul_f32 v231, v111, v111
v_fma_f32 v228, v228, v237, v236
v_fma_f32 v229, v229, v237, v236
v_fma_f32 v230, v230, v237, v236
v_fma_f32 v231, v231, v237, v236
v_mul_f32 v228, v228, v108
v_mul_f32 v229, v229, v109
v_mul_f32 v230, v230, v110
v_mul_f32 v231, v231, v111
v_exp_f32 v228, v228
s_waitcnt lgkmcnt(3)
v_mfma_f32_32x32x16_bf16 v[124:139], a[156:159], a[16:19], v[124:139]
ds_read_b128 a[152:155], v243 offset:9216
v_exp_f32 v229, v229
v_exp_f32 v230, v230
v_exp_f32 v231, v231
v_mfma_f32_32x32x16_bf16 v[124:139], a[160:163], a[20:23], v[124:139]
ds_read_b128 a[156:159], v243 offset:10240
v_fma_f32 v228, v228, v238, v238
v_fma_f32 v229, v229, v238, v238
v_fma_f32 v230, v230, v238, v238
v_fma_f32 v231, v231, v238, v238
v_rcp_f32 v228, v228
s_waitcnt lgkmcnt(3)
v_mfma_f32_32x32x16_bf16 v[124:139], a[164:167], a[24:27], v[124:139]
ds_read_b128 a[160:163], v243 offset:11264
v_rcp_f32 v229, v229
v_rcp_f32 v230, v230
v_rcp_f32 v231, v231
v_mfma_f32_32x32x16_bf16 v[124:139], a[144:147], a[28:31], v[124:139]
ds_read_b128 a[164:167], v243 offset:12288
v_mul_f32 v204, v108, v228
v_mul_f32 v205, v109, v229
v_mul_f32 v206, v110, v230
v_mul_f32 v207, v111, v231
v_add_f32 v240, v240, v204
v_fmac_f32 v241, v204, v204
s_waitcnt lgkmcnt(3)
v_mfma_f32_32x32x16_bf16 v[124:139], a[148:151], a[32:35], v[124:139]
ds_read_b128 a[144:147], v243 offset:13312
v_add_f32 v240, v240, v205
v_fmac_f32 v241, v205, v205
v_add_f32 v240, v240, v206
v_fmac_f32 v241, v206, v206
v_add_f32 v240, v240, v207
v_fmac_f32 v241, v207, v207
v_mfma_f32_32x32x16_bf16 v[124:139], a[152:155], a[36:39], v[124:139]
ds_read_b128 a[148:151], v243 offset:14336
v_mul_f32 v232, v112, v112
v_mul_f32 v233, v113, v113
v_mul_f32 v234, v114, v114
v_mul_f32 v235, v115, v115
v_fma_f32 v232, v232, v237, v236
v_fma_f32 v233, v233, v237, v236
s_waitcnt lgkmcnt(3)
v_mfma_f32_32x32x16_bf16 v[124:139], a[156:159], a[40:43], v[124:139]
ds_read_b128 a[152:155], v243 offset:15360
v_fma_f32 v234, v234, v237, v236
v_fma_f32 v235, v235, v237, v236
v_mul_f32 v232, v232, v112
v_mul_f32 v233, v233, v113
v_mul_f32 v234, v234, v114
v_mul_f32 v235, v235, v115
v_mfma_f32_32x32x16_bf16 v[124:139], a[160:163], a[44:47], v[124:139]
ds_read_b128 a[156:159], v243 offset:16384
v_exp_f32 v232, v232
v_exp_f32 v233, v233
v_exp_f32 v234, v234
s_waitcnt lgkmcnt(3)
v_mfma_f32_32x32x16_bf16 v[124:139], a[164:167], a[48:51], v[124:139]
ds_read_b128 a[160:163], v243 offset:17408
v_exp_f32 v235, v235
v_fma_f32 v232, v232, v238, v238
v_fma_f32 v233, v233, v238, v238
v_fma_f32 v234, v234, v238, v238
v_fma_f32 v235, v235, v238, v238
v_mfma_f32_32x32x16_bf16 v[124:139], a[144:147], a[52:55], v[124:139]
ds_read_b128 a[164:167], v243 offset:18432
v_rcp_f32 v232, v232
v_rcp_f32 v233, v233
v_rcp_f32 v234, v234
s_waitcnt lgkmcnt(3)
v_mfma_f32_32x32x16_bf16 v[124:139], a[148:151], a[56:59], v[124:139]
ds_read_b128 a[144:147], v243 offset:19456
v_rcp_f32 v235, v235
v_mul_f32 v208, v112, v232
v_mul_f32 v209, v113, v233
v_mul_f32 v210, v114, v234
v_mul_f32 v211, v115, v235
v_mfma_f32_32x32x16_bf16 v[124:139], a[152:155], a[60:63], v[124:139]
ds_read_b128 a[148:151], v243 offset:20480
v_add_f32 v240, v240, v208
v_fmac_f32 v241, v208, v208
v_add_f32 v240, v240, v209
v_fmac_f32 v241, v209, v209
v_add_f32 v240, v240, v210
v_fmac_f32 v241, v210, v210
s_waitcnt lgkmcnt(3)
v_mfma_f32_32x32x16_bf16 v[124:139], a[156:159], a[64:67], v[124:139]
ds_read_b128 a[152:155], v243 offset:21504
v_add_f32 v240, v240, v211
v_fmac_f32 v241, v211, v211
v_mov_b32 v212, v240
v_mov_b32 v213, v241
s_lshl_b32 s61, s25, 14
s_lshl_b32 s30, s24, 8
v_mfma_f32_32x32x16_bf16 v[124:139], a[160:163], a[68:71], v[124:139]
ds_read_b128 a[156:159], v243 offset:22528
v_permlane32_swap_b32 v240, v212
v_permlane32_swap_b32 v241, v213
v_add_f32 v240, v240, v212
v_add_f32 v241, v241, v213
s_waitcnt lgkmcnt(3)
v_mfma_f32_32x32x16_bf16 v[124:139], a[164:167], a[72:75], v[124:139]
ds_read_b128 a[160:163], v243 offset:23552
s_add_u32 s61, s61, s30
s_add_u32 s61, s61, 26214400
s_lshl_b32 s30, s26, 10
s_add_u32 s30, s30, s61
v_lshrrev_b32 v6, 1, v1
s_mov_b32 exec_hi, 0
buffer_store_dwordx2 v[240:241], v6, s[8:11], s30 offen sc1
s_mov_b64 exec, -1
v_mfma_f32_32x32x16_bf16 v[124:139], a[144:147], a[76:79], v[124:139]
ds_read_b128 a[164:167], v243 offset:24576
v_and_b32 v6, 0xf8, v6
v_lshrrev_b32 v7, 1, v3
v_lshl_add_u32 v6, v7, 13, v6
v_add_u32 v7, 4096, v6
s_waitcnt lgkmcnt(3)
v_mfma_f32_32x32x16_bf16 v[124:139], a[148:151], a[80:83], v[124:139]
ds_read_b128 a[144:147], v243 offset:25600
buffer_load_dwordx4 v1, s[4:7], s39 offen offset:3072 lds
s_add_u32 m0, m0, 4096
s_add_u32 s39, s39, 4096
buffer_load_dwordx4 v1, s[4:7], s39 offen offset:0 lds
v_mfma_f32_32x32x16_bf16 v[124:139], a[152:155], a[84:87], v[124:139]
ds_read_b128 a[148:151], v243 offset:26624
buffer_load_dwordx4 v1, s[4:7], s39 offen offset:1024 lds
buffer_load_dwordx4 v1, s[4:7], s39 offen offset:2048 lds
buffer_load_dwordx4 v1, s[4:7], s39 offen offset:3072 lds
s_waitcnt lgkmcnt(3)
v_mfma_f32_32x32x16_bf16 v[124:139], a[156:159], a[88:91], v[124:139]
ds_read_b128 a[152:155], v243 offset:27648
s_add_u32 m0, m0, 4096
s_add_u32 s39, s39, 4096
buffer_load_dwordx4 v1, s[4:7], s39 offen offset:0 lds
s_lshl_b32 s38, s24, 8
s_add_u32 s39, s38, s62
v_mfma_f32_32x32x16_bf16 v[124:139], a[160:163], a[92:95], v[124:139]
ds_read_b128 a[156:159], v243 offset:28672
s_add_u32 s39, s39, 339968
s_add_u32 m0, s38, 36864
s_mov_b64 exec, 0xffff
buffer_load_dwordx4 v1, s[4:7], s39 offen lds
s_mov_b64 exec, -1
s_waitcnt lgkmcnt(3)
v_mfma_f32_32x32x16_bf16 v[124:139], a[164:167], a[96:99], v[124:139]
ds_read_b128 a[160:163], v243 offset:29696
v_mul_f32 v228, v116, v116
v_mul_f32 v229, v117, v117
v_mul_f32 v230, v118, v118
v_mul_f32 v231, v119, v119
v_fma_f32 v228, v228, v237, v236
v_fma_f32 v229, v229, v237, v236
v_mfma_f32_32x32x16_bf16 v[124:139], a[144:147], a[100:103], v[124:139]
ds_read_b128 a[164:167], v243 offset:30720
v_fma_f32 v230, v230, v237, v236
v_fma_f32 v231, v231, v237, v236
v_mul_f32 v228, v228, v116
v_mul_f32 v229, v229, v117
v_mul_f32 v230, v230, v118
v_mul_f32 v231, v231, v119
s_waitcnt lgkmcnt(3)
v_mfma_f32_32x32x16_bf16 v[124:139], a[148:151], a[104:107], v[124:139]
ds_read_b128 a[144:147], v243 offset:31744
v_exp_f32 v228, v228
v_exp_f32 v229, v229
v_exp_f32 v230, v230
v_mfma_f32_32x32x16_bf16 v[124:139], a[152:155], a[108:111], v[124:139]
ds_read_b128 a[148:151], v243 offset:32768
v_exp_f32 v231, v231
v_fma_f32 v228, v228, v238, v238
v_fma_f32 v229, v229, v238, v238
v_fma_f32 v230, v230, v238, v238
v_fma_f32 v231, v231, v238, v238
s_waitcnt lgkmcnt(3)
v_mfma_f32_32x32x16_bf16 v[124:139], a[156:159], a[112:115], v[124:139]
ds_read_b128 a[152:155], v243 offset:33792
v_rcp_f32 v228, v228
v_rcp_f32 v229, v229
v_rcp_f32 v230, v230
v_mfma_f32_32x32x16_bf16 v[124:139], a[160:163], a[116:119], v[124:139]
ds_read_b128 a[156:159], v243 offset:34816
v_rcp_f32 v231, v231
v_mul_f32 v100, v116, v228
v_mul_f32 v101, v117, v229
v_mul_f32 v102, v118, v230
v_mul_f32 v103, v119, v231
s_waitcnt lgkmcnt(3)
v_mfma_f32_32x32x16_bf16 v[124:139], a[164:167], a[120:123], v[124:139]
ds_read_b128 a[160:163], v243 offset:35840
v_mul_f32 v232, v120, v120
v_mul_f32 v233, v121, v121
v_mul_f32 v234, v122, v122
v_mul_f32 v235, v123, v123
v_fma_f32 v232, v232, v237, v236
v_fma_f32 v233, v233, v237, v236
v_mfma_f32_32x32x16_bf16 v[124:139], a[144:147], a[124:127], v[124:139]
ds_read_b128 a[164:167], v243 offset:36864
v_fma_f32 v234, v234, v237, v236
v_fma_f32 v235, v235, v237, v236
v_mul_f32 v232, v232, v120
v_mul_f32 v233, v233, v121
v_mul_f32 v234, v234, v122
v_mul_f32 v235, v235, v123
s_waitcnt lgkmcnt(3)
v_mfma_f32_32x32x16_bf16 v[124:139], a[148:151], a[128:131], v[124:139]
ds_read_b128 a[144:147], v244 offset:0
v_exp_f32 v232, v232
v_exp_f32 v233, v233
v_exp_f32 v234, v234
v_mfma_f32_32x32x16_bf16 v[124:139], a[152:155], a[132:135], v[124:139]
ds_read_b128 a[148:151], v244 offset:1024
v_exp_f32 v235, v235
v_fma_f32 v232, v232, v238, v238
v_fma_f32 v233, v233, v238, v238
v_fma_f32 v234, v234, v238, v238
v_fma_f32 v235, v235, v238, v238
s_waitcnt lgkmcnt(3)
v_mfma_f32_32x32x16_bf16 v[124:139], a[156:159], a[136:139], v[124:139]
ds_read_b128 a[152:155], v244 offset:2048
v_rcp_f32 v232, v232
v_rcp_f32 v233, v233
v_rcp_f32 v234, v234
v_mfma_f32_32x32x16_bf16 v[124:139], a[160:163], a[140:143], v[124:139]
ds_read_b128 a[156:159], v244 offset:3072
v_rcp_f32 v235, v235
v_mul_f32 v104, v120, v232
v_mul_f32 v105, v121, v233
v_mul_f32 v106, v122, v234
v_mul_f32 v107, v123, v235
s_waitcnt lgkmcnt(4)
v_mfma_f32_32x32x16_bf16 v[124:139], a[164:167], v[248:251], v[124:139]
ds_read_b128 a[160:163], v244 offset:4096
s_waitcnt vmcnt(11)
s_barrier
s_waitcnt lgkmcnt(3)
v_mfma_f32_32x32x16_bf16 v[108:123], a[144:147], a[0:3], 0
ds_read_b128 a[164:167], v244 offset:5120
v_mfma_f32_32x32x16_bf16 v[108:123], a[148:151], a[4:7], v[108:123]
ds_read_b128 a[144:147], v244 offset:6144
s_waitcnt lgkmcnt(3)
v_mfma_f32_32x32x16_bf16 v[108:123], a[152:155], a[8:11], v[108:123]
ds_read_b128 a[148:151], v244 offset:7168
v_mfma_f32_32x32x16_bf16 v[108:123], a[156:159], a[12:15], v[108:123]
ds_read_b128 a[152:155], v244 offset:8192
v_mul_f32 v228, v124, v124
v_mul_f32 v229, v125, v125
v_mul_f32 v230, v126, v126
v_mul_f32 v231, v127, v127
v_fma_f32 v228, v228, v237, v236
v_fma_f32 v229, v229, v237, v236
v_fma_f32 v230, v230, v237, v236
v_fma_f32 v231, v231, v237, v236
v_mul_f32 v228, v228, v124
v_mul_f32 v229, v229, v125
v_mul_f32 v230, v230, v126
v_mul_f32 v231, v231, v127
v_exp_f32 v228, v228
v_exp_f32 v229, v229
v_exp_f32 v230, v230
s_waitcnt lgkmcnt(3)
v_mfma_f32_32x32x16_bf16 v[108:123], a[160:163], a[16:19], v[108:123]
ds_read_b128 a[156:159], v244 offset:9216
v_exp_f32 v231, v231
v_fma_f32 v228, v228, v238, v238
v_fma_f32 v229, v229, v238, v238
v_mfma_f32_32x32x16_bf16 v[108:123], a[164:167], a[20:23], v[108:123]
ds_read_b128 a[160:163], v244 offset:10240
v_fma_f32 v230, v230, v238, v238
v_fma_f32 v231, v231, v238, v238
v_rcp_f32 v228, v228
s_waitcnt lgkmcnt(3)
v_mfma_f32_32x32x16_bf16 v[108:123], a[144:147], a[24:27], v[108:123]
ds_read_b128 a[164:167], v244 offset:11264
v_rcp_f32 v229, v229
v_rcp_f32 v230, v230
v_mfma_f32_32x32x16_bf16 v[108:123], a[148:151], a[28:31], v[108:123]
ds_read_b128 a[144:147], v244 offset:12288
v_rcp_f32 v231, v231
v_mul_f32 v36, v124, v228
v_mul_f32 v37, v125, v229
s_waitcnt lgkmcnt(3)
v_mfma_f32_32x32x16_bf16 v[108:123], a[152:155], a[32:35], v[108:123]
ds_read_b128 a[148:151], v244 offset:13312
v_mul_f32 v38, v126, v230
v_mul_f32 v39, v127, v231
v_mul_f32 v232, v128, v128
v_mul_f32 v233, v129, v129
v_mfma_f32_32x32x16_bf16 v[108:123], a[156:159], a[36:39], v[108:123]
ds_read_b128 a[152:155], v244 offset:14336
v_mul_f32 v234, v130, v130
v_mul_f32 v235, v131, v131
v_fma_f32 v232, v232, v237, v236
v_fma_f32 v233, v233, v237, v236
v_fma_f32 v234, v234, v237, v236
s_waitcnt lgkmcnt(3)
v_mfma_f32_32x32x16_bf16 v[108:123], a[160:163], a[40:43], v[108:123]
ds_read_b128 a[156:159], v244 offset:15360
v_fma_f32 v235, v235, v237, v236
v_mul_f32 v232, v232, v128
v_mul_f32 v233, v233, v129
v_mul_f32 v234, v234, v130
v_mfma_f32_32x32x16_bf16 v[108:123], a[164:167], a[44:47], v[108:123]
ds_read_b128 a[160:163], v244 offset:16384
v_mul_f32 v235, v235, v131
v_exp_f32 v232, v232
v_exp_f32 v233, v233
s_waitcnt lgkmcnt(3)
v_mfma_f32_32x32x16_bf16 v[108:123], a[144:147], a[48:51], v[108:123]
ds_read_b128 a[164:167], v244 offset:17408
v_exp_f32 v234, v234
v_exp_f32 v235, v235
v_mfma_f32_32x32x16_bf16 v[108:123], a[148:151], a[52:55], v[108:123]
ds_read_b128 a[144:147], v244 offset:18432
v_fma_f32 v232, v232, v238, v238
v_fma_f32 v233, v233, v238, v238
v_fma_f32 v234, v234, v238, v238
v_fma_f32 v235, v235, v238, v238
s_waitcnt lgkmcnt(3)
v_mfma_f32_32x32x16_bf16 v[108:123], a[152:155], a[56:59], v[108:123]
ds_read_b128 a[148:151], v244 offset:19456
v_rcp_f32 v232, v232
v_rcp_f32 v233, v233
v_mfma_f32_32x32x16_bf16 v[108:123], a[156:159], a[60:63], v[108:123]
ds_read_b128 a[152:155], v244 offset:20480
v_rcp_f32 v234, v234
v_rcp_f32 v235, v235
s_waitcnt lgkmcnt(3)
v_mfma_f32_32x32x16_bf16 v[108:123], a[160:163], a[64:67], v[108:123]
ds_read_b128 a[156:159], v244 offset:21504
v_mul_f32 v40, v128, v232
v_mul_f32 v41, v129, v233
v_mul_f32 v42, v130, v234
v_mul_f32 v43, v131, v235
v_mfma_f32_32x32x16_bf16 v[108:123], a[164:167], a[68:71], v[108:123]
ds_read_b128 a[160:163], v244 offset:22528
v_mul_f32 v228, v132, v132
v_mul_f32 v229, v133, v133
v_mul_f32 v230, v134, v134
v_mul_f32 v231, v135, v135
s_waitcnt lgkmcnt(3)
v_mfma_f32_32x32x16_bf16 v[108:123], a[144:147], a[72:75], v[108:123]
ds_read_b128 a[164:167], v244 offset:23552
v_fma_f32 v228, v228, v237, v236
v_fma_f32 v229, v229, v237, v236
v_fma_f32 v230, v230, v237, v236
v_fma_f32 v231, v231, v237, v236
v_mul_f32 v228, v228, v132
v_mfma_f32_32x32x16_bf16 v[108:123], a[148:151], a[76:79], v[108:123]
ds_read_b128 a[144:147], v244 offset:24576
v_mul_f32 v229, v229, v133
v_mul_f32 v230, v230, v134
v_mul_f32 v231, v231, v135
v_exp_f32 v228, v228
s_waitcnt lgkmcnt(3)
v_mfma_f32_32x32x16_bf16 v[108:123], a[152:155], a[80:83], v[108:123]
ds_read_b128 a[148:151], v244 offset:25600
v_exp_f32 v229, v229
v_exp_f32 v230, v230
v_mfma_f32_32x32x16_bf16 v[108:123], a[156:159], a[84:87], v[108:123]
ds_read_b128 a[152:155], v244 offset:26624
v_exp_f32 v231, v231
v_fma_f32 v228, v228, v238, v238
s_waitcnt lgkmcnt(3)
v_mfma_f32_32x32x16_bf16 v[108:123], a[160:163], a[88:91], v[108:123]
ds_read_b128 a[156:159], v244 offset:27648
v_fma_f32 v229, v229, v238, v238
v_fma_f32 v230, v230, v238, v238
v_fma_f32 v231, v231, v238, v238
v_rcp_f32 v228, v228
v_mfma_f32_32x32x16_bf16 v[108:123], a[164:167], a[92:95], v[108:123]
ds_read_b128 a[160:163], v244 offset:28672
v_rcp_f32 v229, v229
v_rcp_f32 v230, v230
s_waitcnt lgkmcnt(3)
v_mfma_f32_32x32x16_bf16 v[108:123], a[144:147], a[96:99], v[108:123]
ds_read_b128 a[164:167], v244 offset:29696
v_rcp_f32 v231, v231
v_mul_f32 v44, v132, v228
v_mul_f32 v45, v133, v229
v_mfma_f32_32x32x16_bf16 v[108:123], a[148:151], a[100:103], v[108:123]
ds_read_b128 a[144:147], v244 offset:30720
v_mul_f32 v46, v134, v230
v_mul_f32 v47, v135, v231
v_mul_f32 v232, v136, v136
v_mul_f32 v233, v137, v137
s_waitcnt lgkmcnt(3)
v_mfma_f32_32x32x16_bf16 v[108:123], a[152:155], a[104:107], v[108:123]
ds_read_b128 a[148:151], v244 offset:31744
v_mul_f32 v234, v138, v138
v_mul_f32 v235, v139, v139
v_fma_f32 v232, v232, v237, v236
v_fma_f32 v233, v233, v237, v236
v_mfma_f32_32x32x16_bf16 v[108:123], a[156:159], a[108:111], v[108:123]
ds_read_b128 a[152:155], v244 offset:32768
v_fma_f32 v234, v234, v237, v236
v_fma_f32 v235, v235, v237, v236
v_mul_f32 v232, v232, v136
v_mul_f32 v233, v233, v137
v_mul_f32 v234, v234, v138
s_waitcnt lgkmcnt(3)
v_mfma_f32_32x32x16_bf16 v[108:123], a[160:163], a[112:115], v[108:123]
ds_read_b128 a[156:159], v244 offset:33792
v_mul_f32 v235, v235, v139
v_exp_f32 v232, v232
v_exp_f32 v233, v233
v_mfma_f32_32x32x16_bf16 v[108:123], a[164:167], a[116:119], v[108:123]
ds_read_b128 a[160:163], v244 offset:34816
v_exp_f32 v234, v234
v_exp_f32 v235, v235
s_waitcnt lgkmcnt(3)
v_mfma_f32_32x32x16_bf16 v[108:123], a[144:147], a[120:123], v[108:123]
ds_read_b128 a[164:167], v244 offset:35840
v_fma_f32 v232, v232, v238, v238
v_fma_f32 v233, v233, v238, v238
v_fma_f32 v234, v234, v238, v238
v_mfma_f32_32x32x16_bf16 v[108:123], a[148:151], a[124:127], v[108:123]
ds_read_b128 a[144:147], v244 offset:36864
v_fma_f32 v235, v235, v238, v238
v_rcp_f32 v232, v232
v_rcp_f32 v233, v233
s_waitcnt lgkmcnt(3)
v_mfma_f32_32x32x16_bf16 v[108:123], a[152:155], a[128:131], v[108:123]
ds_read_b128 a[148:151], v245 offset:0
v_rcp_f32 v234, v234
v_rcp_f32 v235, v235
v_mfma_f32_32x32x16_bf16 v[108:123], a[156:159], a[132:135], v[108:123]
ds_read_b128 a[152:155], v245 offset:1024
v_mul_f32 v48, v136, v232
v_mul_f32 v49, v137, v233
v_mul_f32 v50, v138, v234
v_mul_f32 v51, v139, v235
s_waitcnt lgkmcnt(3)
v_mfma_f32_32x32x16_bf16 v[108:123], a[160:163], a[136:139], v[108:123]
ds_read_b128 a[156:159], v245 offset:2048
v_permlane16_swap_b32 v100, v104
v_permlane16_swap_b32 v101, v105
v_mfma_f32_32x32x16_bf16 v[108:123], a[164:167], a[140:143], v[108:123]
ds_read_b128 a[160:163], v245 offset:3072
v_permlane16_swap_b32 v102, v106
v_permlane16_swap_b32 v103, v107
s_waitcnt lgkmcnt(4)
v_mfma_f32_32x32x16_bf16 v[108:123], a[144:147], v[248:251], v[108:123]
ds_read_b128 a[164:167], v245 offset:4096
s_waitcnt vmcnt(0)
s_barrier
s_waitcnt lgkmcnt(3)
v_mfma_f32_32x32x16_bf16 v[124:139], a[148:151], a[0:3], 0
ds_read_b128 a[144:147], v245 offset:5120
v_mfma_f32_32x32x16_bf16 v[124:139], a[152:155], a[4:7], v[124:139]
ds_read_b128 a[148:151], v245 offset:6144
s_waitcnt lgkmcnt(3)
v_mfma_f32_32x32x16_bf16 v[124:139], a[156:159], a[8:11], v[124:139]
ds_read_b128 a[152:155], v245 offset:7168
v_mfma_f32_32x32x16_bf16 v[124:139], a[160:163], a[12:15], v[124:139]
ds_read_b128 a[156:159], v245 offset:8192
v_mul_f32 v228, v108, v108
v_mul_f32 v229, v109, v109
v_mul_f32 v230, v110, v110
v_mul_f32 v231, v111, v111
v_fma_f32 v228, v228, v237, v236
v_fma_f32 v229, v229, v237, v236
v_fma_f32 v230, v230, v237, v236
v_fma_f32 v231, v231, v237, v236
v_mul_f32 v228, v228, v108
v_mul_f32 v229, v229, v109
v_mul_f32 v230, v230, v110
v_mul_f32 v231, v231, v111
v_exp_f32 v228, v228
v_exp_f32 v229, v229
v_exp_f32 v230, v230
s_waitcnt lgkmcnt(3)
v_mfma_f32_32x32x16_bf16 v[124:139], a[164:167], a[16:19], v[124:139]
ds_read_b128 a[160:163], v245 offset:9216
v_exp_f32 v231, v231
v_fma_f32 v228, v228, v238, v238
v_fma_f32 v229, v229, v238, v238
v_fma_f32 v230, v230, v238, v238
v_mfma_f32_32x32x16_bf16 v[124:139], a[144:147], a[20:23], v[124:139]
ds_read_b128 a[164:167], v245 offset:10240
v_fma_f32 v231, v231, v238, v238
v_rcp_f32 v228, v228
v_rcp_f32 v229, v229
s_waitcnt lgkmcnt(3)
v_mfma_f32_32x32x16_bf16 v[124:139], a[148:151], a[24:27], v[124:139]
ds_read_b128 a[144:147], v245 offset:11264
v_rcp_f32 v230, v230
v_rcp_f32 v231, v231
v_mfma_f32_32x32x16_bf16 v[124:139], a[152:155], a[28:31], v[124:139]
ds_read_b128 a[148:151], v245 offset:12288
v_mul_f32 v52, v108, v228
v_mul_f32 v53, v109, v229
v_mul_f32 v54, v110, v230
v_mul_f32 v55, v111, v231
s_waitcnt lgkmcnt(3)
v_mfma_f32_32x32x16_bf16 v[124:139], a[156:159], a[32:35], v[124:139]
ds_read_b128 a[152:155], v245 offset:13312
v_mul_f32 v232, v112, v112
v_mul_f32 v233, v113, v113
v_mul_f32 v234, v114, v114
v_mul_f32 v235, v115, v115
v_mfma_f32_32x32x16_bf16 v[124:139], a[160:163], a[36:39], v[124:139]
ds_read_b128 a[156:159], v245 offset:14336
v_fma_f32 v232, v232, v237, v236
v_fma_f32 v233, v233, v237, v236
v_fma_f32 v234, v234, v237, v236
v_fma_f32 v235, v235, v237, v236
v_mul_f32 v232, v232, v112
s_waitcnt lgkmcnt(3)
v_mfma_f32_32x32x16_bf16 v[124:139], a[164:167], a[40:43], v[124:139]
ds_read_b128 a[160:163], v245 offset:15360
v_mul_f32 v233, v233, v113
v_mul_f32 v234, v234, v114
v_mul_f32 v235, v235, v115
v_exp_f32 v232, v232
v_mfma_f32_32x32x16_bf16 v[124:139], a[144:147], a[44:47], v[124:139]
ds_read_b128 a[164:167], v245 offset:16384
v_exp_f32 v233, v233
v_exp_f32 v234, v234
s_waitcnt lgkmcnt(3)
v_mfma_f32_32x32x16_bf16 v[124:139], a[148:151], a[48:51], v[124:139]
ds_read_b128 a[144:147], v245 offset:17408
v_exp_f32 v235, v235
v_fma_f32 v232, v232, v238, v238
v_fma_f32 v233, v233, v238, v238
v_mfma_f32_32x32x16_bf16 v[124:139], a[152:155], a[52:55], v[124:139]
ds_read_b128 a[148:151], v245 offset:18432
v_fma_f32 v234, v234, v238, v238
v_fma_f32 v235, v235, v238, v238
v_rcp_f32 v232, v232
v_rcp_f32 v233, v233
s_waitcnt lgkmcnt(3)
v_mfma_f32_32x32x16_bf16 v[124:139], a[156:159], a[56:59], v[124:139]
ds_read_b128 a[152:155], v245 offset:19456
v_rcp_f32 v234, v234
v_rcp_f32 v235, v235
v_mfma_f32_32x32x16_bf16 v[124:139], a[160:163], a[60:63], v[124:139]
ds_read_b128 a[156:159], v245 offset:20480
v_mul_f32 v56, v112, v232
v_mul_f32 v57, v113, v233
v_mul_f32 v58, v114, v234
v_mul_f32 v59, v115, v235
s_waitcnt lgkmcnt(3)
v_mfma_f32_32x32x16_bf16 v[124:139], a[164:167], a[64:67], v[124:139]
ds_read_b128 a[160:163], v245 offset:21504
v_mul_f32 v228, v116, v116
v_mul_f32 v229, v117, v117
v_mul_f32 v230, v118, v118
v_mul_f32 v231, v119, v119
v_mfma_f32_32x32x16_bf16 v[124:139], a[144:147], a[68:71], v[124:139]
ds_read_b128 a[164:167], v245 offset:22528
v_fma_f32 v228, v228, v237, v236
v_fma_f32 v229, v229, v237, v236
v_fma_f32 v230, v230, v237, v236
v_fma_f32 v231, v231, v237, v236
s_waitcnt lgkmcnt(3)
v_mfma_f32_32x32x16_bf16 v[124:139], a[148:151], a[72:75], v[124:139]
ds_read_b128 a[144:147], v245 offset:23552
v_mul_f32 v228, v228, v116
v_mul_f32 v229, v229, v117
v_mul_f32 v230, v230, v118
v_mul_f32 v231, v231, v119
v_exp_f32 v228, v228
v_mfma_f32_32x32x16_bf16 v[124:139], a[152:155], a[76:79], v[124:139]
ds_read_b128 a[148:151], v245 offset:24576
v_exp_f32 v229, v229
v_exp_f32 v230, v230
s_waitcnt lgkmcnt(3)
v_mfma_f32_32x32x16_bf16 v[124:139], a[156:159], a[80:83], v[124:139]
ds_read_b128 a[152:155], v245 offset:25600
v_exp_f32 v231, v231
v_fma_f32 v228, v228, v238, v238
v_fma_f32 v229, v229, v238, v238
v_mfma_f32_32x32x16_bf16 v[124:139], a[160:163], a[84:87], v[124:139]
ds_read_b128 a[156:159], v245 offset:26624
v_fma_f32 v230, v230, v238, v238
v_fma_f32 v231, v231, v238, v238
v_rcp_f32 v228, v228
s_waitcnt lgkmcnt(3)
v_mfma_f32_32x32x16_bf16 v[124:139], a[164:167], a[88:91], v[124:139]
ds_read_b128 a[160:163], v245 offset:27648
v_rcp_f32 v229, v229
v_rcp_f32 v230, v230
v_rcp_f32 v231, v231
v_mfma_f32_32x32x16_bf16 v[124:139], a[144:147], a[92:95], v[124:139]
ds_read_b128 a[164:167], v245 offset:28672
v_mul_f32 v60, v116, v228
v_mul_f32 v61, v117, v229
v_mul_f32 v62, v118, v230
s_waitcnt lgkmcnt(3)
v_mfma_f32_32x32x16_bf16 v[124:139], a[148:151], a[96:99], v[124:139]
ds_read_b128 a[144:147], v245 offset:29696
v_mul_f32 v63, v119, v231
v_mul_f32 v232, v120, v120
v_mul_f32 v233, v121, v121
v_mul_f32 v234, v122, v122
v_mul_f32 v235, v123, v123
v_mfma_f32_32x32x16_bf16 v[124:139], a[152:155], a[100:103], v[124:139]
ds_read_b128 a[148:151], v245 offset:30720
v_fma_f32 v232, v232, v237, v236
v_fma_f32 v233, v233, v237, v236
v_fma_f32 v234, v234, v237, v236
v_fma_f32 v235, v235, v237, v236
s_waitcnt lgkmcnt(3)
v_mfma_f32_32x32x16_bf16 v[124:139], a[156:159], a[104:107], v[124:139]
ds_read_b128 a[152:155], v245 offset:31744
v_mul_f32 v232, v232, v120
v_mul_f32 v233, v233, v121
v_mul_f32 v234, v234, v122
v_mul_f32 v235, v235, v123
v_mfma_f32_32x32x16_bf16 v[124:139], a[160:163], a[108:111], v[124:139]
ds_read_b128 a[156:159], v245 offset:32768
v_exp_f32 v232, v232
v_exp_f32 v233, v233
v_exp_f32 v234, v234
s_waitcnt lgkmcnt(3)
v_mfma_f32_32x32x16_bf16 v[124:139], a[164:167], a[112:115], v[124:139]
ds_read_b128 a[160:163], v245 offset:33792
v_exp_f32 v235, v235
v_fma_f32 v232, v232, v238, v238
v_mfma_f32_32x32x16_bf16 v[124:139], a[144:147], a[116:119], v[124:139]
ds_read_b128 a[164:167], v245 offset:34816
v_fma_f32 v233, v233, v238, v238
v_fma_f32 v234, v234, v238, v238
v_fma_f32 v235, v235, v238, v238
v_rcp_f32 v232, v232
s_waitcnt lgkmcnt(3)
v_mfma_f32_32x32x16_bf16 v[124:139], a[148:151], a[120:123], v[124:139]
ds_read_b128 a[144:147], v245 offset:35840
v_rcp_f32 v233, v233
v_rcp_f32 v234, v234
v_mfma_f32_32x32x16_bf16 v[124:139], a[152:155], a[124:127], v[124:139]
ds_read_b128 a[148:151], v245 offset:36864
v_rcp_f32 v235, v235
v_mul_f32 v64, v120, v232
v_mul_f32 v65, v121, v233
v_mul_f32 v66, v122, v234
s_waitcnt lgkmcnt(3)
v_mfma_f32_32x32x16_bf16 v[124:139], a[156:159], a[128:131], v[124:139]
ds_read_b128 a[152:155], v242 offset:0
v_mul_f32 v67, v123, v235
v_permlane16_swap_b32 v36, v40
v_permlane16_swap_b32 v37, v41
v_mfma_f32_32x32x16_bf16 v[124:139], a[160:163], a[132:135], v[124:139]
ds_read_b128 a[156:159], v242 offset:1024
v_permlane16_swap_b32 v38, v42
v_permlane16_swap_b32 v39, v43
s_waitcnt lgkmcnt(3)
v_mfma_f32_32x32x16_bf16 v[124:139], a[164:167], a[136:139], v[124:139]
ds_read_b128 a[160:163], v242 offset:2048
v_permlane16_swap_b32 v44, v48
v_permlane16_swap_b32 v45, v49
v_mfma_f32_32x32x16_bf16 v[124:139], a[144:147], a[140:143], v[124:139]
ds_read_b128 a[164:167], v242 offset:3072
v_permlane16_swap_b32 v46, v50
v_permlane16_swap_b32 v47, v51
s_waitcnt lgkmcnt(4)
v_mfma_f32_32x32x16_bf16 v[124:139], a[148:151], v[248:251], v[124:139]
ds_read_b128 a[144:147], v242 offset:4096
s_barrier
s_waitcnt lgkmcnt(3)
v_mfma_f32_32x32x16_bf16 v[108:123], a[152:155], a[0:3], 0
ds_read_b128 a[148:151], v242 offset:5120
v_mfma_f32_32x32x16_bf16 v[108:123], a[156:159], a[4:7], v[108:123]
ds_read_b128 a[152:155], v242 offset:6144
s_waitcnt lgkmcnt(3)
v_mfma_f32_32x32x16_bf16 v[108:123], a[160:163], a[8:11], v[108:123]
ds_read_b128 a[156:159], v242 offset:7168
v_mfma_f32_32x32x16_bf16 v[108:123], a[164:167], a[12:15], v[108:123]
ds_read_b128 a[160:163], v242 offset:8192
v_mul_f32 v228, v124, v124
v_mul_f32 v229, v125, v125
v_mul_f32 v230, v126, v126
v_mul_f32 v231, v127, v127
v_fma_f32 v228, v228, v237, v236
v_fma_f32 v229, v229, v237, v236
v_fma_f32 v230, v230, v237, v236
v_fma_f32 v231, v231, v237, v236
v_mul_f32 v228, v228, v124
v_mul_f32 v229, v229, v125
v_mul_f32 v230, v230, v126
v_mul_f32 v231, v231, v127
v_exp_f32 v228, v228
v_exp_f32 v229, v229
v_exp_f32 v230, v230
v_exp_f32 v231, v231
s_waitcnt lgkmcnt(3)
v_mfma_f32_32x32x16_bf16 v[108:123], a[144:147], a[16:19], v[108:123]
ds_read_b128 a[164:167], v242 offset:9216
v_fma_f32 v228, v228, v238, v238
v_fma_f32 v229, v229, v238, v238
v_fma_f32 v230, v230, v238, v238
v_fma_f32 v231, v231, v238, v238
v_rcp_f32 v228, v228
v_mfma_f32_32x32x16_bf16 v[108:123], a[148:151], a[20:23], v[108:123]
ds_read_b128 a[144:147], v242 offset:10240
v_rcp_f32 v229, v229
v_rcp_f32 v230, v230
s_waitcnt lgkmcnt(3)
v_mfma_f32_32x32x16_bf16 v[108:123], a[152:155], a[24:27], v[108:123]
ds_read_b128 a[148:151], v242 offset:11264
v_rcp_f32 v231, v231
v_mul_f32 v68, v124, v228
v_mul_f32 v69, v125, v229
v_mul_f32 v70, v126, v230
v_mfma_f32_32x32x16_bf16 v[108:123], a[156:159], a[28:31], v[108:123]
ds_read_b128 a[152:155], v242 offset:12288
v_mul_f32 v71, v127, v231
v_mul_f32 v232, v128, v128
v_mul_f32 v233, v129, v129
v_mul_f32 v234, v130, v130
v_mul_f32 v235, v131, v131
s_waitcnt lgkmcnt(3)
v_mfma_f32_32x32x16_bf16 v[108:123], a[160:163], a[32:35], v[108:123]
ds_read_b128 a[156:159], v242 offset:13312
v_fma_f32 v232, v232, v237, v236
v_fma_f32 v233, v233, v237, v236
v_fma_f32 v234, v234, v237, v236
v_fma_f32 v235, v235, v237, v236
v_mfma_f32_32x32x16_bf16 v[108:123], a[164:167], a[36:39], v[108:123]
ds_read_b128 a[160:163], v242 offset:14336
v_mul_f32 v232, v232, v128
v_mul_f32 v233, v233, v129
v_mul_f32 v234, v234, v130
v_mul_f32 v235, v235, v131
v_exp_f32 v232, v232
s_waitcnt lgkmcnt(3)
v_mfma_f32_32x32x16_bf16 v[108:123], a[144:147], a[40:43], v[108:123]
ds_read_b128 a[164:167], v242 offset:15360
v_exp_f32 v233, v233
v_exp_f32 v234, v234
v_mfma_f32_32x32x16_bf16 v[108:123], a[148:151], a[44:47], v[108:123]
ds_read_b128 a[144:147], v242 offset:16384
v_exp_f32 v235, v235
v_fma_f32 v232, v232, v238, v238
v_fma_f32 v233, v233, v238, v238
v_fma_f32 v234, v234, v238, v238
s_waitcnt lgkmcnt(3)
v_mfma_f32_32x32x16_bf16 v[108:123], a[152:155], a[48:51], v[108:123]
ds_read_b128 a[148:151], v242 offset:17408
v_fma_f32 v235, v235, v238, v238
v_rcp_f32 v232, v232
v_rcp_f32 v233, v233
v_mfma_f32_32x32x16_bf16 v[108:123], a[156:159], a[52:55], v[108:123]
ds_read_b128 a[152:155], v242 offset:18432
v_rcp_f32 v234, v234
v_rcp_f32 v235, v235
v_mul_f32 v72, v128, v232
s_waitcnt lgkmcnt(3)
v_mfma_f32_32x32x16_bf16 v[108:123], a[160:163], a[56:59], v[108:123]
ds_read_b128 a[156:159], v242 offset:19456
v_mul_f32 v73, v129, v233
v_mul_f32 v74, v130, v234
v_mul_f32 v75, v131, v235
v_mul_f32 v228, v132, v132
v_mul_f32 v229, v133, v133
v_mfma_f32_32x32x16_bf16 v[108:123], a[164:167], a[60:63], v[108:123]
ds_read_b128 a[160:163], v242 offset:20480
v_mul_f32 v230, v134, v134
v_mul_f32 v231, v135, v135
v_fma_f32 v228, v228, v237, v236
v_fma_f32 v229, v229, v237, v236
v_fma_f32 v230, v230, v237, v236
s_waitcnt lgkmcnt(3)
v_mfma_f32_32x32x16_bf16 v[108:123], a[144:147], a[64:67], v[108:123]
ds_read_b128 a[164:167], v242 offset:21504
v_fma_f32 v231, v231, v237, v236
v_mul_f32 v228, v228, v132
v_mul_f32 v229, v229, v133
v_mul_f32 v230, v230, v134
v_mul_f32 v231, v231, v135
v_mfma_f32_32x32x16_bf16 v[108:123], a[148:151], a[68:71], v[108:123]
ds_read_b128 a[144:147], v242 offset:22528
v_exp_f32 v228, v228
v_exp_f32 v229, v229
s_waitcnt lgkmcnt(3)
v_mfma_f32_32x32x16_bf16 v[108:123], a[152:155], a[72:75], v[108:123]
ds_read_b128 a[148:151], v242 offset:23552
v_exp_f32 v230, v230
v_exp_f32 v231, v231
v_fma_f32 v228, v228, v238, v238
v_mfma_f32_32x32x16_bf16 v[108:123], a[156:159], a[76:79], v[108:123]
ds_read_b128 a[152:155], v242 offset:24576
v_fma_f32 v229, v229, v238, v238
v_fma_f32 v230, v230, v238, v238
v_fma_f32 v231, v231, v238, v238
v_rcp_f32 v228, v228
s_waitcnt lgkmcnt(3)
v_mfma_f32_32x32x16_bf16 v[108:123], a[160:163], a[80:83], v[108:123]
ds_read_b128 a[156:159], v242 offset:25600
v_rcp_f32 v229, v229
v_rcp_f32 v230, v230
v_rcp_f32 v231, v231
v_mfma_f32_32x32x16_bf16 v[108:123], a[164:167], a[84:87], v[108:123]
ds_read_b128 a[160:163], v242 offset:26624
v_mul_f32 v76, v132, v228
v_mul_f32 v77, v133, v229
v_mul_f32 v78, v134, v230
v_mul_f32 v79, v135, v231
s_waitcnt lgkmcnt(3)
v_mfma_f32_32x32x16_bf16 v[108:123], a[144:147], a[88:91], v[108:123]
ds_read_b128 a[164:167], v242 offset:27648
v_mul_f32 v232, v136, v136
v_mul_f32 v233, v137, v137
v_mul_f32 v234, v138, v138
v_mul_f32 v235, v139, v139
v_fma_f32 v232, v232, v237, v236
v_mfma_f32_32x32x16_bf16 v[108:123], a[148:151], a[92:95], v[108:123]
ds_read_b128 a[144:147], v242 offset:28672
v_fma_f32 v233, v233, v237, v236
v_fma_f32 v234, v234, v237, v236
v_fma_f32 v235, v235, v237, v236
v_mul_f32 v232, v232, v136
v_mul_f32 v233, v233, v137
s_waitcnt lgkmcnt(3)
v_mfma_f32_32x32x16_bf16 v[108:123], a[152:155], a[96:99], v[108:123]
ds_read_b128 a[148:151], v242 offset:29696
v_mul_f32 v234, v234, v138
v_mul_f32 v235, v235, v139
v_exp_f32 v232, v232
v_exp_f32 v233, v233
v_mfma_f32_32x32x16_bf16 v[108:123], a[156:159], a[100:103], v[108:123]
ds_read_b128 a[152:155], v242 offset:30720
v_exp_f32 v234, v234
v_exp_f32 v235, v235
s_waitcnt lgkmcnt(3)
v_mfma_f32_32x32x16_bf16 v[108:123], a[160:163], a[104:107], v[108:123]
ds_read_b128 a[156:159], v242 offset:31744
v_fma_f32 v232, v232, v238, v238
v_fma_f32 v233, v233, v238, v238
v_fma_f32 v234, v234, v238, v238
v_fma_f32 v235, v235, v238, v238
v_mfma_f32_32x32x16_bf16 v[108:123], a[164:167], a[108:111], v[108:123]
ds_read_b128 a[160:163], v242 offset:32768
v_rcp_f32 v232, v232
v_rcp_f32 v233, v233
v_rcp_f32 v234, v234
s_waitcnt lgkmcnt(3)
v_mfma_f32_32x32x16_bf16 v[108:123], a[144:147], a[112:115], v[108:123]
ds_read_b128 a[164:167], v242 offset:33792
v_rcp_f32 v235, v235
v_mul_f32 v80, v136, v232
v_mul_f32 v81, v137, v233
v_mfma_f32_32x32x16_bf16 v[108:123], a[148:151], a[116:119], v[108:123]
ds_read_b128 a[144:147], v242 offset:34816
v_mul_f32 v82, v138, v234
v_mul_f32 v83, v139, v235
v_permlane16_swap_b32 v52, v56
v_permlane16_swap_b32 v53, v57
s_waitcnt lgkmcnt(3)
v_mfma_f32_32x32x16_bf16 v[108:123], a[152:155], a[120:123], v[108:123]
ds_read_b128 a[148:151], v242 offset:35840
v_permlane16_swap_b32 v54, v58
v_permlane16_swap_b32 v55, v59
v_mfma_f32_32x32x16_bf16 v[108:123], a[156:159], a[124:127], v[108:123]
ds_read_b128 a[152:155], v242 offset:36864
v_permlane16_swap_b32 v60, v64
v_permlane16_swap_b32 v61, v65
v_permlane16_swap_b32 v62, v66
s_waitcnt lgkmcnt(3)
v_mfma_f32_32x32x16_bf16 v[108:123], a[160:163], a[128:131], v[108:123]
v_permlane16_swap_b32 v63, v67
buffer_load_dwordx2 v[212:213], v6, s[8:11], s61 offen offset:0 sc1
s_waitcnt lgkmcnt(3)
v_mfma_f32_32x32x16_bf16 v[108:123], a[164:167], a[132:135], v[108:123]
buffer_load_dwordx2 v[214:215], v6, s[8:11], s61 offen offset:1024 sc1
buffer_load_dwordx2 v[216:217], v6, s[8:11], s61 offen offset:2048 sc1
buffer_load_dwordx2 v[218:219], v6, s[8:11], s61 offen offset:3072 sc1
s_waitcnt lgkmcnt(1)
v_mfma_f32_32x32x16_bf16 v[108:123], a[144:147], a[136:139], v[108:123]
buffer_load_dwordx2 v[220:221], v7, s[8:11], s61 offen offset:0 sc1
buffer_load_dwordx2 v[222:223], v7, s[8:11], s61 offen offset:1024 sc1
s_waitcnt lgkmcnt(1)
v_mfma_f32_32x32x16_bf16 v[108:123], a[148:151], a[140:143], v[108:123]
buffer_load_dwordx2 v[224:225], v7, s[8:11], s61 offen offset:2048 sc1
buffer_load_dwordx2 v[226:227], v7, s[8:11], s61 offen offset:3072 sc1
s_waitcnt lgkmcnt(0)
v_mfma_f32_32x32x16_bf16 v[108:123], a[152:155], v[248:251], v[108:123]
s_nop 7
v_permlane16_swap_b32 v68, v72
v_permlane16_swap_b32 v69, v73
v_permlane16_swap_b32 v70, v74
v_permlane16_swap_b32 v71, v75
v_permlane16_swap_b32 v76, v80
v_permlane16_swap_b32 v77, v81
v_permlane16_swap_b32 v78, v82
v_permlane16_swap_b32 v79, v83
v_mul_f32 v228, v108, v108
v_mul_f32 v229, v109, v109
v_mul_f32 v230, v110, v110
v_mul_f32 v231, v111, v111
v_fma_f32 v228, v228, v237, v236
v_fma_f32 v229, v229, v237, v236
v_fma_f32 v230, v230, v237, v236
v_fma_f32 v231, v231, v237, v236
v_mul_f32 v228, v228, v108
v_mul_f32 v229, v229, v109
v_mul_f32 v230, v230, v110
v_mul_f32 v231, v231, v111
v_exp_f32 v228, v228
v_exp_f32 v229, v229
v_exp_f32 v230, v230
v_exp_f32 v231, v231
v_fma_f32 v228, v228, v238, v238
v_fma_f32 v229, v229, v238, v238
v_fma_f32 v230, v230, v238, v238
v_fma_f32 v231, v231, v238, v238
v_rcp_f32 v228, v228
v_rcp_f32 v229, v229
v_rcp_f32 v230, v230
v_rcp_f32 v231, v231
v_mul_f32 v84, v108, v228
v_mul_f32 v85, v109, v229
v_mul_f32 v86, v110, v230
v_mul_f32 v87, v111, v231
v_mul_f32 v232, v112, v112
v_mul_f32 v233, v113, v113
v_mul_f32 v234, v114, v114
v_mul_f32 v235, v115, v115
v_fma_f32 v232, v232, v237, v236
v_fma_f32 v233, v233, v237, v236
v_fma_f32 v234, v234, v237, v236
v_fma_f32 v235, v235, v237, v236
v_mul_f32 v232, v232, v112
v_mul_f32 v233, v233, v113
v_mul_f32 v234, v234, v114
v_mul_f32 v235, v235, v115
v_exp_f32 v232, v232
v_exp_f32 v233, v233
v_exp_f32 v234, v234
v_exp_f32 v235, v235
v_fma_f32 v232, v232, v238, v238
v_fma_f32 v233, v233, v238, v238
v_fma_f32 v234, v234, v238, v238
v_fma_f32 v235, v235, v238, v238
v_rcp_f32 v232, v232
v_rcp_f32 v233, v233
v_rcp_f32 v234, v234
v_rcp_f32 v235, v235
v_mul_f32 v88, v112, v232
v_mul_f32 v89, v113, v233
v_mul_f32 v90, v114, v234
v_mul_f32 v91, v115, v235
v_mul_f32 v228, v116, v116
v_mul_f32 v229, v117, v117
v_mul_f32 v230, v118, v118
v_mul_f32 v231, v119, v119
v_fma_f32 v228, v228, v237, v236
v_fma_f32 v229, v229, v237, v236
v_fma_f32 v230, v230, v237, v236
v_fma_f32 v231, v231, v237, v236
v_mul_f32 v228, v228, v116
v_mul_f32 v229, v229, v117
v_mul_f32 v230, v230, v118
v_mul_f32 v231, v231, v119
v_exp_f32 v228, v228
v_exp_f32 v229, v229
v_exp_f32 v230, v230
v_exp_f32 v231, v231
v_fma_f32 v228, v228, v238, v238
v_fma_f32 v229, v229, v238, v238
v_fma_f32 v230, v230, v238, v238
v_fma_f32 v231, v231, v238, v238
v_rcp_f32 v228, v228
v_rcp_f32 v229, v229
v_rcp_f32 v230, v230
v_rcp_f32 v231, v231
v_mul_f32 v92, v116, v228
v_mul_f32 v93, v117, v229
v_mul_f32 v94, v118, v230
v_mul_f32 v95, v119, v231
v_mul_f32 v232, v120, v120
v_mul_f32 v233, v121, v121
v_mul_f32 v234, v122, v122
v_mul_f32 v235, v123, v123
v_fma_f32 v232, v232, v237, v236
v_fma_f32 v233, v233, v237, v236
v_fma_f32 v234, v234, v237, v236
v_fma_f32 v235, v235, v237, v236
v_mul_f32 v232, v232, v120
v_mul_f32 v233, v233, v121
v_mul_f32 v234, v234, v122
v_mul_f32 v235, v235, v123
v_exp_f32 v232, v232
v_exp_f32 v233, v233
v_exp_f32 v234, v234
v_exp_f32 v235, v235
v_fma_f32 v232, v232, v238, v238
v_fma_f32 v233, v233, v238, v238
v_fma_f32 v234, v234, v238, v238
v_fma_f32 v235, v235, v238, v238
v_rcp_f32 v232, v232
v_rcp_f32 v233, v233
v_rcp_f32 v234, v234
v_rcp_f32 v235, v235
v_mul_f32 v96, v120, v232
v_mul_f32 v97, v121, v233
v_mul_f32 v98, v122, v234
v_mul_f32 v99, v123, v235
s_mov_b32 s31, 0
s_waitcnt vmcnt(0)
L_stz_7:
v_cmp_eq_u32 vcc, 3212836864, v213
v_mov_b32 v230, 3212836864
s_mov_b64 s[34:35], vcc
v_cmp_eq_u32 s[32:33], v230, v215
s_nop 0
s_or_b64 s[34:35], s[34:35], s[32:33]
v_cmp_eq_u32 s[32:33], v230, v217
s_nop 0
s_or_b64 s[34:35], s[34:35], s[32:33]
v_cmp_eq_u32 s[32:33], v230, v219
s_nop 0
s_or_b64 s[34:35], s[34:35], s[32:33]
v_cmp_eq_u32 s[32:33], v230, v221
s_nop 0
s_or_b64 s[34:35], s[34:35], s[32:33]
v_cmp_eq_u32 s[32:33], v230, v223
s_nop 0
s_or_b64 s[34:35], s[34:35], s[32:33]
v_cmp_eq_u32 s[32:33], v230, v225
s_nop 0
s_or_b64 s[34:35], s[34:35], s[32:33]
v_cmp_eq_u32 s[32:33], v230, v227
s_nop 0
s_or_b64 s[34:35], s[34:35], s[32:33]
s_cbranch_scc0 L_stzok_8
s_add_u32 s31, s31, 1
s_cmp_gt_u32 s31, 200000
s_cbranch_scc1 L_stzok_8
buffer_load_dwordx2 v[212:213], v6, s[8:11], s61 offen offset:0 sc1
buffer_load_dwordx2 v[214:215], v6, s[8:11], s61 offen offset:1024 sc1
buffer_load_dwordx2 v[216:217], v6, s[8:11], s61 offen offset:2048 sc1
buffer_load_dwordx2 v[218:219], v6, s[8:11], s61 offen offset:3072 sc1
buffer_load_dwordx2 v[220:221], v7, s[8:11], s61 offen offset:0 sc1
buffer_load_dwordx2 v[222:223], v7, s[8:11], s61 offen offset:1024 sc1
buffer_load_dwordx2 v[224:225], v7, s[8:11], s61 offen offset:2048 sc1
buffer_load_dwordx2 v[226:227], v7, s[8:11], s61 offen offset:3072 sc1
s_waitcnt vmcnt(0)
s_branch L_stz_7
L_stzok_8:
v_permlane16_swap_b32 v84, v88
v_permlane16_swap_b32 v85, v89
v_permlane16_swap_b32 v86, v90
v_permlane16_swap_b32 v87, v91
v_permlane16_swap_b32 v92, v96
v_permlane16_swap_b32 v93, v97
v_permlane16_swap_b32 v94, v98
v_permlane16_swap_b32 v95, v99
v_add_f32 v228, v212, v214
v_add_f32 v229, v213, v215
v_add_f32 v228, v228, v216
v_add_f32 v229, v229, v217
v_add_f32 v228, v228, v218
v_add_f32 v229, v229, v219
v_add_f32 v228, v228, v220
v_add_f32 v229, v229, v221
v_add_f32 v228, v228, v222
v_add_f32 v229, v229, v223
v_add_f32 v228, v228, v224
v_add_f32 v229, v229, v225
v_add_f32 v228, v228, v226
v_add_f32 v229, v229, v227
v_mov_b32 v230, v228
v_mov_b32 v231, v229
s_mul_i32 s30, s24, 9728
s_add_u32 s30, s30, 124928
v_permlane32_swap_b32 v228, v230
v_permlane32_swap_b32 v229, v231
v_add_f32 v228, v228, v230
v_add_f32 v229, v229, v231
v_mul_f32 v228, 0x39e38e39, v228
v_mul_f32 v230, v228, v228
v_mul_f32 v229, 0x39e38e39, v229
v_sub_f32 v229, v229, v230
v_max_f32 v229, 0, v229
v_add_f32 v229, 0x3727c5ac, v229
v_rsq_f32 v230, v229
v_bfe_u32 v6, v1, 4, 5
v_mul_u32_u24 v212, 304, v6
v_add_u32 v212, s30, v212
v_lshrrev_b32 v6, 1, v3
v_lshl_add_u32 v7, v6, 4, v212
v_lshl_add_u32 v212, v6, 5, v212
v_mul_f32 v232, v228, v230
v_lshrrev_b32 v6, 2, v2
v_lshl_add_u32 v6, v3, 3, v6
v_mul_u32_u24 v213, 304, v6
v_and_b32 v6, 3, v2
v_lshl_add_u32 v213, v6, 3, v213
v_add_u32 v213, s30, v213
v_pk_fma_f32 v[140:141], v[140:141], v[230:231], v[232:233] op_sel_hi:[1,0,0] neg_lo:[0,0,1] neg_hi:[0,0,1]
v_pk_fma_f32 v[142:143], v[142:143], v[230:231], v[232:233] op_sel_hi:[1,0,0] neg_lo:[0,0,1] neg_hi:[0,0,1]
v_pk_fma_f32 v[144:145], v[144:145], v[230:231], v[232:233] op_sel_hi:[1,0,0] neg_lo:[0,0,1] neg_hi:[0,0,1]
v_pk_fma_f32 v[146:147], v[146:147], v[230:231], v[232:233] op_sel_hi:[1,0,0] neg_lo:[0,0,1] neg_hi:[0,0,1]
v_cvt_pk_bf16_f32 v108, v140, v141
v_cvt_pk_bf16_f32 v109, v142, v143
v_cvt_pk_bf16_f32 v110, v144, v145
v_cvt_pk_bf16_f32 v111, v146, v147
ds_write_b128 v212, v[108:111] offset:0
v_pk_fma_f32 v[148:149], v[148:149], v[230:231], v[232:233] op_sel_hi:[1,0,0] neg_lo:[0,0,1] neg_hi:[0,0,1]
v_pk_fma_f32 v[150:151], v[150:151], v[230:231], v[232:233] op_sel_hi:[1,0,0] neg_lo:[0,0,1] neg_hi:[0,0,1]
v_pk_fma_f32 v[152:153], v[152:153], v[230:231], v[232:233] op_sel_hi:[1,0,0] neg_lo:[0,0,1] neg_hi:[0,0,1]
v_pk_fma_f32 v[154:155], v[154:155], v[230:231], v[232:233] op_sel_hi:[1,0,0] neg_lo:[0,0,1] neg_hi:[0,0,1]
v_cvt_pk_bf16_f32 v112, v148, v149
v_cvt_pk_bf16_f32 v113, v150, v151
v_cvt_pk_bf16_f32 v114, v152, v153
v_cvt_pk_bf16_f32 v115, v154, v155
ds_write_b128 v212, v[112:115] offset:16
v_pk_fma_f32 v[156:157], v[156:157], v[230:231], v[232:233] op_sel_hi:[1,0,0] neg_lo:[0,0,1] neg_hi:[0,0,1]
v_pk_fma_f32 v[158:159], v[158:159], v[230:231], v[232:233] op_sel_hi:[1,0,0] neg_lo:[0,0,1] neg_hi:[0,0,1]
v_pk_fma_f32 v[160:161], v[160:161], v[230:231], v[232:233] op_sel_hi:[1,0,0] neg_lo:[0,0,1] neg_hi:[0,0,1]
v_pk_fma_f32 v[162:163], v[162:163], v[230:231], v[232:233] op_sel_hi:[1,0,0] neg_lo:[0,0,1] neg_hi:[0,0,1]
v_cvt_pk_bf16_f32 v116, v156, v157
v_cvt_pk_bf16_f32 v117, v158, v159
v_cvt_pk_bf16_f32 v118, v160, v161
v_cvt_pk_bf16_f32 v119, v162, v163
ds_write_b128 v212, v[116:119] offset:64
v_pk_fma_f32 v[164:165], v[164:165], v[230:231], v[232:233] op_sel_hi:[1,0,0] neg_lo:[0,0,1] neg_hi:[0,0,1]
v_pk_fma_f32 v[166:167], v[166:167], v[230:231], v[232:233] op_sel_hi:[1,0,0] neg_lo:[0,0,1] neg_hi:[0,0,1]
v_pk_fma_f32 v[168:169], v[168:169], v[230:231], v[232:233] op_sel_hi:[1,0,0] neg_lo:[0,0,1] neg_hi:[0,0,1]
v_pk_fma_f32 v[170:171], v[170:171], v[230:231], v[232:233] op_sel_hi:[1,0,0] neg_lo:[0,0,1] neg_hi:[0,0,1]
v_cvt_pk_bf16_f32 v120, v164, v165
v_cvt_pk_bf16_f32 v121, v166, v167
v_cvt_pk_bf16_f32 v122, v168, v169
v_cvt_pk_bf16_f32 v123, v170, v171
ds_write_b128 v212, v[120:123] offset:80
v_pk_fma_f32 v[172:173], v[172:173], v[230:231], v[232:233] op_sel_hi:[1,0,0] neg_lo:[0,0,1] neg_hi:[0,0,1]
v_pk_fma_f32 v[174:175], v[174:175], v[230:231], v[232:233] op_sel_hi:[1,0,0] neg_lo:[0,0,1] neg_hi:[0,0,1]
v_pk_fma_f32 v[176:177], v[176:177], v[230:231], v[232:233] op_sel_hi:[1,0,0] neg_lo:[0,0,1] neg_hi:[0,0,1]
v_pk_fma_f32 v[178:179], v[178:179], v[230:231], v[232:233] op_sel_hi:[1,0,0] neg_lo:[0,0,1] neg_hi:[0,0,1]
v_cvt_pk_bf16_f32 v124, v172, v173
v_cvt_pk_bf16_f32 v125, v174, v175
v_cvt_pk_bf16_f32 v126, v176, v177
v_cvt_pk_bf16_f32 v127, v178, v179
ds_write_b128 v212, v[124:127] offset:128
v_pk_fma_f32 v[180:181], v[180:181], v[230:231], v[232:233] op_sel_hi:[1,0,0] neg_lo:[0,0,1] neg_hi:[0,0,1]
v_pk_fma_f32 v[182:183], v[182:183], v[230:231], v[232:233] op_sel_hi:[1,0,0] neg_lo:[0,0,1] neg_hi:[0,0,1]
v_pk_fma_f32 v[184:185], v[184:185], v[230:231], v[232:233] op_sel_hi:[1,0,0] neg_lo:[0,0,1] neg_hi:[0,0,1]
v_pk_fma_f32 v[186:187], v[186:187], v[230:231], v[232:233] op_sel_hi:[1,0,0] neg_lo:[0,0,1] neg_hi:[0,0,1]
v_cvt_pk_bf16_f32 v128, v180, v181
v_cvt_pk_bf16_f32 v129, v182, v183
v_cvt_pk_bf16_f32 v130, v184, v185
v_cvt_pk_bf16_f32 v131, v186, v187
ds_write_b128 v212, v[128:131] offset:144
v_pk_fma_f32 v[188:189], v[188:189], v[230:231], v[232:233] op_sel_hi:[1,0,0] neg_lo:[0,0,1] neg_hi:[0,0,1]
v_pk_fma_f32 v[190:191], v[190:191], v[230:231], v[232:233] op_sel_hi:[1,0,0] neg_lo:[0,0,1] neg_hi:[0,0,1]
v_pk_fma_f32 v[192:193], v[192:193], v[230:231], v[232:233] op_sel_hi:[1,0,0] neg_lo:[0,0,1] neg_hi:[0,0,1]
v_pk_fma_f32 v[194:195], v[194:195], v[230:231], v[232:233] op_sel_hi:[1,0,0] neg_lo:[0,0,1] neg_hi:[0,0,1]
v_cvt_pk_bf16_f32 v132, v188, v189
v_cvt_pk_bf16_f32 v133, v190, v191
v_cvt_pk_bf16_f32 v134, v192, v193
v_cvt_pk_bf16_f32 v135, v194, v195
ds_write_b128 v212, v[132:135] offset:192
v_pk_fma_f32 v[196:197], v[196:197], v[230:231], v[232:233] op_sel_hi:[1,0,0] neg_lo:[0,0,1] neg_hi:[0,0,1]
v_pk_fma_f32 v[198:199], v[198:199], v[230:231], v[232:233] op_sel_hi:[1,0,0] neg_lo:[0,0,1] neg_hi:[0,0,1]
v_pk_fma_f32 v[200:201], v[200:201], v[230:231], v[232:233] op_sel_hi:[1,0,0] neg_lo:[0,0,1] neg_hi:[0,0,1]
v_pk_fma_f32 v[202:203], v[202:203], v[230:231], v[232:233] op_sel_hi:[1,0,0] neg_lo:[0,0,1] neg_hi:[0,0,1]
v_cvt_pk_bf16_f32 v136, v196, v197
v_cvt_pk_bf16_f32 v137, v198, v199
v_cvt_pk_bf16_f32 v138, v200, v201
v_cvt_pk_bf16_f32 v139, v202, v203
ds_write_b128 v212, v[136:139] offset:208
v_pk_fma_f32 v[204:205], v[204:205], v[230:231], v[232:233] op_sel_hi:[1,0,0] neg_lo:[0,0,1] neg_hi:[0,0,1]
v_pk_fma_f32 v[206:207], v[206:207], v[230:231], v[232:233] op_sel_hi:[1,0,0] neg_lo:[0,0,1] neg_hi:[0,0,1]
v_pk_fma_f32 v[208:209], v[208:209], v[230:231], v[232:233] op_sel_hi:[1,0,0] neg_lo:[0,0,1] neg_hi:[0,0,1]
v_pk_fma_f32 v[210:211], v[210:211], v[230:231], v[232:233] op_sel_hi:[1,0,0] neg_lo:[0,0,1] neg_hi:[0,0,1]
v_cvt_pk_bf16_f32 v108, v204, v205
v_cvt_pk_bf16_f32 v109, v206, v207
v_cvt_pk_bf16_f32 v110, v208, v209
v_cvt_pk_bf16_f32 v111, v210, v211
ds_write_b128 v7, v[108:111] offset:256
s_mul_i32 s30, s26, 589824
s_mul_i32 s31, s60, 9216
s_add_u32 s30, s30, s31
s_add_u32 s30, s30, 7340032
s_waitcnt lgkmcnt(0)
ds_read_b64_tr_b16 v[140:141], v213 offset:0
ds_read_b64_tr_b16 v[142:143], v213 offset:1216
ds_read_b64_tr_b16 v[144:145], v213 offset:32
ds_read_b64_tr_b16 v[146:147], v213 offset:1248
ds_read_b64_tr_b16 v[148:149], v213 offset:64
ds_read_b64_tr_b16 v[150:151], v213 offset:1280
ds_read_b64_tr_b16 v[152:153], v213 offset:96
ds_read_b64_tr_b16 v[154:155], v213 offset:1312
s_waitcnt lgkmcnt(6)
buffer_store_dwordx4 v[140:143], v1, s[8:11], s30 offen offset:0 sc1
ds_read_b64_tr_b16 v[156:157], v213 offset:128
ds_read_b64_tr_b16 v[158:159], v213 offset:1344
s_waitcnt lgkmcnt(6)
buffer_store_dwordx4 v[144:147], v1, s[8:11], s30 offen offset:1024 sc1
ds_read_b64_tr_b16 v[160:161], v213 offset:160
ds_read_b64_tr_b16 v[162:163], v213 offset:1376
s_waitcnt lgkmcnt(6)
buffer_store_dwordx4 v[148:151], v1, s[8:11], s30 offen offset:2048 sc1
ds_read_b64_tr_b16 v[164:165], v213 offset:192
ds_read_b64_tr_b16 v[166:167], v213 offset:1408
s_waitcnt lgkmcnt(6)
buffer_store_dwordx4 v[152:155], v1, s[8:11], s30 offen offset:3072 sc1
ds_read_b64_tr_b16 v[168:169], v213 offset:224
ds_read_b64_tr_b16 v[170:171], v213 offset:1440
s_add_u32 s30, s30, 4096
s_waitcnt lgkmcnt(6)
buffer_store_dwordx4 v[156:159], v1, s[8:11], s30 offen offset:0 sc1
ds_read_b64_tr_b16 v[172:173], v213 offset:256
ds_read_b64_tr_b16 v[174:175], v213 offset:1472
s_waitcnt lgkmcnt(6)
buffer_store_dwordx4 v[160:163], v1, s[8:11], s30 offen offset:1024 sc1
s_waitcnt lgkmcnt(4)
buffer_store_dwordx4 v[164:167], v1, s[8:11], s30 offen offset:2048 sc1
s_waitcnt lgkmcnt(2)
buffer_store_dwordx4 v[168:171], v1, s[8:11], s30 offen offset:3072 sc1
s_add_u32 s30, s30, 4096
s_waitcnt lgkmcnt(0)
buffer_store_dwordx4 v[172:175], v1, s[8:11], s30 offen offset:0 sc1
s_waitcnt vmcnt(0)
s_barrier
s_cmp_eq_u32 s24, 0
s_cbranch_scc0 L_sig_9
v_lshlrev_b32 v6, 7, v1
s_lshl_b32 s31, s26, 7
s_lshl_b32 s32, s25, 2
s_add_u32 s31, s31, s32
v_add_u32 v6, s31, v6
s_mov_b64 exec, 0xffff
s_mov_b32 s30, 26542080
buffer_store_dword v4, v6, s[8:11], s30 offen sc1
s_mov_b64 exec, -1
L_sig_9:
v_lshrrev_b32 v6, 7, v1
v_bfe_u32 v7, v1, 4, 3
v_lshrrev_b32 v8, 1, v6
v_xor_b32 v7, v7, v8
v_lshlrev_b32 v6, 12, v6
v_lshl_add_u32 v248, v7, 4, v6
v_xor_b32 v6, 64, v248
v_add_u32 v249, 31744, v6
v_add_u32 v250, 63488, v248
v_add_u32 v251, 95232, v6
s_lshl_b32 s64, s25, 19
s_lshl_b32 s30, s24, 17
s_add_u32 s64, s64, s30
s_lshl_b32 s71, s24, 12
s_mov_b32 s65, s71
s_mov_b32 m0, s65
s_add_u32 s65, s65, 16384
buffer_load_dwordx4 v248, s[12:15], s64 offen offset:0 lds
buffer_load_dwordx4 v249, s[12:15], s64 offen offset:1024 lds
buffer_load_dwordx4 v250, s[12:15], s64 offen offset:2048 lds
buffer_load_dwordx4 v251, s[12:15], s64 offen offset:3072 lds
s_add_u32 s64, s64, 128
s_cmp_ge_u32 s65, 98304
s_cselect_b32 s65, s71, s65
s_mov_b32 m0, s65
s_add_u32 s65, s65, 16384
buffer_load_dwordx4 v248, s[12:15], s64 offen offset:0 lds
buffer_load_dwordx4 v249, s[12:15], s64 offen offset:1024 lds
buffer_load_dwordx4 v250, s[12:15], s64 offen offset:2048 lds
buffer_load_dwordx4 v251, s[12:15], s64 offen offset:3072 lds
s_add_u32 s64, s64, 128
s_cmp_ge_u32 s65, 98304
s_cselect_b32 s65, s71, s65
s_mov_b32 m0, s65
s_add_u32 s65, s65, 16384
buffer_load_dwordx4 v248, s[12:15], s64 offen offset:0 lds
buffer_load_dwordx4 v249, s[12:15], s64 offen offset:1024 lds
buffer_load_dwordx4 v250, s[12:15], s64 offen offset:2048 lds
buffer_load_dwordx4 v251, s[12:15], s64 offen offset:3072 lds
s_add_u32 s64, s64, 128
s_cmp_ge_u32 s65, 98304
s_cselect_b32 s65, s71, s65
s_mov_b32 m0, s65
s_add_u32 s65, s65, 16384
buffer_load_dwordx4 v248, s[12:15], s64 offen offset:0 lds
buffer_load_dwordx4 v249, s[12:15], s64 offen offset:1024 lds
buffer_load_dwordx4 v250, s[12:15], s64 offen offset:2048 lds
buffer_load_dwordx4 v251, s[12:15], s64 offen offset:3072 lds
s_add_u32 s64, s64, 128
s_cmp_ge_u32 s65, 98304
s_cselect_b32 s65, s71, s65
s_mov_b32 m0, s65
s_add_u32 s65, s65, 16384
buffer_load_dwordx4 v248, s[12:15], s64 offen offset:0 lds
buffer_load_dwordx4 v249, s[12:15], s64 offen offset:1024 lds
buffer_load_dwordx4 v250, s[12:15], s64 offen offset:2048 lds
buffer_load_dwordx4 v251, s[12:15], s64 offen offset:3072 lds
s_add_u32 s64, s64, 128
s_cmp_ge_u32 s65, 98304
s_cselect_b32 s65, s71, s65
s_cmp_eq_u32 s24, 1
s_cbranch_scc0 L_polled_11
s_lshl_b32 s30, s80, 7
s_add_u32 s30, s30, 26542080
v_lshrrev_b32 v6, 2, v1
s_mov_b32 s31, 0
s_mov_b64 exec, 0xffff
L_poll_10:
buffer_load_dword v7, v6, s[8:11], s30 offen sc1
s_add_u32 s31, s31, 1
s_waitcnt vmcnt(0)
v_cmp_ne_u32 vcc, 1, v7
s_cmp_gt_u32 s31, 200000
s_cbranch_scc1 L_polled_11
s_cbranch_vccnz L_poll_10
L_polled_11:
s_mov_b64 exec, -1
s_waitcnt vmcnt(0)
s_barrier
s_mul_i32 s66, s26, 589824
s_mul_i32 s30, s24, 4608
s_add_u32 s66, s66, s30
s_add_u32 s66, s66, 7340032
s_add_u32 s72, s30, 108544
s_mov_b32 s67, s72
s_lshl_b32 s31, s25, 8
s_lshl_b32 s32, s24, 6
s_add_u32 s31, s31, s32
v_lshlrev_b32 v6, 1, v2
buffer_load_ushort v180, v6, s[20:23], s31 offen
buffer_load_ushort v184, v6, s[20:23], s31 offen offset:32
s_mov_b32 m0, s67
s_add_u32 s30, s66, 4096
buffer_load_dwordx4 v1, s[8:11], s66 offen offset:0 sc1 lds
buffer_load_dwordx4 v1, s[8:11], s66 offen offset:1024 sc1 lds
buffer_load_dwordx4 v1, s[8:11], s66 offen offset:2048 sc1 lds
buffer_load_dwordx4 v1, s[8:11], s66 offen offset:3072 sc1 lds
s_add_u32 m0, s67, 4096
s_mov_b32 exec_hi, 0
buffer_load_dwordx4 v1, s[8:11], s30 offen sc1 lds
s_mov_b64 exec, -1
s_add_u32 s67, s67, 18432
s_add_u32 s66, s66, 18432
s_cmp_ge_u32 s67, 163840
s_cselect_b32 s67, s72, s67
s_mov_b32 m0, s67
s_add_u32 s30, s66, 4096
buffer_load_dwordx4 v1, s[8:11], s66 offen offset:0 sc1 lds
buffer_load_dwordx4 v1, s[8:11], s66 offen offset:1024 sc1 lds
buffer_load_dwordx4 v1, s[8:11], s66 offen offset:2048 sc1 lds
buffer_load_dwordx4 v1, s[8:11], s66 offen offset:3072 sc1 lds
s_add_u32 m0, s67, 4096
s_mov_b32 exec_hi, 0
buffer_load_dwordx4 v1, s[8:11], s30 offen sc1 lds
s_mov_b64 exec, -1
s_add_u32 s67, s67, 18432
s_add_u32 s66, s66, 18432
s_cmp_ge_u32 s67, 163840
s_cselect_b32 s67, s72, s67
s_mov_b32 m0, s67
s_add_u32 s30, s66, 4096
buffer_load_dwordx4 v1, s[8:11], s66 offen offset:0 sc1 lds
buffer_load_dwordx4 v1, s[8:11], s66 offen offset:1024 sc1 lds
buffer_load_dwordx4 v1, s[8:11], s66 offen offset:2048 sc1 lds
buffer_load_dwordx4 v1, s[8:11], s66 offen offset:3072 sc1 lds
s_add_u32 m0, s67, 4096
s_mov_b32 exec_hi, 0
buffer_load_dwordx4 v1, s[8:11], s30 offen sc1 lds
s_mov_b64 exec, -1
s_add_u32 s67, s67, 18432
s_add_u32 s66, s66, 18432
s_cmp_ge_u32 s67, 163840
s_cselect_b32 s67, s72, s67
s_mov_b32 m0, s65
s_add_u32 s65, s65, 16384
buffer_load_dwordx4 v248, s[12:15], s64 offen offset:0 lds
buffer_load_dwordx4 v249, s[12:15], s64 offen offset:1024 lds
buffer_load_dwordx4 v250, s[12:15], s64 offen offset:2048 lds
buffer_load_dwordx4 v251, s[12:15], s64 offen offset:3072 lds
s_add_u32 s64, s64, 128
s_cmp_ge_u32 s65, 98304
s_cselect_b32 s65, s71, s65
v_lshrrev_b32 v6, 1, v2
v_xor_b32 v6, v6, v3
v_lshlrev_b32 v6, 4, v6
v_lshl_add_u32 v6, v2, 7, v6
v_add_u32 v192, s71, v6
v_xor_b32 v193, 64, v192
v_mov_b32 v188, v192
v_mov_b32 v189, v193
v_add_u32 v190, 108544, v1
s_mov_b32 s69, 0
s_mov_b32 s70, 108544
s_mov_b32 s68, 0
s_waitcnt vmcnt(14)
s_barrier
ds_read_b128 a[36:39], v188 offset:0
ds_read_b128 a[40:43], v188 offset:2048
ds_read_b128 a[0:3], v190 offset:0
ds_read_b128 a[4:7], v190 offset:1024
ds_read_b128 a[8:11], v190 offset:2048
ds_read_b128 a[12:15], v190 offset:3072
ds_read_b128 a[16:19], v190 offset:4096
ds_read_b128 a[20:23], v190 offset:5120
ds_read_b128 a[24:27], v190 offset:6144
ds_read_b128 a[28:31], v190 offset:7168
ds_read_b128 a[32:35], v190 offset:8192
v_lshlrev_b32 v180, 16, v180
v_lshlrev_b32 v184, 16, v184
v_mov_b32 v108, v180
v_mov_b32 v109, v180
v_mov_b32 v110, v180
v_mov_b32 v111, v180
v_mov_b32 v112, v184
v_mov_b32 v113, v184
v_mov_b32 v114, v184
v_mov_b32 v115, v184
v_mov_b32 v116, v180
v_mov_b32 v117, v180
v_mov_b32 v118, v180
v_mov_b32 v119, v180
v_mov_b32 v120, v184
v_mov_b32 v121, v184
v_mov_b32 v122, v184
v_mov_b32 v123, v184
v_mov_b32 v124, v180
v_mov_b32 v125, v180
v_mov_b32 v126, v180
v_mov_b32 v127, v180
v_mov_b32 v128, v184
v_mov_b32 v129, v184
v_mov_b32 v130, v184
v_mov_b32 v131, v184
v_mov_b32 v132, v180
v_mov_b32 v133, v180
v_mov_b32 v134, v180
v_mov_b32 v135, v180
v_mov_b32 v136, v184
v_mov_b32 v137, v184
v_mov_b32 v138, v184
v_mov_b32 v139, v184
v_mov_b32 v140, v180
v_mov_b32 v141, v180
v_mov_b32 v142, v180
v_mov_b32 v143, v180
v_mov_b32 v144, v184
v_mov_b32 v145, v184
v_mov_b32 v146, v184
v_mov_b32 v147, v184
v_mov_b32 v148, v180
v_mov_b32 v149, v180
v_mov_b32 v150, v180
v_mov_b32 v151, v180
v_mov_b32 v152, v184
v_mov_b32 v153, v184
v_mov_b32 v154, v184
v_mov_b32 v155, v184
v_mov_b32 v156, v180
v_mov_b32 v157, v180
v_mov_b32 v158, v180
v_mov_b32 v159, v180
v_mov_b32 v160, v184
v_mov_b32 v161, v184
v_mov_b32 v162, v184
v_mov_b32 v163, v184
v_mov_b32 v164, v180
v_mov_b32 v165, v180
v_mov_b32 v166, v180
v_mov_b32 v167, v180
v_mov_b32 v168, v184
v_mov_b32 v169, v184
v_mov_b32 v170, v184
v_mov_b32 v171, v184
v_mov_b32 v172, v180
v_mov_b32 v173, v180
v_mov_b32 v174, v180
v_mov_b32 v175, v180
v_mov_b32 v176, v184
v_mov_b32 v177, v184
v_mov_b32 v178, v184
v_mov_b32 v179, v184
L_p4_12:
s_waitcnt lgkmcnt(0)
v_mfma_f32_16x16x32_bf16 v[108:111], a[0:3], a[36:39], v[108:111]
ds_read_b128 a[80:83], v189 offset:0
v_mfma_f32_16x16x32_bf16 v[112:115], a[0:3], a[40:43], v[112:115]
ds_read_b128 a[84:87], v189 offset:2048
v_mfma_f32_16x16x32_bf16 v[116:119], a[4:7], a[36:39], v[116:119]
ds_read_b128 a[44:47], v190 offset:9216
v_mfma_f32_16x16x32_bf16 v[120:123], a[4:7], a[40:43], v[120:123]
ds_read_b128 a[48:51], v190 offset:10240
v_mfma_f32_16x16x32_bf16 v[124:127], a[8:11], a[36:39], v[124:127]
ds_read_b128 a[52:55], v190 offset:11264
v_mfma_f32_16x16x32_bf16 v[128:131], a[8:11], a[40:43], v[128:131]
ds_read_b128 a[56:59], v190 offset:12288
v_mfma_f32_16x16x32_bf16 v[132:135], a[12:15], a[36:39], v[132:135]
ds_read_b128 a[60:63], v190 offset:13312
v_mfma_f32_16x16x32_bf16 v[136:139], a[12:15], a[40:43], v[136:139]
ds_read_b128 a[64:67], v190 offset:14336
v_mfma_f32_16x16x32_bf16 v[140:143], a[16:19], a[36:39], v[140:143]
ds_read_b128 a[68:71], v190 offset:15360
v_mfma_f32_16x16x32_bf16 v[144:147], a[16:19], a[40:43], v[144:147]
ds_read_b128 a[72:75], v190 offset:16384
v_mfma_f32_16x16x32_bf16 v[148:151], a[20:23], a[36:39], v[148:151]
ds_read_b128 a[76:79], v190 offset:17408
v_mfma_f32_16x16x32_bf16 v[152:155], a[20:23], a[40:43], v[152:155]
s_add_u32 s69, s69, 16384
s_cmp_ge_u32 s69, 98304
v_mfma_f32_16x16x32_bf16 v[156:159], a[24:27], a[36:39], v[156:159]
s_cselect_b32 s69, 0, s69
s_add_u32 s70, s70, 18432
v_mfma_f32_16x16x32_bf16 v[160:163], a[24:27], a[40:43], v[160:163]
s_cmp_ge_u32 s70, 163840
s_cselect_b32 s70, 108544, s70
v_mfma_f32_16x16x32_bf16 v[164:167], a[28:31], a[36:39], v[164:167]
v_add_u32 v188, s69, v192
v_add_u32 v189, s69, v193
v_mfma_f32_16x16x32_bf16 v[168:171], a[28:31], a[40:43], v[168:171]
v_add_u32 v190, s70, v1
v_mfma_f32_16x16x32_bf16 v[172:175], a[32:35], a[36:39], v[172:175]
v_mfma_f32_16x16x32_bf16 v[176:179], a[32:35], a[40:43], v[176:179]
s_waitcnt vmcnt(9) lgkmcnt(0)
s_barrier
v_mfma_f32_16x16x32_bf16 v[108:111], a[44:47], a[80:83], v[108:111]
ds_read_b128 a[36:39], v188 offset:0
s_mov_b32 m0, s67
v_mfma_f32_16x16x32_bf16 v[112:115], a[44:47], a[84:87], v[112:115]
ds_read_b128 a[40:43], v188 offset:2048
s_add_u32 s30, s66, 4096
v_mfma_f32_16x16x32_bf16 v[116:119], a[48:51], a[80:83], v[116:119]
ds_read_b128 a[0:3], v190 offset:0
buffer_load_dwordx4 v1, s[8:11], s66 offen offset:0 sc1 lds
v_mfma_f32_16x16x32_bf16 v[120:123], a[48:51], a[84:87], v[120:123]
ds_read_b128 a[4:7], v190 offset:1024
buffer_load_dwordx4 v1, s[8:11], s66 offen offset:1024 sc1 lds
v_mfma_f32_16x16x32_bf16 v[124:127], a[52:55], a[80:83], v[124:127]
ds_read_b128 a[8:11], v190 offset:2048
buffer_load_dwordx4 v1, s[8:11], s66 offen offset:2048 sc1 lds
v_mfma_f32_16x16x32_bf16 v[128:131], a[52:55], a[84:87], v[128:131]
ds_read_b128 a[12:15], v190 offset:3072
buffer_load_dwordx4 v1, s[8:11], s66 offen offset:3072 sc1 lds
v_mfma_f32_16x16x32_bf16 v[132:135], a[56:59], a[80:83], v[132:135]
ds_read_b128 a[16:19], v190 offset:4096
s_add_u32 m0, s67, 4096
v_mfma_f32_16x16x32_bf16 v[136:139], a[56:59], a[84:87], v[136:139]
ds_read_b128 a[20:23], v190 offset:5120
s_mov_b32 exec_hi, 0
buffer_load_dwordx4 v1, s[8:11], s30 offen sc1 lds
s_mov_b64 exec, -1
v_mfma_f32_16x16x32_bf16 v[140:143], a[60:63], a[80:83], v[140:143]
ds_read_b128 a[24:27], v190 offset:6144
s_add_u32 s67, s67, 18432
v_mfma_f32_16x16x32_bf16 v[144:147], a[60:63], a[84:87], v[144:147]
ds_read_b128 a[28:31], v190 offset:7168
s_add_u32 s66, s66, 18432
v_mfma_f32_16x16x32_bf16 v[148:151], a[64:67], a[80:83], v[148:151]
ds_read_b128 a[32:35], v190 offset:8192
s_cmp_ge_u32 s67, 163840
v_mfma_f32_16x16x32_bf16 v[152:155], a[64:67], a[84:87], v[152:155]
s_cselect_b32 s67, s72, s67
s_mov_b32 m0, s65
v_mfma_f32_16x16x32_bf16 v[156:159], a[68:71], a[80:83], v[156:159]
s_add_u32 s65, s65, 16384
buffer_load_dwordx4 v248, s[12:15], s64 offen offset:0 lds
v_mfma_f32_16x16x32_bf16 v[160:163], a[68:71], a[84:87], v[160:163]
buffer_load_dwordx4 v249, s[12:15], s64 offen offset:1024 lds
buffer_load_dwordx4 v250, s[12:15], s64 offen offset:2048 lds
v_mfma_f32_16x16x32_bf16 v[164:167], a[72:75], a[80:83], v[164:167]
buffer_load_dwordx4 v251, s[12:15], s64 offen offset:3072 lds
s_add_u32 s64, s64, 128
v_mfma_f32_16x16x32_bf16 v[168:171], a[72:75], a[84:87], v[168:171]
s_cmp_ge_u32 s65, 98304
s_cselect_b32 s65, s71, s65
v_mfma_f32_16x16x32_bf16 v[172:175], a[76:79], a[80:83], v[172:175]
v_mfma_f32_16x16x32_bf16 v[176:179], a[76:79], a[84:87], v[176:179]
s_add_u32 s68, s68, 1
s_cmp_lt_u32 s68, 26
s_cbranch_scc1 L_p4_12
L_p4_13:
s_waitcnt lgkmcnt(0)
v_mfma_f32_16x16x32_bf16 v[108:111], a[0:3], a[36:39], v[108:111]
ds_read_b128 a[80:83], v189 offset:0
v_mfma_f32_16x16x32_bf16 v[112:115], a[0:3], a[40:43], v[112:115]
ds_read_b128 a[84:87], v189 offset:2048
v_mfma_f32_16x16x32_bf16 v[116:119], a[4:7], a[36:39], v[116:119]
ds_read_b128 a[44:47], v190 offset:9216
v_mfma_f32_16x16x32_bf16 v[120:123], a[4:7], a[40:43], v[120:123]
ds_read_b128 a[48:51], v190 offset:10240
v_mfma_f32_16x16x32_bf16 v[124:127], a[8:11], a[36:39], v[124:127]
ds_read_b128 a[52:55], v190 offset:11264
v_mfma_f32_16x16x32_bf16 v[128:131], a[8:11], a[40:43], v[128:131]
ds_read_b128 a[56:59], v190 offset:12288
v_mfma_f32_16x16x32_bf16 v[132:135], a[12:15], a[36:39], v[132:135]
ds_read_b128 a[60:63], v190 offset:13312
v_mfma_f32_16x16x32_bf16 v[136:139], a[12:15], a[40:43], v[136:139]
ds_read_b128 a[64:67], v190 offset:14336
v_mfma_f32_16x16x32_bf16 v[140:143], a[16:19], a[36:39], v[140:143]
ds_read_b128 a[68:71], v190 offset:15360
v_mfma_f32_16x16x32_bf16 v[144:147], a[16:19], a[40:43], v[144:147]
ds_read_b128 a[72:75], v190 offset:16384
v_mfma_f32_16x16x32_bf16 v[148:151], a[20:23], a[36:39], v[148:151]
ds_read_b128 a[76:79], v190 offset:17408
v_mfma_f32_16x16x32_bf16 v[152:155], a[20:23], a[40:43], v[152:155]
s_add_u32 s69, s69, 16384
s_cmp_ge_u32 s69, 98304
v_mfma_f32_16x16x32_bf16 v[156:159], a[24:27], a[36:39], v[156:159]
s_cselect_b32 s69, 0, s69
s_add_u32 s70, s70, 18432
v_mfma_f32_16x16x32_bf16 v[160:163], a[24:27], a[40:43], v[160:163]
s_cmp_ge_u32 s70, 163840
s_cselect_b32 s70, 108544, s70
v_mfma_f32_16x16x32_bf16 v[164:167], a[28:31], a[36:39], v[164:167]
v_add_u32 v188, s69, v192
v_add_u32 v189, s69, v193
v_mfma_f32_16x16x32_bf16 v[168:171], a[28:31], a[40:43], v[168:171]
v_add_u32 v190, s70, v1
v_mfma_f32_16x16x32_bf16 v[172:175], a[32:35], a[36:39], v[172:175]
v_mfma_f32_16x16x32_bf16 v[176:179], a[32:35], a[40:43], v[176:179]
s_waitcnt vmcnt(5) lgkmcnt(0)
s_barrier
v_mfma_f32_16x16x32_bf16 v[108:111], a[44:47], a[80:83], v[108:111]
ds_read_b128 a[36:39], v188 offset:0
s_mov_b32 m0, s67
v_mfma_f32_16x16x32_bf16 v[112:115], a[44:47], a[84:87], v[112:115]
ds_read_b128 a[40:43], v188 offset:2048
s_add_u32 s30, s66, 4096
v_mfma_f32_16x16x32_bf16 v[116:119], a[48:51], a[80:83], v[116:119]
ds_read_b128 a[0:3], v190 offset:0
buffer_load_dwordx4 v1, s[8:11], s66 offen offset:0 sc1 lds
v_mfma_f32_16x16x32_bf16 v[120:123], a[48:51], a[84:87], v[120:123]
ds_read_b128 a[4:7], v190 offset:1024
buffer_load_dwordx4 v1, s[8:11], s66 offen offset:1024 sc1 lds
v_mfma_f32_16x16x32_bf16 v[124:127], a[52:55], a[80:83], v[124:127]
ds_read_b128 a[8:11], v190 offset:2048
buffer_load_dwordx4 v1, s[8:11], s66 offen offset:2048 sc1 lds
v_mfma_f32_16x16x32_bf16 v[128:131], a[52:55], a[84:87], v[128:131]
ds_read_b128 a[12:15], v190 offset:3072
buffer_load_dwordx4 v1, s[8:11], s66 offen offset:3072 sc1 lds
v_mfma_f32_16x16x32_bf16 v[132:135], a[56:59], a[80:83], v[132:135]
ds_read_b128 a[16:19], v190 offset:4096
s_add_u32 m0, s67, 4096
v_mfma_f32_16x16x32_bf16 v[136:139], a[56:59], a[84:87], v[136:139]
ds_read_b128 a[20:23], v190 offset:5120
s_mov_b32 exec_hi, 0
buffer_load_dwordx4 v1, s[8:11], s30 offen sc1 lds
s_mov_b64 exec, -1
v_mfma_f32_16x16x32_bf16 v[140:143], a[60:63], a[80:83], v[140:143]
ds_read_b128 a[24:27], v190 offset:6144
s_add_u32 s67, s67, 18432
v_mfma_f32_16x16x32_bf16 v[144:147], a[60:63], a[84:87], v[144:147]
ds_read_b128 a[28:31], v190 offset:7168
s_add_u32 s66, s66, 18432
v_mfma_f32_16x16x32_bf16 v[148:151], a[64:67], a[80:83], v[148:151]
ds_read_b128 a[32:35], v190 offset:8192
s_cmp_ge_u32 s67, 163840
v_mfma_f32_16x16x32_bf16 v[152:155], a[64:67], a[84:87], v[152:155]
s_cselect_b32 s67, s72, s67
v_mfma_f32_16x16x32_bf16 v[156:159], a[68:71], a[80:83], v[156:159]
v_mfma_f32_16x16x32_bf16 v[160:163], a[68:71], a[84:87], v[160:163]
v_mfma_f32_16x16x32_bf16 v[164:167], a[72:75], a[80:83], v[164:167]
v_mfma_f32_16x16x32_bf16 v[168:171], a[72:75], a[84:87], v[168:171]
v_mfma_f32_16x16x32_bf16 v[172:175], a[76:79], a[80:83], v[172:175]
v_mfma_f32_16x16x32_bf16 v[176:179], a[76:79], a[84:87], v[176:179]
s_add_u32 s68, s68, 1
s_cmp_lt_u32 s68, 29
s_cbranch_scc1 L_p4_13
s_waitcnt lgkmcnt(0)
v_mfma_f32_16x16x32_bf16 v[108:111], a[0:3], a[36:39], v[108:111]
ds_read_b128 a[80:83], v189 offset:0
v_mfma_f32_16x16x32_bf16 v[112:115], a[0:3], a[40:43], v[112:115]
ds_read_b128 a[84:87], v189 offset:2048
v_mfma_f32_16x16x32_bf16 v[116:119], a[4:7], a[36:39], v[116:119]
ds_read_b128 a[44:47], v190 offset:9216
v_mfma_f32_16x16x32_bf16 v[120:123], a[4:7], a[40:43], v[120:123]
ds_read_b128 a[48:51], v190 offset:10240
v_mfma_f32_16x16x32_bf16 v[124:127], a[8:11], a[36:39], v[124:127]
ds_read_b128 a[52:55], v190 offset:11264
v_mfma_f32_16x16x32_bf16 v[128:131], a[8:11], a[40:43], v[128:131]
ds_read_b128 a[56:59], v190 offset:12288
v_mfma_f32_16x16x32_bf16 v[132:135], a[12:15], a[36:39], v[132:135]
ds_read_b128 a[60:63], v190 offset:13312
v_mfma_f32_16x16x32_bf16 v[136:139], a[12:15], a[40:43], v[136:139]
ds_read_b128 a[64:67], v190 offset:14336
v_mfma_f32_16x16x32_bf16 v[140:143], a[16:19], a[36:39], v[140:143]
ds_read_b128 a[68:71], v190 offset:15360
v_mfma_f32_16x16x32_bf16 v[144:147], a[16:19], a[40:43], v[144:147]
ds_read_b128 a[72:75], v190 offset:16384
v_mfma_f32_16x16x32_bf16 v[148:151], a[20:23], a[36:39], v[148:151]
ds_read_b128 a[76:79], v190 offset:17408
v_mfma_f32_16x16x32_bf16 v[152:155], a[20:23], a[40:43], v[152:155]
s_add_u32 s69, s69, 16384
s_cmp_ge_u32 s69, 98304
v_mfma_f32_16x16x32_bf16 v[156:159], a[24:27], a[36:39], v[156:159]
s_cselect_b32 s69, 0, s69
s_add_u32 s70, s70, 18432
v_mfma_f32_16x16x32_bf16 v[160:163], a[24:27], a[40:43], v[160:163]
s_cmp_ge_u32 s70, 163840
s_cselect_b32 s70, 108544, s70
v_mfma_f32_16x16x32_bf16 v[164:167], a[28:31], a[36:39], v[164:167]
v_add_u32 v188, s69, v192
v_add_u32 v189, s69, v193
v_mfma_f32_16x16x32_bf16 v[168:171], a[28:31], a[40:43], v[168:171]
v_add_u32 v190, s70, v1
v_mfma_f32_16x16x32_bf16 v[172:175], a[32:35], a[36:39], v[172:175]
v_mfma_f32_16x16x32_bf16 v[176:179], a[32:35], a[40:43], v[176:179]
s_waitcnt vmcnt(5) lgkmcnt(0)
s_barrier
v_mfma_f32_16x16x32_bf16 v[108:111], a[44:47], a[80:83], v[108:111]
ds_read_b128 a[36:39], v188 offset:0
v_mfma_f32_16x16x32_bf16 v[112:115], a[44:47], a[84:87], v[112:115]
ds_read_b128 a[40:43], v188 offset:2048
v_mfma_f32_16x16x32_bf16 v[116:119], a[48:51], a[80:83], v[116:119]
ds_read_b128 a[0:3], v190 offset:0
v_mfma_f32_16x16x32_bf16 v[120:123], a[48:51], a[84:87], v[120:123]
ds_read_b128 a[4:7], v190 offset:1024
v_mfma_f32_16x16x32_bf16 v[124:127], a[52:55], a[80:83], v[124:127]
ds_read_b128 a[8:11], v190 offset:2048
v_mfma_f32_16x16x32_bf16 v[128:131], a[52:55], a[84:87], v[128:131]
ds_read_b128 a[12:15], v190 offset:3072
v_mfma_f32_16x16x32_bf16 v[132:135], a[56:59], a[80:83], v[132:135]
ds_read_b128 a[16:19], v190 offset:4096
v_mfma_f32_16x16x32_bf16 v[136:139], a[56:59], a[84:87], v[136:139]
ds_read_b128 a[20:23], v190 offset:5120
v_mfma_f32_16x16x32_bf16 v[140:143], a[60:63], a[80:83], v[140:143]
ds_read_b128 a[24:27], v190 offset:6144
v_mfma_f32_16x16x32_bf16 v[144:147], a[60:63], a[84:87], v[144:147]
ds_read_b128 a[28:31], v190 offset:7168
v_mfma_f32_16x16x32_bf16 v[148:151], a[64:67], a[80:83], v[148:151]
ds_read_b128 a[32:35], v190 offset:8192
v_mfma_f32_16x16x32_bf16 v[152:155], a[64:67], a[84:87], v[152:155]
v_mfma_f32_16x16x32_bf16 v[156:159], a[68:71], a[80:83], v[156:159]
v_mfma_f32_16x16x32_bf16 v[160:163], a[68:71], a[84:87], v[160:163]
v_mfma_f32_16x16x32_bf16 v[164:167], a[72:75], a[80:83], v[164:167]
v_mfma_f32_16x16x32_bf16 v[168:171], a[72:75], a[84:87], v[168:171]
v_mfma_f32_16x16x32_bf16 v[172:175], a[76:79], a[80:83], v[172:175]
v_mfma_f32_16x16x32_bf16 v[176:179], a[76:79], a[84:87], v[176:179]
s_waitcnt lgkmcnt(0)
v_mfma_f32_16x16x32_bf16 v[108:111], a[0:3], a[36:39], v[108:111]
ds_read_b128 a[80:83], v189 offset:0
v_mfma_f32_16x16x32_bf16 v[112:115], a[0:3], a[40:43], v[112:115]
ds_read_b128 a[84:87], v189 offset:2048
v_mfma_f32_16x16x32_bf16 v[116:119], a[4:7], a[36:39], v[116:119]
ds_read_b128 a[44:47], v190 offset:9216
v_mfma_f32_16x16x32_bf16 v[120:123], a[4:7], a[40:43], v[120:123]
ds_read_b128 a[48:51], v190 offset:10240
v_mfma_f32_16x16x32_bf16 v[124:127], a[8:11], a[36:39], v[124:127]
ds_read_b128 a[52:55], v190 offset:11264
v_mfma_f32_16x16x32_bf16 v[128:131], a[8:11], a[40:43], v[128:131]
ds_read_b128 a[56:59], v190 offset:12288
v_mfma_f32_16x16x32_bf16 v[132:135], a[12:15], a[36:39], v[132:135]
ds_read_b128 a[60:63], v190 offset:13312
v_mfma_f32_16x16x32_bf16 v[136:139], a[12:15], a[40:43], v[136:139]
ds_read_b128 a[64:67], v190 offset:14336
v_mfma_f32_16x16x32_bf16 v[140:143], a[16:19], a[36:39], v[140:143]
ds_read_b128 a[68:71], v190 offset:15360
v_mfma_f32_16x16x32_bf16 v[144:147], a[16:19], a[40:43], v[144:147]
ds_read_b128 a[72:75], v190 offset:16384
v_mfma_f32_16x16x32_bf16 v[148:151], a[20:23], a[36:39], v[148:151]
ds_read_b128 a[76:79], v190 offset:17408
v_mfma_f32_16x16x32_bf16 v[152:155], a[20:23], a[40:43], v[152:155]
s_add_u32 s69, s69, 16384
s_cmp_ge_u32 s69, 98304
v_mfma_f32_16x16x32_bf16 v[156:159], a[24:27], a[36:39], v[156:159]
s_cselect_b32 s69, 0, s69
s_add_u32 s70, s70, 18432
v_mfma_f32_16x16x32_bf16 v[160:163], a[24:27], a[40:43], v[160:163]
s_cmp_ge_u32 s70, 163840
s_cselect_b32 s70, 108544, s70
v_mfma_f32_16x16x32_bf16 v[164:167], a[28:31], a[36:39], v[164:167]
v_add_u32 v188, s69, v192
v_add_u32 v189, s69, v193
v_mfma_f32_16x16x32_bf16 v[168:171], a[28:31], a[40:43], v[168:171]
v_add_u32 v190, s70, v1
v_mfma_f32_16x16x32_bf16 v[172:175], a[32:35], a[36:39], v[172:175]
v_mfma_f32_16x16x32_bf16 v[176:179], a[32:35], a[40:43], v[176:179]
s_waitcnt vmcnt(0) lgkmcnt(0)
s_barrier
v_mfma_f32_16x16x32_bf16 v[108:111], a[44:47], a[80:83], v[108:111]
ds_read_b128 a[36:39], v188 offset:0
v_mfma_f32_16x16x32_bf16 v[112:115], a[44:47], a[84:87], v[112:115]
ds_read_b128 a[40:43], v188 offset:2048
v_mfma_f32_16x16x32_bf16 v[116:119], a[48:51], a[80:83], v[116:119]
ds_read_b128 a[0:3], v190 offset:0
v_mfma_f32_16x16x32_bf16 v[120:123], a[48:51], a[84:87], v[120:123]
ds_read_b128 a[4:7], v190 offset:1024
v_mfma_f32_16x16x32_bf16 v[124:127], a[52:55], a[80:83], v[124:127]
ds_read_b128 a[8:11], v190 offset:2048
v_mfma_f32_16x16x32_bf16 v[128:131], a[52:55], a[84:87], v[128:131]
ds_read_b128 a[12:15], v190 offset:3072
v_mfma_f32_16x16x32_bf16 v[132:135], a[56:59], a[80:83], v[132:135]
ds_read_b128 a[16:19], v190 offset:4096
v_mfma_f32_16x16x32_bf16 v[136:139], a[56:59], a[84:87], v[136:139]
ds_read_b128 a[20:23], v190 offset:5120
v_mfma_f32_16x16x32_bf16 v[140:143], a[60:63], a[80:83], v[140:143]
ds_read_b128 a[24:27], v190 offset:6144
v_mfma_f32_16x16x32_bf16 v[144:147], a[60:63], a[84:87], v[144:147]
ds_read_b128 a[28:31], v190 offset:7168
v_mfma_f32_16x16x32_bf16 v[148:151], a[64:67], a[80:83], v[148:151]
ds_read_b128 a[32:35], v190 offset:8192
v_mfma_f32_16x16x32_bf16 v[152:155], a[64:67], a[84:87], v[152:155]
v_mfma_f32_16x16x32_bf16 v[156:159], a[68:71], a[80:83], v[156:159]
v_mfma_f32_16x16x32_bf16 v[160:163], a[68:71], a[84:87], v[160:163]
v_mfma_f32_16x16x32_bf16 v[164:167], a[72:75], a[80:83], v[164:167]
v_mfma_f32_16x16x32_bf16 v[168:171], a[72:75], a[84:87], v[168:171]
v_mfma_f32_16x16x32_bf16 v[172:175], a[76:79], a[80:83], v[172:175]
v_mfma_f32_16x16x32_bf16 v[176:179], a[76:79], a[84:87], v[176:179]
s_waitcnt lgkmcnt(0)
v_mfma_f32_16x16x32_bf16 v[108:111], a[0:3], a[36:39], v[108:111]
ds_read_b128 a[80:83], v189 offset:0
v_mfma_f32_16x16x32_bf16 v[112:115], a[0:3], a[40:43], v[112:115]
ds_read_b128 a[84:87], v189 offset:2048
v_mfma_f32_16x16x32_bf16 v[116:119], a[4:7], a[36:39], v[116:119]
ds_read_b128 a[44:47], v190 offset:9216
v_mfma_f32_16x16x32_bf16 v[120:123], a[4:7], a[40:43], v[120:123]
ds_read_b128 a[48:51], v190 offset:10240
v_mfma_f32_16x16x32_bf16 v[124:127], a[8:11], a[36:39], v[124:127]
ds_read_b128 a[52:55], v190 offset:11264
v_mfma_f32_16x16x32_bf16 v[128:131], a[8:11], a[40:43], v[128:131]
ds_read_b128 a[56:59], v190 offset:12288
v_mfma_f32_16x16x32_bf16 v[132:135], a[12:15], a[36:39], v[132:135]
ds_read_b128 a[60:63], v190 offset:13312
v_mfma_f32_16x16x32_bf16 v[136:139], a[12:15], a[40:43], v[136:139]
ds_read_b128 a[64:67], v190 offset:14336
v_mfma_f32_16x16x32_bf16 v[140:143], a[16:19], a[36:39], v[140:143]
ds_read_b128 a[68:71], v190 offset:15360
v_mfma_f32_16x16x32_bf16 v[144:147], a[16:19], a[40:43], v[144:147]
ds_read_b128 a[72:75], v190 offset:16384
v_mfma_f32_16x16x32_bf16 v[148:151], a[20:23], a[36:39], v[148:151]
ds_read_b128 a[76:79], v190 offset:17408
v_mfma_f32_16x16x32_bf16 v[152:155], a[20:23], a[40:43], v[152:155]
s_add_u32 s69, s69, 16384
s_cmp_ge_u32 s69, 98304
v_mfma_f32_16x16x32_bf16 v[156:159], a[24:27], a[36:39], v[156:159]
s_cselect_b32 s69, 0, s69
s_add_u32 s70, s70, 18432
v_mfma_f32_16x16x32_bf16 v[160:163], a[24:27], a[40:43], v[160:163]
s_cmp_ge_u32 s70, 163840
s_cselect_b32 s70, 108544, s70
v_mfma_f32_16x16x32_bf16 v[164:167], a[28:31], a[36:39], v[164:167]
v_add_u32 v188, s69, v192
v_add_u32 v189, s69, v193
v_mfma_f32_16x16x32_bf16 v[168:171], a[28:31], a[40:43], v[168:171]
v_add_u32 v190, s70, v1
v_mfma_f32_16x16x32_bf16 v[172:175], a[32:35], a[36:39], v[172:175]
v_mfma_f32_16x16x32_bf16 v[176:179], a[32:35], a[40:43], v[176:179]
s_waitcnt vmcnt(0) lgkmcnt(0)
s_barrier
v_mfma_f32_16x16x32_bf16 v[108:111], a[44:47], a[80:83], v[108:111]
v_mfma_f32_16x16x32_bf16 v[112:115], a[44:47], a[84:87], v[112:115]
v_mfma_f32_16x16x32_bf16 v[116:119], a[48:51], a[80:83], v[116:119]
v_mfma_f32_16x16x32_bf16 v[120:123], a[48:51], a[84:87], v[120:123]
v_mfma_f32_16x16x32_bf16 v[124:127], a[52:55], a[80:83], v[124:127]
v_mfma_f32_16x16x32_bf16 v[128:131], a[52:55], a[84:87], v[128:131]
v_mfma_f32_16x16x32_bf16 v[132:135], a[56:59], a[80:83], v[132:135]
v_mfma_f32_16x16x32_bf16 v[136:139], a[56:59], a[84:87], v[136:139]
v_mfma_f32_16x16x32_bf16 v[140:143], a[60:63], a[80:83], v[140:143]
v_mfma_f32_16x16x32_bf16 v[144:147], a[60:63], a[84:87], v[144:147]
v_mfma_f32_16x16x32_bf16 v[148:151], a[64:67], a[80:83], v[148:151]
v_mfma_f32_16x16x32_bf16 v[152:155], a[64:67], a[84:87], v[152:155]
v_mfma_f32_16x16x32_bf16 v[156:159], a[68:71], a[80:83], v[156:159]
v_mfma_f32_16x16x32_bf16 v[160:163], a[68:71], a[84:87], v[160:163]
v_mfma_f32_16x16x32_bf16 v[164:167], a[72:75], a[80:83], v[164:167]
v_mfma_f32_16x16x32_bf16 v[168:171], a[72:75], a[84:87], v[168:171]
v_mfma_f32_16x16x32_bf16 v[172:175], a[76:79], a[80:83], v[172:175]
v_mfma_f32_16x16x32_bf16 v[176:179], a[76:79], a[84:87], v[176:179]
s_lshl_b32 s30, s25, 3
s_lshl_b32 s31, s24, 1
s_add_u32 s30, s30, s31
s_mul_i32 s30, s30, 73728
s_add_u32 s30, s30, 16777216
s_mul_i32 s31, s26, 4608
s_add_u32 s30, s30, s31
s_and_b32 s32, s26, 1
s_lshl_b32 s31, s32, 9
s_add_u32 s31, s31, s30
s_xor_b32 s32, s32, 1
s_lshl_b32 s32, s32, 12
s_add_u32 s32, s32, s30
v_add_u32 v6, 73728, v1
v_and_b32 v7, 1, v3
v_mul_u32_u24 v7, 73728, v7
v_lshrrev_b32 v8, 1, v3
v_lshl_add_u32 v7, v8, 8, v7
v_lshl_add_u32 v7, v2, 4, v7
v_pk_mul_f32 v[108:109], v[108:109], v[36:37]
v_pk_mul_f32 v[110:111], v[110:111], v[38:39]
v_cvt_pk_bf16_f32 v196, v108, v109
v_cvt_pk_bf16_f32 v197, v110, v111
v_pk_mul_f32 v[116:117], v[116:117], v[44:45]
v_pk_mul_f32 v[118:119], v[118:119], v[46:47]
v_cvt_pk_bf16_f32 v198, v116, v117
v_cvt_pk_bf16_f32 v199, v118, v119
buffer_store_dwordx4 v[196:199], v1, s[8:11], s31 offen offset:0 sc1
v_pk_mul_f32 v[112:113], v[112:113], v[40:41]
v_pk_mul_f32 v[114:115], v[114:115], v[42:43]
v_cvt_pk_bf16_f32 v200, v112, v113
v_cvt_pk_bf16_f32 v201, v114, v115
v_pk_mul_f32 v[120:121], v[120:121], v[48:49]
v_pk_mul_f32 v[122:123], v[122:123], v[50:51]
v_cvt_pk_bf16_f32 v202, v120, v121
v_cvt_pk_bf16_f32 v203, v122, v123
buffer_store_dwordx4 v[200:203], v6, s[8:11], s31 offen offset:0 sc1
v_pk_mul_f32 v[124:125], v[124:125], v[52:53]
v_pk_mul_f32 v[126:127], v[126:127], v[54:55]
v_cvt_pk_bf16_f32 v204, v124, v125
v_cvt_pk_bf16_f32 v205, v126, v127
v_pk_mul_f32 v[132:133], v[132:133], v[60:61]
v_pk_mul_f32 v[134:135], v[134:135], v[62:63]
v_cvt_pk_bf16_f32 v206, v132, v133
v_cvt_pk_bf16_f32 v207, v134, v135
buffer_store_dwordx4 v[204:207], v1, s[8:11], s31 offen offset:1024 sc1
v_pk_mul_f32 v[128:129], v[128:129], v[56:57]
v_pk_mul_f32 v[130:131], v[130:131], v[58:59]
v_cvt_pk_bf16_f32 v208, v128, v129
v_cvt_pk_bf16_f32 v209, v130, v131
v_pk_mul_f32 v[136:137], v[136:137], v[64:65]
v_pk_mul_f32 v[138:139], v[138:139], v[66:67]
v_cvt_pk_bf16_f32 v210, v136, v137
v_cvt_pk_bf16_f32 v211, v138, v139
buffer_store_dwordx4 v[208:211], v6, s[8:11], s31 offen offset:1024 sc1
v_pk_mul_f32 v[140:141], v[140:141], v[68:69]
v_pk_mul_f32 v[142:143], v[142:143], v[70:71]
v_cvt_pk_bf16_f32 v212, v140, v141
v_cvt_pk_bf16_f32 v213, v142, v143
v_pk_mul_f32 v[148:149], v[148:149], v[76:77]
v_pk_mul_f32 v[150:151], v[150:151], v[78:79]
v_cvt_pk_bf16_f32 v214, v148, v149
v_cvt_pk_bf16_f32 v215, v150, v151
buffer_store_dwordx4 v[212:215], v1, s[8:11], s31 offen offset:2048 sc1
v_pk_mul_f32 v[144:145], v[144:145], v[72:73]
v_pk_mul_f32 v[146:147], v[146:147], v[74:75]
v_cvt_pk_bf16_f32 v216, v144, v145
v_cvt_pk_bf16_f32 v217, v146, v147
v_pk_mul_f32 v[152:153], v[152:153], v[80:81]
v_pk_mul_f32 v[154:155], v[154:155], v[82:83]
v_cvt_pk_bf16_f32 v218, v152, v153
v_cvt_pk_bf16_f32 v219, v154, v155
buffer_store_dwordx4 v[216:219], v6, s[8:11], s31 offen offset:2048 sc1
v_pk_mul_f32 v[156:157], v[156:157], v[84:85]
v_pk_mul_f32 v[158:159], v[158:159], v[86:87]
v_cvt_pk_bf16_f32 v220, v156, v157
v_cvt_pk_bf16_f32 v221, v158, v159
v_pk_mul_f32 v[164:165], v[164:165], v[92:93]
v_pk_mul_f32 v[166:167], v[166:167], v[94:95]
v_cvt_pk_bf16_f32 v222, v164, v165
v_cvt_pk_bf16_f32 v223, v166, v167
buffer_store_dwordx4 v[220:223], v1, s[8:11], s31 offen offset:3072 sc1
v_pk_mul_f32 v[160:161], v[160:161], v[88:89]
v_pk_mul_f32 v[162:163], v[162:163], v[90:91]
v_cvt_pk_bf16_f32 v224, v160, v161
v_cvt_pk_bf16_f32 v225, v162, v163
v_pk_mul_f32 v[168:169], v[168:169], v[96:97]
v_pk_mul_f32 v[170:171], v[170:171], v[98:99]
v_cvt_pk_bf16_f32 v226, v168, v169
v_cvt_pk_bf16_f32 v227, v170, v171
buffer_store_dwordx4 v[224:227], v6, s[8:11], s31 offen offset:3072 sc1
v_pk_mul_f32 v[172:173], v[172:173], v[100:101]
v_pk_mul_f32 v[174:175], v[174:175], v[102:103]
v_cvt_pk_bf16_f32 v228, v172, v173
v_cvt_pk_bf16_f32 v229, v174, v175
v_pk_mul_f32 v[176:177], v[176:177], v[104:105]
v_pk_mul_f32 v[178:179], v[178:179], v[106:107]
v_cvt_pk_bf16_f32 v230, v176, v177
v_cvt_pk_bf16_f32 v231, v178, v179
s_nop 0
v_permlane16_swap_b32 v228, v230
v_permlane16_swap_b32 v229, v231
buffer_store_dwordx4 v[228:231], v7, s[8:11], s32 offen sc1
s_waitcnt vmcnt(0)
s_barrier
s_cmp_eq_u32 s24, 0
s_cbranch_scc0 L_sig_14
v_lshlrev_b32 v6, 3, v1
s_lshl_b32 s31, s25, 11
s_lshl_b32 s32, s26, 2
s_add_u32 s31, s31, s32
v_add_u32 v6, s31, v6
s_mov_b64 exec, 0xffff
s_mov_b32 s30, 26574848
buffer_store_dword v4, v6, s[8:11], s30 offen sc1
s_mov_b64 exec, -1
L_sig_14:
s_mul_i32 s62, s28, 331776
s_add_u32 s62, s62, 8241152
s_add_u32 s37, s62, 0
s_mul_i32 s38, s24, 9216
s_add_u32 s39, s38, s37
s_add_u32 m0, s38, 0
s_nop 0
buffer_load_dwordx4 v1, s[4:7], s39 offen offset:0  lds
buffer_load_dwordx4 v1, s[4:7], s39 offen offset:1024  lds
buffer_load_dwordx4 v1, s[4:7], s39 offen offset:2048  lds
buffer_load_dwordx4 v1, s[4:7], s39 offen offset:3072  lds
s_add_u32 m0, m0, 4096
s_add_u32 s39, s39, 4096
buffer_load_dwordx4 v1, s[4:7], s39 offen offset:0  lds
buffer_load_dwordx4 v1, s[4:7], s39 offen offset:1024  lds
buffer_load_dwordx4 v1, s[4:7], s39 offen offset:2048  lds
buffer_load_dwordx4 v1, s[4:7], s39 offen offset:3072  lds
s_add_u32 m0, m0, 4096
s_add_u32 s39, s39, 4096
buffer_load_dwordx4 v1, s[4:7], s39 offen offset:0  lds
s_add_u32 s37, s62, 36864
s_mul_i32 s38, s24, 9216
s_add_u32 s39, s38, s37
s_add_u32 m0, s38, 36864
s_nop 0
buffer_load_dwordx4 v1, s[4:7], s39 offen offset:0  lds
buffer_load_dwordx4 v1, s[4:7], s39 offen offset:1024  lds
buffer_load_dwordx4 v1, s[4:7], s39 offen offset:2048  lds
buffer_load_dwordx4 v1, s[4:7], s39 offen offset:3072  lds
s_add_u32 m0, m0, 4096
s_add_u32 s39, s39, 4096
buffer_load_dwordx4 v1, s[4:7], s39 offen offset:0  lds
buffer_load_dwordx4 v1, s[4:7], s39 offen offset:1024  lds
buffer_load_dwordx4 v1, s[4:7], s39 offen offset:2048  lds
buffer_load_dwordx4 v1, s[4:7], s39 offen offset:3072  lds
s_add_u32 m0, m0, 4096
s_add_u32 s39, s39, 4096
buffer_load_dwordx4 v1, s[4:7], s39 offen offset:0  lds
s_add_u32 s37, s62, 73728
s_mul_i32 s38, s24, 9216
s_add_u32 s39, s38, s37
s_add_u32 m0, s38, 73728
s_nop 0
buffer_load_dwordx4 v1, s[4:7], s39 offen offset:0  lds
buffer_load_dwordx4 v1, s[4:7], s39 offen offset:1024  lds
buffer_load_dwordx4 v1, s[4:7], s39 offen offset:2048  lds
buffer_load_dwordx4 v1, s[4:7], s39 offen offset:3072  lds
s_add_u32 m0, m0, 4096
s_add_u32 s39, s39, 4096
buffer_load_dwordx4 v1, s[4:7], s39 offen offset:0  lds
buffer_load_dwordx4 v1, s[4:7], s39 offen offset:1024  lds
buffer_load_dwordx4 v1, s[4:7], s39 offen offset:2048  lds
buffer_load_dwordx4 v1, s[4:7], s39 offen offset:3072  lds
s_add_u32 m0, m0, 4096
s_add_u32 s39, s39, 4096
buffer_load_dwordx4 v1, s[4:7], s39 offen offset:0  lds
s_add_u32 s37, s62, 110592
s_mul_i32 s38, s24, 9216
s_add_u32 s39, s38, s37
s_add_u32 m0, s38, 110592
s_nop 0
buffer_load_dwordx4 v1, s[4:7], s39 offen offset:0  lds
buffer_load_dwordx4 v1, s[4:7], s39 offen offset:1024  lds
buffer_load_dwordx4 v1, s[4:7], s39 offen offset:2048  lds
buffer_load_dwordx4 v1, s[4:7], s39 offen offset:3072  lds
s_add_u32 m0, m0, 4096
s_add_u32 s39, s39, 4096
buffer_load_dwordx4 v1, s[4:7], s39 offen offset:0  lds
buffer_load_dwordx4 v1, s[4:7], s39 offen offset:1024  lds
buffer_load_dwordx4 v1, s[4:7], s39 offen offset:2048  lds
buffer_load_dwordx4 v1, s[4:7], s39 offen offset:3072  lds
s_add_u32 m0, m0, 4096
s_add_u32 s39, s39, 4096
buffer_load_dwordx4 v1, s[4:7], s39 offen offset:0  lds
s_cmp_eq_u32 s24, 1
s_cbranch_scc0 L_polled_16
s_lshl_b32 s30, s81, 7
s_add_u32 s30, s30, 26574848
v_lshrrev_b32 v6, 2, v1
s_mov_b32 s31, 0
s_mov_b64 exec, 0xffff
L_poll_15:
buffer_load_dword v7, v6, s[8:11], s30 offen sc1
s_add_u32 s31, s31, 1
s_waitcnt vmcnt(0)
v_cmp_ne_u32 vcc, 1, v7
s_cmp_gt_u32 s31, 200000
s_cbranch_scc1 L_polled_16
s_cbranch_vccnz L_poll_15
L_polled_16:
s_mov_b64 exec, -1
s_waitcnt vmcnt(0)
s_barrier
s_lshl_b32 s60, s27, 2
s_add_u32 s60, s60, s24
s_mul_i32 s60, s60, 73728
s_add_u32 s60, s60, 16777216
buffer_load_dwordx4 a[0:3], v1, s[8:11], s60 offen offset:0 sc1
buffer_load_dwordx4 a[4:7], v1, s[8:11], s60 offen offset:1024 sc1
buffer_load_dwordx4 a[8:11], v1, s[8:11], s60 offen offset:2048 sc1
buffer_load_dwordx4 a[12:15], v1, s[8:11], s60 offen offset:3072 sc1
s_add_u32 s60, s60, 4096
buffer_load_dwordx4 a[16:19], v1, s[8:11], s60 offen offset:0 sc1
buffer_load_dwordx4 a[20:23], v1, s[8:11], s60 offen offset:1024 sc1
buffer_load_dwordx4 a[24:27], v1, s[8:11], s60 offen offset:2048 sc1
buffer_load_dwordx4 a[28:31], v1, s[8:11], s60 offen offset:3072 sc1
s_add_u32 s60, s60, 4096
buffer_load_dwordx4 a[32:35], v1, s[8:11], s60 offen offset:0 sc1
buffer_load_dwordx4 a[36:39], v1, s[8:11], s60 offen offset:1024 sc1
buffer_load_dwordx4 a[40:43], v1, s[8:11], s60 offen offset:2048 sc1
buffer_load_dwordx4 a[44:47], v1, s[8:11], s60 offen offset:3072 sc1
s_add_u32 s60, s60, 4096
buffer_load_dwordx4 a[48:51], v1, s[8:11], s60 offen offset:0 sc1
buffer_load_dwordx4 a[52:55], v1, s[8:11], s60 offen offset:1024 sc1
buffer_load_dwordx4 a[56:59], v1, s[8:11], s60 offen offset:2048 sc1
buffer_load_dwordx4 a[60:63], v1, s[8:11], s60 offen offset:3072 sc1
s_add_u32 s60, s60, 4096
buffer_load_dwordx4 a[64:67], v1, s[8:11], s60 offen offset:0 sc1
buffer_load_dwordx4 a[68:71], v1, s[8:11], s60 offen offset:1024 sc1
buffer_load_dwordx4 a[72:75], v1, s[8:11], s60 offen offset:2048 sc1
buffer_load_dwordx4 a[76:79], v1, s[8:11], s60 offen offset:3072 sc1
s_add_u32 s60, s60, 4096
buffer_load_dwordx4 a[80:83], v1, s[8:11], s60 offen offset:0 sc1
buffer_load_dwordx4 a[84:87], v1, s[8:11], s60 offen offset:1024 sc1
buffer_load_dwordx4 a[88:91], v1, s[8:11], s60 offen offset:2048 sc1
v_and_b32 v112, 7, v2
v_lshlrev_b32 v112, 4, v112
v_lshl_add_u32 v112, v3, 7, v112
v_add_u32 v112, 4096, v112
v_add_u32 v108, 0, v1
v_add_u32 v109, 36864, v1
v_add_u32 v113, 36864, v112
v_add_u32 v110, 73728, v1
v_add_u32 v114, 73728, v112
v_add_u32 v111, 110592, v1
v_add_u32 v115, 110592, v112
ds_read_b128 a[96:99], v108 offset:0
ds_read_b128 a[100:103], v108 offset:1024
ds_read_b128 a[104:107], v108 offset:2048
ds_read_b128 a[108:111], v108 offset:3072
ds_read_b128 a[112:115], v112 offset:0
ds_read_b128 a[116:119], v108 offset:4608
ds_read_b128 a[120:123], v108 offset:5632
ds_read_b128 a[124:127], v108 offset:6656
ds_read_b128 a[128:131], v108 offset:7680
ds_read_b128 a[132:135], v112 offset:4608
s_waitcnt vmcnt(22)
s_waitcnt lgkmcnt(5)
v_mfma_f32_16x16x32_bf16 v[16:19], a[96:99], a[0:3], v[16:19]
ds_read_b128 a[136:139], v108 offset:9216
buffer_load_dwordx4 a[92:95], v1, s[8:11], s60 offen offset:3072 sc1
v_mfma_f32_16x16x32_bf16 v[20:23], a[100:103], a[0:3], v[20:23]
ds_read_b128 a[140:143], v108 offset:10240
v_mfma_f32_16x16x32_bf16 v[24:27], a[104:107], a[0:3], v[24:27]
ds_read_b128 a[144:147], v108 offset:11264
v_mfma_f32_16x16x32_bf16 v[28:31], a[108:111], a[0:3], v[28:31]
ds_read_b128 a[148:151], v108 offset:12288
v_mfma_f32_16x16x32_bf16 v[32:35], a[112:115], a[0:3], v[32:35]
ds_read_b128 a[152:155], v112 offset:9216
s_waitcnt vmcnt(22)
s_waitcnt lgkmcnt(5)
v_mfma_f32_16x16x32_bf16 v[16:19], a[116:119], a[4:7], v[16:19]
ds_read_b128 a[96:99], v108 offset:13824
s_add_u32 s60, s60, 4096
buffer_load_dwordx4 a[0:3], v1, s[8:11], s60 offen offset:0 sc1
v_mfma_f32_16x16x32_bf16 v[20:23], a[120:123], a[4:7], v[20:23]
ds_read_b128 a[100:103], v108 offset:14848
v_mfma_f32_16x16x32_bf16 v[24:27], a[124:127], a[4:7], v[24:27]
ds_read_b128 a[104:107], v108 offset:15872
v_mfma_f32_16x16x32_bf16 v[28:31], a[128:131], a[4:7], v[28:31]
ds_read_b128 a[108:111], v108 offset:16896
v_mfma_f32_16x16x32_bf16 v[32:35], a[132:135], a[4:7], v[32:35]
ds_read_b128 a[112:115], v112 offset:13824
s_waitcnt vmcnt(22)
s_waitcnt lgkmcnt(5)
v_mfma_f32_16x16x32_bf16 v[16:19], a[136:139], a[8:11], v[16:19]
ds_read_b128 a[116:119], v108 offset:18432
buffer_load_dwordx4 a[4:7], v1, s[8:11], s60 offen offset:1024 sc1
v_mfma_f32_16x16x32_bf16 v[20:23], a[140:143], a[8:11], v[20:23]
ds_read_b128 a[120:123], v108 offset:19456
v_mfma_f32_16x16x32_bf16 v[24:27], a[144:147], a[8:11], v[24:27]
ds_read_b128 a[124:127], v108 offset:20480
v_mfma_f32_16x16x32_bf16 v[28:31], a[148:151], a[8:11], v[28:31]
ds_read_b128 a[128:131], v108 offset:21504
v_mfma_f32_16x16x32_bf16 v[32:35], a[152:155], a[8:11], v[32:35]
ds_read_b128 a[132:135], v112 offset:18432
s_waitcnt vmcnt(22)
s_waitcnt lgkmcnt(5)
v_mfma_f32_16x16x32_bf16 v[16:19], a[96:99], a[12:15], v[16:19]
ds_read_b128 a[136:139], v108 offset:23040
buffer_load_dwordx4 a[8:11], v1, s[8:11], s60 offen offset:2048 sc1
v_mfma_f32_16x16x32_bf16 v[20:23], a[100:103], a[12:15], v[20:23]
ds_read_b128 a[140:143], v108 offset:24064
v_mfma_f32_16x16x32_bf16 v[24:27], a[104:107], a[12:15], v[24:27]
ds_read_b128 a[144:147], v108 offset:25088
v_mfma_f32_16x16x32_bf16 v[28:31], a[108:111], a[12:15], v[28:31]
ds_read_b128 a[148:151], v108 offset:26112
v_mfma_f32_16x16x32_bf16 v[32:35], a[112:115], a[12:15], v[32:35]
ds_read_b128 a[152:155], v112 offset:23040
s_waitcnt vmcnt(22)
s_waitcnt lgkmcnt(5)
v_mfma_f32_16x16x32_bf16 v[16:19], a[116:119], a[16:19], v[16:19]
ds_read_b128 a[96:99], v108 offset:27648
buffer_load_dwordx4 a[12:15], v1, s[8:11], s60 offen offset:3072 sc1
v_mfma_f32_16x16x32_bf16 v[20:23], a[120:123], a[16:19], v[20:23]
ds_read_b128 a[100:103], v108 offset:28672
v_mfma_f32_16x16x32_bf16 v[24:27], a[124:127], a[16:19], v[24:27]
ds_read_b128 a[104:107], v108 offset:29696
v_mfma_f32_16x16x32_bf16 v[28:31], a[128:131], a[16:19], v[28:31]
ds_read_b128 a[108:111], v108 offset:30720
v_mfma_f32_16x16x32_bf16 v[32:35], a[132:135], a[16:19], v[32:35]
ds_read_b128 a[112:115], v112 offset:27648
s_waitcnt vmcnt(22)
s_waitcnt lgkmcnt(5)
v_mfma_f32_16x16x32_bf16 v[16:19], a[136:139], a[20:23], v[16:19]
ds_read_b128 a[116:119], v108 offset:32256
s_add_u32 s60, s60, 4096
buffer_load_dwordx4 a[16:19], v1, s[8:11], s60 offen offset:0 sc1
v_mfma_f32_16x16x32_bf16 v[20:23], a[140:143], a[20:23], v[20:23]
ds_read_b128 a[120:123], v108 offset:33280
v_mfma_f32_16x16x32_bf16 v[24:27], a[144:147], a[20:23], v[24:27]
ds_read_b128 a[124:127], v108 offset:34304
v_mfma_f32_16x16x32_bf16 v[28:31], a[148:151], a[20:23], v[28:31]
ds_read_b128 a[128:131], v108 offset:35328
v_mfma_f32_16x16x32_bf16 v[32:35], a[152:155], a[20:23], v[32:35]
ds_read_b128 a[132:135], v112 offset:32256
s_waitcnt vmcnt(22)
s_waitcnt lgkmcnt(5)
v_mfma_f32_16x16x32_bf16 v[16:19], a[96:99], a[24:27], v[16:19]
ds_read_b128 a[136:139], v109 offset:0
buffer_load_dwordx4 a[20:23], v1, s[8:11], s60 offen offset:1024 sc1
v_mfma_f32_16x16x32_bf16 v[20:23], a[100:103], a[24:27], v[20:23]
ds_read_b128 a[140:143], v109 offset:1024
v_mfma_f32_16x16x32_bf16 v[24:27], a[104:107], a[24:27], v[24:27]
ds_read_b128 a[144:147], v109 offset:2048
v_mfma_f32_16x16x32_bf16 v[28:31], a[108:111], a[24:27], v[28:31]
ds_read_b128 a[148:151], v109 offset:3072
v_mfma_f32_16x16x32_bf16 v[32:35], a[112:115], a[24:27], v[32:35]
ds_read_b128 a[152:155], v113 offset:0
s_waitcnt vmcnt(22)
s_waitcnt lgkmcnt(5)
v_mfma_f32_16x16x32_bf16 v[16:19], a[116:119], a[28:31], v[16:19]
ds_read_b128 a[96:99], v109 offset:4608
buffer_load_dwordx4 a[24:27], v1, s[8:11], s60 offen offset:2048 sc1
v_mfma_f32_16x16x32_bf16 v[20:23], a[120:123], a[28:31], v[20:23]
ds_read_b128 a[100:103], v109 offset:5632
v_mfma_f32_16x16x32_bf16 v[24:27], a[124:127], a[28:31], v[24:27]
ds_read_b128 a[104:107], v109 offset:6656
v_mfma_f32_16x16x32_bf16 v[28:31], a[128:131], a[28:31], v[28:31]
ds_read_b128 a[108:111], v109 offset:7680
v_mfma_f32_16x16x32_bf16 v[32:35], a[132:135], a[28:31], v[32:35]
ds_read_b128 a[112:115], v113 offset:4608
s_barrier
s_waitcnt vmcnt(22)
s_waitcnt lgkmcnt(5)
v_mfma_f32_16x16x32_bf16 v[16:19], a[136:139], a[32:35], v[16:19]
ds_read_b128 a[116:119], v109 offset:9216
buffer_load_dwordx4 a[28:31], v1, s[8:11], s60 offen offset:3072 sc1
v_mfma_f32_16x16x32_bf16 v[20:23], a[140:143], a[32:35], v[20:23]
ds_read_b128 a[120:123], v109 offset:10240
s_add_u32 s37, s62, 147456
v_mfma_f32_16x16x32_bf16 v[24:27], a[144:147], a[32:35], v[24:27]
ds_read_b128 a[124:127], v109 offset:11264
s_mul_i32 s38, s24, 9216
v_mfma_f32_16x16x32_bf16 v[28:31], a[148:151], a[32:35], v[28:31]
ds_read_b128 a[128:131], v109 offset:12288
s_add_u32 s39, s38, s37
v_mfma_f32_16x16x32_bf16 v[32:35], a[152:155], a[32:35], v[32:35]
ds_read_b128 a[132:135], v113 offset:9216
s_add_u32 m0, s38, 0
s_waitcnt vmcnt(22)
s_waitcnt lgkmcnt(5)
v_mfma_f32_16x16x32_bf16 v[16:19], a[96:99], a[36:39], v[16:19]
ds_read_b128 a[136:139], v109 offset:13824
s_add_u32 s60, s60, 4096
buffer_load_dwordx4 a[32:35], v1, s[8:11], s60 offen offset:0 sc1
v_mfma_f32_16x16x32_bf16 v[20:23], a[100:103], a[36:39], v[20:23]
ds_read_b128 a[140:143], v109 offset:14848
s_nop 0
v_mfma_f32_16x16x32_bf16 v[24:27], a[104:107], a[36:39], v[24:27]
ds_read_b128 a[144:147], v109 offset:15872
buffer_load_dwordx4 v1, s[4:7], s39 offen offset:0  lds
v_mfma_f32_16x16x32_bf16 v[28:31], a[108:111], a[36:39], v[28:31]
ds_read_b128 a[148:151], v109 offset:16896
buffer_load_dwordx4 v1, s[4:7], s39 offen offset:1024  lds
v_mfma_f32_16x16x32_bf16 v[32:35], a[112:115], a[36:39], v[32:35]
ds_read_b128 a[152:155], v113 offset:13824
buffer_load_dwordx4 v1, s[4:7], s39 offen offset:2048  lds
s_waitcnt vmcnt(25)
s_waitcnt lgkmcnt(5)
v_mfma_f32_16x16x32_bf16 v[16:19], a[116:119], a[40:43], v[16:19]
ds_read_b128 a[96:99], v109 offset:18432
buffer_load_dwordx4 a[36:39], v1, s[8:11], s60 offen offset:1024 sc1
v_mfma_f32_16x16x32_bf16 v[20:23], a[120:123], a[40:43], v[20:23]
ds_read_b128 a[100:103], v109 offset:19456
buffer_load_dwordx4 v1, s[4:7], s39 offen offset:3072  lds
v_mfma_f32_16x16x32_bf16 v[24:27], a[124:127], a[40:43], v[24:27]
ds_read_b128 a[104:107], v109 offset:20480
s_add_u32 m0, m0, 4096
v_mfma_f32_16x16x32_bf16 v[28:31], a[128:131], a[40:43], v[28:31]
ds_read_b128 a[108:111], v109 offset:21504
s_add_u32 s39, s39, 4096
v_mfma_f32_16x16x32_bf16 v[32:35], a[132:135], a[40:43], v[32:35]
ds_read_b128 a[112:115], v113 offset:18432
buffer_load_dwordx4 v1, s[4:7], s39 offen offset:0  lds
s_waitcnt vmcnt(27)
s_waitcnt lgkmcnt(5)
v_mfma_f32_16x16x32_bf16 v[16:19], a[136:139], a[44:47], v[16:19]
ds_read_b128 a[116:119], v109 offset:23040
buffer_load_dwordx4 a[40:43], v1, s[8:11], s60 offen offset:2048 sc1
v_mfma_f32_16x16x32_bf16 v[20:23], a[140:143], a[44:47], v[20:23]
ds_read_b128 a[120:123], v109 offset:24064
buffer_load_dwordx4 v1, s[4:7], s39 offen offset:1024  lds
v_mfma_f32_16x16x32_bf16 v[24:27], a[144:147], a[44:47], v[24:27]
ds_read_b128 a[124:127], v109 offset:25088
buffer_load_dwordx4 v1, s[4:7], s39 offen offset:2048  lds
v_mfma_f32_16x16x32_bf16 v[28:31], a[148:151], a[44:47], v[28:31]
ds_read_b128 a[128:131], v109 offset:26112
buffer_load_dwordx4 v1, s[4:7], s39 offen offset:3072  lds
v_mfma_f32_16x16x32_bf16 v[32:35], a[152:155], a[44:47], v[32:35]
ds_read_b128 a[132:135], v113 offset:23040
s_add_u32 m0, m0, 4096
s_waitcnt vmcnt(30)
s_waitcnt lgkmcnt(5)
v_mfma_f32_16x16x32_bf16 v[16:19], a[96:99], a[48:51], v[16:19]
ds_read_b128 a[136:139], v109 offset:27648
buffer_load_dwordx4 a[44:47], v1, s[8:11], s60 offen offset:3072 sc1
v_mfma_f32_16x16x32_bf16 v[20:23], a[100:103], a[48:51], v[20:23]
ds_read_b128 a[140:143], v109 offset:28672
s_add_u32 s39, s39, 4096
v_mfma_f32_16x16x32_bf16 v[24:27], a[104:107], a[48:51], v[24:27]
ds_read_b128 a[144:147], v109 offset:29696
buffer_load_dwordx4 v1, s[4:7], s39 offen offset:0  lds
v_mfma_f32_16x16x32_bf16 v[28:31], a[108:111], a[48:51], v[28:31]
ds_read_b128 a[148:151], v109 offset:30720
v_mfma_f32_16x16x32_bf16 v[32:35], a[112:115], a[48:51], v[32:35]
ds_read_b128 a[152:155], v113 offset:27648
s_waitcnt vmcnt(31)
s_waitcnt lgkmcnt(5)
v_mfma_f32_16x16x32_bf16 v[16:19], a[116:119], a[52:55], v[16:19]
ds_read_b128 a[96:99], v109 offset:32256
s_add_u32 s60, s60, 4096
buffer_load_dwordx4 a[48:51], v1, s[8:11], s60 offen offset:0 sc1
v_mfma_f32_16x16x32_bf16 v[20:23], a[120:123], a[52:55], v[20:23]
ds_read_b128 a[100:103], v109 offset:33280
v_mfma_f32_16x16x32_bf16 v[24:27], a[124:127], a[52:55], v[24:27]
ds_read_b128 a[104:107], v109 offset:34304
v_mfma_f32_16x16x32_bf16 v[28:31], a[128:131], a[52:55], v[28:31]
ds_read_b128 a[108:111], v109 offset:35328
v_mfma_f32_16x16x32_bf16 v[32:35], a[132:135], a[52:55], v[32:35]
ds_read_b128 a[112:115], v113 offset:32256
s_waitcnt vmcnt(31)
s_waitcnt lgkmcnt(5)
v_mfma_f32_16x16x32_bf16 v[16:19], a[136:139], a[56:59], v[16:19]
ds_read_b128 a[116:119], v110 offset:0
buffer_load_dwordx4 a[52:55], v1, s[8:11], s60 offen offset:1024 sc1
v_mfma_f32_16x16x32_bf16 v[20:23], a[140:143], a[56:59], v[20:23]
ds_read_b128 a[120:123], v110 offset:1024
v_mfma_f32_16x16x32_bf16 v[24:27], a[144:147], a[56:59], v[24:27]
ds_read_b128 a[124:127], v110 offset:2048
v_mfma_f32_16x16x32_bf16 v[28:31], a[148:151], a[56:59], v[28:31]
ds_read_b128 a[128:131], v110 offset:3072
v_mfma_f32_16x16x32_bf16 v[32:35], a[152:155], a[56:59], v[32:35]
ds_read_b128 a[132:135], v114 offset:0
s_waitcnt vmcnt(31)
s_waitcnt lgkmcnt(5)
v_mfma_f32_16x16x32_bf16 v[16:19], a[96:99], a[60:63], v[16:19]
ds_read_b128 a[136:139], v110 offset:4608
buffer_load_dwordx4 a[56:59], v1, s[8:11], s60 offen offset:2048 sc1
v_mfma_f32_16x16x32_bf16 v[20:23], a[100:103], a[60:63], v[20:23]
ds_read_b128 a[140:143], v110 offset:5632
v_mfma_f32_16x16x32_bf16 v[24:27], a[104:107], a[60:63], v[24:27]
ds_read_b128 a[144:147], v110 offset:6656
v_mfma_f32_16x16x32_bf16 v[28:31], a[108:111], a[60:63], v[28:31]
ds_read_b128 a[148:151], v110 offset:7680
v_mfma_f32_16x16x32_bf16 v[32:35], a[112:115], a[60:63], v[32:35]
ds_read_b128 a[152:155], v114 offset:4608
s_barrier
s_waitcnt vmcnt(31)
s_waitcnt lgkmcnt(5)
v_mfma_f32_16x16x32_bf16 v[16:19], a[116:119], a[64:67], v[16:19]
ds_read_b128 a[96:99], v110 offset:9216
buffer_load_dwordx4 a[60:63], v1, s[8:11], s60 offen offset:3072 sc1
v_mfma_f32_16x16x32_bf16 v[20:23], a[120:123], a[64:67], v[20:23]
ds_read_b128 a[100:103], v110 offset:10240
s_add_u32 s37, s62, 184320
v_mfma_f32_16x16x32_bf16 v[24:27], a[124:127], a[64:67], v[24:27]
ds_read_b128 a[104:107], v110 offset:11264
s_mul_i32 s38, s24, 9216
v_mfma_f32_16x16x32_bf16 v[28:31], a[128:131], a[64:67], v[28:31]
ds_read_b128 a[108:111], v110 offset:12288
s_add_u32 s39, s38, s37
v_mfma_f32_16x16x32_bf16 v[32:35], a[132:135], a[64:67], v[32:35]
ds_read_b128 a[112:115], v114 offset:9216
s_add_u32 m0, s38, 36864
s_waitcnt vmcnt(31)
s_waitcnt lgkmcnt(5)
v_mfma_f32_16x16x32_bf16 v[16:19], a[136:139], a[68:71], v[16:19]
ds_read_b128 a[116:119], v110 offset:13824
s_add_u32 s60, s60, 4096
buffer_load_dwordx4 a[64:67], v1, s[8:11], s60 offen offset:0 sc1
v_mfma_f32_16x16x32_bf16 v[20:23], a[140:143], a[68:71], v[20:23]
ds_read_b128 a[120:123], v110 offset:14848
s_nop 0
v_mfma_f32_16x16x32_bf16 v[24:27], a[144:147], a[68:71], v[24:27]
ds_read_b128 a[124:127], v110 offset:15872
buffer_load_dwordx4 v1, s[4:7], s39 offen offset:0  lds
v_mfma_f32_16x16x32_bf16 v[28:31], a[148:151], a[68:71], v[28:31]
ds_read_b128 a[128:131], v110 offset:16896
buffer_load_dwordx4 v1, s[4:7], s39 offen offset:1024  lds
v_mfma_f32_16x16x32_bf16 v[32:35], a[152:155], a[68:71], v[32:35]
ds_read_b128 a[132:135], v114 offset:13824
buffer_load_dwordx4 v1, s[4:7], s39 offen offset:2048  lds
s_waitcnt vmcnt(34)
s_waitcnt lgkmcnt(5)
v_mfma_f32_16x16x32_bf16 v[16:19], a[96:99], a[72:75], v[16:19]
ds_read_b128 a[136:139], v110 offset:18432
buffer_load_dwordx4 a[68:71], v1, s[8:11], s60 offen offset:1024 sc1
v_mfma_f32_16x16x32_bf16 v[20:23], a[100:103], a[72:75], v[20:23]
ds_read_b128 a[140:143], v110 offset:19456
buffer_load_dwordx4 v1, s[4:7], s39 offen offset:3072  lds
v_mfma_f32_16x16x32_bf16 v[24:27], a[104:107], a[72:75], v[24:27]
ds_read_b128 a[144:147], v110 offset:20480
s_add_u32 m0, m0, 4096
v_mfma_f32_16x16x32_bf16 v[28:31], a[108:111], a[72:75], v[28:31]
ds_read_b128 a[148:151], v110 offset:21504
s_add_u32 s39, s39, 4096
v_mfma_f32_16x16x32_bf16 v[32:35], a[112:115], a[72:75], v[32:35]
ds_read_b128 a[152:155], v114 offset:18432
buffer_load_dwordx4 v1, s[4:7], s39 offen offset:0  lds
s_waitcnt vmcnt(36)
s_waitcnt lgkmcnt(5)
v_mfma_f32_16x16x32_bf16 v[16:19], a[116:119], a[76:79], v[16:19]
ds_read_b128 a[96:99], v110 offset:23040
buffer_load_dwordx4 a[72:75], v1, s[8:11], s60 offen offset:2048 sc1
v_mfma_f32_16x16x32_bf16 v[20:23], a[120:123], a[76:79], v[20:23]
ds_read_b128 a[100:103], v110 offset:24064
buffer_load_dwordx4 v1, s[4:7], s39 offen offset:1024  lds
v_mfma_f32_16x16x32_bf16 v[24:27], a[124:127], a[76:79], v[24:27]
ds_read_b128 a[104:107], v110 offset:25088
buffer_load_dwordx4 v1, s[4:7], s39 offen offset:2048  lds
v_mfma_f32_16x16x32_bf16 v[28:31], a[128:131], a[76:79], v[28:31]
ds_read_b128 a[108:111], v110 offset:26112
buffer_load_dwordx4 v1, s[4:7], s39 offen offset:3072  lds
v_mfma_f32_16x16x32_bf16 v[32:35], a[132:135], a[76:79], v[32:35]
ds_read_b128 a[112:115], v114 offset:23040
s_add_u32 m0, m0, 4096
s_waitcnt vmcnt(39)
s_waitcnt lgkmcnt(5)
v_mfma_f32_16x16x32_bf16 v[16:19], a[136:139], a[80:83], v[16:19]
ds_read_b128 a[116:119], v110 offset:27648
buffer_load_dwordx4 a[76:79], v1, s[8:11], s60 offen offset:3072 sc1
v_mfma_f32_16x16x32_bf16 v[20:23], a[140:143], a[80:83], v[20:23]
ds_read_b128 a[120:123], v110 offset:28672
s_add_u32 s39, s39, 4096
v_mfma_f32_16x16x32_bf16 v[24:27], a[144:147], a[80:83], v[24:27]
ds_read_b128 a[124:127], v110 offset:29696
buffer_load_dwordx4 v1, s[4:7], s39 offen offset:0  lds
v_mfma_f32_16x16x32_bf16 v[28:31], a[148:151], a[80:83], v[28:31]
ds_read_b128 a[128:131], v110 offset:30720
v_mfma_f32_16x16x32_bf16 v[32:35], a[152:155], a[80:83], v[32:35]
ds_read_b128 a[132:135], v114 offset:27648
s_waitcnt vmcnt(40)
s_waitcnt lgkmcnt(5)
v_mfma_f32_16x16x32_bf16 v[16:19], a[96:99], a[84:87], v[16:19]
ds_read_b128 a[136:139], v110 offset:32256
s_add_u32 s60, s60, 4096
buffer_load_dwordx4 a[80:83], v1, s[8:11], s60 offen offset:0 sc1
v_mfma_f32_16x16x32_bf16 v[20:23], a[100:103], a[84:87], v[20:23]
ds_read_b128 a[140:143], v110 offset:33280
v_mfma_f32_16x16x32_bf16 v[24:27], a[104:107], a[84:87], v[24:27]
ds_read_b128 a[144:147], v110 offset:34304
v_mfma_f32_16x16x32_bf16 v[28:31], a[108:111], a[84:87], v[28:31]
ds_read_b128 a[148:151], v110 offset:35328
v_mfma_f32_16x16x32_bf16 v[32:35], a[112:115], a[84:87], v[32:35]
ds_read_b128 a[152:155], v114 offset:32256
s_waitcnt vmcnt(40)
s_waitcnt lgkmcnt(5)
v_mfma_f32_16x16x32_bf16 v[16:19], a[116:119], a[88:91], v[16:19]
ds_read_b128 a[96:99], v111 offset:0
buffer_load_dwordx4 a[84:87], v1, s[8:11], s60 offen offset:1024 sc1
v_mfma_f32_16x16x32_bf16 v[20:23], a[120:123], a[88:91], v[20:23]
ds_read_b128 a[100:103], v111 offset:1024
v_mfma_f32_16x16x32_bf16 v[24:27], a[124:127], a[88:91], v[24:27]
ds_read_b128 a[104:107], v111 offset:2048
v_mfma_f32_16x16x32_bf16 v[28:31], a[128:131], a[88:91], v[28:31]
ds_read_b128 a[108:111], v111 offset:3072
v_mfma_f32_16x16x32_bf16 v[32:35], a[132:135], a[88:91], v[32:35]
ds_read_b128 a[112:115], v115 offset:0
s_waitcnt vmcnt(40)
s_waitcnt lgkmcnt(5)
v_mfma_f32_16x16x32_bf16 v[16:19], a[136:139], a[92:95], v[16:19]
ds_read_b128 a[116:119], v111 offset:4608
buffer_load_dwordx4 a[88:91], v1, s[8:11], s60 offen offset:2048 sc1
v_mfma_f32_16x16x32_bf16 v[20:23], a[140:143], a[92:95], v[20:23]
ds_read_b128 a[120:123], v111 offset:5632
v_mfma_f32_16x16x32_bf16 v[24:27], a[144:147], a[92:95], v[24:27]
ds_read_b128 a[124:127], v111 offset:6656
v_mfma_f32_16x16x32_bf16 v[28:31], a[148:151], a[92:95], v[28:31]
ds_read_b128 a[128:131], v111 offset:7680
v_mfma_f32_16x16x32_bf16 v[32:35], a[152:155], a[92:95], v[32:35]
ds_read_b128 a[132:135], v115 offset:4608
s_waitcnt vmcnt(20)
s_barrier
s_waitcnt lgkmcnt(5)
v_mfma_f32_16x16x32_bf16 v[16:19], a[96:99], a[0:3], v[16:19]
ds_read_b128 a[136:139], v111 offset:9216
buffer_load_dwordx4 a[92:95], v1, s[8:11], s60 offen offset:3072 sc1
v_mfma_f32_16x16x32_bf16 v[20:23], a[100:103], a[0:3], v[20:23]
ds_read_b128 a[140:143], v111 offset:10240
s_add_u32 s37, s62, 221184
v_mfma_f32_16x16x32_bf16 v[24:27], a[104:107], a[0:3], v[24:27]
ds_read_b128 a[144:147], v111 offset:11264
s_mul_i32 s38, s24, 9216
v_mfma_f32_16x16x32_bf16 v[28:31], a[108:111], a[0:3], v[28:31]
ds_read_b128 a[148:151], v111 offset:12288
s_add_u32 s39, s38, s37
v_mfma_f32_16x16x32_bf16 v[32:35], a[112:115], a[0:3], v[32:35]
ds_read_b128 a[152:155], v115 offset:9216
s_add_u32 m0, s38, 73728
s_waitcnt lgkmcnt(5)
v_mfma_f32_16x16x32_bf16 v[16:19], a[116:119], a[4:7], v[16:19]
ds_read_b128 a[96:99], v111 offset:13824
s_add_u32 s60, s60, 4096
buffer_load_dwordx4 a[0:3], v1, s[8:11], s60 offen offset:0 sc1
v_mfma_f32_16x16x32_bf16 v[20:23], a[120:123], a[4:7], v[20:23]
ds_read_b128 a[100:103], v111 offset:14848
s_nop 0
v_mfma_f32_16x16x32_bf16 v[24:27], a[124:127], a[4:7], v[24:27]
ds_read_b128 a[104:107], v111 offset:15872
buffer_load_dwordx4 v1, s[4:7], s39 offen offset:0  lds
v_mfma_f32_16x16x32_bf16 v[28:31], a[128:131], a[4:7], v[28:31]
ds_read_b128 a[108:111], v111 offset:16896
buffer_load_dwordx4 v1, s[4:7], s39 offen offset:1024  lds
v_mfma_f32_16x16x32_bf16 v[32:35], a[132:135], a[4:7], v[32:35]
ds_read_b128 a[112:115], v115 offset:13824
buffer_load_dwordx4 v1, s[4:7], s39 offen offset:2048  lds
s_waitcnt lgkmcnt(5)
v_mfma_f32_16x16x32_bf16 v[16:19], a[136:139], a[8:11], v[16:19]
ds_read_b128 a[116:119], v111 offset:18432
buffer_load_dwordx4 a[4:7], v1, s[8:11], s60 offen offset:1024 sc1
v_mfma_f32_16x16x32_bf16 v[20:23], a[140:143], a[8:11], v[20:23]
ds_read_b128 a[120:123], v111 offset:19456
buffer_load_dwordx4 v1, s[4:7], s39 offen offset:3072  lds
v_mfma_f32_16x16x32_bf16 v[24:27], a[144:147], a[8:11], v[24:27]
ds_read_b128 a[124:127], v111 offset:20480
s_add_u32 m0, m0, 4096
v_mfma_f32_16x16x32_bf16 v[28:31], a[148:151], a[8:11], v[28:31]
ds_read_b128 a[128:131], v111 offset:21504
s_add_u32 s39, s39, 4096
v_mfma_f32_16x16x32_bf16 v[32:35], a[152:155], a[8:11], v[32:35]
ds_read_b128 a[132:135], v115 offset:18432
buffer_load_dwordx4 v1, s[4:7], s39 offen offset:0  lds
s_waitcnt lgkmcnt(5)
v_mfma_f32_16x16x32_bf16 v[16:19], a[96:99], a[12:15], v[16:19]
ds_read_b128 a[136:139], v111 offset:23040
buffer_load_dwordx4 a[8:11], v1, s[8:11], s60 offen offset:2048 sc1
v_mfma_f32_16x16x32_bf16 v[20:23], a[100:103], a[12:15], v[20:23]
ds_read_b128 a[140:143], v111 offset:24064
buffer_load_dwordx4 v1, s[4:7], s39 offen offset:1024  lds
v_mfma_f32_16x16x32_bf16 v[24:27], a[104:107], a[12:15], v[24:27]
ds_read_b128 a[144:147], v111 offset:25088
buffer_load_dwordx4 v1, s[4:7], s39 offen offset:2048  lds
v_mfma_f32_16x16x32_bf16 v[28:31], a[108:111], a[12:15], v[28:31]
ds_read_b128 a[148:151], v111 offset:26112
buffer_load_dwordx4 v1, s[4:7], s39 offen offset:3072  lds
v_mfma_f32_16x16x32_bf16 v[32:35], a[112:115], a[12:15], v[32:35]
ds_read_b128 a[152:155], v115 offset:23040
s_add_u32 m0, m0, 4096
s_waitcnt lgkmcnt(5)
v_mfma_f32_16x16x32_bf16 v[16:19], a[116:119], a[16:19], v[16:19]
ds_read_b128 a[96:99], v111 offset:27648
buffer_load_dwordx4 a[12:15], v1, s[8:11], s60 offen offset:3072 sc1
v_mfma_f32_16x16x32_bf16 v[20:23], a[120:123], a[16:19], v[20:23]
ds_read_b128 a[100:103], v111 offset:28672
s_add_u32 s39, s39, 4096
v_mfma_f32_16x16x32_bf16 v[24:27], a[124:127], a[16:19], v[24:27]
ds_read_b128 a[104:107], v111 offset:29696
buffer_load_dwordx4 v1, s[4:7], s39 offen offset:0  lds
v_mfma_f32_16x16x32_bf16 v[28:31], a[128:131], a[16:19], v[28:31]
ds_read_b128 a[108:111], v111 offset:30720
v_mfma_f32_16x16x32_bf16 v[32:35], a[132:135], a[16:19], v[32:35]
ds_read_b128 a[112:115], v115 offset:27648
s_waitcnt lgkmcnt(5)
v_mfma_f32_16x16x32_bf16 v[16:19], a[136:139], a[20:23], v[16:19]
ds_read_b128 a[116:119], v111 offset:32256
s_add_u32 s60, s60, 4096
buffer_load_dwordx4 a[16:19], v1, s[8:11], s60 offen offset:0 sc1
v_mfma_f32_16x16x32_bf16 v[20:23], a[140:143], a[20:23], v[20:23]
ds_read_b128 a[120:123], v111 offset:33280
v_mfma_f32_16x16x32_bf16 v[24:27], a[144:147], a[20:23], v[24:27]
ds_read_b128 a[124:127], v111 offset:34304
v_mfma_f32_16x16x32_bf16 v[28:31], a[148:151], a[20:23], v[28:31]
ds_read_b128 a[128:131], v111 offset:35328
v_mfma_f32_16x16x32_bf16 v[32:35], a[152:155], a[20:23], v[32:35]
ds_read_b128 a[132:135], v115 offset:32256
s_waitcnt lgkmcnt(5)
v_mfma_f32_16x16x32_bf16 v[16:19], a[96:99], a[24:27], v[16:19]
ds_read_b128 a[136:139], v108 offset:0
buffer_load_dwordx4 a[20:23], v1, s[8:11], s60 offen offset:1024 sc1
v_mfma_f32_16x16x32_bf16 v[20:23], a[100:103], a[24:27], v[20:23]
ds_read_b128 a[140:143], v108 offset:1024
v_mfma_f32_16x16x32_bf16 v[24:27], a[104:107], a[24:27], v[24:27]
ds_read_b128 a[144:147], v108 offset:2048
v_mfma_f32_16x16x32_bf16 v[28:31], a[108:111], a[24:27], v[28:31]
ds_read_b128 a[148:151], v108 offset:3072
v_mfma_f32_16x16x32_bf16 v[32:35], a[112:115], a[24:27], v[32:35]
ds_read_b128 a[152:155], v112 offset:0
s_waitcnt lgkmcnt(5)
v_mfma_f32_16x16x32_bf16 v[16:19], a[116:119], a[28:31], v[16:19]
ds_read_b128 a[96:99], v108 offset:4608
buffer_load_dwordx4 a[24:27], v1, s[8:11], s60 offen offset:2048 sc1
v_mfma_f32_16x16x32_bf16 v[20:23], a[120:123], a[28:31], v[20:23]
ds_read_b128 a[100:103], v108 offset:5632
v_mfma_f32_16x16x32_bf16 v[24:27], a[124:127], a[28:31], v[24:27]
ds_read_b128 a[104:107], v108 offset:6656
v_mfma_f32_16x16x32_bf16 v[28:31], a[128:131], a[28:31], v[28:31]
ds_read_b128 a[108:111], v108 offset:7680
v_mfma_f32_16x16x32_bf16 v[32:35], a[132:135], a[28:31], v[32:35]
ds_read_b128 a[112:115], v112 offset:4608
s_waitcnt vmcnt(20)
s_barrier
s_waitcnt lgkmcnt(5)
v_mfma_f32_16x16x32_bf16 v[16:19], a[136:139], a[32:35], v[16:19]
ds_read_b128 a[116:119], v108 offset:9216
buffer_load_dwordx4 a[28:31], v1, s[8:11], s60 offen offset:3072 sc1
v_mfma_f32_16x16x32_bf16 v[20:23], a[140:143], a[32:35], v[20:23]
ds_read_b128 a[120:123], v108 offset:10240
s_add_u32 s37, s62, 258048
v_mfma_f32_16x16x32_bf16 v[24:27], a[144:147], a[32:35], v[24:27]
ds_read_b128 a[124:127], v108 offset:11264
s_mul_i32 s38, s24, 9216
v_mfma_f32_16x16x32_bf16 v[28:31], a[148:151], a[32:35], v[28:31]
ds_read_b128 a[128:131], v108 offset:12288
s_add_u32 s39, s38, s37
v_mfma_f32_16x16x32_bf16 v[32:35], a[152:155], a[32:35], v[32:35]
ds_read_b128 a[132:135], v112 offset:9216
s_add_u32 m0, s38, 110592
s_waitcnt lgkmcnt(5)
v_mfma_f32_16x16x32_bf16 v[16:19], a[96:99], a[36:39], v[16:19]
ds_read_b128 a[136:139], v108 offset:13824
s_add_u32 s60, s60, 4096
buffer_load_dwordx4 a[32:35], v1, s[8:11], s60 offen offset:0 sc1
v_mfma_f32_16x16x32_bf16 v[20:23], a[100:103], a[36:39], v[20:23]
ds_read_b128 a[140:143], v108 offset:14848
s_nop 0
v_mfma_f32_16x16x32_bf16 v[24:27], a[104:107], a[36:39], v[24:27]
ds_read_b128 a[144:147], v108 offset:15872
buffer_load_dwordx4 v1, s[4:7], s39 offen offset:0  lds
v_mfma_f32_16x16x32_bf16 v[28:31], a[108:111], a[36:39], v[28:31]
ds_read_b128 a[148:151], v108 offset:16896
buffer_load_dwordx4 v1, s[4:7], s39 offen offset:1024  lds
v_mfma_f32_16x16x32_bf16 v[32:35], a[112:115], a[36:39], v[32:35]
ds_read_b128 a[152:155], v112 offset:13824
buffer_load_dwordx4 v1, s[4:7], s39 offen offset:2048  lds
s_waitcnt lgkmcnt(5)
v_mfma_f32_16x16x32_bf16 v[16:19], a[116:119], a[40:43], v[16:19]
ds_read_b128 a[96:99], v108 offset:18432
buffer_load_dwordx4 a[36:39], v1, s[8:11], s60 offen offset:1024 sc1
v_mfma_f32_16x16x32_bf16 v[20:23], a[120:123], a[40:43], v[20:23]
ds_read_b128 a[100:103], v108 offset:19456
buffer_load_dwordx4 v1, s[4:7], s39 offen offset:3072  lds
v_mfma_f32_16x16x32_bf16 v[24:27], a[124:127], a[40:43], v[24:27]
ds_read_b128 a[104:107], v108 offset:20480
s_add_u32 m0, m0, 4096
v_mfma_f32_16x16x32_bf16 v[28:31], a[128:131], a[40:43], v[28:31]
ds_read_b128 a[108:111], v108 offset:21504
s_add_u32 s39, s39, 4096
v_mfma_f32_16x16x32_bf16 v[32:35], a[132:135], a[40:43], v[32:35]
ds_read_b128 a[112:115], v112 offset:18432
buffer_load_dwordx4 v1, s[4:7], s39 offen offset:0  lds
s_waitcnt lgkmcnt(5)
v_mfma_f32_16x16x32_bf16 v[16:19], a[136:139], a[44:47], v[16:19]
ds_read_b128 a[116:119], v108 offset:23040
buffer_load_dwordx4 a[40:43], v1, s[8:11], s60 offen offset:2048 sc1
v_mfma_f32_16x16x32_bf16 v[20:23], a[140:143], a[44:47], v[20:23]
ds_read_b128 a[120:123], v108 offset:24064
buffer_load_dwordx4 v1, s[4:7], s39 offen offset:1024  lds
v_mfma_f32_16x16x32_bf16 v[24:27], a[144:147], a[44:47], v[24:27]
ds_read_b128 a[124:127], v108 offset:25088
buffer_load_dwordx4 v1, s[4:7], s39 offen offset:2048  lds
v_mfma_f32_16x16x32_bf16 v[28:31], a[148:151], a[44:47], v[28:31]
ds_read_b128 a[128:131], v108 offset:26112
buffer_load_dwordx4 v1, s[4:7], s39 offen offset:3072  lds
v_mfma_f32_16x16x32_bf16 v[32:35], a[152:155], a[44:47], v[32:35]
ds_read_b128 a[132:135], v112 offset:23040
s_add_u32 m0, m0, 4096
s_waitcnt lgkmcnt(5)
v_mfma_f32_16x16x32_bf16 v[16:19], a[96:99], a[48:51], v[16:19]
ds_read_b128 a[136:139], v108 offset:27648
buffer_load_dwordx4 a[44:47], v1, s[8:11], s60 offen offset:3072 sc1
v_mfma_f32_16x16x32_bf16 v[20:23], a[100:103], a[48:51], v[20:23]
ds_read_b128 a[140:143], v108 offset:28672
s_add_u32 s39, s39, 4096
v_mfma_f32_16x16x32_bf16 v[24:27], a[104:107], a[48:51], v[24:27]
ds_read_b128 a[144:147], v108 offset:29696
buffer_load_dwordx4 v1, s[4:7], s39 offen offset:0  lds
v_mfma_f32_16x16x32_bf16 v[28:31], a[108:111], a[48:51], v[28:31]
ds_read_b128 a[148:151], v108 offset:30720
v_mfma_f32_16x16x32_bf16 v[32:35], a[112:115], a[48:51], v[32:35]
ds_read_b128 a[152:155], v112 offset:27648
s_waitcnt lgkmcnt(5)
v_mfma_f32_16x16x32_bf16 v[16:19], a[116:119], a[52:55], v[16:19]
ds_read_b128 a[96:99], v108 offset:32256
s_add_u32 s60, s60, 4096
buffer_load_dwordx4 a[48:51], v1, s[8:11], s60 offen offset:0 sc1
v_mfma_f32_16x16x32_bf16 v[20:23], a[120:123], a[52:55], v[20:23]
ds_read_b128 a[100:103], v108 offset:33280
v_mfma_f32_16x16x32_bf16 v[24:27], a[124:127], a[52:55], v[24:27]
ds_read_b128 a[104:107], v108 offset:34304
v_mfma_f32_16x16x32_bf16 v[28:31], a[128:131], a[52:55], v[28:31]
ds_read_b128 a[108:111], v108 offset:35328
v_mfma_f32_16x16x32_bf16 v[32:35], a[132:135], a[52:55], v[32:35]
ds_read_b128 a[112:115], v112 offset:32256
s_waitcnt lgkmcnt(5)
v_mfma_f32_16x16x32_bf16 v[16:19], a[136:139], a[56:59], v[16:19]
ds_read_b128 a[116:119], v109 offset:0
buffer_load_dwordx4 a[52:55], v1, s[8:11], s60 offen offset:1024 sc1
v_mfma_f32_16x16x32_bf16 v[20:23], a[140:143], a[56:59], v[20:23]
ds_read_b128 a[120:123], v109 offset:1024
v_mfma_f32_16x16x32_bf16 v[24:27], a[144:147], a[56:59], v[24:27]
ds_read_b128 a[124:127], v109 offset:2048
v_mfma_f32_16x16x32_bf16 v[28:31], a[148:151], a[56:59], v[28:31]
ds_read_b128 a[128:131], v109 offset:3072
v_mfma_f32_16x16x32_bf16 v[32:35], a[152:155], a[56:59], v[32:35]
ds_read_b128 a[132:135], v113 offset:0
s_waitcnt lgkmcnt(5)
v_mfma_f32_16x16x32_bf16 v[16:19], a[96:99], a[60:63], v[16:19]
ds_read_b128 a[136:139], v109 offset:4608
buffer_load_dwordx4 a[56:59], v1, s[8:11], s60 offen offset:2048 sc1
v_mfma_f32_16x16x32_bf16 v[20:23], a[100:103], a[60:63], v[20:23]
ds_read_b128 a[140:143], v109 offset:5632
v_mfma_f32_16x16x32_bf16 v[24:27], a[104:107], a[60:63], v[24:27]
ds_read_b128 a[144:147], v109 offset:6656
v_mfma_f32_16x16x32_bf16 v[28:31], a[108:111], a[60:63], v[28:31]
ds_read_b128 a[148:151], v109 offset:7680
v_mfma_f32_16x16x32_bf16 v[32:35], a[112:115], a[60:63], v[32:35]
ds_read_b128 a[152:155], v113 offset:4608
s_waitcnt vmcnt(20)
s_barrier
s_waitcnt lgkmcnt(5)
v_mfma_f32_16x16x32_bf16 v[16:19], a[116:119], a[64:67], v[16:19]
ds_read_b128 a[96:99], v109 offset:9216
buffer_load_dwordx4 a[60:63], v1, s[8:11], s60 offen offset:3072 sc1
v_mfma_f32_16x16x32_bf16 v[20:23], a[120:123], a[64:67], v[20:23]
ds_read_b128 a[100:103], v109 offset:10240
s_add_u32 s37, s62, 294912
v_mfma_f32_16x16x32_bf16 v[24:27], a[124:127], a[64:67], v[24:27]
ds_read_b128 a[104:107], v109 offset:11264
s_mul_i32 s38, s24, 9216
v_mfma_f32_16x16x32_bf16 v[28:31], a[128:131], a[64:67], v[28:31]
ds_read_b128 a[108:111], v109 offset:12288
s_add_u32 s39, s38, s37
v_mfma_f32_16x16x32_bf16 v[32:35], a[132:135], a[64:67], v[32:35]
ds_read_b128 a[112:115], v113 offset:9216
s_add_u32 m0, s38, 0
s_waitcnt lgkmcnt(5)
v_mfma_f32_16x16x32_bf16 v[16:19], a[136:139], a[68:71], v[16:19]
ds_read_b128 a[116:119], v109 offset:13824
s_add_u32 s60, s60, 4096
buffer_load_dwordx4 a[64:67], v1, s[8:11], s60 offen offset:0 sc1
v_mfma_f32_16x16x32_bf16 v[20:23], a[140:143], a[68:71], v[20:23]
ds_read_b128 a[120:123], v109 offset:14848
s_nop 0
v_mfma_f32_16x16x32_bf16 v[24:27], a[144:147], a[68:71], v[24:27]
ds_read_b128 a[124:127], v109 offset:15872
buffer_load_dwordx4 v1, s[4:7], s39 offen offset:0  lds
v_mfma_f32_16x16x32_bf16 v[28:31], a[148:151], a[68:71], v[28:31]
ds_read_b128 a[128:131], v109 offset:16896
buffer_load_dwordx4 v1, s[4:7], s39 offen offset:1024  lds
v_mfma_f32_16x16x32_bf16 v[32:35], a[152:155], a[68:71], v[32:35]
ds_read_b128 a[132:135], v113 offset:13824
buffer_load_dwordx4 v1, s[4:7], s39 offen offset:2048  lds
s_waitcnt lgkmcnt(5)
v_mfma_f32_16x16x32_bf16 v[16:19], a[96:99], a[72:75], v[16:19]
ds_read_b128 a[136:139], v109 offset:18432
buffer_load_dwordx4 a[68:71], v1, s[8:11], s60 offen offset:1024 sc1
v_mfma_f32_16x16x32_bf16 v[20:23], a[100:103], a[72:75], v[20:23]
ds_read_b128 a[140:143], v109 offset:19456
buffer_load_dwordx4 v1, s[4:7], s39 offen offset:3072  lds
v_mfma_f32_16x16x32_bf16 v[24:27], a[104:107], a[72:75], v[24:27]
ds_read_b128 a[144:147], v109 offset:20480
s_add_u32 m0, m0, 4096
v_mfma_f32_16x16x32_bf16 v[28:31], a[108:111], a[72:75], v[28:31]
ds_read_b128 a[148:151], v109 offset:21504
s_add_u32 s39, s39, 4096
v_mfma_f32_16x16x32_bf16 v[32:35], a[112:115], a[72:75], v[32:35]
ds_read_b128 a[152:155], v113 offset:18432
buffer_load_dwordx4 v1, s[4:7], s39 offen offset:0  lds
s_waitcnt lgkmcnt(5)
v_mfma_f32_16x16x32_bf16 v[16:19], a[116:119], a[76:79], v[16:19]
ds_read_b128 a[96:99], v109 offset:23040
buffer_load_dwordx4 a[72:75], v1, s[8:11], s60 offen offset:2048 sc1
v_mfma_f32_16x16x32_bf16 v[20:23], a[120:123], a[76:79], v[20:23]
ds_read_b128 a[100:103], v109 offset:24064
buffer_load_dwordx4 v1, s[4:7], s39 offen offset:1024  lds
v_mfma_f32_16x16x32_bf16 v[24:27], a[124:127], a[76:79], v[24:27]
ds_read_b128 a[104:107], v109 offset:25088
buffer_load_dwordx4 v1, s[4:7], s39 offen offset:2048  lds
v_mfma_f32_16x16x32_bf16 v[28:31], a[128:131], a[76:79], v[28:31]
ds_read_b128 a[108:111], v109 offset:26112
buffer_load_dwordx4 v1, s[4:7], s39 offen offset:3072  lds
v_mfma_f32_16x16x32_bf16 v[32:35], a[132:135], a[76:79], v[32:35]
ds_read_b128 a[112:115], v113 offset:23040
s_add_u32 m0, m0, 4096
s_waitcnt lgkmcnt(5)
v_mfma_f32_16x16x32_bf16 v[16:19], a[136:139], a[80:83], v[16:19]
ds_read_b128 a[116:119], v109 offset:27648
buffer_load_dwordx4 a[76:79], v1, s[8:11], s60 offen offset:3072 sc1
v_mfma_f32_16x16x32_bf16 v[20:23], a[140:143], a[80:83], v[20:23]
ds_read_b128 a[120:123], v109 offset:28672
s_add_u32 s39, s39, 4096
v_mfma_f32_16x16x32_bf16 v[24:27], a[144:147], a[80:83], v[24:27]
ds_read_b128 a[124:127], v109 offset:29696
buffer_load_dwordx4 v1, s[4:7], s39 offen offset:0  lds
v_mfma_f32_16x16x32_bf16 v[28:31], a[148:151], a[80:83], v[28:31]
ds_read_b128 a[128:131], v109 offset:30720
v_mfma_f32_16x16x32_bf16 v[32:35], a[152:155], a[80:83], v[32:35]
ds_read_b128 a[132:135], v113 offset:27648
s_waitcnt lgkmcnt(5)
v_mfma_f32_16x16x32_bf16 v[16:19], a[96:99], a[84:87], v[16:19]
ds_read_b128 a[136:139], v109 offset:32256
s_add_u32 s60, s60, 4096
buffer_load_dwordx4 a[80:83], v1, s[8:11], s60 offen offset:0 sc1
v_mfma_f32_16x16x32_bf16 v[20:23], a[100:103], a[84:87], v[20:23]
ds_read_b128 a[140:143], v109 offset:33280
v_mfma_f32_16x16x32_bf16 v[24:27], a[104:107], a[84:87], v[24:27]
ds_read_b128 a[144:147], v109 offset:34304
v_mfma_f32_16x16x32_bf16 v[28:31], a[108:111], a[84:87], v[28:31]
ds_read_b128 a[148:151], v109 offset:35328
v_mfma_f32_16x16x32_bf16 v[32:35], a[112:115], a[84:87], v[32:35]
ds_read_b128 a[152:155], v113 offset:32256
s_waitcnt lgkmcnt(5)
v_mfma_f32_16x16x32_bf16 v[16:19], a[116:119], a[88:91], v[16:19]
ds_read_b128 a[96:99], v110 offset:0
buffer_load_dwordx4 a[84:87], v1, s[8:11], s60 offen offset:1024 sc1
v_mfma_f32_16x16x32_bf16 v[20:23], a[120:123], a[88:91], v[20:23]
ds_read_b128 a[100:103], v110 offset:1024
v_mfma_f32_16x16x32_bf16 v[24:27], a[124:127], a[88:91], v[24:27]
ds_read_b128 a[104:107], v110 offset:2048
v_mfma_f32_16x16x32_bf16 v[28:31], a[128:131], a[88:91], v[28:31]
ds_read_b128 a[108:111], v110 offset:3072
v_mfma_f32_16x16x32_bf16 v[32:35], a[132:135], a[88:91], v[32:35]
ds_read_b128 a[112:115], v114 offset:0
s_waitcnt lgkmcnt(5)
v_mfma_f32_16x16x32_bf16 v[16:19], a[136:139], a[92:95], v[16:19]
ds_read_b128 a[116:119], v110 offset:4608
buffer_load_dwordx4 a[88:91], v1, s[8:11], s60 offen offset:2048 sc1
v_mfma_f32_16x16x32_bf16 v[20:23], a[140:143], a[92:95], v[20:23]
ds_read_b128 a[120:123], v110 offset:5632
v_mfma_f32_16x16x32_bf16 v[24:27], a[144:147], a[92:95], v[24:27]
ds_read_b128 a[124:127], v110 offset:6656
v_mfma_f32_16x16x32_bf16 v[28:31], a[148:151], a[92:95], v[28:31]
ds_read_b128 a[128:131], v110 offset:7680
v_mfma_f32_16x16x32_bf16 v[32:35], a[152:155], a[92:95], v[32:35]
ds_read_b128 a[132:135], v114 offset:4608
s_waitcnt vmcnt(20)
s_barrier
s_waitcnt lgkmcnt(5)
v_mfma_f32_16x16x32_bf16 v[16:19], a[96:99], a[0:3], v[16:19]
ds_read_b128 a[136:139], v110 offset:9216
buffer_load_dwordx4 a[92:95], v1, s[8:11], s60 offen offset:3072 sc1
v_mfma_f32_16x16x32_bf16 v[20:23], a[100:103], a[0:3], v[20:23]
ds_read_b128 a[140:143], v110 offset:10240
v_mfma_f32_16x16x32_bf16 v[24:27], a[104:107], a[0:3], v[24:27]
ds_read_b128 a[144:147], v110 offset:11264
v_mfma_f32_16x16x32_bf16 v[28:31], a[108:111], a[0:3], v[28:31]
ds_read_b128 a[148:151], v110 offset:12288
v_mfma_f32_16x16x32_bf16 v[32:35], a[112:115], a[0:3], v[32:35]
ds_read_b128 a[152:155], v114 offset:9216
s_waitcnt lgkmcnt(5)
v_mfma_f32_16x16x32_bf16 v[16:19], a[116:119], a[4:7], v[16:19]
ds_read_b128 a[96:99], v110 offset:13824
v_mfma_f32_16x16x32_bf16 v[20:23], a[120:123], a[4:7], v[20:23]
ds_read_b128 a[100:103], v110 offset:14848
v_mfma_f32_16x16x32_bf16 v[24:27], a[124:127], a[4:7], v[24:27]
ds_read_b128 a[104:107], v110 offset:15872
v_mfma_f32_16x16x32_bf16 v[28:31], a[128:131], a[4:7], v[28:31]
ds_read_b128 a[108:111], v110 offset:16896
v_mfma_f32_16x16x32_bf16 v[32:35], a[132:135], a[4:7], v[32:35]
ds_read_b128 a[112:115], v114 offset:13824
s_waitcnt lgkmcnt(5)
v_mfma_f32_16x16x32_bf16 v[16:19], a[136:139], a[8:11], v[16:19]
ds_read_b128 a[116:119], v110 offset:18432
v_mfma_f32_16x16x32_bf16 v[20:23], a[140:143], a[8:11], v[20:23]
ds_read_b128 a[120:123], v110 offset:19456
v_mfma_f32_16x16x32_bf16 v[24:27], a[144:147], a[8:11], v[24:27]
ds_read_b128 a[124:127], v110 offset:20480
v_mfma_f32_16x16x32_bf16 v[28:31], a[148:151], a[8:11], v[28:31]
ds_read_b128 a[128:131], v110 offset:21504
v_mfma_f32_16x16x32_bf16 v[32:35], a[152:155], a[8:11], v[32:35]
ds_read_b128 a[132:135], v114 offset:18432
s_waitcnt lgkmcnt(5)
v_mfma_f32_16x16x32_bf16 v[16:19], a[96:99], a[12:15], v[16:19]
ds_read_b128 a[136:139], v110 offset:23040
v_mfma_f32_16x16x32_bf16 v[20:23], a[100:103], a[12:15], v[20:23]
ds_read_b128 a[140:143], v110 offset:24064
v_mfma_f32_16x16x32_bf16 v[24:27], a[104:107], a[12:15], v[24:27]
ds_read_b128 a[144:147], v110 offset:25088
v_mfma_f32_16x16x32_bf16 v[28:31], a[108:111], a[12:15], v[28:31]
ds_read_b128 a[148:151], v110 offset:26112
v_mfma_f32_16x16x32_bf16 v[32:35], a[112:115], a[12:15], v[32:35]
ds_read_b128 a[152:155], v114 offset:23040
s_waitcnt lgkmcnt(5)
v_mfma_f32_16x16x32_bf16 v[16:19], a[116:119], a[16:19], v[16:19]
ds_read_b128 a[96:99], v110 offset:27648
v_mfma_f32_16x16x32_bf16 v[20:23], a[120:123], a[16:19], v[20:23]
ds_read_b128 a[100:103], v110 offset:28672
v_mfma_f32_16x16x32_bf16 v[24:27], a[124:127], a[16:19], v[24:27]
ds_read_b128 a[104:107], v110 offset:29696
v_mfma_f32_16x16x32_bf16 v[28:31], a[128:131], a[16:19], v[28:31]
ds_read_b128 a[108:111], v110 offset:30720
v_mfma_f32_16x16x32_bf16 v[32:35], a[132:135], a[16:19], v[32:35]
ds_read_b128 a[112:115], v114 offset:27648
s_waitcnt lgkmcnt(5)
v_mfma_f32_16x16x32_bf16 v[16:19], a[136:139], a[20:23], v[16:19]
ds_read_b128 a[116:119], v110 offset:32256
v_mfma_f32_16x16x32_bf16 v[20:23], a[140:143], a[20:23], v[20:23]
ds_read_b128 a[120:123], v110 offset:33280
v_mfma_f32_16x16x32_bf16 v[24:27], a[144:147], a[20:23], v[24:27]
ds_read_b128 a[124:127], v110 offset:34304
v_mfma_f32_16x16x32_bf16 v[28:31], a[148:151], a[20:23], v[28:31]
ds_read_b128 a[128:131], v110 offset:35328
v_mfma_f32_16x16x32_bf16 v[32:35], a[152:155], a[20:23], v[32:35]
ds_read_b128 a[132:135], v114 offset:32256
s_waitcnt lgkmcnt(5)
v_mfma_f32_16x16x32_bf16 v[16:19], a[96:99], a[24:27], v[16:19]
ds_read_b128 a[136:139], v111 offset:0
v_mfma_f32_16x16x32_bf16 v[20:23], a[100:103], a[24:27], v[20:23]
ds_read_b128 a[140:143], v111 offset:1024
v_mfma_f32_16x16x32_bf16 v[24:27], a[104:107], a[24:27], v[24:27]
ds_read_b128 a[144:147], v111 offset:2048
v_mfma_f32_16x16x32_bf16 v[28:31], a[108:111], a[24:27], v[28:31]
ds_read_b128 a[148:151], v111 offset:3072
v_mfma_f32_16x16x32_bf16 v[32:35], a[112:115], a[24:27], v[32:35]
ds_read_b128 a[152:155], v115 offset:0
s_waitcnt lgkmcnt(5)
v_mfma_f32_16x16x32_bf16 v[16:19], a[116:119], a[28:31], v[16:19]
ds_read_b128 a[96:99], v111 offset:4608
v_mfma_f32_16x16x32_bf16 v[20:23], a[120:123], a[28:31], v[20:23]
ds_read_b128 a[100:103], v111 offset:5632
v_mfma_f32_16x16x32_bf16 v[24:27], a[124:127], a[28:31], v[24:27]
ds_read_b128 a[104:107], v111 offset:6656
v_mfma_f32_16x16x32_bf16 v[28:31], a[128:131], a[28:31], v[28:31]
ds_read_b128 a[108:111], v111 offset:7680
v_mfma_f32_16x16x32_bf16 v[32:35], a[132:135], a[28:31], v[32:35]
ds_read_b128 a[112:115], v115 offset:4608
s_waitcnt vmcnt(4)
s_barrier
s_waitcnt lgkmcnt(5)
v_mfma_f32_16x16x32_bf16 v[16:19], a[136:139], a[32:35], v[16:19]
ds_read_b128 a[116:119], v111 offset:9216
v_mfma_f32_16x16x32_bf16 v[20:23], a[140:143], a[32:35], v[20:23]
ds_read_b128 a[120:123], v111 offset:10240
v_mfma_f32_16x16x32_bf16 v[24:27], a[144:147], a[32:35], v[24:27]
ds_read_b128 a[124:127], v111 offset:11264
v_mfma_f32_16x16x32_bf16 v[28:31], a[148:151], a[32:35], v[28:31]
ds_read_b128 a[128:131], v111 offset:12288
v_mfma_f32_16x16x32_bf16 v[32:35], a[152:155], a[32:35], v[32:35]
ds_read_b128 a[132:135], v115 offset:9216
s_waitcnt lgkmcnt(5)
v_mfma_f32_16x16x32_bf16 v[16:19], a[96:99], a[36:39], v[16:19]
ds_read_b128 a[136:139], v111 offset:13824
v_mfma_f32_16x16x32_bf16 v[20:23], a[100:103], a[36:39], v[20:23]
ds_read_b128 a[140:143], v111 offset:14848
v_mfma_f32_16x16x32_bf16 v[24:27], a[104:107], a[36:39], v[24:27]
ds_read_b128 a[144:147], v111 offset:15872
v_mfma_f32_16x16x32_bf16 v[28:31], a[108:111], a[36:39], v[28:31]
ds_read_b128 a[148:151], v111 offset:16896
v_mfma_f32_16x16x32_bf16 v[32:35], a[112:115], a[36:39], v[32:35]
ds_read_b128 a[152:155], v115 offset:13824
s_waitcnt lgkmcnt(5)
v_mfma_f32_16x16x32_bf16 v[16:19], a[116:119], a[40:43], v[16:19]
ds_read_b128 a[96:99], v111 offset:18432
v_mfma_f32_16x16x32_bf16 v[20:23], a[120:123], a[40:43], v[20:23]
ds_read_b128 a[100:103], v111 offset:19456
v_mfma_f32_16x16x32_bf16 v[24:27], a[124:127], a[40:43], v[24:27]
ds_read_b128 a[104:107], v111 offset:20480
v_mfma_f32_16x16x32_bf16 v[28:31], a[128:131], a[40:43], v[28:31]
ds_read_b128 a[108:111], v111 offset:21504
v_mfma_f32_16x16x32_bf16 v[32:35], a[132:135], a[40:43], v[32:35]
ds_read_b128 a[112:115], v115 offset:18432
s_waitcnt lgkmcnt(5)
v_mfma_f32_16x16x32_bf16 v[16:19], a[136:139], a[44:47], v[16:19]
ds_read_b128 a[116:119], v111 offset:23040
v_mfma_f32_16x16x32_bf16 v[20:23], a[140:143], a[44:47], v[20:23]
ds_read_b128 a[120:123], v111 offset:24064
v_mfma_f32_16x16x32_bf16 v[24:27], a[144:147], a[44:47], v[24:27]
ds_read_b128 a[124:127], v111 offset:25088
v_mfma_f32_16x16x32_bf16 v[28:31], a[148:151], a[44:47], v[28:31]
ds_read_b128 a[128:131], v111 offset:26112
v_mfma_f32_16x16x32_bf16 v[32:35], a[152:155], a[44:47], v[32:35]
ds_read_b128 a[132:135], v115 offset:23040
s_waitcnt lgkmcnt(5)
v_mfma_f32_16x16x32_bf16 v[16:19], a[96:99], a[48:51], v[16:19]
ds_read_b128 a[136:139], v111 offset:27648
v_mfma_f32_16x16x32_bf16 v[20:23], a[100:103], a[48:51], v[20:23]
ds_read_b128 a[140:143], v111 offset:28672
v_mfma_f32_16x16x32_bf16 v[24:27], a[104:107], a[48:51], v[24:27]
ds_read_b128 a[144:147], v111 offset:29696
v_mfma_f32_16x16x32_bf16 v[28:31], a[108:111], a[48:51], v[28:31]
ds_read_b128 a[148:151], v111 offset:30720
v_mfma_f32_16x16x32_bf16 v[32:35], a[112:115], a[48:51], v[32:35]
ds_read_b128 a[152:155], v115 offset:27648
s_waitcnt lgkmcnt(5)
v_mfma_f32_16x16x32_bf16 v[16:19], a[116:119], a[52:55], v[16:19]
ds_read_b128 a[96:99], v111 offset:32256
v_mfma_f32_16x16x32_bf16 v[20:23], a[120:123], a[52:55], v[20:23]
ds_read_b128 a[100:103], v111 offset:33280
v_mfma_f32_16x16x32_bf16 v[24:27], a[124:127], a[52:55], v[24:27]
ds_read_b128 a[104:107], v111 offset:34304
v_mfma_f32_16x16x32_bf16 v[28:31], a[128:131], a[52:55], v[28:31]
ds_read_b128 a[108:111], v111 offset:35328
v_mfma_f32_16x16x32_bf16 v[32:35], a[132:135], a[52:55], v[32:35]
ds_read_b128 a[112:115], v115 offset:32256
s_waitcnt lgkmcnt(5)
v_mfma_f32_16x16x32_bf16 v[16:19], a[136:139], a[56:59], v[16:19]
ds_read_b128 a[116:119], v108 offset:0
v_mfma_f32_16x16x32_bf16 v[20:23], a[140:143], a[56:59], v[20:23]
ds_read_b128 a[120:123], v108 offset:1024
v_mfma_f32_16x16x32_bf16 v[24:27], a[144:147], a[56:59], v[24:27]
ds_read_b128 a[124:127], v108 offset:2048
v_mfma_f32_16x16x32_bf16 v[28:31], a[148:151], a[56:59], v[28:31]
ds_read_b128 a[128:131], v108 offset:3072
v_mfma_f32_16x16x32_bf16 v[32:35], a[152:155], a[56:59], v[32:35]
ds_read_b128 a[132:135], v112 offset:0
s_waitcnt lgkmcnt(5)
v_mfma_f32_16x16x32_bf16 v[16:19], a[96:99], a[60:63], v[16:19]
ds_read_b128 a[136:139], v108 offset:4608
v_mfma_f32_16x16x32_bf16 v[20:23], a[100:103], a[60:63], v[20:23]
ds_read_b128 a[140:143], v108 offset:5632
v_mfma_f32_16x16x32_bf16 v[24:27], a[104:107], a[60:63], v[24:27]
ds_read_b128 a[144:147], v108 offset:6656
v_mfma_f32_16x16x32_bf16 v[28:31], a[108:111], a[60:63], v[28:31]
ds_read_b128 a[148:151], v108 offset:7680
v_mfma_f32_16x16x32_bf16 v[32:35], a[112:115], a[60:63], v[32:35]
ds_read_b128 a[152:155], v112 offset:4608
s_waitcnt lgkmcnt(5)
v_mfma_f32_16x16x32_bf16 v[16:19], a[116:119], a[64:67], v[16:19]
ds_read_b128 a[96:99], v108 offset:9216
v_mfma_f32_16x16x32_bf16 v[20:23], a[120:123], a[64:67], v[20:23]
ds_read_b128 a[100:103], v108 offset:10240
v_mfma_f32_16x16x32_bf16 v[24:27], a[124:127], a[64:67], v[24:27]
ds_read_b128 a[104:107], v108 offset:11264
v_mfma_f32_16x16x32_bf16 v[28:31], a[128:131], a[64:67], v[28:31]
ds_read_b128 a[108:111], v108 offset:12288
v_mfma_f32_16x16x32_bf16 v[32:35], a[132:135], a[64:67], v[32:35]
ds_read_b128 a[112:115], v112 offset:9216
s_waitcnt lgkmcnt(5)
v_mfma_f32_16x16x32_bf16 v[16:19], a[136:139], a[68:71], v[16:19]
ds_read_b128 a[116:119], v108 offset:13824
v_mfma_f32_16x16x32_bf16 v[20:23], a[140:143], a[68:71], v[20:23]
ds_read_b128 a[120:123], v108 offset:14848
v_mfma_f32_16x16x32_bf16 v[24:27], a[144:147], a[68:71], v[24:27]
ds_read_b128 a[124:127], v108 offset:15872
v_mfma_f32_16x16x32_bf16 v[28:31], a[148:151], a[68:71], v[28:31]
ds_read_b128 a[128:131], v108 offset:16896
v_mfma_f32_16x16x32_bf16 v[32:35], a[152:155], a[68:71], v[32:35]
ds_read_b128 a[132:135], v112 offset:13824
s_waitcnt lgkmcnt(5)
v_mfma_f32_16x16x32_bf16 v[16:19], a[96:99], a[72:75], v[16:19]
ds_read_b128 a[136:139], v108 offset:18432
v_mfma_f32_16x16x32_bf16 v[20:23], a[100:103], a[72:75], v[20:23]
ds_read_b128 a[140:143], v108 offset:19456
v_mfma_f32_16x16x32_bf16 v[24:27], a[104:107], a[72:75], v[24:27]
ds_read_b128 a[144:147], v108 offset:20480
v_mfma_f32_16x16x32_bf16 v[28:31], a[108:111], a[72:75], v[28:31]
ds_read_b128 a[148:151], v108 offset:21504
v_mfma_f32_16x16x32_bf16 v[32:35], a[112:115], a[72:75], v[32:35]
ds_read_b128 a[152:155], v112 offset:18432
s_waitcnt lgkmcnt(5)
v_mfma_f32_16x16x32_bf16 v[16:19], a[116:119], a[76:79], v[16:19]
ds_read_b128 a[96:99], v108 offset:23040
v_mfma_f32_16x16x32_bf16 v[20:23], a[120:123], a[76:79], v[20:23]
ds_read_b128 a[100:103], v108 offset:24064
v_mfma_f32_16x16x32_bf16 v[24:27], a[124:127], a[76:79], v[24:27]
ds_read_b128 a[104:107], v108 offset:25088
v_mfma_f32_16x16x32_bf16 v[28:31], a[128:131], a[76:79], v[28:31]
ds_read_b128 a[108:111], v108 offset:26112
v_mfma_f32_16x16x32_bf16 v[32:35], a[132:135], a[76:79], v[32:35]
ds_read_b128 a[112:115], v112 offset:23040
s_waitcnt vmcnt(3)
s_waitcnt lgkmcnt(5)
v_mfma_f32_16x16x32_bf16 v[16:19], a[136:139], a[80:83], v[16:19]
ds_read_b128 a[116:119], v108 offset:27648
v_mfma_f32_16x16x32_bf16 v[20:23], a[140:143], a[80:83], v[20:23]
ds_read_b128 a[120:123], v108 offset:28672
v_mfma_f32_16x16x32_bf16 v[24:27], a[144:147], a[80:83], v[24:27]
ds_read_b128 a[124:127], v108 offset:29696
v_mfma_f32_16x16x32_bf16 v[28:31], a[148:151], a[80:83], v[28:31]
ds_read_b128 a[128:131], v108 offset:30720
v_mfma_f32_16x16x32_bf16 v[32:35], a[152:155], a[80:83], v[32:35]
ds_read_b128 a[132:135], v112 offset:27648
s_waitcnt vmcnt(2)
s_waitcnt lgkmcnt(5)
v_mfma_f32_16x16x32_bf16 v[16:19], a[96:99], a[84:87], v[16:19]
ds_read_b128 a[136:139], v108 offset:32256
v_mfma_f32_16x16x32_bf16 v[20:23], a[100:103], a[84:87], v[20:23]
ds_read_b128 a[140:143], v108 offset:33280
v_mfma_f32_16x16x32_bf16 v[24:27], a[104:107], a[84:87], v[24:27]
ds_read_b128 a[144:147], v108 offset:34304
v_mfma_f32_16x16x32_bf16 v[28:31], a[108:111], a[84:87], v[28:31]
ds_read_b128 a[148:151], v108 offset:35328
v_mfma_f32_16x16x32_bf16 v[32:35], a[112:115], a[84:87], v[32:35]
ds_read_b128 a[152:155], v112 offset:32256
s_waitcnt vmcnt(1)
s_waitcnt lgkmcnt(5)
v_mfma_f32_16x16x32_bf16 v[16:19], a[116:119], a[88:91], v[16:19]
v_mfma_f32_16x16x32_bf16 v[20:23], a[120:123], a[88:91], v[20:23]
v_mfma_f32_16x16x32_bf16 v[24:27], a[124:127], a[88:91], v[24:27]
v_mfma_f32_16x16x32_bf16 v[28:31], a[128:131], a[88:91], v[28:31]
v_mfma_f32_16x16x32_bf16 v[32:35], a[132:135], a[88:91], v[32:35]
s_waitcnt vmcnt(0)
s_waitcnt lgkmcnt(0)
v_mfma_f32_16x16x32_bf16 v[16:19], a[136:139], a[92:95], v[16:19]
v_mfma_f32_16x16x32_bf16 v[20:23], a[140:143], a[92:95], v[20:23]
v_mfma_f32_16x16x32_bf16 v[24:27], a[144:147], a[92:95], v[24:27]
v_mfma_f32_16x16x32_bf16 v[28:31], a[148:151], a[92:95], v[28:31]
v_mfma_f32_16x16x32_bf16 v[32:35], a[152:155], a[92:95], v[32:35]
s_cmp_eq_u32 s29, 1
s_cbranch_scc1 L_last
s_lshl_b32 s30, s27, 2
s_add_u32 s30, s30, s24
v_mov_b32 v130, 1073741824
s_mul_i32 s31, s30, 18432
s_mul_i32 s32, s28, 2304
s_add_u32 s31, s31, s32
s_add_u32 s31, s31, 26640384
v_mov_b32 v132, v1
v_add_u32 v133, 2048, v132
v_cndmask_b32 v133, v130, v133, s[46:47]
v_cvt_pk_bf16_f32 v116, v16, v17
v_cvt_pk_bf16_f32 v117, v18, v19
v_cvt_pk_bf16_f32 v118, v20, v21
v_cvt_pk_bf16_f32 v119, v22, v23
v_cvt_pk_bf16_f32 v120, v24, v25
v_cvt_pk_bf16_f32 v121, v26, v27
v_cvt_pk_bf16_f32 v122, v28, v29
v_cvt_pk_bf16_f32 v123, v30, v31
v_cvt_pk_bf16_f32 v124, v32, v33
v_cvt_pk_bf16_f32 v125, v34, v35
buffer_store_dwordx4 v[116:119], v132, s[8:11], s31 offen sc1
buffer_store_dwordx4 v[120:123], v132, s[8:11], s31 offen offset:1024 sc1
v_permlane16_swap_b32 v124, v126
v_permlane16_swap_b32 v125, v127
buffer_store_dwordx4 v[124:127], v133, s[8:11], s31 offen sc1
v_add_f32 v128, v32, v33
v_mul_f32 v129, v32, v32
v_fmac_f32 v129, v33, v33
v_add_f32 v128, v128, v34
v_fmac_f32 v129, v34, v34
v_add_f32 v128, v128, v35
v_fmac_f32 v129, v35, v35
v_cndmask_b32 v128, 0, v128, s[50:51]
v_cndmask_b32 v129, 0, v129, s[50:51]
v_add_f32 v128, v128, v16
v_fmac_f32 v129, v16, v16
v_add_f32 v128, v128, v17
v_fmac_f32 v129, v17, v17
v_add_f32 v128, v128, v18
v_fmac_f32 v129, v18, v18
v_add_f32 v128, v128, v19
v_fmac_f32 v129, v19, v19
v_add_f32 v128, v128, v20
v_fmac_f32 v129, v20, v20
v_add_f32 v128, v128, v21
v_fmac_f32 v129, v21, v21
v_add_f32 v128, v128, v22
v_fmac_f32 v129, v22, v22
v_add_f32 v128, v128, v23
v_fmac_f32 v129, v23, v23
v_add_f32 v128, v128, v24
v_fmac_f32 v129, v24, v24
v_add_f32 v128, v128, v25
v_fmac_f32 v129, v25, v25
v_add_f32 v128, v128, v26
v_fmac_f32 v129, v26, v26
v_add_f32 v128, v128, v27
v_fmac_f32 v129, v27, v27
v_add_f32 v128, v128, v28
v_fmac_f32 v129, v28, v28
v_add_f32 v128, v128, v29
v_fmac_f32 v129, v29, v29
v_add_f32 v128, v128, v30
v_fmac_f32 v129, v30, v30
v_add_f32 v128, v128, v31
v_fmac_f32 v129, v31, v31
s_lshl_b32 s31, s30, 7
s_lshl_b32 s32, s28, 14
v_permlane32_swap_b32 v128, v129
v_add_f32 v128, v128, v129
v_mov_b32 v129, v128
s_add_u32 s31, s31, s32
s_add_u32 s31, s31, 28999680
v_permlane16_swap_b32 v128, v129
v_add_f32 v128, v128, v129
v_mov_b32 v129, v128
v_lshlrev_b32 v131, 3, v2
v_cndmask_b32 v130, v130, v131, s[46:47]
v_permlane32_swap_b32 v128, v129
buffer_store_dwordx2 v[128:129], v130, s[8:11], s31 offen sc1
s_and_b32 s33, s27, 1
s_cmp_lt_u32 s27, 31
s_cselect_b32 s33, s33, 0
s_cmp_eq_u32 s33, 1
s_cselect_b32 s34, -1, 0xffff
s_mov_b32 s35, 0
s_waitcnt vmcnt(0)
s_barrier
s_cmp_eq_u32 s24, 0
s_cbranch_scc0 L_sig_17
v_lshlrev_b32 v6, 3, v1
s_lshr_b32 s31, s81, 4
s_lshl_b32 s31, s31, 11
s_and_b32 s32, s81, 15
s_lshl_b32 s32, s32, 2
s_add_u32 s31, s31, s32
v_add_u32 v6, s31, v6
v_lshl_add_u32 v6, v3, 5, v6
s_mov_b64 exec, s[34:35]
s_mov_b32 s30, 26607616
buffer_store_dword v4, v6, s[8:11], s30 offen sc1
s_mov_b64 exec, -1
L_sig_17:
s_cmp_eq_u32 s29, 1
s_cbranch_scc1 L_main_fin
s_mul_i32 s30, s26, 132608
s_mul_i32 s38, s24, 33792
s_add_u32 s39, s38, s30
s_add_u32 m0, s38, 0
s_nop 0
buffer_load_dwordx4 v1, s[4:7], s39 offen offset:0  lds
buffer_load_dwordx4 v1, s[4:7], s39 offen offset:1024  lds
buffer_load_dwordx4 v1, s[4:7], s39 offen offset:2048  lds
buffer_load_dwordx4 v1, s[4:7], s39 offen offset:3072  lds
s_add_u32 m0, m0, 4096
s_add_u32 s39, s39, 4096
buffer_load_dwordx4 v1, s[4:7], s39 offen offset:0  lds
buffer_load_dwordx4 v1, s[4:7], s39 offen offset:1024  lds
buffer_load_dwordx4 v1, s[4:7], s39 offen offset:2048  lds
buffer_load_dwordx4 v1, s[4:7], s39 offen offset:3072  lds
s_add_u32 m0, m0, 4096
s_add_u32 s39, s39, 4096
buffer_load_dwordx4 v1, s[4:7], s39 offen offset:0  lds
buffer_load_dwordx4 v1, s[4:7], s39 offen offset:1024  lds
buffer_load_dwordx4 v1, s[4:7], s39 offen offset:2048  lds
buffer_load_dwordx4 v1, s[4:7], s39 offen offset:3072  lds
s_add_u32 m0, m0, 4096
s_add_u32 s39, s39, 4096
buffer_load_dwordx4 v1, s[4:7], s39 offen offset:0  lds
buffer_load_dwordx4 v1, s[4:7], s39 offen offset:1024  lds
buffer_load_dwordx4 v1, s[4:7], s39 offen offset:2048  lds
buffer_load_dwordx4 v1, s[4:7], s39 offen offset:3072  lds
s_add_u32 m0, m0, 4096
s_add_u32 s39, s39, 4096
buffer_load_dwordx4 v1, s[4:7], s39 offen offset:0  lds
buffer_load_dwordx4 v1, s[4:7], s39 offen offset:1024  lds
buffer_load_dwordx4 v1, s[4:7], s39 offen offset:2048  lds
buffer_load_dwordx4 v1, s[4:7], s39 offen offset:3072  lds
s_add_u32 m0, m0, 4096
s_add_u32 s39, s39, 4096
buffer_load_dwordx4 v1, s[4:7], s39 offen offset:0  lds
buffer_load_dwordx4 v1, s[4:7], s39 offen offset:1024  lds
buffer_load_dwordx4 v1, s[4:7], s39 offen offset:2048  lds
buffer_load_dwordx4 v1, s[4:7], s39 offen offset:3072  lds
s_add_u32 m0, m0, 4096
s_add_u32 s39, s39, 4096
buffer_load_dwordx4 v1, s[4:7], s39 offen offset:0  lds
buffer_load_dwordx4 v1, s[4:7], s39 offen offset:1024  lds
buffer_load_dwordx4 v1, s[4:7], s39 offen offset:2048  lds
buffer_load_dwordx4 v1, s[4:7], s39 offen offset:3072  lds
s_add_u32 m0, m0, 4096
s_add_u32 s39, s39, 4096
buffer_load_dwordx4 v1, s[4:7], s39 offen offset:0  lds
buffer_load_dwordx4 v1, s[4:7], s39 offen offset:1024  lds
buffer_load_dwordx4 v1, s[4:7], s39 offen offset:2048  lds
buffer_load_dwordx4 v1, s[4:7], s39 offen offset:3072  lds
s_add_u32 m0, m0, 4096
s_add_u32 s39, s39, 4096
buffer_load_dwordx4 v1, s[4:7], s39 offen offset:0  lds
s_mov_b32 s34, 0xffffff
s_cmp_eq_u32 s25, 0
s_cselect_b32 s34, 0xffff, s34
s_mov_b32 s35, 0
s_cmp_eq_u32 s24, 1
s_cbranch_scc0 L_polled_19
s_lshl_b32 s30, s80, 7
s_add_u32 s30, s30, 26607616
v_lshrrev_b32 v6, 2, v1
s_mov_b32 s31, 0
s_mov_b64 exec, s[34:35]
L_poll_18:
buffer_load_dword v7, v6, s[8:11], s30 offen sc1
s_add_u32 s31, s31, 1
s_waitcnt vmcnt(0)
v_cmp_ne_u32 vcc, 1, v7
s_cmp_gt_u32 s31, 200000
s_cbranch_scc1 L_polled_19
s_cbranch_vccnz L_poll_18
L_polled_19:
s_mov_b64 exec, -1
s_waitcnt vmcnt(0)
s_barrier
s_mov_b32 s29, 1
s_add_u32 s8, s8, 26640384
s_addc_u32 s9, s9, 0
s_mov_b32 s10, 26640384
s_branch L_layer
L_last:
s_lshl_b32 s30, s27, 2
s_add_u32 s30, s30, s24
v_mov_b32 v130, 1073741824
s_mul_i32 s31, s30, 18432
s_mul_i32 s32, s28, 144
s_add_u32 s31, s31, s32
v_mul_u32_u24 v132, 1152, v2
v_lshl_add_u32 v132, v3, 4, v132
v_add_u32 v133, 128, v132
v_cndmask_b32 v133, v130, v133, s[46:47]
v_cvt_pk_bf16_f32 v116, v16, v17
v_cvt_pk_bf16_f32 v117, v18, v19
v_cvt_pk_bf16_f32 v118, v20, v21
v_cvt_pk_bf16_f32 v119, v22, v23
v_cvt_pk_bf16_f32 v120, v24, v25
v_cvt_pk_bf16_f32 v121, v26, v27
v_cvt_pk_bf16_f32 v122, v28, v29
v_cvt_pk_bf16_f32 v123, v30, v31
v_cvt_pk_bf16_f32 v124, v32, v33
v_cvt_pk_bf16_f32 v125, v34, v35
buffer_store_dwordx4 v[116:119], v132, s[16:19], s31 offen
buffer_store_dwordx4 v[120:123], v132, s[16:19], s31 offen offset:64
v_permlane16_swap_b32 v124, v126
v_permlane16_swap_b32 v125, v127
buffer_store_dwordx4 v[124:127], v133, s[16:19], s31 offen
L_main_fin:
L_main_end:
s_endpgm
.section .rodata,"a"
.p2align 6
.amdhsa_kernel prep_kernel
  .amdhsa_next_free_vgpr 64
  .amdhsa_next_free_sgpr 40
  .amdhsa_accum_offset 64
  .amdhsa_group_segment_fixed_size 0
  .amdhsa_kernarg_size 88
  .amdhsa_user_sgpr_count 2
  .amdhsa_user_sgpr_kernarg_segment_ptr 1
  .amdhsa_system_sgpr_workgroup_id_x 1
  .amdhsa_float_denorm_mode_32 3
.end_amdhsa_kernel
.p2align 6
.amdhsa_kernel main_kernel
  .amdhsa_next_free_vgpr 512
  .amdhsa_next_free_sgpr 102
  .amdhsa_accum_offset 256
  .amdhsa_group_segment_fixed_size 0
  .amdhsa_kernarg_size 88
  .amdhsa_user_sgpr_count 2
  .amdhsa_user_sgpr_kernarg_segment_ptr 1
  .amdhsa_system_sgpr_workgroup_id_x 1
  .amdhsa_float_denorm_mode_32 3
.end_amdhsa_kernel
```

```asm
; @launch kernel=prep_kernel grid=(1216,1,1) block=(256,1,1) lds=20480
; @launch kernel=main_kernel grid=(256,1,1) block=(256,1,1) lds=163840
.amdgcn_target "amdgcn-amd-amdhsa--gfx950"
.text
.globl prep_kernel
.p2align 8
.type prep_kernel,@function
prep_kernel:
s_cmp_ge_u32 s2, 1216
s_cbranch_scc1 L_prep_end
s_load_dwordx2 s[4:5], s[0:1], 80
v_lshrrev_b32 v4, 6, v0
v_and_b32 v1, 63, v0
v_readfirstlane_b32 s12, v4
v_and_b32 v2, 15, v1
v_lshrrev_b32 v3, 4, v1
s_mov_b32 s6, 72564736
s_mov_b32 s7, 0x20000
s_mov_b32 s11, 0x20000
s_cmp_lt_u32 s2, 128
s_cbranch_scc1 L_prep_x
s_cmp_lt_u32 s2, 236
s_cbranch_scc1 L_prep_w1
s_cmp_lt_u32 s2, 272
s_cbranch_scc1 L_prep_w2
s_cmp_lt_u32 s2, 560
s_cbranch_scc1 L_prep_w3
s_cmp_lt_u32 s2, 704
s_cbranch_scc1 L_prep_w5
s_load_dwordx2 s[8:9], s[0:1], 40
s_mov_b32 s10, 8388608
s_sub_u32 s13, s2, 704
s_lshr_b32 s16, s13, 2
s_lshl_b32 s16, s16, 16
s_and_b32 s17, s13, 3
s_lshl_b32 s17, s17, 2
s_add_u32 s17, s17, s12
s_lshl_b32 s18, s17, 8
s_add_u32 s18, s18, s16
s_lshl_b32 s17, s17, 12
s_add_u32 s17, s17, s16
s_add_u32 s17, s17, 10895360
s_lshl_b32 s19, s12, 12
s_mov_b32 m0, s19
v_lshlrev_b32 v8, 4, v1
v_add_u32 v4, 0, v3
v_xor_b32 v5, v4, v2
v_lshlrev_b32 v4, 12, v4
v_lshl_add_u32 v40, v5, 4, v4
v_add_u32 v4, 4, v3
v_xor_b32 v5, v4, v2
v_lshlrev_b32 v4, 12, v4
v_lshl_add_u32 v41, v5, 4, v4
v_subrev_u32 v41, 1024, v41
v_add_u32 v4, 8, v3
v_xor_b32 v5, v4, v2
v_lshlrev_b32 v4, 12, v4
v_lshl_add_u32 v42, v5, 4, v4
v_subrev_u32 v42, 2048, v42
v_add_u32 v4, 12, v3
v_xor_b32 v5, v4, v2
v_lshlrev_b32 v4, 12, v4
v_lshl_add_u32 v43, v5, 4, v4
v_subrev_u32 v43, 3072, v43
s_waitcnt lgkmcnt(0)
buffer_load_dwordx4 v40, s[8:11], s18 offen offset:0 nt lds
buffer_load_dwordx4 v41, s[8:11], s18 offen offset:1024 nt lds
buffer_load_dwordx4 v42, s[8:11], s18 offen offset:2048 nt lds
buffer_load_dwordx4 v43, s[8:11], s18 offen offset:3072 nt lds
v_add_u32 v4, 0, v3
v_xor_b32 v4, v4, v2
v_lshlrev_b32 v4, 4, v4
v_lshl_add_u32 v4, v2, 8, v4
v_add_u32 v44, s19, v4
v_add_u32 v4, 4, v3
v_xor_b32 v4, v4, v2
v_lshlrev_b32 v4, 4, v4
v_lshl_add_u32 v4, v2, 8, v4
v_add_u32 v45, s19, v4
v_add_u32 v4, 8, v3
v_xor_b32 v4, v4, v2
v_lshlrev_b32 v4, 4, v4
v_lshl_add_u32 v4, v2, 8, v4
v_add_u32 v46, s19, v4
v_add_u32 v4, 12, v3
v_xor_b32 v4, v4, v2
v_lshlrev_b32 v4, 4, v4
v_lshl_add_u32 v4, v2, 8, v4
v_add_u32 v47, s19, v4
s_waitcnt vmcnt(0)
ds_read_b128 v[16:19], v44
ds_read_b128 v[20:23], v45
ds_read_b128 v[24:27], v46
ds_read_b128 v[28:31], v47
s_waitcnt lgkmcnt(3)
buffer_store_dwordx4 v[16:19], v8, s[4:7], s17 offen offset:0 sc1
s_waitcnt lgkmcnt(2)
buffer_store_dwordx4 v[20:23], v8, s[4:7], s17 offen offset:1024 sc1
s_waitcnt lgkmcnt(1)
buffer_store_dwordx4 v[24:27], v8, s[4:7], s17 offen offset:2048 sc1
s_waitcnt lgkmcnt(0)
buffer_store_dwordx4 v[28:31], v8, s[4:7], s17 offen offset:3072 sc1
s_branch L_prep_fin
L_prep_w5:
s_load_dwordx2 s[8:9], s[0:1], 56
s_mov_b32 s10, 2654208
s_sub_u32 s13, s2, 560
s_and_b32 s14, s13, 15
s_lshr_b32 s15, s13, 4
s_mul_i32 s16, s14, 165888
s_lshl_b32 s17, s15, 7
s_add_u32 s16, s16, s17
s_mul_i32 s17, s12, 9216
s_add_u32 s16, s16, s17
v_lshrrev_b32 v4, 3, v1
v_mul_u32_u24 v7, 1152, v4
v_and_b32 v4, 7, v1
v_lshl_add_u32 v7, v4, 4, v7
s_lshl_b32 s18, s12, 10
s_waitcnt lgkmcnt(0)
s_add_u32 s19, s18, 0
s_mov_b32 m0, s19
s_add_u32 s17, s16, 0
buffer_load_dwordx4 v7, s[8:11], s17 offen nt lds
s_add_u32 s19, s18, 4096
s_mov_b32 m0, s19
s_add_u32 s17, s16, 36864
buffer_load_dwordx4 v7, s[8:11], s17 offen nt lds
s_add_u32 s19, s18, 8192
s_mov_b32 m0, s19
s_add_u32 s17, s16, 73728
buffer_load_dwordx4 v7, s[8:11], s17 offen nt lds
s_add_u32 s19, s18, 12288
s_mov_b32 m0, s19
s_add_u32 s17, s16, 110592
buffer_load_dwordx4 v7, s[8:11], s17 offen nt lds
s_add_u32 s19, s18, 16384
s_mov_b32 m0, s19
s_add_u32 s17, s16, 147456
s_cmp_lt_u32 s12, 2
s_cselect_b32 s17, s17, 1073741824
buffer_load_dwordx4 v7, s[8:11], s17 offen nt lds
v_lshrrev_b32 v4, 2, v2
v_lshl_add_u32 v4, v3, 3, v4
v_lshlrev_b32 v10, 7, v4
v_and_b32 v4, 3, v2
v_lshl_add_u32 v10, v4, 3, v10
s_lshl_b32 s17, s12, 5
v_add_u32 v10, s17, v10
s_lshl_b32 s17, s15, 6
s_lshl_b32 s19, s12, 4
s_add_u32 s17, s17, s19
v_add_u32 v4, s17, v2
v_mul_u32_u24 v5, 911, v4
v_lshrrev_b32 v5, 16, v5
v_mul_u32_u24 v6, 72, v5
v_sub_u32 v4, v4, v6
s_mov_b32 s17, 331776
v_mul_lo_u32 v8, v5, s17
s_mul_i32 s17, s14, 18
v_add_u32 v5, s17, v3
v_and_b32 v6, 3, v5
v_lshrrev_b32 v5, 2, v5
v_mul_u32_u24 v5, 4608, v5
v_add_u32 v8, v8, v5
v_add_u32 v8, 8241152, v8
v_lshrrev_b32 v14, 5, v4
v_lshlrev_b32 v14, 11, v14
v_bfe_u32 v15, v4, 2, 1
v_lshl_add_u32 v14, v15, 10, v14
v_bfe_u32 v15, v4, 3, 2
v_lshl_add_u32 v14, v15, 6, v14
v_and_b32 v15, 3, v4
v_lshl_add_u32 v14, v15, 4, v14
v_lshl_add_u32 v14, v6, 8, v14
v_lshlrev_b32 v15, 4, v4
v_add_u32 v15, 3072, v15
v_lshl_add_u32 v15, v6, 7, v15
v_cmp_gt_u32 vcc, 64, v4
s_nop 1
v_cndmask_b32 v14, v15, v14, vcc
v_add_u32 v8, v8, v14
s_waitcnt vmcnt(0)
s_barrier
ds_read_b64_tr_b16 v[16:17], v10 offset:0
ds_read_b64_tr_b16 v[18:19], v10 offset:512
ds_read_b64_tr_b16 v[20:21], v10 offset:4096
ds_read_b64_tr_b16 v[22:23], v10 offset:4608
ds_read_b64_tr_b16 v[24:25], v10 offset:8192
ds_read_b64_tr_b16 v[26:27], v10 offset:8704
ds_read_b64_tr_b16 v[28:29], v10 offset:12288
ds_read_b64_tr_b16 v[30:31], v10 offset:12800
ds_read_b64_tr_b16 v[32:33], v10 offset:16384
ds_read_b64_tr_b16 v[34:35], v10 offset:16896
v_cmp_gt_u32 vcc, 2, v3
v_mov_b32 v4, 1073741824
v_mov_b32 v11, 0
v_cndmask_b32 v4, v4, v8, vcc
s_mov_b32 s17, 0
s_waitcnt lgkmcnt(8)
buffer_store_dwordx4 v[16:19], v8, s[4:7], s17 offen sc1
s_mov_b32 s17, 4608
s_waitcnt lgkmcnt(6)
buffer_store_dwordx4 v[20:23], v8, s[4:7], s17 offen sc1
s_mov_b32 s17, 9216
s_waitcnt lgkmcnt(4)
buffer_store_dwordx4 v[24:27], v8, s[4:7], s17 offen sc1
s_mov_b32 s17, 13824
s_waitcnt lgkmcnt(2)
buffer_store_dwordx4 v[28:31], v8, s[4:7], s17 offen sc1
s_mov_b32 s17, 18432
s_waitcnt lgkmcnt(0)
buffer_store_dwordx4 v[32:35], v4, s[4:7], s17 offen sc1
s_branch L_prep_tail
L_prep_w3:
s_load_dwordx2 s[8:9], s[0:1], 32
s_mov_b32 s10, 5308416
s_sub_u32 s13, s2, 272
s_and_b32 s14, s13, 3
s_lshr_b32 s15, s13, 2
s_mul_i32 s16, s14, 1327104
s_lshl_b32 s17, s15, 7
s_add_u32 s16, s16, s17
s_mul_i32 s17, s12, 73728
s_add_u32 s16, s16, s17
v_lshrrev_b32 v4, 3, v1
v_mul_u32_u24 v7, 9216, v4
v_and_b32 v4, 7, v1
v_lshl_add_u32 v7, v4, 4, v7
s_lshl_b32 s18, s12, 10
s_waitcnt lgkmcnt(0)
s_add_u32 s19, s18, 0
s_mov_b32 m0, s19
s_add_u32 s17, s16, 0
buffer_load_dwordx4 v7, s[8:11], s17 offen nt lds
s_add_u32 s19, s18, 4096
s_mov_b32 m0, s19
s_add_u32 s17, s16, 294912
buffer_load_dwordx4 v7, s[8:11], s17 offen nt lds
s_add_u32 s19, s18, 8192
s_mov_b32 m0, s19
s_add_u32 s17, s16, 589824
buffer_load_dwordx4 v7, s[8:11], s17 offen nt lds
s_add_u32 s19, s18, 12288
s_mov_b32 m0, s19
s_add_u32 s17, s16, 884736
buffer_load_dwordx4 v7, s[8:11], s17 offen nt lds
s_add_u32 s19, s18, 16384
s_mov_b32 m0, s19
s_add_u32 s17, s16, 1179648
s_cmp_lt_u32 s12, 2
s_cselect_b32 s17, s17, 1073741824
buffer_load_dwordx4 v7, s[8:11], s17 offen nt lds
v_lshrrev_b32 v4, 2, v2
v_lshl_add_u32 v4, v3, 3, v4
v_lshlrev_b32 v10, 7, v4
v_and_b32 v4, 3, v2
v_lshl_add_u32 v10, v4, 3, v10
s_lshl_b32 s17, s12, 5
v_add_u32 v10, s17, v10
s_lshl_b32 s20, s15, 6
s_lshl_b32 s19, s12, 4
s_add_u32 s20, s20, s19
s_cmp_ge_u32 s20, 2304
s_cselect_b32 s21, 1, 0
s_cselect_b32 s19, 2304, 0
s_sub_u32 s20, s20, s19
s_mul_i32 s22, s20, 1821
s_lshr_b32 s22, s22, 19
s_mul_i32 s19, s22, 288
s_sub_u32 s20, s20, s19
s_lshr_b32 s23, s20, 5
s_bfe_u32 s24, s20, 0x10004
s_lshl_b32 s22, s22, 1
s_cmp_ge_u32 s20, 144
s_addc_u32 s22, s22, 0
s_cmp_gt_u32 s23, 4
s_cselect_b32 s19, 5, 0
s_sub_u32 s25, s23, s19
s_cmp_eq_u32 s21, 0
s_cselect_b32 s19, 5, 0
s_add_u32 s25, s25, s19
s_cmp_eq_u32 s23, 4
s_cselect_b32 s25, 4, s25
s_mul_i32 s22, s22, 9
s_add_u32 s22, s22, s25
s_mul_i32 s22, s22, 37888
s_add_u32 s22, s22, 2785280
v_and_b32 v4, 3, v2
v_bfe_u32 v5, v2, 2, 1
v_bfe_u32 v6, v2, 3, 1
s_cmp_eq_u32 s23, 4
s_cbranch_scc1 L_prep_w3m
s_cmp_eq_u32 s21, 0
s_cbranch_scc1 L_prep_w3a
s_lshl_b32 s19, s24, 4
v_add_u32 v4, s19, v2
s_branch L_prep_w3j
L_prep_w3a:
v_lshl_add_u32 v4, v5, 4, v4
v_lshl_add_u32 v4, v6, 3, v4
s_lshl_b32 s19, s24, 2
v_add_u32 v4, s19, v4
s_branch L_prep_w3j
L_prep_w3m:
v_lshl_add_u32 v4, v5, 3, v4
v_lshl_add_u32 v4, v6, 2, v4
s_xor_b32 s19, s21, 1
s_lshl_b32 s19, s19, 4
v_add_u32 v4, s19, v4
L_prep_w3j:
v_lshlrev_b32 v4, 4, v4
v_add_u32 v4, s22, v4
s_mul_i32 s17, s14, 9216
v_lshl_add_u32 v8, v3, 9, v4
v_add_u32 v8, s17, v8
s_lshr_b32 s17, s14, 1
s_lshl_b32 s17, s17, 9
s_and_b32 s19, s14, 1
s_lshl_b32 s19, s19, 3
s_add_u32 s17, s17, s19
s_add_u32 s17, s17, 36864
v_add_u32 v9, s17, v4
s_waitcnt vmcnt(0)
s_barrier
ds_read_b64_tr_b16 v[16:17], v10 offset:0
ds_read_b64_tr_b16 v[18:19], v10 offset:512
ds_read_b64_tr_b16 v[20:21], v10 offset:4096
ds_read_b64_tr_b16 v[22:23], v10 offset:4608
ds_read_b64_tr_b16 v[24:25], v10 offset:8192
ds_read_b64_tr_b16 v[26:27], v10 offset:8704
ds_read_b64_tr_b16 v[28:29], v10 offset:12288
ds_read_b64_tr_b16 v[30:31], v10 offset:12800
ds_read_b64_tr_b16 v[32:33], v10 offset:16384
ds_read_b64_tr_b16 v[34:35], v10 offset:16896
v_cmp_gt_u32 vcc, 2, v3
v_mov_b32 v4, 1073741824
v_mov_b32 v11, 0
v_cndmask_b32 v4, v4, v8, vcc
s_mov_b32 s17, 0
s_waitcnt lgkmcnt(8)
buffer_store_dwordx4 v[16:19], v8, s[4:7], s17 offen sc1
s_mov_b32 s17, 2048
s_waitcnt lgkmcnt(6)
buffer_store_dwordx4 v[20:23], v8, s[4:7], s17 offen sc1
s_mov_b32 s17, 4096
s_waitcnt lgkmcnt(4)
buffer_store_dwordx4 v[24:27], v8, s[4:7], s17 offen sc1
s_mov_b32 s17, 6144
s_waitcnt lgkmcnt(2)
buffer_store_dwordx4 v[28:31], v8, s[4:7], s17 offen sc1
s_mov_b32 s17, 8192
s_waitcnt lgkmcnt(0)
buffer_store_dwordx4 v[32:35], v4, s[4:7], s17 offen sc1
v_mov_b32 v5, 0x3f803f80
v_dot2c_f32_bf16 v11, v16, v5
v_dot2c_f32_bf16 v11, v17, v5
v_dot2c_f32_bf16 v11, v18, v5
v_dot2c_f32_bf16 v11, v19, v5
v_dot2c_f32_bf16 v11, v20, v5
v_dot2c_f32_bf16 v11, v21, v5
v_dot2c_f32_bf16 v11, v22, v5
v_dot2c_f32_bf16 v11, v23, v5
v_dot2c_f32_bf16 v11, v24, v5
v_dot2c_f32_bf16 v11, v25, v5
v_dot2c_f32_bf16 v11, v26, v5
v_dot2c_f32_bf16 v11, v27, v5
v_dot2c_f32_bf16 v11, v28, v5
v_dot2c_f32_bf16 v11, v29, v5
v_dot2c_f32_bf16 v11, v30, v5
v_dot2c_f32_bf16 v11, v31, v5
v_dot2c_f32_bf16 v11, v32, v5
v_dot2c_f32_bf16 v11, v33, v5
v_dot2c_f32_bf16 v11, v34, v5
v_dot2c_f32_bf16 v11, v35, v5
s_nop 2
v_mov_b32 v5, v11
s_nop 1
v_permlane32_swap_b32 v11, v5
v_add_f32 v11, v11, v5
v_mov_b32 v5, v11
s_nop 1
v_permlane16_swap_b32 v11, v5
v_add_f32 v11, v11, v5
v_cvt_pk_bf16_f32 v14, v11, v11
v_and_b32 v5, 0xffff0000, v14
v_sub_f32 v5, v11, v5
v_cvt_pk_bf16_f32 v15, v5, v5
v_cmp_eq_u32 vcc, 0, v3
v_mov_b32 v4, 1073741824
s_nop 0
v_cndmask_b32 v4, v4, v9, vcc
buffer_store_dwordx2 v[14:15], v4, s[4:7], 0 offen
s_branch L_prep_tail
L_prep_w2:
s_load_dwordx2 s[8:9], s[0:1], 16
s_mov_b32 s10, 663552
s_sub_u32 s13, s2, 236
s_and_b32 s14, s13, 3
s_lshr_b32 s15, s13, 2
s_mul_i32 s16, s14, 165888
s_lshl_b32 s17, s15, 7
s_add_u32 s16, s16, s17
s_mul_i32 s17, s12, 9216
s_add_u32 s16, s16, s17
v_lshrrev_b32 v4, 3, v1
v_mul_u32_u24 v7, 1152, v4
v_and_b32 v4, 7, v1
v_lshl_add_u32 v7, v4, 4, v7
s_lshl_b32 s18, s12, 10
s_waitcnt lgkmcnt(0)
s_add_u32 s19, s18, 0
s_mov_b32 m0, s19
s_add_u32 s17, s16, 0
buffer_load_dwordx4 v7, s[8:11], s17 offen nt lds
s_add_u32 s19, s18, 4096
s_mov_b32 m0, s19
s_add_u32 s17, s16, 36864
buffer_load_dwordx4 v7, s[8:11], s17 offen nt lds
s_add_u32 s19, s18, 8192
s_mov_b32 m0, s19
s_add_u32 s17, s16, 73728
buffer_load_dwordx4 v7, s[8:11], s17 offen nt lds
s_add_u32 s19, s18, 12288
s_mov_b32 m0, s19
s_add_u32 s17, s16, 110592
buffer_load_dwordx4 v7, s[8:11], s17 offen nt lds
s_add_u32 s19, s18, 16384
s_mov_b32 m0, s19
s_add_u32 s17, s16, 147456
s_cmp_lt_u32 s12, 2
s_cselect_b32 s17, s17, 1073741824
buffer_load_dwordx4 v7, s[8:11], s17 offen nt lds
v_lshrrev_b32 v14, 2, v2
v_and_b32 v15, 3, v2
v_lshlrev_b32 v15, 3, v15
s_lshl_b32 s17, s12, 5
v_add_u32 v15, s17, v15
v_add_u32 v4, 0, v3
v_cmp_le_u32 vcc, 9, v4
v_subrev_u32 v5, 9, v4
s_nop 0
v_cndmask_b32 v4, v4, v5, vcc
v_cndmask_b32 v6, 0, 1, vcc
v_mul_u32_u24 v6, 72, v6
v_lshrrev_b32 v5, 2, v4
v_mul_u32_u24 v5, 36, v5
v_and_b32 v13, 3, v4
v_lshl_add_u32 v5, v13, 2, v5
v_add_u32 v5, v5, v14
v_lshrrev_b32 v13, 1, v14
v_mul_u32_u24 v13, 18, v13
v_and_b32 v50, 1, v14
v_add3_u32 v13, v13, v50, 16
v_cmp_eq_u32 vcc, 8, v4
v_mov_b32 v50, 18
s_nop 0
v_cndmask_b32 v5, v5, v13, vcc
v_cndmask_b32 v50, v50, 36, vcc
v_add_u32 v5, v5, v6
v_add_u32 v50, v50, v5
v_min_u32 v5, 159, v5
v_min_u32 v50, 159, v50
v_lshl_add_u32 v40, v5, 7, v15
v_lshl_add_u32 v41, v50, 7, v15
v_add_u32 v4, 4, v3
v_cmp_le_u32 vcc, 9, v4
v_subrev_u32 v5, 9, v4
s_nop 0
v_cndmask_b32 v4, v4, v5, vcc
v_cndmask_b32 v6, 0, 1, vcc
v_mul_u32_u24 v6, 72, v6
v_lshrrev_b32 v5, 2, v4
v_mul_u32_u24 v5, 36, v5
v_and_b32 v13, 3, v4
v_lshl_add_u32 v5, v13, 2, v5
v_add_u32 v5, v5, v14
v_lshrrev_b32 v13, 1, v14
v_mul_u32_u24 v13, 18, v13
v_and_b32 v50, 1, v14
v_add3_u32 v13, v13, v50, 16
v_cmp_eq_u32 vcc, 8, v4
v_mov_b32 v50, 18
s_nop 0
v_cndmask_b32 v5, v5, v13, vcc
v_cndmask_b32 v50, v50, 36, vcc
v_add_u32 v5, v5, v6
v_add_u32 v50, v50, v5
v_min_u32 v5, 159, v5
v_min_u32 v50, 159, v50
v_lshl_add_u32 v42, v5, 7, v15
v_lshl_add_u32 v43, v50, 7, v15
v_add_u32 v4, 8, v3
v_cmp_le_u32 vcc, 9, v4
v_subrev_u32 v5, 9, v4
s_nop 0
v_cndmask_b32 v4, v4, v5, vcc
v_cndmask_b32 v6, 0, 1, vcc
v_mul_u32_u24 v6, 72, v6
v_lshrrev_b32 v5, 2, v4
v_mul_u32_u24 v5, 36, v5
v_and_b32 v13, 3, v4
v_lshl_add_u32 v5, v13, 2, v5
v_add_u32 v5, v5, v14
v_lshrrev_b32 v13, 1, v14
v_mul_u32_u24 v13, 18, v13
v_and_b32 v50, 1, v14
v_add3_u32 v13, v13, v50, 16
v_cmp_eq_u32 vcc, 8, v4
v_mov_b32 v50, 18
s_nop 0
v_cndmask_b32 v5, v5, v13, vcc
v_cndmask_b32 v50, v50, 36, vcc
v_add_u32 v5, v5, v6
v_add_u32 v50, v50, v5
v_min_u32 v5, 159, v5
v_min_u32 v50, 159, v50
v_lshl_add_u32 v44, v5, 7, v15
v_lshl_add_u32 v45, v50, 7, v15
v_add_u32 v4, 12, v3
v_cmp_le_u32 vcc, 9, v4
v_subrev_u32 v5, 9, v4
s_nop 0
v_cndmask_b32 v4, v4, v5, vcc
v_cndmask_b32 v6, 0, 1, vcc
v_mul_u32_u24 v6, 72, v6
v_lshrrev_b32 v5, 2, v4
v_mul_u32_u24 v5, 36, v5
v_and_b32 v13, 3, v4
v_lshl_add_u32 v5, v13, 2, v5
v_add_u32 v5, v5, v14
v_lshrrev_b32 v13, 1, v14
v_mul_u32_u24 v13, 18, v13
v_and_b32 v50, 1, v14
v_add3_u32 v13, v13, v50, 16
v_cmp_eq_u32 vcc, 8, v4
v_mov_b32 v50, 18
s_nop 0
v_cndmask_b32 v5, v5, v13, vcc
v_cndmask_b32 v50, v50, 36, vcc
v_add_u32 v5, v5, v6
v_add_u32 v50, v50, v5
v_min_u32 v5, 159, v5
v_min_u32 v50, 159, v50
v_lshl_add_u32 v46, v5, 7, v15
v_lshl_add_u32 v47, v50, 7, v15
v_add_u32 v4, 16, v3
v_cmp_le_u32 vcc, 9, v4
v_subrev_u32 v5, 9, v4
s_nop 0
v_cndmask_b32 v4, v4, v5, vcc
v_cndmask_b32 v6, 0, 1, vcc
v_mul_u32_u24 v6, 72, v6
v_lshrrev_b32 v5, 2, v4
v_mul_u32_u24 v5, 36, v5
v_and_b32 v13, 3, v4
v_lshl_add_u32 v5, v13, 2, v5
v_add_u32 v5, v5, v14
v_lshrrev_b32 v13, 1, v14
v_mul_u32_u24 v13, 18, v13
v_and_b32 v50, 1, v14
v_add3_u32 v13, v13, v50, 16
v_cmp_eq_u32 vcc, 8, v4
v_mov_b32 v50, 18
s_nop 0
v_cndmask_b32 v5, v5, v13, vcc
v_cndmask_b32 v50, v50, 36, vcc
v_add_u32 v5, v5, v6
v_add_u32 v50, v50, v5
v_min_u32 v5, 159, v5
v_min_u32 v50, 159, v50
v_lshl_add_u32 v48, v5, 7, v15
v_lshl_add_u32 v49, v50, 7, v15
s_lshl_b32 s17, s15, 6
s_lshl_b32 s19, s12, 4
s_add_u32 s17, s17, s19
v_add_u32 v4, s17, v2
v_mul_u32_u24 v5, 911, v4
v_lshrrev_b32 v5, 16, v5
v_mul_u32_u24 v6, 72, v5
v_sub_u32 v4, v4, v6
s_mov_b32 s17, 82944
v_mul_lo_u32 v8, v5, s17
s_mul_i32 s17, s14, 18
v_add_u32 v5, s17, v3
v_and_b32 v6, 3, v5
v_lshrrev_b32 v5, 2, v5
v_mul_u32_u24 v5, 4608, v5
v_add_u32 v8, v8, v5
v_add_u32 v8, 2121728, v8
v_lshrrev_b32 v14, 5, v4
v_lshlrev_b32 v14, 11, v14
v_bfe_u32 v15, v4, 2, 1
v_lshl_add_u32 v14, v15, 10, v14
v_bfe_u32 v15, v4, 3, 2
v_lshl_add_u32 v14, v15, 6, v14
v_and_b32 v15, 3, v4
v_lshl_add_u32 v14, v15, 4, v14
v_lshl_add_u32 v14, v6, 8, v14
v_lshlrev_b32 v15, 4, v4
v_add_u32 v15, 3072, v15
v_lshl_add_u32 v15, v6, 7, v15
v_cmp_gt_u32 vcc, 64, v4
s_nop 1
v_cndmask_b32 v14, v15, v14, vcc
v_add_u32 v8, v8, v14
s_waitcnt vmcnt(0)
s_barrier
ds_read_b64_tr_b16 v[16:17], v40
ds_read_b64_tr_b16 v[18:19], v41
ds_read_b64_tr_b16 v[20:21], v42
ds_read_b64_tr_b16 v[22:23], v43
ds_read_b64_tr_b16 v[24:25], v44
ds_read_b64_tr_b16 v[26:27], v45
ds_read_b64_tr_b16 v[28:29], v46
ds_read_b64_tr_b16 v[30:31], v47
ds_read_b64_tr_b16 v[32:33], v48
ds_read_b64_tr_b16 v[34:35], v49
v_cmp_gt_u32 vcc, 2, v3
v_mov_b32 v4, 1073741824
v_mov_b32 v11, 0
v_cndmask_b32 v4, v4, v8, vcc
s_mov_b32 s17, 0
s_waitcnt lgkmcnt(8)
buffer_store_dwordx4 v[16:19], v8, s[4:7], s17 offen sc1
s_mov_b32 s17, 4608
s_waitcnt lgkmcnt(6)
buffer_store_dwordx4 v[20:23], v8, s[4:7], s17 offen sc1
s_mov_b32 s17, 9216
s_waitcnt lgkmcnt(4)
buffer_store_dwordx4 v[24:27], v8, s[4:7], s17 offen sc1
s_mov_b32 s17, 13824
s_waitcnt lgkmcnt(2)
buffer_store_dwordx4 v[28:31], v8, s[4:7], s17 offen sc1
s_mov_b32 s17, 18432
s_waitcnt lgkmcnt(0)
buffer_store_dwordx4 v[32:35], v4, s[4:7], s17 offen sc1
s_branch L_prep_tail
L_prep_w1:
s_load_dwordx2 s[8:9], s[0:1], 8
s_mov_b32 s10, 1990656
s_sub_u32 s13, s2, 128
s_and_b32 s14, s13, 3
s_lshr_b32 s15, s13, 2
s_mul_i32 s16, s14, 497664
s_lshl_b32 s17, s15, 7
s_add_u32 s16, s16, s17
s_mul_i32 s17, s12, 27648
s_add_u32 s16, s16, s17
v_lshrrev_b32 v4, 3, v1
v_mul_u32_u24 v7, 3456, v4
v_and_b32 v4, 7, v1
v_lshl_add_u32 v7, v4, 4, v7
s_lshl_b32 s18, s12, 10
s_waitcnt lgkmcnt(0)
s_add_u32 s19, s18, 0
s_mov_b32 m0, s19
s_add_u32 s17, s16, 0
buffer_load_dwordx4 v7, s[8:11], s17 offen nt lds
s_add_u32 s19, s18, 4096
s_mov_b32 m0, s19
s_add_u32 s17, s16, 110592
buffer_load_dwordx4 v7, s[8:11], s17 offen nt lds
s_add_u32 s19, s18, 8192
s_mov_b32 m0, s19
s_add_u32 s17, s16, 221184
buffer_load_dwordx4 v7, s[8:11], s17 offen nt lds
s_add_u32 s19, s18, 12288
s_mov_b32 m0, s19
s_add_u32 s17, s16, 331776
buffer_load_dwordx4 v7, s[8:11], s17 offen nt lds
s_add_u32 s19, s18, 16384
s_mov_b32 m0, s19
s_add_u32 s17, s16, 442368
s_cmp_lt_u32 s12, 2
s_cselect_b32 s17, s17, 1073741824
buffer_load_dwordx4 v7, s[8:11], s17 offen nt lds
v_lshrrev_b32 v4, 2, v2
v_lshl_add_u32 v4, v3, 3, v4
v_lshlrev_b32 v10, 7, v4
v_and_b32 v4, 3, v2
v_lshl_add_u32 v10, v4, 3, v10
s_lshl_b32 s17, s12, 5
v_add_u32 v10, s17, v10
s_mul_i32 s20, s15, 29
s_lshr_b32 s20, s20, 8
s_mul_i32 s19, s20, 9
s_sub_u32 s19, s15, s19
s_lshl_b32 s19, s19, 6
s_lshl_b32 s17, s12, 4
s_add_u32 s19, s19, s17
v_add_u32 v4, s19, v2
v_mul_u32_u24 v5, 911, v4
v_lshrrev_b32 v5, 14, v5
v_mul_u32_u24 v6, 18, v5
v_sub_u32 v4, v4, v6
v_and_b32 v6, 1, v5
v_lshrrev_b32 v5, 1, v5
s_mov_b32 s17, 132608
v_mul_lo_u32 v5, v5, s17
s_cmp_eq_u32 s20, 0
s_cselect_b32 s21, 5, 0
s_cselect_b32 s22, 8, 4
s_cmp_eq_u32 s20, 2
s_cselect_b32 s21, 2, s21
s_cselect_b32 s22, 0, s22
s_sub_u32 s22, s22, 16
v_add_u32 v14, s21, v6
v_lshl_add_u32 v15, v6, 1, v4
v_add_u32 v15, s22, v15
v_cmp_gt_u32 vcc, 16, v4
s_nop 1
v_cndmask_b32 v14, 4, v14, vcc
v_cndmask_b32 v15, v15, v4, vcc
v_lshl_add_u32 v8, v14, 10, v5
v_lshl_add_u32 v8, v15, 4, v8
v_lshl_add_u32 v9, v14, 9, v5
v_lshl_add_u32 v9, v15, 3, v9
s_lshl_b32 s17, s14, 7
s_add_u32 s17, s17, 129024
v_add_u32 v9, s17, v9
s_mul_i32 s17, s14, 18
v_add_u32 v5, s17, v3
v_and_b32 v6, 3, v5
v_lshrrev_b32 v5, 2, v5
v_mul_u32_u24 v5, 7168, v5
v_add_u32 v8, v8, v5
v_lshl_add_u32 v8, v6, 8, v8
s_waitcnt vmcnt(0)
s_barrier
ds_read_b64_tr_b16 v[16:17], v10 offset:0
ds_read_b64_tr_b16 v[18:19], v10 offset:512
ds_read_b64_tr_b16 v[20:21], v10 offset:4096
ds_read_b64_tr_b16 v[22:23], v10 offset:4608
ds_read_b64_tr_b16 v[24:25], v10 offset:8192
ds_read_b64_tr_b16 v[26:27], v10 offset:8704
ds_read_b64_tr_b16 v[28:29], v10 offset:12288
ds_read_b64_tr_b16 v[30:31], v10 offset:12800
ds_read_b64_tr_b16 v[32:33], v10 offset:16384
ds_read_b64_tr_b16 v[34:35], v10 offset:16896
v_cmp_gt_u32 vcc, 2, v3
v_mov_b32 v4, 1073741824
v_mov_b32 v11, 0
v_cndmask_b32 v4, v4, v8, vcc
s_mov_b32 s17, 0
s_waitcnt lgkmcnt(8)
buffer_store_dwordx4 v[16:19], v8, s[4:7], s17 offen sc1
s_mov_b32 s17, 7168
s_waitcnt lgkmcnt(6)
buffer_store_dwordx4 v[20:23], v8, s[4:7], s17 offen sc1
s_mov_b32 s17, 14336
s_waitcnt lgkmcnt(4)
buffer_store_dwordx4 v[24:27], v8, s[4:7], s17 offen sc1
s_mov_b32 s17, 21504
s_waitcnt lgkmcnt(2)
buffer_store_dwordx4 v[28:31], v8, s[4:7], s17 offen sc1
s_mov_b32 s17, 28672
s_waitcnt lgkmcnt(0)
buffer_store_dwordx4 v[32:35], v4, s[4:7], s17 offen sc1
v_mov_b32 v5, 0x3f803f80
v_dot2c_f32_bf16 v11, v16, v5
v_dot2c_f32_bf16 v11, v17, v5
v_dot2c_f32_bf16 v11, v18, v5
v_dot2c_f32_bf16 v11, v19, v5
v_dot2c_f32_bf16 v11, v20, v5
v_dot2c_f32_bf16 v11, v21, v5
v_dot2c_f32_bf16 v11, v22, v5
v_dot2c_f32_bf16 v11, v23, v5
v_dot2c_f32_bf16 v11, v24, v5
v_dot2c_f32_bf16 v11, v25, v5
v_dot2c_f32_bf16 v11, v26, v5
v_dot2c_f32_bf16 v11, v27, v5
v_dot2c_f32_bf16 v11, v28, v5
v_dot2c_f32_bf16 v11, v29, v5
v_dot2c_f32_bf16 v11, v30, v5
v_dot2c_f32_bf16 v11, v31, v5
v_dot2c_f32_bf16 v11, v32, v5
v_dot2c_f32_bf16 v11, v33, v5
v_dot2c_f32_bf16 v11, v34, v5
v_dot2c_f32_bf16 v11, v35, v5
s_nop 2
v_mov_b32 v5, v11
s_nop 1
v_permlane32_swap_b32 v11, v5
v_add_f32 v11, v11, v5
v_mov_b32 v5, v11
s_nop 1
v_permlane16_swap_b32 v11, v5
v_add_f32 v11, v11, v5
v_cvt_pk_bf16_f32 v14, v11, v11
v_and_b32 v5, 0xffff0000, v14
v_sub_f32 v5, v11, v5
v_cvt_pk_bf16_f32 v15, v5, v5
v_cmp_eq_u32 vcc, 0, v3
v_mov_b32 v4, 1073741824
s_nop 0
v_cndmask_b32 v4, v4, v9, vcc
buffer_store_dwordx2 v[14:15], v4, s[4:7], 0 offen
s_branch L_prep_tail
L_prep_x:
s_load_dwordx2 s[8:9], s[0:1], 0
s_mov_b32 s10, 2359296
s_mul_i32 s16, s12, 18
v_add_u32 v4, s16, v3
v_mul_u32_u24 v7, 1152, v2
v_lshl_add_u32 v7, v4, 4, v7
s_mul_i32 s16, s2, 18432
v_lshlrev_b32 v8, 8, v4
v_lshl_add_u32 v8, v2, 4, v8
s_add_u32 s17, s16, 19283968
v_cmp_gt_u32 vcc, 2, v3
v_mov_b32 v4, 1073741824
v_mov_b32 v11, 0
v_cndmask_b32 v5, v4, v7, vcc
v_cndmask_b32 v6, v4, v8, vcc
v_add_u32 v6, 4096, v6
v_mov_b32 v12, 0
v_mov_b32 v13, 0x3f803f80
s_waitcnt lgkmcnt(0)
buffer_load_dwordx4 v[16:19], v7, s[8:11], s16 offen offset:0
buffer_load_dwordx4 v[20:23], v7, s[8:11], s16 offen offset:64
buffer_load_dwordx4 v[24:27], v7, s[8:11], s16 offen offset:128
buffer_load_dwordx4 v[28:31], v7, s[8:11], s16 offen offset:192
buffer_load_dwordx4 v[32:35], v5, s[8:11], s16 offen offset:256
s_waitcnt vmcnt(4)
buffer_store_dwordx4 v[16:19], v8, s[4:7], s17 offen offset:0 sc1
s_waitcnt vmcnt(4)
buffer_store_dwordx4 v[20:23], v8, s[4:7], s17 offen offset:1024 sc1
s_waitcnt vmcnt(4)
buffer_store_dwordx4 v[24:27], v8, s[4:7], s17 offen offset:2048 sc1
s_waitcnt vmcnt(4)
buffer_store_dwordx4 v[28:31], v8, s[4:7], s17 offen offset:3072 sc1
s_waitcnt vmcnt(4)
buffer_store_dwordx4 v[32:35], v6, s[4:7], s17 offen offset:0 sc1
v_dot2c_f32_bf16 v11, v16, v13
v_dot2c_f32_bf16 v11, v17, v13
v_dot2c_f32_bf16 v11, v18, v13
v_dot2c_f32_bf16 v11, v19, v13
v_dot2c_f32_bf16 v11, v20, v13
v_dot2c_f32_bf16 v11, v21, v13
v_dot2c_f32_bf16 v11, v22, v13
v_dot2c_f32_bf16 v11, v23, v13
v_dot2c_f32_bf16 v11, v24, v13
v_dot2c_f32_bf16 v11, v25, v13
v_dot2c_f32_bf16 v11, v26, v13
v_dot2c_f32_bf16 v11, v27, v13
v_dot2c_f32_bf16 v11, v28, v13
v_dot2c_f32_bf16 v11, v29, v13
v_dot2c_f32_bf16 v11, v30, v13
v_dot2c_f32_bf16 v11, v31, v13
v_dot2c_f32_bf16 v11, v32, v13
v_dot2c_f32_bf16 v11, v33, v13
v_dot2c_f32_bf16 v11, v34, v13
v_dot2c_f32_bf16 v11, v35, v13
v_dot2c_f32_bf16 v12, v16, v16
v_dot2c_f32_bf16 v12, v17, v17
v_dot2c_f32_bf16 v12, v18, v18
v_dot2c_f32_bf16 v12, v19, v19
v_dot2c_f32_bf16 v12, v20, v20
v_dot2c_f32_bf16 v12, v21, v21
v_dot2c_f32_bf16 v12, v22, v22
v_dot2c_f32_bf16 v12, v23, v23
v_dot2c_f32_bf16 v12, v24, v24
v_dot2c_f32_bf16 v12, v25, v25
v_dot2c_f32_bf16 v12, v26, v26
v_dot2c_f32_bf16 v12, v27, v27
v_dot2c_f32_bf16 v12, v28, v28
v_dot2c_f32_bf16 v12, v29, v29
v_dot2c_f32_bf16 v12, v30, v30
v_dot2c_f32_bf16 v12, v31, v31
v_dot2c_f32_bf16 v12, v32, v32
v_dot2c_f32_bf16 v12, v33, v33
v_dot2c_f32_bf16 v12, v34, v34
v_dot2c_f32_bf16 v12, v35, v35
v_mov_b32 v5, v11
s_nop 1
v_permlane32_swap_b32 v11, v5
v_add_f32 v11, v11, v5
v_mov_b32 v5, v11
s_nop 1
v_permlane16_swap_b32 v11, v5
v_add_f32 v11, v11, v5
v_mov_b32 v5, v12
s_nop 1
v_permlane32_swap_b32 v12, v5
v_add_f32 v12, v12, v5
v_mov_b32 v5, v12
s_nop 1
v_permlane16_swap_b32 v12, v5
v_add_f32 v12, v12, v5
v_cmp_eq_u32 vcc, 0, v3
s_lshl_b32 s16, s2, 7
s_lshl_b32 s17, s12, 14
s_add_u32 s16, s16, s17
s_add_u32 s16, s16, 21643264
v_cndmask_b32 v14, 0, v11, vcc
v_cndmask_b32 v15, 0, v12, vcc
v_lshlrev_b32 v5, 3, v2
v_lshl_add_u32 v5, v3, 16, v5
v_cmp_gt_u32 vcc, 2, v3
s_nop 1
v_cndmask_b32 v5, v4, v5, vcc
buffer_store_dwordx2 v[14:15], v5, s[4:7], s16 offen
L_prep_tail:
s_sub_u32 s16, s2, 272
s_cmp_lt_u32 s16, 208
s_cbranch_scc0 L_prep_t2
s_cmp_ge_u32 s16, 104
s_cselect_b32 s17, 26640384, 0
s_cselect_b32 s18, 104, 0
s_sub_u32 s16, s16, s18
s_cmp_lt_u32 s16, 64
s_cselect_b32 s18, 3212836864, 0
s_lshl_b32 s16, s16, 12
s_add_u32 s16, s16, s17
s_add_u32 s16, s16, 45498368
v_mov_b32 v52, s18
v_mov_b32 v53, s18
v_mov_b32 v54, s18
v_mov_b32 v55, s18
v_lshlrev_b32 v51, 4, v0
buffer_store_dwordx4 v[52:55], v51, s[4:7], s16 offen sc1
L_prep_t2:
s_cmp_lt_u32 s2, 256
s_cbranch_scc0 L_prep_fin
s_getpc_b64 s[20:21]
L_prep_pc:
s_add_u32 s20, s20, main_kernel-L_prep_pc
s_addc_u32 s21, s21, 0
s_mov_b32 s22, 54708
s_mov_b32 s23, 0x20000
s_lshr_b32 s16, s2, 3
s_mul_i32 s16, s16, 1792
v_lshlrev_b32 v51, 4, v0
v_cmp_gt_u32 vcc, 1792, v51
v_mov_b32 v56, 1073741824
s_nop 0
v_cndmask_b32 v51, v56, v51, vcc
buffer_load_dwordx4 v[56:59], v51, s[20:23], s16 offen
L_prep_fin:
L_prep_end:
s_endpgm
.globl main_kernel
.p2align 8
.type main_kernel,@function
main_kernel:
s_cmp_ge_u32 s2, 256
s_cbranch_scc1 L_main_exit
s_load_dwordx2 s[4:5], s[0:1], 80
s_load_dwordx2 s[12:13], s[0:1], 40
s_load_dwordx2 s[16:17], s[0:1], 64
s_load_dwordx2 s[20:21], s[0:1], 48
v_lshrrev_b32 v6, 6, v0
v_and_b32 v0, 63, v0
v_readfirstlane_b32 s24, v6
v_lshlrev_b32 v1, 4, v0
v_and_b32 v2, 15, v0
v_lshrrev_b32 v3, 4, v0
v_mov_b32 v4, 1
v_mov_b32 v5, 0
s_mov_b32 s56, 0
s_mov_b32 s29, 0
v_add_u32 v9, 65536, v1
s_mov_b32 s6, 19283968
s_mov_b32 s7, 0x20000
s_mov_b32 s10, 53280768
s_mov_b32 s11, 0x20000
s_mov_b32 s14, 8388608
s_mov_b32 s15, 0x20000
s_mov_b32 s18, 2359296
s_mov_b32 s19, 0x20000
s_mov_b32 s22, 4096
s_mov_b32 s23, 0x20000
s_and_b32 s30, s2, 7
s_lshr_b32 s31, s2, 3
s_lshr_b32 s32, s31, 2
s_and_b32 s33, s31, 3
s_lshr_b32 s25, s30, 2
s_lshl_b32 s25, s25, 3
s_add_u32 s25, s25, s32
s_and_b32 s26, s30, 3
s_lshl_b32 s26, s26, 2
s_add_u32 s26, s26, s33
s_branch L_main_go
L_main_exit:
s_endpgm
L_main_go:
s_lshr_b32 s27, s30, 1
s_lshl_b32 s27, s27, 3
s_add_u32 s27, s27, s32
s_and_b32 s28, s30, 1
s_lshl_b32 s28, s28, 2
s_add_u32 s28, s28, s33
s_getpc_b64 s[88:89]
L_pc:
s_mov_b32 s90, L_code_end-L_pc
s_mov_b32 s91, 0x20000
s_lshl_b32 s31, s31, 10
s_lshl_b32 s32, s24, 8
s_add_u32 s31, s31, s32
v_lshrrev_b32 v14, 2, v1
v_add_u32 v14, s31, v14
s_waitcnt lgkmcnt(0)
s_add_u32 s8, s4, 19283968
s_addc_u32 s9, s5, 0
s_lshl_b32 s30, s27, 2
s_add_u32 s30, s30, s24
s_mul_i32 s30, s30, 18432
s_mul_i32 s31, s28, 2304
s_add_u32 s30, s30, s31
s_add_u32 s30, s30, 0
v_and_b32 v6, 1, v3
v_lshlrev_b32 v6, 3, v6
v_lshl_add_u32 v6, v2, 4, v6
buffer_load_dwordx4 v[36:39], v1, s[8:11], s30 offen
buffer_load_dwordx4 v[40:43], v1, s[8:11], s30 offen offset:1024
buffer_load_dwordx2 v[44:45], v6, s[8:11], s30 offen offset:2048
s_mul_i32 s36, s26, 132608
s_mul_i32 s38, s24, 12288
s_add_u32 m0, s38, 0
s_add_u32 s39, s38, s36
buffer_load_dwordx4 v1, s[4:7], s39 offen offset:0  lds
buffer_load_dwordx4 v1, s[4:7], s39 offen offset:1024  lds
buffer_load_dwordx4 v1, s[4:7], s39 offen offset:2048  lds
buffer_load_dwordx4 v1, s[4:7], s39 offen offset:3072  lds
s_add_u32 m0, m0, 4096
s_add_u32 s39, s39, 4096
buffer_load_dwordx4 v1, s[4:7], s39 offen offset:0  lds
buffer_load_dwordx4 v1, s[4:7], s39 offen offset:1024  lds
buffer_load_dwordx4 v1, s[4:7], s39 offen offset:2048  lds
buffer_load_dwordx4 v1, s[4:7], s39 offen offset:3072  lds
s_add_u32 m0, m0, 4096
s_add_u32 s39, s39, 4096
buffer_load_dwordx4 v1, s[4:7], s39 offen offset:0  lds
buffer_load_dwordx4 v1, s[4:7], s39 offen offset:1024  lds
buffer_load_dwordx4 v1, s[4:7], s39 offen offset:2048  lds
buffer_load_dwordx4 v1, s[4:7], s39 offen offset:3072  lds
v_and_b32 v6, 1, v2
v_cmp_eq_u32 s[40:41], 1, v6
v_lshl_add_u32 v6, v3, 2, v6
v_cmp_le_u32 s[42:43], v6, v2
v_add_u32 v6, 2, v6
v_cmp_le_u32 s[44:45], v6, v2
v_cmp_eq_u32 s[46:47], 0, v3
v_cmp_eq_u32 s[48:49], 2, v3
v_cmp_gt_u32 s[50:51], 2, v3
v_mov_b32 v6, 0x0c0c0100
v_mov_b32 v7, 0x01000c0c
v_cndmask_b32 v6, v6, v7, s[40:41]
v_mov_b32 v8, 0x0c0c0c0c
v_cndmask_b32 v10, v6, v8, s[42:43]
v_cndmask_b32 v12, v8, v6, s[42:43]
v_mov_b32 v6, 0x0c0c0302
v_mov_b32 v7, 0x03020c0c
v_cndmask_b32 v6, v6, v7, s[40:41]
v_cndmask_b32 v11, v6, v8, s[44:45]
v_cndmask_b32 v13, v8, v6, s[44:45]
s_lshl_b32 s80, s25, 4
s_add_u32 s80, s80, s26
s_lshl_b32 s81, s27, 3
s_add_u32 s81, s81, s28
s_mul_i32 s82, s26, 340992
s_add_u32 s82, s82, 2785280
s_mul_i32 s83, s28, 331776
s_add_u32 s83, s83, 8241152
s_waitcnt vmcnt(12)
v_lshlrev_b32 v16, 16, v36
v_and_b32 v17, 0xffff0000, v36
v_lshlrev_b32 v18, 16, v37
v_and_b32 v19, 0xffff0000, v37
v_lshlrev_b32 v20, 16, v38
v_and_b32 v21, 0xffff0000, v38
v_lshlrev_b32 v22, 16, v39
v_and_b32 v23, 0xffff0000, v39
v_lshlrev_b32 v24, 16, v40
v_and_b32 v25, 0xffff0000, v40
v_lshlrev_b32 v26, 16, v41
v_and_b32 v27, 0xffff0000, v41
v_lshlrev_b32 v28, 16, v42
v_and_b32 v29, 0xffff0000, v42
v_lshlrev_b32 v30, 16, v43
v_and_b32 v31, 0xffff0000, v43
v_lshlrev_b32 v32, 16, v44
v_and_b32 v33, 0xffff0000, v44
v_lshlrev_b32 v34, 16, v45
v_and_b32 v35, 0xffff0000, v45
s_mul_i32 s36, s26, 132608
s_mul_i32 s38, s24, 21504
s_add_u32 m0, s38, 49152
s_add_u32 s39, s38, s36
s_add_u32 s39, s39, 49152
buffer_load_dwordx4 v1, s[4:7], s39 offen offset:0  lds
buffer_load_dwordx4 v1, s[4:7], s39 offen offset:1024  lds
buffer_load_dwordx4 v1, s[4:7], s39 offen offset:2048  lds
buffer_load_dwordx4 v1, s[4:7], s39 offen offset:3072  lds
s_add_u32 m0, m0, 4096
s_add_u32 s39, s39, 4096
buffer_load_dwordx4 v1, s[4:7], s39 offen offset:0  lds
buffer_load_dwordx4 v1, s[4:7], s39 offen offset:1024  lds
buffer_load_dwordx4 v1, s[4:7], s39 offen offset:2048  lds
buffer_load_dwordx4 v1, s[4:7], s39 offen offset:3072  lds
s_add_u32 m0, m0, 4096
s_add_u32 s39, s39, 4096
buffer_load_dwordx4 v1, s[4:7], s39 offen offset:0  lds
buffer_load_dwordx4 v1, s[4:7], s39 offen offset:1024  lds
buffer_load_dwordx4 v1, s[4:7], s39 offen offset:2048  lds
buffer_load_dwordx4 v1, s[4:7], s39 offen offset:3072  lds
s_add_u32 m0, m0, 4096
s_add_u32 s39, s39, 4096
buffer_load_dwordx4 v1, s[4:7], s39 offen offset:0  lds
buffer_load_dwordx4 v1, s[4:7], s39 offen offset:1024  lds
buffer_load_dwordx4 v1, s[4:7], s39 offen offset:2048  lds
buffer_load_dwordx4 v1, s[4:7], s39 offen offset:3072  lds
s_add_u32 m0, m0, 4096
s_add_u32 s39, s39, 4096
buffer_load_dwordx4 v1, s[4:7], s39 offen offset:0  lds
buffer_load_dwordx4 v1, s[4:7], s39 offen offset:1024  lds
buffer_load_dwordx4 v1, s[4:7], s39 offen offset:2048  lds
buffer_load_dwordx4 v1, s[4:7], s39 offen offset:3072  lds
s_add_u32 m0, m0, 4096
s_add_u32 s39, s39, 4096
buffer_load_dwordx4 v1, s[4:7], s39 offen offset:0  lds
L_layer:
s_lshl_b32 s60, s25, 3
s_sub_u32 s61, s60, 1
s_max_i32 s61, s61, 0
s_lshl_b32 s30, s24, 1
s_add_u32 s60, s60, s30
s_mul_i32 s30, s61, 18432
s_mul_i32 s38, s24, 5120
s_add_u32 m0, s38, 135168
s_add_u32 s39, s38, s30
buffer_load_dwordx4 v1, s[8:11], s39 offen offset:0 sc1 lds
buffer_load_dwordx4 v1, s[8:11], s39 offen offset:1024 sc1 lds
buffer_load_dwordx4 v1, s[8:11], s39 offen offset:2048 sc1 lds
buffer_load_dwordx4 v1, s[8:11], s39 offen offset:3072 sc1 lds
s_add_u32 m0, m0, 4096
s_add_u32 s39, s39, 4096
buffer_load_dwordx4 v1, s[8:11], s39 offen offset:0 sc1 lds
s_mul_i32 s62, s60, 18432
s_add_u32 s62, s62, 0
v_add_u32 v127, 18432, v1
buffer_load_dwordx4 a[0:3], v1, s[8:11], s62 offen offset:0 sc1
buffer_load_dwordx4 a[4:7], v127, s[8:11], s62 offen offset:0 sc1
buffer_load_dwordx4 a[8:11], v1, s[8:11], s62 offen offset:1024 sc1
buffer_load_dwordx4 a[12:15], v127, s[8:11], s62 offen offset:1024 sc1
buffer_load_dwordx4 a[16:19], v1, s[8:11], s62 offen offset:2048 sc1
buffer_load_dwordx4 a[20:23], v127, s[8:11], s62 offen offset:2048 sc1
s_sub_u32 s30, s60, 2
v_add_u32 v6, s30, v3
v_max_i32 v6, 0, v6
v_mov_b32 v7, s61
v_cndmask_b32 v6, v6, v7, s[46:47]
v_lshl_add_u32 v6, v6, 4, v2
v_lshlrev_b32 v130, 3, v6
s_lshl_b32 s30, s24, 10
v_add_u32 v125, s30, v1
v_add_u32 v126, 135168, v1
v_lshrrev_b32 v128, 1, v1
v_add_u32 v128, 129024, v128
s_lshl_b32 s30, s24, 9
v_add_u32 v129, s30, v128
v_add_u32 v8, 64512, v1
s_waitcnt vmcnt(6)
s_barrier
ds_read_b128 a[144:147], v1 offset:0
ds_read_b128 a[148:151], v1 offset:1024
ds_read_b128 a[152:155], v1 offset:2048
ds_read_b128 a[156:159], v1 offset:3072
ds_read_b128 a[160:163], v1 offset:4096
ds_read_b128 a[164:167], v1 offset:5120
ds_read_b128 a[168:171], v1 offset:6144
ds_read_b128 a[172:175], v125 offset:0
ds_read_b128 a[176:179], v126 offset:0
s_waitcnt lgkmcnt(0)
s_waitcnt vmcnt(4)
v_mfma_f32_16x16x32_bf16 v[36:39], a[144:147], a[0:3], 0
ds_read_b128 a[180:183], v1 offset:7168
buffer_load_dwordx4 a[24:27], v1, s[8:11], s62 offen offset:3072 sc1
v_mfma_f32_16x16x32_bf16 v[64:67], a[144:147], a[4:7], 0
ds_read_b128 a[184:187], v1 offset:8192
v_mfma_f32_16x16x32_bf16 v[40:43], a[148:151], a[0:3], 0
ds_read_b128 a[188:191], v1 offset:9216
v_mfma_f32_16x16x32_bf16 v[68:71], a[148:151], a[4:7], 0
ds_read_b128 a[192:195], v1 offset:10240
buffer_load_dwordx4 a[28:31], v127, s[8:11], s62 offen offset:3072 sc1
s_add_u32 s62, s62, 4096
v_mfma_f32_16x16x32_bf16 v[44:47], a[152:155], a[0:3], 0
ds_read_b128 a[196:199], v1 offset:11264
v_mfma_f32_16x16x32_bf16 v[72:75], a[152:155], a[4:7], 0
ds_read_b128 a[200:203], v1 offset:12288
v_mfma_f32_16x16x32_bf16 v[48:51], a[156:159], a[0:3], 0
ds_read_b128 a[204:207], v1 offset:13312
v_mfma_f32_16x16x32_bf16 v[76:79], a[156:159], a[4:7], 0
ds_read_b128 a[208:211], v125 offset:7168
v_mfma_f32_16x16x32_bf16 v[52:55], a[160:163], a[0:3], 0
ds_read_b128 a[212:215], v126 offset:1024
v_mfma_f32_16x16x32_bf16 v[80:83], a[160:163], a[4:7], 0
v_mfma_f32_16x16x32_bf16 v[56:59], a[164:167], a[0:3], 0
buffer_load_dwordx4 a[32:35], v1, s[8:11], s62 offen offset:0 sc1
v_mfma_f32_16x16x32_bf16 v[84:87], a[164:167], a[4:7], 0
v_mfma_f32_16x16x32_bf16 v[60:63], a[168:171], a[0:3], 0
v_mfma_f32_16x16x32_bf16 v[88:91], a[168:171], a[4:7], 0
buffer_load_dwordx4 a[36:39], v127, s[8:11], s62 offen offset:0 sc1
v_mfma_f32_16x16x32_bf16 v[92:95], a[172:175], a[176:179], 0
v_mfma_f32_16x16x32_bf16 v[96:99], a[160:163], a[176:179], 0
s_waitcnt lgkmcnt(0)
s_waitcnt vmcnt(6)
v_mfma_f32_16x16x32_bf16 v[36:39], a[180:183], a[8:11], v[36:39]
ds_read_b128 a[144:147], v1 offset:14336
v_lshlrev_b32 v124, 2, v2
v_mfma_f32_16x16x32_bf16 v[64:67], a[180:183], a[12:15], v[64:67]
ds_read_b128 a[148:151], v1 offset:15360
buffer_load_dwordx4 a[40:43], v1, s[8:11], s62 offen offset:1024 sc1
v_mfma_f32_16x16x32_bf16 v[40:43], a[184:187], a[8:11], v[40:43]
ds_read_b128 a[152:155], v1 offset:16384
v_and_b32 v6, 1, v2
v_mfma_f32_16x16x32_bf16 v[68:71], a[184:187], a[12:15], v[68:71]
ds_read_b128 a[156:159], v1 offset:17408
v_mfma_f32_16x16x32_bf16 v[44:47], a[188:191], a[8:11], v[44:47]
ds_read_b128 a[160:163], v1 offset:18432
buffer_load_dwordx4 a[44:47], v127, s[8:11], s62 offen offset:1024 sc1
v_mfma_f32_16x16x32_bf16 v[72:75], a[188:191], a[12:15], v[72:75]
ds_read_b128 a[164:167], v1 offset:19456
v_lshl_add_u32 v6, v3, 2, v6
v_mfma_f32_16x16x32_bf16 v[48:51], a[192:195], a[8:11], v[48:51]
ds_read_b128 a[168:171], v1 offset:20480
v_mfma_f32_16x16x32_bf16 v[76:79], a[192:195], a[12:15], v[76:79]
ds_read_b128 a[172:175], v125 offset:14336
buffer_load_dwordx4 a[48:51], v1, s[8:11], s62 offen offset:2048 sc1
s_mov_b32 s63, 2359296
v_mfma_f32_16x16x32_bf16 v[52:55], a[196:199], a[8:11], v[52:55]
ds_read_b128 a[176:179], v126 offset:2048
v_lshlrev_b32 v6, 2, v6
v_mfma_f32_16x16x32_bf16 v[80:83], a[196:199], a[12:15], v[80:83]
v_mfma_f32_16x16x32_bf16 v[56:59], a[200:203], a[8:11], v[56:59]
v_add_u32 v122, 64, v6
v_mfma_f32_16x16x32_bf16 v[84:87], a[200:203], a[12:15], v[84:87]
v_mfma_f32_16x16x32_bf16 v[60:63], a[204:207], a[8:11], v[60:63]
v_mfma_f32_16x16x32_bf16 v[88:91], a[204:207], a[12:15], v[88:91]
v_add_u32 v7, 128, v6
v_mfma_f32_16x16x32_bf16 v[92:95], a[208:211], a[212:215], v[92:95]
buffer_load_dwordx2 v[100:101], v130, s[8:11], s63 offen sc1
s_mov_b32 s63, 2375680
v_mfma_f32_16x16x32_bf16 v[96:99], a[196:199], a[212:215], v[96:99]
s_waitcnt lgkmcnt(0)
s_waitcnt vmcnt(8)
v_mfma_f32_16x16x32_bf16 v[36:39], a[144:147], a[16:19], v[36:39]
ds_read_b128 a[180:183], v1 offset:21504
v_cndmask_b32 v122, v122, v7, s[42:43]
v_mfma_f32_16x16x32_bf16 v[64:67], a[144:147], a[20:23], v[64:67]
ds_read_b128 a[184:187], v1 offset:22528
v_mfma_f32_16x16x32_bf16 v[40:43], a[148:151], a[16:19], v[40:43]
ds_read_b128 a[188:191], v1 offset:23552
v_add_u32 v123, 72, v6
v_mfma_f32_16x16x32_bf16 v[68:71], a[148:151], a[20:23], v[68:71]
ds_read_b128 a[192:195], v1 offset:24576
v_mfma_f32_16x16x32_bf16 v[44:47], a[152:155], a[16:19], v[44:47]
ds_read_b128 a[196:199], v1 offset:25600
v_mfma_f32_16x16x32_bf16 v[72:75], a[152:155], a[20:23], v[72:75]
ds_read_b128 a[200:203], v1 offset:26624
buffer_load_dwordx2 v[102:103], v130, s[8:11], s63 offen sc1
s_mov_b32 s63, 2392064
v_mfma_f32_16x16x32_bf16 v[48:51], a[156:159], a[16:19], v[48:51]
ds_read_b128 a[204:207], v1 offset:27648
v_add_u32 v7, 136, v6
v_mfma_f32_16x16x32_bf16 v[76:79], a[156:159], a[20:23], v[76:79]
ds_read_b128 a[208:211], v125 offset:21504
v_cndmask_b32 v123, v123, v7, s[44:45]
v_mfma_f32_16x16x32_bf16 v[52:55], a[160:163], a[16:19], v[52:55]
ds_read_b128 a[212:215], v126 offset:3072
s_lshl_b32 s31, s24, 5
v_mfma_f32_16x16x32_bf16 v[80:83], a[160:163], a[20:23], v[80:83]
v_mfma_f32_16x16x32_bf16 v[56:59], a[164:167], a[16:19], v[56:59]
v_mfma_f32_16x16x32_bf16 v[84:87], a[164:167], a[20:23], v[84:87]
v_mfma_f32_16x16x32_bf16 v[60:63], a[168:171], a[16:19], v[60:63]
buffer_load_dwordx2 v[104:105], v130, s[8:11], s63 offen sc1
s_mov_b32 s63, 2408448
v_add_u32 v6, s31, v2
v_mfma_f32_16x16x32_bf16 v[88:91], a[168:171], a[20:23], v[88:91]
v_mfma_f32_16x16x32_bf16 v[92:95], a[172:175], a[176:179], v[92:95]
v_mfma_f32_16x16x32_bf16 v[96:99], a[160:163], a[176:179], v[96:99]
s_waitcnt lgkmcnt(0)
s_waitcnt vmcnt(8)
v_mfma_f32_16x16x32_bf16 v[36:39], a[180:183], a[24:27], v[36:39]
ds_read_b128 a[144:147], v1 offset:28672
v_mul_u32_u24 v212, 176, v6
v_mfma_f32_16x16x32_bf16 v[64:67], a[180:183], a[28:31], v[64:67]
ds_read_b128 a[148:151], v1 offset:29696
v_mfma_f32_16x16x32_bf16 v[40:43], a[184:187], a[24:27], v[40:43]
ds_read_b128 a[152:155], v1 offset:30720
v_add_u32 v212, 135168, v212
v_mfma_f32_16x16x32_bf16 v[68:71], a[184:187], a[28:31], v[68:71]
ds_read_b128 a[156:159], v1 offset:31744
buffer_load_dwordx2 v[106:107], v130, s[8:11], s63 offen sc1
s_mov_b32 s63, 2424832
v_mfma_f32_16x16x32_bf16 v[44:47], a[188:191], a[24:27], v[44:47]
ds_read_b128 a[160:163], v1 offset:32768
v_lshl_add_u32 v210, v3, 3, v212
v_mfma_f32_16x16x32_bf16 v[72:75], a[188:191], a[28:31], v[72:75]
ds_read_b128 a[164:167], v1 offset:33792
v_mfma_f32_16x16x32_bf16 v[48:51], a[192:195], a[24:27], v[48:51]
ds_read_b128 a[168:171], v1 offset:34816
v_mfma_f32_16x16x32_bf16 v[76:79], a[192:195], a[28:31], v[76:79]
ds_read_b128 a[172:175], v125 offset:28672
v_mul_u32_u24 v211, 176, v2
v_mfma_f32_16x16x32_bf16 v[52:55], a[196:199], a[24:27], v[52:55]
ds_read_b128 a[176:179], v126 offset:4096
v_mfma_f32_16x16x32_bf16 v[80:83], a[196:199], a[28:31], v[80:83]
buffer_load_dwordx2 v[108:109], v130, s[8:11], s63 offen sc1
s_mov_b32 s63, 2441216
v_mfma_f32_16x16x32_bf16 v[56:59], a[200:203], a[24:27], v[56:59]
v_lshl_add_u32 v211, v3, 3, v211
v_mfma_f32_16x16x32_bf16 v[84:87], a[200:203], a[28:31], v[84:87]
v_mfma_f32_16x16x32_bf16 v[60:63], a[204:207], a[24:27], v[60:63]
v_add_u32 v211, 135168, v211
v_mfma_f32_16x16x32_bf16 v[88:91], a[204:207], a[28:31], v[88:91]
v_mfma_f32_16x16x32_bf16 v[92:95], a[208:211], a[212:215], v[92:95]
v_mfma_f32_16x16x32_bf16 v[96:99], a[196:199], a[212:215], v[96:99]
s_waitcnt lgkmcnt(0)
s_waitcnt vmcnt(8)
v_mfma_f32_16x16x32_bf16 v[36:39], a[144:147], a[32:35], v[36:39]
ds_read_b128 a[180:183], v1 offset:35840
buffer_load_dwordx2 v[110:111], v130, s[8:11], s63 offen sc1
s_mov_b32 s63, 2457600
v_mfma_f32_16x16x32_bf16 v[64:67], a[144:147], a[36:39], v[64:67]
ds_read_b128 a[184:187], v1 offset:36864
v_add_u32 v214, s31, v211
v_mfma_f32_16x16x32_bf16 v[40:43], a[148:151], a[32:35], v[40:43]
ds_read_b128 a[188:191], v1 offset:37888
v_lshrrev_b32 v6, 2, v2
v_mfma_f32_16x16x32_bf16 v[68:71], a[148:151], a[36:39], v[68:71]
ds_read_b128 a[192:195], v1 offset:38912
v_mfma_f32_16x16x32_bf16 v[44:47], a[152:155], a[32:35], v[44:47]
ds_read_b128 a[196:199], v1 offset:39936
v_lshl_add_u32 v6, v3, 2, v6
v_mfma_f32_16x16x32_bf16 v[72:75], a[152:155], a[36:39], v[72:75]
ds_read_b128 a[200:203], v1 offset:40960
v_mfma_f32_16x16x32_bf16 v[48:51], a[156:159], a[32:35], v[48:51]
ds_read_b128 a[204:207], v1 offset:41984
v_mfma_f32_16x16x32_bf16 v[76:79], a[156:159], a[36:39], v[76:79]
ds_read_b128 a[208:211], v125 offset:35840
buffer_load_dwordx2 v[112:113], v130, s[8:11], s63 offen sc1
s_mov_b32 s63, 2473984
v_mfma_f32_16x16x32_bf16 v[52:55], a[160:163], a[32:35], v[52:55]
ds_read_b128 a[212:215], v126 offset:5120
v_add_u32 v6, s31, v6
v_mfma_f32_16x16x32_bf16 v[80:83], a[160:163], a[36:39], v[80:83]
v_mul_u32_u24 v213, 176, v6
v_mfma_f32_16x16x32_bf16 v[56:59], a[164:167], a[32:35], v[56:59]
v_mfma_f32_16x16x32_bf16 v[84:87], a[164:167], a[36:39], v[84:87]
v_mfma_f32_16x16x32_bf16 v[60:63], a[168:171], a[32:35], v[60:63]
v_and_b32 v6, 3, v2
v_mfma_f32_16x16x32_bf16 v[88:91], a[168:171], a[36:39], v[88:91]
v_mfma_f32_16x16x32_bf16 v[92:95], a[172:175], a[176:179], v[92:95]
buffer_load_dwordx2 v[114:115], v130, s[8:11], s63 offen sc1
v_mfma_f32_16x16x32_bf16 v[96:99], a[160:163], a[176:179], v[96:99]
s_waitcnt lgkmcnt(0)
s_waitcnt vmcnt(9)
v_mfma_f32_16x16x32_bf16 v[36:39], a[180:183], a[40:43], v[36:39]
ds_read_b128 a[144:147], v1 offset:43008
v_lshl_add_u32 v213, v6, 3, v213
v_mfma_f32_16x16x32_bf16 v[64:67], a[180:183], a[44:47], v[64:67]
ds_read_b128 a[148:151], v1 offset:44032
buffer_load_dwordx4 a[52:55], v127, s[8:11], s62 offen offset:2048 sc1
v_mfma_f32_16x16x32_bf16 v[40:43], a[184:187], a[40:43], v[40:43]
ds_read_b128 a[152:155], v1 offset:45056
v_add_u32 v213, 135168, v213
v_mfma_f32_16x16x32_bf16 v[68:71], a[184:187], a[44:47], v[68:71]
ds_read_b128 a[156:159], v1 offset:46080
v_mfma_f32_16x16x32_bf16 v[44:47], a[188:191], a[40:43], v[44:47]
ds_read_b128 a[160:163], v1 offset:47104
v_mov_b32 v169, 0
v_mfma_f32_16x16x32_bf16 v[72:75], a[188:191], a[44:47], v[72:75]
ds_read_b128 a[164:167], v1 offset:48128
buffer_load_dwordx4 a[56:59], v1, s[8:11], s62 offen offset:3072 sc1
v_mfma_f32_16x16x32_bf16 v[48:51], a[192:195], a[40:43], v[48:51]
ds_read_b128 a[168:171], v1 offset:49152
v_mov_b32 v170, 0
v_mfma_f32_16x16x32_bf16 v[76:79], a[192:195], a[44:47], v[76:79]
ds_read_b128 a[172:175], v125 offset:43008
v_mfma_f32_16x16x32_bf16 v[52:55], a[196:199], a[40:43], v[52:55]
ds_read_b128 a[176:179], v126 offset:6144
buffer_load_dwordx4 a[60:63], v127, s[8:11], s62 offen offset:3072 sc1
s_add_u32 s62, s62, 4096
v_mfma_f32_16x16x32_bf16 v[80:83], a[196:199], a[44:47], v[80:83]
v_mov_b32 v177, 0
v_mfma_f32_16x16x32_bf16 v[56:59], a[200:203], a[40:43], v[56:59]
v_mfma_f32_16x16x32_bf16 v[84:87], a[200:203], a[44:47], v[84:87]
v_mfma_f32_16x16x32_bf16 v[60:63], a[204:207], a[40:43], v[60:63]
v_mov_b32 v178, 0
v_mfma_f32_16x16x32_bf16 v[88:91], a[204:207], a[44:47], v[88:91]
s_lshr_b32 s30, s26, 1
v_mfma_f32_16x16x32_bf16 v[92:95], a[208:211], a[212:215], v[92:95]
s_mul_i32 s30, s30, 2304
v_mfma_f32_16x16x32_bf16 v[96:99], a[196:199], a[212:215], v[96:99]
buffer_load_dwordx4 a[64:67], v1, s[8:11], s62 offen offset:0 sc1
s_waitcnt lgkmcnt(0)
s_waitcnt vmcnt(3)
v_mfma_f32_16x16x32_bf16 v[36:39], a[144:147], a[48:51], v[36:39]
ds_read_b128 a[180:183], v1 offset:50176
s_mul_i32 s64, s60, 18432
v_mfma_f32_16x16x32_bf16 v[64:67], a[144:147], a[52:55], v[64:67]
ds_read_b128 a[184:187], v1 offset:51200
s_add_u32 s30, s30, s64
v_mfma_f32_16x16x32_bf16 v[40:43], a[148:151], a[48:51], v[40:43]
ds_read_b128 a[188:191], v1 offset:52224
buffer_load_dwordx4 a[68:71], v127, s[8:11], s62 offen offset:0 sc1
s_add_u32 s30, s30, 2490368
v_mfma_f32_16x16x32_bf16 v[68:71], a[148:151], a[52:55], v[68:71]
ds_read_b128 a[192:195], v1 offset:53248
s_and_b32 s65, s26, 1
v_mfma_f32_16x16x32_bf16 v[44:47], a[152:155], a[48:51], v[44:47]
ds_read_b128 a[196:199], v1 offset:54272
s_lshl_b32 s64, s65, 10
v_mfma_f32_16x16x32_bf16 v[72:75], a[152:155], a[52:55], v[72:75]
ds_read_b128 a[200:203], v1 offset:55296
s_add_u32 s64, s64, s30
v_mfma_f32_16x16x32_bf16 v[48:51], a[156:159], a[48:51], v[48:51]
ds_read_b128 a[204:207], v1 offset:56320
buffer_load_dwordx4 a[72:75], v1, s[8:11], s62 offen offset:1024 sc1
s_lshl_b32 s65, s65, 3
v_mfma_f32_16x16x32_bf16 v[76:79], a[156:159], a[52:55], v[76:79]
ds_read_b128 a[208:211], v125 offset:50176
s_add_u32 s65, s65, s30
v_mfma_f32_16x16x32_bf16 v[52:55], a[160:163], a[48:51], v[52:55]
ds_read_b128 a[212:215], v126 offset:7168
v_mfma_f32_16x16x32_bf16 v[80:83], a[160:163], a[52:55], v[80:83]
buffer_load_dwordx4 a[76:79], v127, s[8:11], s62 offen offset:1024 sc1
v_mfma_f32_16x16x32_bf16 v[56:59], a[164:167], a[48:51], v[56:59]
v_mfma_f32_16x16x32_bf16 v[84:87], a[164:167], a[52:55], v[84:87]
v_mfma_f32_16x16x32_bf16 v[60:63], a[168:171], a[48:51], v[60:63]
buffer_load_dwordx4 a[80:83], v1, s[8:11], s62 offen offset:2048 sc1
v_mfma_f32_16x16x32_bf16 v[88:91], a[168:171], a[52:55], v[88:91]
v_mfma_f32_16x16x32_bf16 v[92:95], a[172:175], a[176:179], v[92:95]
v_mfma_f32_16x16x32_bf16 v[96:99], a[160:163], a[176:179], v[96:99]
s_waitcnt lgkmcnt(0)
s_waitcnt vmcnt(5)
v_mfma_f32_16x16x32_bf16 v[36:39], a[180:183], a[56:59], v[36:39]
ds_read_b128 a[144:147], v1 offset:57344
buffer_load_dwordx4 a[84:87], v127, s[8:11], s62 offen offset:2048 sc1
v_mfma_f32_16x16x32_bf16 v[64:67], a[180:183], a[60:63], v[64:67]
ds_read_b128 a[148:151], v1 offset:58368
v_mfma_f32_16x16x32_bf16 v[40:43], a[184:187], a[56:59], v[40:43]
ds_read_b128 a[152:155], v1 offset:59392
v_mfma_f32_16x16x32_bf16 v[68:71], a[184:187], a[60:63], v[68:71]
ds_read_b128 a[156:159], v1 offset:60416
buffer_load_dwordx4 a[88:91], v1, s[8:11], s62 offen offset:3072 sc1
v_mfma_f32_16x16x32_bf16 v[44:47], a[188:191], a[56:59], v[44:47]
ds_read_b128 a[160:163], v1 offset:61440
v_mfma_f32_16x16x32_bf16 v[72:75], a[188:191], a[60:63], v[72:75]
ds_read_b128 a[164:167], v1 offset:62464
v_mfma_f32_16x16x32_bf16 v[48:51], a[192:195], a[56:59], v[48:51]
ds_read_b128 a[168:171], v1 offset:63488
v_mfma_f32_16x16x32_bf16 v[76:79], a[192:195], a[60:63], v[76:79]
ds_read_b128 a[172:175], v125 offset:57344
buffer_load_dwordx4 a[92:95], v127, s[8:11], s62 offen offset:3072 sc1
s_add_u32 s62, s62, 4096
v_mfma_f32_16x16x32_bf16 v[52:55], a[196:199], a[56:59], v[52:55]
ds_read_b128 a[176:179], v126 offset:8192
v_mfma_f32_16x16x32_bf16 v[80:83], a[196:199], a[60:63], v[80:83]
v_mov_b32 v216, 1073741824
v_mfma_f32_16x16x32_bf16 v[56:59], a[200:203], a[56:59], v[56:59]
v_mfma_f32_16x16x32_bf16 v[84:87], a[200:203], a[60:63], v[84:87]
v_cndmask_b32 v216, v216, v1, s[46:47]
v_mfma_f32_16x16x32_bf16 v[60:63], a[204:207], a[56:59], v[60:63]
v_mfma_f32_16x16x32_bf16 v[88:91], a[204:207], a[60:63], v[88:91]
buffer_load_dwordx4 a[96:99], v1, s[8:11], s62 offen offset:0 sc1
v_mfma_f32_16x16x32_bf16 v[92:95], a[208:211], a[212:215], v[92:95]
v_add_u32 v217, 18432, v216
v_mfma_f32_16x16x32_bf16 v[96:99], a[196:199], a[212:215], v[96:99]
s_waitcnt lgkmcnt(0)
s_waitcnt vmcnt(7)
v_add_u32 v125, 64512, v125
v_mfma_f32_16x16x32_bf16 v[36:39], a[144:147], a[64:67], v[36:39]
ds_read_b128 a[180:183], v8 offset:0
v_mfma_f32_16x16x32_bf16 v[64:67], a[144:147], a[68:71], v[64:67]
ds_read_b128 a[184:187], v8 offset:1024
buffer_load_dwordx4 a[100:103], v127, s[8:11], s62 offen offset:0 sc1
v_mfma_f32_16x16x32_bf16 v[40:43], a[148:151], a[64:67], v[40:43]
ds_read_b128 a[188:191], v8 offset:2048
v_mfma_f32_16x16x32_bf16 v[68:71], a[148:151], a[68:71], v[68:71]
ds_read_b128 a[192:195], v8 offset:3072
v_mfma_f32_16x16x32_bf16 v[44:47], a[152:155], a[64:67], v[44:47]
ds_read_b128 a[196:199], v8 offset:4096
buffer_load_dwordx4 a[104:107], v1, s[8:11], s62 offen offset:1024 sc1
v_mfma_f32_16x16x32_bf16 v[72:75], a[152:155], a[68:71], v[72:75]
ds_read_b128 a[200:203], v8 offset:5120
v_mfma_f32_16x16x32_bf16 v[48:51], a[156:159], a[64:67], v[48:51]
ds_read_b128 a[204:207], v8 offset:6144
v_mfma_f32_16x16x32_bf16 v[76:79], a[156:159], a[68:71], v[76:79]
ds_read_b128 a[208:211], v125 offset:0
v_mfma_f32_16x16x32_bf16 v[52:55], a[160:163], a[64:67], v[52:55]
ds_read_b128 a[212:215], v126 offset:9216
buffer_load_dwordx4 a[108:111], v127, s[8:11], s62 offen offset:1024 sc1
v_mfma_f32_16x16x32_bf16 v[80:83], a[160:163], a[68:71], v[80:83]
v_mfma_f32_16x16x32_bf16 v[56:59], a[164:167], a[64:67], v[56:59]
v_mfma_f32_16x16x32_bf16 v[84:87], a[164:167], a[68:71], v[84:87]
buffer_load_dwordx4 a[112:115], v1, s[8:11], s62 offen offset:2048 sc1
v_mfma_f32_16x16x32_bf16 v[60:63], a[168:171], a[64:67], v[60:63]
v_mfma_f32_16x16x32_bf16 v[88:91], a[168:171], a[68:71], v[88:91]
v_mfma_f32_16x16x32_bf16 v[92:95], a[172:175], a[176:179], v[92:95]
buffer_load_dwordx4 a[116:119], v127, s[8:11], s62 offen offset:2048 sc1
v_mfma_f32_16x16x32_bf16 v[96:99], a[160:163], a[176:179], v[96:99]
s_waitcnt lgkmcnt(0)
s_waitcnt vmcnt(10)
v_mfma_f32_16x16x32_bf16 v[36:39], a[180:183], a[72:75], v[36:39]
ds_read_b128 a[144:147], v8 offset:7168
v_mfma_f32_16x16x32_bf16 v[64:67], a[180:183], a[76:79], v[64:67]
ds_read_b128 a[148:151], v8 offset:8192
v_mfma_f32_16x16x32_bf16 v[40:43], a[184:187], a[72:75], v[40:43]
ds_read_b128 a[152:155], v8 offset:9216
buffer_load_dwordx4 a[120:123], v1, s[8:11], s62 offen offset:3072 sc1
v_mfma_f32_16x16x32_bf16 v[68:71], a[184:187], a[76:79], v[68:71]
ds_read_b128 a[156:159], v8 offset:10240
v_mfma_f32_16x16x32_bf16 v[44:47], a[188:191], a[72:75], v[44:47]
ds_read_b128 a[160:163], v8 offset:11264
v_mfma_f32_16x16x32_bf16 v[72:75], a[188:191], a[76:79], v[72:75]
ds_read_b128 a[164:167], v8 offset:12288
buffer_load_dwordx4 a[124:127], v127, s[8:11], s62 offen offset:3072 sc1
s_add_u32 s62, s62, 4096
v_mfma_f32_16x16x32_bf16 v[48:51], a[192:195], a[72:75], v[48:51]
ds_read_b128 a[168:171], v8 offset:13312
v_mfma_f32_16x16x32_bf16 v[76:79], a[192:195], a[76:79], v[76:79]
ds_read_b128 a[172:175], v125 offset:7168
v_mfma_f32_16x16x32_bf16 v[52:55], a[196:199], a[72:75], v[52:55]
ds_read_b128 a[176:179], v126 offset:10240
v_mfma_f32_16x16x32_bf16 v[80:83], a[196:199], a[76:79], v[80:83]
v_mfma_f32_16x16x32_bf16 v[56:59], a[200:203], a[72:75], v[56:59]
v_mfma_f32_16x16x32_bf16 v[84:87], a[200:203], a[76:79], v[84:87]
v_mfma_f32_16x16x32_bf16 v[60:63], a[204:207], a[72:75], v[60:63]
buffer_load_dwordx4 a[128:131], v1, s[8:11], s62 offen offset:0 sc1
v_mfma_f32_16x16x32_bf16 v[88:91], a[204:207], a[76:79], v[88:91]
v_mfma_f32_16x16x32_bf16 v[92:95], a[208:211], a[212:215], v[92:95]
v_mfma_f32_16x16x32_bf16 v[96:99], a[196:199], a[212:215], v[96:99]
buffer_load_dwordx4 a[132:135], v127, s[8:11], s62 offen offset:0 sc1
s_waitcnt lgkmcnt(0)
s_waitcnt vmcnt(12)
v_mfma_f32_16x16x32_bf16 v[36:39], a[144:147], a[80:83], v[36:39]
ds_read_b128 a[180:183], v8 offset:14336
v_mfma_f32_16x16x32_bf16 v[64:67], a[144:147], a[84:87], v[64:67]
ds_read_b128 a[184:187], v8 offset:15360
v_mfma_f32_16x16x32_bf16 v[40:43], a[148:151], a[80:83], v[40:43]
ds_read_b128 a[188:191], v8 offset:16384
v_mfma_f32_16x16x32_bf16 v[68:71], a[148:151], a[84:87], v[68:71]
ds_read_b128 a[192:195], v8 offset:17408
buffer_load_dwordx4 a[136:139], v1, s[8:11], s62 offen offset:1024 sc1
v_mfma_f32_16x16x32_bf16 v[44:47], a[152:155], a[80:83], v[44:47]
ds_read_b128 a[196:199], v8 offset:18432
v_mfma_f32_16x16x32_bf16 v[72:75], a[152:155], a[84:87], v[72:75]
ds_read_b128 a[200:203], v8 offset:19456
v_mfma_f32_16x16x32_bf16 v[48:51], a[156:159], a[80:83], v[48:51]
ds_read_b128 a[204:207], v8 offset:20480
buffer_load_dwordx4 a[140:143], v127, s[8:11], s62 offen offset:1024 sc1
s_mov_b32 s37, L_c2-L_pc
v_mfma_f32_16x16x32_bf16 v[76:79], a[156:159], a[84:87], v[76:79]
ds_read_b128 a[208:211], v125 offset:14336
v_mfma_f32_16x16x32_bf16 v[52:55], a[160:163], a[80:83], v[52:55]
ds_read_b128 a[212:215], v126 offset:11264
v_mfma_f32_16x16x32_bf16 v[80:83], a[160:163], a[84:87], v[80:83]
v_mfma_f32_16x16x32_bf16 v[56:59], a[164:167], a[80:83], v[56:59]
v_mfma_f32_16x16x32_bf16 v[84:87], a[164:167], a[84:87], v[84:87]
v_mfma_f32_16x16x32_bf16 v[60:63], a[168:171], a[80:83], v[60:63]
v_mfma_f32_16x16x32_bf16 v[88:91], a[168:171], a[84:87], v[88:91]
buffer_load_dword v15, v14, s[88:91], s37 offen
v_mfma_f32_16x16x32_bf16 v[92:95], a[172:175], a[176:179], v[92:95]
v_mfma_f32_16x16x32_bf16 v[96:99], a[160:163], a[176:179], v[96:99]
s_waitcnt lgkmcnt(0)
s_waitcnt vmcnt(13)
v_mfma_f32_16x16x32_bf16 v[36:39], a[180:183], a[88:91], v[36:39]
ds_read_b128 a[144:147], v8 offset:21504
v_mfma_f32_16x16x32_bf16 v[64:67], a[180:183], a[92:95], v[64:67]
ds_read_b128 a[148:151], v8 offset:22528
v_mfma_f32_16x16x32_bf16 v[40:43], a[184:187], a[88:91], v[40:43]
ds_read_b128 a[152:155], v8 offset:23552
v_mfma_f32_16x16x32_bf16 v[68:71], a[184:187], a[92:95], v[68:71]
ds_read_b128 a[156:159], v8 offset:24576
v_mfma_f32_16x16x32_bf16 v[44:47], a[188:191], a[88:91], v[44:47]
ds_read_b128 a[160:163], v8 offset:25600
v_mfma_f32_16x16x32_bf16 v[72:75], a[188:191], a[92:95], v[72:75]
ds_read_b128 a[164:167], v8 offset:26624
v_mfma_f32_16x16x32_bf16 v[48:51], a[192:195], a[88:91], v[48:51]
ds_read_b128 a[168:171], v8 offset:27648
v_mfma_f32_16x16x32_bf16 v[76:79], a[192:195], a[92:95], v[76:79]
ds_read_b128 a[172:175], v125 offset:21504
v_mfma_f32_16x16x32_bf16 v[52:55], a[196:199], a[88:91], v[52:55]
ds_read_b128 a[176:179], v126 offset:12288
v_mfma_f32_16x16x32_bf16 v[80:83], a[196:199], a[92:95], v[80:83]
v_mfma_f32_16x16x32_bf16 v[56:59], a[200:203], a[88:91], v[56:59]
v_mfma_f32_16x16x32_bf16 v[84:87], a[200:203], a[92:95], v[84:87]
v_mfma_f32_16x16x32_bf16 v[60:63], a[204:207], a[88:91], v[60:63]
v_mfma_f32_16x16x32_bf16 v[88:91], a[204:207], a[92:95], v[88:91]
v_mfma_f32_16x16x32_bf16 v[92:95], a[208:211], a[212:215], v[92:95]
v_mfma_f32_16x16x32_bf16 v[96:99], a[196:199], a[212:215], v[96:99]
s_waitcnt lgkmcnt(0)
s_waitcnt vmcnt(11)
v_mfma_f32_16x16x32_bf16 v[36:39], a[144:147], a[96:99], v[36:39]
ds_read_b128 a[180:183], v8 offset:28672
v_mfma_f32_16x16x32_bf16 v[64:67], a[144:147], a[100:103], v[64:67]
ds_read_b128 a[184:187], v8 offset:29696
v_mfma_f32_16x16x32_bf16 v[40:43], a[148:151], a[96:99], v[40:43]
ds_read_b128 a[188:191], v8 offset:30720
v_mfma_f32_16x16x32_bf16 v[68:71], a[148:151], a[100:103], v[68:71]
ds_read_b128 a[192:195], v8 offset:31744
v_mfma_f32_16x16x32_bf16 v[44:47], a[152:155], a[96:99], v[44:47]
ds_read_b128 a[196:199], v8 offset:32768
v_mfma_f32_16x16x32_bf16 v[72:75], a[152:155], a[100:103], v[72:75]
ds_read_b128 a[200:203], v8 offset:33792
v_mfma_f32_16x16x32_bf16 v[48:51], a[156:159], a[96:99], v[48:51]
ds_read_b128 a[204:207], v8 offset:34816
v_mfma_f32_16x16x32_bf16 v[76:79], a[156:159], a[100:103], v[76:79]
ds_read_b128 a[208:211], v125 offset:28672
v_mfma_f32_16x16x32_bf16 v[52:55], a[160:163], a[96:99], v[52:55]
ds_read_b128 a[212:215], v126 offset:13312
v_mfma_f32_16x16x32_bf16 v[80:83], a[160:163], a[100:103], v[80:83]
v_mfma_f32_16x16x32_bf16 v[56:59], a[164:167], a[96:99], v[56:59]
v_mfma_f32_16x16x32_bf16 v[84:87], a[164:167], a[100:103], v[84:87]
v_mfma_f32_16x16x32_bf16 v[60:63], a[168:171], a[96:99], v[60:63]
v_mfma_f32_16x16x32_bf16 v[88:91], a[168:171], a[100:103], v[88:91]
v_mfma_f32_16x16x32_bf16 v[92:95], a[172:175], a[176:179], v[92:95]
v_mfma_f32_16x16x32_bf16 v[96:99], a[160:163], a[176:179], v[96:99]
s_waitcnt lgkmcnt(0)
s_waitcnt vmcnt(9)
v_mfma_f32_16x16x32_bf16 v[36:39], a[180:183], a[104:107], v[36:39]
ds_read_b128 a[144:147], v8 offset:35840
v_mfma_f32_16x16x32_bf16 v[64:67], a[180:183], a[108:111], v[64:67]
ds_read_b128 a[148:151], v8 offset:36864
v_add_f32 v131, v100, v102
v_mfma_f32_16x16x32_bf16 v[40:43], a[184:187], a[104:107], v[40:43]
ds_read_b128 a[152:155], v8 offset:37888
v_add_f32 v132, v101, v103
v_mfma_f32_16x16x32_bf16 v[68:71], a[184:187], a[108:111], v[68:71]
ds_read_b128 a[156:159], v8 offset:38912
v_add_f32 v131, v131, v104
v_mfma_f32_16x16x32_bf16 v[44:47], a[188:191], a[104:107], v[44:47]
ds_read_b128 a[160:163], v8 offset:39936
v_add_f32 v132, v132, v105
v_mfma_f32_16x16x32_bf16 v[72:75], a[188:191], a[108:111], v[72:75]
ds_read_b128 a[164:167], v8 offset:40960
v_add_f32 v131, v131, v106
v_mfma_f32_16x16x32_bf16 v[48:51], a[192:195], a[104:107], v[48:51]
ds_read_b128 a[168:171], v8 offset:41984
v_add_f32 v132, v132, v107
v_mfma_f32_16x16x32_bf16 v[76:79], a[192:195], a[108:111], v[76:79]
ds_read_b128 a[172:175], v125 offset:35840
v_add_f32 v131, v131, v108
v_mfma_f32_16x16x32_bf16 v[52:55], a[196:199], a[104:107], v[52:55]
ds_read_b128 a[176:179], v126 offset:14336
v_add_f32 v132, v132, v109
v_mfma_f32_16x16x32_bf16 v[80:83], a[196:199], a[108:111], v[80:83]
v_mfma_f32_16x16x32_bf16 v[56:59], a[200:203], a[104:107], v[56:59]
v_add_f32 v131, v131, v110
v_mfma_f32_16x16x32_bf16 v[84:87], a[200:203], a[108:111], v[84:87]
v_add_f32 v132, v132, v111
v_mfma_f32_16x16x32_bf16 v[60:63], a[204:207], a[104:107], v[60:63]
v_add_f32 v131, v131, v112
v_mfma_f32_16x16x32_bf16 v[88:91], a[204:207], a[108:111], v[88:91]
v_add_f32 v132, v132, v113
v_mfma_f32_16x16x32_bf16 v[92:95], a[208:211], a[212:215], v[92:95]
v_add_f32 v131, v131, v114
v_mfma_f32_16x16x32_bf16 v[96:99], a[196:199], a[212:215], v[96:99]
s_waitcnt lgkmcnt(0)
s_waitcnt vmcnt(7)
v_mfma_f32_16x16x32_bf16 v[36:39], a[144:147], a[112:115], v[36:39]
ds_read_b128 a[180:183], v8 offset:43008
v_add_f32 v132, v132, v115
v_mfma_f32_16x16x32_bf16 v[64:67], a[144:147], a[116:119], v[64:67]
ds_read_b128 a[184:187], v8 offset:44032
v_mul_f32 v131, 0x3ae38e39, v131
v_mfma_f32_16x16x32_bf16 v[40:43], a[148:151], a[112:115], v[40:43]
ds_read_b128 a[188:191], v8 offset:45056
v_mul_f32 v6, v131, v131
v_mfma_f32_16x16x32_bf16 v[68:71], a[148:151], a[116:119], v[68:71]
ds_read_b128 a[192:195], v8 offset:46080
v_mul_f32 v132, 0x3ae38e39, v132
v_mfma_f32_16x16x32_bf16 v[44:47], a[152:155], a[112:115], v[44:47]
ds_read_b128 a[196:199], v8 offset:47104
v_sub_f32 v132, v132, v6
v_mfma_f32_16x16x32_bf16 v[72:75], a[152:155], a[116:119], v[72:75]
ds_read_b128 a[200:203], v8 offset:48128
v_max_f32 v132, 0, v132
v_mfma_f32_16x16x32_bf16 v[48:51], a[156:159], a[112:115], v[48:51]
ds_read_b128 a[204:207], v8 offset:49152
v_add_f32 v132, 0x3727c5ac, v132
v_mfma_f32_16x16x32_bf16 v[76:79], a[156:159], a[116:119], v[76:79]
ds_read_b128 a[208:211], v125 offset:43008
v_mfma_f32_16x16x32_bf16 v[52:55], a[160:163], a[112:115], v[52:55]
ds_read_b128 a[212:215], v126 offset:15360
v_mfma_f32_16x16x32_bf16 v[80:83], a[160:163], a[116:119], v[80:83]
v_rsq_f32 v133, v132
v_mfma_f32_16x16x32_bf16 v[56:59], a[164:167], a[112:115], v[56:59]
v_cvt_pk_bf16_f32 v6, -v131, -v131
v_and_b32 v6, 0xffff0000, v6
v_mfma_f32_16x16x32_bf16 v[84:87], a[164:167], a[116:119], v[84:87]
v_add_f32 v6, v131, v6
v_mfma_f32_16x16x32_bf16 v[60:63], a[168:171], a[112:115], v[60:63]
v_cvt_pk_bf16_f32 v134, -v131, -v6
v_mfma_f32_16x16x32_bf16 v[88:91], a[168:171], a[116:119], v[88:91]
v_mfma_f32_16x16x32_bf16 v[92:95], a[172:175], a[176:179], v[92:95]
v_mfma_f32_16x16x32_bf16 v[96:99], a[160:163], a[176:179], v[96:99]
s_waitcnt lgkmcnt(0)
s_waitcnt vmcnt(5)
v_mfma_f32_16x16x32_bf16 v[36:39], a[180:183], a[120:123], v[36:39]
ds_read_b128 a[144:147], v8 offset:50176
v_mfma_f32_16x16x32_bf16 v[64:67], a[180:183], a[124:127], v[64:67]
ds_read_b128 a[148:151], v8 offset:51200
v_mfma_f32_16x16x32_bf16 v[40:43], a[184:187], a[120:123], v[40:43]
ds_read_b128 a[152:155], v8 offset:52224
v_mfma_f32_16x16x32_bf16 v[68:71], a[184:187], a[124:127], v[68:71]
ds_read_b128 a[156:159], v8 offset:53248
v_mfma_f32_16x16x32_bf16 v[44:47], a[188:191], a[120:123], v[44:47]
ds_read_b128 a[160:163], v8 offset:54272
v_mfma_f32_16x16x32_bf16 v[72:75], a[188:191], a[124:127], v[72:75]
ds_read_b128 a[164:167], v8 offset:55296
v_mfma_f32_16x16x32_bf16 v[48:51], a[192:195], a[120:123], v[48:51]
ds_read_b128 a[168:171], v8 offset:56320
v_mfma_f32_16x16x32_bf16 v[76:79], a[192:195], a[124:127], v[76:79]
ds_read_b128 a[172:175], v125 offset:50176
v_mfma_f32_16x16x32_bf16 v[52:55], a[196:199], a[120:123], v[52:55]
ds_read_b128 a[176:179], v126 offset:16384
v_mfma_f32_16x16x32_bf16 v[80:83], a[196:199], a[124:127], v[80:83]
ds_bpermute_b32 v116, v124, v134 offset:128
v_mfma_f32_16x16x32_bf16 v[56:59], a[200:203], a[120:123], v[56:59]
ds_bpermute_b32 v118, v124, v134 offset:192
v_mfma_f32_16x16x32_bf16 v[84:87], a[200:203], a[124:127], v[84:87]
ds_bpermute_b32 v120, v124, v134
v_mfma_f32_16x16x32_bf16 v[60:63], a[204:207], a[120:123], v[60:63]
ds_bpermute_b32 v136, v124, v133 offset:128
v_mfma_f32_16x16x32_bf16 v[88:91], a[204:207], a[124:127], v[88:91]
ds_bpermute_b32 v137, v124, v133 offset:192
v_mfma_f32_16x16x32_bf16 v[92:95], a[208:211], a[212:215], v[92:95]
v_mfma_f32_16x16x32_bf16 v[96:99], a[196:199], a[212:215], v[96:99]
s_waitcnt lgkmcnt(0)
s_waitcnt vmcnt(3)
v_mfma_f32_16x16x32_bf16 v[36:39], a[144:147], a[128:131], v[36:39]
ds_read_b128 a[180:183], v8 offset:57344
v_mfma_f32_16x16x32_bf16 v[64:67], a[144:147], a[132:135], v[64:67]
ds_read_b128 a[184:187], v8 offset:58368
v_mfma_f32_16x16x32_bf16 v[40:43], a[148:151], a[128:131], v[40:43]
ds_read_b128 a[188:191], v8 offset:59392
v_mfma_f32_16x16x32_bf16 v[68:71], a[148:151], a[132:135], v[68:71]
ds_read_b128 a[192:195], v8 offset:60416
v_mfma_f32_16x16x32_bf16 v[44:47], a[152:155], a[128:131], v[44:47]
ds_read_b128 a[196:199], v8 offset:61440
v_mfma_f32_16x16x32_bf16 v[72:75], a[152:155], a[132:135], v[72:75]
ds_read_b128 a[200:203], v8 offset:62464
v_mfma_f32_16x16x32_bf16 v[48:51], a[156:159], a[128:131], v[48:51]
ds_read_b128 a[204:207], v8 offset:63488
v_mfma_f32_16x16x32_bf16 v[76:79], a[156:159], a[132:135], v[76:79]
ds_read_b128 a[208:211], v125 offset:57344
v_mfma_f32_16x16x32_bf16 v[52:55], a[160:163], a[128:131], v[52:55]
ds_read_b128 a[212:215], v126 offset:17408
v_mfma_f32_16x16x32_bf16 v[80:83], a[160:163], a[132:135], v[80:83]
ds_bpermute_b32 v138, v122, v133 offset:0
v_mfma_f32_16x16x32_bf16 v[56:59], a[164:167], a[128:131], v[56:59]
ds_bpermute_b32 v139, v123, v133 offset:0
v_mfma_f32_16x16x32_bf16 v[84:87], a[164:167], a[132:135], v[84:87]
ds_bpermute_b32 v140, v122, v133 offset:64
v_mfma_f32_16x16x32_bf16 v[60:63], a[168:171], a[128:131], v[60:63]
ds_bpermute_b32 v141, v123, v133 offset:64
v_mfma_f32_16x16x32_bf16 v[88:91], a[168:171], a[132:135], v[88:91]
v_mfma_f32_16x16x32_bf16 v[92:95], a[172:175], a[176:179], v[92:95]
v_mfma_f32_16x16x32_bf16 v[96:99], a[160:163], a[176:179], v[96:99]
s_waitcnt lgkmcnt(0)
s_waitcnt vmcnt(1)
v_mfma_f32_16x16x32_bf16 v[36:39], a[180:183], a[136:139], v[36:39]
ds_read_b64 a[216:217], v128 offset:0
v_mov_b32 v117, v116
v_mfma_f32_16x16x32_bf16 v[64:67], a[180:183], a[140:143], v[64:67]
ds_read_b64 a[218:219], v128 offset:512
v_mov_b32 v119, v118
v_mfma_f32_16x16x32_bf16 v[40:43], a[184:187], a[136:139], v[40:43]
ds_read_b64 a[220:221], v128 offset:1024
v_mov_b32 v121, v120
v_mfma_f32_16x16x32_bf16 v[68:71], a[184:187], a[140:143], v[68:71]
ds_read_b64 a[222:223], v128 offset:1536
v_mul_f32 v136, 0x3eae1a93, v136
v_mfma_f32_16x16x32_bf16 v[44:47], a[188:191], a[136:139], v[44:47]
ds_read_b64 a[224:225], v128 offset:2048
v_mul_f32 v137, 0x3eae1a93, v137
v_mfma_f32_16x16x32_bf16 v[72:75], a[188:191], a[140:143], v[72:75]
ds_read_b64 a[226:227], v128 offset:2560
v_mul_f32 v142, v136, v138
v_mfma_f32_16x16x32_bf16 v[48:51], a[192:195], a[136:139], v[48:51]
ds_read_b64 a[228:229], v128 offset:3072
v_mul_f32 v143, v136, v139
v_mfma_f32_16x16x32_bf16 v[76:79], a[192:195], a[140:143], v[76:79]
ds_read_b64 a[230:231], v129
v_mul_f32 v144, v137, v140
v_mfma_f32_16x16x32_bf16 v[52:55], a[196:199], a[136:139], v[52:55]
v_mul_f32 v145, v137, v141
v_mfma_f32_16x16x32_bf16 v[80:83], a[196:199], a[140:143], v[80:83]
s_cmp_eq_u32 s60, 0
s_cselect_b32 s30, 0xf149f2ca, 0
v_mfma_f32_16x16x32_bf16 v[56:59], a[200:203], a[136:139], v[56:59]
v_mov_b32 v6, s30
v_mfma_f32_16x16x32_bf16 v[84:87], a[200:203], a[140:143], v[84:87]
v_cndmask_b32 v146, v6, 0, s[42:43]
v_mfma_f32_16x16x32_bf16 v[60:63], a[204:207], a[136:139], v[60:63]
v_cndmask_b32 v147, v6, 0, s[44:45]
v_mfma_f32_16x16x32_bf16 v[88:91], a[204:207], a[140:143], v[88:91]
v_mfma_f32_16x16x32_bf16 v[92:95], a[208:211], a[212:215], v[92:95]
v_mfma_f32_16x16x32_bf16 v[96:99], a[196:199], a[212:215], v[96:99]
s_waitcnt lgkmcnt(0)
v_mfma_f32_16x16x16_bf16 v[36:39], a[216:217], v[116:117], v[36:39]
v_mfma_f32_16x16x16_bf16 v[64:67], a[216:217], v[118:119], v[64:67]
v_mfma_f32_16x16x16_bf16 v[40:43], a[218:219], v[116:117], v[40:43]
v_mfma_f32_16x16x16_bf16 v[68:71], a[218:219], v[118:119], v[68:71]
v_mfma_f32_16x16x16_bf16 v[44:47], a[220:221], v[116:117], v[44:47]
v_mfma_f32_16x16x16_bf16 v[72:75], a[220:221], v[118:119], v[72:75]
v_mfma_f32_16x16x16_bf16 v[48:51], a[222:223], v[116:117], v[48:51]
v_mfma_f32_16x16x16_bf16 v[76:79], a[222:223], v[118:119], v[76:79]
v_mfma_f32_16x16x16_bf16 v[52:55], a[224:225], v[116:117], v[52:55]
v_mfma_f32_16x16x16_bf16 v[80:83], a[224:225], v[118:119], v[80:83]
v_mfma_f32_16x16x16_bf16 v[56:59], a[226:227], v[116:117], v[56:59]
v_mfma_f32_16x16x16_bf16 v[84:87], a[226:227], v[118:119], v[84:87]
v_mfma_f32_16x16x16_bf16 v[60:63], a[228:229], v[116:117], v[60:63]
v_mfma_f32_16x16x16_bf16 v[88:91], a[228:229], v[118:119], v[88:91]
v_mfma_f32_16x16x16_bf16 v[92:95], a[230:231], v[120:121], v[92:95]
v_mfma_f32_16x16x16_bf16 v[96:99], a[224:225], v[120:121], v[96:99]
s_barrier
v_cvt_pk_bf16_f32 v154, v36, v37
v_cvt_pk_bf16_f32 v155, v38, v39
ds_write_b64 v210, v[154:155] offset:2816
v_cvt_pk_bf16_f32 v158, v40, v41
v_cvt_pk_bf16_f32 v159, v42, v43
ds_write_b64 v210, v[158:159] offset:2848
s_mul_i32 s36, s28, 82944
v_cvt_pk_bf16_f32 v200, v44, v45
v_cvt_pk_bf16_f32 v201, v46, v47
ds_write_b64 v210, v[200:201] offset:2880
v_cvt_pk_bf16_f32 v202, v48, v49
v_cvt_pk_bf16_f32 v203, v50, v51
ds_write_b64 v210, v[202:203] offset:2912
s_mul_i32 s38, s24, 21504
v_cvt_pk_bf16_f32 v204, v52, v53
v_cvt_pk_bf16_f32 v205, v54, v55
ds_write_b64 v210, v[204:205] offset:2944
v_cndmask_b32 v168, 0, v204, s[48:49]
v_cndmask_b32 v171, 0, v205, s[48:49]
s_add_u32 m0, s38, 0
v_cvt_pk_bf16_f32 v160, v64, v65
v_cvt_pk_bf16_f32 v161, v66, v67
ds_write_b64 v210, v[160:161] offset:5632
v_cvt_pk_bf16_f32 v164, v68, v69
v_cvt_pk_bf16_f32 v165, v70, v71
ds_write_b64 v210, v[164:165] offset:5664
s_add_u32 s39, s38, s36
v_cvt_pk_bf16_f32 v200, v72, v73
v_cvt_pk_bf16_f32 v201, v74, v75
ds_write_b64 v210, v[200:201] offset:5696
v_cvt_pk_bf16_f32 v202, v76, v77
v_cvt_pk_bf16_f32 v203, v78, v79
s_add_u32 s39, s39, 2121728
ds_write_b64 v210, v[202:203] offset:5728
v_cvt_pk_bf16_f32 v204, v80, v81
v_cvt_pk_bf16_f32 v205, v82, v83
ds_write_b64 v210, v[204:205] offset:5760
v_cndmask_b32 v176, 0, v204, s[48:49]
v_cndmask_b32 v179, 0, v205, s[48:49]
buffer_load_dwordx4 v1, s[4:7], s39 offen offset:0  lds
v_cvt_pk_bf16_f32 v206, v92, v93
v_cvt_pk_bf16_f32 v207, v94, v95
ds_write_b64 v214, v[206:207]
v_cvt_pk_bf16_f32 v208, v96, v97
v_cvt_pk_bf16_f32 v209, v98, v99
buffer_load_dwordx4 v1, s[4:7], s39 offen offset:1024  lds
ds_write_b64 v211, v[208:209] offset:128
v_cvt_pk_bf16_f32 v166, v56, v57
v_cvt_pk_bf16_f32 v167, v58, v59
v_cvt_pk_bf16_f32 v172, v60, v61
v_cvt_pk_bf16_f32 v173, v62, v63
v_cvt_pk_bf16_f32 v174, v84, v85
buffer_load_dwordx4 v1, s[4:7], s39 offen offset:2048  lds
v_cvt_pk_bf16_f32 v175, v86, v87
v_cvt_pk_bf16_f32 v180, v88, v89
v_cvt_pk_bf16_f32 v181, v90, v91
s_waitcnt lgkmcnt(0)
s_barrier
buffer_load_dwordx4 v1, s[4:7], s39 offen offset:3072  lds
ds_read_b64 v[148:149], v210
ds_read_b64 v[152:153], v210 offset:32
ds_read_b64 v[150:151], v212 offset:136
ds_read_b64 v[156:157], v212 offset:2952
ds_read_b64 v[162:163], v212 offset:5768
ds_read_b64_tr_b16 v[182:183], v213 offset:64
s_add_u32 m0, m0, 4096
ds_read_b64_tr_b16 v[184:185], v213 offset:2880
ds_read_b64_tr_b16 v[186:187], v213 offset:5696
ds_read_b64_tr_b16 v[188:189], v213 offset:96
ds_read_b64_tr_b16 v[190:191], v213 offset:2912
ds_read_b64_tr_b16 v[192:193], v213 offset:5728
ds_read_b64_tr_b16 v[194:195], v213 offset:128
s_add_u32 s39, s39, 4096
ds_read_b64_tr_b16 v[196:197], v213 offset:2944
ds_read_b64_tr_b16 v[198:199], v213 offset:5760
s_waitcnt lgkmcnt(9)
v_mfma_f32_16x16x32_bf16 v[36:39], v[148:151], v[166:169], 0
v_mfma_f32_16x16x32_bf16 v[40:43], v[154:157], v[166:169], 0
buffer_load_dwordx4 v1, s[4:7], s39 offen offset:0  lds
v_mfma_f32_16x16x32_bf16 v[44:47], v[150:153], v[170:173], 0
v_mfma_f32_16x16x32_bf16 v[48:51], v[156:159], v[170:173], 0
v_mfma_f32_16x16x32_bf16 v[52:55], v[154:157], v[174:177], 0
v_mfma_f32_16x16x32_bf16 v[56:59], v[160:163], v[174:177], 0
v_mfma_f32_16x16x32_bf16 v[60:63], v[156:159], v[178:181], 0
v_mfma_f32_16x16x32_bf16 v[64:67], v[162:165], v[178:181], 0
buffer_load_dwordx4 v1, s[4:7], s39 offen offset:1024  lds
s_nop 1
v_cndmask_b32 v36, v36, v37, s[40:41]
v_cndmask_b32 v40, v40, v41, s[40:41]
v_cndmask_b32 v36, v36, v40, s[42:43]
v_fma_f32 v68, v36, v142, v146
buffer_load_dwordx4 v1, s[4:7], s39 offen offset:2048  lds
v_cndmask_b32 v38, v38, v39, s[40:41]
v_cndmask_b32 v42, v42, v43, s[40:41]
v_cndmask_b32 v38, v38, v42, s[44:45]
v_fma_f32 v69, v38, v143, v147
v_max_f32 v76, v68, v69
v_cndmask_b32 v44, v44, v45, s[40:41]
buffer_load_dwordx4 v1, s[4:7], s39 offen offset:3072  lds
v_cndmask_b32 v48, v48, v49, s[40:41]
v_cndmask_b32 v44, v44, v48, s[42:43]
v_fma_f32 v70, v44, v142, v146
v_cndmask_b32 v46, v46, v47, s[40:41]
v_cndmask_b32 v50, v50, v51, s[40:41]
s_add_u32 m0, m0, 4096
v_cndmask_b32 v46, v46, v50, s[44:45]
v_fma_f32 v71, v46, v143, v147
v_max_f32 v77, v70, v71
v_cndmask_b32 v52, v52, v53, s[40:41]
v_cndmask_b32 v56, v56, v57, s[40:41]
v_cndmask_b32 v52, v52, v56, s[42:43]
s_add_u32 s39, s39, 4096
v_mul_f32 v72, v52, v144
v_cndmask_b32 v54, v54, v55, s[40:41]
v_cndmask_b32 v58, v58, v59, s[40:41]
v_cndmask_b32 v54, v54, v58, s[44:45]
v_mul_f32 v73, v54, v145
buffer_load_dwordx4 v1, s[4:7], s39 offen offset:0  lds
v_max_f32 v78, v72, v73
v_cndmask_b32 v60, v60, v61, s[40:41]
v_cndmask_b32 v64, v64, v65, s[40:41]
v_cndmask_b32 v60, v60, v64, s[42:43]
v_mul_f32 v74, v60, v144
v_cndmask_b32 v62, v62, v63, s[40:41]
buffer_load_dwordx4 v1, s[4:7], s39 offen offset:1024  lds
v_cndmask_b32 v66, v66, v67, s[40:41]
v_cndmask_b32 v62, v62, v66, s[44:45]
v_mul_f32 v75, v62, v145
v_max_f32 v79, v74, v75
s_nop 1
v_permlane32_swap_b32 v76, v77
buffer_load_dwordx4 v1, s[4:7], s39 offen offset:2048  lds
v_permlane32_swap_b32 v78, v79
v_max_f32 v76, v76, v77
v_max_f32 v78, v78, v79
s_nop 1
v_permlane16_swap_b32 v76, v78
buffer_load_dwordx4 v1, s[4:7], s39 offen offset:3072  lds
v_max_f32 v76, v76, v78
v_mov_b32 v78, v76
s_nop 1
v_permlane16_swap_b32 v76, v78
v_mov_b32 v77, v76
v_mov_b32 v79, v78
s_add_u32 m0, m0, 4096
s_nop 0
v_permlane32_swap_b32 v76, v77
v_permlane32_swap_b32 v78, v79
v_sub_f32 v68, v68, v76
v_sub_f32 v69, v69, v76
s_add_u32 s39, s39, 4096
v_sub_f32 v70, v70, v77
v_sub_f32 v71, v71, v77
v_sub_f32 v72, v72, v78
v_sub_f32 v73, v73, v78
v_sub_f32 v74, v74, v79
v_sub_f32 v75, v75, v79
buffer_load_dwordx4 v1, s[4:7], s39 offen offset:0  lds
v_exp_f32 v68, v68
v_exp_f32 v69, v69
v_exp_f32 v70, v70
v_exp_f32 v71, v71
v_exp_f32 v72, v72
buffer_load_dwordx4 v1, s[4:7], s39 offen offset:1024  lds
v_exp_f32 v73, v73
v_exp_f32 v74, v74
v_exp_f32 v75, v75
v_add_f32 v76, v68, v69
v_add_f32 v77, v70, v71
v_add_f32 v78, v72, v73
buffer_load_dwordx4 v1, s[4:7], s39 offen offset:2048  lds
v_add_f32 v79, v74, v75
v_mul_f32 v68, v68, v138
v_mul_f32 v69, v69, v139
v_mul_f32 v70, v70, v138
v_mul_f32 v71, v71, v139
buffer_load_dwordx4 v1, s[4:7], s39 offen offset:3072  lds
v_mul_f32 v72, v72, v140
v_mul_f32 v73, v73, v141
v_mul_f32 v74, v74, v140
v_mul_f32 v75, v75, v141
s_nop 1
v_permlane32_swap_b32 v76, v77
s_add_u32 m0, m0, 4096
v_permlane32_swap_b32 v78, v79
v_add_f32 v76, v76, v77
v_add_f32 v78, v78, v79
s_nop 1
v_permlane16_swap_b32 v76, v78
v_add_f32 v76, v76, v78
s_add_u32 s39, s39, 4096
v_rcp_f32 v76, v76
s_nop 0
v_mov_b32 v78, v76
s_nop 1
v_permlane16_swap_b32 v76, v78
buffer_load_dwordx4 v1, s[4:7], s39 offen offset:0  lds
v_mov_b32 v77, v76
v_mov_b32 v79, v78
s_nop 0
v_permlane32_swap_b32 v76, v77
v_permlane32_swap_b32 v78, v79
v_mul_f32 v68, v68, v76
buffer_load_dwordx4 v1, s[4:7], s39 offen offset:1024  lds
v_mul_f32 v69, v69, v76
v_mul_f32 v70, v70, v77
v_mul_f32 v71, v71, v77
v_mul_f32 v72, v72, v78
v_mul_f32 v73, v73, v78
buffer_load_dwordx4 v1, s[4:7], s39 offen offset:2048  lds
v_mul_f32 v74, v74, v79
v_mul_f32 v75, v75, v79
v_cvt_pk_bf16_f32 v68, v68, v69
v_perm_b32 v84, v68, v68, v10
v_perm_b32 v85, v68, v68, v11
v_perm_b32 v86, v68, v68, v12
buffer_load_dwordx4 v1, s[4:7], s39 offen offset:3072  lds
v_perm_b32 v87, v68, v68, v13
v_cvt_pk_bf16_f32 v70, v70, v71
v_perm_b32 v88, v70, v70, v10
v_perm_b32 v89, v70, v70, v11
v_perm_b32 v90, v70, v70, v12
s_add_u32 m0, m0, 4096
v_perm_b32 v91, v70, v70, v13
v_cvt_pk_bf16_f32 v72, v72, v73
v_perm_b32 v92, v72, v72, v10
v_perm_b32 v93, v72, v72, v11
v_perm_b32 v94, v72, v72, v12
v_perm_b32 v95, v72, v72, v13
s_add_u32 s39, s39, 4096
v_cvt_pk_bf16_f32 v74, v74, v75
v_perm_b32 v96, v74, v74, v10
v_perm_b32 v97, v74, v74, v11
v_perm_b32 v98, v74, v74, v12
v_perm_b32 v99, v74, v74, v13
buffer_load_dwordx4 v1, s[4:7], s39 offen offset:0  lds
s_waitcnt lgkmcnt(0)
v_mfma_f32_16x16x32_bf16 v[36:39], v[182:185], v[84:87], 0
v_mfma_f32_16x16x32_bf16 v[40:43], v[194:197], v[84:87], 0
v_mfma_f32_16x16x32_bf16 v[44:47], v[188:191], v[88:91], 0
v_mfma_f32_16x16x32_bf16 v[48:51], v[194:197], v[88:91], 0
v_mfma_f32_16x16x32_bf16 v[52:55], v[184:187], v[92:95], 0
v_mfma_f32_16x16x32_bf16 v[56:59], v[196:199], v[92:95], 0
v_mfma_f32_16x16x32_bf16 v[60:63], v[190:193], v[96:99], 0
v_mfma_f32_16x16x32_bf16 v[64:67], v[196:199], v[96:99], 0
s_nop 3
v_cvt_pk_bf16_f32 v166, v36, v37
v_cvt_pk_bf16_f32 v167, v38, v39
v_cvt_pk_bf16_f32 v168, v44, v45
v_cvt_pk_bf16_f32 v169, v46, v47
v_cvt_pk_bf16_f32 v170, v40, v41
v_cvt_pk_bf16_f32 v171, v50, v51
buffer_store_dwordx4 v[166:169], v1, s[8:11], s64 offen sc1
buffer_store_dwordx2 v[170:171], v216, s[8:11], s65 offen offset:2048 sc1
v_cvt_pk_bf16_f32 v174, v52, v53
v_cvt_pk_bf16_f32 v175, v54, v55
v_cvt_pk_bf16_f32 v176, v60, v61
v_cvt_pk_bf16_f32 v177, v62, v63
v_cvt_pk_bf16_f32 v178, v56, v57
v_cvt_pk_bf16_f32 v179, v66, v67
buffer_store_dwordx4 v[174:177], v127, s[8:11], s64 offen sc1
buffer_store_dwordx2 v[178:179], v217, s[8:11], s65 offen offset:2048 sc1
L_c2:
s_mul_i32 s38, s24, 9216
s_add_u32 m0, s38, 86016
s_add_u32 s39, s38, s82
buffer_load_dwordx4 v1, s[4:7], s39 offen offset:0  lds
buffer_load_dwordx4 v1, s[4:7], s39 offen offset:1024  lds
buffer_load_dwordx4 v1, s[4:7], s39 offen offset:2048  lds
buffer_load_dwordx4 v1, s[4:7], s39 offen offset:3072  lds
s_add_u32 m0, m0, 4096
s_add_u32 s39, s39, 4096
buffer_load_dwordx4 v1, s[4:7], s39 offen offset:0  lds
buffer_load_dwordx4 v1, s[4:7], s39 offen offset:1024  lds
buffer_load_dwordx4 v1, s[4:7], s39 offen offset:2048  lds
buffer_load_dwordx4 v1, s[4:7], s39 offen offset:3072  lds
s_add_u32 m0, m0, 4096
s_add_u32 s39, s39, 4096
buffer_load_dwordx4 v1, s[4:7], s39 offen offset:0  lds
s_lshl_b32 s38, s24, 8
s_add_u32 m0, s38, 122880
s_add_u32 s39, s38, s82
s_add_u32 s39, s39, 36864
s_mov_b64 exec, 0xffff
buffer_load_dwordx4 v1, s[4:7], s39 offen lds
s_mov_b64 exec, -1
s_waitcnt vmcnt(10)
s_barrier
s_cmp_eq_u32 s24, 0
s_cbranch_scc0 L_sig_1
v_lshlrev_b32 v6, 3, v1
s_lshl_b32 s31, s25, 11
s_lshl_b32 s32, s26, 2
s_add_u32 s31, s31, s32
v_add_u32 v6, s31, v6
s_mov_b64 exec, 0xffff
s_mov_b32 s30, 26476544
buffer_store_dword v4, v6, s[8:11], s30 offen sc1
s_mov_b64 exec, -1
L_sig_1:
s_mul_i32 s38, s24, 9216
s_add_u32 m0, s38, 123904
s_add_u32 s39, s38, s82
s_add_u32 s39, s39, 37888
buffer_load_dwordx4 v1, s[4:7], s39 offen offset:0  lds
buffer_load_dwordx4 v1, s[4:7], s39 offen offset:1024  lds
buffer_load_dwordx4 v1, s[4:7], s39 offen offset:2048  lds
buffer_load_dwordx4 v1, s[4:7], s39 offen offset:3072  lds
s_add_u32 m0, m0, 4096
s_add_u32 s39, s39, 4096
buffer_load_dwordx4 v1, s[4:7], s39 offen offset:0  lds
buffer_load_dwordx4 v1, s[4:7], s39 offen offset:1024  lds
buffer_load_dwordx4 v1, s[4:7], s39 offen offset:2048  lds
buffer_load_dwordx4 v1, s[4:7], s39 offen offset:3072  lds
s_add_u32 m0, m0, 4096
s_add_u32 s39, s39, 4096
buffer_load_dwordx4 v1, s[4:7], s39 offen offset:0  lds
s_lshl_b32 s38, s24, 8
s_add_u32 m0, s38, 160768
s_add_u32 s39, s38, s82
s_add_u32 s39, s39, 74752
s_mov_b64 exec, 0xffff
buffer_load_dwordx4 v1, s[4:7], s39 offen lds
s_mov_b64 exec, -1
s_cmp_eq_u32 s24, 1
s_cbranch_scc0 L_polled_3
s_lshl_b32 s30, s81, 7
s_add_u32 s30, s30, 26476544
v_lshrrev_b32 v6, 2, v1
s_mov_b32 s31, 0
s_mov_b64 exec, 0xffff
L_poll_2:
buffer_load_dword v7, v6, s[8:11], s30 offen sc1
s_add_u32 s31, s31, 1
s_waitcnt vmcnt(0)
v_cmp_ne_u32 vcc, 1, v7
s_cmp_gt_u32 s31, 200000
s_cbranch_scc1 L_polled_3
s_cbranch_vccnz L_poll_2
L_polled_3:
s_mov_b64 exec, -1
s_waitcnt vmcnt(0)
s_barrier
s_lshl_b32 s60, s27, 2
s_add_u32 s60, s60, s24
s_mul_i32 s60, s60, 18432
s_add_u32 s60, s60, 2490368
buffer_load_dwordx4 a[0:3], v1, s[8:11], s60 offen offset:0 sc1
buffer_load_dwordx4 a[4:7], v1, s[8:11], s60 offen offset:1024 sc1
buffer_load_dwordx4 a[8:11], v1, s[8:11], s60 offen offset:2048 sc1
buffer_load_dwordx4 a[12:15], v1, s[8:11], s60 offen offset:3072 sc1
s_add_u32 s60, s60, 4096
buffer_load_dwordx4 a[16:19], v1, s[8:11], s60 offen offset:0 sc1
buffer_load_dwordx4 a[20:23], v1, s[8:11], s60 offen offset:1024 sc1
buffer_load_dwordx4 a[24:27], v1, s[8:11], s60 offen offset:2048 sc1
buffer_load_dwordx4 a[28:31], v1, s[8:11], s60 offen offset:3072 sc1
s_add_u32 s60, s60, 4096
buffer_load_dwordx4 a[32:35], v1, s[8:11], s60 offen offset:0 sc1
v_and_b32 v36, 7, v2
v_lshlrev_b32 v36, 4, v36
v_lshl_add_u32 v36, v3, 7, v36
v_add_u32 v36, 4096, v36
v_add_u32 v37, 41472, v1
v_add_u32 v38, 41472, v36
ds_read_b128 a[72:75], v1 offset:0
ds_read_b128 a[76:79], v1 offset:1024
ds_read_b128 a[80:83], v1 offset:2048
ds_read_b128 a[84:87], v1 offset:3072
ds_read_b128 a[88:91], v36 offset:0
ds_read_b128 a[92:95], v1 offset:4608
ds_read_b128 a[96:99], v1 offset:5632
ds_read_b128 a[100:103], v1 offset:6656
ds_read_b128 a[104:107], v1 offset:7680
ds_read_b128 a[108:111], v36 offset:4608
s_waitcnt vmcnt(8)
s_waitcnt lgkmcnt(5)
v_mfma_f32_16x16x32_bf16 v[16:19], a[72:75], a[0:3], v[16:19]
ds_read_b128 a[112:115], v1 offset:9216
buffer_load_dwordx4 a[36:39], v1, s[8:11], s60 offen offset:1024 sc1
v_mfma_f32_16x16x32_bf16 v[20:23], a[76:79], a[0:3], v[20:23]
ds_read_b128 a[116:119], v1 offset:10240
v_mfma_f32_16x16x32_bf16 v[24:27], a[80:83], a[0:3], v[24:27]
ds_read_b128 a[120:123], v1 offset:11264
v_mfma_f32_16x16x32_bf16 v[28:31], a[84:87], a[0:3], v[28:31]
ds_read_b128 a[124:127], v1 offset:12288
v_mfma_f32_16x16x32_bf16 v[32:35], a[88:91], a[0:3], v[32:35]
ds_read_b128 a[128:131], v36 offset:9216
s_waitcnt vmcnt(8)
s_waitcnt lgkmcnt(5)
v_mfma_f32_16x16x32_bf16 v[16:19], a[92:95], a[4:7], v[16:19]
ds_read_b128 a[72:75], v1 offset:13824
buffer_load_dwordx4 a[40:43], v1, s[8:11], s60 offen offset:2048 sc1
v_mfma_f32_16x16x32_bf16 v[20:23], a[96:99], a[4:7], v[20:23]
ds_read_b128 a[76:79], v1 offset:14848
v_mfma_f32_16x16x32_bf16 v[24:27], a[100:103], a[4:7], v[24:27]
ds_read_b128 a[80:83], v1 offset:15872
v_mfma_f32_16x16x32_bf16 v[28:31], a[104:107], a[4:7], v[28:31]
ds_read_b128 a[84:87], v1 offset:16896
v_mfma_f32_16x16x32_bf16 v[32:35], a[108:111], a[4:7], v[32:35]
ds_read_b128 a[88:91], v36 offset:13824
s_waitcnt vmcnt(8)
s_waitcnt lgkmcnt(5)
v_mfma_f32_16x16x32_bf16 v[16:19], a[112:115], a[8:11], v[16:19]
ds_read_b128 a[92:95], v1 offset:18432
buffer_load_dwordx4 a[44:47], v1, s[8:11], s60 offen offset:3072 sc1
v_mfma_f32_16x16x32_bf16 v[20:23], a[116:119], a[8:11], v[20:23]
ds_read_b128 a[96:99], v1 offset:19456
v_mfma_f32_16x16x32_bf16 v[24:27], a[120:123], a[8:11], v[24:27]
ds_read_b128 a[100:103], v1 offset:20480
v_mfma_f32_16x16x32_bf16 v[28:31], a[124:127], a[8:11], v[28:31]
ds_read_b128 a[104:107], v1 offset:21504
v_mfma_f32_16x16x32_bf16 v[32:35], a[128:131], a[8:11], v[32:35]
ds_read_b128 a[108:111], v36 offset:18432
s_waitcnt vmcnt(8)
s_waitcnt lgkmcnt(5)
v_mfma_f32_16x16x32_bf16 v[16:19], a[72:75], a[12:15], v[16:19]
ds_read_b128 a[112:115], v1 offset:23040
s_add_u32 s60, s60, 4096
buffer_load_dwordx4 a[48:51], v1, s[8:11], s60 offen offset:0 sc1
v_mfma_f32_16x16x32_bf16 v[20:23], a[76:79], a[12:15], v[20:23]
ds_read_b128 a[116:119], v1 offset:24064
v_mfma_f32_16x16x32_bf16 v[24:27], a[80:83], a[12:15], v[24:27]
ds_read_b128 a[120:123], v1 offset:25088
v_mfma_f32_16x16x32_bf16 v[28:31], a[84:87], a[12:15], v[28:31]
ds_read_b128 a[124:127], v1 offset:26112
v_mfma_f32_16x16x32_bf16 v[32:35], a[88:91], a[12:15], v[32:35]
ds_read_b128 a[128:131], v36 offset:23040
s_waitcnt vmcnt(8)
s_waitcnt lgkmcnt(5)
v_mfma_f32_16x16x32_bf16 v[16:19], a[92:95], a[16:19], v[16:19]
ds_read_b128 a[72:75], v1 offset:27648
buffer_load_dwordx4 a[52:55], v1, s[8:11], s60 offen offset:1024 sc1
v_mfma_f32_16x16x32_bf16 v[20:23], a[96:99], a[16:19], v[20:23]
ds_read_b128 a[76:79], v1 offset:28672
v_mfma_f32_16x16x32_bf16 v[24:27], a[100:103], a[16:19], v[24:27]
ds_read_b128 a[80:83], v1 offset:29696
v_mfma_f32_16x16x32_bf16 v[28:31], a[104:107], a[16:19], v[28:31]
ds_read_b128 a[84:87], v1 offset:30720
v_mfma_f32_16x16x32_bf16 v[32:35], a[108:111], a[16:19], v[32:35]
ds_read_b128 a[88:91], v36 offset:27648
s_waitcnt vmcnt(8)
s_waitcnt lgkmcnt(5)
v_mfma_f32_16x16x32_bf16 v[16:19], a[112:115], a[20:23], v[16:19]
ds_read_b128 a[92:95], v1 offset:32256
buffer_load_dwordx4 a[56:59], v1, s[8:11], s60 offen offset:2048 sc1
v_mfma_f32_16x16x32_bf16 v[20:23], a[116:119], a[20:23], v[20:23]
ds_read_b128 a[96:99], v1 offset:33280
v_mfma_f32_16x16x32_bf16 v[24:27], a[120:123], a[20:23], v[24:27]
ds_read_b128 a[100:103], v1 offset:34304
v_mfma_f32_16x16x32_bf16 v[28:31], a[124:127], a[20:23], v[28:31]
ds_read_b128 a[104:107], v1 offset:35328
v_mfma_f32_16x16x32_bf16 v[32:35], a[128:131], a[20:23], v[32:35]
ds_read_b128 a[108:111], v36 offset:32256
s_waitcnt vmcnt(8)
s_waitcnt lgkmcnt(5)
v_mfma_f32_16x16x32_bf16 v[16:19], a[72:75], a[24:27], v[16:19]
ds_read_b128 a[112:115], v1 offset:36864
buffer_load_dwordx4 a[60:63], v1, s[8:11], s60 offen offset:3072 sc1
v_mfma_f32_16x16x32_bf16 v[20:23], a[76:79], a[24:27], v[20:23]
ds_read_b128 a[116:119], v1 offset:37888
v_mfma_f32_16x16x32_bf16 v[24:27], a[80:83], a[24:27], v[24:27]
ds_read_b128 a[120:123], v1 offset:38912
v_mfma_f32_16x16x32_bf16 v[28:31], a[84:87], a[24:27], v[28:31]
ds_read_b128 a[124:127], v1 offset:39936
v_mfma_f32_16x16x32_bf16 v[32:35], a[88:91], a[24:27], v[32:35]
ds_read_b128 a[128:131], v36 offset:36864
s_waitcnt vmcnt(8)
s_waitcnt lgkmcnt(5)
v_mfma_f32_16x16x32_bf16 v[16:19], a[92:95], a[28:31], v[16:19]
ds_read_b128 a[72:75], v37 offset:0
s_add_u32 s60, s60, 4096
buffer_load_dwordx4 a[64:67], v1, s[8:11], s60 offen offset:0 sc1
v_mfma_f32_16x16x32_bf16 v[20:23], a[96:99], a[28:31], v[20:23]
ds_read_b128 a[76:79], v37 offset:1024
v_mfma_f32_16x16x32_bf16 v[24:27], a[100:103], a[28:31], v[24:27]
ds_read_b128 a[80:83], v37 offset:2048
v_mfma_f32_16x16x32_bf16 v[28:31], a[104:107], a[28:31], v[28:31]
ds_read_b128 a[84:87], v37 offset:3072
v_mfma_f32_16x16x32_bf16 v[32:35], a[108:111], a[28:31], v[32:35]
ds_read_b128 a[88:91], v38 offset:0
s_waitcnt vmcnt(8)
s_waitcnt lgkmcnt(5)
v_mfma_f32_16x16x32_bf16 v[16:19], a[112:115], a[32:35], v[16:19]
ds_read_b128 a[92:95], v37 offset:4608
buffer_load_dwordx4 a[68:71], v1, s[8:11], s60 offen offset:1024 sc1
v_mfma_f32_16x16x32_bf16 v[20:23], a[116:119], a[32:35], v[20:23]
ds_read_b128 a[96:99], v37 offset:5632
v_mfma_f32_16x16x32_bf16 v[24:27], a[120:123], a[32:35], v[24:27]
ds_read_b128 a[100:103], v37 offset:6656
v_mfma_f32_16x16x32_bf16 v[28:31], a[124:127], a[32:35], v[28:31]
ds_read_b128 a[104:107], v37 offset:7680
v_mfma_f32_16x16x32_bf16 v[32:35], a[128:131], a[32:35], v[32:35]
ds_read_b128 a[108:111], v38 offset:4608
s_waitcnt vmcnt(8)
s_waitcnt lgkmcnt(5)
v_mfma_f32_16x16x32_bf16 v[16:19], a[72:75], a[36:39], v[16:19]
ds_read_b128 a[112:115], v37 offset:9216
v_mfma_f32_16x16x32_bf16 v[20:23], a[76:79], a[36:39], v[20:23]
ds_read_b128 a[116:119], v37 offset:10240
v_mfma_f32_16x16x32_bf16 v[24:27], a[80:83], a[36:39], v[24:27]
ds_read_b128 a[120:123], v37 offset:11264
v_mfma_f32_16x16x32_bf16 v[28:31], a[84:87], a[36:39], v[28:31]
ds_read_b128 a[124:127], v37 offset:12288
v_mfma_f32_16x16x32_bf16 v[32:35], a[88:91], a[36:39], v[32:35]
ds_read_b128 a[128:131], v38 offset:9216
s_waitcnt vmcnt(7)
s_waitcnt lgkmcnt(5)
v_mfma_f32_16x16x32_bf16 v[16:19], a[92:95], a[40:43], v[16:19]
ds_read_b128 a[72:75], v37 offset:13824
v_mfma_f32_16x16x32_bf16 v[20:23], a[96:99], a[40:43], v[20:23]
ds_read_b128 a[76:79], v37 offset:14848
v_mfma_f32_16x16x32_bf16 v[24:27], a[100:103], a[40:43], v[24:27]
ds_read_b128 a[80:83], v37 offset:15872
v_mfma_f32_16x16x32_bf16 v[28:31], a[104:107], a[40:43], v[28:31]
ds_read_b128 a[84:87], v37 offset:16896
v_mfma_f32_16x16x32_bf16 v[32:35], a[108:111], a[40:43], v[32:35]
ds_read_b128 a[88:91], v38 offset:13824
s_waitcnt vmcnt(6)
s_waitcnt lgkmcnt(5)
v_mfma_f32_16x16x32_bf16 v[16:19], a[112:115], a[44:47], v[16:19]
ds_read_b128 a[92:95], v37 offset:18432
v_mfma_f32_16x16x32_bf16 v[20:23], a[116:119], a[44:47], v[20:23]
ds_read_b128 a[96:99], v37 offset:19456
v_mfma_f32_16x16x32_bf16 v[24:27], a[120:123], a[44:47], v[24:27]
ds_read_b128 a[100:103], v37 offset:20480
v_mfma_f32_16x16x32_bf16 v[28:31], a[124:127], a[44:47], v[28:31]
ds_read_b128 a[104:107], v37 offset:21504
v_mfma_f32_16x16x32_bf16 v[32:35], a[128:131], a[44:47], v[32:35]
ds_read_b128 a[108:111], v38 offset:18432
s_waitcnt vmcnt(5)
s_waitcnt lgkmcnt(5)
v_mfma_f32_16x16x32_bf16 v[16:19], a[72:75], a[48:51], v[16:19]
ds_read_b128 a[112:115], v37 offset:23040
v_mfma_f32_16x16x32_bf16 v[20:23], a[76:79], a[48:51], v[20:23]
ds_read_b128 a[116:119], v37 offset:24064
v_mfma_f32_16x16x32_bf16 v[24:27], a[80:83], a[48:51], v[24:27]
ds_read_b128 a[120:123], v37 offset:25088
v_mfma_f32_16x16x32_bf16 v[28:31], a[84:87], a[48:51], v[28:31]
ds_read_b128 a[124:127], v37 offset:26112
v_mfma_f32_16x16x32_bf16 v[32:35], a[88:91], a[48:51], v[32:35]
ds_read_b128 a[128:131], v38 offset:23040
s_waitcnt vmcnt(4)
s_waitcnt lgkmcnt(5)
v_mfma_f32_16x16x32_bf16 v[16:19], a[92:95], a[52:55], v[16:19]
ds_read_b128 a[72:75], v37 offset:27648
v_mfma_f32_16x16x32_bf16 v[20:23], a[96:99], a[52:55], v[20:23]
ds_read_b128 a[76:79], v37 offset:28672
v_mfma_f32_16x16x32_bf16 v[24:27], a[100:103], a[52:55], v[24:27]
ds_read_b128 a[80:83], v37 offset:29696
v_mfma_f32_16x16x32_bf16 v[28:31], a[104:107], a[52:55], v[28:31]
ds_read_b128 a[84:87], v37 offset:30720
v_mfma_f32_16x16x32_bf16 v[32:35], a[108:111], a[52:55], v[32:35]
ds_read_b128 a[88:91], v38 offset:27648
s_waitcnt vmcnt(3)
s_waitcnt lgkmcnt(5)
v_mfma_f32_16x16x32_bf16 v[16:19], a[112:115], a[56:59], v[16:19]
ds_read_b128 a[92:95], v37 offset:32256
v_mfma_f32_16x16x32_bf16 v[20:23], a[116:119], a[56:59], v[20:23]
ds_read_b128 a[96:99], v37 offset:33280
v_mfma_f32_16x16x32_bf16 v[24:27], a[120:123], a[56:59], v[24:27]
ds_read_b128 a[100:103], v37 offset:34304
v_mfma_f32_16x16x32_bf16 v[28:31], a[124:127], a[56:59], v[28:31]
ds_read_b128 a[104:107], v37 offset:35328
v_mfma_f32_16x16x32_bf16 v[32:35], a[128:131], a[56:59], v[32:35]
ds_read_b128 a[108:111], v38 offset:32256
s_waitcnt vmcnt(2)
s_waitcnt lgkmcnt(5)
v_mfma_f32_16x16x32_bf16 v[16:19], a[72:75], a[60:63], v[16:19]
ds_read_b128 a[112:115], v37 offset:36864
v_mfma_f32_16x16x32_bf16 v[20:23], a[76:79], a[60:63], v[20:23]
ds_read_b128 a[116:119], v37 offset:37888
v_mfma_f32_16x16x32_bf16 v[24:27], a[80:83], a[60:63], v[24:27]
ds_read_b128 a[120:123], v37 offset:38912
v_mfma_f32_16x16x32_bf16 v[28:31], a[84:87], a[60:63], v[28:31]
ds_read_b128 a[124:127], v37 offset:39936
v_mfma_f32_16x16x32_bf16 v[32:35], a[88:91], a[60:63], v[32:35]
ds_read_b128 a[128:131], v38 offset:36864
s_waitcnt vmcnt(1)
s_waitcnt lgkmcnt(5)
v_mfma_f32_16x16x32_bf16 v[16:19], a[92:95], a[64:67], v[16:19]
v_mfma_f32_16x16x32_bf16 v[20:23], a[96:99], a[64:67], v[20:23]
v_mfma_f32_16x16x32_bf16 v[24:27], a[100:103], a[64:67], v[24:27]
v_mfma_f32_16x16x32_bf16 v[28:31], a[104:107], a[64:67], v[28:31]
v_mfma_f32_16x16x32_bf16 v[32:35], a[108:111], a[64:67], v[32:35]
s_waitcnt vmcnt(0)
s_waitcnt lgkmcnt(0)
v_mfma_f32_16x16x32_bf16 v[16:19], a[112:115], a[68:71], v[16:19]
v_mfma_f32_16x16x32_bf16 v[20:23], a[116:119], a[68:71], v[20:23]
v_mfma_f32_16x16x32_bf16 v[24:27], a[120:123], a[68:71], v[24:27]
v_mfma_f32_16x16x32_bf16 v[28:31], a[124:127], a[68:71], v[28:31]
v_mfma_f32_16x16x32_bf16 v[32:35], a[128:131], a[68:71], v[32:35]
s_barrier
s_lshl_b32 s30, s27, 2
s_add_u32 s30, s30, s24
v_mov_b32 v54, 1073741824
s_lshr_b32 s31, s30, 1
s_mul_i32 s31, s31, 36864
s_and_b32 s32, s30, 1
s_lshl_b32 s32, s32, 8
s_add_u32 s31, s31, s32
s_mul_i32 s32, s28, 4608
s_add_u32 s31, s31, s32
s_add_u32 s31, s31, 4849664
v_lshlrev_b32 v56, 4, v2
v_lshl_add_u32 v56, v3, 9, v56
v_add_u32 v57, 4096, v56
v_cndmask_b32 v57, v54, v57, s[46:47]
v_cvt_pk_bf16_f32 v40, v16, v17
v_cvt_pk_bf16_f32 v41, v18, v19
v_cvt_pk_bf16_f32 v42, v20, v21
v_cvt_pk_bf16_f32 v43, v22, v23
v_cvt_pk_bf16_f32 v44, v24, v25
v_cvt_pk_bf16_f32 v45, v26, v27
v_cvt_pk_bf16_f32 v46, v28, v29
v_cvt_pk_bf16_f32 v47, v30, v31
v_cvt_pk_bf16_f32 v48, v32, v33
v_cvt_pk_bf16_f32 v49, v34, v35
buffer_store_dwordx4 v[40:43], v56, s[8:11], s31 offen sc1
buffer_store_dwordx4 v[44:47], v56, s[8:11], s31 offen offset:2048 sc1
v_permlane16_swap_b32 v48, v50
v_permlane16_swap_b32 v49, v51
buffer_store_dwordx4 v[48:51], v57, s[8:11], s31 offen sc1
v_pk_add_f32 v[58:59], v[32:33], v[34:35]
v_pk_mul_f32 v[60:61], v[32:33], v[32:33]
v_pk_fma_f32 v[60:61], v[34:35], v[34:35], v[60:61]
v_cndmask_b32 v58, 0, v58, s[50:51]
v_cndmask_b32 v59, 0, v59, s[50:51]
v_cndmask_b32 v60, 0, v60, s[50:51]
v_cndmask_b32 v61, 0, v61, s[50:51]
v_pk_add_f32 v[58:59], v[58:59], v[16:17]
v_pk_fma_f32 v[60:61], v[16:17], v[16:17], v[60:61]
v_pk_add_f32 v[58:59], v[58:59], v[18:19]
v_pk_fma_f32 v[60:61], v[18:19], v[18:19], v[60:61]
v_pk_add_f32 v[58:59], v[58:59], v[20:21]
v_pk_fma_f32 v[60:61], v[20:21], v[20:21], v[60:61]
v_pk_add_f32 v[58:59], v[58:59], v[22:23]
v_pk_fma_f32 v[60:61], v[22:23], v[22:23], v[60:61]
v_pk_add_f32 v[58:59], v[58:59], v[24:25]
v_pk_fma_f32 v[60:61], v[24:25], v[24:25], v[60:61]
v_pk_add_f32 v[58:59], v[58:59], v[26:27]
v_pk_fma_f32 v[60:61], v[26:27], v[26:27], v[60:61]
v_pk_add_f32 v[58:59], v[58:59], v[28:29]
v_pk_fma_f32 v[60:61], v[28:29], v[28:29], v[60:61]
v_pk_add_f32 v[58:59], v[58:59], v[30:31]
v_pk_fma_f32 v[60:61], v[30:31], v[30:31], v[60:61]
v_add_f32 v52, v58, v59
v_add_f32 v53, v60, v61
s_lshl_b32 s31, s30, 7
s_lshl_b32 s32, s28, 14
v_permlane32_swap_b32 v52, v53
v_add_f32 v52, v52, v53
v_mov_b32 v53, v52
s_add_u32 s31, s31, s32
s_add_u32 s31, s31, 7208960
v_permlane16_swap_b32 v52, v53
v_add_f32 v52, v52, v53
v_mov_b32 v53, v52
v_lshlrev_b32 v55, 3, v2
v_cndmask_b32 v54, v54, v55, s[46:47]
v_permlane32_swap_b32 v52, v53
buffer_store_dwordx2 v[52:53], v54, s[8:11], s31 offen sc1
s_mul_i32 s38, s24, 9216
s_add_u32 m0, s38, 0
s_add_u32 s39, s38, s82
s_add_u32 s39, s39, 75776
buffer_load_dwordx4 v1, s[4:7], s39 offen offset:0  lds
buffer_load_dwordx4 v1, s[4:7], s39 offen offset:1024  lds
buffer_load_dwordx4 v1, s[4:7], s39 offen offset:2048  lds
buffer_load_dwordx4 v1, s[4:7], s39 offen offset:3072  lds
s_add_u32 m0, m0, 4096
s_add_u32 s39, s39, 4096
buffer_load_dwordx4 v1, s[4:7], s39 offen offset:0  lds
buffer_load_dwordx4 v1, s[4:7], s39 offen offset:1024  lds
buffer_load_dwordx4 v1, s[4:7], s39 offen offset:2048  lds
buffer_load_dwordx4 v1, s[4:7], s39 offen offset:3072  lds
s_add_u32 m0, m0, 4096
s_add_u32 s39, s39, 4096
buffer_load_dwordx4 v1, s[4:7], s39 offen offset:0  lds
s_lshl_b32 s38, s24, 8
s_add_u32 m0, s38, 36864
s_add_u32 s39, s38, s82
s_add_u32 s39, s39, 112640
s_mov_b64 exec, 0xffff
buffer_load_dwordx4 v1, s[4:7], s39 offen lds
s_mov_b64 exec, -1
s_waitcnt vmcnt(10)
s_barrier
s_cmp_eq_u32 s24, 0
s_cbranch_scc0 L_sig_4
v_lshlrev_b32 v6, 3, v1
s_lshr_b32 s31, s81, 4
s_lshl_b32 s31, s31, 11
s_and_b32 s32, s81, 15
s_lshl_b32 s32, s32, 2
s_add_u32 s31, s31, s32
v_add_u32 v6, s31, v6
s_mov_b64 exec, 0xffff
s_mov_b32 s30, 26509312
buffer_store_dword v4, v6, s[8:11], s30 offen sc1
s_mov_b64 exec, -1
L_sig_4:
s_mul_i32 s38, s24, 9216
s_add_u32 m0, s38, 37888
s_add_u32 s39, s38, s82
s_add_u32 s39, s39, 113664
buffer_load_dwordx4 v1, s[4:7], s39 offen offset:0  lds
buffer_load_dwordx4 v1, s[4:7], s39 offen offset:1024  lds
buffer_load_dwordx4 v1, s[4:7], s39 offen offset:2048  lds
buffer_load_dwordx4 v1, s[4:7], s39 offen offset:3072  lds
s_add_u32 m0, m0, 4096
s_add_u32 s39, s39, 4096
buffer_load_dwordx4 v1, s[4:7], s39 offen offset:0  lds
buffer_load_dwordx4 v1, s[4:7], s39 offen offset:1024  lds
buffer_load_dwordx4 v1, s[4:7], s39 offen offset:2048  lds
buffer_load_dwordx4 v1, s[4:7], s39 offen offset:3072  lds
s_add_u32 m0, m0, 4096
s_add_u32 s39, s39, 4096
buffer_load_dwordx4 v1, s[4:7], s39 offen offset:0  lds
s_lshl_b32 s38, s24, 8
s_add_u32 m0, s38, 74752
s_add_u32 s39, s38, s82
s_add_u32 s39, s39, 150528
s_mov_b64 exec, 0xffff
buffer_load_dwordx4 v1, s[4:7], s39 offen lds
s_mov_b64 exec, -1
s_cmp_eq_u32 s24, 1
s_cbranch_scc0 L_polled_6
s_lshl_b32 s30, s80, 7
s_add_u32 s30, s30, 26509312
v_lshrrev_b32 v6, 2, v1
s_mov_b32 s31, 0
s_mov_b64 exec, 0xffff
L_poll_5:
buffer_load_dword v7, v6, s[8:11], s30 offen sc1
s_add_u32 s31, s31, 1
s_waitcnt vmcnt(0)
v_cmp_ne_u32 vcc, 1, v7
s_cmp_gt_u32 s31, 200000
s_cbranch_scc1 L_polled_6
s_cbranch_vccnz L_poll_5
L_polled_6:
s_mov_b64 exec, -1
s_waitcnt vmcnt(0)
s_barrier
s_lshl_b32 s60, s25, 2
s_add_u32 s60, s60, s24
s_mul_i32 s62, s60, 36864
s_add_u32 s62, s62, 4849664
buffer_load_dwordx4 a[0:3], v1, s[8:11], s62 offen offset:0 sc1
buffer_load_dwordx4 a[4:7], v1, s[8:11], s62 offen offset:1024 sc1
buffer_load_dwordx4 a[8:11], v1, s[8:11], s62 offen offset:2048 sc1
buffer_load_dwordx4 a[12:15], v1, s[8:11], s62 offen offset:3072 sc1
s_add_u32 s62, s62, 4096
buffer_load_dwordx4 a[16:19], v1, s[8:11], s62 offen offset:0 sc1
buffer_load_dwordx4 a[20:23], v1, s[8:11], s62 offen offset:1024 sc1
buffer_load_dwordx4 a[24:27], v1, s[8:11], s62 offen offset:2048 sc1
buffer_load_dwordx4 a[28:31], v1, s[8:11], s62 offen offset:3072 sc1
s_add_u32 s62, s62, 4096
buffer_load_dwordx4 a[32:35], v1, s[8:11], s62 offen offset:0 sc1
v_lshrrev_b32 v6, 1, v1
v_and_b32 v6, 0xf8, v6
v_lshrrev_b32 v7, 1, v3
v_lshl_add_u32 v232, v7, 16, v6
s_lshl_b32 s63, s60, 8
s_add_u32 s63, s63, 7208960
v_add_u32 v206, 86016, v1
v_add_u32 v207, 123904, v1
v_add_u32 v208, 0, v1
v_add_u32 v209, 37888, v1
ds_read_b128 a[144:147], v206 offset:0
ds_read_b128 a[148:151], v207 offset:0
ds_read_b128 a[152:155], v206 offset:1024
ds_read_b128 a[156:159], v207 offset:1024
ds_read_b128 a[160:163], v206 offset:2048
ds_read_b128 a[164:167], v207 offset:2048
ds_read_b128 a[168:171], v206 offset:3072
s_waitcnt vmcnt(8)
s_waitcnt lgkmcnt(3)
v_mfma_f32_32x32x16_bf16 v[36:51], a[144:147], a[0:3], 0
ds_read_b128 a[172:175], v207 offset:3072
buffer_load_dwordx4 a[36:39], v1, s[8:11], s62 offen offset:1024 sc1
v_mfma_f32_32x32x16_bf16 v[52:67], a[148:151], a[0:3], 0
ds_read_b128 a[144:147], v206 offset:4096
buffer_load_dwordx4 a[40:43], v1, s[8:11], s62 offen offset:2048 sc1
s_waitcnt vmcnt(9)
v_mfma_f32_32x32x16_bf16 v[36:51], a[152:155], a[4:7], v[36:51]
ds_read_b128 a[148:151], v207 offset:4096
buffer_load_dwordx4 a[44:47], v1, s[8:11], s62 offen offset:3072 sc1
s_add_u32 s62, s62, 4096
v_mfma_f32_32x32x16_bf16 v[52:67], a[156:159], a[4:7], v[52:67]
ds_read_b128 a[152:155], v206 offset:5120
s_waitcnt vmcnt(9)
s_waitcnt lgkmcnt(3)
v_mfma_f32_32x32x16_bf16 v[36:51], a[160:163], a[8:11], v[36:51]
ds_read_b128 a[156:159], v207 offset:5120
v_mfma_f32_32x32x16_bf16 v[52:67], a[164:167], a[8:11], v[52:67]
ds_read_b128 a[160:163], v206 offset:6144
buffer_load_dwordx4 a[48:51], v1, s[8:11], s62 offen offset:0 sc1
s_waitcnt vmcnt(9)
v_mfma_f32_32x32x16_bf16 v[36:51], a[168:171], a[12:15], v[36:51]
ds_read_b128 a[164:167], v207 offset:6144
buffer_load_dwordx4 a[52:55], v1, s[8:11], s62 offen offset:1024 sc1
v_mfma_f32_32x32x16_bf16 v[52:67], a[172:175], a[12:15], v[52:67]
ds_read_b128 a[168:171], v206 offset:7168
s_waitcnt vmcnt(9)
s_waitcnt lgkmcnt(3)
v_mfma_f32_32x32x16_bf16 v[36:51], a[144:147], a[16:19], v[36:51]
ds_read_b128 a[172:175], v207 offset:7168
buffer_load_dwordx2 v[180:181], v232, s[8:11], s63 offen sc1
s_add_u32 s63, s63, 16384
v_mfma_f32_32x32x16_bf16 v[52:67], a[148:151], a[16:19], v[52:67]
ds_read_b128 a[144:147], v206 offset:8192
s_waitcnt vmcnt(9)
v_mfma_f32_32x32x16_bf16 v[36:51], a[152:155], a[20:23], v[36:51]
ds_read_b128 a[148:151], v207 offset:8192
buffer_load_dwordx2 v[182:183], v232, s[8:11], s63 offen sc1
s_add_u32 s63, s63, 16384
v_mfma_f32_32x32x16_bf16 v[52:67], a[156:159], a[20:23], v[52:67]
ds_read_b128 a[152:155], v206 offset:9216
s_waitcnt vmcnt(9)
s_waitcnt lgkmcnt(3)
v_mfma_f32_32x32x16_bf16 v[36:51], a[160:163], a[24:27], v[36:51]
ds_read_b128 a[156:159], v207 offset:9216
v_mfma_f32_32x32x16_bf16 v[52:67], a[164:167], a[24:27], v[52:67]
ds_read_b128 a[160:163], v206 offset:10240
buffer_load_dwordx2 v[184:185], v232, s[8:11], s63 offen sc1
s_add_u32 s63, s63, 16384
s_waitcnt vmcnt(9)
v_mfma_f32_32x32x16_bf16 v[36:51], a[168:171], a[28:31], v[36:51]
ds_read_b128 a[164:167], v207 offset:10240
v_mfma_f32_32x32x16_bf16 v[52:67], a[172:175], a[28:31], v[52:67]
ds_read_b128 a[168:171], v206 offset:11264
s_waitcnt vmcnt(8)
s_waitcnt lgkmcnt(3)
v_mfma_f32_32x32x16_bf16 v[36:51], a[144:147], a[32:35], v[36:51]
ds_read_b128 a[172:175], v207 offset:11264
buffer_load_dwordx2 v[186:187], v232, s[8:11], s63 offen sc1
s_add_u32 s63, s63, 16384
v_mfma_f32_32x32x16_bf16 v[52:67], a[148:151], a[32:35], v[52:67]
ds_read_b128 a[144:147], v206 offset:12288
s_waitcnt vmcnt(8)
v_mfma_f32_32x32x16_bf16 v[36:51], a[152:155], a[36:39], v[36:51]
ds_read_b128 a[148:151], v207 offset:12288
buffer_load_dwordx4 a[56:59], v1, s[8:11], s62 offen offset:2048 sc1
v_mfma_f32_32x32x16_bf16 v[52:67], a[156:159], a[36:39], v[52:67]
ds_read_b128 a[152:155], v206 offset:13312
s_waitcnt vmcnt(8)
s_waitcnt lgkmcnt(3)
v_mfma_f32_32x32x16_bf16 v[36:51], a[160:163], a[40:43], v[36:51]
ds_read_b128 a[156:159], v207 offset:13312
buffer_load_dwordx4 a[60:63], v1, s[8:11], s62 offen offset:3072 sc1
s_add_u32 s62, s62, 4096
v_mfma_f32_32x32x16_bf16 v[52:67], a[164:167], a[40:43], v[52:67]
ds_read_b128 a[160:163], v206 offset:14336
s_waitcnt vmcnt(8)
v_mfma_f32_32x32x16_bf16 v[36:51], a[168:171], a[44:47], v[36:51]
ds_read_b128 a[164:167], v207 offset:14336
buffer_load_dwordx4 a[64:67], v1, s[8:11], s62 offen offset:0 sc1
v_mfma_f32_32x32x16_bf16 v[52:67], a[172:175], a[44:47], v[52:67]
ds_read_b128 a[168:171], v206 offset:15360
s_waitcnt vmcnt(8)
s_waitcnt lgkmcnt(3)
v_mfma_f32_32x32x16_bf16 v[36:51], a[144:147], a[48:51], v[36:51]
ds_read_b128 a[172:175], v207 offset:15360
buffer_load_dwordx4 a[68:71], v1, s[8:11], s62 offen offset:1024 sc1
v_mfma_f32_32x32x16_bf16 v[52:67], a[148:151], a[48:51], v[52:67]
ds_read_b128 a[144:147], v206 offset:16384
buffer_load_dwordx4 a[72:75], v1, s[8:11], s62 offen offset:2048 sc1
s_waitcnt vmcnt(9)
v_mfma_f32_32x32x16_bf16 v[36:51], a[152:155], a[52:55], v[36:51]
ds_read_b128 a[148:151], v207 offset:16384
buffer_load_dwordx4 a[76:79], v1, s[8:11], s62 offen offset:3072 sc1
s_add_u32 s62, s62, 4096
v_mfma_f32_32x32x16_bf16 v[52:67], a[156:159], a[52:55], v[52:67]
ds_read_b128 a[152:155], v206 offset:17408
s_waitcnt vmcnt(5)
s_waitcnt lgkmcnt(3)
v_mfma_f32_32x32x16_bf16 v[36:51], a[160:163], a[56:59], v[36:51]
ds_read_b128 a[156:159], v207 offset:17408
v_mfma_f32_32x32x16_bf16 v[52:67], a[164:167], a[56:59], v[52:67]
ds_read_b128 a[160:163], v206 offset:18432
buffer_load_dwordx4 a[80:83], v1, s[8:11], s62 offen offset:0 sc1
s_waitcnt vmcnt(5)
v_mfma_f32_32x32x16_bf16 v[36:51], a[168:171], a[60:63], v[36:51]
ds_read_b128 a[164:167], v207 offset:18432
buffer_load_dwordx4 a[84:87], v1, s[8:11], s62 offen offset:1024 sc1
v_mfma_f32_32x32x16_bf16 v[52:67], a[172:175], a[60:63], v[52:67]
ds_read_b128 a[168:171], v206 offset:19456
s_waitcnt vmcnt(5)
s_waitcnt lgkmcnt(3)
v_mfma_f32_32x32x16_bf16 v[36:51], a[144:147], a[64:67], v[36:51]
ds_read_b128 a[172:175], v207 offset:19456
buffer_load_dwordx4 a[88:91], v1, s[8:11], s62 offen offset:2048 sc1
v_mfma_f32_32x32x16_bf16 v[52:67], a[148:151], a[64:67], v[52:67]
ds_read_b128 a[144:147], v206 offset:20480
buffer_load_dwordx4 a[92:95], v1, s[8:11], s62 offen offset:3072 sc1
s_add_u32 s62, s62, 4096
s_waitcnt vmcnt(6)
v_mfma_f32_32x32x16_bf16 v[36:51], a[152:155], a[68:71], v[36:51]
ds_read_b128 a[148:151], v207 offset:20480
v_mfma_f32_32x32x16_bf16 v[52:67], a[156:159], a[68:71], v[52:67]
ds_read_b128 a[152:155], v206 offset:21504
s_waitcnt vmcnt(5)
s_waitcnt lgkmcnt(3)
v_mfma_f32_32x32x16_bf16 v[36:51], a[160:163], a[72:75], v[36:51]
ds_read_b128 a[156:159], v207 offset:21504
buffer_load_dwordx4 a[96:99], v1, s[8:11], s62 offen offset:0 sc1
v_mfma_f32_32x32x16_bf16 v[52:67], a[164:167], a[72:75], v[52:67]
ds_read_b128 a[160:163], v206 offset:22528
buffer_load_dwordx4 a[100:103], v1, s[8:11], s62 offen offset:1024 sc1
s_waitcnt vmcnt(6)
v_mfma_f32_32x32x16_bf16 v[36:51], a[168:171], a[76:79], v[36:51]
ds_read_b128 a[164:167], v207 offset:22528
buffer_load_dwordx4 a[104:107], v1, s[8:11], s62 offen offset:2048 sc1
v_mfma_f32_32x32x16_bf16 v[52:67], a[172:175], a[76:79], v[52:67]
ds_read_b128 a[168:171], v206 offset:23552
s_waitcnt vmcnt(6)
s_waitcnt lgkmcnt(3)
v_mfma_f32_32x32x16_bf16 v[36:51], a[144:147], a[80:83], v[36:51]
ds_read_b128 a[172:175], v207 offset:23552
buffer_load_dwordx4 a[108:111], v1, s[8:11], s62 offen offset:3072 sc1
s_add_u32 s62, s62, 4096
v_add_f32 v196, v180, v182
v_mfma_f32_32x32x16_bf16 v[52:67], a[148:151], a[80:83], v[52:67]
ds_read_b128 a[144:147], v206 offset:24576
v_add_f32 v197, v181, v183
s_waitcnt vmcnt(6)
v_mfma_f32_32x32x16_bf16 v[36:51], a[152:155], a[84:87], v[36:51]
ds_read_b128 a[148:151], v207 offset:24576
buffer_load_dwordx4 a[112:115], v1, s[8:11], s62 offen offset:0 sc1
v_add_f32 v196, v196, v184
v_mfma_f32_32x32x16_bf16 v[52:67], a[156:159], a[84:87], v[52:67]
ds_read_b128 a[152:155], v206 offset:25600
v_add_f32 v197, v197, v185
s_waitcnt vmcnt(6)
s_waitcnt lgkmcnt(3)
v_mfma_f32_32x32x16_bf16 v[36:51], a[160:163], a[88:91], v[36:51]
ds_read_b128 a[156:159], v207 offset:25600
buffer_load_dwordx4 a[116:119], v1, s[8:11], s62 offen offset:1024 sc1
v_add_f32 v196, v196, v186
v_add_f32 v197, v197, v187
v_mfma_f32_32x32x16_bf16 v[52:67], a[164:167], a[88:91], v[52:67]
ds_read_b128 a[160:163], v206 offset:26624
buffer_load_dwordx4 a[120:123], v1, s[8:11], s62 offen offset:2048 sc1
v_mov_b32 v198, v196
s_waitcnt vmcnt(7)
v_mfma_f32_32x32x16_bf16 v[36:51], a[168:171], a[92:95], v[36:51]
ds_read_b128 a[164:167], v207 offset:26624
buffer_load_dwordx4 a[124:127], v1, s[8:11], s62 offen offset:3072 sc1
s_add_u32 s62, s62, 4096
v_mov_b32 v199, v197
v_mfma_f32_32x32x16_bf16 v[52:67], a[172:175], a[92:95], v[52:67]
ds_read_b128 a[168:171], v206 offset:27648
v_mov_b32 v204, 0
s_waitcnt vmcnt(7)
s_waitcnt lgkmcnt(3)
v_mfma_f32_32x32x16_bf16 v[36:51], a[144:147], a[96:99], v[36:51]
ds_read_b128 a[172:175], v207 offset:27648
v_mov_b32 v205, 0
v_permlane32_swap_b32 v196, v198
v_mfma_f32_32x32x16_bf16 v[52:67], a[148:151], a[96:99], v[52:67]
ds_read_b128 a[144:147], v206 offset:28672
buffer_load_dwordx4 a[128:131], v1, s[8:11], s62 offen offset:0 sc1
s_waitcnt vmcnt(7)
v_mfma_f32_32x32x16_bf16 v[36:51], a[152:155], a[100:103], v[36:51]
ds_read_b128 a[148:151], v207 offset:28672
buffer_load_dwordx4 a[132:135], v1, s[8:11], s62 offen offset:1024 sc1
v_permlane32_swap_b32 v197, v199
v_mfma_f32_32x32x16_bf16 v[52:67], a[156:159], a[100:103], v[52:67]
ds_read_b128 a[152:155], v206 offset:29696
s_waitcnt vmcnt(7)
s_waitcnt lgkmcnt(3)
v_mfma_f32_32x32x16_bf16 v[36:51], a[160:163], a[104:107], v[36:51]
ds_read_b128 a[156:159], v207 offset:29696
buffer_load_dwordx4 a[136:139], v1, s[8:11], s62 offen offset:2048 sc1
v_add_f32 v196, v196, v198
v_mfma_f32_32x32x16_bf16 v[52:67], a[164:167], a[104:107], v[52:67]
ds_read_b128 a[160:163], v206 offset:30720
buffer_load_dwordx4 a[140:143], v1, s[8:11], s62 offen offset:3072 sc1
v_add_f32 v197, v197, v199
v_mul_f32 v196, 0x3ae38e39, v196
s_waitcnt vmcnt(8)
v_mfma_f32_32x32x16_bf16 v[36:51], a[168:171], a[108:111], v[36:51]
ds_read_b128 a[164:167], v207 offset:30720
v_mul_f32 v198, v196, v196
v_mfma_f32_32x32x16_bf16 v[52:67], a[172:175], a[108:111], v[52:67]
ds_read_b128 a[168:171], v206 offset:31744
v_mul_f32 v197, 0x3ae38e39, v197
s_waitcnt vmcnt(7)
s_waitcnt lgkmcnt(3)
v_mfma_f32_32x32x16_bf16 v[36:51], a[144:147], a[112:115], v[36:51]
ds_read_b128 a[172:175], v207 offset:31744
v_sub_f32 v197, v197, v198
v_mfma_f32_32x32x16_bf16 v[52:67], a[148:151], a[112:115], v[52:67]
ds_read_b128 a[144:147], v206 offset:32768
v_max_f32 v197, 0, v197
v_add_f32 v197, 0x3727c5ac, v197
s_waitcnt vmcnt(6)
v_mfma_f32_32x32x16_bf16 v[36:51], a[152:155], a[116:119], v[36:51]
ds_read_b128 a[148:151], v207 offset:32768
v_rsq_f32 v253, v197
v_mfma_f32_32x32x16_bf16 v[52:67], a[156:159], a[116:119], v[52:67]
ds_read_b128 a[152:155], v206 offset:33792
s_waitcnt vmcnt(5)
s_waitcnt lgkmcnt(3)
v_mfma_f32_32x32x16_bf16 v[36:51], a[160:163], a[120:123], v[36:51]
ds_read_b128 a[156:159], v207 offset:33792
v_sqrt_f32 v255, v197
v_mfma_f32_32x32x16_bf16 v[52:67], a[164:167], a[120:123], v[52:67]
ds_read_b128 a[160:163], v206 offset:34816
s_waitcnt vmcnt(4)
v_mfma_f32_32x32x16_bf16 v[36:51], a[168:171], a[124:127], v[36:51]
ds_read_b128 a[164:167], v207 offset:34816
v_cvt_pk_bf16_f32 v198, -v196, -v196
v_and_b32 v198, 0xffff0000, v198
v_mfma_f32_32x32x16_bf16 v[52:67], a[172:175], a[124:127], v[52:67]
ds_read_b128 a[168:171], v206 offset:35840
v_add_f32 v198, v196, v198
s_waitcnt vmcnt(3)
s_waitcnt lgkmcnt(3)
v_mfma_f32_32x32x16_bf16 v[36:51], a[144:147], a[128:131], v[36:51]
ds_read_b128 a[172:175], v207 offset:35840
v_cvt_pk_bf16_f32 v212, -v196, -v198
v_mfma_f32_32x32x16_bf16 v[52:67], a[148:151], a[128:131], v[52:67]
ds_read_b128 a[144:147], v206 offset:36864
v_mov_b32 v213, v212
s_waitcnt vmcnt(2)
v_mfma_f32_32x32x16_bf16 v[36:51], a[152:155], a[132:135], v[36:51]
ds_read_b128 a[148:151], v207 offset:36864
v_mov_b32 v214, v212
v_mov_b32 v215, v212
v_mfma_f32_32x32x16_bf16 v[52:67], a[156:159], a[132:135], v[52:67]
ds_read_b128 a[152:155], v208 offset:0
v_mul_f32 v254, v253, v253
s_waitcnt vmcnt(1)
s_waitcnt lgkmcnt(3)
v_mfma_f32_32x32x16_bf16 v[36:51], a[160:163], a[136:139], v[36:51]
ds_read_b128 a[156:159], v208 offset:1024
v_mul_f32 v254, v254, v253
v_mfma_f32_32x32x16_bf16 v[52:67], a[164:167], a[136:139], v[52:67]
ds_read_b128 a[160:163], v208 offset:2048
v_mul_f32 v254, 0xbdd2d3e8, v254
s_waitcnt vmcnt(0)
v_mfma_f32_32x32x16_bf16 v[36:51], a[168:171], a[140:143], v[36:51]
ds_read_b128 a[164:167], v208 offset:3072
v_mul_f32 v253, 0xc0135761, v253
v_mfma_f32_32x32x16_bf16 v[52:67], a[172:175], a[140:143], v[52:67]
ds_read_b128 a[168:171], v208 offset:4096
s_waitcnt lgkmcnt(3)
v_mfma_f32_32x32x16_bf16 v[36:51], a[144:147], v[212:215], v[36:51]
ds_read_b128 a[172:175], v208 offset:5120
v_mfma_f32_32x32x16_bf16 v[52:67], a[148:151], v[212:215], v[52:67]
ds_read_b128 a[144:147], v208 offset:6144
s_barrier
v_mfma_f32_32x32x16_bf16 v[68:83], a[152:155], a[0:3], 0
ds_read_b128 a[148:151], v208 offset:7168
s_mul_i32 s38, s24, 9216
s_add_u32 m0, s38, 86016
v_mfma_f32_32x32x16_bf16 v[68:83], a[156:159], a[4:7], v[68:83]
ds_read_b128 a[152:155], v208 offset:8192
s_add_u32 s39, s38, s82
s_waitcnt lgkmcnt(3)
v_mfma_f32_32x32x16_bf16 v[68:83], a[160:163], a[8:11], v[68:83]
ds_read_b128 a[156:159], v208 offset:9216
s_add_u32 s39, s39, 151552
v_mfma_f32_32x32x16_bf16 v[68:83], a[164:167], a[12:15], v[68:83]
ds_read_b128 a[160:163], v208 offset:10240
buffer_load_dwordx4 v1, s[4:7], s39 offen offset:0  lds
v_mul_f32 v196, v36, v36
v_mul_f32 v197, v37, v37
v_mul_f32 v198, v38, v38
v_mul_f32 v199, v39, v39
v_mfma_f32_32x32x16_bf16 v[68:83], a[168:171], a[16:19], v[68:83]
ds_read_b128 a[164:167], v208 offset:11264
buffer_load_dwordx4 v1, s[4:7], s39 offen offset:1024  lds
v_fma_f32 v196, v196, v254, v253
v_fma_f32 v197, v197, v254, v253
v_fma_f32 v198, v198, v254, v253
v_fma_f32 v199, v199, v254, v253
v_mfma_f32_32x32x16_bf16 v[68:83], a[172:175], a[20:23], v[68:83]
ds_read_b128 a[168:171], v208 offset:12288
buffer_load_dwordx4 v1, s[4:7], s39 offen offset:2048  lds
v_mul_f32 v196, v196, v36
v_mul_f32 v197, v197, v37
v_mul_f32 v198, v198, v38
s_waitcnt lgkmcnt(3)
v_mfma_f32_32x32x16_bf16 v[68:83], a[144:147], a[24:27], v[68:83]
ds_read_b128 a[172:175], v208 offset:13312
buffer_load_dwordx4 v1, s[4:7], s39 offen offset:3072  lds
s_add_u32 m0, m0, 4096
s_add_u32 s39, s39, 4096
v_mul_f32 v199, v199, v39
v_exp_f32 v196, v196
v_mfma_f32_32x32x16_bf16 v[68:83], a[148:151], a[28:31], v[68:83]
ds_read_b128 a[144:147], v208 offset:14336
buffer_load_dwordx4 v1, s[4:7], s39 offen offset:0  lds
v_exp_f32 v197, v197
v_exp_f32 v198, v198
v_mfma_f32_32x32x16_bf16 v[68:83], a[152:155], a[32:35], v[68:83]
ds_read_b128 a[148:151], v208 offset:15360
buffer_load_dwordx4 v1, s[4:7], s39 offen offset:1024  lds
v_exp_f32 v199, v199
v_fma_f32 v196, v196, v255, v255
v_fma_f32 v197, v197, v255, v255
v_mfma_f32_32x32x16_bf16 v[68:83], a[156:159], a[36:39], v[68:83]
ds_read_b128 a[152:155], v208 offset:16384
buffer_load_dwordx4 v1, s[4:7], s39 offen offset:2048  lds
v_fma_f32 v198, v198, v255, v255
v_fma_f32 v199, v199, v255, v255
s_waitcnt lgkmcnt(3)
v_mfma_f32_32x32x16_bf16 v[68:83], a[160:163], a[40:43], v[68:83]
ds_read_b128 a[156:159], v208 offset:17408
buffer_load_dwordx4 v1, s[4:7], s39 offen offset:3072  lds
s_add_u32 m0, m0, 4096
s_add_u32 s39, s39, 4096
v_rcp_f32 v196, v196
v_mfma_f32_32x32x16_bf16 v[68:83], a[164:167], a[44:47], v[68:83]
ds_read_b128 a[160:163], v208 offset:18432
buffer_load_dwordx4 v1, s[4:7], s39 offen offset:0  lds
s_lshl_b32 s38, s24, 8
v_rcp_f32 v197, v197
v_rcp_f32 v198, v198
v_mfma_f32_32x32x16_bf16 v[68:83], a[168:171], a[48:51], v[68:83]
ds_read_b128 a[164:167], v208 offset:19456
s_add_u32 m0, s38, 122880
v_rcp_f32 v199, v199
v_mul_f32 v36, v36, v196
v_mul_f32 v37, v37, v197
v_mul_f32 v38, v38, v198
v_mfma_f32_32x32x16_bf16 v[68:83], a[172:175], a[52:55], v[68:83]
ds_read_b128 a[168:171], v208 offset:20480
s_add_u32 s39, s38, s82
v_mul_f32 v39, v39, v199
v_add_f32 v204, v204, v36
v_fmac_f32 v205, v36, v36
v_add_f32 v204, v204, v37
s_waitcnt lgkmcnt(3)
v_mfma_f32_32x32x16_bf16 v[68:83], a[144:147], a[56:59], v[68:83]
ds_read_b128 a[172:175], v208 offset:21504
s_add_u32 s39, s39, 188416
v_fmac_f32 v205, v37, v37
v_add_f32 v204, v204, v38
v_fmac_f32 v205, v38, v38
v_add_f32 v204, v204, v39
v_fmac_f32 v205, v39, v39
v_mfma_f32_32x32x16_bf16 v[68:83], a[148:151], a[60:63], v[68:83]
ds_read_b128 a[144:147], v208 offset:22528
s_mov_b64 exec, 0xffff
buffer_load_dwordx4 v1, s[4:7], s39 offen lds
s_mov_b64 exec, -1
s_mul_i32 s38, s24, 9216
v_mul_f32 v200, v40, v40
v_mul_f32 v201, v41, v41
v_mfma_f32_32x32x16_bf16 v[68:83], a[152:155], a[64:67], v[68:83]
ds_read_b128 a[148:151], v208 offset:23552
s_add_u32 m0, s38, 123904
v_mul_f32 v202, v42, v42
v_mul_f32 v203, v43, v43
v_fma_f32 v200, v200, v254, v253
v_fma_f32 v201, v201, v254, v253
v_fma_f32 v202, v202, v254, v253
v_mfma_f32_32x32x16_bf16 v[68:83], a[156:159], a[68:71], v[68:83]
ds_read_b128 a[152:155], v208 offset:24576
s_add_u32 s39, s38, s82
v_fma_f32 v203, v203, v254, v253
v_mul_f32 v200, v200, v40
v_mul_f32 v201, v201, v41
v_mul_f32 v202, v202, v42
s_waitcnt lgkmcnt(3)
v_mfma_f32_32x32x16_bf16 v[68:83], a[160:163], a[72:75], v[68:83]
ds_read_b128 a[156:159], v208 offset:25600
s_add_u32 s39, s39, 189440
v_mul_f32 v203, v203, v43
v_exp_f32 v200, v200
v_exp_f32 v201, v201
v_mfma_f32_32x32x16_bf16 v[68:83], a[164:167], a[76:79], v[68:83]
ds_read_b128 a[160:163], v208 offset:26624
v_exp_f32 v202, v202
v_exp_f32 v203, v203
v_fma_f32 v200, v200, v255, v255
v_mfma_f32_32x32x16_bf16 v[68:83], a[168:171], a[80:83], v[68:83]
ds_read_b128 a[164:167], v208 offset:27648
buffer_load_dwordx4 v1, s[4:7], s39 offen offset:0  lds
v_fma_f32 v201, v201, v255, v255
v_fma_f32 v202, v202, v255, v255
v_fma_f32 v203, v203, v255, v255
v_mfma_f32_32x32x16_bf16 v[68:83], a[172:175], a[84:87], v[68:83]
ds_read_b128 a[168:171], v208 offset:28672
buffer_load_dwordx4 v1, s[4:7], s39 offen offset:1024  lds
v_rcp_f32 v200, v200
s_waitcnt lgkmcnt(3)
v_mfma_f32_32x32x16_bf16 v[68:83], a[144:147], a[88:91], v[68:83]
ds_read_b128 a[172:175], v208 offset:29696
buffer_load_dwordx4 v1, s[4:7], s39 offen offset:2048  lds
v_rcp_f32 v201, v201
v_rcp_f32 v202, v202
v_mfma_f32_32x32x16_bf16 v[68:83], a[148:151], a[92:95], v[68:83]
ds_read_b128 a[144:147], v208 offset:30720
buffer_load_dwordx4 v1, s[4:7], s39 offen offset:3072  lds
s_add_u32 m0, m0, 4096
v_rcp_f32 v203, v203
v_mul_f32 v40, v40, v200
v_mul_f32 v41, v41, v201
v_mfma_f32_32x32x16_bf16 v[68:83], a[152:155], a[96:99], v[68:83]
ds_read_b128 a[148:151], v208 offset:31744
s_add_u32 s39, s39, 4096
v_mul_f32 v42, v42, v202
v_mul_f32 v43, v43, v203
v_add_f32 v204, v204, v40
v_fmac_f32 v205, v40, v40
v_add_f32 v204, v204, v41
v_mfma_f32_32x32x16_bf16 v[68:83], a[156:159], a[100:103], v[68:83]
ds_read_b128 a[152:155], v208 offset:32768
buffer_load_dwordx4 v1, s[4:7], s39 offen offset:0  lds
v_fmac_f32 v205, v41, v41
v_add_f32 v204, v204, v42
v_fmac_f32 v205, v42, v42
s_waitcnt lgkmcnt(3)
v_mfma_f32_32x32x16_bf16 v[68:83], a[160:163], a[104:107], v[68:83]
ds_read_b128 a[156:159], v208 offset:33792
buffer_load_dwordx4 v1, s[4:7], s39 offen offset:1024  lds
v_add_f32 v204, v204, v43
v_fmac_f32 v205, v43, v43
v_mul_f32 v196, v44, v44
v_mul_f32 v197, v45, v45
v_mfma_f32_32x32x16_bf16 v[68:83], a[164:167], a[108:111], v[68:83]
ds_read_b128 a[160:163], v208 offset:34816
buffer_load_dwordx4 v1, s[4:7], s39 offen offset:2048  lds
v_mul_f32 v198, v46, v46
v_mul_f32 v199, v47, v47
v_fma_f32 v196, v196, v254, v253
v_fma_f32 v197, v197, v254, v253
v_mfma_f32_32x32x16_bf16 v[68:83], a[168:171], a[112:115], v[68:83]
ds_read_b128 a[164:167], v208 offset:35840
buffer_load_dwordx4 v1, s[4:7], s39 offen offset:3072  lds
s_add_u32 m0, m0, 4096
s_add_u32 s39, s39, 4096
v_fma_f32 v198, v198, v254, v253
v_fma_f32 v199, v199, v254, v253
v_mul_f32 v196, v196, v44
v_mfma_f32_32x32x16_bf16 v[68:83], a[172:175], a[116:119], v[68:83]
ds_read_b128 a[168:171], v208 offset:36864
buffer_load_dwordx4 v1, s[4:7], s39 offen offset:0  lds
s_lshl_b32 s38, s24, 8
v_mul_f32 v197, v197, v45
v_mul_f32 v198, v198, v46
v_mul_f32 v199, v199, v47
s_waitcnt lgkmcnt(3)
v_mfma_f32_32x32x16_bf16 v[68:83], a[144:147], a[120:123], v[68:83]
ds_read_b128 a[172:175], v209 offset:0
s_add_u32 m0, s38, 160768
v_exp_f32 v196, v196
v_exp_f32 v197, v197
v_mfma_f32_32x32x16_bf16 v[68:83], a[148:151], a[124:127], v[68:83]
ds_read_b128 a[144:147], v209 offset:1024
s_add_u32 s39, s38, s82
v_exp_f32 v198, v198
v_exp_f32 v199, v199
v_fma_f32 v196, v196, v255, v255
v_mfma_f32_32x32x16_bf16 v[68:83], a[152:155], a[128:131], v[68:83]
ds_read_b128 a[148:151], v209 offset:2048
s_add_u32 s39, s39, 226304
v_fma_f32 v197, v197, v255, v255
v_fma_f32 v198, v198, v255, v255
v_fma_f32 v199, v199, v255, v255
v_rcp_f32 v196, v196
v_mfma_f32_32x32x16_bf16 v[68:83], a[156:159], a[132:135], v[68:83]
ds_read_b128 a[152:155], v209 offset:3072
s_mov_b64 exec, 0xffff
buffer_load_dwordx4 v1, s[4:7], s39 offen lds
s_mov_b64 exec, -1
s_waitcnt lgkmcnt(3)
v_mfma_f32_32x32x16_bf16 v[68:83], a[160:163], a[136:139], v[68:83]
ds_read_b128 a[156:159], v209 offset:4096
v_rcp_f32 v197, v197
v_rcp_f32 v198, v198
v_mfma_f32_32x32x16_bf16 v[68:83], a[164:167], a[140:143], v[68:83]
ds_read_b128 a[160:163], v209 offset:5120
v_rcp_f32 v199, v199
v_mul_f32 v44, v44, v196
v_mul_f32 v45, v45, v197
v_mul_f32 v46, v46, v198
v_mfma_f32_32x32x16_bf16 v[68:83], a[168:171], v[212:215], v[68:83]
ds_read_b128 a[164:167], v209 offset:6144
v_mul_f32 v47, v47, v199
v_add_f32 v204, v204, v44
v_fmac_f32 v205, v44, v44
s_waitcnt vmcnt(10)
s_barrier
v_mfma_f32_32x32x16_bf16 v[84:99], a[172:175], a[0:3], 0
ds_read_b128 a[168:171], v209 offset:7168
s_mul_i32 s38, s24, 9216
v_add_f32 v204, v204, v45
v_fmac_f32 v205, v45, v45
v_add_f32 v204, v204, v46
v_fmac_f32 v205, v46, v46
s_waitcnt lgkmcnt(3)
v_mfma_f32_32x32x16_bf16 v[84:99], a[144:147], a[4:7], v[84:99]
ds_read_b128 a[172:175], v209 offset:8192
s_add_u32 m0, s38, 0
v_add_f32 v204, v204, v47
v_fmac_f32 v205, v47, v47
v_mul_f32 v200, v48, v48
v_mul_f32 v201, v49, v49
v_mul_f32 v202, v50, v50
v_mfma_f32_32x32x16_bf16 v[84:99], a[148:151], a[8:11], v[84:99]
ds_read_b128 a[144:147], v209 offset:9216
s_add_u32 s39, s38, s82
v_mul_f32 v203, v51, v51
v_fma_f32 v200, v200, v254, v253
v_fma_f32 v201, v201, v254, v253
v_fma_f32 v202, v202, v254, v253
v_fma_f32 v203, v203, v254, v253
v_mfma_f32_32x32x16_bf16 v[84:99], a[152:155], a[12:15], v[84:99]
ds_read_b128 a[148:151], v209 offset:10240
s_add_u32 s39, s39, 227328
v_mul_f32 v200, v200, v48
v_mul_f32 v201, v201, v49
v_mul_f32 v202, v202, v50
v_mul_f32 v203, v203, v51
v_mfma_f32_32x32x16_bf16 v[84:99], a[156:159], a[16:19], v[84:99]
ds_read_b128 a[152:155], v209 offset:11264
v_exp_f32 v200, v200
v_exp_f32 v201, v201
s_waitcnt lgkmcnt(3)
v_mfma_f32_32x32x16_bf16 v[84:99], a[160:163], a[20:23], v[84:99]
ds_read_b128 a[156:159], v209 offset:12288
buffer_load_dwordx4 v1, s[4:7], s39 offen offset:0  lds
v_exp_f32 v202, v202
v_exp_f32 v203, v203
v_mfma_f32_32x32x16_bf16 v[84:99], a[164:167], a[24:27], v[84:99]
ds_read_b128 a[160:163], v209 offset:13312
v_fma_f32 v200, v200, v255, v255
v_fma_f32 v201, v201, v255, v255
v_fma_f32 v202, v202, v255, v255
v_fma_f32 v203, v203, v255, v255
v_mfma_f32_32x32x16_bf16 v[84:99], a[168:171], a[28:31], v[84:99]
ds_read_b128 a[164:167], v209 offset:14336
buffer_load_dwordx4 v1, s[4:7], s39 offen offset:1024  lds
v_rcp_f32 v200, v200
v_rcp_f32 v201, v201
v_mfma_f32_32x32x16_bf16 v[84:99], a[172:175], a[32:35], v[84:99]
ds_read_b128 a[168:171], v209 offset:15360
buffer_load_dwordx4 v1, s[4:7], s39 offen offset:2048  lds
v_rcp_f32 v202, v202
s_waitcnt lgkmcnt(3)
v_mfma_f32_32x32x16_bf16 v[84:99], a[144:147], a[36:39], v[84:99]
ds_read_b128 a[172:175], v209 offset:16384
v_rcp_f32 v203, v203
v_mul_f32 v48, v48, v200
v_mul_f32 v49, v49, v201
v_mul_f32 v50, v50, v202
v_mfma_f32_32x32x16_bf16 v[84:99], a[148:151], a[40:43], v[84:99]
ds_read_b128 a[144:147], v209 offset:17408
buffer_load_dwordx4 v1, s[4:7], s39 offen offset:3072  lds
s_add_u32 m0, m0, 4096
v_mul_f32 v51, v51, v203
v_add_f32 v204, v204, v48
v_fmac_f32 v205, v48, v48
v_add_f32 v204, v204, v49
v_mfma_f32_32x32x16_bf16 v[84:99], a[152:155], a[44:47], v[84:99]
ds_read_b128 a[148:151], v209 offset:18432
s_add_u32 s39, s39, 4096
v_fmac_f32 v205, v49, v49
v_add_f32 v204, v204, v50
v_fmac_f32 v205, v50, v50
v_add_f32 v204, v204, v51
v_fmac_f32 v205, v51, v51
v_mfma_f32_32x32x16_bf16 v[84:99], a[156:159], a[48:51], v[84:99]
ds_read_b128 a[152:155], v209 offset:19456
v_mul_f32 v196, v52, v52
v_mul_f32 v197, v53, v53
v_mul_f32 v198, v54, v54
v_mul_f32 v199, v55, v55
s_waitcnt lgkmcnt(3)
v_mfma_f32_32x32x16_bf16 v[84:99], a[160:163], a[52:55], v[84:99]
ds_read_b128 a[156:159], v209 offset:20480
v_fma_f32 v196, v196, v254, v253
v_fma_f32 v197, v197, v254, v253
v_fma_f32 v198, v198, v254, v253
v_fma_f32 v199, v199, v254, v253
v_mul_f32 v196, v196, v52
v_mfma_f32_32x32x16_bf16 v[84:99], a[164:167], a[56:59], v[84:99]
ds_read_b128 a[160:163], v209 offset:21504
buffer_load_dwordx4 v1, s[4:7], s39 offen offset:0  lds
v_mul_f32 v197, v197, v53
v_mul_f32 v198, v198, v54
v_mul_f32 v199, v199, v55
v_mfma_f32_32x32x16_bf16 v[84:99], a[168:171], a[60:63], v[84:99]
ds_read_b128 a[164:167], v209 offset:22528
v_exp_f32 v196, v196
v_exp_f32 v197, v197
v_mfma_f32_32x32x16_bf16 v[84:99], a[172:175], a[64:67], v[84:99]
ds_read_b128 a[168:171], v209 offset:23552
buffer_load_dwordx4 v1, s[4:7], s39 offen offset:1024  lds
v_exp_f32 v198, v198
s_waitcnt lgkmcnt(3)
v_mfma_f32_32x32x16_bf16 v[84:99], a[144:147], a[68:71], v[84:99]
ds_read_b128 a[172:175], v209 offset:24576
buffer_load_dwordx4 v1, s[4:7], s39 offen offset:2048  lds
v_exp_f32 v199, v199
v_fma_f32 v196, v196, v255, v255
v_fma_f32 v197, v197, v255, v255
v_mfma_f32_32x32x16_bf16 v[84:99], a[148:151], a[72:75], v[84:99]
ds_read_b128 a[144:147], v209 offset:25600
buffer_load_dwordx4 v1, s[4:7], s39 offen offset:3072  lds
s_add_u32 m0, m0, 4096
v_fma_f32 v198, v198, v255, v255
v_fma_f32 v199, v199, v255, v255
v_rcp_f32 v196, v196
v_mfma_f32_32x32x16_bf16 v[84:99], a[152:155], a[76:79], v[84:99]
ds_read_b128 a[148:151], v209 offset:26624
s_add_u32 s39, s39, 4096
v_rcp_f32 v197, v197
v_rcp_f32 v198, v198
v_mfma_f32_32x32x16_bf16 v[84:99], a[156:159], a[80:83], v[84:99]
ds_read_b128 a[152:155], v209 offset:27648
v_rcp_f32 v199, v199
v_mul_f32 v52, v52, v196
v_mul_f32 v53, v53, v197
s_waitcnt lgkmcnt(3)
v_mfma_f32_32x32x16_bf16 v[84:99], a[160:163], a[84:87], v[84:99]
ds_read_b128 a[156:159], v209 offset:28672
v_mul_f32 v54, v54, v198
v_mul_f32 v55, v55, v199
v_add_f32 v204, v204, v52
v_fmac_f32 v205, v52, v52
v_add_f32 v204, v204, v53
v_mfma_f32_32x32x16_bf16 v[84:99], a[164:167], a[88:91], v[84:99]
ds_read_b128 a[160:163], v209 offset:29696
v_fmac_f32 v205, v53, v53
v_add_f32 v204, v204, v54
v_fmac_f32 v205, v54, v54
v_add_f32 v204, v204, v55
v_fmac_f32 v205, v55, v55
v_mfma_f32_32x32x16_bf16 v[84:99], a[168:171], a[92:95], v[84:99]
ds_read_b128 a[164:167], v209 offset:30720
buffer_load_dwordx4 v1, s[4:7], s39 offen offset:0  lds
s_lshl_b32 s38, s24, 8
v_mul_f32 v200, v56, v56
v_mul_f32 v201, v57, v57
v_mul_f32 v202, v58, v58
v_mul_f32 v203, v59, v59
v_mfma_f32_32x32x16_bf16 v[84:99], a[172:175], a[96:99], v[84:99]
ds_read_b128 a[168:171], v209 offset:31744
s_add_u32 m0, s38, 36864
v_fma_f32 v200, v200, v254, v253
v_fma_f32 v201, v201, v254, v253
v_fma_f32 v202, v202, v254, v253
v_fma_f32 v203, v203, v254, v253
s_waitcnt lgkmcnt(3)
v_mfma_f32_32x32x16_bf16 v[84:99], a[144:147], a[100:103], v[84:99]
ds_read_b128 a[172:175], v209 offset:32768
s_add_u32 s39, s38, s82
v_mul_f32 v200, v200, v56
v_mul_f32 v201, v201, v57
v_mul_f32 v202, v202, v58
v_mul_f32 v203, v203, v59
v_mfma_f32_32x32x16_bf16 v[84:99], a[148:151], a[104:107], v[84:99]
ds_read_b128 a[144:147], v209 offset:33792
s_add_u32 s39, s39, 264192
v_exp_f32 v200, v200
v_exp_f32 v201, v201
v_mfma_f32_32x32x16_bf16 v[84:99], a[152:155], a[108:111], v[84:99]
ds_read_b128 a[148:151], v209 offset:34816
v_exp_f32 v202, v202
v_exp_f32 v203, v203
v_mfma_f32_32x32x16_bf16 v[84:99], a[156:159], a[112:115], v[84:99]
ds_read_b128 a[152:155], v209 offset:35840
v_fma_f32 v200, v200, v255, v255
v_fma_f32 v201, v201, v255, v255
v_fma_f32 v202, v202, v255, v255
s_waitcnt lgkmcnt(3)
v_mfma_f32_32x32x16_bf16 v[84:99], a[160:163], a[116:119], v[84:99]
ds_read_b128 a[156:159], v209 offset:36864
v_fma_f32 v203, v203, v255, v255
v_rcp_f32 v200, v200
v_rcp_f32 v201, v201
v_mfma_f32_32x32x16_bf16 v[84:99], a[164:167], a[120:123], v[84:99]
ds_read_b128 a[160:163], v206 offset:0
s_mov_b64 exec, 0xffff
buffer_load_dwordx4 v1, s[4:7], s39 offen lds
s_mov_b64 exec, -1
v_rcp_f32 v202, v202
v_mfma_f32_32x32x16_bf16 v[84:99], a[168:171], a[124:127], v[84:99]
ds_read_b128 a[164:167], v206 offset:1024
v_rcp_f32 v203, v203
v_mul_f32 v56, v56, v200
v_mul_f32 v57, v57, v201
v_mul_f32 v58, v58, v202
v_mfma_f32_32x32x16_bf16 v[84:99], a[172:175], a[128:131], v[84:99]
ds_read_b128 a[168:171], v206 offset:2048
v_mul_f32 v59, v59, v203
v_add_f32 v204, v204, v56
v_fmac_f32 v205, v56, v56
v_add_f32 v204, v204, v57
s_waitcnt lgkmcnt(3)
v_mfma_f32_32x32x16_bf16 v[84:99], a[144:147], a[132:135], v[84:99]
ds_read_b128 a[172:175], v206 offset:3072
v_fmac_f32 v205, v57, v57
v_add_f32 v204, v204, v58
v_fmac_f32 v205, v58, v58
v_add_f32 v204, v204, v59
v_mfma_f32_32x32x16_bf16 v[84:99], a[148:151], a[136:139], v[84:99]
ds_read_b128 a[144:147], v206 offset:4096
v_fmac_f32 v205, v59, v59
v_mul_f32 v196, v60, v60
v_mul_f32 v197, v61, v61
v_mul_f32 v198, v62, v62
v_mfma_f32_32x32x16_bf16 v[84:99], a[152:155], a[140:143], v[84:99]
ds_read_b128 a[148:151], v206 offset:5120
v_mul_f32 v199, v63, v63
v_fma_f32 v196, v196, v254, v253
v_fma_f32 v197, v197, v254, v253
v_mfma_f32_32x32x16_bf16 v[84:99], a[156:159], v[212:215], v[84:99]
ds_read_b128 a[152:155], v206 offset:6144
v_fma_f32 v198, v198, v254, v253
v_fma_f32 v199, v199, v254, v253
s_waitcnt vmcnt(10)
s_barrier
s_waitcnt lgkmcnt(3)
v_mfma_f32_32x32x16_bf16 v[100:115], a[160:163], a[0:3], 0
ds_read_b128 a[156:159], v206 offset:7168
s_mul_i32 s38, s24, 9216
v_mul_f32 v196, v196, v60
v_mul_f32 v197, v197, v61
v_mul_f32 v198, v198, v62
v_mul_f32 v199, v199, v63
v_mfma_f32_32x32x16_bf16 v[100:115], a[164:167], a[4:7], v[100:115]
ds_read_b128 a[160:163], v206 offset:8192
s_add_u32 m0, s38, 37888
v_exp_f32 v196, v196
v_exp_f32 v197, v197
v_mfma_f32_32x32x16_bf16 v[100:115], a[168:171], a[8:11], v[100:115]
ds_read_b128 a[164:167], v206 offset:9216
s_add_u32 s39, s38, s82
v_exp_f32 v198, v198
v_exp_f32 v199, v199
v_fma_f32 v196, v196, v255, v255
v_mfma_f32_32x32x16_bf16 v[100:115], a[172:175], a[12:15], v[100:115]
ds_read_b128 a[168:171], v206 offset:10240
s_add_u32 s39, s39, 265216
v_fma_f32 v197, v197, v255, v255
v_fma_f32 v198, v198, v255, v255
v_fma_f32 v199, v199, v255, v255
s_waitcnt lgkmcnt(3)
v_mfma_f32_32x32x16_bf16 v[100:115], a[144:147], a[16:19], v[100:115]
ds_read_b128 a[172:175], v206 offset:11264
v_rcp_f32 v196, v196
v_rcp_f32 v197, v197
v_mfma_f32_32x32x16_bf16 v[100:115], a[148:151], a[20:23], v[100:115]
ds_read_b128 a[144:147], v206 offset:12288
buffer_load_dwordx4 v1, s[4:7], s39 offen offset:0  lds
v_rcp_f32 v198, v198
v_rcp_f32 v199, v199
v_mfma_f32_32x32x16_bf16 v[100:115], a[152:155], a[24:27], v[100:115]
ds_read_b128 a[148:151], v206 offset:13312
v_mul_f32 v60, v60, v196
v_mul_f32 v61, v61, v197
v_mul_f32 v62, v62, v198
v_mul_f32 v63, v63, v199
v_add_f32 v204, v204, v60
v_mfma_f32_32x32x16_bf16 v[100:115], a[156:159], a[28:31], v[100:115]
ds_read_b128 a[152:155], v206 offset:14336
buffer_load_dwordx4 v1, s[4:7], s39 offen offset:1024  lds
v_fmac_f32 v205, v60, v60
v_add_f32 v204, v204, v61
v_fmac_f32 v205, v61, v61
s_waitcnt lgkmcnt(3)
v_mfma_f32_32x32x16_bf16 v[100:115], a[160:163], a[32:35], v[100:115]
ds_read_b128 a[156:159], v206 offset:15360
buffer_load_dwordx4 v1, s[4:7], s39 offen offset:2048  lds
v_add_f32 v204, v204, v62
v_fmac_f32 v205, v62, v62
v_add_f32 v204, v204, v63
v_fmac_f32 v205, v63, v63
v_mfma_f32_32x32x16_bf16 v[100:115], a[164:167], a[36:39], v[100:115]
ds_read_b128 a[160:163], v206 offset:16384
v_mul_f32 v200, v64, v64
v_mul_f32 v201, v65, v65
v_mul_f32 v202, v66, v66
v_mul_f32 v203, v67, v67
v_fma_f32 v200, v200, v254, v253
v_mfma_f32_32x32x16_bf16 v[100:115], a[168:171], a[40:43], v[100:115]
ds_read_b128 a[164:167], v206 offset:17408
buffer_load_dwordx4 v1, s[4:7], s39 offen offset:3072  lds
s_add_u32 m0, m0, 4096
v_fma_f32 v201, v201, v254, v253
v_fma_f32 v202, v202, v254, v253
v_fma_f32 v203, v203, v254, v253
v_mul_f32 v200, v200, v64
v_mfma_f32_32x32x16_bf16 v[100:115], a[172:175], a[44:47], v[100:115]
ds_read_b128 a[168:171], v206 offset:18432
s_add_u32 s39, s39, 4096
v_mul_f32 v201, v201, v65
v_mul_f32 v202, v202, v66
v_mul_f32 v203, v203, v67
s_waitcnt lgkmcnt(3)
v_mfma_f32_32x32x16_bf16 v[100:115], a[144:147], a[48:51], v[100:115]
ds_read_b128 a[172:175], v206 offset:19456
v_exp_f32 v200, v200
v_exp_f32 v201, v201
v_mfma_f32_32x32x16_bf16 v[100:115], a[148:151], a[52:55], v[100:115]
ds_read_b128 a[144:147], v206 offset:20480
v_exp_f32 v202, v202
v_exp_f32 v203, v203
v_mfma_f32_32x32x16_bf16 v[100:115], a[152:155], a[56:59], v[100:115]
ds_read_b128 a[148:151], v206 offset:21504
buffer_load_dwordx4 v1, s[4:7], s39 offen offset:0  lds
v_fma_f32 v200, v200, v255, v255
v_fma_f32 v201, v201, v255, v255
v_fma_f32 v202, v202, v255, v255
v_fma_f32 v203, v203, v255, v255
v_mfma_f32_32x32x16_bf16 v[100:115], a[156:159], a[60:63], v[100:115]
ds_read_b128 a[152:155], v206 offset:22528
v_rcp_f32 v200, v200
v_rcp_f32 v201, v201
s_waitcnt lgkmcnt(3)
v_mfma_f32_32x32x16_bf16 v[100:115], a[160:163], a[64:67], v[100:115]
ds_read_b128 a[156:159], v206 offset:23552
buffer_load_dwordx4 v1, s[4:7], s39 offen offset:1024  lds
v_rcp_f32 v202, v202
v_rcp_f32 v203, v203
v_mfma_f32_32x32x16_bf16 v[100:115], a[164:167], a[68:71], v[100:115]
ds_read_b128 a[160:163], v206 offset:24576
buffer_load_dwordx4 v1, s[4:7], s39 offen offset:2048  lds
v_mul_f32 v64, v64, v200
v_mul_f32 v65, v65, v201
v_mul_f32 v66, v66, v202
v_mul_f32 v67, v67, v203
v_mfma_f32_32x32x16_bf16 v[100:115], a[168:171], a[72:75], v[100:115]
ds_read_b128 a[164:167], v206 offset:25600
buffer_load_dwordx4 v1, s[4:7], s39 offen offset:3072  lds
s_add_u32 m0, m0, 4096
v_add_f32 v204, v204, v64
v_fmac_f32 v205, v64, v64
v_add_f32 v204, v204, v65
v_fmac_f32 v205, v65, v65
v_mfma_f32_32x32x16_bf16 v[100:115], a[172:175], a[76:79], v[100:115]
ds_read_b128 a[168:171], v206 offset:26624
s_add_u32 s39, s39, 4096
v_add_f32 v204, v204, v66
v_fmac_f32 v205, v66, v66
v_add_f32 v204, v204, v67
s_waitcnt lgkmcnt(3)
v_mfma_f32_32x32x16_bf16 v[100:115], a[144:147], a[80:83], v[100:115]
ds_read_b128 a[172:175], v206 offset:27648
v_fmac_f32 v205, v67, v67
v_mul_f32 v196, v68, v68
v_mul_f32 v197, v69, v69
v_mul_f32 v198, v70, v70
v_mfma_f32_32x32x16_bf16 v[100:115], a[148:151], a[84:87], v[100:115]
ds_read_b128 a[144:147], v206 offset:28672
v_mul_f32 v199, v71, v71
v_fma_f32 v196, v196, v254, v253
v_fma_f32 v197, v197, v254, v253
v_fma_f32 v198, v198, v254, v253
v_mfma_f32_32x32x16_bf16 v[100:115], a[152:155], a[88:91], v[100:115]
ds_read_b128 a[148:151], v206 offset:29696
v_fma_f32 v199, v199, v254, v253
v_mul_f32 v196, v196, v68
v_mul_f32 v197, v197, v69
v_mul_f32 v198, v198, v70
v_mfma_f32_32x32x16_bf16 v[100:115], a[156:159], a[92:95], v[100:115]
ds_read_b128 a[152:155], v206 offset:30720
buffer_load_dwordx4 v1, s[4:7], s39 offen offset:0  lds
s_lshl_b32 s38, s24, 8
v_mul_f32 v199, v199, v71
v_exp_f32 v196, v196
s_waitcnt lgkmcnt(3)
v_mfma_f32_32x32x16_bf16 v[100:115], a[160:163], a[96:99], v[100:115]
ds_read_b128 a[156:159], v206 offset:31744
s_add_u32 m0, s38, 74752
v_exp_f32 v197, v197
v_exp_f32 v198, v198
v_mfma_f32_32x32x16_bf16 v[100:115], a[164:167], a[100:103], v[100:115]
ds_read_b128 a[160:163], v206 offset:32768
s_add_u32 s39, s38, s82
v_exp_f32 v199, v199
v_fma_f32 v196, v196, v255, v255
v_fma_f32 v197, v197, v255, v255
v_fma_f32 v198, v198, v255, v255
v_mfma_f32_32x32x16_bf16 v[100:115], a[168:171], a[104:107], v[100:115]
ds_read_b128 a[164:167], v206 offset:33792
s_add_u32 s39, s39, 302080
v_fma_f32 v199, v199, v255, v255
v_rcp_f32 v196, v196
v_mfma_f32_32x32x16_bf16 v[100:115], a[172:175], a[108:111], v[100:115]
ds_read_b128 a[168:171], v206 offset:34816
v_rcp_f32 v197, v197
v_rcp_f32 v198, v198
s_waitcnt lgkmcnt(3)
v_mfma_f32_32x32x16_bf16 v[100:115], a[144:147], a[112:115], v[100:115]
ds_read_b128 a[172:175], v206 offset:35840
v_rcp_f32 v199, v199
v_mul_f32 v68, v68, v196
v_mul_f32 v69, v69, v197
v_mfma_f32_32x32x16_bf16 v[100:115], a[148:151], a[116:119], v[100:115]
ds_read_b128 a[144:147], v206 offset:36864
v_mul_f32 v70, v70, v198
v_mul_f32 v71, v71, v199
v_add_f32 v204, v204, v68
v_fmac_f32 v205, v68, v68
v_mfma_f32_32x32x16_bf16 v[100:115], a[152:155], a[120:123], v[100:115]
ds_read_b128 a[148:151], v207 offset:0
s_mov_b64 exec, 0xffff
buffer_load_dwordx4 v1, s[4:7], s39 offen lds
s_mov_b64 exec, -1
v_add_f32 v204, v204, v69
v_fmac_f32 v205, v69, v69
v_mfma_f32_32x32x16_bf16 v[100:115], a[156:159], a[124:127], v[100:115]
ds_read_b128 a[152:155], v207 offset:1024
v_add_f32 v204, v204, v70
v_fmac_f32 v205, v70, v70
v_add_f32 v204, v204, v71
v_fmac_f32 v205, v71, v71
s_waitcnt lgkmcnt(3)
v_mfma_f32_32x32x16_bf16 v[100:115], a[160:163], a[128:131], v[100:115]
ds_read_b128 a[156:159], v207 offset:2048
v_mul_f32 v200, v72, v72
v_mul_f32 v201, v73, v73
v_mul_f32 v202, v74, v74
v_mul_f32 v203, v75, v75
v_fma_f32 v200, v200, v254, v253
v_mfma_f32_32x32x16_bf16 v[100:115], a[164:167], a[132:135], v[100:115]
ds_read_b128 a[160:163], v207 offset:3072
v_fma_f32 v201, v201, v254, v253
v_fma_f32 v202, v202, v254, v253
v_fma_f32 v203, v203, v254, v253
v_mul_f32 v200, v200, v72
v_mfma_f32_32x32x16_bf16 v[100:115], a[168:171], a[136:139], v[100:115]
ds_read_b128 a[164:167], v207 offset:4096
v_mul_f32 v201, v201, v73
v_mul_f32 v202, v202, v74
v_mul_f32 v203, v203, v75
v_exp_f32 v200, v200
v_mfma_f32_32x32x16_bf16 v[100:115], a[172:175], a[140:143], v[100:115]
ds_read_b128 a[168:171], v207 offset:5120
v_exp_f32 v201, v201
v_exp_f32 v202, v202
s_waitcnt lgkmcnt(3)
v_mfma_f32_32x32x16_bf16 v[100:115], a[144:147], v[212:215], v[100:115]
ds_read_b128 a[172:175], v207 offset:6144
v_exp_f32 v203, v203
v_fma_f32 v200, v200, v255, v255
s_waitcnt vmcnt(10)
s_barrier
v_mfma_f32_32x32x16_bf16 v[116:131], a[148:151], a[0:3], 0
ds_read_b128 a[144:147], v207 offset:7168
s_mul_i32 s38, s24, 9216
v_fma_f32 v201, v201, v255, v255
v_fma_f32 v202, v202, v255, v255
v_fma_f32 v203, v203, v255, v255
v_rcp_f32 v200, v200
v_mfma_f32_32x32x16_bf16 v[116:131], a[152:155], a[4:7], v[116:131]
ds_read_b128 a[148:151], v207 offset:8192
s_add_u32 m0, s38, 86016
v_rcp_f32 v201, v201
v_rcp_f32 v202, v202
v_mfma_f32_32x32x16_bf16 v[116:131], a[156:159], a[8:11], v[116:131]
ds_read_b128 a[152:155], v207 offset:9216
s_add_u32 s39, s38, s82
v_rcp_f32 v203, v203
v_mul_f32 v72, v72, v200
s_waitcnt lgkmcnt(3)
v_mfma_f32_32x32x16_bf16 v[116:131], a[160:163], a[12:15], v[116:131]
ds_read_b128 a[156:159], v207 offset:10240
s_add_u32 s39, s39, 303104
v_mul_f32 v73, v73, v201
v_mul_f32 v74, v74, v202
v_mul_f32 v75, v75, v203
v_mfma_f32_32x32x16_bf16 v[116:131], a[164:167], a[16:19], v[116:131]
ds_read_b128 a[160:163], v207 offset:11264
v_add_f32 v204, v204, v72
v_fmac_f32 v205, v72, v72
v_add_f32 v204, v204, v73
v_fmac_f32 v205, v73, v73
v_mfma_f32_32x32x16_bf16 v[116:131], a[168:171], a[20:23], v[116:131]
ds_read_b128 a[164:167], v207 offset:12288
buffer_load_dwordx4 v1, s[4:7], s39 offen offset:0  lds
v_add_f32 v204, v204, v74
v_fmac_f32 v205, v74, v74
v_add_f32 v204, v204, v75
v_fmac_f32 v205, v75, v75
v_mfma_f32_32x32x16_bf16 v[116:131], a[172:175], a[24:27], v[116:131]
ds_read_b128 a[168:171], v207 offset:13312
v_mul_f32 v196, v76, v76
v_mul_f32 v197, v77, v77
v_mul_f32 v198, v78, v78
v_mul_f32 v199, v79, v79
s_waitcnt lgkmcnt(3)
v_mfma_f32_32x32x16_bf16 v[116:131], a[144:147], a[28:31], v[116:131]
ds_read_b128 a[172:175], v207 offset:14336
buffer_load_dwordx4 v1, s[4:7], s39 offen offset:1024  lds
v_fma_f32 v196, v196, v254, v253
v_fma_f32 v197, v197, v254, v253
v_fma_f32 v198, v198, v254, v253
v_fma_f32 v199, v199, v254, v253
v_mfma_f32_32x32x16_bf16 v[116:131], a[148:151], a[32:35], v[116:131]
ds_read_b128 a[144:147], v207 offset:15360
buffer_load_dwordx4 v1, s[4:7], s39 offen offset:2048  lds
v_mul_f32 v196, v196, v76
v_mul_f32 v197, v197, v77
v_mul_f32 v198, v198, v78
v_mul_f32 v199, v199, v79
v_mfma_f32_32x32x16_bf16 v[116:131], a[152:155], a[36:39], v[116:131]
ds_read_b128 a[148:151], v207 offset:16384
v_exp_f32 v196, v196
v_exp_f32 v197, v197
v_mfma_f32_32x32x16_bf16 v[116:131], a[156:159], a[40:43], v[116:131]
ds_read_b128 a[152:155], v207 offset:17408
buffer_load_dwordx4 v1, s[4:7], s39 offen offset:3072  lds
s_add_u32 m0, m0, 4096
v_exp_f32 v198, v198
s_waitcnt lgkmcnt(3)
v_mfma_f32_32x32x16_bf16 v[116:131], a[160:163], a[44:47], v[116:131]
ds_read_b128 a[156:159], v207 offset:18432
s_add_u32 s39, s39, 4096
v_exp_f32 v199, v199
v_fma_f32 v196, v196, v255, v255
v_fma_f32 v197, v197, v255, v255
v_fma_f32 v198, v198, v255, v255
v_mfma_f32_32x32x16_bf16 v[116:131], a[164:167], a[48:51], v[116:131]
ds_read_b128 a[160:163], v207 offset:19456
v_fma_f32 v199, v199, v255, v255
v_rcp_f32 v196, v196
v_rcp_f32 v197, v197
v_mfma_f32_32x32x16_bf16 v[116:131], a[168:171], a[52:55], v[116:131]
ds_read_b128 a[164:167], v207 offset:20480
v_rcp_f32 v198, v198
v_rcp_f32 v199, v199
v_mfma_f32_32x32x16_bf16 v[116:131], a[172:175], a[56:59], v[116:131]
ds_read_b128 a[168:171], v207 offset:21504
buffer_load_dwordx4 v1, s[4:7], s39 offen offset:0  lds
v_mul_f32 v76, v76, v196
v_mul_f32 v77, v77, v197
v_mul_f32 v78, v78, v198
s_waitcnt lgkmcnt(3)
v_mfma_f32_32x32x16_bf16 v[116:131], a[144:147], a[60:63], v[116:131]
ds_read_b128 a[172:175], v207 offset:22528
v_mul_f32 v79, v79, v199
v_add_f32 v204, v204, v76
v_fmac_f32 v205, v76, v76
v_add_f32 v204, v204, v77
v_mfma_f32_32x32x16_bf16 v[116:131], a[148:151], a[64:67], v[116:131]
ds_read_b128 a[144:147], v207 offset:23552
buffer_load_dwordx4 v1, s[4:7], s39 offen offset:1024  lds
v_fmac_f32 v205, v77, v77
v_add_f32 v204, v204, v78
v_fmac_f32 v205, v78, v78
v_add_f32 v204, v204, v79
v_mfma_f32_32x32x16_bf16 v[116:131], a[152:155], a[68:71], v[116:131]
ds_read_b128 a[148:151], v207 offset:24576
buffer_load_dwordx4 v1, s[4:7], s39 offen offset:2048  lds
v_fmac_f32 v205, v79, v79
v_mul_f32 v200, v80, v80
v_mul_f32 v201, v81, v81
v_mfma_f32_32x32x16_bf16 v[116:131], a[156:159], a[72:75], v[116:131]
ds_read_b128 a[152:155], v207 offset:25600
buffer_load_dwordx4 v1, s[4:7], s39 offen offset:3072  lds
s_add_u32 m0, m0, 4096
v_mul_f32 v202, v82, v82
v_mul_f32 v203, v83, v83
v_fma_f32 v200, v200, v254, v253
s_waitcnt lgkmcnt(3)
v_mfma_f32_32x32x16_bf16 v[116:131], a[160:163], a[76:79], v[116:131]
ds_read_b128 a[156:159], v207 offset:26624
s_add_u32 s39, s39, 4096
v_fma_f32 v201, v201, v254, v253
v_fma_f32 v202, v202, v254, v253
v_fma_f32 v203, v203, v254, v253
v_mul_f32 v200, v200, v80
v_mul_f32 v201, v201, v81
v_mfma_f32_32x32x16_bf16 v[116:131], a[164:167], a[80:83], v[116:131]
ds_read_b128 a[160:163], v207 offset:27648
v_mul_f32 v202, v202, v82
v_mul_f32 v203, v203, v83
v_exp_f32 v200, v200
v_mfma_f32_32x32x16_bf16 v[116:131], a[168:171], a[84:87], v[116:131]
ds_read_b128 a[164:167], v207 offset:28672
v_exp_f32 v201, v201
v_exp_f32 v202, v202
v_mfma_f32_32x32x16_bf16 v[116:131], a[172:175], a[88:91], v[116:131]
ds_read_b128 a[168:171], v207 offset:29696
v_exp_f32 v203, v203
v_fma_f32 v200, v200, v255, v255
v_fma_f32 v201, v201, v255, v255
s_waitcnt lgkmcnt(3)
v_mfma_f32_32x32x16_bf16 v[116:131], a[144:147], a[92:95], v[116:131]
ds_read_b128 a[172:175], v207 offset:30720
buffer_load_dwordx4 v1, s[4:7], s39 offen offset:0  lds
s_lshl_b32 s38, s24, 8
v_fma_f32 v202, v202, v255, v255
v_fma_f32 v203, v203, v255, v255
v_rcp_f32 v200, v200
v_mfma_f32_32x32x16_bf16 v[116:131], a[148:151], a[96:99], v[116:131]
ds_read_b128 a[144:147], v207 offset:31744
s_add_u32 m0, s38, 122880
v_rcp_f32 v201, v201
v_rcp_f32 v202, v202
v_mfma_f32_32x32x16_bf16 v[116:131], a[152:155], a[100:103], v[116:131]
ds_read_b128 a[148:151], v207 offset:32768
s_add_u32 s39, s38, s82
v_rcp_f32 v203, v203
v_mul_f32 v80, v80, v200
v_mfma_f32_32x32x16_bf16 v[116:131], a[156:159], a[104:107], v[116:131]
ds_read_b128 a[152:155], v207 offset:33792
s_add_u32 s39, s39, 339968
v_mul_f32 v81, v81, v201
v_mul_f32 v82, v82, v202
v_mul_f32 v83, v83, v203
v_add_f32 v204, v204, v80
s_waitcnt lgkmcnt(3)
v_mfma_f32_32x32x16_bf16 v[116:131], a[160:163], a[108:111], v[116:131]
ds_read_b128 a[156:159], v207 offset:34816
v_fmac_f32 v205, v80, v80
v_add_f32 v204, v204, v81
v_fmac_f32 v205, v81, v81
v_add_f32 v204, v204, v82
v_mfma_f32_32x32x16_bf16 v[116:131], a[164:167], a[112:115], v[116:131]
ds_read_b128 a[160:163], v207 offset:35840
v_fmac_f32 v205, v82, v82
v_add_f32 v204, v204, v83
v_fmac_f32 v205, v83, v83
v_mul_f32 v196, v84, v84
v_mfma_f32_32x32x16_bf16 v[116:131], a[168:171], a[116:119], v[116:131]
ds_read_b128 a[164:167], v207 offset:36864
v_mul_f32 v197, v85, v85
v_mul_f32 v198, v86, v86
v_mul_f32 v199, v87, v87
v_fma_f32 v196, v196, v254, v253
v_mfma_f32_32x32x16_bf16 v[116:131], a[172:175], a[120:123], v[116:131]
ds_read_b128 a[168:171], v208 offset:0
s_mov_b64 exec, 0xffff
buffer_load_dwordx4 v1, s[4:7], s39 offen lds
s_mov_b64 exec, -1
v_fma_f32 v197, v197, v254, v253
s_waitcnt lgkmcnt(3)
v_mfma_f32_32x32x16_bf16 v[116:131], a[144:147], a[124:127], v[116:131]
ds_read_b128 a[172:175], v208 offset:1024
v_fma_f32 v198, v198, v254, v253
v_fma_f32 v199, v199, v254, v253
v_mul_f32 v196, v196, v84
v_mul_f32 v197, v197, v85
v_mul_f32 v198, v198, v86
v_mfma_f32_32x32x16_bf16 v[116:131], a[148:151], a[128:131], v[116:131]
ds_read_b128 a[144:147], v208 offset:2048
v_mul_f32 v199, v199, v87
v_exp_f32 v196, v196
v_exp_f32 v197, v197
v_mfma_f32_32x32x16_bf16 v[116:131], a[152:155], a[132:135], v[116:131]
ds_read_b128 a[148:151], v208 offset:3072
v_exp_f32 v198, v198
v_exp_f32 v199, v199
v_mfma_f32_32x32x16_bf16 v[116:131], a[156:159], a[136:139], v[116:131]
ds_read_b128 a[152:155], v208 offset:4096
v_fma_f32 v196, v196, v255, v255
v_fma_f32 v197, v197, v255, v255
v_fma_f32 v198, v198, v255, v255
v_fma_f32 v199, v199, v255, v255
s_waitcnt lgkmcnt(3)
v_mfma_f32_32x32x16_bf16 v[116:131], a[160:163], a[140:143], v[116:131]
ds_read_b128 a[156:159], v208 offset:5120
v_rcp_f32 v196, v196
v_rcp_f32 v197, v197
v_mfma_f32_32x32x16_bf16 v[116:131], a[164:167], v[212:215], v[116:131]
ds_read_b128 a[160:163], v208 offset:6144
v_rcp_f32 v198, v198
s_waitcnt vmcnt(10)
s_barrier
v_mfma_f32_32x32x16_bf16 v[132:147], a[168:171], a[0:3], 0
ds_read_b128 a[164:167], v208 offset:7168
s_lshl_b32 s84, s25, 19
v_rcp_f32 v199, v199
v_mul_f32 v84, v84, v196
v_mul_f32 v85, v85, v197
v_mul_f32 v86, v86, v198
v_mfma_f32_32x32x16_bf16 v[132:147], a[172:175], a[4:7], v[132:147]
ds_read_b128 a[168:171], v208 offset:8192
s_lshl_b32 s38, s24, 17
v_mul_f32 v87, v87, v199
v_add_f32 v204, v204, v84
v_fmac_f32 v205, v84, v84
v_add_f32 v204, v204, v85
s_waitcnt lgkmcnt(3)
v_mfma_f32_32x32x16_bf16 v[132:147], a[144:147], a[8:11], v[132:147]
ds_read_b128 a[172:175], v208 offset:9216
s_add_u32 s84, s84, s38
v_fmac_f32 v205, v85, v85
v_add_f32 v204, v204, v86
v_fmac_f32 v205, v86, v86
v_add_f32 v204, v204, v87
v_mfma_f32_32x32x16_bf16 v[132:147], a[148:151], a[12:15], v[132:147]
ds_read_b128 a[144:147], v208 offset:10240
s_add_u32 s84, s84, 10895360
v_fmac_f32 v205, v87, v87
v_mul_f32 v200, v88, v88
v_mul_f32 v201, v89, v89
v_mul_f32 v202, v90, v90
v_mfma_f32_32x32x16_bf16 v[132:147], a[152:155], a[16:19], v[132:147]
ds_read_b128 a[148:151], v208 offset:11264
v_mul_f32 v203, v91, v91
v_fma_f32 v200, v200, v254, v253
v_fma_f32 v201, v201, v254, v253
v_fma_f32 v202, v202, v254, v253
v_mfma_f32_32x32x16_bf16 v[132:147], a[156:159], a[20:23], v[132:147]
ds_read_b128 a[152:155], v208 offset:12288
v_fma_f32 v203, v203, v254, v253
v_mul_f32 v200, v200, v88
v_mul_f32 v201, v201, v89
v_mul_f32 v202, v202, v90
s_waitcnt lgkmcnt(3)
v_mfma_f32_32x32x16_bf16 v[132:147], a[160:163], a[24:27], v[132:147]
ds_read_b128 a[156:159], v208 offset:13312
v_mul_f32 v203, v203, v91
v_exp_f32 v200, v200
v_exp_f32 v201, v201
v_mfma_f32_32x32x16_bf16 v[132:147], a[164:167], a[28:31], v[132:147]
ds_read_b128 a[160:163], v208 offset:14336
v_exp_f32 v202, v202
v_exp_f32 v203, v203
v_mfma_f32_32x32x16_bf16 v[132:147], a[168:171], a[32:35], v[132:147]
ds_read_b128 a[164:167], v208 offset:15360
buffer_load_dwordx4 a[176:179], v1, s[4:7], s84 offen offset:0 sc1
v_fma_f32 v200, v200, v255, v255
v_fma_f32 v201, v201, v255, v255
v_mfma_f32_32x32x16_bf16 v[132:147], a[172:175], a[36:39], v[132:147]
ds_read_b128 a[168:171], v208 offset:16384
v_fma_f32 v202, v202, v255, v255
v_fma_f32 v203, v203, v255, v255
v_rcp_f32 v200, v200
s_waitcnt lgkmcnt(3)
v_mfma_f32_32x32x16_bf16 v[132:147], a[144:147], a[40:43], v[132:147]
ds_read_b128 a[172:175], v208 offset:17408
buffer_load_dwordx4 a[180:183], v9, s[4:7], s84 offen offset:0 sc1
v_rcp_f32 v201, v201
v_rcp_f32 v202, v202
v_mfma_f32_32x32x16_bf16 v[132:147], a[148:151], a[44:47], v[132:147]
ds_read_b128 a[144:147], v208 offset:18432
v_rcp_f32 v203, v203
v_mul_f32 v88, v88, v200
v_mul_f32 v89, v89, v201
v_mfma_f32_32x32x16_bf16 v[132:147], a[152:155], a[48:51], v[132:147]
ds_read_b128 a[148:151], v208 offset:19456
v_mul_f32 v90, v90, v202
v_mul_f32 v91, v91, v203
v_add_f32 v204, v204, v88
v_fmac_f32 v205, v88, v88
v_mfma_f32_32x32x16_bf16 v[132:147], a[156:159], a[52:55], v[132:147]
ds_read_b128 a[152:155], v208 offset:20480
buffer_load_dwordx4 a[184:187], v1, s[4:7], s84 offen offset:1024 sc1
v_add_f32 v204, v204, v89
v_fmac_f32 v205, v89, v89
v_add_f32 v204, v204, v90
s_waitcnt lgkmcnt(3)
v_mfma_f32_32x32x16_bf16 v[132:147], a[160:163], a[56:59], v[132:147]
ds_read_b128 a[156:159], v208 offset:21504
v_fmac_f32 v205, v90, v90
v_add_f32 v204, v204, v91
v_fmac_f32 v205, v91, v91
v_mul_f32 v196, v92, v92
v_mul_f32 v197, v93, v93
v_mfma_f32_32x32x16_bf16 v[132:147], a[164:167], a[60:63], v[132:147]
ds_read_b128 a[160:163], v208 offset:22528
buffer_load_dwordx4 a[188:191], v9, s[4:7], s84 offen offset:1024 sc1
v_mul_f32 v198, v94, v94
v_mul_f32 v199, v95, v95
v_fma_f32 v196, v196, v254, v253
v_mfma_f32_32x32x16_bf16 v[132:147], a[168:171], a[64:67], v[132:147]
ds_read_b128 a[164:167], v208 offset:23552
v_fma_f32 v197, v197, v254, v253
v_fma_f32 v198, v198, v254, v253
v_fma_f32 v199, v199, v254, v253
v_mul_f32 v196, v196, v92
v_mfma_f32_32x32x16_bf16 v[132:147], a[172:175], a[68:71], v[132:147]
ds_read_b128 a[168:171], v208 offset:24576
buffer_load_dwordx4 a[192:195], v1, s[4:7], s84 offen offset:2048 sc1
v_mul_f32 v197, v197, v93
v_mul_f32 v198, v198, v94
v_mul_f32 v199, v199, v95
s_waitcnt lgkmcnt(3)
v_mfma_f32_32x32x16_bf16 v[132:147], a[144:147], a[72:75], v[132:147]
ds_read_b128 a[172:175], v208 offset:25600
v_exp_f32 v196, v196
v_exp_f32 v197, v197
v_mfma_f32_32x32x16_bf16 v[132:147], a[148:151], a[76:79], v[132:147]
ds_read_b128 a[144:147], v208 offset:26624
buffer_load_dwordx4 a[196:199], v9, s[4:7], s84 offen offset:2048 sc1
v_exp_f32 v198, v198
v_exp_f32 v199, v199
v_mfma_f32_32x32x16_bf16 v[132:147], a[152:155], a[80:83], v[132:147]
ds_read_b128 a[148:151], v208 offset:27648
v_fma_f32 v196, v196, v255, v255
v_fma_f32 v197, v197, v255, v255
v_fma_f32 v198, v198, v255, v255
v_fma_f32 v199, v199, v255, v255
v_mfma_f32_32x32x16_bf16 v[132:147], a[156:159], a[84:87], v[132:147]
ds_read_b128 a[152:155], v208 offset:28672
buffer_load_dwordx4 a[200:203], v1, s[4:7], s84 offen offset:3072 sc1
v_rcp_f32 v196, v196
s_waitcnt lgkmcnt(3)
v_mfma_f32_32x32x16_bf16 v[132:147], a[160:163], a[88:91], v[132:147]
ds_read_b128 a[156:159], v208 offset:29696
v_rcp_f32 v197, v197
v_rcp_f32 v198, v198
v_mfma_f32_32x32x16_bf16 v[132:147], a[164:167], a[92:95], v[132:147]
ds_read_b128 a[160:163], v208 offset:30720
buffer_load_dwordx4 a[204:207], v9, s[4:7], s84 offen offset:3072 sc1
s_add_u32 s84, s84, 4096
v_rcp_f32 v199, v199
v_mul_f32 v92, v92, v196
v_mul_f32 v93, v93, v197
v_mfma_f32_32x32x16_bf16 v[132:147], a[168:171], a[96:99], v[132:147]
ds_read_b128 a[164:167], v208 offset:31744
v_mul_f32 v94, v94, v198
v_mul_f32 v95, v95, v199
v_add_f32 v204, v204, v92
v_fmac_f32 v205, v92, v92
v_add_f32 v204, v204, v93
v_mfma_f32_32x32x16_bf16 v[132:147], a[172:175], a[100:103], v[132:147]
ds_read_b128 a[168:171], v208 offset:32768
v_fmac_f32 v205, v93, v93
v_add_f32 v204, v204, v94
v_fmac_f32 v205, v94, v94
v_add_f32 v204, v204, v95
s_waitcnt lgkmcnt(3)
v_mfma_f32_32x32x16_bf16 v[132:147], a[144:147], a[104:107], v[132:147]
ds_read_b128 a[172:175], v208 offset:33792
v_fmac_f32 v205, v95, v95
v_mul_f32 v200, v96, v96
v_mul_f32 v201, v97, v97
v_mul_f32 v202, v98, v98
v_mul_f32 v203, v99, v99
v_mfma_f32_32x32x16_bf16 v[132:147], a[148:151], a[108:111], v[132:147]
ds_read_b128 a[144:147], v208 offset:34816
v_fma_f32 v200, v200, v254, v253
v_fma_f32 v201, v201, v254, v253
v_fma_f32 v202, v202, v254, v253
v_fma_f32 v203, v203, v254, v253
v_mfma_f32_32x32x16_bf16 v[132:147], a[152:155], a[112:115], v[132:147]
ds_read_b128 a[148:151], v208 offset:35840
buffer_load_dwordx4 a[208:211], v1, s[4:7], s84 offen offset:0 sc1
v_mul_f32 v200, v200, v96
v_mul_f32 v201, v201, v97
v_mul_f32 v202, v202, v98
v_mul_f32 v203, v203, v99
v_mfma_f32_32x32x16_bf16 v[132:147], a[156:159], a[116:119], v[132:147]
ds_read_b128 a[152:155], v208 offset:36864
v_exp_f32 v200, v200
v_exp_f32 v201, v201
s_waitcnt lgkmcnt(3)
v_mfma_f32_32x32x16_bf16 v[132:147], a[160:163], a[120:123], v[132:147]
ds_read_b128 a[156:159], v209 offset:0
buffer_load_dwordx4 a[212:215], v9, s[4:7], s84 offen offset:0 sc1
v_exp_f32 v202, v202
v_exp_f32 v203, v203
v_mfma_f32_32x32x16_bf16 v[132:147], a[164:167], a[124:127], v[132:147]
ds_read_b128 a[160:163], v209 offset:1024
v_fma_f32 v200, v200, v255, v255
v_fma_f32 v201, v201, v255, v255
v_fma_f32 v202, v202, v255, v255
v_mfma_f32_32x32x16_bf16 v[132:147], a[168:171], a[128:131], v[132:147]
ds_read_b128 a[164:167], v209 offset:2048
buffer_load_dwordx4 a[216:219], v1, s[4:7], s84 offen offset:1024 sc1
v_fma_f32 v203, v203, v255, v255
v_rcp_f32 v200, v200
v_mfma_f32_32x32x16_bf16 v[132:147], a[172:175], a[132:135], v[132:147]
ds_read_b128 a[168:171], v209 offset:3072
v_rcp_f32 v201, v201
v_rcp_f32 v202, v202
s_waitcnt lgkmcnt(3)
v_mfma_f32_32x32x16_bf16 v[132:147], a[144:147], a[136:139], v[132:147]
ds_read_b128 a[172:175], v209 offset:4096
buffer_load_dwordx4 a[220:223], v9, s[4:7], s84 offen offset:1024 sc1
v_rcp_f32 v203, v203
v_mul_f32 v96, v96, v200
v_mul_f32 v97, v97, v201
v_mfma_f32_32x32x16_bf16 v[132:147], a[148:151], a[140:143], v[132:147]
ds_read_b128 a[144:147], v209 offset:5120
v_mul_f32 v98, v98, v202
v_mul_f32 v99, v99, v203
v_add_f32 v204, v204, v96
v_fmac_f32 v205, v96, v96
v_add_f32 v204, v204, v97
v_mfma_f32_32x32x16_bf16 v[132:147], a[152:155], v[212:215], v[132:147]
ds_read_b128 a[148:151], v209 offset:6144
buffer_load_dwordx4 a[224:227], v1, s[4:7], s84 offen offset:2048 sc1
v_fmac_f32 v205, v97, v97
v_add_f32 v204, v204, v98
s_waitcnt vmcnt(13)
s_barrier
v_mfma_f32_32x32x16_bf16 v[148:163], a[156:159], a[0:3], 0
ds_read_b128 a[152:155], v209 offset:7168
v_fmac_f32 v205, v98, v98
v_add_f32 v204, v204, v99
v_fmac_f32 v205, v99, v99
v_mul_f32 v196, v100, v100
s_waitcnt lgkmcnt(3)
v_mfma_f32_32x32x16_bf16 v[148:163], a[160:163], a[4:7], v[148:163]
ds_read_b128 a[156:159], v209 offset:8192
v_mul_f32 v197, v101, v101
v_mul_f32 v198, v102, v102
v_mul_f32 v199, v103, v103
v_fma_f32 v196, v196, v254, v253
v_fma_f32 v197, v197, v254, v253
v_mfma_f32_32x32x16_bf16 v[148:163], a[164:167], a[8:11], v[148:163]
ds_read_b128 a[160:163], v209 offset:9216
buffer_load_dwordx4 a[228:231], v9, s[4:7], s84 offen offset:2048 sc1
v_fma_f32 v198, v198, v254, v253
v_fma_f32 v199, v199, v254, v253
v_mul_f32 v196, v196, v100
v_mul_f32 v197, v197, v101
v_mfma_f32_32x32x16_bf16 v[148:163], a[168:171], a[12:15], v[148:163]
ds_read_b128 a[164:167], v209 offset:10240
v_mul_f32 v198, v198, v102
v_mul_f32 v199, v199, v103
v_exp_f32 v196, v196
v_mfma_f32_32x32x16_bf16 v[148:163], a[172:175], a[16:19], v[148:163]
ds_read_b128 a[168:171], v209 offset:11264
buffer_load_dwordx4 a[232:235], v1, s[4:7], s84 offen offset:3072 sc1
v_exp_f32 v197, v197
s_waitcnt lgkmcnt(3)
v_mfma_f32_32x32x16_bf16 v[148:163], a[144:147], a[20:23], v[148:163]
ds_read_b128 a[172:175], v209 offset:12288
v_exp_f32 v198, v198
v_exp_f32 v199, v199
v_fma_f32 v196, v196, v255, v255
v_mfma_f32_32x32x16_bf16 v[148:163], a[148:151], a[24:27], v[148:163]
ds_read_b128 a[144:147], v209 offset:13312
buffer_load_dwordx4 a[236:239], v9, s[4:7], s84 offen offset:3072 sc1
s_add_u32 s84, s84, 4096
v_fma_f32 v197, v197, v255, v255
v_fma_f32 v198, v198, v255, v255
v_fma_f32 v199, v199, v255, v255
v_mfma_f32_32x32x16_bf16 v[148:163], a[152:155], a[28:31], v[148:163]
ds_read_b128 a[148:151], v209 offset:14336
v_rcp_f32 v196, v196
v_rcp_f32 v197, v197
v_mfma_f32_32x32x16_bf16 v[148:163], a[156:159], a[32:35], v[148:163]
ds_read_b128 a[152:155], v209 offset:15360
v_rcp_f32 v198, v198
v_rcp_f32 v199, v199
s_waitcnt lgkmcnt(3)
v_mfma_f32_32x32x16_bf16 v[148:163], a[160:163], a[36:39], v[148:163]
ds_read_b128 a[156:159], v209 offset:16384
v_mul_f32 v100, v100, v196
v_mul_f32 v101, v101, v197
v_mul_f32 v102, v102, v198
v_mul_f32 v103, v103, v199
v_add_f32 v204, v204, v100
v_mfma_f32_32x32x16_bf16 v[148:163], a[164:167], a[40:43], v[148:163]
ds_read_b128 a[160:163], v209 offset:17408
buffer_load_dwordx4 a[240:243], v1, s[4:7], s84 offen offset:0 sc1
v_fmac_f32 v205, v100, v100
v_add_f32 v204, v204, v101
v_fmac_f32 v205, v101, v101
v_add_f32 v204, v204, v102
v_mfma_f32_32x32x16_bf16 v[148:163], a[168:171], a[44:47], v[148:163]
ds_read_b128 a[164:167], v209 offset:18432
v_fmac_f32 v205, v102, v102
v_add_f32 v204, v204, v103
v_fmac_f32 v205, v103, v103
v_mul_f32 v200, v104, v104
v_mfma_f32_32x32x16_bf16 v[148:163], a[172:175], a[48:51], v[148:163]
ds_read_b128 a[168:171], v209 offset:19456
buffer_load_dwordx4 a[244:247], v9, s[4:7], s84 offen offset:0 sc1
v_mul_f32 v201, v105, v105
v_mul_f32 v202, v106, v106
v_mul_f32 v203, v107, v107
s_waitcnt lgkmcnt(3)
v_mfma_f32_32x32x16_bf16 v[148:163], a[144:147], a[52:55], v[148:163]
ds_read_b128 a[172:175], v209 offset:20480
v_fma_f32 v200, v200, v254, v253
v_fma_f32 v201, v201, v254, v253
v_fma_f32 v202, v202, v254, v253
v_fma_f32 v203, v203, v254, v253
v_mfma_f32_32x32x16_bf16 v[148:163], a[148:151], a[56:59], v[148:163]
ds_read_b128 a[144:147], v209 offset:21504
v_mul_f32 v200, v200, v104
v_mul_f32 v201, v201, v105
v_mul_f32 v202, v202, v106
v_mul_f32 v203, v203, v107
v_mfma_f32_32x32x16_bf16 v[148:163], a[152:155], a[60:63], v[148:163]
ds_read_b128 a[148:151], v209 offset:22528
buffer_load_dwordx4 a[248:251], v1, s[4:7], s84 offen offset:1024 sc1
v_exp_f32 v200, v200
v_exp_f32 v201, v201
v_mfma_f32_32x32x16_bf16 v[148:163], a[156:159], a[64:67], v[148:163]
ds_read_b128 a[152:155], v209 offset:23552
v_exp_f32 v202, v202
v_exp_f32 v203, v203
s_waitcnt lgkmcnt(3)
v_mfma_f32_32x32x16_bf16 v[148:163], a[160:163], a[68:71], v[148:163]
ds_read_b128 a[156:159], v209 offset:24576
buffer_load_dwordx4 a[252:255], v9, s[4:7], s84 offen offset:1024 sc1
s_and_b32 s84, s84, 0x3fffffff
v_fma_f32 v200, v200, v255, v255
v_fma_f32 v201, v201, v255, v255
v_fma_f32 v202, v202, v255, v255
v_fma_f32 v203, v203, v255, v255
v_mfma_f32_32x32x16_bf16 v[148:163], a[164:167], a[72:75], v[148:163]
ds_read_b128 a[160:163], v209 offset:25600
s_mov_b32 s37, L_c4-L_pc
v_rcp_f32 v200, v200
v_rcp_f32 v201, v201
v_mfma_f32_32x32x16_bf16 v[148:163], a[168:171], a[76:79], v[148:163]
ds_read_b128 a[164:167], v209 offset:26624
v_rcp_f32 v202, v202
v_rcp_f32 v203, v203
v_mfma_f32_32x32x16_bf16 v[148:163], a[172:175], a[80:83], v[148:163]
ds_read_b128 a[168:171], v209 offset:27648
v_mul_f32 v104, v104, v200
v_mul_f32 v105, v105, v201
v_mul_f32 v106, v106, v202
s_waitcnt lgkmcnt(3)
v_mfma_f32_32x32x16_bf16 v[148:163], a[144:147], a[84:87], v[148:163]
ds_read_b128 a[172:175], v209 offset:28672
v_mul_f32 v107, v107, v203
v_add_f32 v204, v204, v104
v_fmac_f32 v205, v104, v104
v_add_f32 v204, v204, v105
v_mfma_f32_32x32x16_bf16 v[148:163], a[148:151], a[88:91], v[148:163]
ds_read_b128 a[144:147], v209 offset:29696
v_fmac_f32 v205, v105, v105
v_add_f32 v204, v204, v106
v_fmac_f32 v205, v106, v106
v_add_f32 v204, v204, v107
v_mfma_f32_32x32x16_bf16 v[148:163], a[152:155], a[92:95], v[148:163]
ds_read_b128 a[148:151], v209 offset:30720
buffer_load_dword v15, v14, s[88:91], s37 offen
v_fmac_f32 v205, v107, v107
v_mov_b32 v180, v204
v_mov_b32 v181, v205
s_lshl_b32 s61, s25, 14
v_mfma_f32_32x32x16_bf16 v[148:163], a[156:159], a[96:99], v[148:163]
ds_read_b128 a[152:155], v209 offset:31744
s_lshl_b32 s30, s24, 8
v_permlane32_swap_b32 v204, v180
v_permlane32_swap_b32 v205, v181
s_waitcnt lgkmcnt(3)
v_mfma_f32_32x32x16_bf16 v[148:163], a[160:163], a[100:103], v[148:163]
ds_read_b128 a[156:159], v209 offset:32768
v_add_f32 v204, v204, v180
v_add_f32 v205, v205, v181
s_add_u32 s61, s61, s30
v_mfma_f32_32x32x16_bf16 v[148:163], a[164:167], a[104:107], v[148:163]
ds_read_b128 a[160:163], v209 offset:33792
s_add_u32 s61, s61, 26214400
s_lshl_b32 s30, s26, 10
s_add_u32 s30, s30, s61
v_lshrrev_b32 v6, 1, v1
v_mfma_f32_32x32x16_bf16 v[148:163], a[168:171], a[108:111], v[148:163]
ds_read_b128 a[164:167], v209 offset:34816
s_mov_b32 exec_hi, 0
buffer_store_dwordx2 v[204:205], v6, s[8:11], s30 offen sc1
s_mov_b64 exec, -1
v_mfma_f32_32x32x16_bf16 v[148:163], a[172:175], a[112:115], v[148:163]
ds_read_b128 a[168:171], v209 offset:35840
v_and_b32 v6, 0xf8, v6
s_waitcnt lgkmcnt(3)
v_mfma_f32_32x32x16_bf16 v[148:163], a[144:147], a[116:119], v[148:163]
ds_read_b128 a[172:175], v209 offset:36864
v_lshrrev_b32 v7, 1, v3
v_mfma_f32_32x32x16_bf16 v[148:163], a[148:151], a[120:123], v[148:163]
ds_read_b128 a[144:147], v206 offset:0
v_lshl_add_u32 v6, v7, 13, v6
v_mfma_f32_32x32x16_bf16 v[148:163], a[152:155], a[124:127], v[148:163]
ds_read_b128 a[148:151], v206 offset:1024
v_add_u32 v7, 4096, v6
v_mfma_f32_32x32x16_bf16 v[148:163], a[156:159], a[128:131], v[148:163]
ds_read_b128 a[152:155], v206 offset:2048
s_mul_i32 s30, s24, 9728
s_waitcnt lgkmcnt(3)
v_mfma_f32_32x32x16_bf16 v[148:163], a[160:163], a[132:135], v[148:163]
ds_read_b128 a[156:159], v206 offset:3072
s_add_u32 s30, s30, 0
v_mfma_f32_32x32x16_bf16 v[148:163], a[164:167], a[136:139], v[148:163]
ds_read_b128 a[160:163], v206 offset:4096
v_bfe_u32 v8, v1, 4, 5
v_mfma_f32_32x32x16_bf16 v[148:163], a[168:171], a[140:143], v[148:163]
ds_read_b128 a[164:167], v206 offset:5120
v_mul_u32_u24 v233, 304, v8
v_mfma_f32_32x32x16_bf16 v[148:163], a[172:175], v[212:215], v[148:163]
ds_read_b128 a[168:171], v206 offset:6144
v_add_u32 v233, s30, v233
s_barrier
s_waitcnt lgkmcnt(3)
v_mfma_f32_32x32x16_bf16 v[164:179], a[144:147], a[0:3], 0
ds_read_b128 a[172:175], v206 offset:7168
v_lshrrev_b32 v8, 1, v3
v_mfma_f32_32x32x16_bf16 v[164:179], a[148:151], a[4:7], v[164:179]
ds_read_b128 a[144:147], v206 offset:8192
v_lshl_add_u32 v235, v8, 4, v233
v_mfma_f32_32x32x16_bf16 v[164:179], a[152:155], a[8:11], v[164:179]
ds_read_b128 a[148:151], v206 offset:9216
v_lshl_add_u32 v233, v8, 5, v233
v_mfma_f32_32x32x16_bf16 v[164:179], a[156:159], a[12:15], v[164:179]
ds_read_b128 a[152:155], v206 offset:10240
v_lshrrev_b32 v8, 2, v2
s_waitcnt lgkmcnt(3)
v_mfma_f32_32x32x16_bf16 v[164:179], a[160:163], a[16:19], v[164:179]
ds_read_b128 a[156:159], v206 offset:11264
v_lshl_add_u32 v8, v3, 3, v8
v_mfma_f32_32x32x16_bf16 v[164:179], a[164:167], a[20:23], v[164:179]
ds_read_b128 a[160:163], v206 offset:12288
v_mul_u32_u24 v234, 304, v8
v_mfma_f32_32x32x16_bf16 v[164:179], a[168:171], a[24:27], v[164:179]
ds_read_b128 a[164:167], v206 offset:13312
v_and_b32 v8, 3, v2
v_mfma_f32_32x32x16_bf16 v[164:179], a[172:175], a[28:31], v[164:179]
ds_read_b128 a[168:171], v206 offset:14336
v_lshl_add_u32 v234, v8, 3, v234
s_waitcnt lgkmcnt(3)
v_mfma_f32_32x32x16_bf16 v[164:179], a[144:147], a[32:35], v[164:179]
ds_read_b128 a[172:175], v206 offset:15360
v_add_u32 v234, s30, v234
v_mfma_f32_32x32x16_bf16 v[164:179], a[148:151], a[36:39], v[164:179]
ds_read_b128 a[144:147], v206 offset:16384
s_mul_i32 s62, s26, 589824
v_mfma_f32_32x32x16_bf16 v[164:179], a[152:155], a[40:43], v[164:179]
ds_read_b128 a[148:151], v206 offset:17408
s_mul_i32 s31, s60, 9216
v_mfma_f32_32x32x16_bf16 v[164:179], a[156:159], a[44:47], v[164:179]
ds_read_b128 a[152:155], v206 offset:18432
s_add_u32 s62, s62, s31
s_waitcnt lgkmcnt(3)
v_mfma_f32_32x32x16_bf16 v[164:179], a[160:163], a[48:51], v[164:179]
ds_read_b128 a[156:159], v206 offset:19456
s_add_u32 s62, s62, 7340032
v_mfma_f32_32x32x16_bf16 v[164:179], a[164:167], a[52:55], v[164:179]
ds_read_b128 a[160:163], v206 offset:20480
v_mov_b32 v202, 3212836864
v_mfma_f32_32x32x16_bf16 v[164:179], a[168:171], a[56:59], v[164:179]
ds_read_b128 a[164:167], v206 offset:21504
v_mfma_f32_32x32x16_bf16 v[164:179], a[172:175], a[60:63], v[164:179]
ds_read_b128 a[168:171], v206 offset:22528
buffer_load_dwordx2 v[180:181], v6, s[8:11], s61 offen offset:0 sc1
s_waitcnt lgkmcnt(3)
v_mfma_f32_32x32x16_bf16 v[164:179], a[144:147], a[64:67], v[164:179]
ds_read_b128 a[172:175], v206 offset:23552
buffer_load_dwordx2 v[182:183], v6, s[8:11], s61 offen offset:1024 sc1
v_mfma_f32_32x32x16_bf16 v[164:179], a[148:151], a[68:71], v[164:179]
ds_read_b128 a[144:147], v206 offset:24576
buffer_load_dwordx2 v[184:185], v6, s[8:11], s61 offen offset:2048 sc1
v_mfma_f32_32x32x16_bf16 v[164:179], a[152:155], a[72:75], v[164:179]
ds_read_b128 a[148:151], v206 offset:25600
buffer_load_dwordx2 v[186:187], v6, s[8:11], s61 offen offset:3072 sc1
v_mfma_f32_32x32x16_bf16 v[164:179], a[156:159], a[76:79], v[164:179]
ds_read_b128 a[152:155], v206 offset:26624
buffer_load_dwordx2 v[188:189], v7, s[8:11], s61 offen offset:0 sc1
s_waitcnt lgkmcnt(3)
v_mfma_f32_32x32x16_bf16 v[164:179], a[160:163], a[80:83], v[164:179]
ds_read_b128 a[156:159], v206 offset:27648
buffer_load_dwordx2 v[190:191], v7, s[8:11], s61 offen offset:1024 sc1
v_mfma_f32_32x32x16_bf16 v[164:179], a[164:167], a[84:87], v[164:179]
ds_read_b128 a[160:163], v206 offset:28672
buffer_load_dwordx2 v[192:193], v7, s[8:11], s61 offen offset:2048 sc1
v_mfma_f32_32x32x16_bf16 v[164:179], a[168:171], a[88:91], v[164:179]
ds_read_b128 a[164:167], v206 offset:29696
buffer_load_dwordx2 v[194:195], v7, s[8:11], s61 offen offset:3072 sc1
v_mfma_f32_32x32x16_bf16 v[164:179], a[172:175], a[92:95], v[164:179]
ds_read_b128 a[168:171], v206 offset:30720
s_waitcnt lgkmcnt(3)
v_mfma_f32_32x32x16_bf16 v[164:179], a[144:147], a[96:99], v[164:179]
ds_read_b128 a[172:175], v206 offset:31744
v_mfma_f32_32x32x16_bf16 v[164:179], a[148:151], a[100:103], v[164:179]
ds_read_b128 a[144:147], v206 offset:32768
v_mfma_f32_32x32x16_bf16 v[164:179], a[152:155], a[104:107], v[164:179]
ds_read_b128 a[148:151], v206 offset:33792
v_mfma_f32_32x32x16_bf16 v[164:179], a[156:159], a[108:111], v[164:179]
ds_read_b128 a[152:155], v206 offset:34816
s_waitcnt lgkmcnt(3)
v_mfma_f32_32x32x16_bf16 v[164:179], a[160:163], a[112:115], v[164:179]
ds_read_b128 a[156:159], v206 offset:35840
v_mfma_f32_32x32x16_bf16 v[164:179], a[164:167], a[116:119], v[164:179]
ds_read_b128 a[160:163], v206 offset:36864
v_mfma_f32_32x32x16_bf16 v[164:179], a[168:171], a[120:123], v[164:179]
v_mfma_f32_32x32x16_bf16 v[164:179], a[172:175], a[124:127], v[164:179]
s_waitcnt lgkmcnt(1)
v_mfma_f32_32x32x16_bf16 v[164:179], a[144:147], a[128:131], v[164:179]
v_mfma_f32_32x32x16_bf16 v[164:179], a[148:151], a[132:135], v[164:179]
v_mfma_f32_32x32x16_bf16 v[164:179], a[152:155], a[136:139], v[164:179]
v_mfma_f32_32x32x16_bf16 v[164:179], a[156:159], a[140:143], v[164:179]
s_waitcnt lgkmcnt(0)
v_mfma_f32_32x32x16_bf16 v[164:179], a[160:163], v[212:215], v[164:179]
s_mov_b32 s31, 0
s_waitcnt vmcnt(0)
L_stz_7:
v_cmp_eq_u32 s[34:35], v202, v181
v_cmp_eq_u32 s[32:33], v202, v183
s_nop 0
s_or_b64 s[34:35], s[34:35], s[32:33]
v_cmp_eq_u32 s[32:33], v202, v185
s_nop 0
s_or_b64 s[34:35], s[34:35], s[32:33]
v_cmp_eq_u32 s[32:33], v202, v187
s_nop 0
s_or_b64 s[34:35], s[34:35], s[32:33]
v_cmp_eq_u32 s[32:33], v202, v189
s_nop 0
s_or_b64 s[34:35], s[34:35], s[32:33]
v_cmp_eq_u32 s[32:33], v202, v191
s_nop 0
s_or_b64 s[34:35], s[34:35], s[32:33]
v_cmp_eq_u32 s[32:33], v202, v193
s_nop 0
s_or_b64 s[34:35], s[34:35], s[32:33]
v_cmp_eq_u32 s[32:33], v202, v195
s_nop 0
s_or_b64 s[34:35], s[34:35], s[32:33]
s_cbranch_scc0 L_stzok_8
s_add_u32 s31, s31, 1
s_cmp_gt_u32 s31, 200000
s_cbranch_scc1 L_stzok_8
buffer_load_dwordx2 v[180:181], v6, s[8:11], s61 offen offset:0 sc1
buffer_load_dwordx2 v[182:183], v6, s[8:11], s61 offen offset:1024 sc1
buffer_load_dwordx2 v[184:185], v6, s[8:11], s61 offen offset:2048 sc1
buffer_load_dwordx2 v[186:187], v6, s[8:11], s61 offen offset:3072 sc1
buffer_load_dwordx2 v[188:189], v7, s[8:11], s61 offen offset:0 sc1
buffer_load_dwordx2 v[190:191], v7, s[8:11], s61 offen offset:1024 sc1
buffer_load_dwordx2 v[192:193], v7, s[8:11], s61 offen offset:2048 sc1
buffer_load_dwordx2 v[194:195], v7, s[8:11], s61 offen offset:3072 sc1
s_waitcnt vmcnt(0)
s_branch L_stz_7
L_stzok_8:
v_pk_add_f32 v[196:197], v[180:181], v[182:183]
v_pk_add_f32 v[196:197], v[196:197], v[184:185]
v_pk_add_f32 v[196:197], v[196:197], v[186:187]
v_pk_add_f32 v[196:197], v[196:197], v[188:189]
v_pk_add_f32 v[196:197], v[196:197], v[190:191]
v_pk_add_f32 v[196:197], v[196:197], v[192:193]
v_pk_add_f32 v[196:197], v[196:197], v[194:195]
v_mov_b32 v198, v196
v_mov_b32 v199, v197
s_nop 0
v_permlane32_swap_b32 v196, v198
v_permlane32_swap_b32 v197, v199
buffer_load_dwordx4 a[80:83], v1, s[4:7], s84 offen offset:2048 sc1
v_add_f32 v196, v196, v198
v_add_f32 v197, v197, v199
v_mul_f32 v196, 0x39e38e39, v196
v_mul_f32 v198, v196, v196
v_mul_f32 v197, 0x39e38e39, v197
v_sub_f32 v197, v197, v198
v_max_f32 v197, 0, v197
v_add_f32 v197, 0x3727c5ac, v197
v_rsq_f32 v198, v197
s_nop 0
v_mul_f32 v200, v196, v198
v_pk_fma_f32 v[36:37], v[36:37], v[198:199], v[200:201] op_sel_hi:[1,0,0] neg_lo:[0,0,1] neg_hi:[0,0,1]
buffer_load_dwordx4 a[84:87], v9, s[4:7], s84 offen offset:2048 sc1
v_pk_fma_f32 v[38:39], v[38:39], v[198:199], v[200:201] op_sel_hi:[1,0,0] neg_lo:[0,0,1] neg_hi:[0,0,1]
v_pk_fma_f32 v[40:41], v[40:41], v[198:199], v[200:201] op_sel_hi:[1,0,0] neg_lo:[0,0,1] neg_hi:[0,0,1]
v_pk_fma_f32 v[42:43], v[42:43], v[198:199], v[200:201] op_sel_hi:[1,0,0] neg_lo:[0,0,1] neg_hi:[0,0,1]
v_cvt_pk_bf16_f32 v216, v36, v37
v_cvt_pk_bf16_f32 v217, v38, v39
v_cvt_pk_bf16_f32 v218, v40, v41
v_cvt_pk_bf16_f32 v219, v42, v43
ds_write_b128 v233, v[216:219] offset:0
v_pk_fma_f32 v[44:45], v[44:45], v[198:199], v[200:201] op_sel_hi:[1,0,0] neg_lo:[0,0,1] neg_hi:[0,0,1]
v_pk_fma_f32 v[46:47], v[46:47], v[198:199], v[200:201] op_sel_hi:[1,0,0] neg_lo:[0,0,1] neg_hi:[0,0,1]
v_pk_fma_f32 v[48:49], v[48:49], v[198:199], v[200:201] op_sel_hi:[1,0,0] neg_lo:[0,0,1] neg_hi:[0,0,1]
buffer_load_dwordx4 a[88:91], v1, s[4:7], s84 offen offset:3072 sc1
v_pk_fma_f32 v[50:51], v[50:51], v[198:199], v[200:201] op_sel_hi:[1,0,0] neg_lo:[0,0,1] neg_hi:[0,0,1]
v_cvt_pk_bf16_f32 v220, v44, v45
v_cvt_pk_bf16_f32 v221, v46, v47
v_cvt_pk_bf16_f32 v222, v48, v49
v_cvt_pk_bf16_f32 v223, v50, v51
ds_write_b128 v233, v[220:223] offset:16
v_pk_fma_f32 v[52:53], v[52:53], v[198:199], v[200:201] op_sel_hi:[1,0,0] neg_lo:[0,0,1] neg_hi:[0,0,1]
v_pk_fma_f32 v[54:55], v[54:55], v[198:199], v[200:201] op_sel_hi:[1,0,0] neg_lo:[0,0,1] neg_hi:[0,0,1]
v_pk_fma_f32 v[56:57], v[56:57], v[198:199], v[200:201] op_sel_hi:[1,0,0] neg_lo:[0,0,1] neg_hi:[0,0,1]
v_pk_fma_f32 v[58:59], v[58:59], v[198:199], v[200:201] op_sel_hi:[1,0,0] neg_lo:[0,0,1] neg_hi:[0,0,1]
v_cvt_pk_bf16_f32 v224, v52, v53
v_cvt_pk_bf16_f32 v225, v54, v55
buffer_load_dwordx4 a[92:95], v9, s[4:7], s84 offen offset:3072 sc1
v_cvt_pk_bf16_f32 v226, v56, v57
v_cvt_pk_bf16_f32 v227, v58, v59
ds_write_b128 v233, v[224:227] offset:64
v_pk_fma_f32 v[60:61], v[60:61], v[198:199], v[200:201] op_sel_hi:[1,0,0] neg_lo:[0,0,1] neg_hi:[0,0,1]
v_pk_fma_f32 v[62:63], v[62:63], v[198:199], v[200:201] op_sel_hi:[1,0,0] neg_lo:[0,0,1] neg_hi:[0,0,1]
v_pk_fma_f32 v[64:65], v[64:65], v[198:199], v[200:201] op_sel_hi:[1,0,0] neg_lo:[0,0,1] neg_hi:[0,0,1]
v_pk_fma_f32 v[66:67], v[66:67], v[198:199], v[200:201] op_sel_hi:[1,0,0] neg_lo:[0,0,1] neg_hi:[0,0,1]
v_cvt_pk_bf16_f32 v228, v60, v61
v_cvt_pk_bf16_f32 v229, v62, v63
v_cvt_pk_bf16_f32 v230, v64, v65
v_cvt_pk_bf16_f32 v231, v66, v67
s_add_u32 s84, s84, 4096
ds_write_b128 v233, v[228:231] offset:80
v_pk_fma_f32 v[68:69], v[68:69], v[198:199], v[200:201] op_sel_hi:[1,0,0] neg_lo:[0,0,1] neg_hi:[0,0,1]
v_pk_fma_f32 v[70:71], v[70:71], v[198:199], v[200:201] op_sel_hi:[1,0,0] neg_lo:[0,0,1] neg_hi:[0,0,1]
v_pk_fma_f32 v[72:73], v[72:73], v[198:199], v[200:201] op_sel_hi:[1,0,0] neg_lo:[0,0,1] neg_hi:[0,0,1]
v_pk_fma_f32 v[74:75], v[74:75], v[198:199], v[200:201] op_sel_hi:[1,0,0] neg_lo:[0,0,1] neg_hi:[0,0,1]
v_cvt_pk_bf16_f32 v216, v68, v69
v_cvt_pk_bf16_f32 v217, v70, v71
v_cvt_pk_bf16_f32 v218, v72, v73
v_cvt_pk_bf16_f32 v219, v74, v75
ds_write_b128 v233, v[216:219] offset:128
v_pk_fma_f32 v[76:77], v[76:77], v[198:199], v[200:201] op_sel_hi:[1,0,0] neg_lo:[0,0,1] neg_hi:[0,0,1]
v_pk_fma_f32 v[78:79], v[78:79], v[198:199], v[200:201] op_sel_hi:[1,0,0] neg_lo:[0,0,1] neg_hi:[0,0,1]
buffer_load_dwordx4 a[96:99], v1, s[4:7], s84 offen offset:0 sc1
v_pk_fma_f32 v[80:81], v[80:81], v[198:199], v[200:201] op_sel_hi:[1,0,0] neg_lo:[0,0,1] neg_hi:[0,0,1]
v_pk_fma_f32 v[82:83], v[82:83], v[198:199], v[200:201] op_sel_hi:[1,0,0] neg_lo:[0,0,1] neg_hi:[0,0,1]
v_cvt_pk_bf16_f32 v220, v76, v77
v_cvt_pk_bf16_f32 v221, v78, v79
v_cvt_pk_bf16_f32 v222, v80, v81
v_cvt_pk_bf16_f32 v223, v82, v83
ds_write_b128 v233, v[220:223] offset:144
v_pk_fma_f32 v[84:85], v[84:85], v[198:199], v[200:201] op_sel_hi:[1,0,0] neg_lo:[0,0,1] neg_hi:[0,0,1]
v_pk_fma_f32 v[86:87], v[86:87], v[198:199], v[200:201] op_sel_hi:[1,0,0] neg_lo:[0,0,1] neg_hi:[0,0,1]
v_pk_fma_f32 v[88:89], v[88:89], v[198:199], v[200:201] op_sel_hi:[1,0,0] neg_lo:[0,0,1] neg_hi:[0,0,1]
v_pk_fma_f32 v[90:91], v[90:91], v[198:199], v[200:201] op_sel_hi:[1,0,0] neg_lo:[0,0,1] neg_hi:[0,0,1]
buffer_load_dwordx4 a[100:103], v9, s[4:7], s84 offen offset:0 sc1
v_cvt_pk_bf16_f32 v224, v84, v85
v_cvt_pk_bf16_f32 v225, v86, v87
v_cvt_pk_bf16_f32 v226, v88, v89
v_cvt_pk_bf16_f32 v227, v90, v91
ds_write_b128 v233, v[224:227] offset:192
v_pk_fma_f32 v[92:93], v[92:93], v[198:199], v[200:201] op_sel_hi:[1,0,0] neg_lo:[0,0,1] neg_hi:[0,0,1]
v_pk_fma_f32 v[94:95], v[94:95], v[198:199], v[200:201] op_sel_hi:[1,0,0] neg_lo:[0,0,1] neg_hi:[0,0,1]
v_pk_fma_f32 v[96:97], v[96:97], v[198:199], v[200:201] op_sel_hi:[1,0,0] neg_lo:[0,0,1] neg_hi:[0,0,1]
v_pk_fma_f32 v[98:99], v[98:99], v[198:199], v[200:201] op_sel_hi:[1,0,0] neg_lo:[0,0,1] neg_hi:[0,0,1]
v_cvt_pk_bf16_f32 v228, v92, v93
v_cvt_pk_bf16_f32 v229, v94, v95
v_cvt_pk_bf16_f32 v230, v96, v97
buffer_load_dwordx4 a[104:107], v1, s[4:7], s84 offen offset:1024 sc1
v_cvt_pk_bf16_f32 v231, v98, v99
ds_write_b128 v233, v[228:231] offset:208
v_pk_fma_f32 v[100:101], v[100:101], v[198:199], v[200:201] op_sel_hi:[1,0,0] neg_lo:[0,0,1] neg_hi:[0,0,1]
v_pk_fma_f32 v[102:103], v[102:103], v[198:199], v[200:201] op_sel_hi:[1,0,0] neg_lo:[0,0,1] neg_hi:[0,0,1]
v_pk_fma_f32 v[104:105], v[104:105], v[198:199], v[200:201] op_sel_hi:[1,0,0] neg_lo:[0,0,1] neg_hi:[0,0,1]
v_pk_fma_f32 v[106:107], v[106:107], v[198:199], v[200:201] op_sel_hi:[1,0,0] neg_lo:[0,0,1] neg_hi:[0,0,1]
v_cvt_pk_bf16_f32 v216, v100, v101
v_cvt_pk_bf16_f32 v217, v102, v103
v_cvt_pk_bf16_f32 v218, v104, v105
v_cvt_pk_bf16_f32 v219, v106, v107
ds_write_b128 v235, v[216:219] offset:256
buffer_load_dwordx4 a[108:111], v9, s[4:7], s84 offen offset:1024 sc1
s_waitcnt lgkmcnt(0)
ds_read_b64_tr_b16 v[36:37], v234 offset:0
ds_read_b64_tr_b16 v[38:39], v234 offset:1216
ds_read_b64_tr_b16 v[40:41], v234 offset:32
ds_read_b64_tr_b16 v[42:43], v234 offset:1248
ds_read_b64_tr_b16 v[44:45], v234 offset:64
ds_read_b64_tr_b16 v[46:47], v234 offset:1280
ds_read_b64_tr_b16 v[48:49], v234 offset:96
ds_read_b64_tr_b16 v[50:51], v234 offset:1312
s_waitcnt lgkmcnt(6)
buffer_store_dwordx4 v[36:39], v1, s[8:11], s62 offen offset:0 sc1
ds_read_b64_tr_b16 v[52:53], v234 offset:128
ds_read_b64_tr_b16 v[54:55], v234 offset:1344
s_waitcnt lgkmcnt(6)
buffer_store_dwordx4 v[40:43], v1, s[8:11], s62 offen offset:1024 sc1
ds_read_b64_tr_b16 v[56:57], v234 offset:160
ds_read_b64_tr_b16 v[58:59], v234 offset:1376
s_waitcnt lgkmcnt(6)
buffer_store_dwordx4 v[44:47], v1, s[8:11], s62 offen offset:2048 sc1
ds_read_b64_tr_b16 v[60:61], v234 offset:192
ds_read_b64_tr_b16 v[62:63], v234 offset:1408
s_waitcnt lgkmcnt(6)
buffer_store_dwordx4 v[48:51], v1, s[8:11], s62 offen offset:3072 sc1
ds_read_b64_tr_b16 v[64:65], v234 offset:224
ds_read_b64_tr_b16 v[66:67], v234 offset:1440
s_add_u32 s62, s62, 4096
s_waitcnt lgkmcnt(6)
buffer_store_dwordx4 v[52:55], v1, s[8:11], s62 offen offset:0 sc1
ds_read_b64_tr_b16 v[68:69], v234 offset:256
ds_read_b64_tr_b16 v[70:71], v234 offset:1472
s_waitcnt lgkmcnt(6)
buffer_store_dwordx4 v[56:59], v1, s[8:11], s62 offen offset:1024 sc1
s_waitcnt lgkmcnt(4)
buffer_store_dwordx4 v[60:63], v1, s[8:11], s62 offen offset:2048 sc1
s_waitcnt lgkmcnt(2)
buffer_store_dwordx4 v[64:67], v1, s[8:11], s62 offen offset:3072 sc1
s_add_u32 s62, s62, 4096
s_waitcnt lgkmcnt(0)
buffer_store_dwordx4 v[68:71], v1, s[8:11], s62 offen offset:0 sc1
L_c4:
buffer_load_dwordx4 a[112:115], v1, s[4:7], s84 offen offset:2048 sc1
buffer_load_dwordx4 a[116:119], v9, s[4:7], s84 offen offset:2048 sc1
buffer_load_dwordx4 a[120:123], v1, s[4:7], s84 offen offset:3072 sc1
buffer_load_dwordx4 a[124:127], v9, s[4:7], s84 offen offset:3072 sc1
s_add_u32 s84, s84, 4096
buffer_load_dwordx4 a[128:131], v1, s[4:7], s84 offen offset:0 sc1
buffer_load_dwordx4 a[132:135], v9, s[4:7], s84 offen offset:0 sc1
buffer_load_dwordx4 a[136:139], v1, s[4:7], s84 offen offset:1024 sc1
buffer_load_dwordx4 a[140:143], v9, s[4:7], s84 offen offset:1024 sc1
s_waitcnt vmcnt(8)
s_barrier
s_cmp_eq_u32 s24, 0
s_cbranch_scc0 L_sig_9
v_lshlrev_b32 v6, 7, v1
s_lshl_b32 s31, s26, 7
s_lshl_b32 s32, s25, 2
s_add_u32 s31, s31, s32
v_add_u32 v6, s31, v6
s_mov_b64 exec, 0xffff
s_mov_b32 s30, 26542080
buffer_store_dword v4, v6, s[8:11], s30 offen sc1
s_mov_b64 exec, -1
L_sig_9:
buffer_load_dwordx4 a[144:147], v1, s[4:7], s84 offen offset:2048 sc1
buffer_load_dwordx4 a[148:151], v9, s[4:7], s84 offen offset:2048 sc1
buffer_load_dwordx4 a[152:155], v1, s[4:7], s84 offen offset:3072 sc1
buffer_load_dwordx4 a[156:159], v9, s[4:7], s84 offen offset:3072 sc1
s_add_u32 s84, s84, 4096
buffer_load_dwordx4 a[160:163], v1, s[4:7], s84 offen offset:0 sc1
buffer_load_dwordx4 a[164:167], v9, s[4:7], s84 offen offset:0 sc1
buffer_load_dwordx4 a[168:171], v1, s[4:7], s84 offen offset:1024 sc1
buffer_load_dwordx4 a[172:175], v9, s[4:7], s84 offen offset:1024 sc1
s_lshl_b32 s31, s25, 8
s_lshl_b32 s32, s24, 6
s_add_u32 s31, s31, s32
v_lshlrev_b32 v8, 1, v2
buffer_load_ushort v180, v8, s[20:23], s31 offen
buffer_load_ushort v181, v8, s[20:23], s31 offen offset:32
s_cmp_eq_u32 s24, 1
s_cbranch_scc0 L_polled_11
s_lshl_b32 s30, s80, 7
s_add_u32 s30, s30, 26542080
v_lshrrev_b32 v6, 2, v1
s_mov_b32 s31, 0
s_mov_b64 exec, 0xffff
L_poll_10:
buffer_load_dword v7, v6, s[8:11], s30 offen sc1
s_add_u32 s31, s31, 1
s_waitcnt vmcnt(0)
v_cmp_ne_u32 vcc, 1, v7
s_cmp_gt_u32 s31, 200000
s_cbranch_scc1 L_polled_11
s_cbranch_vccnz L_poll_10
L_polled_11:
s_mov_b64 exec, -1
s_waitcnt vmcnt(0)
s_barrier
s_mul_i32 s30, s26, 589824
s_add_u32 s30, s30, 7340032
s_lshl_b32 s62, s24, 12
s_lshl_b32 s63, s24, 10
s_add_u32 s60, s30, s62
s_add_u32 s61, s30, s63
s_add_u32 s61, s61, 16384
s_add_u32 m0, s62, 90112
s_add_u32 s60, s60, 0
buffer_load_dwordx4 v1, s[8:11], s60 offen offset:0 sc1 lds
buffer_load_dwordx4 v1, s[8:11], s60 offen offset:1024 sc1 lds
buffer_load_dwordx4 v1, s[8:11], s60 offen offset:2048 sc1 lds
buffer_load_dwordx4 v1, s[8:11], s60 offen offset:3072 sc1 lds
s_add_u32 m0, s63, 106496
s_add_u32 s61, s61, 0
buffer_load_dwordx4 v1, s[8:11], s61 offen offset:0 sc1 lds
s_add_u32 m0, s62, 110592
s_add_u32 s60, s60, 20480
buffer_load_dwordx4 v1, s[8:11], s60 offen offset:0 sc1 lds
buffer_load_dwordx4 v1, s[8:11], s60 offen offset:1024 sc1 lds
buffer_load_dwordx4 v1, s[8:11], s60 offen offset:2048 sc1 lds
buffer_load_dwordx4 v1, s[8:11], s60 offen offset:3072 sc1 lds
v_add_u32 v190, 90112, v1
v_add_u32 v191, 126976, v1
v_lshlrev_b32 v180, 16, v180
v_lshlrev_b32 v181, 16, v181
v_mov_b32 v36, v180
v_mov_b32 v37, v180
v_mov_b32 v38, v180
v_mov_b32 v39, v180
v_mov_b32 v40, v181
v_mov_b32 v41, v181
v_mov_b32 v42, v181
v_mov_b32 v43, v181
v_mov_b32 v44, v180
v_mov_b32 v45, v180
v_mov_b32 v46, v180
v_mov_b32 v47, v180
v_mov_b32 v48, v181
v_mov_b32 v49, v181
v_mov_b32 v50, v181
v_mov_b32 v51, v181
v_mov_b32 v52, v180
v_mov_b32 v53, v180
v_mov_b32 v54, v180
v_mov_b32 v55, v180
v_mov_b32 v56, v181
v_mov_b32 v57, v181
v_mov_b32 v58, v181
v_mov_b32 v59, v181
v_mov_b32 v60, v180
v_mov_b32 v61, v180
v_mov_b32 v62, v180
v_mov_b32 v63, v180
v_mov_b32 v64, v181
v_mov_b32 v65, v181
v_mov_b32 v66, v181
v_mov_b32 v67, v181
v_mov_b32 v68, v180
v_mov_b32 v69, v180
v_mov_b32 v70, v180
v_mov_b32 v71, v180
v_mov_b32 v72, v181
v_mov_b32 v73, v181
v_mov_b32 v74, v181
v_mov_b32 v75, v181
v_mov_b32 v76, v180
v_mov_b32 v77, v180
v_mov_b32 v78, v180
v_mov_b32 v79, v180
v_mov_b32 v80, v181
v_mov_b32 v81, v181
v_mov_b32 v82, v181
v_mov_b32 v83, v181
v_mov_b32 v84, v180
v_mov_b32 v85, v180
v_mov_b32 v86, v180
v_mov_b32 v87, v180
v_mov_b32 v88, v181
v_mov_b32 v89, v181
v_mov_b32 v90, v181
v_mov_b32 v91, v181
v_mov_b32 v92, v180
v_mov_b32 v93, v180
v_mov_b32 v94, v180
v_mov_b32 v95, v180
v_mov_b32 v96, v181
v_mov_b32 v97, v181
v_mov_b32 v98, v181
v_mov_b32 v99, v181
v_mov_b32 v100, v180
v_mov_b32 v101, v180
v_mov_b32 v102, v180
v_mov_b32 v103, v180
v_mov_b32 v104, v181
v_mov_b32 v105, v181
v_mov_b32 v106, v181
v_mov_b32 v107, v181
s_waitcnt vmcnt(4)
s_barrier
ds_read_b128 a[0:3], v190 offset:0
ds_read_b128 a[4:7], v190 offset:1024
ds_read_b128 a[8:11], v190 offset:2048
ds_read_b128 a[12:15], v190 offset:3072
ds_read_b128 a[16:19], v190 offset:4096
ds_read_b128 a[20:23], v190 offset:5120
ds_read_b128 a[24:27], v190 offset:6144
ds_read_b128 a[28:31], v190 offset:7168
ds_read_b128 a[32:35], v190 offset:8192
s_waitcnt lgkmcnt(0)
v_mfma_f32_16x16x32_bf16 v[36:39], a[0:3], a[176:179], v[36:39]
ds_read_b128 a[36:39], v190 offset:9216
s_add_u32 m0, s62, 126976
v_mul_f32 v182, v108, v108
v_mfma_f32_16x16x32_bf16 v[40:43], a[0:3], a[180:183], v[40:43]
ds_read_b128 a[40:43], v190 offset:10240
s_add_u32 s60, s60, 16384
v_mul_f32 v183, v109, v109
v_mfma_f32_16x16x32_bf16 v[44:47], a[4:7], a[176:179], v[44:47]
ds_read_b128 a[44:47], v190 offset:11264
v_mul_f32 v184, v110, v110
v_mfma_f32_16x16x32_bf16 v[48:51], a[4:7], a[180:183], v[48:51]
ds_read_b128 a[48:51], v190 offset:12288
v_mfma_f32_16x16x32_bf16 v[52:55], a[8:11], a[176:179], v[52:55]
ds_read_b128 a[52:55], v190 offset:13312
v_mul_f32 v185, v111, v111
v_mfma_f32_16x16x32_bf16 v[56:59], a[8:11], a[180:183], v[56:59]
ds_read_b128 a[56:59], v190 offset:14336
buffer_load_dwordx4 v1, s[8:11], s60 offen offset:0 sc1 lds
v_mfma_f32_16x16x32_bf16 v[60:63], a[12:15], a[176:179], v[60:63]
ds_read_b128 a[60:63], v190 offset:15360
v_fma_f32 v182, v182, v254, v253
v_mfma_f32_16x16x32_bf16 v[64:67], a[12:15], a[180:183], v[64:67]
ds_read_b128 a[64:67], v190 offset:16384
v_fma_f32 v183, v183, v254, v253
v_mfma_f32_16x16x32_bf16 v[68:71], a[16:19], a[176:179], v[68:71]
ds_read_b128 a[68:71], v190 offset:17408
buffer_load_dwordx4 v1, s[8:11], s60 offen offset:1024 sc1 lds
v_mfma_f32_16x16x32_bf16 v[72:75], a[16:19], a[180:183], v[72:75]
v_fma_f32 v184, v184, v254, v253
v_mfma_f32_16x16x32_bf16 v[76:79], a[20:23], a[176:179], v[76:79]
v_fma_f32 v185, v185, v254, v253
v_mfma_f32_16x16x32_bf16 v[80:83], a[20:23], a[180:183], v[80:83]
buffer_load_dwordx4 v1, s[8:11], s60 offen offset:2048 sc1 lds
v_mul_f32 v182, v182, v108
v_mfma_f32_16x16x32_bf16 v[84:87], a[24:27], a[176:179], v[84:87]
v_mfma_f32_16x16x32_bf16 v[88:91], a[24:27], a[180:183], v[88:91]
v_mul_f32 v183, v183, v109
v_mfma_f32_16x16x32_bf16 v[92:95], a[28:31], a[176:179], v[92:95]
buffer_load_dwordx4 v1, s[8:11], s60 offen offset:3072 sc1 lds
v_mul_f32 v184, v184, v110
v_mfma_f32_16x16x32_bf16 v[96:99], a[28:31], a[180:183], v[96:99]
v_mfma_f32_16x16x32_bf16 v[100:103], a[32:35], a[176:179], v[100:103]
v_mul_f32 v185, v185, v111
v_mfma_f32_16x16x32_bf16 v[104:107], a[32:35], a[180:183], v[104:107]
s_waitcnt vmcnt(4)
s_waitcnt lgkmcnt(0)
s_barrier
v_mfma_f32_16x16x32_bf16 v[36:39], a[36:39], a[184:187], v[36:39]
ds_read_b128 a[0:3], v190 offset:18432
s_add_u32 m0, s63, 143360
v_mfma_f32_16x16x32_bf16 v[40:43], a[36:39], a[188:191], v[40:43]
ds_read_b128 a[4:7], v190 offset:19456
s_add_u32 s61, s61, 36864
v_mfma_f32_16x16x32_bf16 v[44:47], a[40:43], a[184:187], v[44:47]
ds_read_b128 a[8:11], v190 offset:20480
v_mfma_f32_16x16x32_bf16 v[48:51], a[40:43], a[188:191], v[48:51]
ds_read_b128 a[12:15], v190 offset:21504
v_mfma_f32_16x16x32_bf16 v[52:55], a[44:47], a[184:187], v[52:55]
ds_read_b128 a[16:19], v190 offset:22528
buffer_load_dwordx4 v1, s[8:11], s61 offen offset:0 sc1 lds
s_add_u32 m0, s62, 147456
v_mfma_f32_16x16x32_bf16 v[56:59], a[44:47], a[188:191], v[56:59]
ds_read_b128 a[20:23], v190 offset:23552
s_add_u32 s60, s60, 20480
v_mfma_f32_16x16x32_bf16 v[60:63], a[48:51], a[184:187], v[60:63]
ds_read_b128 a[24:27], v190 offset:24576
v_mfma_f32_16x16x32_bf16 v[64:67], a[48:51], a[188:191], v[64:67]
ds_read_b128 a[28:31], v190 offset:25600
v_mfma_f32_16x16x32_bf16 v[68:71], a[52:55], a[184:187], v[68:71]
ds_read_b128 a[32:35], v190 offset:26624
v_mfma_f32_16x16x32_bf16 v[72:75], a[52:55], a[188:191], v[72:75]
v_exp_f32 v182, v182
v_mfma_f32_16x16x32_bf16 v[76:79], a[56:59], a[184:187], v[76:79]
buffer_load_dwordx4 v1, s[8:11], s60 offen offset:0 sc1 lds
v_mfma_f32_16x16x32_bf16 v[80:83], a[56:59], a[188:191], v[80:83]
v_exp_f32 v183, v183
v_mfma_f32_16x16x32_bf16 v[84:87], a[60:63], a[184:187], v[84:87]
buffer_load_dwordx4 v1, s[8:11], s60 offen offset:1024 sc1 lds
v_mfma_f32_16x16x32_bf16 v[88:91], a[60:63], a[188:191], v[88:91]
v_exp_f32 v184, v184
v_mfma_f32_16x16x32_bf16 v[92:95], a[64:67], a[184:187], v[92:95]
buffer_load_dwordx4 v1, s[8:11], s60 offen offset:2048 sc1 lds
v_mfma_f32_16x16x32_bf16 v[96:99], a[64:67], a[188:191], v[96:99]
v_exp_f32 v185, v185
v_mfma_f32_16x16x32_bf16 v[100:103], a[68:71], a[184:187], v[100:103]
v_fma_f32 v182, v182, v255, v255
v_fma_f32 v183, v183, v255, v255
v_mfma_f32_16x16x32_bf16 v[104:107], a[68:71], a[188:191], v[104:107]
v_fma_f32 v184, v184, v255, v255
s_waitcnt lgkmcnt(0)
v_mfma_f32_16x16x32_bf16 v[36:39], a[0:3], a[192:195], v[36:39]
ds_read_b128 a[36:39], v190 offset:27648
buffer_load_dwordx4 v1, s[8:11], s60 offen offset:3072 sc1 lds
s_add_u32 m0, s62, 90112
v_mfma_f32_16x16x32_bf16 v[40:43], a[0:3], a[196:199], v[40:43]
ds_read_b128 a[40:43], v190 offset:28672
s_add_u32 s60, s60, 16384
v_fma_f32 v185, v185, v255, v255
v_mfma_f32_16x16x32_bf16 v[44:47], a[4:7], a[192:195], v[44:47]
ds_read_b128 a[44:47], v190 offset:29696
v_mfma_f32_16x16x32_bf16 v[48:51], a[4:7], a[196:199], v[48:51]
ds_read_b128 a[48:51], v190 offset:30720
v_mfma_f32_16x16x32_bf16 v[52:55], a[8:11], a[192:195], v[52:55]
ds_read_b128 a[52:55], v190 offset:31744
v_mfma_f32_16x16x32_bf16 v[56:59], a[8:11], a[196:199], v[56:59]
ds_read_b128 a[56:59], v190 offset:32768
v_mfma_f32_16x16x32_bf16 v[60:63], a[12:15], a[192:195], v[60:63]
ds_read_b128 a[60:63], v190 offset:33792
v_mfma_f32_16x16x32_bf16 v[64:67], a[12:15], a[196:199], v[64:67]
ds_read_b128 a[64:67], v190 offset:34816
v_mfma_f32_16x16x32_bf16 v[68:71], a[16:19], a[192:195], v[68:71]
ds_read_b128 a[68:71], v190 offset:35840
buffer_load_dwordx4 v1, s[8:11], s60 offen offset:0 sc1 lds
v_mfma_f32_16x16x32_bf16 v[72:75], a[16:19], a[196:199], v[72:75]
v_rcp_f32 v182, v182
v_mfma_f32_16x16x32_bf16 v[76:79], a[20:23], a[192:195], v[76:79]
v_rcp_f32 v183, v183
v_mfma_f32_16x16x32_bf16 v[80:83], a[20:23], a[196:199], v[80:83]
buffer_load_dwordx4 v1, s[8:11], s60 offen offset:1024 sc1 lds
v_mfma_f32_16x16x32_bf16 v[84:87], a[24:27], a[192:195], v[84:87]
v_rcp_f32 v184, v184
v_mfma_f32_16x16x32_bf16 v[88:91], a[24:27], a[196:199], v[88:91]
v_rcp_f32 v185, v185
v_mfma_f32_16x16x32_bf16 v[92:95], a[28:31], a[192:195], v[92:95]
buffer_load_dwordx4 v1, s[8:11], s60 offen offset:2048 sc1 lds
v_mul_f32 v108, v108, v182
v_mfma_f32_16x16x32_bf16 v[96:99], a[28:31], a[196:199], v[96:99]
v_mul_f32 v109, v109, v183
v_mul_f32 v110, v110, v184
v_mfma_f32_16x16x32_bf16 v[100:103], a[32:35], a[192:195], v[100:103]
v_mul_f32 v111, v111, v185
v_mul_f32 v186, v112, v112
v_mfma_f32_16x16x32_bf16 v[104:107], a[32:35], a[196:199], v[104:107]
s_waitcnt vmcnt(7)
s_waitcnt lgkmcnt(0)
s_barrier
v_mfma_f32_16x16x32_bf16 v[36:39], a[36:39], a[200:203], v[36:39]
ds_read_b128 a[0:3], v191 offset:0
buffer_load_dwordx4 v1, s[8:11], s60 offen offset:3072 sc1 lds
s_add_u32 m0, s63, 106496
v_mfma_f32_16x16x32_bf16 v[40:43], a[36:39], a[204:207], v[40:43]
ds_read_b128 a[4:7], v191 offset:1024
s_add_u32 s61, s61, 36864
v_mul_f32 v187, v113, v113
v_mfma_f32_16x16x32_bf16 v[44:47], a[40:43], a[200:203], v[44:47]
ds_read_b128 a[8:11], v191 offset:2048
v_mul_f32 v188, v114, v114
v_mfma_f32_16x16x32_bf16 v[48:51], a[40:43], a[204:207], v[48:51]
ds_read_b128 a[12:15], v191 offset:3072
v_mul_f32 v189, v115, v115
v_mfma_f32_16x16x32_bf16 v[52:55], a[44:47], a[200:203], v[52:55]
ds_read_b128 a[16:19], v191 offset:4096
v_fma_f32 v186, v186, v254, v253
v_mfma_f32_16x16x32_bf16 v[56:59], a[44:47], a[204:207], v[56:59]
ds_read_b128 a[20:23], v191 offset:5120
v_fma_f32 v187, v187, v254, v253
v_mfma_f32_16x16x32_bf16 v[60:63], a[48:51], a[200:203], v[60:63]
ds_read_b128 a[24:27], v191 offset:6144
buffer_load_dwordx4 v1, s[8:11], s61 offen offset:0 sc1 lds
s_add_u32 m0, s62, 110592
v_mfma_f32_16x16x32_bf16 v[64:67], a[48:51], a[204:207], v[64:67]
ds_read_b128 a[28:31], v191 offset:7168
s_add_u32 s60, s60, 20480
v_fma_f32 v188, v188, v254, v253
v_mfma_f32_16x16x32_bf16 v[68:71], a[52:55], a[200:203], v[68:71]
ds_read_b128 a[32:35], v191 offset:8192
v_fma_f32 v189, v189, v254, v253
v_mfma_f32_16x16x32_bf16 v[72:75], a[52:55], a[204:207], v[72:75]
v_mfma_f32_16x16x32_bf16 v[76:79], a[56:59], a[200:203], v[76:79]
v_mul_f32 v186, v186, v112
v_mfma_f32_16x16x32_bf16 v[80:83], a[56:59], a[204:207], v[80:83]
v_mul_f32 v187, v187, v113
v_mfma_f32_16x16x32_bf16 v[84:87], a[60:63], a[200:203], v[84:87]
buffer_load_dwordx4 v1, s[8:11], s60 offen offset:0 sc1 lds
v_mfma_f32_16x16x32_bf16 v[88:91], a[60:63], a[204:207], v[88:91]
v_mul_f32 v188, v188, v114
v_mfma_f32_16x16x32_bf16 v[92:95], a[64:67], a[200:203], v[92:95]
buffer_load_dwordx4 v1, s[8:11], s60 offen offset:1024 sc1 lds
v_mul_f32 v189, v189, v115
v_mfma_f32_16x16x32_bf16 v[96:99], a[64:67], a[204:207], v[96:99]
v_mfma_f32_16x16x32_bf16 v[100:103], a[68:71], a[200:203], v[100:103]
v_exp_f32 v186, v186
v_mfma_f32_16x16x32_bf16 v[104:107], a[68:71], a[204:207], v[104:107]
s_waitcnt lgkmcnt(0)
v_mfma_f32_16x16x32_bf16 v[36:39], a[0:3], a[208:211], v[36:39]
ds_read_b128 a[36:39], v191 offset:9216
buffer_load_dwordx4 v1, s[8:11], s60 offen offset:2048 sc1 lds
v_mfma_f32_16x16x32_bf16 v[40:43], a[0:3], a[212:215], v[40:43]
ds_read_b128 a[40:43], v191 offset:10240
v_mfma_f32_16x16x32_bf16 v[44:47], a[4:7], a[208:211], v[44:47]
ds_read_b128 a[44:47], v191 offset:11264
v_mfma_f32_16x16x32_bf16 v[48:51], a[4:7], a[212:215], v[48:51]
ds_read_b128 a[48:51], v191 offset:12288
v_mfma_f32_16x16x32_bf16 v[52:55], a[8:11], a[208:211], v[52:55]
ds_read_b128 a[52:55], v191 offset:13312
buffer_load_dwordx4 v1, s[8:11], s60 offen offset:3072 sc1 lds
v_mfma_f32_16x16x32_bf16 v[56:59], a[8:11], a[212:215], v[56:59]
ds_read_b128 a[56:59], v191 offset:14336
v_mfma_f32_16x16x32_bf16 v[60:63], a[12:15], a[208:211], v[60:63]
ds_read_b128 a[60:63], v191 offset:15360
v_mfma_f32_16x16x32_bf16 v[64:67], a[12:15], a[212:215], v[64:67]
ds_read_b128 a[64:67], v191 offset:16384
v_mfma_f32_16x16x32_bf16 v[68:71], a[16:19], a[208:211], v[68:71]
ds_read_b128 a[68:71], v191 offset:17408
buffer_load_dwordx4 a[176:179], v1, s[4:7], s84 offen offset:2048 sc1
v_mfma_f32_16x16x32_bf16 v[72:75], a[16:19], a[212:215], v[72:75]
v_exp_f32 v187, v187
v_mfma_f32_16x16x32_bf16 v[76:79], a[20:23], a[208:211], v[76:79]
v_exp_f32 v188, v188
v_mfma_f32_16x16x32_bf16 v[80:83], a[20:23], a[212:215], v[80:83]
v_exp_f32 v189, v189
v_mfma_f32_16x16x32_bf16 v[84:87], a[24:27], a[208:211], v[84:87]
buffer_load_dwordx4 a[180:183], v9, s[4:7], s84 offen offset:2048 sc1
v_fma_f32 v186, v186, v255, v255
v_mfma_f32_16x16x32_bf16 v[88:91], a[24:27], a[212:215], v[88:91]
v_fma_f32 v187, v187, v255, v255
v_fma_f32 v188, v188, v255, v255
v_mfma_f32_16x16x32_bf16 v[92:95], a[28:31], a[208:211], v[92:95]
v_fma_f32 v189, v189, v255, v255
v_mfma_f32_16x16x32_bf16 v[96:99], a[28:31], a[212:215], v[96:99]
v_rcp_f32 v186, v186
v_mfma_f32_16x16x32_bf16 v[100:103], a[32:35], a[208:211], v[100:103]
v_mfma_f32_16x16x32_bf16 v[104:107], a[32:35], a[212:215], v[104:107]
s_waitcnt vmcnt(11)
s_waitcnt lgkmcnt(0)
s_barrier
v_mfma_f32_16x16x32_bf16 v[36:39], a[36:39], a[216:219], v[36:39]
ds_read_b128 a[0:3], v191 offset:18432
buffer_load_dwordx4 a[184:187], v1, s[4:7], s84 offen offset:3072 sc1
v_mfma_f32_16x16x32_bf16 v[40:43], a[36:39], a[220:223], v[40:43]
ds_read_b128 a[4:7], v191 offset:19456
v_mfma_f32_16x16x32_bf16 v[44:47], a[40:43], a[216:219], v[44:47]
ds_read_b128 a[8:11], v191 offset:20480
v_mfma_f32_16x16x32_bf16 v[48:51], a[40:43], a[220:223], v[48:51]
ds_read_b128 a[12:15], v191 offset:21504
buffer_load_dwordx4 a[188:191], v9, s[4:7], s84 offen offset:3072 sc1
s_add_u32 m0, s62, 126976
v_mfma_f32_16x16x32_bf16 v[52:55], a[44:47], a[216:219], v[52:55]
ds_read_b128 a[16:19], v191 offset:22528
s_add_u32 s60, s60, 16384
v_mfma_f32_16x16x32_bf16 v[56:59], a[44:47], a[220:223], v[56:59]
ds_read_b128 a[20:23], v191 offset:23552
v_mfma_f32_16x16x32_bf16 v[60:63], a[48:51], a[216:219], v[60:63]
ds_read_b128 a[24:27], v191 offset:24576
v_mfma_f32_16x16x32_bf16 v[64:67], a[48:51], a[220:223], v[64:67]
ds_read_b128 a[28:31], v191 offset:25600
v_mfma_f32_16x16x32_bf16 v[68:71], a[52:55], a[216:219], v[68:71]
ds_read_b128 a[32:35], v191 offset:26624
v_mfma_f32_16x16x32_bf16 v[72:75], a[52:55], a[220:223], v[72:75]
v_rcp_f32 v187, v187
v_mfma_f32_16x16x32_bf16 v[76:79], a[56:59], a[216:219], v[76:79]
v_rcp_f32 v188, v188
v_mfma_f32_16x16x32_bf16 v[80:83], a[56:59], a[220:223], v[80:83]
v_rcp_f32 v189, v189
v_mfma_f32_16x16x32_bf16 v[84:87], a[60:63], a[216:219], v[84:87]
v_mul_f32 v112, v112, v186
v_mul_f32 v113, v113, v187
v_mfma_f32_16x16x32_bf16 v[88:91], a[60:63], a[220:223], v[88:91]
buffer_load_dwordx4 v1, s[8:11], s60 offen offset:0 sc1 lds
v_mul_f32 v114, v114, v188
v_mfma_f32_16x16x32_bf16 v[92:95], a[64:67], a[216:219], v[92:95]
v_mul_f32 v115, v115, v189
v_mfma_f32_16x16x32_bf16 v[96:99], a[64:67], a[220:223], v[96:99]
v_mul_f32 v182, v116, v116
v_mfma_f32_16x16x32_bf16 v[100:103], a[68:71], a[216:219], v[100:103]
v_mul_f32 v183, v117, v117
v_mfma_f32_16x16x32_bf16 v[104:107], a[68:71], a[220:223], v[104:107]
s_waitcnt lgkmcnt(0)
v_mfma_f32_16x16x32_bf16 v[36:39], a[0:3], a[224:227], v[36:39]
ds_read_b128 a[36:39], v191 offset:27648
buffer_load_dwordx4 v1, s[8:11], s60 offen offset:1024 sc1 lds
v_mfma_f32_16x16x32_bf16 v[40:43], a[0:3], a[228:231], v[40:43]
ds_read_b128 a[40:43], v191 offset:28672
v_mul_f32 v184, v118, v118
v_mfma_f32_16x16x32_bf16 v[44:47], a[4:7], a[224:227], v[44:47]
ds_read_b128 a[44:47], v191 offset:29696
v_mul_f32 v185, v119, v119
v_mfma_f32_16x16x32_bf16 v[48:51], a[4:7], a[228:231], v[48:51]
ds_read_b128 a[48:51], v191 offset:30720
buffer_load_dwordx4 v1, s[8:11], s60 offen offset:2048 sc1 lds
v_mfma_f32_16x16x32_bf16 v[52:55], a[8:11], a[224:227], v[52:55]
ds_read_b128 a[52:55], v191 offset:31744
v_fma_f32 v182, v182, v254, v253
v_mfma_f32_16x16x32_bf16 v[56:59], a[8:11], a[228:231], v[56:59]
ds_read_b128 a[56:59], v191 offset:32768
v_fma_f32 v183, v183, v254, v253
v_mfma_f32_16x16x32_bf16 v[60:63], a[12:15], a[224:227], v[60:63]
ds_read_b128 a[60:63], v191 offset:33792
buffer_load_dwordx4 v1, s[8:11], s60 offen offset:3072 sc1 lds
s_add_u32 s84, s84, 4096
v_mfma_f32_16x16x32_bf16 v[64:67], a[12:15], a[228:231], v[64:67]
ds_read_b128 a[64:67], v191 offset:34816
v_fma_f32 v184, v184, v254, v253
v_mfma_f32_16x16x32_bf16 v[68:71], a[16:19], a[224:227], v[68:71]
ds_read_b128 a[68:71], v191 offset:35840
v_fma_f32 v185, v185, v254, v253
v_mfma_f32_16x16x32_bf16 v[72:75], a[16:19], a[228:231], v[72:75]
v_mul_f32 v182, v182, v116
v_mfma_f32_16x16x32_bf16 v[76:79], a[20:23], a[224:227], v[76:79]
v_mul_f32 v183, v183, v117
v_mfma_f32_16x16x32_bf16 v[80:83], a[20:23], a[228:231], v[80:83]
v_mul_f32 v184, v184, v118
v_mfma_f32_16x16x32_bf16 v[84:87], a[24:27], a[224:227], v[84:87]
v_mfma_f32_16x16x32_bf16 v[88:91], a[24:27], a[228:231], v[88:91]
buffer_load_dwordx4 a[192:195], v1, s[4:7], s84 offen offset:0 sc1
v_mul_f32 v185, v185, v119
v_mfma_f32_16x16x32_bf16 v[92:95], a[28:31], a[224:227], v[92:95]
v_exp_f32 v182, v182
v_mfma_f32_16x16x32_bf16 v[96:99], a[28:31], a[228:231], v[96:99]
v_mfma_f32_16x16x32_bf16 v[100:103], a[32:35], a[224:227], v[100:103]
v_mfma_f32_16x16x32_bf16 v[104:107], a[32:35], a[228:231], v[104:107]
s_waitcnt vmcnt(13)
s_waitcnt lgkmcnt(0)
s_barrier
v_mfma_f32_16x16x32_bf16 v[36:39], a[36:39], a[232:235], v[36:39]
ds_read_b128 a[0:3], v190 offset:0
buffer_load_dwordx4 a[196:199], v9, s[4:7], s84 offen offset:0 sc1
v_mfma_f32_16x16x32_bf16 v[40:43], a[36:39], a[236:239], v[40:43]
ds_read_b128 a[4:7], v190 offset:1024
v_mfma_f32_16x16x32_bf16 v[44:47], a[40:43], a[232:235], v[44:47]
ds_read_b128 a[8:11], v190 offset:2048
buffer_load_dwordx4 a[200:203], v1, s[4:7], s84 offen offset:1024 sc1
v_mfma_f32_16x16x32_bf16 v[48:51], a[40:43], a[236:239], v[48:51]
ds_read_b128 a[12:15], v190 offset:3072
v_mfma_f32_16x16x32_bf16 v[52:55], a[44:47], a[232:235], v[52:55]
ds_read_b128 a[16:19], v190 offset:4096
v_mfma_f32_16x16x32_bf16 v[56:59], a[44:47], a[236:239], v[56:59]
ds_read_b128 a[20:23], v190 offset:5120
buffer_load_dwordx4 a[204:207], v9, s[4:7], s84 offen offset:1024 sc1
s_add_u32 m0, s63, 143360
v_mfma_f32_16x16x32_bf16 v[60:63], a[48:51], a[232:235], v[60:63]
ds_read_b128 a[24:27], v190 offset:6144
s_add_u32 s61, s61, 36864
v_mfma_f32_16x16x32_bf16 v[64:67], a[48:51], a[236:239], v[64:67]
ds_read_b128 a[28:31], v190 offset:7168
v_mfma_f32_16x16x32_bf16 v[68:71], a[52:55], a[232:235], v[68:71]
ds_read_b128 a[32:35], v190 offset:8192
v_mfma_f32_16x16x32_bf16 v[72:75], a[52:55], a[236:239], v[72:75]
v_exp_f32 v183, v183
v_mfma_f32_16x16x32_bf16 v[76:79], a[56:59], a[232:235], v[76:79]
v_exp_f32 v184, v184
v_mfma_f32_16x16x32_bf16 v[80:83], a[56:59], a[236:239], v[80:83]
v_exp_f32 v185, v185
v_mfma_f32_16x16x32_bf16 v[84:87], a[60:63], a[232:235], v[84:87]
v_fma_f32 v182, v182, v255, v255
v_fma_f32 v183, v183, v255, v255
v_mfma_f32_16x16x32_bf16 v[88:91], a[60:63], a[236:239], v[88:91]
v_fma_f32 v184, v184, v255, v255
v_fma_f32 v185, v185, v255, v255
v_mfma_f32_16x16x32_bf16 v[92:95], a[64:67], a[232:235], v[92:95]
buffer_load_dwordx4 v1, s[8:11], s61 offen offset:0 sc1 lds
v_mfma_f32_16x16x32_bf16 v[96:99], a[64:67], a[236:239], v[96:99]
v_rcp_f32 v182, v182
v_mfma_f32_16x16x32_bf16 v[100:103], a[68:71], a[232:235], v[100:103]
v_mfma_f32_16x16x32_bf16 v[104:107], a[68:71], a[236:239], v[104:107]
s_waitcnt lgkmcnt(0)
v_mfma_f32_16x16x32_bf16 v[36:39], a[0:3], a[240:243], v[36:39]
ds_read_b128 a[36:39], v190 offset:9216
s_add_u32 m0, s62, 147456
v_mfma_f32_16x16x32_bf16 v[40:43], a[0:3], a[244:247], v[40:43]
ds_read_b128 a[40:43], v190 offset:10240
s_add_u32 s60, s60, 20480
v_mfma_f32_16x16x32_bf16 v[44:47], a[4:7], a[240:243], v[44:47]
ds_read_b128 a[44:47], v190 offset:11264
v_mfma_f32_16x16x32_bf16 v[48:51], a[4:7], a[244:247], v[48:51]
ds_read_b128 a[48:51], v190 offset:12288
v_mfma_f32_16x16x32_bf16 v[52:55], a[8:11], a[240:243], v[52:55]
ds_read_b128 a[52:55], v190 offset:13312
v_mfma_f32_16x16x32_bf16 v[56:59], a[8:11], a[244:247], v[56:59]
ds_read_b128 a[56:59], v190 offset:14336
buffer_load_dwordx4 v1, s[8:11], s60 offen offset:0 sc1 lds
v_mfma_f32_16x16x32_bf16 v[60:63], a[12:15], a[240:243], v[60:63]
ds_read_b128 a[60:63], v190 offset:15360
v_mfma_f32_16x16x32_bf16 v[64:67], a[12:15], a[244:247], v[64:67]
ds_read_b128 a[64:67], v190 offset:16384
v_mfma_f32_16x16x32_bf16 v[68:71], a[16:19], a[240:243], v[68:71]
ds_read_b128 a[68:71], v190 offset:17408
buffer_load_dwordx4 v1, s[8:11], s60 offen offset:1024 sc1 lds
v_mfma_f32_16x16x32_bf16 v[72:75], a[16:19], a[244:247], v[72:75]
v_rcp_f32 v183, v183
v_mfma_f32_16x16x32_bf16 v[76:79], a[20:23], a[240:243], v[76:79]
v_rcp_f32 v184, v184
v_mfma_f32_16x16x32_bf16 v[80:83], a[20:23], a[244:247], v[80:83]
buffer_load_dwordx4 v1, s[8:11], s60 offen offset:2048 sc1 lds
v_mfma_f32_16x16x32_bf16 v[84:87], a[24:27], a[240:243], v[84:87]
v_rcp_f32 v185, v185
v_mfma_f32_16x16x32_bf16 v[88:91], a[24:27], a[244:247], v[88:91]
v_mul_f32 v116, v116, v182
v_mul_f32 v117, v117, v183
v_mfma_f32_16x16x32_bf16 v[92:95], a[28:31], a[240:243], v[92:95]
buffer_load_dwordx4 v1, s[8:11], s60 offen offset:3072 sc1 lds
v_mul_f32 v118, v118, v184
v_mfma_f32_16x16x32_bf16 v[96:99], a[28:31], a[244:247], v[96:99]
v_mul_f32 v119, v119, v185
v_mfma_f32_16x16x32_bf16 v[100:103], a[32:35], a[240:243], v[100:103]
v_permlane16_swap_b32 v108, v112
v_mfma_f32_16x16x32_bf16 v[104:107], a[32:35], a[244:247], v[104:107]
s_waitcnt vmcnt(17)
s_waitcnt lgkmcnt(0)
s_barrier
v_mfma_f32_16x16x32_bf16 v[36:39], a[36:39], a[248:251], v[36:39]
ds_read_b128 a[0:3], v190 offset:18432
s_add_u32 m0, s62, 90112
v_mfma_f32_16x16x32_bf16 v[40:43], a[36:39], a[252:255], v[40:43]
ds_read_b128 a[4:7], v190 offset:19456
s_add_u32 s60, s60, 16384
v_mfma_f32_16x16x32_bf16 v[44:47], a[40:43], a[248:251], v[44:47]
ds_read_b128 a[8:11], v190 offset:20480
v_mfma_f32_16x16x32_bf16 v[48:51], a[40:43], a[252:255], v[48:51]
ds_read_b128 a[12:15], v190 offset:21504
v_mfma_f32_16x16x32_bf16 v[52:55], a[44:47], a[248:251], v[52:55]
ds_read_b128 a[16:19], v190 offset:22528
v_mfma_f32_16x16x32_bf16 v[56:59], a[44:47], a[252:255], v[56:59]
ds_read_b128 a[20:23], v190 offset:23552
buffer_load_dwordx4 v1, s[8:11], s60 offen offset:0 sc1 lds
v_mfma_f32_16x16x32_bf16 v[60:63], a[48:51], a[248:251], v[60:63]
ds_read_b128 a[24:27], v190 offset:24576
v_mfma_f32_16x16x32_bf16 v[64:67], a[48:51], a[252:255], v[64:67]
ds_read_b128 a[28:31], v190 offset:25600
v_mfma_f32_16x16x32_bf16 v[68:71], a[52:55], a[248:251], v[68:71]
ds_read_b128 a[32:35], v190 offset:26624
buffer_load_dwordx4 v1, s[8:11], s60 offen offset:1024 sc1 lds
v_mfma_f32_16x16x32_bf16 v[72:75], a[52:55], a[252:255], v[72:75]
v_permlane16_swap_b32 v109, v113
v_mfma_f32_16x16x32_bf16 v[76:79], a[56:59], a[248:251], v[76:79]
v_permlane16_swap_b32 v110, v114
v_mfma_f32_16x16x32_bf16 v[80:83], a[56:59], a[252:255], v[80:83]
buffer_load_dwordx4 v1, s[8:11], s60 offen offset:2048 sc1 lds
v_mfma_f32_16x16x32_bf16 v[84:87], a[60:63], a[248:251], v[84:87]
v_permlane16_swap_b32 v111, v115
v_mfma_f32_16x16x32_bf16 v[88:91], a[60:63], a[252:255], v[88:91]
v_mul_f32 v186, v120, v120
v_mul_f32 v187, v121, v121
v_mfma_f32_16x16x32_bf16 v[92:95], a[64:67], a[248:251], v[92:95]
buffer_load_dwordx4 v1, s[8:11], s60 offen offset:3072 sc1 lds
v_mul_f32 v188, v122, v122
v_mfma_f32_16x16x32_bf16 v[96:99], a[64:67], a[252:255], v[96:99]
v_mul_f32 v189, v123, v123
v_fma_f32 v186, v186, v254, v253
v_mfma_f32_16x16x32_bf16 v[100:103], a[68:71], a[248:251], v[100:103]
v_fma_f32 v187, v187, v254, v253
v_fma_f32 v188, v188, v254, v253
v_mfma_f32_16x16x32_bf16 v[104:107], a[68:71], a[252:255], v[104:107]
v_fma_f32 v189, v189, v254, v253
s_waitcnt lgkmcnt(0)
v_mfma_f32_16x16x32_bf16 v[36:39], a[0:3], a[80:83], v[36:39]
ds_read_b128 a[36:39], v190 offset:27648
buffer_load_dwordx4 a[208:211], v1, s[4:7], s84 offen offset:2048 sc1
v_mfma_f32_16x16x32_bf16 v[40:43], a[0:3], a[84:87], v[40:43]
ds_read_b128 a[40:43], v190 offset:28672
v_mul_f32 v186, v186, v120
v_mfma_f32_16x16x32_bf16 v[44:47], a[4:7], a[80:83], v[44:47]
ds_read_b128 a[44:47], v190 offset:29696
v_mul_f32 v187, v187, v121
v_mfma_f32_16x16x32_bf16 v[48:51], a[4:7], a[84:87], v[48:51]
ds_read_b128 a[48:51], v190 offset:30720
v_mfma_f32_16x16x32_bf16 v[52:55], a[8:11], a[80:83], v[52:55]
ds_read_b128 a[52:55], v190 offset:31744
v_mul_f32 v188, v188, v122
v_mfma_f32_16x16x32_bf16 v[56:59], a[8:11], a[84:87], v[56:59]
ds_read_b128 a[56:59], v190 offset:32768
buffer_load_dwordx4 a[212:215], v9, s[4:7], s84 offen offset:2048 sc1
v_mfma_f32_16x16x32_bf16 v[60:63], a[12:15], a[80:83], v[60:63]
ds_read_b128 a[60:63], v190 offset:33792
v_mul_f32 v189, v189, v123
v_mfma_f32_16x16x32_bf16 v[64:67], a[12:15], a[84:87], v[64:67]
ds_read_b128 a[64:67], v190 offset:34816
v_mfma_f32_16x16x32_bf16 v[68:71], a[16:19], a[80:83], v[68:71]
ds_read_b128 a[68:71], v190 offset:35840
v_mfma_f32_16x16x32_bf16 v[72:75], a[16:19], a[84:87], v[72:75]
v_exp_f32 v186, v186
v_mfma_f32_16x16x32_bf16 v[76:79], a[20:23], a[80:83], v[76:79]
v_exp_f32 v187, v187
v_mfma_f32_16x16x32_bf16 v[80:83], a[20:23], a[84:87], v[80:83]
buffer_load_dwordx4 a[216:219], v1, s[4:7], s84 offen offset:3072 sc1
v_mfma_f32_16x16x32_bf16 v[84:87], a[24:27], a[80:83], v[84:87]
v_mfma_f32_16x16x32_bf16 v[88:91], a[24:27], a[84:87], v[88:91]
v_exp_f32 v188, v188
v_mfma_f32_16x16x32_bf16 v[92:95], a[28:31], a[80:83], v[92:95]
v_mfma_f32_16x16x32_bf16 v[96:99], a[28:31], a[84:87], v[96:99]
v_mfma_f32_16x16x32_bf16 v[100:103], a[32:35], a[80:83], v[100:103]
v_exp_f32 v189, v189
v_mfma_f32_16x16x32_bf16 v[104:107], a[32:35], a[84:87], v[104:107]
s_waitcnt vmcnt(11)
s_waitcnt lgkmcnt(0)
s_barrier
v_mfma_f32_16x16x32_bf16 v[36:39], a[36:39], a[88:91], v[36:39]
ds_read_b128 a[0:3], v191 offset:0
buffer_load_dwordx4 a[220:223], v9, s[4:7], s84 offen offset:3072 sc1
s_add_u32 m0, s63, 106496
v_mfma_f32_16x16x32_bf16 v[40:43], a[36:39], a[92:95], v[40:43]
ds_read_b128 a[4:7], v191 offset:1024
s_add_u32 s61, s61, 36864
v_fma_f32 v186, v186, v255, v255
v_mfma_f32_16x16x32_bf16 v[44:47], a[40:43], a[88:91], v[44:47]
ds_read_b128 a[8:11], v191 offset:2048
v_fma_f32 v187, v187, v255, v255
v_mfma_f32_16x16x32_bf16 v[48:51], a[40:43], a[92:95], v[48:51]
ds_read_b128 a[12:15], v191 offset:3072
v_fma_f32 v188, v188, v255, v255
v_mfma_f32_16x16x32_bf16 v[52:55], a[44:47], a[88:91], v[52:55]
ds_read_b128 a[16:19], v191 offset:4096
v_mfma_f32_16x16x32_bf16 v[56:59], a[44:47], a[92:95], v[56:59]
ds_read_b128 a[20:23], v191 offset:5120
v_fma_f32 v189, v189, v255, v255
v_mfma_f32_16x16x32_bf16 v[60:63], a[48:51], a[88:91], v[60:63]
ds_read_b128 a[24:27], v191 offset:6144
buffer_load_dwordx4 v1, s[8:11], s61 offen offset:0 sc1 lds
s_add_u32 m0, s62, 110592
v_mfma_f32_16x16x32_bf16 v[64:67], a[48:51], a[92:95], v[64:67]
ds_read_b128 a[28:31], v191 offset:7168
s_add_u32 s60, s60, 20480
v_mfma_f32_16x16x32_bf16 v[68:71], a[52:55], a[88:91], v[68:71]
ds_read_b128 a[32:35], v191 offset:8192
v_mfma_f32_16x16x32_bf16 v[72:75], a[52:55], a[92:95], v[72:75]
v_rcp_f32 v186, v186
v_mfma_f32_16x16x32_bf16 v[76:79], a[56:59], a[88:91], v[76:79]
v_rcp_f32 v187, v187
v_mfma_f32_16x16x32_bf16 v[80:83], a[56:59], a[92:95], v[80:83]
v_mfma_f32_16x16x32_bf16 v[84:87], a[60:63], a[88:91], v[84:87]
buffer_load_dwordx4 v1, s[8:11], s60 offen offset:0 sc1 lds
v_mfma_f32_16x16x32_bf16 v[88:91], a[60:63], a[92:95], v[88:91]
v_rcp_f32 v188, v188
v_mfma_f32_16x16x32_bf16 v[92:95], a[64:67], a[88:91], v[92:95]
buffer_load_dwordx4 v1, s[8:11], s60 offen offset:1024 sc1 lds
v_mfma_f32_16x16x32_bf16 v[96:99], a[64:67], a[92:95], v[96:99]
v_rcp_f32 v189, v189
v_mfma_f32_16x16x32_bf16 v[100:103], a[68:71], a[88:91], v[100:103]
v_mfma_f32_16x16x32_bf16 v[104:107], a[68:71], a[92:95], v[104:107]
s_waitcnt lgkmcnt(0)
v_mfma_f32_16x16x32_bf16 v[36:39], a[0:3], a[96:99], v[36:39]
ds_read_b128 a[36:39], v191 offset:9216
buffer_load_dwordx4 v1, s[8:11], s60 offen offset:2048 sc1 lds
v_mfma_f32_16x16x32_bf16 v[40:43], a[0:3], a[100:103], v[40:43]
ds_read_b128 a[40:43], v191 offset:10240
v_mul_f32 v120, v120, v186
v_mfma_f32_16x16x32_bf16 v[44:47], a[4:7], a[96:99], v[44:47]
ds_read_b128 a[44:47], v191 offset:11264
v_mul_f32 v121, v121, v187
v_mfma_f32_16x16x32_bf16 v[48:51], a[4:7], a[100:103], v[48:51]
ds_read_b128 a[48:51], v191 offset:12288
buffer_load_dwordx4 v1, s[8:11], s60 offen offset:3072 sc1 lds
s_add_u32 s84, s84, 4096
v_mfma_f32_16x16x32_bf16 v[52:55], a[8:11], a[96:99], v[52:55]
ds_read_b128 a[52:55], v191 offset:13312
v_mul_f32 v122, v122, v188
v_mfma_f32_16x16x32_bf16 v[56:59], a[8:11], a[100:103], v[56:59]
ds_read_b128 a[56:59], v191 offset:14336
v_mul_f32 v123, v123, v189
v_mfma_f32_16x16x32_bf16 v[60:63], a[12:15], a[96:99], v[60:63]
ds_read_b128 a[60:63], v191 offset:15360
v_mul_f32 v182, v124, v124
v_mfma_f32_16x16x32_bf16 v[64:67], a[12:15], a[100:103], v[64:67]
ds_read_b128 a[64:67], v191 offset:16384
v_mul_f32 v183, v125, v125
v_mfma_f32_16x16x32_bf16 v[68:71], a[16:19], a[96:99], v[68:71]
ds_read_b128 a[68:71], v191 offset:17408
v_mfma_f32_16x16x32_bf16 v[72:75], a[16:19], a[100:103], v[72:75]
v_mul_f32 v184, v126, v126
v_mfma_f32_16x16x32_bf16 v[76:79], a[20:23], a[96:99], v[76:79]
buffer_load_dwordx4 a[224:227], v1, s[4:7], s84 offen offset:0 sc1
v_mul_f32 v185, v127, v127
v_mfma_f32_16x16x32_bf16 v[80:83], a[20:23], a[100:103], v[80:83]
v_mfma_f32_16x16x32_bf16 v[84:87], a[24:27], a[96:99], v[84:87]
v_fma_f32 v182, v182, v254, v253
v_mfma_f32_16x16x32_bf16 v[88:91], a[24:27], a[100:103], v[88:91]
buffer_load_dwordx4 a[228:231], v9, s[4:7], s84 offen offset:0 sc1
v_fma_f32 v183, v183, v254, v253
v_mfma_f32_16x16x32_bf16 v[92:95], a[28:31], a[96:99], v[92:95]
v_mfma_f32_16x16x32_bf16 v[96:99], a[28:31], a[100:103], v[96:99]
v_fma_f32 v184, v184, v254, v253
v_mfma_f32_16x16x32_bf16 v[100:103], a[32:35], a[96:99], v[100:103]
v_fma_f32 v185, v185, v254, v253
v_mfma_f32_16x16x32_bf16 v[104:107], a[32:35], a[100:103], v[104:107]
s_waitcnt vmcnt(15)
s_waitcnt lgkmcnt(0)
s_barrier
v_mfma_f32_16x16x32_bf16 v[36:39], a[36:39], a[104:107], v[36:39]
ds_read_b128 a[0:3], v191 offset:18432
buffer_load_dwordx4 a[232:235], v1, s[4:7], s84 offen offset:1024 sc1
v_mfma_f32_16x16x32_bf16 v[40:43], a[36:39], a[108:111], v[40:43]
ds_read_b128 a[4:7], v191 offset:19456
v_mul_f32 v182, v182, v124
v_mfma_f32_16x16x32_bf16 v[44:47], a[40:43], a[104:107], v[44:47]
ds_read_b128 a[8:11], v191 offset:20480
buffer_load_dwordx4 a[236:239], v9, s[4:7], s84 offen offset:1024 sc1
s_add_u32 m0, s62, 126976
v_mfma_f32_16x16x32_bf16 v[48:51], a[40:43], a[108:111], v[48:51]
ds_read_b128 a[12:15], v191 offset:21504
s_add_u32 s60, s60, 16384
v_mul_f32 v183, v183, v125
v_mfma_f32_16x16x32_bf16 v[52:55], a[44:47], a[104:107], v[52:55]
ds_read_b128 a[16:19], v191 offset:22528
v_mul_f32 v184, v184, v126
v_mfma_f32_16x16x32_bf16 v[56:59], a[44:47], a[108:111], v[56:59]
ds_read_b128 a[20:23], v191 offset:23552
v_mul_f32 v185, v185, v127
v_mfma_f32_16x16x32_bf16 v[60:63], a[48:51], a[104:107], v[60:63]
ds_read_b128 a[24:27], v191 offset:24576
v_mfma_f32_16x16x32_bf16 v[64:67], a[48:51], a[108:111], v[64:67]
ds_read_b128 a[28:31], v191 offset:25600
v_mfma_f32_16x16x32_bf16 v[68:71], a[52:55], a[104:107], v[68:71]
ds_read_b128 a[32:35], v191 offset:26624
v_mfma_f32_16x16x32_bf16 v[72:75], a[52:55], a[108:111], v[72:75]
v_exp_f32 v182, v182
v_mfma_f32_16x16x32_bf16 v[76:79], a[56:59], a[104:107], v[76:79]
v_exp_f32 v183, v183
v_mfma_f32_16x16x32_bf16 v[80:83], a[56:59], a[108:111], v[80:83]
buffer_load_dwordx4 v1, s[8:11], s60 offen offset:0 sc1 lds
v_mfma_f32_16x16x32_bf16 v[84:87], a[60:63], a[104:107], v[84:87]
v_exp_f32 v184, v184
v_mfma_f32_16x16x32_bf16 v[88:91], a[60:63], a[108:111], v[88:91]
v_mfma_f32_16x16x32_bf16 v[92:95], a[64:67], a[104:107], v[92:95]
buffer_load_dwordx4 v1, s[8:11], s60 offen offset:1024 sc1 lds
v_mfma_f32_16x16x32_bf16 v[96:99], a[64:67], a[108:111], v[96:99]
v_exp_f32 v185, v185
v_mfma_f32_16x16x32_bf16 v[100:103], a[68:71], a[104:107], v[100:103]
v_mfma_f32_16x16x32_bf16 v[104:107], a[68:71], a[108:111], v[104:107]
v_fma_f32 v182, v182, v255, v255
s_waitcnt lgkmcnt(0)
v_mfma_f32_16x16x32_bf16 v[36:39], a[0:3], a[112:115], v[36:39]
ds_read_b128 a[36:39], v191 offset:27648
buffer_load_dwordx4 v1, s[8:11], s60 offen offset:2048 sc1 lds
v_mfma_f32_16x16x32_bf16 v[40:43], a[0:3], a[116:119], v[40:43]
ds_read_b128 a[40:43], v191 offset:28672
v_fma_f32 v183, v183, v255, v255
v_mfma_f32_16x16x32_bf16 v[44:47], a[4:7], a[112:115], v[44:47]
ds_read_b128 a[44:47], v191 offset:29696
v_fma_f32 v184, v184, v255, v255
v_mfma_f32_16x16x32_bf16 v[48:51], a[4:7], a[116:119], v[48:51]
ds_read_b128 a[48:51], v191 offset:30720
v_fma_f32 v185, v185, v255, v255
v_mfma_f32_16x16x32_bf16 v[52:55], a[8:11], a[112:115], v[52:55]
ds_read_b128 a[52:55], v191 offset:31744
buffer_load_dwordx4 v1, s[8:11], s60 offen offset:3072 sc1 lds
v_mfma_f32_16x16x32_bf16 v[56:59], a[8:11], a[116:119], v[56:59]
ds_read_b128 a[56:59], v191 offset:32768
v_mfma_f32_16x16x32_bf16 v[60:63], a[12:15], a[112:115], v[60:63]
ds_read_b128 a[60:63], v191 offset:33792
v_mfma_f32_16x16x32_bf16 v[64:67], a[12:15], a[116:119], v[64:67]
ds_read_b128 a[64:67], v191 offset:34816
v_mfma_f32_16x16x32_bf16 v[68:71], a[16:19], a[112:115], v[68:71]
ds_read_b128 a[68:71], v191 offset:35840
buffer_load_dwordx4 a[240:243], v1, s[4:7], s84 offen offset:2048 sc1
v_mfma_f32_16x16x32_bf16 v[72:75], a[16:19], a[116:119], v[72:75]
v_rcp_f32 v182, v182
v_mfma_f32_16x16x32_bf16 v[76:79], a[20:23], a[112:115], v[76:79]
v_rcp_f32 v183, v183
v_mfma_f32_16x16x32_bf16 v[80:83], a[20:23], a[116:119], v[80:83]
v_rcp_f32 v184, v184
v_mfma_f32_16x16x32_bf16 v[84:87], a[24:27], a[112:115], v[84:87]
buffer_load_dwordx4 a[244:247], v9, s[4:7], s84 offen offset:2048 sc1
v_mfma_f32_16x16x32_bf16 v[88:91], a[24:27], a[116:119], v[88:91]
v_mfma_f32_16x16x32_bf16 v[92:95], a[28:31], a[112:115], v[92:95]
v_rcp_f32 v185, v185
v_mfma_f32_16x16x32_bf16 v[96:99], a[28:31], a[116:119], v[96:99]
v_mfma_f32_16x16x32_bf16 v[100:103], a[32:35], a[112:115], v[100:103]
v_mfma_f32_16x16x32_bf16 v[104:107], a[32:35], a[116:119], v[104:107]
s_waitcnt vmcnt(14)
s_waitcnt lgkmcnt(0)
s_barrier
v_mfma_f32_16x16x32_bf16 v[36:39], a[36:39], a[120:123], v[36:39]
ds_read_b128 a[0:3], v190 offset:0
buffer_load_dwordx4 a[248:251], v1, s[4:7], s84 offen offset:3072 sc1
v_mfma_f32_16x16x32_bf16 v[40:43], a[36:39], a[124:127], v[40:43]
ds_read_b128 a[4:7], v190 offset:1024
v_mul_f32 v124, v124, v182
v_mfma_f32_16x16x32_bf16 v[44:47], a[40:43], a[120:123], v[44:47]
ds_read_b128 a[8:11], v190 offset:2048
v_mul_f32 v125, v125, v183
v_mfma_f32_16x16x32_bf16 v[48:51], a[40:43], a[124:127], v[48:51]
ds_read_b128 a[12:15], v190 offset:3072
buffer_load_dwordx4 a[252:255], v9, s[4:7], s84 offen offset:3072 sc1
s_add_u32 m0, s63, 143360
v_mfma_f32_16x16x32_bf16 v[52:55], a[44:47], a[120:123], v[52:55]
ds_read_b128 a[16:19], v190 offset:4096
s_add_u32 s61, s61, 36864
v_mul_f32 v126, v126, v184
v_mfma_f32_16x16x32_bf16 v[56:59], a[44:47], a[124:127], v[56:59]
ds_read_b128 a[20:23], v190 offset:5120
v_mul_f32 v127, v127, v185
v_mfma_f32_16x16x32_bf16 v[60:63], a[48:51], a[120:123], v[60:63]
ds_read_b128 a[24:27], v190 offset:6144
v_mfma_f32_16x16x32_bf16 v[64:67], a[48:51], a[124:127], v[64:67]
ds_read_b128 a[28:31], v190 offset:7168
v_mfma_f32_16x16x32_bf16 v[68:71], a[52:55], a[120:123], v[68:71]
ds_read_b128 a[32:35], v190 offset:8192
v_mfma_f32_16x16x32_bf16 v[72:75], a[52:55], a[124:127], v[72:75]
v_permlane16_swap_b32 v116, v120
v_mfma_f32_16x16x32_bf16 v[76:79], a[56:59], a[120:123], v[76:79]
v_permlane16_swap_b32 v117, v121
v_mfma_f32_16x16x32_bf16 v[80:83], a[56:59], a[124:127], v[80:83]
v_permlane16_swap_b32 v118, v122
v_mfma_f32_16x16x32_bf16 v[84:87], a[60:63], a[120:123], v[84:87]
v_mfma_f32_16x16x32_bf16 v[88:91], a[60:63], a[124:127], v[88:91]
buffer_load_dwordx4 v1, s[8:11], s61 offen offset:0 sc1 lds
v_mfma_f32_16x16x32_bf16 v[92:95], a[64:67], a[120:123], v[92:95]
v_permlane16_swap_b32 v119, v123
v_mfma_f32_16x16x32_bf16 v[96:99], a[64:67], a[124:127], v[96:99]
v_mfma_f32_16x16x32_bf16 v[100:103], a[68:71], a[120:123], v[100:103]
v_mul_f32 v186, v128, v128
v_mfma_f32_16x16x32_bf16 v[104:107], a[68:71], a[124:127], v[104:107]
s_waitcnt lgkmcnt(0)
v_mfma_f32_16x16x32_bf16 v[36:39], a[0:3], a[128:131], v[36:39]
ds_read_b128 a[36:39], v190 offset:9216
s_add_u32 m0, s62, 147456
v_mul_f32 v187, v129, v129
v_mfma_f32_16x16x32_bf16 v[40:43], a[0:3], a[132:135], v[40:43]
ds_read_b128 a[40:43], v190 offset:10240
s_add_u32 s60, s60, 20480
v_mul_f32 v188, v130, v130
v_mfma_f32_16x16x32_bf16 v[44:47], a[4:7], a[128:131], v[44:47]
ds_read_b128 a[44:47], v190 offset:11264
v_mfma_f32_16x16x32_bf16 v[48:51], a[4:7], a[132:135], v[48:51]
ds_read_b128 a[48:51], v190 offset:12288
v_mul_f32 v189, v131, v131
v_mfma_f32_16x16x32_bf16 v[52:55], a[8:11], a[128:131], v[52:55]
ds_read_b128 a[52:55], v190 offset:13312
v_fma_f32 v186, v186, v254, v253
v_mfma_f32_16x16x32_bf16 v[56:59], a[8:11], a[132:135], v[56:59]
ds_read_b128 a[56:59], v190 offset:14336
buffer_load_dwordx4 v1, s[8:11], s60 offen offset:0 sc1 lds
v_mfma_f32_16x16x32_bf16 v[60:63], a[12:15], a[128:131], v[60:63]
ds_read_b128 a[60:63], v190 offset:15360
v_fma_f32 v187, v187, v254, v253
v_mfma_f32_16x16x32_bf16 v[64:67], a[12:15], a[132:135], v[64:67]
ds_read_b128 a[64:67], v190 offset:16384
v_fma_f32 v188, v188, v254, v253
v_mfma_f32_16x16x32_bf16 v[68:71], a[16:19], a[128:131], v[68:71]
ds_read_b128 a[68:71], v190 offset:17408
buffer_load_dwordx4 v1, s[8:11], s60 offen offset:1024 sc1 lds
v_mfma_f32_16x16x32_bf16 v[72:75], a[16:19], a[132:135], v[72:75]
v_fma_f32 v189, v189, v254, v253
v_mfma_f32_16x16x32_bf16 v[76:79], a[20:23], a[128:131], v[76:79]
v_mul_f32 v186, v186, v128
v_mfma_f32_16x16x32_bf16 v[80:83], a[20:23], a[132:135], v[80:83]
buffer_load_dwordx4 v1, s[8:11], s60 offen offset:2048 sc1 lds
v_mul_f32 v187, v187, v129
v_mfma_f32_16x16x32_bf16 v[84:87], a[24:27], a[128:131], v[84:87]
v_mfma_f32_16x16x32_bf16 v[88:91], a[24:27], a[132:135], v[88:91]
v_mul_f32 v188, v188, v130
v_mfma_f32_16x16x32_bf16 v[92:95], a[28:31], a[128:131], v[92:95]
buffer_load_dwordx4 v1, s[8:11], s60 offen offset:3072 sc1 lds
v_mul_f32 v189, v189, v131
v_mfma_f32_16x16x32_bf16 v[96:99], a[28:31], a[132:135], v[96:99]
v_mfma_f32_16x16x32_bf16 v[100:103], a[32:35], a[128:131], v[100:103]
v_exp_f32 v186, v186
v_mfma_f32_16x16x32_bf16 v[104:107], a[32:35], a[132:135], v[104:107]
s_waitcnt vmcnt(17)
s_waitcnt lgkmcnt(0)
s_barrier
v_mfma_f32_16x16x32_bf16 v[36:39], a[36:39], a[136:139], v[36:39]
ds_read_b128 a[0:3], v190 offset:18432
s_add_u32 m0, s62, 90112
v_mfma_f32_16x16x32_bf16 v[40:43], a[36:39], a[140:143], v[40:43]
ds_read_b128 a[4:7], v190 offset:19456
s_add_u32 s60, s60, 16384
v_mfma_f32_16x16x32_bf16 v[44:47], a[40:43], a[136:139], v[44:47]
ds_read_b128 a[8:11], v190 offset:20480
v_mfma_f32_16x16x32_bf16 v[48:51], a[40:43], a[140:143], v[48:51]
ds_read_b128 a[12:15], v190 offset:21504
v_mfma_f32_16x16x32_bf16 v[52:55], a[44:47], a[136:139], v[52:55]
ds_read_b128 a[16:19], v190 offset:22528
v_mfma_f32_16x16x32_bf16 v[56:59], a[44:47], a[140:143], v[56:59]
ds_read_b128 a[20:23], v190 offset:23552
buffer_load_dwordx4 v1, s[8:11], s60 offen offset:0 sc1 lds
v_mfma_f32_16x16x32_bf16 v[60:63], a[48:51], a[136:139], v[60:63]
ds_read_b128 a[24:27], v190 offset:24576
v_mfma_f32_16x16x32_bf16 v[64:67], a[48:51], a[140:143], v[64:67]
ds_read_b128 a[28:31], v190 offset:25600
v_mfma_f32_16x16x32_bf16 v[68:71], a[52:55], a[136:139], v[68:71]
ds_read_b128 a[32:35], v190 offset:26624
buffer_load_dwordx4 v1, s[8:11], s60 offen offset:1024 sc1 lds
v_mfma_f32_16x16x32_bf16 v[72:75], a[52:55], a[140:143], v[72:75]
v_exp_f32 v187, v187
v_mfma_f32_16x16x32_bf16 v[76:79], a[56:59], a[136:139], v[76:79]
v_exp_f32 v188, v188
v_mfma_f32_16x16x32_bf16 v[80:83], a[56:59], a[140:143], v[80:83]
buffer_load_dwordx4 v1, s[8:11], s60 offen offset:2048 sc1 lds
v_mfma_f32_16x16x32_bf16 v[84:87], a[60:63], a[136:139], v[84:87]
v_exp_f32 v189, v189
v_mfma_f32_16x16x32_bf16 v[88:91], a[60:63], a[140:143], v[88:91]
v_fma_f32 v186, v186, v255, v255
v_fma_f32 v187, v187, v255, v255
v_mfma_f32_16x16x32_bf16 v[92:95], a[64:67], a[136:139], v[92:95]
buffer_load_dwordx4 v1, s[8:11], s60 offen offset:3072 sc1 lds
v_fma_f32 v188, v188, v255, v255
v_mfma_f32_16x16x32_bf16 v[96:99], a[64:67], a[140:143], v[96:99]
v_fma_f32 v189, v189, v255, v255
v_mfma_f32_16x16x32_bf16 v[100:103], a[68:71], a[136:139], v[100:103]
v_rcp_f32 v186, v186
v_mfma_f32_16x16x32_bf16 v[104:107], a[68:71], a[140:143], v[104:107]
s_waitcnt lgkmcnt(0)
v_mfma_f32_16x16x32_bf16 v[36:39], a[0:3], a[144:147], v[36:39]
ds_read_b128 a[36:39], v190 offset:27648
s_add_u32 s84, s84, 4096
v_mfma_f32_16x16x32_bf16 v[40:43], a[0:3], a[148:151], v[40:43]
ds_read_b128 a[40:43], v190 offset:28672
v_mfma_f32_16x16x32_bf16 v[44:47], a[4:7], a[144:147], v[44:47]
ds_read_b128 a[44:47], v190 offset:29696
v_mfma_f32_16x16x32_bf16 v[48:51], a[4:7], a[148:151], v[48:51]
ds_read_b128 a[48:51], v190 offset:30720
buffer_load_dwordx4 a[80:83], v1, s[4:7], s84 offen offset:0 sc1
v_mfma_f32_16x16x32_bf16 v[52:55], a[8:11], a[144:147], v[52:55]
ds_read_b128 a[52:55], v190 offset:31744
v_mfma_f32_16x16x32_bf16 v[56:59], a[8:11], a[148:151], v[56:59]
ds_read_b128 a[56:59], v190 offset:32768
v_mfma_f32_16x16x32_bf16 v[60:63], a[12:15], a[144:147], v[60:63]
ds_read_b128 a[60:63], v190 offset:33792
buffer_load_dwordx4 a[84:87], v9, s[4:7], s84 offen offset:0 sc1
v_mfma_f32_16x16x32_bf16 v[64:67], a[12:15], a[148:151], v[64:67]
ds_read_b128 a[64:67], v190 offset:34816
v_mfma_f32_16x16x32_bf16 v[68:71], a[16:19], a[144:147], v[68:71]
ds_read_b128 a[68:71], v190 offset:35840
v_mfma_f32_16x16x32_bf16 v[72:75], a[16:19], a[148:151], v[72:75]
v_rcp_f32 v187, v187
v_mfma_f32_16x16x32_bf16 v[76:79], a[20:23], a[144:147], v[76:79]
buffer_load_dwordx4 a[88:91], v1, s[4:7], s84 offen offset:1024 sc1
v_mfma_f32_16x16x32_bf16 v[80:83], a[20:23], a[148:151], v[80:83]
v_rcp_f32 v188, v188
v_mfma_f32_16x16x32_bf16 v[84:87], a[24:27], a[144:147], v[84:87]
v_rcp_f32 v189, v189
v_mfma_f32_16x16x32_bf16 v[88:91], a[24:27], a[148:151], v[88:91]
buffer_load_dwordx4 a[92:95], v9, s[4:7], s84 offen offset:1024 sc1
v_mul_f32 v128, v128, v186
v_mfma_f32_16x16x32_bf16 v[92:95], a[28:31], a[144:147], v[92:95]
v_mul_f32 v129, v129, v187
v_mul_f32 v130, v130, v188
v_mfma_f32_16x16x32_bf16 v[96:99], a[28:31], a[148:151], v[96:99]
v_mul_f32 v131, v131, v189
v_mul_f32 v182, v132, v132
v_mfma_f32_16x16x32_bf16 v[100:103], a[32:35], a[144:147], v[100:103]
v_mul_f32 v183, v133, v133
v_mfma_f32_16x16x32_bf16 v[104:107], a[32:35], a[148:151], v[104:107]
s_waitcnt vmcnt(12)
s_waitcnt lgkmcnt(0)
s_barrier
v_mfma_f32_16x16x32_bf16 v[36:39], a[36:39], a[152:155], v[36:39]
ds_read_b128 a[0:3], v191 offset:0
s_add_u32 m0, s63, 106496
v_mul_f32 v184, v134, v134
v_mfma_f32_16x16x32_bf16 v[40:43], a[36:39], a[156:159], v[40:43]
ds_read_b128 a[4:7], v191 offset:1024
s_add_u32 s61, s61, 36864
v_mul_f32 v185, v135, v135
v_mfma_f32_16x16x32_bf16 v[44:47], a[40:43], a[152:155], v[44:47]
ds_read_b128 a[8:11], v191 offset:2048
v_mfma_f32_16x16x32_bf16 v[48:51], a[40:43], a[156:159], v[48:51]
ds_read_b128 a[12:15], v191 offset:3072
v_fma_f32 v182, v182, v254, v253
v_mfma_f32_16x16x32_bf16 v[52:55], a[44:47], a[152:155], v[52:55]
ds_read_b128 a[16:19], v191 offset:4096
buffer_load_dwordx4 v1, s[8:11], s61 offen offset:0 sc1 lds
s_add_u32 m0, s62, 110592
v_mfma_f32_16x16x32_bf16 v[56:59], a[44:47], a[156:159], v[56:59]
ds_read_b128 a[20:23], v191 offset:5120
s_add_u32 s60, s60, 20480
v_fma_f32 v183, v183, v254, v253
v_mfma_f32_16x16x32_bf16 v[60:63], a[48:51], a[152:155], v[60:63]
ds_read_b128 a[24:27], v191 offset:6144
v_fma_f32 v184, v184, v254, v253
v_mfma_f32_16x16x32_bf16 v[64:67], a[48:51], a[156:159], v[64:67]
ds_read_b128 a[28:31], v191 offset:7168
v_fma_f32 v185, v185, v254, v253
v_mfma_f32_16x16x32_bf16 v[68:71], a[52:55], a[152:155], v[68:71]
ds_read_b128 a[32:35], v191 offset:8192
v_mfma_f32_16x16x32_bf16 v[72:75], a[52:55], a[156:159], v[72:75]
v_mul_f32 v182, v182, v132
v_mfma_f32_16x16x32_bf16 v[76:79], a[56:59], a[152:155], v[76:79]
buffer_load_dwordx4 v1, s[8:11], s60 offen offset:0 sc1 lds
v_mul_f32 v183, v183, v133
v_mfma_f32_16x16x32_bf16 v[80:83], a[56:59], a[156:159], v[80:83]
v_mul_f32 v184, v184, v134
v_mfma_f32_16x16x32_bf16 v[84:87], a[60:63], a[152:155], v[84:87]
buffer_load_dwordx4 v1, s[8:11], s60 offen offset:1024 sc1 lds
v_mfma_f32_16x16x32_bf16 v[88:91], a[60:63], a[156:159], v[88:91]
v_mul_f32 v185, v185, v135
v_mfma_f32_16x16x32_bf16 v[92:95], a[64:67], a[152:155], v[92:95]
buffer_load_dwordx4 v1, s[8:11], s60 offen offset:2048 sc1 lds
v_mfma_f32_16x16x32_bf16 v[96:99], a[64:67], a[156:159], v[96:99]
v_exp_f32 v182, v182
v_mfma_f32_16x16x32_bf16 v[100:103], a[68:71], a[152:155], v[100:103]
v_mfma_f32_16x16x32_bf16 v[104:107], a[68:71], a[156:159], v[104:107]
s_waitcnt lgkmcnt(0)
v_mfma_f32_16x16x32_bf16 v[36:39], a[0:3], a[160:163], v[36:39]
ds_read_b128 a[36:39], v191 offset:9216
buffer_load_dwordx4 v1, s[8:11], s60 offen offset:3072 sc1 lds
v_mfma_f32_16x16x32_bf16 v[40:43], a[0:3], a[164:167], v[40:43]
ds_read_b128 a[40:43], v191 offset:10240
v_mfma_f32_16x16x32_bf16 v[44:47], a[4:7], a[160:163], v[44:47]
ds_read_b128 a[44:47], v191 offset:11264
v_mfma_f32_16x16x32_bf16 v[48:51], a[4:7], a[164:167], v[48:51]
ds_read_b128 a[48:51], v191 offset:12288
v_mfma_f32_16x16x32_bf16 v[52:55], a[8:11], a[160:163], v[52:55]
ds_read_b128 a[52:55], v191 offset:13312
v_mfma_f32_16x16x32_bf16 v[56:59], a[8:11], a[164:167], v[56:59]
ds_read_b128 a[56:59], v191 offset:14336
buffer_load_dwordx4 a[96:99], v1, s[4:7], s84 offen offset:2048 sc1
v_mfma_f32_16x16x32_bf16 v[60:63], a[12:15], a[160:163], v[60:63]
ds_read_b128 a[60:63], v191 offset:15360
v_mfma_f32_16x16x32_bf16 v[64:67], a[12:15], a[164:167], v[64:67]
ds_read_b128 a[64:67], v191 offset:16384
v_mfma_f32_16x16x32_bf16 v[68:71], a[16:19], a[160:163], v[68:71]
ds_read_b128 a[68:71], v191 offset:17408
v_mfma_f32_16x16x32_bf16 v[72:75], a[16:19], a[164:167], v[72:75]
v_exp_f32 v183, v183
v_mfma_f32_16x16x32_bf16 v[76:79], a[20:23], a[160:163], v[76:79]
v_exp_f32 v184, v184
v_mfma_f32_16x16x32_bf16 v[80:83], a[20:23], a[164:167], v[80:83]
buffer_load_dwordx4 a[100:103], v9, s[4:7], s84 offen offset:2048 sc1
v_mfma_f32_16x16x32_bf16 v[84:87], a[24:27], a[160:163], v[84:87]
v_exp_f32 v185, v185
v_mfma_f32_16x16x32_bf16 v[88:91], a[24:27], a[164:167], v[88:91]
v_fma_f32 v182, v182, v255, v255
v_fma_f32 v183, v183, v255, v255
v_mfma_f32_16x16x32_bf16 v[92:95], a[28:31], a[160:163], v[92:95]
v_fma_f32 v184, v184, v255, v255
v_fma_f32 v185, v185, v255, v255
v_mfma_f32_16x16x32_bf16 v[96:99], a[28:31], a[164:167], v[96:99]
v_rcp_f32 v182, v182
v_mfma_f32_16x16x32_bf16 v[100:103], a[32:35], a[160:163], v[100:103]
v_mfma_f32_16x16x32_bf16 v[104:107], a[32:35], a[164:167], v[104:107]
s_waitcnt vmcnt(15)
s_waitcnt lgkmcnt(0)
s_barrier
v_mfma_f32_16x16x32_bf16 v[36:39], a[36:39], a[168:171], v[36:39]
ds_read_b128 a[0:3], v191 offset:18432
buffer_load_dwordx4 a[104:107], v1, s[4:7], s84 offen offset:3072 sc1
v_mfma_f32_16x16x32_bf16 v[40:43], a[36:39], a[172:175], v[40:43]
ds_read_b128 a[4:7], v191 offset:19456
v_mfma_f32_16x16x32_bf16 v[44:47], a[40:43], a[168:171], v[44:47]
ds_read_b128 a[8:11], v191 offset:20480
buffer_load_dwordx4 a[108:111], v9, s[4:7], s84 offen offset:3072 sc1
s_add_u32 m0, s62, 126976
v_mfma_f32_16x16x32_bf16 v[48:51], a[40:43], a[172:175], v[48:51]
ds_read_b128 a[12:15], v191 offset:21504
s_add_u32 s60, s60, 16384
v_mfma_f32_16x16x32_bf16 v[52:55], a[44:47], a[168:171], v[52:55]
ds_read_b128 a[16:19], v191 offset:22528
v_mfma_f32_16x16x32_bf16 v[56:59], a[44:47], a[172:175], v[56:59]
ds_read_b128 a[20:23], v191 offset:23552
v_mfma_f32_16x16x32_bf16 v[60:63], a[48:51], a[168:171], v[60:63]
ds_read_b128 a[24:27], v191 offset:24576
v_mfma_f32_16x16x32_bf16 v[64:67], a[48:51], a[172:175], v[64:67]
ds_read_b128 a[28:31], v191 offset:25600
v_mfma_f32_16x16x32_bf16 v[68:71], a[52:55], a[168:171], v[68:71]
ds_read_b128 a[32:35], v191 offset:26624
v_mfma_f32_16x16x32_bf16 v[72:75], a[52:55], a[172:175], v[72:75]
v_rcp_f32 v183, v183
v_mfma_f32_16x16x32_bf16 v[76:79], a[56:59], a[168:171], v[76:79]
v_rcp_f32 v184, v184
v_mfma_f32_16x16x32_bf16 v[80:83], a[56:59], a[172:175], v[80:83]
buffer_load_dwordx4 v1, s[8:11], s60 offen offset:0 sc1 lds
v_mfma_f32_16x16x32_bf16 v[84:87], a[60:63], a[168:171], v[84:87]
v_rcp_f32 v185, v185
v_mfma_f32_16x16x32_bf16 v[88:91], a[60:63], a[172:175], v[88:91]
v_mul_f32 v132, v132, v182
v_mul_f32 v133, v133, v183
v_mfma_f32_16x16x32_bf16 v[92:95], a[64:67], a[168:171], v[92:95]
buffer_load_dwordx4 v1, s[8:11], s60 offen offset:1024 sc1 lds
v_mul_f32 v134, v134, v184
v_mfma_f32_16x16x32_bf16 v[96:99], a[64:67], a[172:175], v[96:99]
v_mul_f32 v135, v135, v185
v_mfma_f32_16x16x32_bf16 v[100:103], a[68:71], a[168:171], v[100:103]
v_permlane16_swap_b32 v124, v128
v_mfma_f32_16x16x32_bf16 v[104:107], a[68:71], a[172:175], v[104:107]
s_waitcnt lgkmcnt(0)
v_mfma_f32_16x16x32_bf16 v[36:39], a[0:3], a[176:179], v[36:39]
ds_read_b128 a[36:39], v191 offset:27648
buffer_load_dwordx4 v1, s[8:11], s60 offen offset:2048 sc1 lds
v_mfma_f32_16x16x32_bf16 v[40:43], a[0:3], a[180:183], v[40:43]
ds_read_b128 a[40:43], v191 offset:28672
v_mfma_f32_16x16x32_bf16 v[44:47], a[4:7], a[176:179], v[44:47]
ds_read_b128 a[44:47], v191 offset:29696
v_mfma_f32_16x16x32_bf16 v[48:51], a[4:7], a[180:183], v[48:51]
ds_read_b128 a[48:51], v191 offset:30720
buffer_load_dwordx4 v1, s[8:11], s60 offen offset:3072 sc1 lds
s_add_u32 s84, s84, 4096
v_mfma_f32_16x16x32_bf16 v[52:55], a[8:11], a[176:179], v[52:55]
ds_read_b128 a[52:55], v191 offset:31744
v_mfma_f32_16x16x32_bf16 v[56:59], a[8:11], a[180:183], v[56:59]
ds_read_b128 a[56:59], v191 offset:32768
v_mfma_f32_16x16x32_bf16 v[60:63], a[12:15], a[176:179], v[60:63]
ds_read_b128 a[60:63], v191 offset:33792
v_mfma_f32_16x16x32_bf16 v[64:67], a[12:15], a[180:183], v[64:67]
ds_read_b128 a[64:67], v191 offset:34816
v_mfma_f32_16x16x32_bf16 v[68:71], a[16:19], a[176:179], v[68:71]
ds_read_b128 a[68:71], v191 offset:35840
v_mfma_f32_16x16x32_bf16 v[72:75], a[16:19], a[180:183], v[72:75]
v_permlane16_swap_b32 v125, v129
v_mfma_f32_16x16x32_bf16 v[76:79], a[20:23], a[176:179], v[76:79]
buffer_load_dwordx4 a[112:115], v1, s[4:7], s84 offen offset:0 sc1
v_mfma_f32_16x16x32_bf16 v[80:83], a[20:23], a[180:183], v[80:83]
v_permlane16_swap_b32 v126, v130
v_mfma_f32_16x16x32_bf16 v[84:87], a[24:27], a[176:179], v[84:87]
v_permlane16_swap_b32 v127, v131
v_mfma_f32_16x16x32_bf16 v[88:91], a[24:27], a[180:183], v[88:91]
buffer_load_dwordx4 a[116:119], v9, s[4:7], s84 offen offset:0 sc1
v_mul_f32 v186, v136, v136
v_mfma_f32_16x16x32_bf16 v[92:95], a[28:31], a[176:179], v[92:95]
v_mul_f32 v187, v137, v137
v_mul_f32 v188, v138, v138
v_mfma_f32_16x16x32_bf16 v[96:99], a[28:31], a[180:183], v[96:99]
v_mul_f32 v189, v139, v139
v_fma_f32 v186, v186, v254, v253
v_mfma_f32_16x16x32_bf16 v[100:103], a[32:35], a[176:179], v[100:103]
v_fma_f32 v187, v187, v254, v253
v_fma_f32 v188, v188, v254, v253
v_mfma_f32_16x16x32_bf16 v[104:107], a[32:35], a[180:183], v[104:107]
s_waitcnt vmcnt(14)
s_waitcnt lgkmcnt(0)
s_barrier
v_mfma_f32_16x16x32_bf16 v[36:39], a[36:39], a[184:187], v[36:39]
ds_read_b128 a[0:3], v190 offset:0
buffer_load_dwordx4 a[120:123], v1, s[4:7], s84 offen offset:1024 sc1
v_mfma_f32_16x16x32_bf16 v[40:43], a[36:39], a[188:191], v[40:43]
ds_read_b128 a[4:7], v190 offset:1024
v_fma_f32 v189, v189, v254, v253
v_mfma_f32_16x16x32_bf16 v[44:47], a[40:43], a[184:187], v[44:47]
ds_read_b128 a[8:11], v190 offset:2048
buffer_load_dwordx4 a[124:127], v9, s[4:7], s84 offen offset:1024 sc1
s_add_u32 m0, s63, 143360
v_mfma_f32_16x16x32_bf16 v[48:51], a[40:43], a[188:191], v[48:51]
ds_read_b128 a[12:15], v190 offset:3072
s_add_u32 s61, s61, 36864
v_mul_f32 v186, v186, v136
v_mfma_f32_16x16x32_bf16 v[52:55], a[44:47], a[184:187], v[52:55]
ds_read_b128 a[16:19], v190 offset:4096
v_mul_f32 v187, v187, v137
v_mfma_f32_16x16x32_bf16 v[56:59], a[44:47], a[188:191], v[56:59]
ds_read_b128 a[20:23], v190 offset:5120
v_mul_f32 v188, v188, v138
v_mfma_f32_16x16x32_bf16 v[60:63], a[48:51], a[184:187], v[60:63]
ds_read_b128 a[24:27], v190 offset:6144
v_mul_f32 v189, v189, v139
v_mfma_f32_16x16x32_bf16 v[64:67], a[48:51], a[188:191], v[64:67]
ds_read_b128 a[28:31], v190 offset:7168
v_mfma_f32_16x16x32_bf16 v[68:71], a[52:55], a[184:187], v[68:71]
ds_read_b128 a[32:35], v190 offset:8192
buffer_load_dwordx4 v1, s[8:11], s61 offen offset:0 sc1 lds
s_add_u32 m0, s62, 147456
v_mfma_f32_16x16x32_bf16 v[72:75], a[52:55], a[188:191], v[72:75]
s_add_u32 s60, s60, 20480
v_exp_f32 v186, v186
v_mfma_f32_16x16x32_bf16 v[76:79], a[56:59], a[184:187], v[76:79]
v_exp_f32 v187, v187
v_mfma_f32_16x16x32_bf16 v[80:83], a[56:59], a[188:191], v[80:83]
v_mfma_f32_16x16x32_bf16 v[84:87], a[60:63], a[184:187], v[84:87]
v_mfma_f32_16x16x32_bf16 v[88:91], a[60:63], a[188:191], v[88:91]
v_exp_f32 v188, v188
v_mfma_f32_16x16x32_bf16 v[92:95], a[64:67], a[184:187], v[92:95]
buffer_load_dwordx4 v1, s[8:11], s60 offen offset:0 sc1 lds
v_mfma_f32_16x16x32_bf16 v[96:99], a[64:67], a[188:191], v[96:99]
v_mfma_f32_16x16x32_bf16 v[100:103], a[68:71], a[184:187], v[100:103]
v_exp_f32 v189, v189
v_mfma_f32_16x16x32_bf16 v[104:107], a[68:71], a[188:191], v[104:107]
s_waitcnt lgkmcnt(0)
v_mfma_f32_16x16x32_bf16 v[36:39], a[0:3], a[192:195], v[36:39]
ds_read_b128 a[36:39], v190 offset:9216
buffer_load_dwordx4 v1, s[8:11], s60 offen offset:1024 sc1 lds
v_mfma_f32_16x16x32_bf16 v[40:43], a[0:3], a[196:199], v[40:43]
ds_read_b128 a[40:43], v190 offset:10240
v_fma_f32 v186, v186, v255, v255
v_mfma_f32_16x16x32_bf16 v[44:47], a[4:7], a[192:195], v[44:47]
ds_read_b128 a[44:47], v190 offset:11264
v_fma_f32 v187, v187, v255, v255
v_mfma_f32_16x16x32_bf16 v[48:51], a[4:7], a[196:199], v[48:51]
ds_read_b128 a[48:51], v190 offset:12288
v_fma_f32 v188, v188, v255, v255
v_mfma_f32_16x16x32_bf16 v[52:55], a[8:11], a[192:195], v[52:55]
ds_read_b128 a[52:55], v190 offset:13312
buffer_load_dwordx4 v1, s[8:11], s60 offen offset:2048 sc1 lds
v_mfma_f32_16x16x32_bf16 v[56:59], a[8:11], a[196:199], v[56:59]
ds_read_b128 a[56:59], v190 offset:14336
v_fma_f32 v189, v189, v255, v255
v_mfma_f32_16x16x32_bf16 v[60:63], a[12:15], a[192:195], v[60:63]
ds_read_b128 a[60:63], v190 offset:15360
v_mfma_f32_16x16x32_bf16 v[64:67], a[12:15], a[196:199], v[64:67]
ds_read_b128 a[64:67], v190 offset:16384
v_mfma_f32_16x16x32_bf16 v[68:71], a[16:19], a[192:195], v[68:71]
ds_read_b128 a[68:71], v190 offset:17408
buffer_load_dwordx4 v1, s[8:11], s60 offen offset:3072 sc1 lds
v_mfma_f32_16x16x32_bf16 v[72:75], a[16:19], a[196:199], v[72:75]
v_rcp_f32 v186, v186
v_mfma_f32_16x16x32_bf16 v[76:79], a[20:23], a[192:195], v[76:79]
v_rcp_f32 v187, v187
v_mfma_f32_16x16x32_bf16 v[80:83], a[20:23], a[196:199], v[80:83]
v_mfma_f32_16x16x32_bf16 v[84:87], a[24:27], a[192:195], v[84:87]
buffer_load_dwordx4 a[128:131], v1, s[4:7], s84 offen offset:2048 sc1
v_mfma_f32_16x16x32_bf16 v[88:91], a[24:27], a[196:199], v[88:91]
v_rcp_f32 v188, v188
v_mfma_f32_16x16x32_bf16 v[92:95], a[28:31], a[192:195], v[92:95]
v_mfma_f32_16x16x32_bf16 v[96:99], a[28:31], a[196:199], v[96:99]
v_rcp_f32 v189, v189
v_mfma_f32_16x16x32_bf16 v[100:103], a[32:35], a[192:195], v[100:103]
v_mfma_f32_16x16x32_bf16 v[104:107], a[32:35], a[196:199], v[104:107]
s_waitcnt vmcnt(18)
s_waitcnt lgkmcnt(0)
s_barrier
v_mfma_f32_16x16x32_bf16 v[36:39], a[36:39], a[200:203], v[36:39]
ds_read_b128 a[0:3], v190 offset:18432
buffer_load_dwordx4 a[132:135], v9, s[4:7], s84 offen offset:2048 sc1
v_mfma_f32_16x16x32_bf16 v[40:43], a[36:39], a[204:207], v[40:43]
ds_read_b128 a[4:7], v190 offset:19456
v_mul_f32 v136, v136, v186
v_mfma_f32_16x16x32_bf16 v[44:47], a[40:43], a[200:203], v[44:47]
ds_read_b128 a[8:11], v190 offset:20480
v_mul_f32 v137, v137, v187
v_mfma_f32_16x16x32_bf16 v[48:51], a[40:43], a[204:207], v[48:51]
ds_read_b128 a[12:15], v190 offset:21504
v_mul_f32 v138, v138, v188
v_mfma_f32_16x16x32_bf16 v[52:55], a[44:47], a[200:203], v[52:55]
ds_read_b128 a[16:19], v190 offset:22528
v_mul_f32 v139, v139, v189
v_mfma_f32_16x16x32_bf16 v[56:59], a[44:47], a[204:207], v[56:59]
ds_read_b128 a[20:23], v190 offset:23552
buffer_load_dwordx4 a[136:139], v1, s[4:7], s84 offen offset:3072 sc1
v_mfma_f32_16x16x32_bf16 v[60:63], a[48:51], a[200:203], v[60:63]
ds_read_b128 a[24:27], v190 offset:24576
v_mul_f32 v182, v140, v140
v_mfma_f32_16x16x32_bf16 v[64:67], a[48:51], a[204:207], v[64:67]
ds_read_b128 a[28:31], v190 offset:25600
v_mul_f32 v183, v141, v141
v_mfma_f32_16x16x32_bf16 v[68:71], a[52:55], a[200:203], v[68:71]
ds_read_b128 a[32:35], v190 offset:26624
v_mfma_f32_16x16x32_bf16 v[72:75], a[52:55], a[204:207], v[72:75]
v_mul_f32 v184, v142, v142
v_mfma_f32_16x16x32_bf16 v[76:79], a[56:59], a[200:203], v[76:79]
v_mul_f32 v185, v143, v143
v_mfma_f32_16x16x32_bf16 v[80:83], a[56:59], a[204:207], v[80:83]
buffer_load_dwordx4 a[140:143], v9, s[4:7], s84 offen offset:3072 sc1
v_mfma_f32_16x16x32_bf16 v[84:87], a[60:63], a[200:203], v[84:87]
v_fma_f32 v182, v182, v254, v253
v_mfma_f32_16x16x32_bf16 v[88:91], a[60:63], a[204:207], v[88:91]
v_fma_f32 v183, v183, v254, v253
v_mfma_f32_16x16x32_bf16 v[92:95], a[64:67], a[200:203], v[92:95]
v_mfma_f32_16x16x32_bf16 v[96:99], a[64:67], a[204:207], v[96:99]
v_fma_f32 v184, v184, v254, v253
v_mfma_f32_16x16x32_bf16 v[100:103], a[68:71], a[200:203], v[100:103]
v_fma_f32 v185, v185, v254, v253
v_mfma_f32_16x16x32_bf16 v[104:107], a[68:71], a[204:207], v[104:107]
s_waitcnt lgkmcnt(0)
v_mfma_f32_16x16x32_bf16 v[36:39], a[0:3], a[208:211], v[36:39]
ds_read_b128 a[36:39], v190 offset:27648
s_add_u32 m0, s62, 90112
v_mul_f32 v182, v182, v140
v_mfma_f32_16x16x32_bf16 v[40:43], a[0:3], a[212:215], v[40:43]
ds_read_b128 a[40:43], v190 offset:28672
s_add_u32 s60, s60, 16384
v_mul_f32 v183, v183, v141
v_mfma_f32_16x16x32_bf16 v[44:47], a[4:7], a[208:211], v[44:47]
ds_read_b128 a[44:47], v190 offset:29696
v_mfma_f32_16x16x32_bf16 v[48:51], a[4:7], a[212:215], v[48:51]
ds_read_b128 a[48:51], v190 offset:30720
v_mul_f32 v184, v184, v142
v_mfma_f32_16x16x32_bf16 v[52:55], a[8:11], a[208:211], v[52:55]
ds_read_b128 a[52:55], v190 offset:31744
v_mul_f32 v185, v185, v143
v_mfma_f32_16x16x32_bf16 v[56:59], a[8:11], a[212:215], v[56:59]
ds_read_b128 a[56:59], v190 offset:32768
buffer_load_dwordx4 v1, s[8:11], s60 offen offset:0 sc1 lds
v_mfma_f32_16x16x32_bf16 v[60:63], a[12:15], a[208:211], v[60:63]
ds_read_b128 a[60:63], v190 offset:33792
v_mfma_f32_16x16x32_bf16 v[64:67], a[12:15], a[212:215], v[64:67]
ds_read_b128 a[64:67], v190 offset:34816
v_mfma_f32_16x16x32_bf16 v[68:71], a[16:19], a[208:211], v[68:71]
ds_read_b128 a[68:71], v190 offset:35840
buffer_load_dwordx4 v1, s[8:11], s60 offen offset:1024 sc1 lds
v_mfma_f32_16x16x32_bf16 v[72:75], a[16:19], a[212:215], v[72:75]
v_exp_f32 v182, v182
v_mfma_f32_16x16x32_bf16 v[76:79], a[20:23], a[208:211], v[76:79]
v_exp_f32 v183, v183
v_mfma_f32_16x16x32_bf16 v[80:83], a[20:23], a[212:215], v[80:83]
buffer_load_dwordx4 v1, s[8:11], s60 offen offset:2048 sc1 lds
v_mfma_f32_16x16x32_bf16 v[84:87], a[24:27], a[208:211], v[84:87]
v_exp_f32 v184, v184
v_mfma_f32_16x16x32_bf16 v[88:91], a[24:27], a[212:215], v[88:91]
v_mfma_f32_16x16x32_bf16 v[92:95], a[28:31], a[208:211], v[92:95]
buffer_load_dwordx4 v1, s[8:11], s60 offen offset:3072 sc1 lds
v_mfma_f32_16x16x32_bf16 v[96:99], a[28:31], a[212:215], v[96:99]
v_exp_f32 v185, v185
v_mfma_f32_16x16x32_bf16 v[100:103], a[32:35], a[208:211], v[100:103]
v_mfma_f32_16x16x32_bf16 v[104:107], a[32:35], a[212:215], v[104:107]
s_waitcnt vmcnt(12)
s_waitcnt lgkmcnt(0)
s_barrier
v_mfma_f32_16x16x32_bf16 v[36:39], a[36:39], a[216:219], v[36:39]
ds_read_b128 a[0:3], v191 offset:0
s_add_u32 m0, s63, 106496
v_fma_f32 v182, v182, v255, v255
v_mfma_f32_16x16x32_bf16 v[40:43], a[36:39], a[220:223], v[40:43]
ds_read_b128 a[4:7], v191 offset:1024
s_add_u32 s61, s61, 36864
v_fma_f32 v183, v183, v255, v255
v_mfma_f32_16x16x32_bf16 v[44:47], a[40:43], a[216:219], v[44:47]
ds_read_b128 a[8:11], v191 offset:2048
v_fma_f32 v184, v184, v255, v255
v_mfma_f32_16x16x32_bf16 v[48:51], a[40:43], a[220:223], v[48:51]
ds_read_b128 a[12:15], v191 offset:3072
v_mfma_f32_16x16x32_bf16 v[52:55], a[44:47], a[216:219], v[52:55]
ds_read_b128 a[16:19], v191 offset:4096
buffer_load_dwordx4 v1, s[8:11], s61 offen offset:0 sc1 lds
s_add_u32 m0, s62, 110592
v_mfma_f32_16x16x32_bf16 v[56:59], a[44:47], a[220:223], v[56:59]
ds_read_b128 a[20:23], v191 offset:5120
s_add_u32 s60, s60, 20480
v_fma_f32 v185, v185, v255, v255
v_mfma_f32_16x16x32_bf16 v[60:63], a[48:51], a[216:219], v[60:63]
ds_read_b128 a[24:27], v191 offset:6144
v_mfma_f32_16x16x32_bf16 v[64:67], a[48:51], a[220:223], v[64:67]
ds_read_b128 a[28:31], v191 offset:7168
v_mfma_f32_16x16x32_bf16 v[68:71], a[52:55], a[216:219], v[68:71]
ds_read_b128 a[32:35], v191 offset:8192
v_mfma_f32_16x16x32_bf16 v[72:75], a[52:55], a[220:223], v[72:75]
v_rcp_f32 v182, v182
v_mfma_f32_16x16x32_bf16 v[76:79], a[56:59], a[216:219], v[76:79]
buffer_load_dwordx4 v1, s[8:11], s60 offen offset:0 sc1 lds
v_mfma_f32_16x16x32_bf16 v[80:83], a[56:59], a[220:223], v[80:83]
v_rcp_f32 v183, v183
v_mfma_f32_16x16x32_bf16 v[84:87], a[60:63], a[216:219], v[84:87]
buffer_load_dwordx4 v1, s[8:11], s60 offen offset:1024 sc1 lds
v_mfma_f32_16x16x32_bf16 v[88:91], a[60:63], a[220:223], v[88:91]
v_rcp_f32 v184, v184
v_mfma_f32_16x16x32_bf16 v[92:95], a[64:67], a[216:219], v[92:95]
buffer_load_dwordx4 v1, s[8:11], s60 offen offset:2048 sc1 lds
v_mfma_f32_16x16x32_bf16 v[96:99], a[64:67], a[220:223], v[96:99]
v_rcp_f32 v185, v185
v_mfma_f32_16x16x32_bf16 v[100:103], a[68:71], a[216:219], v[100:103]
v_mfma_f32_16x16x32_bf16 v[104:107], a[68:71], a[220:223], v[104:107]
v_mul_f32 v140, v140, v182
s_waitcnt lgkmcnt(0)
v_mfma_f32_16x16x32_bf16 v[36:39], a[0:3], a[224:227], v[36:39]
ds_read_b128 a[36:39], v191 offset:9216
buffer_load_dwordx4 v1, s[8:11], s60 offen offset:3072 sc1 lds
s_add_u32 s84, s84, 4096
v_mfma_f32_16x16x32_bf16 v[40:43], a[0:3], a[228:231], v[40:43]
ds_read_b128 a[40:43], v191 offset:10240
v_mul_f32 v141, v141, v183
v_mfma_f32_16x16x32_bf16 v[44:47], a[4:7], a[224:227], v[44:47]
ds_read_b128 a[44:47], v191 offset:11264
v_mul_f32 v142, v142, v184
v_mfma_f32_16x16x32_bf16 v[48:51], a[4:7], a[228:231], v[48:51]
ds_read_b128 a[48:51], v191 offset:12288
v_mul_f32 v143, v143, v185
v_mfma_f32_16x16x32_bf16 v[52:55], a[8:11], a[224:227], v[52:55]
ds_read_b128 a[52:55], v191 offset:13312
v_mfma_f32_16x16x32_bf16 v[56:59], a[8:11], a[228:231], v[56:59]
ds_read_b128 a[56:59], v191 offset:14336
v_mfma_f32_16x16x32_bf16 v[60:63], a[12:15], a[224:227], v[60:63]
ds_read_b128 a[60:63], v191 offset:15360
buffer_load_dwordx4 a[144:147], v1, s[4:7], s84 offen offset:0 sc1
v_mfma_f32_16x16x32_bf16 v[64:67], a[12:15], a[228:231], v[64:67]
ds_read_b128 a[64:67], v191 offset:16384
v_mfma_f32_16x16x32_bf16 v[68:71], a[16:19], a[224:227], v[68:71]
ds_read_b128 a[68:71], v191 offset:17408
v_mfma_f32_16x16x32_bf16 v[72:75], a[16:19], a[228:231], v[72:75]
v_permlane16_swap_b32 v132, v136
v_mfma_f32_16x16x32_bf16 v[76:79], a[20:23], a[224:227], v[76:79]
buffer_load_dwordx4 a[148:151], v9, s[4:7], s84 offen offset:0 sc1
v_mfma_f32_16x16x32_bf16 v[80:83], a[20:23], a[228:231], v[80:83]
v_permlane16_swap_b32 v133, v137
v_mfma_f32_16x16x32_bf16 v[84:87], a[24:27], a[224:227], v[84:87]
v_permlane16_swap_b32 v134, v138
v_mfma_f32_16x16x32_bf16 v[88:91], a[24:27], a[228:231], v[88:91]
buffer_load_dwordx4 a[152:155], v1, s[4:7], s84 offen offset:1024 sc1
v_mfma_f32_16x16x32_bf16 v[92:95], a[28:31], a[224:227], v[92:95]
v_permlane16_swap_b32 v135, v139
v_mfma_f32_16x16x32_bf16 v[96:99], a[28:31], a[228:231], v[96:99]
v_mfma_f32_16x16x32_bf16 v[100:103], a[32:35], a[224:227], v[100:103]
v_mul_f32 v186, v144, v144
v_mfma_f32_16x16x32_bf16 v[104:107], a[32:35], a[228:231], v[104:107]
s_waitcnt vmcnt(16)
s_waitcnt lgkmcnt(0)
s_barrier
v_mfma_f32_16x16x32_bf16 v[36:39], a[36:39], a[232:235], v[36:39]
ds_read_b128 a[0:3], v191 offset:18432
buffer_load_dwordx4 a[156:159], v9, s[4:7], s84 offen offset:1024 sc1
s_add_u32 m0, s62, 126976
v_mfma_f32_16x16x32_bf16 v[40:43], a[36:39], a[236:239], v[40:43]
ds_read_b128 a[4:7], v191 offset:19456
s_add_u32 s60, s60, 16384
v_mul_f32 v187, v145, v145
v_mfma_f32_16x16x32_bf16 v[44:47], a[40:43], a[232:235], v[44:47]
ds_read_b128 a[8:11], v191 offset:20480
v_mul_f32 v188, v146, v146
v_mfma_f32_16x16x32_bf16 v[48:51], a[40:43], a[236:239], v[48:51]
ds_read_b128 a[12:15], v191 offset:21504
v_mul_f32 v189, v147, v147
v_mfma_f32_16x16x32_bf16 v[52:55], a[44:47], a[232:235], v[52:55]
ds_read_b128 a[16:19], v191 offset:22528
v_fma_f32 v186, v186, v254, v253
v_mfma_f32_16x16x32_bf16 v[56:59], a[44:47], a[236:239], v[56:59]
ds_read_b128 a[20:23], v191 offset:23552
v_mfma_f32_16x16x32_bf16 v[60:63], a[48:51], a[232:235], v[60:63]
ds_read_b128 a[24:27], v191 offset:24576
v_fma_f32 v187, v187, v254, v253
v_mfma_f32_16x16x32_bf16 v[64:67], a[48:51], a[236:239], v[64:67]
ds_read_b128 a[28:31], v191 offset:25600
v_fma_f32 v188, v188, v254, v253
v_mfma_f32_16x16x32_bf16 v[68:71], a[52:55], a[232:235], v[68:71]
ds_read_b128 a[32:35], v191 offset:26624
buffer_load_dwordx4 v1, s[8:11], s60 offen offset:0 sc1 lds
v_mfma_f32_16x16x32_bf16 v[72:75], a[52:55], a[236:239], v[72:75]
v_fma_f32 v189, v189, v254, v253
v_mfma_f32_16x16x32_bf16 v[76:79], a[56:59], a[232:235], v[76:79]
v_mul_f32 v186, v186, v144
v_mfma_f32_16x16x32_bf16 v[80:83], a[56:59], a[236:239], v[80:83]
buffer_load_dwordx4 v1, s[8:11], s60 offen offset:1024 sc1 lds
v_mul_f32 v187, v187, v145
v_mfma_f32_16x16x32_bf16 v[84:87], a[60:63], a[232:235], v[84:87]
v_mfma_f32_16x16x32_bf16 v[88:91], a[60:63], a[236:239], v[88:91]
v_mul_f32 v188, v188, v146
v_mfma_f32_16x16x32_bf16 v[92:95], a[64:67], a[232:235], v[92:95]
buffer_load_dwordx4 v1, s[8:11], s60 offen offset:2048 sc1 lds
v_mul_f32 v189, v189, v147
v_mfma_f32_16x16x32_bf16 v[96:99], a[64:67], a[236:239], v[96:99]
v_mfma_f32_16x16x32_bf16 v[100:103], a[68:71], a[232:235], v[100:103]
v_exp_f32 v186, v186
v_mfma_f32_16x16x32_bf16 v[104:107], a[68:71], a[236:239], v[104:107]
s_waitcnt lgkmcnt(0)
v_mfma_f32_16x16x32_bf16 v[36:39], a[0:3], a[240:243], v[36:39]
ds_read_b128 a[36:39], v191 offset:27648
buffer_load_dwordx4 v1, s[8:11], s60 offen offset:3072 sc1 lds
v_mfma_f32_16x16x32_bf16 v[40:43], a[0:3], a[244:247], v[40:43]
ds_read_b128 a[40:43], v191 offset:28672
v_mfma_f32_16x16x32_bf16 v[44:47], a[4:7], a[240:243], v[44:47]
ds_read_b128 a[44:47], v191 offset:29696
v_mfma_f32_16x16x32_bf16 v[48:51], a[4:7], a[244:247], v[48:51]
ds_read_b128 a[48:51], v191 offset:30720
v_mfma_f32_16x16x32_bf16 v[52:55], a[8:11], a[240:243], v[52:55]
ds_read_b128 a[52:55], v191 offset:31744
v_mfma_f32_16x16x32_bf16 v[56:59], a[8:11], a[244:247], v[56:59]
ds_read_b128 a[56:59], v191 offset:32768
buffer_load_dwordx4 a[160:163], v1, s[4:7], s84 offen offset:2048 sc1
v_mfma_f32_16x16x32_bf16 v[60:63], a[12:15], a[240:243], v[60:63]
ds_read_b128 a[60:63], v191 offset:33792
v_mfma_f32_16x16x32_bf16 v[64:67], a[12:15], a[244:247], v[64:67]
ds_read_b128 a[64:67], v191 offset:34816
v_mfma_f32_16x16x32_bf16 v[68:71], a[16:19], a[240:243], v[68:71]
ds_read_b128 a[68:71], v191 offset:35840
v_mfma_f32_16x16x32_bf16 v[72:75], a[16:19], a[244:247], v[72:75]
v_exp_f32 v187, v187
v_mfma_f32_16x16x32_bf16 v[76:79], a[20:23], a[240:243], v[76:79]
v_exp_f32 v188, v188
v_mfma_f32_16x16x32_bf16 v[80:83], a[20:23], a[244:247], v[80:83]
buffer_load_dwordx4 a[164:167], v9, s[4:7], s84 offen offset:2048 sc1
v_mfma_f32_16x16x32_bf16 v[84:87], a[24:27], a[240:243], v[84:87]
v_exp_f32 v189, v189
v_mfma_f32_16x16x32_bf16 v[88:91], a[24:27], a[244:247], v[88:91]
v_fma_f32 v186, v186, v255, v255
v_fma_f32 v187, v187, v255, v255
v_mfma_f32_16x16x32_bf16 v[92:95], a[28:31], a[240:243], v[92:95]
v_fma_f32 v188, v188, v255, v255
v_fma_f32 v189, v189, v255, v255
v_mfma_f32_16x16x32_bf16 v[96:99], a[28:31], a[244:247], v[96:99]
v_rcp_f32 v186, v186
v_mfma_f32_16x16x32_bf16 v[100:103], a[32:35], a[240:243], v[100:103]
v_mfma_f32_16x16x32_bf16 v[104:107], a[32:35], a[244:247], v[104:107]
s_waitcnt vmcnt(14)
s_waitcnt lgkmcnt(0)
s_barrier
v_mfma_f32_16x16x32_bf16 v[36:39], a[36:39], a[248:251], v[36:39]
ds_read_b128 a[0:3], v190 offset:0
buffer_load_dwordx4 a[168:171], v1, s[4:7], s84 offen offset:3072 sc1
v_mfma_f32_16x16x32_bf16 v[40:43], a[36:39], a[252:255], v[40:43]
ds_read_b128 a[4:7], v190 offset:1024
v_mfma_f32_16x16x32_bf16 v[44:47], a[40:43], a[248:251], v[44:47]
ds_read_b128 a[8:11], v190 offset:2048
buffer_load_dwordx4 a[172:175], v9, s[4:7], s84 offen offset:3072 sc1
s_add_u32 m0, s63, 143360
v_mfma_f32_16x16x32_bf16 v[48:51], a[40:43], a[252:255], v[48:51]
ds_read_b128 a[12:15], v190 offset:3072
s_add_u32 s61, s61, 36864
v_mfma_f32_16x16x32_bf16 v[52:55], a[44:47], a[248:251], v[52:55]
ds_read_b128 a[16:19], v190 offset:4096
v_mfma_f32_16x16x32_bf16 v[56:59], a[44:47], a[252:255], v[56:59]
ds_read_b128 a[20:23], v190 offset:5120
v_mfma_f32_16x16x32_bf16 v[60:63], a[48:51], a[248:251], v[60:63]
ds_read_b128 a[24:27], v190 offset:6144
v_mfma_f32_16x16x32_bf16 v[64:67], a[48:51], a[252:255], v[64:67]
ds_read_b128 a[28:31], v190 offset:7168
v_mfma_f32_16x16x32_bf16 v[68:71], a[52:55], a[248:251], v[68:71]
ds_read_b128 a[32:35], v190 offset:8192
buffer_load_dwordx4 v1, s[8:11], s61 offen offset:0 sc1 lds
s_add_u32 m0, s62, 147456
v_mfma_f32_16x16x32_bf16 v[72:75], a[52:55], a[252:255], v[72:75]
s_add_u32 s60, s60, 20480
v_rcp_f32 v187, v187
v_mfma_f32_16x16x32_bf16 v[76:79], a[56:59], a[248:251], v[76:79]
v_rcp_f32 v188, v188
v_mfma_f32_16x16x32_bf16 v[80:83], a[56:59], a[252:255], v[80:83]
v_rcp_f32 v189, v189
v_mfma_f32_16x16x32_bf16 v[84:87], a[60:63], a[248:251], v[84:87]
v_mul_f32 v144, v144, v186
v_mul_f32 v145, v145, v187
v_mfma_f32_16x16x32_bf16 v[88:91], a[60:63], a[252:255], v[88:91]
v_mul_f32 v146, v146, v188
v_mul_f32 v147, v147, v189
v_mfma_f32_16x16x32_bf16 v[92:95], a[64:67], a[248:251], v[92:95]
buffer_load_dwordx4 v1, s[8:11], s60 offen offset:0 sc1 lds
v_mfma_f32_16x16x32_bf16 v[96:99], a[64:67], a[252:255], v[96:99]
v_mul_f32 v182, v148, v148
v_mfma_f32_16x16x32_bf16 v[100:103], a[68:71], a[248:251], v[100:103]
v_mul_f32 v183, v149, v149
v_mfma_f32_16x16x32_bf16 v[104:107], a[68:71], a[252:255], v[104:107]
s_waitcnt lgkmcnt(0)
v_mfma_f32_16x16x32_bf16 v[36:39], a[0:3], a[80:83], v[36:39]
ds_read_b128 a[36:39], v190 offset:9216
buffer_load_dwordx4 v1, s[8:11], s60 offen offset:1024 sc1 lds
v_mfma_f32_16x16x32_bf16 v[40:43], a[0:3], a[84:87], v[40:43]
ds_read_b128 a[40:43], v190 offset:10240
v_mul_f32 v184, v150, v150
v_mfma_f32_16x16x32_bf16 v[44:47], a[4:7], a[80:83], v[44:47]
ds_read_b128 a[44:47], v190 offset:11264
v_mul_f32 v185, v151, v151
v_mfma_f32_16x16x32_bf16 v[48:51], a[4:7], a[84:87], v[48:51]
ds_read_b128 a[48:51], v190 offset:12288
buffer_load_dwordx4 v1, s[8:11], s60 offen offset:2048 sc1 lds
v_mfma_f32_16x16x32_bf16 v[52:55], a[8:11], a[80:83], v[52:55]
ds_read_b128 a[52:55], v190 offset:13312
v_fma_f32 v182, v182, v254, v253
v_mfma_f32_16x16x32_bf16 v[56:59], a[8:11], a[84:87], v[56:59]
ds_read_b128 a[56:59], v190 offset:14336
v_fma_f32 v183, v183, v254, v253
v_mfma_f32_16x16x32_bf16 v[60:63], a[12:15], a[80:83], v[60:63]
ds_read_b128 a[60:63], v190 offset:15360
buffer_load_dwordx4 v1, s[8:11], s60 offen offset:3072 sc1 lds
s_add_u32 s84, s84, 4096
v_mfma_f32_16x16x32_bf16 v[64:67], a[12:15], a[84:87], v[64:67]
ds_read_b128 a[64:67], v190 offset:16384
v_fma_f32 v184, v184, v254, v253
v_mfma_f32_16x16x32_bf16 v[68:71], a[16:19], a[80:83], v[68:71]
ds_read_b128 a[68:71], v190 offset:17408
v_fma_f32 v185, v185, v254, v253
v_mfma_f32_16x16x32_bf16 v[72:75], a[16:19], a[84:87], v[72:75]
v_mul_f32 v182, v182, v148
v_mfma_f32_16x16x32_bf16 v[76:79], a[20:23], a[80:83], v[76:79]
v_mul_f32 v183, v183, v149
v_mfma_f32_16x16x32_bf16 v[80:83], a[20:23], a[84:87], v[80:83]
v_mfma_f32_16x16x32_bf16 v[84:87], a[24:27], a[80:83], v[84:87]
v_mul_f32 v184, v184, v150
v_mfma_f32_16x16x32_bf16 v[88:91], a[24:27], a[84:87], v[88:91]
buffer_load_dwordx4 a[176:179], v1, s[4:7], s84 offen offset:0 sc1
v_mul_f32 v185, v185, v151
v_mfma_f32_16x16x32_bf16 v[92:95], a[28:31], a[80:83], v[92:95]
v_exp_f32 v182, v182
v_mfma_f32_16x16x32_bf16 v[96:99], a[28:31], a[84:87], v[96:99]
v_mfma_f32_16x16x32_bf16 v[100:103], a[32:35], a[80:83], v[100:103]
v_mfma_f32_16x16x32_bf16 v[104:107], a[32:35], a[84:87], v[104:107]
s_waitcnt vmcnt(18)
s_waitcnt lgkmcnt(0)
s_barrier
v_mfma_f32_16x16x32_bf16 v[36:39], a[36:39], a[88:91], v[36:39]
ds_read_b128 a[0:3], v190 offset:18432
buffer_load_dwordx4 a[180:183], v9, s[4:7], s84 offen offset:0 sc1
v_mfma_f32_16x16x32_bf16 v[40:43], a[36:39], a[92:95], v[40:43]
ds_read_b128 a[4:7], v190 offset:19456
v_mfma_f32_16x16x32_bf16 v[44:47], a[40:43], a[88:91], v[44:47]
ds_read_b128 a[8:11], v190 offset:20480
buffer_load_dwordx4 a[184:187], v1, s[4:7], s84 offen offset:1024 sc1
v_mfma_f32_16x16x32_bf16 v[48:51], a[40:43], a[92:95], v[48:51]
ds_read_b128 a[12:15], v190 offset:21504
v_mfma_f32_16x16x32_bf16 v[52:55], a[44:47], a[88:91], v[52:55]
ds_read_b128 a[16:19], v190 offset:22528
v_mfma_f32_16x16x32_bf16 v[56:59], a[44:47], a[92:95], v[56:59]
ds_read_b128 a[20:23], v190 offset:23552
buffer_load_dwordx4 a[188:191], v9, s[4:7], s84 offen offset:1024 sc1
s_add_u32 m0, s62, 90112
v_mfma_f32_16x16x32_bf16 v[60:63], a[48:51], a[88:91], v[60:63]
ds_read_b128 a[24:27], v190 offset:24576
s_add_u32 s60, s60, 16384
v_mfma_f32_16x16x32_bf16 v[64:67], a[48:51], a[92:95], v[64:67]
ds_read_b128 a[28:31], v190 offset:25600
v_mfma_f32_16x16x32_bf16 v[68:71], a[52:55], a[88:91], v[68:71]
ds_read_b128 a[32:35], v190 offset:26624
v_mfma_f32_16x16x32_bf16 v[72:75], a[52:55], a[92:95], v[72:75]
v_exp_f32 v183, v183
v_mfma_f32_16x16x32_bf16 v[76:79], a[56:59], a[88:91], v[76:79]
v_exp_f32 v184, v184
v_mfma_f32_16x16x32_bf16 v[80:83], a[56:59], a[92:95], v[80:83]
v_exp_f32 v185, v185
v_mfma_f32_16x16x32_bf16 v[84:87], a[60:63], a[88:91], v[84:87]
v_fma_f32 v182, v182, v255, v255
v_fma_f32 v183, v183, v255, v255
v_mfma_f32_16x16x32_bf16 v[88:91], a[60:63], a[92:95], v[88:91]
v_fma_f32 v184, v184, v255, v255
v_fma_f32 v185, v185, v255, v255
v_mfma_f32_16x16x32_bf16 v[92:95], a[64:67], a[88:91], v[92:95]
buffer_load_dwordx4 v1, s[8:11], s60 offen offset:0 sc1 lds
v_mfma_f32_16x16x32_bf16 v[96:99], a[64:67], a[92:95], v[96:99]
v_rcp_f32 v182, v182
v_mfma_f32_16x16x32_bf16 v[100:103], a[68:71], a[88:91], v[100:103]
v_mfma_f32_16x16x32_bf16 v[104:107], a[68:71], a[92:95], v[104:107]
s_waitcnt lgkmcnt(0)
v_mfma_f32_16x16x32_bf16 v[36:39], a[0:3], a[96:99], v[36:39]
ds_read_b128 a[36:39], v190 offset:27648
buffer_load_dwordx4 v1, s[8:11], s60 offen offset:1024 sc1 lds
v_mfma_f32_16x16x32_bf16 v[40:43], a[0:3], a[100:103], v[40:43]
ds_read_b128 a[40:43], v190 offset:28672
v_mfma_f32_16x16x32_bf16 v[44:47], a[4:7], a[96:99], v[44:47]
ds_read_b128 a[44:47], v190 offset:29696
v_mfma_f32_16x16x32_bf16 v[48:51], a[4:7], a[100:103], v[48:51]
ds_read_b128 a[48:51], v190 offset:30720
v_mfma_f32_16x16x32_bf16 v[52:55], a[8:11], a[96:99], v[52:55]
ds_read_b128 a[52:55], v190 offset:31744
buffer_load_dwordx4 v1, s[8:11], s60 offen offset:2048 sc1 lds
v_mfma_f32_16x16x32_bf16 v[56:59], a[8:11], a[100:103], v[56:59]
ds_read_b128 a[56:59], v190 offset:32768
v_mfma_f32_16x16x32_bf16 v[60:63], a[12:15], a[96:99], v[60:63]
ds_read_b128 a[60:63], v190 offset:33792
v_mfma_f32_16x16x32_bf16 v[64:67], a[12:15], a[100:103], v[64:67]
ds_read_b128 a[64:67], v190 offset:34816
v_mfma_f32_16x16x32_bf16 v[68:71], a[16:19], a[96:99], v[68:71]
ds_read_b128 a[68:71], v190 offset:35840
buffer_load_dwordx4 v1, s[8:11], s60 offen offset:3072 sc1 lds
v_mfma_f32_16x16x32_bf16 v[72:75], a[16:19], a[100:103], v[72:75]
v_rcp_f32 v183, v183
v_mfma_f32_16x16x32_bf16 v[76:79], a[20:23], a[96:99], v[76:79]
v_rcp_f32 v184, v184
v_mfma_f32_16x16x32_bf16 v[80:83], a[20:23], a[100:103], v[80:83]
v_rcp_f32 v185, v185
v_mfma_f32_16x16x32_bf16 v[84:87], a[24:27], a[96:99], v[84:87]
buffer_load_dwordx4 a[192:195], v1, s[4:7], s84 offen offset:2048 sc1
v_mul_f32 v148, v148, v182
v_mfma_f32_16x16x32_bf16 v[88:91], a[24:27], a[100:103], v[88:91]
v_mul_f32 v149, v149, v183
v_mul_f32 v150, v150, v184
v_mfma_f32_16x16x32_bf16 v[92:95], a[28:31], a[96:99], v[92:95]
v_mul_f32 v151, v151, v185
v_mfma_f32_16x16x32_bf16 v[96:99], a[28:31], a[100:103], v[96:99]
v_permlane16_swap_b32 v140, v144
v_mfma_f32_16x16x32_bf16 v[100:103], a[32:35], a[96:99], v[100:103]
v_permlane16_swap_b32 v141, v145
v_mfma_f32_16x16x32_bf16 v[104:107], a[32:35], a[100:103], v[104:107]
s_waitcnt vmcnt(13)
s_waitcnt lgkmcnt(0)
s_barrier
v_mfma_f32_16x16x32_bf16 v[36:39], a[36:39], a[104:107], v[36:39]
ds_read_b128 a[0:3], v191 offset:0
buffer_load_dwordx4 a[196:199], v9, s[4:7], s84 offen offset:2048 sc1
v_mfma_f32_16x16x32_bf16 v[40:43], a[36:39], a[108:111], v[40:43]
ds_read_b128 a[4:7], v191 offset:1024
v_mfma_f32_16x16x32_bf16 v[44:47], a[40:43], a[104:107], v[44:47]
ds_read_b128 a[8:11], v191 offset:2048
v_mfma_f32_16x16x32_bf16 v[48:51], a[40:43], a[108:111], v[48:51]
ds_read_b128 a[12:15], v191 offset:3072
v_mfma_f32_16x16x32_bf16 v[52:55], a[44:47], a[104:107], v[52:55]
ds_read_b128 a[16:19], v191 offset:4096
v_mfma_f32_16x16x32_bf16 v[56:59], a[44:47], a[108:111], v[56:59]
ds_read_b128 a[20:23], v191 offset:5120
buffer_load_dwordx4 a[200:203], v1, s[4:7], s84 offen offset:3072 sc1
v_mfma_f32_16x16x32_bf16 v[60:63], a[48:51], a[104:107], v[60:63]
ds_read_b128 a[24:27], v191 offset:6144
v_mfma_f32_16x16x32_bf16 v[64:67], a[48:51], a[108:111], v[64:67]
ds_read_b128 a[28:31], v191 offset:7168
v_mfma_f32_16x16x32_bf16 v[68:71], a[52:55], a[104:107], v[68:71]
ds_read_b128 a[32:35], v191 offset:8192
v_mfma_f32_16x16x32_bf16 v[72:75], a[52:55], a[108:111], v[72:75]
v_permlane16_swap_b32 v142, v146
v_mfma_f32_16x16x32_bf16 v[76:79], a[56:59], a[104:107], v[76:79]
v_permlane16_swap_b32 v143, v147
v_mfma_f32_16x16x32_bf16 v[80:83], a[56:59], a[108:111], v[80:83]
buffer_load_dwordx4 a[204:207], v9, s[4:7], s84 offen offset:3072 sc1
v_mul_f32 v186, v152, v152
v_mfma_f32_16x16x32_bf16 v[84:87], a[60:63], a[104:107], v[84:87]
v_mul_f32 v187, v153, v153
v_mul_f32 v188, v154, v154
v_mfma_f32_16x16x32_bf16 v[88:91], a[60:63], a[108:111], v[88:91]
v_mul_f32 v189, v155, v155
v_fma_f32 v186, v186, v254, v253
v_mfma_f32_16x16x32_bf16 v[92:95], a[64:67], a[104:107], v[92:95]
v_mfma_f32_16x16x32_bf16 v[96:99], a[64:67], a[108:111], v[96:99]
v_fma_f32 v187, v187, v254, v253
v_mfma_f32_16x16x32_bf16 v[100:103], a[68:71], a[104:107], v[100:103]
v_fma_f32 v188, v188, v254, v253
v_mfma_f32_16x16x32_bf16 v[104:107], a[68:71], a[108:111], v[104:107]
s_waitcnt lgkmcnt(0)
v_mfma_f32_16x16x32_bf16 v[36:39], a[0:3], a[112:115], v[36:39]
ds_read_b128 a[36:39], v191 offset:9216
s_add_u32 m0, s63, 106496
v_fma_f32 v189, v189, v254, v253
v_mfma_f32_16x16x32_bf16 v[40:43], a[0:3], a[116:119], v[40:43]
ds_read_b128 a[40:43], v191 offset:10240
s_add_u32 s61, s61, 36864
v_mul_f32 v186, v186, v152
v_mfma_f32_16x16x32_bf16 v[44:47], a[4:7], a[112:115], v[44:47]
ds_read_b128 a[44:47], v191 offset:11264
v_mul_f32 v187, v187, v153
v_mfma_f32_16x16x32_bf16 v[48:51], a[4:7], a[116:119], v[48:51]
ds_read_b128 a[48:51], v191 offset:12288
v_mfma_f32_16x16x32_bf16 v[52:55], a[8:11], a[112:115], v[52:55]
ds_read_b128 a[52:55], v191 offset:13312
buffer_load_dwordx4 v1, s[8:11], s61 offen offset:0 sc1 lds
s_add_u32 m0, s62, 110592
v_mfma_f32_16x16x32_bf16 v[56:59], a[8:11], a[116:119], v[56:59]
ds_read_b128 a[56:59], v191 offset:14336
s_add_u32 s60, s60, 20480
v_mul_f32 v188, v188, v154
v_mfma_f32_16x16x32_bf16 v[60:63], a[12:15], a[112:115], v[60:63]
ds_read_b128 a[60:63], v191 offset:15360
v_mul_f32 v189, v189, v155
v_mfma_f32_16x16x32_bf16 v[64:67], a[12:15], a[116:119], v[64:67]
ds_read_b128 a[64:67], v191 offset:16384
v_mfma_f32_16x16x32_bf16 v[68:71], a[16:19], a[112:115], v[68:71]
ds_read_b128 a[68:71], v191 offset:17408
v_mfma_f32_16x16x32_bf16 v[72:75], a[16:19], a[116:119], v[72:75]
v_exp_f32 v186, v186
v_mfma_f32_16x16x32_bf16 v[76:79], a[20:23], a[112:115], v[76:79]
buffer_load_dwordx4 v1, s[8:11], s60 offen offset:0 sc1 lds
v_mfma_f32_16x16x32_bf16 v[80:83], a[20:23], a[116:119], v[80:83]
v_exp_f32 v187, v187
v_mfma_f32_16x16x32_bf16 v[84:87], a[24:27], a[112:115], v[84:87]
buffer_load_dwordx4 v1, s[8:11], s60 offen offset:1024 sc1 lds
v_mfma_f32_16x16x32_bf16 v[88:91], a[24:27], a[116:119], v[88:91]
v_exp_f32 v188, v188
v_mfma_f32_16x16x32_bf16 v[92:95], a[28:31], a[112:115], v[92:95]
buffer_load_dwordx4 v1, s[8:11], s60 offen offset:2048 sc1 lds
v_mfma_f32_16x16x32_bf16 v[96:99], a[28:31], a[116:119], v[96:99]
v_mfma_f32_16x16x32_bf16 v[100:103], a[32:35], a[112:115], v[100:103]
v_exp_f32 v189, v189
v_mfma_f32_16x16x32_bf16 v[104:107], a[32:35], a[116:119], v[104:107]
s_waitcnt vmcnt(16)
s_waitcnt lgkmcnt(0)
s_barrier
v_mfma_f32_16x16x32_bf16 v[36:39], a[36:39], a[120:123], v[36:39]
ds_read_b128 a[0:3], v191 offset:18432
buffer_load_dwordx4 v1, s[8:11], s60 offen offset:3072 sc1 lds
s_add_u32 m0, s62, 126976
v_mfma_f32_16x16x32_bf16 v[40:43], a[36:39], a[124:127], v[40:43]
ds_read_b128 a[4:7], v191 offset:19456
s_add_u32 s60, s60, 16384
v_fma_f32 v186, v186, v255, v255
v_mfma_f32_16x16x32_bf16 v[44:47], a[40:43], a[120:123], v[44:47]
ds_read_b128 a[8:11], v191 offset:20480
v_fma_f32 v187, v187, v255, v255
v_mfma_f32_16x16x32_bf16 v[48:51], a[40:43], a[124:127], v[48:51]
ds_read_b128 a[12:15], v191 offset:21504
v_fma_f32 v188, v188, v255, v255
v_mfma_f32_16x16x32_bf16 v[52:55], a[44:47], a[120:123], v[52:55]
ds_read_b128 a[16:19], v191 offset:22528
v_mfma_f32_16x16x32_bf16 v[56:59], a[44:47], a[124:127], v[56:59]
ds_read_b128 a[20:23], v191 offset:23552
v_fma_f32 v189, v189, v255, v255
v_mfma_f32_16x16x32_bf16 v[60:63], a[48:51], a[120:123], v[60:63]
ds_read_b128 a[24:27], v191 offset:24576
v_mfma_f32_16x16x32_bf16 v[64:67], a[48:51], a[124:127], v[64:67]
ds_read_b128 a[28:31], v191 offset:25600
v_mfma_f32_16x16x32_bf16 v[68:71], a[52:55], a[120:123], v[68:71]
ds_read_b128 a[32:35], v191 offset:26624
buffer_load_dwordx4 v1, s[8:11], s60 offen offset:0 sc1 lds
v_mfma_f32_16x16x32_bf16 v[72:75], a[52:55], a[124:127], v[72:75]
v_rcp_f32 v186, v186
v_mfma_f32_16x16x32_bf16 v[76:79], a[56:59], a[120:123], v[76:79]
v_rcp_f32 v187, v187
v_mfma_f32_16x16x32_bf16 v[80:83], a[56:59], a[124:127], v[80:83]
buffer_load_dwordx4 v1, s[8:11], s60 offen offset:1024 sc1 lds
v_mfma_f32_16x16x32_bf16 v[84:87], a[60:63], a[120:123], v[84:87]
v_rcp_f32 v188, v188
v_mfma_f32_16x16x32_bf16 v[88:91], a[60:63], a[124:127], v[88:91]
v_mfma_f32_16x16x32_bf16 v[92:95], a[64:67], a[120:123], v[92:95]
buffer_load_dwordx4 v1, s[8:11], s60 offen offset:2048 sc1 lds
v_mfma_f32_16x16x32_bf16 v[96:99], a[64:67], a[124:127], v[96:99]
v_rcp_f32 v189, v189
v_mfma_f32_16x16x32_bf16 v[100:103], a[68:71], a[120:123], v[100:103]
v_mfma_f32_16x16x32_bf16 v[104:107], a[68:71], a[124:127], v[104:107]
s_waitcnt lgkmcnt(0)
v_mfma_f32_16x16x32_bf16 v[36:39], a[0:3], a[128:131], v[36:39]
ds_read_b128 a[36:39], v191 offset:27648
buffer_load_dwordx4 v1, s[8:11], s60 offen offset:3072 sc1 lds
s_add_u32 s84, s84, 4096
v_mfma_f32_16x16x32_bf16 v[40:43], a[0:3], a[132:135], v[40:43]
ds_read_b128 a[40:43], v191 offset:28672
v_mul_f32 v152, v152, v186
v_mfma_f32_16x16x32_bf16 v[44:47], a[4:7], a[128:131], v[44:47]
ds_read_b128 a[44:47], v191 offset:29696
v_mul_f32 v153, v153, v187
v_mfma_f32_16x16x32_bf16 v[48:51], a[4:7], a[132:135], v[48:51]
ds_read_b128 a[48:51], v191 offset:30720
v_mul_f32 v154, v154, v188
v_mfma_f32_16x16x32_bf16 v[52:55], a[8:11], a[128:131], v[52:55]
ds_read_b128 a[52:55], v191 offset:31744
v_mul_f32 v155, v155, v189
v_mfma_f32_16x16x32_bf16 v[56:59], a[8:11], a[132:135], v[56:59]
ds_read_b128 a[56:59], v191 offset:32768
v_mfma_f32_16x16x32_bf16 v[60:63], a[12:15], a[128:131], v[60:63]
ds_read_b128 a[60:63], v191 offset:33792
buffer_load_dwordx4 a[208:211], v1, s[4:7], s84 offen offset:0 sc1
v_mfma_f32_16x16x32_bf16 v[64:67], a[12:15], a[132:135], v[64:67]
ds_read_b128 a[64:67], v191 offset:34816
v_mul_f32 v182, v156, v156
v_mfma_f32_16x16x32_bf16 v[68:71], a[16:19], a[128:131], v[68:71]
ds_read_b128 a[68:71], v191 offset:35840
v_mul_f32 v183, v157, v157
v_mfma_f32_16x16x32_bf16 v[72:75], a[16:19], a[132:135], v[72:75]
v_mul_f32 v184, v158, v158
v_mfma_f32_16x16x32_bf16 v[76:79], a[20:23], a[128:131], v[76:79]
buffer_load_dwordx4 a[212:215], v9, s[4:7], s84 offen offset:0 sc1
v_mul_f32 v185, v159, v159
v_mfma_f32_16x16x32_bf16 v[80:83], a[20:23], a[132:135], v[80:83]
v_mfma_f32_16x16x32_bf16 v[84:87], a[24:27], a[128:131], v[84:87]
v_fma_f32 v182, v182, v254, v253
v_mfma_f32_16x16x32_bf16 v[88:91], a[24:27], a[132:135], v[88:91]
buffer_load_dwordx4 a[216:219], v1, s[4:7], s84 offen offset:1024 sc1
v_fma_f32 v183, v183, v254, v253
v_mfma_f32_16x16x32_bf16 v[92:95], a[28:31], a[128:131], v[92:95]
v_mfma_f32_16x16x32_bf16 v[96:99], a[28:31], a[132:135], v[96:99]
v_fma_f32 v184, v184, v254, v253
v_mfma_f32_16x16x32_bf16 v[100:103], a[32:35], a[128:131], v[100:103]
v_fma_f32 v185, v185, v254, v253
v_mfma_f32_16x16x32_bf16 v[104:107], a[32:35], a[132:135], v[104:107]
s_waitcnt vmcnt(11)
s_waitcnt lgkmcnt(0)
s_barrier
v_mfma_f32_16x16x32_bf16 v[36:39], a[36:39], a[136:139], v[36:39]
ds_read_b128 a[0:3], v190 offset:0
buffer_load_dwordx4 a[220:223], v9, s[4:7], s84 offen offset:1024 sc1
s_add_u32 m0, s63, 143360
v_mfma_f32_16x16x32_bf16 v[40:43], a[36:39], a[140:143], v[40:43]
ds_read_b128 a[4:7], v190 offset:1024
s_add_u32 s61, s61, 36864
v_mul_f32 v182, v182, v156
v_mfma_f32_16x16x32_bf16 v[44:47], a[40:43], a[136:139], v[44:47]
ds_read_b128 a[8:11], v190 offset:2048
v_mul_f32 v183, v183, v157
v_mfma_f32_16x16x32_bf16 v[48:51], a[40:43], a[140:143], v[48:51]
ds_read_b128 a[12:15], v190 offset:3072
v_mul_f32 v184, v184, v158
v_mfma_f32_16x16x32_bf16 v[52:55], a[44:47], a[136:139], v[52:55]
ds_read_b128 a[16:19], v190 offset:4096
v_mul_f32 v185, v185, v159
v_mfma_f32_16x16x32_bf16 v[56:59], a[44:47], a[140:143], v[56:59]
ds_read_b128 a[20:23], v190 offset:5120
v_mfma_f32_16x16x32_bf16 v[60:63], a[48:51], a[136:139], v[60:63]
ds_read_b128 a[24:27], v190 offset:6144
buffer_load_dwordx4 v1, s[8:11], s61 offen offset:0 sc1 lds
s_add_u32 m0, s62, 147456
v_mfma_f32_16x16x32_bf16 v[64:67], a[48:51], a[140:143], v[64:67]
ds_read_b128 a[28:31], v190 offset:7168
s_add_u32 s60, s60, 20480
v_mfma_f32_16x16x32_bf16 v[68:71], a[52:55], a[136:139], v[68:71]
ds_read_b128 a[32:35], v190 offset:8192
v_mfma_f32_16x16x32_bf16 v[72:75], a[52:55], a[140:143], v[72:75]
v_exp_f32 v182, v182
v_mfma_f32_16x16x32_bf16 v[76:79], a[56:59], a[136:139], v[76:79]
v_exp_f32 v183, v183
v_mfma_f32_16x16x32_bf16 v[80:83], a[56:59], a[140:143], v[80:83]
v_exp_f32 v184, v184
v_mfma_f32_16x16x32_bf16 v[84:87], a[60:63], a[136:139], v[84:87]
buffer_load_dwordx4 v1, s[8:11], s60 offen offset:0 sc1 lds
v_mfma_f32_16x16x32_bf16 v[88:91], a[60:63], a[140:143], v[88:91]
v_mfma_f32_16x16x32_bf16 v[92:95], a[64:67], a[136:139], v[92:95]
buffer_load_dwordx4 v1, s[8:11], s60 offen offset:1024 sc1 lds
v_mfma_f32_16x16x32_bf16 v[96:99], a[64:67], a[140:143], v[96:99]
v_exp_f32 v185, v185
v_mfma_f32_16x16x32_bf16 v[100:103], a[68:71], a[136:139], v[100:103]
v_mfma_f32_16x16x32_bf16 v[104:107], a[68:71], a[140:143], v[104:107]
v_fma_f32 v182, v182, v255, v255
s_waitcnt lgkmcnt(0)
v_mfma_f32_16x16x32_bf16 v[36:39], a[0:3], a[144:147], v[36:39]
ds_read_b128 a[36:39], v190 offset:9216
buffer_load_dwordx4 v1, s[8:11], s60 offen offset:2048 sc1 lds
v_mfma_f32_16x16x32_bf16 v[40:43], a[0:3], a[148:151], v[40:43]
ds_read_b128 a[40:43], v190 offset:10240
v_fma_f32 v183, v183, v255, v255
v_mfma_f32_16x16x32_bf16 v[44:47], a[4:7], a[144:147], v[44:47]
ds_read_b128 a[44:47], v190 offset:11264
v_fma_f32 v184, v184, v255, v255
v_mfma_f32_16x16x32_bf16 v[48:51], a[4:7], a[148:151], v[48:51]
ds_read_b128 a[48:51], v190 offset:12288
v_mfma_f32_16x16x32_bf16 v[52:55], a[8:11], a[144:147], v[52:55]
ds_read_b128 a[52:55], v190 offset:13312
v_fma_f32 v185, v185, v255, v255
v_mfma_f32_16x16x32_bf16 v[56:59], a[8:11], a[148:151], v[56:59]
ds_read_b128 a[56:59], v190 offset:14336
buffer_load_dwordx4 v1, s[8:11], s60 offen offset:3072 sc1 lds
v_mfma_f32_16x16x32_bf16 v[60:63], a[12:15], a[144:147], v[60:63]
ds_read_b128 a[60:63], v190 offset:15360
v_mfma_f32_16x16x32_bf16 v[64:67], a[12:15], a[148:151], v[64:67]
ds_read_b128 a[64:67], v190 offset:16384
v_mfma_f32_16x16x32_bf16 v[68:71], a[16:19], a[144:147], v[68:71]
ds_read_b128 a[68:71], v190 offset:17408
v_mfma_f32_16x16x32_bf16 v[72:75], a[16:19], a[148:151], v[72:75]
v_rcp_f32 v182, v182
v_mfma_f32_16x16x32_bf16 v[76:79], a[20:23], a[144:147], v[76:79]
v_rcp_f32 v183, v183
v_mfma_f32_16x16x32_bf16 v[80:83], a[20:23], a[148:151], v[80:83]
buffer_load_dwordx4 a[224:227], v1, s[4:7], s84 offen offset:2048 sc1
v_mfma_f32_16x16x32_bf16 v[84:87], a[24:27], a[144:147], v[84:87]
v_rcp_f32 v184, v184
v_mfma_f32_16x16x32_bf16 v[88:91], a[24:27], a[148:151], v[88:91]
v_mfma_f32_16x16x32_bf16 v[92:95], a[28:31], a[144:147], v[92:95]
v_rcp_f32 v185, v185
v_mfma_f32_16x16x32_bf16 v[96:99], a[28:31], a[148:151], v[96:99]
v_mfma_f32_16x16x32_bf16 v[100:103], a[32:35], a[144:147], v[100:103]
v_mfma_f32_16x16x32_bf16 v[104:107], a[32:35], a[148:151], v[104:107]
s_waitcnt vmcnt(14)
s_waitcnt lgkmcnt(0)
s_barrier
v_mfma_f32_16x16x32_bf16 v[36:39], a[36:39], a[152:155], v[36:39]
ds_read_b128 a[0:3], v190 offset:18432
buffer_load_dwordx4 a[228:231], v9, s[4:7], s84 offen offset:2048 sc1
v_mfma_f32_16x16x32_bf16 v[40:43], a[36:39], a[156:159], v[40:43]
ds_read_b128 a[4:7], v190 offset:19456
v_mul_f32 v156, v156, v182
v_mfma_f32_16x16x32_bf16 v[44:47], a[40:43], a[152:155], v[44:47]
ds_read_b128 a[8:11], v190 offset:20480
buffer_load_dwordx4 a[232:235], v1, s[4:7], s84 offen offset:3072 sc1
v_mfma_f32_16x16x32_bf16 v[48:51], a[40:43], a[156:159], v[48:51]
ds_read_b128 a[12:15], v190 offset:21504
v_mul_f32 v157, v157, v183
v_mfma_f32_16x16x32_bf16 v[52:55], a[44:47], a[152:155], v[52:55]
ds_read_b128 a[16:19], v190 offset:22528
v_mul_f32 v158, v158, v184
v_mfma_f32_16x16x32_bf16 v[56:59], a[44:47], a[156:159], v[56:59]
ds_read_b128 a[20:23], v190 offset:23552
buffer_load_dwordx4 a[236:239], v9, s[4:7], s84 offen offset:3072 sc1
s_add_u32 m0, s62, 90112
v_mfma_f32_16x16x32_bf16 v[60:63], a[48:51], a[152:155], v[60:63]
ds_read_b128 a[24:27], v190 offset:24576
s_add_u32 s60, s60, 16384
v_mul_f32 v159, v159, v185
v_mfma_f32_16x16x32_bf16 v[64:67], a[48:51], a[156:159], v[64:67]
ds_read_b128 a[28:31], v190 offset:25600
v_mfma_f32_16x16x32_bf16 v[68:71], a[52:55], a[152:155], v[68:71]
ds_read_b128 a[32:35], v190 offset:26624
v_mfma_f32_16x16x32_bf16 v[72:75], a[52:55], a[156:159], v[72:75]
v_permlane16_swap_b32 v148, v152
v_mfma_f32_16x16x32_bf16 v[76:79], a[56:59], a[152:155], v[76:79]
v_permlane16_swap_b32 v149, v153
v_mfma_f32_16x16x32_bf16 v[80:83], a[56:59], a[156:159], v[80:83]
v_permlane16_swap_b32 v150, v154
v_mfma_f32_16x16x32_bf16 v[84:87], a[60:63], a[152:155], v[84:87]
v_mfma_f32_16x16x32_bf16 v[88:91], a[60:63], a[156:159], v[88:91]
v_permlane16_swap_b32 v151, v155
v_mfma_f32_16x16x32_bf16 v[92:95], a[64:67], a[152:155], v[92:95]
buffer_load_dwordx4 v1, s[8:11], s60 offen offset:0 sc1 lds
v_mfma_f32_16x16x32_bf16 v[96:99], a[64:67], a[156:159], v[96:99]
v_mfma_f32_16x16x32_bf16 v[100:103], a[68:71], a[152:155], v[100:103]
v_mul_f32 v186, v160, v160
v_mfma_f32_16x16x32_bf16 v[104:107], a[68:71], a[156:159], v[104:107]
s_waitcnt lgkmcnt(0)
v_mfma_f32_16x16x32_bf16 v[36:39], a[0:3], a[160:163], v[36:39]
ds_read_b128 a[36:39], v190 offset:27648
buffer_load_dwordx4 v1, s[8:11], s60 offen offset:1024 sc1 lds
v_mfma_f32_16x16x32_bf16 v[40:43], a[0:3], a[164:167], v[40:43]
ds_read_b128 a[40:43], v190 offset:28672
v_mul_f32 v187, v161, v161
v_mfma_f32_16x16x32_bf16 v[44:47], a[4:7], a[160:163], v[44:47]
ds_read_b128 a[44:47], v190 offset:29696
v_mul_f32 v188, v162, v162
v_mfma_f32_16x16x32_bf16 v[48:51], a[4:7], a[164:167], v[48:51]
ds_read_b128 a[48:51], v190 offset:30720
buffer_load_dwordx4 v1, s[8:11], s60 offen offset:2048 sc1 lds
v_mfma_f32_16x16x32_bf16 v[52:55], a[8:11], a[160:163], v[52:55]
ds_read_b128 a[52:55], v190 offset:31744
v_mul_f32 v189, v163, v163
v_mfma_f32_16x16x32_bf16 v[56:59], a[8:11], a[164:167], v[56:59]
ds_read_b128 a[56:59], v190 offset:32768
v_fma_f32 v186, v186, v254, v253
v_mfma_f32_16x16x32_bf16 v[60:63], a[12:15], a[160:163], v[60:63]
ds_read_b128 a[60:63], v190 offset:33792
buffer_load_dwordx4 v1, s[8:11], s60 offen offset:3072 sc1 lds
s_add_u32 s84, s84, 4096
v_mfma_f32_16x16x32_bf16 v[64:67], a[12:15], a[164:167], v[64:67]
ds_read_b128 a[64:67], v190 offset:34816
v_fma_f32 v187, v187, v254, v253
v_mfma_f32_16x16x32_bf16 v[68:71], a[16:19], a[160:163], v[68:71]
ds_read_b128 a[68:71], v190 offset:35840
v_fma_f32 v188, v188, v254, v253
v_mfma_f32_16x16x32_bf16 v[72:75], a[16:19], a[164:167], v[72:75]
v_fma_f32 v189, v189, v254, v253
v_mfma_f32_16x16x32_bf16 v[76:79], a[20:23], a[160:163], v[76:79]
v_mul_f32 v186, v186, v160
v_mfma_f32_16x16x32_bf16 v[80:83], a[20:23], a[164:167], v[80:83]
v_mul_f32 v187, v187, v161
v_mfma_f32_16x16x32_bf16 v[84:87], a[24:27], a[160:163], v[84:87]
v_mfma_f32_16x16x32_bf16 v[88:91], a[24:27], a[164:167], v[88:91]
buffer_load_dwordx4 a[240:243], v1, s[4:7], s84 offen offset:0 sc1
v_mul_f32 v188, v188, v162
v_mfma_f32_16x16x32_bf16 v[92:95], a[28:31], a[160:163], v[92:95]
v_mul_f32 v189, v189, v163
v_mfma_f32_16x16x32_bf16 v[96:99], a[28:31], a[164:167], v[96:99]
v_mfma_f32_16x16x32_bf16 v[100:103], a[32:35], a[160:163], v[100:103]
v_exp_f32 v186, v186
v_mfma_f32_16x16x32_bf16 v[104:107], a[32:35], a[164:167], v[104:107]
s_waitcnt vmcnt(13)
s_waitcnt lgkmcnt(0)
s_barrier
v_mfma_f32_16x16x32_bf16 v[36:39], a[36:39], a[168:171], v[36:39]
ds_read_b128 a[0:3], v191 offset:0
buffer_load_dwordx4 a[244:247], v9, s[4:7], s84 offen offset:0 sc1
v_mfma_f32_16x16x32_bf16 v[40:43], a[36:39], a[172:175], v[40:43]
ds_read_b128 a[4:7], v191 offset:1024
v_mfma_f32_16x16x32_bf16 v[44:47], a[40:43], a[168:171], v[44:47]
ds_read_b128 a[8:11], v191 offset:2048
buffer_load_dwordx4 a[248:251], v1, s[4:7], s84 offen offset:1024 sc1
v_mfma_f32_16x16x32_bf16 v[48:51], a[40:43], a[172:175], v[48:51]
ds_read_b128 a[12:15], v191 offset:3072
v_mfma_f32_16x16x32_bf16 v[52:55], a[44:47], a[168:171], v[52:55]
ds_read_b128 a[16:19], v191 offset:4096
v_mfma_f32_16x16x32_bf16 v[56:59], a[44:47], a[172:175], v[56:59]
ds_read_b128 a[20:23], v191 offset:5120
buffer_load_dwordx4 a[252:255], v9, s[4:7], s84 offen offset:1024 sc1
s_add_u32 m0, s63, 106496
v_mfma_f32_16x16x32_bf16 v[60:63], a[48:51], a[168:171], v[60:63]
ds_read_b128 a[24:27], v191 offset:6144
s_add_u32 s61, s61, 36864
v_mfma_f32_16x16x32_bf16 v[64:67], a[48:51], a[172:175], v[64:67]
ds_read_b128 a[28:31], v191 offset:7168
v_mfma_f32_16x16x32_bf16 v[68:71], a[52:55], a[168:171], v[68:71]
ds_read_b128 a[32:35], v191 offset:8192
v_mfma_f32_16x16x32_bf16 v[72:75], a[52:55], a[172:175], v[72:75]
v_exp_f32 v187, v187
v_mfma_f32_16x16x32_bf16 v[76:79], a[56:59], a[168:171], v[76:79]
v_exp_f32 v188, v188
v_mfma_f32_16x16x32_bf16 v[80:83], a[56:59], a[172:175], v[80:83]
v_exp_f32 v189, v189
v_mfma_f32_16x16x32_bf16 v[84:87], a[60:63], a[168:171], v[84:87]
v_fma_f32 v186, v186, v255, v255
v_fma_f32 v187, v187, v255, v255
v_mfma_f32_16x16x32_bf16 v[88:91], a[60:63], a[172:175], v[88:91]
v_fma_f32 v188, v188, v255, v255
v_mfma_f32_16x16x32_bf16 v[92:95], a[64:67], a[168:171], v[92:95]
buffer_load_dwordx4 v1, s[8:11], s61 offen offset:0 sc1 lds
v_fma_f32 v189, v189, v255, v255
v_mfma_f32_16x16x32_bf16 v[96:99], a[64:67], a[172:175], v[96:99]
v_rcp_f32 v186, v186
v_mfma_f32_16x16x32_bf16 v[100:103], a[68:71], a[168:171], v[100:103]
v_mfma_f32_16x16x32_bf16 v[104:107], a[68:71], a[172:175], v[104:107]
s_waitcnt lgkmcnt(0)
v_mfma_f32_16x16x32_bf16 v[36:39], a[0:3], a[176:179], v[36:39]
ds_read_b128 a[36:39], v191 offset:9216
s_add_u32 m0, s62, 110592
v_mfma_f32_16x16x32_bf16 v[40:43], a[0:3], a[180:183], v[40:43]
ds_read_b128 a[40:43], v191 offset:10240
s_add_u32 s60, s60, 20480
v_mfma_f32_16x16x32_bf16 v[44:47], a[4:7], a[176:179], v[44:47]
ds_read_b128 a[44:47], v191 offset:11264
v_mfma_f32_16x16x32_bf16 v[48:51], a[4:7], a[180:183], v[48:51]
ds_read_b128 a[48:51], v191 offset:12288
v_mfma_f32_16x16x32_bf16 v[52:55], a[8:11], a[176:179], v[52:55]
ds_read_b128 a[52:55], v191 offset:13312
v_mfma_f32_16x16x32_bf16 v[56:59], a[8:11], a[180:183], v[56:59]
ds_read_b128 a[56:59], v191 offset:14336
buffer_load_dwordx4 v1, s[8:11], s60 offen offset:0 sc1 lds
v_mfma_f32_16x16x32_bf16 v[60:63], a[12:15], a[176:179], v[60:63]
ds_read_b128 a[60:63], v191 offset:15360
v_mfma_f32_16x16x32_bf16 v[64:67], a[12:15], a[180:183], v[64:67]
ds_read_b128 a[64:67], v191 offset:16384
v_mfma_f32_16x16x32_bf16 v[68:71], a[16:19], a[176:179], v[68:71]
ds_read_b128 a[68:71], v191 offset:17408
buffer_load_dwordx4 v1, s[8:11], s60 offen offset:1024 sc1 lds
v_mfma_f32_16x16x32_bf16 v[72:75], a[16:19], a[180:183], v[72:75]
v_rcp_f32 v187, v187
v_mfma_f32_16x16x32_bf16 v[76:79], a[20:23], a[176:179], v[76:79]
v_rcp_f32 v188, v188
v_mfma_f32_16x16x32_bf16 v[80:83], a[20:23], a[180:183], v[80:83]
buffer_load_dwordx4 v1, s[8:11], s60 offen offset:2048 sc1 lds
v_mfma_f32_16x16x32_bf16 v[84:87], a[24:27], a[176:179], v[84:87]
v_rcp_f32 v189, v189
v_mfma_f32_16x16x32_bf16 v[88:91], a[24:27], a[180:183], v[88:91]
v_mul_f32 v160, v160, v186
v_mul_f32 v161, v161, v187
v_mfma_f32_16x16x32_bf16 v[92:95], a[28:31], a[176:179], v[92:95]
buffer_load_dwordx4 v1, s[8:11], s60 offen offset:3072 sc1 lds
v_mul_f32 v162, v162, v188
v_mfma_f32_16x16x32_bf16 v[96:99], a[28:31], a[180:183], v[96:99]
v_mul_f32 v163, v163, v189
v_mul_f32 v182, v164, v164
v_mfma_f32_16x16x32_bf16 v[100:103], a[32:35], a[176:179], v[100:103]
v_mul_f32 v183, v165, v165
v_mfma_f32_16x16x32_bf16 v[104:107], a[32:35], a[180:183], v[104:107]
s_waitcnt vmcnt(17)
s_waitcnt lgkmcnt(0)
s_barrier
v_mfma_f32_16x16x32_bf16 v[36:39], a[36:39], a[184:187], v[36:39]
ds_read_b128 a[0:3], v191 offset:18432
s_add_u32 m0, s62, 126976
v_mul_f32 v184, v166, v166
v_mfma_f32_16x16x32_bf16 v[40:43], a[36:39], a[188:191], v[40:43]
ds_read_b128 a[4:7], v191 offset:19456
s_add_u32 s60, s60, 16384
v_mul_f32 v185, v167, v167
v_mfma_f32_16x16x32_bf16 v[44:47], a[40:43], a[184:187], v[44:47]
ds_read_b128 a[8:11], v191 offset:20480
v_mfma_f32_16x16x32_bf16 v[48:51], a[40:43], a[188:191], v[48:51]
ds_read_b128 a[12:15], v191 offset:21504
v_fma_f32 v182, v182, v254, v253
v_mfma_f32_16x16x32_bf16 v[52:55], a[44:47], a[184:187], v[52:55]
ds_read_b128 a[16:19], v191 offset:22528
v_fma_f32 v183, v183, v254, v253
v_mfma_f32_16x16x32_bf16 v[56:59], a[44:47], a[188:191], v[56:59]
ds_read_b128 a[20:23], v191 offset:23552
v_mfma_f32_16x16x32_bf16 v[60:63], a[48:51], a[184:187], v[60:63]
ds_read_b128 a[24:27], v191 offset:24576
buffer_load_dwordx4 v1, s[8:11], s60 offen offset:0 sc1 lds
v_mfma_f32_16x16x32_bf16 v[64:67], a[48:51], a[188:191], v[64:67]
ds_read_b128 a[28:31], v191 offset:25600
v_fma_f32 v184, v184, v254, v253
v_mfma_f32_16x16x32_bf16 v[68:71], a[52:55], a[184:187], v[68:71]
ds_read_b128 a[32:35], v191 offset:26624
v_fma_f32 v185, v185, v254, v253
v_mfma_f32_16x16x32_bf16 v[72:75], a[52:55], a[188:191], v[72:75]
v_mul_f32 v182, v182, v164
v_mfma_f32_16x16x32_bf16 v[76:79], a[56:59], a[184:187], v[76:79]
buffer_load_dwordx4 v1, s[8:11], s60 offen offset:1024 sc1 lds
v_mul_f32 v183, v183, v165
v_mfma_f32_16x16x32_bf16 v[80:83], a[56:59], a[188:191], v[80:83]
v_mfma_f32_16x16x32_bf16 v[84:87], a[60:63], a[184:187], v[84:87]
v_mul_f32 v184, v184, v166
v_mfma_f32_16x16x32_bf16 v[88:91], a[60:63], a[188:191], v[88:91]
buffer_load_dwordx4 v1, s[8:11], s60 offen offset:2048 sc1 lds
v_mul_f32 v185, v185, v167
v_mfma_f32_16x16x32_bf16 v[92:95], a[64:67], a[184:187], v[92:95]
v_mfma_f32_16x16x32_bf16 v[96:99], a[64:67], a[188:191], v[96:99]
v_exp_f32 v182, v182
v_mfma_f32_16x16x32_bf16 v[100:103], a[68:71], a[184:187], v[100:103]
v_mfma_f32_16x16x32_bf16 v[104:107], a[68:71], a[188:191], v[104:107]
s_waitcnt lgkmcnt(0)
v_mfma_f32_16x16x32_bf16 v[36:39], a[0:3], a[192:195], v[36:39]
ds_read_b128 a[36:39], v191 offset:27648
buffer_load_dwordx4 v1, s[8:11], s60 offen offset:3072 sc1 lds
v_mfma_f32_16x16x32_bf16 v[40:43], a[0:3], a[196:199], v[40:43]
ds_read_b128 a[40:43], v191 offset:28672
v_mfma_f32_16x16x32_bf16 v[44:47], a[4:7], a[192:195], v[44:47]
ds_read_b128 a[44:47], v191 offset:29696
v_mfma_f32_16x16x32_bf16 v[48:51], a[4:7], a[196:199], v[48:51]
ds_read_b128 a[48:51], v191 offset:30720
v_mfma_f32_16x16x32_bf16 v[52:55], a[8:11], a[192:195], v[52:55]
ds_read_b128 a[52:55], v191 offset:31744
buffer_load_dwordx4 a[80:83], v1, s[4:7], s84 offen offset:2048 sc1
v_mfma_f32_16x16x32_bf16 v[56:59], a[8:11], a[196:199], v[56:59]
ds_read_b128 a[56:59], v191 offset:32768
v_mfma_f32_16x16x32_bf16 v[60:63], a[12:15], a[192:195], v[60:63]
ds_read_b128 a[60:63], v191 offset:33792
v_mfma_f32_16x16x32_bf16 v[64:67], a[12:15], a[196:199], v[64:67]
ds_read_b128 a[64:67], v191 offset:34816
v_mfma_f32_16x16x32_bf16 v[68:71], a[16:19], a[192:195], v[68:71]
ds_read_b128 a[68:71], v191 offset:35840
buffer_load_dwordx4 a[84:87], v9, s[4:7], s84 offen offset:2048 sc1
v_mfma_f32_16x16x32_bf16 v[72:75], a[16:19], a[196:199], v[72:75]
v_exp_f32 v183, v183
v_mfma_f32_16x16x32_bf16 v[76:79], a[20:23], a[192:195], v[76:79]
v_exp_f32 v184, v184
v_mfma_f32_16x16x32_bf16 v[80:83], a[20:23], a[196:199], v[80:83]
v_exp_f32 v185, v185
v_mfma_f32_16x16x32_bf16 v[84:87], a[24:27], a[192:195], v[84:87]
buffer_load_dwordx4 a[88:91], v1, s[4:7], s84 offen offset:3072 sc1
v_fma_f32 v182, v182, v255, v255
v_mfma_f32_16x16x32_bf16 v[88:91], a[24:27], a[196:199], v[88:91]
v_fma_f32 v183, v183, v255, v255
v_fma_f32 v184, v184, v255, v255
v_mfma_f32_16x16x32_bf16 v[92:95], a[28:31], a[192:195], v[92:95]
v_fma_f32 v185, v185, v255, v255
v_mfma_f32_16x16x32_bf16 v[96:99], a[28:31], a[196:199], v[96:99]
v_rcp_f32 v182, v182
v_mfma_f32_16x16x32_bf16 v[100:103], a[32:35], a[192:195], v[100:103]
v_mfma_f32_16x16x32_bf16 v[104:107], a[32:35], a[196:199], v[104:107]
s_waitcnt vmcnt(11)
s_waitcnt lgkmcnt(0)
s_barrier
v_mfma_f32_16x16x32_bf16 v[36:39], a[36:39], a[200:203], v[36:39]
ds_read_b128 a[0:3], v190 offset:0
buffer_load_dwordx4 a[92:95], v9, s[4:7], s84 offen offset:3072 sc1
s_add_u32 m0, s63, 143360
v_mfma_f32_16x16x32_bf16 v[40:43], a[36:39], a[204:207], v[40:43]
ds_read_b128 a[4:7], v190 offset:1024
s_add_u32 s61, s61, 36864
v_mfma_f32_16x16x32_bf16 v[44:47], a[40:43], a[200:203], v[44:47]
ds_read_b128 a[8:11], v190 offset:2048
v_mfma_f32_16x16x32_bf16 v[48:51], a[40:43], a[204:207], v[48:51]
ds_read_b128 a[12:15], v190 offset:3072
v_mfma_f32_16x16x32_bf16 v[52:55], a[44:47], a[200:203], v[52:55]
ds_read_b128 a[16:19], v190 offset:4096
v_mfma_f32_16x16x32_bf16 v[56:59], a[44:47], a[204:207], v[56:59]
ds_read_b128 a[20:23], v190 offset:5120
v_mfma_f32_16x16x32_bf16 v[60:63], a[48:51], a[200:203], v[60:63]
ds_read_b128 a[24:27], v190 offset:6144
buffer_load_dwordx4 v1, s[8:11], s61 offen offset:0 sc1 lds
s_add_u32 m0, s62, 147456
v_mfma_f32_16x16x32_bf16 v[64:67], a[48:51], a[204:207], v[64:67]
ds_read_b128 a[28:31], v190 offset:7168
s_add_u32 s60, s60, 20480
v_mfma_f32_16x16x32_bf16 v[68:71], a[52:55], a[200:203], v[68:71]
ds_read_b128 a[32:35], v190 offset:8192
v_mfma_f32_16x16x32_bf16 v[72:75], a[52:55], a[204:207], v[72:75]
v_rcp_f32 v183, v183
v_mfma_f32_16x16x32_bf16 v[76:79], a[56:59], a[200:203], v[76:79]
v_rcp_f32 v184, v184
v_mfma_f32_16x16x32_bf16 v[80:83], a[56:59], a[204:207], v[80:83]
v_rcp_f32 v185, v185
v_mfma_f32_16x16x32_bf16 v[84:87], a[60:63], a[200:203], v[84:87]
buffer_load_dwordx4 v1, s[8:11], s60 offen offset:0 sc1 lds
v_mul_f32 v164, v164, v182
v_mfma_f32_16x16x32_bf16 v[88:91], a[60:63], a[204:207], v[88:91]
v_mul_f32 v165, v165, v183
v_mul_f32 v166, v166, v184
v_mfma_f32_16x16x32_bf16 v[92:95], a[64:67], a[200:203], v[92:95]
buffer_load_dwordx4 v1, s[8:11], s60 offen offset:1024 sc1 lds
v_mul_f32 v167, v167, v185
v_mfma_f32_16x16x32_bf16 v[96:99], a[64:67], a[204:207], v[96:99]
v_permlane16_swap_b32 v156, v160
v_mfma_f32_16x16x32_bf16 v[100:103], a[68:71], a[200:203], v[100:103]
v_mfma_f32_16x16x32_bf16 v[104:107], a[68:71], a[204:207], v[104:107]
s_waitcnt lgkmcnt(0)
v_mfma_f32_16x16x32_bf16 v[36:39], a[0:3], a[208:211], v[36:39]
ds_read_b128 a[36:39], v190 offset:9216
buffer_load_dwordx4 v1, s[8:11], s60 offen offset:2048 sc1 lds
v_mfma_f32_16x16x32_bf16 v[40:43], a[0:3], a[212:215], v[40:43]
ds_read_b128 a[40:43], v190 offset:10240
v_mfma_f32_16x16x32_bf16 v[44:47], a[4:7], a[208:211], v[44:47]
ds_read_b128 a[44:47], v190 offset:11264
v_mfma_f32_16x16x32_bf16 v[48:51], a[4:7], a[212:215], v[48:51]
ds_read_b128 a[48:51], v190 offset:12288
buffer_load_dwordx4 v1, s[8:11], s60 offen offset:3072 sc1 lds
s_add_u32 s84, s84, 4096
v_mfma_f32_16x16x32_bf16 v[52:55], a[8:11], a[208:211], v[52:55]
ds_read_b128 a[52:55], v190 offset:13312
v_mfma_f32_16x16x32_bf16 v[56:59], a[8:11], a[212:215], v[56:59]
ds_read_b128 a[56:59], v190 offset:14336
v_mfma_f32_16x16x32_bf16 v[60:63], a[12:15], a[208:211], v[60:63]
ds_read_b128 a[60:63], v190 offset:15360
v_mfma_f32_16x16x32_bf16 v[64:67], a[12:15], a[212:215], v[64:67]
ds_read_b128 a[64:67], v190 offset:16384
v_mfma_f32_16x16x32_bf16 v[68:71], a[16:19], a[208:211], v[68:71]
ds_read_b128 a[68:71], v190 offset:17408
v_mfma_f32_16x16x32_bf16 v[72:75], a[16:19], a[212:215], v[72:75]
v_permlane16_swap_b32 v157, v161
v_mfma_f32_16x16x32_bf16 v[76:79], a[20:23], a[208:211], v[76:79]
buffer_load_dwordx4 a[96:99], v1, s[4:7], s84 offen offset:0 sc1
v_mfma_f32_16x16x32_bf16 v[80:83], a[20:23], a[212:215], v[80:83]
v_permlane16_swap_b32 v158, v162
v_mfma_f32_16x16x32_bf16 v[84:87], a[24:27], a[208:211], v[84:87]
v_permlane16_swap_b32 v159, v163
v_mfma_f32_16x16x32_bf16 v[88:91], a[24:27], a[212:215], v[88:91]
buffer_load_dwordx4 a[100:103], v9, s[4:7], s84 offen offset:0 sc1
v_mul_f32 v186, v168, v168
v_mfma_f32_16x16x32_bf16 v[92:95], a[28:31], a[208:211], v[92:95]
v_mul_f32 v187, v169, v169
v_mul_f32 v188, v170, v170
v_mfma_f32_16x16x32_bf16 v[96:99], a[28:31], a[212:215], v[96:99]
v_mul_f32 v189, v171, v171
v_fma_f32 v186, v186, v254, v253
v_mfma_f32_16x16x32_bf16 v[100:103], a[32:35], a[208:211], v[100:103]
v_fma_f32 v187, v187, v254, v253
v_fma_f32 v188, v188, v254, v253
v_mfma_f32_16x16x32_bf16 v[104:107], a[32:35], a[212:215], v[104:107]
s_waitcnt vmcnt(15)
s_waitcnt lgkmcnt(0)
s_barrier
v_mfma_f32_16x16x32_bf16 v[36:39], a[36:39], a[216:219], v[36:39]
ds_read_b128 a[0:3], v190 offset:18432
buffer_load_dwordx4 a[104:107], v1, s[4:7], s84 offen offset:1024 sc1
v_mfma_f32_16x16x32_bf16 v[40:43], a[36:39], a[220:223], v[40:43]
ds_read_b128 a[4:7], v190 offset:19456
v_fma_f32 v189, v189, v254, v253
v_mfma_f32_16x16x32_bf16 v[44:47], a[40:43], a[216:219], v[44:47]
ds_read_b128 a[8:11], v190 offset:20480
buffer_load_dwordx4 a[108:111], v9, s[4:7], s84 offen offset:1024 sc1
s_add_u32 m0, s62, 90112
v_mfma_f32_16x16x32_bf16 v[48:51], a[40:43], a[220:223], v[48:51]
ds_read_b128 a[12:15], v190 offset:21504
s_add_u32 s60, s60, 16384
v_mul_f32 v186, v186, v168
v_mfma_f32_16x16x32_bf16 v[52:55], a[44:47], a[216:219], v[52:55]
ds_read_b128 a[16:19], v190 offset:22528
v_mul_f32 v187, v187, v169
v_mfma_f32_16x16x32_bf16 v[56:59], a[44:47], a[220:223], v[56:59]
ds_read_b128 a[20:23], v190 offset:23552
v_mul_f32 v188, v188, v170
v_mfma_f32_16x16x32_bf16 v[60:63], a[48:51], a[216:219], v[60:63]
ds_read_b128 a[24:27], v190 offset:24576
v_mul_f32 v189, v189, v171
v_mfma_f32_16x16x32_bf16 v[64:67], a[48:51], a[220:223], v[64:67]
ds_read_b128 a[28:31], v190 offset:25600
v_mfma_f32_16x16x32_bf16 v[68:71], a[52:55], a[216:219], v[68:71]
ds_read_b128 a[32:35], v190 offset:26624
v_mfma_f32_16x16x32_bf16 v[72:75], a[52:55], a[220:223], v[72:75]
v_exp_f32 v186, v186
v_mfma_f32_16x16x32_bf16 v[76:79], a[56:59], a[216:219], v[76:79]
v_exp_f32 v187, v187
v_mfma_f32_16x16x32_bf16 v[80:83], a[56:59], a[220:223], v[80:83]
buffer_load_dwordx4 v1, s[8:11], s60 offen offset:0 sc1 lds
v_mfma_f32_16x16x32_bf16 v[84:87], a[60:63], a[216:219], v[84:87]
v_mfma_f32_16x16x32_bf16 v[88:91], a[60:63], a[220:223], v[88:91]
v_exp_f32 v188, v188
v_mfma_f32_16x16x32_bf16 v[92:95], a[64:67], a[216:219], v[92:95]
buffer_load_dwordx4 v1, s[8:11], s60 offen offset:1024 sc1 lds
v_mfma_f32_16x16x32_bf16 v[96:99], a[64:67], a[220:223], v[96:99]
v_mfma_f32_16x16x32_bf16 v[100:103], a[68:71], a[216:219], v[100:103]
v_exp_f32 v189, v189
v_mfma_f32_16x16x32_bf16 v[104:107], a[68:71], a[220:223], v[104:107]
s_waitcnt lgkmcnt(0)
v_mfma_f32_16x16x32_bf16 v[36:39], a[0:3], a[224:227], v[36:39]
ds_read_b128 a[36:39], v190 offset:27648
buffer_load_dwordx4 v1, s[8:11], s60 offen offset:2048 sc1 lds
s_mov_b32 s37, L_c5-L_pc
v_mfma_f32_16x16x32_bf16 v[40:43], a[0:3], a[228:231], v[40:43]
ds_read_b128 a[40:43], v190 offset:28672
v_fma_f32 v186, v186, v255, v255
v_mfma_f32_16x16x32_bf16 v[44:47], a[4:7], a[224:227], v[44:47]
ds_read_b128 a[44:47], v190 offset:29696
v_fma_f32 v187, v187, v255, v255
v_mfma_f32_16x16x32_bf16 v[48:51], a[4:7], a[228:231], v[48:51]
ds_read_b128 a[48:51], v190 offset:30720
v_mfma_f32_16x16x32_bf16 v[52:55], a[8:11], a[224:227], v[52:55]
ds_read_b128 a[52:55], v190 offset:31744
buffer_load_dword v15, v14, s[88:91], s37 offen
v_mfma_f32_16x16x32_bf16 v[56:59], a[8:11], a[228:231], v[56:59]
ds_read_b128 a[56:59], v190 offset:32768
buffer_load_dwordx4 v1, s[8:11], s60 offen offset:3072 sc1 lds
v_mfma_f32_16x16x32_bf16 v[60:63], a[12:15], a[224:227], v[60:63]
ds_read_b128 a[60:63], v190 offset:33792
v_fma_f32 v188, v188, v255, v255
v_mfma_f32_16x16x32_bf16 v[64:67], a[12:15], a[228:231], v[64:67]
ds_read_b128 a[64:67], v190 offset:34816
v_fma_f32 v189, v189, v255, v255
v_mfma_f32_16x16x32_bf16 v[68:71], a[16:19], a[224:227], v[68:71]
ds_read_b128 a[68:71], v190 offset:35840
v_mfma_f32_16x16x32_bf16 v[72:75], a[16:19], a[228:231], v[72:75]
v_rcp_f32 v186, v186
v_mfma_f32_16x16x32_bf16 v[76:79], a[20:23], a[224:227], v[76:79]
v_rcp_f32 v187, v187
v_mfma_f32_16x16x32_bf16 v[80:83], a[20:23], a[228:231], v[80:83]
buffer_load_dwordx4 a[112:115], v1, s[4:7], s84 offen offset:2048 sc1
v_mfma_f32_16x16x32_bf16 v[84:87], a[24:27], a[224:227], v[84:87]
v_rcp_f32 v188, v188
v_mfma_f32_16x16x32_bf16 v[88:91], a[24:27], a[228:231], v[88:91]
v_mfma_f32_16x16x32_bf16 v[92:95], a[28:31], a[224:227], v[92:95]
v_mfma_f32_16x16x32_bf16 v[96:99], a[28:31], a[228:231], v[96:99]
v_rcp_f32 v189, v189
v_mfma_f32_16x16x32_bf16 v[100:103], a[32:35], a[224:227], v[100:103]
v_mfma_f32_16x16x32_bf16 v[104:107], a[32:35], a[228:231], v[104:107]
s_waitcnt vmcnt(14)
s_waitcnt lgkmcnt(0)
s_barrier
v_mfma_f32_16x16x32_bf16 v[36:39], a[36:39], a[232:235], v[36:39]
ds_read_b128 a[0:3], v191 offset:0
buffer_load_dwordx4 a[116:119], v9, s[4:7], s84 offen offset:2048 sc1
v_mfma_f32_16x16x32_bf16 v[40:43], a[36:39], a[236:239], v[40:43]
ds_read_b128 a[4:7], v191 offset:1024
v_mul_f32 v168, v168, v186
v_mfma_f32_16x16x32_bf16 v[44:47], a[40:43], a[232:235], v[44:47]
ds_read_b128 a[8:11], v191 offset:2048
buffer_load_dwordx4 a[120:123], v1, s[4:7], s84 offen offset:3072 sc1
v_mfma_f32_16x16x32_bf16 v[48:51], a[40:43], a[236:239], v[48:51]
ds_read_b128 a[12:15], v191 offset:3072
v_mul_f32 v169, v169, v187
v_mfma_f32_16x16x32_bf16 v[52:55], a[44:47], a[232:235], v[52:55]
ds_read_b128 a[16:19], v191 offset:4096
v_mul_f32 v170, v170, v188
v_mfma_f32_16x16x32_bf16 v[56:59], a[44:47], a[236:239], v[56:59]
ds_read_b128 a[20:23], v191 offset:5120
buffer_load_dwordx4 a[124:127], v9, s[4:7], s84 offen offset:3072 sc1
s_add_u32 m0, s63, 106496
v_mfma_f32_16x16x32_bf16 v[60:63], a[48:51], a[232:235], v[60:63]
ds_read_b128 a[24:27], v191 offset:6144
s_add_u32 s61, s61, 36864
v_mul_f32 v171, v171, v189
v_mfma_f32_16x16x32_bf16 v[64:67], a[48:51], a[236:239], v[64:67]
ds_read_b128 a[28:31], v191 offset:7168
v_mul_f32 v182, v172, v172
v_mfma_f32_16x16x32_bf16 v[68:71], a[52:55], a[232:235], v[68:71]
ds_read_b128 a[32:35], v191 offset:8192
v_mul_f32 v183, v173, v173
v_mfma_f32_16x16x32_bf16 v[72:75], a[52:55], a[236:239], v[72:75]
v_mul_f32 v184, v174, v174
v_mfma_f32_16x16x32_bf16 v[76:79], a[56:59], a[232:235], v[76:79]
v_mul_f32 v185, v175, v175
v_mfma_f32_16x16x32_bf16 v[80:83], a[56:59], a[236:239], v[80:83]
v_mfma_f32_16x16x32_bf16 v[84:87], a[60:63], a[232:235], v[84:87]
v_fma_f32 v182, v182, v254, v253
v_mfma_f32_16x16x32_bf16 v[88:91], a[60:63], a[236:239], v[88:91]
v_fma_f32 v183, v183, v254, v253
v_mfma_f32_16x16x32_bf16 v[92:95], a[64:67], a[232:235], v[92:95]
buffer_load_dwordx4 v1, s[8:11], s61 offen offset:0 sc1 lds
v_mfma_f32_16x16x32_bf16 v[96:99], a[64:67], a[236:239], v[96:99]
v_fma_f32 v184, v184, v254, v253
v_mfma_f32_16x16x32_bf16 v[100:103], a[68:71], a[232:235], v[100:103]
v_fma_f32 v185, v185, v254, v253
v_mfma_f32_16x16x32_bf16 v[104:107], a[68:71], a[236:239], v[104:107]
s_waitcnt lgkmcnt(0)
v_mfma_f32_16x16x32_bf16 v[36:39], a[0:3], a[240:243], v[36:39]
ds_read_b128 a[36:39], v191 offset:9216
s_add_u32 m0, s62, 110592
v_mul_f32 v182, v182, v172
v_mfma_f32_16x16x32_bf16 v[40:43], a[0:3], a[244:247], v[40:43]
ds_read_b128 a[40:43], v191 offset:10240
s_add_u32 s60, s60, 20480
v_mul_f32 v183, v183, v173
v_mfma_f32_16x16x32_bf16 v[44:47], a[4:7], a[240:243], v[44:47]
ds_read_b128 a[44:47], v191 offset:11264
v_mfma_f32_16x16x32_bf16 v[48:51], a[4:7], a[244:247], v[48:51]
ds_read_b128 a[48:51], v191 offset:12288
v_mul_f32 v184, v184, v174
v_mfma_f32_16x16x32_bf16 v[52:55], a[8:11], a[240:243], v[52:55]
ds_read_b128 a[52:55], v191 offset:13312
v_mul_f32 v185, v185, v175
v_mfma_f32_16x16x32_bf16 v[56:59], a[8:11], a[244:247], v[56:59]
ds_read_b128 a[56:59], v191 offset:14336
buffer_load_dwordx4 v1, s[8:11], s60 offen offset:0 sc1 lds
v_mfma_f32_16x16x32_bf16 v[60:63], a[12:15], a[240:243], v[60:63]
ds_read_b128 a[60:63], v191 offset:15360
v_mfma_f32_16x16x32_bf16 v[64:67], a[12:15], a[244:247], v[64:67]
ds_read_b128 a[64:67], v191 offset:16384
v_mfma_f32_16x16x32_bf16 v[68:71], a[16:19], a[240:243], v[68:71]
ds_read_b128 a[68:71], v191 offset:17408
buffer_load_dwordx4 v1, s[8:11], s60 offen offset:1024 sc1 lds
v_mfma_f32_16x16x32_bf16 v[72:75], a[16:19], a[244:247], v[72:75]
v_exp_f32 v182, v182
v_mfma_f32_16x16x32_bf16 v[76:79], a[20:23], a[240:243], v[76:79]
v_exp_f32 v183, v183
v_mfma_f32_16x16x32_bf16 v[80:83], a[20:23], a[244:247], v[80:83]
buffer_load_dwordx4 v1, s[8:11], s60 offen offset:2048 sc1 lds
v_mfma_f32_16x16x32_bf16 v[84:87], a[24:27], a[240:243], v[84:87]
v_exp_f32 v184, v184
v_mfma_f32_16x16x32_bf16 v[88:91], a[24:27], a[244:247], v[88:91]
v_mfma_f32_16x16x32_bf16 v[92:95], a[28:31], a[240:243], v[92:95]
buffer_load_dwordx4 v1, s[8:11], s60 offen offset:3072 sc1 lds
v_mfma_f32_16x16x32_bf16 v[96:99], a[28:31], a[244:247], v[96:99]
v_exp_f32 v185, v185
v_mfma_f32_16x16x32_bf16 v[100:103], a[32:35], a[240:243], v[100:103]
v_mfma_f32_16x16x32_bf16 v[104:107], a[32:35], a[244:247], v[104:107]
s_waitcnt vmcnt(18)
s_waitcnt lgkmcnt(0)
s_barrier
v_mfma_f32_16x16x32_bf16 v[36:39], a[36:39], a[248:251], v[36:39]
ds_read_b128 a[0:3], v191 offset:18432
s_add_u32 m0, s62, 126976
v_fma_f32 v182, v182, v255, v255
v_mfma_f32_16x16x32_bf16 v[40:43], a[36:39], a[252:255], v[40:43]
ds_read_b128 a[4:7], v191 offset:19456
s_add_u32 s60, s60, 16384
v_fma_f32 v183, v183, v255, v255
v_mfma_f32_16x16x32_bf16 v[44:47], a[40:43], a[248:251], v[44:47]
ds_read_b128 a[8:11], v191 offset:20480
v_fma_f32 v184, v184, v255, v255
v_mfma_f32_16x16x32_bf16 v[48:51], a[40:43], a[252:255], v[48:51]
ds_read_b128 a[12:15], v191 offset:21504
v_mfma_f32_16x16x32_bf16 v[52:55], a[44:47], a[248:251], v[52:55]
ds_read_b128 a[16:19], v191 offset:22528
v_fma_f32 v185, v185, v255, v255
v_mfma_f32_16x16x32_bf16 v[56:59], a[44:47], a[252:255], v[56:59]
ds_read_b128 a[20:23], v191 offset:23552
buffer_load_dwordx4 v1, s[8:11], s60 offen offset:0 sc1 lds
v_mfma_f32_16x16x32_bf16 v[60:63], a[48:51], a[248:251], v[60:63]
ds_read_b128 a[24:27], v191 offset:24576
v_mfma_f32_16x16x32_bf16 v[64:67], a[48:51], a[252:255], v[64:67]
ds_read_b128 a[28:31], v191 offset:25600
v_mfma_f32_16x16x32_bf16 v[68:71], a[52:55], a[248:251], v[68:71]
ds_read_b128 a[32:35], v191 offset:26624
buffer_load_dwordx4 v1, s[8:11], s60 offen offset:1024 sc1 lds
v_mfma_f32_16x16x32_bf16 v[72:75], a[52:55], a[252:255], v[72:75]
v_rcp_f32 v182, v182
v_mfma_f32_16x16x32_bf16 v[76:79], a[56:59], a[248:251], v[76:79]
v_rcp_f32 v183, v183
v_mfma_f32_16x16x32_bf16 v[80:83], a[56:59], a[252:255], v[80:83]
buffer_load_dwordx4 v1, s[8:11], s60 offen offset:2048 sc1 lds
v_mfma_f32_16x16x32_bf16 v[84:87], a[60:63], a[248:251], v[84:87]
v_rcp_f32 v184, v184
v_mfma_f32_16x16x32_bf16 v[88:91], a[60:63], a[252:255], v[88:91]
v_mfma_f32_16x16x32_bf16 v[92:95], a[64:67], a[248:251], v[92:95]
buffer_load_dwordx4 v1, s[8:11], s60 offen offset:3072 sc1 lds
v_mfma_f32_16x16x32_bf16 v[96:99], a[64:67], a[252:255], v[96:99]
v_rcp_f32 v185, v185
v_mfma_f32_16x16x32_bf16 v[100:103], a[68:71], a[248:251], v[100:103]
v_mfma_f32_16x16x32_bf16 v[104:107], a[68:71], a[252:255], v[104:107]
v_mul_f32 v172, v172, v182
s_waitcnt lgkmcnt(0)
v_mfma_f32_16x16x32_bf16 v[36:39], a[0:3], a[80:83], v[36:39]
ds_read_b128 a[36:39], v191 offset:27648
s_add_u32 s84, s84, 4096
v_mul_f32 v173, v173, v183
v_mfma_f32_16x16x32_bf16 v[40:43], a[0:3], a[84:87], v[40:43]
ds_read_b128 a[40:43], v191 offset:28672
v_mfma_f32_16x16x32_bf16 v[44:47], a[4:7], a[80:83], v[44:47]
ds_read_b128 a[44:47], v191 offset:29696
v_mul_f32 v174, v174, v184
v_mfma_f32_16x16x32_bf16 v[48:51], a[4:7], a[84:87], v[48:51]
ds_read_b128 a[48:51], v191 offset:30720
buffer_load_dwordx4 a[128:131], v1, s[4:7], s84 offen offset:0 sc1
v_mfma_f32_16x16x32_bf16 v[52:55], a[8:11], a[80:83], v[52:55]
ds_read_b128 a[52:55], v191 offset:31744
v_mul_f32 v175, v175, v185
v_mfma_f32_16x16x32_bf16 v[56:59], a[8:11], a[84:87], v[56:59]
ds_read_b128 a[56:59], v191 offset:32768
v_mfma_f32_16x16x32_bf16 v[60:63], a[12:15], a[80:83], v[60:63]
ds_read_b128 a[60:63], v191 offset:33792
buffer_load_dwordx4 a[132:135], v9, s[4:7], s84 offen offset:0 sc1
v_mfma_f32_16x16x32_bf16 v[64:67], a[12:15], a[84:87], v[64:67]
ds_read_b128 a[64:67], v191 offset:34816
v_mfma_f32_16x16x32_bf16 v[68:71], a[16:19], a[80:83], v[68:71]
ds_read_b128 a[68:71], v191 offset:35840
v_mfma_f32_16x16x32_bf16 v[72:75], a[16:19], a[84:87], v[72:75]
v_permlane16_swap_b32 v164, v168
v_mfma_f32_16x16x32_bf16 v[76:79], a[20:23], a[80:83], v[76:79]
buffer_load_dwordx4 a[136:139], v1, s[4:7], s84 offen offset:1024 sc1
v_mfma_f32_16x16x32_bf16 v[80:83], a[20:23], a[84:87], v[80:83]
v_permlane16_swap_b32 v165, v169
v_mfma_f32_16x16x32_bf16 v[84:87], a[24:27], a[80:83], v[84:87]
v_permlane16_swap_b32 v166, v170
v_mfma_f32_16x16x32_bf16 v[88:91], a[24:27], a[84:87], v[88:91]
buffer_load_dwordx4 a[140:143], v9, s[4:7], s84 offen offset:1024 sc1
v_mfma_f32_16x16x32_bf16 v[92:95], a[28:31], a[80:83], v[92:95]
v_permlane16_swap_b32 v167, v171
v_mfma_f32_16x16x32_bf16 v[96:99], a[28:31], a[84:87], v[96:99]
v_mfma_f32_16x16x32_bf16 v[100:103], a[32:35], a[80:83], v[100:103]
v_mul_f32 v186, v176, v176
v_mfma_f32_16x16x32_bf16 v[104:107], a[32:35], a[84:87], v[104:107]
s_waitcnt vmcnt(12)
s_waitcnt lgkmcnt(0)
s_barrier
v_mfma_f32_16x16x32_bf16 v[36:39], a[36:39], a[88:91], v[36:39]
ds_read_b128 a[0:3], v190 offset:0
s_add_u32 m0, s63, 143360
v_mul_f32 v187, v177, v177
v_mfma_f32_16x16x32_bf16 v[40:43], a[36:39], a[92:95], v[40:43]
ds_read_b128 a[4:7], v190 offset:1024
s_add_u32 s61, s61, 36864
v_mul_f32 v188, v178, v178
v_mfma_f32_16x16x32_bf16 v[44:47], a[40:43], a[88:91], v[44:47]
ds_read_b128 a[8:11], v190 offset:2048
v_mfma_f32_16x16x32_bf16 v[48:51], a[40:43], a[92:95], v[48:51]
ds_read_b128 a[12:15], v190 offset:3072
v_mul_f32 v189, v179, v179
v_mfma_f32_16x16x32_bf16 v[52:55], a[44:47], a[88:91], v[52:55]
ds_read_b128 a[16:19], v190 offset:4096
buffer_load_dwordx4 v1, s[8:11], s61 offen offset:0 sc1 lds
s_add_u32 m0, s62, 147456
v_mfma_f32_16x16x32_bf16 v[56:59], a[44:47], a[92:95], v[56:59]
ds_read_b128 a[20:23], v190 offset:5120
s_add_u32 s60, s60, 20480
v_fma_f32 v186, v186, v254, v253
v_mfma_f32_16x16x32_bf16 v[60:63], a[48:51], a[88:91], v[60:63]
ds_read_b128 a[24:27], v190 offset:6144
v_fma_f32 v187, v187, v254, v253
v_mfma_f32_16x16x32_bf16 v[64:67], a[48:51], a[92:95], v[64:67]
ds_read_b128 a[28:31], v190 offset:7168
v_fma_f32 v188, v188, v254, v253
v_mfma_f32_16x16x32_bf16 v[68:71], a[52:55], a[88:91], v[68:71]
ds_read_b128 a[32:35], v190 offset:8192
v_mfma_f32_16x16x32_bf16 v[72:75], a[52:55], a[92:95], v[72:75]
v_fma_f32 v189, v189, v254, v253
v_mfma_f32_16x16x32_bf16 v[76:79], a[56:59], a[88:91], v[76:79]
v_mul_f32 v186, v186, v176
v_mfma_f32_16x16x32_bf16 v[80:83], a[56:59], a[92:95], v[80:83]
v_mfma_f32_16x16x32_bf16 v[84:87], a[60:63], a[88:91], v[84:87]
buffer_load_dwordx4 v1, s[8:11], s60 offen offset:0 sc1 lds
v_mul_f32 v187, v187, v177
v_mfma_f32_16x16x32_bf16 v[88:91], a[60:63], a[92:95], v[88:91]
v_mul_f32 v188, v188, v178
v_mfma_f32_16x16x32_bf16 v[92:95], a[64:67], a[88:91], v[92:95]
buffer_load_dwordx4 v1, s[8:11], s60 offen offset:1024 sc1 lds
v_mul_f32 v189, v189, v179
v_mfma_f32_16x16x32_bf16 v[96:99], a[64:67], a[92:95], v[96:99]
v_mfma_f32_16x16x32_bf16 v[100:103], a[68:71], a[88:91], v[100:103]
v_exp_f32 v186, v186
v_mfma_f32_16x16x32_bf16 v[104:107], a[68:71], a[92:95], v[104:107]
s_waitcnt lgkmcnt(0)
v_mfma_f32_16x16x32_bf16 v[36:39], a[0:3], a[96:99], v[36:39]
ds_read_b128 a[36:39], v190 offset:9216
buffer_load_dwordx4 v1, s[8:11], s60 offen offset:2048 sc1 lds
v_mfma_f32_16x16x32_bf16 v[40:43], a[0:3], a[100:103], v[40:43]
ds_read_b128 a[40:43], v190 offset:10240
v_mfma_f32_16x16x32_bf16 v[44:47], a[4:7], a[96:99], v[44:47]
ds_read_b128 a[44:47], v190 offset:11264
v_mfma_f32_16x16x32_bf16 v[48:51], a[4:7], a[100:103], v[48:51]
ds_read_b128 a[48:51], v190 offset:12288
v_mfma_f32_16x16x32_bf16 v[52:55], a[8:11], a[96:99], v[52:55]
ds_read_b128 a[52:55], v190 offset:13312
buffer_load_dwordx4 v1, s[8:11], s60 offen offset:3072 sc1 lds
v_mfma_f32_16x16x32_bf16 v[56:59], a[8:11], a[100:103], v[56:59]
ds_read_b128 a[56:59], v190 offset:14336
v_mfma_f32_16x16x32_bf16 v[60:63], a[12:15], a[96:99], v[60:63]
ds_read_b128 a[60:63], v190 offset:15360
v_mfma_f32_16x16x32_bf16 v[64:67], a[12:15], a[100:103], v[64:67]
ds_read_b128 a[64:67], v190 offset:16384
v_mfma_f32_16x16x32_bf16 v[68:71], a[16:19], a[96:99], v[68:71]
ds_read_b128 a[68:71], v190 offset:17408
buffer_load_dwordx4 a[144:147], v1, s[4:7], s84 offen offset:2048 sc1
v_mfma_f32_16x16x32_bf16 v[72:75], a[16:19], a[100:103], v[72:75]
v_exp_f32 v187, v187
v_mfma_f32_16x16x32_bf16 v[76:79], a[20:23], a[96:99], v[76:79]
v_exp_f32 v188, v188
v_mfma_f32_16x16x32_bf16 v[80:83], a[20:23], a[100:103], v[80:83]
v_exp_f32 v189, v189
v_mfma_f32_16x16x32_bf16 v[84:87], a[24:27], a[96:99], v[84:87]
buffer_load_dwordx4 a[148:151], v9, s[4:7], s84 offen offset:2048 sc1
v_fma_f32 v186, v186, v255, v255
v_mfma_f32_16x16x32_bf16 v[88:91], a[24:27], a[100:103], v[88:91]
v_fma_f32 v187, v187, v255, v255
v_fma_f32 v188, v188, v255, v255
v_mfma_f32_16x16x32_bf16 v[92:95], a[28:31], a[96:99], v[92:95]
v_fma_f32 v189, v189, v255, v255
v_mfma_f32_16x16x32_bf16 v[96:99], a[28:31], a[100:103], v[96:99]
v_rcp_f32 v186, v186
v_mfma_f32_16x16x32_bf16 v[100:103], a[32:35], a[96:99], v[100:103]
v_mfma_f32_16x16x32_bf16 v[104:107], a[32:35], a[100:103], v[104:107]
s_waitcnt vmcnt(15)
s_waitcnt lgkmcnt(0)
s_barrier
v_mfma_f32_16x16x32_bf16 v[36:39], a[36:39], a[104:107], v[36:39]
ds_read_b128 a[0:3], v190 offset:18432
buffer_load_dwordx4 a[152:155], v1, s[4:7], s84 offen offset:3072 sc1
v_mfma_f32_16x16x32_bf16 v[40:43], a[36:39], a[108:111], v[40:43]
ds_read_b128 a[4:7], v190 offset:19456
v_mfma_f32_16x16x32_bf16 v[44:47], a[40:43], a[104:107], v[44:47]
ds_read_b128 a[8:11], v190 offset:20480
buffer_load_dwordx4 a[156:159], v9, s[4:7], s84 offen offset:3072 sc1
s_mul_i32 s38, s24, 9216
v_mfma_f32_16x16x32_bf16 v[48:51], a[40:43], a[108:111], v[48:51]
ds_read_b128 a[12:15], v190 offset:21504
s_add_u32 m0, s38, 0
v_mfma_f32_16x16x32_bf16 v[52:55], a[44:47], a[104:107], v[52:55]
ds_read_b128 a[16:19], v190 offset:22528
s_add_u32 s39, s38, s83
v_mfma_f32_16x16x32_bf16 v[56:59], a[44:47], a[108:111], v[56:59]
ds_read_b128 a[20:23], v190 offset:23552
v_mfma_f32_16x16x32_bf16 v[60:63], a[48:51], a[104:107], v[60:63]
ds_read_b128 a[24:27], v190 offset:24576
v_mfma_f32_16x16x32_bf16 v[64:67], a[48:51], a[108:111], v[64:67]
ds_read_b128 a[28:31], v190 offset:25600
v_mfma_f32_16x16x32_bf16 v[68:71], a[52:55], a[104:107], v[68:71]
ds_read_b128 a[32:35], v190 offset:26624
v_mfma_f32_16x16x32_bf16 v[72:75], a[52:55], a[108:111], v[72:75]
v_rcp_f32 v187, v187
v_mfma_f32_16x16x32_bf16 v[76:79], a[56:59], a[104:107], v[76:79]
v_rcp_f32 v188, v188
v_mfma_f32_16x16x32_bf16 v[80:83], a[56:59], a[108:111], v[80:83]
v_rcp_f32 v189, v189
v_mfma_f32_16x16x32_bf16 v[84:87], a[60:63], a[104:107], v[84:87]
buffer_load_dwordx4 v1, s[4:7], s39 offen offset:0  lds
v_mul_f32 v176, v176, v186
v_mfma_f32_16x16x32_bf16 v[88:91], a[60:63], a[108:111], v[88:91]
v_mul_f32 v177, v177, v187
v_mul_f32 v178, v178, v188
v_mfma_f32_16x16x32_bf16 v[92:95], a[64:67], a[104:107], v[92:95]
buffer_load_dwordx4 v1, s[4:7], s39 offen offset:1024  lds
v_mul_f32 v179, v179, v189
v_mfma_f32_16x16x32_bf16 v[96:99], a[64:67], a[108:111], v[96:99]
s_lshl_b32 s30, s25, 3
v_mfma_f32_16x16x32_bf16 v[100:103], a[68:71], a[104:107], v[100:103]
s_lshl_b32 s31, s24, 1
v_mfma_f32_16x16x32_bf16 v[104:107], a[68:71], a[108:111], v[104:107]
s_add_u32 s30, s30, s31
s_waitcnt lgkmcnt(0)
v_mfma_f32_16x16x32_bf16 v[36:39], a[0:3], a[112:115], v[36:39]
ds_read_b128 a[36:39], v190 offset:27648
buffer_load_dwordx4 v1, s[4:7], s39 offen offset:2048  lds
s_mul_i32 s30, s30, 73728
v_mfma_f32_16x16x32_bf16 v[40:43], a[0:3], a[116:119], v[40:43]
ds_read_b128 a[40:43], v190 offset:28672
s_add_u32 s30, s30, 16777216
v_mfma_f32_16x16x32_bf16 v[44:47], a[4:7], a[112:115], v[44:47]
ds_read_b128 a[44:47], v190 offset:29696
buffer_load_dwordx4 v1, s[4:7], s39 offen offset:3072  lds
s_add_u32 m0, m0, 4096
v_mfma_f32_16x16x32_bf16 v[48:51], a[4:7], a[116:119], v[48:51]
ds_read_b128 a[48:51], v190 offset:30720
s_add_u32 s39, s39, 4096
v_mfma_f32_16x16x32_bf16 v[52:55], a[8:11], a[112:115], v[52:55]
ds_read_b128 a[52:55], v190 offset:31744
s_mul_i32 s31, s26, 4608
v_mfma_f32_16x16x32_bf16 v[56:59], a[8:11], a[116:119], v[56:59]
ds_read_b128 a[56:59], v190 offset:32768
s_add_u32 s30, s30, s31
v_mfma_f32_16x16x32_bf16 v[60:63], a[12:15], a[112:115], v[60:63]
ds_read_b128 a[60:63], v190 offset:33792
s_and_b32 s65, s26, 1
v_mfma_f32_16x16x32_bf16 v[64:67], a[12:15], a[116:119], v[64:67]
ds_read_b128 a[64:67], v190 offset:34816
s_lshl_b32 s64, s65, 9
v_mfma_f32_16x16x32_bf16 v[68:71], a[16:19], a[112:115], v[68:71]
ds_read_b128 a[68:71], v190 offset:35840
s_add_u32 s64, s64, s30
v_mfma_f32_16x16x32_bf16 v[72:75], a[16:19], a[116:119], v[72:75]
s_xor_b32 s65, s65, 1
v_mfma_f32_16x16x32_bf16 v[76:79], a[20:23], a[112:115], v[76:79]
s_lshl_b32 s65, s65, 12
v_mfma_f32_16x16x32_bf16 v[80:83], a[20:23], a[116:119], v[80:83]
buffer_load_dwordx4 v1, s[4:7], s39 offen offset:0  lds
s_add_u32 s65, s65, s30
v_mfma_f32_16x16x32_bf16 v[84:87], a[24:27], a[112:115], v[84:87]
v_mfma_f32_16x16x32_bf16 v[88:91], a[24:27], a[116:119], v[88:91]
v_mfma_f32_16x16x32_bf16 v[92:95], a[28:31], a[112:115], v[92:95]
buffer_load_dwordx4 v1, s[4:7], s39 offen offset:1024  lds
v_mfma_f32_16x16x32_bf16 v[96:99], a[28:31], a[116:119], v[96:99]
v_mfma_f32_16x16x32_bf16 v[100:103], a[32:35], a[112:115], v[100:103]
v_permlane16_swap_b32 v172, v176
v_mfma_f32_16x16x32_bf16 v[104:107], a[32:35], a[116:119], v[104:107]
s_waitcnt vmcnt(14)
s_waitcnt lgkmcnt(0)
s_barrier
v_mfma_f32_16x16x32_bf16 v[36:39], a[36:39], a[120:123], v[36:39]
ds_read_b128 a[0:3], v191 offset:0
buffer_load_dwordx4 v1, s[4:7], s39 offen offset:2048  lds
v_mfma_f32_16x16x32_bf16 v[40:43], a[36:39], a[124:127], v[40:43]
ds_read_b128 a[4:7], v191 offset:1024
buffer_load_dwordx4 v1, s[4:7], s39 offen offset:3072  lds
s_add_u32 m0, m0, 4096
v_mfma_f32_16x16x32_bf16 v[44:47], a[40:43], a[120:123], v[44:47]
ds_read_b128 a[8:11], v191 offset:2048
s_add_u32 s39, s39, 4096
v_mfma_f32_16x16x32_bf16 v[48:51], a[40:43], a[124:127], v[48:51]
ds_read_b128 a[12:15], v191 offset:3072
v_mfma_f32_16x16x32_bf16 v[52:55], a[44:47], a[120:123], v[52:55]
ds_read_b128 a[16:19], v191 offset:4096
v_mfma_f32_16x16x32_bf16 v[56:59], a[44:47], a[124:127], v[56:59]
ds_read_b128 a[20:23], v191 offset:5120
v_mfma_f32_16x16x32_bf16 v[60:63], a[48:51], a[120:123], v[60:63]
ds_read_b128 a[24:27], v191 offset:6144
buffer_load_dwordx4 v1, s[4:7], s39 offen offset:0  lds
s_mul_i32 s38, s24, 9216
v_mfma_f32_16x16x32_bf16 v[64:67], a[48:51], a[124:127], v[64:67]
ds_read_b128 a[28:31], v191 offset:7168
s_add_u32 m0, s38, 36864
v_mfma_f32_16x16x32_bf16 v[68:71], a[52:55], a[120:123], v[68:71]
ds_read_b128 a[32:35], v191 offset:8192
s_add_u32 s39, s38, s83
v_mfma_f32_16x16x32_bf16 v[72:75], a[52:55], a[124:127], v[72:75]
s_add_u32 s39, s39, 36864
v_permlane16_swap_b32 v173, v177
v_mfma_f32_16x16x32_bf16 v[76:79], a[56:59], a[120:123], v[76:79]
v_permlane16_swap_b32 v174, v178
v_mfma_f32_16x16x32_bf16 v[80:83], a[56:59], a[124:127], v[80:83]
v_permlane16_swap_b32 v175, v179
v_mfma_f32_16x16x32_bf16 v[84:87], a[60:63], a[120:123], v[84:87]
v_add_u32 v233, 73728, v1
v_and_b32 v232, 1, v3
v_mfma_f32_16x16x32_bf16 v[88:91], a[60:63], a[124:127], v[88:91]
v_mul_u32_u24 v232, 73728, v232
v_mfma_f32_16x16x32_bf16 v[92:95], a[64:67], a[120:123], v[92:95]
v_lshrrev_b32 v8, 1, v3
v_mfma_f32_16x16x32_bf16 v[96:99], a[64:67], a[124:127], v[96:99]
buffer_load_dwordx4 v1, s[4:7], s39 offen offset:0  lds
v_mfma_f32_16x16x32_bf16 v[100:103], a[68:71], a[120:123], v[100:103]
v_lshl_add_u32 v232, v8, 8, v232
v_mfma_f32_16x16x32_bf16 v[104:107], a[68:71], a[124:127], v[104:107]
v_lshl_add_u32 v232, v2, 4, v232
s_waitcnt lgkmcnt(0)
v_mfma_f32_16x16x32_bf16 v[36:39], a[0:3], a[128:131], v[36:39]
ds_read_b128 a[36:39], v191 offset:9216
buffer_load_dwordx4 v1, s[4:7], s39 offen offset:1024  lds
v_mfma_f32_16x16x32_bf16 v[40:43], a[0:3], a[132:135], v[40:43]
ds_read_b128 a[40:43], v191 offset:10240
v_mfma_f32_16x16x32_bf16 v[44:47], a[4:7], a[128:131], v[44:47]
ds_read_b128 a[44:47], v191 offset:11264
v_mfma_f32_16x16x32_bf16 v[48:51], a[4:7], a[132:135], v[48:51]
ds_read_b128 a[48:51], v191 offset:12288
v_mfma_f32_16x16x32_bf16 v[52:55], a[8:11], a[128:131], v[52:55]
ds_read_b128 a[52:55], v191 offset:13312
v_mfma_f32_16x16x32_bf16 v[56:59], a[8:11], a[132:135], v[56:59]
ds_read_b128 a[56:59], v191 offset:14336
buffer_load_dwordx4 v1, s[4:7], s39 offen offset:2048  lds
v_mfma_f32_16x16x32_bf16 v[60:63], a[12:15], a[128:131], v[60:63]
ds_read_b128 a[60:63], v191 offset:15360
v_mfma_f32_16x16x32_bf16 v[64:67], a[12:15], a[132:135], v[64:67]
ds_read_b128 a[64:67], v191 offset:16384
v_mfma_f32_16x16x32_bf16 v[68:71], a[16:19], a[128:131], v[68:71]
ds_read_b128 a[68:71], v191 offset:17408
v_mfma_f32_16x16x32_bf16 v[72:75], a[16:19], a[132:135], v[72:75]
v_mfma_f32_16x16x32_bf16 v[76:79], a[20:23], a[128:131], v[76:79]
v_mfma_f32_16x16x32_bf16 v[80:83], a[20:23], a[132:135], v[80:83]
buffer_load_dwordx4 v1, s[4:7], s39 offen offset:3072  lds
v_mfma_f32_16x16x32_bf16 v[84:87], a[24:27], a[128:131], v[84:87]
v_mfma_f32_16x16x32_bf16 v[88:91], a[24:27], a[132:135], v[88:91]
v_mfma_f32_16x16x32_bf16 v[92:95], a[28:31], a[128:131], v[92:95]
v_mfma_f32_16x16x32_bf16 v[96:99], a[28:31], a[132:135], v[96:99]
v_mfma_f32_16x16x32_bf16 v[100:103], a[32:35], a[128:131], v[100:103]
v_mfma_f32_16x16x32_bf16 v[104:107], a[32:35], a[132:135], v[104:107]
s_waitcnt vmcnt(13)
s_waitcnt lgkmcnt(0)
s_barrier
v_mfma_f32_16x16x32_bf16 v[36:39], a[36:39], a[136:139], v[36:39]
ds_read_b128 a[0:3], v191 offset:18432
s_add_u32 m0, m0, 4096
v_mfma_f32_16x16x32_bf16 v[40:43], a[36:39], a[140:143], v[40:43]
ds_read_b128 a[4:7], v191 offset:19456
s_add_u32 s39, s39, 4096
v_mfma_f32_16x16x32_bf16 v[44:47], a[40:43], a[136:139], v[44:47]
ds_read_b128 a[8:11], v191 offset:20480
v_mfma_f32_16x16x32_bf16 v[48:51], a[40:43], a[140:143], v[48:51]
ds_read_b128 a[12:15], v191 offset:21504
v_mfma_f32_16x16x32_bf16 v[52:55], a[44:47], a[136:139], v[52:55]
ds_read_b128 a[16:19], v191 offset:22528
v_mfma_f32_16x16x32_bf16 v[56:59], a[44:47], a[140:143], v[56:59]
ds_read_b128 a[20:23], v191 offset:23552
buffer_load_dwordx4 v1, s[4:7], s39 offen offset:0  lds
v_mfma_f32_16x16x32_bf16 v[60:63], a[48:51], a[136:139], v[60:63]
ds_read_b128 a[24:27], v191 offset:24576
v_mfma_f32_16x16x32_bf16 v[64:67], a[48:51], a[140:143], v[64:67]
ds_read_b128 a[28:31], v191 offset:25600
v_mfma_f32_16x16x32_bf16 v[68:71], a[52:55], a[136:139], v[68:71]
ds_read_b128 a[32:35], v191 offset:26624
buffer_load_dwordx4 v1, s[4:7], s39 offen offset:1024  lds
v_mfma_f32_16x16x32_bf16 v[72:75], a[52:55], a[140:143], v[72:75]
v_mfma_f32_16x16x32_bf16 v[76:79], a[56:59], a[136:139], v[76:79]
v_mfma_f32_16x16x32_bf16 v[80:83], a[56:59], a[140:143], v[80:83]
buffer_load_dwordx4 v1, s[4:7], s39 offen offset:2048  lds
v_mfma_f32_16x16x32_bf16 v[84:87], a[60:63], a[136:139], v[84:87]
v_mfma_f32_16x16x32_bf16 v[88:91], a[60:63], a[140:143], v[88:91]
v_mfma_f32_16x16x32_bf16 v[92:95], a[64:67], a[136:139], v[92:95]
buffer_load_dwordx4 v1, s[4:7], s39 offen offset:3072  lds
v_mfma_f32_16x16x32_bf16 v[96:99], a[64:67], a[140:143], v[96:99]
v_mfma_f32_16x16x32_bf16 v[100:103], a[68:71], a[136:139], v[100:103]
v_mfma_f32_16x16x32_bf16 v[104:107], a[68:71], a[140:143], v[104:107]
s_waitcnt lgkmcnt(0)
v_mfma_f32_16x16x32_bf16 v[36:39], a[0:3], a[144:147], v[36:39]
ds_read_b128 a[36:39], v191 offset:27648
s_add_u32 m0, m0, 4096
v_mfma_f32_16x16x32_bf16 v[40:43], a[0:3], a[148:151], v[40:43]
ds_read_b128 a[40:43], v191 offset:28672
s_add_u32 s39, s39, 4096
v_mfma_f32_16x16x32_bf16 v[44:47], a[4:7], a[144:147], v[44:47]
ds_read_b128 a[44:47], v191 offset:29696
v_mfma_f32_16x16x32_bf16 v[48:51], a[4:7], a[148:151], v[48:51]
ds_read_b128 a[48:51], v191 offset:30720
buffer_load_dwordx4 v1, s[4:7], s39 offen offset:0  lds
s_mul_i32 s38, s24, 9216
v_mfma_f32_16x16x32_bf16 v[52:55], a[8:11], a[144:147], v[52:55]
ds_read_b128 a[52:55], v191 offset:31744
s_add_u32 m0, s38, 73728
v_mfma_f32_16x16x32_bf16 v[56:59], a[8:11], a[148:151], v[56:59]
ds_read_b128 a[56:59], v191 offset:32768
s_add_u32 s39, s38, s83
v_mfma_f32_16x16x32_bf16 v[60:63], a[12:15], a[144:147], v[60:63]
ds_read_b128 a[60:63], v191 offset:33792
s_add_u32 s39, s39, 73728
v_mfma_f32_16x16x32_bf16 v[64:67], a[12:15], a[148:151], v[64:67]
ds_read_b128 a[64:67], v191 offset:34816
v_mfma_f32_16x16x32_bf16 v[68:71], a[16:19], a[144:147], v[68:71]
ds_read_b128 a[68:71], v191 offset:35840
v_mfma_f32_16x16x32_bf16 v[72:75], a[16:19], a[148:151], v[72:75]
v_mfma_f32_16x16x32_bf16 v[76:79], a[20:23], a[144:147], v[76:79]
v_mfma_f32_16x16x32_bf16 v[80:83], a[20:23], a[148:151], v[80:83]
buffer_load_dwordx4 v1, s[4:7], s39 offen offset:0  lds
v_mfma_f32_16x16x32_bf16 v[84:87], a[24:27], a[144:147], v[84:87]
v_mfma_f32_16x16x32_bf16 v[88:91], a[24:27], a[148:151], v[88:91]
buffer_load_dwordx4 v1, s[4:7], s39 offen offset:1024  lds
v_mfma_f32_16x16x32_bf16 v[92:95], a[28:31], a[144:147], v[92:95]
v_mfma_f32_16x16x32_bf16 v[96:99], a[28:31], a[148:151], v[96:99]
buffer_load_dwordx4 v1, s[4:7], s39 offen offset:2048  lds
v_mfma_f32_16x16x32_bf16 v[100:103], a[32:35], a[144:147], v[100:103]
v_mfma_f32_16x16x32_bf16 v[104:107], a[32:35], a[148:151], v[104:107]
s_waitcnt lgkmcnt(0)
s_barrier
v_mfma_f32_16x16x32_bf16 v[36:39], a[36:39], a[152:155], v[36:39]
buffer_load_dwordx4 v1, s[4:7], s39 offen offset:3072  lds
s_add_u32 m0, m0, 4096
v_mfma_f32_16x16x32_bf16 v[40:43], a[36:39], a[156:159], v[40:43]
s_add_u32 s39, s39, 4096
v_mfma_f32_16x16x32_bf16 v[44:47], a[40:43], a[152:155], v[44:47]
v_mfma_f32_16x16x32_bf16 v[48:51], a[40:43], a[156:159], v[48:51]
v_mfma_f32_16x16x32_bf16 v[52:55], a[44:47], a[152:155], v[52:55]
v_mfma_f32_16x16x32_bf16 v[56:59], a[44:47], a[156:159], v[56:59]
v_mfma_f32_16x16x32_bf16 v[60:63], a[48:51], a[152:155], v[60:63]
v_mfma_f32_16x16x32_bf16 v[64:67], a[48:51], a[156:159], v[64:67]
v_mfma_f32_16x16x32_bf16 v[68:71], a[52:55], a[152:155], v[68:71]
buffer_load_dwordx4 v1, s[4:7], s39 offen offset:0  lds
v_mfma_f32_16x16x32_bf16 v[72:75], a[52:55], a[156:159], v[72:75]
v_mfma_f32_16x16x32_bf16 v[76:79], a[56:59], a[152:155], v[76:79]
v_mfma_f32_16x16x32_bf16 v[80:83], a[56:59], a[156:159], v[80:83]
buffer_load_dwordx4 v1, s[4:7], s39 offen offset:1024  lds
v_mfma_f32_16x16x32_bf16 v[84:87], a[60:63], a[152:155], v[84:87]
v_mfma_f32_16x16x32_bf16 v[88:91], a[60:63], a[156:159], v[88:91]
v_mfma_f32_16x16x32_bf16 v[92:95], a[64:67], a[152:155], v[92:95]
buffer_load_dwordx4 v1, s[4:7], s39 offen offset:2048  lds
v_mfma_f32_16x16x32_bf16 v[96:99], a[64:67], a[156:159], v[96:99]
v_mfma_f32_16x16x32_bf16 v[100:103], a[68:71], a[152:155], v[100:103]
v_mfma_f32_16x16x32_bf16 v[104:107], a[68:71], a[156:159], v[104:107]
v_pk_mul_f32 v[36:37], v[36:37], v[116:117]
v_pk_mul_f32 v[38:39], v[38:39], v[118:119]
v_cvt_pk_bf16_f32 v192, v36, v37
v_cvt_pk_bf16_f32 v193, v38, v39
v_pk_mul_f32 v[44:45], v[44:45], v[124:125]
v_pk_mul_f32 v[46:47], v[46:47], v[126:127]
v_cvt_pk_bf16_f32 v194, v44, v45
v_cvt_pk_bf16_f32 v195, v46, v47
buffer_store_dwordx4 v[192:195], v1, s[8:11], s64 offen offset:0 sc1
v_pk_mul_f32 v[40:41], v[40:41], v[120:121]
v_pk_mul_f32 v[42:43], v[42:43], v[122:123]
v_cvt_pk_bf16_f32 v196, v40, v41
v_cvt_pk_bf16_f32 v197, v42, v43
v_pk_mul_f32 v[48:49], v[48:49], v[128:129]
v_pk_mul_f32 v[50:51], v[50:51], v[130:131]
v_cvt_pk_bf16_f32 v198, v48, v49
v_cvt_pk_bf16_f32 v199, v50, v51
buffer_store_dwordx4 v[196:199], v233, s[8:11], s64 offen offset:0 sc1
v_pk_mul_f32 v[52:53], v[52:53], v[132:133]
v_pk_mul_f32 v[54:55], v[54:55], v[134:135]
v_cvt_pk_bf16_f32 v200, v52, v53
v_cvt_pk_bf16_f32 v201, v54, v55
v_pk_mul_f32 v[60:61], v[60:61], v[140:141]
v_pk_mul_f32 v[62:63], v[62:63], v[142:143]
v_cvt_pk_bf16_f32 v202, v60, v61
v_cvt_pk_bf16_f32 v203, v62, v63
buffer_store_dwordx4 v[200:203], v1, s[8:11], s64 offen offset:1024 sc1
v_pk_mul_f32 v[56:57], v[56:57], v[136:137]
v_pk_mul_f32 v[58:59], v[58:59], v[138:139]
v_cvt_pk_bf16_f32 v204, v56, v57
v_cvt_pk_bf16_f32 v205, v58, v59
v_pk_mul_f32 v[64:65], v[64:65], v[144:145]
v_pk_mul_f32 v[66:67], v[66:67], v[146:147]
v_cvt_pk_bf16_f32 v206, v64, v65
v_cvt_pk_bf16_f32 v207, v66, v67
buffer_store_dwordx4 v[204:207], v233, s[8:11], s64 offen offset:1024 sc1
v_pk_mul_f32 v[68:69], v[68:69], v[148:149]
v_pk_mul_f32 v[70:71], v[70:71], v[150:151]
v_cvt_pk_bf16_f32 v208, v68, v69
v_cvt_pk_bf16_f32 v209, v70, v71
v_pk_mul_f32 v[76:77], v[76:77], v[156:157]
v_pk_mul_f32 v[78:79], v[78:79], v[158:159]
v_cvt_pk_bf16_f32 v210, v76, v77
v_cvt_pk_bf16_f32 v211, v78, v79
buffer_store_dwordx4 v[208:211], v1, s[8:11], s64 offen offset:2048 sc1
v_pk_mul_f32 v[72:73], v[72:73], v[152:153]
v_pk_mul_f32 v[74:75], v[74:75], v[154:155]
v_cvt_pk_bf16_f32 v212, v72, v73
v_cvt_pk_bf16_f32 v213, v74, v75
v_pk_mul_f32 v[80:81], v[80:81], v[160:161]
v_pk_mul_f32 v[82:83], v[82:83], v[162:163]
v_cvt_pk_bf16_f32 v214, v80, v81
v_cvt_pk_bf16_f32 v215, v82, v83
buffer_store_dwordx4 v[212:215], v233, s[8:11], s64 offen offset:2048 sc1
v_pk_mul_f32 v[84:85], v[84:85], v[164:165]
v_pk_mul_f32 v[86:87], v[86:87], v[166:167]
v_cvt_pk_bf16_f32 v216, v84, v85
v_cvt_pk_bf16_f32 v217, v86, v87
v_pk_mul_f32 v[92:93], v[92:93], v[172:173]
v_pk_mul_f32 v[94:95], v[94:95], v[174:175]
v_cvt_pk_bf16_f32 v218, v92, v93
v_cvt_pk_bf16_f32 v219, v94, v95
buffer_store_dwordx4 v[216:219], v1, s[8:11], s64 offen offset:3072 sc1
v_pk_mul_f32 v[88:89], v[88:89], v[168:169]
v_pk_mul_f32 v[90:91], v[90:91], v[170:171]
v_cvt_pk_bf16_f32 v220, v88, v89
v_cvt_pk_bf16_f32 v221, v90, v91
v_pk_mul_f32 v[96:97], v[96:97], v[176:177]
v_pk_mul_f32 v[98:99], v[98:99], v[178:179]
v_cvt_pk_bf16_f32 v222, v96, v97
v_cvt_pk_bf16_f32 v223, v98, v99
buffer_store_dwordx4 v[220:223], v233, s[8:11], s64 offen offset:3072 sc1
v_pk_mul_f32 v[100:101], v[100:101], v[108:109]
v_pk_mul_f32 v[102:103], v[102:103], v[110:111]
v_cvt_pk_bf16_f32 v224, v100, v101
v_cvt_pk_bf16_f32 v225, v102, v103
v_pk_mul_f32 v[104:105], v[104:105], v[112:113]
v_pk_mul_f32 v[106:107], v[106:107], v[114:115]
v_cvt_pk_bf16_f32 v226, v104, v105
v_cvt_pk_bf16_f32 v227, v106, v107
s_nop 0
v_permlane16_swap_b32 v224, v226
v_permlane16_swap_b32 v225, v227
buffer_store_dwordx4 v[224:227], v232, s[8:11], s65 offen sc1
L_c5:
buffer_load_dwordx4 v1, s[4:7], s39 offen offset:3072  lds
s_add_u32 m0, m0, 4096
s_add_u32 s39, s39, 4096
buffer_load_dwordx4 v1, s[4:7], s39 offen offset:0  lds
s_waitcnt vmcnt(2)
s_barrier
s_cmp_eq_u32 s24, 0
s_cbranch_scc0 L_sig_12
v_lshlrev_b32 v6, 3, v1
s_lshl_b32 s31, s25, 11
s_lshl_b32 s32, s26, 2
s_add_u32 s31, s31, s32
v_add_u32 v6, s31, v6
s_mov_b64 exec, 0xffff
s_mov_b32 s30, 26574848
buffer_store_dword v4, v6, s[8:11], s30 offen sc1
s_mov_b64 exec, -1
L_sig_12:
s_mul_i32 s38, s24, 9216
s_add_u32 m0, s38, 110592
s_add_u32 s39, s38, s83
s_add_u32 s39, s39, 110592
buffer_load_dwordx4 v1, s[4:7], s39 offen offset:0  lds
buffer_load_dwordx4 v1, s[4:7], s39 offen offset:1024  lds
buffer_load_dwordx4 v1, s[4:7], s39 offen offset:2048  lds
buffer_load_dwordx4 v1, s[4:7], s39 offen offset:3072  lds
s_add_u32 m0, m0, 4096
s_add_u32 s39, s39, 4096
buffer_load_dwordx4 v1, s[4:7], s39 offen offset:0  lds
buffer_load_dwordx4 v1, s[4:7], s39 offen offset:1024  lds
buffer_load_dwordx4 v1, s[4:7], s39 offen offset:2048  lds
buffer_load_dwordx4 v1, s[4:7], s39 offen offset:3072  lds
s_add_u32 m0, m0, 4096
s_add_u32 s39, s39, 4096
buffer_load_dwordx4 v1, s[4:7], s39 offen offset:0  lds
s_cmp_eq_u32 s24, 1
s_cbranch_scc0 L_polled_14
s_lshl_b32 s30, s81, 7
s_add_u32 s30, s30, 26574848
v_lshrrev_b32 v6, 2, v1
s_mov_b32 s31, 0
s_mov_b64 exec, 0xffff
L_poll_13:
buffer_load_dword v7, v6, s[8:11], s30 offen sc1
s_add_u32 s31, s31, 1
s_waitcnt vmcnt(0)
v_cmp_ne_u32 vcc, 1, v7
s_cmp_gt_u32 s31, 200000
s_cbranch_scc1 L_polled_14
s_cbranch_vccnz L_poll_13
L_polled_14:
s_mov_b64 exec, -1
s_waitcnt vmcnt(0)
s_barrier
s_lshl_b32 s60, s27, 2
s_add_u32 s60, s60, s24
s_mul_i32 s60, s60, 73728
s_add_u32 s60, s60, 16777216
buffer_load_dwordx4 a[0:3], v1, s[8:11], s60 offen offset:0 sc1
buffer_load_dwordx4 a[4:7], v1, s[8:11], s60 offen offset:1024 sc1
buffer_load_dwordx4 a[8:11], v1, s[8:11], s60 offen offset:2048 sc1
buffer_load_dwordx4 a[12:15], v1, s[8:11], s60 offen offset:3072 sc1
s_add_u32 s60, s60, 4096
buffer_load_dwordx4 a[16:19], v1, s[8:11], s60 offen offset:0 sc1
buffer_load_dwordx4 a[20:23], v1, s[8:11], s60 offen offset:1024 sc1
buffer_load_dwordx4 a[24:27], v1, s[8:11], s60 offen offset:2048 sc1
buffer_load_dwordx4 a[28:31], v1, s[8:11], s60 offen offset:3072 sc1
s_add_u32 s60, s60, 4096
buffer_load_dwordx4 a[32:35], v1, s[8:11], s60 offen offset:0 sc1
buffer_load_dwordx4 a[36:39], v1, s[8:11], s60 offen offset:1024 sc1
v_and_b32 v40, 7, v2
v_lshlrev_b32 v40, 4, v40
v_lshl_add_u32 v40, v3, 7, v40
v_add_u32 v40, 4096, v40
v_add_u32 v36, 0, v1
v_add_u32 v37, 36864, v1
v_add_u32 v41, 36864, v40
v_add_u32 v38, 73728, v1
v_add_u32 v42, 73728, v40
v_add_u32 v39, 110592, v1
v_add_u32 v43, 110592, v40
ds_read_b128 a[160:163], v36 offset:0
ds_read_b128 a[164:167], v36 offset:1024
ds_read_b128 a[168:171], v36 offset:2048
ds_read_b128 a[172:175], v36 offset:3072
ds_read_b128 a[176:179], v40 offset:0
ds_read_b128 a[180:183], v36 offset:4608
ds_read_b128 a[184:187], v36 offset:5632
ds_read_b128 a[188:191], v36 offset:6656
ds_read_b128 a[192:195], v36 offset:7680
ds_read_b128 a[196:199], v40 offset:4608
s_waitcnt vmcnt(9)
s_waitcnt lgkmcnt(5)
v_mfma_f32_16x16x32_bf16 v[16:19], a[160:163], a[0:3], v[16:19]
ds_read_b128 a[200:203], v36 offset:9216
buffer_load_dwordx4 a[40:43], v1, s[8:11], s60 offen offset:2048 sc1
v_mfma_f32_16x16x32_bf16 v[20:23], a[164:167], a[0:3], v[20:23]
ds_read_b128 a[204:207], v36 offset:10240
v_mfma_f32_16x16x32_bf16 v[24:27], a[168:171], a[0:3], v[24:27]
ds_read_b128 a[208:211], v36 offset:11264
v_mfma_f32_16x16x32_bf16 v[28:31], a[172:175], a[0:3], v[28:31]
ds_read_b128 a[212:215], v36 offset:12288
v_mfma_f32_16x16x32_bf16 v[32:35], a[176:179], a[0:3], v[32:35]
ds_read_b128 a[216:219], v40 offset:9216
s_waitcnt vmcnt(9)
s_waitcnt lgkmcnt(5)
v_mfma_f32_16x16x32_bf16 v[16:19], a[180:183], a[4:7], v[16:19]
ds_read_b128 a[160:163], v36 offset:13824
buffer_load_dwordx4 a[0:3], v1, s[8:11], s60 offen offset:3072 sc1
v_mfma_f32_16x16x32_bf16 v[20:23], a[184:187], a[4:7], v[20:23]
ds_read_b128 a[164:167], v36 offset:14848
v_mfma_f32_16x16x32_bf16 v[24:27], a[188:191], a[4:7], v[24:27]
ds_read_b128 a[168:171], v36 offset:15872
v_mfma_f32_16x16x32_bf16 v[28:31], a[192:195], a[4:7], v[28:31]
ds_read_b128 a[172:175], v36 offset:16896
v_mfma_f32_16x16x32_bf16 v[32:35], a[196:199], a[4:7], v[32:35]
ds_read_b128 a[176:179], v40 offset:13824
s_waitcnt vmcnt(9)
s_waitcnt lgkmcnt(5)
v_mfma_f32_16x16x32_bf16 v[16:19], a[200:203], a[8:11], v[16:19]
ds_read_b128 a[180:183], v36 offset:18432
s_add_u32 s60, s60, 4096
buffer_load_dwordx4 a[4:7], v1, s[8:11], s60 offen offset:0 sc1
v_mfma_f32_16x16x32_bf16 v[20:23], a[204:207], a[8:11], v[20:23]
ds_read_b128 a[184:187], v36 offset:19456
v_mfma_f32_16x16x32_bf16 v[24:27], a[208:211], a[8:11], v[24:27]
ds_read_b128 a[188:191], v36 offset:20480
v_mfma_f32_16x16x32_bf16 v[28:31], a[212:215], a[8:11], v[28:31]
ds_read_b128 a[192:195], v36 offset:21504
v_mfma_f32_16x16x32_bf16 v[32:35], a[216:219], a[8:11], v[32:35]
ds_read_b128 a[196:199], v40 offset:18432
s_waitcnt vmcnt(9)
s_waitcnt lgkmcnt(5)
v_mfma_f32_16x16x32_bf16 v[16:19], a[160:163], a[12:15], v[16:19]
ds_read_b128 a[200:203], v36 offset:23040
buffer_load_dwordx4 a[8:11], v1, s[8:11], s60 offen offset:1024 sc1
v_mfma_f32_16x16x32_bf16 v[20:23], a[164:167], a[12:15], v[20:23]
ds_read_b128 a[204:207], v36 offset:24064
v_mfma_f32_16x16x32_bf16 v[24:27], a[168:171], a[12:15], v[24:27]
ds_read_b128 a[208:211], v36 offset:25088
v_mfma_f32_16x16x32_bf16 v[28:31], a[172:175], a[12:15], v[28:31]
ds_read_b128 a[212:215], v36 offset:26112
v_mfma_f32_16x16x32_bf16 v[32:35], a[176:179], a[12:15], v[32:35]
ds_read_b128 a[216:219], v40 offset:23040
s_waitcnt vmcnt(9)
s_waitcnt lgkmcnt(5)
v_mfma_f32_16x16x32_bf16 v[16:19], a[180:183], a[16:19], v[16:19]
ds_read_b128 a[160:163], v36 offset:27648
buffer_load_dwordx4 a[12:15], v1, s[8:11], s60 offen offset:2048 sc1
v_mfma_f32_16x16x32_bf16 v[20:23], a[184:187], a[16:19], v[20:23]
ds_read_b128 a[164:167], v36 offset:28672
v_mfma_f32_16x16x32_bf16 v[24:27], a[188:191], a[16:19], v[24:27]
ds_read_b128 a[168:171], v36 offset:29696
v_mfma_f32_16x16x32_bf16 v[28:31], a[192:195], a[16:19], v[28:31]
ds_read_b128 a[172:175], v36 offset:30720
v_mfma_f32_16x16x32_bf16 v[32:35], a[196:199], a[16:19], v[32:35]
ds_read_b128 a[176:179], v40 offset:27648
s_waitcnt vmcnt(9)
s_waitcnt lgkmcnt(5)
v_mfma_f32_16x16x32_bf16 v[16:19], a[200:203], a[20:23], v[16:19]
ds_read_b128 a[180:183], v36 offset:32256
buffer_load_dwordx4 a[16:19], v1, s[8:11], s60 offen offset:3072 sc1
v_mfma_f32_16x16x32_bf16 v[20:23], a[204:207], a[20:23], v[20:23]
ds_read_b128 a[184:187], v36 offset:33280
v_mfma_f32_16x16x32_bf16 v[24:27], a[208:211], a[20:23], v[24:27]
ds_read_b128 a[188:191], v36 offset:34304
v_mfma_f32_16x16x32_bf16 v[28:31], a[212:215], a[20:23], v[28:31]
ds_read_b128 a[192:195], v36 offset:35328
v_mfma_f32_16x16x32_bf16 v[32:35], a[216:219], a[20:23], v[32:35]
ds_read_b128 a[196:199], v40 offset:32256
s_waitcnt vmcnt(9)
s_waitcnt lgkmcnt(5)
v_mfma_f32_16x16x32_bf16 v[16:19], a[160:163], a[24:27], v[16:19]
ds_read_b128 a[200:203], v37 offset:0
s_add_u32 s60, s60, 4096
buffer_load_dwordx4 a[20:23], v1, s[8:11], s60 offen offset:0 sc1
v_mfma_f32_16x16x32_bf16 v[20:23], a[164:167], a[24:27], v[20:23]
ds_read_b128 a[204:207], v37 offset:1024
v_mfma_f32_16x16x32_bf16 v[24:27], a[168:171], a[24:27], v[24:27]
ds_read_b128 a[208:211], v37 offset:2048
v_mfma_f32_16x16x32_bf16 v[28:31], a[172:175], a[24:27], v[28:31]
ds_read_b128 a[212:215], v37 offset:3072
v_mfma_f32_16x16x32_bf16 v[32:35], a[176:179], a[24:27], v[32:35]
ds_read_b128 a[216:219], v41 offset:0
s_waitcnt vmcnt(9)
s_waitcnt lgkmcnt(5)
v_mfma_f32_16x16x32_bf16 v[16:19], a[180:183], a[28:31], v[16:19]
ds_read_b128 a[160:163], v37 offset:4608
buffer_load_dwordx4 a[24:27], v1, s[8:11], s60 offen offset:1024 sc1
v_mfma_f32_16x16x32_bf16 v[20:23], a[184:187], a[28:31], v[20:23]
ds_read_b128 a[164:167], v37 offset:5632
v_mfma_f32_16x16x32_bf16 v[24:27], a[188:191], a[28:31], v[24:27]
ds_read_b128 a[168:171], v37 offset:6656
v_mfma_f32_16x16x32_bf16 v[28:31], a[192:195], a[28:31], v[28:31]
ds_read_b128 a[172:175], v37 offset:7680
v_mfma_f32_16x16x32_bf16 v[32:35], a[196:199], a[28:31], v[32:35]
ds_read_b128 a[176:179], v41 offset:4608
s_barrier
s_waitcnt vmcnt(9)
s_waitcnt lgkmcnt(5)
v_mfma_f32_16x16x32_bf16 v[16:19], a[200:203], a[32:35], v[16:19]
ds_read_b128 a[180:183], v37 offset:9216
buffer_load_dwordx4 a[28:31], v1, s[8:11], s60 offen offset:2048 sc1
s_mul_i32 s38, s24, 9216
v_mfma_f32_16x16x32_bf16 v[20:23], a[204:207], a[32:35], v[20:23]
ds_read_b128 a[184:187], v37 offset:10240
s_add_u32 m0, s38, 0
v_mfma_f32_16x16x32_bf16 v[24:27], a[208:211], a[32:35], v[24:27]
ds_read_b128 a[188:191], v37 offset:11264
s_add_u32 s39, s38, s83
v_mfma_f32_16x16x32_bf16 v[28:31], a[212:215], a[32:35], v[28:31]
ds_read_b128 a[192:195], v37 offset:12288
s_add_u32 s39, s39, 147456
v_mfma_f32_16x16x32_bf16 v[32:35], a[216:219], a[32:35], v[32:35]
ds_read_b128 a[196:199], v41 offset:9216
s_waitcnt vmcnt(9)
s_waitcnt lgkmcnt(5)
v_mfma_f32_16x16x32_bf16 v[16:19], a[160:163], a[36:39], v[16:19]
ds_read_b128 a[200:203], v37 offset:13824
buffer_load_dwordx4 a[32:35], v1, s[8:11], s60 offen offset:3072 sc1
v_mfma_f32_16x16x32_bf16 v[20:23], a[164:167], a[36:39], v[20:23]
ds_read_b128 a[204:207], v37 offset:14848
v_mfma_f32_16x16x32_bf16 v[24:27], a[168:171], a[36:39], v[24:27]
ds_read_b128 a[208:211], v37 offset:15872
v_mfma_f32_16x16x32_bf16 v[28:31], a[172:175], a[36:39], v[28:31]
ds_read_b128 a[212:215], v37 offset:16896
v_mfma_f32_16x16x32_bf16 v[32:35], a[176:179], a[36:39], v[32:35]
ds_read_b128 a[216:219], v41 offset:13824
s_waitcnt vmcnt(9)
s_waitcnt lgkmcnt(5)
v_mfma_f32_16x16x32_bf16 v[16:19], a[180:183], a[40:43], v[16:19]
ds_read_b128 a[160:163], v37 offset:18432
s_add_u32 s60, s60, 4096
buffer_load_dwordx4 a[36:39], v1, s[8:11], s60 offen offset:0 sc1
v_mfma_f32_16x16x32_bf16 v[20:23], a[184:187], a[40:43], v[20:23]
ds_read_b128 a[164:167], v37 offset:19456
buffer_load_dwordx4 v1, s[4:7], s39 offen offset:0  lds
v_mfma_f32_16x16x32_bf16 v[24:27], a[188:191], a[40:43], v[24:27]
ds_read_b128 a[168:171], v37 offset:20480
buffer_load_dwordx4 v1, s[4:7], s39 offen offset:1024  lds
v_mfma_f32_16x16x32_bf16 v[28:31], a[192:195], a[40:43], v[28:31]
ds_read_b128 a[172:175], v37 offset:21504
buffer_load_dwordx4 v1, s[4:7], s39 offen offset:2048  lds
v_mfma_f32_16x16x32_bf16 v[32:35], a[196:199], a[40:43], v[32:35]
ds_read_b128 a[176:179], v41 offset:18432
s_waitcnt vmcnt(12)
s_waitcnt lgkmcnt(5)
v_mfma_f32_16x16x32_bf16 v[16:19], a[200:203], a[0:3], v[16:19]
ds_read_b128 a[180:183], v37 offset:23040
buffer_load_dwordx4 a[40:43], v1, s[8:11], s60 offen offset:1024 sc1
v_mfma_f32_16x16x32_bf16 v[20:23], a[204:207], a[0:3], v[20:23]
ds_read_b128 a[184:187], v37 offset:24064
buffer_load_dwordx4 v1, s[4:7], s39 offen offset:3072  lds
s_add_u32 m0, m0, 4096
v_mfma_f32_16x16x32_bf16 v[24:27], a[208:211], a[0:3], v[24:27]
ds_read_b128 a[188:191], v37 offset:25088
s_add_u32 s39, s39, 4096
v_mfma_f32_16x16x32_bf16 v[28:31], a[212:215], a[0:3], v[28:31]
ds_read_b128 a[192:195], v37 offset:26112
v_mfma_f32_16x16x32_bf16 v[32:35], a[216:219], a[0:3], v[32:35]
ds_read_b128 a[196:199], v41 offset:23040
s_waitcnt vmcnt(13)
s_waitcnt lgkmcnt(5)
v_mfma_f32_16x16x32_bf16 v[16:19], a[160:163], a[4:7], v[16:19]
ds_read_b128 a[200:203], v37 offset:27648
buffer_load_dwordx4 a[0:3], v1, s[8:11], s60 offen offset:2048 sc1
v_mfma_f32_16x16x32_bf16 v[20:23], a[164:167], a[4:7], v[20:23]
ds_read_b128 a[204:207], v37 offset:28672
v_mfma_f32_16x16x32_bf16 v[24:27], a[168:171], a[4:7], v[24:27]
ds_read_b128 a[208:211], v37 offset:29696
buffer_load_dwordx4 v1, s[4:7], s39 offen offset:0  lds
v_mfma_f32_16x16x32_bf16 v[28:31], a[172:175], a[4:7], v[28:31]
ds_read_b128 a[212:215], v37 offset:30720
v_mfma_f32_16x16x32_bf16 v[32:35], a[176:179], a[4:7], v[32:35]
ds_read_b128 a[216:219], v41 offset:27648
s_waitcnt vmcnt(14)
s_waitcnt lgkmcnt(5)
v_mfma_f32_16x16x32_bf16 v[16:19], a[180:183], a[8:11], v[16:19]
ds_read_b128 a[160:163], v37 offset:32256
buffer_load_dwordx4 a[4:7], v1, s[8:11], s60 offen offset:3072 sc1
buffer_load_dwordx4 v1, s[4:7], s39 offen offset:1024  lds
v_mfma_f32_16x16x32_bf16 v[20:23], a[184:187], a[8:11], v[20:23]
ds_read_b128 a[164:167], v37 offset:33280
v_mfma_f32_16x16x32_bf16 v[24:27], a[188:191], a[8:11], v[24:27]
ds_read_b128 a[168:171], v37 offset:34304
buffer_load_dwordx4 v1, s[4:7], s39 offen offset:2048  lds
v_mfma_f32_16x16x32_bf16 v[28:31], a[192:195], a[8:11], v[28:31]
ds_read_b128 a[172:175], v37 offset:35328
v_mfma_f32_16x16x32_bf16 v[32:35], a[196:199], a[8:11], v[32:35]
ds_read_b128 a[176:179], v41 offset:32256
s_waitcnt vmcnt(16)
s_waitcnt lgkmcnt(5)
v_mfma_f32_16x16x32_bf16 v[16:19], a[200:203], a[12:15], v[16:19]
ds_read_b128 a[180:183], v38 offset:0
s_add_u32 s60, s60, 4096
buffer_load_dwordx4 a[8:11], v1, s[8:11], s60 offen offset:0 sc1
v_mfma_f32_16x16x32_bf16 v[20:23], a[204:207], a[12:15], v[20:23]
ds_read_b128 a[184:187], v38 offset:1024
buffer_load_dwordx4 v1, s[4:7], s39 offen offset:3072  lds
s_add_u32 m0, m0, 4096
v_mfma_f32_16x16x32_bf16 v[24:27], a[208:211], a[12:15], v[24:27]
ds_read_b128 a[188:191], v38 offset:2048
s_add_u32 s39, s39, 4096
v_mfma_f32_16x16x32_bf16 v[28:31], a[212:215], a[12:15], v[28:31]
ds_read_b128 a[192:195], v38 offset:3072
v_mfma_f32_16x16x32_bf16 v[32:35], a[216:219], a[12:15], v[32:35]
ds_read_b128 a[196:199], v42 offset:0
s_waitcnt vmcnt(17)
s_waitcnt lgkmcnt(5)
v_mfma_f32_16x16x32_bf16 v[16:19], a[160:163], a[16:19], v[16:19]
ds_read_b128 a[200:203], v38 offset:4608
buffer_load_dwordx4 a[12:15], v1, s[8:11], s60 offen offset:1024 sc1
v_mfma_f32_16x16x32_bf16 v[20:23], a[164:167], a[16:19], v[20:23]
ds_read_b128 a[204:207], v38 offset:5632
buffer_load_dwordx4 v1, s[4:7], s39 offen offset:0  lds
v_mfma_f32_16x16x32_bf16 v[24:27], a[168:171], a[16:19], v[24:27]
ds_read_b128 a[208:211], v38 offset:6656
v_mfma_f32_16x16x32_bf16 v[28:31], a[172:175], a[16:19], v[28:31]
ds_read_b128 a[212:215], v38 offset:7680
v_mfma_f32_16x16x32_bf16 v[32:35], a[176:179], a[16:19], v[32:35]
ds_read_b128 a[216:219], v42 offset:4608
s_barrier
s_waitcnt vmcnt(18)
s_waitcnt lgkmcnt(5)
v_mfma_f32_16x16x32_bf16 v[16:19], a[180:183], a[20:23], v[16:19]
ds_read_b128 a[160:163], v38 offset:9216
buffer_load_dwordx4 a[16:19], v1, s[8:11], s60 offen offset:2048 sc1
s_mul_i32 s38, s24, 9216
v_mfma_f32_16x16x32_bf16 v[20:23], a[184:187], a[20:23], v[20:23]
ds_read_b128 a[164:167], v38 offset:10240
s_add_u32 m0, s38, 36864
v_mfma_f32_16x16x32_bf16 v[24:27], a[188:191], a[20:23], v[24:27]
ds_read_b128 a[168:171], v38 offset:11264
s_add_u32 s39, s38, s83
v_mfma_f32_16x16x32_bf16 v[28:31], a[192:195], a[20:23], v[28:31]
ds_read_b128 a[172:175], v38 offset:12288
s_add_u32 s39, s39, 184320
v_mfma_f32_16x16x32_bf16 v[32:35], a[196:199], a[20:23], v[32:35]
ds_read_b128 a[176:179], v42 offset:9216
s_waitcnt vmcnt(18)
s_waitcnt lgkmcnt(5)
v_mfma_f32_16x16x32_bf16 v[16:19], a[200:203], a[24:27], v[16:19]
ds_read_b128 a[180:183], v38 offset:13824
buffer_load_dwordx4 a[20:23], v1, s[8:11], s60 offen offset:3072 sc1
v_mfma_f32_16x16x32_bf16 v[20:23], a[204:207], a[24:27], v[20:23]
ds_read_b128 a[184:187], v38 offset:14848
v_mfma_f32_16x16x32_bf16 v[24:27], a[208:211], a[24:27], v[24:27]
ds_read_b128 a[188:191], v38 offset:15872
v_mfma_f32_16x16x32_bf16 v[28:31], a[212:215], a[24:27], v[28:31]
ds_read_b128 a[192:195], v38 offset:16896
v_mfma_f32_16x16x32_bf16 v[32:35], a[216:219], a[24:27], v[32:35]
ds_read_b128 a[196:199], v42 offset:13824
s_waitcnt vmcnt(18)
s_waitcnt lgkmcnt(5)
v_mfma_f32_16x16x32_bf16 v[16:19], a[160:163], a[28:31], v[16:19]
ds_read_b128 a[200:203], v38 offset:18432
s_add_u32 s60, s60, 4096
buffer_load_dwordx4 a[24:27], v1, s[8:11], s60 offen offset:0 sc1
v_mfma_f32_16x16x32_bf16 v[20:23], a[164:167], a[28:31], v[20:23]
ds_read_b128 a[204:207], v38 offset:19456
buffer_load_dwordx4 v1, s[4:7], s39 offen offset:0  lds
v_mfma_f32_16x16x32_bf16 v[24:27], a[168:171], a[28:31], v[24:27]
ds_read_b128 a[208:211], v38 offset:20480
buffer_load_dwordx4 v1, s[4:7], s39 offen offset:1024  lds
v_mfma_f32_16x16x32_bf16 v[28:31], a[172:175], a[28:31], v[28:31]
ds_read_b128 a[212:215], v38 offset:21504
buffer_load_dwordx4 v1, s[4:7], s39 offen offset:2048  lds
v_mfma_f32_16x16x32_bf16 v[32:35], a[176:179], a[28:31], v[32:35]
ds_read_b128 a[216:219], v42 offset:18432
s_waitcnt vmcnt(21)
s_waitcnt lgkmcnt(5)
v_mfma_f32_16x16x32_bf16 v[16:19], a[180:183], a[32:35], v[16:19]
ds_read_b128 a[160:163], v38 offset:23040
buffer_load_dwordx4 a[28:31], v1, s[8:11], s60 offen offset:1024 sc1
v_mfma_f32_16x16x32_bf16 v[20:23], a[184:187], a[32:35], v[20:23]
ds_read_b128 a[164:167], v38 offset:24064
buffer_load_dwordx4 v1, s[4:7], s39 offen offset:3072  lds
s_add_u32 m0, m0, 4096
v_mfma_f32_16x16x32_bf16 v[24:27], a[188:191], a[32:35], v[24:27]
ds_read_b128 a[168:171], v38 offset:25088
s_add_u32 s39, s39, 4096
v_mfma_f32_16x16x32_bf16 v[28:31], a[192:195], a[32:35], v[28:31]
ds_read_b128 a[172:175], v38 offset:26112
v_mfma_f32_16x16x32_bf16 v[32:35], a[196:199], a[32:35], v[32:35]
ds_read_b128 a[176:179], v42 offset:23040
s_waitcnt vmcnt(22)
s_waitcnt lgkmcnt(5)
v_mfma_f32_16x16x32_bf16 v[16:19], a[200:203], a[36:39], v[16:19]
ds_read_b128 a[180:183], v38 offset:27648
buffer_load_dwordx4 a[32:35], v1, s[8:11], s60 offen offset:2048 sc1
v_mfma_f32_16x16x32_bf16 v[20:23], a[204:207], a[36:39], v[20:23]
ds_read_b128 a[184:187], v38 offset:28672
v_mfma_f32_16x16x32_bf16 v[24:27], a[208:211], a[36:39], v[24:27]
ds_read_b128 a[188:191], v38 offset:29696
buffer_load_dwordx4 v1, s[4:7], s39 offen offset:0  lds
v_mfma_f32_16x16x32_bf16 v[28:31], a[212:215], a[36:39], v[28:31]
ds_read_b128 a[192:195], v38 offset:30720
v_mfma_f32_16x16x32_bf16 v[32:35], a[216:219], a[36:39], v[32:35]
ds_read_b128 a[196:199], v42 offset:27648
s_waitcnt vmcnt(20)
s_waitcnt lgkmcnt(5)
v_mfma_f32_16x16x32_bf16 v[16:19], a[160:163], a[40:43], v[16:19]
ds_read_b128 a[200:203], v38 offset:32256
buffer_load_dwordx4 a[36:39], v1, s[8:11], s60 offen offset:3072 sc1
buffer_load_dwordx4 v1, s[4:7], s39 offen offset:1024  lds
v_mfma_f32_16x16x32_bf16 v[20:23], a[164:167], a[40:43], v[20:23]
ds_read_b128 a[204:207], v38 offset:33280
v_mfma_f32_16x16x32_bf16 v[24:27], a[168:171], a[40:43], v[24:27]
ds_read_b128 a[208:211], v38 offset:34304
buffer_load_dwordx4 v1, s[4:7], s39 offen offset:2048  lds
v_mfma_f32_16x16x32_bf16 v[28:31], a[172:175], a[40:43], v[28:31]
ds_read_b128 a[212:215], v38 offset:35328
v_mfma_f32_16x16x32_bf16 v[32:35], a[176:179], a[40:43], v[32:35]
ds_read_b128 a[216:219], v42 offset:32256
s_waitcnt vmcnt(21)
s_waitcnt lgkmcnt(5)
v_mfma_f32_16x16x32_bf16 v[16:19], a[180:183], a[0:3], v[16:19]
ds_read_b128 a[160:163], v39 offset:0
s_add_u32 s60, s60, 4096
buffer_load_dwordx4 a[40:43], v1, s[8:11], s60 offen offset:0 sc1
v_mfma_f32_16x16x32_bf16 v[20:23], a[184:187], a[0:3], v[20:23]
ds_read_b128 a[164:167], v39 offset:1024
buffer_load_dwordx4 v1, s[4:7], s39 offen offset:3072  lds
s_add_u32 m0, m0, 4096
v_mfma_f32_16x16x32_bf16 v[24:27], a[188:191], a[0:3], v[24:27]
ds_read_b128 a[168:171], v39 offset:2048
s_add_u32 s39, s39, 4096
v_mfma_f32_16x16x32_bf16 v[28:31], a[192:195], a[0:3], v[28:31]
ds_read_b128 a[172:175], v39 offset:3072
v_mfma_f32_16x16x32_bf16 v[32:35], a[196:199], a[0:3], v[32:35]
ds_read_b128 a[176:179], v43 offset:0
s_waitcnt vmcnt(21)
s_waitcnt lgkmcnt(5)
v_mfma_f32_16x16x32_bf16 v[16:19], a[200:203], a[4:7], v[16:19]
ds_read_b128 a[180:183], v39 offset:4608
buffer_load_dwordx4 a[0:3], v1, s[8:11], s60 offen offset:1024 sc1
v_mfma_f32_16x16x32_bf16 v[20:23], a[204:207], a[4:7], v[20:23]
ds_read_b128 a[184:187], v39 offset:5632
buffer_load_dwordx4 v1, s[4:7], s39 offen offset:0  lds
v_mfma_f32_16x16x32_bf16 v[24:27], a[208:211], a[4:7], v[24:27]
ds_read_b128 a[188:191], v39 offset:6656
v_mfma_f32_16x16x32_bf16 v[28:31], a[212:215], a[4:7], v[28:31]
ds_read_b128 a[192:195], v39 offset:7680
v_mfma_f32_16x16x32_bf16 v[32:35], a[216:219], a[4:7], v[32:35]
ds_read_b128 a[196:199], v43 offset:4608
s_waitcnt vmcnt(17)
s_barrier
s_waitcnt lgkmcnt(5)
v_mfma_f32_16x16x32_bf16 v[16:19], a[160:163], a[8:11], v[16:19]
ds_read_b128 a[200:203], v39 offset:9216
buffer_load_dwordx4 a[4:7], v1, s[8:11], s60 offen offset:2048 sc1
s_mul_i32 s38, s24, 9216
v_mfma_f32_16x16x32_bf16 v[20:23], a[164:167], a[8:11], v[20:23]
ds_read_b128 a[204:207], v39 offset:10240
s_add_u32 m0, s38, 73728
v_mfma_f32_16x16x32_bf16 v[24:27], a[168:171], a[8:11], v[24:27]
ds_read_b128 a[208:211], v39 offset:11264
s_add_u32 s39, s38, s83
v_mfma_f32_16x16x32_bf16 v[28:31], a[172:175], a[8:11], v[28:31]
ds_read_b128 a[212:215], v39 offset:12288
s_add_u32 s39, s39, 221184
v_mfma_f32_16x16x32_bf16 v[32:35], a[176:179], a[8:11], v[32:35]
ds_read_b128 a[216:219], v43 offset:9216
s_waitcnt lgkmcnt(5)
v_mfma_f32_16x16x32_bf16 v[16:19], a[180:183], a[12:15], v[16:19]
ds_read_b128 a[160:163], v39 offset:13824
buffer_load_dwordx4 a[8:11], v1, s[8:11], s60 offen offset:3072 sc1
v_mfma_f32_16x16x32_bf16 v[20:23], a[184:187], a[12:15], v[20:23]
ds_read_b128 a[164:167], v39 offset:14848
v_mfma_f32_16x16x32_bf16 v[24:27], a[188:191], a[12:15], v[24:27]
ds_read_b128 a[168:171], v39 offset:15872
v_mfma_f32_16x16x32_bf16 v[28:31], a[192:195], a[12:15], v[28:31]
ds_read_b128 a[172:175], v39 offset:16896
v_mfma_f32_16x16x32_bf16 v[32:35], a[196:199], a[12:15], v[32:35]
ds_read_b128 a[176:179], v43 offset:13824
s_waitcnt vmcnt(18)
s_waitcnt lgkmcnt(5)
v_mfma_f32_16x16x32_bf16 v[16:19], a[200:203], a[16:19], v[16:19]
ds_read_b128 a[180:183], v39 offset:18432
s_add_u32 s60, s60, 4096
buffer_load_dwordx4 a[12:15], v1, s[8:11], s60 offen offset:0 sc1
v_mfma_f32_16x16x32_bf16 v[20:23], a[204:207], a[16:19], v[20:23]
ds_read_b128 a[184:187], v39 offset:19456
buffer_load_dwordx4 v1, s[4:7], s39 offen offset:0  lds
v_mfma_f32_16x16x32_bf16 v[24:27], a[208:211], a[16:19], v[24:27]
ds_read_b128 a[188:191], v39 offset:20480
buffer_load_dwordx4 v1, s[4:7], s39 offen offset:1024  lds
v_mfma_f32_16x16x32_bf16 v[28:31], a[212:215], a[16:19], v[28:31]
ds_read_b128 a[192:195], v39 offset:21504
buffer_load_dwordx4 v1, s[4:7], s39 offen offset:2048  lds
v_mfma_f32_16x16x32_bf16 v[32:35], a[216:219], a[16:19], v[32:35]
ds_read_b128 a[196:199], v43 offset:18432
s_waitcnt vmcnt(21)
s_waitcnt lgkmcnt(5)
v_mfma_f32_16x16x32_bf16 v[16:19], a[160:163], a[20:23], v[16:19]
ds_read_b128 a[200:203], v39 offset:23040
buffer_load_dwordx4 a[16:19], v1, s[8:11], s60 offen offset:1024 sc1
v_mfma_f32_16x16x32_bf16 v[20:23], a[164:167], a[20:23], v[20:23]
ds_read_b128 a[204:207], v39 offset:24064
buffer_load_dwordx4 v1, s[4:7], s39 offen offset:3072  lds
s_add_u32 m0, m0, 4096
v_mfma_f32_16x16x32_bf16 v[24:27], a[168:171], a[20:23], v[24:27]
ds_read_b128 a[208:211], v39 offset:25088
s_add_u32 s39, s39, 4096
v_mfma_f32_16x16x32_bf16 v[28:31], a[172:175], a[20:23], v[28:31]
ds_read_b128 a[212:215], v39 offset:26112
v_mfma_f32_16x16x32_bf16 v[32:35], a[176:179], a[20:23], v[32:35]
ds_read_b128 a[216:219], v43 offset:23040
s_waitcnt vmcnt(22)
s_waitcnt lgkmcnt(5)
v_mfma_f32_16x16x32_bf16 v[16:19], a[180:183], a[24:27], v[16:19]
ds_read_b128 a[160:163], v39 offset:27648
buffer_load_dwordx4 a[20:23], v1, s[8:11], s60 offen offset:2048 sc1
v_mfma_f32_16x16x32_bf16 v[20:23], a[184:187], a[24:27], v[20:23]
ds_read_b128 a[164:167], v39 offset:28672
v_mfma_f32_16x16x32_bf16 v[24:27], a[188:191], a[24:27], v[24:27]
ds_read_b128 a[168:171], v39 offset:29696
buffer_load_dwordx4 v1, s[4:7], s39 offen offset:0  lds
v_mfma_f32_16x16x32_bf16 v[28:31], a[192:195], a[24:27], v[28:31]
ds_read_b128 a[172:175], v39 offset:30720
v_mfma_f32_16x16x32_bf16 v[32:35], a[196:199], a[24:27], v[32:35]
ds_read_b128 a[176:179], v43 offset:27648
s_waitcnt vmcnt(20)
s_waitcnt lgkmcnt(5)
v_mfma_f32_16x16x32_bf16 v[16:19], a[200:203], a[28:31], v[16:19]
ds_read_b128 a[180:183], v39 offset:32256
buffer_load_dwordx4 a[24:27], v1, s[8:11], s60 offen offset:3072 sc1
buffer_load_dwordx4 v1, s[4:7], s39 offen offset:1024  lds
v_mfma_f32_16x16x32_bf16 v[20:23], a[204:207], a[28:31], v[20:23]
ds_read_b128 a[184:187], v39 offset:33280
v_mfma_f32_16x16x32_bf16 v[24:27], a[208:211], a[28:31], v[24:27]
ds_read_b128 a[188:191], v39 offset:34304
buffer_load_dwordx4 v1, s[4:7], s39 offen offset:2048  lds
v_mfma_f32_16x16x32_bf16 v[28:31], a[212:215], a[28:31], v[28:31]
ds_read_b128 a[192:195], v39 offset:35328
v_mfma_f32_16x16x32_bf16 v[32:35], a[216:219], a[28:31], v[32:35]
ds_read_b128 a[196:199], v43 offset:32256
s_waitcnt vmcnt(21)
s_waitcnt lgkmcnt(5)
v_mfma_f32_16x16x32_bf16 v[16:19], a[160:163], a[32:35], v[16:19]
ds_read_b128 a[200:203], v36 offset:0
s_add_u32 s60, s60, 4096
buffer_load_dwordx4 a[28:31], v1, s[8:11], s60 offen offset:0 sc1
v_mfma_f32_16x16x32_bf16 v[20:23], a[164:167], a[32:35], v[20:23]
ds_read_b128 a[204:207], v36 offset:1024
buffer_load_dwordx4 v1, s[4:7], s39 offen offset:3072  lds
s_add_u32 m0, m0, 4096
v_mfma_f32_16x16x32_bf16 v[24:27], a[168:171], a[32:35], v[24:27]
ds_read_b128 a[208:211], v36 offset:2048
s_add_u32 s39, s39, 4096
v_mfma_f32_16x16x32_bf16 v[28:31], a[172:175], a[32:35], v[28:31]
ds_read_b128 a[212:215], v36 offset:3072
v_mfma_f32_16x16x32_bf16 v[32:35], a[176:179], a[32:35], v[32:35]
ds_read_b128 a[216:219], v40 offset:0
s_waitcnt vmcnt(21)
s_waitcnt lgkmcnt(5)
v_mfma_f32_16x16x32_bf16 v[16:19], a[180:183], a[36:39], v[16:19]
ds_read_b128 a[160:163], v36 offset:4608
buffer_load_dwordx4 a[32:35], v1, s[8:11], s60 offen offset:1024 sc1
v_mfma_f32_16x16x32_bf16 v[20:23], a[184:187], a[36:39], v[20:23]
ds_read_b128 a[164:167], v36 offset:5632
buffer_load_dwordx4 v1, s[4:7], s39 offen offset:0  lds
v_mfma_f32_16x16x32_bf16 v[24:27], a[188:191], a[36:39], v[24:27]
ds_read_b128 a[168:171], v36 offset:6656
v_mfma_f32_16x16x32_bf16 v[28:31], a[192:195], a[36:39], v[28:31]
ds_read_b128 a[172:175], v36 offset:7680
v_mfma_f32_16x16x32_bf16 v[32:35], a[196:199], a[36:39], v[32:35]
ds_read_b128 a[176:179], v40 offset:4608
s_waitcnt vmcnt(17)
s_barrier
s_waitcnt lgkmcnt(5)
v_mfma_f32_16x16x32_bf16 v[16:19], a[200:203], a[40:43], v[16:19]
ds_read_b128 a[180:183], v36 offset:9216
buffer_load_dwordx4 a[36:39], v1, s[8:11], s60 offen offset:2048 sc1
s_mul_i32 s38, s24, 9216
v_mfma_f32_16x16x32_bf16 v[20:23], a[204:207], a[40:43], v[20:23]
ds_read_b128 a[184:187], v36 offset:10240
s_add_u32 m0, s38, 110592
v_mfma_f32_16x16x32_bf16 v[24:27], a[208:211], a[40:43], v[24:27]
ds_read_b128 a[188:191], v36 offset:11264
s_add_u32 s39, s38, s83
v_mfma_f32_16x16x32_bf16 v[28:31], a[212:215], a[40:43], v[28:31]
ds_read_b128 a[192:195], v36 offset:12288
s_add_u32 s39, s39, 258048
v_mfma_f32_16x16x32_bf16 v[32:35], a[216:219], a[40:43], v[32:35]
ds_read_b128 a[196:199], v40 offset:9216
s_waitcnt lgkmcnt(5)
v_mfma_f32_16x16x32_bf16 v[16:19], a[160:163], a[0:3], v[16:19]
ds_read_b128 a[200:203], v36 offset:13824
buffer_load_dwordx4 a[40:43], v1, s[8:11], s60 offen offset:3072 sc1
v_mfma_f32_16x16x32_bf16 v[20:23], a[164:167], a[0:3], v[20:23]
ds_read_b128 a[204:207], v36 offset:14848
v_mfma_f32_16x16x32_bf16 v[24:27], a[168:171], a[0:3], v[24:27]
ds_read_b128 a[208:211], v36 offset:15872
v_mfma_f32_16x16x32_bf16 v[28:31], a[172:175], a[0:3], v[28:31]
ds_read_b128 a[212:215], v36 offset:16896
v_mfma_f32_16x16x32_bf16 v[32:35], a[176:179], a[0:3], v[32:35]
ds_read_b128 a[216:219], v40 offset:13824
s_waitcnt vmcnt(18)
s_waitcnt lgkmcnt(5)
v_mfma_f32_16x16x32_bf16 v[16:19], a[180:183], a[4:7], v[16:19]
ds_read_b128 a[160:163], v36 offset:18432
s_add_u32 s60, s60, 4096
buffer_load_dwordx4 a[0:3], v1, s[8:11], s60 offen offset:0 sc1
v_mfma_f32_16x16x32_bf16 v[20:23], a[184:187], a[4:7], v[20:23]
ds_read_b128 a[164:167], v36 offset:19456
buffer_load_dwordx4 v1, s[4:7], s39 offen offset:0  lds
v_mfma_f32_16x16x32_bf16 v[24:27], a[188:191], a[4:7], v[24:27]
ds_read_b128 a[168:171], v36 offset:20480
buffer_load_dwordx4 v1, s[4:7], s39 offen offset:1024  lds
v_mfma_f32_16x16x32_bf16 v[28:31], a[192:195], a[4:7], v[28:31]
ds_read_b128 a[172:175], v36 offset:21504
buffer_load_dwordx4 v1, s[4:7], s39 offen offset:2048  lds
v_mfma_f32_16x16x32_bf16 v[32:35], a[196:199], a[4:7], v[32:35]
ds_read_b128 a[176:179], v40 offset:18432
s_waitcnt vmcnt(21)
s_waitcnt lgkmcnt(5)
v_mfma_f32_16x16x32_bf16 v[16:19], a[200:203], a[8:11], v[16:19]
ds_read_b128 a[180:183], v36 offset:23040
buffer_load_dwordx4 a[4:7], v1, s[8:11], s60 offen offset:1024 sc1
v_mfma_f32_16x16x32_bf16 v[20:23], a[204:207], a[8:11], v[20:23]
ds_read_b128 a[184:187], v36 offset:24064
buffer_load_dwordx4 v1, s[4:7], s39 offen offset:3072  lds
s_add_u32 m0, m0, 4096
v_mfma_f32_16x16x32_bf16 v[24:27], a[208:211], a[8:11], v[24:27]
ds_read_b128 a[188:191], v36 offset:25088
s_add_u32 s39, s39, 4096
v_mfma_f32_16x16x32_bf16 v[28:31], a[212:215], a[8:11], v[28:31]
ds_read_b128 a[192:195], v36 offset:26112
v_mfma_f32_16x16x32_bf16 v[32:35], a[216:219], a[8:11], v[32:35]
ds_read_b128 a[196:199], v40 offset:23040
s_waitcnt vmcnt(22)
s_waitcnt lgkmcnt(5)
v_mfma_f32_16x16x32_bf16 v[16:19], a[160:163], a[12:15], v[16:19]
ds_read_b128 a[200:203], v36 offset:27648
buffer_load_dwordx4 a[8:11], v1, s[8:11], s60 offen offset:2048 sc1
v_mfma_f32_16x16x32_bf16 v[20:23], a[164:167], a[12:15], v[20:23]
ds_read_b128 a[204:207], v36 offset:28672
v_mfma_f32_16x16x32_bf16 v[24:27], a[168:171], a[12:15], v[24:27]
ds_read_b128 a[208:211], v36 offset:29696
buffer_load_dwordx4 v1, s[4:7], s39 offen offset:0  lds
v_mfma_f32_16x16x32_bf16 v[28:31], a[172:175], a[12:15], v[28:31]
ds_read_b128 a[212:215], v36 offset:30720
v_mfma_f32_16x16x32_bf16 v[32:35], a[176:179], a[12:15], v[32:35]
ds_read_b128 a[216:219], v40 offset:27648
s_waitcnt vmcnt(20)
s_waitcnt lgkmcnt(5)
v_mfma_f32_16x16x32_bf16 v[16:19], a[180:183], a[16:19], v[16:19]
ds_read_b128 a[160:163], v36 offset:32256
buffer_load_dwordx4 a[12:15], v1, s[8:11], s60 offen offset:3072 sc1
buffer_load_dwordx4 v1, s[4:7], s39 offen offset:1024  lds
v_mfma_f32_16x16x32_bf16 v[20:23], a[184:187], a[16:19], v[20:23]
ds_read_b128 a[164:167], v36 offset:33280
v_mfma_f32_16x16x32_bf16 v[24:27], a[188:191], a[16:19], v[24:27]
ds_read_b128 a[168:171], v36 offset:34304
buffer_load_dwordx4 v1, s[4:7], s39 offen offset:2048  lds
v_mfma_f32_16x16x32_bf16 v[28:31], a[192:195], a[16:19], v[28:31]
ds_read_b128 a[172:175], v36 offset:35328
v_mfma_f32_16x16x32_bf16 v[32:35], a[196:199], a[16:19], v[32:35]
ds_read_b128 a[176:179], v40 offset:32256
s_waitcnt vmcnt(21)
s_waitcnt lgkmcnt(5)
v_mfma_f32_16x16x32_bf16 v[16:19], a[200:203], a[20:23], v[16:19]
ds_read_b128 a[180:183], v37 offset:0
s_add_u32 s60, s60, 4096
buffer_load_dwordx4 a[16:19], v1, s[8:11], s60 offen offset:0 sc1
v_mfma_f32_16x16x32_bf16 v[20:23], a[204:207], a[20:23], v[20:23]
ds_read_b128 a[184:187], v37 offset:1024
buffer_load_dwordx4 v1, s[4:7], s39 offen offset:3072  lds
s_add_u32 m0, m0, 4096
v_mfma_f32_16x16x32_bf16 v[24:27], a[208:211], a[20:23], v[24:27]
ds_read_b128 a[188:191], v37 offset:2048
s_add_u32 s39, s39, 4096
v_mfma_f32_16x16x32_bf16 v[28:31], a[212:215], a[20:23], v[28:31]
ds_read_b128 a[192:195], v37 offset:3072
v_mfma_f32_16x16x32_bf16 v[32:35], a[216:219], a[20:23], v[32:35]
ds_read_b128 a[196:199], v41 offset:0
s_waitcnt vmcnt(21)
s_waitcnt lgkmcnt(5)
v_mfma_f32_16x16x32_bf16 v[16:19], a[160:163], a[24:27], v[16:19]
ds_read_b128 a[200:203], v37 offset:4608
buffer_load_dwordx4 a[20:23], v1, s[8:11], s60 offen offset:1024 sc1
v_mfma_f32_16x16x32_bf16 v[20:23], a[164:167], a[24:27], v[20:23]
ds_read_b128 a[204:207], v37 offset:5632
buffer_load_dwordx4 v1, s[4:7], s39 offen offset:0  lds
v_mfma_f32_16x16x32_bf16 v[24:27], a[168:171], a[24:27], v[24:27]
ds_read_b128 a[208:211], v37 offset:6656
v_mfma_f32_16x16x32_bf16 v[28:31], a[172:175], a[24:27], v[28:31]
ds_read_b128 a[212:215], v37 offset:7680
v_mfma_f32_16x16x32_bf16 v[32:35], a[176:179], a[24:27], v[32:35]
ds_read_b128 a[216:219], v41 offset:4608
s_waitcnt vmcnt(17)
s_barrier
s_waitcnt lgkmcnt(5)
v_mfma_f32_16x16x32_bf16 v[16:19], a[180:183], a[28:31], v[16:19]
ds_read_b128 a[160:163], v37 offset:9216
buffer_load_dwordx4 a[24:27], v1, s[8:11], s60 offen offset:2048 sc1
s_mul_i32 s38, s24, 9216
v_mfma_f32_16x16x32_bf16 v[20:23], a[184:187], a[28:31], v[20:23]
ds_read_b128 a[164:167], v37 offset:10240
s_add_u32 m0, s38, 0
v_mfma_f32_16x16x32_bf16 v[24:27], a[188:191], a[28:31], v[24:27]
ds_read_b128 a[168:171], v37 offset:11264
s_add_u32 s39, s38, s83
v_mfma_f32_16x16x32_bf16 v[28:31], a[192:195], a[28:31], v[28:31]
ds_read_b128 a[172:175], v37 offset:12288
s_add_u32 s39, s39, 294912
v_mfma_f32_16x16x32_bf16 v[32:35], a[196:199], a[28:31], v[32:35]
ds_read_b128 a[176:179], v41 offset:9216
s_waitcnt lgkmcnt(5)
v_mfma_f32_16x16x32_bf16 v[16:19], a[200:203], a[32:35], v[16:19]
ds_read_b128 a[180:183], v37 offset:13824
buffer_load_dwordx4 a[28:31], v1, s[8:11], s60 offen offset:3072 sc1
v_mfma_f32_16x16x32_bf16 v[20:23], a[204:207], a[32:35], v[20:23]
ds_read_b128 a[184:187], v37 offset:14848
v_mfma_f32_16x16x32_bf16 v[24:27], a[208:211], a[32:35], v[24:27]
ds_read_b128 a[188:191], v37 offset:15872
v_mfma_f32_16x16x32_bf16 v[28:31], a[212:215], a[32:35], v[28:31]
ds_read_b128 a[192:195], v37 offset:16896
v_mfma_f32_16x16x32_bf16 v[32:35], a[216:219], a[32:35], v[32:35]
ds_read_b128 a[196:199], v41 offset:13824
s_waitcnt vmcnt(18)
s_waitcnt lgkmcnt(5)
v_mfma_f32_16x16x32_bf16 v[16:19], a[160:163], a[36:39], v[16:19]
ds_read_b128 a[200:203], v37 offset:18432
s_add_u32 s60, s60, 4096
buffer_load_dwordx4 a[32:35], v1, s[8:11], s60 offen offset:0 sc1
v_mfma_f32_16x16x32_bf16 v[20:23], a[164:167], a[36:39], v[20:23]
ds_read_b128 a[204:207], v37 offset:19456
buffer_load_dwordx4 v1, s[4:7], s39 offen offset:0  lds
v_mfma_f32_16x16x32_bf16 v[24:27], a[168:171], a[36:39], v[24:27]
ds_read_b128 a[208:211], v37 offset:20480
buffer_load_dwordx4 v1, s[4:7], s39 offen offset:1024  lds
v_mfma_f32_16x16x32_bf16 v[28:31], a[172:175], a[36:39], v[28:31]
ds_read_b128 a[212:215], v37 offset:21504
buffer_load_dwordx4 v1, s[4:7], s39 offen offset:2048  lds
v_mfma_f32_16x16x32_bf16 v[32:35], a[176:179], a[36:39], v[32:35]
ds_read_b128 a[216:219], v41 offset:18432
s_waitcnt vmcnt(21)
s_waitcnt lgkmcnt(5)
v_mfma_f32_16x16x32_bf16 v[16:19], a[180:183], a[40:43], v[16:19]
ds_read_b128 a[160:163], v37 offset:23040
buffer_load_dwordx4 a[36:39], v1, s[8:11], s60 offen offset:1024 sc1
v_mfma_f32_16x16x32_bf16 v[20:23], a[184:187], a[40:43], v[20:23]
ds_read_b128 a[164:167], v37 offset:24064
buffer_load_dwordx4 v1, s[4:7], s39 offen offset:3072  lds
s_add_u32 m0, m0, 4096
v_mfma_f32_16x16x32_bf16 v[24:27], a[188:191], a[40:43], v[24:27]
ds_read_b128 a[168:171], v37 offset:25088
s_add_u32 s39, s39, 4096
v_mfma_f32_16x16x32_bf16 v[28:31], a[192:195], a[40:43], v[28:31]
ds_read_b128 a[172:175], v37 offset:26112
v_mfma_f32_16x16x32_bf16 v[32:35], a[196:199], a[40:43], v[32:35]
ds_read_b128 a[176:179], v41 offset:23040
s_waitcnt vmcnt(22)
s_waitcnt lgkmcnt(5)
v_mfma_f32_16x16x32_bf16 v[16:19], a[200:203], a[0:3], v[16:19]
ds_read_b128 a[180:183], v37 offset:27648
buffer_load_dwordx4 a[40:43], v1, s[8:11], s60 offen offset:2048 sc1
v_mfma_f32_16x16x32_bf16 v[20:23], a[204:207], a[0:3], v[20:23]
ds_read_b128 a[184:187], v37 offset:28672
v_mfma_f32_16x16x32_bf16 v[24:27], a[208:211], a[0:3], v[24:27]
ds_read_b128 a[188:191], v37 offset:29696
buffer_load_dwordx4 v1, s[4:7], s39 offen offset:0  lds
v_mfma_f32_16x16x32_bf16 v[28:31], a[212:215], a[0:3], v[28:31]
ds_read_b128 a[192:195], v37 offset:30720
v_mfma_f32_16x16x32_bf16 v[32:35], a[216:219], a[0:3], v[32:35]
ds_read_b128 a[196:199], v41 offset:27648
s_waitcnt vmcnt(20)
s_waitcnt lgkmcnt(5)
v_mfma_f32_16x16x32_bf16 v[16:19], a[160:163], a[4:7], v[16:19]
ds_read_b128 a[200:203], v37 offset:32256
buffer_load_dwordx4 a[0:3], v1, s[8:11], s60 offen offset:3072 sc1
buffer_load_dwordx4 v1, s[4:7], s39 offen offset:1024  lds
v_mfma_f32_16x16x32_bf16 v[20:23], a[164:167], a[4:7], v[20:23]
ds_read_b128 a[204:207], v37 offset:33280
v_mfma_f32_16x16x32_bf16 v[24:27], a[168:171], a[4:7], v[24:27]
ds_read_b128 a[208:211], v37 offset:34304
buffer_load_dwordx4 v1, s[4:7], s39 offen offset:2048  lds
v_mfma_f32_16x16x32_bf16 v[28:31], a[172:175], a[4:7], v[28:31]
ds_read_b128 a[212:215], v37 offset:35328
v_mfma_f32_16x16x32_bf16 v[32:35], a[176:179], a[4:7], v[32:35]
ds_read_b128 a[216:219], v41 offset:32256
s_waitcnt vmcnt(21)
s_waitcnt lgkmcnt(5)
v_mfma_f32_16x16x32_bf16 v[16:19], a[180:183], a[8:11], v[16:19]
ds_read_b128 a[160:163], v38 offset:0
s_add_u32 s60, s60, 4096
buffer_load_dwordx4 a[4:7], v1, s[8:11], s60 offen offset:0 sc1
v_mfma_f32_16x16x32_bf16 v[20:23], a[184:187], a[8:11], v[20:23]
ds_read_b128 a[164:167], v38 offset:1024
buffer_load_dwordx4 v1, s[4:7], s39 offen offset:3072  lds
s_add_u32 m0, m0, 4096
v_mfma_f32_16x16x32_bf16 v[24:27], a[188:191], a[8:11], v[24:27]
ds_read_b128 a[168:171], v38 offset:2048
s_add_u32 s39, s39, 4096
v_mfma_f32_16x16x32_bf16 v[28:31], a[192:195], a[8:11], v[28:31]
ds_read_b128 a[172:175], v38 offset:3072
v_mfma_f32_16x16x32_bf16 v[32:35], a[196:199], a[8:11], v[32:35]
ds_read_b128 a[176:179], v42 offset:0
s_waitcnt vmcnt(21)
s_waitcnt lgkmcnt(5)
v_mfma_f32_16x16x32_bf16 v[16:19], a[200:203], a[12:15], v[16:19]
ds_read_b128 a[180:183], v38 offset:4608
buffer_load_dwordx4 a[8:11], v1, s[8:11], s60 offen offset:1024 sc1
v_mfma_f32_16x16x32_bf16 v[20:23], a[204:207], a[12:15], v[20:23]
ds_read_b128 a[184:187], v38 offset:5632
buffer_load_dwordx4 v1, s[4:7], s39 offen offset:0  lds
v_mfma_f32_16x16x32_bf16 v[24:27], a[208:211], a[12:15], v[24:27]
ds_read_b128 a[188:191], v38 offset:6656
v_mfma_f32_16x16x32_bf16 v[28:31], a[212:215], a[12:15], v[28:31]
ds_read_b128 a[192:195], v38 offset:7680
v_mfma_f32_16x16x32_bf16 v[32:35], a[216:219], a[12:15], v[32:35]
ds_read_b128 a[196:199], v42 offset:4608
s_waitcnt vmcnt(17)
s_barrier
s_waitcnt lgkmcnt(5)
v_mfma_f32_16x16x32_bf16 v[16:19], a[160:163], a[16:19], v[16:19]
ds_read_b128 a[200:203], v38 offset:9216
buffer_load_dwordx4 a[12:15], v1, s[8:11], s60 offen offset:2048 sc1
v_mfma_f32_16x16x32_bf16 v[20:23], a[164:167], a[16:19], v[20:23]
ds_read_b128 a[204:207], v38 offset:10240
v_mfma_f32_16x16x32_bf16 v[24:27], a[168:171], a[16:19], v[24:27]
ds_read_b128 a[208:211], v38 offset:11264
v_mfma_f32_16x16x32_bf16 v[28:31], a[172:175], a[16:19], v[28:31]
ds_read_b128 a[212:215], v38 offset:12288
v_mfma_f32_16x16x32_bf16 v[32:35], a[176:179], a[16:19], v[32:35]
ds_read_b128 a[216:219], v42 offset:9216
s_waitcnt lgkmcnt(5)
v_mfma_f32_16x16x32_bf16 v[16:19], a[180:183], a[20:23], v[16:19]
ds_read_b128 a[160:163], v38 offset:13824
buffer_load_dwordx4 a[16:19], v1, s[8:11], s60 offen offset:3072 sc1
v_mfma_f32_16x16x32_bf16 v[20:23], a[184:187], a[20:23], v[20:23]
ds_read_b128 a[164:167], v38 offset:14848
v_mfma_f32_16x16x32_bf16 v[24:27], a[188:191], a[20:23], v[24:27]
ds_read_b128 a[168:171], v38 offset:15872
v_mfma_f32_16x16x32_bf16 v[28:31], a[192:195], a[20:23], v[28:31]
ds_read_b128 a[172:175], v38 offset:16896
v_mfma_f32_16x16x32_bf16 v[32:35], a[196:199], a[20:23], v[32:35]
ds_read_b128 a[176:179], v42 offset:13824
s_waitcnt vmcnt(18)
s_waitcnt lgkmcnt(5)
v_mfma_f32_16x16x32_bf16 v[16:19], a[200:203], a[24:27], v[16:19]
ds_read_b128 a[180:183], v38 offset:18432
s_add_u32 s60, s60, 4096
buffer_load_dwordx4 a[20:23], v1, s[8:11], s60 offen offset:0 sc1
v_mfma_f32_16x16x32_bf16 v[20:23], a[204:207], a[24:27], v[20:23]
ds_read_b128 a[184:187], v38 offset:19456
v_mfma_f32_16x16x32_bf16 v[24:27], a[208:211], a[24:27], v[24:27]
ds_read_b128 a[188:191], v38 offset:20480
v_mfma_f32_16x16x32_bf16 v[28:31], a[212:215], a[24:27], v[28:31]
ds_read_b128 a[192:195], v38 offset:21504
v_mfma_f32_16x16x32_bf16 v[32:35], a[216:219], a[24:27], v[32:35]
ds_read_b128 a[196:199], v42 offset:18432
s_waitcnt vmcnt(18)
s_waitcnt lgkmcnt(5)
v_mfma_f32_16x16x32_bf16 v[16:19], a[160:163], a[28:31], v[16:19]
ds_read_b128 a[200:203], v38 offset:23040
buffer_load_dwordx4 a[24:27], v1, s[8:11], s60 offen offset:1024 sc1
v_mfma_f32_16x16x32_bf16 v[20:23], a[164:167], a[28:31], v[20:23]
ds_read_b128 a[204:207], v38 offset:24064
v_mfma_f32_16x16x32_bf16 v[24:27], a[168:171], a[28:31], v[24:27]
ds_read_b128 a[208:211], v38 offset:25088
v_mfma_f32_16x16x32_bf16 v[28:31], a[172:175], a[28:31], v[28:31]
ds_read_b128 a[212:215], v38 offset:26112
v_mfma_f32_16x16x32_bf16 v[32:35], a[176:179], a[28:31], v[32:35]
ds_read_b128 a[216:219], v42 offset:23040
s_waitcnt vmcnt(18)
s_waitcnt lgkmcnt(5)
v_mfma_f32_16x16x32_bf16 v[16:19], a[180:183], a[32:35], v[16:19]
ds_read_b128 a[160:163], v38 offset:27648
buffer_load_dwordx4 a[28:31], v1, s[8:11], s60 offen offset:2048 sc1
v_mfma_f32_16x16x32_bf16 v[20:23], a[184:187], a[32:35], v[20:23]
ds_read_b128 a[164:167], v38 offset:28672
v_mfma_f32_16x16x32_bf16 v[24:27], a[188:191], a[32:35], v[24:27]
ds_read_b128 a[168:171], v38 offset:29696
v_mfma_f32_16x16x32_bf16 v[28:31], a[192:195], a[32:35], v[28:31]
ds_read_b128 a[172:175], v38 offset:30720
v_mfma_f32_16x16x32_bf16 v[32:35], a[196:199], a[32:35], v[32:35]
ds_read_b128 a[176:179], v42 offset:27648
s_waitcnt vmcnt(15)
s_waitcnt lgkmcnt(5)
v_mfma_f32_16x16x32_bf16 v[16:19], a[200:203], a[36:39], v[16:19]
ds_read_b128 a[180:183], v38 offset:32256
buffer_load_dwordx4 a[32:35], v1, s[8:11], s60 offen offset:3072 sc1
v_mfma_f32_16x16x32_bf16 v[20:23], a[204:207], a[36:39], v[20:23]
ds_read_b128 a[184:187], v38 offset:33280
v_mfma_f32_16x16x32_bf16 v[24:27], a[208:211], a[36:39], v[24:27]
ds_read_b128 a[188:191], v38 offset:34304
v_mfma_f32_16x16x32_bf16 v[28:31], a[212:215], a[36:39], v[28:31]
ds_read_b128 a[192:195], v38 offset:35328
v_mfma_f32_16x16x32_bf16 v[32:35], a[216:219], a[36:39], v[32:35]
ds_read_b128 a[196:199], v42 offset:32256
s_waitcnt vmcnt(14)
s_waitcnt lgkmcnt(5)
v_mfma_f32_16x16x32_bf16 v[16:19], a[160:163], a[40:43], v[16:19]
ds_read_b128 a[200:203], v39 offset:0
s_add_u32 s60, s60, 4096
buffer_load_dwordx4 a[36:39], v1, s[8:11], s60 offen offset:0 sc1
v_mfma_f32_16x16x32_bf16 v[20:23], a[164:167], a[40:43], v[20:23]
ds_read_b128 a[204:207], v39 offset:1024
v_mfma_f32_16x16x32_bf16 v[24:27], a[168:171], a[40:43], v[24:27]
ds_read_b128 a[208:211], v39 offset:2048
v_mfma_f32_16x16x32_bf16 v[28:31], a[172:175], a[40:43], v[28:31]
ds_read_b128 a[212:215], v39 offset:3072
v_mfma_f32_16x16x32_bf16 v[32:35], a[176:179], a[40:43], v[32:35]
ds_read_b128 a[216:219], v43 offset:0
s_waitcnt vmcnt(13)
s_waitcnt lgkmcnt(5)
v_mfma_f32_16x16x32_bf16 v[16:19], a[180:183], a[0:3], v[16:19]
ds_read_b128 a[160:163], v39 offset:4608
buffer_load_dwordx4 a[40:43], v1, s[8:11], s60 offen offset:1024 sc1
v_mfma_f32_16x16x32_bf16 v[20:23], a[184:187], a[0:3], v[20:23]
ds_read_b128 a[164:167], v39 offset:5632
v_mfma_f32_16x16x32_bf16 v[24:27], a[188:191], a[0:3], v[24:27]
ds_read_b128 a[168:171], v39 offset:6656
v_mfma_f32_16x16x32_bf16 v[28:31], a[192:195], a[0:3], v[28:31]
ds_read_b128 a[172:175], v39 offset:7680
v_mfma_f32_16x16x32_bf16 v[32:35], a[196:199], a[0:3], v[32:35]
ds_read_b128 a[176:179], v43 offset:4608
s_waitcnt vmcnt(8)
s_barrier
s_waitcnt lgkmcnt(5)
v_mfma_f32_16x16x32_bf16 v[16:19], a[200:203], a[4:7], v[16:19]
ds_read_b128 a[180:183], v39 offset:9216
buffer_load_dwordx4 a[0:3], v1, s[8:11], s60 offen offset:2048 sc1
v_mfma_f32_16x16x32_bf16 v[20:23], a[204:207], a[4:7], v[20:23]
ds_read_b128 a[184:187], v39 offset:10240
v_mfma_f32_16x16x32_bf16 v[24:27], a[208:211], a[4:7], v[24:27]
ds_read_b128 a[188:191], v39 offset:11264
v_mfma_f32_16x16x32_bf16 v[28:31], a[212:215], a[4:7], v[28:31]
ds_read_b128 a[192:195], v39 offset:12288
v_mfma_f32_16x16x32_bf16 v[32:35], a[216:219], a[4:7], v[32:35]
ds_read_b128 a[196:199], v43 offset:9216
s_waitcnt lgkmcnt(5)
v_mfma_f32_16x16x32_bf16 v[16:19], a[160:163], a[8:11], v[16:19]
ds_read_b128 a[200:203], v39 offset:13824
buffer_load_dwordx4 a[4:7], v1, s[8:11], s60 offen offset:3072 sc1
v_mfma_f32_16x16x32_bf16 v[20:23], a[164:167], a[8:11], v[20:23]
ds_read_b128 a[204:207], v39 offset:14848
v_mfma_f32_16x16x32_bf16 v[24:27], a[168:171], a[8:11], v[24:27]
ds_read_b128 a[208:211], v39 offset:15872
v_mfma_f32_16x16x32_bf16 v[28:31], a[172:175], a[8:11], v[28:31]
ds_read_b128 a[212:215], v39 offset:16896
v_mfma_f32_16x16x32_bf16 v[32:35], a[176:179], a[8:11], v[32:35]
ds_read_b128 a[216:219], v43 offset:13824
s_waitcnt vmcnt(9)
s_waitcnt lgkmcnt(5)
v_mfma_f32_16x16x32_bf16 v[16:19], a[180:183], a[12:15], v[16:19]
ds_read_b128 a[160:163], v39 offset:18432
s_add_u32 s60, s60, 4096
buffer_load_dwordx4 a[8:11], v1, s[8:11], s60 offen offset:0 sc1
v_mfma_f32_16x16x32_bf16 v[20:23], a[184:187], a[12:15], v[20:23]
ds_read_b128 a[164:167], v39 offset:19456
v_mfma_f32_16x16x32_bf16 v[24:27], a[188:191], a[12:15], v[24:27]
ds_read_b128 a[168:171], v39 offset:20480
v_mfma_f32_16x16x32_bf16 v[28:31], a[192:195], a[12:15], v[28:31]
ds_read_b128 a[172:175], v39 offset:21504
v_mfma_f32_16x16x32_bf16 v[32:35], a[196:199], a[12:15], v[32:35]
ds_read_b128 a[176:179], v43 offset:18432
s_waitcnt vmcnt(9)
s_waitcnt lgkmcnt(5)
v_mfma_f32_16x16x32_bf16 v[16:19], a[200:203], a[16:19], v[16:19]
ds_read_b128 a[180:183], v39 offset:23040
buffer_load_dwordx4 a[12:15], v1, s[8:11], s60 offen offset:1024 sc1
v_mfma_f32_16x16x32_bf16 v[20:23], a[204:207], a[16:19], v[20:23]
ds_read_b128 a[184:187], v39 offset:24064
v_mfma_f32_16x16x32_bf16 v[24:27], a[208:211], a[16:19], v[24:27]
ds_read_b128 a[188:191], v39 offset:25088
v_mfma_f32_16x16x32_bf16 v[28:31], a[212:215], a[16:19], v[28:31]
ds_read_b128 a[192:195], v39 offset:26112
v_mfma_f32_16x16x32_bf16 v[32:35], a[216:219], a[16:19], v[32:35]
ds_read_b128 a[196:199], v43 offset:23040
s_waitcnt vmcnt(9)
s_waitcnt lgkmcnt(5)
v_mfma_f32_16x16x32_bf16 v[16:19], a[160:163], a[20:23], v[16:19]
ds_read_b128 a[200:203], v39 offset:27648
buffer_load_dwordx4 a[16:19], v1, s[8:11], s60 offen offset:2048 sc1
v_mfma_f32_16x16x32_bf16 v[20:23], a[164:167], a[20:23], v[20:23]
ds_read_b128 a[204:207], v39 offset:28672
v_mfma_f32_16x16x32_bf16 v[24:27], a[168:171], a[20:23], v[24:27]
ds_read_b128 a[208:211], v39 offset:29696
v_mfma_f32_16x16x32_bf16 v[28:31], a[172:175], a[20:23], v[28:31]
ds_read_b128 a[212:215], v39 offset:30720
v_mfma_f32_16x16x32_bf16 v[32:35], a[176:179], a[20:23], v[32:35]
ds_read_b128 a[216:219], v43 offset:27648
s_waitcnt vmcnt(9)
s_waitcnt lgkmcnt(5)
v_mfma_f32_16x16x32_bf16 v[16:19], a[180:183], a[24:27], v[16:19]
ds_read_b128 a[160:163], v39 offset:32256
buffer_load_dwordx4 a[20:23], v1, s[8:11], s60 offen offset:3072 sc1
v_mfma_f32_16x16x32_bf16 v[20:23], a[184:187], a[24:27], v[20:23]
ds_read_b128 a[164:167], v39 offset:33280
v_mfma_f32_16x16x32_bf16 v[24:27], a[188:191], a[24:27], v[24:27]
ds_read_b128 a[168:171], v39 offset:34304
v_mfma_f32_16x16x32_bf16 v[28:31], a[192:195], a[24:27], v[28:31]
ds_read_b128 a[172:175], v39 offset:35328
v_mfma_f32_16x16x32_bf16 v[32:35], a[196:199], a[24:27], v[32:35]
ds_read_b128 a[176:179], v43 offset:32256
s_waitcnt vmcnt(9)
s_waitcnt lgkmcnt(5)
v_mfma_f32_16x16x32_bf16 v[16:19], a[200:203], a[28:31], v[16:19]
ds_read_b128 a[180:183], v36 offset:0
v_mfma_f32_16x16x32_bf16 v[20:23], a[204:207], a[28:31], v[20:23]
ds_read_b128 a[184:187], v36 offset:1024
v_mfma_f32_16x16x32_bf16 v[24:27], a[208:211], a[28:31], v[24:27]
ds_read_b128 a[188:191], v36 offset:2048
v_mfma_f32_16x16x32_bf16 v[28:31], a[212:215], a[28:31], v[28:31]
ds_read_b128 a[192:195], v36 offset:3072
v_mfma_f32_16x16x32_bf16 v[32:35], a[216:219], a[28:31], v[32:35]
ds_read_b128 a[196:199], v40 offset:0
s_waitcnt vmcnt(8)
s_waitcnt lgkmcnt(5)
v_mfma_f32_16x16x32_bf16 v[16:19], a[160:163], a[32:35], v[16:19]
ds_read_b128 a[200:203], v36 offset:4608
v_mfma_f32_16x16x32_bf16 v[20:23], a[164:167], a[32:35], v[20:23]
ds_read_b128 a[204:207], v36 offset:5632
v_mfma_f32_16x16x32_bf16 v[24:27], a[168:171], a[32:35], v[24:27]
ds_read_b128 a[208:211], v36 offset:6656
v_mfma_f32_16x16x32_bf16 v[28:31], a[172:175], a[32:35], v[28:31]
ds_read_b128 a[212:215], v36 offset:7680
v_mfma_f32_16x16x32_bf16 v[32:35], a[176:179], a[32:35], v[32:35]
ds_read_b128 a[216:219], v40 offset:4608
s_waitcnt vmcnt(7)
s_waitcnt lgkmcnt(5)
v_mfma_f32_16x16x32_bf16 v[16:19], a[180:183], a[36:39], v[16:19]
ds_read_b128 a[160:163], v36 offset:9216
v_mfma_f32_16x16x32_bf16 v[20:23], a[184:187], a[36:39], v[20:23]
ds_read_b128 a[164:167], v36 offset:10240
v_mfma_f32_16x16x32_bf16 v[24:27], a[188:191], a[36:39], v[24:27]
ds_read_b128 a[168:171], v36 offset:11264
v_mfma_f32_16x16x32_bf16 v[28:31], a[192:195], a[36:39], v[28:31]
ds_read_b128 a[172:175], v36 offset:12288
v_mfma_f32_16x16x32_bf16 v[32:35], a[196:199], a[36:39], v[32:35]
ds_read_b128 a[176:179], v40 offset:9216
s_waitcnt vmcnt(6)
s_waitcnt lgkmcnt(5)
v_mfma_f32_16x16x32_bf16 v[16:19], a[200:203], a[40:43], v[16:19]
ds_read_b128 a[180:183], v36 offset:13824
v_mfma_f32_16x16x32_bf16 v[20:23], a[204:207], a[40:43], v[20:23]
ds_read_b128 a[184:187], v36 offset:14848
v_mfma_f32_16x16x32_bf16 v[24:27], a[208:211], a[40:43], v[24:27]
ds_read_b128 a[188:191], v36 offset:15872
v_mfma_f32_16x16x32_bf16 v[28:31], a[212:215], a[40:43], v[28:31]
ds_read_b128 a[192:195], v36 offset:16896
v_mfma_f32_16x16x32_bf16 v[32:35], a[216:219], a[40:43], v[32:35]
ds_read_b128 a[196:199], v40 offset:13824
s_waitcnt vmcnt(5)
s_waitcnt lgkmcnt(5)
v_mfma_f32_16x16x32_bf16 v[16:19], a[160:163], a[0:3], v[16:19]
ds_read_b128 a[200:203], v36 offset:18432
v_mfma_f32_16x16x32_bf16 v[20:23], a[164:167], a[0:3], v[20:23]
ds_read_b128 a[204:207], v36 offset:19456
v_mfma_f32_16x16x32_bf16 v[24:27], a[168:171], a[0:3], v[24:27]
ds_read_b128 a[208:211], v36 offset:20480
v_mfma_f32_16x16x32_bf16 v[28:31], a[172:175], a[0:3], v[28:31]
ds_read_b128 a[212:215], v36 offset:21504
v_mfma_f32_16x16x32_bf16 v[32:35], a[176:179], a[0:3], v[32:35]
ds_read_b128 a[216:219], v40 offset:18432
s_waitcnt vmcnt(4)
s_waitcnt lgkmcnt(5)
v_mfma_f32_16x16x32_bf16 v[16:19], a[180:183], a[4:7], v[16:19]
ds_read_b128 a[160:163], v36 offset:23040
v_mfma_f32_16x16x32_bf16 v[20:23], a[184:187], a[4:7], v[20:23]
ds_read_b128 a[164:167], v36 offset:24064
v_mfma_f32_16x16x32_bf16 v[24:27], a[188:191], a[4:7], v[24:27]
ds_read_b128 a[168:171], v36 offset:25088
v_mfma_f32_16x16x32_bf16 v[28:31], a[192:195], a[4:7], v[28:31]
ds_read_b128 a[172:175], v36 offset:26112
v_mfma_f32_16x16x32_bf16 v[32:35], a[196:199], a[4:7], v[32:35]
ds_read_b128 a[176:179], v40 offset:23040
s_waitcnt vmcnt(3)
s_waitcnt lgkmcnt(5)
v_mfma_f32_16x16x32_bf16 v[16:19], a[200:203], a[8:11], v[16:19]
ds_read_b128 a[180:183], v36 offset:27648
v_mfma_f32_16x16x32_bf16 v[20:23], a[204:207], a[8:11], v[20:23]
ds_read_b128 a[184:187], v36 offset:28672
v_mfma_f32_16x16x32_bf16 v[24:27], a[208:211], a[8:11], v[24:27]
ds_read_b128 a[188:191], v36 offset:29696
v_mfma_f32_16x16x32_bf16 v[28:31], a[212:215], a[8:11], v[28:31]
ds_read_b128 a[192:195], v36 offset:30720
v_mfma_f32_16x16x32_bf16 v[32:35], a[216:219], a[8:11], v[32:35]
ds_read_b128 a[196:199], v40 offset:27648
s_waitcnt vmcnt(2)
s_waitcnt lgkmcnt(5)
v_mfma_f32_16x16x32_bf16 v[16:19], a[160:163], a[12:15], v[16:19]
ds_read_b128 a[200:203], v36 offset:32256
v_mfma_f32_16x16x32_bf16 v[20:23], a[164:167], a[12:15], v[20:23]
ds_read_b128 a[204:207], v36 offset:33280
v_mfma_f32_16x16x32_bf16 v[24:27], a[168:171], a[12:15], v[24:27]
ds_read_b128 a[208:211], v36 offset:34304
v_mfma_f32_16x16x32_bf16 v[28:31], a[172:175], a[12:15], v[28:31]
ds_read_b128 a[212:215], v36 offset:35328
v_mfma_f32_16x16x32_bf16 v[32:35], a[176:179], a[12:15], v[32:35]
ds_read_b128 a[216:219], v40 offset:32256
s_waitcnt vmcnt(1)
s_waitcnt lgkmcnt(5)
v_mfma_f32_16x16x32_bf16 v[16:19], a[180:183], a[16:19], v[16:19]
v_mfma_f32_16x16x32_bf16 v[20:23], a[184:187], a[16:19], v[20:23]
v_mfma_f32_16x16x32_bf16 v[24:27], a[188:191], a[16:19], v[24:27]
v_mfma_f32_16x16x32_bf16 v[28:31], a[192:195], a[16:19], v[28:31]
v_mfma_f32_16x16x32_bf16 v[32:35], a[196:199], a[16:19], v[32:35]
s_waitcnt vmcnt(0)
s_waitcnt lgkmcnt(0)
v_mfma_f32_16x16x32_bf16 v[16:19], a[200:203], a[20:23], v[16:19]
v_mfma_f32_16x16x32_bf16 v[20:23], a[204:207], a[20:23], v[20:23]
v_mfma_f32_16x16x32_bf16 v[24:27], a[208:211], a[20:23], v[24:27]
v_mfma_f32_16x16x32_bf16 v[28:31], a[212:215], a[20:23], v[28:31]
v_mfma_f32_16x16x32_bf16 v[32:35], a[216:219], a[20:23], v[32:35]
s_cmp_eq_u32 s29, 1
s_cbranch_scc1 L_last
s_barrier
s_lshl_b32 s30, s27, 2
s_add_u32 s30, s30, s24
v_mov_b32 v58, 1073741824
s_mul_i32 s31, s30, 18432
s_mul_i32 s32, s28, 2304
s_add_u32 s31, s31, s32
s_add_u32 s31, s31, 26640384
v_mov_b32 v60, v1
v_add_u32 v61, 2048, v60
v_cndmask_b32 v61, v58, v61, s[46:47]
v_cvt_pk_bf16_f32 v44, v16, v17
v_cvt_pk_bf16_f32 v45, v18, v19
v_cvt_pk_bf16_f32 v46, v20, v21
v_cvt_pk_bf16_f32 v47, v22, v23
v_cvt_pk_bf16_f32 v48, v24, v25
v_cvt_pk_bf16_f32 v49, v26, v27
v_cvt_pk_bf16_f32 v50, v28, v29
v_cvt_pk_bf16_f32 v51, v30, v31
v_cvt_pk_bf16_f32 v52, v32, v33
v_cvt_pk_bf16_f32 v53, v34, v35
buffer_store_dwordx4 v[44:47], v60, s[8:11], s31 offen sc1
buffer_store_dwordx4 v[48:51], v60, s[8:11], s31 offen offset:1024 sc1
v_permlane16_swap_b32 v52, v54
v_permlane16_swap_b32 v53, v55
buffer_store_dwordx4 v[52:55], v61, s[8:11], s31 offen sc1
v_pk_add_f32 v[62:63], v[32:33], v[34:35]
v_pk_mul_f32 v[64:65], v[32:33], v[32:33]
v_pk_fma_f32 v[64:65], v[34:35], v[34:35], v[64:65]
v_cndmask_b32 v62, 0, v62, s[50:51]
v_cndmask_b32 v63, 0, v63, s[50:51]
v_cndmask_b32 v64, 0, v64, s[50:51]
v_cndmask_b32 v65, 0, v65, s[50:51]
v_pk_add_f32 v[62:63], v[62:63], v[16:17]
v_pk_fma_f32 v[64:65], v[16:17], v[16:17], v[64:65]
v_pk_add_f32 v[62:63], v[62:63], v[18:19]
v_pk_fma_f32 v[64:65], v[18:19], v[18:19], v[64:65]
v_pk_add_f32 v[62:63], v[62:63], v[20:21]
v_pk_fma_f32 v[64:65], v[20:21], v[20:21], v[64:65]
v_pk_add_f32 v[62:63], v[62:63], v[22:23]
v_pk_fma_f32 v[64:65], v[22:23], v[22:23], v[64:65]
v_pk_add_f32 v[62:63], v[62:63], v[24:25]
v_pk_fma_f32 v[64:65], v[24:25], v[24:25], v[64:65]
v_pk_add_f32 v[62:63], v[62:63], v[26:27]
v_pk_fma_f32 v[64:65], v[26:27], v[26:27], v[64:65]
v_pk_add_f32 v[62:63], v[62:63], v[28:29]
v_pk_fma_f32 v[64:65], v[28:29], v[28:29], v[64:65]
v_pk_add_f32 v[62:63], v[62:63], v[30:31]
v_pk_fma_f32 v[64:65], v[30:31], v[30:31], v[64:65]
v_add_f32 v56, v62, v63
v_add_f32 v57, v64, v65
s_lshl_b32 s31, s30, 7
s_lshl_b32 s32, s28, 14
v_permlane32_swap_b32 v56, v57
v_add_f32 v56, v56, v57
v_mov_b32 v57, v56
s_add_u32 s31, s31, s32
s_add_u32 s31, s31, 28999680
v_permlane16_swap_b32 v56, v57
v_add_f32 v56, v56, v57
v_mov_b32 v57, v56
v_lshlrev_b32 v59, 3, v2
v_cndmask_b32 v58, v58, v59, s[46:47]
v_permlane32_swap_b32 v56, v57
buffer_store_dwordx2 v[56:57], v58, s[8:11], s31 offen sc1
s_mul_i32 s36, s26, 132608
s_mul_i32 s38, s24, 12288
s_add_u32 m0, s38, 0
s_add_u32 s39, s38, s36
buffer_load_dwordx4 v1, s[4:7], s39 offen offset:0  lds
buffer_load_dwordx4 v1, s[4:7], s39 offen offset:1024  lds
buffer_load_dwordx4 v1, s[4:7], s39 offen offset:2048  lds
buffer_load_dwordx4 v1, s[4:7], s39 offen offset:3072  lds
s_add_u32 m0, m0, 4096
s_add_u32 s39, s39, 4096
buffer_load_dwordx4 v1, s[4:7], s39 offen offset:0  lds
buffer_load_dwordx4 v1, s[4:7], s39 offen offset:1024  lds
buffer_load_dwordx4 v1, s[4:7], s39 offen offset:2048  lds
buffer_load_dwordx4 v1, s[4:7], s39 offen offset:3072  lds
s_add_u32 m0, m0, 4096
s_add_u32 s39, s39, 4096
buffer_load_dwordx4 v1, s[4:7], s39 offen offset:0  lds
buffer_load_dwordx4 v1, s[4:7], s39 offen offset:1024  lds
buffer_load_dwordx4 v1, s[4:7], s39 offen offset:2048  lds
buffer_load_dwordx4 v1, s[4:7], s39 offen offset:3072  lds
s_and_b32 s33, s27, 1
s_cmp_lt_u32 s27, 31
s_cselect_b32 s33, s33, 0
s_cmp_eq_u32 s33, 1
s_cselect_b32 s34, -1, 0xffff
s_mov_b32 s35, 0
s_waitcnt vmcnt(12)
s_barrier
s_cmp_eq_u32 s24, 0
s_cbranch_scc0 L_sig_15
v_lshlrev_b32 v6, 3, v1
s_lshr_b32 s31, s81, 4
s_lshl_b32 s31, s31, 11
s_and_b32 s32, s81, 15
s_lshl_b32 s32, s32, 2
s_add_u32 s31, s31, s32
v_add_u32 v6, s31, v6
v_lshl_add_u32 v6, v3, 5, v6
s_mov_b64 exec, s[34:35]
s_mov_b32 s30, 26607616
buffer_store_dword v4, v6, s[8:11], s30 offen sc1
s_mov_b64 exec, -1
L_sig_15:
s_cmp_eq_u32 s29, 1
s_cbranch_scc1 L_main_fin
s_mul_i32 s36, s26, 132608
s_mul_i32 s38, s24, 21504
s_add_u32 m0, s38, 49152
s_add_u32 s39, s38, s36
s_add_u32 s39, s39, 49152
buffer_load_dwordx4 v1, s[4:7], s39 offen offset:0  lds
buffer_load_dwordx4 v1, s[4:7], s39 offen offset:1024  lds
buffer_load_dwordx4 v1, s[4:7], s39 offen offset:2048  lds
buffer_load_dwordx4 v1, s[4:7], s39 offen offset:3072  lds
s_add_u32 m0, m0, 4096
s_add_u32 s39, s39, 4096
buffer_load_dwordx4 v1, s[4:7], s39 offen offset:0  lds
buffer_load_dwordx4 v1, s[4:7], s39 offen offset:1024  lds
buffer_load_dwordx4 v1, s[4:7], s39 offen offset:2048  lds
buffer_load_dwordx4 v1, s[4:7], s39 offen offset:3072  lds
s_add_u32 m0, m0, 4096
s_add_u32 s39, s39, 4096
buffer_load_dwordx4 v1, s[4:7], s39 offen offset:0  lds
buffer_load_dwordx4 v1, s[4:7], s39 offen offset:1024  lds
buffer_load_dwordx4 v1, s[4:7], s39 offen offset:2048  lds
buffer_load_dwordx4 v1, s[4:7], s39 offen offset:3072  lds
s_add_u32 m0, m0, 4096
s_add_u32 s39, s39, 4096
buffer_load_dwordx4 v1, s[4:7], s39 offen offset:0  lds
buffer_load_dwordx4 v1, s[4:7], s39 offen offset:1024  lds
buffer_load_dwordx4 v1, s[4:7], s39 offen offset:2048  lds
buffer_load_dwordx4 v1, s[4:7], s39 offen offset:3072  lds
s_add_u32 m0, m0, 4096
s_add_u32 s39, s39, 4096
buffer_load_dwordx4 v1, s[4:7], s39 offen offset:0  lds
buffer_load_dwordx4 v1, s[4:7], s39 offen offset:1024  lds
buffer_load_dwordx4 v1, s[4:7], s39 offen offset:2048  lds
buffer_load_dwordx4 v1, s[4:7], s39 offen offset:3072  lds
s_add_u32 m0, m0, 4096
s_add_u32 s39, s39, 4096
buffer_load_dwordx4 v1, s[4:7], s39 offen offset:0  lds
s_mov_b32 s34, 0xffffff
s_cmp_eq_u32 s25, 0
s_cselect_b32 s34, 0xffff, s34
s_mov_b32 s35, 0
s_cmp_eq_u32 s24, 1
s_cbranch_scc0 L_polled_17
s_lshl_b32 s30, s80, 7
s_add_u32 s30, s30, 26607616
v_lshrrev_b32 v6, 2, v1
s_mov_b32 s31, 0
s_mov_b64 exec, s[34:35]
L_poll_16:
buffer_load_dword v7, v6, s[8:11], s30 offen sc1
s_add_u32 s31, s31, 1
s_waitcnt vmcnt(0)
v_cmp_ne_u32 vcc, 1, v7
s_cmp_gt_u32 s31, 200000
s_cbranch_scc1 L_polled_17
s_cbranch_vccnz L_poll_16
L_polled_17:
s_mov_b64 exec, -1
s_waitcnt vmcnt(0)
s_barrier
s_mov_b32 s29, 1
s_add_u32 s8, s8, 26640384
s_addc_u32 s9, s9, 0
s_mov_b32 s10, 26640384
s_branch L_layer
L_last:
s_lshl_b32 s30, s27, 2
s_add_u32 s30, s30, s24
v_mov_b32 v58, 1073741824
s_mul_i32 s31, s30, 18432
s_mul_i32 s32, s28, 144
s_add_u32 s31, s31, s32
v_mul_u32_u24 v60, 1152, v2
v_lshl_add_u32 v60, v3, 4, v60
v_add_u32 v61, 128, v60
v_cndmask_b32 v61, v58, v61, s[46:47]
v_cvt_pk_bf16_f32 v44, v16, v17
v_cvt_pk_bf16_f32 v45, v18, v19
v_cvt_pk_bf16_f32 v46, v20, v21
v_cvt_pk_bf16_f32 v47, v22, v23
v_cvt_pk_bf16_f32 v48, v24, v25
v_cvt_pk_bf16_f32 v49, v26, v27
v_cvt_pk_bf16_f32 v50, v28, v29
v_cvt_pk_bf16_f32 v51, v30, v31
v_cvt_pk_bf16_f32 v52, v32, v33
v_cvt_pk_bf16_f32 v53, v34, v35
buffer_store_dwordx4 v[44:47], v60, s[16:19], s31 offen
buffer_store_dwordx4 v[48:51], v60, s[16:19], s31 offen offset:64
v_permlane16_swap_b32 v52, v54
v_permlane16_swap_b32 v53, v55
buffer_store_dwordx4 v[52:55], v61, s[16:19], s31 offen
L_main_fin:
L_main_end:
s_endpgm
L_code_end:
.section .rodata,"a"
.p2align 6
.amdhsa_kernel prep_kernel
  .amdhsa_next_free_vgpr 64
  .amdhsa_next_free_sgpr 40
  .amdhsa_accum_offset 64
  .amdhsa_group_segment_fixed_size 0
  .amdhsa_kernarg_size 88
  .amdhsa_user_sgpr_count 2
  .amdhsa_user_sgpr_kernarg_segment_ptr 1
  .amdhsa_system_sgpr_workgroup_id_x 1
  .amdhsa_float_denorm_mode_32 3
.end_amdhsa_kernel
.p2align 6
.amdhsa_kernel main_kernel
  .amdhsa_next_free_vgpr 512
  .amdhsa_next_free_sgpr 102
  .amdhsa_accum_offset 256
  .amdhsa_group_segment_fixed_size 0
  .amdhsa_kernarg_size 88
  .amdhsa_user_sgpr_count 2
  .amdhsa_user_sgpr_kernarg_segment_ptr 1
  .amdhsa_system_sgpr_workgroup_id_x 1
  .amdhsa_float_denorm_mode_32 3
.end_amdhsa_kernel
```

```asm
; @launch kernel=main_kernel grid=(256,1,1) block=(256,1,1) lds=163840
.amdgcn_target "amdgcn-amd-amdhsa--gfx950"
.text
.globl main_kernel
.p2align 8
.type main_kernel,@function
main_kernel:
s_cmp_ge_u32 s2, 256
s_cbranch_scc1 L_main_exit
s_load_dwordx16 s[64:79], s[0:1], 0
s_load_dwordx2 s[4:5], s[0:1], 80
s_load_dwordx2 s[16:17], s[0:1], 64
s_load_dwordx2 s[84:85], s[0:1], 72
v_lshrrev_b32 v6, 6, v0
v_and_b32 v0, 63, v0
v_readfirstlane_b32 s24, v6
v_lshlrev_b32 v1, 4, v0
v_and_b32 v2, 15, v0
v_lshrrev_b32 v3, 4, v0
v_mov_b32 v4, 1
v_mov_b32 v5, 0
s_mov_b32 s56, 0
s_mov_b32 s29, 0
v_add_u32 v9, 65536, v1
v_cmp_eq_u32 s[46:47], 0, v3
v_cmp_eq_u32 s[48:49], 2, v3
v_cmp_gt_u32 s[50:51], 2, v3
s_mov_b32 s6, 19320832
s_mov_b32 s7, 0x20000
s_mov_b32 s10, 61669376
s_mov_b32 s11, 0x20000
s_mov_b32 s18, 2359296
s_mov_b32 s19, 0x20000
s_mov_b32 s22, 4096
s_mov_b32 s23, 0x20000
s_mov_b32 s86, 256
s_mov_b32 s87, 0x20000
s_and_b32 s30, s2, 7
s_lshr_b32 s31, s2, 3
s_lshr_b32 s32, s31, 2
s_and_b32 s33, s31, 3
s_lshr_b32 s25, s30, 2
s_lshl_b32 s25, s25, 3
s_add_u32 s25, s25, s32
s_and_b32 s26, s30, 3
s_lshl_b32 s26, s26, 2
s_add_u32 s26, s26, s33
s_branch L_main_go
L_main_exit:
s_endpgm
L_main_go:
s_lshr_b32 s27, s30, 1
s_lshl_b32 s27, s27, 3
s_add_u32 s27, s27, s32
s_and_b32 s28, s30, 1
s_lshl_b32 s28, s28, 2
s_add_u32 s28, s28, s33
s_lshr_b32 s27, s30, 1
s_lshl_b32 s27, s27, 2
s_lshr_b32 s32, s31, 3
s_add_u32 s27, s27, s32
s_lshl_b32 s27, s27, 1
s_and_b32 s32, s30, 1
s_add_u32 s27, s27, s32
s_and_b32 s28, s31, 7
s_lshl_b32 s80, s25, 4
s_add_u32 s80, s80, s26
s_lshl_b32 s81, s27, 3
s_add_u32 s81, s81, s28
s_getpc_b64 s[88:89]
L_pc:
s_mov_b32 s90, L_code_end-L_pc
s_mov_b32 s91, 0x20000
s_lshl_b32 s31, s31, 10
s_lshl_b32 s32, s24, 8
s_add_u32 s31, s31, s32
v_lshrrev_b32 v14, 2, v1
v_add_u32 v14, s31, v14
s_waitcnt lgkmcnt(0)
s_add_u32 s8, s4, 19320832
s_addc_u32 s9, s5, 0
s_mov_b32 s20, s76
s_mov_b32 s21, s77
s_memrealtime s[54:55]
s_or_b32 s30, s2, s24
s_cmp_eq_u32 s30, 0
s_cselect_b32 s30, 0, 1073741824
v_mov_b32 v48, 0
s_waitcnt lgkmcnt(0)
s_or_b32 s54, s54, 1
v_mov_b32 v238, s54
v_mov_b32 v239, s55
s_mov_b64 exec, 1
buffer_store_dwordx2 v[238:239], v48, s[84:87], s30 offen sc1
s_mov_b64 exec, -1
s_cmp_lt_u32 s2, 128
s_cbranch_scc1 L_p0_x1
s_mov_b32 s12, s66
s_mov_b32 s13, s67
s_mov_b32 s14, 1990656
s_mov_b32 s15, 0x20000
s_sub_u32 s30, s2, 128
s_cmp_lt_u32 s30, 108
s_cselect_b32 s62, 0, 1073741824
s_cselect_b32 s30, s30, 0
s_and_b32 s60, s30, 3
s_lshr_b32 s61, s30, 2
s_mul_i32 s30, s60, 497664
s_lshl_b32 s31, s61, 7
s_add_u32 s30, s30, s31
s_mul_i32 s31, s24, 27648
s_add_u32 s30, s30, s31
s_add_u32 s30, s30, s62
v_lshrrev_b32 v36, 7, v1
v_mul_u32_u24 v42, 3456, v36
v_and_b32 v36, 0x70, v1
v_add_u32 v42, v36, v42
s_lshl_b32 s32, s24, 10
s_add_u32 m0, s32, 0
s_add_u32 s31, s30, 0
buffer_load_dwordx4 v42, s[12:15], s31 offen nt lds
s_add_u32 m0, s32, 4096
s_add_u32 s31, s30, 110592
buffer_load_dwordx4 v42, s[12:15], s31 offen nt lds
s_add_u32 m0, s32, 8192
s_add_u32 s31, s30, 221184
buffer_load_dwordx4 v42, s[12:15], s31 offen nt lds
s_add_u32 m0, s32, 12288
s_add_u32 s31, s30, 331776
buffer_load_dwordx4 v42, s[12:15], s31 offen nt lds
s_add_u32 m0, s32, 16384
s_add_u32 s31, s30, 442368
s_cmp_lt_u32 s24, 2
s_cselect_b32 s31, s31, 1073741824
buffer_load_dwordx4 v42, s[12:15], s31 offen nt lds
s_branch L_p0_j1
L_p0_x1:
s_mov_b32 s12, s64
s_mov_b32 s13, s65
s_mov_b32 s14, 2359296
s_mov_b32 s15, 0x20000
s_mul_i32 s30, s24, 18
v_add_u32 v36, s30, v3
v_mul_u32_u24 v42, 1152, v2
v_lshl_add_u32 v42, v36, 4, v42
s_mul_i32 s30, s2, 18432
v_mov_b32 v37, 1073741824
v_cndmask_b32 v37, v37, v42, s[50:51]
buffer_load_dwordx4 v[64:67], v42, s[12:15], s30 offen offset:0
buffer_load_dwordx4 v[68:71], v42, s[12:15], s30 offen offset:64
buffer_load_dwordx4 v[72:75], v42, s[12:15], s30 offen offset:128
buffer_load_dwordx4 v[76:79], v42, s[12:15], s30 offen offset:192
buffer_load_dwordx4 v[80:83], v37, s[12:15], s30 offen offset:256
L_p0_j1:
s_mov_b32 s37, L_pc-L_pc
buffer_load_dword v15, v14, s[88:91], s37 offen
s_mov_b32 s37, L_pc+32768-L_pc
buffer_load_dword v15, v14, s[88:91], s37 offen
v_lshrrev_b32 v36, 2, v2
v_lshl_add_u32 v36, v3, 3, v36
v_lshlrev_b32 v45, 7, v36
v_and_b32 v36, 3, v2
v_lshl_add_u32 v45, v36, 3, v45
s_lshl_b32 s31, s24, 5
v_add_u32 v45, s31, v45
v_mov_b32 v164, 3212836864
v_mov_b32 v165, 3212836864
v_mov_b32 v166, 3212836864
v_mov_b32 v167, 3212836864
s_lshl_b32 s30, s80, 10
s_lshl_b32 s31, s24, 8
s_add_u32 s30, s30, s31
s_add_u32 s30, s30, 26214400
s_mov_b32 s31, 30834688
v_mul_lo_u32 v36, v3, s31
v_lshl_add_u32 v37, v2, 4, v36
s_mov_b32 exec_hi, 0
buffer_store_dwordx4 v[164:167], v37, s[8:11], s30 offen sc1
s_mov_b64 exec, -1
v_lshl_add_u32 v37, v2, 15, v36
s_lshl_b32 s30, s2, 7
s_add_u32 s30, s30, 26476544
s_cmp_eq_u32 s24, 0
s_cselect_b32 s30, s30, 1073741824
s_mov_b64 exec, 0x001f001f
buffer_store_dword v48, v37, s[8:11], s30 offen sc1
s_mov_b64 exec, -1
s_cmp_lt_u32 s2, 128
s_cbranch_scc1 L_p0_x2
s_mul_i32 s92, s61, 29
s_lshr_b32 s92, s92, 8
s_mul_i32 s33, s92, 9
s_sub_u32 s33, s61, s33
s_lshl_b32 s33, s33, 6
s_lshl_b32 s31, s24, 4
s_add_u32 s33, s33, s31
v_add_u32 v36, s33, v2
v_mul_u32_u24 v37, 911, v36
v_lshrrev_b32 v37, 14, v37
v_mul_u32_u24 v38, 18, v37
v_sub_u32 v36, v36, v38
v_and_b32 v38, 1, v37
v_lshrrev_b32 v37, 1, v37
s_mov_b32 s31, 132608
v_mul_lo_u32 v37, v37, s31
s_cmp_eq_u32 s92, 0
s_cselect_b32 s93, 5, 0
s_cselect_b32 s94, 8, 4
s_cmp_eq_u32 s92, 2
s_cselect_b32 s93, 2, s93
s_cselect_b32 s94, 0, s94
s_sub_u32 s94, s94, 16
v_add_u32 v39, s93, v38
v_lshl_add_u32 v40, v38, 1, v36
v_add_u32 v40, s94, v40
v_cmp_gt_u32 vcc, 16, v36
s_nop 1
v_cndmask_b32 v39, 4, v39, vcc
v_cndmask_b32 v40, v40, v36, vcc
v_lshl_add_u32 v43, v39, 10, v37
v_lshl_add_u32 v43, v40, 4, v43
v_lshl_add_u32 v44, v39, 9, v37
v_lshl_add_u32 v44, v40, 3, v44
s_lshl_b32 s31, s60, 7
s_add_u32 s31, s31, 129024
v_add_u32 v44, s31, v44
s_mul_i32 s31, s60, 18
v_add_u32 v37, s31, v3
v_and_b32 v38, 3, v37
v_lshrrev_b32 v37, 2, v37
v_mul_u32_u24 v37, 7168, v37
v_add_u32 v43, v43, v37
v_lshl_add_u32 v43, v38, 8, v43
s_waitcnt vmcnt(4)
s_barrier
ds_read_b64_tr_b16 v[64:65], v45 offset:0
ds_read_b64_tr_b16 v[66:67], v45 offset:512
ds_read_b64_tr_b16 v[68:69], v45 offset:4096
ds_read_b64_tr_b16 v[70:71], v45 offset:4608
ds_read_b64_tr_b16 v[72:73], v45 offset:8192
ds_read_b64_tr_b16 v[74:75], v45 offset:8704
ds_read_b64_tr_b16 v[76:77], v45 offset:12288
ds_read_b64_tr_b16 v[78:79], v45 offset:12800
ds_read_b64_tr_b16 v[80:81], v45 offset:16384
ds_read_b64_tr_b16 v[82:83], v45 offset:16896
v_mov_b32 v36, 1073741824
v_mov_b32 v46, 0
v_cndmask_b32 v37, v36, v43, s[50:51]
s_add_u32 s31, s62, 0
s_waitcnt lgkmcnt(8)
buffer_store_dwordx4 v[64:67], v43, s[4:7], s31 offen sc1
s_add_u32 s31, s62, 7168
s_waitcnt lgkmcnt(6)
buffer_store_dwordx4 v[68:71], v43, s[4:7], s31 offen sc1
s_add_u32 s31, s62, 14336
s_waitcnt lgkmcnt(4)
buffer_store_dwordx4 v[72:75], v43, s[4:7], s31 offen sc1
s_add_u32 s31, s62, 21504
s_waitcnt lgkmcnt(2)
buffer_store_dwordx4 v[76:79], v43, s[4:7], s31 offen sc1
s_add_u32 s31, s62, 28672
s_waitcnt lgkmcnt(0)
buffer_store_dwordx4 v[80:83], v37, s[4:7], s31 offen sc1
v_mov_b32 v37, 0x3f803f80
v_dot2c_f32_bf16 v46, v64, v37
v_dot2c_f32_bf16 v46, v65, v37
v_dot2c_f32_bf16 v46, v66, v37
v_dot2c_f32_bf16 v46, v67, v37
v_dot2c_f32_bf16 v46, v68, v37
v_dot2c_f32_bf16 v46, v69, v37
v_dot2c_f32_bf16 v46, v70, v37
v_dot2c_f32_bf16 v46, v71, v37
v_dot2c_f32_bf16 v46, v72, v37
v_dot2c_f32_bf16 v46, v73, v37
v_dot2c_f32_bf16 v46, v74, v37
v_dot2c_f32_bf16 v46, v75, v37
v_dot2c_f32_bf16 v46, v76, v37
v_dot2c_f32_bf16 v46, v77, v37
v_dot2c_f32_bf16 v46, v78, v37
v_dot2c_f32_bf16 v46, v79, v37
v_dot2c_f32_bf16 v46, v80, v37
v_dot2c_f32_bf16 v46, v81, v37
v_dot2c_f32_bf16 v46, v82, v37
v_dot2c_f32_bf16 v46, v83, v37
s_nop 2
v_mov_b32 v37, v46
s_nop 1
v_permlane32_swap_b32 v46, v37
v_add_f32 v46, v46, v37
v_mov_b32 v37, v46
s_nop 1
v_permlane16_swap_b32 v46, v37
v_add_f32 v46, v46, v37
v_cvt_pk_bf16_f32 v50, v46, v46
v_and_b32 v37, 0xffff0000, v50
v_sub_f32 v37, v46, v37
v_cvt_pk_bf16_f32 v51, v37, v37
v_cndmask_b32 v36, v36, v44, s[46:47]
buffer_store_dwordx2 v[50:51], v36, s[4:7], s62 offen sc1
s_branch L_p0_j2
L_p0_x2:
s_mul_i32 s30, s24, 4608
s_mul_i32 s31, s2, 18432
s_add_u32 s31, s31, s30
s_add_u32 s31, s31, 0
v_mov_b32 v36, 1073741824
v_add_u32 v38, 4096, v1
v_cndmask_b32 v38, v36, v38, s[50:51]
v_mov_b32 v46, 0
v_mov_b32 v47, 0
v_mov_b32 v39, 0x3f803f80
s_waitcnt vmcnt(4)
buffer_store_dwordx4 v[64:67], v1, s[8:11], s31 offen offset:0 sc1
buffer_store_dwordx4 v[68:71], v1, s[8:11], s31 offen offset:1024 sc1
buffer_store_dwordx4 v[72:75], v1, s[8:11], s31 offen offset:2048 sc1
buffer_store_dwordx4 v[76:79], v1, s[8:11], s31 offen offset:3072 sc1
buffer_store_dwordx4 v[80:83], v38, s[8:11], s31 offen offset:0 sc1
v_dot2c_f32_bf16 v46, v64, v39
v_dot2c_f32_bf16 v46, v65, v39
v_dot2c_f32_bf16 v46, v66, v39
v_dot2c_f32_bf16 v46, v67, v39
v_dot2c_f32_bf16 v46, v68, v39
v_dot2c_f32_bf16 v46, v69, v39
v_dot2c_f32_bf16 v46, v70, v39
v_dot2c_f32_bf16 v46, v71, v39
v_dot2c_f32_bf16 v46, v72, v39
v_dot2c_f32_bf16 v46, v73, v39
v_dot2c_f32_bf16 v46, v74, v39
v_dot2c_f32_bf16 v46, v75, v39
v_dot2c_f32_bf16 v46, v76, v39
v_dot2c_f32_bf16 v46, v77, v39
v_dot2c_f32_bf16 v46, v78, v39
v_dot2c_f32_bf16 v46, v79, v39
v_dot2c_f32_bf16 v46, v80, v39
v_dot2c_f32_bf16 v46, v81, v39
v_dot2c_f32_bf16 v46, v82, v39
v_dot2c_f32_bf16 v46, v83, v39
v_dot2c_f32_bf16 v47, v64, v64
v_dot2c_f32_bf16 v47, v65, v65
v_dot2c_f32_bf16 v47, v66, v66
v_dot2c_f32_bf16 v47, v67, v67
v_dot2c_f32_bf16 v47, v68, v68
v_dot2c_f32_bf16 v47, v69, v69
v_dot2c_f32_bf16 v47, v70, v70
v_dot2c_f32_bf16 v47, v71, v71
v_dot2c_f32_bf16 v47, v72, v72
v_dot2c_f32_bf16 v47, v73, v73
v_dot2c_f32_bf16 v47, v74, v74
v_dot2c_f32_bf16 v47, v75, v75
v_dot2c_f32_bf16 v47, v76, v76
v_dot2c_f32_bf16 v47, v77, v77
v_dot2c_f32_bf16 v47, v78, v78
v_dot2c_f32_bf16 v47, v79, v79
v_dot2c_f32_bf16 v47, v80, v80
v_dot2c_f32_bf16 v47, v81, v81
v_dot2c_f32_bf16 v47, v82, v82
v_dot2c_f32_bf16 v47, v83, v83
v_mov_b32 v37, v46
s_nop 1
v_permlane32_swap_b32 v46, v37
v_add_f32 v46, v46, v37
v_mov_b32 v37, v46
s_nop 1
v_permlane16_swap_b32 v46, v37
v_add_f32 v46, v46, v37
v_mov_b32 v37, v47
s_nop 1
v_permlane32_swap_b32 v47, v37
v_add_f32 v47, v47, v37
v_mov_b32 v37, v47
s_nop 1
v_permlane16_swap_b32 v47, v37
v_add_f32 v47, v47, v37
s_lshl_b32 s30, s2, 7
s_lshl_b32 s31, s24, 14
s_add_u32 s30, s30, s31
s_add_u32 s30, s30, 2359296
v_cndmask_b32 v50, 0, v46, s[46:47]
v_cndmask_b32 v51, 0, v47, s[46:47]
v_lshlrev_b32 v37, 3, v2
v_lshl_add_u32 v37, v3, 16, v37
v_cndmask_b32 v37, v36, v37, s[50:51]
buffer_store_dwordx2 v[50:51], v37, s[8:11], s30 offen sc1
L_p0_j2:
buffer_load_dwordx2 v[238:239], v48, s[84:87], 0 offen sc1
s_mov_b32 s12, s72
s_mov_b32 s13, s73
s_mov_b32 s14, 5308416
s_mov_b32 s15, 0x20000
s_sub_u32 s30, s2, 0
s_cmp_lt_u32 s30, 256
s_cselect_b32 s36, 0, 1073741824
s_cselect_b32 s30, s30, 0
s_and_b32 s34, s30, 3
s_lshr_b32 s35, s30, 2
s_mul_i32 s30, s34, 1327104
s_lshl_b32 s31, s35, 7
s_add_u32 s30, s30, s31
s_mul_i32 s31, s24, 73728
s_add_u32 s30, s30, s31
s_add_u32 s30, s30, s36
v_lshrrev_b32 v36, 7, v1
v_mul_u32_u24 v42, 9216, v36
v_and_b32 v36, 0x70, v1
v_add_u32 v42, v36, v42
s_lshl_b32 s32, s24, 10
s_add_u32 m0, s32, 20480
s_add_u32 s31, s30, 0
buffer_load_dwordx4 v42, s[12:15], s31 offen nt lds
s_add_u32 m0, s32, 24576
s_add_u32 s31, s30, 294912
buffer_load_dwordx4 v42, s[12:15], s31 offen nt lds
s_add_u32 m0, s32, 28672
s_add_u32 s31, s30, 589824
buffer_load_dwordx4 v42, s[12:15], s31 offen nt lds
s_add_u32 m0, s32, 32768
s_add_u32 s31, s30, 884736
buffer_load_dwordx4 v42, s[12:15], s31 offen nt lds
s_add_u32 m0, s32, 36864
s_add_u32 s31, s30, 1179648
s_cmp_lt_u32 s24, 2
s_cselect_b32 s31, s31, 1073741824
buffer_load_dwordx4 v42, s[12:15], s31 offen nt lds
s_lshl_b32 s30, s2, 7
s_add_u32 s30, s30, 19283968
s_lshl_b32 s32, s2, 3
s_add_u32 s32, s32, 19316736
s_cmp_eq_u32 s24, 0
s_cselect_b32 s30, s30, 1073741824
s_cselect_b32 s100, s32, 1073741824
s_waitcnt vmcnt(5)
v_cmp_eq_u32 vcc, 0, v238
s_mov_b32 s31, 0
s_cbranch_vccnz L_tagslow_1
L_tagback_2:
s_barrier
s_mov_b64 exec, 1
buffer_store_dwordx2 v[238:239], v48, s[4:7], s30 offen sc1
s_mov_b64 exec, -1
s_cmp_lt_u32 s2, 32
s_cbranch_scc1 L_p0_a3
s_cmp_lt_u32 s2, 176
s_cbranch_scc1 L_p0_b3
s_mov_b32 s12, s68
s_mov_b32 s13, s69
s_mov_b32 s14, 663552
s_mov_b32 s15, 0x20000
s_sub_u32 s30, s2, 176
s_cmp_lt_u32 s30, 36
s_cselect_b32 s53, 0, 1073741824
s_cselect_b32 s30, s30, 0
s_and_b32 s37, s30, 3
s_lshr_b32 s52, s30, 2
s_mul_i32 s30, s37, 165888
s_lshl_b32 s31, s52, 7
s_add_u32 s30, s30, s31
s_mul_i32 s31, s24, 9216
s_add_u32 s30, s30, s31
s_add_u32 s30, s30, s53
v_lshrrev_b32 v36, 7, v1
v_mul_u32_u24 v42, 1152, v36
v_and_b32 v36, 0x70, v1
v_add_u32 v42, v36, v42
s_lshl_b32 s32, s24, 10
s_add_u32 m0, s32, 40960
s_add_u32 s31, s30, 0
buffer_load_dwordx4 v42, s[12:15], s31 offen nt lds
s_add_u32 m0, s32, 45056
s_add_u32 s31, s30, 36864
buffer_load_dwordx4 v42, s[12:15], s31 offen nt lds
s_add_u32 m0, s32, 49152
s_add_u32 s31, s30, 73728
buffer_load_dwordx4 v42, s[12:15], s31 offen nt lds
s_add_u32 m0, s32, 53248
s_add_u32 s31, s30, 110592
buffer_load_dwordx4 v42, s[12:15], s31 offen nt lds
s_add_u32 m0, s32, 57344
s_add_u32 s31, s30, 147456
s_cmp_lt_u32 s24, 2
s_cselect_b32 s31, s31, 1073741824
buffer_load_dwordx4 v42, s[12:15], s31 offen nt lds
s_branch L_p0_j3
L_p0_b3:
s_mov_b32 s12, s78
s_mov_b32 s13, s79
s_mov_b32 s14, 2654208
s_mov_b32 s15, 0x20000
s_sub_u32 s30, s2, 32
s_cmp_lt_u32 s30, 144
s_cselect_b32 s53, 0, 1073741824
s_cselect_b32 s30, s30, 0
s_and_b32 s37, s30, 15
s_lshr_b32 s52, s30, 4
s_mul_i32 s30, s37, 165888
s_lshl_b32 s31, s52, 7
s_add_u32 s30, s30, s31
s_mul_i32 s31, s24, 9216
s_add_u32 s30, s30, s31
s_add_u32 s30, s30, s53
v_lshrrev_b32 v36, 7, v1
v_mul_u32_u24 v42, 1152, v36
v_and_b32 v36, 0x70, v1
v_add_u32 v42, v36, v42
s_lshl_b32 s32, s24, 10
s_add_u32 m0, s32, 40960
s_add_u32 s31, s30, 0
buffer_load_dwordx4 v42, s[12:15], s31 offen nt lds
s_add_u32 m0, s32, 45056
s_add_u32 s31, s30, 36864
buffer_load_dwordx4 v42, s[12:15], s31 offen nt lds
s_add_u32 m0, s32, 49152
s_add_u32 s31, s30, 73728
buffer_load_dwordx4 v42, s[12:15], s31 offen nt lds
s_add_u32 m0, s32, 53248
s_add_u32 s31, s30, 110592
buffer_load_dwordx4 v42, s[12:15], s31 offen nt lds
s_add_u32 m0, s32, 57344
s_add_u32 s31, s30, 147456
s_cmp_lt_u32 s24, 2
s_cselect_b32 s31, s31, 1073741824
buffer_load_dwordx4 v42, s[12:15], s31 offen nt lds
s_branch L_p0_j3
L_p0_a3:
s_mov_b32 s12, s72
s_mov_b32 s13, s73
s_mov_b32 s14, 5308416
s_mov_b32 s15, 0x20000
s_add_u32 s30, s2, 256
s_cmp_lt_u32 s30, 288
s_cselect_b32 s53, 0, 1073741824
s_cselect_b32 s30, s30, 0
s_and_b32 s37, s30, 3
s_lshr_b32 s52, s30, 2
s_mul_i32 s30, s37, 1327104
s_lshl_b32 s31, s52, 7
s_add_u32 s30, s30, s31
s_mul_i32 s31, s24, 73728
s_add_u32 s30, s30, s31
s_add_u32 s30, s30, s53
v_lshrrev_b32 v36, 7, v1
v_mul_u32_u24 v42, 9216, v36
v_and_b32 v36, 0x70, v1
v_add_u32 v42, v36, v42
s_lshl_b32 s32, s24, 10
s_add_u32 m0, s32, 40960
s_add_u32 s31, s30, 0
buffer_load_dwordx4 v42, s[12:15], s31 offen nt lds
s_add_u32 m0, s32, 45056
s_add_u32 s31, s30, 294912
buffer_load_dwordx4 v42, s[12:15], s31 offen nt lds
s_add_u32 m0, s32, 49152
s_add_u32 s31, s30, 589824
buffer_load_dwordx4 v42, s[12:15], s31 offen nt lds
s_add_u32 m0, s32, 53248
s_add_u32 s31, s30, 884736
buffer_load_dwordx4 v42, s[12:15], s31 offen nt lds
s_add_u32 m0, s32, 57344
s_add_u32 s31, s30, 1179648
s_cmp_lt_u32 s24, 2
s_cselect_b32 s31, s31, 1073741824
buffer_load_dwordx4 v42, s[12:15], s31 offen nt lds
L_p0_j3:
s_lshl_b32 s92, s35, 6
s_lshl_b32 s33, s24, 4
s_add_u32 s92, s92, s33
s_cmp_ge_u32 s92, 2304
s_cselect_b32 s93, 1, 0
s_cselect_b32 s33, 2304, 0
s_sub_u32 s92, s92, s33
s_mul_i32 s94, s92, 1821
s_lshr_b32 s94, s94, 19
s_mul_i32 s33, s94, 288
s_sub_u32 s92, s92, s33
s_lshr_b32 s95, s92, 5
s_bfe_u32 s96, s92, 0x10004
s_lshl_b32 s94, s94, 1
s_cmp_ge_u32 s92, 144
s_addc_u32 s94, s94, 0
s_cmp_gt_u32 s95, 4
s_cselect_b32 s33, 5, 0
s_sub_u32 s97, s95, s33
s_cmp_eq_u32 s93, 0
s_cselect_b32 s33, 5, 0
s_add_u32 s97, s97, s33
s_cmp_eq_u32 s95, 4
s_cselect_b32 s97, 4, s97
s_mul_i32 s94, s94, 9
s_add_u32 s94, s94, s97
s_mul_i32 s94, s94, 37888
s_add_u32 s94, s94, 2785280
v_and_b32 v36, 3, v2
v_bfe_u32 v37, v2, 2, 1
v_bfe_u32 v38, v2, 3, 1
s_cmp_eq_u32 s95, 4
s_cbranch_scc1 L_w3m_3
s_cmp_eq_u32 s93, 0
s_cbranch_scc1 L_w3a_4
s_lshl_b32 s33, s96, 4
v_add_u32 v36, s33, v2
s_branch L_w3j_5
L_w3a_4:
v_lshl_add_u32 v36, v37, 4, v36
v_lshl_add_u32 v36, v38, 3, v36
s_lshl_b32 s33, s96, 2
v_add_u32 v36, s33, v36
s_branch L_w3j_5
L_w3m_3:
v_lshl_add_u32 v36, v37, 3, v36
v_lshl_add_u32 v36, v38, 2, v36
s_xor_b32 s33, s93, 1
s_lshl_b32 s33, s33, 4
v_add_u32 v36, s33, v36
L_w3j_5:
v_lshlrev_b32 v36, 4, v36
v_add_u32 v36, s94, v36
s_mul_i32 s31, s34, 9216
v_lshl_add_u32 v43, v3, 9, v36
v_add_u32 v43, s31, v43
s_lshr_b32 s31, s34, 1
s_lshl_b32 s31, s31, 9
s_and_b32 s33, s34, 1
s_lshl_b32 s33, s33, 3
s_add_u32 s31, s31, s33
s_add_u32 s31, s31, 36864
v_add_u32 v44, s31, v36
s_waitcnt vmcnt(6)
s_barrier
ds_read_b64_tr_b16 v[84:85], v45 offset:20480
ds_read_b64_tr_b16 v[86:87], v45 offset:20992
ds_read_b64_tr_b16 v[88:89], v45 offset:24576
ds_read_b64_tr_b16 v[90:91], v45 offset:25088
ds_read_b64_tr_b16 v[92:93], v45 offset:28672
ds_read_b64_tr_b16 v[94:95], v45 offset:29184
ds_read_b64_tr_b16 v[96:97], v45 offset:32768
ds_read_b64_tr_b16 v[98:99], v45 offset:33280
ds_read_b64_tr_b16 v[100:101], v45 offset:36864
ds_read_b64_tr_b16 v[102:103], v45 offset:37376
v_mov_b32 v36, 1073741824
v_mov_b32 v46, 0
v_cndmask_b32 v37, v36, v43, s[50:51]
s_add_u32 s31, s36, 0
s_waitcnt lgkmcnt(8)
buffer_store_dwordx4 v[84:87], v43, s[4:7], s31 offen sc1
s_add_u32 s31, s36, 2048
s_waitcnt lgkmcnt(6)
buffer_store_dwordx4 v[88:91], v43, s[4:7], s31 offen sc1
s_add_u32 s31, s36, 4096
s_waitcnt lgkmcnt(4)
buffer_store_dwordx4 v[92:95], v43, s[4:7], s31 offen sc1
s_add_u32 s31, s36, 6144
s_waitcnt lgkmcnt(2)
buffer_store_dwordx4 v[96:99], v43, s[4:7], s31 offen sc1
s_add_u32 s31, s36, 8192
s_waitcnt lgkmcnt(0)
buffer_store_dwordx4 v[100:103], v37, s[4:7], s31 offen sc1
v_mov_b32 v37, 0x3f803f80
v_dot2c_f32_bf16 v46, v84, v37
v_dot2c_f32_bf16 v46, v85, v37
v_dot2c_f32_bf16 v46, v86, v37
v_dot2c_f32_bf16 v46, v87, v37
v_dot2c_f32_bf16 v46, v88, v37
v_dot2c_f32_bf16 v46, v89, v37
v_dot2c_f32_bf16 v46, v90, v37
v_dot2c_f32_bf16 v46, v91, v37
v_dot2c_f32_bf16 v46, v92, v37
v_dot2c_f32_bf16 v46, v93, v37
v_dot2c_f32_bf16 v46, v94, v37
v_dot2c_f32_bf16 v46, v95, v37
v_dot2c_f32_bf16 v46, v96, v37
v_dot2c_f32_bf16 v46, v97, v37
v_dot2c_f32_bf16 v46, v98, v37
v_dot2c_f32_bf16 v46, v99, v37
v_dot2c_f32_bf16 v46, v100, v37
v_dot2c_f32_bf16 v46, v101, v37
v_dot2c_f32_bf16 v46, v102, v37
v_dot2c_f32_bf16 v46, v103, v37
s_nop 2
v_mov_b32 v37, v46
s_nop 1
v_permlane32_swap_b32 v46, v37
v_add_f32 v46, v46, v37
v_mov_b32 v37, v46
s_nop 1
v_permlane16_swap_b32 v46, v37
v_add_f32 v46, v46, v37
v_cvt_pk_bf16_f32 v50, v46, v46
v_and_b32 v37, 0xffff0000, v50
v_sub_f32 v37, v46, v37
v_cvt_pk_bf16_f32 v51, v37, v37
v_cndmask_b32 v36, v36, v44, s[46:47]
buffer_store_dwordx2 v[50:51], v36, s[4:7], s36 offen sc1
s_cmp_lt_u32 s2, 32
s_cbranch_scc1 L_p0_a4
s_cmp_lt_u32 s2, 176
s_cbranch_scc1 L_p0_b4
v_lshrrev_b32 v39, 2, v2
v_and_b32 v40, 3, v2
v_lshlrev_b32 v40, 3, v40
s_lshl_b32 s31, s24, 5
v_add_u32 v40, s31, v40
v_lshrrev_b32 v47, 1, v39
v_mul_u32_u24 v47, 18, v47
v_and_b32 v41, 1, v39
v_add3_u32 v47, v47, v41, 16
v_add_u32 v36, 0, v3
v_cmp_le_u32 vcc, 9, v36
v_subrev_u32 v37, 9, v36
v_mov_b32 v38, 72
v_cndmask_b32 v36, v36, v37, vcc
v_cndmask_b32 v38, 0, v38, vcc
v_lshrrev_b32 v37, 2, v36
v_mul_u32_u24 v37, 36, v37
v_and_b32 v41, 3, v36
v_lshl_add_u32 v37, v41, 2, v37
v_cmp_eq_u32 vcc, 8, v36
v_add_u32 v37, v37, v39
v_mov_b32 v41, 18
v_cndmask_b32 v37, v37, v47, vcc
v_cndmask_b32 v41, v41, 36, vcc
v_add_u32 v37, v37, v38
v_add_u32 v41, v41, v37
v_min_u32 v37, 159, v37
v_min_u32 v41, 159, v41
v_lshl_add_u32 v52, v37, 7, v40
v_lshl_add_u32 v53, v41, 7, v40
v_add_u32 v36, 4, v3
v_cmp_le_u32 vcc, 9, v36
v_subrev_u32 v37, 9, v36
v_mov_b32 v38, 72
v_cndmask_b32 v36, v36, v37, vcc
v_cndmask_b32 v38, 0, v38, vcc
v_lshrrev_b32 v37, 2, v36
v_mul_u32_u24 v37, 36, v37
v_and_b32 v41, 3, v36
v_lshl_add_u32 v37, v41, 2, v37
v_cmp_eq_u32 vcc, 8, v36
v_add_u32 v37, v37, v39
v_mov_b32 v41, 18
v_cndmask_b32 v37, v37, v47, vcc
v_cndmask_b32 v41, v41, 36, vcc
v_add_u32 v37, v37, v38
v_add_u32 v41, v41, v37
v_min_u32 v37, 159, v37
v_min_u32 v41, 159, v41
v_lshl_add_u32 v54, v37, 7, v40
v_lshl_add_u32 v55, v41, 7, v40
v_add_u32 v36, 8, v3
v_cmp_le_u32 vcc, 9, v36
v_subrev_u32 v37, 9, v36
v_mov_b32 v38, 72
v_cndmask_b32 v36, v36, v37, vcc
v_cndmask_b32 v38, 0, v38, vcc
v_lshrrev_b32 v37, 2, v36
v_mul_u32_u24 v37, 36, v37
v_and_b32 v41, 3, v36
v_lshl_add_u32 v37, v41, 2, v37
v_cmp_eq_u32 vcc, 8, v36
v_add_u32 v37, v37, v39
v_mov_b32 v41, 18
v_cndmask_b32 v37, v37, v47, vcc
v_cndmask_b32 v41, v41, 36, vcc
v_add_u32 v37, v37, v38
v_add_u32 v41, v41, v37
v_min_u32 v37, 159, v37
v_min_u32 v41, 159, v41
v_lshl_add_u32 v56, v37, 7, v40
v_lshl_add_u32 v57, v41, 7, v40
v_add_u32 v36, 12, v3
v_cmp_le_u32 vcc, 9, v36
v_subrev_u32 v37, 9, v36
v_mov_b32 v38, 72
v_cndmask_b32 v36, v36, v37, vcc
v_cndmask_b32 v38, 0, v38, vcc
v_lshrrev_b32 v37, 2, v36
v_mul_u32_u24 v37, 36, v37
v_and_b32 v41, 3, v36
v_lshl_add_u32 v37, v41, 2, v37
v_cmp_eq_u32 vcc, 8, v36
v_add_u32 v37, v37, v39
v_mov_b32 v41, 18
v_cndmask_b32 v37, v37, v47, vcc
v_cndmask_b32 v41, v41, 36, vcc
v_add_u32 v37, v37, v38
v_add_u32 v41, v41, v37
v_min_u32 v37, 159, v37
v_min_u32 v41, 159, v41
v_lshl_add_u32 v58, v37, 7, v40
v_lshl_add_u32 v59, v41, 7, v40
v_add_u32 v36, 16, v3
v_cmp_le_u32 vcc, 9, v36
v_subrev_u32 v37, 9, v36
v_mov_b32 v38, 72
v_cndmask_b32 v36, v36, v37, vcc
v_cndmask_b32 v38, 0, v38, vcc
v_lshrrev_b32 v37, 2, v36
v_mul_u32_u24 v37, 36, v37
v_and_b32 v41, 3, v36
v_lshl_add_u32 v37, v41, 2, v37
v_cmp_eq_u32 vcc, 8, v36
v_add_u32 v37, v37, v39
v_mov_b32 v41, 18
v_cndmask_b32 v37, v37, v47, vcc
v_cndmask_b32 v41, v41, 36, vcc
v_add_u32 v37, v37, v38
v_add_u32 v41, v41, v37
v_min_u32 v37, 159, v37
v_min_u32 v41, 159, v41
v_lshl_add_u32 v60, v37, 7, v40
v_lshl_add_u32 v61, v41, 7, v40
s_lshl_b32 s31, s52, 6
s_lshl_b32 s33, s24, 4
s_add_u32 s31, s31, s33
v_add_u32 v36, s31, v2
v_mul_u32_u24 v37, 911, v36
v_lshrrev_b32 v37, 16, v37
v_mul_u32_u24 v38, 72, v37
v_sub_u32 v36, v36, v38
s_mov_b32 s31, 82944
v_mul_lo_u32 v43, v37, s31
s_mul_i32 s31, s37, 18
v_add_u32 v37, s31, v3
v_and_b32 v38, 3, v37
v_lshrrev_b32 v37, 2, v37
v_mul_u32_u24 v37, 4608, v37
v_add_u32 v43, v43, v37
v_add_u32 v43, 2121728, v43
v_lshrrev_b32 v39, 5, v36
v_lshlrev_b32 v39, 11, v39
v_bfe_u32 v40, v36, 2, 1
v_lshl_add_u32 v39, v40, 10, v39
v_bfe_u32 v40, v36, 3, 2
v_lshl_add_u32 v39, v40, 6, v39
v_and_b32 v40, 3, v36
v_lshl_add_u32 v39, v40, 4, v39
v_lshl_add_u32 v39, v38, 8, v39
v_lshlrev_b32 v40, 4, v36
v_add_u32 v40, 3072, v40
v_lshl_add_u32 v40, v38, 7, v40
v_cmp_gt_u32 vcc, 64, v36
s_nop 1
v_cndmask_b32 v39, v40, v39, vcc
v_add_u32 v43, v43, v39
s_waitcnt vmcnt(6)
s_barrier
ds_read_b64_tr_b16 v[104:105], v52 offset:40960
ds_read_b64_tr_b16 v[106:107], v53 offset:40960
ds_read_b64_tr_b16 v[108:109], v54 offset:40960
ds_read_b64_tr_b16 v[110:111], v55 offset:40960
ds_read_b64_tr_b16 v[112:113], v56 offset:40960
ds_read_b64_tr_b16 v[114:115], v57 offset:40960
ds_read_b64_tr_b16 v[116:117], v58 offset:40960
ds_read_b64_tr_b16 v[118:119], v59 offset:40960
ds_read_b64_tr_b16 v[120:121], v60 offset:40960
ds_read_b64_tr_b16 v[122:123], v61 offset:40960
v_mov_b32 v36, 1073741824
v_mov_b32 v46, 0
v_cndmask_b32 v37, v36, v43, s[50:51]
s_add_u32 s31, s53, 0
s_waitcnt lgkmcnt(8)
buffer_store_dwordx4 v[104:107], v43, s[4:7], s31 offen sc1
s_add_u32 s31, s53, 4608
s_waitcnt lgkmcnt(6)
buffer_store_dwordx4 v[108:111], v43, s[4:7], s31 offen sc1
s_add_u32 s31, s53, 9216
s_waitcnt lgkmcnt(4)
buffer_store_dwordx4 v[112:115], v43, s[4:7], s31 offen sc1
s_add_u32 s31, s53, 13824
s_waitcnt lgkmcnt(2)
buffer_store_dwordx4 v[116:119], v43, s[4:7], s31 offen sc1
s_add_u32 s31, s53, 18432
s_waitcnt lgkmcnt(0)
buffer_store_dwordx4 v[120:123], v37, s[4:7], s31 offen sc1
buffer_store_dwordx2 v[50:51], v36, s[4:7], s53 offen sc1
s_branch L_p0_j4
L_p0_b4:
s_lshl_b32 s31, s52, 6
s_lshl_b32 s33, s24, 4
s_add_u32 s31, s31, s33
v_add_u32 v36, s31, v2
v_mul_u32_u24 v37, 911, v36
v_lshrrev_b32 v37, 16, v37
v_mul_u32_u24 v38, 72, v37
v_sub_u32 v36, v36, v38
s_mov_b32 s31, 331776
v_mul_lo_u32 v43, v37, s31
s_mul_i32 s31, s37, 18
v_add_u32 v37, s31, v3
v_and_b32 v38, 3, v37
v_lshrrev_b32 v37, 2, v37
v_mul_u32_u24 v37, 4608, v37
v_add_u32 v43, v43, v37
v_add_u32 v43, 8241152, v43
v_lshrrev_b32 v39, 5, v36
v_lshlrev_b32 v39, 11, v39
v_bfe_u32 v40, v36, 2, 1
v_lshl_add_u32 v39, v40, 10, v39
v_bfe_u32 v40, v36, 3, 2
v_lshl_add_u32 v39, v40, 6, v39
v_and_b32 v40, 3, v36
v_lshl_add_u32 v39, v40, 4, v39
v_lshl_add_u32 v39, v38, 8, v39
v_lshlrev_b32 v40, 4, v36
v_add_u32 v40, 3072, v40
v_lshl_add_u32 v40, v38, 7, v40
v_cmp_gt_u32 vcc, 64, v36
s_nop 1
v_cndmask_b32 v39, v40, v39, vcc
v_add_u32 v43, v43, v39
s_waitcnt vmcnt(6)
s_barrier
ds_read_b64_tr_b16 v[104:105], v45 offset:40960
ds_read_b64_tr_b16 v[106:107], v45 offset:41472
ds_read_b64_tr_b16 v[108:109], v45 offset:45056
ds_read_b64_tr_b16 v[110:111], v45 offset:45568
ds_read_b64_tr_b16 v[112:113], v45 offset:49152
ds_read_b64_tr_b16 v[114:115], v45 offset:49664
ds_read_b64_tr_b16 v[116:117], v45 offset:53248
ds_read_b64_tr_b16 v[118:119], v45 offset:53760
ds_read_b64_tr_b16 v[120:121], v45 offset:57344
ds_read_b64_tr_b16 v[122:123], v45 offset:57856
v_mov_b32 v36, 1073741824
v_mov_b32 v46, 0
v_cndmask_b32 v37, v36, v43, s[50:51]
s_add_u32 s31, s53, 0
s_waitcnt lgkmcnt(8)
buffer_store_dwordx4 v[104:107], v43, s[4:7], s31 offen sc1
s_add_u32 s31, s53, 4608
s_waitcnt lgkmcnt(6)
buffer_store_dwordx4 v[108:111], v43, s[4:7], s31 offen sc1
s_add_u32 s31, s53, 9216
s_waitcnt lgkmcnt(4)
buffer_store_dwordx4 v[112:115], v43, s[4:7], s31 offen sc1
s_add_u32 s31, s53, 13824
s_waitcnt lgkmcnt(2)
buffer_store_dwordx4 v[116:119], v43, s[4:7], s31 offen sc1
s_add_u32 s31, s53, 18432
s_waitcnt lgkmcnt(0)
buffer_store_dwordx4 v[120:123], v37, s[4:7], s31 offen sc1
buffer_store_dwordx2 v[50:51], v36, s[4:7], s53 offen sc1
s_branch L_p0_j4
L_p0_a4:
s_lshl_b32 s92, s52, 6
s_lshl_b32 s33, s24, 4
s_add_u32 s92, s92, s33
s_cmp_ge_u32 s92, 2304
s_cselect_b32 s93, 1, 0
s_cselect_b32 s33, 2304, 0
s_sub_u32 s92, s92, s33
s_mul_i32 s94, s92, 1821
s_lshr_b32 s94, s94, 19
s_mul_i32 s33, s94, 288
s_sub_u32 s92, s92, s33
s_lshr_b32 s95, s92, 5
s_bfe_u32 s96, s92, 0x10004
s_lshl_b32 s94, s94, 1
s_cmp_ge_u32 s92, 144
s_addc_u32 s94, s94, 0
s_cmp_gt_u32 s95, 4
s_cselect_b32 s33, 5, 0
s_sub_u32 s97, s95, s33
s_cmp_eq_u32 s93, 0
s_cselect_b32 s33, 5, 0
s_add_u32 s97, s97, s33
s_cmp_eq_u32 s95, 4
s_cselect_b32 s97, 4, s97
s_mul_i32 s94, s94, 9
s_add_u32 s94, s94, s97
s_mul_i32 s94, s94, 37888
s_add_u32 s94, s94, 2785280
v_and_b32 v36, 3, v2
v_bfe_u32 v37, v2, 2, 1
v_bfe_u32 v38, v2, 3, 1
s_cmp_eq_u32 s95, 4
s_cbranch_scc1 L_w3m_6
s_cmp_eq_u32 s93, 0
s_cbranch_scc1 L_w3a_7
s_lshl_b32 s33, s96, 4
v_add_u32 v36, s33, v2
s_branch L_w3j_8
L_w3a_7:
v_lshl_add_u32 v36, v37, 4, v36
v_lshl_add_u32 v36, v38, 3, v36
s_lshl_b32 s33, s96, 2
v_add_u32 v36, s33, v36
s_branch L_w3j_8
L_w3m_6:
v_lshl_add_u32 v36, v37, 3, v36
v_lshl_add_u32 v36, v38, 2, v36
s_xor_b32 s33, s93, 1
s_lshl_b32 s33, s33, 4
v_add_u32 v36, s33, v36
L_w3j_8:
v_lshlrev_b32 v36, 4, v36
v_add_u32 v36, s94, v36
s_mul_i32 s31, s37, 9216
v_lshl_add_u32 v43, v3, 9, v36
v_add_u32 v43, s31, v43
s_lshr_b32 s31, s37, 1
s_lshl_b32 s31, s31, 9
s_and_b32 s33, s37, 1
s_lshl_b32 s33, s33, 3
s_add_u32 s31, s31, s33
s_add_u32 s31, s31, 36864
v_add_u32 v44, s31, v36
s_waitcnt vmcnt(6)
s_barrier
ds_read_b64_tr_b16 v[104:105], v45 offset:40960
ds_read_b64_tr_b16 v[106:107], v45 offset:41472
ds_read_b64_tr_b16 v[108:109], v45 offset:45056
ds_read_b64_tr_b16 v[110:111], v45 offset:45568
ds_read_b64_tr_b16 v[112:113], v45 offset:49152
ds_read_b64_tr_b16 v[114:115], v45 offset:49664
ds_read_b64_tr_b16 v[116:117], v45 offset:53248
ds_read_b64_tr_b16 v[118:119], v45 offset:53760
ds_read_b64_tr_b16 v[120:121], v45 offset:57344
ds_read_b64_tr_b16 v[122:123], v45 offset:57856
v_mov_b32 v36, 1073741824
v_mov_b32 v46, 0
v_cndmask_b32 v37, v36, v43, s[50:51]
s_add_u32 s31, s53, 0
s_waitcnt lgkmcnt(8)
buffer_store_dwordx4 v[104:107], v43, s[4:7], s31 offen sc1
s_add_u32 s31, s53, 2048
s_waitcnt lgkmcnt(6)
buffer_store_dwordx4 v[108:111], v43, s[4:7], s31 offen sc1
s_add_u32 s31, s53, 4096
s_waitcnt lgkmcnt(4)
buffer_store_dwordx4 v[112:115], v43, s[4:7], s31 offen sc1
s_add_u32 s31, s53, 6144
s_waitcnt lgkmcnt(2)
buffer_store_dwordx4 v[116:119], v43, s[4:7], s31 offen sc1
s_add_u32 s31, s53, 8192
s_waitcnt lgkmcnt(0)
buffer_store_dwordx4 v[120:123], v37, s[4:7], s31 offen sc1
v_mov_b32 v37, 0x3f803f80
v_dot2c_f32_bf16 v46, v104, v37
v_dot2c_f32_bf16 v46, v105, v37
v_dot2c_f32_bf16 v46, v106, v37
v_dot2c_f32_bf16 v46, v107, v37
v_dot2c_f32_bf16 v46, v108, v37
v_dot2c_f32_bf16 v46, v109, v37
v_dot2c_f32_bf16 v46, v110, v37
v_dot2c_f32_bf16 v46, v111, v37
v_dot2c_f32_bf16 v46, v112, v37
v_dot2c_f32_bf16 v46, v113, v37
v_dot2c_f32_bf16 v46, v114, v37
v_dot2c_f32_bf16 v46, v115, v37
v_dot2c_f32_bf16 v46, v116, v37
v_dot2c_f32_bf16 v46, v117, v37
v_dot2c_f32_bf16 v46, v118, v37
v_dot2c_f32_bf16 v46, v119, v37
v_dot2c_f32_bf16 v46, v120, v37
v_dot2c_f32_bf16 v46, v121, v37
v_dot2c_f32_bf16 v46, v122, v37
v_dot2c_f32_bf16 v46, v123, v37
s_nop 2
v_mov_b32 v37, v46
s_nop 1
v_permlane32_swap_b32 v46, v37
v_add_f32 v46, v46, v37
v_mov_b32 v37, v46
s_nop 1
v_permlane16_swap_b32 v46, v37
v_add_f32 v46, v46, v37
v_cvt_pk_bf16_f32 v50, v46, v46
v_and_b32 v37, 0xffff0000, v50
v_sub_f32 v37, v46, v37
v_cvt_pk_bf16_f32 v51, v37, v37
v_cndmask_b32 v36, v36, v44, s[46:47]
buffer_store_dwordx2 v[50:51], v36, s[4:7], s53 offen sc1
L_p0_j4:
s_mov_b32 s12, s74
s_mov_b32 s13, s75
s_mov_b32 s14, 8388608
s_mov_b32 s15, 0x20000
s_lshl_b32 s30, s25, 2
s_add_u32 s30, s30, s24
s_lshl_b32 s30, s30, 17
s_lshl_b32 s98, s26, 8
s_add_u32 s98, s98, s30
s_lshl_b32 s101, s26, 12
s_add_u32 s101, s101, s30
s_add_u32 s101, s101, 10895360
s_lshl_b32 s63, s24, 13
s_add_u32 s63, s63, 61440
s_mov_b32 m0, s63
v_add_u32 v36, 0, v3
v_xor_b32 v37, v36, v2
v_lshlrev_b32 v36, 12, v36
v_lshl_add_u32 v156, v37, 4, v36
v_lshlrev_b32 v37, 4, v37
v_lshl_add_u32 v37, v2, 8, v37
v_add_u32 v160, s63, v37
v_add_u32 v36, 4, v3
v_xor_b32 v37, v36, v2
v_lshlrev_b32 v36, 12, v36
v_lshl_add_u32 v157, v37, 4, v36
v_lshlrev_b32 v37, 4, v37
v_lshl_add_u32 v37, v2, 8, v37
v_add_u32 v161, s63, v37
v_subrev_u32 v157, 1024, v157
v_add_u32 v36, 8, v3
v_xor_b32 v37, v36, v2
v_lshlrev_b32 v36, 12, v36
v_lshl_add_u32 v158, v37, 4, v36
v_lshlrev_b32 v37, 4, v37
v_lshl_add_u32 v37, v2, 8, v37
v_add_u32 v162, s63, v37
v_subrev_u32 v158, 2048, v158
v_add_u32 v36, 12, v3
v_xor_b32 v37, v36, v2
v_lshlrev_b32 v36, 12, v36
v_lshl_add_u32 v159, v37, 4, v36
v_lshlrev_b32 v37, 4, v37
v_lshl_add_u32 v37, v2, 8, v37
v_add_u32 v163, s63, v37
v_subrev_u32 v159, 3072, v159
buffer_load_dwordx4 v156, s[12:15], s98 offen offset:0 nt lds
buffer_load_dwordx4 v157, s[12:15], s98 offen offset:1024 nt lds
buffer_load_dwordx4 v158, s[12:15], s98 offen offset:2048 nt lds
buffer_load_dwordx4 v159, s[12:15], s98 offen offset:3072 nt lds
s_add_u32 m0, s63, 4096
s_add_u32 s98, s98, 65536
buffer_load_dwordx4 v156, s[12:15], s98 offen offset:0 nt lds
buffer_load_dwordx4 v157, s[12:15], s98 offen offset:1024 nt lds
buffer_load_dwordx4 v158, s[12:15], s98 offen offset:2048 nt lds
buffer_load_dwordx4 v159, s[12:15], s98 offen offset:3072 nt lds
s_cmp_eq_u32 s24, 1
s_cbranch_scc0 L_p0done_10
v_lshrrev_b32 v41, 4, v1
s_lshl_b32 s30, s25, 3
s_sub_u32 s30, s30, 1
v_add_u32 v36, s30, v41
v_max_i32 v36, 0, v36
s_lshl_b32 s30, s27, 2
v_add_u32 v37, s30, v2
v_cndmask_b32 v36, v37, v36, s[46:47]
v_bfe_u32 v37, v41, 2, 1
v_mul_u32_u24 v37, 35, v37
s_mul_i32 s30, s26, 36
v_add_u32 v37, s30, v37
v_lshrrev_b32 v37, 6, v37
v_bfe_u32 v38, v41, 3, 2
v_mad_u32_u24 v37, v38, 9, v37
v_and_b32 v38, 3, v41
v_lshl_add_u32 v37, v37, 2, v38
v_add_u32 v37, 128, v37
v_cndmask_b32 v36, v37, v36, s[50:51]
v_lshlrev_b32 v36, 7, v36
s_mov_b32 s30, 19283968
s_mov_b32 s31, 0
s_mov_b32 exec_lo, 0x000f01ff
s_mov_b32 exec_hi, 0x00ffffff
L_p0poll_9:
buffer_load_dwordx2 v[50:51], v36, s[4:7], s30 offen sc1
s_add_u32 s31, s31, 1
s_waitcnt vmcnt(0)
v_cmp_ne_u64 vcc, v[50:51], v[238:239]
s_cmp_gt_u32 s31, 200000
s_cbranch_scc1 L_p0done_10
s_cbranch_vccnz L_p0poll_9
L_p0done_10:
s_mov_b64 exec, -1
s_barrier
s_lshl_b32 s30, s27, 2
s_add_u32 s30, s30, s24
s_mul_i32 s30, s30, 18432
s_mul_i32 s31, s28, 2304
s_add_u32 s30, s30, s31
s_add_u32 s30, s30, 0
v_and_b32 v6, 1, v3
v_lshlrev_b32 v6, 3, v6
v_lshl_add_u32 v6, v2, 4, v6
buffer_load_dwordx4 v[36:39], v1, s[8:11], s30 offen sc1
buffer_load_dwordx4 v[40:43], v1, s[8:11], s30 offen offset:1024 sc1
buffer_load_dwordx2 v[44:45], v6, s[8:11], s30 offen offset:2048 sc1
s_mul_i32 s36, s26, 132608
s_mul_i32 s38, s24, 12288
s_add_u32 m0, s38, 0
s_add_u32 s39, s38, s36
buffer_load_dwordx4 v1, s[4:7], s39 offen offset:0 sc1 lds
buffer_load_dwordx4 v1, s[4:7], s39 offen offset:1024 sc1 lds
buffer_load_dwordx4 v1, s[4:7], s39 offen offset:2048 sc1 lds
buffer_load_dwordx4 v1, s[4:7], s39 offen offset:3072 sc1 lds
s_add_u32 m0, m0, 4096
s_add_u32 s39, s39, 4096
buffer_load_dwordx4 v1, s[4:7], s39 offen offset:0 sc1 lds
buffer_load_dwordx4 v1, s[4:7], s39 offen offset:1024 sc1 lds
buffer_load_dwordx4 v1, s[4:7], s39 offen offset:2048 sc1 lds
buffer_load_dwordx4 v1, s[4:7], s39 offen offset:3072 sc1 lds
s_add_u32 m0, m0, 4096
s_add_u32 s39, s39, 4096
buffer_load_dwordx4 v1, s[4:7], s39 offen offset:0 sc1 lds
buffer_load_dwordx4 v1, s[4:7], s39 offen offset:1024 sc1 lds
buffer_load_dwordx4 v1, s[4:7], s39 offen offset:2048 sc1 lds
buffer_load_dwordx4 v1, s[4:7], s39 offen offset:3072 sc1 lds
v_and_b32 v6, 1, v2
v_cmp_eq_u32 s[40:41], 1, v6
v_lshl_add_u32 v6, v3, 2, v6
v_cmp_le_u32 s[42:43], v6, v2
v_add_u32 v6, 2, v6
v_cmp_le_u32 s[44:45], v6, v2
v_mov_b32 v6, 0x0c0c0100
v_mov_b32 v7, 0x01000c0c
v_cndmask_b32 v6, v6, v7, s[40:41]
v_mov_b32 v8, 0x0c0c0c0c
v_cndmask_b32 v10, v6, v8, s[42:43]
v_cndmask_b32 v12, v8, v6, s[42:43]
v_mov_b32 v6, 0x0c0c0302
v_mov_b32 v7, 0x03020c0c
v_cndmask_b32 v6, v6, v7, s[40:41]
v_cndmask_b32 v11, v6, v8, s[44:45]
v_cndmask_b32 v13, v8, v6, s[44:45]
s_mul_i32 s82, s26, 340992
s_add_u32 s82, s82, 2785280
s_mul_i32 s83, s28, 331776
s_add_u32 s83, s83, 8241152
s_and_b32 s30, s27, 1
s_mul_i32 s30, s30, 165888
s_add_u32 s83, s83, s30
s_waitcnt vmcnt(12)
v_lshlrev_b32 v16, 16, v36
v_and_b32 v17, 0xffff0000, v36
v_lshlrev_b32 v18, 16, v37
v_and_b32 v19, 0xffff0000, v37
v_lshlrev_b32 v20, 16, v38
v_and_b32 v21, 0xffff0000, v38
v_lshlrev_b32 v22, 16, v39
v_and_b32 v23, 0xffff0000, v39
v_lshlrev_b32 v24, 16, v40
v_and_b32 v25, 0xffff0000, v40
v_lshlrev_b32 v26, 16, v41
v_and_b32 v27, 0xffff0000, v41
v_lshlrev_b32 v28, 16, v42
v_and_b32 v29, 0xffff0000, v42
v_lshlrev_b32 v30, 16, v43
v_and_b32 v31, 0xffff0000, v43
v_lshlrev_b32 v32, 16, v44
v_and_b32 v33, 0xffff0000, v44
v_lshlrev_b32 v34, 16, v45
v_and_b32 v35, 0xffff0000, v45
ds_read_b128 a[232:235], v160 offset:0
ds_read_b128 a[236:239], v161 offset:0
ds_read_b128 a[240:243], v162 offset:0
ds_read_b128 a[244:247], v163 offset:0
ds_read_b128 a[248:251], v160 offset:4096
ds_read_b128 a[252:255], v161 offset:4096
ds_read_b128 v[240:243], v162 offset:4096
ds_read_b128 v[244:247], v163 offset:4096
s_waitcnt lgkmcnt(0)
s_barrier
v_mov_b32 v248, v238
s_mul_i32 s36, s26, 132608
s_mul_i32 s38, s24, 9216
s_add_u32 m0, s38, 49152
s_add_u32 s39, s38, s36
s_add_u32 s39, s39, 49152
buffer_load_dwordx4 v1, s[4:7], s39 offen offset:0 sc1 lds
buffer_load_dwordx4 v1, s[4:7], s39 offen offset:1024 sc1 lds
buffer_load_dwordx4 v1, s[4:7], s39 offen offset:2048 sc1 lds
buffer_load_dwordx4 v1, s[4:7], s39 offen offset:3072 sc1 lds
s_add_u32 m0, m0, 4096
s_add_u32 s39, s39, 4096
buffer_load_dwordx4 v1, s[4:7], s39 offen offset:0 sc1 lds
buffer_load_dwordx4 v1, s[4:7], s39 offen offset:1024 sc1 lds
buffer_load_dwordx4 v1, s[4:7], s39 offen offset:2048 sc1 lds
buffer_load_dwordx4 v1, s[4:7], s39 offen offset:3072 sc1 lds
s_add_u32 m0, m0, 4096
s_add_u32 s39, s39, 4096
buffer_load_dwordx4 v1, s[4:7], s39 offen offset:0 sc1 lds
L_layer:
s_lshl_b32 s60, s25, 3
s_sub_u32 s61, s60, 1
s_max_i32 s61, s61, 0
s_lshl_b32 s30, s24, 1
s_add_u32 s60, s60, s30
s_mul_i32 s30, s61, 18432
s_mul_i32 s38, s24, 5120
s_add_u32 m0, s38, 135168
s_add_u32 s39, s38, s30
buffer_load_dwordx4 v1, s[8:11], s39 offen offset:0 sc1 lds
buffer_load_dwordx4 v1, s[8:11], s39 offen offset:1024 sc1 lds
buffer_load_dwordx4 v1, s[8:11], s39 offen offset:2048 sc1 lds
buffer_load_dwordx4 v1, s[8:11], s39 offen offset:3072 sc1 lds
s_add_u32 m0, m0, 4096
s_add_u32 s39, s39, 4096
buffer_load_dwordx4 v1, s[8:11], s39 offen offset:0 sc1 lds
s_mul_i32 s62, s60, 18432
s_add_u32 s62, s62, 0
v_add_u32 v127, 18432, v1
buffer_load_dwordx4 a[0:3], v1, s[8:11], s62 offen offset:0 sc1
buffer_load_dwordx4 a[4:7], v127, s[8:11], s62 offen offset:0 sc1
buffer_load_dwordx4 a[8:11], v1, s[8:11], s62 offen offset:1024 sc1
buffer_load_dwordx4 a[12:15], v127, s[8:11], s62 offen offset:1024 sc1
buffer_load_dwordx4 a[16:19], v1, s[8:11], s62 offen offset:2048 sc1
buffer_load_dwordx4 a[20:23], v127, s[8:11], s62 offen offset:2048 sc1
buffer_load_dwordx4 a[24:27], v1, s[8:11], s62 offen offset:3072 sc1
buffer_load_dwordx4 a[28:31], v127, s[8:11], s62 offen offset:3072 sc1
s_add_u32 s62, s62, 4096
buffer_load_dwordx4 a[32:35], v1, s[8:11], s62 offen offset:0 sc1
buffer_load_dwordx4 a[36:39], v127, s[8:11], s62 offen offset:0 sc1
buffer_load_dwordx4 a[40:43], v1, s[8:11], s62 offen offset:1024 sc1
buffer_load_dwordx4 a[44:47], v127, s[8:11], s62 offen offset:1024 sc1
s_sub_u32 s30, s60, 2
v_add_u32 v6, s30, v3
v_max_i32 v6, 0, v6
v_mov_b32 v7, s61
v_cndmask_b32 v6, v6, v7, s[46:47]
v_lshl_add_u32 v6, v6, 4, v2
v_lshlrev_b32 v130, 3, v6
s_lshl_b32 s30, s24, 10
v_add_u32 v125, s30, v1
v_add_u32 v126, 135168, v1
v_lshrrev_b32 v128, 1, v1
v_add_u32 v128, 129024, v128
s_lshl_b32 s30, s24, 9
v_add_u32 v129, s30, v128
v_add_u32 v8, 64512, v1
s_waitcnt vmcnt(12)
s_barrier
ds_read_b128 a[144:147], v1 offset:0
ds_read_b128 a[148:151], v1 offset:1024
ds_read_b128 a[152:155], v1 offset:2048
ds_read_b128 a[156:159], v1 offset:3072
ds_read_b128 a[160:163], v1 offset:4096
ds_read_b128 a[164:167], v1 offset:5120
ds_read_b128 a[168:171], v1 offset:6144
ds_read_b128 a[172:175], v125 offset:0
ds_read_b128 a[176:179], v126 offset:0
v_mov_b32 v148, 0
s_mov_b64 exec, 1
buffer_store_dwordx2 v[238:239], v148, s[4:7], s100 offen sc1
s_mov_b64 exec, -1
s_mov_b32 s100, 1073741824
v_lshrrev_b32 v148, 1, v1
s_lshl_b32 s66, s24, 9
s_add_u32 s66, s66, 19316736
s_waitcnt lgkmcnt(0)
s_waitcnt vmcnt(11)
v_mfma_f32_16x16x32_bf16 v[36:39], a[144:147], a[0:3], 0
ds_read_b128 a[180:183], v1 offset:7168
buffer_load_dwordx4 a[48:51], v1, s[8:11], s62 offen offset:2048 sc1
v_mfma_f32_16x16x32_bf16 v[64:67], a[144:147], a[4:7], 0
ds_read_b128 a[184:187], v1 offset:8192
v_mfma_f32_16x16x32_bf16 v[40:43], a[148:151], a[0:3], 0
ds_read_b128 a[188:191], v1 offset:9216
v_mfma_f32_16x16x32_bf16 v[68:71], a[148:151], a[4:7], 0
ds_read_b128 a[192:195], v1 offset:10240
v_mfma_f32_16x16x32_bf16 v[44:47], a[152:155], a[0:3], 0
ds_read_b128 a[196:199], v1 offset:11264
buffer_load_dwordx4 a[52:55], v127, s[8:11], s62 offen offset:2048 sc1
v_mfma_f32_16x16x32_bf16 v[72:75], a[152:155], a[4:7], 0
ds_read_b128 a[200:203], v1 offset:12288
v_mfma_f32_16x16x32_bf16 v[48:51], a[156:159], a[0:3], 0
ds_read_b128 a[204:207], v1 offset:13312
v_mfma_f32_16x16x32_bf16 v[76:79], a[156:159], a[4:7], 0
ds_read_b128 a[208:211], v125 offset:7168
v_mfma_f32_16x16x32_bf16 v[52:55], a[160:163], a[0:3], 0
ds_read_b128 a[212:215], v126 offset:1024
buffer_load_dwordx4 a[56:59], v1, s[8:11], s62 offen offset:3072 sc1
v_mfma_f32_16x16x32_bf16 v[80:83], a[160:163], a[4:7], 0
v_mfma_f32_16x16x32_bf16 v[56:59], a[164:167], a[0:3], 0
v_mfma_f32_16x16x32_bf16 v[84:87], a[164:167], a[4:7], 0
v_mfma_f32_16x16x32_bf16 v[60:63], a[168:171], a[0:3], 0
buffer_load_dwordx4 a[60:63], v127, s[8:11], s62 offen offset:3072 sc1
v_mfma_f32_16x16x32_bf16 v[88:91], a[168:171], a[4:7], 0
s_add_u32 s62, s62, 4096
v_mfma_f32_16x16x32_bf16 v[92:95], a[172:175], a[176:179], 0
v_mfma_f32_16x16x32_bf16 v[96:99], a[160:163], a[176:179], 0
s_waitcnt lgkmcnt(0)
s_waitcnt vmcnt(13)
v_mfma_f32_16x16x32_bf16 v[36:39], a[180:183], a[8:11], v[36:39]
ds_read_b128 a[144:147], v1 offset:14336
v_lshlrev_b32 v124, 2, v2
v_mfma_f32_16x16x32_bf16 v[64:67], a[180:183], a[12:15], v[64:67]
ds_read_b128 a[148:151], v1 offset:15360
v_mfma_f32_16x16x32_bf16 v[40:43], a[184:187], a[8:11], v[40:43]
ds_read_b128 a[152:155], v1 offset:16384
v_and_b32 v6, 1, v2
v_mfma_f32_16x16x32_bf16 v[68:71], a[184:187], a[12:15], v[68:71]
ds_read_b128 a[156:159], v1 offset:17408
v_mfma_f32_16x16x32_bf16 v[44:47], a[188:191], a[8:11], v[44:47]
ds_read_b128 a[160:163], v1 offset:18432
v_mfma_f32_16x16x32_bf16 v[72:75], a[188:191], a[12:15], v[72:75]
ds_read_b128 a[164:167], v1 offset:19456
buffer_load_dwordx4 a[64:67], v1, s[8:11], s62 offen offset:0 sc1
v_mfma_f32_16x16x32_bf16 v[48:51], a[192:195], a[8:11], v[48:51]
ds_read_b128 a[168:171], v1 offset:20480
v_lshl_add_u32 v6, v3, 2, v6
v_mfma_f32_16x16x32_bf16 v[76:79], a[192:195], a[12:15], v[76:79]
ds_read_b128 a[172:175], v125 offset:14336
v_lshlrev_b32 v6, 2, v6
v_mfma_f32_16x16x32_bf16 v[52:55], a[196:199], a[8:11], v[52:55]
ds_read_b128 a[176:179], v126 offset:2048
v_mfma_f32_16x16x32_bf16 v[80:83], a[196:199], a[12:15], v[80:83]
buffer_load_dwordx4 a[68:71], v127, s[8:11], s62 offen offset:0 sc1
v_mfma_f32_16x16x32_bf16 v[56:59], a[200:203], a[8:11], v[56:59]
v_add_u32 v122, 64, v6
v_mfma_f32_16x16x32_bf16 v[84:87], a[200:203], a[12:15], v[84:87]
v_mfma_f32_16x16x32_bf16 v[60:63], a[204:207], a[8:11], v[60:63]
v_mfma_f32_16x16x32_bf16 v[88:91], a[204:207], a[12:15], v[88:91]
v_add_u32 v7, 128, v6
v_mfma_f32_16x16x32_bf16 v[92:95], a[208:211], a[212:215], v[92:95]
buffer_load_dwordx4 a[72:75], v1, s[8:11], s62 offen offset:1024 sc1
v_mfma_f32_16x16x32_bf16 v[96:99], a[196:199], a[212:215], v[96:99]
s_mov_b32 s63, 2359296
s_waitcnt lgkmcnt(0)
s_waitcnt vmcnt(14)
v_mfma_f32_16x16x32_bf16 v[36:39], a[144:147], a[16:19], v[36:39]
ds_read_b128 a[180:183], v1 offset:21504
v_cndmask_b32 v122, v122, v7, s[42:43]
v_mfma_f32_16x16x32_bf16 v[64:67], a[144:147], a[20:23], v[64:67]
ds_read_b128 a[184:187], v1 offset:22528
v_mfma_f32_16x16x32_bf16 v[40:43], a[148:151], a[16:19], v[40:43]
ds_read_b128 a[188:191], v1 offset:23552
v_add_u32 v123, 72, v6
v_mfma_f32_16x16x32_bf16 v[68:71], a[148:151], a[20:23], v[68:71]
ds_read_b128 a[192:195], v1 offset:24576
v_mfma_f32_16x16x32_bf16 v[44:47], a[152:155], a[16:19], v[44:47]
ds_read_b128 a[196:199], v1 offset:25600
v_mfma_f32_16x16x32_bf16 v[72:75], a[152:155], a[20:23], v[72:75]
ds_read_b128 a[200:203], v1 offset:26624
v_add_u32 v7, 136, v6
v_mfma_f32_16x16x32_bf16 v[48:51], a[156:159], a[16:19], v[48:51]
ds_read_b128 a[204:207], v1 offset:27648
buffer_load_dwordx2 v[100:101], v130, s[8:11], s63 offen sc1
v_mfma_f32_16x16x32_bf16 v[76:79], a[156:159], a[20:23], v[76:79]
ds_read_b128 a[208:211], v125 offset:21504
v_cndmask_b32 v123, v123, v7, s[44:45]
v_mfma_f32_16x16x32_bf16 v[52:55], a[160:163], a[16:19], v[52:55]
ds_read_b128 a[212:215], v126 offset:3072
s_mul_i32 s36, s26, 132608
v_mfma_f32_16x16x32_bf16 v[80:83], a[160:163], a[20:23], v[80:83]
s_mov_b32 s63, 2375680
v_mfma_f32_16x16x32_bf16 v[56:59], a[164:167], a[16:19], v[56:59]
s_mul_i32 s38, s24, 12288
s_lshl_b32 s31, s24, 5
v_mfma_f32_16x16x32_bf16 v[84:87], a[164:167], a[20:23], v[84:87]
s_add_u32 m0, s38, 86016
v_mfma_f32_16x16x32_bf16 v[60:63], a[168:171], a[16:19], v[60:63]
s_add_u32 s39, s38, s36
v_add_u32 v6, s31, v2
v_mfma_f32_16x16x32_bf16 v[88:91], a[168:171], a[20:23], v[88:91]
s_add_u32 s39, s39, 86016
v_mfma_f32_16x16x32_bf16 v[92:95], a[172:175], a[176:179], v[92:95]
v_mfma_f32_16x16x32_bf16 v[96:99], a[160:163], a[176:179], v[96:99]
s_waitcnt lgkmcnt(0)
s_waitcnt vmcnt(13)
v_mfma_f32_16x16x32_bf16 v[36:39], a[180:183], a[24:27], v[36:39]
ds_read_b128 a[144:147], v1 offset:28672
buffer_load_dwordx2 v[102:103], v130, s[8:11], s63 offen sc1
v_mfma_f32_16x16x32_bf16 v[64:67], a[180:183], a[28:31], v[64:67]
ds_read_b128 a[148:151], v1 offset:29696
v_mul_u32_u24 v216, 176, v6
v_mfma_f32_16x16x32_bf16 v[40:43], a[184:187], a[24:27], v[40:43]
ds_read_b128 a[152:155], v1 offset:30720
v_add_u32 v216, 135168, v216
v_mfma_f32_16x16x32_bf16 v[68:71], a[184:187], a[28:31], v[68:71]
ds_read_b128 a[156:159], v1 offset:31744
s_mov_b32 s63, 2392064
v_mfma_f32_16x16x32_bf16 v[44:47], a[188:191], a[24:27], v[44:47]
ds_read_b128 a[160:163], v1 offset:32768
v_lshl_add_u32 v214, v3, 3, v216
v_mfma_f32_16x16x32_bf16 v[72:75], a[188:191], a[28:31], v[72:75]
ds_read_b128 a[164:167], v1 offset:33792
v_mfma_f32_16x16x32_bf16 v[48:51], a[192:195], a[24:27], v[48:51]
ds_read_b128 a[168:171], v1 offset:34816
v_mfma_f32_16x16x32_bf16 v[76:79], a[192:195], a[28:31], v[76:79]
ds_read_b128 a[172:175], v125 offset:28672
buffer_load_dwordx2 v[104:105], v130, s[8:11], s63 offen sc1
v_mfma_f32_16x16x32_bf16 v[52:55], a[196:199], a[24:27], v[52:55]
ds_read_b128 a[176:179], v126 offset:4096
v_mul_u32_u24 v215, 176, v2
v_mfma_f32_16x16x32_bf16 v[80:83], a[196:199], a[28:31], v[80:83]
s_mov_b32 s63, 2408448
v_mfma_f32_16x16x32_bf16 v[56:59], a[200:203], a[24:27], v[56:59]
v_lshl_add_u32 v215, v3, 3, v215
v_mfma_f32_16x16x32_bf16 v[84:87], a[200:203], a[28:31], v[84:87]
v_mfma_f32_16x16x32_bf16 v[60:63], a[204:207], a[24:27], v[60:63]
v_add_u32 v215, 135168, v215
v_mfma_f32_16x16x32_bf16 v[88:91], a[204:207], a[28:31], v[88:91]
buffer_load_dwordx4 v1, s[4:7], s39 offen offset:0 sc1 lds
v_mfma_f32_16x16x32_bf16 v[92:95], a[208:211], a[212:215], v[92:95]
v_mfma_f32_16x16x32_bf16 v[96:99], a[196:199], a[212:215], v[96:99]
s_waitcnt lgkmcnt(0)
s_waitcnt vmcnt(14)
v_mfma_f32_16x16x32_bf16 v[36:39], a[144:147], a[32:35], v[36:39]
ds_read_b128 a[180:183], v1 offset:35840
buffer_load_dwordx2 v[106:107], v130, s[8:11], s63 offen sc1
v_mfma_f32_16x16x32_bf16 v[64:67], a[144:147], a[36:39], v[64:67]
ds_read_b128 a[184:187], v1 offset:36864
buffer_load_dwordx4 v1, s[4:7], s39 offen offset:1024 sc1 lds
v_mfma_f32_16x16x32_bf16 v[40:43], a[148:151], a[32:35], v[40:43]
ds_read_b128 a[188:191], v1 offset:37888
v_add_u32 v218, s31, v215
v_mfma_f32_16x16x32_bf16 v[68:71], a[148:151], a[36:39], v[68:71]
ds_read_b128 a[192:195], v1 offset:38912
v_lshrrev_b32 v6, 2, v2
v_mfma_f32_16x16x32_bf16 v[44:47], a[152:155], a[32:35], v[44:47]
ds_read_b128 a[196:199], v1 offset:39936
s_mov_b32 s63, 2424832
v_mfma_f32_16x16x32_bf16 v[72:75], a[152:155], a[36:39], v[72:75]
ds_read_b128 a[200:203], v1 offset:40960
buffer_load_dwordx4 v1, s[4:7], s39 offen offset:2048 sc1 lds
v_mfma_f32_16x16x32_bf16 v[48:51], a[156:159], a[32:35], v[48:51]
ds_read_b128 a[204:207], v1 offset:41984
v_lshl_add_u32 v6, v3, 2, v6
v_mfma_f32_16x16x32_bf16 v[76:79], a[156:159], a[36:39], v[76:79]
ds_read_b128 a[208:211], v125 offset:35840
v_add_u32 v6, s31, v6
v_mfma_f32_16x16x32_bf16 v[52:55], a[160:163], a[32:35], v[52:55]
ds_read_b128 a[212:215], v126 offset:5120
buffer_load_dwordx2 v[108:109], v130, s[8:11], s63 offen sc1
v_mfma_f32_16x16x32_bf16 v[80:83], a[160:163], a[36:39], v[80:83]
buffer_load_dwordx4 v1, s[4:7], s39 offen offset:3072 sc1 lds
v_mul_u32_u24 v217, 176, v6
v_mfma_f32_16x16x32_bf16 v[56:59], a[164:167], a[32:35], v[56:59]
s_mov_b32 s63, 2441216
v_mfma_f32_16x16x32_bf16 v[84:87], a[164:167], a[36:39], v[84:87]
s_add_u32 m0, m0, 4096
v_mfma_f32_16x16x32_bf16 v[60:63], a[168:171], a[32:35], v[60:63]
s_add_u32 s39, s39, 4096
v_and_b32 v6, 3, v2
v_mfma_f32_16x16x32_bf16 v[88:91], a[168:171], a[36:39], v[88:91]
v_mfma_f32_16x16x32_bf16 v[92:95], a[172:175], a[176:179], v[92:95]
v_mfma_f32_16x16x32_bf16 v[96:99], a[160:163], a[176:179], v[96:99]
s_waitcnt lgkmcnt(0)
s_waitcnt vmcnt(17)
v_mfma_f32_16x16x32_bf16 v[36:39], a[180:183], a[40:43], v[36:39]
ds_read_b128 a[144:147], v1 offset:43008
v_lshl_add_u32 v217, v6, 3, v217
v_mfma_f32_16x16x32_bf16 v[64:67], a[180:183], a[44:47], v[64:67]
ds_read_b128 a[148:151], v1 offset:44032
buffer_load_dwordx2 v[110:111], v130, s[8:11], s63 offen sc1
v_mfma_f32_16x16x32_bf16 v[40:43], a[184:187], a[40:43], v[40:43]
ds_read_b128 a[152:155], v1 offset:45056
v_add_u32 v217, 135168, v217
v_mfma_f32_16x16x32_bf16 v[68:71], a[184:187], a[44:47], v[68:71]
ds_read_b128 a[156:159], v1 offset:46080
v_mfma_f32_16x16x32_bf16 v[44:47], a[188:191], a[40:43], v[44:47]
ds_read_b128 a[160:163], v1 offset:47104
v_mov_b32 v173, 0
v_mfma_f32_16x16x32_bf16 v[72:75], a[188:191], a[44:47], v[72:75]
ds_read_b128 a[164:167], v1 offset:48128
s_mov_b32 s63, 2457600
v_mfma_f32_16x16x32_bf16 v[48:51], a[192:195], a[40:43], v[48:51]
ds_read_b128 a[168:171], v1 offset:49152
buffer_load_dwordx4 v1, s[4:7], s39 offen offset:0 sc1 lds
v_mfma_f32_16x16x32_bf16 v[76:79], a[192:195], a[44:47], v[76:79]
ds_read_b128 a[172:175], v125 offset:43008
v_mov_b32 v174, 0
v_mfma_f32_16x16x32_bf16 v[52:55], a[196:199], a[40:43], v[52:55]
ds_read_b128 a[176:179], v126 offset:6144
v_mfma_f32_16x16x32_bf16 v[80:83], a[196:199], a[44:47], v[80:83]
v_mov_b32 v181, 0
v_mfma_f32_16x16x32_bf16 v[56:59], a[200:203], a[40:43], v[56:59]
buffer_load_dwordx2 v[112:113], v130, s[8:11], s63 offen sc1
buffer_load_dwordx4 v1, s[4:7], s39 offen offset:1024 sc1 lds
v_mfma_f32_16x16x32_bf16 v[84:87], a[200:203], a[44:47], v[84:87]
s_mov_b32 s63, 2473984
v_mfma_f32_16x16x32_bf16 v[60:63], a[204:207], a[40:43], v[60:63]
v_mov_b32 v182, 0
v_mfma_f32_16x16x32_bf16 v[88:91], a[204:207], a[44:47], v[88:91]
s_lshr_b32 s30, s26, 1
v_mfma_f32_16x16x32_bf16 v[92:95], a[208:211], a[212:215], v[92:95]
s_mul_i32 s30, s30, 2304
v_mfma_f32_16x16x32_bf16 v[96:99], a[196:199], a[212:215], v[96:99]
s_mul_i32 s64, s60, 18432
s_waitcnt lgkmcnt(0)
s_waitcnt vmcnt(18)
v_mfma_f32_16x16x32_bf16 v[36:39], a[144:147], a[48:51], v[36:39]
ds_read_b128 a[180:183], v1 offset:50176
buffer_load_dwordx4 v1, s[4:7], s39 offen offset:2048 sc1 lds
v_mfma_f32_16x16x32_bf16 v[64:67], a[144:147], a[52:55], v[64:67]
ds_read_b128 a[184:187], v1 offset:51200
v_mfma_f32_16x16x32_bf16 v[40:43], a[148:151], a[48:51], v[40:43]
ds_read_b128 a[188:191], v1 offset:52224
buffer_load_dwordx2 v[114:115], v130, s[8:11], s63 offen sc1
v_mfma_f32_16x16x32_bf16 v[68:71], a[148:151], a[52:55], v[68:71]
ds_read_b128 a[192:195], v1 offset:53248
buffer_load_dwordx4 v1, s[4:7], s39 offen offset:3072 sc1 lds
v_mfma_f32_16x16x32_bf16 v[44:47], a[152:155], a[48:51], v[44:47]
ds_read_b128 a[196:199], v1 offset:54272
v_mfma_f32_16x16x32_bf16 v[72:75], a[152:155], a[52:55], v[72:75]
ds_read_b128 a[200:203], v1 offset:55296
v_mfma_f32_16x16x32_bf16 v[48:51], a[156:159], a[48:51], v[48:51]
ds_read_b128 a[204:207], v1 offset:56320
buffer_load_dwordx4 a[76:79], v127, s[8:11], s62 offen offset:1024 sc1
v_mfma_f32_16x16x32_bf16 v[76:79], a[156:159], a[52:55], v[76:79]
ds_read_b128 a[208:211], v125 offset:50176
s_add_u32 m0, m0, 4096
v_mfma_f32_16x16x32_bf16 v[52:55], a[160:163], a[48:51], v[52:55]
ds_read_b128 a[212:215], v126 offset:7168
s_add_u32 s30, s30, s64
v_mfma_f32_16x16x32_bf16 v[80:83], a[160:163], a[52:55], v[80:83]
s_add_u32 s39, s39, 4096
s_add_u32 s30, s30, 2490368
v_mfma_f32_16x16x32_bf16 v[56:59], a[164:167], a[48:51], v[56:59]
s_and_b32 s65, s26, 1
v_mfma_f32_16x16x32_bf16 v[84:87], a[164:167], a[52:55], v[84:87]
buffer_load_dwordx4 a[80:83], v1, s[8:11], s62 offen offset:2048 sc1
v_mfma_f32_16x16x32_bf16 v[60:63], a[168:171], a[48:51], v[60:63]
s_lshl_b32 s64, s65, 10
v_mfma_f32_16x16x32_bf16 v[88:91], a[168:171], a[52:55], v[88:91]
s_add_u32 s64, s64, s30
v_mfma_f32_16x16x32_bf16 v[92:95], a[172:175], a[176:179], v[92:95]
s_lshl_b32 s65, s65, 3
v_mfma_f32_16x16x32_bf16 v[96:99], a[160:163], a[176:179], v[96:99]
s_add_u32 s65, s65, s30
s_waitcnt lgkmcnt(0)
s_waitcnt vmcnt(21)
v_mfma_f32_16x16x32_bf16 v[36:39], a[180:183], a[56:59], v[36:39]
ds_read_b128 a[144:147], v1 offset:57344
buffer_load_dwordx4 a[84:87], v127, s[8:11], s62 offen offset:2048 sc1
v_mfma_f32_16x16x32_bf16 v[64:67], a[180:183], a[60:63], v[64:67]
ds_read_b128 a[148:151], v1 offset:58368
buffer_load_dwordx4 v1, s[4:7], s39 offen offset:0 sc1 lds
v_mfma_f32_16x16x32_bf16 v[40:43], a[184:187], a[56:59], v[40:43]
ds_read_b128 a[152:155], v1 offset:59392
v_mfma_f32_16x16x32_bf16 v[68:71], a[184:187], a[60:63], v[68:71]
ds_read_b128 a[156:159], v1 offset:60416
buffer_load_dwordx4 a[88:91], v1, s[8:11], s62 offen offset:3072 sc1
v_mfma_f32_16x16x32_bf16 v[44:47], a[188:191], a[56:59], v[44:47]
ds_read_b128 a[160:163], v1 offset:61440
buffer_load_dwordx4 v1, s[4:7], s39 offen offset:1024 sc1 lds
v_mfma_f32_16x16x32_bf16 v[72:75], a[188:191], a[60:63], v[72:75]
ds_read_b128 a[164:167], v1 offset:62464
v_mfma_f32_16x16x32_bf16 v[48:51], a[192:195], a[56:59], v[48:51]
ds_read_b128 a[168:171], v1 offset:63488
v_mfma_f32_16x16x32_bf16 v[76:79], a[192:195], a[60:63], v[76:79]
ds_read_b128 a[172:175], v125 offset:57344
v_mfma_f32_16x16x32_bf16 v[52:55], a[196:199], a[56:59], v[52:55]
ds_read_b128 a[176:179], v126 offset:8192
buffer_load_dwordx4 a[92:95], v127, s[8:11], s62 offen offset:3072 sc1
v_mfma_f32_16x16x32_bf16 v[80:83], a[196:199], a[60:63], v[80:83]
buffer_load_dwordx4 v1, s[4:7], s39 offen offset:2048 sc1 lds
v_mov_b32 v220, 1073741824
v_mfma_f32_16x16x32_bf16 v[56:59], a[200:203], a[56:59], v[56:59]
s_add_u32 s62, s62, 4096
v_mfma_f32_16x16x32_bf16 v[84:87], a[200:203], a[60:63], v[84:87]
v_cndmask_b32 v220, v220, v1, s[46:47]
v_mfma_f32_16x16x32_bf16 v[60:63], a[204:207], a[56:59], v[60:63]
buffer_load_dwordx4 v1, s[4:7], s39 offen offset:3072 sc1 lds
v_mfma_f32_16x16x32_bf16 v[88:91], a[204:207], a[60:63], v[88:91]
v_mfma_f32_16x16x32_bf16 v[92:95], a[208:211], a[212:215], v[92:95]
v_add_u32 v221, 18432, v220
v_mfma_f32_16x16x32_bf16 v[96:99], a[196:199], a[212:215], v[96:99]
s_waitcnt lgkmcnt(0)
s_waitcnt vmcnt(26)
v_add_u32 v125, 64512, v125
v_mfma_f32_16x16x32_bf16 v[36:39], a[144:147], a[64:67], v[36:39]
ds_read_b128 a[180:183], v8 offset:0
buffer_load_dwordx4 a[96:99], v1, s[8:11], s62 offen offset:0 sc1
v_mfma_f32_16x16x32_bf16 v[64:67], a[144:147], a[68:71], v[64:67]
ds_read_b128 a[184:187], v8 offset:1024
v_mfma_f32_16x16x32_bf16 v[40:43], a[148:151], a[64:67], v[40:43]
ds_read_b128 a[188:191], v8 offset:2048
v_mfma_f32_16x16x32_bf16 v[68:71], a[148:151], a[68:71], v[68:71]
ds_read_b128 a[192:195], v8 offset:3072
v_mfma_f32_16x16x32_bf16 v[44:47], a[152:155], a[64:67], v[44:47]
ds_read_b128 a[196:199], v8 offset:4096
buffer_load_dwordx4 a[100:103], v127, s[8:11], s62 offen offset:0 sc1
v_mfma_f32_16x16x32_bf16 v[72:75], a[152:155], a[68:71], v[72:75]
ds_read_b128 a[200:203], v8 offset:5120
v_mfma_f32_16x16x32_bf16 v[48:51], a[156:159], a[64:67], v[48:51]
ds_read_b128 a[204:207], v8 offset:6144
v_mfma_f32_16x16x32_bf16 v[76:79], a[156:159], a[68:71], v[76:79]
ds_read_b128 a[208:211], v125 offset:0
v_mfma_f32_16x16x32_bf16 v[52:55], a[160:163], a[64:67], v[52:55]
ds_read_b128 a[212:215], v126 offset:9216
v_mfma_f32_16x16x32_bf16 v[80:83], a[160:163], a[68:71], v[80:83]
buffer_load_dwordx4 a[104:107], v1, s[8:11], s62 offen offset:1024 sc1
v_mfma_f32_16x16x32_bf16 v[56:59], a[164:167], a[64:67], v[56:59]
v_mfma_f32_16x16x32_bf16 v[84:87], a[164:167], a[68:71], v[84:87]
v_mfma_f32_16x16x32_bf16 v[60:63], a[168:171], a[64:67], v[60:63]
v_mfma_f32_16x16x32_bf16 v[88:91], a[168:171], a[68:71], v[88:91]
buffer_load_dwordx4 a[108:111], v127, s[8:11], s62 offen offset:1024 sc1
v_mfma_f32_16x16x32_bf16 v[92:95], a[172:175], a[176:179], v[92:95]
v_mfma_f32_16x16x32_bf16 v[96:99], a[160:163], a[176:179], v[96:99]
s_waitcnt lgkmcnt(0)
s_waitcnt vmcnt(12)
v_mfma_f32_16x16x32_bf16 v[36:39], a[180:183], a[72:75], v[36:39]
ds_read_b128 a[144:147], v8 offset:7168
v_mfma_f32_16x16x32_bf16 v[64:67], a[180:183], a[76:79], v[64:67]
ds_read_b128 a[148:151], v8 offset:8192
buffer_load_dwordx4 a[112:115], v1, s[8:11], s62 offen offset:2048 sc1
v_mfma_f32_16x16x32_bf16 v[40:43], a[184:187], a[72:75], v[40:43]
ds_read_b128 a[152:155], v8 offset:9216
v_mfma_f32_16x16x32_bf16 v[68:71], a[184:187], a[76:79], v[68:71]
ds_read_b128 a[156:159], v8 offset:10240
v_mfma_f32_16x16x32_bf16 v[44:47], a[188:191], a[72:75], v[44:47]
ds_read_b128 a[160:163], v8 offset:11264
v_mfma_f32_16x16x32_bf16 v[72:75], a[188:191], a[76:79], v[72:75]
ds_read_b128 a[164:167], v8 offset:12288
v_mfma_f32_16x16x32_bf16 v[48:51], a[192:195], a[72:75], v[48:51]
ds_read_b128 a[168:171], v8 offset:13312
buffer_load_dwordx4 a[116:119], v127, s[8:11], s62 offen offset:2048 sc1
v_mfma_f32_16x16x32_bf16 v[76:79], a[192:195], a[76:79], v[76:79]
ds_read_b128 a[172:175], v125 offset:7168
v_mfma_f32_16x16x32_bf16 v[52:55], a[196:199], a[72:75], v[52:55]
ds_read_b128 a[176:179], v126 offset:10240
v_mfma_f32_16x16x32_bf16 v[80:83], a[196:199], a[76:79], v[80:83]
v_mfma_f32_16x16x32_bf16 v[56:59], a[200:203], a[72:75], v[56:59]
buffer_load_dwordx4 a[120:123], v1, s[8:11], s62 offen offset:3072 sc1
v_mfma_f32_16x16x32_bf16 v[84:87], a[200:203], a[76:79], v[84:87]
v_mfma_f32_16x16x32_bf16 v[60:63], a[204:207], a[72:75], v[60:63]
v_mfma_f32_16x16x32_bf16 v[88:91], a[204:207], a[76:79], v[88:91]
v_mfma_f32_16x16x32_bf16 v[92:95], a[208:211], a[212:215], v[92:95]
buffer_load_dwordx4 a[124:127], v127, s[8:11], s62 offen offset:3072 sc1
v_mfma_f32_16x16x32_bf16 v[96:99], a[196:199], a[212:215], v[96:99]
s_add_u32 s62, s62, 4096
s_waitcnt lgkmcnt(0)
s_waitcnt vmcnt(14)
v_mfma_f32_16x16x32_bf16 v[36:39], a[144:147], a[80:83], v[36:39]
ds_read_b128 a[180:183], v8 offset:14336
v_mfma_f32_16x16x32_bf16 v[64:67], a[144:147], a[84:87], v[64:67]
ds_read_b128 a[184:187], v8 offset:15360
v_mfma_f32_16x16x32_bf16 v[40:43], a[148:151], a[80:83], v[40:43]
ds_read_b128 a[188:191], v8 offset:16384
v_mfma_f32_16x16x32_bf16 v[68:71], a[148:151], a[84:87], v[68:71]
ds_read_b128 a[192:195], v8 offset:17408
v_mfma_f32_16x16x32_bf16 v[44:47], a[152:155], a[80:83], v[44:47]
ds_read_b128 a[196:199], v8 offset:18432
v_mfma_f32_16x16x32_bf16 v[72:75], a[152:155], a[84:87], v[72:75]
ds_read_b128 a[200:203], v8 offset:19456
v_mfma_f32_16x16x32_bf16 v[48:51], a[156:159], a[80:83], v[48:51]
ds_read_b128 a[204:207], v8 offset:20480
v_mfma_f32_16x16x32_bf16 v[76:79], a[156:159], a[84:87], v[76:79]
ds_read_b128 a[208:211], v125 offset:14336
buffer_load_dwordx4 a[128:131], v1, s[8:11], s62 offen offset:0 sc1
v_mfma_f32_16x16x32_bf16 v[52:55], a[160:163], a[80:83], v[52:55]
ds_read_b128 a[212:215], v126 offset:11264
v_mfma_f32_16x16x32_bf16 v[80:83], a[160:163], a[84:87], v[80:83]
v_mfma_f32_16x16x32_bf16 v[56:59], a[164:167], a[80:83], v[56:59]
v_mfma_f32_16x16x32_bf16 v[84:87], a[164:167], a[84:87], v[84:87]
buffer_load_dwordx4 a[132:135], v127, s[8:11], s62 offen offset:0 sc1
v_mfma_f32_16x16x32_bf16 v[60:63], a[168:171], a[80:83], v[60:63]
v_mfma_f32_16x16x32_bf16 v[88:91], a[168:171], a[84:87], v[88:91]
v_mfma_f32_16x16x32_bf16 v[92:95], a[172:175], a[176:179], v[92:95]
v_mfma_f32_16x16x32_bf16 v[96:99], a[160:163], a[176:179], v[96:99]
s_waitcnt lgkmcnt(0)
s_waitcnt vmcnt(12)
s_waitcnt vmcnt(10)
s_barrier
v_mfma_f32_16x16x32_bf16 v[36:39], a[180:183], a[88:91], v[36:39]
ds_read_b128 a[144:147], v8 offset:21504
buffer_load_dwordx4 a[136:139], v1, s[8:11], s62 offen offset:1024 sc1
v_mfma_f32_16x16x32_bf16 v[64:67], a[180:183], a[92:95], v[64:67]
ds_read_b128 a[148:151], v8 offset:22528
v_mfma_f32_16x16x32_bf16 v[40:43], a[184:187], a[88:91], v[40:43]
ds_read_b128 a[152:155], v8 offset:23552
v_mfma_f32_16x16x32_bf16 v[68:71], a[184:187], a[92:95], v[68:71]
ds_read_b128 a[156:159], v8 offset:24576
v_mfma_f32_16x16x32_bf16 v[44:47], a[188:191], a[88:91], v[44:47]
ds_read_b128 a[160:163], v8 offset:25600
buffer_load_dwordx4 a[140:143], v127, s[8:11], s62 offen offset:1024 sc1
v_mfma_f32_16x16x32_bf16 v[72:75], a[188:191], a[92:95], v[72:75]
ds_read_b128 a[164:167], v8 offset:26624
v_mfma_f32_16x16x32_bf16 v[48:51], a[192:195], a[88:91], v[48:51]
ds_read_b128 a[168:171], v8 offset:27648
v_mfma_f32_16x16x32_bf16 v[76:79], a[192:195], a[92:95], v[76:79]
ds_read_b128 a[172:175], v125 offset:21504
v_mfma_f32_16x16x32_bf16 v[52:55], a[196:199], a[88:91], v[52:55]
ds_read_b128 a[176:179], v126 offset:12288
s_mov_b32 s37, L_c2-L_pc
v_mfma_f32_16x16x32_bf16 v[80:83], a[196:199], a[92:95], v[80:83]
v_mfma_f32_16x16x32_bf16 v[56:59], a[200:203], a[88:91], v[56:59]
v_mfma_f32_16x16x32_bf16 v[84:87], a[200:203], a[92:95], v[84:87]
v_mfma_f32_16x16x32_bf16 v[60:63], a[204:207], a[88:91], v[60:63]
buffer_load_dword v15, v14, s[88:91], s37 offen
v_mfma_f32_16x16x32_bf16 v[88:91], a[204:207], a[92:95], v[88:91]
v_mfma_f32_16x16x32_bf16 v[92:95], a[208:211], a[212:215], v[92:95]
v_mfma_f32_16x16x32_bf16 v[96:99], a[196:199], a[212:215], v[96:99]
s_waitcnt lgkmcnt(0)
s_waitcnt vmcnt(11)
v_mfma_f32_16x16x32_bf16 v[36:39], a[144:147], a[96:99], v[36:39]
ds_read_b128 a[180:183], v8 offset:28672
v_mfma_f32_16x16x32_bf16 v[64:67], a[144:147], a[100:103], v[64:67]
ds_read_b128 a[184:187], v8 offset:29696
buffer_load_dwordx2 v[150:151], v148, s[4:7], s66 offen sc1
v_mfma_f32_16x16x32_bf16 v[40:43], a[148:151], a[96:99], v[40:43]
ds_read_b128 a[188:191], v8 offset:30720
v_mfma_f32_16x16x32_bf16 v[68:71], a[148:151], a[100:103], v[68:71]
ds_read_b128 a[192:195], v8 offset:31744
v_mfma_f32_16x16x32_bf16 v[44:47], a[152:155], a[96:99], v[44:47]
ds_read_b128 a[196:199], v8 offset:32768
v_mfma_f32_16x16x32_bf16 v[72:75], a[152:155], a[100:103], v[72:75]
ds_read_b128 a[200:203], v8 offset:33792
v_mfma_f32_16x16x32_bf16 v[48:51], a[156:159], a[96:99], v[48:51]
ds_read_b128 a[204:207], v8 offset:34816
buffer_store_dwordx4 a[232:235], v1, s[4:7], s101 offen offset:0 sc1
v_mfma_f32_16x16x32_bf16 v[76:79], a[156:159], a[100:103], v[76:79]
ds_read_b128 a[208:211], v125 offset:28672
v_mfma_f32_16x16x32_bf16 v[52:55], a[160:163], a[96:99], v[52:55]
ds_read_b128 a[212:215], v126 offset:13312
v_mfma_f32_16x16x32_bf16 v[80:83], a[160:163], a[100:103], v[80:83]
v_mfma_f32_16x16x32_bf16 v[56:59], a[164:167], a[96:99], v[56:59]
v_mfma_f32_16x16x32_bf16 v[84:87], a[164:167], a[100:103], v[84:87]
v_mfma_f32_16x16x32_bf16 v[60:63], a[168:171], a[96:99], v[60:63]
v_mfma_f32_16x16x32_bf16 v[88:91], a[168:171], a[100:103], v[88:91]
v_mfma_f32_16x16x32_bf16 v[92:95], a[172:175], a[176:179], v[92:95]
v_mfma_f32_16x16x32_bf16 v[96:99], a[160:163], a[176:179], v[96:99]
s_waitcnt lgkmcnt(0)
s_waitcnt vmcnt(11)
v_mfma_f32_16x16x32_bf16 v[36:39], a[180:183], a[104:107], v[36:39]
ds_read_b128 a[144:147], v8 offset:35840
v_mfma_f32_16x16x32_bf16 v[64:67], a[180:183], a[108:111], v[64:67]
ds_read_b128 a[148:151], v8 offset:36864
buffer_store_dwordx4 a[236:239], v1, s[4:7], s101 offen offset:1024 sc1
v_mfma_f32_16x16x32_bf16 v[40:43], a[184:187], a[104:107], v[40:43]
ds_read_b128 a[152:155], v8 offset:37888
v_add_f32 v131, v100, v102
v_mfma_f32_16x16x32_bf16 v[68:71], a[184:187], a[108:111], v[68:71]
ds_read_b128 a[156:159], v8 offset:38912
v_add_f32 v132, v101, v103
v_mfma_f32_16x16x32_bf16 v[44:47], a[188:191], a[104:107], v[44:47]
ds_read_b128 a[160:163], v8 offset:39936
v_add_f32 v131, v131, v104
v_mfma_f32_16x16x32_bf16 v[72:75], a[188:191], a[108:111], v[72:75]
ds_read_b128 a[164:167], v8 offset:40960
v_add_f32 v132, v132, v105
v_mfma_f32_16x16x32_bf16 v[48:51], a[192:195], a[104:107], v[48:51]
ds_read_b128 a[168:171], v8 offset:41984
v_add_f32 v131, v131, v106
v_mfma_f32_16x16x32_bf16 v[76:79], a[192:195], a[108:111], v[76:79]
ds_read_b128 a[172:175], v125 offset:35840
v_add_f32 v132, v132, v107
v_mfma_f32_16x16x32_bf16 v[52:55], a[196:199], a[104:107], v[52:55]
ds_read_b128 a[176:179], v126 offset:14336
v_add_f32 v131, v131, v108
v_mfma_f32_16x16x32_bf16 v[80:83], a[196:199], a[108:111], v[80:83]
v_add_f32 v132, v132, v109
v_mfma_f32_16x16x32_bf16 v[56:59], a[200:203], a[104:107], v[56:59]
v_add_f32 v131, v131, v110
v_mfma_f32_16x16x32_bf16 v[84:87], a[200:203], a[108:111], v[84:87]
v_add_f32 v132, v132, v111
v_mfma_f32_16x16x32_bf16 v[60:63], a[204:207], a[104:107], v[60:63]
v_add_f32 v131, v131, v112
v_mfma_f32_16x16x32_bf16 v[88:91], a[204:207], a[108:111], v[88:91]
buffer_store_dwordx4 a[240:243], v1, s[4:7], s101 offen offset:2048 sc1
v_add_f32 v132, v132, v113
v_mfma_f32_16x16x32_bf16 v[92:95], a[208:211], a[212:215], v[92:95]
v_add_f32 v131, v131, v114
v_mfma_f32_16x16x32_bf16 v[96:99], a[196:199], a[212:215], v[96:99]
s_waitcnt lgkmcnt(0)
s_waitcnt vmcnt(11)
v_mfma_f32_16x16x32_bf16 v[36:39], a[144:147], a[112:115], v[36:39]
ds_read_b128 a[180:183], v8 offset:43008
v_add_f32 v132, v132, v115
v_mfma_f32_16x16x32_bf16 v[64:67], a[144:147], a[116:119], v[64:67]
ds_read_b128 a[184:187], v8 offset:44032
v_mul_f32 v131, 0x3ae38e39, v131
v_mfma_f32_16x16x32_bf16 v[40:43], a[148:151], a[112:115], v[40:43]
ds_read_b128 a[188:191], v8 offset:45056
v_mul_f32 v6, v131, v131
v_mfma_f32_16x16x32_bf16 v[68:71], a[148:151], a[116:119], v[68:71]
ds_read_b128 a[192:195], v8 offset:46080
v_mul_f32 v132, 0x3ae38e39, v132
v_mfma_f32_16x16x32_bf16 v[44:47], a[152:155], a[112:115], v[44:47]
ds_read_b128 a[196:199], v8 offset:47104
v_sub_f32 v132, v132, v6
v_mfma_f32_16x16x32_bf16 v[72:75], a[152:155], a[116:119], v[72:75]
ds_read_b128 a[200:203], v8 offset:48128
v_max_f32 v132, 0, v132
v_mfma_f32_16x16x32_bf16 v[48:51], a[156:159], a[112:115], v[48:51]
ds_read_b128 a[204:207], v8 offset:49152
v_add_f32 v132, 0x3727c5ac, v132
v_mfma_f32_16x16x32_bf16 v[76:79], a[156:159], a[116:119], v[76:79]
ds_read_b128 a[208:211], v125 offset:43008
v_mfma_f32_16x16x32_bf16 v[52:55], a[160:163], a[112:115], v[52:55]
ds_read_b128 a[212:215], v126 offset:15360
v_mfma_f32_16x16x32_bf16 v[80:83], a[160:163], a[116:119], v[80:83]
buffer_store_dwordx4 a[244:247], v1, s[4:7], s101 offen offset:3072 sc1
v_mfma_f32_16x16x32_bf16 v[56:59], a[164:167], a[112:115], v[56:59]
v_rsq_f32 v133, v132
v_mfma_f32_16x16x32_bf16 v[84:87], a[164:167], a[116:119], v[84:87]
v_cvt_pk_bf16_f32 v6, -v131, -v131
v_and_b32 v6, 0xffff0000, v6
v_mfma_f32_16x16x32_bf16 v[60:63], a[168:171], a[112:115], v[60:63]
v_add_f32 v6, v131, v6
v_cvt_pk_bf16_f32 v134, -v131, -v6
v_mfma_f32_16x16x32_bf16 v[88:91], a[168:171], a[116:119], v[88:91]
v_mfma_f32_16x16x32_bf16 v[92:95], a[172:175], a[176:179], v[92:95]
v_mfma_f32_16x16x32_bf16 v[96:99], a[160:163], a[176:179], v[96:99]
s_waitcnt lgkmcnt(0)
s_waitcnt vmcnt(10)
v_mfma_f32_16x16x32_bf16 v[36:39], a[180:183], a[120:123], v[36:39]
ds_read_b128 a[144:147], v8 offset:50176
v_mfma_f32_16x16x32_bf16 v[64:67], a[180:183], a[124:127], v[64:67]
ds_read_b128 a[148:151], v8 offset:51200
v_mfma_f32_16x16x32_bf16 v[40:43], a[184:187], a[120:123], v[40:43]
ds_read_b128 a[152:155], v8 offset:52224
v_mfma_f32_16x16x32_bf16 v[68:71], a[184:187], a[124:127], v[68:71]
ds_read_b128 a[156:159], v8 offset:53248
v_mfma_f32_16x16x32_bf16 v[44:47], a[188:191], a[120:123], v[44:47]
ds_read_b128 a[160:163], v8 offset:54272
buffer_store_dwordx4 a[248:251], v9, s[4:7], s101 offen offset:0 sc1
v_mfma_f32_16x16x32_bf16 v[72:75], a[188:191], a[124:127], v[72:75]
ds_read_b128 a[164:167], v8 offset:55296
v_mfma_f32_16x16x32_bf16 v[48:51], a[192:195], a[120:123], v[48:51]
ds_read_b128 a[168:171], v8 offset:56320
v_mfma_f32_16x16x32_bf16 v[76:79], a[192:195], a[124:127], v[76:79]
ds_read_b128 a[172:175], v125 offset:50176
v_mfma_f32_16x16x32_bf16 v[52:55], a[196:199], a[120:123], v[52:55]
ds_read_b128 a[176:179], v126 offset:16384
v_mfma_f32_16x16x32_bf16 v[80:83], a[196:199], a[124:127], v[80:83]
ds_bpermute_b32 v116, v124, v134 offset:128
v_mfma_f32_16x16x32_bf16 v[56:59], a[200:203], a[120:123], v[56:59]
ds_bpermute_b32 v118, v124, v134 offset:192
v_mfma_f32_16x16x32_bf16 v[84:87], a[200:203], a[124:127], v[84:87]
ds_bpermute_b32 v120, v124, v134
v_mfma_f32_16x16x32_bf16 v[60:63], a[204:207], a[120:123], v[60:63]
ds_bpermute_b32 v136, v124, v133 offset:128
v_mfma_f32_16x16x32_bf16 v[88:91], a[204:207], a[124:127], v[88:91]
ds_bpermute_b32 v137, v124, v133 offset:192
v_mfma_f32_16x16x32_bf16 v[92:95], a[208:211], a[212:215], v[92:95]
v_mfma_f32_16x16x32_bf16 v[96:99], a[196:199], a[212:215], v[96:99]
s_waitcnt lgkmcnt(0)
s_waitcnt vmcnt(9)
v_mfma_f32_16x16x32_bf16 v[36:39], a[144:147], a[128:131], v[36:39]
ds_read_b128 a[180:183], v8 offset:57344
buffer_store_dwordx4 a[252:255], v9, s[4:7], s101 offen offset:1024 sc1
v_mfma_f32_16x16x32_bf16 v[64:67], a[144:147], a[132:135], v[64:67]
ds_read_b128 a[184:187], v8 offset:58368
v_mfma_f32_16x16x32_bf16 v[40:43], a[148:151], a[128:131], v[40:43]
ds_read_b128 a[188:191], v8 offset:59392
v_mfma_f32_16x16x32_bf16 v[68:71], a[148:151], a[132:135], v[68:71]
ds_read_b128 a[192:195], v8 offset:60416
v_mfma_f32_16x16x32_bf16 v[44:47], a[152:155], a[128:131], v[44:47]
ds_read_b128 a[196:199], v8 offset:61440
v_mfma_f32_16x16x32_bf16 v[72:75], a[152:155], a[132:135], v[72:75]
ds_read_b128 a[200:203], v8 offset:62464
v_mfma_f32_16x16x32_bf16 v[48:51], a[156:159], a[128:131], v[48:51]
ds_read_b128 a[204:207], v8 offset:63488
v_mfma_f32_16x16x32_bf16 v[76:79], a[156:159], a[132:135], v[76:79]
ds_read_b128 a[208:211], v125 offset:57344
v_mfma_f32_16x16x32_bf16 v[52:55], a[160:163], a[128:131], v[52:55]
ds_read_b128 a[212:215], v126 offset:17408
v_mfma_f32_16x16x32_bf16 v[80:83], a[160:163], a[132:135], v[80:83]
ds_bpermute_b32 v138, v122, v133 offset:0
v_mfma_f32_16x16x32_bf16 v[56:59], a[164:167], a[128:131], v[56:59]
ds_bpermute_b32 v139, v123, v133 offset:0
v_mfma_f32_16x16x32_bf16 v[84:87], a[164:167], a[132:135], v[84:87]
ds_bpermute_b32 v140, v122, v133 offset:64
v_mfma_f32_16x16x32_bf16 v[60:63], a[168:171], a[128:131], v[60:63]
ds_bpermute_b32 v141, v123, v133 offset:64
buffer_store_dwordx4 v[240:243], v9, s[4:7], s101 offen offset:2048 sc1
v_mfma_f32_16x16x32_bf16 v[88:91], a[168:171], a[132:135], v[88:91]
v_mfma_f32_16x16x32_bf16 v[92:95], a[172:175], a[176:179], v[92:95]
v_mfma_f32_16x16x32_bf16 v[96:99], a[160:163], a[176:179], v[96:99]
s_waitcnt lgkmcnt(0)
s_waitcnt vmcnt(9)
v_mfma_f32_16x16x32_bf16 v[36:39], a[180:183], a[136:139], v[36:39]
ds_read_b64 a[216:217], v128 offset:0
v_mov_b32 v117, v116
v_mfma_f32_16x16x32_bf16 v[64:67], a[180:183], a[140:143], v[64:67]
ds_read_b64 a[218:219], v128 offset:512
v_mov_b32 v119, v118
v_mfma_f32_16x16x32_bf16 v[40:43], a[184:187], a[136:139], v[40:43]
ds_read_b64 a[220:221], v128 offset:1024
v_mov_b32 v121, v120
v_mfma_f32_16x16x32_bf16 v[68:71], a[184:187], a[140:143], v[68:71]
ds_read_b64 a[222:223], v128 offset:1536
v_mul_f32 v136, 0x3eae1a93, v136
v_mfma_f32_16x16x32_bf16 v[44:47], a[188:191], a[136:139], v[44:47]
ds_read_b64 a[224:225], v128 offset:2048
v_mul_f32 v137, 0x3eae1a93, v137
v_mfma_f32_16x16x32_bf16 v[72:75], a[188:191], a[140:143], v[72:75]
ds_read_b64 a[226:227], v128 offset:2560
v_mul_f32 v142, v136, v138
v_mfma_f32_16x16x32_bf16 v[48:51], a[192:195], a[136:139], v[48:51]
ds_read_b64 a[228:229], v128 offset:3072
v_mul_f32 v143, v136, v139
v_mfma_f32_16x16x32_bf16 v[76:79], a[192:195], a[140:143], v[76:79]
ds_read_b64 a[230:231], v129
buffer_store_dwordx4 v[244:247], v9, s[4:7], s101 offen offset:3072 sc1
v_mfma_f32_16x16x32_bf16 v[52:55], a[196:199], a[136:139], v[52:55]
s_mov_b32 s101, 1073741824
v_mul_f32 v144, v137, v140
v_mul_f32 v145, v137, v141
v_mfma_f32_16x16x32_bf16 v[80:83], a[196:199], a[140:143], v[80:83]
s_cmp_eq_u32 s60, 0
s_cselect_b32 s30, 0xf149f2ca, 0
v_mfma_f32_16x16x32_bf16 v[56:59], a[200:203], a[136:139], v[56:59]
v_mov_b32 v6, s30
v_mfma_f32_16x16x32_bf16 v[84:87], a[200:203], a[140:143], v[84:87]
v_cndmask_b32 v146, v6, 0, s[42:43]
v_mfma_f32_16x16x32_bf16 v[60:63], a[204:207], a[136:139], v[60:63]
v_cndmask_b32 v147, v6, 0, s[44:45]
v_mfma_f32_16x16x32_bf16 v[88:91], a[204:207], a[140:143], v[88:91]
v_mfma_f32_16x16x32_bf16 v[92:95], a[208:211], a[212:215], v[92:95]
v_mfma_f32_16x16x32_bf16 v[96:99], a[196:199], a[212:215], v[96:99]
s_waitcnt lgkmcnt(0)
v_mfma_f32_16x16x16_bf16 v[36:39], a[216:217], v[116:117], v[36:39]
v_mfma_f32_16x16x16_bf16 v[64:67], a[216:217], v[118:119], v[64:67]
v_mfma_f32_16x16x16_bf16 v[40:43], a[218:219], v[116:117], v[40:43]
v_mfma_f32_16x16x16_bf16 v[68:71], a[218:219], v[118:119], v[68:71]
v_mfma_f32_16x16x16_bf16 v[44:47], a[220:221], v[116:117], v[44:47]
v_mfma_f32_16x16x16_bf16 v[72:75], a[220:221], v[118:119], v[72:75]
v_mfma_f32_16x16x16_bf16 v[48:51], a[222:223], v[116:117], v[48:51]
v_mfma_f32_16x16x16_bf16 v[76:79], a[222:223], v[118:119], v[76:79]
v_mfma_f32_16x16x16_bf16 v[52:55], a[224:225], v[116:117], v[52:55]
v_mfma_f32_16x16x16_bf16 v[80:83], a[224:225], v[118:119], v[80:83]
v_mfma_f32_16x16x16_bf16 v[56:59], a[226:227], v[116:117], v[56:59]
v_mfma_f32_16x16x16_bf16 v[84:87], a[226:227], v[118:119], v[84:87]
v_mfma_f32_16x16x16_bf16 v[60:63], a[228:229], v[116:117], v[60:63]
v_mfma_f32_16x16x16_bf16 v[88:91], a[228:229], v[118:119], v[88:91]
v_mfma_f32_16x16x16_bf16 v[92:95], a[230:231], v[120:121], v[92:95]
v_mfma_f32_16x16x16_bf16 v[96:99], a[224:225], v[120:121], v[96:99]
s_waitcnt vmcnt(8)
v_cmp_ne_u64 vcc, v[150:151], v[238:239]
s_mov_b32 s31, 0
s_cmp_eq_u32 s29, 0
s_cbranch_scc0 L_dbback_12
s_cbranch_vccnz L_dbslow_11
L_dbback_12:
s_barrier
v_cvt_pk_bf16_f32 v158, v36, v37
v_cvt_pk_bf16_f32 v159, v38, v39
ds_write_b64 v214, v[158:159] offset:2816
v_cvt_pk_bf16_f32 v162, v40, v41
v_cvt_pk_bf16_f32 v163, v42, v43
ds_write_b64 v214, v[162:163] offset:2848
s_mul_i32 s36, s28, 82944
v_cvt_pk_bf16_f32 v204, v44, v45
v_cvt_pk_bf16_f32 v205, v46, v47
ds_write_b64 v214, v[204:205] offset:2880
v_cvt_pk_bf16_f32 v206, v48, v49
v_cvt_pk_bf16_f32 v207, v50, v51
ds_write_b64 v214, v[206:207] offset:2912
s_mul_i32 s38, s24, 21504
v_cvt_pk_bf16_f32 v208, v52, v53
v_cvt_pk_bf16_f32 v209, v54, v55
ds_write_b64 v214, v[208:209] offset:2944
v_cndmask_b32 v172, 0, v208, s[48:49]
v_cndmask_b32 v175, 0, v209, s[48:49]
s_add_u32 m0, s38, 0
v_cvt_pk_bf16_f32 v164, v64, v65
v_cvt_pk_bf16_f32 v165, v66, v67
ds_write_b64 v214, v[164:165] offset:5632
v_cvt_pk_bf16_f32 v168, v68, v69
v_cvt_pk_bf16_f32 v169, v70, v71
ds_write_b64 v214, v[168:169] offset:5664
s_add_u32 s39, s38, s36
v_cvt_pk_bf16_f32 v204, v72, v73
v_cvt_pk_bf16_f32 v205, v74, v75
ds_write_b64 v214, v[204:205] offset:5696
v_cvt_pk_bf16_f32 v206, v76, v77
v_cvt_pk_bf16_f32 v207, v78, v79
s_add_u32 s39, s39, 2121728
ds_write_b64 v214, v[206:207] offset:5728
v_cvt_pk_bf16_f32 v208, v80, v81
v_cvt_pk_bf16_f32 v209, v82, v83
ds_write_b64 v214, v[208:209] offset:5760
v_cndmask_b32 v180, 0, v208, s[48:49]
v_cndmask_b32 v183, 0, v209, s[48:49]
buffer_load_dwordx4 v1, s[4:7], s39 offen offset:0 sc1 lds
v_cvt_pk_bf16_f32 v210, v92, v93
v_cvt_pk_bf16_f32 v211, v94, v95
ds_write_b64 v218, v[210:211]
v_cvt_pk_bf16_f32 v212, v96, v97
v_cvt_pk_bf16_f32 v213, v98, v99
buffer_load_dwordx4 v1, s[4:7], s39 offen offset:1024 sc1 lds
ds_write_b64 v215, v[212:213] offset:128
v_cvt_pk_bf16_f32 v170, v56, v57
v_cvt_pk_bf16_f32 v171, v58, v59
v_cvt_pk_bf16_f32 v176, v60, v61
v_cvt_pk_bf16_f32 v177, v62, v63
v_cvt_pk_bf16_f32 v178, v84, v85
buffer_load_dwordx4 v1, s[4:7], s39 offen offset:2048 sc1 lds
v_cvt_pk_bf16_f32 v179, v86, v87
v_cvt_pk_bf16_f32 v184, v88, v89
v_cvt_pk_bf16_f32 v185, v90, v91
s_waitcnt lgkmcnt(0)
s_barrier
buffer_load_dwordx4 v1, s[4:7], s39 offen offset:3072 sc1 lds
ds_read_b64 v[152:153], v214
ds_read_b64 v[156:157], v214 offset:32
ds_read_b64 v[154:155], v216 offset:136
ds_read_b64 v[160:161], v216 offset:2952
ds_read_b64 v[166:167], v216 offset:5768
ds_read_b64_tr_b16 v[186:187], v217 offset:64
s_add_u32 m0, m0, 4096
ds_read_b64_tr_b16 v[188:189], v217 offset:2880
ds_read_b64_tr_b16 v[190:191], v217 offset:5696
ds_read_b64_tr_b16 v[192:193], v217 offset:96
ds_read_b64_tr_b16 v[194:195], v217 offset:2912
ds_read_b64_tr_b16 v[196:197], v217 offset:5728
ds_read_b64_tr_b16 v[198:199], v217 offset:128
s_add_u32 s39, s39, 4096
ds_read_b64_tr_b16 v[200:201], v217 offset:2944
ds_read_b64_tr_b16 v[202:203], v217 offset:5760
s_waitcnt lgkmcnt(9)
v_mfma_f32_16x16x32_bf16 v[36:39], v[152:155], v[170:173], 0
v_mfma_f32_16x16x32_bf16 v[40:43], v[158:161], v[170:173], 0
buffer_load_dwordx4 v1, s[4:7], s39 offen offset:0 sc1 lds
v_mfma_f32_16x16x32_bf16 v[44:47], v[154:157], v[174:177], 0
v_mfma_f32_16x16x32_bf16 v[48:51], v[160:163], v[174:177], 0
v_mfma_f32_16x16x32_bf16 v[52:55], v[158:161], v[178:181], 0
v_mfma_f32_16x16x32_bf16 v[56:59], v[164:167], v[178:181], 0
v_mfma_f32_16x16x32_bf16 v[60:63], v[160:163], v[182:185], 0
v_mfma_f32_16x16x32_bf16 v[64:67], v[166:169], v[182:185], 0
buffer_load_dwordx4 v1, s[4:7], s39 offen offset:1024 sc1 lds
s_nop 1
v_cndmask_b32 v36, v36, v37, s[40:41]
v_cndmask_b32 v40, v40, v41, s[40:41]
v_cndmask_b32 v36, v36, v40, s[42:43]
v_fma_f32 v68, v36, v142, v146
buffer_load_dwordx4 v1, s[4:7], s39 offen offset:2048 sc1 lds
v_cndmask_b32 v38, v38, v39, s[40:41]
v_cndmask_b32 v42, v42, v43, s[40:41]
v_cndmask_b32 v38, v38, v42, s[44:45]
v_fma_f32 v69, v38, v143, v147
v_max_f32 v76, v68, v69
v_cndmask_b32 v44, v44, v45, s[40:41]
buffer_load_dwordx4 v1, s[4:7], s39 offen offset:3072 sc1 lds
v_cndmask_b32 v48, v48, v49, s[40:41]
v_cndmask_b32 v44, v44, v48, s[42:43]
v_fma_f32 v70, v44, v142, v146
v_cndmask_b32 v46, v46, v47, s[40:41]
v_cndmask_b32 v50, v50, v51, s[40:41]
s_add_u32 m0, m0, 4096
v_cndmask_b32 v46, v46, v50, s[44:45]
v_fma_f32 v71, v46, v143, v147
v_max_f32 v77, v70, v71
v_cndmask_b32 v52, v52, v53, s[40:41]
v_cndmask_b32 v56, v56, v57, s[40:41]
v_cndmask_b32 v52, v52, v56, s[42:43]
s_add_u32 s39, s39, 4096
v_mul_f32 v72, v52, v144
v_cndmask_b32 v54, v54, v55, s[40:41]
v_cndmask_b32 v58, v58, v59, s[40:41]
v_cndmask_b32 v54, v54, v58, s[44:45]
v_mul_f32 v73, v54, v145
buffer_load_dwordx4 v1, s[4:7], s39 offen offset:0 sc1 lds
v_max_f32 v78, v72, v73
v_cndmask_b32 v60, v60, v61, s[40:41]
v_cndmask_b32 v64, v64, v65, s[40:41]
v_cndmask_b32 v60, v60, v64, s[42:43]
v_mul_f32 v74, v60, v144
v_cndmask_b32 v62, v62, v63, s[40:41]
buffer_load_dwordx4 v1, s[4:7], s39 offen offset:1024 sc1 lds
v_cndmask_b32 v66, v66, v67, s[40:41]
v_cndmask_b32 v62, v62, v66, s[44:45]
v_mul_f32 v75, v62, v145
v_max_f32 v79, v74, v75
s_nop 1
v_permlane32_swap_b32 v76, v77
buffer_load_dwordx4 v1, s[4:7], s39 offen offset:2048 sc1 lds
v_permlane32_swap_b32 v78, v79
v_max_f32 v76, v76, v77
v_max_f32 v78, v78, v79
s_nop 1
v_permlane16_swap_b32 v76, v78
buffer_load_dwordx4 v1, s[4:7], s39 offen offset:3072 sc1 lds
v_max_f32 v76, v76, v78
v_mov_b32 v78, v76
s_nop 1
v_permlane16_swap_b32 v76, v78
v_mov_b32 v77, v76
v_mov_b32 v79, v78
s_add_u32 m0, m0, 4096
s_nop 0
v_permlane32_swap_b32 v76, v77
v_permlane32_swap_b32 v78, v79
v_sub_f32 v68, v68, v76
v_sub_f32 v69, v69, v76
s_add_u32 s39, s39, 4096
v_sub_f32 v70, v70, v77
v_sub_f32 v71, v71, v77
v_sub_f32 v72, v72, v78
v_sub_f32 v73, v73, v78
v_sub_f32 v74, v74, v79
v_sub_f32 v75, v75, v79
buffer_load_dwordx4 v1, s[4:7], s39 offen offset:0 sc1 lds
v_exp_f32 v68, v68
v_exp_f32 v69, v69
v_exp_f32 v70, v70
v_exp_f32 v71, v71
v_exp_f32 v72, v72
buffer_load_dwordx4 v1, s[4:7], s39 offen offset:1024 sc1 lds
v_exp_f32 v73, v73
v_exp_f32 v74, v74
v_exp_f32 v75, v75
v_add_f32 v76, v68, v69
v_add_f32 v77, v70, v71
v_add_f32 v78, v72, v73
buffer_load_dwordx4 v1, s[4:7], s39 offen offset:2048 sc1 lds
v_add_f32 v79, v74, v75
v_mul_f32 v68, v68, v138
v_mul_f32 v69, v69, v139
v_mul_f32 v70, v70, v138
v_mul_f32 v71, v71, v139
buffer_load_dwordx4 v1, s[4:7], s39 offen offset:3072 sc1 lds
v_mul_f32 v72, v72, v140
v_mul_f32 v73, v73, v141
v_mul_f32 v74, v74, v140
v_mul_f32 v75, v75, v141
s_nop 1
v_permlane32_swap_b32 v76, v77
s_add_u32 m0, m0, 4096
v_permlane32_swap_b32 v78, v79
v_add_f32 v76, v76, v77
v_add_f32 v78, v78, v79
s_nop 1
v_permlane16_swap_b32 v76, v78
v_add_f32 v76, v76, v78
s_add_u32 s39, s39, 4096
v_rcp_f32 v76, v76
s_nop 0
v_mov_b32 v78, v76
s_nop 1
v_permlane16_swap_b32 v76, v78
buffer_load_dwordx4 v1, s[4:7], s39 offen offset:0 sc1 lds
v_mov_b32 v77, v76
v_mov_b32 v79, v78
s_nop 0
v_permlane32_swap_b32 v76, v77
v_permlane32_swap_b32 v78, v79
v_mul_f32 v68, v68, v76
buffer_load_dwordx4 v1, s[4:7], s39 offen offset:1024 sc1 lds
v_mul_f32 v69, v69, v76
v_mul_f32 v70, v70, v77
v_mul_f32 v71, v71, v77
v_mul_f32 v72, v72, v78
v_mul_f32 v73, v73, v78
buffer_load_dwordx4 v1, s[4:7], s39 offen offset:2048 sc1 lds
v_mul_f32 v74, v74, v79
v_mul_f32 v75, v75, v79
v_cvt_pk_bf16_f32 v68, v68, v69
v_perm_b32 v84, v68, v68, v10
v_perm_b32 v85, v68, v68, v11
v_perm_b32 v86, v68, v68, v12
buffer_load_dwordx4 v1, s[4:7], s39 offen offset:3072 sc1 lds
v_perm_b32 v87, v68, v68, v13
v_cvt_pk_bf16_f32 v70, v70, v71
v_perm_b32 v88, v70, v70, v10
v_perm_b32 v89, v70, v70, v11
v_perm_b32 v90, v70, v70, v12
s_add_u32 m0, m0, 4096
v_perm_b32 v91, v70, v70, v13
v_cvt_pk_bf16_f32 v72, v72, v73
v_perm_b32 v92, v72, v72, v10
v_perm_b32 v93, v72, v72, v11
v_perm_b32 v94, v72, v72, v12
v_perm_b32 v95, v72, v72, v13
s_add_u32 s39, s39, 4096
v_cvt_pk_bf16_f32 v74, v74, v75
v_perm_b32 v96, v74, v74, v10
v_perm_b32 v97, v74, v74, v11
v_perm_b32 v98, v74, v74, v12
v_perm_b32 v99, v74, v74, v13
buffer_load_dwordx4 v1, s[4:7], s39 offen offset:0 sc1 lds
s_waitcnt lgkmcnt(0)
v_mfma_f32_16x16x32_bf16 v[36:39], v[186:189], v[84:87], 0
v_mfma_f32_16x16x32_bf16 v[40:43], v[198:201], v[84:87], 0
v_mfma_f32_16x16x32_bf16 v[44:47], v[192:195], v[88:91], 0
v_mfma_f32_16x16x32_bf16 v[48:51], v[198:201], v[88:91], 0
v_mfma_f32_16x16x32_bf16 v[52:55], v[188:191], v[92:95], 0
v_mfma_f32_16x16x32_bf16 v[56:59], v[200:203], v[92:95], 0
v_mfma_f32_16x16x32_bf16 v[60:63], v[194:197], v[96:99], 0
v_mfma_f32_16x16x32_bf16 v[64:67], v[200:203], v[96:99], 0
s_nop 3
v_cvt_pk_bf16_f32 v170, v36, v37
v_cvt_pk_bf16_f32 v171, v38, v39
v_cvt_pk_bf16_f32 v172, v44, v45
v_cvt_pk_bf16_f32 v173, v46, v47
v_cvt_pk_bf16_f32 v174, v40, v41
v_cvt_pk_bf16_f32 v175, v50, v51
buffer_store_dwordx4 v[170:173], v1, s[8:11], s64 offen sc1
buffer_store_dwordx2 v[174:175], v220, s[8:11], s65 offen offset:2048 sc1
v_cvt_pk_bf16_f32 v178, v52, v53
v_cvt_pk_bf16_f32 v179, v54, v55
v_cvt_pk_bf16_f32 v180, v60, v61
v_cvt_pk_bf16_f32 v181, v62, v63
v_cvt_pk_bf16_f32 v182, v56, v57
v_cvt_pk_bf16_f32 v183, v66, v67
buffer_store_dwordx4 v[178:181], v127, s[8:11], s64 offen sc1
buffer_store_dwordx2 v[182:183], v221, s[8:11], s65 offen offset:2048 sc1
L_c2:
s_mul_i32 s38, s24, 9216
s_add_u32 m0, s38, 86016
s_add_u32 s39, s38, s82
buffer_load_dwordx4 v1, s[4:7], s39 offen offset:0 sc1 lds
buffer_load_dwordx4 v1, s[4:7], s39 offen offset:1024 sc1 lds
buffer_load_dwordx4 v1, s[4:7], s39 offen offset:2048 sc1 lds
buffer_load_dwordx4 v1, s[4:7], s39 offen offset:3072 sc1 lds
s_add_u32 m0, m0, 4096
s_add_u32 s39, s39, 4096
buffer_load_dwordx4 v1, s[4:7], s39 offen offset:0 sc1 lds
buffer_load_dwordx4 v1, s[4:7], s39 offen offset:1024 sc1 lds
buffer_load_dwordx4 v1, s[4:7], s39 offen offset:2048 sc1 lds
buffer_load_dwordx4 v1, s[4:7], s39 offen offset:3072 sc1 lds
s_add_u32 m0, m0, 4096
s_add_u32 s39, s39, 4096
buffer_load_dwordx4 v1, s[4:7], s39 offen offset:0 sc1 lds
s_lshl_b32 s38, s24, 8
s_add_u32 m0, s38, 122880
s_add_u32 s39, s38, s82
s_add_u32 s39, s39, 36864
s_mov_b64 exec, 0xffff
buffer_load_dwordx4 v1, s[4:7], s39 offen sc1 lds
s_mov_b64 exec, -1
s_waitcnt vmcnt(10)
s_barrier
s_cmp_eq_u32 s24, 0
s_cbranch_scc0 L_sig_13
v_lshlrev_b32 v6, 3, v1
s_lshl_b32 s31, s25, 11
v_add_u32 v6, s31, v6
s_mov_b64 exec, 0xffff
s_mov_b32 s30, 26476544
buffer_atomic_add v4, v6, s[8:11], s30 offen sc1
s_mov_b64 exec, -1
L_sig_13:
s_mul_i32 s38, s24, 9216
s_add_u32 m0, s38, 123904
s_add_u32 s39, s38, s82
s_add_u32 s39, s39, 37888
buffer_load_dwordx4 v1, s[4:7], s39 offen offset:0 sc1 lds
buffer_load_dwordx4 v1, s[4:7], s39 offen offset:1024 sc1 lds
buffer_load_dwordx4 v1, s[4:7], s39 offen offset:2048 sc1 lds
buffer_load_dwordx4 v1, s[4:7], s39 offen offset:3072 sc1 lds
s_add_u32 m0, m0, 4096
s_add_u32 s39, s39, 4096
buffer_load_dwordx4 v1, s[4:7], s39 offen offset:0 sc1 lds
buffer_load_dwordx4 v1, s[4:7], s39 offen offset:1024 sc1 lds
buffer_load_dwordx4 v1, s[4:7], s39 offen offset:2048 sc1 lds
buffer_load_dwordx4 v1, s[4:7], s39 offen offset:3072 sc1 lds
s_add_u32 m0, m0, 4096
s_add_u32 s39, s39, 4096
buffer_load_dwordx4 v1, s[4:7], s39 offen offset:0 sc1 lds
s_lshl_b32 s38, s24, 8
s_add_u32 m0, s38, 160768
s_add_u32 s39, s38, s82
s_add_u32 s39, s39, 74752
s_mov_b64 exec, 0xffff
buffer_load_dwordx4 v1, s[4:7], s39 offen sc1 lds
s_mov_b64 exec, -1
s_cmp_eq_u32 s24, 1
s_cbranch_scc0 L_other_16
s_lshl_b32 s30, s81, 7
s_add_u32 s30, s30, 26476544
v_mov_b32 v6, 0
s_mov_b32 s31, 0
s_mov_b64 exec, 1
v_mov_b32 v249, 0
buffer_atomic_add v249, v6, s[8:11], s30 offen sc0 sc1
s_sleep 3
v_mov_b32 v250, 0
buffer_atomic_add v250, v6, s[8:11], s30 offen sc0 sc1
s_sleep 3
v_mov_b32 v251, 0
buffer_atomic_add v251, v6, s[8:11], s30 offen sc0 sc1
s_sleep 3
L_poll_14:
s_add_u32 s31, s31, 1
s_cmp_gt_u32 s31, 100000
s_cbranch_scc1 L_polled_15
v_mov_b32 v252, 0
buffer_atomic_add v252, v6, s[8:11], s30 offen sc0 sc1
s_waitcnt vmcnt(3)
v_cmp_gt_u32 vcc, 16, v249
s_nop 0
s_cbranch_vccz L_polled_15
v_mov_b32 v249, 0
buffer_atomic_add v249, v6, s[8:11], s30 offen sc0 sc1
s_waitcnt vmcnt(3)
v_cmp_gt_u32 vcc, 16, v250
s_nop 0
s_cbranch_vccz L_polled_15
v_mov_b32 v250, 0
buffer_atomic_add v250, v6, s[8:11], s30 offen sc0 sc1
s_waitcnt vmcnt(3)
v_cmp_gt_u32 vcc, 16, v251
s_nop 0
s_cbranch_vccz L_polled_15
v_mov_b32 v251, 0
buffer_atomic_add v251, v6, s[8:11], s30 offen sc0 sc1
s_waitcnt vmcnt(3)
v_cmp_gt_u32 vcc, 16, v252
s_nop 0
s_cbranch_vccz L_polled_15
s_branch L_poll_14
L_polled_15:
s_mov_b64 exec, -1
s_branch L_join_17
L_other_16:
s_waitcnt vmcnt(0)
L_join_17:
s_barrier
s_lshl_b32 s60, s27, 2
s_add_u32 s60, s60, s24
s_mul_i32 s60, s60, 18432
s_add_u32 s60, s60, 2490368
buffer_load_dwordx4 a[0:3], v1, s[8:11], s60 offen offset:0 sc1
buffer_load_dwordx4 a[4:7], v1, s[8:11], s60 offen offset:1024 sc1
buffer_load_dwordx4 a[8:11], v1, s[8:11], s60 offen offset:2048 sc1
buffer_load_dwordx4 a[12:15], v1, s[8:11], s60 offen offset:3072 sc1
s_add_u32 s60, s60, 4096
buffer_load_dwordx4 a[16:19], v1, s[8:11], s60 offen offset:0 sc1
buffer_load_dwordx4 a[20:23], v1, s[8:11], s60 offen offset:1024 sc1
buffer_load_dwordx4 a[24:27], v1, s[8:11], s60 offen offset:2048 sc1
buffer_load_dwordx4 a[28:31], v1, s[8:11], s60 offen offset:3072 sc1
s_add_u32 s60, s60, 4096
buffer_load_dwordx4 a[32:35], v1, s[8:11], s60 offen offset:0 sc1
v_and_b32 v36, 7, v2
v_lshlrev_b32 v36, 4, v36
v_lshl_add_u32 v36, v3, 7, v36
v_add_u32 v36, 4096, v36
v_add_u32 v37, 41472, v1
v_add_u32 v38, 41472, v36
ds_read_b128 a[72:75], v1 offset:0
ds_read_b128 a[76:79], v1 offset:1024
ds_read_b128 a[80:83], v1 offset:2048
ds_read_b128 a[84:87], v1 offset:3072
ds_read_b128 a[88:91], v36 offset:0
ds_read_b128 a[92:95], v1 offset:4608
ds_read_b128 a[96:99], v1 offset:5632
ds_read_b128 a[100:103], v1 offset:6656
ds_read_b128 a[104:107], v1 offset:7680
ds_read_b128 a[108:111], v36 offset:4608
s_waitcnt vmcnt(8)
s_waitcnt lgkmcnt(5)
v_mfma_f32_16x16x32_bf16 v[16:19], a[72:75], a[0:3], v[16:19]
ds_read_b128 a[112:115], v1 offset:9216
buffer_load_dwordx4 a[36:39], v1, s[8:11], s60 offen offset:1024 sc1
v_mfma_f32_16x16x32_bf16 v[20:23], a[76:79], a[0:3], v[20:23]
ds_read_b128 a[116:119], v1 offset:10240
v_mfma_f32_16x16x32_bf16 v[24:27], a[80:83], a[0:3], v[24:27]
ds_read_b128 a[120:123], v1 offset:11264
v_mfma_f32_16x16x32_bf16 v[28:31], a[84:87], a[0:3], v[28:31]
ds_read_b128 a[124:127], v1 offset:12288
v_mfma_f32_16x16x32_bf16 v[32:35], a[88:91], a[0:3], v[32:35]
ds_read_b128 a[128:131], v36 offset:9216
s_waitcnt vmcnt(8)
s_waitcnt lgkmcnt(5)
v_mfma_f32_16x16x32_bf16 v[16:19], a[92:95], a[4:7], v[16:19]
ds_read_b128 a[72:75], v1 offset:13824
buffer_load_dwordx4 a[40:43], v1, s[8:11], s60 offen offset:2048 sc1
v_mfma_f32_16x16x32_bf16 v[20:23], a[96:99], a[4:7], v[20:23]
ds_read_b128 a[76:79], v1 offset:14848
v_mfma_f32_16x16x32_bf16 v[24:27], a[100:103], a[4:7], v[24:27]
ds_read_b128 a[80:83], v1 offset:15872
v_mfma_f32_16x16x32_bf16 v[28:31], a[104:107], a[4:7], v[28:31]
ds_read_b128 a[84:87], v1 offset:16896
v_mfma_f32_16x16x32_bf16 v[32:35], a[108:111], a[4:7], v[32:35]
ds_read_b128 a[88:91], v36 offset:13824
s_waitcnt vmcnt(8)
s_waitcnt lgkmcnt(5)
v_mfma_f32_16x16x32_bf16 v[16:19], a[112:115], a[8:11], v[16:19]
ds_read_b128 a[92:95], v1 offset:18432
buffer_load_dwordx4 a[44:47], v1, s[8:11], s60 offen offset:3072 sc1
v_mfma_f32_16x16x32_bf16 v[20:23], a[116:119], a[8:11], v[20:23]
ds_read_b128 a[96:99], v1 offset:19456
v_mfma_f32_16x16x32_bf16 v[24:27], a[120:123], a[8:11], v[24:27]
ds_read_b128 a[100:103], v1 offset:20480
v_mfma_f32_16x16x32_bf16 v[28:31], a[124:127], a[8:11], v[28:31]
ds_read_b128 a[104:107], v1 offset:21504
v_mfma_f32_16x16x32_bf16 v[32:35], a[128:131], a[8:11], v[32:35]
ds_read_b128 a[108:111], v36 offset:18432
s_waitcnt vmcnt(8)
s_waitcnt lgkmcnt(5)
v_mfma_f32_16x16x32_bf16 v[16:19], a[72:75], a[12:15], v[16:19]
ds_read_b128 a[112:115], v1 offset:23040
s_add_u32 s60, s60, 4096
buffer_load_dwordx4 a[48:51], v1, s[8:11], s60 offen offset:0 sc1
v_mfma_f32_16x16x32_bf16 v[20:23], a[76:79], a[12:15], v[20:23]
ds_read_b128 a[116:119], v1 offset:24064
v_mfma_f32_16x16x32_bf16 v[24:27], a[80:83], a[12:15], v[24:27]
ds_read_b128 a[120:123], v1 offset:25088
v_mfma_f32_16x16x32_bf16 v[28:31], a[84:87], a[12:15], v[28:31]
ds_read_b128 a[124:127], v1 offset:26112
v_mfma_f32_16x16x32_bf16 v[32:35], a[88:91], a[12:15], v[32:35]
ds_read_b128 a[128:131], v36 offset:23040
s_waitcnt vmcnt(8)
s_waitcnt lgkmcnt(5)
v_mfma_f32_16x16x32_bf16 v[16:19], a[92:95], a[16:19], v[16:19]
ds_read_b128 a[72:75], v1 offset:27648
buffer_load_dwordx4 a[52:55], v1, s[8:11], s60 offen offset:1024 sc1
v_mfma_f32_16x16x32_bf16 v[20:23], a[96:99], a[16:19], v[20:23]
ds_read_b128 a[76:79], v1 offset:28672
v_mfma_f32_16x16x32_bf16 v[24:27], a[100:103], a[16:19], v[24:27]
ds_read_b128 a[80:83], v1 offset:29696
v_mfma_f32_16x16x32_bf16 v[28:31], a[104:107], a[16:19], v[28:31]
ds_read_b128 a[84:87], v1 offset:30720
v_mfma_f32_16x16x32_bf16 v[32:35], a[108:111], a[16:19], v[32:35]
ds_read_b128 a[88:91], v36 offset:27648
s_waitcnt vmcnt(8)
s_waitcnt lgkmcnt(5)
v_mfma_f32_16x16x32_bf16 v[16:19], a[112:115], a[20:23], v[16:19]
ds_read_b128 a[92:95], v1 offset:32256
buffer_load_dwordx4 a[56:59], v1, s[8:11], s60 offen offset:2048 sc1
v_mfma_f32_16x16x32_bf16 v[20:23], a[116:119], a[20:23], v[20:23]
ds_read_b128 a[96:99], v1 offset:33280
v_mfma_f32_16x16x32_bf16 v[24:27], a[120:123], a[20:23], v[24:27]
ds_read_b128 a[100:103], v1 offset:34304
v_mfma_f32_16x16x32_bf16 v[28:31], a[124:127], a[20:23], v[28:31]
ds_read_b128 a[104:107], v1 offset:35328
v_mfma_f32_16x16x32_bf16 v[32:35], a[128:131], a[20:23], v[32:35]
ds_read_b128 a[108:111], v36 offset:32256
s_waitcnt vmcnt(8)
s_waitcnt lgkmcnt(5)
v_mfma_f32_16x16x32_bf16 v[16:19], a[72:75], a[24:27], v[16:19]
ds_read_b128 a[112:115], v1 offset:36864
buffer_load_dwordx4 a[60:63], v1, s[8:11], s60 offen offset:3072 sc1
v_mfma_f32_16x16x32_bf16 v[20:23], a[76:79], a[24:27], v[20:23]
ds_read_b128 a[116:119], v1 offset:37888
v_mfma_f32_16x16x32_bf16 v[24:27], a[80:83], a[24:27], v[24:27]
ds_read_b128 a[120:123], v1 offset:38912
v_mfma_f32_16x16x32_bf16 v[28:31], a[84:87], a[24:27], v[28:31]
ds_read_b128 a[124:127], v1 offset:39936
v_mfma_f32_16x16x32_bf16 v[32:35], a[88:91], a[24:27], v[32:35]
ds_read_b128 a[128:131], v36 offset:36864
s_waitcnt vmcnt(8)
s_waitcnt lgkmcnt(5)
v_mfma_f32_16x16x32_bf16 v[16:19], a[92:95], a[28:31], v[16:19]
ds_read_b128 a[72:75], v37 offset:0
s_add_u32 s60, s60, 4096
buffer_load_dwordx4 a[64:67], v1, s[8:11], s60 offen offset:0 sc1
v_mfma_f32_16x16x32_bf16 v[20:23], a[96:99], a[28:31], v[20:23]
ds_read_b128 a[76:79], v37 offset:1024
v_mfma_f32_16x16x32_bf16 v[24:27], a[100:103], a[28:31], v[24:27]
ds_read_b128 a[80:83], v37 offset:2048
v_mfma_f32_16x16x32_bf16 v[28:31], a[104:107], a[28:31], v[28:31]
ds_read_b128 a[84:87], v37 offset:3072
v_mfma_f32_16x16x32_bf16 v[32:35], a[108:111], a[28:31], v[32:35]
ds_read_b128 a[88:91], v38 offset:0
s_waitcnt vmcnt(8)
s_waitcnt lgkmcnt(5)
v_mfma_f32_16x16x32_bf16 v[16:19], a[112:115], a[32:35], v[16:19]
ds_read_b128 a[92:95], v37 offset:4608
buffer_load_dwordx4 a[68:71], v1, s[8:11], s60 offen offset:1024 sc1
v_mfma_f32_16x16x32_bf16 v[20:23], a[116:119], a[32:35], v[20:23]
ds_read_b128 a[96:99], v37 offset:5632
v_mfma_f32_16x16x32_bf16 v[24:27], a[120:123], a[32:35], v[24:27]
ds_read_b128 a[100:103], v37 offset:6656
v_mfma_f32_16x16x32_bf16 v[28:31], a[124:127], a[32:35], v[28:31]
ds_read_b128 a[104:107], v37 offset:7680
v_mfma_f32_16x16x32_bf16 v[32:35], a[128:131], a[32:35], v[32:35]
ds_read_b128 a[108:111], v38 offset:4608
s_waitcnt vmcnt(8)
s_waitcnt lgkmcnt(5)
v_mfma_f32_16x16x32_bf16 v[16:19], a[72:75], a[36:39], v[16:19]
ds_read_b128 a[112:115], v37 offset:9216
v_mfma_f32_16x16x32_bf16 v[20:23], a[76:79], a[36:39], v[20:23]
ds_read_b128 a[116:119], v37 offset:10240
v_mfma_f32_16x16x32_bf16 v[24:27], a[80:83], a[36:39], v[24:27]
ds_read_b128 a[120:123], v37 offset:11264
v_mfma_f32_16x16x32_bf16 v[28:31], a[84:87], a[36:39], v[28:31]
ds_read_b128 a[124:127], v37 offset:12288
v_mfma_f32_16x16x32_bf16 v[32:35], a[88:91], a[36:39], v[32:35]
ds_read_b128 a[128:131], v38 offset:9216
s_waitcnt vmcnt(7)
s_waitcnt lgkmcnt(5)
v_mfma_f32_16x16x32_bf16 v[16:19], a[92:95], a[40:43], v[16:19]
ds_read_b128 a[72:75], v37 offset:13824
v_mfma_f32_16x16x32_bf16 v[20:23], a[96:99], a[40:43], v[20:23]
ds_read_b128 a[76:79], v37 offset:14848
v_mfma_f32_16x16x32_bf16 v[24:27], a[100:103], a[40:43], v[24:27]
ds_read_b128 a[80:83], v37 offset:15872
v_mfma_f32_16x16x32_bf16 v[28:31], a[104:107], a[40:43], v[28:31]
ds_read_b128 a[84:87], v37 offset:16896
v_mfma_f32_16x16x32_bf16 v[32:35], a[108:111], a[40:43], v[32:35]
ds_read_b128 a[88:91], v38 offset:13824
s_waitcnt vmcnt(6)
s_waitcnt lgkmcnt(5)
v_mfma_f32_16x16x32_bf16 v[16:19], a[112:115], a[44:47], v[16:19]
ds_read_b128 a[92:95], v37 offset:18432
v_mfma_f32_16x16x32_bf16 v[20:23], a[116:119], a[44:47], v[20:23]
ds_read_b128 a[96:99], v37 offset:19456
v_mfma_f32_16x16x32_bf16 v[24:27], a[120:123], a[44:47], v[24:27]
ds_read_b128 a[100:103], v37 offset:20480
v_mfma_f32_16x16x32_bf16 v[28:31], a[124:127], a[44:47], v[28:31]
ds_read_b128 a[104:107], v37 offset:21504
v_mfma_f32_16x16x32_bf16 v[32:35], a[128:131], a[44:47], v[32:35]
ds_read_b128 a[108:111], v38 offset:18432
s_waitcnt vmcnt(5)
s_waitcnt lgkmcnt(5)
v_mfma_f32_16x16x32_bf16 v[16:19], a[72:75], a[48:51], v[16:19]
ds_read_b128 a[112:115], v37 offset:23040
v_mfma_f32_16x16x32_bf16 v[20:23], a[76:79], a[48:51], v[20:23]
ds_read_b128 a[116:119], v37 offset:24064
v_mfma_f32_16x16x32_bf16 v[24:27], a[80:83], a[48:51], v[24:27]
ds_read_b128 a[120:123], v37 offset:25088
v_mfma_f32_16x16x32_bf16 v[28:31], a[84:87], a[48:51], v[28:31]
ds_read_b128 a[124:127], v37 offset:26112
v_mfma_f32_16x16x32_bf16 v[32:35], a[88:91], a[48:51], v[32:35]
ds_read_b128 a[128:131], v38 offset:23040
s_waitcnt vmcnt(4)
s_waitcnt lgkmcnt(5)
v_mfma_f32_16x16x32_bf16 v[16:19], a[92:95], a[52:55], v[16:19]
ds_read_b128 a[72:75], v37 offset:27648
v_mfma_f32_16x16x32_bf16 v[20:23], a[96:99], a[52:55], v[20:23]
ds_read_b128 a[76:79], v37 offset:28672
v_mfma_f32_16x16x32_bf16 v[24:27], a[100:103], a[52:55], v[24:27]
ds_read_b128 a[80:83], v37 offset:29696
v_mfma_f32_16x16x32_bf16 v[28:31], a[104:107], a[52:55], v[28:31]
ds_read_b128 a[84:87], v37 offset:30720
v_mfma_f32_16x16x32_bf16 v[32:35], a[108:111], a[52:55], v[32:35]
ds_read_b128 a[88:91], v38 offset:27648
s_waitcnt vmcnt(3)
s_waitcnt lgkmcnt(5)
v_mfma_f32_16x16x32_bf16 v[16:19], a[112:115], a[56:59], v[16:19]
ds_read_b128 a[92:95], v37 offset:32256
v_mfma_f32_16x16x32_bf16 v[20:23], a[116:119], a[56:59], v[20:23]
ds_read_b128 a[96:99], v37 offset:33280
v_mfma_f32_16x16x32_bf16 v[24:27], a[120:123], a[56:59], v[24:27]
ds_read_b128 a[100:103], v37 offset:34304
v_mfma_f32_16x16x32_bf16 v[28:31], a[124:127], a[56:59], v[28:31]
ds_read_b128 a[104:107], v37 offset:35328
v_mfma_f32_16x16x32_bf16 v[32:35], a[128:131], a[56:59], v[32:35]
ds_read_b128 a[108:111], v38 offset:32256
s_waitcnt vmcnt(2)
s_waitcnt lgkmcnt(5)
v_mfma_f32_16x16x32_bf16 v[16:19], a[72:75], a[60:63], v[16:19]
ds_read_b128 a[112:115], v37 offset:36864
v_mfma_f32_16x16x32_bf16 v[20:23], a[76:79], a[60:63], v[20:23]
ds_read_b128 a[116:119], v37 offset:37888
v_mfma_f32_16x16x32_bf16 v[24:27], a[80:83], a[60:63], v[24:27]
ds_read_b128 a[120:123], v37 offset:38912
v_mfma_f32_16x16x32_bf16 v[28:31], a[84:87], a[60:63], v[28:31]
ds_read_b128 a[124:127], v37 offset:39936
v_mfma_f32_16x16x32_bf16 v[32:35], a[88:91], a[60:63], v[32:35]
ds_read_b128 a[128:131], v38 offset:36864
s_waitcnt vmcnt(1)
s_waitcnt lgkmcnt(5)
v_mfma_f32_16x16x32_bf16 v[16:19], a[92:95], a[64:67], v[16:19]
v_mfma_f32_16x16x32_bf16 v[20:23], a[96:99], a[64:67], v[20:23]
v_mfma_f32_16x16x32_bf16 v[24:27], a[100:103], a[64:67], v[24:27]
v_mfma_f32_16x16x32_bf16 v[28:31], a[104:107], a[64:67], v[28:31]
v_mfma_f32_16x16x32_bf16 v[32:35], a[108:111], a[64:67], v[32:35]
s_waitcnt vmcnt(0)
s_waitcnt lgkmcnt(0)
v_mfma_f32_16x16x32_bf16 v[16:19], a[112:115], a[68:71], v[16:19]
v_mfma_f32_16x16x32_bf16 v[20:23], a[116:119], a[68:71], v[20:23]
v_mfma_f32_16x16x32_bf16 v[24:27], a[120:123], a[68:71], v[24:27]
v_mfma_f32_16x16x32_bf16 v[28:31], a[124:127], a[68:71], v[28:31]
v_mfma_f32_16x16x32_bf16 v[32:35], a[128:131], a[68:71], v[32:35]
s_barrier
s_lshl_b32 s30, s27, 2
s_add_u32 s30, s30, s24
v_mov_b32 v54, 1073741824
s_lshr_b32 s31, s30, 1
s_mul_i32 s31, s31, 36864
s_and_b32 s32, s30, 1
s_lshl_b32 s32, s32, 8
s_add_u32 s31, s31, s32
s_mul_i32 s32, s28, 4608
s_add_u32 s31, s31, s32
s_add_u32 s31, s31, 4849664
v_lshlrev_b32 v56, 4, v2
v_lshl_add_u32 v56, v3, 9, v56
v_add_u32 v57, 4096, v56
v_cndmask_b32 v57, v54, v57, s[46:47]
v_cvt_pk_bf16_f32 v40, v16, v17
v_cvt_pk_bf16_f32 v41, v18, v19
v_cvt_pk_bf16_f32 v42, v20, v21
v_cvt_pk_bf16_f32 v43, v22, v23
v_cvt_pk_bf16_f32 v44, v24, v25
v_cvt_pk_bf16_f32 v45, v26, v27
v_cvt_pk_bf16_f32 v46, v28, v29
v_cvt_pk_bf16_f32 v47, v30, v31
v_cvt_pk_bf16_f32 v48, v32, v33
v_cvt_pk_bf16_f32 v49, v34, v35
buffer_store_dwordx4 v[40:43], v56, s[8:11], s31 offen sc1
buffer_store_dwordx4 v[44:47], v56, s[8:11], s31 offen offset:2048 sc1
v_permlane16_swap_b32 v48, v50
v_permlane16_swap_b32 v49, v51
buffer_store_dwordx4 v[48:51], v57, s[8:11], s31 offen sc1
v_pk_add_f32 v[58:59], v[32:33], v[34:35]
v_pk_mul_f32 v[60:61], v[32:33], v[32:33]
v_pk_fma_f32 v[60:61], v[34:35], v[34:35], v[60:61]
v_cndmask_b32 v58, 0, v58, s[50:51]
v_cndmask_b32 v59, 0, v59, s[50:51]
v_cndmask_b32 v60, 0, v60, s[50:51]
v_cndmask_b32 v61, 0, v61, s[50:51]
v_pk_add_f32 v[58:59], v[58:59], v[16:17]
v_pk_fma_f32 v[60:61], v[16:17], v[16:17], v[60:61]
v_pk_add_f32 v[58:59], v[58:59], v[18:19]
v_pk_fma_f32 v[60:61], v[18:19], v[18:19], v[60:61]
v_pk_add_f32 v[58:59], v[58:59], v[20:21]
v_pk_fma_f32 v[60:61], v[20:21], v[20:21], v[60:61]
v_pk_add_f32 v[58:59], v[58:59], v[22:23]
v_pk_fma_f32 v[60:61], v[22:23], v[22:23], v[60:61]
v_pk_add_f32 v[58:59], v[58:59], v[24:25]
v_pk_fma_f32 v[60:61], v[24:25], v[24:25], v[60:61]
v_pk_add_f32 v[58:59], v[58:59], v[26:27]
v_pk_fma_f32 v[60:61], v[26:27], v[26:27], v[60:61]
v_pk_add_f32 v[58:59], v[58:59], v[28:29]
v_pk_fma_f32 v[60:61], v[28:29], v[28:29], v[60:61]
v_pk_add_f32 v[58:59], v[58:59], v[30:31]
v_pk_fma_f32 v[60:61], v[30:31], v[30:31], v[60:61]
v_add_f32 v52, v58, v59
v_add_f32 v53, v60, v61
s_lshl_b32 s31, s30, 7
s_lshl_b32 s32, s28, 14
v_permlane32_swap_b32 v52, v53
v_add_f32 v52, v52, v53
v_mov_b32 v53, v52
s_add_u32 s31, s31, s32
s_add_u32 s31, s31, 7208960
v_permlane16_swap_b32 v52, v53
v_add_f32 v52, v52, v53
v_mov_b32 v53, v52
v_lshlrev_b32 v55, 3, v2
v_cndmask_b32 v54, v54, v55, s[46:47]
v_permlane32_swap_b32 v52, v53
buffer_store_dwordx2 v[52:53], v54, s[8:11], s31 offen sc1
s_mul_i32 s38, s24, 9216
s_add_u32 m0, s38, 0
s_add_u32 s39, s38, s82
s_add_u32 s39, s39, 75776
buffer_load_dwordx4 v1, s[4:7], s39 offen offset:0 sc1 lds
buffer_load_dwordx4 v1, s[4:7], s39 offen offset:1024 sc1 lds
buffer_load_dwordx4 v1, s[4:7], s39 offen offset:2048 sc1 lds
buffer_load_dwordx4 v1, s[4:7], s39 offen offset:3072 sc1 lds
s_add_u32 m0, m0, 4096
s_add_u32 s39, s39, 4096
buffer_load_dwordx4 v1, s[4:7], s39 offen offset:0 sc1 lds
buffer_load_dwordx4 v1, s[4:7], s39 offen offset:1024 sc1 lds
buffer_load_dwordx4 v1, s[4:7], s39 offen offset:2048 sc1 lds
buffer_load_dwordx4 v1, s[4:7], s39 offen offset:3072 sc1 lds
s_add_u32 m0, m0, 4096
s_add_u32 s39, s39, 4096
buffer_load_dwordx4 v1, s[4:7], s39 offen offset:0 sc1 lds
s_lshl_b32 s38, s24, 8
s_add_u32 m0, s38, 36864
s_add_u32 s39, s38, s82
s_add_u32 s39, s39, 112640
s_mov_b64 exec, 0xffff
buffer_load_dwordx4 v1, s[4:7], s39 offen sc1 lds
s_mov_b64 exec, -1
s_waitcnt vmcnt(10)
s_barrier
s_cmp_eq_u32 s24, 0
s_cbranch_scc0 L_sig_18
v_lshlrev_b32 v6, 3, v1
s_lshr_b32 s31, s81, 4
s_lshl_b32 s31, s31, 11
v_add_u32 v6, s31, v6
s_mov_b64 exec, 0xffff
s_mov_b32 s30, 26509312
buffer_atomic_add v4, v6, s[8:11], s30 offen sc1
s_mov_b64 exec, -1
L_sig_18:
s_mul_i32 s38, s24, 9216
s_add_u32 m0, s38, 37888
s_add_u32 s39, s38, s82
s_add_u32 s39, s39, 113664
buffer_load_dwordx4 v1, s[4:7], s39 offen offset:0 sc1 lds
buffer_load_dwordx4 v1, s[4:7], s39 offen offset:1024 sc1 lds
buffer_load_dwordx4 v1, s[4:7], s39 offen offset:2048 sc1 lds
buffer_load_dwordx4 v1, s[4:7], s39 offen offset:3072 sc1 lds
s_add_u32 m0, m0, 4096
s_add_u32 s39, s39, 4096
buffer_load_dwordx4 v1, s[4:7], s39 offen offset:0 sc1 lds
buffer_load_dwordx4 v1, s[4:7], s39 offen offset:1024 sc1 lds
buffer_load_dwordx4 v1, s[4:7], s39 offen offset:2048 sc1 lds
buffer_load_dwordx4 v1, s[4:7], s39 offen offset:3072 sc1 lds
s_add_u32 m0, m0, 4096
s_add_u32 s39, s39, 4096
buffer_load_dwordx4 v1, s[4:7], s39 offen offset:0 sc1 lds
s_lshl_b32 s38, s24, 8
s_add_u32 m0, s38, 74752
s_add_u32 s39, s38, s82
s_add_u32 s39, s39, 150528
s_mov_b64 exec, 0xffff
buffer_load_dwordx4 v1, s[4:7], s39 offen sc1 lds
s_mov_b64 exec, -1
s_cmp_eq_u32 s24, 1
s_cbranch_scc0 L_other_21
s_lshl_b32 s30, s80, 7
s_add_u32 s30, s30, 26509312
v_mov_b32 v6, 0
s_mov_b32 s31, 0
s_mov_b64 exec, 1
v_mov_b32 v249, 0
buffer_atomic_add v249, v6, s[8:11], s30 offen sc0 sc1
s_sleep 3
v_mov_b32 v250, 0
buffer_atomic_add v250, v6, s[8:11], s30 offen sc0 sc1
s_sleep 3
v_mov_b32 v251, 0
buffer_atomic_add v251, v6, s[8:11], s30 offen sc0 sc1
s_sleep 3
L_poll_19:
s_add_u32 s31, s31, 1
s_cmp_gt_u32 s31, 100000
s_cbranch_scc1 L_polled_20
v_mov_b32 v252, 0
buffer_atomic_add v252, v6, s[8:11], s30 offen sc0 sc1
s_waitcnt vmcnt(3)
v_cmp_gt_u32 vcc, 16, v249
s_nop 0
s_cbranch_vccz L_polled_20
v_mov_b32 v249, 0
buffer_atomic_add v249, v6, s[8:11], s30 offen sc0 sc1
s_waitcnt vmcnt(3)
v_cmp_gt_u32 vcc, 16, v250
s_nop 0
s_cbranch_vccz L_polled_20
v_mov_b32 v250, 0
buffer_atomic_add v250, v6, s[8:11], s30 offen sc0 sc1
s_waitcnt vmcnt(3)
v_cmp_gt_u32 vcc, 16, v251
s_nop 0
s_cbranch_vccz L_polled_20
v_mov_b32 v251, 0
buffer_atomic_add v251, v6, s[8:11], s30 offen sc0 sc1
s_waitcnt vmcnt(3)
v_cmp_gt_u32 vcc, 16, v252
s_nop 0
s_cbranch_vccz L_polled_20
s_branch L_poll_19
L_polled_20:
s_mov_b64 exec, -1
s_branch L_join_22
L_other_21:
s_waitcnt vmcnt(0)
L_join_22:
s_barrier
s_lshl_b32 s60, s25, 2
s_add_u32 s60, s60, s24
s_mul_i32 s62, s60, 36864
s_add_u32 s62, s62, 4849664
buffer_load_dwordx4 a[0:3], v1, s[8:11], s62 offen offset:0 sc1
buffer_load_dwordx4 a[4:7], v1, s[8:11], s62 offen offset:1024 sc1
buffer_load_dwordx4 a[8:11], v1, s[8:11], s62 offen offset:2048 sc1
buffer_load_dwordx4 a[12:15], v1, s[8:11], s62 offen offset:3072 sc1
s_add_u32 s62, s62, 4096
buffer_load_dwordx4 a[16:19], v1, s[8:11], s62 offen offset:0 sc1
buffer_load_dwordx4 a[20:23], v1, s[8:11], s62 offen offset:1024 sc1
buffer_load_dwordx4 a[24:27], v1, s[8:11], s62 offen offset:2048 sc1
buffer_load_dwordx4 a[28:31], v1, s[8:11], s62 offen offset:3072 sc1
s_add_u32 s62, s62, 4096
buffer_load_dwordx4 a[32:35], v1, s[8:11], s62 offen offset:0 sc1
buffer_load_dwordx4 a[36:39], v1, s[8:11], s62 offen offset:1024 sc1
buffer_load_dwordx4 a[40:43], v1, s[8:11], s62 offen offset:2048 sc1
buffer_load_dwordx4 a[44:47], v1, s[8:11], s62 offen offset:3072 sc1
s_lshl_b32 s52, s25, 19
s_lshl_b32 s38, s24, 17
s_add_u32 s52, s52, s38
s_add_u32 s52, s52, 10895360
v_lshrrev_b32 v6, 1, v1
v_and_b32 v6, 0xf8, v6
v_lshrrev_b32 v7, 1, v3
v_lshl_add_u32 v232, v7, 16, v6
s_lshl_b32 s63, s60, 8
s_add_u32 s63, s63, 7208960
v_add_u32 v206, 86016, v1
v_add_u32 v207, 123904, v1
v_add_u32 v208, 0, v1
v_add_u32 v209, 37888, v1
ds_read_b128 a[144:147], v206 offset:0
ds_read_b128 a[148:151], v207 offset:0
ds_read_b128 a[152:155], v206 offset:1024
ds_read_b128 a[156:159], v207 offset:1024
ds_read_b128 a[160:163], v206 offset:2048
ds_read_b128 a[164:167], v207 offset:2048
ds_read_b128 a[168:171], v206 offset:3072
s_waitcnt vmcnt(11)
s_waitcnt lgkmcnt(3)
v_mfma_f32_32x32x16_bf16 v[36:51], a[144:147], a[0:3], 0
ds_read_b128 a[172:175], v207 offset:3072
s_add_u32 s62, s62, 4096
v_mfma_f32_32x32x16_bf16 v[52:67], a[148:151], a[0:3], 0
ds_read_b128 a[144:147], v206 offset:4096
buffer_load_dwordx4 a[48:51], v1, s[8:11], s62 offen offset:0 sc1
s_waitcnt vmcnt(11)
v_mfma_f32_32x32x16_bf16 v[36:51], a[152:155], a[4:7], v[36:51]
ds_read_b128 a[148:151], v207 offset:4096
buffer_load_dwordx4 a[52:55], v1, s[8:11], s62 offen offset:1024 sc1
v_lshl_add_u32 v234, v7, 13, v6
v_mfma_f32_32x32x16_bf16 v[52:67], a[156:159], a[4:7], v[52:67]
ds_read_b128 a[152:155], v206 offset:5120
buffer_load_dwordx4 a[56:59], v1, s[8:11], s62 offen offset:2048 sc1
v_add_u32 v235, 4096, v234
s_waitcnt vmcnt(12)
s_waitcnt lgkmcnt(3)
v_mfma_f32_32x32x16_bf16 v[36:51], a[160:163], a[8:11], v[36:51]
ds_read_b128 a[156:159], v207 offset:5120
s_mul_i32 s30, s24, 9728
v_mfma_f32_32x32x16_bf16 v[52:67], a[164:167], a[8:11], v[52:67]
ds_read_b128 a[160:163], v206 offset:6144
buffer_load_dwordx4 a[60:63], v1, s[8:11], s62 offen offset:3072 sc1
s_add_u32 s30, s30, 123904
s_waitcnt vmcnt(12)
v_mfma_f32_32x32x16_bf16 v[36:51], a[168:171], a[12:15], v[36:51]
ds_read_b128 a[164:167], v207 offset:6144
s_add_u32 s62, s62, 4096
v_mfma_f32_32x32x16_bf16 v[52:67], a[172:175], a[12:15], v[52:67]
ds_read_b128 a[168:171], v206 offset:7168
buffer_load_dwordx2 v[180:181], v232, s[8:11], s63 offen sc1
v_bfe_u32 v8, v1, 4, 5
s_waitcnt vmcnt(12)
s_waitcnt lgkmcnt(3)
v_mfma_f32_32x32x16_bf16 v[36:51], a[144:147], a[16:19], v[36:51]
ds_read_b128 a[172:175], v207 offset:7168
v_mul_u32_u24 v237, 304, v8
v_mfma_f32_32x32x16_bf16 v[52:67], a[148:151], a[16:19], v[52:67]
ds_read_b128 a[144:147], v206 offset:8192
s_add_u32 s63, s63, 16384
v_add_u32 v237, s30, v237
s_waitcnt vmcnt(11)
v_mfma_f32_32x32x16_bf16 v[36:51], a[152:155], a[20:23], v[36:51]
ds_read_b128 a[148:151], v207 offset:8192
buffer_load_dwordx2 v[182:183], v232, s[8:11], s63 offen sc1
v_lshl_add_u32 v239, v7, 4, v237
v_mfma_f32_32x32x16_bf16 v[52:67], a[156:159], a[20:23], v[52:67]
ds_read_b128 a[152:155], v206 offset:9216
s_add_u32 s63, s63, 16384
s_waitcnt vmcnt(11)
s_waitcnt lgkmcnt(3)
v_mfma_f32_32x32x16_bf16 v[36:51], a[160:163], a[24:27], v[36:51]
ds_read_b128 a[156:159], v207 offset:9216
buffer_load_dwordx2 v[184:185], v232, s[8:11], s63 offen sc1
v_lshl_add_u32 v237, v7, 5, v237
v_mfma_f32_32x32x16_bf16 v[52:67], a[164:167], a[24:27], v[52:67]
ds_read_b128 a[160:163], v206 offset:10240
v_lshrrev_b32 v8, 2, v2
s_waitcnt vmcnt(11)
v_mfma_f32_32x32x16_bf16 v[36:51], a[168:171], a[28:31], v[36:51]
ds_read_b128 a[164:167], v207 offset:10240
s_add_u32 s63, s63, 16384
v_lshl_add_u32 v8, v3, 3, v8
v_mfma_f32_32x32x16_bf16 v[52:67], a[172:175], a[28:31], v[52:67]
ds_read_b128 a[168:171], v206 offset:11264
buffer_load_dwordx2 v[186:187], v232, s[8:11], s63 offen sc1
s_waitcnt vmcnt(11)
s_waitcnt lgkmcnt(3)
v_mfma_f32_32x32x16_bf16 v[36:51], a[144:147], a[32:35], v[36:51]
ds_read_b128 a[172:175], v207 offset:11264
s_add_u32 s63, s63, 16384
v_mul_u32_u24 v238, 304, v8
v_mfma_f32_32x32x16_bf16 v[52:67], a[148:151], a[32:35], v[52:67]
ds_read_b128 a[144:147], v206 offset:12288
v_and_b32 v8, 3, v2
s_waitcnt vmcnt(10)
v_mfma_f32_32x32x16_bf16 v[36:51], a[152:155], a[36:39], v[36:51]
ds_read_b128 a[148:151], v207 offset:12288
buffer_load_dwordx4 a[64:67], v1, s[8:11], s62 offen offset:0 sc1
v_lshl_add_u32 v238, v8, 3, v238
v_mfma_f32_32x32x16_bf16 v[52:67], a[156:159], a[36:39], v[52:67]
ds_read_b128 a[152:155], v206 offset:13312
buffer_load_dwordx4 a[68:71], v1, s[8:11], s62 offen offset:1024 sc1
v_add_u32 v238, s30, v238
s_waitcnt vmcnt(11)
s_waitcnt lgkmcnt(3)
v_mfma_f32_32x32x16_bf16 v[36:51], a[160:163], a[40:43], v[36:51]
ds_read_b128 a[156:159], v207 offset:13312
buffer_load_dwordx4 a[72:75], v1, s[8:11], s62 offen offset:2048 sc1
v_mfma_f32_32x32x16_bf16 v[52:67], a[164:167], a[40:43], v[52:67]
ds_read_b128 a[160:163], v206 offset:14336
buffer_load_dwordx4 a[76:79], v1, s[8:11], s62 offen offset:3072 sc1
s_mul_i32 s66, s26, 589824
s_waitcnt vmcnt(12)
v_mfma_f32_32x32x16_bf16 v[36:51], a[168:171], a[44:47], v[36:51]
ds_read_b128 a[164:167], v207 offset:14336
s_mul_i32 s31, s60, 9216
v_mfma_f32_32x32x16_bf16 v[52:67], a[172:175], a[44:47], v[52:67]
ds_read_b128 a[168:171], v206 offset:15360
s_add_u32 s62, s62, 4096
s_add_u32 s66, s66, s31
s_waitcnt vmcnt(11)
s_waitcnt lgkmcnt(3)
v_mfma_f32_32x32x16_bf16 v[36:51], a[144:147], a[48:51], v[36:51]
ds_read_b128 a[172:175], v207 offset:15360
buffer_load_dwordx4 a[80:83], v1, s[8:11], s62 offen offset:0 sc1
s_add_u32 s66, s66, 7340032
v_mfma_f32_32x32x16_bf16 v[52:67], a[148:151], a[48:51], v[52:67]
ds_read_b128 a[144:147], v206 offset:16384
buffer_load_dwordx4 a[84:87], v1, s[8:11], s62 offen offset:1024 sc1
s_waitcnt vmcnt(12)
v_mfma_f32_32x32x16_bf16 v[36:51], a[152:155], a[52:55], v[36:51]
ds_read_b128 a[148:151], v207 offset:16384
v_lshlrev_b32 v236, 7, v1
v_mfma_f32_32x32x16_bf16 v[52:67], a[156:159], a[52:55], v[52:67]
ds_read_b128 a[152:155], v206 offset:17408
buffer_load_dwordx4 a[88:91], v1, s[8:11], s62 offen offset:2048 sc1
s_lshl_b32 s31, s26, 7
s_waitcnt vmcnt(12)
s_waitcnt lgkmcnt(3)
v_mfma_f32_32x32x16_bf16 v[36:51], a[160:163], a[56:59], v[36:51]
ds_read_b128 a[156:159], v207 offset:17408
buffer_load_dwordx4 a[92:95], v1, s[8:11], s62 offen offset:3072 sc1
v_add_u32 v236, s31, v236
v_mfma_f32_32x32x16_bf16 v[52:67], a[164:167], a[56:59], v[52:67]
ds_read_b128 a[160:163], v206 offset:18432
s_add_u32 s62, s62, 4096
s_waitcnt vmcnt(12)
v_mfma_f32_32x32x16_bf16 v[36:51], a[168:171], a[60:63], v[36:51]
ds_read_b128 a[164:167], v207 offset:18432
buffer_load_dwordx4 a[96:99], v1, s[8:11], s62 offen offset:0 sc1
s_lshl_b32 s61, s25, 14
v_mfma_f32_32x32x16_bf16 v[52:67], a[172:175], a[60:63], v[52:67]
ds_read_b128 a[168:171], v206 offset:19456
s_lshl_b32 s30, s24, 8
s_waitcnt vmcnt(8)
s_waitcnt lgkmcnt(3)
v_mfma_f32_32x32x16_bf16 v[36:51], a[144:147], a[64:67], v[36:51]
ds_read_b128 a[172:175], v207 offset:19456
buffer_load_dwordx4 a[100:103], v1, s[8:11], s62 offen offset:1024 sc1
s_add_u32 s61, s61, s30
v_mfma_f32_32x32x16_bf16 v[52:67], a[148:151], a[64:67], v[52:67]
ds_read_b128 a[144:147], v206 offset:20480
buffer_load_dwordx4 a[104:107], v1, s[8:11], s62 offen offset:2048 sc1
s_add_u32 s61, s61, 26214400
s_waitcnt vmcnt(9)
v_mfma_f32_32x32x16_bf16 v[36:51], a[152:155], a[68:71], v[36:51]
ds_read_b128 a[148:151], v207 offset:20480
buffer_load_dwordx4 a[108:111], v1, s[8:11], s62 offen offset:3072 sc1
v_mfma_f32_32x32x16_bf16 v[52:67], a[156:159], a[68:71], v[52:67]
ds_read_b128 a[152:155], v206 offset:21504
s_lshl_b32 s30, s26, 10
s_waitcnt vmcnt(9)
s_waitcnt lgkmcnt(3)
v_mfma_f32_32x32x16_bf16 v[36:51], a[160:163], a[72:75], v[36:51]
ds_read_b128 a[156:159], v207 offset:21504
s_add_u32 s62, s62, 4096
s_add_u32 s30, s30, s61
v_mfma_f32_32x32x16_bf16 v[52:67], a[164:167], a[72:75], v[52:67]
ds_read_b128 a[160:163], v206 offset:22528
buffer_load_dwordx4 a[112:115], v1, s[8:11], s62 offen offset:0 sc1
v_lshrrev_b32 v6, 1, v1
s_waitcnt vmcnt(9)
v_mfma_f32_32x32x16_bf16 v[36:51], a[168:171], a[76:79], v[36:51]
ds_read_b128 a[164:167], v207 offset:22528
buffer_load_dwordx4 a[116:119], v1, s[8:11], s62 offen offset:1024 sc1
v_mfma_f32_32x32x16_bf16 v[52:67], a[172:175], a[76:79], v[52:67]
ds_read_b128 a[168:171], v206 offset:23552
buffer_load_dwordx4 a[120:123], v1, s[8:11], s62 offen offset:2048 sc1
s_waitcnt vmcnt(10)
s_waitcnt lgkmcnt(3)
v_mfma_f32_32x32x16_bf16 v[36:51], a[144:147], a[80:83], v[36:51]
ds_read_b128 a[172:175], v207 offset:23552
v_add_f32 v196, v180, v182
v_mfma_f32_32x32x16_bf16 v[52:67], a[148:151], a[80:83], v[52:67]
ds_read_b128 a[144:147], v206 offset:24576
buffer_load_dwordx4 a[124:127], v1, s[8:11], s62 offen offset:3072 sc1
v_add_f32 v197, v181, v183
s_waitcnt vmcnt(10)
v_mfma_f32_32x32x16_bf16 v[36:51], a[152:155], a[84:87], v[36:51]
ds_read_b128 a[148:151], v207 offset:24576
s_add_u32 s62, s62, 4096
v_add_f32 v196, v196, v184
v_mfma_f32_32x32x16_bf16 v[52:67], a[156:159], a[84:87], v[52:67]
ds_read_b128 a[152:155], v206 offset:25600
buffer_load_dwordx4 a[128:131], v1, s[8:11], s62 offen offset:0 sc1
v_add_f32 v197, v197, v185
v_add_f32 v196, v196, v186
s_waitcnt vmcnt(10)
s_waitcnt lgkmcnt(3)
v_mfma_f32_32x32x16_bf16 v[36:51], a[160:163], a[88:91], v[36:51]
ds_read_b128 a[156:159], v207 offset:25600
v_add_f32 v197, v197, v187
v_mfma_f32_32x32x16_bf16 v[52:67], a[164:167], a[88:91], v[52:67]
ds_read_b128 a[160:163], v206 offset:26624
buffer_load_dwordx4 a[132:135], v1, s[8:11], s62 offen offset:1024 sc1
v_mov_b32 v198, v196
s_waitcnt vmcnt(10)
v_mfma_f32_32x32x16_bf16 v[36:51], a[168:171], a[92:95], v[36:51]
ds_read_b128 a[164:167], v207 offset:26624
buffer_load_dwordx4 a[136:139], v1, s[8:11], s62 offen offset:2048 sc1
v_mov_b32 v199, v197
v_mov_b32 v204, 0
v_mfma_f32_32x32x16_bf16 v[52:67], a[172:175], a[92:95], v[52:67]
ds_read_b128 a[168:171], v206 offset:27648
buffer_load_dwordx4 a[140:143], v1, s[8:11], s62 offen offset:3072 sc1
v_mov_b32 v205, 0
s_waitcnt vmcnt(11)
s_waitcnt lgkmcnt(3)
v_mfma_f32_32x32x16_bf16 v[36:51], a[144:147], a[96:99], v[36:51]
ds_read_b128 a[172:175], v207 offset:27648
v_permlane32_swap_b32 v196, v198
v_mfma_f32_32x32x16_bf16 v[52:67], a[148:151], a[96:99], v[52:67]
ds_read_b128 a[144:147], v206 offset:28672
s_waitcnt vmcnt(10)
v_mfma_f32_32x32x16_bf16 v[36:51], a[152:155], a[100:103], v[36:51]
ds_read_b128 a[148:151], v207 offset:28672
v_permlane32_swap_b32 v197, v199
v_mfma_f32_32x32x16_bf16 v[52:67], a[156:159], a[100:103], v[52:67]
ds_read_b128 a[152:155], v206 offset:29696
v_add_f32 v196, v196, v198
s_waitcnt vmcnt(9)
s_waitcnt lgkmcnt(3)
v_mfma_f32_32x32x16_bf16 v[36:51], a[160:163], a[104:107], v[36:51]
ds_read_b128 a[156:159], v207 offset:29696
v_add_f32 v197, v197, v199
v_mfma_f32_32x32x16_bf16 v[52:67], a[164:167], a[104:107], v[52:67]
ds_read_b128 a[160:163], v206 offset:30720
v_mul_f32 v196, 0x3ae38e39, v196
v_mul_f32 v198, v196, v196
s_waitcnt vmcnt(8)
v_mfma_f32_32x32x16_bf16 v[36:51], a[168:171], a[108:111], v[36:51]
ds_read_b128 a[164:167], v207 offset:30720
v_mul_f32 v197, 0x3ae38e39, v197
v_mfma_f32_32x32x16_bf16 v[52:67], a[172:175], a[108:111], v[52:67]
ds_read_b128 a[168:171], v206 offset:31744
v_sub_f32 v197, v197, v198
s_waitcnt vmcnt(7)
s_waitcnt lgkmcnt(3)
v_mfma_f32_32x32x16_bf16 v[36:51], a[144:147], a[112:115], v[36:51]
ds_read_b128 a[172:175], v207 offset:31744
v_max_f32 v197, 0, v197
v_mfma_f32_32x32x16_bf16 v[52:67], a[148:151], a[112:115], v[52:67]
ds_read_b128 a[144:147], v206 offset:32768
v_add_f32 v197, 0x3727c5ac, v197
v_rsq_f32 v253, v197
s_waitcnt vmcnt(6)
v_mfma_f32_32x32x16_bf16 v[36:51], a[152:155], a[116:119], v[36:51]
ds_read_b128 a[148:151], v207 offset:32768
v_mfma_f32_32x32x16_bf16 v[52:67], a[156:159], a[116:119], v[52:67]
ds_read_b128 a[152:155], v206 offset:33792
v_sqrt_f32 v255, v197
s_waitcnt vmcnt(5)
s_waitcnt lgkmcnt(3)
v_mfma_f32_32x32x16_bf16 v[36:51], a[160:163], a[120:123], v[36:51]
ds_read_b128 a[156:159], v207 offset:33792
v_cvt_pk_bf16_f32 v198, -v196, -v196
v_mfma_f32_32x32x16_bf16 v[52:67], a[164:167], a[120:123], v[52:67]
ds_read_b128 a[160:163], v206 offset:34816
v_and_b32 v198, 0xffff0000, v198
s_waitcnt vmcnt(4)
v_mfma_f32_32x32x16_bf16 v[36:51], a[168:171], a[124:127], v[36:51]
ds_read_b128 a[164:167], v207 offset:34816
v_add_f32 v198, v196, v198
v_mfma_f32_32x32x16_bf16 v[52:67], a[172:175], a[124:127], v[52:67]
ds_read_b128 a[168:171], v206 offset:35840
v_cvt_pk_bf16_f32 v212, -v196, -v198
s_waitcnt vmcnt(3)
s_waitcnt lgkmcnt(3)
v_mfma_f32_32x32x16_bf16 v[36:51], a[144:147], a[128:131], v[36:51]
ds_read_b128 a[172:175], v207 offset:35840
v_mov_b32 v213, v212
v_mov_b32 v214, v212
v_mfma_f32_32x32x16_bf16 v[52:67], a[148:151], a[128:131], v[52:67]
ds_read_b128 a[144:147], v206 offset:36864
v_mov_b32 v215, v212
s_waitcnt vmcnt(2)
v_mfma_f32_32x32x16_bf16 v[36:51], a[152:155], a[132:135], v[36:51]
ds_read_b128 a[148:151], v207 offset:36864
v_mul_f32 v254, v253, v253
v_mfma_f32_32x32x16_bf16 v[52:67], a[156:159], a[132:135], v[52:67]
ds_read_b128 a[152:155], v208 offset:0
v_mul_f32 v254, v254, v253
v_mul_f32 v254, 0xbdd2d3e8, v254
s_waitcnt vmcnt(1)
s_waitcnt lgkmcnt(3)
v_mfma_f32_32x32x16_bf16 v[36:51], a[160:163], a[136:139], v[36:51]
ds_read_b128 a[156:159], v208 offset:1024
v_mul_f32 v253, 0xc0135761, v253
v_mfma_f32_32x32x16_bf16 v[52:67], a[164:167], a[136:139], v[52:67]
ds_read_b128 a[160:163], v208 offset:2048
v_mov_b32 v240, v253
s_waitcnt vmcnt(0)
v_mfma_f32_32x32x16_bf16 v[36:51], a[168:171], a[140:143], v[36:51]
ds_read_b128 a[164:167], v208 offset:3072
v_mov_b32 v242, v254
v_mfma_f32_32x32x16_bf16 v[52:67], a[172:175], a[140:143], v[52:67]
ds_read_b128 a[168:171], v208 offset:4096
s_waitcnt lgkmcnt(3)
v_mfma_f32_32x32x16_bf16 v[36:51], a[144:147], v[212:215], v[36:51]
ds_read_b128 a[172:175], v208 offset:5120
v_mfma_f32_32x32x16_bf16 v[52:67], a[148:151], v[212:215], v[52:67]
ds_read_b128 a[144:147], v208 offset:6144
s_barrier
v_mfma_f32_32x32x16_bf16 v[68:83], a[152:155], a[0:3], 0
ds_read_b128 a[148:151], v208 offset:7168
s_mul_i32 s38, s24, 9216
s_add_u32 m0, s38, 86016
v_mfma_f32_32x32x16_bf16 v[68:83], a[156:159], a[4:7], v[68:83]
ds_read_b128 a[152:155], v208 offset:8192
s_add_u32 s39, s38, s82
s_waitcnt lgkmcnt(3)
v_mfma_f32_32x32x16_bf16 v[68:83], a[160:163], a[8:11], v[68:83]
ds_read_b128 a[156:159], v208 offset:9216
s_add_u32 s39, s39, 151552
v_mfma_f32_32x32x16_bf16 v[68:83], a[164:167], a[12:15], v[68:83]
ds_read_b128 a[160:163], v208 offset:10240
buffer_load_dwordx4 v1, s[4:7], s39 offen offset:0 sc1 lds
v_mfma_f32_32x32x16_bf16 v[68:83], a[168:171], a[16:19], v[68:83]
ds_read_b128 a[164:167], v208 offset:11264
buffer_load_dwordx4 v1, s[4:7], s39 offen offset:1024 sc1 lds
v_pk_mul_f32 v[216:217], v[36:37], v[36:37]
v_pk_mul_f32 v[218:219], v[38:39], v[38:39]
v_pk_mul_f32 v[220:221], v[40:41], v[40:41]
v_pk_mul_f32 v[222:223], v[42:43], v[42:43]
v_pk_fma_f32 v[216:217], v[216:217], v[242:243], v[240:241] op_sel_hi:[1,0,0]
v_pk_fma_f32 v[218:219], v[218:219], v[242:243], v[240:241] op_sel_hi:[1,0,0]
v_pk_fma_f32 v[220:221], v[220:221], v[242:243], v[240:241] op_sel_hi:[1,0,0]
v_pk_fma_f32 v[222:223], v[222:223], v[242:243], v[240:241] op_sel_hi:[1,0,0]
v_pk_mul_f32 v[216:217], v[216:217], v[36:37]
v_pk_mul_f32 v[218:219], v[218:219], v[38:39]
v_pk_mul_f32 v[220:221], v[220:221], v[40:41]
v_pk_mul_f32 v[222:223], v[222:223], v[42:43]
v_mfma_f32_32x32x16_bf16 v[68:83], a[172:175], a[20:23], v[68:83]
ds_read_b128 a[168:171], v208 offset:12288
buffer_load_dwordx4 v1, s[4:7], s39 offen offset:2048 sc1 lds
v_exp_f32 v216, v216
v_exp_f32 v217, v217
v_exp_f32 v218, v218
s_waitcnt lgkmcnt(3)
v_mfma_f32_32x32x16_bf16 v[68:83], a[144:147], a[24:27], v[68:83]
ds_read_b128 a[172:175], v208 offset:13312
buffer_load_dwordx4 v1, s[4:7], s39 offen offset:3072 sc1 lds
s_add_u32 m0, m0, 4096
v_exp_f32 v219, v219
v_fma_f32 v216, v216, v255, v255
v_mfma_f32_32x32x16_bf16 v[68:83], a[148:151], a[28:31], v[68:83]
ds_read_b128 a[144:147], v208 offset:14336
s_add_u32 s39, s39, 4096
v_fma_f32 v217, v217, v255, v255
v_fma_f32 v218, v218, v255, v255
v_fma_f32 v219, v219, v255, v255
v_mfma_f32_32x32x16_bf16 v[68:83], a[152:155], a[32:35], v[68:83]
ds_read_b128 a[148:151], v208 offset:15360
buffer_load_dwordx4 v1, s[4:7], s39 offen offset:0 sc1 lds
v_rcp_f32 v216, v216
v_rcp_f32 v217, v217
v_mfma_f32_32x32x16_bf16 v[68:83], a[156:159], a[36:39], v[68:83]
ds_read_b128 a[152:155], v208 offset:16384
buffer_load_dwordx4 v1, s[4:7], s39 offen offset:1024 sc1 lds
v_rcp_f32 v218, v218
v_rcp_f32 v219, v219
s_waitcnt lgkmcnt(3)
v_mfma_f32_32x32x16_bf16 v[68:83], a[160:163], a[40:43], v[68:83]
ds_read_b128 a[156:159], v208 offset:17408
buffer_load_dwordx4 v1, s[4:7], s39 offen offset:2048 sc1 lds
v_mul_f32 v36, v36, v216
v_mul_f32 v37, v37, v217
v_mul_f32 v38, v38, v218
v_mul_f32 v39, v39, v219
v_mfma_f32_32x32x16_bf16 v[68:83], a[164:167], a[44:47], v[68:83]
ds_read_b128 a[160:163], v208 offset:18432
buffer_load_dwordx4 v1, s[4:7], s39 offen offset:3072 sc1 lds
s_add_u32 m0, m0, 4096
v_exp_f32 v220, v220
v_mfma_f32_32x32x16_bf16 v[68:83], a[168:171], a[48:51], v[68:83]
ds_read_b128 a[164:167], v208 offset:19456
s_add_u32 s39, s39, 4096
v_exp_f32 v221, v221
v_exp_f32 v222, v222
v_mfma_f32_32x32x16_bf16 v[68:83], a[172:175], a[52:55], v[68:83]
ds_read_b128 a[168:171], v208 offset:20480
buffer_load_dwordx4 v1, s[4:7], s39 offen offset:0 sc1 lds
v_exp_f32 v223, v223
v_fma_f32 v220, v220, v255, v255
s_waitcnt lgkmcnt(3)
v_mfma_f32_32x32x16_bf16 v[68:83], a[144:147], a[56:59], v[68:83]
ds_read_b128 a[172:175], v208 offset:21504
s_lshl_b32 s38, s24, 8
v_fma_f32 v221, v221, v255, v255
v_fma_f32 v222, v222, v255, v255
v_fma_f32 v223, v223, v255, v255
v_mfma_f32_32x32x16_bf16 v[68:83], a[148:151], a[60:63], v[68:83]
ds_read_b128 a[144:147], v208 offset:22528
s_add_u32 m0, s38, 122880
s_add_u32 s39, s38, s82
v_rcp_f32 v220, v220
v_rcp_f32 v221, v221
v_mfma_f32_32x32x16_bf16 v[68:83], a[152:155], a[64:67], v[68:83]
ds_read_b128 a[148:151], v208 offset:23552
s_add_u32 s39, s39, 188416
v_rcp_f32 v222, v222
v_rcp_f32 v223, v223
v_mfma_f32_32x32x16_bf16 v[68:83], a[156:159], a[68:71], v[68:83]
ds_read_b128 a[152:155], v208 offset:24576
s_mov_b64 exec, 0xffff
buffer_load_dwordx4 v1, s[4:7], s39 offen sc1 lds
s_mov_b64 exec, -1
v_mul_f32 v40, v40, v220
v_mul_f32 v41, v41, v221
v_mul_f32 v42, v42, v222
v_mul_f32 v43, v43, v223
s_waitcnt lgkmcnt(3)
v_mfma_f32_32x32x16_bf16 v[68:83], a[160:163], a[72:75], v[68:83]
ds_read_b128 a[156:159], v208 offset:25600
v_pk_mul_f32 v[224:225], v[44:45], v[44:45]
v_pk_mul_f32 v[226:227], v[46:47], v[46:47]
v_pk_mul_f32 v[228:229], v[48:49], v[48:49]
v_pk_mul_f32 v[230:231], v[50:51], v[50:51]
v_pk_fma_f32 v[224:225], v[224:225], v[242:243], v[240:241] op_sel_hi:[1,0,0]
v_pk_fma_f32 v[226:227], v[226:227], v[242:243], v[240:241] op_sel_hi:[1,0,0]
v_pk_fma_f32 v[228:229], v[228:229], v[242:243], v[240:241] op_sel_hi:[1,0,0]
v_pk_fma_f32 v[230:231], v[230:231], v[242:243], v[240:241] op_sel_hi:[1,0,0]
v_pk_mul_f32 v[224:225], v[224:225], v[44:45]
v_pk_mul_f32 v[226:227], v[226:227], v[46:47]
v_pk_mul_f32 v[228:229], v[228:229], v[48:49]
v_pk_mul_f32 v[230:231], v[230:231], v[50:51]
v_mfma_f32_32x32x16_bf16 v[68:83], a[164:167], a[76:79], v[68:83]
ds_read_b128 a[160:163], v208 offset:26624
v_exp_f32 v224, v224
v_exp_f32 v225, v225
v_exp_f32 v226, v226
v_mfma_f32_32x32x16_bf16 v[68:83], a[168:171], a[80:83], v[68:83]
ds_read_b128 a[164:167], v208 offset:27648
s_mul_i32 s38, s24, 9216
v_exp_f32 v227, v227
v_fma_f32 v224, v224, v255, v255
v_fma_f32 v225, v225, v255, v255
v_mfma_f32_32x32x16_bf16 v[68:83], a[172:175], a[84:87], v[68:83]
ds_read_b128 a[168:171], v208 offset:28672
s_add_u32 m0, s38, 123904
v_fma_f32 v226, v226, v255, v255
v_fma_f32 v227, v227, v255, v255
v_rcp_f32 v224, v224
s_waitcnt lgkmcnt(3)
v_mfma_f32_32x32x16_bf16 v[68:83], a[144:147], a[88:91], v[68:83]
ds_read_b128 a[172:175], v208 offset:29696
v_rcp_f32 v225, v225
v_rcp_f32 v226, v226
v_mfma_f32_32x32x16_bf16 v[68:83], a[148:151], a[92:95], v[68:83]
ds_read_b128 a[144:147], v208 offset:30720
s_add_u32 s39, s38, s82
v_rcp_f32 v227, v227
v_mul_f32 v44, v44, v224
v_mul_f32 v45, v45, v225
v_mul_f32 v46, v46, v226
v_mul_f32 v47, v47, v227
v_mfma_f32_32x32x16_bf16 v[68:83], a[152:155], a[96:99], v[68:83]
ds_read_b128 a[148:151], v208 offset:31744
s_add_u32 s39, s39, 189440
v_exp_f32 v228, v228
v_exp_f32 v229, v229
v_mfma_f32_32x32x16_bf16 v[68:83], a[156:159], a[100:103], v[68:83]
ds_read_b128 a[152:155], v208 offset:32768
v_exp_f32 v230, v230
v_exp_f32 v231, v231
s_waitcnt lgkmcnt(3)
v_mfma_f32_32x32x16_bf16 v[68:83], a[160:163], a[104:107], v[68:83]
ds_read_b128 a[156:159], v208 offset:33792
buffer_load_dwordx4 v1, s[4:7], s39 offen offset:0 sc1 lds
v_fma_f32 v228, v228, v255, v255
v_fma_f32 v229, v229, v255, v255
v_fma_f32 v230, v230, v255, v255
v_mfma_f32_32x32x16_bf16 v[68:83], a[164:167], a[108:111], v[68:83]
ds_read_b128 a[160:163], v208 offset:34816
buffer_load_dwordx4 v1, s[4:7], s39 offen offset:1024 sc1 lds
v_fma_f32 v231, v231, v255, v255
v_rcp_f32 v228, v228
v_mfma_f32_32x32x16_bf16 v[68:83], a[168:171], a[112:115], v[68:83]
ds_read_b128 a[164:167], v208 offset:35840
v_rcp_f32 v229, v229
v_rcp_f32 v230, v230
v_mfma_f32_32x32x16_bf16 v[68:83], a[172:175], a[116:119], v[68:83]
ds_read_b128 a[168:171], v208 offset:36864
buffer_load_dwordx4 v1, s[4:7], s39 offen offset:2048 sc1 lds
v_rcp_f32 v231, v231
v_mul_f32 v48, v48, v228
s_waitcnt lgkmcnt(3)
v_mfma_f32_32x32x16_bf16 v[68:83], a[144:147], a[120:123], v[68:83]
ds_read_b128 a[172:175], v209 offset:0
buffer_load_dwordx4 v1, s[4:7], s39 offen offset:3072 sc1 lds
v_mul_f32 v49, v49, v229
v_mul_f32 v50, v50, v230
v_mul_f32 v51, v51, v231
v_mfma_f32_32x32x16_bf16 v[68:83], a[148:151], a[124:127], v[68:83]
ds_read_b128 a[144:147], v209 offset:1024
v_pk_mul_f32 v[216:217], v[52:53], v[52:53]
v_pk_mul_f32 v[218:219], v[54:55], v[54:55]
v_pk_mul_f32 v[220:221], v[56:57], v[56:57]
v_pk_mul_f32 v[222:223], v[58:59], v[58:59]
v_pk_fma_f32 v[216:217], v[216:217], v[242:243], v[240:241] op_sel_hi:[1,0,0]
v_pk_fma_f32 v[218:219], v[218:219], v[242:243], v[240:241] op_sel_hi:[1,0,0]
v_pk_fma_f32 v[220:221], v[220:221], v[242:243], v[240:241] op_sel_hi:[1,0,0]
v_pk_fma_f32 v[222:223], v[222:223], v[242:243], v[240:241] op_sel_hi:[1,0,0]
v_pk_mul_f32 v[216:217], v[216:217], v[52:53]
v_pk_mul_f32 v[218:219], v[218:219], v[54:55]
v_pk_mul_f32 v[220:221], v[220:221], v[56:57]
v_pk_mul_f32 v[222:223], v[222:223], v[58:59]
v_mfma_f32_32x32x16_bf16 v[68:83], a[152:155], a[128:131], v[68:83]
ds_read_b128 a[148:151], v209 offset:2048
s_add_u32 m0, m0, 4096
v_exp_f32 v216, v216
v_exp_f32 v217, v217
v_exp_f32 v218, v218
v_mfma_f32_32x32x16_bf16 v[68:83], a[156:159], a[132:135], v[68:83]
ds_read_b128 a[152:155], v209 offset:3072
s_add_u32 s39, s39, 4096
v_exp_f32 v219, v219
v_fma_f32 v216, v216, v255, v255
s_waitcnt lgkmcnt(3)
v_mfma_f32_32x32x16_bf16 v[68:83], a[160:163], a[136:139], v[68:83]
ds_read_b128 a[156:159], v209 offset:4096
v_fma_f32 v217, v217, v255, v255
v_fma_f32 v218, v218, v255, v255
v_fma_f32 v219, v219, v255, v255
v_rcp_f32 v216, v216
v_mfma_f32_32x32x16_bf16 v[68:83], a[164:167], a[140:143], v[68:83]
ds_read_b128 a[160:163], v209 offset:5120
buffer_load_dwordx4 v1, s[4:7], s39 offen offset:0 sc1 lds
v_rcp_f32 v217, v217
v_rcp_f32 v218, v218
v_mfma_f32_32x32x16_bf16 v[68:83], a[168:171], v[212:215], v[68:83]
ds_read_b128 a[164:167], v209 offset:6144
buffer_load_dwordx4 v1, s[4:7], s39 offen offset:1024 sc1 lds
v_rcp_f32 v219, v219
s_waitcnt vmcnt(6)
s_barrier
v_mfma_f32_32x32x16_bf16 v[84:99], a[172:175], a[0:3], 0
ds_read_b128 a[168:171], v209 offset:7168
buffer_load_dwordx4 a[176:179], v1, s[4:7], s52 offen offset:0 sc1
v_mul_f32 v52, v52, v216
v_mul_f32 v53, v53, v217
v_mul_f32 v54, v54, v218
v_mul_f32 v55, v55, v219
s_waitcnt lgkmcnt(3)
v_mfma_f32_32x32x16_bf16 v[84:99], a[144:147], a[4:7], v[84:99]
ds_read_b128 a[172:175], v209 offset:8192
buffer_load_dwordx4 v1, s[4:7], s39 offen offset:2048 sc1 lds
v_exp_f32 v220, v220
v_exp_f32 v221, v221
v_mfma_f32_32x32x16_bf16 v[84:99], a[148:151], a[8:11], v[84:99]
ds_read_b128 a[144:147], v209 offset:9216
buffer_load_dwordx4 v1, s[4:7], s39 offen offset:3072 sc1 lds
v_exp_f32 v222, v222
v_exp_f32 v223, v223
v_mfma_f32_32x32x16_bf16 v[84:99], a[152:155], a[12:15], v[84:99]
ds_read_b128 a[148:151], v209 offset:10240
buffer_load_dwordx4 a[180:183], v9, s[4:7], s52 offen offset:0 sc1
v_fma_f32 v220, v220, v255, v255
v_fma_f32 v221, v221, v255, v255
v_fma_f32 v222, v222, v255, v255
v_fma_f32 v223, v223, v255, v255
v_mfma_f32_32x32x16_bf16 v[84:99], a[156:159], a[16:19], v[84:99]
ds_read_b128 a[152:155], v209 offset:11264
s_add_u32 m0, m0, 4096
v_rcp_f32 v220, v220
s_waitcnt lgkmcnt(3)
v_mfma_f32_32x32x16_bf16 v[84:99], a[160:163], a[20:23], v[84:99]
ds_read_b128 a[156:159], v209 offset:12288
s_add_u32 s39, s39, 4096
v_rcp_f32 v221, v221
v_rcp_f32 v222, v222
v_mfma_f32_32x32x16_bf16 v[84:99], a[164:167], a[24:27], v[84:99]
ds_read_b128 a[160:163], v209 offset:13312
buffer_load_dwordx4 a[184:187], v1, s[4:7], s52 offen offset:1024 sc1
v_rcp_f32 v223, v223
v_mul_f32 v56, v56, v220
v_mul_f32 v57, v57, v221
v_mul_f32 v58, v58, v222
v_mul_f32 v59, v59, v223
v_mfma_f32_32x32x16_bf16 v[84:99], a[168:171], a[28:31], v[84:99]
ds_read_b128 a[164:167], v209 offset:14336
buffer_load_dwordx4 v1, s[4:7], s39 offen offset:0 sc1 lds
v_pk_mul_f32 v[224:225], v[60:61], v[60:61]
v_pk_mul_f32 v[226:227], v[62:63], v[62:63]
v_pk_mul_f32 v[228:229], v[64:65], v[64:65]
v_pk_mul_f32 v[230:231], v[66:67], v[66:67]
v_pk_fma_f32 v[224:225], v[224:225], v[242:243], v[240:241] op_sel_hi:[1,0,0]
v_pk_fma_f32 v[226:227], v[226:227], v[242:243], v[240:241] op_sel_hi:[1,0,0]
v_pk_fma_f32 v[228:229], v[228:229], v[242:243], v[240:241] op_sel_hi:[1,0,0]
v_pk_fma_f32 v[230:231], v[230:231], v[242:243], v[240:241] op_sel_hi:[1,0,0]
v_pk_mul_f32 v[224:225], v[224:225], v[60:61]
v_pk_mul_f32 v[226:227], v[226:227], v[62:63]
v_pk_mul_f32 v[228:229], v[228:229], v[64:65]
v_pk_mul_f32 v[230:231], v[230:231], v[66:67]
v_mfma_f32_32x32x16_bf16 v[84:99], a[172:175], a[32:35], v[84:99]
ds_read_b128 a[168:171], v209 offset:15360
s_lshl_b32 s38, s24, 8
v_exp_f32 v224, v224
v_exp_f32 v225, v225
v_exp_f32 v226, v226
s_waitcnt lgkmcnt(3)
v_mfma_f32_32x32x16_bf16 v[84:99], a[144:147], a[36:39], v[84:99]
ds_read_b128 a[172:175], v209 offset:16384
v_exp_f32 v227, v227
v_fma_f32 v224, v224, v255, v255
v_fma_f32 v225, v225, v255, v255
v_fma_f32 v226, v226, v255, v255
v_mfma_f32_32x32x16_bf16 v[84:99], a[148:151], a[40:43], v[84:99]
ds_read_b128 a[144:147], v209 offset:17408
buffer_load_dwordx4 a[188:191], v9, s[4:7], s52 offen offset:1024 sc1
s_add_u32 m0, s38, 160768
v_fma_f32 v227, v227, v255, v255
v_rcp_f32 v224, v224
v_mfma_f32_32x32x16_bf16 v[84:99], a[152:155], a[44:47], v[84:99]
ds_read_b128 a[148:151], v209 offset:18432
s_add_u32 s39, s38, s82
v_rcp_f32 v225, v225
v_rcp_f32 v226, v226
v_mfma_f32_32x32x16_bf16 v[84:99], a[156:159], a[48:51], v[84:99]
ds_read_b128 a[152:155], v209 offset:19456
v_rcp_f32 v227, v227
v_mul_f32 v60, v60, v224
s_waitcnt lgkmcnt(3)
v_mfma_f32_32x32x16_bf16 v[84:99], a[160:163], a[52:55], v[84:99]
ds_read_b128 a[156:159], v209 offset:20480
buffer_load_dwordx4 a[192:195], v1, s[4:7], s52 offen offset:2048 sc1
s_add_u32 s39, s39, 226304
v_mul_f32 v61, v61, v225
v_mul_f32 v62, v62, v226
v_mul_f32 v63, v63, v227
v_mfma_f32_32x32x16_bf16 v[84:99], a[164:167], a[56:59], v[84:99]
ds_read_b128 a[160:163], v209 offset:21504
s_mov_b64 exec, 0xffff
buffer_load_dwordx4 v1, s[4:7], s39 offen sc1 lds
s_mov_b64 exec, -1
v_exp_f32 v228, v228
v_mfma_f32_32x32x16_bf16 v[84:99], a[168:171], a[60:63], v[84:99]
ds_read_b128 a[164:167], v209 offset:22528
v_exp_f32 v229, v229
v_exp_f32 v230, v230
v_mfma_f32_32x32x16_bf16 v[84:99], a[172:175], a[64:67], v[84:99]
ds_read_b128 a[168:171], v209 offset:23552
v_exp_f32 v231, v231
v_fma_f32 v228, v228, v255, v255
v_fma_f32 v229, v229, v255, v255
s_waitcnt lgkmcnt(3)
v_mfma_f32_32x32x16_bf16 v[84:99], a[144:147], a[68:71], v[84:99]
ds_read_b128 a[172:175], v209 offset:24576
buffer_load_dwordx4 a[196:199], v9, s[4:7], s52 offen offset:2048 sc1
v_fma_f32 v230, v230, v255, v255
v_fma_f32 v231, v231, v255, v255
v_rcp_f32 v228, v228
v_mfma_f32_32x32x16_bf16 v[84:99], a[148:151], a[72:75], v[84:99]
ds_read_b128 a[144:147], v209 offset:25600
v_rcp_f32 v229, v229
v_rcp_f32 v230, v230
v_mfma_f32_32x32x16_bf16 v[84:99], a[152:155], a[76:79], v[84:99]
ds_read_b128 a[148:151], v209 offset:26624
s_mul_i32 s38, s24, 9216
v_rcp_f32 v231, v231
v_mul_f32 v64, v64, v228
v_mul_f32 v65, v65, v229
v_mul_f32 v66, v66, v230
v_mul_f32 v67, v67, v231
v_mfma_f32_32x32x16_bf16 v[84:99], a[156:159], a[80:83], v[84:99]
ds_read_b128 a[152:155], v209 offset:27648
buffer_load_dwordx4 a[200:203], v1, s[4:7], s52 offen offset:3072 sc1
s_add_u32 m0, s38, 0
v_pk_mul_f32 v[216:217], v[68:69], v[68:69]
v_pk_mul_f32 v[218:219], v[70:71], v[70:71]
v_pk_mul_f32 v[220:221], v[72:73], v[72:73]
v_pk_mul_f32 v[222:223], v[74:75], v[74:75]
v_pk_fma_f32 v[216:217], v[216:217], v[242:243], v[240:241] op_sel_hi:[1,0,0]
v_pk_fma_f32 v[218:219], v[218:219], v[242:243], v[240:241] op_sel_hi:[1,0,0]
v_pk_fma_f32 v[220:221], v[220:221], v[242:243], v[240:241] op_sel_hi:[1,0,0]
v_pk_fma_f32 v[222:223], v[222:223], v[242:243], v[240:241] op_sel_hi:[1,0,0]
v_pk_mul_f32 v[216:217], v[216:217], v[68:69]
v_pk_mul_f32 v[218:219], v[218:219], v[70:71]
v_pk_mul_f32 v[220:221], v[220:221], v[72:73]
v_pk_mul_f32 v[222:223], v[222:223], v[74:75]
s_waitcnt lgkmcnt(3)
v_mfma_f32_32x32x16_bf16 v[84:99], a[160:163], a[84:87], v[84:99]
ds_read_b128 a[156:159], v209 offset:28672
v_exp_f32 v216, v216
v_exp_f32 v217, v217
v_exp_f32 v218, v218
v_mfma_f32_32x32x16_bf16 v[84:99], a[164:167], a[88:91], v[84:99]
ds_read_b128 a[160:163], v209 offset:29696
s_add_u32 s39, s38, s82
v_exp_f32 v219, v219
v_fma_f32 v216, v216, v255, v255
v_fma_f32 v217, v217, v255, v255
v_mfma_f32_32x32x16_bf16 v[84:99], a[168:171], a[92:95], v[84:99]
ds_read_b128 a[164:167], v209 offset:30720
s_add_u32 s39, s39, 227328
v_fma_f32 v218, v218, v255, v255
v_fma_f32 v219, v219, v255, v255
v_rcp_f32 v216, v216
v_mfma_f32_32x32x16_bf16 v[84:99], a[172:175], a[96:99], v[84:99]
ds_read_b128 a[168:171], v209 offset:31744
buffer_load_dwordx4 a[204:207], v9, s[4:7], s52 offen offset:3072 sc1
v_rcp_f32 v217, v217
s_waitcnt lgkmcnt(3)
v_mfma_f32_32x32x16_bf16 v[84:99], a[144:147], a[100:103], v[84:99]
ds_read_b128 a[172:175], v209 offset:32768
buffer_load_dwordx4 v1, s[4:7], s39 offen offset:0 sc1 lds
v_rcp_f32 v218, v218
v_rcp_f32 v219, v219
v_mfma_f32_32x32x16_bf16 v[84:99], a[148:151], a[104:107], v[84:99]
ds_read_b128 a[144:147], v209 offset:33792
buffer_load_dwordx4 v1, s[4:7], s39 offen offset:1024 sc1 lds
v_mul_f32 v68, v68, v216
v_mul_f32 v69, v69, v217
v_mul_f32 v70, v70, v218
v_mul_f32 v71, v71, v219
v_mfma_f32_32x32x16_bf16 v[84:99], a[152:155], a[108:111], v[84:99]
ds_read_b128 a[148:151], v209 offset:34816
s_add_u32 s52, s52, 4096
v_exp_f32 v220, v220
v_exp_f32 v221, v221
v_mfma_f32_32x32x16_bf16 v[84:99], a[156:159], a[112:115], v[84:99]
ds_read_b128 a[152:155], v209 offset:35840
buffer_load_dwordx4 v1, s[4:7], s39 offen offset:2048 sc1 lds
v_exp_f32 v222, v222
s_waitcnt lgkmcnt(3)
v_mfma_f32_32x32x16_bf16 v[84:99], a[160:163], a[116:119], v[84:99]
ds_read_b128 a[156:159], v209 offset:36864
buffer_load_dwordx4 v1, s[4:7], s39 offen offset:3072 sc1 lds
v_exp_f32 v223, v223
v_fma_f32 v220, v220, v255, v255
v_fma_f32 v221, v221, v255, v255
v_mfma_f32_32x32x16_bf16 v[84:99], a[164:167], a[120:123], v[84:99]
ds_read_b128 a[160:163], v206 offset:0
v_fma_f32 v222, v222, v255, v255
v_fma_f32 v223, v223, v255, v255
v_rcp_f32 v220, v220
v_mfma_f32_32x32x16_bf16 v[84:99], a[168:171], a[124:127], v[84:99]
ds_read_b128 a[164:167], v206 offset:1024
buffer_load_dwordx4 a[208:211], v1, s[4:7], s52 offen offset:0 sc1
s_add_u32 m0, m0, 4096
v_rcp_f32 v221, v221
v_mfma_f32_32x32x16_bf16 v[84:99], a[172:175], a[128:131], v[84:99]
ds_read_b128 a[168:171], v206 offset:2048
s_add_u32 s39, s39, 4096
v_rcp_f32 v222, v222
v_rcp_f32 v223, v223
s_waitcnt lgkmcnt(3)
v_mfma_f32_32x32x16_bf16 v[84:99], a[144:147], a[132:135], v[84:99]
ds_read_b128 a[172:175], v206 offset:3072
v_mul_f32 v72, v72, v220
v_mul_f32 v73, v73, v221
v_mul_f32 v74, v74, v222
v_mul_f32 v75, v75, v223
v_mfma_f32_32x32x16_bf16 v[84:99], a[148:151], a[136:139], v[84:99]
ds_read_b128 a[144:147], v206 offset:4096
buffer_load_dwordx4 v1, s[4:7], s39 offen offset:0 sc1 lds
buffer_load_dwordx4 a[212:215], v9, s[4:7], s52 offen offset:0 sc1
v_pk_mul_f32 v[224:225], v[76:77], v[76:77]
v_pk_mul_f32 v[226:227], v[78:79], v[78:79]
v_pk_mul_f32 v[228:229], v[80:81], v[80:81]
v_pk_mul_f32 v[230:231], v[82:83], v[82:83]
v_pk_fma_f32 v[224:225], v[224:225], v[242:243], v[240:241] op_sel_hi:[1,0,0]
v_pk_fma_f32 v[226:227], v[226:227], v[242:243], v[240:241] op_sel_hi:[1,0,0]
v_pk_fma_f32 v[228:229], v[228:229], v[242:243], v[240:241] op_sel_hi:[1,0,0]
v_pk_fma_f32 v[230:231], v[230:231], v[242:243], v[240:241] op_sel_hi:[1,0,0]
v_pk_mul_f32 v[224:225], v[224:225], v[76:77]
v_pk_mul_f32 v[226:227], v[226:227], v[78:79]
v_pk_mul_f32 v[228:229], v[228:229], v[80:81]
v_pk_mul_f32 v[230:231], v[230:231], v[82:83]
v_mfma_f32_32x32x16_bf16 v[84:99], a[152:155], a[140:143], v[84:99]
ds_read_b128 a[148:151], v206 offset:5120
buffer_load_dwordx4 v1, s[4:7], s39 offen offset:1024 sc1 lds
v_exp_f32 v224, v224
v_exp_f32 v225, v225
v_exp_f32 v226, v226
v_mfma_f32_32x32x16_bf16 v[84:99], a[156:159], v[212:215], v[84:99]
ds_read_b128 a[152:155], v206 offset:6144
v_exp_f32 v227, v227
v_fma_f32 v224, v224, v255, v255
v_fma_f32 v225, v225, v255, v255
s_waitcnt vmcnt(11)
s_barrier
s_waitcnt lgkmcnt(3)
v_mfma_f32_32x32x16_bf16 v[100:115], a[160:163], a[0:3], 0
ds_read_b128 a[156:159], v206 offset:7168
buffer_load_dwordx4 v1, s[4:7], s39 offen offset:2048 sc1 lds
v_fma_f32 v226, v226, v255, v255
v_fma_f32 v227, v227, v255, v255
v_rcp_f32 v224, v224
v_mfma_f32_32x32x16_bf16 v[100:115], a[164:167], a[4:7], v[100:115]
ds_read_b128 a[160:163], v206 offset:8192
buffer_load_dwordx4 v1, s[4:7], s39 offen offset:3072 sc1 lds
buffer_load_dwordx4 a[216:219], v1, s[4:7], s52 offen offset:1024 sc1
v_rcp_f32 v225, v225
v_rcp_f32 v226, v226
v_mfma_f32_32x32x16_bf16 v[100:115], a[168:171], a[8:11], v[100:115]
ds_read_b128 a[164:167], v206 offset:9216
v_rcp_f32 v227, v227
v_mul_f32 v76, v76, v224
v_mul_f32 v77, v77, v225
v_mul_f32 v78, v78, v226
v_mul_f32 v79, v79, v227
v_mfma_f32_32x32x16_bf16 v[100:115], a[172:175], a[12:15], v[100:115]
ds_read_b128 a[168:171], v206 offset:10240
s_add_u32 m0, m0, 4096
v_exp_f32 v228, v228
s_waitcnt lgkmcnt(3)
v_mfma_f32_32x32x16_bf16 v[100:115], a[144:147], a[16:19], v[100:115]
ds_read_b128 a[172:175], v206 offset:11264
buffer_load_dwordx4 a[220:223], v9, s[4:7], s52 offen offset:1024 sc1
s_add_u32 s39, s39, 4096
v_exp_f32 v229, v229
v_exp_f32 v230, v230
v_mfma_f32_32x32x16_bf16 v[100:115], a[148:151], a[20:23], v[100:115]
ds_read_b128 a[144:147], v206 offset:12288
v_exp_f32 v231, v231
v_fma_f32 v228, v228, v255, v255
v_fma_f32 v229, v229, v255, v255
v_fma_f32 v230, v230, v255, v255
v_mfma_f32_32x32x16_bf16 v[100:115], a[152:155], a[24:27], v[100:115]
ds_read_b128 a[148:151], v206 offset:13312
buffer_load_dwordx4 v1, s[4:7], s39 offen offset:0 sc1 lds
v_fma_f32 v231, v231, v255, v255
v_rcp_f32 v228, v228
v_mfma_f32_32x32x16_bf16 v[100:115], a[156:159], a[28:31], v[100:115]
ds_read_b128 a[152:155], v206 offset:14336
buffer_load_dwordx4 a[224:227], v1, s[4:7], s52 offen offset:2048 sc1
s_lshl_b32 s38, s24, 8
v_rcp_f32 v229, v229
s_waitcnt lgkmcnt(3)
v_mfma_f32_32x32x16_bf16 v[100:115], a[160:163], a[32:35], v[100:115]
ds_read_b128 a[156:159], v206 offset:15360
v_rcp_f32 v230, v230
v_rcp_f32 v231, v231
v_mul_f32 v80, v80, v228
v_mfma_f32_32x32x16_bf16 v[100:115], a[164:167], a[36:39], v[100:115]
ds_read_b128 a[160:163], v206 offset:16384
s_add_u32 m0, s38, 36864
v_mul_f32 v81, v81, v229
v_mul_f32 v82, v82, v230
v_mul_f32 v83, v83, v231
v_mfma_f32_32x32x16_bf16 v[100:115], a[168:171], a[40:43], v[100:115]
ds_read_b128 a[164:167], v206 offset:17408
s_add_u32 s39, s38, s82
v_pk_mul_f32 v[216:217], v[84:85], v[84:85]
v_pk_mul_f32 v[218:219], v[86:87], v[86:87]
v_pk_mul_f32 v[220:221], v[88:89], v[88:89]
v_pk_mul_f32 v[222:223], v[90:91], v[90:91]
v_pk_fma_f32 v[216:217], v[216:217], v[242:243], v[240:241] op_sel_hi:[1,0,0]
v_pk_fma_f32 v[218:219], v[218:219], v[242:243], v[240:241] op_sel_hi:[1,0,0]
v_pk_fma_f32 v[220:221], v[220:221], v[242:243], v[240:241] op_sel_hi:[1,0,0]
v_pk_fma_f32 v[222:223], v[222:223], v[242:243], v[240:241] op_sel_hi:[1,0,0]
v_pk_mul_f32 v[216:217], v[216:217], v[84:85]
v_pk_mul_f32 v[218:219], v[218:219], v[86:87]
v_pk_mul_f32 v[220:221], v[220:221], v[88:89]
v_pk_mul_f32 v[222:223], v[222:223], v[90:91]
v_mfma_f32_32x32x16_bf16 v[100:115], a[172:175], a[44:47], v[100:115]
ds_read_b128 a[168:171], v206 offset:18432
buffer_load_dwordx4 a[228:231], v9, s[4:7], s52 offen offset:2048 sc1
v_exp_f32 v216, v216
v_exp_f32 v217, v217
v_exp_f32 v218, v218
s_waitcnt lgkmcnt(3)
v_mfma_f32_32x32x16_bf16 v[100:115], a[144:147], a[48:51], v[100:115]
ds_read_b128 a[172:175], v206 offset:19456
s_add_u32 s39, s39, 264192
v_exp_f32 v219, v219
v_fma_f32 v216, v216, v255, v255
v_fma_f32 v217, v217, v255, v255
v_mfma_f32_32x32x16_bf16 v[100:115], a[148:151], a[52:55], v[100:115]
ds_read_b128 a[144:147], v206 offset:20480
s_mov_b64 exec, 0xffff
buffer_load_dwordx4 v1, s[4:7], s39 offen sc1 lds
s_mov_b64 exec, -1
v_fma_f32 v218, v218, v255, v255
v_fma_f32 v219, v219, v255, v255
v_rcp_f32 v216, v216
v_mfma_f32_32x32x16_bf16 v[100:115], a[152:155], a[56:59], v[100:115]
ds_read_b128 a[148:151], v206 offset:21504
buffer_load_dwordx4 a[232:235], v1, s[4:7], s52 offen offset:3072 sc1
v_rcp_f32 v217, v217
v_rcp_f32 v218, v218
v_mfma_f32_32x32x16_bf16 v[100:115], a[156:159], a[60:63], v[100:115]
ds_read_b128 a[152:155], v206 offset:22528
v_rcp_f32 v219, v219
v_mul_f32 v84, v84, v216
v_mul_f32 v85, v85, v217
v_mul_f32 v86, v86, v218
v_mul_f32 v87, v87, v219
s_waitcnt lgkmcnt(3)
v_mfma_f32_32x32x16_bf16 v[100:115], a[160:163], a[64:67], v[100:115]
ds_read_b128 a[156:159], v206 offset:23552
v_exp_f32 v220, v220
v_exp_f32 v221, v221
v_mfma_f32_32x32x16_bf16 v[100:115], a[164:167], a[68:71], v[100:115]
ds_read_b128 a[160:163], v206 offset:24576
v_exp_f32 v222, v222
v_exp_f32 v223, v223
v_mfma_f32_32x32x16_bf16 v[100:115], a[168:171], a[72:75], v[100:115]
ds_read_b128 a[164:167], v206 offset:25600
buffer_load_dwordx4 a[236:239], v9, s[4:7], s52 offen offset:3072 sc1
s_mul_i32 s38, s24, 9216
v_fma_f32 v220, v220, v255, v255
v_fma_f32 v221, v221, v255, v255
v_fma_f32 v222, v222, v255, v255
v_mfma_f32_32x32x16_bf16 v[100:115], a[172:175], a[76:79], v[100:115]
ds_read_b128 a[168:171], v206 offset:26624
s_add_u32 m0, s38, 37888
v_fma_f32 v223, v223, v255, v255
v_rcp_f32 v220, v220
s_waitcnt lgkmcnt(3)
v_mfma_f32_32x32x16_bf16 v[100:115], a[144:147], a[80:83], v[100:115]
ds_read_b128 a[172:175], v206 offset:27648
v_rcp_f32 v221, v221
v_rcp_f32 v222, v222
v_mfma_f32_32x32x16_bf16 v[100:115], a[148:151], a[84:87], v[100:115]
ds_read_b128 a[144:147], v206 offset:28672
s_add_u32 s39, s38, s82
s_add_u32 s52, s52, 4096
v_rcp_f32 v223, v223
v_mul_f32 v88, v88, v220
v_mfma_f32_32x32x16_bf16 v[100:115], a[152:155], a[88:91], v[100:115]
ds_read_b128 a[148:151], v206 offset:29696
s_add_u32 s39, s39, 265216
v_mul_f32 v89, v89, v221
v_mul_f32 v90, v90, v222
v_mul_f32 v91, v91, v223
v_mfma_f32_32x32x16_bf16 v[100:115], a[156:159], a[92:95], v[100:115]
ds_read_b128 a[152:155], v206 offset:30720
v_pk_mul_f32 v[224:225], v[92:93], v[92:93]
v_pk_mul_f32 v[226:227], v[94:95], v[94:95]
v_pk_mul_f32 v[228:229], v[96:97], v[96:97]
v_pk_mul_f32 v[230:231], v[98:99], v[98:99]
v_pk_fma_f32 v[224:225], v[224:225], v[242:243], v[240:241] op_sel_hi:[1,0,0]
v_pk_fma_f32 v[226:227], v[226:227], v[242:243], v[240:241] op_sel_hi:[1,0,0]
v_pk_fma_f32 v[228:229], v[228:229], v[242:243], v[240:241] op_sel_hi:[1,0,0]
v_pk_fma_f32 v[230:231], v[230:231], v[242:243], v[240:241] op_sel_hi:[1,0,0]
v_pk_mul_f32 v[224:225], v[224:225], v[92:93]
v_pk_mul_f32 v[226:227], v[226:227], v[94:95]
v_pk_mul_f32 v[228:229], v[228:229], v[96:97]
v_pk_mul_f32 v[230:231], v[230:231], v[98:99]
s_waitcnt lgkmcnt(3)
v_mfma_f32_32x32x16_bf16 v[100:115], a[160:163], a[96:99], v[100:115]
ds_read_b128 a[156:159], v206 offset:31744
buffer_load_dwordx4 v1, s[4:7], s39 offen offset:0 sc1 lds
v_exp_f32 v224, v224
v_exp_f32 v225, v225
v_exp_f32 v226, v226
v_mfma_f32_32x32x16_bf16 v[100:115], a[164:167], a[100:103], v[100:115]
ds_read_b128 a[160:163], v206 offset:32768
buffer_load_dwordx4 v1, s[4:7], s39 offen offset:1024 sc1 lds
buffer_load_dwordx4 a[240:243], v1, s[4:7], s52 offen offset:0 sc1
v_exp_f32 v227, v227
v_fma_f32 v224, v224, v255, v255
v_mfma_f32_32x32x16_bf16 v[100:115], a[168:171], a[104:107], v[100:115]
ds_read_b128 a[164:167], v206 offset:33792
v_fma_f32 v225, v225, v255, v255
v_fma_f32 v226, v226, v255, v255
v_fma_f32 v227, v227, v255, v255
v_rcp_f32 v224, v224
v_mfma_f32_32x32x16_bf16 v[100:115], a[172:175], a[108:111], v[100:115]
ds_read_b128 a[168:171], v206 offset:34816
buffer_load_dwordx4 v1, s[4:7], s39 offen offset:2048 sc1 lds
v_rcp_f32 v225, v225
s_waitcnt lgkmcnt(3)
v_mfma_f32_32x32x16_bf16 v[100:115], a[144:147], a[112:115], v[100:115]
ds_read_b128 a[172:175], v206 offset:35840
buffer_load_dwordx4 v1, s[4:7], s39 offen offset:3072 sc1 lds
buffer_load_dwordx4 a[244:247], v9, s[4:7], s52 offen offset:0 sc1
v_rcp_f32 v226, v226
v_rcp_f32 v227, v227
v_mfma_f32_32x32x16_bf16 v[100:115], a[148:151], a[116:119], v[100:115]
ds_read_b128 a[144:147], v206 offset:36864
v_mul_f32 v92, v92, v224
v_mul_f32 v93, v93, v225
v_mul_f32 v94, v94, v226
v_mul_f32 v95, v95, v227
v_mfma_f32_32x32x16_bf16 v[100:115], a[152:155], a[120:123], v[100:115]
ds_read_b128 a[148:151], v207 offset:0
s_add_u32 m0, m0, 4096
v_exp_f32 v228, v228
v_exp_f32 v229, v229
v_mfma_f32_32x32x16_bf16 v[100:115], a[156:159], a[124:127], v[100:115]
ds_read_b128 a[152:155], v207 offset:1024
s_add_u32 s39, s39, 4096
v_exp_f32 v230, v230
s_waitcnt lgkmcnt(3)
v_mfma_f32_32x32x16_bf16 v[100:115], a[160:163], a[128:131], v[100:115]
ds_read_b128 a[156:159], v207 offset:2048
buffer_load_dwordx4 a[248:251], v1, s[4:7], s52 offen offset:1024 sc1
v_exp_f32 v231, v231
v_fma_f32 v228, v228, v255, v255
v_fma_f32 v229, v229, v255, v255
v_mfma_f32_32x32x16_bf16 v[100:115], a[164:167], a[132:135], v[100:115]
ds_read_b128 a[160:163], v207 offset:3072
buffer_load_dwordx4 v1, s[4:7], s39 offen offset:0 sc1 lds
v_fma_f32 v230, v230, v255, v255
v_fma_f32 v231, v231, v255, v255
v_rcp_f32 v228, v228
v_mfma_f32_32x32x16_bf16 v[100:115], a[168:171], a[136:139], v[100:115]
ds_read_b128 a[164:167], v207 offset:4096
buffer_load_dwordx4 v1, s[4:7], s39 offen offset:1024 sc1 lds
v_rcp_f32 v229, v229
v_rcp_f32 v230, v230
v_mfma_f32_32x32x16_bf16 v[100:115], a[172:175], a[140:143], v[100:115]
ds_read_b128 a[168:171], v207 offset:5120
buffer_load_dwordx4 a[252:255], v9, s[4:7], s52 offen offset:1024 sc1
v_rcp_f32 v231, v231
v_mul_f32 v96, v96, v228
v_mul_f32 v97, v97, v229
v_mul_f32 v98, v98, v230
v_mul_f32 v99, v99, v231
s_waitcnt lgkmcnt(3)
v_mfma_f32_32x32x16_bf16 v[100:115], a[144:147], v[212:215], v[100:115]
ds_read_b128 a[172:175], v207 offset:6144
buffer_load_dwordx4 v1, s[4:7], s39 offen offset:2048 sc1 lds
s_waitcnt vmcnt(13)
s_barrier
v_mfma_f32_32x32x16_bf16 v[116:131], a[148:151], a[0:3], 0
ds_read_b128 a[144:147], v207 offset:7168
buffer_load_dwordx4 v1, s[4:7], s39 offen offset:3072 sc1 lds
v_mfma_f32_32x32x16_bf16 v[116:131], a[152:155], a[4:7], v[116:131]
ds_read_b128 a[148:151], v207 offset:8192
v_mfma_f32_32x32x16_bf16 v[116:131], a[156:159], a[8:11], v[116:131]
ds_read_b128 a[152:155], v207 offset:9216
s_add_u32 m0, m0, 4096
s_mov_b32 s37, L_c4-L_pc
s_waitcnt lgkmcnt(3)
v_mfma_f32_32x32x16_bf16 v[116:131], a[160:163], a[12:15], v[116:131]
ds_read_b128 a[156:159], v207 offset:10240
s_add_u32 s39, s39, 4096
v_mfma_f32_32x32x16_bf16 v[116:131], a[164:167], a[16:19], v[116:131]
ds_read_b128 a[160:163], v207 offset:11264
v_pk_mul_f32 v[216:217], v[100:101], v[100:101]
v_pk_mul_f32 v[218:219], v[102:103], v[102:103]
v_pk_mul_f32 v[220:221], v[104:105], v[104:105]
v_pk_mul_f32 v[222:223], v[106:107], v[106:107]
v_pk_fma_f32 v[216:217], v[216:217], v[242:243], v[240:241] op_sel_hi:[1,0,0]
v_pk_fma_f32 v[218:219], v[218:219], v[242:243], v[240:241] op_sel_hi:[1,0,0]
v_pk_fma_f32 v[220:221], v[220:221], v[242:243], v[240:241] op_sel_hi:[1,0,0]
v_pk_fma_f32 v[222:223], v[222:223], v[242:243], v[240:241] op_sel_hi:[1,0,0]
v_pk_mul_f32 v[216:217], v[216:217], v[100:101]
v_pk_mul_f32 v[218:219], v[218:219], v[102:103]
v_pk_mul_f32 v[220:221], v[220:221], v[104:105]
v_pk_mul_f32 v[222:223], v[222:223], v[106:107]
v_mfma_f32_32x32x16_bf16 v[116:131], a[168:171], a[20:23], v[116:131]
ds_read_b128 a[164:167], v207 offset:12288
buffer_load_dwordx4 v1, s[4:7], s39 offen offset:0 sc1 lds
buffer_load_dword v15, v14, s[88:91], s37 offen
v_exp_f32 v216, v216
v_exp_f32 v217, v217
v_exp_f32 v218, v218
v_exp_f32 v219, v219
v_mfma_f32_32x32x16_bf16 v[116:131], a[172:175], a[24:27], v[116:131]
ds_read_b128 a[168:171], v207 offset:13312
s_lshl_b32 s38, s24, 8
v_fma_f32 v216, v216, v255, v255
v_fma_f32 v217, v217, v255, v255
v_fma_f32 v218, v218, v255, v255
v_fma_f32 v219, v219, v255, v255
v_rcp_f32 v216, v216
s_waitcnt lgkmcnt(3)
v_mfma_f32_32x32x16_bf16 v[116:131], a[144:147], a[28:31], v[116:131]
ds_read_b128 a[172:175], v207 offset:14336
v_rcp_f32 v217, v217
v_rcp_f32 v218, v218
v_mfma_f32_32x32x16_bf16 v[116:131], a[148:151], a[32:35], v[116:131]
ds_read_b128 a[144:147], v207 offset:15360
s_add_u32 m0, s38, 74752
v_rcp_f32 v219, v219
v_mul_f32 v100, v100, v216
v_mul_f32 v101, v101, v217
v_mul_f32 v102, v102, v218
v_mul_f32 v103, v103, v219
v_mfma_f32_32x32x16_bf16 v[116:131], a[152:155], a[36:39], v[116:131]
ds_read_b128 a[148:151], v207 offset:16384
s_add_u32 s39, s38, s82
v_exp_f32 v220, v220
v_exp_f32 v221, v221
v_mfma_f32_32x32x16_bf16 v[116:131], a[156:159], a[40:43], v[116:131]
ds_read_b128 a[152:155], v207 offset:17408
v_exp_f32 v222, v222
v_exp_f32 v223, v223
v_fma_f32 v220, v220, v255, v255
v_fma_f32 v221, v221, v255, v255
s_waitcnt lgkmcnt(3)
v_mfma_f32_32x32x16_bf16 v[116:131], a[160:163], a[44:47], v[116:131]
ds_read_b128 a[156:159], v207 offset:18432
s_add_u32 s39, s39, 302080
v_fma_f32 v222, v222, v255, v255
v_fma_f32 v223, v223, v255, v255
v_rcp_f32 v220, v220
v_rcp_f32 v221, v221
v_mfma_f32_32x32x16_bf16 v[116:131], a[164:167], a[48:51], v[116:131]
ds_read_b128 a[160:163], v207 offset:19456
s_mov_b64 exec, 0xffff
buffer_load_dwordx4 v1, s[4:7], s39 offen sc1 lds
s_mov_b64 exec, -1
v_rcp_f32 v222, v222
v_rcp_f32 v223, v223
v_mul_f32 v104, v104, v220
v_mul_f32 v105, v105, v221
v_mul_f32 v106, v106, v222
v_mul_f32 v107, v107, v223
v_mfma_f32_32x32x16_bf16 v[116:131], a[168:171], a[52:55], v[116:131]
ds_read_b128 a[164:167], v207 offset:20480
v_pk_add_f32 v[196:197], v[36:37], v[38:39]
v_pk_mul_f32 v[198:199], v[36:37], v[36:37]
v_pk_add_f32 v[200:201], v[40:41], v[42:43]
v_pk_mul_f32 v[202:203], v[38:39], v[38:39]
v_pk_fma_f32 v[198:199], v[40:41], v[40:41], v[198:199]
v_pk_fma_f32 v[202:203], v[42:43], v[42:43], v[202:203]
v_pk_add_f32 v[196:197], v[196:197], v[44:45]
v_pk_fma_f32 v[198:199], v[44:45], v[44:45], v[198:199]
v_pk_add_f32 v[200:201], v[200:201], v[46:47]
v_pk_fma_f32 v[202:203], v[46:47], v[46:47], v[202:203]
v_pk_add_f32 v[196:197], v[196:197], v[48:49]
v_pk_fma_f32 v[198:199], v[48:49], v[48:49], v[198:199]
v_pk_add_f32 v[200:201], v[200:201], v[50:51]
v_pk_fma_f32 v[202:203], v[50:51], v[50:51], v[202:203]
v_pk_add_f32 v[196:197], v[196:197], v[52:53]
v_pk_fma_f32 v[198:199], v[52:53], v[52:53], v[198:199]
v_pk_add_f32 v[200:201], v[200:201], v[54:55]
v_pk_fma_f32 v[202:203], v[54:55], v[54:55], v[202:203]
v_pk_add_f32 v[196:197], v[196:197], v[56:57]
v_pk_fma_f32 v[198:199], v[56:57], v[56:57], v[198:199]
v_pk_add_f32 v[200:201], v[200:201], v[58:59]
v_pk_fma_f32 v[202:203], v[58:59], v[58:59], v[202:203]
v_pk_add_f32 v[196:197], v[196:197], v[60:61]
v_pk_fma_f32 v[198:199], v[60:61], v[60:61], v[198:199]
v_pk_add_f32 v[200:201], v[200:201], v[62:63]
v_pk_fma_f32 v[202:203], v[62:63], v[62:63], v[202:203]
v_pk_add_f32 v[196:197], v[196:197], v[64:65]
v_pk_fma_f32 v[198:199], v[64:65], v[64:65], v[198:199]
v_pk_add_f32 v[200:201], v[200:201], v[66:67]
v_pk_fma_f32 v[202:203], v[66:67], v[66:67], v[202:203]
v_pk_add_f32 v[196:197], v[196:197], v[68:69]
v_pk_fma_f32 v[198:199], v[68:69], v[68:69], v[198:199]
v_pk_add_f32 v[200:201], v[200:201], v[70:71]
v_pk_fma_f32 v[202:203], v[70:71], v[70:71], v[202:203]
v_pk_add_f32 v[196:197], v[196:197], v[72:73]
v_pk_fma_f32 v[198:199], v[72:73], v[72:73], v[198:199]
v_pk_add_f32 v[200:201], v[200:201], v[74:75]
v_pk_fma_f32 v[202:203], v[74:75], v[74:75], v[202:203]
v_pk_add_f32 v[196:197], v[196:197], v[76:77]
v_pk_fma_f32 v[198:199], v[76:77], v[76:77], v[198:199]
v_pk_add_f32 v[200:201], v[200:201], v[78:79]
v_pk_fma_f32 v[202:203], v[78:79], v[78:79], v[202:203]
v_pk_add_f32 v[196:197], v[196:197], v[80:81]
v_pk_fma_f32 v[198:199], v[80:81], v[80:81], v[198:199]
v_pk_add_f32 v[200:201], v[200:201], v[82:83]
v_pk_fma_f32 v[202:203], v[82:83], v[82:83], v[202:203]
v_pk_add_f32 v[196:197], v[196:197], v[84:85]
v_pk_fma_f32 v[198:199], v[84:85], v[84:85], v[198:199]
v_pk_add_f32 v[200:201], v[200:201], v[86:87]
v_pk_fma_f32 v[202:203], v[86:87], v[86:87], v[202:203]
v_pk_add_f32 v[196:197], v[196:197], v[88:89]
v_pk_fma_f32 v[198:199], v[88:89], v[88:89], v[198:199]
v_pk_add_f32 v[200:201], v[200:201], v[90:91]
v_pk_fma_f32 v[202:203], v[90:91], v[90:91], v[202:203]
v_pk_add_f32 v[196:197], v[196:197], v[92:93]
v_pk_fma_f32 v[198:199], v[92:93], v[92:93], v[198:199]
v_pk_add_f32 v[200:201], v[200:201], v[94:95]
v_pk_fma_f32 v[202:203], v[94:95], v[94:95], v[202:203]
v_pk_add_f32 v[196:197], v[196:197], v[96:97]
v_pk_fma_f32 v[198:199], v[96:97], v[96:97], v[198:199]
v_pk_add_f32 v[200:201], v[200:201], v[98:99]
v_pk_fma_f32 v[202:203], v[98:99], v[98:99], v[202:203]
v_pk_add_f32 v[196:197], v[196:197], v[100:101]
v_pk_fma_f32 v[198:199], v[100:101], v[100:101], v[198:199]
v_pk_add_f32 v[200:201], v[200:201], v[102:103]
v_pk_fma_f32 v[202:203], v[102:103], v[102:103], v[202:203]
v_pk_add_f32 v[196:197], v[196:197], v[104:105]
v_pk_fma_f32 v[198:199], v[104:105], v[104:105], v[198:199]
v_pk_add_f32 v[200:201], v[200:201], v[106:107]
v_pk_fma_f32 v[202:203], v[106:107], v[106:107], v[202:203]
v_pk_add_f32 v[196:197], v[196:197], v[200:201]
v_pk_add_f32 v[198:199], v[198:199], v[202:203]
v_mfma_f32_32x32x16_bf16 v[116:131], a[172:175], a[56:59], v[116:131]
ds_read_b128 a[168:171], v207 offset:21504
v_add_f32 v204, v196, v197
v_add_f32 v205, v198, v199
v_mov_b32 v180, v204
v_mov_b32 v181, v205
s_nop 0
v_permlane32_swap_b32 v204, v180
v_permlane32_swap_b32 v205, v181
s_waitcnt lgkmcnt(3)
v_mfma_f32_32x32x16_bf16 v[116:131], a[144:147], a[60:63], v[116:131]
ds_read_b128 a[172:175], v207 offset:22528
v_add_f32 v204, v204, v180
v_add_f32 v205, v205, v181
s_mov_b32 exec_hi, 0
buffer_store_dwordx2 v[204:205], v6, s[8:11], s30 offen sc1
s_mov_b64 exec, -1
v_mfma_f32_32x32x16_bf16 v[116:131], a[148:151], a[64:67], v[116:131]
ds_read_b128 a[144:147], v207 offset:23552
v_mfma_f32_32x32x16_bf16 v[116:131], a[152:155], a[68:71], v[116:131]
ds_read_b128 a[148:151], v207 offset:24576
s_mul_i32 s38, s24, 9216
v_mfma_f32_32x32x16_bf16 v[116:131], a[156:159], a[72:75], v[116:131]
ds_read_b128 a[152:155], v207 offset:25600
s_add_u32 m0, s38, 86016
s_waitcnt lgkmcnt(3)
v_mfma_f32_32x32x16_bf16 v[116:131], a[160:163], a[76:79], v[116:131]
ds_read_b128 a[156:159], v207 offset:26624
v_mfma_f32_32x32x16_bf16 v[116:131], a[164:167], a[80:83], v[116:131]
ds_read_b128 a[160:163], v207 offset:27648
s_add_u32 s39, s38, s82
v_mfma_f32_32x32x16_bf16 v[116:131], a[168:171], a[84:87], v[116:131]
ds_read_b128 a[164:167], v207 offset:28672
s_add_u32 s39, s39, 303104
v_mfma_f32_32x32x16_bf16 v[116:131], a[172:175], a[88:91], v[116:131]
ds_read_b128 a[168:171], v207 offset:29696
s_waitcnt lgkmcnt(3)
v_mfma_f32_32x32x16_bf16 v[116:131], a[144:147], a[92:95], v[116:131]
ds_read_b128 a[172:175], v207 offset:30720
buffer_load_dwordx4 v1, s[4:7], s39 offen offset:0 sc1 lds
v_mfma_f32_32x32x16_bf16 v[116:131], a[148:151], a[96:99], v[116:131]
ds_read_b128 a[144:147], v207 offset:31744
buffer_load_dwordx4 v1, s[4:7], s39 offen offset:1024 sc1 lds
v_mfma_f32_32x32x16_bf16 v[116:131], a[152:155], a[100:103], v[116:131]
ds_read_b128 a[148:151], v207 offset:32768
v_mfma_f32_32x32x16_bf16 v[116:131], a[156:159], a[104:107], v[116:131]
ds_read_b128 a[152:155], v207 offset:33792
buffer_load_dwordx4 v1, s[4:7], s39 offen offset:2048 sc1 lds
s_waitcnt lgkmcnt(3)
v_mfma_f32_32x32x16_bf16 v[116:131], a[160:163], a[108:111], v[116:131]
ds_read_b128 a[156:159], v207 offset:34816
buffer_load_dwordx4 v1, s[4:7], s39 offen offset:3072 sc1 lds
v_mfma_f32_32x32x16_bf16 v[116:131], a[164:167], a[112:115], v[116:131]
ds_read_b128 a[160:163], v207 offset:35840
v_mfma_f32_32x32x16_bf16 v[116:131], a[168:171], a[116:119], v[116:131]
ds_read_b128 a[164:167], v207 offset:36864
s_add_u32 m0, m0, 4096
v_mfma_f32_32x32x16_bf16 v[116:131], a[172:175], a[120:123], v[116:131]
ds_read_b128 a[168:171], v208 offset:0
s_add_u32 s39, s39, 4096
s_waitcnt lgkmcnt(3)
v_mfma_f32_32x32x16_bf16 v[116:131], a[144:147], a[124:127], v[116:131]
ds_read_b128 a[172:175], v208 offset:1024
v_mfma_f32_32x32x16_bf16 v[116:131], a[148:151], a[128:131], v[116:131]
ds_read_b128 a[144:147], v208 offset:2048
buffer_load_dwordx4 v1, s[4:7], s39 offen offset:0 sc1 lds
v_mfma_f32_32x32x16_bf16 v[116:131], a[152:155], a[132:135], v[116:131]
ds_read_b128 a[148:151], v208 offset:3072
buffer_load_dwordx4 v1, s[4:7], s39 offen offset:1024 sc1 lds
v_mfma_f32_32x32x16_bf16 v[116:131], a[156:159], a[136:139], v[116:131]
ds_read_b128 a[152:155], v208 offset:4096
s_waitcnt lgkmcnt(3)
v_mfma_f32_32x32x16_bf16 v[116:131], a[160:163], a[140:143], v[116:131]
ds_read_b128 a[156:159], v208 offset:5120
buffer_load_dwordx4 v1, s[4:7], s39 offen offset:2048 sc1 lds
v_mfma_f32_32x32x16_bf16 v[116:131], a[164:167], v[212:215], v[116:131]
ds_read_b128 a[160:163], v208 offset:6144
buffer_load_dwordx4 v1, s[4:7], s39 offen offset:3072 sc1 lds
s_waitcnt vmcnt(9)
s_barrier
v_mfma_f32_32x32x16_bf16 v[132:147], a[168:171], a[0:3], 0
ds_read_b128 a[164:167], v208 offset:7168
v_mfma_f32_32x32x16_bf16 v[132:147], a[172:175], a[4:7], v[132:147]
ds_read_b128 a[168:171], v208 offset:8192
buffer_load_dwordx2 v[180:181], v234, s[8:11], s61 offen offset:0 sc1
s_add_u32 m0, m0, 4096
s_waitcnt lgkmcnt(3)
v_mfma_f32_32x32x16_bf16 v[132:147], a[144:147], a[8:11], v[132:147]
ds_read_b128 a[172:175], v208 offset:9216
buffer_load_dwordx2 v[182:183], v234, s[8:11], s61 offen offset:1024 sc1
s_add_u32 s39, s39, 4096
v_mfma_f32_32x32x16_bf16 v[132:147], a[148:151], a[12:15], v[132:147]
ds_read_b128 a[144:147], v208 offset:10240
buffer_load_dwordx2 v[184:185], v234, s[8:11], s61 offen offset:2048 sc1
v_mfma_f32_32x32x16_bf16 v[132:147], a[152:155], a[16:19], v[132:147]
ds_read_b128 a[148:151], v208 offset:11264
buffer_load_dwordx4 v1, s[4:7], s39 offen offset:0 sc1 lds
buffer_load_dwordx2 v[186:187], v234, s[8:11], s61 offen offset:3072 sc1
v_mfma_f32_32x32x16_bf16 v[132:147], a[156:159], a[20:23], v[132:147]
ds_read_b128 a[152:155], v208 offset:12288
buffer_load_dwordx2 v[188:189], v235, s[8:11], s61 offen offset:0 sc1
s_lshl_b32 s38, s24, 8
s_waitcnt lgkmcnt(3)
v_mfma_f32_32x32x16_bf16 v[132:147], a[160:163], a[24:27], v[132:147]
ds_read_b128 a[156:159], v208 offset:13312
buffer_load_dwordx2 v[190:191], v235, s[8:11], s61 offen offset:1024 sc1
v_mfma_f32_32x32x16_bf16 v[132:147], a[164:167], a[28:31], v[132:147]
ds_read_b128 a[160:163], v208 offset:14336
buffer_load_dwordx2 v[192:193], v235, s[8:11], s61 offen offset:2048 sc1
s_add_u32 m0, s38, 122880
v_mfma_f32_32x32x16_bf16 v[132:147], a[168:171], a[32:35], v[132:147]
ds_read_b128 a[164:167], v208 offset:15360
buffer_load_dwordx2 v[194:195], v235, s[8:11], s61 offen offset:3072 sc1
s_add_u32 s39, s38, s82
v_mfma_f32_32x32x16_bf16 v[132:147], a[172:175], a[36:39], v[132:147]
ds_read_b128 a[168:171], v208 offset:16384
s_waitcnt lgkmcnt(3)
v_mfma_f32_32x32x16_bf16 v[132:147], a[144:147], a[40:43], v[132:147]
ds_read_b128 a[172:175], v208 offset:17408
s_add_u32 s39, s39, 339968
v_mfma_f32_32x32x16_bf16 v[132:147], a[148:151], a[44:47], v[132:147]
ds_read_b128 a[144:147], v208 offset:18432
s_mov_b64 exec, 0xffff
buffer_load_dwordx4 v1, s[4:7], s39 offen sc1 lds
s_mov_b64 exec, -1
v_mfma_f32_32x32x16_bf16 v[132:147], a[152:155], a[48:51], v[132:147]
ds_read_b128 a[148:151], v208 offset:19456
v_mfma_f32_32x32x16_bf16 v[132:147], a[156:159], a[52:55], v[132:147]
ds_read_b128 a[152:155], v208 offset:20480
s_waitcnt lgkmcnt(3)
v_mfma_f32_32x32x16_bf16 v[132:147], a[160:163], a[56:59], v[132:147]
ds_read_b128 a[156:159], v208 offset:21504
v_mfma_f32_32x32x16_bf16 v[132:147], a[164:167], a[60:63], v[132:147]
ds_read_b128 a[160:163], v208 offset:22528
v_mfma_f32_32x32x16_bf16 v[132:147], a[168:171], a[64:67], v[132:147]
ds_read_b128 a[164:167], v208 offset:23552
v_mfma_f32_32x32x16_bf16 v[132:147], a[172:175], a[68:71], v[132:147]
ds_read_b128 a[168:171], v208 offset:24576
s_waitcnt lgkmcnt(3)
v_mfma_f32_32x32x16_bf16 v[132:147], a[144:147], a[72:75], v[132:147]
ds_read_b128 a[172:175], v208 offset:25600
v_mfma_f32_32x32x16_bf16 v[132:147], a[148:151], a[76:79], v[132:147]
ds_read_b128 a[144:147], v208 offset:26624
v_mfma_f32_32x32x16_bf16 v[132:147], a[152:155], a[80:83], v[132:147]
ds_read_b128 a[148:151], v208 offset:27648
v_mfma_f32_32x32x16_bf16 v[132:147], a[156:159], a[84:87], v[132:147]
ds_read_b128 a[152:155], v208 offset:28672
s_waitcnt vmcnt(1)
v_min3_f32 v198, v181, v183, v185
v_min3_f32 v199, v187, v189, v191
v_min3_f32 v198, v198, v193, v195
s_waitcnt lgkmcnt(3)
v_mfma_f32_32x32x16_bf16 v[132:147], a[160:163], a[88:91], v[132:147]
ds_read_b128 a[156:159], v208 offset:29696
v_min_f32 v198, v198, v199
v_cmp_gt_f32 vcc, 0, v198
s_nop 0
s_cbranch_vccnz L_stzslow_23
L_stzback_24:
v_mfma_f32_32x32x16_bf16 v[132:147], a[164:167], a[92:95], v[132:147]
ds_read_b128 a[160:163], v208 offset:30720
v_add_f32 v196, v180, v182
v_add_f32 v197, v181, v183
v_add_f32 v196, v196, v184
v_mfma_f32_32x32x16_bf16 v[132:147], a[168:171], a[96:99], v[132:147]
ds_read_b128 a[164:167], v208 offset:31744
v_add_f32 v197, v197, v185
v_add_f32 v196, v196, v186
v_add_f32 v197, v197, v187
v_add_f32 v196, v196, v188
v_mfma_f32_32x32x16_bf16 v[132:147], a[172:175], a[100:103], v[132:147]
ds_read_b128 a[168:171], v208 offset:32768
v_add_f32 v197, v197, v189
v_add_f32 v196, v196, v190
v_add_f32 v197, v197, v191
s_waitcnt lgkmcnt(3)
v_mfma_f32_32x32x16_bf16 v[132:147], a[144:147], a[104:107], v[132:147]
ds_read_b128 a[172:175], v208 offset:33792
v_add_f32 v196, v196, v192
v_add_f32 v197, v197, v193
v_add_f32 v196, v196, v194
v_add_f32 v197, v197, v195
v_mfma_f32_32x32x16_bf16 v[132:147], a[148:151], a[108:111], v[132:147]
ds_read_b128 a[144:147], v208 offset:34816
v_mov_b32 v198, v196
v_mov_b32 v199, v197
s_nop 0
v_permlane32_swap_b32 v196, v198
v_mfma_f32_32x32x16_bf16 v[132:147], a[152:155], a[112:115], v[132:147]
ds_read_b128 a[148:151], v208 offset:35840
v_permlane32_swap_b32 v197, v199
v_add_f32 v196, v196, v198
v_mfma_f32_32x32x16_bf16 v[132:147], a[156:159], a[116:119], v[132:147]
ds_read_b128 a[152:155], v208 offset:36864
v_add_f32 v197, v197, v199
v_mul_f32 v196, 0x39e38e39, v196
v_mul_f32 v198, v196, v196
v_mul_f32 v197, 0x39e38e39, v197
s_waitcnt lgkmcnt(3)
v_mfma_f32_32x32x16_bf16 v[132:147], a[160:163], a[120:123], v[132:147]
ds_read_b128 a[156:159], v209 offset:0
v_sub_f32 v197, v197, v198
v_max_f32 v197, 0, v197
v_add_f32 v197, 0x3727c5ac, v197
v_mfma_f32_32x32x16_bf16 v[132:147], a[164:167], a[124:127], v[132:147]
ds_read_b128 a[160:163], v209 offset:1024
v_rsq_f32 v198, v197
s_nop 0
v_mul_f32 v200, v196, v198
v_mfma_f32_32x32x16_bf16 v[132:147], a[168:171], a[128:131], v[132:147]
ds_read_b128 a[164:167], v209 offset:2048
v_fma_f32 v36, v36, v198, -v200
v_fma_f32 v37, v37, v198, -v200
v_fma_f32 v38, v38, v198, -v200
v_fma_f32 v39, v39, v198, -v200
v_mfma_f32_32x32x16_bf16 v[132:147], a[172:175], a[132:135], v[132:147]
ds_read_b128 a[168:171], v209 offset:3072
v_fma_f32 v40, v40, v198, -v200
v_fma_f32 v41, v41, v198, -v200
v_fma_f32 v42, v42, v198, -v200
v_fma_f32 v43, v43, v198, -v200
s_waitcnt lgkmcnt(3)
v_mfma_f32_32x32x16_bf16 v[132:147], a[144:147], a[136:139], v[132:147]
ds_read_b128 a[172:175], v209 offset:4096
v_cvt_pk_bf16_f32 v216, v36, v37
v_cvt_pk_bf16_f32 v217, v38, v39
v_cvt_pk_bf16_f32 v218, v40, v41
v_cvt_pk_bf16_f32 v219, v42, v43
v_mfma_f32_32x32x16_bf16 v[132:147], a[148:151], a[140:143], v[132:147]
ds_read_b128 a[144:147], v209 offset:5120
ds_write_b128 v237, v[216:219] offset:0
v_mfma_f32_32x32x16_bf16 v[132:147], a[152:155], v[212:215], v[132:147]
ds_read_b128 a[148:151], v209 offset:6144
v_fma_f32 v44, v44, v198, -v200
v_fma_f32 v45, v45, v198, -v200
v_fma_f32 v46, v46, v198, -v200
v_fma_f32 v47, v47, v198, -v200
s_waitcnt vmcnt(0)
s_barrier
v_mfma_f32_32x32x16_bf16 v[148:163], a[156:159], a[0:3], 0
ds_read_b128 a[152:155], v209 offset:7168
v_fma_f32 v48, v48, v198, -v200
v_fma_f32 v49, v49, v198, -v200
v_fma_f32 v50, v50, v198, -v200
v_fma_f32 v51, v51, v198, -v200
s_waitcnt lgkmcnt(4)
v_mfma_f32_32x32x16_bf16 v[148:163], a[160:163], a[4:7], v[148:163]
ds_read_b128 a[156:159], v209 offset:8192
v_cvt_pk_bf16_f32 v220, v44, v45
v_cvt_pk_bf16_f32 v221, v46, v47
v_cvt_pk_bf16_f32 v222, v48, v49
v_cvt_pk_bf16_f32 v223, v50, v51
v_mfma_f32_32x32x16_bf16 v[148:163], a[164:167], a[8:11], v[148:163]
ds_read_b128 a[160:163], v209 offset:9216
ds_write_b128 v237, v[220:223] offset:16
ds_read_b64_tr_b16 v[36:37], v238 offset:0
ds_read_b64_tr_b16 v[38:39], v238 offset:1216
ds_read_b64_tr_b16 v[40:41], v238 offset:32
ds_read_b64_tr_b16 v[42:43], v238 offset:1248
v_mfma_f32_32x32x16_bf16 v[148:163], a[168:171], a[12:15], v[148:163]
ds_read_b128 a[164:167], v209 offset:10240
v_fma_f32 v52, v52, v198, -v200
v_fma_f32 v53, v53, v198, -v200
v_fma_f32 v54, v54, v198, -v200
v_mfma_f32_32x32x16_bf16 v[148:163], a[172:175], a[16:19], v[148:163]
ds_read_b128 a[168:171], v209 offset:11264
v_fma_f32 v55, v55, v198, -v200
v_fma_f32 v56, v56, v198, -v200
s_waitcnt lgkmcnt(8)
v_mfma_f32_32x32x16_bf16 v[148:163], a[144:147], a[20:23], v[148:163]
ds_read_b128 a[172:175], v209 offset:12288
v_fma_f32 v57, v57, v198, -v200
v_fma_f32 v58, v58, v198, -v200
v_fma_f32 v59, v59, v198, -v200
v_mfma_f32_32x32x16_bf16 v[148:163], a[148:151], a[24:27], v[148:163]
ds_read_b128 a[144:147], v209 offset:13312
v_cvt_pk_bf16_f32 v224, v52, v53
v_cvt_pk_bf16_f32 v225, v54, v55
v_mfma_f32_32x32x16_bf16 v[148:163], a[152:155], a[28:31], v[148:163]
ds_read_b128 a[148:151], v209 offset:14336
v_cvt_pk_bf16_f32 v226, v56, v57
v_cvt_pk_bf16_f32 v227, v58, v59
v_mfma_f32_32x32x16_bf16 v[148:163], a[156:159], a[32:35], v[148:163]
ds_read_b128 a[152:155], v209 offset:15360
ds_write_b128 v237, v[224:227] offset:64
s_waitcnt lgkmcnt(9)
buffer_store_dwordx4 v[36:39], v1, s[8:11], s66 offen offset:0 sc1
s_waitcnt lgkmcnt(4)
v_mfma_f32_32x32x16_bf16 v[148:163], a[160:163], a[36:39], v[148:163]
ds_read_b128 a[156:159], v209 offset:16384
v_fma_f32 v60, v60, v198, -v200
v_fma_f32 v61, v61, v198, -v200
v_fma_f32 v62, v62, v198, -v200
v_fma_f32 v63, v63, v198, -v200
v_mfma_f32_32x32x16_bf16 v[148:163], a[164:167], a[40:43], v[148:163]
ds_read_b128 a[160:163], v209 offset:17408
v_fma_f32 v64, v64, v198, -v200
v_fma_f32 v65, v65, v198, -v200
v_fma_f32 v66, v66, v198, -v200
v_mfma_f32_32x32x16_bf16 v[148:163], a[168:171], a[44:47], v[148:163]
ds_read_b128 a[164:167], v209 offset:18432
v_fma_f32 v67, v67, v198, -v200
v_cvt_pk_bf16_f32 v228, v60, v61
v_cvt_pk_bf16_f32 v229, v62, v63
v_mfma_f32_32x32x16_bf16 v[148:163], a[172:175], a[48:51], v[148:163]
ds_read_b128 a[168:171], v209 offset:19456
v_cvt_pk_bf16_f32 v230, v64, v65
v_cvt_pk_bf16_f32 v231, v66, v67
s_waitcnt lgkmcnt(3)
v_mfma_f32_32x32x16_bf16 v[148:163], a[144:147], a[52:55], v[148:163]
ds_read_b128 a[172:175], v209 offset:20480
ds_write_b128 v237, v[228:231] offset:80
v_mfma_f32_32x32x16_bf16 v[148:163], a[148:151], a[56:59], v[148:163]
ds_read_b128 a[144:147], v209 offset:21504
ds_read_b64_tr_b16 v[44:45], v238 offset:64
ds_read_b64_tr_b16 v[46:47], v238 offset:1280
ds_read_b64_tr_b16 v[48:49], v238 offset:96
ds_read_b64_tr_b16 v[50:51], v238 offset:1312
buffer_store_dwordx4 v[40:43], v1, s[8:11], s66 offen offset:1024 sc1
v_mfma_f32_32x32x16_bf16 v[148:163], a[152:155], a[60:63], v[148:163]
ds_read_b128 a[148:151], v209 offset:22528
v_fma_f32 v68, v68, v198, -v200
v_fma_f32 v69, v69, v198, -v200
v_fma_f32 v70, v70, v198, -v200
v_mfma_f32_32x32x16_bf16 v[148:163], a[156:159], a[64:67], v[148:163]
ds_read_b128 a[152:155], v209 offset:23552
v_fma_f32 v71, v71, v198, -v200
v_fma_f32 v72, v72, v198, -v200
s_waitcnt lgkmcnt(8)
v_mfma_f32_32x32x16_bf16 v[148:163], a[160:163], a[68:71], v[148:163]
ds_read_b128 a[156:159], v209 offset:24576
v_fma_f32 v73, v73, v198, -v200
v_fma_f32 v74, v74, v198, -v200
v_fma_f32 v75, v75, v198, -v200
v_mfma_f32_32x32x16_bf16 v[148:163], a[164:167], a[72:75], v[148:163]
ds_read_b128 a[160:163], v209 offset:25600
v_cvt_pk_bf16_f32 v216, v68, v69
v_cvt_pk_bf16_f32 v217, v70, v71
v_mfma_f32_32x32x16_bf16 v[148:163], a[168:171], a[76:79], v[148:163]
ds_read_b128 a[164:167], v209 offset:26624
v_cvt_pk_bf16_f32 v218, v72, v73
v_cvt_pk_bf16_f32 v219, v74, v75
v_mfma_f32_32x32x16_bf16 v[148:163], a[172:175], a[80:83], v[148:163]
ds_read_b128 a[168:171], v209 offset:27648
ds_write_b128 v237, v[216:219] offset:128
s_waitcnt lgkmcnt(9)
buffer_store_dwordx4 v[44:47], v1, s[8:11], s66 offen offset:2048 sc1
s_waitcnt lgkmcnt(4)
v_mfma_f32_32x32x16_bf16 v[148:163], a[144:147], a[84:87], v[148:163]
ds_read_b128 a[172:175], v209 offset:28672
v_fma_f32 v76, v76, v198, -v200
v_fma_f32 v77, v77, v198, -v200
v_fma_f32 v78, v78, v198, -v200
v_fma_f32 v79, v79, v198, -v200
v_mfma_f32_32x32x16_bf16 v[148:163], a[148:151], a[88:91], v[148:163]
ds_read_b128 a[144:147], v209 offset:29696
v_fma_f32 v80, v80, v198, -v200
v_fma_f32 v81, v81, v198, -v200
v_fma_f32 v82, v82, v198, -v200
v_mfma_f32_32x32x16_bf16 v[148:163], a[152:155], a[92:95], v[148:163]
ds_read_b128 a[148:151], v209 offset:30720
v_fma_f32 v83, v83, v198, -v200
v_cvt_pk_bf16_f32 v220, v76, v77
v_cvt_pk_bf16_f32 v221, v78, v79
v_mfma_f32_32x32x16_bf16 v[148:163], a[156:159], a[96:99], v[148:163]
ds_read_b128 a[152:155], v209 offset:31744
v_cvt_pk_bf16_f32 v222, v80, v81
v_cvt_pk_bf16_f32 v223, v82, v83
s_waitcnt lgkmcnt(3)
v_mfma_f32_32x32x16_bf16 v[148:163], a[160:163], a[100:103], v[148:163]
ds_read_b128 a[156:159], v209 offset:32768
ds_write_b128 v237, v[220:223] offset:144
v_mfma_f32_32x32x16_bf16 v[148:163], a[164:167], a[104:107], v[148:163]
ds_read_b128 a[160:163], v209 offset:33792
ds_read_b64_tr_b16 v[52:53], v238 offset:128
ds_read_b64_tr_b16 v[54:55], v238 offset:1344
ds_read_b64_tr_b16 v[56:57], v238 offset:160
ds_read_b64_tr_b16 v[58:59], v238 offset:1376
buffer_store_dwordx4 v[48:51], v1, s[8:11], s66 offen offset:3072 sc1
v_mfma_f32_32x32x16_bf16 v[148:163], a[168:171], a[108:111], v[148:163]
ds_read_b128 a[164:167], v209 offset:34816
v_fma_f32 v84, v84, v198, -v200
v_fma_f32 v85, v85, v198, -v200
v_fma_f32 v86, v86, v198, -v200
v_mfma_f32_32x32x16_bf16 v[148:163], a[172:175], a[112:115], v[148:163]
ds_read_b128 a[168:171], v209 offset:35840
v_fma_f32 v87, v87, v198, -v200
v_fma_f32 v88, v88, v198, -v200
v_fma_f32 v89, v89, v198, -v200
s_waitcnt lgkmcnt(8)
v_mfma_f32_32x32x16_bf16 v[148:163], a[144:147], a[116:119], v[148:163]
ds_read_b128 a[172:175], v209 offset:36864
v_fma_f32 v90, v90, v198, -v200
v_fma_f32 v91, v91, v198, -v200
v_mfma_f32_32x32x16_bf16 v[148:163], a[148:151], a[120:123], v[148:163]
ds_read_b128 a[144:147], v206 offset:0
v_cvt_pk_bf16_f32 v224, v84, v85
v_cvt_pk_bf16_f32 v225, v86, v87
v_cvt_pk_bf16_f32 v226, v88, v89
v_mfma_f32_32x32x16_bf16 v[148:163], a[152:155], a[124:127], v[148:163]
ds_read_b128 a[148:151], v206 offset:1024
v_cvt_pk_bf16_f32 v227, v90, v91
v_mfma_f32_32x32x16_bf16 v[148:163], a[156:159], a[128:131], v[148:163]
ds_read_b128 a[152:155], v206 offset:2048
ds_write_b128 v237, v[224:227] offset:192
s_add_u32 s66, s66, 4096
s_waitcnt lgkmcnt(9)
buffer_store_dwordx4 v[52:55], v1, s[8:11], s66 offen offset:0 sc1
s_waitcnt lgkmcnt(4)
v_mfma_f32_32x32x16_bf16 v[148:163], a[160:163], a[132:135], v[148:163]
ds_read_b128 a[156:159], v206 offset:3072
v_fma_f32 v92, v92, v198, -v200
v_fma_f32 v93, v93, v198, -v200
v_fma_f32 v94, v94, v198, -v200
v_fma_f32 v95, v95, v198, -v200
v_mfma_f32_32x32x16_bf16 v[148:163], a[164:167], a[136:139], v[148:163]
ds_read_b128 a[160:163], v206 offset:4096
v_fma_f32 v96, v96, v198, -v200
v_fma_f32 v97, v97, v198, -v200
v_fma_f32 v98, v98, v198, -v200
v_mfma_f32_32x32x16_bf16 v[148:163], a[168:171], a[140:143], v[148:163]
ds_read_b128 a[164:167], v206 offset:5120
v_fma_f32 v99, v99, v198, -v200
v_cvt_pk_bf16_f32 v228, v92, v93
v_cvt_pk_bf16_f32 v229, v94, v95
v_mfma_f32_32x32x16_bf16 v[148:163], a[172:175], v[212:215], v[148:163]
ds_read_b128 a[168:171], v206 offset:6144
v_cvt_pk_bf16_f32 v230, v96, v97
v_cvt_pk_bf16_f32 v231, v98, v99
s_waitcnt lgkmcnt(3)
v_mfma_f32_32x32x16_bf16 v[164:179], a[144:147], a[0:3], 0
ds_read_b128 a[172:175], v206 offset:7168
ds_write_b128 v237, v[228:231] offset:208
v_mfma_f32_32x32x16_bf16 v[164:179], a[148:151], a[4:7], v[164:179]
ds_read_b128 a[144:147], v206 offset:8192
ds_read_b64_tr_b16 v[60:61], v238 offset:192
ds_read_b64_tr_b16 v[62:63], v238 offset:1408
ds_read_b64_tr_b16 v[64:65], v238 offset:224
ds_read_b64_tr_b16 v[66:67], v238 offset:1440
buffer_store_dwordx4 v[56:59], v1, s[8:11], s66 offen offset:1024 sc1
v_mfma_f32_32x32x16_bf16 v[164:179], a[152:155], a[8:11], v[164:179]
ds_read_b128 a[148:151], v206 offset:9216
v_fma_f32 v100, v100, v198, -v200
v_fma_f32 v101, v101, v198, -v200
v_fma_f32 v102, v102, v198, -v200
v_mfma_f32_32x32x16_bf16 v[164:179], a[156:159], a[12:15], v[164:179]
ds_read_b128 a[152:155], v206 offset:10240
v_fma_f32 v103, v103, v198, -v200
v_fma_f32 v104, v104, v198, -v200
v_fma_f32 v105, v105, v198, -v200
s_waitcnt lgkmcnt(8)
v_mfma_f32_32x32x16_bf16 v[164:179], a[160:163], a[16:19], v[164:179]
ds_read_b128 a[156:159], v206 offset:11264
v_fma_f32 v106, v106, v198, -v200
v_fma_f32 v107, v107, v198, -v200
v_cvt_pk_bf16_f32 v216, v100, v101
v_mfma_f32_32x32x16_bf16 v[164:179], a[164:167], a[20:23], v[164:179]
ds_read_b128 a[160:163], v206 offset:12288
v_cvt_pk_bf16_f32 v217, v102, v103
v_cvt_pk_bf16_f32 v218, v104, v105
v_cvt_pk_bf16_f32 v219, v106, v107
v_mfma_f32_32x32x16_bf16 v[164:179], a[168:171], a[24:27], v[164:179]
ds_read_b128 a[164:167], v206 offset:13312
ds_write_b128 v239, v[216:219] offset:256
v_mfma_f32_32x32x16_bf16 v[164:179], a[172:175], a[28:31], v[164:179]
ds_read_b128 a[168:171], v206 offset:14336
ds_read_b64_tr_b16 v[68:69], v238 offset:256
ds_read_b64_tr_b16 v[70:71], v238 offset:1472
s_waitcnt lgkmcnt(11)
buffer_store_dwordx4 v[60:63], v1, s[8:11], s66 offen offset:2048 sc1
s_waitcnt lgkmcnt(6)
v_mfma_f32_32x32x16_bf16 v[164:179], a[144:147], a[32:35], v[164:179]
ds_read_b128 a[172:175], v206 offset:15360
v_mfma_f32_32x32x16_bf16 v[164:179], a[148:151], a[36:39], v[164:179]
ds_read_b128 a[144:147], v206 offset:16384
v_mfma_f32_32x32x16_bf16 v[164:179], a[152:155], a[40:43], v[164:179]
ds_read_b128 a[148:151], v206 offset:17408
v_mfma_f32_32x32x16_bf16 v[164:179], a[156:159], a[44:47], v[164:179]
ds_read_b128 a[152:155], v206 offset:18432
s_waitcnt lgkmcnt(3)
v_mfma_f32_32x32x16_bf16 v[164:179], a[160:163], a[48:51], v[164:179]
ds_read_b128 a[156:159], v206 offset:19456
v_mfma_f32_32x32x16_bf16 v[164:179], a[164:167], a[52:55], v[164:179]
ds_read_b128 a[160:163], v206 offset:20480
buffer_store_dwordx4 v[64:67], v1, s[8:11], s66 offen offset:3072 sc1
v_mfma_f32_32x32x16_bf16 v[164:179], a[168:171], a[56:59], v[164:179]
ds_read_b128 a[164:167], v206 offset:21504
v_mfma_f32_32x32x16_bf16 v[164:179], a[172:175], a[60:63], v[164:179]
ds_read_b128 a[168:171], v206 offset:22528
s_waitcnt lgkmcnt(3)
v_mfma_f32_32x32x16_bf16 v[164:179], a[144:147], a[64:67], v[164:179]
ds_read_b128 a[172:175], v206 offset:23552
v_mfma_f32_32x32x16_bf16 v[164:179], a[148:151], a[68:71], v[164:179]
ds_read_b128 a[144:147], v206 offset:24576
v_mfma_f32_32x32x16_bf16 v[164:179], a[152:155], a[72:75], v[164:179]
ds_read_b128 a[148:151], v206 offset:25600
s_add_u32 s66, s66, 4096
v_mfma_f32_32x32x16_bf16 v[164:179], a[156:159], a[76:79], v[164:179]
ds_read_b128 a[152:155], v206 offset:26624
buffer_store_dwordx4 v[68:71], v1, s[8:11], s66 offen offset:0 sc1
s_waitcnt lgkmcnt(3)
v_mfma_f32_32x32x16_bf16 v[164:179], a[160:163], a[80:83], v[164:179]
ds_read_b128 a[156:159], v206 offset:27648
v_mfma_f32_32x32x16_bf16 v[164:179], a[164:167], a[84:87], v[164:179]
ds_read_b128 a[160:163], v206 offset:28672
v_mfma_f32_32x32x16_bf16 v[164:179], a[168:171], a[88:91], v[164:179]
ds_read_b128 a[164:167], v206 offset:29696
v_mfma_f32_32x32x16_bf16 v[164:179], a[172:175], a[92:95], v[164:179]
ds_read_b128 a[168:171], v206 offset:30720
s_waitcnt lgkmcnt(3)
v_mfma_f32_32x32x16_bf16 v[164:179], a[144:147], a[96:99], v[164:179]
ds_read_b128 a[172:175], v206 offset:31744
v_mfma_f32_32x32x16_bf16 v[164:179], a[148:151], a[100:103], v[164:179]
ds_read_b128 a[144:147], v206 offset:32768
v_mfma_f32_32x32x16_bf16 v[164:179], a[152:155], a[104:107], v[164:179]
ds_read_b128 a[148:151], v206 offset:33792
v_mfma_f32_32x32x16_bf16 v[164:179], a[156:159], a[108:111], v[164:179]
ds_read_b128 a[152:155], v206 offset:34816
s_waitcnt lgkmcnt(3)
v_mfma_f32_32x32x16_bf16 v[164:179], a[160:163], a[112:115], v[164:179]
ds_read_b128 a[156:159], v206 offset:35840
v_mfma_f32_32x32x16_bf16 v[164:179], a[164:167], a[116:119], v[164:179]
ds_read_b128 a[160:163], v206 offset:36864
v_mfma_f32_32x32x16_bf16 v[164:179], a[168:171], a[120:123], v[164:179]
v_mfma_f32_32x32x16_bf16 v[164:179], a[172:175], a[124:127], v[164:179]
s_waitcnt lgkmcnt(1)
v_mfma_f32_32x32x16_bf16 v[164:179], a[144:147], a[128:131], v[164:179]
v_mfma_f32_32x32x16_bf16 v[164:179], a[148:151], a[132:135], v[164:179]
v_mfma_f32_32x32x16_bf16 v[164:179], a[152:155], a[136:139], v[164:179]
v_mfma_f32_32x32x16_bf16 v[164:179], a[156:159], a[140:143], v[164:179]
s_waitcnt lgkmcnt(0)
v_mfma_f32_32x32x16_bf16 v[164:179], a[160:163], v[212:215], v[164:179]
s_cmp_eq_u32 s24, 0
s_cselect_b32 s67, 0, 1073741824
s_add_u32 s67, s67, 26542080
s_waitcnt vmcnt(0)
s_barrier
s_mov_b64 exec, 0xffff
buffer_atomic_add v4, v236, s[8:11], s67 offen sc1
s_mov_b64 exec, -1
buffer_load_dwordx4 a[80:83], v1, s[4:7], s52 offen offset:2048 sc1
buffer_load_dwordx4 a[84:87], v9, s[4:7], s52 offen offset:2048 sc1
buffer_load_dwordx4 a[88:91], v1, s[4:7], s52 offen offset:3072 sc1
buffer_load_dwordx4 a[92:95], v9, s[4:7], s52 offen offset:3072 sc1
s_add_u32 s52, s52, 4096
buffer_load_dwordx4 a[96:99], v1, s[4:7], s52 offen offset:0 sc1
buffer_load_dwordx4 a[100:103], v9, s[4:7], s52 offen offset:0 sc1
buffer_load_dwordx4 a[104:107], v1, s[4:7], s52 offen offset:1024 sc1
buffer_load_dwordx4 a[108:111], v9, s[4:7], s52 offen offset:1024 sc1
buffer_load_dwordx4 a[112:115], v1, s[4:7], s52 offen offset:2048 sc1
buffer_load_dwordx4 a[116:119], v9, s[4:7], s52 offen offset:2048 sc1
buffer_load_dwordx4 a[120:123], v1, s[4:7], s52 offen offset:3072 sc1
buffer_load_dwordx4 a[124:127], v9, s[4:7], s52 offen offset:3072 sc1
s_add_u32 s52, s52, 4096
buffer_load_dwordx4 a[128:131], v1, s[4:7], s52 offen offset:0 sc1
buffer_load_dwordx4 a[132:135], v9, s[4:7], s52 offen offset:0 sc1
buffer_load_dwordx4 a[136:139], v1, s[4:7], s52 offen offset:1024 sc1
buffer_load_dwordx4 a[140:143], v9, s[4:7], s52 offen offset:1024 sc1
L_c4:
s_lshl_b32 s31, s25, 8
s_lshl_b32 s32, s24, 6
s_add_u32 s31, s31, s32
v_lshlrev_b32 v8, 1, v2
buffer_load_ushort v180, v8, s[20:23], s31 offen
buffer_load_ushort v181, v8, s[20:23], s31 offen offset:32
s_cmp_eq_u32 s24, 1
s_cbranch_scc0 L_other_28
s_lshl_b32 s30, s80, 7
s_add_u32 s30, s30, 26542080
v_mov_b32 v6, 0
s_mov_b32 s31, 0
s_mov_b64 exec, 1
v_mov_b32 v249, 0
buffer_atomic_add v249, v6, s[8:11], s30 offen sc0 sc1
s_sleep 3
v_mov_b32 v250, 0
buffer_atomic_add v250, v6, s[8:11], s30 offen sc0 sc1
s_sleep 3
v_mov_b32 v251, 0
buffer_atomic_add v251, v6, s[8:11], s30 offen sc0 sc1
s_sleep 3
L_poll_26:
s_add_u32 s31, s31, 1
s_cmp_gt_u32 s31, 100000
s_cbranch_scc1 L_polled_27
v_mov_b32 v252, 0
buffer_atomic_add v252, v6, s[8:11], s30 offen sc0 sc1
s_waitcnt vmcnt(3)
v_cmp_gt_u32 vcc, 16, v249
s_nop 0
s_cbranch_vccz L_polled_27
v_mov_b32 v249, 0
buffer_atomic_add v249, v6, s[8:11], s30 offen sc0 sc1
s_waitcnt vmcnt(3)
v_cmp_gt_u32 vcc, 16, v250
s_nop 0
s_cbranch_vccz L_polled_27
v_mov_b32 v250, 0
buffer_atomic_add v250, v6, s[8:11], s30 offen sc0 sc1
s_waitcnt vmcnt(3)
v_cmp_gt_u32 vcc, 16, v251
s_nop 0
s_cbranch_vccz L_polled_27
v_mov_b32 v251, 0
buffer_atomic_add v251, v6, s[8:11], s30 offen sc0 sc1
s_waitcnt vmcnt(3)
v_cmp_gt_u32 vcc, 16, v252
s_nop 0
s_cbranch_vccz L_polled_27
s_branch L_poll_26
L_polled_27:
s_mov_b64 exec, -1
s_branch L_join_29
L_other_28:
s_waitcnt vmcnt(0)
L_join_29:
s_barrier
s_mul_i32 s30, s26, 589824
s_add_u32 s30, s30, 7340032
s_lshl_b32 s62, s24, 12
s_lshl_b32 s63, s24, 10
s_add_u32 s60, s30, s62
s_add_u32 s61, s30, s63
s_add_u32 s61, s61, 16384
s_add_u32 m0, s62, 90112
s_add_u32 s60, s60, 0
buffer_load_dwordx4 v1, s[8:11], s60 offen offset:0 sc1 lds
buffer_load_dwordx4 v1, s[8:11], s60 offen offset:1024 sc1 lds
buffer_load_dwordx4 v1, s[8:11], s60 offen offset:2048 sc1 lds
buffer_load_dwordx4 v1, s[8:11], s60 offen offset:3072 sc1 lds
s_add_u32 m0, s63, 106496
s_add_u32 s61, s61, 0
buffer_load_dwordx4 v1, s[8:11], s61 offen offset:0 sc1 lds
s_add_u32 m0, s62, 110592
s_add_u32 s60, s60, 20480
buffer_load_dwordx4 v1, s[8:11], s60 offen offset:0 sc1 lds
buffer_load_dwordx4 v1, s[8:11], s60 offen offset:1024 sc1 lds
buffer_load_dwordx4 v1, s[8:11], s60 offen offset:2048 sc1 lds
buffer_load_dwordx4 v1, s[8:11], s60 offen offset:3072 sc1 lds
v_add_u32 v190, 90112, v1
v_add_u32 v191, 126976, v1
v_lshlrev_b32 v180, 16, v180
v_lshlrev_b32 v181, 16, v181
v_mov_b32 v36, v180
v_mov_b32 v37, v180
v_mov_b32 v38, v180
v_mov_b32 v39, v180
v_mov_b32 v40, v181
v_mov_b32 v41, v181
v_mov_b32 v42, v181
v_mov_b32 v43, v181
v_mov_b32 v44, v180
v_mov_b32 v45, v180
v_mov_b32 v46, v180
v_mov_b32 v47, v180
v_mov_b32 v48, v181
v_mov_b32 v49, v181
v_mov_b32 v50, v181
v_mov_b32 v51, v181
v_mov_b32 v52, v180
v_mov_b32 v53, v180
v_mov_b32 v54, v180
v_mov_b32 v55, v180
v_mov_b32 v56, v181
v_mov_b32 v57, v181
v_mov_b32 v58, v181
v_mov_b32 v59, v181
v_mov_b32 v60, v180
v_mov_b32 v61, v180
v_mov_b32 v62, v180
v_mov_b32 v63, v180
v_mov_b32 v64, v181
v_mov_b32 v65, v181
v_mov_b32 v66, v181
v_mov_b32 v67, v181
v_mov_b32 v68, v180
v_mov_b32 v69, v180
v_mov_b32 v70, v180
v_mov_b32 v71, v180
v_mov_b32 v72, v181
v_mov_b32 v73, v181
v_mov_b32 v74, v181
v_mov_b32 v75, v181
v_mov_b32 v76, v180
v_mov_b32 v77, v180
v_mov_b32 v78, v180
v_mov_b32 v79, v180
v_mov_b32 v80, v181
v_mov_b32 v81, v181
v_mov_b32 v82, v181
v_mov_b32 v83, v181
v_mov_b32 v84, v180
v_mov_b32 v85, v180
v_mov_b32 v86, v180
v_mov_b32 v87, v180
v_mov_b32 v88, v181
v_mov_b32 v89, v181
v_mov_b32 v90, v181
v_mov_b32 v91, v181
v_mov_b32 v92, v180
v_mov_b32 v93, v180
v_mov_b32 v94, v180
v_mov_b32 v95, v180
v_mov_b32 v96, v181
v_mov_b32 v97, v181
v_mov_b32 v98, v181
v_mov_b32 v99, v181
v_mov_b32 v100, v180
v_mov_b32 v101, v180
v_mov_b32 v102, v180
v_mov_b32 v103, v180
v_mov_b32 v104, v181
v_mov_b32 v105, v181
v_mov_b32 v106, v181
v_mov_b32 v107, v181
s_waitcnt vmcnt(4)
s_barrier
ds_read_b128 a[0:3], v190 offset:0
ds_read_b128 a[4:7], v190 offset:1024
ds_read_b128 a[8:11], v190 offset:2048
ds_read_b128 a[12:15], v190 offset:3072
ds_read_b128 a[16:19], v190 offset:4096
ds_read_b128 a[20:23], v190 offset:5120
ds_read_b128 a[24:27], v190 offset:6144
ds_read_b128 a[28:31], v190 offset:7168
ds_read_b128 a[32:35], v190 offset:8192
s_waitcnt lgkmcnt(0)
v_mfma_f32_16x16x32_bf16 v[36:39], a[0:3], a[176:179], v[36:39]
ds_read_b128 a[36:39], v190 offset:9216
s_add_u32 m0, s62, 126976
v_mfma_f32_16x16x32_bf16 v[40:43], a[0:3], a[180:183], v[40:43]
ds_read_b128 a[40:43], v190 offset:10240
v_mul_f32 v182, v108, v108
v_mfma_f32_16x16x32_bf16 v[44:47], a[4:7], a[176:179], v[44:47]
ds_read_b128 a[44:47], v190 offset:11264
s_add_u32 s60, s60, 16384
v_mfma_f32_16x16x32_bf16 v[48:51], a[4:7], a[180:183], v[48:51]
ds_read_b128 a[48:51], v190 offset:12288
v_mul_f32 v183, v109, v109
v_mfma_f32_16x16x32_bf16 v[52:55], a[8:11], a[176:179], v[52:55]
ds_read_b128 a[52:55], v190 offset:13312
v_mul_f32 v184, v110, v110
v_mfma_f32_16x16x32_bf16 v[56:59], a[8:11], a[180:183], v[56:59]
ds_read_b128 a[56:59], v190 offset:14336
buffer_load_dwordx4 v1, s[8:11], s60 offen offset:0 sc1 lds
v_mfma_f32_16x16x32_bf16 v[60:63], a[12:15], a[176:179], v[60:63]
ds_read_b128 a[60:63], v190 offset:15360
v_mul_f32 v185, v111, v111
v_mfma_f32_16x16x32_bf16 v[64:67], a[12:15], a[180:183], v[64:67]
ds_read_b128 a[64:67], v190 offset:16384
v_fma_f32 v182, v182, v254, v253
v_mfma_f32_16x16x32_bf16 v[68:71], a[16:19], a[176:179], v[68:71]
ds_read_b128 a[68:71], v190 offset:17408
buffer_load_dwordx4 v1, s[8:11], s60 offen offset:1024 sc1 lds
v_mfma_f32_16x16x32_bf16 v[72:75], a[16:19], a[180:183], v[72:75]
v_fma_f32 v183, v183, v254, v253
v_fma_f32 v184, v184, v254, v253
v_mfma_f32_16x16x32_bf16 v[76:79], a[20:23], a[176:179], v[76:79]
v_fma_f32 v185, v185, v254, v253
v_mfma_f32_16x16x32_bf16 v[80:83], a[20:23], a[180:183], v[80:83]
buffer_load_dwordx4 v1, s[8:11], s60 offen offset:2048 sc1 lds
v_mul_f32 v182, v182, v108
v_mfma_f32_16x16x32_bf16 v[84:87], a[24:27], a[176:179], v[84:87]
v_mul_f32 v183, v183, v109
v_mfma_f32_16x16x32_bf16 v[88:91], a[24:27], a[180:183], v[88:91]
v_mfma_f32_16x16x32_bf16 v[92:95], a[28:31], a[176:179], v[92:95]
buffer_load_dwordx4 v1, s[8:11], s60 offen offset:3072 sc1 lds
v_mul_f32 v184, v184, v110
v_mfma_f32_16x16x32_bf16 v[96:99], a[28:31], a[180:183], v[96:99]
v_mul_f32 v185, v185, v111
v_mfma_f32_16x16x32_bf16 v[100:103], a[32:35], a[176:179], v[100:103]
v_mfma_f32_16x16x32_bf16 v[104:107], a[32:35], a[180:183], v[104:107]
s_waitcnt vmcnt(4)
s_waitcnt lgkmcnt(0)
s_barrier
v_mfma_f32_16x16x32_bf16 v[36:39], a[36:39], a[184:187], v[36:39]
ds_read_b128 a[0:3], v190 offset:18432
s_add_u32 m0, s63, 143360
v_mfma_f32_16x16x32_bf16 v[40:43], a[36:39], a[188:191], v[40:43]
ds_read_b128 a[4:7], v190 offset:19456
v_mfma_f32_16x16x32_bf16 v[44:47], a[40:43], a[184:187], v[44:47]
ds_read_b128 a[8:11], v190 offset:20480
s_add_u32 s61, s61, 36864
v_mfma_f32_16x16x32_bf16 v[48:51], a[40:43], a[188:191], v[48:51]
ds_read_b128 a[12:15], v190 offset:21504
v_mfma_f32_16x16x32_bf16 v[52:55], a[44:47], a[184:187], v[52:55]
ds_read_b128 a[16:19], v190 offset:22528
buffer_load_dwordx4 v1, s[8:11], s61 offen offset:0 sc1 lds
v_mfma_f32_16x16x32_bf16 v[56:59], a[44:47], a[188:191], v[56:59]
ds_read_b128 a[20:23], v190 offset:23552
v_mfma_f32_16x16x32_bf16 v[60:63], a[48:51], a[184:187], v[60:63]
ds_read_b128 a[24:27], v190 offset:24576
s_add_u32 m0, s62, 147456
v_mfma_f32_16x16x32_bf16 v[64:67], a[48:51], a[188:191], v[64:67]
ds_read_b128 a[28:31], v190 offset:25600
v_mfma_f32_16x16x32_bf16 v[68:71], a[52:55], a[184:187], v[68:71]
ds_read_b128 a[32:35], v190 offset:26624
s_add_u32 s60, s60, 20480
v_mfma_f32_16x16x32_bf16 v[72:75], a[52:55], a[188:191], v[72:75]
v_exp_f32 v182, v182
v_mfma_f32_16x16x32_bf16 v[76:79], a[56:59], a[184:187], v[76:79]
buffer_load_dwordx4 v1, s[8:11], s60 offen offset:0 sc1 lds
v_mfma_f32_16x16x32_bf16 v[80:83], a[56:59], a[188:191], v[80:83]
v_exp_f32 v183, v183
v_mfma_f32_16x16x32_bf16 v[84:87], a[60:63], a[184:187], v[84:87]
buffer_load_dwordx4 v1, s[8:11], s60 offen offset:1024 sc1 lds
v_mfma_f32_16x16x32_bf16 v[88:91], a[60:63], a[188:191], v[88:91]
v_exp_f32 v184, v184
v_mfma_f32_16x16x32_bf16 v[92:95], a[64:67], a[184:187], v[92:95]
buffer_load_dwordx4 v1, s[8:11], s60 offen offset:2048 sc1 lds
v_mfma_f32_16x16x32_bf16 v[96:99], a[64:67], a[188:191], v[96:99]
v_exp_f32 v185, v185
v_mfma_f32_16x16x32_bf16 v[100:103], a[68:71], a[184:187], v[100:103]
v_fma_f32 v182, v182, v255, v255
v_fma_f32 v183, v183, v255, v255
v_mfma_f32_16x16x32_bf16 v[104:107], a[68:71], a[188:191], v[104:107]
v_fma_f32 v184, v184, v255, v255
s_waitcnt lgkmcnt(0)
v_mfma_f32_16x16x32_bf16 v[36:39], a[0:3], a[192:195], v[36:39]
ds_read_b128 a[36:39], v190 offset:27648
buffer_load_dwordx4 v1, s[8:11], s60 offen offset:3072 sc1 lds
v_mfma_f32_16x16x32_bf16 v[40:43], a[0:3], a[196:199], v[40:43]
ds_read_b128 a[40:43], v190 offset:28672
v_fma_f32 v185, v185, v255, v255
v_mfma_f32_16x16x32_bf16 v[44:47], a[4:7], a[192:195], v[44:47]
ds_read_b128 a[44:47], v190 offset:29696
s_add_u32 m0, s62, 90112
v_mfma_f32_16x16x32_bf16 v[48:51], a[4:7], a[196:199], v[48:51]
ds_read_b128 a[48:51], v190 offset:30720
v_mfma_f32_16x16x32_bf16 v[52:55], a[8:11], a[192:195], v[52:55]
ds_read_b128 a[52:55], v190 offset:31744
v_mfma_f32_16x16x32_bf16 v[56:59], a[8:11], a[196:199], v[56:59]
ds_read_b128 a[56:59], v190 offset:32768
s_add_u32 s60, s60, 16384
v_mfma_f32_16x16x32_bf16 v[60:63], a[12:15], a[192:195], v[60:63]
ds_read_b128 a[60:63], v190 offset:33792
v_mfma_f32_16x16x32_bf16 v[64:67], a[12:15], a[196:199], v[64:67]
ds_read_b128 a[64:67], v190 offset:34816
v_mfma_f32_16x16x32_bf16 v[68:71], a[16:19], a[192:195], v[68:71]
ds_read_b128 a[68:71], v190 offset:35840
buffer_load_dwordx4 v1, s[8:11], s60 offen offset:0 sc1 lds
v_mfma_f32_16x16x32_bf16 v[72:75], a[16:19], a[196:199], v[72:75]
v_rcp_f32 v182, v182
v_mfma_f32_16x16x32_bf16 v[76:79], a[20:23], a[192:195], v[76:79]
v_rcp_f32 v183, v183
v_mfma_f32_16x16x32_bf16 v[80:83], a[20:23], a[196:199], v[80:83]
buffer_load_dwordx4 v1, s[8:11], s60 offen offset:1024 sc1 lds
v_mfma_f32_16x16x32_bf16 v[84:87], a[24:27], a[192:195], v[84:87]
v_rcp_f32 v184, v184
v_mfma_f32_16x16x32_bf16 v[88:91], a[24:27], a[196:199], v[88:91]
v_rcp_f32 v185, v185
v_mfma_f32_16x16x32_bf16 v[92:95], a[28:31], a[192:195], v[92:95]
buffer_load_dwordx4 v1, s[8:11], s60 offen offset:2048 sc1 lds
v_mul_f32 v108, v108, v182
v_mfma_f32_16x16x32_bf16 v[96:99], a[28:31], a[196:199], v[96:99]
v_mul_f32 v109, v109, v183
v_mul_f32 v110, v110, v184
v_mfma_f32_16x16x32_bf16 v[100:103], a[32:35], a[192:195], v[100:103]
v_mul_f32 v111, v111, v185
v_mul_f32 v186, v112, v112
v_mfma_f32_16x16x32_bf16 v[104:107], a[32:35], a[196:199], v[104:107]
s_waitcnt vmcnt(7)
s_waitcnt lgkmcnt(0)
s_barrier
v_mfma_f32_16x16x32_bf16 v[36:39], a[36:39], a[200:203], v[36:39]
ds_read_b128 a[0:3], v191 offset:0
buffer_load_dwordx4 v1, s[8:11], s60 offen offset:3072 sc1 lds
v_mfma_f32_16x16x32_bf16 v[40:43], a[36:39], a[204:207], v[40:43]
ds_read_b128 a[4:7], v191 offset:1024
v_mul_f32 v187, v113, v113
v_mfma_f32_16x16x32_bf16 v[44:47], a[40:43], a[200:203], v[44:47]
ds_read_b128 a[8:11], v191 offset:2048
s_add_u32 m0, s63, 106496
v_mfma_f32_16x16x32_bf16 v[48:51], a[40:43], a[204:207], v[48:51]
ds_read_b128 a[12:15], v191 offset:3072
v_mul_f32 v188, v114, v114
v_mfma_f32_16x16x32_bf16 v[52:55], a[44:47], a[200:203], v[52:55]
ds_read_b128 a[16:19], v191 offset:4096
s_add_u32 s61, s61, 36864
v_mfma_f32_16x16x32_bf16 v[56:59], a[44:47], a[204:207], v[56:59]
ds_read_b128 a[20:23], v191 offset:5120
v_mul_f32 v189, v115, v115
v_mfma_f32_16x16x32_bf16 v[60:63], a[48:51], a[200:203], v[60:63]
ds_read_b128 a[24:27], v191 offset:6144
buffer_load_dwordx4 v1, s[8:11], s61 offen offset:0 sc1 lds
v_mfma_f32_16x16x32_bf16 v[64:67], a[48:51], a[204:207], v[64:67]
ds_read_b128 a[28:31], v191 offset:7168
v_fma_f32 v186, v186, v254, v253
v_mfma_f32_16x16x32_bf16 v[68:71], a[52:55], a[200:203], v[68:71]
ds_read_b128 a[32:35], v191 offset:8192
s_add_u32 m0, s62, 110592
v_mfma_f32_16x16x32_bf16 v[72:75], a[52:55], a[204:207], v[72:75]
s_add_u32 s60, s60, 20480
v_fma_f32 v187, v187, v254, v253
v_fma_f32 v188, v188, v254, v253
v_mfma_f32_16x16x32_bf16 v[76:79], a[56:59], a[200:203], v[76:79]
v_fma_f32 v189, v189, v254, v253
v_mul_f32 v186, v186, v112
v_mfma_f32_16x16x32_bf16 v[80:83], a[56:59], a[204:207], v[80:83]
v_mul_f32 v187, v187, v113
v_mfma_f32_16x16x32_bf16 v[84:87], a[60:63], a[200:203], v[84:87]
buffer_load_dwordx4 v1, s[8:11], s60 offen offset:0 sc1 lds
v_mul_f32 v188, v188, v114
v_mfma_f32_16x16x32_bf16 v[88:91], a[60:63], a[204:207], v[88:91]
v_mul_f32 v189, v189, v115
v_mfma_f32_16x16x32_bf16 v[92:95], a[64:67], a[200:203], v[92:95]
buffer_load_dwordx4 v1, s[8:11], s60 offen offset:1024 sc1 lds
v_mfma_f32_16x16x32_bf16 v[96:99], a[64:67], a[204:207], v[96:99]
v_exp_f32 v186, v186
v_mfma_f32_16x16x32_bf16 v[100:103], a[68:71], a[200:203], v[100:103]
v_mfma_f32_16x16x32_bf16 v[104:107], a[68:71], a[204:207], v[104:107]
s_waitcnt lgkmcnt(0)
v_mfma_f32_16x16x32_bf16 v[36:39], a[0:3], a[208:211], v[36:39]
ds_read_b128 a[36:39], v191 offset:9216
buffer_load_dwordx4 v1, s[8:11], s60 offen offset:2048 sc1 lds
v_mfma_f32_16x16x32_bf16 v[40:43], a[0:3], a[212:215], v[40:43]
ds_read_b128 a[40:43], v191 offset:10240
v_mfma_f32_16x16x32_bf16 v[44:47], a[4:7], a[208:211], v[44:47]
ds_read_b128 a[44:47], v191 offset:11264
v_mfma_f32_16x16x32_bf16 v[48:51], a[4:7], a[212:215], v[48:51]
ds_read_b128 a[48:51], v191 offset:12288
v_mfma_f32_16x16x32_bf16 v[52:55], a[8:11], a[208:211], v[52:55]
ds_read_b128 a[52:55], v191 offset:13312
buffer_load_dwordx4 v1, s[8:11], s60 offen offset:3072 sc1 lds
v_mfma_f32_16x16x32_bf16 v[56:59], a[8:11], a[212:215], v[56:59]
ds_read_b128 a[56:59], v191 offset:14336
v_mfma_f32_16x16x32_bf16 v[60:63], a[12:15], a[208:211], v[60:63]
ds_read_b128 a[60:63], v191 offset:15360
v_mfma_f32_16x16x32_bf16 v[64:67], a[12:15], a[212:215], v[64:67]
ds_read_b128 a[64:67], v191 offset:16384
v_mfma_f32_16x16x32_bf16 v[68:71], a[16:19], a[208:211], v[68:71]
ds_read_b128 a[68:71], v191 offset:17408
buffer_load_dwordx4 a[144:147], v1, s[4:7], s52 offen offset:2048 sc1
v_mfma_f32_16x16x32_bf16 v[72:75], a[16:19], a[212:215], v[72:75]
v_exp_f32 v187, v187
v_mfma_f32_16x16x32_bf16 v[76:79], a[20:23], a[208:211], v[76:79]
v_exp_f32 v188, v188
v_mfma_f32_16x16x32_bf16 v[80:83], a[20:23], a[212:215], v[80:83]
v_exp_f32 v189, v189
v_mfma_f32_16x16x32_bf16 v[84:87], a[24:27], a[208:211], v[84:87]
buffer_load_dwordx4 a[148:151], v9, s[4:7], s52 offen offset:2048 sc1
v_fma_f32 v186, v186, v255, v255
v_mfma_f32_16x16x32_bf16 v[88:91], a[24:27], a[212:215], v[88:91]
v_fma_f32 v187, v187, v255, v255
v_fma_f32 v188, v188, v255, v255
v_mfma_f32_16x16x32_bf16 v[92:95], a[28:31], a[208:211], v[92:95]
v_fma_f32 v189, v189, v255, v255
v_mfma_f32_16x16x32_bf16 v[96:99], a[28:31], a[212:215], v[96:99]
v_rcp_f32 v186, v186
v_mfma_f32_16x16x32_bf16 v[100:103], a[32:35], a[208:211], v[100:103]
v_mfma_f32_16x16x32_bf16 v[104:107], a[32:35], a[212:215], v[104:107]
s_waitcnt vmcnt(11)
s_waitcnt lgkmcnt(0)
s_barrier
v_mfma_f32_16x16x32_bf16 v[36:39], a[36:39], a[216:219], v[36:39]
ds_read_b128 a[0:3], v191 offset:18432
buffer_load_dwordx4 a[152:155], v1, s[4:7], s52 offen offset:3072 sc1
v_mfma_f32_16x16x32_bf16 v[40:43], a[36:39], a[220:223], v[40:43]
ds_read_b128 a[4:7], v191 offset:19456
v_mfma_f32_16x16x32_bf16 v[44:47], a[40:43], a[216:219], v[44:47]
ds_read_b128 a[8:11], v191 offset:20480
buffer_load_dwordx4 a[156:159], v9, s[4:7], s52 offen offset:3072 sc1
v_mfma_f32_16x16x32_bf16 v[48:51], a[40:43], a[220:223], v[48:51]
ds_read_b128 a[12:15], v191 offset:21504
v_mfma_f32_16x16x32_bf16 v[52:55], a[44:47], a[216:219], v[52:55]
ds_read_b128 a[16:19], v191 offset:22528
v_mfma_f32_16x16x32_bf16 v[56:59], a[44:47], a[220:223], v[56:59]
ds_read_b128 a[20:23], v191 offset:23552
s_add_u32 m0, s62, 126976
v_mfma_f32_16x16x32_bf16 v[60:63], a[48:51], a[216:219], v[60:63]
ds_read_b128 a[24:27], v191 offset:24576
v_mfma_f32_16x16x32_bf16 v[64:67], a[48:51], a[220:223], v[64:67]
ds_read_b128 a[28:31], v191 offset:25600
v_mfma_f32_16x16x32_bf16 v[68:71], a[52:55], a[216:219], v[68:71]
ds_read_b128 a[32:35], v191 offset:26624
s_add_u32 s60, s60, 16384
v_mfma_f32_16x16x32_bf16 v[72:75], a[52:55], a[220:223], v[72:75]
v_rcp_f32 v187, v187
v_mfma_f32_16x16x32_bf16 v[76:79], a[56:59], a[216:219], v[76:79]
v_rcp_f32 v188, v188
v_mfma_f32_16x16x32_bf16 v[80:83], a[56:59], a[220:223], v[80:83]
buffer_load_dwordx4 v1, s[8:11], s60 offen offset:0 sc1 lds
v_mfma_f32_16x16x32_bf16 v[84:87], a[60:63], a[216:219], v[84:87]
v_rcp_f32 v189, v189
v_mfma_f32_16x16x32_bf16 v[88:91], a[60:63], a[220:223], v[88:91]
v_mul_f32 v112, v112, v186
v_mul_f32 v113, v113, v187
v_mfma_f32_16x16x32_bf16 v[92:95], a[64:67], a[216:219], v[92:95]
buffer_load_dwordx4 v1, s[8:11], s60 offen offset:1024 sc1 lds
v_mul_f32 v114, v114, v188
v_mfma_f32_16x16x32_bf16 v[96:99], a[64:67], a[220:223], v[96:99]
v_mul_f32 v115, v115, v189
v_mul_f32 v182, v116, v116
v_mfma_f32_16x16x32_bf16 v[100:103], a[68:71], a[216:219], v[100:103]
v_mul_f32 v183, v117, v117
v_mul_f32 v184, v118, v118
v_mfma_f32_16x16x32_bf16 v[104:107], a[68:71], a[220:223], v[104:107]
v_mul_f32 v185, v119, v119
s_waitcnt lgkmcnt(0)
v_mfma_f32_16x16x32_bf16 v[36:39], a[0:3], a[224:227], v[36:39]
ds_read_b128 a[36:39], v191 offset:27648
buffer_load_dwordx4 v1, s[8:11], s60 offen offset:2048 sc1 lds
v_mfma_f32_16x16x32_bf16 v[40:43], a[0:3], a[228:231], v[40:43]
ds_read_b128 a[40:43], v191 offset:28672
v_fma_f32 v182, v182, v254, v253
v_mfma_f32_16x16x32_bf16 v[44:47], a[4:7], a[224:227], v[44:47]
ds_read_b128 a[44:47], v191 offset:29696
v_fma_f32 v183, v183, v254, v253
v_mfma_f32_16x16x32_bf16 v[48:51], a[4:7], a[228:231], v[48:51]
ds_read_b128 a[48:51], v191 offset:30720
buffer_load_dwordx4 v1, s[8:11], s60 offen offset:3072 sc1 lds
v_mfma_f32_16x16x32_bf16 v[52:55], a[8:11], a[224:227], v[52:55]
ds_read_b128 a[52:55], v191 offset:31744
v_fma_f32 v184, v184, v254, v253
v_mfma_f32_16x16x32_bf16 v[56:59], a[8:11], a[228:231], v[56:59]
ds_read_b128 a[56:59], v191 offset:32768
v_fma_f32 v185, v185, v254, v253
v_mfma_f32_16x16x32_bf16 v[60:63], a[12:15], a[224:227], v[60:63]
ds_read_b128 a[60:63], v191 offset:33792
s_add_u32 s52, s52, 4096
v_mfma_f32_16x16x32_bf16 v[64:67], a[12:15], a[228:231], v[64:67]
ds_read_b128 a[64:67], v191 offset:34816
v_mul_f32 v182, v182, v116
v_mfma_f32_16x16x32_bf16 v[68:71], a[16:19], a[224:227], v[68:71]
ds_read_b128 a[68:71], v191 offset:35840
v_mul_f32 v183, v183, v117
v_mfma_f32_16x16x32_bf16 v[72:75], a[16:19], a[228:231], v[72:75]
v_mul_f32 v184, v184, v118
v_mfma_f32_16x16x32_bf16 v[76:79], a[20:23], a[224:227], v[76:79]
buffer_load_dwordx4 a[160:163], v1, s[4:7], s52 offen offset:0 sc1
v_mfma_f32_16x16x32_bf16 v[80:83], a[20:23], a[228:231], v[80:83]
v_mul_f32 v185, v185, v119
v_mfma_f32_16x16x32_bf16 v[84:87], a[24:27], a[224:227], v[84:87]
v_exp_f32 v182, v182
v_mfma_f32_16x16x32_bf16 v[88:91], a[24:27], a[228:231], v[88:91]
buffer_load_dwordx4 a[164:167], v9, s[4:7], s52 offen offset:0 sc1
v_mfma_f32_16x16x32_bf16 v[92:95], a[28:31], a[224:227], v[92:95]
v_mfma_f32_16x16x32_bf16 v[96:99], a[28:31], a[228:231], v[96:99]
v_exp_f32 v183, v183
v_mfma_f32_16x16x32_bf16 v[100:103], a[32:35], a[224:227], v[100:103]
v_mfma_f32_16x16x32_bf16 v[104:107], a[32:35], a[228:231], v[104:107]
s_waitcnt vmcnt(14)
s_waitcnt lgkmcnt(0)
s_barrier
v_mfma_f32_16x16x32_bf16 v[36:39], a[36:39], a[232:235], v[36:39]
ds_read_b128 a[0:3], v190 offset:0
buffer_load_dwordx4 a[168:171], v1, s[4:7], s52 offen offset:1024 sc1
v_mfma_f32_16x16x32_bf16 v[40:43], a[36:39], a[236:239], v[40:43]
ds_read_b128 a[4:7], v190 offset:1024
v_mfma_f32_16x16x32_bf16 v[44:47], a[40:43], a[232:235], v[44:47]
ds_read_b128 a[8:11], v190 offset:2048
buffer_load_dwordx4 a[172:175], v9, s[4:7], s52 offen offset:1024 sc1
v_mfma_f32_16x16x32_bf16 v[48:51], a[40:43], a[236:239], v[48:51]
ds_read_b128 a[12:15], v190 offset:3072
v_mfma_f32_16x16x32_bf16 v[52:55], a[44:47], a[232:235], v[52:55]
ds_read_b128 a[16:19], v190 offset:4096
s_add_u32 m0, s63, 143360
v_mfma_f32_16x16x32_bf16 v[56:59], a[44:47], a[236:239], v[56:59]
ds_read_b128 a[20:23], v190 offset:5120
v_mfma_f32_16x16x32_bf16 v[60:63], a[48:51], a[232:235], v[60:63]
ds_read_b128 a[24:27], v190 offset:6144
s_add_u32 s61, s61, 36864
v_mfma_f32_16x16x32_bf16 v[64:67], a[48:51], a[236:239], v[64:67]
ds_read_b128 a[28:31], v190 offset:7168
v_mfma_f32_16x16x32_bf16 v[68:71], a[52:55], a[232:235], v[68:71]
ds_read_b128 a[32:35], v190 offset:8192
buffer_load_dwordx4 v1, s[8:11], s61 offen offset:0 sc1 lds
v_mfma_f32_16x16x32_bf16 v[72:75], a[52:55], a[236:239], v[72:75]
s_add_u32 m0, s62, 147456
v_exp_f32 v184, v184
v_mfma_f32_16x16x32_bf16 v[76:79], a[56:59], a[232:235], v[76:79]
s_add_u32 s60, s60, 20480
v_exp_f32 v185, v185
v_mfma_f32_16x16x32_bf16 v[80:83], a[56:59], a[236:239], v[80:83]
v_fma_f32 v182, v182, v255, v255
v_fma_f32 v183, v183, v255, v255
v_mfma_f32_16x16x32_bf16 v[84:87], a[60:63], a[232:235], v[84:87]
v_fma_f32 v184, v184, v255, v255
v_fma_f32 v185, v185, v255, v255
v_mfma_f32_16x16x32_bf16 v[88:91], a[60:63], a[236:239], v[88:91]
v_rcp_f32 v182, v182
v_mfma_f32_16x16x32_bf16 v[92:95], a[64:67], a[232:235], v[92:95]
buffer_load_dwordx4 v1, s[8:11], s60 offen offset:0 sc1 lds
v_mfma_f32_16x16x32_bf16 v[96:99], a[64:67], a[236:239], v[96:99]
v_rcp_f32 v183, v183
v_mfma_f32_16x16x32_bf16 v[100:103], a[68:71], a[232:235], v[100:103]
v_mfma_f32_16x16x32_bf16 v[104:107], a[68:71], a[236:239], v[104:107]
s_waitcnt lgkmcnt(0)
v_mfma_f32_16x16x32_bf16 v[36:39], a[0:3], a[240:243], v[36:39]
ds_read_b128 a[36:39], v190 offset:9216
buffer_load_dwordx4 v1, s[8:11], s60 offen offset:1024 sc1 lds
v_mfma_f32_16x16x32_bf16 v[40:43], a[0:3], a[244:247], v[40:43]
ds_read_b128 a[40:43], v190 offset:10240
v_mfma_f32_16x16x32_bf16 v[44:47], a[4:7], a[240:243], v[44:47]
ds_read_b128 a[44:47], v190 offset:11264
v_mfma_f32_16x16x32_bf16 v[48:51], a[4:7], a[244:247], v[48:51]
ds_read_b128 a[48:51], v190 offset:12288
v_mfma_f32_16x16x32_bf16 v[52:55], a[8:11], a[240:243], v[52:55]
ds_read_b128 a[52:55], v190 offset:13312
buffer_load_dwordx4 v1, s[8:11], s60 offen offset:2048 sc1 lds
v_mfma_f32_16x16x32_bf16 v[56:59], a[8:11], a[244:247], v[56:59]
ds_read_b128 a[56:59], v190 offset:14336
v_mfma_f32_16x16x32_bf16 v[60:63], a[12:15], a[240:243], v[60:63]
ds_read_b128 a[60:63], v190 offset:15360
v_mfma_f32_16x16x32_bf16 v[64:67], a[12:15], a[244:247], v[64:67]
ds_read_b128 a[64:67], v190 offset:16384
v_mfma_f32_16x16x32_bf16 v[68:71], a[16:19], a[240:243], v[68:71]
ds_read_b128 a[68:71], v190 offset:17408
buffer_load_dwordx4 v1, s[8:11], s60 offen offset:3072 sc1 lds
v_mfma_f32_16x16x32_bf16 v[72:75], a[16:19], a[244:247], v[72:75]
v_rcp_f32 v184, v184
v_mfma_f32_16x16x32_bf16 v[76:79], a[20:23], a[240:243], v[76:79]
v_rcp_f32 v185, v185
v_mfma_f32_16x16x32_bf16 v[80:83], a[20:23], a[244:247], v[80:83]
v_mul_f32 v116, v116, v182
v_mul_f32 v117, v117, v183
v_mfma_f32_16x16x32_bf16 v[84:87], a[24:27], a[240:243], v[84:87]
buffer_load_dwordx4 a[176:179], v1, s[4:7], s52 offen offset:2048 sc1
v_mul_f32 v118, v118, v184
v_mfma_f32_16x16x32_bf16 v[88:91], a[24:27], a[244:247], v[88:91]
v_mul_f32 v119, v119, v185
v_mfma_f32_16x16x32_bf16 v[92:95], a[28:31], a[240:243], v[92:95]
v_permlane16_swap_b32 v108, v112
v_mfma_f32_16x16x32_bf16 v[96:99], a[28:31], a[244:247], v[96:99]
v_permlane16_swap_b32 v109, v113
v_mfma_f32_16x16x32_bf16 v[100:103], a[32:35], a[240:243], v[100:103]
v_mfma_f32_16x16x32_bf16 v[104:107], a[32:35], a[244:247], v[104:107]
s_waitcnt vmcnt(18)
s_waitcnt lgkmcnt(0)
s_barrier
v_mfma_f32_16x16x32_bf16 v[36:39], a[36:39], a[248:251], v[36:39]
ds_read_b128 a[0:3], v190 offset:18432
buffer_load_dwordx4 a[180:183], v9, s[4:7], s52 offen offset:2048 sc1
v_mfma_f32_16x16x32_bf16 v[40:43], a[36:39], a[252:255], v[40:43]
ds_read_b128 a[4:7], v190 offset:19456
v_mfma_f32_16x16x32_bf16 v[44:47], a[40:43], a[248:251], v[44:47]
ds_read_b128 a[8:11], v190 offset:20480
buffer_load_dwordx4 a[184:187], v1, s[4:7], s52 offen offset:3072 sc1
v_mfma_f32_16x16x32_bf16 v[48:51], a[40:43], a[252:255], v[48:51]
ds_read_b128 a[12:15], v190 offset:21504
v_mfma_f32_16x16x32_bf16 v[52:55], a[44:47], a[248:251], v[52:55]
ds_read_b128 a[16:19], v190 offset:22528
v_mfma_f32_16x16x32_bf16 v[56:59], a[44:47], a[252:255], v[56:59]
ds_read_b128 a[20:23], v190 offset:23552
buffer_load_dwordx4 a[188:191], v9, s[4:7], s52 offen offset:3072 sc1
v_mfma_f32_16x16x32_bf16 v[60:63], a[48:51], a[248:251], v[60:63]
ds_read_b128 a[24:27], v190 offset:24576
v_mfma_f32_16x16x32_bf16 v[64:67], a[48:51], a[252:255], v[64:67]
ds_read_b128 a[28:31], v190 offset:25600
v_mfma_f32_16x16x32_bf16 v[68:71], a[52:55], a[248:251], v[68:71]
ds_read_b128 a[32:35], v190 offset:26624
s_add_u32 m0, s62, 90112
v_mfma_f32_16x16x32_bf16 v[72:75], a[52:55], a[252:255], v[72:75]
s_add_u32 s60, s60, 16384
v_permlane16_swap_b32 v110, v114
v_mfma_f32_16x16x32_bf16 v[76:79], a[56:59], a[248:251], v[76:79]
v_permlane16_swap_b32 v111, v115
v_mfma_f32_16x16x32_bf16 v[80:83], a[56:59], a[252:255], v[80:83]
v_mul_f32 v186, v120, v120
v_mul_f32 v187, v121, v121
v_mfma_f32_16x16x32_bf16 v[84:87], a[60:63], a[248:251], v[84:87]
v_mul_f32 v188, v122, v122
v_mul_f32 v189, v123, v123
v_mfma_f32_16x16x32_bf16 v[88:91], a[60:63], a[252:255], v[88:91]
v_fma_f32 v186, v186, v254, v253
v_fma_f32 v187, v187, v254, v253
v_mfma_f32_16x16x32_bf16 v[92:95], a[64:67], a[248:251], v[92:95]
buffer_load_dwordx4 v1, s[8:11], s60 offen offset:0 sc1 lds
v_fma_f32 v188, v188, v254, v253
v_mfma_f32_16x16x32_bf16 v[96:99], a[64:67], a[252:255], v[96:99]
v_fma_f32 v189, v189, v254, v253
v_mfma_f32_16x16x32_bf16 v[100:103], a[68:71], a[248:251], v[100:103]
v_mul_f32 v186, v186, v120
v_mfma_f32_16x16x32_bf16 v[104:107], a[68:71], a[252:255], v[104:107]
v_mul_f32 v187, v187, v121
s_waitcnt lgkmcnt(0)
v_mfma_f32_16x16x32_bf16 v[36:39], a[0:3], a[80:83], v[36:39]
ds_read_b128 a[36:39], v190 offset:27648
buffer_load_dwordx4 v1, s[8:11], s60 offen offset:1024 sc1 lds
v_mfma_f32_16x16x32_bf16 v[40:43], a[0:3], a[84:87], v[40:43]
ds_read_b128 a[40:43], v190 offset:28672
v_mul_f32 v188, v188, v122
v_mfma_f32_16x16x32_bf16 v[44:47], a[4:7], a[80:83], v[44:47]
ds_read_b128 a[44:47], v190 offset:29696
v_mul_f32 v189, v189, v123
v_mfma_f32_16x16x32_bf16 v[48:51], a[4:7], a[84:87], v[48:51]
ds_read_b128 a[48:51], v190 offset:30720
buffer_load_dwordx4 v1, s[8:11], s60 offen offset:2048 sc1 lds
v_mfma_f32_16x16x32_bf16 v[52:55], a[8:11], a[80:83], v[52:55]
ds_read_b128 a[52:55], v190 offset:31744
v_mfma_f32_16x16x32_bf16 v[56:59], a[8:11], a[84:87], v[56:59]
ds_read_b128 a[56:59], v190 offset:32768
v_mfma_f32_16x16x32_bf16 v[60:63], a[12:15], a[80:83], v[60:63]
ds_read_b128 a[60:63], v190 offset:33792
buffer_load_dwordx4 v1, s[8:11], s60 offen offset:3072 sc1 lds
v_mfma_f32_16x16x32_bf16 v[64:67], a[12:15], a[84:87], v[64:67]
ds_read_b128 a[64:67], v190 offset:34816
v_mfma_f32_16x16x32_bf16 v[68:71], a[16:19], a[80:83], v[68:71]
ds_read_b128 a[68:71], v190 offset:35840
v_mfma_f32_16x16x32_bf16 v[72:75], a[16:19], a[84:87], v[72:75]
s_add_u32 s52, s52, 4096
v_exp_f32 v186, v186
v_mfma_f32_16x16x32_bf16 v[76:79], a[20:23], a[80:83], v[76:79]
v_exp_f32 v187, v187
v_mfma_f32_16x16x32_bf16 v[80:83], a[20:23], a[84:87], v[80:83]
v_exp_f32 v188, v188
v_mfma_f32_16x16x32_bf16 v[84:87], a[24:27], a[80:83], v[84:87]
v_exp_f32 v189, v189
v_mfma_f32_16x16x32_bf16 v[88:91], a[24:27], a[84:87], v[88:91]
buffer_load_dwordx4 a[192:195], v1, s[4:7], s52 offen offset:0 sc1
v_mfma_f32_16x16x32_bf16 v[92:95], a[28:31], a[80:83], v[92:95]
v_mfma_f32_16x16x32_bf16 v[96:99], a[28:31], a[84:87], v[96:99]
v_fma_f32 v186, v186, v255, v255
v_mfma_f32_16x16x32_bf16 v[100:103], a[32:35], a[80:83], v[100:103]
v_mfma_f32_16x16x32_bf16 v[104:107], a[32:35], a[84:87], v[104:107]
s_waitcnt vmcnt(13)
s_waitcnt lgkmcnt(0)
s_barrier
v_mfma_f32_16x16x32_bf16 v[36:39], a[36:39], a[88:91], v[36:39]
ds_read_b128 a[0:3], v191 offset:0
buffer_load_dwordx4 a[196:199], v9, s[4:7], s52 offen offset:0 sc1
v_mfma_f32_16x16x32_bf16 v[40:43], a[36:39], a[92:95], v[40:43]
ds_read_b128 a[4:7], v191 offset:1024
v_fma_f32 v187, v187, v255, v255
v_mfma_f32_16x16x32_bf16 v[44:47], a[40:43], a[88:91], v[44:47]
ds_read_b128 a[8:11], v191 offset:2048
buffer_load_dwordx4 a[200:203], v1, s[4:7], s52 offen offset:1024 sc1
v_mfma_f32_16x16x32_bf16 v[48:51], a[40:43], a[92:95], v[48:51]
ds_read_b128 a[12:15], v191 offset:3072
v_fma_f32 v188, v188, v255, v255
v_mfma_f32_16x16x32_bf16 v[52:55], a[44:47], a[88:91], v[52:55]
ds_read_b128 a[16:19], v191 offset:4096
v_fma_f32 v189, v189, v255, v255
v_mfma_f32_16x16x32_bf16 v[56:59], a[44:47], a[92:95], v[56:59]
ds_read_b128 a[20:23], v191 offset:5120
buffer_load_dwordx4 a[204:207], v9, s[4:7], s52 offen offset:1024 sc1
v_mfma_f32_16x16x32_bf16 v[60:63], a[48:51], a[88:91], v[60:63]
ds_read_b128 a[24:27], v191 offset:6144
v_mfma_f32_16x16x32_bf16 v[64:67], a[48:51], a[92:95], v[64:67]
ds_read_b128 a[28:31], v191 offset:7168
v_mfma_f32_16x16x32_bf16 v[68:71], a[52:55], a[88:91], v[68:71]
ds_read_b128 a[32:35], v191 offset:8192
s_add_u32 m0, s63, 106496
v_mfma_f32_16x16x32_bf16 v[72:75], a[52:55], a[92:95], v[72:75]
s_add_u32 s61, s61, 36864
v_rcp_f32 v186, v186
v_mfma_f32_16x16x32_bf16 v[76:79], a[56:59], a[88:91], v[76:79]
v_rcp_f32 v187, v187
v_mfma_f32_16x16x32_bf16 v[80:83], a[56:59], a[92:95], v[80:83]
v_rcp_f32 v188, v188
v_mfma_f32_16x16x32_bf16 v[84:87], a[60:63], a[88:91], v[84:87]
v_rcp_f32 v189, v189
v_mfma_f32_16x16x32_bf16 v[88:91], a[60:63], a[92:95], v[88:91]
v_mfma_f32_16x16x32_bf16 v[92:95], a[64:67], a[88:91], v[92:95]
buffer_load_dwordx4 v1, s[8:11], s61 offen offset:0 sc1 lds
v_mul_f32 v120, v120, v186
v_mfma_f32_16x16x32_bf16 v[96:99], a[64:67], a[92:95], v[96:99]
v_mfma_f32_16x16x32_bf16 v[100:103], a[68:71], a[88:91], v[100:103]
v_mul_f32 v121, v121, v187
v_mfma_f32_16x16x32_bf16 v[104:107], a[68:71], a[92:95], v[104:107]
v_mul_f32 v122, v122, v188
s_waitcnt lgkmcnt(0)
v_mfma_f32_16x16x32_bf16 v[36:39], a[0:3], a[96:99], v[36:39]
ds_read_b128 a[36:39], v191 offset:9216
s_add_u32 m0, s62, 110592
v_mfma_f32_16x16x32_bf16 v[40:43], a[0:3], a[100:103], v[40:43]
ds_read_b128 a[40:43], v191 offset:10240
v_mul_f32 v123, v123, v189
v_mfma_f32_16x16x32_bf16 v[44:47], a[4:7], a[96:99], v[44:47]
ds_read_b128 a[44:47], v191 offset:11264
s_add_u32 s60, s60, 20480
v_mfma_f32_16x16x32_bf16 v[48:51], a[4:7], a[100:103], v[48:51]
ds_read_b128 a[48:51], v191 offset:12288
v_mul_f32 v182, v124, v124
v_mfma_f32_16x16x32_bf16 v[52:55], a[8:11], a[96:99], v[52:55]
ds_read_b128 a[52:55], v191 offset:13312
v_mul_f32 v183, v125, v125
v_mfma_f32_16x16x32_bf16 v[56:59], a[8:11], a[100:103], v[56:59]
ds_read_b128 a[56:59], v191 offset:14336
buffer_load_dwordx4 v1, s[8:11], s60 offen offset:0 sc1 lds
v_mfma_f32_16x16x32_bf16 v[60:63], a[12:15], a[96:99], v[60:63]
ds_read_b128 a[60:63], v191 offset:15360
v_mul_f32 v184, v126, v126
v_mfma_f32_16x16x32_bf16 v[64:67], a[12:15], a[100:103], v[64:67]
ds_read_b128 a[64:67], v191 offset:16384
v_mul_f32 v185, v127, v127
v_mfma_f32_16x16x32_bf16 v[68:71], a[16:19], a[96:99], v[68:71]
ds_read_b128 a[68:71], v191 offset:17408
buffer_load_dwordx4 v1, s[8:11], s60 offen offset:1024 sc1 lds
v_mfma_f32_16x16x32_bf16 v[72:75], a[16:19], a[100:103], v[72:75]
v_fma_f32 v182, v182, v254, v253
v_fma_f32 v183, v183, v254, v253
v_mfma_f32_16x16x32_bf16 v[76:79], a[20:23], a[96:99], v[76:79]
v_mfma_f32_16x16x32_bf16 v[80:83], a[20:23], a[100:103], v[80:83]
buffer_load_dwordx4 v1, s[8:11], s60 offen offset:2048 sc1 lds
v_fma_f32 v184, v184, v254, v253
v_mfma_f32_16x16x32_bf16 v[84:87], a[24:27], a[96:99], v[84:87]
v_fma_f32 v185, v185, v254, v253
v_mfma_f32_16x16x32_bf16 v[88:91], a[24:27], a[100:103], v[88:91]
v_mfma_f32_16x16x32_bf16 v[92:95], a[28:31], a[96:99], v[92:95]
buffer_load_dwordx4 v1, s[8:11], s60 offen offset:3072 sc1 lds
v_mul_f32 v182, v182, v124
v_mfma_f32_16x16x32_bf16 v[96:99], a[28:31], a[100:103], v[96:99]
v_mul_f32 v183, v183, v125
v_mfma_f32_16x16x32_bf16 v[100:103], a[32:35], a[96:99], v[100:103]
v_mfma_f32_16x16x32_bf16 v[104:107], a[32:35], a[100:103], v[104:107]
s_waitcnt vmcnt(17)
s_waitcnt lgkmcnt(0)
s_barrier
v_mfma_f32_16x16x32_bf16 v[36:39], a[36:39], a[104:107], v[36:39]
ds_read_b128 a[0:3], v191 offset:18432
s_add_u32 m0, s62, 126976
v_mfma_f32_16x16x32_bf16 v[40:43], a[36:39], a[108:111], v[40:43]
ds_read_b128 a[4:7], v191 offset:19456
v_mul_f32 v184, v184, v126
v_mfma_f32_16x16x32_bf16 v[44:47], a[40:43], a[104:107], v[44:47]
ds_read_b128 a[8:11], v191 offset:20480
s_add_u32 s60, s60, 16384
v_mfma_f32_16x16x32_bf16 v[48:51], a[40:43], a[108:111], v[48:51]
ds_read_b128 a[12:15], v191 offset:21504
v_mul_f32 v185, v185, v127
v_mfma_f32_16x16x32_bf16 v[52:55], a[44:47], a[104:107], v[52:55]
ds_read_b128 a[16:19], v191 offset:22528
v_mfma_f32_16x16x32_bf16 v[56:59], a[44:47], a[108:111], v[56:59]
ds_read_b128 a[20:23], v191 offset:23552
buffer_load_dwordx4 v1, s[8:11], s60 offen offset:0 sc1 lds
v_mfma_f32_16x16x32_bf16 v[60:63], a[48:51], a[104:107], v[60:63]
ds_read_b128 a[24:27], v191 offset:24576
v_mfma_f32_16x16x32_bf16 v[64:67], a[48:51], a[108:111], v[64:67]
ds_read_b128 a[28:31], v191 offset:25600
v_mfma_f32_16x16x32_bf16 v[68:71], a[52:55], a[104:107], v[68:71]
ds_read_b128 a[32:35], v191 offset:26624
buffer_load_dwordx4 v1, s[8:11], s60 offen offset:1024 sc1 lds
v_mfma_f32_16x16x32_bf16 v[72:75], a[52:55], a[108:111], v[72:75]
v_exp_f32 v182, v182
v_mfma_f32_16x16x32_bf16 v[76:79], a[56:59], a[104:107], v[76:79]
v_exp_f32 v183, v183
v_mfma_f32_16x16x32_bf16 v[80:83], a[56:59], a[108:111], v[80:83]
buffer_load_dwordx4 v1, s[8:11], s60 offen offset:2048 sc1 lds
v_mfma_f32_16x16x32_bf16 v[84:87], a[60:63], a[104:107], v[84:87]
v_exp_f32 v184, v184
v_mfma_f32_16x16x32_bf16 v[88:91], a[60:63], a[108:111], v[88:91]
v_exp_f32 v185, v185
v_mfma_f32_16x16x32_bf16 v[92:95], a[64:67], a[104:107], v[92:95]
buffer_load_dwordx4 v1, s[8:11], s60 offen offset:3072 sc1 lds
v_fma_f32 v182, v182, v255, v255
v_mfma_f32_16x16x32_bf16 v[96:99], a[64:67], a[108:111], v[96:99]
v_fma_f32 v183, v183, v255, v255
v_mfma_f32_16x16x32_bf16 v[100:103], a[68:71], a[104:107], v[100:103]
v_fma_f32 v184, v184, v255, v255
v_mfma_f32_16x16x32_bf16 v[104:107], a[68:71], a[108:111], v[104:107]
v_fma_f32 v185, v185, v255, v255
s_waitcnt lgkmcnt(0)
v_mfma_f32_16x16x32_bf16 v[36:39], a[0:3], a[112:115], v[36:39]
ds_read_b128 a[36:39], v191 offset:27648
buffer_load_dwordx4 a[208:211], v1, s[4:7], s52 offen offset:2048 sc1
v_mfma_f32_16x16x32_bf16 v[40:43], a[0:3], a[116:119], v[40:43]
ds_read_b128 a[40:43], v191 offset:28672
v_mfma_f32_16x16x32_bf16 v[44:47], a[4:7], a[112:115], v[44:47]
ds_read_b128 a[44:47], v191 offset:29696
v_mfma_f32_16x16x32_bf16 v[48:51], a[4:7], a[116:119], v[48:51]
ds_read_b128 a[48:51], v191 offset:30720
v_mfma_f32_16x16x32_bf16 v[52:55], a[8:11], a[112:115], v[52:55]
ds_read_b128 a[52:55], v191 offset:31744
buffer_load_dwordx4 a[212:215], v9, s[4:7], s52 offen offset:2048 sc1
v_mfma_f32_16x16x32_bf16 v[56:59], a[8:11], a[116:119], v[56:59]
ds_read_b128 a[56:59], v191 offset:32768
v_mfma_f32_16x16x32_bf16 v[60:63], a[12:15], a[112:115], v[60:63]
ds_read_b128 a[60:63], v191 offset:33792
v_mfma_f32_16x16x32_bf16 v[64:67], a[12:15], a[116:119], v[64:67]
ds_read_b128 a[64:67], v191 offset:34816
v_mfma_f32_16x16x32_bf16 v[68:71], a[16:19], a[112:115], v[68:71]
ds_read_b128 a[68:71], v191 offset:35840
buffer_load_dwordx4 a[216:219], v1, s[4:7], s52 offen offset:3072 sc1
v_mfma_f32_16x16x32_bf16 v[72:75], a[16:19], a[116:119], v[72:75]
v_rcp_f32 v182, v182
v_mfma_f32_16x16x32_bf16 v[76:79], a[20:23], a[112:115], v[76:79]
v_rcp_f32 v183, v183
v_mfma_f32_16x16x32_bf16 v[80:83], a[20:23], a[116:119], v[80:83]
v_rcp_f32 v184, v184
v_mfma_f32_16x16x32_bf16 v[84:87], a[24:27], a[112:115], v[84:87]
buffer_load_dwordx4 a[220:223], v9, s[4:7], s52 offen offset:3072 sc1
v_mfma_f32_16x16x32_bf16 v[88:91], a[24:27], a[116:119], v[88:91]
v_rcp_f32 v185, v185
v_mfma_f32_16x16x32_bf16 v[92:95], a[28:31], a[112:115], v[92:95]
v_mul_f32 v124, v124, v182
v_mul_f32 v125, v125, v183
v_mfma_f32_16x16x32_bf16 v[96:99], a[28:31], a[116:119], v[96:99]
v_mul_f32 v126, v126, v184
v_mfma_f32_16x16x32_bf16 v[100:103], a[32:35], a[112:115], v[100:103]
v_mul_f32 v127, v127, v185
v_mfma_f32_16x16x32_bf16 v[104:107], a[32:35], a[116:119], v[104:107]
s_waitcnt vmcnt(12)
s_waitcnt lgkmcnt(0)
s_barrier
v_mfma_f32_16x16x32_bf16 v[36:39], a[36:39], a[120:123], v[36:39]
ds_read_b128 a[0:3], v190 offset:0
s_add_u32 m0, s63, 143360
v_mfma_f32_16x16x32_bf16 v[40:43], a[36:39], a[124:127], v[40:43]
ds_read_b128 a[4:7], v190 offset:1024
v_mfma_f32_16x16x32_bf16 v[44:47], a[40:43], a[120:123], v[44:47]
ds_read_b128 a[8:11], v190 offset:2048
s_add_u32 s61, s61, 36864
v_mfma_f32_16x16x32_bf16 v[48:51], a[40:43], a[124:127], v[48:51]
ds_read_b128 a[12:15], v190 offset:3072
v_mfma_f32_16x16x32_bf16 v[52:55], a[44:47], a[120:123], v[52:55]
ds_read_b128 a[16:19], v190 offset:4096
buffer_load_dwordx4 v1, s[8:11], s61 offen offset:0 sc1 lds
v_mfma_f32_16x16x32_bf16 v[56:59], a[44:47], a[124:127], v[56:59]
ds_read_b128 a[20:23], v190 offset:5120
v_mfma_f32_16x16x32_bf16 v[60:63], a[48:51], a[120:123], v[60:63]
ds_read_b128 a[24:27], v190 offset:6144
s_add_u32 m0, s62, 147456
v_mfma_f32_16x16x32_bf16 v[64:67], a[48:51], a[124:127], v[64:67]
ds_read_b128 a[28:31], v190 offset:7168
v_mfma_f32_16x16x32_bf16 v[68:71], a[52:55], a[120:123], v[68:71]
ds_read_b128 a[32:35], v190 offset:8192
s_add_u32 s60, s60, 20480
v_mfma_f32_16x16x32_bf16 v[72:75], a[52:55], a[124:127], v[72:75]
v_permlane16_swap_b32 v116, v120
v_mfma_f32_16x16x32_bf16 v[76:79], a[56:59], a[120:123], v[76:79]
buffer_load_dwordx4 v1, s[8:11], s60 offen offset:0 sc1 lds
v_mfma_f32_16x16x32_bf16 v[80:83], a[56:59], a[124:127], v[80:83]
v_permlane16_swap_b32 v117, v121
v_mfma_f32_16x16x32_bf16 v[84:87], a[60:63], a[120:123], v[84:87]
buffer_load_dwordx4 v1, s[8:11], s60 offen offset:1024 sc1 lds
v_mfma_f32_16x16x32_bf16 v[88:91], a[60:63], a[124:127], v[88:91]
v_permlane16_swap_b32 v118, v122
v_mfma_f32_16x16x32_bf16 v[92:95], a[64:67], a[120:123], v[92:95]
buffer_load_dwordx4 v1, s[8:11], s60 offen offset:2048 sc1 lds
v_mfma_f32_16x16x32_bf16 v[96:99], a[64:67], a[124:127], v[96:99]
v_permlane16_swap_b32 v119, v123
v_mfma_f32_16x16x32_bf16 v[100:103], a[68:71], a[120:123], v[100:103]
v_mul_f32 v186, v128, v128
v_mul_f32 v187, v129, v129
v_mfma_f32_16x16x32_bf16 v[104:107], a[68:71], a[124:127], v[104:107]
v_mul_f32 v188, v130, v130
s_waitcnt lgkmcnt(0)
v_mfma_f32_16x16x32_bf16 v[36:39], a[0:3], a[128:131], v[36:39]
ds_read_b128 a[36:39], v190 offset:9216
buffer_load_dwordx4 v1, s[8:11], s60 offen offset:3072 sc1 lds
v_mfma_f32_16x16x32_bf16 v[40:43], a[0:3], a[132:135], v[40:43]
ds_read_b128 a[40:43], v190 offset:10240
v_mul_f32 v189, v131, v131
v_mfma_f32_16x16x32_bf16 v[44:47], a[4:7], a[128:131], v[44:47]
ds_read_b128 a[44:47], v190 offset:11264
v_fma_f32 v186, v186, v254, v253
v_mfma_f32_16x16x32_bf16 v[48:51], a[4:7], a[132:135], v[48:51]
ds_read_b128 a[48:51], v190 offset:12288
s_add_u32 s52, s52, 4096
v_mfma_f32_16x16x32_bf16 v[52:55], a[8:11], a[128:131], v[52:55]
ds_read_b128 a[52:55], v190 offset:13312
v_fma_f32 v187, v187, v254, v253
v_mfma_f32_16x16x32_bf16 v[56:59], a[8:11], a[132:135], v[56:59]
ds_read_b128 a[56:59], v190 offset:14336
v_fma_f32 v188, v188, v254, v253
v_mfma_f32_16x16x32_bf16 v[60:63], a[12:15], a[128:131], v[60:63]
ds_read_b128 a[60:63], v190 offset:15360
buffer_load_dwordx4 a[224:227], v1, s[4:7], s52 offen offset:0 sc1
v_mfma_f32_16x16x32_bf16 v[64:67], a[12:15], a[132:135], v[64:67]
ds_read_b128 a[64:67], v190 offset:16384
v_fma_f32 v189, v189, v254, v253
v_mfma_f32_16x16x32_bf16 v[68:71], a[16:19], a[128:131], v[68:71]
ds_read_b128 a[68:71], v190 offset:17408
v_mul_f32 v186, v186, v128
v_mfma_f32_16x16x32_bf16 v[72:75], a[16:19], a[132:135], v[72:75]
v_mul_f32 v187, v187, v129
v_mul_f32 v188, v188, v130
v_mfma_f32_16x16x32_bf16 v[76:79], a[20:23], a[128:131], v[76:79]
buffer_load_dwordx4 a[228:231], v9, s[4:7], s52 offen offset:0 sc1
v_mul_f32 v189, v189, v131
v_mfma_f32_16x16x32_bf16 v[80:83], a[20:23], a[132:135], v[80:83]
v_exp_f32 v186, v186
v_mfma_f32_16x16x32_bf16 v[84:87], a[24:27], a[128:131], v[84:87]
v_mfma_f32_16x16x32_bf16 v[88:91], a[24:27], a[132:135], v[88:91]
buffer_load_dwordx4 a[232:235], v1, s[4:7], s52 offen offset:1024 sc1
v_mfma_f32_16x16x32_bf16 v[92:95], a[28:31], a[128:131], v[92:95]
v_exp_f32 v187, v187
v_mfma_f32_16x16x32_bf16 v[96:99], a[28:31], a[132:135], v[96:99]
v_mfma_f32_16x16x32_bf16 v[100:103], a[32:35], a[128:131], v[100:103]
v_exp_f32 v188, v188
v_mfma_f32_16x16x32_bf16 v[104:107], a[32:35], a[132:135], v[104:107]
s_waitcnt vmcnt(16)
s_waitcnt lgkmcnt(0)
s_barrier
v_mfma_f32_16x16x32_bf16 v[36:39], a[36:39], a[136:139], v[36:39]
ds_read_b128 a[0:3], v190 offset:18432
buffer_load_dwordx4 a[236:239], v9, s[4:7], s52 offen offset:1024 sc1
v_mfma_f32_16x16x32_bf16 v[40:43], a[36:39], a[140:143], v[40:43]
ds_read_b128 a[4:7], v190 offset:19456
v_mfma_f32_16x16x32_bf16 v[44:47], a[40:43], a[136:139], v[44:47]
ds_read_b128 a[8:11], v190 offset:20480
s_add_u32 m0, s62, 90112
v_mfma_f32_16x16x32_bf16 v[48:51], a[40:43], a[140:143], v[48:51]
ds_read_b128 a[12:15], v190 offset:21504
v_mfma_f32_16x16x32_bf16 v[52:55], a[44:47], a[136:139], v[52:55]
ds_read_b128 a[16:19], v190 offset:22528
v_mfma_f32_16x16x32_bf16 v[56:59], a[44:47], a[140:143], v[56:59]
ds_read_b128 a[20:23], v190 offset:23552
s_add_u32 s60, s60, 16384
v_mfma_f32_16x16x32_bf16 v[60:63], a[48:51], a[136:139], v[60:63]
ds_read_b128 a[24:27], v190 offset:24576
v_mfma_f32_16x16x32_bf16 v[64:67], a[48:51], a[140:143], v[64:67]
ds_read_b128 a[28:31], v190 offset:25600
v_mfma_f32_16x16x32_bf16 v[68:71], a[52:55], a[136:139], v[68:71]
ds_read_b128 a[32:35], v190 offset:26624
buffer_load_dwordx4 v1, s[8:11], s60 offen offset:0 sc1 lds
v_mfma_f32_16x16x32_bf16 v[72:75], a[52:55], a[140:143], v[72:75]
v_exp_f32 v189, v189
v_mfma_f32_16x16x32_bf16 v[76:79], a[56:59], a[136:139], v[76:79]
v_fma_f32 v186, v186, v255, v255
v_fma_f32 v187, v187, v255, v255
v_mfma_f32_16x16x32_bf16 v[80:83], a[56:59], a[140:143], v[80:83]
buffer_load_dwordx4 v1, s[8:11], s60 offen offset:1024 sc1 lds
v_fma_f32 v188, v188, v255, v255
v_mfma_f32_16x16x32_bf16 v[84:87], a[60:63], a[136:139], v[84:87]
v_fma_f32 v189, v189, v255, v255
v_mfma_f32_16x16x32_bf16 v[88:91], a[60:63], a[140:143], v[88:91]
v_rcp_f32 v186, v186
v_mfma_f32_16x16x32_bf16 v[92:95], a[64:67], a[136:139], v[92:95]
buffer_load_dwordx4 v1, s[8:11], s60 offen offset:2048 sc1 lds
v_mfma_f32_16x16x32_bf16 v[96:99], a[64:67], a[140:143], v[96:99]
v_rcp_f32 v187, v187
v_mfma_f32_16x16x32_bf16 v[100:103], a[68:71], a[136:139], v[100:103]
v_rcp_f32 v188, v188
v_mfma_f32_16x16x32_bf16 v[104:107], a[68:71], a[140:143], v[104:107]
s_waitcnt lgkmcnt(0)
v_mfma_f32_16x16x32_bf16 v[36:39], a[0:3], a[144:147], v[36:39]
ds_read_b128 a[36:39], v190 offset:27648
buffer_load_dwordx4 v1, s[8:11], s60 offen offset:3072 sc1 lds
v_mfma_f32_16x16x32_bf16 v[40:43], a[0:3], a[148:151], v[40:43]
ds_read_b128 a[40:43], v190 offset:28672
v_mfma_f32_16x16x32_bf16 v[44:47], a[4:7], a[144:147], v[44:47]
ds_read_b128 a[44:47], v190 offset:29696
v_mfma_f32_16x16x32_bf16 v[48:51], a[4:7], a[148:151], v[48:51]
ds_read_b128 a[48:51], v190 offset:30720
v_mfma_f32_16x16x32_bf16 v[52:55], a[8:11], a[144:147], v[52:55]
ds_read_b128 a[52:55], v190 offset:31744
buffer_load_dwordx4 a[240:243], v1, s[4:7], s52 offen offset:2048 sc1
v_mfma_f32_16x16x32_bf16 v[56:59], a[8:11], a[148:151], v[56:59]
ds_read_b128 a[56:59], v190 offset:32768
v_mfma_f32_16x16x32_bf16 v[60:63], a[12:15], a[144:147], v[60:63]
ds_read_b128 a[60:63], v190 offset:33792
v_mfma_f32_16x16x32_bf16 v[64:67], a[12:15], a[148:151], v[64:67]
ds_read_b128 a[64:67], v190 offset:34816
v_mfma_f32_16x16x32_bf16 v[68:71], a[16:19], a[144:147], v[68:71]
ds_read_b128 a[68:71], v190 offset:35840
buffer_load_dwordx4 a[244:247], v9, s[4:7], s52 offen offset:2048 sc1
v_mfma_f32_16x16x32_bf16 v[72:75], a[16:19], a[148:151], v[72:75]
v_rcp_f32 v189, v189
v_mfma_f32_16x16x32_bf16 v[76:79], a[20:23], a[144:147], v[76:79]
v_mul_f32 v128, v128, v186
v_mul_f32 v129, v129, v187
v_mfma_f32_16x16x32_bf16 v[80:83], a[20:23], a[148:151], v[80:83]
v_mul_f32 v130, v130, v188
v_mul_f32 v131, v131, v189
v_mfma_f32_16x16x32_bf16 v[84:87], a[24:27], a[144:147], v[84:87]
buffer_load_dwordx4 a[248:251], v1, s[4:7], s52 offen offset:3072 sc1
v_mul_f32 v182, v132, v132
v_mfma_f32_16x16x32_bf16 v[88:91], a[24:27], a[148:151], v[88:91]
v_mul_f32 v183, v133, v133
v_mul_f32 v184, v134, v134
v_mfma_f32_16x16x32_bf16 v[92:95], a[28:31], a[144:147], v[92:95]
v_mul_f32 v185, v135, v135
v_mfma_f32_16x16x32_bf16 v[96:99], a[28:31], a[148:151], v[96:99]
v_fma_f32 v182, v182, v254, v253
v_mfma_f32_16x16x32_bf16 v[100:103], a[32:35], a[144:147], v[100:103]
v_fma_f32 v183, v183, v254, v253
v_mfma_f32_16x16x32_bf16 v[104:107], a[32:35], a[148:151], v[104:107]
s_waitcnt vmcnt(15)
s_waitcnt lgkmcnt(0)
s_barrier
v_mfma_f32_16x16x32_bf16 v[36:39], a[36:39], a[152:155], v[36:39]
ds_read_b128 a[0:3], v191 offset:0
buffer_load_dwordx4 a[252:255], v9, s[4:7], s52 offen offset:3072 sc1
v_mfma_f32_16x16x32_bf16 v[40:43], a[36:39], a[156:159], v[40:43]
ds_read_b128 a[4:7], v191 offset:1024
v_fma_f32 v184, v184, v254, v253
v_mfma_f32_16x16x32_bf16 v[44:47], a[40:43], a[152:155], v[44:47]
ds_read_b128 a[8:11], v191 offset:2048
s_add_u32 m0, s63, 106496
v_mfma_f32_16x16x32_bf16 v[48:51], a[40:43], a[156:159], v[48:51]
ds_read_b128 a[12:15], v191 offset:3072
v_fma_f32 v185, v185, v254, v253
v_mfma_f32_16x16x32_bf16 v[52:55], a[44:47], a[152:155], v[52:55]
ds_read_b128 a[16:19], v191 offset:4096
s_add_u32 s61, s61, 36864
v_mfma_f32_16x16x32_bf16 v[56:59], a[44:47], a[156:159], v[56:59]
ds_read_b128 a[20:23], v191 offset:5120
v_mul_f32 v182, v182, v132
v_mfma_f32_16x16x32_bf16 v[60:63], a[48:51], a[152:155], v[60:63]
ds_read_b128 a[24:27], v191 offset:6144
buffer_load_dwordx4 v1, s[8:11], s61 offen offset:0 sc1 lds
v_mfma_f32_16x16x32_bf16 v[64:67], a[48:51], a[156:159], v[64:67]
ds_read_b128 a[28:31], v191 offset:7168
v_mul_f32 v183, v183, v133
v_mfma_f32_16x16x32_bf16 v[68:71], a[52:55], a[152:155], v[68:71]
ds_read_b128 a[32:35], v191 offset:8192
s_add_u32 m0, s62, 110592
v_mfma_f32_16x16x32_bf16 v[72:75], a[52:55], a[156:159], v[72:75]
s_add_u32 s60, s60, 20480
v_mul_f32 v184, v184, v134
v_mul_f32 v185, v185, v135
v_mfma_f32_16x16x32_bf16 v[76:79], a[56:59], a[152:155], v[76:79]
v_exp_f32 v182, v182
v_mfma_f32_16x16x32_bf16 v[80:83], a[56:59], a[156:159], v[80:83]
v_exp_f32 v183, v183
v_mfma_f32_16x16x32_bf16 v[84:87], a[60:63], a[152:155], v[84:87]
buffer_load_dwordx4 v1, s[8:11], s60 offen offset:0 sc1 lds
v_mfma_f32_16x16x32_bf16 v[88:91], a[60:63], a[156:159], v[88:91]
v_mfma_f32_16x16x32_bf16 v[92:95], a[64:67], a[152:155], v[92:95]
buffer_load_dwordx4 v1, s[8:11], s60 offen offset:1024 sc1 lds
v_mfma_f32_16x16x32_bf16 v[96:99], a[64:67], a[156:159], v[96:99]
v_exp_f32 v184, v184
v_mfma_f32_16x16x32_bf16 v[100:103], a[68:71], a[152:155], v[100:103]
v_mfma_f32_16x16x32_bf16 v[104:107], a[68:71], a[156:159], v[104:107]
s_waitcnt lgkmcnt(0)
v_mfma_f32_16x16x32_bf16 v[36:39], a[0:3], a[160:163], v[36:39]
ds_read_b128 a[36:39], v191 offset:9216
buffer_load_dwordx4 v1, s[8:11], s60 offen offset:2048 sc1 lds
v_mfma_f32_16x16x32_bf16 v[40:43], a[0:3], a[164:167], v[40:43]
ds_read_b128 a[40:43], v191 offset:10240
v_mfma_f32_16x16x32_bf16 v[44:47], a[4:7], a[160:163], v[44:47]
ds_read_b128 a[44:47], v191 offset:11264
v_mfma_f32_16x16x32_bf16 v[48:51], a[4:7], a[164:167], v[48:51]
ds_read_b128 a[48:51], v191 offset:12288
buffer_load_dwordx4 v1, s[8:11], s60 offen offset:3072 sc1 lds
v_mfma_f32_16x16x32_bf16 v[52:55], a[8:11], a[160:163], v[52:55]
ds_read_b128 a[52:55], v191 offset:13312
v_mfma_f32_16x16x32_bf16 v[56:59], a[8:11], a[164:167], v[56:59]
ds_read_b128 a[56:59], v191 offset:14336
v_mfma_f32_16x16x32_bf16 v[60:63], a[12:15], a[160:163], v[60:63]
ds_read_b128 a[60:63], v191 offset:15360
s_add_u32 s52, s52, 4096
v_mfma_f32_16x16x32_bf16 v[64:67], a[12:15], a[164:167], v[64:67]
ds_read_b128 a[64:67], v191 offset:16384
v_mfma_f32_16x16x32_bf16 v[68:71], a[16:19], a[160:163], v[68:71]
ds_read_b128 a[68:71], v191 offset:17408
v_mfma_f32_16x16x32_bf16 v[72:75], a[16:19], a[164:167], v[72:75]
v_exp_f32 v185, v185
v_mfma_f32_16x16x32_bf16 v[76:79], a[20:23], a[160:163], v[76:79]
buffer_load_dwordx4 a[80:83], v1, s[4:7], s52 offen offset:0 sc1
v_fma_f32 v182, v182, v255, v255
v_mfma_f32_16x16x32_bf16 v[80:83], a[20:23], a[164:167], v[80:83]
v_fma_f32 v183, v183, v255, v255
v_fma_f32 v184, v184, v255, v255
v_mfma_f32_16x16x32_bf16 v[84:87], a[24:27], a[160:163], v[84:87]
v_fma_f32 v185, v185, v255, v255
v_mfma_f32_16x16x32_bf16 v[88:91], a[24:27], a[164:167], v[88:91]
buffer_load_dwordx4 a[84:87], v9, s[4:7], s52 offen offset:0 sc1
v_mfma_f32_16x16x32_bf16 v[92:95], a[28:31], a[160:163], v[92:95]
v_rcp_f32 v182, v182
v_mfma_f32_16x16x32_bf16 v[96:99], a[28:31], a[164:167], v[96:99]
v_rcp_f32 v183, v183
v_mfma_f32_16x16x32_bf16 v[100:103], a[32:35], a[160:163], v[100:103]
v_rcp_f32 v184, v184
v_mfma_f32_16x16x32_bf16 v[104:107], a[32:35], a[164:167], v[104:107]
s_waitcnt vmcnt(19)
s_waitcnt lgkmcnt(0)
s_barrier
v_mfma_f32_16x16x32_bf16 v[36:39], a[36:39], a[168:171], v[36:39]
ds_read_b128 a[0:3], v191 offset:18432
buffer_load_dwordx4 a[88:91], v1, s[4:7], s52 offen offset:1024 sc1
v_mfma_f32_16x16x32_bf16 v[40:43], a[36:39], a[172:175], v[40:43]
ds_read_b128 a[4:7], v191 offset:19456
v_mfma_f32_16x16x32_bf16 v[44:47], a[40:43], a[168:171], v[44:47]
ds_read_b128 a[8:11], v191 offset:20480
buffer_load_dwordx4 a[92:95], v9, s[4:7], s52 offen offset:1024 sc1
v_mfma_f32_16x16x32_bf16 v[48:51], a[40:43], a[172:175], v[48:51]
ds_read_b128 a[12:15], v191 offset:21504
v_mfma_f32_16x16x32_bf16 v[52:55], a[44:47], a[168:171], v[52:55]
ds_read_b128 a[16:19], v191 offset:22528
v_mfma_f32_16x16x32_bf16 v[56:59], a[44:47], a[172:175], v[56:59]
ds_read_b128 a[20:23], v191 offset:23552
s_add_u32 m0, s62, 126976
v_mfma_f32_16x16x32_bf16 v[60:63], a[48:51], a[168:171], v[60:63]
ds_read_b128 a[24:27], v191 offset:24576
v_mfma_f32_16x16x32_bf16 v[64:67], a[48:51], a[172:175], v[64:67]
ds_read_b128 a[28:31], v191 offset:25600
v_mfma_f32_16x16x32_bf16 v[68:71], a[52:55], a[168:171], v[68:71]
ds_read_b128 a[32:35], v191 offset:26624
s_add_u32 s60, s60, 16384
v_mfma_f32_16x16x32_bf16 v[72:75], a[52:55], a[172:175], v[72:75]
v_rcp_f32 v185, v185
v_mfma_f32_16x16x32_bf16 v[76:79], a[56:59], a[168:171], v[76:79]
v_mul_f32 v132, v132, v182
v_mul_f32 v133, v133, v183
v_mfma_f32_16x16x32_bf16 v[80:83], a[56:59], a[172:175], v[80:83]
buffer_load_dwordx4 v1, s[8:11], s60 offen offset:0 sc1 lds
v_mul_f32 v134, v134, v184
v_mfma_f32_16x16x32_bf16 v[84:87], a[60:63], a[168:171], v[84:87]
v_mul_f32 v135, v135, v185
v_mfma_f32_16x16x32_bf16 v[88:91], a[60:63], a[172:175], v[88:91]
v_permlane16_swap_b32 v124, v128
v_mfma_f32_16x16x32_bf16 v[92:95], a[64:67], a[168:171], v[92:95]
buffer_load_dwordx4 v1, s[8:11], s60 offen offset:1024 sc1 lds
v_mfma_f32_16x16x32_bf16 v[96:99], a[64:67], a[172:175], v[96:99]
v_permlane16_swap_b32 v125, v129
v_mfma_f32_16x16x32_bf16 v[100:103], a[68:71], a[168:171], v[100:103]
v_permlane16_swap_b32 v126, v130
v_mfma_f32_16x16x32_bf16 v[104:107], a[68:71], a[172:175], v[104:107]
s_waitcnt lgkmcnt(0)
v_mfma_f32_16x16x32_bf16 v[36:39], a[0:3], a[176:179], v[36:39]
ds_read_b128 a[36:39], v191 offset:27648
buffer_load_dwordx4 v1, s[8:11], s60 offen offset:2048 sc1 lds
v_mfma_f32_16x16x32_bf16 v[40:43], a[0:3], a[180:183], v[40:43]
ds_read_b128 a[40:43], v191 offset:28672
v_mfma_f32_16x16x32_bf16 v[44:47], a[4:7], a[176:179], v[44:47]
ds_read_b128 a[44:47], v191 offset:29696
v_mfma_f32_16x16x32_bf16 v[48:51], a[4:7], a[180:183], v[48:51]
ds_read_b128 a[48:51], v191 offset:30720
v_mfma_f32_16x16x32_bf16 v[52:55], a[8:11], a[176:179], v[52:55]
ds_read_b128 a[52:55], v191 offset:31744
buffer_load_dwordx4 v1, s[8:11], s60 offen offset:3072 sc1 lds
v_mfma_f32_16x16x32_bf16 v[56:59], a[8:11], a[180:183], v[56:59]
ds_read_b128 a[56:59], v191 offset:32768
v_mfma_f32_16x16x32_bf16 v[60:63], a[12:15], a[176:179], v[60:63]
ds_read_b128 a[60:63], v191 offset:33792
v_mfma_f32_16x16x32_bf16 v[64:67], a[12:15], a[180:183], v[64:67]
ds_read_b128 a[64:67], v191 offset:34816
v_mfma_f32_16x16x32_bf16 v[68:71], a[16:19], a[176:179], v[68:71]
ds_read_b128 a[68:71], v191 offset:35840
buffer_load_dwordx4 a[96:99], v1, s[4:7], s52 offen offset:2048 sc1
v_mfma_f32_16x16x32_bf16 v[72:75], a[16:19], a[180:183], v[72:75]
v_permlane16_swap_b32 v127, v131
v_mfma_f32_16x16x32_bf16 v[76:79], a[20:23], a[176:179], v[76:79]
v_mul_f32 v186, v136, v136
v_mul_f32 v187, v137, v137
v_mfma_f32_16x16x32_bf16 v[80:83], a[20:23], a[180:183], v[80:83]
v_mul_f32 v188, v138, v138
v_mul_f32 v189, v139, v139
v_mfma_f32_16x16x32_bf16 v[84:87], a[24:27], a[176:179], v[84:87]
buffer_load_dwordx4 a[100:103], v9, s[4:7], s52 offen offset:2048 sc1
v_fma_f32 v186, v186, v254, v253
v_mfma_f32_16x16x32_bf16 v[88:91], a[24:27], a[180:183], v[88:91]
v_fma_f32 v187, v187, v254, v253
v_fma_f32 v188, v188, v254, v253
v_mfma_f32_16x16x32_bf16 v[92:95], a[28:31], a[176:179], v[92:95]
v_fma_f32 v189, v189, v254, v253
v_mul_f32 v186, v186, v136
v_mfma_f32_16x16x32_bf16 v[96:99], a[28:31], a[180:183], v[96:99]
v_mul_f32 v187, v187, v137
v_mul_f32 v188, v188, v138
v_mfma_f32_16x16x32_bf16 v[100:103], a[32:35], a[176:179], v[100:103]
v_mul_f32 v189, v189, v139
v_mfma_f32_16x16x32_bf16 v[104:107], a[32:35], a[180:183], v[104:107]
s_waitcnt vmcnt(14)
s_waitcnt lgkmcnt(0)
s_barrier
v_mfma_f32_16x16x32_bf16 v[36:39], a[36:39], a[184:187], v[36:39]
ds_read_b128 a[0:3], v190 offset:0
buffer_load_dwordx4 a[104:107], v1, s[4:7], s52 offen offset:3072 sc1
v_mfma_f32_16x16x32_bf16 v[40:43], a[36:39], a[188:191], v[40:43]
ds_read_b128 a[4:7], v190 offset:1024
v_mfma_f32_16x16x32_bf16 v[44:47], a[40:43], a[184:187], v[44:47]
ds_read_b128 a[8:11], v190 offset:2048
buffer_load_dwordx4 a[108:111], v9, s[4:7], s52 offen offset:3072 sc1
v_mfma_f32_16x16x32_bf16 v[48:51], a[40:43], a[188:191], v[48:51]
ds_read_b128 a[12:15], v190 offset:3072
v_mfma_f32_16x16x32_bf16 v[52:55], a[44:47], a[184:187], v[52:55]
ds_read_b128 a[16:19], v190 offset:4096
s_add_u32 m0, s63, 143360
v_mfma_f32_16x16x32_bf16 v[56:59], a[44:47], a[188:191], v[56:59]
ds_read_b128 a[20:23], v190 offset:5120
v_mfma_f32_16x16x32_bf16 v[60:63], a[48:51], a[184:187], v[60:63]
ds_read_b128 a[24:27], v190 offset:6144
s_add_u32 s61, s61, 36864
v_mfma_f32_16x16x32_bf16 v[64:67], a[48:51], a[188:191], v[64:67]
ds_read_b128 a[28:31], v190 offset:7168
v_mfma_f32_16x16x32_bf16 v[68:71], a[52:55], a[184:187], v[68:71]
ds_read_b128 a[32:35], v190 offset:8192
buffer_load_dwordx4 v1, s[8:11], s61 offen offset:0 sc1 lds
v_mfma_f32_16x16x32_bf16 v[72:75], a[52:55], a[188:191], v[72:75]
s_add_u32 m0, s62, 147456
v_exp_f32 v186, v186
v_mfma_f32_16x16x32_bf16 v[76:79], a[56:59], a[184:187], v[76:79]
s_add_u32 s60, s60, 20480
v_exp_f32 v187, v187
v_mfma_f32_16x16x32_bf16 v[80:83], a[56:59], a[188:191], v[80:83]
v_exp_f32 v188, v188
v_mfma_f32_16x16x32_bf16 v[84:87], a[60:63], a[184:187], v[84:87]
v_exp_f32 v189, v189
v_mfma_f32_16x16x32_bf16 v[88:91], a[60:63], a[188:191], v[88:91]
v_fma_f32 v186, v186, v255, v255
v_fma_f32 v187, v187, v255, v255
v_mfma_f32_16x16x32_bf16 v[92:95], a[64:67], a[184:187], v[92:95]
buffer_load_dwordx4 v1, s[8:11], s60 offen offset:0 sc1 lds
v_fma_f32 v188, v188, v255, v255
v_mfma_f32_16x16x32_bf16 v[96:99], a[64:67], a[188:191], v[96:99]
v_mfma_f32_16x16x32_bf16 v[100:103], a[68:71], a[184:187], v[100:103]
v_fma_f32 v189, v189, v255, v255
v_mfma_f32_16x16x32_bf16 v[104:107], a[68:71], a[188:191], v[104:107]
s_waitcnt lgkmcnt(0)
v_mfma_f32_16x16x32_bf16 v[36:39], a[0:3], a[192:195], v[36:39]
ds_read_b128 a[36:39], v190 offset:9216
buffer_load_dwordx4 v1, s[8:11], s60 offen offset:1024 sc1 lds
v_mfma_f32_16x16x32_bf16 v[40:43], a[0:3], a[196:199], v[40:43]
ds_read_b128 a[40:43], v190 offset:10240
v_mfma_f32_16x16x32_bf16 v[44:47], a[4:7], a[192:195], v[44:47]
ds_read_b128 a[44:47], v190 offset:11264
v_mfma_f32_16x16x32_bf16 v[48:51], a[4:7], a[196:199], v[48:51]
ds_read_b128 a[48:51], v190 offset:12288
buffer_load_dwordx4 v1, s[8:11], s60 offen offset:2048 sc1 lds
v_mfma_f32_16x16x32_bf16 v[52:55], a[8:11], a[192:195], v[52:55]
ds_read_b128 a[52:55], v190 offset:13312
v_mfma_f32_16x16x32_bf16 v[56:59], a[8:11], a[196:199], v[56:59]
ds_read_b128 a[56:59], v190 offset:14336
v_mfma_f32_16x16x32_bf16 v[60:63], a[12:15], a[192:195], v[60:63]
ds_read_b128 a[60:63], v190 offset:15360
buffer_load_dwordx4 v1, s[8:11], s60 offen offset:3072 sc1 lds
v_mfma_f32_16x16x32_bf16 v[64:67], a[12:15], a[196:199], v[64:67]
ds_read_b128 a[64:67], v190 offset:16384
v_mfma_f32_16x16x32_bf16 v[68:71], a[16:19], a[192:195], v[68:71]
ds_read_b128 a[68:71], v190 offset:17408
v_mfma_f32_16x16x32_bf16 v[72:75], a[16:19], a[196:199], v[72:75]
s_add_u32 s52, s52, 4096
v_rcp_f32 v186, v186
v_mfma_f32_16x16x32_bf16 v[76:79], a[20:23], a[192:195], v[76:79]
v_rcp_f32 v187, v187
v_mfma_f32_16x16x32_bf16 v[80:83], a[20:23], a[196:199], v[80:83]
v_rcp_f32 v188, v188
v_mfma_f32_16x16x32_bf16 v[84:87], a[24:27], a[192:195], v[84:87]
v_rcp_f32 v189, v189
v_mfma_f32_16x16x32_bf16 v[88:91], a[24:27], a[196:199], v[88:91]
buffer_load_dwordx4 a[112:115], v1, s[4:7], s52 offen offset:0 sc1
v_mul_f32 v136, v136, v186
v_mfma_f32_16x16x32_bf16 v[92:95], a[28:31], a[192:195], v[92:95]
v_mul_f32 v137, v137, v187
v_mul_f32 v138, v138, v188
v_mfma_f32_16x16x32_bf16 v[96:99], a[28:31], a[196:199], v[96:99]
v_mul_f32 v139, v139, v189
v_mfma_f32_16x16x32_bf16 v[100:103], a[32:35], a[192:195], v[100:103]
v_mul_f32 v182, v140, v140
v_mfma_f32_16x16x32_bf16 v[104:107], a[32:35], a[196:199], v[104:107]
s_waitcnt vmcnt(18)
s_waitcnt lgkmcnt(0)
s_barrier
v_mfma_f32_16x16x32_bf16 v[36:39], a[36:39], a[200:203], v[36:39]
ds_read_b128 a[0:3], v190 offset:18432
buffer_load_dwordx4 a[116:119], v9, s[4:7], s52 offen offset:0 sc1
v_mfma_f32_16x16x32_bf16 v[40:43], a[36:39], a[204:207], v[40:43]
ds_read_b128 a[4:7], v190 offset:19456
v_mul_f32 v183, v141, v141
v_mfma_f32_16x16x32_bf16 v[44:47], a[40:43], a[200:203], v[44:47]
ds_read_b128 a[8:11], v190 offset:20480
buffer_load_dwordx4 a[120:123], v1, s[4:7], s52 offen offset:1024 sc1
v_mfma_f32_16x16x32_bf16 v[48:51], a[40:43], a[204:207], v[48:51]
ds_read_b128 a[12:15], v190 offset:21504
v_mul_f32 v184, v142, v142
v_mfma_f32_16x16x32_bf16 v[52:55], a[44:47], a[200:203], v[52:55]
ds_read_b128 a[16:19], v190 offset:22528
v_mul_f32 v185, v143, v143
v_mfma_f32_16x16x32_bf16 v[56:59], a[44:47], a[204:207], v[56:59]
ds_read_b128 a[20:23], v190 offset:23552
buffer_load_dwordx4 a[124:127], v9, s[4:7], s52 offen offset:1024 sc1
v_mfma_f32_16x16x32_bf16 v[60:63], a[48:51], a[200:203], v[60:63]
ds_read_b128 a[24:27], v190 offset:24576
v_fma_f32 v182, v182, v254, v253
v_mfma_f32_16x16x32_bf16 v[64:67], a[48:51], a[204:207], v[64:67]
ds_read_b128 a[28:31], v190 offset:25600
v_fma_f32 v183, v183, v254, v253
v_mfma_f32_16x16x32_bf16 v[68:71], a[52:55], a[200:203], v[68:71]
ds_read_b128 a[32:35], v190 offset:26624
s_add_u32 m0, s62, 90112
v_mfma_f32_16x16x32_bf16 v[72:75], a[52:55], a[204:207], v[72:75]
s_add_u32 s60, s60, 16384
v_fma_f32 v184, v184, v254, v253
v_fma_f32 v185, v185, v254, v253
v_mfma_f32_16x16x32_bf16 v[76:79], a[56:59], a[200:203], v[76:79]
v_mul_f32 v182, v182, v140
v_mfma_f32_16x16x32_bf16 v[80:83], a[56:59], a[204:207], v[80:83]
v_mul_f32 v183, v183, v141
v_mfma_f32_16x16x32_bf16 v[84:87], a[60:63], a[200:203], v[84:87]
v_mfma_f32_16x16x32_bf16 v[88:91], a[60:63], a[204:207], v[88:91]
v_mul_f32 v184, v184, v142
v_mfma_f32_16x16x32_bf16 v[92:95], a[64:67], a[200:203], v[92:95]
buffer_load_dwordx4 v1, s[8:11], s60 offen offset:0 sc1 lds
v_mul_f32 v185, v185, v143
v_mfma_f32_16x16x32_bf16 v[96:99], a[64:67], a[204:207], v[96:99]
v_mfma_f32_16x16x32_bf16 v[100:103], a[68:71], a[200:203], v[100:103]
v_exp_f32 v182, v182
v_mfma_f32_16x16x32_bf16 v[104:107], a[68:71], a[204:207], v[104:107]
s_waitcnt lgkmcnt(0)
v_mfma_f32_16x16x32_bf16 v[36:39], a[0:3], a[208:211], v[36:39]
ds_read_b128 a[36:39], v190 offset:27648
buffer_load_dwordx4 v1, s[8:11], s60 offen offset:1024 sc1 lds
v_mfma_f32_16x16x32_bf16 v[40:43], a[0:3], a[212:215], v[40:43]
ds_read_b128 a[40:43], v190 offset:28672
v_mfma_f32_16x16x32_bf16 v[44:47], a[4:7], a[208:211], v[44:47]
ds_read_b128 a[44:47], v190 offset:29696
v_mfma_f32_16x16x32_bf16 v[48:51], a[4:7], a[212:215], v[48:51]
ds_read_b128 a[48:51], v190 offset:30720
v_mfma_f32_16x16x32_bf16 v[52:55], a[8:11], a[208:211], v[52:55]
ds_read_b128 a[52:55], v190 offset:31744
buffer_load_dwordx4 v1, s[8:11], s60 offen offset:2048 sc1 lds
v_mfma_f32_16x16x32_bf16 v[56:59], a[8:11], a[212:215], v[56:59]
ds_read_b128 a[56:59], v190 offset:32768
v_mfma_f32_16x16x32_bf16 v[60:63], a[12:15], a[208:211], v[60:63]
ds_read_b128 a[60:63], v190 offset:33792
v_mfma_f32_16x16x32_bf16 v[64:67], a[12:15], a[212:215], v[64:67]
ds_read_b128 a[64:67], v190 offset:34816
v_mfma_f32_16x16x32_bf16 v[68:71], a[16:19], a[208:211], v[68:71]
ds_read_b128 a[68:71], v190 offset:35840
buffer_load_dwordx4 v1, s[8:11], s60 offen offset:3072 sc1 lds
v_mfma_f32_16x16x32_bf16 v[72:75], a[16:19], a[212:215], v[72:75]
v_exp_f32 v183, v183
v_mfma_f32_16x16x32_bf16 v[76:79], a[20:23], a[208:211], v[76:79]
v_exp_f32 v184, v184
v_mfma_f32_16x16x32_bf16 v[80:83], a[20:23], a[212:215], v[80:83]
v_exp_f32 v185, v185
v_mfma_f32_16x16x32_bf16 v[84:87], a[24:27], a[208:211], v[84:87]
buffer_load_dwordx4 a[128:131], v1, s[4:7], s52 offen offset:2048 sc1
v_fma_f32 v182, v182, v255, v255
v_mfma_f32_16x16x32_bf16 v[88:91], a[24:27], a[212:215], v[88:91]
v_fma_f32 v183, v183, v255, v255
v_fma_f32 v184, v184, v255, v255
v_mfma_f32_16x16x32_bf16 v[92:95], a[28:31], a[208:211], v[92:95]
v_fma_f32 v185, v185, v255, v255
v_mfma_f32_16x16x32_bf16 v[96:99], a[28:31], a[212:215], v[96:99]
v_rcp_f32 v182, v182
v_mfma_f32_16x16x32_bf16 v[100:103], a[32:35], a[208:211], v[100:103]
v_mfma_f32_16x16x32_bf16 v[104:107], a[32:35], a[212:215], v[104:107]
s_waitcnt vmcnt(13)
s_waitcnt lgkmcnt(0)
s_barrier
v_mfma_f32_16x16x32_bf16 v[36:39], a[36:39], a[216:219], v[36:39]
ds_read_b128 a[0:3], v191 offset:0
buffer_load_dwordx4 a[132:135], v9, s[4:7], s52 offen offset:2048 sc1
v_mfma_f32_16x16x32_bf16 v[40:43], a[36:39], a[220:223], v[40:43]
ds_read_b128 a[4:7], v191 offset:1024
v_mfma_f32_16x16x32_bf16 v[44:47], a[40:43], a[216:219], v[44:47]
ds_read_b128 a[8:11], v191 offset:2048
buffer_load_dwordx4 a[136:139], v1, s[4:7], s52 offen offset:3072 sc1
v_mfma_f32_16x16x32_bf16 v[48:51], a[40:43], a[220:223], v[48:51]
ds_read_b128 a[12:15], v191 offset:3072
v_mfma_f32_16x16x32_bf16 v[52:55], a[44:47], a[216:219], v[52:55]
ds_read_b128 a[16:19], v191 offset:4096
v_mfma_f32_16x16x32_bf16 v[56:59], a[44:47], a[220:223], v[56:59]
ds_read_b128 a[20:23], v191 offset:5120
buffer_load_dwordx4 a[140:143], v9, s[4:7], s52 offen offset:3072 sc1
v_mfma_f32_16x16x32_bf16 v[60:63], a[48:51], a[216:219], v[60:63]
ds_read_b128 a[24:27], v191 offset:6144
v_mfma_f32_16x16x32_bf16 v[64:67], a[48:51], a[220:223], v[64:67]
ds_read_b128 a[28:31], v191 offset:7168
v_mfma_f32_16x16x32_bf16 v[68:71], a[52:55], a[216:219], v[68:71]
ds_read_b128 a[32:35], v191 offset:8192
s_add_u32 m0, s63, 106496
v_mfma_f32_16x16x32_bf16 v[72:75], a[52:55], a[220:223], v[72:75]
s_add_u32 s61, s61, 36864
v_rcp_f32 v183, v183
v_mfma_f32_16x16x32_bf16 v[76:79], a[56:59], a[216:219], v[76:79]
v_rcp_f32 v184, v184
v_mfma_f32_16x16x32_bf16 v[80:83], a[56:59], a[220:223], v[80:83]
v_rcp_f32 v185, v185
v_mfma_f32_16x16x32_bf16 v[84:87], a[60:63], a[216:219], v[84:87]
v_mul_f32 v140, v140, v182
v_mul_f32 v141, v141, v183
v_mfma_f32_16x16x32_bf16 v[88:91], a[60:63], a[220:223], v[88:91]
v_mul_f32 v142, v142, v184
v_mul_f32 v143, v143, v185
v_mfma_f32_16x16x32_bf16 v[92:95], a[64:67], a[216:219], v[92:95]
buffer_load_dwordx4 v1, s[8:11], s61 offen offset:0 sc1 lds
v_mfma_f32_16x16x32_bf16 v[96:99], a[64:67], a[220:223], v[96:99]
v_permlane16_swap_b32 v132, v136
v_mfma_f32_16x16x32_bf16 v[100:103], a[68:71], a[216:219], v[100:103]
v_mfma_f32_16x16x32_bf16 v[104:107], a[68:71], a[220:223], v[104:107]
s_waitcnt lgkmcnt(0)
v_mfma_f32_16x16x32_bf16 v[36:39], a[0:3], a[224:227], v[36:39]
ds_read_b128 a[36:39], v191 offset:9216
s_add_u32 m0, s62, 110592
v_mfma_f32_16x16x32_bf16 v[40:43], a[0:3], a[228:231], v[40:43]
ds_read_b128 a[40:43], v191 offset:10240
v_mfma_f32_16x16x32_bf16 v[44:47], a[4:7], a[224:227], v[44:47]
ds_read_b128 a[44:47], v191 offset:11264
s_add_u32 s60, s60, 20480
v_mfma_f32_16x16x32_bf16 v[48:51], a[4:7], a[228:231], v[48:51]
ds_read_b128 a[48:51], v191 offset:12288
v_mfma_f32_16x16x32_bf16 v[52:55], a[8:11], a[224:227], v[52:55]
ds_read_b128 a[52:55], v191 offset:13312
v_mfma_f32_16x16x32_bf16 v[56:59], a[8:11], a[228:231], v[56:59]
ds_read_b128 a[56:59], v191 offset:14336
buffer_load_dwordx4 v1, s[8:11], s60 offen offset:0 sc1 lds
v_mfma_f32_16x16x32_bf16 v[60:63], a[12:15], a[224:227], v[60:63]
ds_read_b128 a[60:63], v191 offset:15360
v_mfma_f32_16x16x32_bf16 v[64:67], a[12:15], a[228:231], v[64:67]
ds_read_b128 a[64:67], v191 offset:16384
v_mfma_f32_16x16x32_bf16 v[68:71], a[16:19], a[224:227], v[68:71]
ds_read_b128 a[68:71], v191 offset:17408
buffer_load_dwordx4 v1, s[8:11], s60 offen offset:1024 sc1 lds
v_mfma_f32_16x16x32_bf16 v[72:75], a[16:19], a[228:231], v[72:75]
v_permlane16_swap_b32 v133, v137
v_mfma_f32_16x16x32_bf16 v[76:79], a[20:23], a[224:227], v[76:79]
v_permlane16_swap_b32 v134, v138
v_mfma_f32_16x16x32_bf16 v[80:83], a[20:23], a[228:231], v[80:83]
buffer_load_dwordx4 v1, s[8:11], s60 offen offset:2048 sc1 lds
v_mfma_f32_16x16x32_bf16 v[84:87], a[24:27], a[224:227], v[84:87]
v_permlane16_swap_b32 v135, v139
v_mfma_f32_16x16x32_bf16 v[88:91], a[24:27], a[228:231], v[88:91]
v_mul_f32 v186, v144, v144
v_mul_f32 v187, v145, v145
v_mfma_f32_16x16x32_bf16 v[92:95], a[28:31], a[224:227], v[92:95]
buffer_load_dwordx4 v1, s[8:11], s60 offen offset:3072 sc1 lds
v_mul_f32 v188, v146, v146
v_mfma_f32_16x16x32_bf16 v[96:99], a[28:31], a[228:231], v[96:99]
v_mul_f32 v189, v147, v147
v_fma_f32 v186, v186, v254, v253
v_mfma_f32_16x16x32_bf16 v[100:103], a[32:35], a[224:227], v[100:103]
v_fma_f32 v187, v187, v254, v253
v_fma_f32 v188, v188, v254, v253
v_mfma_f32_16x16x32_bf16 v[104:107], a[32:35], a[228:231], v[104:107]
s_waitcnt vmcnt(17)
s_waitcnt lgkmcnt(0)
s_barrier
v_mfma_f32_16x16x32_bf16 v[36:39], a[36:39], a[232:235], v[36:39]
ds_read_b128 a[0:3], v191 offset:18432
s_add_u32 m0, s62, 126976
v_mfma_f32_16x16x32_bf16 v[40:43], a[36:39], a[236:239], v[40:43]
ds_read_b128 a[4:7], v191 offset:19456
v_fma_f32 v189, v189, v254, v253
v_mfma_f32_16x16x32_bf16 v[44:47], a[40:43], a[232:235], v[44:47]
ds_read_b128 a[8:11], v191 offset:20480
s_add_u32 s60, s60, 16384
v_mfma_f32_16x16x32_bf16 v[48:51], a[40:43], a[236:239], v[48:51]
ds_read_b128 a[12:15], v191 offset:21504
v_mul_f32 v186, v186, v144
v_mfma_f32_16x16x32_bf16 v[52:55], a[44:47], a[232:235], v[52:55]
ds_read_b128 a[16:19], v191 offset:22528
v_mul_f32 v187, v187, v145
v_mfma_f32_16x16x32_bf16 v[56:59], a[44:47], a[236:239], v[56:59]
ds_read_b128 a[20:23], v191 offset:23552
buffer_load_dwordx4 v1, s[8:11], s60 offen offset:0 sc1 lds
v_mfma_f32_16x16x32_bf16 v[60:63], a[48:51], a[232:235], v[60:63]
ds_read_b128 a[24:27], v191 offset:24576
v_mul_f32 v188, v188, v146
v_mfma_f32_16x16x32_bf16 v[64:67], a[48:51], a[236:239], v[64:67]
ds_read_b128 a[28:31], v191 offset:25600
v_mul_f32 v189, v189, v147
v_mfma_f32_16x16x32_bf16 v[68:71], a[52:55], a[232:235], v[68:71]
ds_read_b128 a[32:35], v191 offset:26624
buffer_load_dwordx4 v1, s[8:11], s60 offen offset:1024 sc1 lds
v_mfma_f32_16x16x32_bf16 v[72:75], a[52:55], a[236:239], v[72:75]
v_exp_f32 v186, v186
v_mfma_f32_16x16x32_bf16 v[76:79], a[56:59], a[232:235], v[76:79]
v_exp_f32 v187, v187
v_mfma_f32_16x16x32_bf16 v[80:83], a[56:59], a[236:239], v[80:83]
buffer_load_dwordx4 v1, s[8:11], s60 offen offset:2048 sc1 lds
v_mfma_f32_16x16x32_bf16 v[84:87], a[60:63], a[232:235], v[84:87]
v_mfma_f32_16x16x32_bf16 v[88:91], a[60:63], a[236:239], v[88:91]
v_exp_f32 v188, v188
v_mfma_f32_16x16x32_bf16 v[92:95], a[64:67], a[232:235], v[92:95]
buffer_load_dwordx4 v1, s[8:11], s60 offen offset:3072 sc1 lds
v_mfma_f32_16x16x32_bf16 v[96:99], a[64:67], a[236:239], v[96:99]
v_exp_f32 v189, v189
v_mfma_f32_16x16x32_bf16 v[100:103], a[68:71], a[232:235], v[100:103]
v_mfma_f32_16x16x32_bf16 v[104:107], a[68:71], a[236:239], v[104:107]
s_waitcnt lgkmcnt(0)
v_mfma_f32_16x16x32_bf16 v[36:39], a[0:3], a[240:243], v[36:39]
ds_read_b128 a[36:39], v191 offset:27648
s_add_u32 s52, s52, 4096
v_mfma_f32_16x16x32_bf16 v[40:43], a[0:3], a[244:247], v[40:43]
ds_read_b128 a[40:43], v191 offset:28672
v_fma_f32 v186, v186, v255, v255
v_mfma_f32_16x16x32_bf16 v[44:47], a[4:7], a[240:243], v[44:47]
ds_read_b128 a[44:47], v191 offset:29696
v_fma_f32 v187, v187, v255, v255
v_mfma_f32_16x16x32_bf16 v[48:51], a[4:7], a[244:247], v[48:51]
ds_read_b128 a[48:51], v191 offset:30720
buffer_load_dwordx4 a[144:147], v1, s[4:7], s52 offen offset:0 sc1
v_mfma_f32_16x16x32_bf16 v[52:55], a[8:11], a[240:243], v[52:55]
ds_read_b128 a[52:55], v191 offset:31744
v_fma_f32 v188, v188, v255, v255
v_mfma_f32_16x16x32_bf16 v[56:59], a[8:11], a[244:247], v[56:59]
ds_read_b128 a[56:59], v191 offset:32768
v_fma_f32 v189, v189, v255, v255
v_mfma_f32_16x16x32_bf16 v[60:63], a[12:15], a[240:243], v[60:63]
ds_read_b128 a[60:63], v191 offset:33792
buffer_load_dwordx4 a[148:151], v9, s[4:7], s52 offen offset:0 sc1
v_mfma_f32_16x16x32_bf16 v[64:67], a[12:15], a[244:247], v[64:67]
ds_read_b128 a[64:67], v191 offset:34816
v_mfma_f32_16x16x32_bf16 v[68:71], a[16:19], a[240:243], v[68:71]
ds_read_b128 a[68:71], v191 offset:35840
v_mfma_f32_16x16x32_bf16 v[72:75], a[16:19], a[244:247], v[72:75]
v_rcp_f32 v186, v186
v_mfma_f32_16x16x32_bf16 v[76:79], a[20:23], a[240:243], v[76:79]
buffer_load_dwordx4 a[152:155], v1, s[4:7], s52 offen offset:1024 sc1
v_mfma_f32_16x16x32_bf16 v[80:83], a[20:23], a[244:247], v[80:83]
v_rcp_f32 v187, v187
v_mfma_f32_16x16x32_bf16 v[84:87], a[24:27], a[240:243], v[84:87]
v_rcp_f32 v188, v188
v_mfma_f32_16x16x32_bf16 v[88:91], a[24:27], a[244:247], v[88:91]
buffer_load_dwordx4 a[156:159], v9, s[4:7], s52 offen offset:1024 sc1
v_mfma_f32_16x16x32_bf16 v[92:95], a[28:31], a[240:243], v[92:95]
v_mfma_f32_16x16x32_bf16 v[96:99], a[28:31], a[244:247], v[96:99]
v_rcp_f32 v189, v189
v_mfma_f32_16x16x32_bf16 v[100:103], a[32:35], a[240:243], v[100:103]
v_mfma_f32_16x16x32_bf16 v[104:107], a[32:35], a[244:247], v[104:107]
s_waitcnt vmcnt(12)
s_waitcnt lgkmcnt(0)
s_barrier
v_mfma_f32_16x16x32_bf16 v[36:39], a[36:39], a[248:251], v[36:39]
ds_read_b128 a[0:3], v190 offset:0
s_add_u32 m0, s63, 143360
v_mfma_f32_16x16x32_bf16 v[40:43], a[36:39], a[252:255], v[40:43]
ds_read_b128 a[4:7], v190 offset:1024
v_mul_f32 v144, v144, v186
v_mfma_f32_16x16x32_bf16 v[44:47], a[40:43], a[248:251], v[44:47]
ds_read_b128 a[8:11], v190 offset:2048
s_add_u32 s61, s61, 36864
v_mfma_f32_16x16x32_bf16 v[48:51], a[40:43], a[252:255], v[48:51]
ds_read_b128 a[12:15], v190 offset:3072
v_mul_f32 v145, v145, v187
v_mfma_f32_16x16x32_bf16 v[52:55], a[44:47], a[248:251], v[52:55]
ds_read_b128 a[16:19], v190 offset:4096
buffer_load_dwordx4 v1, s[8:11], s61 offen offset:0 sc1 lds
v_mfma_f32_16x16x32_bf16 v[56:59], a[44:47], a[252:255], v[56:59]
ds_read_b128 a[20:23], v190 offset:5120
v_mul_f32 v146, v146, v188
v_mfma_f32_16x16x32_bf16 v[60:63], a[48:51], a[248:251], v[60:63]
ds_read_b128 a[24:27], v190 offset:6144
s_add_u32 m0, s62, 147456
v_mfma_f32_16x16x32_bf16 v[64:67], a[48:51], a[252:255], v[64:67]
ds_read_b128 a[28:31], v190 offset:7168
v_mul_f32 v147, v147, v189
v_mfma_f32_16x16x32_bf16 v[68:71], a[52:55], a[248:251], v[68:71]
ds_read_b128 a[32:35], v190 offset:8192
s_add_u32 s60, s60, 20480
v_mfma_f32_16x16x32_bf16 v[72:75], a[52:55], a[252:255], v[72:75]
v_mul_f32 v182, v148, v148
v_mul_f32 v183, v149, v149
v_mfma_f32_16x16x32_bf16 v[76:79], a[56:59], a[248:251], v[76:79]
buffer_load_dwordx4 v1, s[8:11], s60 offen offset:0 sc1 lds
v_mul_f32 v184, v150, v150
v_mfma_f32_16x16x32_bf16 v[80:83], a[56:59], a[252:255], v[80:83]
v_mul_f32 v185, v151, v151
v_fma_f32 v182, v182, v254, v253
v_mfma_f32_16x16x32_bf16 v[84:87], a[60:63], a[248:251], v[84:87]
buffer_load_dwordx4 v1, s[8:11], s60 offen offset:1024 sc1 lds
v_mfma_f32_16x16x32_bf16 v[88:91], a[60:63], a[252:255], v[88:91]
v_fma_f32 v183, v183, v254, v253
v_mfma_f32_16x16x32_bf16 v[92:95], a[64:67], a[248:251], v[92:95]
buffer_load_dwordx4 v1, s[8:11], s60 offen offset:2048 sc1 lds
v_fma_f32 v184, v184, v254, v253
v_mfma_f32_16x16x32_bf16 v[96:99], a[64:67], a[252:255], v[96:99]
v_fma_f32 v185, v185, v254, v253
v_mfma_f32_16x16x32_bf16 v[100:103], a[68:71], a[248:251], v[100:103]
v_mfma_f32_16x16x32_bf16 v[104:107], a[68:71], a[252:255], v[104:107]
v_mul_f32 v182, v182, v148
s_waitcnt lgkmcnt(0)
v_mfma_f32_16x16x32_bf16 v[36:39], a[0:3], a[80:83], v[36:39]
ds_read_b128 a[36:39], v190 offset:9216
buffer_load_dwordx4 v1, s[8:11], s60 offen offset:3072 sc1 lds
v_mfma_f32_16x16x32_bf16 v[40:43], a[0:3], a[84:87], v[40:43]
ds_read_b128 a[40:43], v190 offset:10240
v_mul_f32 v183, v183, v149
v_mfma_f32_16x16x32_bf16 v[44:47], a[4:7], a[80:83], v[44:47]
ds_read_b128 a[44:47], v190 offset:11264
v_mul_f32 v184, v184, v150
v_mfma_f32_16x16x32_bf16 v[48:51], a[4:7], a[84:87], v[48:51]
ds_read_b128 a[48:51], v190 offset:12288
v_mul_f32 v185, v185, v151
v_mfma_f32_16x16x32_bf16 v[52:55], a[8:11], a[80:83], v[52:55]
ds_read_b128 a[52:55], v190 offset:13312
buffer_load_dwordx4 a[160:163], v1, s[4:7], s52 offen offset:2048 sc1
v_mfma_f32_16x16x32_bf16 v[56:59], a[8:11], a[84:87], v[56:59]
ds_read_b128 a[56:59], v190 offset:14336
v_mfma_f32_16x16x32_bf16 v[60:63], a[12:15], a[80:83], v[60:63]
ds_read_b128 a[60:63], v190 offset:15360
v_mfma_f32_16x16x32_bf16 v[64:67], a[12:15], a[84:87], v[64:67]
ds_read_b128 a[64:67], v190 offset:16384
v_mfma_f32_16x16x32_bf16 v[68:71], a[16:19], a[80:83], v[68:71]
ds_read_b128 a[68:71], v190 offset:17408
buffer_load_dwordx4 a[164:167], v9, s[4:7], s52 offen offset:2048 sc1
v_mfma_f32_16x16x32_bf16 v[72:75], a[16:19], a[84:87], v[72:75]
v_exp_f32 v182, v182
v_mfma_f32_16x16x32_bf16 v[76:79], a[20:23], a[80:83], v[76:79]
v_exp_f32 v183, v183
v_mfma_f32_16x16x32_bf16 v[80:83], a[20:23], a[84:87], v[80:83]
v_exp_f32 v184, v184
v_mfma_f32_16x16x32_bf16 v[84:87], a[24:27], a[80:83], v[84:87]
buffer_load_dwordx4 a[168:171], v1, s[4:7], s52 offen offset:3072 sc1
v_mfma_f32_16x16x32_bf16 v[88:91], a[24:27], a[84:87], v[88:91]
v_exp_f32 v185, v185
v_mfma_f32_16x16x32_bf16 v[92:95], a[28:31], a[80:83], v[92:95]
v_mfma_f32_16x16x32_bf16 v[96:99], a[28:31], a[84:87], v[96:99]
v_mfma_f32_16x16x32_bf16 v[100:103], a[32:35], a[80:83], v[100:103]
v_fma_f32 v182, v182, v255, v255
v_mfma_f32_16x16x32_bf16 v[104:107], a[32:35], a[84:87], v[104:107]
s_waitcnt vmcnt(16)
s_waitcnt lgkmcnt(0)
s_barrier
v_mfma_f32_16x16x32_bf16 v[36:39], a[36:39], a[88:91], v[36:39]
ds_read_b128 a[0:3], v190 offset:18432
buffer_load_dwordx4 a[172:175], v9, s[4:7], s52 offen offset:3072 sc1
v_mfma_f32_16x16x32_bf16 v[40:43], a[36:39], a[92:95], v[40:43]
ds_read_b128 a[4:7], v190 offset:19456
v_fma_f32 v183, v183, v255, v255
v_mfma_f32_16x16x32_bf16 v[44:47], a[40:43], a[88:91], v[44:47]
ds_read_b128 a[8:11], v190 offset:20480
s_add_u32 m0, s62, 90112
v_mfma_f32_16x16x32_bf16 v[48:51], a[40:43], a[92:95], v[48:51]
ds_read_b128 a[12:15], v190 offset:21504
v_fma_f32 v184, v184, v255, v255
v_mfma_f32_16x16x32_bf16 v[52:55], a[44:47], a[88:91], v[52:55]
ds_read_b128 a[16:19], v190 offset:22528
v_fma_f32 v185, v185, v255, v255
v_mfma_f32_16x16x32_bf16 v[56:59], a[44:47], a[92:95], v[56:59]
ds_read_b128 a[20:23], v190 offset:23552
s_add_u32 s60, s60, 16384
v_mfma_f32_16x16x32_bf16 v[60:63], a[48:51], a[88:91], v[60:63]
ds_read_b128 a[24:27], v190 offset:24576
v_mfma_f32_16x16x32_bf16 v[64:67], a[48:51], a[92:95], v[64:67]
ds_read_b128 a[28:31], v190 offset:25600
v_mfma_f32_16x16x32_bf16 v[68:71], a[52:55], a[88:91], v[68:71]
ds_read_b128 a[32:35], v190 offset:26624
buffer_load_dwordx4 v1, s[8:11], s60 offen offset:0 sc1 lds
v_mfma_f32_16x16x32_bf16 v[72:75], a[52:55], a[92:95], v[72:75]
v_rcp_f32 v182, v182
v_mfma_f32_16x16x32_bf16 v[76:79], a[56:59], a[88:91], v[76:79]
v_rcp_f32 v183, v183
v_mfma_f32_16x16x32_bf16 v[80:83], a[56:59], a[92:95], v[80:83]
buffer_load_dwordx4 v1, s[8:11], s60 offen offset:1024 sc1 lds
v_mfma_f32_16x16x32_bf16 v[84:87], a[60:63], a[88:91], v[84:87]
v_rcp_f32 v184, v184
v_mfma_f32_16x16x32_bf16 v[88:91], a[60:63], a[92:95], v[88:91]
v_rcp_f32 v185, v185
v_mfma_f32_16x16x32_bf16 v[92:95], a[64:67], a[88:91], v[92:95]
buffer_load_dwordx4 v1, s[8:11], s60 offen offset:2048 sc1 lds
v_mfma_f32_16x16x32_bf16 v[96:99], a[64:67], a[92:95], v[96:99]
v_mul_f32 v148, v148, v182
v_mfma_f32_16x16x32_bf16 v[100:103], a[68:71], a[88:91], v[100:103]
v_mfma_f32_16x16x32_bf16 v[104:107], a[68:71], a[92:95], v[104:107]
v_mul_f32 v149, v149, v183
s_waitcnt lgkmcnt(0)
v_mfma_f32_16x16x32_bf16 v[36:39], a[0:3], a[96:99], v[36:39]
ds_read_b128 a[36:39], v190 offset:27648
buffer_load_dwordx4 v1, s[8:11], s60 offen offset:3072 sc1 lds
v_mfma_f32_16x16x32_bf16 v[40:43], a[0:3], a[100:103], v[40:43]
ds_read_b128 a[40:43], v190 offset:28672
v_mul_f32 v150, v150, v184
v_mfma_f32_16x16x32_bf16 v[44:47], a[4:7], a[96:99], v[44:47]
ds_read_b128 a[44:47], v190 offset:29696
v_mul_f32 v151, v151, v185
v_mfma_f32_16x16x32_bf16 v[48:51], a[4:7], a[100:103], v[48:51]
ds_read_b128 a[48:51], v190 offset:30720
s_add_u32 s52, s52, 4096
v_mfma_f32_16x16x32_bf16 v[52:55], a[8:11], a[96:99], v[52:55]
ds_read_b128 a[52:55], v190 offset:31744
v_mfma_f32_16x16x32_bf16 v[56:59], a[8:11], a[100:103], v[56:59]
ds_read_b128 a[56:59], v190 offset:32768
v_mfma_f32_16x16x32_bf16 v[60:63], a[12:15], a[96:99], v[60:63]
ds_read_b128 a[60:63], v190 offset:33792
buffer_load_dwordx4 a[176:179], v1, s[4:7], s52 offen offset:0 sc1
v_mfma_f32_16x16x32_bf16 v[64:67], a[12:15], a[100:103], v[64:67]
ds_read_b128 a[64:67], v190 offset:34816
v_mfma_f32_16x16x32_bf16 v[68:71], a[16:19], a[96:99], v[68:71]
ds_read_b128 a[68:71], v190 offset:35840
v_mfma_f32_16x16x32_bf16 v[72:75], a[16:19], a[100:103], v[72:75]
v_permlane16_swap_b32 v140, v144
v_mfma_f32_16x16x32_bf16 v[76:79], a[20:23], a[96:99], v[76:79]
buffer_load_dwordx4 a[180:183], v9, s[4:7], s52 offen offset:0 sc1
v_mfma_f32_16x16x32_bf16 v[80:83], a[20:23], a[100:103], v[80:83]
v_permlane16_swap_b32 v141, v145
v_mfma_f32_16x16x32_bf16 v[84:87], a[24:27], a[96:99], v[84:87]
v_permlane16_swap_b32 v142, v146
v_mfma_f32_16x16x32_bf16 v[88:91], a[24:27], a[100:103], v[88:91]
buffer_load_dwordx4 a[184:187], v1, s[4:7], s52 offen offset:1024 sc1
v_mfma_f32_16x16x32_bf16 v[92:95], a[28:31], a[96:99], v[92:95]
v_permlane16_swap_b32 v143, v147
v_mfma_f32_16x16x32_bf16 v[96:99], a[28:31], a[100:103], v[96:99]
v_mul_f32 v186, v152, v152
v_mfma_f32_16x16x32_bf16 v[100:103], a[32:35], a[96:99], v[100:103]
v_mul_f32 v187, v153, v153
v_mfma_f32_16x16x32_bf16 v[104:107], a[32:35], a[100:103], v[104:107]
s_waitcnt vmcnt(15)
s_waitcnt lgkmcnt(0)
s_barrier
v_mfma_f32_16x16x32_bf16 v[36:39], a[36:39], a[104:107], v[36:39]
ds_read_b128 a[0:3], v191 offset:0
buffer_load_dwordx4 a[188:191], v9, s[4:7], s52 offen offset:1024 sc1
v_mfma_f32_16x16x32_bf16 v[40:43], a[36:39], a[108:111], v[40:43]
ds_read_b128 a[4:7], v191 offset:1024
v_mul_f32 v188, v154, v154
v_mfma_f32_16x16x32_bf16 v[44:47], a[40:43], a[104:107], v[44:47]
ds_read_b128 a[8:11], v191 offset:2048
s_add_u32 m0, s63, 106496
v_mfma_f32_16x16x32_bf16 v[48:51], a[40:43], a[108:111], v[48:51]
ds_read_b128 a[12:15], v191 offset:3072
v_mul_f32 v189, v155, v155
v_mfma_f32_16x16x32_bf16 v[52:55], a[44:47], a[104:107], v[52:55]
ds_read_b128 a[16:19], v191 offset:4096
s_add_u32 s61, s61, 36864
v_mfma_f32_16x16x32_bf16 v[56:59], a[44:47], a[108:111], v[56:59]
ds_read_b128 a[20:23], v191 offset:5120
v_fma_f32 v186, v186, v254, v253
v_mfma_f32_16x16x32_bf16 v[60:63], a[48:51], a[104:107], v[60:63]
ds_read_b128 a[24:27], v191 offset:6144
buffer_load_dwordx4 v1, s[8:11], s61 offen offset:0 sc1 lds
v_mfma_f32_16x16x32_bf16 v[64:67], a[48:51], a[108:111], v[64:67]
ds_read_b128 a[28:31], v191 offset:7168
v_fma_f32 v187, v187, v254, v253
v_mfma_f32_16x16x32_bf16 v[68:71], a[52:55], a[104:107], v[68:71]
ds_read_b128 a[32:35], v191 offset:8192
s_add_u32 m0, s62, 110592
v_mfma_f32_16x16x32_bf16 v[72:75], a[52:55], a[108:111], v[72:75]
s_add_u32 s60, s60, 20480
v_fma_f32 v188, v188, v254, v253
v_fma_f32 v189, v189, v254, v253
v_mfma_f32_16x16x32_bf16 v[76:79], a[56:59], a[104:107], v[76:79]
v_mul_f32 v186, v186, v152
v_mul_f32 v187, v187, v153
v_mfma_f32_16x16x32_bf16 v[80:83], a[56:59], a[108:111], v[80:83]
v_mul_f32 v188, v188, v154
v_mfma_f32_16x16x32_bf16 v[84:87], a[60:63], a[104:107], v[84:87]
buffer_load_dwordx4 v1, s[8:11], s60 offen offset:0 sc1 lds
v_mul_f32 v189, v189, v155
v_mfma_f32_16x16x32_bf16 v[88:91], a[60:63], a[108:111], v[88:91]
v_mfma_f32_16x16x32_bf16 v[92:95], a[64:67], a[104:107], v[92:95]
buffer_load_dwordx4 v1, s[8:11], s60 offen offset:1024 sc1 lds
v_mfma_f32_16x16x32_bf16 v[96:99], a[64:67], a[108:111], v[96:99]
v_exp_f32 v186, v186
v_mfma_f32_16x16x32_bf16 v[100:103], a[68:71], a[104:107], v[100:103]
v_mfma_f32_16x16x32_bf16 v[104:107], a[68:71], a[108:111], v[104:107]
s_waitcnt lgkmcnt(0)
v_mfma_f32_16x16x32_bf16 v[36:39], a[0:3], a[112:115], v[36:39]
ds_read_b128 a[36:39], v191 offset:9216
buffer_load_dwordx4 v1, s[8:11], s60 offen offset:2048 sc1 lds
v_mfma_f32_16x16x32_bf16 v[40:43], a[0:3], a[116:119], v[40:43]
ds_read_b128 a[40:43], v191 offset:10240
v_mfma_f32_16x16x32_bf16 v[44:47], a[4:7], a[112:115], v[44:47]
ds_read_b128 a[44:47], v191 offset:11264
v_mfma_f32_16x16x32_bf16 v[48:51], a[4:7], a[116:119], v[48:51]
ds_read_b128 a[48:51], v191 offset:12288
v_mfma_f32_16x16x32_bf16 v[52:55], a[8:11], a[112:115], v[52:55]
ds_read_b128 a[52:55], v191 offset:13312
buffer_load_dwordx4 v1, s[8:11], s60 offen offset:3072 sc1 lds
v_mfma_f32_16x16x32_bf16 v[56:59], a[8:11], a[116:119], v[56:59]
ds_read_b128 a[56:59], v191 offset:14336
v_mfma_f32_16x16x32_bf16 v[60:63], a[12:15], a[112:115], v[60:63]
ds_read_b128 a[60:63], v191 offset:15360
v_mfma_f32_16x16x32_bf16 v[64:67], a[12:15], a[116:119], v[64:67]
ds_read_b128 a[64:67], v191 offset:16384
v_mfma_f32_16x16x32_bf16 v[68:71], a[16:19], a[112:115], v[68:71]
ds_read_b128 a[68:71], v191 offset:17408
buffer_load_dwordx4 a[192:195], v1, s[4:7], s52 offen offset:2048 sc1
v_mfma_f32_16x16x32_bf16 v[72:75], a[16:19], a[116:119], v[72:75]
v_exp_f32 v187, v187
v_mfma_f32_16x16x32_bf16 v[76:79], a[20:23], a[112:115], v[76:79]
v_exp_f32 v188, v188
v_mfma_f32_16x16x32_bf16 v[80:83], a[20:23], a[116:119], v[80:83]
v_exp_f32 v189, v189
v_mfma_f32_16x16x32_bf16 v[84:87], a[24:27], a[112:115], v[84:87]
buffer_load_dwordx4 a[196:199], v9, s[4:7], s52 offen offset:2048 sc1
v_fma_f32 v186, v186, v255, v255
v_mfma_f32_16x16x32_bf16 v[88:91], a[24:27], a[116:119], v[88:91]
v_fma_f32 v187, v187, v255, v255
v_fma_f32 v188, v188, v255, v255
v_mfma_f32_16x16x32_bf16 v[92:95], a[28:31], a[112:115], v[92:95]
v_fma_f32 v189, v189, v255, v255
v_mfma_f32_16x16x32_bf16 v[96:99], a[28:31], a[116:119], v[96:99]
v_rcp_f32 v186, v186
v_mfma_f32_16x16x32_bf16 v[100:103], a[32:35], a[112:115], v[100:103]
v_rcp_f32 v187, v187
v_mfma_f32_16x16x32_bf16 v[104:107], a[32:35], a[116:119], v[104:107]
s_waitcnt vmcnt(19)
s_waitcnt lgkmcnt(0)
s_barrier
v_mfma_f32_16x16x32_bf16 v[36:39], a[36:39], a[120:123], v[36:39]
ds_read_b128 a[0:3], v191 offset:18432
buffer_load_dwordx4 a[200:203], v1, s[4:7], s52 offen offset:3072 sc1
v_mfma_f32_16x16x32_bf16 v[40:43], a[36:39], a[124:127], v[40:43]
ds_read_b128 a[4:7], v191 offset:19456
v_mfma_f32_16x16x32_bf16 v[44:47], a[40:43], a[120:123], v[44:47]
ds_read_b128 a[8:11], v191 offset:20480
buffer_load_dwordx4 a[204:207], v9, s[4:7], s52 offen offset:3072 sc1
v_mfma_f32_16x16x32_bf16 v[48:51], a[40:43], a[124:127], v[48:51]
ds_read_b128 a[12:15], v191 offset:21504
v_mfma_f32_16x16x32_bf16 v[52:55], a[44:47], a[120:123], v[52:55]
ds_read_b128 a[16:19], v191 offset:22528
v_mfma_f32_16x16x32_bf16 v[56:59], a[44:47], a[124:127], v[56:59]
ds_read_b128 a[20:23], v191 offset:23552
s_add_u32 m0, s62, 126976
v_mfma_f32_16x16x32_bf16 v[60:63], a[48:51], a[120:123], v[60:63]
ds_read_b128 a[24:27], v191 offset:24576
v_mfma_f32_16x16x32_bf16 v[64:67], a[48:51], a[124:127], v[64:67]
ds_read_b128 a[28:31], v191 offset:25600
v_mfma_f32_16x16x32_bf16 v[68:71], a[52:55], a[120:123], v[68:71]
ds_read_b128 a[32:35], v191 offset:26624
s_add_u32 s60, s60, 16384
v_mfma_f32_16x16x32_bf16 v[72:75], a[52:55], a[124:127], v[72:75]
v_rcp_f32 v188, v188
v_mfma_f32_16x16x32_bf16 v[76:79], a[56:59], a[120:123], v[76:79]
v_rcp_f32 v189, v189
v_mfma_f32_16x16x32_bf16 v[80:83], a[56:59], a[124:127], v[80:83]
buffer_load_dwordx4 v1, s[8:11], s60 offen offset:0 sc1 lds
v_mul_f32 v152, v152, v186
v_mfma_f32_16x16x32_bf16 v[84:87], a[60:63], a[120:123], v[84:87]
v_mul_f32 v153, v153, v187
v_mul_f32 v154, v154, v188
v_mfma_f32_16x16x32_bf16 v[88:91], a[60:63], a[124:127], v[88:91]
v_mul_f32 v155, v155, v189
v_mul_f32 v182, v156, v156
v_mfma_f32_16x16x32_bf16 v[92:95], a[64:67], a[120:123], v[92:95]
buffer_load_dwordx4 v1, s[8:11], s60 offen offset:1024 sc1 lds
v_mul_f32 v183, v157, v157
v_mfma_f32_16x16x32_bf16 v[96:99], a[64:67], a[124:127], v[96:99]
v_mul_f32 v184, v158, v158
v_mfma_f32_16x16x32_bf16 v[100:103], a[68:71], a[120:123], v[100:103]
v_mfma_f32_16x16x32_bf16 v[104:107], a[68:71], a[124:127], v[104:107]
v_mul_f32 v185, v159, v159
s_waitcnt lgkmcnt(0)
v_mfma_f32_16x16x32_bf16 v[36:39], a[0:3], a[128:131], v[36:39]
ds_read_b128 a[36:39], v191 offset:27648
buffer_load_dwordx4 v1, s[8:11], s60 offen offset:2048 sc1 lds
v_mfma_f32_16x16x32_bf16 v[40:43], a[0:3], a[132:135], v[40:43]
ds_read_b128 a[40:43], v191 offset:28672
v_fma_f32 v182, v182, v254, v253
v_mfma_f32_16x16x32_bf16 v[44:47], a[4:7], a[128:131], v[44:47]
ds_read_b128 a[44:47], v191 offset:29696
v_fma_f32 v183, v183, v254, v253
v_mfma_f32_16x16x32_bf16 v[48:51], a[4:7], a[132:135], v[48:51]
ds_read_b128 a[48:51], v191 offset:30720
buffer_load_dwordx4 v1, s[8:11], s60 offen offset:3072 sc1 lds
v_mfma_f32_16x16x32_bf16 v[52:55], a[8:11], a[128:131], v[52:55]
ds_read_b128 a[52:55], v191 offset:31744
v_fma_f32 v184, v184, v254, v253
v_mfma_f32_16x16x32_bf16 v[56:59], a[8:11], a[132:135], v[56:59]
ds_read_b128 a[56:59], v191 offset:32768
v_fma_f32 v185, v185, v254, v253
v_mfma_f32_16x16x32_bf16 v[60:63], a[12:15], a[128:131], v[60:63]
ds_read_b128 a[60:63], v191 offset:33792
s_add_u32 s52, s52, 4096
v_mfma_f32_16x16x32_bf16 v[64:67], a[12:15], a[132:135], v[64:67]
ds_read_b128 a[64:67], v191 offset:34816
v_mul_f32 v182, v182, v156
v_mfma_f32_16x16x32_bf16 v[68:71], a[16:19], a[128:131], v[68:71]
ds_read_b128 a[68:71], v191 offset:35840
v_mul_f32 v183, v183, v157
v_mfma_f32_16x16x32_bf16 v[72:75], a[16:19], a[132:135], v[72:75]
v_mul_f32 v184, v184, v158
v_mfma_f32_16x16x32_bf16 v[76:79], a[20:23], a[128:131], v[76:79]
buffer_load_dwordx4 a[208:211], v1, s[4:7], s52 offen offset:0 sc1
v_mul_f32 v185, v185, v159
v_mfma_f32_16x16x32_bf16 v[80:83], a[20:23], a[132:135], v[80:83]
v_mfma_f32_16x16x32_bf16 v[84:87], a[24:27], a[128:131], v[84:87]
v_exp_f32 v182, v182
v_mfma_f32_16x16x32_bf16 v[88:91], a[24:27], a[132:135], v[88:91]
buffer_load_dwordx4 a[212:215], v9, s[4:7], s52 offen offset:0 sc1
v_mfma_f32_16x16x32_bf16 v[92:95], a[28:31], a[128:131], v[92:95]
v_mfma_f32_16x16x32_bf16 v[96:99], a[28:31], a[132:135], v[96:99]
v_exp_f32 v183, v183
v_mfma_f32_16x16x32_bf16 v[100:103], a[32:35], a[128:131], v[100:103]
v_mfma_f32_16x16x32_bf16 v[104:107], a[32:35], a[132:135], v[104:107]
s_waitcnt vmcnt(14)
s_waitcnt lgkmcnt(0)
s_barrier
v_mfma_f32_16x16x32_bf16 v[36:39], a[36:39], a[136:139], v[36:39]
ds_read_b128 a[0:3], v190 offset:0
buffer_load_dwordx4 a[216:219], v1, s[4:7], s52 offen offset:1024 sc1
v_mfma_f32_16x16x32_bf16 v[40:43], a[36:39], a[140:143], v[40:43]
ds_read_b128 a[4:7], v190 offset:1024
v_mfma_f32_16x16x32_bf16 v[44:47], a[40:43], a[136:139], v[44:47]
ds_read_b128 a[8:11], v190 offset:2048
buffer_load_dwordx4 a[220:223], v9, s[4:7], s52 offen offset:1024 sc1
v_mfma_f32_16x16x32_bf16 v[48:51], a[40:43], a[140:143], v[48:51]
ds_read_b128 a[12:15], v190 offset:3072
v_mfma_f32_16x16x32_bf16 v[52:55], a[44:47], a[136:139], v[52:55]
ds_read_b128 a[16:19], v190 offset:4096
s_add_u32 m0, s63, 143360
v_mfma_f32_16x16x32_bf16 v[56:59], a[44:47], a[140:143], v[56:59]
ds_read_b128 a[20:23], v190 offset:5120
v_mfma_f32_16x16x32_bf16 v[60:63], a[48:51], a[136:139], v[60:63]
ds_read_b128 a[24:27], v190 offset:6144
s_add_u32 s61, s61, 36864
v_mfma_f32_16x16x32_bf16 v[64:67], a[48:51], a[140:143], v[64:67]
ds_read_b128 a[28:31], v190 offset:7168
v_mfma_f32_16x16x32_bf16 v[68:71], a[52:55], a[136:139], v[68:71]
ds_read_b128 a[32:35], v190 offset:8192
buffer_load_dwordx4 v1, s[8:11], s61 offen offset:0 sc1 lds
v_mfma_f32_16x16x32_bf16 v[72:75], a[52:55], a[140:143], v[72:75]
s_add_u32 m0, s62, 147456
v_exp_f32 v184, v184
v_mfma_f32_16x16x32_bf16 v[76:79], a[56:59], a[136:139], v[76:79]
s_add_u32 s60, s60, 20480
v_exp_f32 v185, v185
v_mfma_f32_16x16x32_bf16 v[80:83], a[56:59], a[140:143], v[80:83]
v_fma_f32 v182, v182, v255, v255
v_fma_f32 v183, v183, v255, v255
v_mfma_f32_16x16x32_bf16 v[84:87], a[60:63], a[136:139], v[84:87]
v_fma_f32 v184, v184, v255, v255
v_fma_f32 v185, v185, v255, v255
v_mfma_f32_16x16x32_bf16 v[88:91], a[60:63], a[140:143], v[88:91]
v_rcp_f32 v182, v182
v_mfma_f32_16x16x32_bf16 v[92:95], a[64:67], a[136:139], v[92:95]
buffer_load_dwordx4 v1, s[8:11], s60 offen offset:0 sc1 lds
v_mfma_f32_16x16x32_bf16 v[96:99], a[64:67], a[140:143], v[96:99]
v_rcp_f32 v183, v183
v_mfma_f32_16x16x32_bf16 v[100:103], a[68:71], a[136:139], v[100:103]
v_mfma_f32_16x16x32_bf16 v[104:107], a[68:71], a[140:143], v[104:107]
s_waitcnt lgkmcnt(0)
v_mfma_f32_16x16x32_bf16 v[36:39], a[0:3], a[144:147], v[36:39]
ds_read_b128 a[36:39], v190 offset:9216
buffer_load_dwordx4 v1, s[8:11], s60 offen offset:1024 sc1 lds
v_mfma_f32_16x16x32_bf16 v[40:43], a[0:3], a[148:151], v[40:43]
ds_read_b128 a[40:43], v190 offset:10240
v_mfma_f32_16x16x32_bf16 v[44:47], a[4:7], a[144:147], v[44:47]
ds_read_b128 a[44:47], v190 offset:11264
v_mfma_f32_16x16x32_bf16 v[48:51], a[4:7], a[148:151], v[48:51]
ds_read_b128 a[48:51], v190 offset:12288
v_mfma_f32_16x16x32_bf16 v[52:55], a[8:11], a[144:147], v[52:55]
ds_read_b128 a[52:55], v190 offset:13312
buffer_load_dwordx4 v1, s[8:11], s60 offen offset:2048 sc1 lds
v_mfma_f32_16x16x32_bf16 v[56:59], a[8:11], a[148:151], v[56:59]
ds_read_b128 a[56:59], v190 offset:14336
v_mfma_f32_16x16x32_bf16 v[60:63], a[12:15], a[144:147], v[60:63]
ds_read_b128 a[60:63], v190 offset:15360
v_mfma_f32_16x16x32_bf16 v[64:67], a[12:15], a[148:151], v[64:67]
ds_read_b128 a[64:67], v190 offset:16384
v_mfma_f32_16x16x32_bf16 v[68:71], a[16:19], a[144:147], v[68:71]
ds_read_b128 a[68:71], v190 offset:17408
buffer_load_dwordx4 v1, s[8:11], s60 offen offset:3072 sc1 lds
v_mfma_f32_16x16x32_bf16 v[72:75], a[16:19], a[148:151], v[72:75]
v_rcp_f32 v184, v184
v_mfma_f32_16x16x32_bf16 v[76:79], a[20:23], a[144:147], v[76:79]
v_rcp_f32 v185, v185
v_mfma_f32_16x16x32_bf16 v[80:83], a[20:23], a[148:151], v[80:83]
v_mul_f32 v156, v156, v182
v_mul_f32 v157, v157, v183
v_mfma_f32_16x16x32_bf16 v[84:87], a[24:27], a[144:147], v[84:87]
buffer_load_dwordx4 a[224:227], v1, s[4:7], s52 offen offset:2048 sc1
v_mul_f32 v158, v158, v184
v_mfma_f32_16x16x32_bf16 v[88:91], a[24:27], a[148:151], v[88:91]
v_mul_f32 v159, v159, v185
v_mfma_f32_16x16x32_bf16 v[92:95], a[28:31], a[144:147], v[92:95]
v_permlane16_swap_b32 v148, v152
v_mfma_f32_16x16x32_bf16 v[96:99], a[28:31], a[148:151], v[96:99]
v_permlane16_swap_b32 v149, v153
v_mfma_f32_16x16x32_bf16 v[100:103], a[32:35], a[144:147], v[100:103]
v_permlane16_swap_b32 v150, v154
v_mfma_f32_16x16x32_bf16 v[104:107], a[32:35], a[148:151], v[104:107]
s_waitcnt vmcnt(18)
s_waitcnt lgkmcnt(0)
s_barrier
v_mfma_f32_16x16x32_bf16 v[36:39], a[36:39], a[152:155], v[36:39]
ds_read_b128 a[0:3], v190 offset:18432
buffer_load_dwordx4 a[228:231], v9, s[4:7], s52 offen offset:2048 sc1
v_mfma_f32_16x16x32_bf16 v[40:43], a[36:39], a[156:159], v[40:43]
ds_read_b128 a[4:7], v190 offset:19456
v_mfma_f32_16x16x32_bf16 v[44:47], a[40:43], a[152:155], v[44:47]
ds_read_b128 a[8:11], v190 offset:20480
buffer_load_dwordx4 a[232:235], v1, s[4:7], s52 offen offset:3072 sc1
v_mfma_f32_16x16x32_bf16 v[48:51], a[40:43], a[156:159], v[48:51]
ds_read_b128 a[12:15], v190 offset:21504
v_mfma_f32_16x16x32_bf16 v[52:55], a[44:47], a[152:155], v[52:55]
ds_read_b128 a[16:19], v190 offset:22528
v_mfma_f32_16x16x32_bf16 v[56:59], a[44:47], a[156:159], v[56:59]
ds_read_b128 a[20:23], v190 offset:23552
buffer_load_dwordx4 a[236:239], v9, s[4:7], s52 offen offset:3072 sc1
v_mfma_f32_16x16x32_bf16 v[60:63], a[48:51], a[152:155], v[60:63]
ds_read_b128 a[24:27], v190 offset:24576
v_mfma_f32_16x16x32_bf16 v[64:67], a[48:51], a[156:159], v[64:67]
ds_read_b128 a[28:31], v190 offset:25600
v_mfma_f32_16x16x32_bf16 v[68:71], a[52:55], a[152:155], v[68:71]
ds_read_b128 a[32:35], v190 offset:26624
s_add_u32 m0, s62, 90112
v_mfma_f32_16x16x32_bf16 v[72:75], a[52:55], a[156:159], v[72:75]
s_add_u32 s60, s60, 16384
v_permlane16_swap_b32 v151, v155
v_mfma_f32_16x16x32_bf16 v[76:79], a[56:59], a[152:155], v[76:79]
v_mul_f32 v186, v160, v160
v_mul_f32 v187, v161, v161
v_mfma_f32_16x16x32_bf16 v[80:83], a[56:59], a[156:159], v[80:83]
v_mul_f32 v188, v162, v162
v_mul_f32 v189, v163, v163
v_mfma_f32_16x16x32_bf16 v[84:87], a[60:63], a[152:155], v[84:87]
v_fma_f32 v186, v186, v254, v253
v_fma_f32 v187, v187, v254, v253
v_mfma_f32_16x16x32_bf16 v[88:91], a[60:63], a[156:159], v[88:91]
v_fma_f32 v188, v188, v254, v253
v_mfma_f32_16x16x32_bf16 v[92:95], a[64:67], a[152:155], v[92:95]
buffer_load_dwordx4 v1, s[8:11], s60 offen offset:0 sc1 lds
v_fma_f32 v189, v189, v254, v253
v_mfma_f32_16x16x32_bf16 v[96:99], a[64:67], a[156:159], v[96:99]
v_mul_f32 v186, v186, v160
v_mfma_f32_16x16x32_bf16 v[100:103], a[68:71], a[152:155], v[100:103]
v_mfma_f32_16x16x32_bf16 v[104:107], a[68:71], a[156:159], v[104:107]
v_mul_f32 v187, v187, v161
s_waitcnt lgkmcnt(0)
v_mfma_f32_16x16x32_bf16 v[36:39], a[0:3], a[160:163], v[36:39]
ds_read_b128 a[36:39], v190 offset:27648
buffer_load_dwordx4 v1, s[8:11], s60 offen offset:1024 sc1 lds
v_mfma_f32_16x16x32_bf16 v[40:43], a[0:3], a[164:167], v[40:43]
ds_read_b128 a[40:43], v190 offset:28672
v_mul_f32 v188, v188, v162
v_mfma_f32_16x16x32_bf16 v[44:47], a[4:7], a[160:163], v[44:47]
ds_read_b128 a[44:47], v190 offset:29696
v_mul_f32 v189, v189, v163
v_mfma_f32_16x16x32_bf16 v[48:51], a[4:7], a[164:167], v[48:51]
ds_read_b128 a[48:51], v190 offset:30720
buffer_load_dwordx4 v1, s[8:11], s60 offen offset:2048 sc1 lds
v_mfma_f32_16x16x32_bf16 v[52:55], a[8:11], a[160:163], v[52:55]
ds_read_b128 a[52:55], v190 offset:31744
v_mfma_f32_16x16x32_bf16 v[56:59], a[8:11], a[164:167], v[56:59]
ds_read_b128 a[56:59], v190 offset:32768
v_mfma_f32_16x16x32_bf16 v[60:63], a[12:15], a[160:163], v[60:63]
ds_read_b128 a[60:63], v190 offset:33792
buffer_load_dwordx4 v1, s[8:11], s60 offen offset:3072 sc1 lds
v_mfma_f32_16x16x32_bf16 v[64:67], a[12:15], a[164:167], v[64:67]
ds_read_b128 a[64:67], v190 offset:34816
v_mfma_f32_16x16x32_bf16 v[68:71], a[16:19], a[160:163], v[68:71]
ds_read_b128 a[68:71], v190 offset:35840
v_mfma_f32_16x16x32_bf16 v[72:75], a[16:19], a[164:167], v[72:75]
s_add_u32 s52, s52, 4096
v_exp_f32 v186, v186
v_mfma_f32_16x16x32_bf16 v[76:79], a[20:23], a[160:163], v[76:79]
v_exp_f32 v187, v187
v_mfma_f32_16x16x32_bf16 v[80:83], a[20:23], a[164:167], v[80:83]
v_exp_f32 v188, v188
v_mfma_f32_16x16x32_bf16 v[84:87], a[24:27], a[160:163], v[84:87]
v_exp_f32 v189, v189
v_mfma_f32_16x16x32_bf16 v[88:91], a[24:27], a[164:167], v[88:91]
buffer_load_dwordx4 a[240:243], v1, s[4:7], s52 offen offset:0 sc1
v_mfma_f32_16x16x32_bf16 v[92:95], a[28:31], a[160:163], v[92:95]
v_fma_f32 v186, v186, v255, v255
v_mfma_f32_16x16x32_bf16 v[96:99], a[28:31], a[164:167], v[96:99]
v_mfma_f32_16x16x32_bf16 v[100:103], a[32:35], a[160:163], v[100:103]
v_fma_f32 v187, v187, v255, v255
v_mfma_f32_16x16x32_bf16 v[104:107], a[32:35], a[164:167], v[104:107]
s_waitcnt vmcnt(13)
s_waitcnt lgkmcnt(0)
s_barrier
v_mfma_f32_16x16x32_bf16 v[36:39], a[36:39], a[168:171], v[36:39]
ds_read_b128 a[0:3], v191 offset:0
buffer_load_dwordx4 a[244:247], v9, s[4:7], s52 offen offset:0 sc1
v_mfma_f32_16x16x32_bf16 v[40:43], a[36:39], a[172:175], v[40:43]
ds_read_b128 a[4:7], v191 offset:1024
v_fma_f32 v188, v188, v255, v255
v_mfma_f32_16x16x32_bf16 v[44:47], a[40:43], a[168:171], v[44:47]
ds_read_b128 a[8:11], v191 offset:2048
buffer_load_dwordx4 a[248:251], v1, s[4:7], s52 offen offset:1024 sc1
v_mfma_f32_16x16x32_bf16 v[48:51], a[40:43], a[172:175], v[48:51]
ds_read_b128 a[12:15], v191 offset:3072
v_fma_f32 v189, v189, v255, v255
v_mfma_f32_16x16x32_bf16 v[52:55], a[44:47], a[168:171], v[52:55]
ds_read_b128 a[16:19], v191 offset:4096
v_mfma_f32_16x16x32_bf16 v[56:59], a[44:47], a[172:175], v[56:59]
ds_read_b128 a[20:23], v191 offset:5120
buffer_load_dwordx4 a[252:255], v9, s[4:7], s52 offen offset:1024 sc1
v_mfma_f32_16x16x32_bf16 v[60:63], a[48:51], a[168:171], v[60:63]
ds_read_b128 a[24:27], v191 offset:6144
v_mfma_f32_16x16x32_bf16 v[64:67], a[48:51], a[172:175], v[64:67]
ds_read_b128 a[28:31], v191 offset:7168
v_mfma_f32_16x16x32_bf16 v[68:71], a[52:55], a[168:171], v[68:71]
ds_read_b128 a[32:35], v191 offset:8192
s_add_u32 m0, s63, 106496
v_mfma_f32_16x16x32_bf16 v[72:75], a[52:55], a[172:175], v[72:75]
s_add_u32 s61, s61, 36864
v_rcp_f32 v186, v186
v_mfma_f32_16x16x32_bf16 v[76:79], a[56:59], a[168:171], v[76:79]
v_rcp_f32 v187, v187
v_mfma_f32_16x16x32_bf16 v[80:83], a[56:59], a[172:175], v[80:83]
v_rcp_f32 v188, v188
v_mfma_f32_16x16x32_bf16 v[84:87], a[60:63], a[168:171], v[84:87]
v_rcp_f32 v189, v189
v_mfma_f32_16x16x32_bf16 v[88:91], a[60:63], a[172:175], v[88:91]
v_mfma_f32_16x16x32_bf16 v[92:95], a[64:67], a[168:171], v[92:95]
buffer_load_dwordx4 v1, s[8:11], s61 offen offset:0 sc1 lds
v_mul_f32 v160, v160, v186
v_mfma_f32_16x16x32_bf16 v[96:99], a[64:67], a[172:175], v[96:99]
v_mul_f32 v161, v161, v187
v_mfma_f32_16x16x32_bf16 v[100:103], a[68:71], a[168:171], v[100:103]
v_mfma_f32_16x16x32_bf16 v[104:107], a[68:71], a[172:175], v[104:107]
v_mul_f32 v162, v162, v188
s_waitcnt lgkmcnt(0)
v_mfma_f32_16x16x32_bf16 v[36:39], a[0:3], a[176:179], v[36:39]
ds_read_b128 a[36:39], v191 offset:9216
s_add_u32 m0, s62, 110592
v_mfma_f32_16x16x32_bf16 v[40:43], a[0:3], a[180:183], v[40:43]
ds_read_b128 a[40:43], v191 offset:10240
v_mul_f32 v163, v163, v189
v_mfma_f32_16x16x32_bf16 v[44:47], a[4:7], a[176:179], v[44:47]
ds_read_b128 a[44:47], v191 offset:11264
s_add_u32 s60, s60, 20480
v_mfma_f32_16x16x32_bf16 v[48:51], a[4:7], a[180:183], v[48:51]
ds_read_b128 a[48:51], v191 offset:12288
v_mul_f32 v182, v164, v164
v_mfma_f32_16x16x32_bf16 v[52:55], a[8:11], a[176:179], v[52:55]
ds_read_b128 a[52:55], v191 offset:13312
v_mul_f32 v183, v165, v165
v_mfma_f32_16x16x32_bf16 v[56:59], a[8:11], a[180:183], v[56:59]
ds_read_b128 a[56:59], v191 offset:14336
buffer_load_dwordx4 v1, s[8:11], s60 offen offset:0 sc1 lds
v_mfma_f32_16x16x32_bf16 v[60:63], a[12:15], a[176:179], v[60:63]
ds_read_b128 a[60:63], v191 offset:15360
v_mul_f32 v184, v166, v166
v_mfma_f32_16x16x32_bf16 v[64:67], a[12:15], a[180:183], v[64:67]
ds_read_b128 a[64:67], v191 offset:16384
v_mul_f32 v185, v167, v167
v_mfma_f32_16x16x32_bf16 v[68:71], a[16:19], a[176:179], v[68:71]
ds_read_b128 a[68:71], v191 offset:17408
buffer_load_dwordx4 v1, s[8:11], s60 offen offset:1024 sc1 lds
v_mfma_f32_16x16x32_bf16 v[72:75], a[16:19], a[180:183], v[72:75]
v_fma_f32 v182, v182, v254, v253
v_fma_f32 v183, v183, v254, v253
v_mfma_f32_16x16x32_bf16 v[76:79], a[20:23], a[176:179], v[76:79]
v_fma_f32 v184, v184, v254, v253
v_mfma_f32_16x16x32_bf16 v[80:83], a[20:23], a[180:183], v[80:83]
buffer_load_dwordx4 v1, s[8:11], s60 offen offset:2048 sc1 lds
v_mfma_f32_16x16x32_bf16 v[84:87], a[24:27], a[176:179], v[84:87]
v_fma_f32 v185, v185, v254, v253
v_mfma_f32_16x16x32_bf16 v[88:91], a[24:27], a[180:183], v[88:91]
v_mul_f32 v182, v182, v164
v_mfma_f32_16x16x32_bf16 v[92:95], a[28:31], a[176:179], v[92:95]
buffer_load_dwordx4 v1, s[8:11], s60 offen offset:3072 sc1 lds
v_mul_f32 v183, v183, v165
v_mfma_f32_16x16x32_bf16 v[96:99], a[28:31], a[180:183], v[96:99]
v_mfma_f32_16x16x32_bf16 v[100:103], a[32:35], a[176:179], v[100:103]
v_mul_f32 v184, v184, v166
v_mfma_f32_16x16x32_bf16 v[104:107], a[32:35], a[180:183], v[104:107]
s_waitcnt vmcnt(17)
s_waitcnt lgkmcnt(0)
s_barrier
v_mfma_f32_16x16x32_bf16 v[36:39], a[36:39], a[184:187], v[36:39]
ds_read_b128 a[0:3], v191 offset:18432
s_add_u32 m0, s62, 126976
v_mfma_f32_16x16x32_bf16 v[40:43], a[36:39], a[188:191], v[40:43]
ds_read_b128 a[4:7], v191 offset:19456
v_mul_f32 v185, v185, v167
v_mfma_f32_16x16x32_bf16 v[44:47], a[40:43], a[184:187], v[44:47]
ds_read_b128 a[8:11], v191 offset:20480
s_add_u32 s60, s60, 16384
v_mfma_f32_16x16x32_bf16 v[48:51], a[40:43], a[188:191], v[48:51]
ds_read_b128 a[12:15], v191 offset:21504
v_mfma_f32_16x16x32_bf16 v[52:55], a[44:47], a[184:187], v[52:55]
ds_read_b128 a[16:19], v191 offset:22528
v_mfma_f32_16x16x32_bf16 v[56:59], a[44:47], a[188:191], v[56:59]
ds_read_b128 a[20:23], v191 offset:23552
buffer_load_dwordx4 v1, s[8:11], s60 offen offset:0 sc1 lds
v_mfma_f32_16x16x32_bf16 v[60:63], a[48:51], a[184:187], v[60:63]
ds_read_b128 a[24:27], v191 offset:24576
v_mfma_f32_16x16x32_bf16 v[64:67], a[48:51], a[188:191], v[64:67]
ds_read_b128 a[28:31], v191 offset:25600
v_mfma_f32_16x16x32_bf16 v[68:71], a[52:55], a[184:187], v[68:71]
ds_read_b128 a[32:35], v191 offset:26624
buffer_load_dwordx4 v1, s[8:11], s60 offen offset:1024 sc1 lds
v_mfma_f32_16x16x32_bf16 v[72:75], a[52:55], a[188:191], v[72:75]
v_exp_f32 v182, v182
v_mfma_f32_16x16x32_bf16 v[76:79], a[56:59], a[184:187], v[76:79]
v_exp_f32 v183, v183
v_mfma_f32_16x16x32_bf16 v[80:83], a[56:59], a[188:191], v[80:83]
buffer_load_dwordx4 v1, s[8:11], s60 offen offset:2048 sc1 lds
v_mfma_f32_16x16x32_bf16 v[84:87], a[60:63], a[184:187], v[84:87]
v_exp_f32 v184, v184
v_mfma_f32_16x16x32_bf16 v[88:91], a[60:63], a[188:191], v[88:91]
v_exp_f32 v185, v185
v_mfma_f32_16x16x32_bf16 v[92:95], a[64:67], a[184:187], v[92:95]
buffer_load_dwordx4 v1, s[8:11], s60 offen offset:3072 sc1 lds
v_fma_f32 v182, v182, v255, v255
v_mfma_f32_16x16x32_bf16 v[96:99], a[64:67], a[188:191], v[96:99]
v_fma_f32 v183, v183, v255, v255
v_fma_f32 v184, v184, v255, v255
v_mfma_f32_16x16x32_bf16 v[100:103], a[68:71], a[184:187], v[100:103]
v_mfma_f32_16x16x32_bf16 v[104:107], a[68:71], a[188:191], v[104:107]
v_fma_f32 v185, v185, v255, v255
s_waitcnt lgkmcnt(0)
v_mfma_f32_16x16x32_bf16 v[36:39], a[0:3], a[192:195], v[36:39]
ds_read_b128 a[36:39], v191 offset:27648
buffer_load_dwordx4 a[80:83], v1, s[4:7], s52 offen offset:2048 sc1
v_mfma_f32_16x16x32_bf16 v[40:43], a[0:3], a[196:199], v[40:43]
ds_read_b128 a[40:43], v191 offset:28672
v_mfma_f32_16x16x32_bf16 v[44:47], a[4:7], a[192:195], v[44:47]
ds_read_b128 a[44:47], v191 offset:29696
v_mfma_f32_16x16x32_bf16 v[48:51], a[4:7], a[196:199], v[48:51]
ds_read_b128 a[48:51], v191 offset:30720
v_mfma_f32_16x16x32_bf16 v[52:55], a[8:11], a[192:195], v[52:55]
ds_read_b128 a[52:55], v191 offset:31744
buffer_load_dwordx4 a[84:87], v9, s[4:7], s52 offen offset:2048 sc1
v_mfma_f32_16x16x32_bf16 v[56:59], a[8:11], a[196:199], v[56:59]
ds_read_b128 a[56:59], v191 offset:32768
v_mfma_f32_16x16x32_bf16 v[60:63], a[12:15], a[192:195], v[60:63]
ds_read_b128 a[60:63], v191 offset:33792
v_mfma_f32_16x16x32_bf16 v[64:67], a[12:15], a[196:199], v[64:67]
ds_read_b128 a[64:67], v191 offset:34816
v_mfma_f32_16x16x32_bf16 v[68:71], a[16:19], a[192:195], v[68:71]
ds_read_b128 a[68:71], v191 offset:35840
buffer_load_dwordx4 a[88:91], v1, s[4:7], s52 offen offset:3072 sc1
v_mfma_f32_16x16x32_bf16 v[72:75], a[16:19], a[196:199], v[72:75]
v_rcp_f32 v182, v182
v_mfma_f32_16x16x32_bf16 v[76:79], a[20:23], a[192:195], v[76:79]
v_rcp_f32 v183, v183
v_mfma_f32_16x16x32_bf16 v[80:83], a[20:23], a[196:199], v[80:83]
v_rcp_f32 v184, v184
v_mfma_f32_16x16x32_bf16 v[84:87], a[24:27], a[192:195], v[84:87]
buffer_load_dwordx4 a[92:95], v9, s[4:7], s52 offen offset:3072 sc1
v_mfma_f32_16x16x32_bf16 v[88:91], a[24:27], a[196:199], v[88:91]
v_rcp_f32 v185, v185
v_mfma_f32_16x16x32_bf16 v[92:95], a[28:31], a[192:195], v[92:95]
v_mul_f32 v164, v164, v182
v_mul_f32 v165, v165, v183
v_mfma_f32_16x16x32_bf16 v[96:99], a[28:31], a[196:199], v[96:99]
v_mul_f32 v166, v166, v184
v_mfma_f32_16x16x32_bf16 v[100:103], a[32:35], a[192:195], v[100:103]
v_mul_f32 v167, v167, v185
v_mfma_f32_16x16x32_bf16 v[104:107], a[32:35], a[196:199], v[104:107]
s_waitcnt vmcnt(12)
s_waitcnt lgkmcnt(0)
s_barrier
v_mfma_f32_16x16x32_bf16 v[36:39], a[36:39], a[200:203], v[36:39]
ds_read_b128 a[0:3], v190 offset:0
s_add_u32 m0, s63, 143360
v_mfma_f32_16x16x32_bf16 v[40:43], a[36:39], a[204:207], v[40:43]
ds_read_b128 a[4:7], v190 offset:1024
v_mfma_f32_16x16x32_bf16 v[44:47], a[40:43], a[200:203], v[44:47]
ds_read_b128 a[8:11], v190 offset:2048
s_add_u32 s61, s61, 36864
v_mfma_f32_16x16x32_bf16 v[48:51], a[40:43], a[204:207], v[48:51]
ds_read_b128 a[12:15], v190 offset:3072
v_mfma_f32_16x16x32_bf16 v[52:55], a[44:47], a[200:203], v[52:55]
ds_read_b128 a[16:19], v190 offset:4096
buffer_load_dwordx4 v1, s[8:11], s61 offen offset:0 sc1 lds
v_mfma_f32_16x16x32_bf16 v[56:59], a[44:47], a[204:207], v[56:59]
ds_read_b128 a[20:23], v190 offset:5120
v_mfma_f32_16x16x32_bf16 v[60:63], a[48:51], a[200:203], v[60:63]
ds_read_b128 a[24:27], v190 offset:6144
s_add_u32 m0, s62, 147456
v_mfma_f32_16x16x32_bf16 v[64:67], a[48:51], a[204:207], v[64:67]
ds_read_b128 a[28:31], v190 offset:7168
v_mfma_f32_16x16x32_bf16 v[68:71], a[52:55], a[200:203], v[68:71]
ds_read_b128 a[32:35], v190 offset:8192
s_add_u32 s60, s60, 20480
v_mfma_f32_16x16x32_bf16 v[72:75], a[52:55], a[204:207], v[72:75]
v_permlane16_swap_b32 v156, v160
v_mfma_f32_16x16x32_bf16 v[76:79], a[56:59], a[200:203], v[76:79]
buffer_load_dwordx4 v1, s[8:11], s60 offen offset:0 sc1 lds
v_mfma_f32_16x16x32_bf16 v[80:83], a[56:59], a[204:207], v[80:83]
v_permlane16_swap_b32 v157, v161
v_mfma_f32_16x16x32_bf16 v[84:87], a[60:63], a[200:203], v[84:87]
buffer_load_dwordx4 v1, s[8:11], s60 offen offset:1024 sc1 lds
v_mfma_f32_16x16x32_bf16 v[88:91], a[60:63], a[204:207], v[88:91]
v_permlane16_swap_b32 v158, v162
v_mfma_f32_16x16x32_bf16 v[92:95], a[64:67], a[200:203], v[92:95]
buffer_load_dwordx4 v1, s[8:11], s60 offen offset:2048 sc1 lds
v_mfma_f32_16x16x32_bf16 v[96:99], a[64:67], a[204:207], v[96:99]
v_permlane16_swap_b32 v159, v163
v_mfma_f32_16x16x32_bf16 v[100:103], a[68:71], a[200:203], v[100:103]
v_mul_f32 v186, v168, v168
v_mul_f32 v187, v169, v169
v_mfma_f32_16x16x32_bf16 v[104:107], a[68:71], a[204:207], v[104:107]
v_mul_f32 v188, v170, v170
s_waitcnt lgkmcnt(0)
v_mfma_f32_16x16x32_bf16 v[36:39], a[0:3], a[208:211], v[36:39]
ds_read_b128 a[36:39], v190 offset:9216
buffer_load_dwordx4 v1, s[8:11], s60 offen offset:3072 sc1 lds
v_mfma_f32_16x16x32_bf16 v[40:43], a[0:3], a[212:215], v[40:43]
ds_read_b128 a[40:43], v190 offset:10240
v_mul_f32 v189, v171, v171
v_mfma_f32_16x16x32_bf16 v[44:47], a[4:7], a[208:211], v[44:47]
ds_read_b128 a[44:47], v190 offset:11264
v_fma_f32 v186, v186, v254, v253
v_mfma_f32_16x16x32_bf16 v[48:51], a[4:7], a[212:215], v[48:51]
ds_read_b128 a[48:51], v190 offset:12288
s_add_u32 s52, s52, 4096
v_mfma_f32_16x16x32_bf16 v[52:55], a[8:11], a[208:211], v[52:55]
ds_read_b128 a[52:55], v190 offset:13312
v_fma_f32 v187, v187, v254, v253
v_mfma_f32_16x16x32_bf16 v[56:59], a[8:11], a[212:215], v[56:59]
ds_read_b128 a[56:59], v190 offset:14336
v_fma_f32 v188, v188, v254, v253
v_mfma_f32_16x16x32_bf16 v[60:63], a[12:15], a[208:211], v[60:63]
ds_read_b128 a[60:63], v190 offset:15360
buffer_load_dwordx4 a[96:99], v1, s[4:7], s52 offen offset:0 sc1
v_mfma_f32_16x16x32_bf16 v[64:67], a[12:15], a[212:215], v[64:67]
ds_read_b128 a[64:67], v190 offset:16384
v_fma_f32 v189, v189, v254, v253
v_mfma_f32_16x16x32_bf16 v[68:71], a[16:19], a[208:211], v[68:71]
ds_read_b128 a[68:71], v190 offset:17408
v_mul_f32 v186, v186, v168
v_mfma_f32_16x16x32_bf16 v[72:75], a[16:19], a[212:215], v[72:75]
v_mul_f32 v187, v187, v169
v_mul_f32 v188, v188, v170
v_mfma_f32_16x16x32_bf16 v[76:79], a[20:23], a[208:211], v[76:79]
buffer_load_dwordx4 a[100:103], v9, s[4:7], s52 offen offset:0 sc1
v_mul_f32 v189, v189, v171
v_mfma_f32_16x16x32_bf16 v[80:83], a[20:23], a[212:215], v[80:83]
v_exp_f32 v186, v186
v_mfma_f32_16x16x32_bf16 v[84:87], a[24:27], a[208:211], v[84:87]
v_mfma_f32_16x16x32_bf16 v[88:91], a[24:27], a[212:215], v[88:91]
buffer_load_dwordx4 a[104:107], v1, s[4:7], s52 offen offset:1024 sc1
v_mfma_f32_16x16x32_bf16 v[92:95], a[28:31], a[208:211], v[92:95]
v_exp_f32 v187, v187
v_mfma_f32_16x16x32_bf16 v[96:99], a[28:31], a[212:215], v[96:99]
v_mfma_f32_16x16x32_bf16 v[100:103], a[32:35], a[208:211], v[100:103]
v_exp_f32 v188, v188
v_mfma_f32_16x16x32_bf16 v[104:107], a[32:35], a[212:215], v[104:107]
s_waitcnt vmcnt(16)
s_waitcnt lgkmcnt(0)
s_barrier
v_mfma_f32_16x16x32_bf16 v[36:39], a[36:39], a[216:219], v[36:39]
ds_read_b128 a[0:3], v190 offset:18432
buffer_load_dwordx4 a[108:111], v9, s[4:7], s52 offen offset:1024 sc1
v_mfma_f32_16x16x32_bf16 v[40:43], a[36:39], a[220:223], v[40:43]
ds_read_b128 a[4:7], v190 offset:19456
v_mfma_f32_16x16x32_bf16 v[44:47], a[40:43], a[216:219], v[44:47]
ds_read_b128 a[8:11], v190 offset:20480
s_add_u32 m0, s62, 90112
v_mfma_f32_16x16x32_bf16 v[48:51], a[40:43], a[220:223], v[48:51]
ds_read_b128 a[12:15], v190 offset:21504
v_mfma_f32_16x16x32_bf16 v[52:55], a[44:47], a[216:219], v[52:55]
ds_read_b128 a[16:19], v190 offset:22528
v_mfma_f32_16x16x32_bf16 v[56:59], a[44:47], a[220:223], v[56:59]
ds_read_b128 a[20:23], v190 offset:23552
s_add_u32 s60, s60, 16384
v_mfma_f32_16x16x32_bf16 v[60:63], a[48:51], a[216:219], v[60:63]
ds_read_b128 a[24:27], v190 offset:24576
v_mfma_f32_16x16x32_bf16 v[64:67], a[48:51], a[220:223], v[64:67]
ds_read_b128 a[28:31], v190 offset:25600
v_mfma_f32_16x16x32_bf16 v[68:71], a[52:55], a[216:219], v[68:71]
ds_read_b128 a[32:35], v190 offset:26624
buffer_load_dwordx4 v1, s[8:11], s60 offen offset:0 sc1 lds
v_mfma_f32_16x16x32_bf16 v[72:75], a[52:55], a[220:223], v[72:75]
v_exp_f32 v189, v189
v_mfma_f32_16x16x32_bf16 v[76:79], a[56:59], a[216:219], v[76:79]
v_fma_f32 v186, v186, v255, v255
v_fma_f32 v187, v187, v255, v255
v_mfma_f32_16x16x32_bf16 v[80:83], a[56:59], a[220:223], v[80:83]
buffer_load_dwordx4 v1, s[8:11], s60 offen offset:1024 sc1 lds
v_fma_f32 v188, v188, v255, v255
v_mfma_f32_16x16x32_bf16 v[84:87], a[60:63], a[216:219], v[84:87]
v_fma_f32 v189, v189, v255, v255
v_mfma_f32_16x16x32_bf16 v[88:91], a[60:63], a[220:223], v[88:91]
v_rcp_f32 v186, v186
v_mfma_f32_16x16x32_bf16 v[92:95], a[64:67], a[216:219], v[92:95]
buffer_load_dwordx4 v1, s[8:11], s60 offen offset:2048 sc1 lds
v_mfma_f32_16x16x32_bf16 v[96:99], a[64:67], a[220:223], v[96:99]
v_rcp_f32 v187, v187
v_mfma_f32_16x16x32_bf16 v[100:103], a[68:71], a[216:219], v[100:103]
v_rcp_f32 v188, v188
v_mfma_f32_16x16x32_bf16 v[104:107], a[68:71], a[220:223], v[104:107]
s_waitcnt lgkmcnt(0)
v_mfma_f32_16x16x32_bf16 v[36:39], a[0:3], a[224:227], v[36:39]
ds_read_b128 a[36:39], v190 offset:27648
buffer_load_dwordx4 v1, s[8:11], s60 offen offset:3072 sc1 lds
v_mfma_f32_16x16x32_bf16 v[40:43], a[0:3], a[228:231], v[40:43]
ds_read_b128 a[40:43], v190 offset:28672
s_mov_b32 s37, L_c5-L_pc
v_mfma_f32_16x16x32_bf16 v[44:47], a[4:7], a[224:227], v[44:47]
ds_read_b128 a[44:47], v190 offset:29696
v_mfma_f32_16x16x32_bf16 v[48:51], a[4:7], a[228:231], v[48:51]
ds_read_b128 a[48:51], v190 offset:30720
v_mfma_f32_16x16x32_bf16 v[52:55], a[8:11], a[224:227], v[52:55]
ds_read_b128 a[52:55], v190 offset:31744
buffer_load_dwordx4 a[112:115], v1, s[4:7], s52 offen offset:2048 sc1
v_mfma_f32_16x16x32_bf16 v[56:59], a[8:11], a[228:231], v[56:59]
ds_read_b128 a[56:59], v190 offset:32768
buffer_load_dword v15, v14, s[88:91], s37 offen
v_mfma_f32_16x16x32_bf16 v[60:63], a[12:15], a[224:227], v[60:63]
ds_read_b128 a[60:63], v190 offset:33792
v_mfma_f32_16x16x32_bf16 v[64:67], a[12:15], a[228:231], v[64:67]
ds_read_b128 a[64:67], v190 offset:34816
v_mfma_f32_16x16x32_bf16 v[68:71], a[16:19], a[224:227], v[68:71]
ds_read_b128 a[68:71], v190 offset:35840
buffer_load_dwordx4 a[116:119], v9, s[4:7], s52 offen offset:2048 sc1
v_mfma_f32_16x16x32_bf16 v[72:75], a[16:19], a[228:231], v[72:75]
v_rcp_f32 v189, v189
v_mfma_f32_16x16x32_bf16 v[76:79], a[20:23], a[224:227], v[76:79]
v_mul_f32 v168, v168, v186
v_mul_f32 v169, v169, v187
v_mfma_f32_16x16x32_bf16 v[80:83], a[20:23], a[228:231], v[80:83]
v_mul_f32 v170, v170, v188
v_mul_f32 v171, v171, v189
v_mfma_f32_16x16x32_bf16 v[84:87], a[24:27], a[224:227], v[84:87]
buffer_load_dwordx4 a[120:123], v1, s[4:7], s52 offen offset:3072 sc1
v_mul_f32 v182, v172, v172
v_mfma_f32_16x16x32_bf16 v[88:91], a[24:27], a[228:231], v[88:91]
v_mul_f32 v183, v173, v173
v_mul_f32 v184, v174, v174
v_mfma_f32_16x16x32_bf16 v[92:95], a[28:31], a[224:227], v[92:95]
v_mul_f32 v185, v175, v175
v_fma_f32 v182, v182, v254, v253
v_mfma_f32_16x16x32_bf16 v[96:99], a[28:31], a[228:231], v[96:99]
v_mfma_f32_16x16x32_bf16 v[100:103], a[32:35], a[224:227], v[100:103]
v_fma_f32 v183, v183, v254, v253
v_mfma_f32_16x16x32_bf16 v[104:107], a[32:35], a[228:231], v[104:107]
s_waitcnt vmcnt(16)
s_waitcnt lgkmcnt(0)
s_barrier
v_mfma_f32_16x16x32_bf16 v[36:39], a[36:39], a[232:235], v[36:39]
ds_read_b128 a[0:3], v191 offset:0
buffer_load_dwordx4 a[124:127], v9, s[4:7], s52 offen offset:3072 sc1
v_mfma_f32_16x16x32_bf16 v[40:43], a[36:39], a[236:239], v[40:43]
ds_read_b128 a[4:7], v191 offset:1024
v_fma_f32 v184, v184, v254, v253
v_mfma_f32_16x16x32_bf16 v[44:47], a[40:43], a[232:235], v[44:47]
ds_read_b128 a[8:11], v191 offset:2048
s_add_u32 m0, s63, 106496
v_mfma_f32_16x16x32_bf16 v[48:51], a[40:43], a[236:239], v[48:51]
ds_read_b128 a[12:15], v191 offset:3072
v_fma_f32 v185, v185, v254, v253
v_mfma_f32_16x16x32_bf16 v[52:55], a[44:47], a[232:235], v[52:55]
ds_read_b128 a[16:19], v191 offset:4096
s_add_u32 s61, s61, 36864
v_mfma_f32_16x16x32_bf16 v[56:59], a[44:47], a[236:239], v[56:59]
ds_read_b128 a[20:23], v191 offset:5120
v_mul_f32 v182, v182, v172
v_mfma_f32_16x16x32_bf16 v[60:63], a[48:51], a[232:235], v[60:63]
ds_read_b128 a[24:27], v191 offset:6144
buffer_load_dwordx4 v1, s[8:11], s61 offen offset:0 sc1 lds
v_mfma_f32_16x16x32_bf16 v[64:67], a[48:51], a[236:239], v[64:67]
ds_read_b128 a[28:31], v191 offset:7168
v_mul_f32 v183, v183, v173
v_mfma_f32_16x16x32_bf16 v[68:71], a[52:55], a[232:235], v[68:71]
ds_read_b128 a[32:35], v191 offset:8192
s_add_u32 m0, s62, 110592
v_mfma_f32_16x16x32_bf16 v[72:75], a[52:55], a[236:239], v[72:75]
s_add_u32 s60, s60, 20480
v_mul_f32 v184, v184, v174
v_mul_f32 v185, v185, v175
v_mfma_f32_16x16x32_bf16 v[76:79], a[56:59], a[232:235], v[76:79]
v_exp_f32 v182, v182
v_mfma_f32_16x16x32_bf16 v[80:83], a[56:59], a[236:239], v[80:83]
v_exp_f32 v183, v183
v_mfma_f32_16x16x32_bf16 v[84:87], a[60:63], a[232:235], v[84:87]
buffer_load_dwordx4 v1, s[8:11], s60 offen offset:0 sc1 lds
v_mfma_f32_16x16x32_bf16 v[88:91], a[60:63], a[236:239], v[88:91]
v_mfma_f32_16x16x32_bf16 v[92:95], a[64:67], a[232:235], v[92:95]
buffer_load_dwordx4 v1, s[8:11], s60 offen offset:1024 sc1 lds
v_mfma_f32_16x16x32_bf16 v[96:99], a[64:67], a[236:239], v[96:99]
v_exp_f32 v184, v184
v_mfma_f32_16x16x32_bf16 v[100:103], a[68:71], a[232:235], v[100:103]
v_exp_f32 v185, v185
v_mfma_f32_16x16x32_bf16 v[104:107], a[68:71], a[236:239], v[104:107]
s_waitcnt lgkmcnt(0)
v_mfma_f32_16x16x32_bf16 v[36:39], a[0:3], a[240:243], v[36:39]
ds_read_b128 a[36:39], v191 offset:9216
buffer_load_dwordx4 v1, s[8:11], s60 offen offset:2048 sc1 lds
v_mfma_f32_16x16x32_bf16 v[40:43], a[0:3], a[244:247], v[40:43]
ds_read_b128 a[40:43], v191 offset:10240
v_fma_f32 v182, v182, v255, v255
v_mfma_f32_16x16x32_bf16 v[44:47], a[4:7], a[240:243], v[44:47]
ds_read_b128 a[44:47], v191 offset:11264
v_mfma_f32_16x16x32_bf16 v[48:51], a[4:7], a[244:247], v[48:51]
ds_read_b128 a[48:51], v191 offset:12288
buffer_load_dwordx4 v1, s[8:11], s60 offen offset:3072 sc1 lds
v_mfma_f32_16x16x32_bf16 v[52:55], a[8:11], a[240:243], v[52:55]
ds_read_b128 a[52:55], v191 offset:13312
v_fma_f32 v183, v183, v255, v255
v_mfma_f32_16x16x32_bf16 v[56:59], a[8:11], a[244:247], v[56:59]
ds_read_b128 a[56:59], v191 offset:14336
v_fma_f32 v184, v184, v255, v255
v_mfma_f32_16x16x32_bf16 v[60:63], a[12:15], a[240:243], v[60:63]
ds_read_b128 a[60:63], v191 offset:15360
s_add_u32 s52, s52, 4096
v_mfma_f32_16x16x32_bf16 v[64:67], a[12:15], a[244:247], v[64:67]
ds_read_b128 a[64:67], v191 offset:16384
v_fma_f32 v185, v185, v255, v255
v_mfma_f32_16x16x32_bf16 v[68:71], a[16:19], a[240:243], v[68:71]
ds_read_b128 a[68:71], v191 offset:17408
v_mfma_f32_16x16x32_bf16 v[72:75], a[16:19], a[244:247], v[72:75]
v_rcp_f32 v182, v182
v_mfma_f32_16x16x32_bf16 v[76:79], a[20:23], a[240:243], v[76:79]
buffer_load_dwordx4 a[128:131], v1, s[4:7], s52 offen offset:0 sc1
v_mfma_f32_16x16x32_bf16 v[80:83], a[20:23], a[244:247], v[80:83]
v_rcp_f32 v183, v183
v_mfma_f32_16x16x32_bf16 v[84:87], a[24:27], a[240:243], v[84:87]
v_mfma_f32_16x16x32_bf16 v[88:91], a[24:27], a[244:247], v[88:91]
buffer_load_dwordx4 a[132:135], v9, s[4:7], s52 offen offset:0 sc1
v_mfma_f32_16x16x32_bf16 v[92:95], a[28:31], a[240:243], v[92:95]
v_rcp_f32 v184, v184
v_mfma_f32_16x16x32_bf16 v[96:99], a[28:31], a[244:247], v[96:99]
v_mfma_f32_16x16x32_bf16 v[100:103], a[32:35], a[240:243], v[100:103]
v_rcp_f32 v185, v185
v_mfma_f32_16x16x32_bf16 v[104:107], a[32:35], a[244:247], v[104:107]
s_waitcnt vmcnt(20)
s_waitcnt lgkmcnt(0)
s_barrier
v_mfma_f32_16x16x32_bf16 v[36:39], a[36:39], a[248:251], v[36:39]
ds_read_b128 a[0:3], v191 offset:18432
buffer_load_dwordx4 a[136:139], v1, s[4:7], s52 offen offset:1024 sc1
v_mfma_f32_16x16x32_bf16 v[40:43], a[36:39], a[252:255], v[40:43]
ds_read_b128 a[4:7], v191 offset:19456
v_mul_f32 v172, v172, v182
v_mfma_f32_16x16x32_bf16 v[44:47], a[40:43], a[248:251], v[44:47]
ds_read_b128 a[8:11], v191 offset:20480
buffer_load_dwordx4 a[140:143], v9, s[4:7], s52 offen offset:1024 sc1
v_mfma_f32_16x16x32_bf16 v[48:51], a[40:43], a[252:255], v[48:51]
ds_read_b128 a[12:15], v191 offset:21504
v_mul_f32 v173, v173, v183
v_mfma_f32_16x16x32_bf16 v[52:55], a[44:47], a[248:251], v[52:55]
ds_read_b128 a[16:19], v191 offset:22528
v_mul_f32 v174, v174, v184
v_mfma_f32_16x16x32_bf16 v[56:59], a[44:47], a[252:255], v[56:59]
ds_read_b128 a[20:23], v191 offset:23552
s_add_u32 m0, s62, 126976
v_mfma_f32_16x16x32_bf16 v[60:63], a[48:51], a[248:251], v[60:63]
ds_read_b128 a[24:27], v191 offset:24576
v_mul_f32 v175, v175, v185
v_mfma_f32_16x16x32_bf16 v[64:67], a[48:51], a[252:255], v[64:67]
ds_read_b128 a[28:31], v191 offset:25600
v_mfma_f32_16x16x32_bf16 v[68:71], a[52:55], a[248:251], v[68:71]
ds_read_b128 a[32:35], v191 offset:26624
s_add_u32 s60, s60, 16384
v_mfma_f32_16x16x32_bf16 v[72:75], a[52:55], a[252:255], v[72:75]
v_permlane16_swap_b32 v164, v168
v_mfma_f32_16x16x32_bf16 v[76:79], a[56:59], a[248:251], v[76:79]
v_permlane16_swap_b32 v165, v169
v_mfma_f32_16x16x32_bf16 v[80:83], a[56:59], a[252:255], v[80:83]
buffer_load_dwordx4 v1, s[8:11], s60 offen offset:0 sc1 lds
v_mfma_f32_16x16x32_bf16 v[84:87], a[60:63], a[248:251], v[84:87]
v_permlane16_swap_b32 v166, v170
v_mfma_f32_16x16x32_bf16 v[88:91], a[60:63], a[252:255], v[88:91]
v_mfma_f32_16x16x32_bf16 v[92:95], a[64:67], a[248:251], v[92:95]
buffer_load_dwordx4 v1, s[8:11], s60 offen offset:1024 sc1 lds
v_mfma_f32_16x16x32_bf16 v[96:99], a[64:67], a[252:255], v[96:99]
v_permlane16_swap_b32 v167, v171
v_mfma_f32_16x16x32_bf16 v[100:103], a[68:71], a[248:251], v[100:103]
v_mfma_f32_16x16x32_bf16 v[104:107], a[68:71], a[252:255], v[104:107]
s_waitcnt lgkmcnt(0)
v_mfma_f32_16x16x32_bf16 v[36:39], a[0:3], a[80:83], v[36:39]
ds_read_b128 a[36:39], v191 offset:27648
buffer_load_dwordx4 v1, s[8:11], s60 offen offset:2048 sc1 lds
v_mfma_f32_16x16x32_bf16 v[40:43], a[0:3], a[84:87], v[40:43]
ds_read_b128 a[40:43], v191 offset:28672
v_mul_f32 v186, v176, v176
v_mfma_f32_16x16x32_bf16 v[44:47], a[4:7], a[80:83], v[44:47]
ds_read_b128 a[44:47], v191 offset:29696
v_mul_f32 v187, v177, v177
v_mfma_f32_16x16x32_bf16 v[48:51], a[4:7], a[84:87], v[48:51]
ds_read_b128 a[48:51], v191 offset:30720
v_mul_f32 v188, v178, v178
v_mfma_f32_16x16x32_bf16 v[52:55], a[8:11], a[80:83], v[52:55]
ds_read_b128 a[52:55], v191 offset:31744
buffer_load_dwordx4 v1, s[8:11], s60 offen offset:3072 sc1 lds
v_mfma_f32_16x16x32_bf16 v[56:59], a[8:11], a[84:87], v[56:59]
ds_read_b128 a[56:59], v191 offset:32768
v_mul_f32 v189, v179, v179
v_mfma_f32_16x16x32_bf16 v[60:63], a[12:15], a[80:83], v[60:63]
ds_read_b128 a[60:63], v191 offset:33792
v_fma_f32 v186, v186, v254, v253
v_mfma_f32_16x16x32_bf16 v[64:67], a[12:15], a[84:87], v[64:67]
ds_read_b128 a[64:67], v191 offset:34816
v_fma_f32 v187, v187, v254, v253
v_mfma_f32_16x16x32_bf16 v[68:71], a[16:19], a[80:83], v[68:71]
ds_read_b128 a[68:71], v191 offset:35840
buffer_load_dwordx4 a[144:147], v1, s[4:7], s52 offen offset:2048 sc1
v_mfma_f32_16x16x32_bf16 v[72:75], a[16:19], a[84:87], v[72:75]
v_fma_f32 v188, v188, v254, v253
v_mfma_f32_16x16x32_bf16 v[76:79], a[20:23], a[80:83], v[76:79]
v_fma_f32 v189, v189, v254, v253
v_mfma_f32_16x16x32_bf16 v[80:83], a[20:23], a[84:87], v[80:83]
v_mul_f32 v186, v186, v176
v_mfma_f32_16x16x32_bf16 v[84:87], a[24:27], a[80:83], v[84:87]
buffer_load_dwordx4 a[148:151], v9, s[4:7], s52 offen offset:2048 sc1
v_mfma_f32_16x16x32_bf16 v[88:91], a[24:27], a[84:87], v[88:91]
v_mul_f32 v187, v187, v177
v_mfma_f32_16x16x32_bf16 v[92:95], a[28:31], a[80:83], v[92:95]
v_mul_f32 v188, v188, v178
v_mfma_f32_16x16x32_bf16 v[96:99], a[28:31], a[84:87], v[96:99]
v_mfma_f32_16x16x32_bf16 v[100:103], a[32:35], a[80:83], v[100:103]
v_mul_f32 v189, v189, v179
v_mfma_f32_16x16x32_bf16 v[104:107], a[32:35], a[84:87], v[104:107]
s_waitcnt vmcnt(14)
s_waitcnt lgkmcnt(0)
s_barrier
v_mfma_f32_16x16x32_bf16 v[36:39], a[36:39], a[88:91], v[36:39]
ds_read_b128 a[0:3], v190 offset:0
buffer_load_dwordx4 a[152:155], v1, s[4:7], s52 offen offset:3072 sc1
v_mfma_f32_16x16x32_bf16 v[40:43], a[36:39], a[92:95], v[40:43]
ds_read_b128 a[4:7], v190 offset:1024
v_mfma_f32_16x16x32_bf16 v[44:47], a[40:43], a[88:91], v[44:47]
ds_read_b128 a[8:11], v190 offset:2048
buffer_load_dwordx4 a[156:159], v9, s[4:7], s52 offen offset:3072 sc1
v_mfma_f32_16x16x32_bf16 v[48:51], a[40:43], a[92:95], v[48:51]
ds_read_b128 a[12:15], v190 offset:3072
v_mfma_f32_16x16x32_bf16 v[52:55], a[44:47], a[88:91], v[52:55]
ds_read_b128 a[16:19], v190 offset:4096
s_add_u32 m0, s63, 143360
v_mfma_f32_16x16x32_bf16 v[56:59], a[44:47], a[92:95], v[56:59]
ds_read_b128 a[20:23], v190 offset:5120
v_mfma_f32_16x16x32_bf16 v[60:63], a[48:51], a[88:91], v[60:63]
ds_read_b128 a[24:27], v190 offset:6144
s_add_u32 s61, s61, 36864
v_mfma_f32_16x16x32_bf16 v[64:67], a[48:51], a[92:95], v[64:67]
ds_read_b128 a[28:31], v190 offset:7168
v_mfma_f32_16x16x32_bf16 v[68:71], a[52:55], a[88:91], v[68:71]
ds_read_b128 a[32:35], v190 offset:8192
buffer_load_dwordx4 v1, s[8:11], s61 offen offset:0 sc1 lds
v_mfma_f32_16x16x32_bf16 v[72:75], a[52:55], a[92:95], v[72:75]
s_add_u32 m0, s62, 147456
v_exp_f32 v186, v186
v_mfma_f32_16x16x32_bf16 v[76:79], a[56:59], a[88:91], v[76:79]
s_add_u32 s60, s60, 20480
v_exp_f32 v187, v187
v_mfma_f32_16x16x32_bf16 v[80:83], a[56:59], a[92:95], v[80:83]
v_exp_f32 v188, v188
v_mfma_f32_16x16x32_bf16 v[84:87], a[60:63], a[88:91], v[84:87]
v_exp_f32 v189, v189
v_mfma_f32_16x16x32_bf16 v[88:91], a[60:63], a[92:95], v[88:91]
v_fma_f32 v186, v186, v255, v255
v_fma_f32 v187, v187, v255, v255
v_mfma_f32_16x16x32_bf16 v[92:95], a[64:67], a[88:91], v[92:95]
buffer_load_dwordx4 v1, s[8:11], s60 offen offset:0 sc1 lds
v_fma_f32 v188, v188, v255, v255
v_mfma_f32_16x16x32_bf16 v[96:99], a[64:67], a[92:95], v[96:99]
v_fma_f32 v189, v189, v255, v255
v_mfma_f32_16x16x32_bf16 v[100:103], a[68:71], a[88:91], v[100:103]
v_rcp_f32 v186, v186
v_mfma_f32_16x16x32_bf16 v[104:107], a[68:71], a[92:95], v[104:107]
s_waitcnt lgkmcnt(0)
v_mfma_f32_16x16x32_bf16 v[36:39], a[0:3], a[96:99], v[36:39]
ds_read_b128 a[36:39], v190 offset:9216
buffer_load_dwordx4 v1, s[8:11], s60 offen offset:1024 sc1 lds
v_mfma_f32_16x16x32_bf16 v[40:43], a[0:3], a[100:103], v[40:43]
ds_read_b128 a[40:43], v190 offset:10240
v_mfma_f32_16x16x32_bf16 v[44:47], a[4:7], a[96:99], v[44:47]
ds_read_b128 a[44:47], v190 offset:11264
buffer_load_dwordx4 v1, s[8:11], s60 offen offset:2048 sc1 lds
v_mfma_f32_16x16x32_bf16 v[48:51], a[4:7], a[100:103], v[48:51]
ds_read_b128 a[48:51], v190 offset:12288
v_mfma_f32_16x16x32_bf16 v[52:55], a[8:11], a[96:99], v[52:55]
ds_read_b128 a[52:55], v190 offset:13312
buffer_load_dwordx4 v1, s[8:11], s60 offen offset:3072 sc1 lds
v_mfma_f32_16x16x32_bf16 v[56:59], a[8:11], a[100:103], v[56:59]
ds_read_b128 a[56:59], v190 offset:14336
v_mfma_f32_16x16x32_bf16 v[60:63], a[12:15], a[96:99], v[60:63]
ds_read_b128 a[60:63], v190 offset:15360
v_mfma_f32_16x16x32_bf16 v[64:67], a[12:15], a[100:103], v[64:67]
ds_read_b128 a[64:67], v190 offset:16384
s_mul_i32 s38, s24, 11264
v_mfma_f32_16x16x32_bf16 v[68:71], a[16:19], a[96:99], v[68:71]
ds_read_b128 a[68:71], v190 offset:17408
v_mfma_f32_16x16x32_bf16 v[72:75], a[16:19], a[100:103], v[72:75]
s_add_u32 m0, s38, 0
v_rcp_f32 v187, v187
v_mfma_f32_16x16x32_bf16 v[76:79], a[20:23], a[96:99], v[76:79]
s_add_u32 s39, s38, s83
v_rcp_f32 v188, v188
v_mfma_f32_16x16x32_bf16 v[80:83], a[20:23], a[100:103], v[80:83]
v_rcp_f32 v189, v189
v_mfma_f32_16x16x32_bf16 v[84:87], a[24:27], a[96:99], v[84:87]
v_mul_f32 v176, v176, v186
v_mul_f32 v177, v177, v187
v_mfma_f32_16x16x32_bf16 v[88:91], a[24:27], a[100:103], v[88:91]
v_mul_f32 v178, v178, v188
v_mfma_f32_16x16x32_bf16 v[92:95], a[28:31], a[96:99], v[92:95]
buffer_load_dwordx4 v1, s[4:7], s39 offen offset:0 sc1 lds
v_mul_f32 v179, v179, v189
v_mfma_f32_16x16x32_bf16 v[96:99], a[28:31], a[100:103], v[96:99]
s_lshl_b32 s30, s25, 3
v_mfma_f32_16x16x32_bf16 v[100:103], a[32:35], a[96:99], v[100:103]
s_lshl_b32 s31, s24, 1
v_mfma_f32_16x16x32_bf16 v[104:107], a[32:35], a[100:103], v[104:107]
s_waitcnt vmcnt(18)
s_waitcnt lgkmcnt(0)
s_barrier
v_mfma_f32_16x16x32_bf16 v[36:39], a[36:39], a[104:107], v[36:39]
ds_read_b128 a[0:3], v190 offset:18432
buffer_load_dwordx4 v1, s[4:7], s39 offen offset:1024 sc1 lds
v_mfma_f32_16x16x32_bf16 v[40:43], a[36:39], a[108:111], v[40:43]
ds_read_b128 a[4:7], v190 offset:19456
s_add_u32 s30, s30, s31
v_mfma_f32_16x16x32_bf16 v[44:47], a[40:43], a[104:107], v[44:47]
ds_read_b128 a[8:11], v190 offset:20480
buffer_load_dwordx4 v1, s[4:7], s39 offen offset:2048 sc1 lds
v_mfma_f32_16x16x32_bf16 v[48:51], a[40:43], a[108:111], v[48:51]
ds_read_b128 a[12:15], v190 offset:21504
s_mul_i32 s30, s30, 73728
v_mfma_f32_16x16x32_bf16 v[52:55], a[44:47], a[104:107], v[52:55]
ds_read_b128 a[16:19], v190 offset:22528
s_add_u32 s30, s30, 16777216
v_mfma_f32_16x16x32_bf16 v[56:59], a[44:47], a[108:111], v[56:59]
ds_read_b128 a[20:23], v190 offset:23552
buffer_load_dwordx4 v1, s[4:7], s39 offen offset:3072 sc1 lds
v_mfma_f32_16x16x32_bf16 v[60:63], a[48:51], a[104:107], v[60:63]
ds_read_b128 a[24:27], v190 offset:24576
s_mul_i32 s31, s26, 4608
v_mfma_f32_16x16x32_bf16 v[64:67], a[48:51], a[108:111], v[64:67]
ds_read_b128 a[28:31], v190 offset:25600
s_add_u32 s30, s30, s31
v_mfma_f32_16x16x32_bf16 v[68:71], a[52:55], a[104:107], v[68:71]
ds_read_b128 a[32:35], v190 offset:26624
s_add_u32 m0, m0, 4096
v_mfma_f32_16x16x32_bf16 v[72:75], a[52:55], a[108:111], v[72:75]
s_add_u32 s39, s39, 4096
s_and_b32 s65, s26, 1
s_lshl_b32 s64, s65, 9
v_mfma_f32_16x16x32_bf16 v[76:79], a[56:59], a[104:107], v[76:79]
s_add_u32 s64, s64, s30
v_mfma_f32_16x16x32_bf16 v[80:83], a[56:59], a[108:111], v[80:83]
s_xor_b32 s65, s65, 1
v_mfma_f32_16x16x32_bf16 v[84:87], a[60:63], a[104:107], v[84:87]
s_lshl_b32 s65, s65, 12
v_mfma_f32_16x16x32_bf16 v[88:91], a[60:63], a[108:111], v[88:91]
s_add_u32 s65, s65, s30
v_mfma_f32_16x16x32_bf16 v[92:95], a[64:67], a[104:107], v[92:95]
buffer_load_dwordx4 v1, s[4:7], s39 offen offset:0 sc1 lds
v_mfma_f32_16x16x32_bf16 v[96:99], a[64:67], a[108:111], v[96:99]
v_mfma_f32_16x16x32_bf16 v[100:103], a[68:71], a[104:107], v[100:103]
v_permlane16_swap_b32 v172, v176
v_mfma_f32_16x16x32_bf16 v[104:107], a[68:71], a[108:111], v[104:107]
s_waitcnt lgkmcnt(0)
v_mfma_f32_16x16x32_bf16 v[36:39], a[0:3], a[112:115], v[36:39]
ds_read_b128 a[36:39], v190 offset:27648
buffer_load_dwordx4 v1, s[4:7], s39 offen offset:1024 sc1 lds
v_mfma_f32_16x16x32_bf16 v[40:43], a[0:3], a[116:119], v[40:43]
ds_read_b128 a[40:43], v190 offset:28672
v_mfma_f32_16x16x32_bf16 v[44:47], a[4:7], a[112:115], v[44:47]
ds_read_b128 a[44:47], v190 offset:29696
buffer_load_dwordx4 v1, s[4:7], s39 offen offset:2048 sc1 lds
v_mfma_f32_16x16x32_bf16 v[48:51], a[4:7], a[116:119], v[48:51]
ds_read_b128 a[48:51], v190 offset:30720
v_mfma_f32_16x16x32_bf16 v[52:55], a[8:11], a[112:115], v[52:55]
ds_read_b128 a[52:55], v190 offset:31744
v_mfma_f32_16x16x32_bf16 v[56:59], a[8:11], a[116:119], v[56:59]
ds_read_b128 a[56:59], v190 offset:32768
buffer_load_dwordx4 v1, s[4:7], s39 offen offset:3072 sc1 lds
v_mfma_f32_16x16x32_bf16 v[60:63], a[12:15], a[112:115], v[60:63]
ds_read_b128 a[60:63], v190 offset:33792
v_mfma_f32_16x16x32_bf16 v[64:67], a[12:15], a[116:119], v[64:67]
ds_read_b128 a[64:67], v190 offset:34816
v_mfma_f32_16x16x32_bf16 v[68:71], a[16:19], a[112:115], v[68:71]
ds_read_b128 a[68:71], v190 offset:35840
s_add_u32 m0, m0, 4096
v_mfma_f32_16x16x32_bf16 v[72:75], a[16:19], a[116:119], v[72:75]
s_add_u32 s39, s39, 4096
v_permlane16_swap_b32 v173, v177
v_mfma_f32_16x16x32_bf16 v[76:79], a[20:23], a[112:115], v[76:79]
v_permlane16_swap_b32 v174, v178
v_mfma_f32_16x16x32_bf16 v[80:83], a[20:23], a[116:119], v[80:83]
v_permlane16_swap_b32 v175, v179
v_mfma_f32_16x16x32_bf16 v[84:87], a[24:27], a[112:115], v[84:87]
v_add_u32 v233, 73728, v1
v_and_b32 v232, 1, v3
v_mfma_f32_16x16x32_bf16 v[88:91], a[24:27], a[116:119], v[88:91]
v_mul_u32_u24 v232, 73728, v232
v_mfma_f32_16x16x32_bf16 v[92:95], a[28:31], a[112:115], v[92:95]
buffer_load_dwordx4 v1, s[4:7], s39 offen offset:0 sc1 lds
v_lshrrev_b32 v8, 1, v3
v_mfma_f32_16x16x32_bf16 v[96:99], a[28:31], a[116:119], v[96:99]
v_mfma_f32_16x16x32_bf16 v[100:103], a[32:35], a[112:115], v[100:103]
v_lshl_add_u32 v232, v8, 8, v232
v_mfma_f32_16x16x32_bf16 v[104:107], a[32:35], a[116:119], v[104:107]
s_waitcnt vmcnt(9)
s_waitcnt lgkmcnt(0)
s_barrier
v_mfma_f32_16x16x32_bf16 v[36:39], a[36:39], a[120:123], v[36:39]
ds_read_b128 a[0:3], v191 offset:8192
buffer_load_dwordx4 v1, s[4:7], s39 offen offset:1024 sc1 lds
v_lshl_add_u32 v232, v2, 4, v232
v_mfma_f32_16x16x32_bf16 v[40:43], a[36:39], a[124:127], v[40:43]
ds_read_b128 a[4:7], v191 offset:17408
v_mfma_f32_16x16x32_bf16 v[44:47], a[40:43], a[120:123], v[44:47]
ds_read_b128 a[8:11], v191 offset:26624
buffer_load_dwordx4 v1, s[4:7], s39 offen offset:2048 sc1 lds
v_mfma_f32_16x16x32_bf16 v[48:51], a[40:43], a[124:127], v[48:51]
ds_read_b128 a[12:15], v191 offset:35840
v_mfma_f32_16x16x32_bf16 v[52:55], a[44:47], a[120:123], v[52:55]
ds_read_b128 a[16:19], v191 offset:0
s_mul_i32 s38, s24, 11264
v_mfma_f32_16x16x32_bf16 v[56:59], a[44:47], a[124:127], v[56:59]
ds_read_b128 a[20:23], v191 offset:1024
v_mfma_f32_16x16x32_bf16 v[60:63], a[48:51], a[120:123], v[60:63]
ds_read_b128 a[24:27], v191 offset:9216
s_add_u32 m0, s38, 45056
v_mfma_f32_16x16x32_bf16 v[64:67], a[48:51], a[124:127], v[64:67]
ds_read_b128 a[28:31], v191 offset:10240
v_mfma_f32_16x16x32_bf16 v[68:71], a[52:55], a[120:123], v[68:71]
ds_read_b128 a[32:35], v191 offset:18432
s_add_u32 s39, s38, s83
v_mfma_f32_16x16x32_bf16 v[72:75], a[52:55], a[124:127], v[72:75]
s_add_u32 s39, s39, 45056
v_mfma_f32_16x16x32_bf16 v[76:79], a[56:59], a[120:123], v[76:79]
v_mfma_f32_16x16x32_bf16 v[80:83], a[56:59], a[124:127], v[80:83]
v_mfma_f32_16x16x32_bf16 v[84:87], a[60:63], a[120:123], v[84:87]
buffer_load_dwordx4 v1, s[4:7], s39 offen offset:0 sc1 lds
v_mfma_f32_16x16x32_bf16 v[88:91], a[60:63], a[124:127], v[88:91]
v_mfma_f32_16x16x32_bf16 v[92:95], a[64:67], a[120:123], v[92:95]
buffer_load_dwordx4 v1, s[4:7], s39 offen offset:1024 sc1 lds
v_mfma_f32_16x16x32_bf16 v[96:99], a[64:67], a[124:127], v[96:99]
v_mfma_f32_16x16x32_bf16 v[100:103], a[68:71], a[120:123], v[100:103]
v_mfma_f32_16x16x32_bf16 v[104:107], a[68:71], a[124:127], v[104:107]
s_waitcnt lgkmcnt(7)
v_mfma_f32_16x16x32_bf16 v[100:103], a[0:3], a[128:131], v[100:103]
ds_read_b128 a[36:39], v191 offset:19456
v_mfma_f32_16x16x32_bf16 v[104:107], a[0:3], a[132:135], v[104:107]
v_mfma_f32_16x16x32_bf16 v[100:103], a[4:7], a[136:139], v[100:103]
ds_read_b128 a[40:43], v191 offset:27648
v_mfma_f32_16x16x32_bf16 v[104:107], a[4:7], a[140:143], v[104:107]
s_waitcnt lgkmcnt(7)
v_mfma_f32_16x16x32_bf16 v[100:103], a[8:11], a[144:147], v[100:103]
ds_read_b128 a[44:47], v191 offset:28672
v_mfma_f32_16x16x32_bf16 v[104:107], a[8:11], a[148:151], v[104:107]
v_mfma_f32_16x16x32_bf16 v[100:103], a[12:15], a[152:155], v[100:103]
ds_read_b128 a[48:51], v191 offset:2048
v_mfma_f32_16x16x32_bf16 v[104:107], a[12:15], a[156:159], v[104:107]
s_waitcnt lgkmcnt(7)
v_mfma_f32_16x16x32_bf16 v[36:39], a[16:19], a[128:131], v[36:39]
ds_read_b128 a[52:55], v191 offset:3072
v_mfma_f32_16x16x32_bf16 v[40:43], a[16:19], a[132:135], v[40:43]
v_mfma_f32_16x16x32_bf16 v[44:47], a[20:23], a[128:131], v[44:47]
ds_read_b128 a[56:59], v191 offset:11264
v_mfma_f32_16x16x32_bf16 v[48:51], a[20:23], a[132:135], v[48:51]
v_mul_f32 v100, v100, v108
s_waitcnt lgkmcnt(7)
v_mfma_f32_16x16x32_bf16 v[36:39], a[24:27], a[136:139], v[36:39]
ds_read_b128 a[60:63], v191 offset:12288
v_mul_f32 v101, v101, v109
v_mfma_f32_16x16x32_bf16 v[40:43], a[24:27], a[140:143], v[40:43]
v_mul_f32 v102, v102, v110
v_mul_f32 v103, v103, v111
v_mfma_f32_16x16x32_bf16 v[44:47], a[28:31], a[136:139], v[44:47]
ds_read_b128 a[64:67], v191 offset:20480
v_cvt_pk_bf16_f32 v224, v100, v101
v_mfma_f32_16x16x32_bf16 v[48:51], a[28:31], a[140:143], v[48:51]
v_cvt_pk_bf16_f32 v225, v102, v103
s_waitcnt lgkmcnt(7)
v_mfma_f32_16x16x32_bf16 v[36:39], a[32:35], a[144:147], v[36:39]
ds_read_b128 a[68:71], v191 offset:21504
v_mul_f32 v104, v104, v112
v_mfma_f32_16x16x32_bf16 v[40:43], a[32:35], a[148:151], v[40:43]
v_mul_f32 v105, v105, v113
v_mfma_f32_16x16x32_bf16 v[44:47], a[36:39], a[144:147], v[44:47]
ds_read_b128 a[0:3], v191 offset:29696
v_mul_f32 v106, v106, v114
v_mfma_f32_16x16x32_bf16 v[48:51], a[36:39], a[148:151], v[48:51]
v_mul_f32 v107, v107, v115
s_waitcnt lgkmcnt(7)
v_mfma_f32_16x16x32_bf16 v[36:39], a[40:43], a[152:155], v[36:39]
ds_read_b128 a[4:7], v191 offset:30720
v_cvt_pk_bf16_f32 v226, v104, v105
v_mfma_f32_16x16x32_bf16 v[40:43], a[40:43], a[156:159], v[40:43]
v_cvt_pk_bf16_f32 v227, v106, v107
s_nop 0
v_mfma_f32_16x16x32_bf16 v[44:47], a[44:47], a[152:155], v[44:47]
ds_read_b128 a[8:11], v191 offset:4096
v_mfma_f32_16x16x32_bf16 v[48:51], a[44:47], a[156:159], v[48:51]
s_waitcnt lgkmcnt(7)
v_mfma_f32_16x16x32_bf16 v[52:55], a[48:51], a[128:131], v[52:55]
ds_read_b128 a[12:15], v191 offset:5120
v_permlane16_swap_b32 v224, v226
v_mfma_f32_16x16x32_bf16 v[56:59], a[48:51], a[132:135], v[56:59]
v_permlane16_swap_b32 v225, v227
v_mfma_f32_16x16x32_bf16 v[60:63], a[52:55], a[128:131], v[60:63]
ds_read_b128 a[16:19], v191 offset:13312
buffer_store_dwordx4 v[224:227], v232, s[8:11], s65 offen sc1
v_mfma_f32_16x16x32_bf16 v[64:67], a[52:55], a[132:135], v[64:67]
v_mul_f32 v36, v36, v116
s_waitcnt lgkmcnt(7)
v_mfma_f32_16x16x32_bf16 v[52:55], a[56:59], a[136:139], v[52:55]
ds_read_b128 a[20:23], v191 offset:14336
v_mul_f32 v37, v37, v117
v_mfma_f32_16x16x32_bf16 v[56:59], a[56:59], a[140:143], v[56:59]
v_mul_f32 v38, v38, v118
v_mul_f32 v39, v39, v119
v_mfma_f32_16x16x32_bf16 v[60:63], a[60:63], a[136:139], v[60:63]
ds_read_b128 a[24:27], v191 offset:22528
v_cvt_pk_bf16_f32 v192, v36, v37
v_mfma_f32_16x16x32_bf16 v[64:67], a[60:63], a[140:143], v[64:67]
v_cvt_pk_bf16_f32 v193, v38, v39
v_mul_f32 v44, v44, v124
s_waitcnt lgkmcnt(7)
v_mfma_f32_16x16x32_bf16 v[52:55], a[64:67], a[144:147], v[52:55]
ds_read_b128 a[28:31], v191 offset:23552
v_mul_f32 v45, v45, v125
v_mfma_f32_16x16x32_bf16 v[56:59], a[64:67], a[148:151], v[56:59]
v_mul_f32 v46, v46, v126
v_mul_f32 v47, v47, v127
v_mfma_f32_16x16x32_bf16 v[60:63], a[68:71], a[144:147], v[60:63]
ds_read_b128 a[32:35], v191 offset:31744
v_cvt_pk_bf16_f32 v194, v44, v45
v_mfma_f32_16x16x32_bf16 v[64:67], a[68:71], a[148:151], v[64:67]
v_cvt_pk_bf16_f32 v195, v46, v47
s_waitcnt lgkmcnt(7)
v_mfma_f32_16x16x32_bf16 v[52:55], a[0:3], a[152:155], v[52:55]
ds_read_b128 a[36:39], v191 offset:32768
buffer_store_dwordx4 v[192:195], v1, s[8:11], s64 offen offset:0 sc1
v_mul_f32 v40, v40, v120
v_mul_f32 v41, v41, v121
v_mfma_f32_16x16x32_bf16 v[56:59], a[0:3], a[156:159], v[56:59]
v_mul_f32 v42, v42, v122
v_mul_f32 v43, v43, v123
v_mfma_f32_16x16x32_bf16 v[60:63], a[4:7], a[152:155], v[60:63]
ds_read_b128 a[40:43], v191 offset:6144
v_cvt_pk_bf16_f32 v196, v40, v41
v_mfma_f32_16x16x32_bf16 v[64:67], a[4:7], a[156:159], v[64:67]
v_cvt_pk_bf16_f32 v197, v42, v43
v_mul_f32 v48, v48, v128
s_waitcnt lgkmcnt(7)
v_mfma_f32_16x16x32_bf16 v[68:71], a[8:11], a[128:131], v[68:71]
ds_read_b128 a[44:47], v191 offset:7168
v_mul_f32 v49, v49, v129
v_mfma_f32_16x16x32_bf16 v[72:75], a[8:11], a[132:135], v[72:75]
v_mul_f32 v50, v50, v130
v_mul_f32 v51, v51, v131
v_mfma_f32_16x16x32_bf16 v[76:79], a[12:15], a[128:131], v[76:79]
ds_read_b128 a[48:51], v191 offset:15360
v_cvt_pk_bf16_f32 v198, v48, v49
v_cvt_pk_bf16_f32 v199, v50, v51
buffer_store_dwordx4 v[196:199], v233, s[8:11], s64 offen offset:0 sc1
v_mfma_f32_16x16x32_bf16 v[80:83], a[12:15], a[132:135], v[80:83]
v_mul_f32 v52, v52, v132
s_waitcnt lgkmcnt(7)
v_mfma_f32_16x16x32_bf16 v[68:71], a[16:19], a[136:139], v[68:71]
ds_read_b128 a[52:55], v191 offset:16384
v_mul_f32 v53, v53, v133
v_mfma_f32_16x16x32_bf16 v[72:75], a[16:19], a[140:143], v[72:75]
v_mul_f32 v54, v54, v134
v_mul_f32 v55, v55, v135
v_mfma_f32_16x16x32_bf16 v[76:79], a[20:23], a[136:139], v[76:79]
ds_read_b128 a[56:59], v191 offset:24576
v_cvt_pk_bf16_f32 v200, v52, v53
v_mfma_f32_16x16x32_bf16 v[80:83], a[20:23], a[140:143], v[80:83]
v_cvt_pk_bf16_f32 v201, v54, v55
v_mul_f32 v60, v60, v140
s_waitcnt lgkmcnt(7)
v_mfma_f32_16x16x32_bf16 v[68:71], a[24:27], a[144:147], v[68:71]
ds_read_b128 a[60:63], v191 offset:25600
v_mul_f32 v61, v61, v141
v_mfma_f32_16x16x32_bf16 v[72:75], a[24:27], a[148:151], v[72:75]
v_mul_f32 v62, v62, v142
v_mul_f32 v63, v63, v143
v_mfma_f32_16x16x32_bf16 v[76:79], a[28:31], a[144:147], v[76:79]
ds_read_b128 a[64:67], v191 offset:33792
v_cvt_pk_bf16_f32 v202, v60, v61
v_mfma_f32_16x16x32_bf16 v[80:83], a[28:31], a[148:151], v[80:83]
v_cvt_pk_bf16_f32 v203, v62, v63
s_waitcnt lgkmcnt(7)
v_mfma_f32_16x16x32_bf16 v[68:71], a[32:35], a[152:155], v[68:71]
ds_read_b128 a[68:71], v191 offset:34816
buffer_store_dwordx4 v[200:203], v1, s[8:11], s64 offen offset:1024 sc1
v_mul_f32 v56, v56, v136
v_mul_f32 v57, v57, v137
v_mfma_f32_16x16x32_bf16 v[72:75], a[32:35], a[156:159], v[72:75]
v_mul_f32 v58, v58, v138
v_mul_f32 v59, v59, v139
v_mfma_f32_16x16x32_bf16 v[76:79], a[36:39], a[152:155], v[76:79]
v_cvt_pk_bf16_f32 v204, v56, v57
v_cvt_pk_bf16_f32 v205, v58, v59
v_mfma_f32_16x16x32_bf16 v[80:83], a[36:39], a[156:159], v[80:83]
v_mul_f32 v64, v64, v144
s_waitcnt lgkmcnt(6)
v_mfma_f32_16x16x32_bf16 v[84:87], a[40:43], a[128:131], v[84:87]
v_mul_f32 v65, v65, v145
v_mul_f32 v66, v66, v146
v_mfma_f32_16x16x32_bf16 v[88:91], a[40:43], a[132:135], v[88:91]
v_mul_f32 v67, v67, v147
v_cvt_pk_bf16_f32 v206, v64, v65
v_mfma_f32_16x16x32_bf16 v[92:95], a[44:47], a[128:131], v[92:95]
v_cvt_pk_bf16_f32 v207, v66, v67
buffer_store_dwordx4 v[204:207], v233, s[8:11], s64 offen offset:1024 sc1
v_mfma_f32_16x16x32_bf16 v[96:99], a[44:47], a[132:135], v[96:99]
v_mul_f32 v68, v68, v148
s_waitcnt lgkmcnt(4)
v_mfma_f32_16x16x32_bf16 v[84:87], a[48:51], a[136:139], v[84:87]
v_mul_f32 v69, v69, v149
v_mul_f32 v70, v70, v150
v_mfma_f32_16x16x32_bf16 v[88:91], a[48:51], a[140:143], v[88:91]
v_mul_f32 v71, v71, v151
v_cvt_pk_bf16_f32 v208, v68, v69
v_mfma_f32_16x16x32_bf16 v[92:95], a[52:55], a[136:139], v[92:95]
v_cvt_pk_bf16_f32 v209, v70, v71
v_mul_f32 v76, v76, v156
v_mfma_f32_16x16x32_bf16 v[96:99], a[52:55], a[140:143], v[96:99]
v_mul_f32 v77, v77, v157
s_waitcnt lgkmcnt(2)
v_mfma_f32_16x16x32_bf16 v[84:87], a[56:59], a[144:147], v[84:87]
v_mul_f32 v78, v78, v158
v_mul_f32 v79, v79, v159
v_mfma_f32_16x16x32_bf16 v[88:91], a[56:59], a[148:151], v[88:91]
v_cvt_pk_bf16_f32 v210, v76, v77
v_cvt_pk_bf16_f32 v211, v78, v79
v_mfma_f32_16x16x32_bf16 v[92:95], a[60:63], a[144:147], v[92:95]
buffer_store_dwordx4 v[208:211], v1, s[8:11], s64 offen offset:2048 sc1
v_mul_f32 v72, v72, v152
v_mfma_f32_16x16x32_bf16 v[96:99], a[60:63], a[148:151], v[96:99]
v_mul_f32 v73, v73, v153
v_mul_f32 v74, v74, v154
s_waitcnt lgkmcnt(0)
v_mfma_f32_16x16x32_bf16 v[84:87], a[64:67], a[152:155], v[84:87]
v_mul_f32 v75, v75, v155
v_cvt_pk_bf16_f32 v212, v72, v73
v_mfma_f32_16x16x32_bf16 v[88:91], a[64:67], a[156:159], v[88:91]
v_cvt_pk_bf16_f32 v213, v74, v75
v_mul_f32 v80, v80, v160
v_mfma_f32_16x16x32_bf16 v[92:95], a[68:71], a[152:155], v[92:95]
v_mul_f32 v81, v81, v161
v_mul_f32 v82, v82, v162
v_mfma_f32_16x16x32_bf16 v[96:99], a[68:71], a[156:159], v[96:99]
v_mul_f32 v83, v83, v163
v_cvt_pk_bf16_f32 v214, v80, v81
v_cvt_pk_bf16_f32 v215, v82, v83
buffer_store_dwordx4 v[212:215], v233, s[8:11], s64 offen offset:2048 sc1
s_nop 1
v_pk_mul_f32 v[84:85], v[84:85], v[164:165]
v_pk_mul_f32 v[86:87], v[86:87], v[166:167]
v_cvt_pk_bf16_f32 v216, v84, v85
v_cvt_pk_bf16_f32 v217, v86, v87
v_pk_mul_f32 v[92:93], v[92:93], v[172:173]
v_pk_mul_f32 v[94:95], v[94:95], v[174:175]
v_cvt_pk_bf16_f32 v218, v92, v93
v_cvt_pk_bf16_f32 v219, v94, v95
buffer_store_dwordx4 v[216:219], v1, s[8:11], s64 offen offset:3072 sc1
v_pk_mul_f32 v[88:89], v[88:89], v[168:169]
v_pk_mul_f32 v[90:91], v[90:91], v[170:171]
v_cvt_pk_bf16_f32 v220, v88, v89
v_cvt_pk_bf16_f32 v221, v90, v91
v_pk_mul_f32 v[96:97], v[96:97], v[176:177]
v_pk_mul_f32 v[98:99], v[98:99], v[178:179]
v_cvt_pk_bf16_f32 v222, v96, v97
v_cvt_pk_bf16_f32 v223, v98, v99
buffer_store_dwordx4 v[220:223], v233, s[8:11], s64 offen offset:3072 sc1
L_c5:
buffer_load_dwordx4 v1, s[4:7], s39 offen offset:2048 sc1 lds
buffer_load_dwordx4 v1, s[4:7], s39 offen offset:3072 sc1 lds
s_add_u32 m0, m0, 4096
s_add_u32 s39, s39, 4096
buffer_load_dwordx4 v1, s[4:7], s39 offen offset:0 sc1 lds
buffer_load_dwordx4 v1, s[4:7], s39 offen offset:1024 sc1 lds
buffer_load_dwordx4 v1, s[4:7], s39 offen offset:2048 sc1 lds
buffer_load_dwordx4 v1, s[4:7], s39 offen offset:3072 sc1 lds
s_add_u32 m0, m0, 4096
s_add_u32 s39, s39, 4096
buffer_load_dwordx4 v1, s[4:7], s39 offen offset:0 sc1 lds
buffer_load_dwordx4 v1, s[4:7], s39 offen offset:1024 sc1 lds
buffer_load_dwordx4 v1, s[4:7], s39 offen offset:2048 sc1 lds
s_waitcnt vmcnt(9)
s_barrier
s_cmp_eq_u32 s24, 0
s_cbranch_scc0 L_sig_30
v_lshlrev_b32 v6, 3, v1
s_lshl_b32 s31, s25, 11
v_add_u32 v6, s31, v6
s_mov_b64 exec, 0xffff
s_mov_b32 s30, 26574848
buffer_atomic_add v4, v6, s[8:11], s30 offen sc1
s_mov_b64 exec, -1
L_sig_30:
s_mul_i32 s38, s24, 9216
s_add_u32 m0, s38, 90112
s_add_u32 s39, s38, s83
s_add_u32 s39, s39, 90112
buffer_load_dwordx4 v1, s[4:7], s39 offen offset:0 sc1 lds
buffer_load_dwordx4 v1, s[4:7], s39 offen offset:1024 sc1 lds
buffer_load_dwordx4 v1, s[4:7], s39 offen offset:2048 sc1 lds
buffer_load_dwordx4 v1, s[4:7], s39 offen offset:3072 sc1 lds
s_add_u32 m0, m0, 4096
s_add_u32 s39, s39, 4096
buffer_load_dwordx4 v1, s[4:7], s39 offen offset:0 sc1 lds
buffer_load_dwordx4 v1, s[4:7], s39 offen offset:1024 sc1 lds
buffer_load_dwordx4 v1, s[4:7], s39 offen offset:2048 sc1 lds
buffer_load_dwordx4 v1, s[4:7], s39 offen offset:3072 sc1 lds
s_add_u32 m0, m0, 4096
s_add_u32 s39, s39, 4096
buffer_load_dwordx4 v1, s[4:7], s39 offen offset:0 sc1 lds
s_mul_i32 s38, s24, 9216
s_add_u32 m0, s38, 126976
s_add_u32 s39, s38, s83
s_add_u32 s39, s39, 126976
buffer_load_dwordx4 v1, s[4:7], s39 offen offset:0 sc1 lds
buffer_load_dwordx4 v1, s[4:7], s39 offen offset:1024 sc1 lds
buffer_load_dwordx4 v1, s[4:7], s39 offen offset:2048 sc1 lds
buffer_load_dwordx4 v1, s[4:7], s39 offen offset:3072 sc1 lds
s_add_u32 m0, m0, 4096
s_add_u32 s39, s39, 4096
buffer_load_dwordx4 v1, s[4:7], s39 offen offset:0 sc1 lds
buffer_load_dwordx4 v1, s[4:7], s39 offen offset:1024 sc1 lds
buffer_load_dwordx4 v1, s[4:7], s39 offen offset:2048 sc1 lds
buffer_load_dwordx4 v1, s[4:7], s39 offen offset:3072 sc1 lds
s_add_u32 m0, m0, 4096
s_add_u32 s39, s39, 4096
buffer_load_dwordx4 v1, s[4:7], s39 offen offset:0 sc1 lds
s_cmp_eq_u32 s24, 1
s_cbranch_scc0 L_other_33
s_lshl_b32 s30, s81, 7
s_add_u32 s30, s30, 26574848
v_mov_b32 v6, 0
s_mov_b32 s31, 0
s_mov_b64 exec, 1
v_mov_b32 v249, 0
buffer_atomic_add v249, v6, s[8:11], s30 offen sc0 sc1
s_sleep 3
v_mov_b32 v250, 0
buffer_atomic_add v250, v6, s[8:11], s30 offen sc0 sc1
s_sleep 3
v_mov_b32 v251, 0
buffer_atomic_add v251, v6, s[8:11], s30 offen sc0 sc1
s_sleep 3
L_poll_31:
s_add_u32 s31, s31, 1
s_cmp_gt_u32 s31, 100000
s_cbranch_scc1 L_polled_32
v_mov_b32 v252, 0
buffer_atomic_add v252, v6, s[8:11], s30 offen sc0 sc1
s_waitcnt vmcnt(3)
v_cmp_gt_u32 vcc, 16, v249
s_nop 0
s_cbranch_vccz L_polled_32
v_mov_b32 v249, 0
buffer_atomic_add v249, v6, s[8:11], s30 offen sc0 sc1
s_waitcnt vmcnt(3)
v_cmp_gt_u32 vcc, 16, v250
s_nop 0
s_cbranch_vccz L_polled_32
v_mov_b32 v250, 0
buffer_atomic_add v250, v6, s[8:11], s30 offen sc0 sc1
s_waitcnt vmcnt(3)
v_cmp_gt_u32 vcc, 16, v251
s_nop 0
s_cbranch_vccz L_polled_32
v_mov_b32 v251, 0
buffer_atomic_add v251, v6, s[8:11], s30 offen sc0 sc1
s_waitcnt vmcnt(3)
v_cmp_gt_u32 vcc, 16, v252
s_nop 0
s_cbranch_vccz L_polled_32
s_branch L_poll_31
L_polled_32:
s_mov_b64 exec, -1
s_branch L_join_34
L_other_33:
s_waitcnt vmcnt(0)
L_join_34:
s_barrier
s_xor_b32 s30, s27, 1
s_lshl_b32 s60, s30, 2
s_add_u32 s60, s60, s24
s_mul_i32 s60, s60, 73728
s_and_b32 s31, s27, 1
s_mul_i32 s31, s31, 36864
s_add_u32 s31, s31, 16777216
s_add_u32 s60, s60, s31
buffer_load_dwordx4 a[0:3], v1, s[8:11], s60 offen offset:0 sc1
buffer_load_dwordx4 a[4:7], v1, s[8:11], s60 offen offset:1024 sc1
buffer_load_dwordx4 a[8:11], v1, s[8:11], s60 offen offset:2048 sc1
buffer_load_dwordx4 a[12:15], v1, s[8:11], s60 offen offset:3072 sc1
s_add_u32 s60, s60, 4096
buffer_load_dwordx4 a[16:19], v1, s[8:11], s60 offen offset:0 sc1
buffer_load_dwordx4 a[20:23], v1, s[8:11], s60 offen offset:1024 sc1
buffer_load_dwordx4 a[24:27], v1, s[8:11], s60 offen offset:2048 sc1
buffer_load_dwordx4 a[28:31], v1, s[8:11], s60 offen offset:3072 sc1
s_add_u32 s60, s60, 4096
buffer_load_dwordx4 a[32:35], v1, s[8:11], s60 offen offset:0 sc1
buffer_load_dwordx4 a[36:39], v1, s[8:11], s60 offen offset:1024 sc1
v_and_b32 v40, 7, v2
v_lshlrev_b32 v40, 4, v40
v_lshl_add_u32 v40, v3, 7, v40
v_add_u32 v40, 4096, v40
s_lshl_b32 s61, s27, 2
s_add_u32 s61, s61, s24
s_mul_i32 s61, s61, 73728
s_add_u32 s61, s61, s31
s_lshl_b32 s63, s81, 14
s_lshl_b32 s30, s24, 12
s_add_u32 s63, s63, s30
s_xor_b32 s62, s63, 131072
s_add_u32 s63, s63, 26640384
s_add_u32 s62, s62, 26640384
s_add_u32 s64, s83, 161280
v_mov_b32 v116, v40
v_add_u32 v36, 0, v1
v_add_u32 v37, 55296, v1
v_add_u32 v41, 55296, v40
v_add_u32 v38, 110592, v1
v_add_u32 v42, 110592, v40
ds_read_b128 a[160:163], v36 offset:0
ds_read_b128 a[164:167], v36 offset:1024
ds_read_b128 a[168:171], v36 offset:2048
ds_read_b128 a[172:175], v36 offset:3072
ds_read_b128 a[176:179], v40 offset:0
ds_read_b128 a[180:183], v36 offset:4608
ds_read_b128 a[184:187], v36 offset:5632
ds_read_b128 a[188:191], v36 offset:6656
ds_read_b128 a[192:195], v36 offset:7680
ds_read_b128 a[196:199], v40 offset:4608
s_waitcnt vmcnt(9)
s_waitcnt lgkmcnt(5)
v_mfma_f32_16x16x32_bf16 v[44:47], a[160:163], a[0:3], 0
ds_read_b128 a[200:203], v36 offset:9216
buffer_load_dwordx4 a[40:43], v1, s[8:11], s60 offen offset:2048 sc1
v_mfma_f32_16x16x32_bf16 v[48:51], a[164:167], a[0:3], 0
ds_read_b128 a[204:207], v36 offset:10240
v_mfma_f32_16x16x32_bf16 v[52:55], a[168:171], a[0:3], 0
ds_read_b128 a[208:211], v36 offset:11264
v_mfma_f32_16x16x32_bf16 v[56:59], a[172:175], a[0:3], 0
ds_read_b128 a[212:215], v36 offset:12288
v_mfma_f32_16x16x32_bf16 v[60:63], a[176:179], a[0:3], 0
ds_read_b128 a[216:219], v40 offset:9216
s_waitcnt vmcnt(9)
s_waitcnt lgkmcnt(5)
v_mfma_f32_16x16x32_bf16 v[44:47], a[180:183], a[4:7], v[44:47]
ds_read_b128 a[160:163], v36 offset:13824
buffer_load_dwordx4 a[0:3], v1, s[8:11], s60 offen offset:3072 sc1
v_mfma_f32_16x16x32_bf16 v[48:51], a[184:187], a[4:7], v[48:51]
ds_read_b128 a[164:167], v36 offset:14848
v_mfma_f32_16x16x32_bf16 v[52:55], a[188:191], a[4:7], v[52:55]
ds_read_b128 a[168:171], v36 offset:15872
v_mfma_f32_16x16x32_bf16 v[56:59], a[192:195], a[4:7], v[56:59]
ds_read_b128 a[172:175], v36 offset:16896
v_mfma_f32_16x16x32_bf16 v[60:63], a[196:199], a[4:7], v[60:63]
ds_read_b128 a[176:179], v40 offset:13824
s_waitcnt vmcnt(9)
s_waitcnt lgkmcnt(5)
v_mfma_f32_16x16x32_bf16 v[44:47], a[200:203], a[8:11], v[44:47]
ds_read_b128 a[180:183], v36 offset:18432
s_add_u32 s60, s60, 4096
buffer_load_dwordx4 a[4:7], v1, s[8:11], s60 offen offset:0 sc1
v_mfma_f32_16x16x32_bf16 v[48:51], a[204:207], a[8:11], v[48:51]
ds_read_b128 a[184:187], v36 offset:19456
v_mov_b32 v67, v248
v_mfma_f32_16x16x32_bf16 v[52:55], a[208:211], a[8:11], v[52:55]
ds_read_b128 a[188:191], v36 offset:20480
v_mfma_f32_16x16x32_bf16 v[56:59], a[212:215], a[8:11], v[56:59]
ds_read_b128 a[192:195], v36 offset:21504
v_mfma_f32_16x16x32_bf16 v[60:63], a[216:219], a[8:11], v[60:63]
ds_read_b128 a[196:199], v40 offset:18432
s_waitcnt vmcnt(9)
s_waitcnt lgkmcnt(5)
v_mfma_f32_16x16x32_bf16 v[44:47], a[160:163], a[12:15], v[44:47]
ds_read_b128 a[200:203], v36 offset:23040
buffer_load_dwordx4 a[8:11], v1, s[8:11], s60 offen offset:1024 sc1
v_mfma_f32_16x16x32_bf16 v[48:51], a[164:167], a[12:15], v[48:51]
ds_read_b128 a[204:207], v36 offset:24064
v_mfma_f32_16x16x32_bf16 v[52:55], a[168:171], a[12:15], v[52:55]
ds_read_b128 a[208:211], v36 offset:25088
v_mov_b32 v71, v248
v_mfma_f32_16x16x32_bf16 v[56:59], a[172:175], a[12:15], v[56:59]
ds_read_b128 a[212:215], v36 offset:26112
v_mfma_f32_16x16x32_bf16 v[60:63], a[176:179], a[12:15], v[60:63]
ds_read_b128 a[216:219], v40 offset:23040
s_waitcnt vmcnt(9)
s_waitcnt lgkmcnt(5)
v_mfma_f32_16x16x32_bf16 v[44:47], a[180:183], a[16:19], v[44:47]
ds_read_b128 a[160:163], v36 offset:27648
buffer_load_dwordx4 a[12:15], v1, s[8:11], s60 offen offset:2048 sc1
v_mfma_f32_16x16x32_bf16 v[48:51], a[184:187], a[16:19], v[48:51]
ds_read_b128 a[164:167], v36 offset:28672
v_mfma_f32_16x16x32_bf16 v[52:55], a[188:191], a[16:19], v[52:55]
ds_read_b128 a[168:171], v36 offset:29696
v_mfma_f32_16x16x32_bf16 v[56:59], a[192:195], a[16:19], v[56:59]
ds_read_b128 a[172:175], v36 offset:30720
v_mfma_f32_16x16x32_bf16 v[60:63], a[196:199], a[16:19], v[60:63]
ds_read_b128 a[176:179], v40 offset:27648
s_waitcnt vmcnt(9)
s_waitcnt lgkmcnt(5)
v_mfma_f32_16x16x32_bf16 v[44:47], a[200:203], a[20:23], v[44:47]
ds_read_b128 a[180:183], v36 offset:32256
buffer_load_dwordx4 a[16:19], v1, s[8:11], s60 offen offset:3072 sc1
v_mfma_f32_16x16x32_bf16 v[48:51], a[204:207], a[20:23], v[48:51]
ds_read_b128 a[184:187], v36 offset:33280
v_mov_b32 v75, v248
v_mfma_f32_16x16x32_bf16 v[52:55], a[208:211], a[20:23], v[52:55]
ds_read_b128 a[188:191], v36 offset:34304
v_mfma_f32_16x16x32_bf16 v[56:59], a[212:215], a[20:23], v[56:59]
ds_read_b128 a[192:195], v36 offset:35328
v_mfma_f32_16x16x32_bf16 v[60:63], a[216:219], a[20:23], v[60:63]
ds_read_b128 a[196:199], v40 offset:32256
s_waitcnt vmcnt(9)
s_waitcnt lgkmcnt(5)
v_mfma_f32_16x16x32_bf16 v[44:47], a[160:163], a[24:27], v[44:47]
ds_read_b128 a[200:203], v36 offset:36864
s_add_u32 s60, s60, 4096
buffer_load_dwordx4 a[20:23], v1, s[8:11], s60 offen offset:0 sc1
v_mfma_f32_16x16x32_bf16 v[48:51], a[164:167], a[24:27], v[48:51]
ds_read_b128 a[204:207], v36 offset:37888
v_mfma_f32_16x16x32_bf16 v[52:55], a[168:171], a[24:27], v[52:55]
ds_read_b128 a[208:211], v36 offset:38912
v_mfma_f32_16x16x32_bf16 v[56:59], a[172:175], a[24:27], v[56:59]
ds_read_b128 a[212:215], v36 offset:39936
v_mov_b32 v79, v248
v_mfma_f32_16x16x32_bf16 v[60:63], a[176:179], a[24:27], v[60:63]
ds_read_b128 a[216:219], v40 offset:36864
s_waitcnt vmcnt(9)
s_waitcnt lgkmcnt(5)
v_mfma_f32_16x16x32_bf16 v[44:47], a[180:183], a[28:31], v[44:47]
ds_read_b128 a[160:163], v36 offset:41472
buffer_load_dwordx4 a[24:27], v1, s[8:11], s60 offen offset:1024 sc1
v_mfma_f32_16x16x32_bf16 v[48:51], a[184:187], a[28:31], v[48:51]
ds_read_b128 a[164:167], v36 offset:42496
v_mfma_f32_16x16x32_bf16 v[52:55], a[188:191], a[28:31], v[52:55]
ds_read_b128 a[168:171], v36 offset:43520
v_mfma_f32_16x16x32_bf16 v[56:59], a[192:195], a[28:31], v[56:59]
ds_read_b128 a[172:175], v36 offset:44544
v_mfma_f32_16x16x32_bf16 v[60:63], a[196:199], a[28:31], v[60:63]
ds_read_b128 a[176:179], v40 offset:41472
s_waitcnt vmcnt(9)
s_waitcnt lgkmcnt(5)
v_mfma_f32_16x16x32_bf16 v[44:47], a[200:203], a[32:35], v[44:47]
ds_read_b128 a[180:183], v36 offset:46080
buffer_load_dwordx4 a[28:31], v1, s[8:11], s60 offen offset:2048 sc1
v_mfma_f32_16x16x32_bf16 v[48:51], a[204:207], a[32:35], v[48:51]
ds_read_b128 a[184:187], v36 offset:47104
v_mfma_f32_16x16x32_bf16 v[52:55], a[208:211], a[32:35], v[52:55]
ds_read_b128 a[188:191], v36 offset:48128
v_mfma_f32_16x16x32_bf16 v[56:59], a[212:215], a[32:35], v[56:59]
ds_read_b128 a[192:195], v36 offset:49152
v_mfma_f32_16x16x32_bf16 v[60:63], a[216:219], a[32:35], v[60:63]
ds_read_b128 a[196:199], v40 offset:46080
s_waitcnt vmcnt(9)
s_waitcnt lgkmcnt(5)
v_mfma_f32_16x16x32_bf16 v[44:47], a[160:163], a[36:39], v[44:47]
ds_read_b128 a[200:203], v36 offset:50688
buffer_load_dwordx4 a[32:35], v1, s[8:11], s60 offen offset:3072 sc1
v_mfma_f32_16x16x32_bf16 v[48:51], a[164:167], a[36:39], v[48:51]
ds_read_b128 a[204:207], v36 offset:51712
v_mfma_f32_16x16x32_bf16 v[52:55], a[168:171], a[36:39], v[52:55]
ds_read_b128 a[208:211], v36 offset:52736
v_mfma_f32_16x16x32_bf16 v[56:59], a[172:175], a[36:39], v[56:59]
ds_read_b128 a[212:215], v36 offset:53760
v_mfma_f32_16x16x32_bf16 v[60:63], a[176:179], a[36:39], v[60:63]
ds_read_b128 a[216:219], v40 offset:50688
s_waitcnt vmcnt(9)
s_waitcnt lgkmcnt(5)
v_mfma_f32_16x16x32_bf16 v[44:47], a[180:183], a[40:43], v[44:47]
ds_read_b128 a[160:163], v37 offset:0
s_add_u32 s60, s60, 4096
buffer_load_dwordx4 a[36:39], v1, s[8:11], s60 offen offset:0 sc1
v_mfma_f32_16x16x32_bf16 v[48:51], a[184:187], a[40:43], v[48:51]
ds_read_b128 a[164:167], v37 offset:1024
v_mfma_f32_16x16x32_bf16 v[52:55], a[188:191], a[40:43], v[52:55]
ds_read_b128 a[168:171], v37 offset:2048
v_mfma_f32_16x16x32_bf16 v[56:59], a[192:195], a[40:43], v[56:59]
ds_read_b128 a[172:175], v37 offset:3072
v_mfma_f32_16x16x32_bf16 v[60:63], a[196:199], a[40:43], v[60:63]
ds_read_b128 a[176:179], v41 offset:0
s_waitcnt vmcnt(9)
s_waitcnt lgkmcnt(5)
v_mfma_f32_16x16x32_bf16 v[44:47], a[200:203], a[0:3], v[44:47]
ds_read_b128 a[180:183], v37 offset:4608
buffer_load_dwordx4 a[40:43], v1, s[8:11], s60 offen offset:1024 sc1
v_mfma_f32_16x16x32_bf16 v[48:51], a[204:207], a[0:3], v[48:51]
ds_read_b128 a[184:187], v37 offset:5632
v_mfma_f32_16x16x32_bf16 v[52:55], a[208:211], a[0:3], v[52:55]
ds_read_b128 a[188:191], v37 offset:6656
v_mfma_f32_16x16x32_bf16 v[56:59], a[212:215], a[0:3], v[56:59]
ds_read_b128 a[192:195], v37 offset:7680
v_mfma_f32_16x16x32_bf16 v[60:63], a[216:219], a[0:3], v[60:63]
ds_read_b128 a[196:199], v41 offset:4608
s_waitcnt vmcnt(9)
s_waitcnt lgkmcnt(5)
v_mfma_f32_16x16x32_bf16 v[44:47], a[160:163], a[4:7], v[44:47]
ds_read_b128 a[200:203], v37 offset:9216
buffer_load_dwordx4 a[0:3], v1, s[8:11], s60 offen offset:2048 sc1
v_mfma_f32_16x16x32_bf16 v[48:51], a[164:167], a[4:7], v[48:51]
ds_read_b128 a[204:207], v37 offset:10240
v_mfma_f32_16x16x32_bf16 v[52:55], a[168:171], a[4:7], v[52:55]
ds_read_b128 a[208:211], v37 offset:11264
v_mfma_f32_16x16x32_bf16 v[56:59], a[172:175], a[4:7], v[56:59]
ds_read_b128 a[212:215], v37 offset:12288
v_mfma_f32_16x16x32_bf16 v[60:63], a[176:179], a[4:7], v[60:63]
ds_read_b128 a[216:219], v41 offset:9216
s_waitcnt vmcnt(9)
s_waitcnt lgkmcnt(5)
v_mfma_f32_16x16x32_bf16 v[44:47], a[180:183], a[8:11], v[44:47]
ds_read_b128 a[160:163], v37 offset:13824
buffer_load_dwordx4 a[4:7], v1, s[8:11], s60 offen offset:3072 sc1
v_mfma_f32_16x16x32_bf16 v[48:51], a[184:187], a[8:11], v[48:51]
ds_read_b128 a[164:167], v37 offset:14848
v_mfma_f32_16x16x32_bf16 v[52:55], a[188:191], a[8:11], v[52:55]
ds_read_b128 a[168:171], v37 offset:15872
v_mfma_f32_16x16x32_bf16 v[56:59], a[192:195], a[8:11], v[56:59]
ds_read_b128 a[172:175], v37 offset:16896
v_mfma_f32_16x16x32_bf16 v[60:63], a[196:199], a[8:11], v[60:63]
ds_read_b128 a[176:179], v41 offset:13824
s_waitcnt vmcnt(9)
s_waitcnt lgkmcnt(5)
v_mfma_f32_16x16x32_bf16 v[44:47], a[200:203], a[12:15], v[44:47]
ds_read_b128 a[180:183], v37 offset:18432
s_add_u32 s60, s60, 4096
buffer_load_dwordx4 a[8:11], v1, s[8:11], s60 offen offset:0 sc1
v_mfma_f32_16x16x32_bf16 v[48:51], a[204:207], a[12:15], v[48:51]
ds_read_b128 a[184:187], v37 offset:19456
v_mfma_f32_16x16x32_bf16 v[52:55], a[208:211], a[12:15], v[52:55]
ds_read_b128 a[188:191], v37 offset:20480
v_mfma_f32_16x16x32_bf16 v[56:59], a[212:215], a[12:15], v[56:59]
ds_read_b128 a[192:195], v37 offset:21504
v_mfma_f32_16x16x32_bf16 v[60:63], a[216:219], a[12:15], v[60:63]
ds_read_b128 a[196:199], v41 offset:18432
s_waitcnt vmcnt(9)
s_waitcnt lgkmcnt(5)
v_mfma_f32_16x16x32_bf16 v[44:47], a[160:163], a[16:19], v[44:47]
ds_read_b128 a[200:203], v37 offset:23040
buffer_load_dwordx4 a[12:15], v1, s[8:11], s60 offen offset:1024 sc1
v_mfma_f32_16x16x32_bf16 v[48:51], a[164:167], a[16:19], v[48:51]
ds_read_b128 a[204:207], v37 offset:24064
v_mfma_f32_16x16x32_bf16 v[52:55], a[168:171], a[16:19], v[52:55]
ds_read_b128 a[208:211], v37 offset:25088
v_mfma_f32_16x16x32_bf16 v[56:59], a[172:175], a[16:19], v[56:59]
ds_read_b128 a[212:215], v37 offset:26112
v_mfma_f32_16x16x32_bf16 v[60:63], a[176:179], a[16:19], v[60:63]
ds_read_b128 a[216:219], v41 offset:23040
s_waitcnt vmcnt(9)
s_waitcnt lgkmcnt(5)
v_mfma_f32_16x16x32_bf16 v[44:47], a[180:183], a[20:23], v[44:47]
ds_read_b128 a[160:163], v37 offset:27648
buffer_load_dwordx4 a[16:19], v1, s[8:11], s60 offen offset:2048 sc1
v_mfma_f32_16x16x32_bf16 v[48:51], a[184:187], a[20:23], v[48:51]
ds_read_b128 a[164:167], v37 offset:28672
buffer_load_dwordx4 a[228:231], v1, s[4:7], s64 offen offset:2048 sc1
v_mfma_f32_16x16x32_bf16 v[52:55], a[188:191], a[20:23], v[52:55]
ds_read_b128 a[168:171], v37 offset:29696
v_mfma_f32_16x16x32_bf16 v[56:59], a[192:195], a[20:23], v[56:59]
ds_read_b128 a[172:175], v37 offset:30720
v_mfma_f32_16x16x32_bf16 v[60:63], a[196:199], a[20:23], v[60:63]
ds_read_b128 a[176:179], v41 offset:27648
s_waitcnt vmcnt(10)
s_waitcnt lgkmcnt(5)
v_mfma_f32_16x16x32_bf16 v[44:47], a[200:203], a[24:27], v[44:47]
ds_read_b128 a[180:183], v37 offset:32256
buffer_load_dwordx4 a[20:23], v1, s[8:11], s60 offen offset:3072 sc1
v_mfma_f32_16x16x32_bf16 v[48:51], a[204:207], a[24:27], v[48:51]
ds_read_b128 a[184:187], v37 offset:33280
v_mfma_f32_16x16x32_bf16 v[52:55], a[208:211], a[24:27], v[52:55]
ds_read_b128 a[188:191], v37 offset:34304
v_mfma_f32_16x16x32_bf16 v[56:59], a[212:215], a[24:27], v[56:59]
ds_read_b128 a[192:195], v37 offset:35328
v_mfma_f32_16x16x32_bf16 v[60:63], a[216:219], a[24:27], v[60:63]
ds_read_b128 a[196:199], v41 offset:32256
s_waitcnt vmcnt(10)
s_waitcnt lgkmcnt(5)
v_mfma_f32_16x16x32_bf16 v[44:47], a[160:163], a[28:31], v[44:47]
ds_read_b128 a[200:203], v37 offset:36864
s_add_u32 s60, s60, 4096
buffer_load_dwordx4 a[24:27], v1, s[8:11], s60 offen offset:0 sc1
v_mfma_f32_16x16x32_bf16 v[48:51], a[164:167], a[28:31], v[48:51]
ds_read_b128 a[204:207], v37 offset:37888
v_mfma_f32_16x16x32_bf16 v[52:55], a[168:171], a[28:31], v[52:55]
ds_read_b128 a[208:211], v37 offset:38912
v_mfma_f32_16x16x32_bf16 v[56:59], a[172:175], a[28:31], v[56:59]
ds_read_b128 a[212:215], v37 offset:39936
buffer_load_dwordx4 a[232:235], v1, s[4:7], s64 offen offset:3072 sc1
v_mfma_f32_16x16x32_bf16 v[60:63], a[176:179], a[28:31], v[60:63]
ds_read_b128 a[216:219], v41 offset:36864
s_waitcnt vmcnt(11)
s_waitcnt lgkmcnt(5)
v_mfma_f32_16x16x32_bf16 v[44:47], a[180:183], a[32:35], v[44:47]
ds_read_b128 a[160:163], v37 offset:41472
buffer_load_dwordx4 a[28:31], v1, s[8:11], s60 offen offset:1024 sc1
v_mfma_f32_16x16x32_bf16 v[48:51], a[184:187], a[32:35], v[48:51]
ds_read_b128 a[164:167], v37 offset:42496
v_mfma_f32_16x16x32_bf16 v[52:55], a[188:191], a[32:35], v[52:55]
ds_read_b128 a[168:171], v37 offset:43520
v_mfma_f32_16x16x32_bf16 v[56:59], a[192:195], a[32:35], v[56:59]
ds_read_b128 a[172:175], v37 offset:44544
v_mfma_f32_16x16x32_bf16 v[60:63], a[196:199], a[32:35], v[60:63]
ds_read_b128 a[176:179], v41 offset:41472
s_waitcnt vmcnt(11)
s_waitcnt lgkmcnt(5)
v_mfma_f32_16x16x32_bf16 v[44:47], a[200:203], a[36:39], v[44:47]
ds_read_b128 a[180:183], v37 offset:46080
buffer_load_dwordx4 a[32:35], v1, s[8:11], s60 offen offset:2048 sc1
v_mfma_f32_16x16x32_bf16 v[48:51], a[204:207], a[36:39], v[48:51]
ds_read_b128 a[184:187], v37 offset:47104
v_mfma_f32_16x16x32_bf16 v[52:55], a[208:211], a[36:39], v[52:55]
ds_read_b128 a[188:191], v37 offset:48128
v_mfma_f32_16x16x32_bf16 v[56:59], a[212:215], a[36:39], v[56:59]
ds_read_b128 a[192:195], v37 offset:49152
v_mfma_f32_16x16x32_bf16 v[60:63], a[216:219], a[36:39], v[60:63]
ds_read_b128 a[196:199], v41 offset:46080
s_waitcnt vmcnt(11)
s_waitcnt lgkmcnt(5)
v_mfma_f32_16x16x32_bf16 v[44:47], a[160:163], a[40:43], v[44:47]
ds_read_b128 a[200:203], v37 offset:50688
buffer_load_dwordx4 a[36:39], v1, s[8:11], s60 offen offset:3072 sc1
v_mfma_f32_16x16x32_bf16 v[48:51], a[164:167], a[40:43], v[48:51]
ds_read_b128 a[204:207], v37 offset:51712
v_mfma_f32_16x16x32_bf16 v[52:55], a[168:171], a[40:43], v[52:55]
ds_read_b128 a[208:211], v37 offset:52736
buffer_load_dwordx4 a[236:239], v116, s[4:7], s64 offen sc1
v_mfma_f32_16x16x32_bf16 v[56:59], a[172:175], a[40:43], v[56:59]
ds_read_b128 a[212:215], v37 offset:53760
v_mfma_f32_16x16x32_bf16 v[60:63], a[176:179], a[40:43], v[60:63]
ds_read_b128 a[216:219], v41 offset:50688
s_waitcnt vmcnt(12)
s_waitcnt lgkmcnt(5)
v_mfma_f32_16x16x32_bf16 v[44:47], a[180:183], a[0:3], v[44:47]
ds_read_b128 a[160:163], v38 offset:0
s_add_u32 s60, s60, 4096
buffer_load_dwordx4 a[40:43], v1, s[8:11], s60 offen offset:0 sc1
v_mfma_f32_16x16x32_bf16 v[48:51], a[184:187], a[0:3], v[48:51]
ds_read_b128 a[164:167], v38 offset:1024
v_mfma_f32_16x16x32_bf16 v[52:55], a[188:191], a[0:3], v[52:55]
ds_read_b128 a[168:171], v38 offset:2048
v_mfma_f32_16x16x32_bf16 v[56:59], a[192:195], a[0:3], v[56:59]
ds_read_b128 a[172:175], v38 offset:3072
v_mfma_f32_16x16x32_bf16 v[60:63], a[196:199], a[0:3], v[60:63]
ds_read_b128 a[176:179], v42 offset:0
s_waitcnt vmcnt(12)
s_waitcnt lgkmcnt(5)
v_mfma_f32_16x16x32_bf16 v[44:47], a[200:203], a[4:7], v[44:47]
ds_read_b128 a[180:183], v38 offset:4608
buffer_load_dwordx4 a[0:3], v1, s[8:11], s60 offen offset:1024 sc1
v_mfma_f32_16x16x32_bf16 v[48:51], a[204:207], a[4:7], v[48:51]
ds_read_b128 a[184:187], v38 offset:5632
v_mfma_f32_16x16x32_bf16 v[52:55], a[208:211], a[4:7], v[52:55]
ds_read_b128 a[188:191], v38 offset:6656
v_mfma_f32_16x16x32_bf16 v[56:59], a[212:215], a[4:7], v[56:59]
ds_read_b128 a[192:195], v38 offset:7680
v_mfma_f32_16x16x32_bf16 v[60:63], a[216:219], a[4:7], v[60:63]
ds_read_b128 a[196:199], v42 offset:4608
s_waitcnt vmcnt(12)
s_waitcnt lgkmcnt(5)
v_mfma_f32_16x16x32_bf16 v[44:47], a[160:163], a[8:11], v[44:47]
ds_read_b128 a[200:203], v38 offset:9216
buffer_load_dwordx4 a[4:7], v1, s[8:11], s60 offen offset:2048 sc1
v_mfma_f32_16x16x32_bf16 v[48:51], a[164:167], a[8:11], v[48:51]
ds_read_b128 a[204:207], v38 offset:10240
v_mfma_f32_16x16x32_bf16 v[52:55], a[168:171], a[8:11], v[52:55]
ds_read_b128 a[208:211], v38 offset:11264
v_mfma_f32_16x16x32_bf16 v[56:59], a[172:175], a[8:11], v[56:59]
ds_read_b128 a[212:215], v38 offset:12288
v_mfma_f32_16x16x32_bf16 v[60:63], a[176:179], a[8:11], v[60:63]
ds_read_b128 a[216:219], v42 offset:9216
s_waitcnt vmcnt(12)
s_waitcnt lgkmcnt(5)
v_mfma_f32_16x16x32_bf16 v[44:47], a[180:183], a[12:15], v[44:47]
ds_read_b128 a[160:163], v38 offset:13824
buffer_load_dwordx4 a[8:11], v1, s[8:11], s60 offen offset:3072 sc1
v_mfma_f32_16x16x32_bf16 v[48:51], a[184:187], a[12:15], v[48:51]
ds_read_b128 a[164:167], v38 offset:14848
v_mfma_f32_16x16x32_bf16 v[52:55], a[188:191], a[12:15], v[52:55]
ds_read_b128 a[168:171], v38 offset:15872
v_mfma_f32_16x16x32_bf16 v[56:59], a[192:195], a[12:15], v[56:59]
ds_read_b128 a[172:175], v38 offset:16896
v_mfma_f32_16x16x32_bf16 v[60:63], a[196:199], a[12:15], v[60:63]
ds_read_b128 a[176:179], v42 offset:13824
s_waitcnt vmcnt(12)
s_waitcnt lgkmcnt(5)
v_mfma_f32_16x16x32_bf16 v[44:47], a[200:203], a[16:19], v[44:47]
ds_read_b128 a[180:183], v38 offset:18432
s_mov_b32 s60, s61
buffer_load_dwordx4 a[12:15], v1, s[8:11], s60 offen offset:0 sc1
v_mfma_f32_16x16x32_bf16 v[48:51], a[204:207], a[16:19], v[48:51]
ds_read_b128 a[184:187], v38 offset:19456
v_mfma_f32_16x16x32_bf16 v[52:55], a[208:211], a[16:19], v[52:55]
ds_read_b128 a[188:191], v38 offset:20480
v_mfma_f32_16x16x32_bf16 v[56:59], a[212:215], a[16:19], v[56:59]
ds_read_b128 a[192:195], v38 offset:21504
v_mfma_f32_16x16x32_bf16 v[60:63], a[216:219], a[16:19], v[60:63]
ds_read_b128 a[196:199], v42 offset:18432
s_waitcnt vmcnt(11)
s_waitcnt lgkmcnt(5)
v_mfma_f32_16x16x32_bf16 v[44:47], a[160:163], a[20:23], v[44:47]
ds_read_b128 a[200:203], v38 offset:23040
buffer_load_dwordx4 a[16:19], v1, s[8:11], s60 offen offset:1024 sc1
v_mfma_f32_16x16x32_bf16 v[48:51], a[164:167], a[20:23], v[48:51]
ds_read_b128 a[204:207], v38 offset:24064
v_mfma_f32_16x16x32_bf16 v[52:55], a[168:171], a[20:23], v[52:55]
ds_read_b128 a[208:211], v38 offset:25088
v_mfma_f32_16x16x32_bf16 v[56:59], a[172:175], a[20:23], v[56:59]
ds_read_b128 a[212:215], v38 offset:26112
v_mfma_f32_16x16x32_bf16 v[60:63], a[176:179], a[20:23], v[60:63]
ds_read_b128 a[216:219], v42 offset:23040
s_waitcnt vmcnt(11)
s_waitcnt lgkmcnt(5)
v_mfma_f32_16x16x32_bf16 v[44:47], a[180:183], a[24:27], v[44:47]
ds_read_b128 a[160:163], v38 offset:27648
buffer_load_dwordx4 a[20:23], v1, s[8:11], s60 offen offset:2048 sc1
v_mfma_f32_16x16x32_bf16 v[48:51], a[184:187], a[24:27], v[48:51]
ds_read_b128 a[164:167], v38 offset:28672
v_mfma_f32_16x16x32_bf16 v[52:55], a[188:191], a[24:27], v[52:55]
ds_read_b128 a[168:171], v38 offset:29696
v_mfma_f32_16x16x32_bf16 v[56:59], a[192:195], a[24:27], v[56:59]
ds_read_b128 a[172:175], v38 offset:30720
v_mfma_f32_16x16x32_bf16 v[60:63], a[196:199], a[24:27], v[60:63]
ds_read_b128 a[176:179], v42 offset:27648
s_waitcnt vmcnt(10)
s_waitcnt lgkmcnt(5)
v_mfma_f32_16x16x32_bf16 v[44:47], a[200:203], a[28:31], v[44:47]
ds_read_b128 a[180:183], v38 offset:32256
buffer_load_dwordx4 a[24:27], v1, s[8:11], s60 offen offset:3072 sc1
v_mfma_f32_16x16x32_bf16 v[48:51], a[204:207], a[28:31], v[48:51]
ds_read_b128 a[184:187], v38 offset:33280
v_mfma_f32_16x16x32_bf16 v[52:55], a[208:211], a[28:31], v[52:55]
ds_read_b128 a[188:191], v38 offset:34304
v_mfma_f32_16x16x32_bf16 v[56:59], a[212:215], a[28:31], v[56:59]
ds_read_b128 a[192:195], v38 offset:35328
v_mfma_f32_16x16x32_bf16 v[60:63], a[216:219], a[28:31], v[60:63]
ds_read_b128 a[196:199], v42 offset:32256
s_waitcnt vmcnt(10)
s_waitcnt lgkmcnt(5)
v_mfma_f32_16x16x32_bf16 v[44:47], a[160:163], a[32:35], v[44:47]
ds_read_b128 a[200:203], v38 offset:36864
s_add_u32 s60, s60, 4096
buffer_load_dwordx4 a[28:31], v1, s[8:11], s60 offen offset:0 sc1
v_mfma_f32_16x16x32_bf16 v[48:51], a[164:167], a[32:35], v[48:51]
ds_read_b128 a[204:207], v38 offset:37888
v_mfma_f32_16x16x32_bf16 v[52:55], a[168:171], a[32:35], v[52:55]
ds_read_b128 a[208:211], v38 offset:38912
v_mfma_f32_16x16x32_bf16 v[56:59], a[172:175], a[32:35], v[56:59]
ds_read_b128 a[212:215], v38 offset:39936
v_mfma_f32_16x16x32_bf16 v[60:63], a[176:179], a[32:35], v[60:63]
ds_read_b128 a[216:219], v42 offset:36864
s_waitcnt vmcnt(10)
s_waitcnt lgkmcnt(5)
v_mfma_f32_16x16x32_bf16 v[44:47], a[180:183], a[36:39], v[44:47]
ds_read_b128 a[160:163], v38 offset:41472
buffer_load_dwordx4 a[32:35], v1, s[8:11], s60 offen offset:1024 sc1
v_mfma_f32_16x16x32_bf16 v[48:51], a[184:187], a[36:39], v[48:51]
ds_read_b128 a[164:167], v38 offset:42496
v_mfma_f32_16x16x32_bf16 v[52:55], a[188:191], a[36:39], v[52:55]
ds_read_b128 a[168:171], v38 offset:43520
v_mfma_f32_16x16x32_bf16 v[56:59], a[192:195], a[36:39], v[56:59]
ds_read_b128 a[172:175], v38 offset:44544
v_mfma_f32_16x16x32_bf16 v[60:63], a[196:199], a[36:39], v[60:63]
ds_read_b128 a[176:179], v42 offset:41472
s_waitcnt vmcnt(9)
s_waitcnt lgkmcnt(5)
v_mfma_f32_16x16x32_bf16 v[44:47], a[200:203], a[40:43], v[44:47]
ds_read_b128 a[180:183], v38 offset:46080
buffer_load_dwordx4 a[36:39], v1, s[8:11], s60 offen offset:2048 sc1
v_mfma_f32_16x16x32_bf16 v[48:51], a[204:207], a[40:43], v[48:51]
ds_read_b128 a[184:187], v38 offset:47104
v_mfma_f32_16x16x32_bf16 v[52:55], a[208:211], a[40:43], v[52:55]
ds_read_b128 a[188:191], v38 offset:48128
v_mfma_f32_16x16x32_bf16 v[56:59], a[212:215], a[40:43], v[56:59]
ds_read_b128 a[192:195], v38 offset:49152
v_mfma_f32_16x16x32_bf16 v[60:63], a[216:219], a[40:43], v[60:63]
ds_read_b128 a[196:199], v42 offset:46080
s_waitcnt vmcnt(9)
s_waitcnt lgkmcnt(5)
v_mfma_f32_16x16x32_bf16 v[44:47], a[160:163], a[0:3], v[44:47]
ds_read_b128 a[200:203], v38 offset:50688
buffer_load_dwordx4 a[40:43], v1, s[8:11], s60 offen offset:3072 sc1
v_mfma_f32_16x16x32_bf16 v[48:51], a[164:167], a[0:3], v[48:51]
ds_read_b128 a[204:207], v38 offset:51712
v_mfma_f32_16x16x32_bf16 v[52:55], a[168:171], a[0:3], v[52:55]
v_mfma_f32_16x16x32_bf16 v[56:59], a[172:175], a[0:3], v[56:59]
v_mfma_f32_16x16x32_bf16 v[60:63], a[176:179], a[0:3], v[60:63]
s_waitcnt vmcnt(9)
s_waitcnt lgkmcnt(2)
v_mfma_f32_16x16x32_bf16 v[44:47], a[180:183], a[4:7], v[44:47]
ds_read_b128 a[160:163], v36 offset:0
s_add_u32 s60, s60, 4096
buffer_load_dwordx4 a[0:3], v1, s[8:11], s60 offen offset:0 sc1
v_mfma_f32_16x16x32_bf16 v[48:51], a[184:187], a[4:7], v[48:51]
ds_read_b128 a[164:167], v36 offset:1024
v_mfma_f32_16x16x32_bf16 v[52:55], a[188:191], a[4:7], v[52:55]
ds_read_b128 a[168:171], v36 offset:2048
v_mfma_f32_16x16x32_bf16 v[56:59], a[192:195], a[4:7], v[56:59]
ds_read_b128 a[172:175], v36 offset:3072
v_mfma_f32_16x16x32_bf16 v[60:63], a[196:199], a[4:7], v[60:63]
ds_read_b128 a[176:179], v40 offset:0
s_waitcnt vmcnt(9)
s_waitcnt lgkmcnt(5)
v_mfma_f32_16x16x32_bf16 v[44:47], a[200:203], a[8:11], v[44:47]
ds_read_b128 a[180:183], v36 offset:4608
buffer_load_dwordx4 a[4:7], v1, s[8:11], s60 offen offset:1024 sc1
v_mfma_f32_16x16x32_bf16 v[48:51], a[204:207], a[8:11], v[48:51]
ds_read_b128 a[184:187], v36 offset:5632
v_mfma_f32_16x16x32_bf16 v[52:55], a[228:231], a[8:11], v[52:55]
ds_read_b128 a[188:191], v36 offset:6656
v_mfma_f32_16x16x32_bf16 v[56:59], a[232:235], a[8:11], v[56:59]
ds_read_b128 a[192:195], v36 offset:7680
v_mfma_f32_16x16x32_bf16 v[60:63], a[236:239], a[8:11], v[60:63]
ds_read_b128 a[196:199], v40 offset:4608
s_waitcnt vmcnt(9)
s_waitcnt lgkmcnt(5)
v_mfma_f32_16x16x32_bf16 v[16:19], a[160:163], a[12:15], v[16:19]
ds_read_b128 a[200:203], v36 offset:9216
buffer_load_dwordx4 a[8:11], v1, s[8:11], s60 offen offset:2048 sc1
v_mfma_f32_16x16x32_bf16 v[20:23], a[164:167], a[12:15], v[20:23]
ds_read_b128 a[204:207], v36 offset:10240
v_mfma_f32_16x16x32_bf16 v[24:27], a[168:171], a[12:15], v[24:27]
ds_read_b128 a[208:211], v36 offset:11264
v_mfma_f32_16x16x32_bf16 v[28:31], a[172:175], a[12:15], v[28:31]
ds_read_b128 a[212:215], v36 offset:12288
v_mfma_f32_16x16x32_bf16 v[32:35], a[176:179], a[12:15], v[32:35]
ds_read_b128 a[216:219], v40 offset:9216
s_waitcnt vmcnt(9)
s_waitcnt lgkmcnt(5)
v_mfma_f32_16x16x32_bf16 v[16:19], a[180:183], a[16:19], v[16:19]
ds_read_b128 a[160:163], v36 offset:13824
buffer_load_dwordx4 a[12:15], v1, s[8:11], s60 offen offset:3072 sc1
v_mfma_f32_16x16x32_bf16 v[20:23], a[184:187], a[16:19], v[20:23]
ds_read_b128 a[164:167], v36 offset:14848
v_mfma_f32_16x16x32_bf16 v[24:27], a[188:191], a[16:19], v[24:27]
ds_read_b128 a[168:171], v36 offset:15872
v_mfma_f32_16x16x32_bf16 v[28:31], a[192:195], a[16:19], v[28:31]
ds_read_b128 a[172:175], v36 offset:16896
v_cvt_pk_bf16_f32 v64, v44, v45
v_mfma_f32_16x16x32_bf16 v[32:35], a[196:199], a[16:19], v[32:35]
ds_read_b128 a[176:179], v40 offset:13824
s_waitcnt vmcnt(9)
s_waitcnt lgkmcnt(5)
v_mfma_f32_16x16x32_bf16 v[16:19], a[200:203], a[20:23], v[16:19]
ds_read_b128 a[180:183], v36 offset:18432
s_add_u32 s60, s60, 4096
buffer_load_dwordx4 a[16:19], v1, s[8:11], s60 offen offset:0 sc1
v_mfma_f32_16x16x32_bf16 v[20:23], a[204:207], a[20:23], v[20:23]
ds_read_b128 a[184:187], v36 offset:19456
v_cvt_pk_bf16_f32 v65, v46, v47
v_mfma_f32_16x16x32_bf16 v[24:27], a[208:211], a[20:23], v[24:27]
ds_read_b128 a[188:191], v36 offset:20480
v_mfma_f32_16x16x32_bf16 v[28:31], a[212:215], a[20:23], v[28:31]
ds_read_b128 a[192:195], v36 offset:21504
v_mfma_f32_16x16x32_bf16 v[32:35], a[216:219], a[20:23], v[32:35]
ds_read_b128 a[196:199], v40 offset:18432
s_waitcnt vmcnt(9)
s_waitcnt lgkmcnt(5)
v_mfma_f32_16x16x32_bf16 v[16:19], a[160:163], a[24:27], v[16:19]
ds_read_b128 a[200:203], v36 offset:23040
buffer_load_dwordx4 a[20:23], v1, s[8:11], s60 offen offset:1024 sc1
v_mfma_f32_16x16x32_bf16 v[20:23], a[164:167], a[24:27], v[20:23]
ds_read_b128 a[204:207], v36 offset:24064
v_cvt_pk_bf16_f32 v66, v48, v49
v_mfma_f32_16x16x32_bf16 v[24:27], a[168:171], a[24:27], v[24:27]
ds_read_b128 a[208:211], v36 offset:25088
buffer_store_dwordx4 v[64:67], v1, s[8:11], s62 offen offset:0 sc1
v_mfma_f32_16x16x32_bf16 v[28:31], a[172:175], a[24:27], v[28:31]
ds_read_b128 a[212:215], v36 offset:26112
v_mfma_f32_16x16x32_bf16 v[32:35], a[176:179], a[24:27], v[32:35]
ds_read_b128 a[216:219], v40 offset:23040
s_waitcnt vmcnt(10)
s_waitcnt lgkmcnt(5)
v_mfma_f32_16x16x32_bf16 v[16:19], a[180:183], a[28:31], v[16:19]
ds_read_b128 a[160:163], v36 offset:27648
buffer_load_dwordx4 a[24:27], v1, s[8:11], s60 offen offset:2048 sc1
v_mfma_f32_16x16x32_bf16 v[20:23], a[184:187], a[28:31], v[20:23]
ds_read_b128 a[164:167], v36 offset:28672
v_cvt_pk_bf16_f32 v68, v50, v51
v_mfma_f32_16x16x32_bf16 v[24:27], a[188:191], a[28:31], v[24:27]
ds_read_b128 a[168:171], v36 offset:29696
v_mfma_f32_16x16x32_bf16 v[28:31], a[192:195], a[28:31], v[28:31]
ds_read_b128 a[172:175], v36 offset:30720
v_cvt_pk_bf16_f32 v69, v52, v53
v_mfma_f32_16x16x32_bf16 v[32:35], a[196:199], a[28:31], v[32:35]
ds_read_b128 a[176:179], v40 offset:27648
s_waitcnt vmcnt(10)
s_waitcnt lgkmcnt(5)
v_mfma_f32_16x16x32_bf16 v[16:19], a[200:203], a[32:35], v[16:19]
ds_read_b128 a[180:183], v36 offset:32256
buffer_load_dwordx4 a[28:31], v1, s[8:11], s60 offen offset:3072 sc1
v_mfma_f32_16x16x32_bf16 v[20:23], a[204:207], a[32:35], v[20:23]
ds_read_b128 a[184:187], v36 offset:33280
v_cvt_pk_bf16_f32 v70, v54, v55
v_mfma_f32_16x16x32_bf16 v[24:27], a[208:211], a[32:35], v[24:27]
ds_read_b128 a[188:191], v36 offset:34304
v_mfma_f32_16x16x32_bf16 v[28:31], a[212:215], a[32:35], v[28:31]
ds_read_b128 a[192:195], v36 offset:35328
v_mfma_f32_16x16x32_bf16 v[32:35], a[216:219], a[32:35], v[32:35]
ds_read_b128 a[196:199], v40 offset:32256
s_waitcnt vmcnt(10)
s_waitcnt lgkmcnt(5)
v_mfma_f32_16x16x32_bf16 v[16:19], a[160:163], a[36:39], v[16:19]
ds_read_b128 a[200:203], v36 offset:36864
s_add_u32 s60, s60, 4096
buffer_load_dwordx4 a[32:35], v1, s[8:11], s60 offen offset:0 sc1
v_mfma_f32_16x16x32_bf16 v[20:23], a[164:167], a[36:39], v[20:23]
ds_read_b128 a[204:207], v36 offset:37888
buffer_store_dwordx4 v[68:71], v1, s[8:11], s62 offen offset:1024 sc1
v_mfma_f32_16x16x32_bf16 v[24:27], a[168:171], a[36:39], v[24:27]
ds_read_b128 a[208:211], v36 offset:38912
v_cvt_pk_bf16_f32 v72, v56, v57
v_mfma_f32_16x16x32_bf16 v[28:31], a[172:175], a[36:39], v[28:31]
ds_read_b128 a[212:215], v36 offset:39936
v_mfma_f32_16x16x32_bf16 v[32:35], a[176:179], a[36:39], v[32:35]
ds_read_b128 a[216:219], v40 offset:36864
s_waitcnt vmcnt(11)
s_waitcnt lgkmcnt(5)
v_mfma_f32_16x16x32_bf16 v[16:19], a[180:183], a[40:43], v[16:19]
ds_read_b128 a[160:163], v36 offset:41472
buffer_load_dwordx4 a[36:39], v1, s[8:11], s60 offen offset:1024 sc1
v_mfma_f32_16x16x32_bf16 v[20:23], a[184:187], a[40:43], v[20:23]
ds_read_b128 a[164:167], v36 offset:42496
v_cvt_pk_bf16_f32 v73, v58, v59
v_mfma_f32_16x16x32_bf16 v[24:27], a[188:191], a[40:43], v[24:27]
ds_read_b128 a[168:171], v36 offset:43520
v_mfma_f32_16x16x32_bf16 v[28:31], a[192:195], a[40:43], v[28:31]
ds_read_b128 a[172:175], v36 offset:44544
v_cvt_pk_bf16_f32 v74, v60, v61
v_mfma_f32_16x16x32_bf16 v[32:35], a[196:199], a[40:43], v[32:35]
ds_read_b128 a[176:179], v40 offset:41472
s_waitcnt vmcnt(11)
s_waitcnt lgkmcnt(5)
v_mfma_f32_16x16x32_bf16 v[16:19], a[200:203], a[0:3], v[16:19]
ds_read_b128 a[180:183], v36 offset:46080
buffer_load_dwordx4 a[40:43], v1, s[8:11], s60 offen offset:2048 sc1
v_mfma_f32_16x16x32_bf16 v[20:23], a[204:207], a[0:3], v[20:23]
ds_read_b128 a[184:187], v36 offset:47104
buffer_store_dwordx4 v[72:75], v1, s[8:11], s62 offen offset:2048 sc1
v_mfma_f32_16x16x32_bf16 v[24:27], a[208:211], a[0:3], v[24:27]
ds_read_b128 a[188:191], v36 offset:48128
v_mfma_f32_16x16x32_bf16 v[28:31], a[212:215], a[0:3], v[28:31]
ds_read_b128 a[192:195], v36 offset:49152
v_mfma_f32_16x16x32_bf16 v[32:35], a[216:219], a[0:3], v[32:35]
ds_read_b128 a[196:199], v40 offset:46080
s_waitcnt vmcnt(12)
s_waitcnt lgkmcnt(5)
v_mfma_f32_16x16x32_bf16 v[16:19], a[160:163], a[4:7], v[16:19]
ds_read_b128 a[200:203], v36 offset:50688
buffer_load_dwordx4 a[0:3], v1, s[8:11], s60 offen offset:3072 sc1
v_mfma_f32_16x16x32_bf16 v[20:23], a[164:167], a[4:7], v[20:23]
ds_read_b128 a[204:207], v36 offset:51712
v_cvt_pk_bf16_f32 v76, v62, v63
v_mfma_f32_16x16x32_bf16 v[24:27], a[168:171], a[4:7], v[24:27]
ds_read_b128 a[208:211], v36 offset:52736
buffer_store_dwordx4 v[76:79], v1, s[8:11], s62 offen offset:3072 sc1
v_mfma_f32_16x16x32_bf16 v[28:31], a[172:175], a[4:7], v[28:31]
ds_read_b128 a[212:215], v36 offset:53760
v_mfma_f32_16x16x32_bf16 v[32:35], a[176:179], a[4:7], v[32:35]
ds_read_b128 a[216:219], v40 offset:50688
s_waitcnt vmcnt(13)
s_waitcnt lgkmcnt(5)
v_mfma_f32_16x16x32_bf16 v[16:19], a[180:183], a[8:11], v[16:19]
ds_read_b128 a[160:163], v37 offset:0
s_add_u32 s60, s60, 4096
buffer_load_dwordx4 a[4:7], v1, s[8:11], s60 offen offset:0 sc1
v_mfma_f32_16x16x32_bf16 v[20:23], a[184:187], a[8:11], v[20:23]
ds_read_b128 a[164:167], v37 offset:1024
v_mfma_f32_16x16x32_bf16 v[24:27], a[188:191], a[8:11], v[24:27]
ds_read_b128 a[168:171], v37 offset:2048
v_mfma_f32_16x16x32_bf16 v[28:31], a[192:195], a[8:11], v[28:31]
ds_read_b128 a[172:175], v37 offset:3072
v_mfma_f32_16x16x32_bf16 v[32:35], a[196:199], a[8:11], v[32:35]
ds_read_b128 a[176:179], v41 offset:0
s_waitcnt vmcnt(13)
s_waitcnt lgkmcnt(5)
v_mfma_f32_16x16x32_bf16 v[16:19], a[200:203], a[12:15], v[16:19]
ds_read_b128 a[180:183], v37 offset:4608
buffer_load_dwordx4 a[8:11], v1, s[8:11], s60 offen offset:1024 sc1
v_mfma_f32_16x16x32_bf16 v[20:23], a[204:207], a[12:15], v[20:23]
ds_read_b128 a[184:187], v37 offset:5632
v_mfma_f32_16x16x32_bf16 v[24:27], a[208:211], a[12:15], v[24:27]
ds_read_b128 a[188:191], v37 offset:6656
v_mfma_f32_16x16x32_bf16 v[28:31], a[212:215], a[12:15], v[28:31]
ds_read_b128 a[192:195], v37 offset:7680
v_mfma_f32_16x16x32_bf16 v[32:35], a[216:219], a[12:15], v[32:35]
ds_read_b128 a[196:199], v41 offset:4608
s_waitcnt vmcnt(13)
s_waitcnt lgkmcnt(5)
v_mfma_f32_16x16x32_bf16 v[16:19], a[160:163], a[16:19], v[16:19]
ds_read_b128 a[200:203], v37 offset:9216
buffer_load_dwordx4 a[12:15], v1, s[8:11], s60 offen offset:2048 sc1
v_mfma_f32_16x16x32_bf16 v[20:23], a[164:167], a[16:19], v[20:23]
ds_read_b128 a[204:207], v37 offset:10240
v_mfma_f32_16x16x32_bf16 v[24:27], a[168:171], a[16:19], v[24:27]
ds_read_b128 a[208:211], v37 offset:11264
v_mfma_f32_16x16x32_bf16 v[28:31], a[172:175], a[16:19], v[28:31]
ds_read_b128 a[212:215], v37 offset:12288
v_mfma_f32_16x16x32_bf16 v[32:35], a[176:179], a[16:19], v[32:35]
ds_read_b128 a[216:219], v41 offset:9216
s_waitcnt vmcnt(13)
s_waitcnt lgkmcnt(5)
v_mfma_f32_16x16x32_bf16 v[16:19], a[180:183], a[20:23], v[16:19]
ds_read_b128 a[160:163], v37 offset:13824
buffer_load_dwordx4 a[16:19], v1, s[8:11], s60 offen offset:3072 sc1
v_mfma_f32_16x16x32_bf16 v[20:23], a[184:187], a[20:23], v[20:23]
ds_read_b128 a[164:167], v37 offset:14848
v_mfma_f32_16x16x32_bf16 v[24:27], a[188:191], a[20:23], v[24:27]
ds_read_b128 a[168:171], v37 offset:15872
v_mfma_f32_16x16x32_bf16 v[28:31], a[192:195], a[20:23], v[28:31]
ds_read_b128 a[172:175], v37 offset:16896
v_mfma_f32_16x16x32_bf16 v[32:35], a[196:199], a[20:23], v[32:35]
ds_read_b128 a[176:179], v41 offset:13824
s_waitcnt vmcnt(12)
s_waitcnt lgkmcnt(5)
v_mfma_f32_16x16x32_bf16 v[16:19], a[200:203], a[24:27], v[16:19]
ds_read_b128 a[180:183], v37 offset:18432
s_add_u32 s60, s60, 4096
buffer_load_dwordx4 a[20:23], v1, s[8:11], s60 offen offset:0 sc1
v_mfma_f32_16x16x32_bf16 v[20:23], a[204:207], a[24:27], v[20:23]
ds_read_b128 a[184:187], v37 offset:19456
v_mfma_f32_16x16x32_bf16 v[24:27], a[208:211], a[24:27], v[24:27]
ds_read_b128 a[188:191], v37 offset:20480
v_mfma_f32_16x16x32_bf16 v[28:31], a[212:215], a[24:27], v[28:31]
ds_read_b128 a[192:195], v37 offset:21504
v_mfma_f32_16x16x32_bf16 v[32:35], a[216:219], a[24:27], v[32:35]
ds_read_b128 a[196:199], v41 offset:18432
s_waitcnt vmcnt(12)
s_waitcnt lgkmcnt(5)
v_mfma_f32_16x16x32_bf16 v[16:19], a[160:163], a[28:31], v[16:19]
ds_read_b128 a[200:203], v37 offset:23040
buffer_load_dwordx4 a[24:27], v1, s[8:11], s60 offen offset:1024 sc1
v_mfma_f32_16x16x32_bf16 v[20:23], a[164:167], a[28:31], v[20:23]
ds_read_b128 a[204:207], v37 offset:24064
v_mfma_f32_16x16x32_bf16 v[24:27], a[168:171], a[28:31], v[24:27]
ds_read_b128 a[208:211], v37 offset:25088
v_mfma_f32_16x16x32_bf16 v[28:31], a[172:175], a[28:31], v[28:31]
ds_read_b128 a[212:215], v37 offset:26112
v_mfma_f32_16x16x32_bf16 v[32:35], a[176:179], a[28:31], v[32:35]
ds_read_b128 a[216:219], v41 offset:23040
s_waitcnt vmcnt(12)
s_waitcnt lgkmcnt(5)
v_mfma_f32_16x16x32_bf16 v[16:19], a[180:183], a[32:35], v[16:19]
ds_read_b128 a[160:163], v37 offset:27648
buffer_load_dwordx4 a[28:31], v1, s[8:11], s60 offen offset:2048 sc1
v_mfma_f32_16x16x32_bf16 v[20:23], a[184:187], a[32:35], v[20:23]
ds_read_b128 a[164:167], v37 offset:28672
v_mfma_f32_16x16x32_bf16 v[24:27], a[188:191], a[32:35], v[24:27]
ds_read_b128 a[168:171], v37 offset:29696
v_mfma_f32_16x16x32_bf16 v[28:31], a[192:195], a[32:35], v[28:31]
ds_read_b128 a[172:175], v37 offset:30720
v_mfma_f32_16x16x32_bf16 v[32:35], a[196:199], a[32:35], v[32:35]
ds_read_b128 a[176:179], v41 offset:27648
s_waitcnt vmcnt(11)
s_waitcnt lgkmcnt(5)
v_mfma_f32_16x16x32_bf16 v[16:19], a[200:203], a[36:39], v[16:19]
ds_read_b128 a[180:183], v37 offset:32256
buffer_load_dwordx4 a[32:35], v1, s[8:11], s60 offen offset:3072 sc1
v_mfma_f32_16x16x32_bf16 v[20:23], a[204:207], a[36:39], v[20:23]
ds_read_b128 a[184:187], v37 offset:33280
v_mfma_f32_16x16x32_bf16 v[24:27], a[208:211], a[36:39], v[24:27]
ds_read_b128 a[188:191], v37 offset:34304
v_mfma_f32_16x16x32_bf16 v[28:31], a[212:215], a[36:39], v[28:31]
ds_read_b128 a[192:195], v37 offset:35328
v_mfma_f32_16x16x32_bf16 v[32:35], a[216:219], a[36:39], v[32:35]
ds_read_b128 a[196:199], v41 offset:32256
s_waitcnt vmcnt(11)
s_waitcnt lgkmcnt(5)
v_mfma_f32_16x16x32_bf16 v[16:19], a[160:163], a[40:43], v[16:19]
ds_read_b128 a[200:203], v37 offset:36864
s_add_u32 s60, s60, 4096
buffer_load_dwordx4 a[36:39], v1, s[8:11], s60 offen offset:0 sc1
v_mfma_f32_16x16x32_bf16 v[20:23], a[164:167], a[40:43], v[20:23]
ds_read_b128 a[204:207], v37 offset:37888
v_mfma_f32_16x16x32_bf16 v[24:27], a[168:171], a[40:43], v[24:27]
ds_read_b128 a[208:211], v37 offset:38912
v_mfma_f32_16x16x32_bf16 v[28:31], a[172:175], a[40:43], v[28:31]
ds_read_b128 a[212:215], v37 offset:39936
v_mfma_f32_16x16x32_bf16 v[32:35], a[176:179], a[40:43], v[32:35]
ds_read_b128 a[216:219], v41 offset:36864
s_waitcnt vmcnt(10)
s_waitcnt lgkmcnt(5)
v_mfma_f32_16x16x32_bf16 v[16:19], a[180:183], a[0:3], v[16:19]
ds_read_b128 a[160:163], v37 offset:41472
buffer_load_dwordx4 a[40:43], v1, s[8:11], s60 offen offset:1024 sc1
v_mfma_f32_16x16x32_bf16 v[20:23], a[184:187], a[0:3], v[20:23]
ds_read_b128 a[164:167], v37 offset:42496
v_mfma_f32_16x16x32_bf16 v[24:27], a[188:191], a[0:3], v[24:27]
ds_read_b128 a[168:171], v37 offset:43520
v_mfma_f32_16x16x32_bf16 v[28:31], a[192:195], a[0:3], v[28:31]
ds_read_b128 a[172:175], v37 offset:44544
v_mfma_f32_16x16x32_bf16 v[32:35], a[196:199], a[0:3], v[32:35]
ds_read_b128 a[176:179], v41 offset:41472
s_waitcnt vmcnt(9)
s_waitcnt lgkmcnt(5)
v_mfma_f32_16x16x32_bf16 v[16:19], a[200:203], a[4:7], v[16:19]
ds_read_b128 a[180:183], v37 offset:46080
buffer_load_dwordx4 a[0:3], v1, s[8:11], s60 offen offset:2048 sc1
v_mfma_f32_16x16x32_bf16 v[20:23], a[204:207], a[4:7], v[20:23]
ds_read_b128 a[184:187], v37 offset:47104
buffer_load_dwordx4 v[80:83], v1, s[8:11], s63 offen offset:0 sc1
v_mfma_f32_16x16x32_bf16 v[24:27], a[208:211], a[4:7], v[24:27]
ds_read_b128 a[188:191], v37 offset:48128
v_mfma_f32_16x16x32_bf16 v[28:31], a[212:215], a[4:7], v[28:31]
ds_read_b128 a[192:195], v37 offset:49152
v_mfma_f32_16x16x32_bf16 v[32:35], a[216:219], a[4:7], v[32:35]
ds_read_b128 a[196:199], v41 offset:46080
s_waitcnt vmcnt(10)
s_waitcnt lgkmcnt(5)
v_mfma_f32_16x16x32_bf16 v[16:19], a[160:163], a[8:11], v[16:19]
ds_read_b128 a[200:203], v37 offset:50688
buffer_load_dwordx4 a[4:7], v1, s[8:11], s60 offen offset:3072 sc1
v_mfma_f32_16x16x32_bf16 v[20:23], a[164:167], a[8:11], v[20:23]
ds_read_b128 a[204:207], v37 offset:51712
buffer_load_dwordx4 v[84:87], v1, s[8:11], s63 offen offset:1024 sc1
v_mfma_f32_16x16x32_bf16 v[24:27], a[168:171], a[8:11], v[24:27]
ds_read_b128 a[208:211], v37 offset:52736
v_mfma_f32_16x16x32_bf16 v[28:31], a[172:175], a[8:11], v[28:31]
ds_read_b128 a[212:215], v37 offset:53760
v_mfma_f32_16x16x32_bf16 v[32:35], a[176:179], a[8:11], v[32:35]
ds_read_b128 a[216:219], v41 offset:50688
s_waitcnt vmcnt(11)
s_waitcnt lgkmcnt(5)
v_mfma_f32_16x16x32_bf16 v[16:19], a[180:183], a[12:15], v[16:19]
ds_read_b128 a[160:163], v38 offset:0
s_add_u32 s60, s60, 4096
buffer_load_dwordx4 a[8:11], v1, s[8:11], s60 offen offset:0 sc1
v_mfma_f32_16x16x32_bf16 v[20:23], a[184:187], a[12:15], v[20:23]
ds_read_b128 a[164:167], v38 offset:1024
buffer_load_dwordx4 v[88:91], v1, s[8:11], s63 offen offset:2048 sc1
v_mfma_f32_16x16x32_bf16 v[24:27], a[188:191], a[12:15], v[24:27]
ds_read_b128 a[168:171], v38 offset:2048
v_mfma_f32_16x16x32_bf16 v[28:31], a[192:195], a[12:15], v[28:31]
ds_read_b128 a[172:175], v38 offset:3072
v_mfma_f32_16x16x32_bf16 v[32:35], a[196:199], a[12:15], v[32:35]
ds_read_b128 a[176:179], v42 offset:0
s_waitcnt vmcnt(12)
s_waitcnt lgkmcnt(5)
v_mfma_f32_16x16x32_bf16 v[16:19], a[200:203], a[16:19], v[16:19]
ds_read_b128 a[180:183], v38 offset:4608
buffer_load_dwordx4 a[12:15], v1, s[8:11], s60 offen offset:1024 sc1
v_mfma_f32_16x16x32_bf16 v[20:23], a[204:207], a[16:19], v[20:23]
ds_read_b128 a[184:187], v38 offset:5632
buffer_load_dwordx4 v[92:95], v1, s[8:11], s63 offen offset:3072 sc1
v_mfma_f32_16x16x32_bf16 v[24:27], a[208:211], a[16:19], v[24:27]
ds_read_b128 a[188:191], v38 offset:6656
v_mfma_f32_16x16x32_bf16 v[28:31], a[212:215], a[16:19], v[28:31]
ds_read_b128 a[192:195], v38 offset:7680
v_mfma_f32_16x16x32_bf16 v[32:35], a[216:219], a[16:19], v[32:35]
ds_read_b128 a[196:199], v42 offset:4608
s_waitcnt vmcnt(13)
s_waitcnt lgkmcnt(5)
v_mfma_f32_16x16x32_bf16 v[16:19], a[160:163], a[20:23], v[16:19]
ds_read_b128 a[200:203], v38 offset:9216
buffer_load_dwordx4 a[16:19], v1, s[8:11], s60 offen offset:2048 sc1
v_mfma_f32_16x16x32_bf16 v[20:23], a[164:167], a[20:23], v[20:23]
ds_read_b128 a[204:207], v38 offset:10240
v_mfma_f32_16x16x32_bf16 v[24:27], a[168:171], a[20:23], v[24:27]
ds_read_b128 a[208:211], v38 offset:11264
v_mfma_f32_16x16x32_bf16 v[28:31], a[172:175], a[20:23], v[28:31]
ds_read_b128 a[212:215], v38 offset:12288
v_mfma_f32_16x16x32_bf16 v[32:35], a[176:179], a[20:23], v[32:35]
ds_read_b128 a[216:219], v42 offset:9216
s_waitcnt vmcnt(13)
s_waitcnt lgkmcnt(5)
v_mfma_f32_16x16x32_bf16 v[16:19], a[180:183], a[24:27], v[16:19]
ds_read_b128 a[160:163], v38 offset:13824
buffer_load_dwordx4 a[20:23], v1, s[8:11], s60 offen offset:3072 sc1
v_mfma_f32_16x16x32_bf16 v[20:23], a[184:187], a[24:27], v[20:23]
ds_read_b128 a[164:167], v38 offset:14848
v_mfma_f32_16x16x32_bf16 v[24:27], a[188:191], a[24:27], v[24:27]
ds_read_b128 a[168:171], v38 offset:15872
v_mfma_f32_16x16x32_bf16 v[28:31], a[192:195], a[24:27], v[28:31]
ds_read_b128 a[172:175], v38 offset:16896
v_mfma_f32_16x16x32_bf16 v[32:35], a[196:199], a[24:27], v[32:35]
ds_read_b128 a[176:179], v42 offset:13824
s_waitcnt vmcnt(13)
s_waitcnt lgkmcnt(5)
v_mfma_f32_16x16x32_bf16 v[16:19], a[200:203], a[28:31], v[16:19]
ds_read_b128 a[180:183], v38 offset:18432
v_mfma_f32_16x16x32_bf16 v[20:23], a[204:207], a[28:31], v[20:23]
ds_read_b128 a[184:187], v38 offset:19456
v_mfma_f32_16x16x32_bf16 v[24:27], a[208:211], a[28:31], v[24:27]
ds_read_b128 a[188:191], v38 offset:20480
v_mfma_f32_16x16x32_bf16 v[28:31], a[212:215], a[28:31], v[28:31]
ds_read_b128 a[192:195], v38 offset:21504
v_mfma_f32_16x16x32_bf16 v[32:35], a[216:219], a[28:31], v[32:35]
ds_read_b128 a[196:199], v42 offset:18432
s_waitcnt vmcnt(12)
s_waitcnt lgkmcnt(5)
v_mfma_f32_16x16x32_bf16 v[16:19], a[160:163], a[32:35], v[16:19]
ds_read_b128 a[200:203], v38 offset:23040
v_mfma_f32_16x16x32_bf16 v[20:23], a[164:167], a[32:35], v[20:23]
ds_read_b128 a[204:207], v38 offset:24064
v_mfma_f32_16x16x32_bf16 v[24:27], a[168:171], a[32:35], v[24:27]
ds_read_b128 a[208:211], v38 offset:25088
v_mfma_f32_16x16x32_bf16 v[28:31], a[172:175], a[32:35], v[28:31]
ds_read_b128 a[212:215], v38 offset:26112
v_mfma_f32_16x16x32_bf16 v[32:35], a[176:179], a[32:35], v[32:35]
ds_read_b128 a[216:219], v42 offset:23040
s_waitcnt vmcnt(11)
s_waitcnt lgkmcnt(5)
v_mfma_f32_16x16x32_bf16 v[16:19], a[180:183], a[36:39], v[16:19]
ds_read_b128 a[160:163], v38 offset:27648
v_mfma_f32_16x16x32_bf16 v[20:23], a[184:187], a[36:39], v[20:23]
ds_read_b128 a[164:167], v38 offset:28672
v_mfma_f32_16x16x32_bf16 v[24:27], a[188:191], a[36:39], v[24:27]
ds_read_b128 a[168:171], v38 offset:29696
v_mfma_f32_16x16x32_bf16 v[28:31], a[192:195], a[36:39], v[28:31]
ds_read_b128 a[172:175], v38 offset:30720
v_mfma_f32_16x16x32_bf16 v[32:35], a[196:199], a[36:39], v[32:35]
ds_read_b128 a[176:179], v42 offset:27648
s_waitcnt vmcnt(10)
s_waitcnt lgkmcnt(5)
v_mfma_f32_16x16x32_bf16 v[16:19], a[200:203], a[40:43], v[16:19]
ds_read_b128 a[180:183], v38 offset:32256
s_waitcnt vmcnt(2)
v_mfma_f32_16x16x32_bf16 v[20:23], a[204:207], a[40:43], v[20:23]
ds_read_b128 a[184:187], v38 offset:33280
v_xor_b32 v118, v248, v83
v_mfma_f32_16x16x32_bf16 v[24:27], a[208:211], a[40:43], v[24:27]
ds_read_b128 a[188:191], v38 offset:34304
v_xor_b32 v119, v248, v87
v_mfma_f32_16x16x32_bf16 v[28:31], a[212:215], a[40:43], v[28:31]
ds_read_b128 a[192:195], v38 offset:35328
v_xor_b32 v120, v248, v91
v_mfma_f32_16x16x32_bf16 v[32:35], a[216:219], a[40:43], v[32:35]
ds_read_b128 a[196:199], v42 offset:32256
s_waitcnt lgkmcnt(5)
v_mfma_f32_16x16x32_bf16 v[16:19], a[160:163], a[0:3], v[16:19]
ds_read_b128 a[200:203], v38 offset:36864
v_xor_b32 v121, v248, v95
v_mfma_f32_16x16x32_bf16 v[20:23], a[164:167], a[0:3], v[20:23]
ds_read_b128 a[204:207], v38 offset:37888
v_or3_b32 v118, v118, v119, v120
v_mfma_f32_16x16x32_bf16 v[24:27], a[168:171], a[0:3], v[24:27]
ds_read_b128 a[208:211], v38 offset:38912
v_or_b32 v118, v118, v121
v_mfma_f32_16x16x32_bf16 v[28:31], a[172:175], a[0:3], v[28:31]
ds_read_b128 a[212:215], v38 offset:39936
v_cmp_ne_u32 vcc, 0, v118
v_mfma_f32_16x16x32_bf16 v[32:35], a[176:179], a[0:3], v[32:35]
ds_read_b128 a[216:219], v42 offset:36864
s_waitcnt lgkmcnt(5)
v_mfma_f32_16x16x32_bf16 v[16:19], a[180:183], a[4:7], v[16:19]
ds_read_b128 a[160:163], v38 offset:41472
v_mfma_f32_16x16x32_bf16 v[20:23], a[184:187], a[4:7], v[20:23]
ds_read_b128 a[164:167], v38 offset:42496
s_nop 0
s_cbranch_vccnz L_xslow_35
L_xback_36:
v_mfma_f32_16x16x32_bf16 v[24:27], a[188:191], a[4:7], v[24:27]
ds_read_b128 a[168:171], v38 offset:43520
v_lshlrev_b32 v96, 16, v80
v_mfma_f32_16x16x32_bf16 v[28:31], a[192:195], a[4:7], v[28:31]
ds_read_b128 a[172:175], v38 offset:44544
v_and_b32 v97, 0xffff0000, v80
v_mfma_f32_16x16x32_bf16 v[32:35], a[196:199], a[4:7], v[32:35]
ds_read_b128 a[176:179], v42 offset:41472
s_waitcnt lgkmcnt(5)
v_mfma_f32_16x16x32_bf16 v[16:19], a[200:203], a[8:11], v[16:19]
ds_read_b128 a[180:183], v38 offset:46080
v_lshlrev_b32 v98, 16, v81
v_mfma_f32_16x16x32_bf16 v[20:23], a[204:207], a[8:11], v[20:23]
ds_read_b128 a[184:187], v38 offset:47104
v_and_b32 v99, 0xffff0000, v81
v_mfma_f32_16x16x32_bf16 v[24:27], a[208:211], a[8:11], v[24:27]
ds_read_b128 a[188:191], v38 offset:48128
v_lshlrev_b32 v100, 16, v82
v_mfma_f32_16x16x32_bf16 v[28:31], a[212:215], a[8:11], v[28:31]
ds_read_b128 a[192:195], v38 offset:49152
v_and_b32 v101, 0xffff0000, v82
v_mfma_f32_16x16x32_bf16 v[32:35], a[216:219], a[8:11], v[32:35]
ds_read_b128 a[196:199], v42 offset:46080
s_waitcnt lgkmcnt(5)
v_mfma_f32_16x16x32_bf16 v[16:19], a[160:163], a[12:15], v[16:19]
ds_read_b128 a[200:203], v38 offset:50688
v_lshlrev_b32 v102, 16, v84
v_mfma_f32_16x16x32_bf16 v[20:23], a[164:167], a[12:15], v[20:23]
ds_read_b128 a[204:207], v38 offset:51712
v_and_b32 v103, 0xffff0000, v84
v_mfma_f32_16x16x32_bf16 v[24:27], a[168:171], a[12:15], v[24:27]
v_lshlrev_b32 v104, 16, v85
v_and_b32 v105, 0xffff0000, v85
v_mfma_f32_16x16x32_bf16 v[28:31], a[172:175], a[12:15], v[28:31]
v_lshlrev_b32 v106, 16, v86
v_mfma_f32_16x16x32_bf16 v[32:35], a[176:179], a[12:15], v[32:35]
s_waitcnt vmcnt(1)
s_waitcnt lgkmcnt(2)
v_mfma_f32_16x16x32_bf16 v[16:19], a[180:183], a[16:19], v[16:19]
v_and_b32 v107, 0xffff0000, v86
v_lshlrev_b32 v108, 16, v88
v_mfma_f32_16x16x32_bf16 v[20:23], a[184:187], a[16:19], v[20:23]
v_mfma_f32_16x16x32_bf16 v[24:27], a[188:191], a[16:19], v[24:27]
v_and_b32 v109, 0xffff0000, v88
v_mfma_f32_16x16x32_bf16 v[28:31], a[192:195], a[16:19], v[28:31]
v_lshlrev_b32 v110, 16, v89
v_mfma_f32_16x16x32_bf16 v[32:35], a[196:199], a[16:19], v[32:35]
s_waitcnt vmcnt(0)
s_waitcnt lgkmcnt(0)
v_mfma_f32_16x16x32_bf16 v[16:19], a[200:203], a[20:23], v[16:19]
v_and_b32 v111, 0xffff0000, v89
v_lshlrev_b32 v112, 16, v90
v_mfma_f32_16x16x32_bf16 v[20:23], a[204:207], a[20:23], v[20:23]
v_and_b32 v113, 0xffff0000, v90
v_mfma_f32_16x16x32_bf16 v[24:27], a[228:231], a[20:23], v[24:27]
v_lshlrev_b32 v114, 16, v92
v_mfma_f32_16x16x32_bf16 v[28:31], a[232:235], a[20:23], v[28:31]
v_and_b32 v115, 0xffff0000, v92
v_mfma_f32_16x16x32_bf16 v[32:35], a[236:239], a[20:23], v[32:35]
s_nop 3
v_pk_add_f32 v[16:17], v[16:17], v[96:97]
v_pk_add_f32 v[18:19], v[18:19], v[98:99]
v_pk_add_f32 v[20:21], v[20:21], v[100:101]
v_pk_add_f32 v[22:23], v[22:23], v[102:103]
v_pk_add_f32 v[24:25], v[24:25], v[104:105]
v_pk_add_f32 v[26:27], v[26:27], v[106:107]
v_pk_add_f32 v[28:29], v[28:29], v[108:109]
v_pk_add_f32 v[30:31], v[30:31], v[110:111]
v_pk_add_f32 v[32:33], v[32:33], v[112:113]
v_pk_add_f32 v[34:35], v[34:35], v[114:115]
s_cmp_eq_u32 s29, 1
s_cbranch_scc1 L_last
s_barrier
s_lshl_b32 s30, s27, 2
s_add_u32 s30, s30, s24
v_mov_b32 v138, 1073741824
s_mul_i32 s31, s30, 18432
s_mul_i32 s32, s28, 2304
s_add_u32 s31, s31, s32
s_add_u32 s31, s31, 30834688
v_mov_b32 v140, v1
v_add_u32 v141, 2048, v140
v_cndmask_b32 v141, v138, v141, s[46:47]
v_cvt_pk_bf16_f32 v124, v16, v17
v_cvt_pk_bf16_f32 v125, v18, v19
v_cvt_pk_bf16_f32 v126, v20, v21
v_cvt_pk_bf16_f32 v127, v22, v23
v_cvt_pk_bf16_f32 v128, v24, v25
v_cvt_pk_bf16_f32 v129, v26, v27
v_cvt_pk_bf16_f32 v130, v28, v29
v_cvt_pk_bf16_f32 v131, v30, v31
v_cvt_pk_bf16_f32 v132, v32, v33
v_cvt_pk_bf16_f32 v133, v34, v35
buffer_store_dwordx4 v[124:127], v140, s[8:11], s31 offen sc1
buffer_store_dwordx4 v[128:131], v140, s[8:11], s31 offen offset:1024 sc1
v_permlane16_swap_b32 v132, v134
v_permlane16_swap_b32 v133, v135
buffer_store_dwordx4 v[132:135], v141, s[8:11], s31 offen sc1
v_pk_add_f32 v[142:143], v[32:33], v[34:35]
v_pk_mul_f32 v[144:145], v[32:33], v[32:33]
v_pk_fma_f32 v[144:145], v[34:35], v[34:35], v[144:145]
v_cndmask_b32 v142, 0, v142, s[50:51]
v_cndmask_b32 v143, 0, v143, s[50:51]
v_cndmask_b32 v144, 0, v144, s[50:51]
v_cndmask_b32 v145, 0, v145, s[50:51]
v_pk_add_f32 v[142:143], v[142:143], v[16:17]
v_pk_fma_f32 v[144:145], v[16:17], v[16:17], v[144:145]
v_pk_add_f32 v[142:143], v[142:143], v[18:19]
v_pk_fma_f32 v[144:145], v[18:19], v[18:19], v[144:145]
v_pk_add_f32 v[142:143], v[142:143], v[20:21]
v_pk_fma_f32 v[144:145], v[20:21], v[20:21], v[144:145]
v_pk_add_f32 v[142:143], v[142:143], v[22:23]
v_pk_fma_f32 v[144:145], v[22:23], v[22:23], v[144:145]
v_pk_add_f32 v[142:143], v[142:143], v[24:25]
v_pk_fma_f32 v[144:145], v[24:25], v[24:25], v[144:145]
v_pk_add_f32 v[142:143], v[142:143], v[26:27]
v_pk_fma_f32 v[144:145], v[26:27], v[26:27], v[144:145]
v_pk_add_f32 v[142:143], v[142:143], v[28:29]
v_pk_fma_f32 v[144:145], v[28:29], v[28:29], v[144:145]
v_pk_add_f32 v[142:143], v[142:143], v[30:31]
v_pk_fma_f32 v[144:145], v[30:31], v[30:31], v[144:145]
v_add_f32 v136, v142, v143
v_add_f32 v137, v144, v145
s_lshl_b32 s31, s30, 7
s_lshl_b32 s32, s28, 14
v_permlane32_swap_b32 v136, v137
v_add_f32 v136, v136, v137
v_mov_b32 v137, v136
s_add_u32 s31, s31, s32
s_add_u32 s31, s31, 33193984
v_permlane16_swap_b32 v136, v137
v_add_f32 v136, v136, v137
v_mov_b32 v137, v136
v_lshlrev_b32 v139, 3, v2
v_cndmask_b32 v138, v138, v139, s[46:47]
v_permlane32_swap_b32 v136, v137
buffer_store_dwordx2 v[136:137], v138, s[8:11], s31 offen sc1
s_mul_i32 s36, s26, 132608
s_mul_i32 s38, s24, 12288
s_add_u32 m0, s38, 0
s_add_u32 s39, s38, s36
buffer_load_dwordx4 v1, s[4:7], s39 offen offset:0 sc1 lds
buffer_load_dwordx4 v1, s[4:7], s39 offen offset:1024 sc1 lds
buffer_load_dwordx4 v1, s[4:7], s39 offen offset:2048 sc1 lds
buffer_load_dwordx4 v1, s[4:7], s39 offen offset:3072 sc1 lds
s_add_u32 m0, m0, 4096
s_add_u32 s39, s39, 4096
buffer_load_dwordx4 v1, s[4:7], s39 offen offset:0 sc1 lds
buffer_load_dwordx4 v1, s[4:7], s39 offen offset:1024 sc1 lds
buffer_load_dwordx4 v1, s[4:7], s39 offen offset:2048 sc1 lds
buffer_load_dwordx4 v1, s[4:7], s39 offen offset:3072 sc1 lds
s_add_u32 m0, m0, 4096
s_add_u32 s39, s39, 4096
buffer_load_dwordx4 v1, s[4:7], s39 offen offset:0 sc1 lds
buffer_load_dwordx4 v1, s[4:7], s39 offen offset:1024 sc1 lds
buffer_load_dwordx4 v1, s[4:7], s39 offen offset:2048 sc1 lds
buffer_load_dwordx4 v1, s[4:7], s39 offen offset:3072 sc1 lds
s_and_b32 s33, s27, 1
s_cmp_lt_u32 s27, 31
s_cselect_b32 s33, s33, 0
s_cmp_eq_u32 s33, 1
s_cselect_b32 s34, -1, 0xffff
s_mov_b32 s35, 0
s_waitcnt vmcnt(12)
s_barrier
s_cmp_eq_u32 s24, 0
s_cbranch_scc0 L_sig_38
v_lshlrev_b32 v6, 3, v1
s_lshr_b32 s31, s81, 4
s_lshl_b32 s31, s31, 11
v_add_u32 v6, s31, v6
s_mov_b64 exec, s[34:35]
s_mov_b32 s30, 26607616
buffer_atomic_add v4, v6, s[8:11], s30 offen sc1
s_mov_b64 exec, -1
L_sig_38:
s_cmp_eq_u32 s29, 1
s_cbranch_scc1 L_main_fin
s_mul_i32 s36, s26, 132608
s_mul_i32 s38, s24, 9216
s_add_u32 m0, s38, 49152
s_add_u32 s39, s38, s36
s_add_u32 s39, s39, 49152
buffer_load_dwordx4 v1, s[4:7], s39 offen offset:0 sc1 lds
buffer_load_dwordx4 v1, s[4:7], s39 offen offset:1024 sc1 lds
buffer_load_dwordx4 v1, s[4:7], s39 offen offset:2048 sc1 lds
buffer_load_dwordx4 v1, s[4:7], s39 offen offset:3072 sc1 lds
s_add_u32 m0, m0, 4096
s_add_u32 s39, s39, 4096
buffer_load_dwordx4 v1, s[4:7], s39 offen offset:0 sc1 lds
buffer_load_dwordx4 v1, s[4:7], s39 offen offset:1024 sc1 lds
buffer_load_dwordx4 v1, s[4:7], s39 offen offset:2048 sc1 lds
buffer_load_dwordx4 v1, s[4:7], s39 offen offset:3072 sc1 lds
s_add_u32 m0, m0, 4096
s_add_u32 s39, s39, 4096
buffer_load_dwordx4 v1, s[4:7], s39 offen offset:0 sc1 lds
s_cmp_eq_u32 s25, 0
s_cselect_b32 s34, 16, 24
s_cmp_eq_u32 s24, 1
s_cbranch_scc0 L_other_41
s_lshl_b32 s30, s80, 7
s_add_u32 s30, s30, 26607616
v_mov_b32 v6, 0
s_mov_b32 s31, 0
s_mov_b64 exec, 1
v_mov_b32 v249, 0
buffer_atomic_add v249, v6, s[8:11], s30 offen sc0 sc1
s_sleep 3
v_mov_b32 v250, 0
buffer_atomic_add v250, v6, s[8:11], s30 offen sc0 sc1
s_sleep 3
v_mov_b32 v251, 0
buffer_atomic_add v251, v6, s[8:11], s30 offen sc0 sc1
s_sleep 3
L_poll_39:
s_add_u32 s31, s31, 1
s_cmp_gt_u32 s31, 100000
s_cbranch_scc1 L_polled_40
v_mov_b32 v252, 0
buffer_atomic_add v252, v6, s[8:11], s30 offen sc0 sc1
s_waitcnt vmcnt(3)
v_cmp_gt_u32 vcc, s34, v249
s_nop 0
s_cbranch_vccz L_polled_40
v_mov_b32 v249, 0
buffer_atomic_add v249, v6, s[8:11], s30 offen sc0 sc1
s_waitcnt vmcnt(3)
v_cmp_gt_u32 vcc, s34, v250
s_nop 0
s_cbranch_vccz L_polled_40
v_mov_b32 v250, 0
buffer_atomic_add v250, v6, s[8:11], s30 offen sc0 sc1
s_waitcnt vmcnt(3)
v_cmp_gt_u32 vcc, s34, v251
s_nop 0
s_cbranch_vccz L_polled_40
v_mov_b32 v251, 0
buffer_atomic_add v251, v6, s[8:11], s30 offen sc0 sc1
s_waitcnt vmcnt(3)
v_cmp_gt_u32 vcc, s34, v252
s_nop 0
s_cbranch_vccz L_polled_40
s_branch L_poll_39
L_polled_40:
s_mov_b64 exec, -1
s_branch L_join_42
L_other_41:
s_waitcnt vmcnt(0)
L_join_42:
s_barrier
s_mov_b32 s29, 1
s_add_u32 s8, s8, 30834688
s_addc_u32 s9, s9, 0
s_mov_b32 s10, 30834688
s_branch L_layer
L_last:
s_lshl_b32 s30, s27, 2
s_add_u32 s30, s30, s24
v_mov_b32 v138, 1073741824
s_mul_i32 s31, s30, 18432
s_mul_i32 s32, s28, 144
s_add_u32 s31, s31, s32
v_mul_u32_u24 v140, 1152, v2
v_lshl_add_u32 v140, v3, 4, v140
v_add_u32 v141, 128, v140
v_cndmask_b32 v141, v138, v141, s[46:47]
v_cvt_pk_bf16_f32 v124, v16, v17
v_cvt_pk_bf16_f32 v125, v18, v19
v_cvt_pk_bf16_f32 v126, v20, v21
v_cvt_pk_bf16_f32 v127, v22, v23
v_cvt_pk_bf16_f32 v128, v24, v25
v_cvt_pk_bf16_f32 v129, v26, v27
v_cvt_pk_bf16_f32 v130, v28, v29
v_cvt_pk_bf16_f32 v131, v30, v31
v_cvt_pk_bf16_f32 v132, v32, v33
v_cvt_pk_bf16_f32 v133, v34, v35
buffer_store_dwordx4 v[124:127], v140, s[16:19], s31 offen
buffer_store_dwordx4 v[128:131], v140, s[16:19], s31 offen offset:64
v_permlane16_swap_b32 v132, v134
v_permlane16_swap_b32 v133, v135
buffer_store_dwordx4 v[132:135], v141, s[16:19], s31 offen
L_main_fin:
L_main_end:
s_endpgm
L_tagslow_1:
buffer_load_dwordx2 v[238:239], v48, s[84:87], 0 offen sc1
s_add_u32 s31, s31, 1
s_waitcnt vmcnt(0)
v_cmp_eq_u32 vcc, 0, v238
s_cmp_gt_u32 s31, 200000
s_cbranch_scc1 L_tagback_2
s_cbranch_vccnz L_tagslow_1
s_branch L_tagback_2
L_dbslow_11:
buffer_load_dwordx2 v[150:151], v148, s[4:7], s66 offen sc1
s_add_u32 s31, s31, 1
s_waitcnt vmcnt(0)
v_cmp_ne_u64 vcc, v[150:151], v[238:239]
s_cmp_gt_u32 s31, 200000
s_cbranch_scc1 L_dbback_12
s_cbranch_vccnz L_dbslow_11
s_branch L_dbback_12
L_stzslow_23:
s_mov_b32 s31, 0
L_stzloop_25:
buffer_load_dwordx2 v[180:181], v234, s[8:11], s61 offen offset:0 sc1
buffer_load_dwordx2 v[182:183], v234, s[8:11], s61 offen offset:1024 sc1
buffer_load_dwordx2 v[184:185], v234, s[8:11], s61 offen offset:2048 sc1
buffer_load_dwordx2 v[186:187], v234, s[8:11], s61 offen offset:3072 sc1
buffer_load_dwordx2 v[188:189], v235, s[8:11], s61 offen offset:0 sc1
buffer_load_dwordx2 v[190:191], v235, s[8:11], s61 offen offset:1024 sc1
buffer_load_dwordx2 v[192:193], v235, s[8:11], s61 offen offset:2048 sc1
buffer_load_dwordx2 v[194:195], v235, s[8:11], s61 offen offset:3072 sc1
s_add_u32 s31, s31, 1
s_waitcnt vmcnt(0)
v_min3_f32 v198, v181, v183, v185
v_min3_f32 v199, v187, v189, v191
v_min3_f32 v198, v198, v193, v195
v_min_f32 v198, v198, v199
v_cmp_gt_f32 vcc, 0, v198
s_cmp_gt_u32 s31, 200000
s_cbranch_scc1 L_stzback_24
s_cbranch_vccnz L_stzloop_25
s_branch L_stzback_24
L_xslow_35:
s_mov_b32 s31, 0
L_xloop_37:
buffer_load_dwordx4 v[80:83], v1, s[8:11], s63 offen offset:0 sc1
buffer_load_dwordx4 v[84:87], v1, s[8:11], s63 offen offset:1024 sc1
buffer_load_dwordx4 v[88:91], v1, s[8:11], s63 offen offset:2048 sc1
buffer_load_dwordx4 v[92:95], v1, s[8:11], s63 offen offset:3072 sc1
s_add_u32 s31, s31, 1
s_waitcnt vmcnt(0)
v_xor_b32 v118, v248, v83
v_xor_b32 v119, v248, v87
v_xor_b32 v120, v248, v91
v_xor_b32 v121, v248, v95
v_or3_b32 v118, v118, v119, v120
v_or_b32 v118, v118, v121
v_cmp_ne_u32 vcc, 0, v118
s_cmp_gt_u32 s31, 200000
s_cbranch_scc1 L_xback_36
s_cbranch_vccnz L_xloop_37
s_branch L_xback_36
L_code_end:
.section .rodata,"a"
.p2align 6
.amdhsa_kernel main_kernel
  .amdhsa_next_free_vgpr 512
  .amdhsa_next_free_sgpr 102
  .amdhsa_accum_offset 256
  .amdhsa_group_segment_fixed_size 0
  .amdhsa_kernarg_size 88
  .amdhsa_user_sgpr_count 2
  .amdhsa_user_sgpr_kernarg_segment_ptr 1
  .amdhsa_system_sgpr_workgroup_id_x 1
  .amdhsa_float_denorm_mode_32 3
.end_amdhsa_kernel
```

```asm
; @launch kernel=main_kernel grid=(256,1,1) block=(256,1,1) lds=163840
.amdgcn_target "amdgcn-amd-amdhsa--gfx950"
.text
.globl main_kernel
.p2align 8
.type main_kernel,@function
main_kernel:
s_cmp_ge_u32 s2, 256
s_cbranch_scc1 L_main_exit
s_load_dwordx16 s[64:79], s[0:1], 0
s_load_dwordx2 s[4:5], s[0:1], 80
s_load_dwordx2 s[16:17], s[0:1], 64
s_load_dwordx2 s[84:85], s[0:1], 72
v_lshrrev_b32 v6, 6, v0
v_and_b32 v0, 63, v0
v_readfirstlane_b32 s24, v6
v_lshlrev_b32 v1, 4, v0
v_and_b32 v2, 15, v0
v_lshrrev_b32 v3, 4, v0
v_mov_b32 v4, 1
v_mov_b32 v5, 0
s_mov_b32 s56, 0
s_mov_b32 s29, 0
v_add_u32 v9, 65536, v1
v_cmp_eq_u32 s[46:47], 0, v3
v_cmp_eq_u32 s[48:49], 2, v3
v_cmp_gt_u32 s[50:51], 2, v3
s_mov_b32 s6, 19320832
s_mov_b32 s7, 0x20000
s_mov_b32 s10, 61669376
s_mov_b32 s11, 0x20000
s_mov_b32 s18, 2359296
s_mov_b32 s19, 0x20000
s_mov_b32 s22, 4096
s_mov_b32 s23, 0x20000
s_mov_b32 s86, 256
s_mov_b32 s87, 0x20000
s_and_b32 s30, s2, 7
s_lshr_b32 s31, s2, 3
s_lshr_b32 s32, s31, 2
s_and_b32 s33, s31, 3
s_lshr_b32 s25, s30, 2
s_lshl_b32 s25, s25, 3
s_add_u32 s25, s25, s32
s_and_b32 s26, s30, 3
s_lshl_b32 s26, s26, 2
s_add_u32 s26, s26, s33
s_branch L_main_go
L_main_exit:
s_endpgm
L_main_go:
s_lshr_b32 s27, s30, 1
s_lshl_b32 s27, s27, 3
s_add_u32 s27, s27, s32
s_and_b32 s28, s30, 1
s_lshl_b32 s28, s28, 2
s_add_u32 s28, s28, s33
s_lshr_b32 s27, s30, 1
s_lshl_b32 s27, s27, 2
s_lshr_b32 s32, s31, 3
s_add_u32 s27, s27, s32
s_lshl_b32 s27, s27, 1
s_and_b32 s32, s30, 1
s_add_u32 s27, s27, s32
s_and_b32 s28, s31, 7
s_lshl_b32 s80, s25, 4
s_add_u32 s80, s80, s26
s_lshl_b32 s81, s27, 3
s_add_u32 s81, s81, s28
s_getpc_b64 s[88:89]
L_pc:
s_mov_b32 s90, L_code_end-L_pc
s_mov_b32 s91, 0x20000
s_lshl_b32 s31, s31, 10
s_lshl_b32 s32, s24, 8
s_add_u32 s31, s31, s32
v_lshrrev_b32 v14, 2, v1
v_add_u32 v14, s31, v14
s_waitcnt lgkmcnt(0)
s_add_u32 s8, s4, 19320832
s_addc_u32 s9, s5, 0
s_mov_b32 s20, s76
s_mov_b32 s21, s77
s_memrealtime s[54:55]
s_or_b32 s30, s2, s24
s_cmp_eq_u32 s30, 0
s_cselect_b32 s30, 0, 1073741824
v_mov_b32 v48, 0
s_waitcnt lgkmcnt(0)
s_or_b32 s54, s54, 1
v_mov_b32 v238, s54
v_mov_b32 v239, s55
s_mov_b64 exec, 1
buffer_store_dwordx2 v[238:239], v48, s[84:87], s30 offen sc1
s_mov_b64 exec, -1
s_cmp_lt_u32 s2, 128
s_cbranch_scc1 L_p0_x1
s_mov_b32 s12, s66
s_mov_b32 s13, s67
s_mov_b32 s14, 1990656
s_mov_b32 s15, 0x20000
s_sub_u32 s30, s2, 128
s_cmp_lt_u32 s30, 108
s_cselect_b32 s62, 0, 1073741824
s_cselect_b32 s30, s30, 0
s_and_b32 s60, s30, 3
s_lshr_b32 s61, s30, 2
s_mul_i32 s30, s60, 497664
s_lshl_b32 s31, s61, 7
s_add_u32 s30, s30, s31
s_mul_i32 s31, s24, 27648
s_add_u32 s30, s30, s31
s_add_u32 s30, s30, s62
v_lshrrev_b32 v36, 7, v1
v_mul_u32_u24 v42, 3456, v36
v_and_b32 v36, 0x70, v1
v_add_u32 v42, v36, v42
s_lshl_b32 s32, s24, 10
s_add_u32 m0, s32, 0
s_add_u32 s31, s30, 0
buffer_load_dwordx4 v42, s[12:15], s31 offen nt lds
s_add_u32 m0, s32, 4096
s_add_u32 s31, s30, 110592
buffer_load_dwordx4 v42, s[12:15], s31 offen nt lds
s_add_u32 m0, s32, 8192
s_add_u32 s31, s30, 221184
buffer_load_dwordx4 v42, s[12:15], s31 offen nt lds
s_add_u32 m0, s32, 12288
s_add_u32 s31, s30, 331776
buffer_load_dwordx4 v42, s[12:15], s31 offen nt lds
s_add_u32 m0, s32, 16384
s_add_u32 s31, s30, 442368
s_cmp_lt_u32 s24, 2
s_cselect_b32 s31, s31, 1073741824
buffer_load_dwordx4 v42, s[12:15], s31 offen nt lds
s_branch L_p0_j1
L_p0_x1:
s_mov_b32 s12, s64
s_mov_b32 s13, s65
s_mov_b32 s14, 2359296
s_mov_b32 s15, 0x20000
s_mul_i32 s30, s24, 18
v_add_u32 v36, s30, v3
v_mul_u32_u24 v42, 1152, v2
v_lshl_add_u32 v42, v36, 4, v42
s_mul_i32 s30, s2, 18432
v_mov_b32 v37, 1073741824
v_cndmask_b32 v37, v37, v42, s[50:51]
buffer_load_dwordx4 v[64:67], v42, s[12:15], s30 offen offset:0
buffer_load_dwordx4 v[68:71], v42, s[12:15], s30 offen offset:64
buffer_load_dwordx4 v[72:75], v42, s[12:15], s30 offen offset:128
buffer_load_dwordx4 v[76:79], v42, s[12:15], s30 offen offset:192
buffer_load_dwordx4 v[80:83], v37, s[12:15], s30 offen offset:256
L_p0_j1:
s_mov_b32 s37, L_pc-L_pc
buffer_load_dword v15, v14, s[88:91], s37 offen
s_mov_b32 s37, L_pc+32768-L_pc
buffer_load_dword v15, v14, s[88:91], s37 offen
v_lshrrev_b32 v36, 2, v2
v_lshl_add_u32 v36, v3, 3, v36
v_lshlrev_b32 v45, 7, v36
v_and_b32 v36, 3, v2
v_lshl_add_u32 v45, v36, 3, v45
s_lshl_b32 s31, s24, 5
v_add_u32 v45, s31, v45
v_mov_b32 v164, 3212836864
v_mov_b32 v165, 3212836864
v_mov_b32 v166, 3212836864
v_mov_b32 v167, 3212836864
s_lshl_b32 s30, s80, 10
s_lshl_b32 s31, s24, 8
s_add_u32 s30, s30, s31
s_add_u32 s30, s30, 26214400
s_mov_b32 s31, 30834688
v_mul_lo_u32 v36, v3, s31
v_lshl_add_u32 v37, v2, 4, v36
s_mov_b32 exec_hi, 0
buffer_store_dwordx4 v[164:167], v37, s[8:11], s30 offen sc1
s_mov_b64 exec, -1
v_lshl_add_u32 v37, v2, 15, v36
s_lshl_b32 s30, s2, 7
s_add_u32 s30, s30, 26476544
s_cmp_eq_u32 s24, 0
s_cselect_b32 s30, s30, 1073741824
s_mov_b64 exec, 0x001f001f
buffer_store_dword v48, v37, s[8:11], s30 offen sc1
s_mov_b64 exec, -1
s_cmp_lt_u32 s2, 128
s_cbranch_scc1 L_p0_x2
s_mul_i32 s92, s61, 29
s_lshr_b32 s92, s92, 8
s_mul_i32 s33, s92, 9
s_sub_u32 s33, s61, s33
s_lshl_b32 s33, s33, 6
s_lshl_b32 s31, s24, 4
s_add_u32 s33, s33, s31
v_add_u32 v36, s33, v2
v_mul_u32_u24 v37, 911, v36
v_lshrrev_b32 v37, 14, v37
v_mul_u32_u24 v38, 18, v37
v_sub_u32 v36, v36, v38
v_and_b32 v38, 1, v37
v_lshrrev_b32 v37, 1, v37
s_mov_b32 s31, 132608
v_mul_lo_u32 v37, v37, s31
s_cmp_eq_u32 s92, 0
s_cselect_b32 s93, 5, 0
s_cselect_b32 s94, 8, 4
s_cmp_eq_u32 s92, 2
s_cselect_b32 s93, 2, s93
s_cselect_b32 s94, 0, s94
s_sub_u32 s94, s94, 16
v_add_u32 v39, s93, v38
v_lshl_add_u32 v40, v38, 1, v36
v_add_u32 v40, s94, v40
v_cmp_gt_u32 vcc, 16, v36
s_nop 1
v_cndmask_b32 v39, 4, v39, vcc
v_cndmask_b32 v40, v40, v36, vcc
v_lshl_add_u32 v43, v39, 10, v37
v_lshl_add_u32 v43, v40, 4, v43
v_lshl_add_u32 v44, v39, 9, v37
v_lshl_add_u32 v44, v40, 3, v44
s_lshl_b32 s31, s60, 7
s_add_u32 s31, s31, 129024
v_add_u32 v44, s31, v44
s_mul_i32 s31, s60, 18
v_add_u32 v37, s31, v3
v_and_b32 v38, 3, v37
v_lshrrev_b32 v37, 2, v37
v_mul_u32_u24 v37, 7168, v37
v_add_u32 v43, v43, v37
v_lshl_add_u32 v43, v38, 8, v43
s_waitcnt vmcnt(4)
s_barrier
ds_read_b64_tr_b16 v[64:65], v45 offset:0
ds_read_b64_tr_b16 v[66:67], v45 offset:512
ds_read_b64_tr_b16 v[68:69], v45 offset:4096
ds_read_b64_tr_b16 v[70:71], v45 offset:4608
ds_read_b64_tr_b16 v[72:73], v45 offset:8192
ds_read_b64_tr_b16 v[74:75], v45 offset:8704
ds_read_b64_tr_b16 v[76:77], v45 offset:12288
ds_read_b64_tr_b16 v[78:79], v45 offset:12800
ds_read_b64_tr_b16 v[80:81], v45 offset:16384
ds_read_b64_tr_b16 v[82:83], v45 offset:16896
v_mov_b32 v36, 1073741824
v_mov_b32 v46, 0
v_cndmask_b32 v37, v36, v43, s[50:51]
s_add_u32 s31, s62, 0
s_waitcnt lgkmcnt(8)
buffer_store_dwordx4 v[64:67], v43, s[4:7], s31 offen sc1
s_add_u32 s31, s62, 7168
s_waitcnt lgkmcnt(6)
buffer_store_dwordx4 v[68:71], v43, s[4:7], s31 offen sc1
s_add_u32 s31, s62, 14336
s_waitcnt lgkmcnt(4)
buffer_store_dwordx4 v[72:75], v43, s[4:7], s31 offen sc1
s_add_u32 s31, s62, 21504
s_waitcnt lgkmcnt(2)
buffer_store_dwordx4 v[76:79], v43, s[4:7], s31 offen sc1
s_add_u32 s31, s62, 28672
s_waitcnt lgkmcnt(0)
buffer_store_dwordx4 v[80:83], v37, s[4:7], s31 offen sc1
v_mov_b32 v37, 0x3f803f80
v_dot2c_f32_bf16 v46, v64, v37
v_dot2c_f32_bf16 v46, v65, v37
v_dot2c_f32_bf16 v46, v66, v37
v_dot2c_f32_bf16 v46, v67, v37
v_dot2c_f32_bf16 v46, v68, v37
v_dot2c_f32_bf16 v46, v69, v37
v_dot2c_f32_bf16 v46, v70, v37
v_dot2c_f32_bf16 v46, v71, v37
v_dot2c_f32_bf16 v46, v72, v37
v_dot2c_f32_bf16 v46, v73, v37
v_dot2c_f32_bf16 v46, v74, v37
v_dot2c_f32_bf16 v46, v75, v37
v_dot2c_f32_bf16 v46, v76, v37
v_dot2c_f32_bf16 v46, v77, v37
v_dot2c_f32_bf16 v46, v78, v37
v_dot2c_f32_bf16 v46, v79, v37
v_dot2c_f32_bf16 v46, v80, v37
v_dot2c_f32_bf16 v46, v81, v37
v_dot2c_f32_bf16 v46, v82, v37
v_dot2c_f32_bf16 v46, v83, v37
s_nop 2
v_mov_b32 v37, v46
s_nop 1
v_permlane32_swap_b32 v46, v37
v_add_f32 v46, v46, v37
v_mov_b32 v37, v46
s_nop 1
v_permlane16_swap_b32 v46, v37
v_add_f32 v46, v46, v37
v_cvt_pk_bf16_f32 v50, v46, v46
v_and_b32 v37, 0xffff0000, v50
v_sub_f32 v37, v46, v37
v_cvt_pk_bf16_f32 v51, v37, v37
v_cndmask_b32 v36, v36, v44, s[46:47]
buffer_store_dwordx2 v[50:51], v36, s[4:7], s62 offen sc1
s_branch L_p0_j2
L_p0_x2:
s_mul_i32 s30, s24, 4608
s_mul_i32 s31, s2, 18432
s_add_u32 s31, s31, s30
s_add_u32 s31, s31, 0
v_mov_b32 v36, 1073741824
v_add_u32 v38, 4096, v1
v_cndmask_b32 v38, v36, v38, s[50:51]
v_mov_b32 v46, 0
v_mov_b32 v47, 0
v_mov_b32 v39, 0x3f803f80
s_waitcnt vmcnt(4)
buffer_store_dwordx4 v[64:67], v1, s[8:11], s31 offen offset:0 sc1
buffer_store_dwordx4 v[68:71], v1, s[8:11], s31 offen offset:1024 sc1
buffer_store_dwordx4 v[72:75], v1, s[8:11], s31 offen offset:2048 sc1
buffer_store_dwordx4 v[76:79], v1, s[8:11], s31 offen offset:3072 sc1
buffer_store_dwordx4 v[80:83], v38, s[8:11], s31 offen offset:0 sc1
v_dot2c_f32_bf16 v46, v64, v39
v_dot2c_f32_bf16 v46, v65, v39
v_dot2c_f32_bf16 v46, v66, v39
v_dot2c_f32_bf16 v46, v67, v39
v_dot2c_f32_bf16 v46, v68, v39
v_dot2c_f32_bf16 v46, v69, v39
v_dot2c_f32_bf16 v46, v70, v39
v_dot2c_f32_bf16 v46, v71, v39
v_dot2c_f32_bf16 v46, v72, v39
v_dot2c_f32_bf16 v46, v73, v39
v_dot2c_f32_bf16 v46, v74, v39
v_dot2c_f32_bf16 v46, v75, v39
v_dot2c_f32_bf16 v46, v76, v39
v_dot2c_f32_bf16 v46, v77, v39
v_dot2c_f32_bf16 v46, v78, v39
v_dot2c_f32_bf16 v46, v79, v39
v_dot2c_f32_bf16 v46, v80, v39
v_dot2c_f32_bf16 v46, v81, v39
v_dot2c_f32_bf16 v46, v82, v39
v_dot2c_f32_bf16 v46, v83, v39
v_dot2c_f32_bf16 v47, v64, v64
v_dot2c_f32_bf16 v47, v65, v65
v_dot2c_f32_bf16 v47, v66, v66
v_dot2c_f32_bf16 v47, v67, v67
v_dot2c_f32_bf16 v47, v68, v68
v_dot2c_f32_bf16 v47, v69, v69
v_dot2c_f32_bf16 v47, v70, v70
v_dot2c_f32_bf16 v47, v71, v71
v_dot2c_f32_bf16 v47, v72, v72
v_dot2c_f32_bf16 v47, v73, v73
v_dot2c_f32_bf16 v47, v74, v74
v_dot2c_f32_bf16 v47, v75, v75
v_dot2c_f32_bf16 v47, v76, v76
v_dot2c_f32_bf16 v47, v77, v77
v_dot2c_f32_bf16 v47, v78, v78
v_dot2c_f32_bf16 v47, v79, v79
v_dot2c_f32_bf16 v47, v80, v80
v_dot2c_f32_bf16 v47, v81, v81
v_dot2c_f32_bf16 v47, v82, v82
v_dot2c_f32_bf16 v47, v83, v83
v_mov_b32 v37, v46
s_nop 1
v_permlane32_swap_b32 v46, v37
v_add_f32 v46, v46, v37
v_mov_b32 v37, v46
s_nop 1
v_permlane16_swap_b32 v46, v37
v_add_f32 v46, v46, v37
v_mov_b32 v37, v47
s_nop 1
v_permlane32_swap_b32 v47, v37
v_add_f32 v47, v47, v37
v_mov_b32 v37, v47
s_nop 1
v_permlane16_swap_b32 v47, v37
v_add_f32 v47, v47, v37
s_lshl_b32 s30, s2, 7
s_lshl_b32 s31, s24, 14
s_add_u32 s30, s30, s31
s_add_u32 s30, s30, 2359296
v_cndmask_b32 v50, 0, v46, s[46:47]
v_cndmask_b32 v51, 0, v47, s[46:47]
v_lshlrev_b32 v37, 3, v2
v_lshl_add_u32 v37, v3, 16, v37
v_cndmask_b32 v37, v36, v37, s[50:51]
buffer_store_dwordx2 v[50:51], v37, s[8:11], s30 offen sc1
L_p0_j2:
buffer_load_dwordx2 v[238:239], v48, s[84:87], 0 offen sc1
s_mov_b32 s12, s72
s_mov_b32 s13, s73
s_mov_b32 s14, 5308416
s_mov_b32 s15, 0x20000
s_sub_u32 s30, s2, 0
s_cmp_lt_u32 s30, 256
s_cselect_b32 s36, 0, 1073741824
s_cselect_b32 s30, s30, 0
s_and_b32 s34, s30, 3
s_lshr_b32 s35, s30, 2
s_mul_i32 s30, s34, 1327104
s_lshl_b32 s31, s35, 7
s_add_u32 s30, s30, s31
s_mul_i32 s31, s24, 73728
s_add_u32 s30, s30, s31
s_add_u32 s30, s30, s36
v_lshrrev_b32 v36, 7, v1
v_mul_u32_u24 v42, 9216, v36
v_and_b32 v36, 0x70, v1
v_add_u32 v42, v36, v42
s_lshl_b32 s32, s24, 10
s_add_u32 m0, s32, 20480
s_add_u32 s31, s30, 0
buffer_load_dwordx4 v42, s[12:15], s31 offen nt lds
s_add_u32 m0, s32, 24576
s_add_u32 s31, s30, 294912
buffer_load_dwordx4 v42, s[12:15], s31 offen nt lds
s_add_u32 m0, s32, 28672
s_add_u32 s31, s30, 589824
buffer_load_dwordx4 v42, s[12:15], s31 offen nt lds
s_add_u32 m0, s32, 32768
s_add_u32 s31, s30, 884736
buffer_load_dwordx4 v42, s[12:15], s31 offen nt lds
s_add_u32 m0, s32, 36864
s_add_u32 s31, s30, 1179648
s_cmp_lt_u32 s24, 2
s_cselect_b32 s31, s31, 1073741824
buffer_load_dwordx4 v42, s[12:15], s31 offen nt lds
s_lshl_b32 s30, s2, 7
s_add_u32 s30, s30, 19283968
s_lshl_b32 s32, s2, 3
s_add_u32 s32, s32, 19316736
s_cmp_eq_u32 s24, 0
s_cselect_b32 s30, s30, 1073741824
s_cselect_b32 s100, s32, 1073741824
s_waitcnt vmcnt(5)
v_cmp_eq_u32 vcc, 0, v238
s_mov_b32 s31, 0
s_cbranch_vccnz L_tagslow_1
L_tagback_2:
s_barrier
s_mov_b64 exec, 1
buffer_store_dwordx2 v[238:239], v48, s[4:7], s30 offen sc1
s_mov_b64 exec, -1
s_cmp_lt_u32 s2, 32
s_cbranch_scc1 L_p0_a3
s_cmp_lt_u32 s2, 176
s_cbranch_scc1 L_p0_b3
s_mov_b32 s12, s68
s_mov_b32 s13, s69
s_mov_b32 s14, 663552
s_mov_b32 s15, 0x20000
s_sub_u32 s30, s2, 176
s_cmp_lt_u32 s30, 36
s_cselect_b32 s53, 0, 1073741824
s_cselect_b32 s30, s30, 0
s_and_b32 s37, s30, 3
s_lshr_b32 s52, s30, 2
s_mul_i32 s30, s37, 165888
s_lshl_b32 s31, s52, 7
s_add_u32 s30, s30, s31
s_mul_i32 s31, s24, 9216
s_add_u32 s30, s30, s31
s_add_u32 s30, s30, s53
v_lshrrev_b32 v36, 7, v1
v_mul_u32_u24 v42, 1152, v36
v_and_b32 v36, 0x70, v1
v_add_u32 v42, v36, v42
s_lshl_b32 s32, s24, 10
s_add_u32 m0, s32, 40960
s_add_u32 s31, s30, 0
buffer_load_dwordx4 v42, s[12:15], s31 offen nt lds
s_add_u32 m0, s32, 45056
s_add_u32 s31, s30, 36864
buffer_load_dwordx4 v42, s[12:15], s31 offen nt lds
s_add_u32 m0, s32, 49152
s_add_u32 s31, s30, 73728
buffer_load_dwordx4 v42, s[12:15], s31 offen nt lds
s_add_u32 m0, s32, 53248
s_add_u32 s31, s30, 110592
buffer_load_dwordx4 v42, s[12:15], s31 offen nt lds
s_add_u32 m0, s32, 57344
s_add_u32 s31, s30, 147456
s_cmp_lt_u32 s24, 2
s_cselect_b32 s31, s31, 1073741824
buffer_load_dwordx4 v42, s[12:15], s31 offen nt lds
s_branch L_p0_j3
L_p0_b3:
s_mov_b32 s12, s78
s_mov_b32 s13, s79
s_mov_b32 s14, 2654208
s_mov_b32 s15, 0x20000
s_sub_u32 s30, s2, 32
s_cmp_lt_u32 s30, 144
s_cselect_b32 s53, 0, 1073741824
s_cselect_b32 s30, s30, 0
s_and_b32 s37, s30, 15
s_lshr_b32 s52, s30, 4
s_mul_i32 s30, s37, 165888
s_lshl_b32 s31, s52, 7
s_add_u32 s30, s30, s31
s_mul_i32 s31, s24, 9216
s_add_u32 s30, s30, s31
s_add_u32 s30, s30, s53
v_lshrrev_b32 v36, 7, v1
v_mul_u32_u24 v42, 1152, v36
v_and_b32 v36, 0x70, v1
v_add_u32 v42, v36, v42
s_lshl_b32 s32, s24, 10
s_add_u32 m0, s32, 40960
s_add_u32 s31, s30, 0
buffer_load_dwordx4 v42, s[12:15], s31 offen nt lds
s_add_u32 m0, s32, 45056
s_add_u32 s31, s30, 36864
buffer_load_dwordx4 v42, s[12:15], s31 offen nt lds
s_add_u32 m0, s32, 49152
s_add_u32 s31, s30, 73728
buffer_load_dwordx4 v42, s[12:15], s31 offen nt lds
s_add_u32 m0, s32, 53248
s_add_u32 s31, s30, 110592
buffer_load_dwordx4 v42, s[12:15], s31 offen nt lds
s_add_u32 m0, s32, 57344
s_add_u32 s31, s30, 147456
s_cmp_lt_u32 s24, 2
s_cselect_b32 s31, s31, 1073741824
buffer_load_dwordx4 v42, s[12:15], s31 offen nt lds
s_branch L_p0_j3
L_p0_a3:
s_mov_b32 s12, s72
s_mov_b32 s13, s73
s_mov_b32 s14, 5308416
s_mov_b32 s15, 0x20000
s_add_u32 s30, s2, 256
s_cmp_lt_u32 s30, 288
s_cselect_b32 s53, 0, 1073741824
s_cselect_b32 s30, s30, 0
s_and_b32 s37, s30, 3
s_lshr_b32 s52, s30, 2
s_mul_i32 s30, s37, 1327104
s_lshl_b32 s31, s52, 7
s_add_u32 s30, s30, s31
s_mul_i32 s31, s24, 73728
s_add_u32 s30, s30, s31
s_add_u32 s30, s30, s53
v_lshrrev_b32 v36, 7, v1
v_mul_u32_u24 v42, 9216, v36
v_and_b32 v36, 0x70, v1
v_add_u32 v42, v36, v42
s_lshl_b32 s32, s24, 10
s_add_u32 m0, s32, 40960
s_add_u32 s31, s30, 0
buffer_load_dwordx4 v42, s[12:15], s31 offen nt lds
s_add_u32 m0, s32, 45056
s_add_u32 s31, s30, 294912
buffer_load_dwordx4 v42, s[12:15], s31 offen nt lds
s_add_u32 m0, s32, 49152
s_add_u32 s31, s30, 589824
buffer_load_dwordx4 v42, s[12:15], s31 offen nt lds
s_add_u32 m0, s32, 53248
s_add_u32 s31, s30, 884736
buffer_load_dwordx4 v42, s[12:15], s31 offen nt lds
s_add_u32 m0, s32, 57344
s_add_u32 s31, s30, 1179648
s_cmp_lt_u32 s24, 2
s_cselect_b32 s31, s31, 1073741824
buffer_load_dwordx4 v42, s[12:15], s31 offen nt lds
L_p0_j3:
s_lshl_b32 s92, s35, 6
s_lshl_b32 s33, s24, 4
s_add_u32 s92, s92, s33
s_cmp_ge_u32 s92, 2304
s_cselect_b32 s93, 1, 0
s_cselect_b32 s33, 2304, 0
s_sub_u32 s92, s92, s33
s_mul_i32 s94, s92, 1821
s_lshr_b32 s94, s94, 19
s_mul_i32 s33, s94, 288
s_sub_u32 s92, s92, s33
s_lshr_b32 s95, s92, 5
s_bfe_u32 s96, s92, 0x10004
s_lshl_b32 s94, s94, 1
s_cmp_ge_u32 s92, 144
s_addc_u32 s94, s94, 0
s_cmp_gt_u32 s95, 4
s_cselect_b32 s33, 5, 0
s_sub_u32 s97, s95, s33
s_cmp_eq_u32 s93, 0
s_cselect_b32 s33, 5, 0
s_add_u32 s97, s97, s33
s_cmp_eq_u32 s95, 4
s_cselect_b32 s97, 4, s97
s_mul_i32 s94, s94, 9
s_add_u32 s94, s94, s97
s_mul_i32 s94, s94, 37888
s_add_u32 s94, s94, 2785280
v_and_b32 v36, 3, v2
v_bfe_u32 v37, v2, 2, 1
v_bfe_u32 v38, v2, 3, 1
s_cmp_eq_u32 s95, 4
s_cbranch_scc1 L_w3m_3
s_cmp_eq_u32 s93, 0
s_cbranch_scc1 L_w3a_4
s_lshl_b32 s33, s96, 4
v_add_u32 v36, s33, v2
s_branch L_w3j_5
L_w3a_4:
v_lshl_add_u32 v36, v37, 4, v36
v_lshl_add_u32 v36, v38, 3, v36
s_lshl_b32 s33, s96, 2
v_add_u32 v36, s33, v36
s_branch L_w3j_5
L_w3m_3:
v_lshl_add_u32 v36, v37, 3, v36
v_lshl_add_u32 v36, v38, 2, v36
s_xor_b32 s33, s93, 1
s_lshl_b32 s33, s33, 4
v_add_u32 v36, s33, v36
L_w3j_5:
v_lshlrev_b32 v36, 4, v36
v_add_u32 v36, s94, v36
s_mul_i32 s31, s34, 9216
v_lshl_add_u32 v43, v3, 9, v36
v_add_u32 v43, s31, v43
s_lshr_b32 s31, s34, 1
s_lshl_b32 s31, s31, 9
s_and_b32 s33, s34, 1
s_lshl_b32 s33, s33, 3
s_add_u32 s31, s31, s33
s_add_u32 s31, s31, 36864
v_add_u32 v44, s31, v36
s_waitcnt vmcnt(6)
s_barrier
ds_read_b64_tr_b16 v[84:85], v45 offset:20480
ds_read_b64_tr_b16 v[86:87], v45 offset:20992
ds_read_b64_tr_b16 v[88:89], v45 offset:24576
ds_read_b64_tr_b16 v[90:91], v45 offset:25088
ds_read_b64_tr_b16 v[92:93], v45 offset:28672
ds_read_b64_tr_b16 v[94:95], v45 offset:29184
ds_read_b64_tr_b16 v[96:97], v45 offset:32768
ds_read_b64_tr_b16 v[98:99], v45 offset:33280
ds_read_b64_tr_b16 v[100:101], v45 offset:36864
ds_read_b64_tr_b16 v[102:103], v45 offset:37376
v_mov_b32 v36, 1073741824
v_mov_b32 v46, 0
v_cndmask_b32 v37, v36, v43, s[50:51]
s_add_u32 s31, s36, 0
s_waitcnt lgkmcnt(8)
buffer_store_dwordx4 v[84:87], v43, s[4:7], s31 offen sc1
s_add_u32 s31, s36, 2048
s_waitcnt lgkmcnt(6)
buffer_store_dwordx4 v[88:91], v43, s[4:7], s31 offen sc1
s_add_u32 s31, s36, 4096
s_waitcnt lgkmcnt(4)
buffer_store_dwordx4 v[92:95], v43, s[4:7], s31 offen sc1
s_add_u32 s31, s36, 6144
s_waitcnt lgkmcnt(2)
buffer_store_dwordx4 v[96:99], v43, s[4:7], s31 offen sc1
s_add_u32 s31, s36, 8192
s_waitcnt lgkmcnt(0)
buffer_store_dwordx4 v[100:103], v37, s[4:7], s31 offen sc1
v_mov_b32 v37, 0x3f803f80
v_dot2c_f32_bf16 v46, v84, v37
v_dot2c_f32_bf16 v46, v85, v37
v_dot2c_f32_bf16 v46, v86, v37
v_dot2c_f32_bf16 v46, v87, v37
v_dot2c_f32_bf16 v46, v88, v37
v_dot2c_f32_bf16 v46, v89, v37
v_dot2c_f32_bf16 v46, v90, v37
v_dot2c_f32_bf16 v46, v91, v37
v_dot2c_f32_bf16 v46, v92, v37
v_dot2c_f32_bf16 v46, v93, v37
v_dot2c_f32_bf16 v46, v94, v37
v_dot2c_f32_bf16 v46, v95, v37
v_dot2c_f32_bf16 v46, v96, v37
v_dot2c_f32_bf16 v46, v97, v37
v_dot2c_f32_bf16 v46, v98, v37
v_dot2c_f32_bf16 v46, v99, v37
v_dot2c_f32_bf16 v46, v100, v37
v_dot2c_f32_bf16 v46, v101, v37
v_dot2c_f32_bf16 v46, v102, v37
v_dot2c_f32_bf16 v46, v103, v37
s_nop 2
v_mov_b32 v37, v46
s_nop 1
v_permlane32_swap_b32 v46, v37
v_add_f32 v46, v46, v37
v_mov_b32 v37, v46
s_nop 1
v_permlane16_swap_b32 v46, v37
v_add_f32 v46, v46, v37
v_cvt_pk_bf16_f32 v50, v46, v46
v_and_b32 v37, 0xffff0000, v50
v_sub_f32 v37, v46, v37
v_cvt_pk_bf16_f32 v51, v37, v37
v_cndmask_b32 v36, v36, v44, s[46:47]
buffer_store_dwordx2 v[50:51], v36, s[4:7], s36 offen sc1
s_cmp_lt_u32 s2, 32
s_cbranch_scc1 L_p0_a4
s_cmp_lt_u32 s2, 176
s_cbranch_scc1 L_p0_b4
v_lshrrev_b32 v39, 2, v2
v_and_b32 v40, 3, v2
v_lshlrev_b32 v40, 3, v40
s_lshl_b32 s31, s24, 5
v_add_u32 v40, s31, v40
v_lshrrev_b32 v47, 1, v39
v_mul_u32_u24 v47, 18, v47
v_and_b32 v41, 1, v39
v_add3_u32 v47, v47, v41, 16
v_add_u32 v36, 0, v3
v_cmp_le_u32 vcc, 9, v36
v_subrev_u32 v37, 9, v36
v_mov_b32 v38, 72
v_cndmask_b32 v36, v36, v37, vcc
v_cndmask_b32 v38, 0, v38, vcc
v_lshrrev_b32 v37, 2, v36
v_mul_u32_u24 v37, 36, v37
v_and_b32 v41, 3, v36
v_lshl_add_u32 v37, v41, 2, v37
v_cmp_eq_u32 vcc, 8, v36
v_add_u32 v37, v37, v39
v_mov_b32 v41, 18
v_cndmask_b32 v37, v37, v47, vcc
v_cndmask_b32 v41, v41, 36, vcc
v_add_u32 v37, v37, v38
v_add_u32 v41, v41, v37
v_min_u32 v37, 159, v37
v_min_u32 v41, 159, v41
v_lshl_add_u32 v52, v37, 7, v40
v_lshl_add_u32 v53, v41, 7, v40
v_add_u32 v36, 4, v3
v_cmp_le_u32 vcc, 9, v36
v_subrev_u32 v37, 9, v36
v_mov_b32 v38, 72
v_cndmask_b32 v36, v36, v37, vcc
v_cndmask_b32 v38, 0, v38, vcc
v_lshrrev_b32 v37, 2, v36
v_mul_u32_u24 v37, 36, v37
v_and_b32 v41, 3, v36
v_lshl_add_u32 v37, v41, 2, v37
v_cmp_eq_u32 vcc, 8, v36
v_add_u32 v37, v37, v39
v_mov_b32 v41, 18
v_cndmask_b32 v37, v37, v47, vcc
v_cndmask_b32 v41, v41, 36, vcc
v_add_u32 v37, v37, v38
v_add_u32 v41, v41, v37
v_min_u32 v37, 159, v37
v_min_u32 v41, 159, v41
v_lshl_add_u32 v54, v37, 7, v40
v_lshl_add_u32 v55, v41, 7, v40
v_add_u32 v36, 8, v3
v_cmp_le_u32 vcc, 9, v36
v_subrev_u32 v37, 9, v36
v_mov_b32 v38, 72
v_cndmask_b32 v36, v36, v37, vcc
v_cndmask_b32 v38, 0, v38, vcc
v_lshrrev_b32 v37, 2, v36
v_mul_u32_u24 v37, 36, v37
v_and_b32 v41, 3, v36
v_lshl_add_u32 v37, v41, 2, v37
v_cmp_eq_u32 vcc, 8, v36
v_add_u32 v37, v37, v39
v_mov_b32 v41, 18
v_cndmask_b32 v37, v37, v47, vcc
v_cndmask_b32 v41, v41, 36, vcc
v_add_u32 v37, v37, v38
v_add_u32 v41, v41, v37
v_min_u32 v37, 159, v37
v_min_u32 v41, 159, v41
v_lshl_add_u32 v56, v37, 7, v40
v_lshl_add_u32 v57, v41, 7, v40
v_add_u32 v36, 12, v3
v_cmp_le_u32 vcc, 9, v36
v_subrev_u32 v37, 9, v36
v_mov_b32 v38, 72
v_cndmask_b32 v36, v36, v37, vcc
v_cndmask_b32 v38, 0, v38, vcc
v_lshrrev_b32 v37, 2, v36
v_mul_u32_u24 v37, 36, v37
v_and_b32 v41, 3, v36
v_lshl_add_u32 v37, v41, 2, v37
v_cmp_eq_u32 vcc, 8, v36
v_add_u32 v37, v37, v39
v_mov_b32 v41, 18
v_cndmask_b32 v37, v37, v47, vcc
v_cndmask_b32 v41, v41, 36, vcc
v_add_u32 v37, v37, v38
v_add_u32 v41, v41, v37
v_min_u32 v37, 159, v37
v_min_u32 v41, 159, v41
v_lshl_add_u32 v58, v37, 7, v40
v_lshl_add_u32 v59, v41, 7, v40
v_add_u32 v36, 16, v3
v_cmp_le_u32 vcc, 9, v36
v_subrev_u32 v37, 9, v36
v_mov_b32 v38, 72
v_cndmask_b32 v36, v36, v37, vcc
v_cndmask_b32 v38, 0, v38, vcc
v_lshrrev_b32 v37, 2, v36
v_mul_u32_u24 v37, 36, v37
v_and_b32 v41, 3, v36
v_lshl_add_u32 v37, v41, 2, v37
v_cmp_eq_u32 vcc, 8, v36
v_add_u32 v37, v37, v39
v_mov_b32 v41, 18
v_cndmask_b32 v37, v37, v47, vcc
v_cndmask_b32 v41, v41, 36, vcc
v_add_u32 v37, v37, v38
v_add_u32 v41, v41, v37
v_min_u32 v37, 159, v37
v_min_u32 v41, 159, v41
v_lshl_add_u32 v60, v37, 7, v40
v_lshl_add_u32 v61, v41, 7, v40
s_lshl_b32 s31, s52, 6
s_lshl_b32 s33, s24, 4
s_add_u32 s31, s31, s33
v_add_u32 v36, s31, v2
v_mul_u32_u24 v37, 911, v36
v_lshrrev_b32 v37, 16, v37
v_mul_u32_u24 v38, 72, v37
v_sub_u32 v36, v36, v38
s_mov_b32 s31, 82944
v_mul_lo_u32 v43, v37, s31
s_mul_i32 s31, s37, 18
v_add_u32 v37, s31, v3
v_and_b32 v38, 3, v37
v_lshrrev_b32 v37, 2, v37
v_mul_u32_u24 v37, 4608, v37
v_add_u32 v43, v43, v37
v_add_u32 v43, 2121728, v43
v_lshrrev_b32 v39, 5, v36
v_lshlrev_b32 v39, 11, v39
v_bfe_u32 v40, v36, 2, 1
v_lshl_add_u32 v39, v40, 10, v39
v_bfe_u32 v40, v36, 3, 2
v_lshl_add_u32 v39, v40, 6, v39
v_and_b32 v40, 3, v36
v_lshl_add_u32 v39, v40, 4, v39
v_lshl_add_u32 v39, v38, 8, v39
v_lshlrev_b32 v40, 4, v36
v_add_u32 v40, 3072, v40
v_lshl_add_u32 v40, v38, 7, v40
v_cmp_gt_u32 vcc, 64, v36
s_nop 1
v_cndmask_b32 v39, v40, v39, vcc
v_add_u32 v43, v43, v39
s_waitcnt vmcnt(6)
s_barrier
ds_read_b64_tr_b16 v[104:105], v52 offset:40960
ds_read_b64_tr_b16 v[106:107], v53 offset:40960
ds_read_b64_tr_b16 v[108:109], v54 offset:40960
ds_read_b64_tr_b16 v[110:111], v55 offset:40960
ds_read_b64_tr_b16 v[112:113], v56 offset:40960
ds_read_b64_tr_b16 v[114:115], v57 offset:40960
ds_read_b64_tr_b16 v[116:117], v58 offset:40960
ds_read_b64_tr_b16 v[118:119], v59 offset:40960
ds_read_b64_tr_b16 v[120:121], v60 offset:40960
ds_read_b64_tr_b16 v[122:123], v61 offset:40960
v_mov_b32 v36, 1073741824
v_mov_b32 v46, 0
v_cndmask_b32 v37, v36, v43, s[50:51]
s_add_u32 s31, s53, 0
s_waitcnt lgkmcnt(8)
buffer_store_dwordx4 v[104:107], v43, s[4:7], s31 offen sc1
s_add_u32 s31, s53, 4608
s_waitcnt lgkmcnt(6)
buffer_store_dwordx4 v[108:111], v43, s[4:7], s31 offen sc1
s_add_u32 s31, s53, 9216
s_waitcnt lgkmcnt(4)
buffer_store_dwordx4 v[112:115], v43, s[4:7], s31 offen sc1
s_add_u32 s31, s53, 13824
s_waitcnt lgkmcnt(2)
buffer_store_dwordx4 v[116:119], v43, s[4:7], s31 offen sc1
s_add_u32 s31, s53, 18432
s_waitcnt lgkmcnt(0)
buffer_store_dwordx4 v[120:123], v37, s[4:7], s31 offen sc1
buffer_store_dwordx2 v[50:51], v36, s[4:7], s53 offen sc1
s_branch L_p0_j4
L_p0_b4:
s_lshl_b32 s31, s52, 6
s_lshl_b32 s33, s24, 4
s_add_u32 s31, s31, s33
v_add_u32 v36, s31, v2
v_mul_u32_u24 v37, 911, v36
v_lshrrev_b32 v37, 16, v37
v_mul_u32_u24 v38, 72, v37
v_sub_u32 v36, v36, v38
s_mov_b32 s31, 331776
v_mul_lo_u32 v43, v37, s31
s_mul_i32 s31, s37, 18
v_add_u32 v37, s31, v3
v_and_b32 v38, 3, v37
v_lshrrev_b32 v37, 2, v37
v_mul_u32_u24 v37, 4608, v37
v_add_u32 v43, v43, v37
v_add_u32 v43, 8241152, v43
v_lshrrev_b32 v39, 5, v36
v_lshlrev_b32 v39, 11, v39
v_bfe_u32 v40, v36, 2, 1
v_lshl_add_u32 v39, v40, 10, v39
v_bfe_u32 v40, v36, 3, 2
v_lshl_add_u32 v39, v40, 6, v39
v_and_b32 v40, 3, v36
v_lshl_add_u32 v39, v40, 4, v39
v_lshl_add_u32 v39, v38, 8, v39
v_lshlrev_b32 v40, 4, v36
v_add_u32 v40, 3072, v40
v_lshl_add_u32 v40, v38, 7, v40
v_cmp_gt_u32 vcc, 64, v36
s_nop 1
v_cndmask_b32 v39, v40, v39, vcc
v_add_u32 v43, v43, v39
s_waitcnt vmcnt(6)
s_barrier
ds_read_b64_tr_b16 v[104:105], v45 offset:40960
ds_read_b64_tr_b16 v[106:107], v45 offset:41472
ds_read_b64_tr_b16 v[108:109], v45 offset:45056
ds_read_b64_tr_b16 v[110:111], v45 offset:45568
ds_read_b64_tr_b16 v[112:113], v45 offset:49152
ds_read_b64_tr_b16 v[114:115], v45 offset:49664
ds_read_b64_tr_b16 v[116:117], v45 offset:53248
ds_read_b64_tr_b16 v[118:119], v45 offset:53760
ds_read_b64_tr_b16 v[120:121], v45 offset:57344
ds_read_b64_tr_b16 v[122:123], v45 offset:57856
v_mov_b32 v36, 1073741824
v_mov_b32 v46, 0
v_cndmask_b32 v37, v36, v43, s[50:51]
s_add_u32 s31, s53, 0
s_waitcnt lgkmcnt(8)
buffer_store_dwordx4 v[104:107], v43, s[4:7], s31 offen sc1
s_add_u32 s31, s53, 4608
s_waitcnt lgkmcnt(6)
buffer_store_dwordx4 v[108:111], v43, s[4:7], s31 offen sc1
s_add_u32 s31, s53, 9216
s_waitcnt lgkmcnt(4)
buffer_store_dwordx4 v[112:115], v43, s[4:7], s31 offen sc1
s_add_u32 s31, s53, 13824
s_waitcnt lgkmcnt(2)
buffer_store_dwordx4 v[116:119], v43, s[4:7], s31 offen sc1
s_add_u32 s31, s53, 18432
s_waitcnt lgkmcnt(0)
buffer_store_dwordx4 v[120:123], v37, s[4:7], s31 offen sc1
buffer_store_dwordx2 v[50:51], v36, s[4:7], s53 offen sc1
s_branch L_p0_j4
L_p0_a4:
s_lshl_b32 s92, s52, 6
s_lshl_b32 s33, s24, 4
s_add_u32 s92, s92, s33
s_cmp_ge_u32 s92, 2304
s_cselect_b32 s93, 1, 0
s_cselect_b32 s33, 2304, 0
s_sub_u32 s92, s92, s33
s_mul_i32 s94, s92, 1821
s_lshr_b32 s94, s94, 19
s_mul_i32 s33, s94, 288
s_sub_u32 s92, s92, s33
s_lshr_b32 s95, s92, 5
s_bfe_u32 s96, s92, 0x10004
s_lshl_b32 s94, s94, 1
s_cmp_ge_u32 s92, 144
s_addc_u32 s94, s94, 0
s_cmp_gt_u32 s95, 4
s_cselect_b32 s33, 5, 0
s_sub_u32 s97, s95, s33
s_cmp_eq_u32 s93, 0
s_cselect_b32 s33, 5, 0
s_add_u32 s97, s97, s33
s_cmp_eq_u32 s95, 4
s_cselect_b32 s97, 4, s97
s_mul_i32 s94, s94, 9
s_add_u32 s94, s94, s97
s_mul_i32 s94, s94, 37888
s_add_u32 s94, s94, 2785280
v_and_b32 v36, 3, v2
v_bfe_u32 v37, v2, 2, 1
v_bfe_u32 v38, v2, 3, 1
s_cmp_eq_u32 s95, 4
s_cbranch_scc1 L_w3m_6
s_cmp_eq_u32 s93, 0
s_cbranch_scc1 L_w3a_7
s_lshl_b32 s33, s96, 4
v_add_u32 v36, s33, v2
s_branch L_w3j_8
L_w3a_7:
v_lshl_add_u32 v36, v37, 4, v36
v_lshl_add_u32 v36, v38, 3, v36
s_lshl_b32 s33, s96, 2
v_add_u32 v36, s33, v36
s_branch L_w3j_8
L_w3m_6:
v_lshl_add_u32 v36, v37, 3, v36
v_lshl_add_u32 v36, v38, 2, v36
s_xor_b32 s33, s93, 1
s_lshl_b32 s33, s33, 4
v_add_u32 v36, s33, v36
L_w3j_8:
v_lshlrev_b32 v36, 4, v36
v_add_u32 v36, s94, v36
s_mul_i32 s31, s37, 9216
v_lshl_add_u32 v43, v3, 9, v36
v_add_u32 v43, s31, v43
s_lshr_b32 s31, s37, 1
s_lshl_b32 s31, s31, 9
s_and_b32 s33, s37, 1
s_lshl_b32 s33, s33, 3
s_add_u32 s31, s31, s33
s_add_u32 s31, s31, 36864
v_add_u32 v44, s31, v36
s_waitcnt vmcnt(6)
s_barrier
ds_read_b64_tr_b16 v[104:105], v45 offset:40960
ds_read_b64_tr_b16 v[106:107], v45 offset:41472
ds_read_b64_tr_b16 v[108:109], v45 offset:45056
ds_read_b64_tr_b16 v[110:111], v45 offset:45568
ds_read_b64_tr_b16 v[112:113], v45 offset:49152
ds_read_b64_tr_b16 v[114:115], v45 offset:49664
ds_read_b64_tr_b16 v[116:117], v45 offset:53248
ds_read_b64_tr_b16 v[118:119], v45 offset:53760
ds_read_b64_tr_b16 v[120:121], v45 offset:57344
ds_read_b64_tr_b16 v[122:123], v45 offset:57856
v_mov_b32 v36, 1073741824
v_mov_b32 v46, 0
v_cndmask_b32 v37, v36, v43, s[50:51]
s_add_u32 s31, s53, 0
s_waitcnt lgkmcnt(8)
buffer_store_dwordx4 v[104:107], v43, s[4:7], s31 offen sc1
s_add_u32 s31, s53, 2048
s_waitcnt lgkmcnt(6)
buffer_store_dwordx4 v[108:111], v43, s[4:7], s31 offen sc1
s_add_u32 s31, s53, 4096
s_waitcnt lgkmcnt(4)
buffer_store_dwordx4 v[112:115], v43, s[4:7], s31 offen sc1
s_add_u32 s31, s53, 6144
s_waitcnt lgkmcnt(2)
buffer_store_dwordx4 v[116:119], v43, s[4:7], s31 offen sc1
s_add_u32 s31, s53, 8192
s_waitcnt lgkmcnt(0)
buffer_store_dwordx4 v[120:123], v37, s[4:7], s31 offen sc1
v_mov_b32 v37, 0x3f803f80
v_dot2c_f32_bf16 v46, v104, v37
v_dot2c_f32_bf16 v46, v105, v37
v_dot2c_f32_bf16 v46, v106, v37
v_dot2c_f32_bf16 v46, v107, v37
v_dot2c_f32_bf16 v46, v108, v37
v_dot2c_f32_bf16 v46, v109, v37
v_dot2c_f32_bf16 v46, v110, v37
v_dot2c_f32_bf16 v46, v111, v37
v_dot2c_f32_bf16 v46, v112, v37
v_dot2c_f32_bf16 v46, v113, v37
v_dot2c_f32_bf16 v46, v114, v37
v_dot2c_f32_bf16 v46, v115, v37
v_dot2c_f32_bf16 v46, v116, v37
v_dot2c_f32_bf16 v46, v117, v37
v_dot2c_f32_bf16 v46, v118, v37
v_dot2c_f32_bf16 v46, v119, v37
v_dot2c_f32_bf16 v46, v120, v37
v_dot2c_f32_bf16 v46, v121, v37
v_dot2c_f32_bf16 v46, v122, v37
v_dot2c_f32_bf16 v46, v123, v37
s_nop 2
v_mov_b32 v37, v46
s_nop 1
v_permlane32_swap_b32 v46, v37
v_add_f32 v46, v46, v37
v_mov_b32 v37, v46
s_nop 1
v_permlane16_swap_b32 v46, v37
v_add_f32 v46, v46, v37
v_cvt_pk_bf16_f32 v50, v46, v46
v_and_b32 v37, 0xffff0000, v50
v_sub_f32 v37, v46, v37
v_cvt_pk_bf16_f32 v51, v37, v37
v_cndmask_b32 v36, v36, v44, s[46:47]
buffer_store_dwordx2 v[50:51], v36, s[4:7], s53 offen sc1
L_p0_j4:
s_mov_b32 s12, s74
s_mov_b32 s13, s75
s_mov_b32 s14, 8388608
s_mov_b32 s15, 0x20000
s_lshl_b32 s30, s25, 2
s_add_u32 s30, s30, s24
s_lshl_b32 s30, s30, 17
s_lshl_b32 s98, s26, 8
s_add_u32 s98, s98, s30
s_lshl_b32 s101, s26, 12
s_add_u32 s101, s101, s30
s_add_u32 s101, s101, 10895360
s_lshl_b32 s63, s24, 13
s_add_u32 s63, s63, 61440
s_mov_b32 m0, s63
v_add_u32 v36, 0, v3
v_xor_b32 v37, v36, v2
v_lshlrev_b32 v36, 12, v36
v_lshl_add_u32 v156, v37, 4, v36
v_lshlrev_b32 v37, 4, v37
v_lshl_add_u32 v37, v2, 8, v37
v_add_u32 v160, s63, v37
v_add_u32 v36, 4, v3
v_xor_b32 v37, v36, v2
v_lshlrev_b32 v36, 12, v36
v_lshl_add_u32 v157, v37, 4, v36
v_lshlrev_b32 v37, 4, v37
v_lshl_add_u32 v37, v2, 8, v37
v_add_u32 v161, s63, v37
v_subrev_u32 v157, 1024, v157
v_add_u32 v36, 8, v3
v_xor_b32 v37, v36, v2
v_lshlrev_b32 v36, 12, v36
v_lshl_add_u32 v158, v37, 4, v36
v_lshlrev_b32 v37, 4, v37
v_lshl_add_u32 v37, v2, 8, v37
v_add_u32 v162, s63, v37
v_subrev_u32 v158, 2048, v158
v_add_u32 v36, 12, v3
v_xor_b32 v37, v36, v2
v_lshlrev_b32 v36, 12, v36
v_lshl_add_u32 v159, v37, 4, v36
v_lshlrev_b32 v37, 4, v37
v_lshl_add_u32 v37, v2, 8, v37
v_add_u32 v163, s63, v37
v_subrev_u32 v159, 3072, v159
buffer_load_dwordx4 v156, s[12:15], s98 offen offset:0 nt lds
buffer_load_dwordx4 v157, s[12:15], s98 offen offset:1024 nt lds
buffer_load_dwordx4 v158, s[12:15], s98 offen offset:2048 nt lds
buffer_load_dwordx4 v159, s[12:15], s98 offen offset:3072 nt lds
s_add_u32 m0, s63, 4096
s_add_u32 s98, s98, 65536
buffer_load_dwordx4 v156, s[12:15], s98 offen offset:0 nt lds
buffer_load_dwordx4 v157, s[12:15], s98 offen offset:1024 nt lds
buffer_load_dwordx4 v158, s[12:15], s98 offen offset:2048 nt lds
buffer_load_dwordx4 v159, s[12:15], s98 offen offset:3072 nt lds
s_cmp_eq_u32 s24, 1
s_cbranch_scc0 L_p0done_10
v_lshrrev_b32 v41, 4, v1
s_lshl_b32 s30, s25, 3
s_sub_u32 s30, s30, 1
v_add_u32 v36, s30, v41
v_max_i32 v36, 0, v36
s_lshl_b32 s30, s27, 2
v_add_u32 v37, s30, v2
v_cndmask_b32 v36, v37, v36, s[46:47]
v_bfe_u32 v37, v41, 2, 1
v_mul_u32_u24 v37, 35, v37
s_mul_i32 s30, s26, 36
v_add_u32 v37, s30, v37
v_lshrrev_b32 v37, 6, v37
v_bfe_u32 v38, v41, 3, 2
v_mad_u32_u24 v37, v38, 9, v37
v_and_b32 v38, 3, v41
v_lshl_add_u32 v37, v37, 2, v38
v_add_u32 v37, 128, v37
v_cndmask_b32 v36, v37, v36, s[50:51]
v_lshlrev_b32 v36, 7, v36
s_mov_b32 s30, 19283968
s_mov_b32 s31, 0
s_mov_b32 exec_lo, 0x000f01ff
s_mov_b32 exec_hi, 0x00ffffff
L_p0poll_9:
buffer_load_dwordx2 v[50:51], v36, s[4:7], s30 offen sc1
s_add_u32 s31, s31, 1
s_waitcnt vmcnt(0)
v_cmp_ne_u64 vcc, v[50:51], v[238:239]
s_cmp_gt_u32 s31, 200000
s_cbranch_scc1 L_p0done_10
s_cbranch_vccnz L_p0poll_9
L_p0done_10:
s_mov_b64 exec, -1
s_barrier
s_lshl_b32 s30, s27, 2
s_add_u32 s30, s30, s24
s_mul_i32 s30, s30, 18432
s_mul_i32 s31, s28, 2304
s_add_u32 s30, s30, s31
s_add_u32 s30, s30, 0
v_and_b32 v6, 1, v3
v_lshlrev_b32 v6, 3, v6
v_lshl_add_u32 v6, v2, 4, v6
buffer_load_dwordx4 v[36:39], v1, s[8:11], s30 offen sc1
buffer_load_dwordx4 v[40:43], v1, s[8:11], s30 offen offset:1024 sc1
buffer_load_dwordx2 v[44:45], v6, s[8:11], s30 offen offset:2048 sc1
s_mul_i32 s36, s26, 132608
s_mul_i32 s38, s24, 12288
s_add_u32 m0, s38, 0
s_add_u32 s39, s38, s36
buffer_load_dwordx4 v1, s[4:7], s39 offen offset:0 sc1 lds
buffer_load_dwordx4 v1, s[4:7], s39 offen offset:1024 sc1 lds
buffer_load_dwordx4 v1, s[4:7], s39 offen offset:2048 sc1 lds
buffer_load_dwordx4 v1, s[4:7], s39 offen offset:3072 sc1 lds
s_add_u32 m0, m0, 4096
s_add_u32 s39, s39, 4096
buffer_load_dwordx4 v1, s[4:7], s39 offen offset:0 sc1 lds
buffer_load_dwordx4 v1, s[4:7], s39 offen offset:1024 sc1 lds
buffer_load_dwordx4 v1, s[4:7], s39 offen offset:2048 sc1 lds
buffer_load_dwordx4 v1, s[4:7], s39 offen offset:3072 sc1 lds
s_add_u32 m0, m0, 4096
s_add_u32 s39, s39, 4096
buffer_load_dwordx4 v1, s[4:7], s39 offen offset:0 sc1 lds
buffer_load_dwordx4 v1, s[4:7], s39 offen offset:1024 sc1 lds
buffer_load_dwordx4 v1, s[4:7], s39 offen offset:2048 sc1 lds
buffer_load_dwordx4 v1, s[4:7], s39 offen offset:3072 sc1 lds
v_and_b32 v6, 1, v2
v_cmp_eq_u32 s[40:41], 1, v6
v_lshl_add_u32 v6, v3, 2, v6
v_cmp_le_u32 s[42:43], v6, v2
v_add_u32 v6, 2, v6
v_cmp_le_u32 s[44:45], v6, v2
v_mov_b32 v6, 0x0c0c0100
v_mov_b32 v7, 0x01000c0c
v_cndmask_b32 v6, v6, v7, s[40:41]
v_mov_b32 v8, 0x0c0c0c0c
v_cndmask_b32 v10, v6, v8, s[42:43]
v_cndmask_b32 v12, v8, v6, s[42:43]
v_mov_b32 v6, 0x0c0c0302
v_mov_b32 v7, 0x03020c0c
v_cndmask_b32 v6, v6, v7, s[40:41]
v_cndmask_b32 v11, v6, v8, s[44:45]
v_cndmask_b32 v13, v8, v6, s[44:45]
s_mul_i32 s82, s26, 340992
s_add_u32 s82, s82, 2785280
s_mul_i32 s83, s28, 331776
s_add_u32 s83, s83, 8241152
s_and_b32 s30, s27, 1
s_mul_i32 s30, s30, 165888
s_add_u32 s83, s83, s30
s_waitcnt vmcnt(12)
v_lshlrev_b32 v16, 16, v36
v_and_b32 v17, 0xffff0000, v36
v_lshlrev_b32 v18, 16, v37
v_and_b32 v19, 0xffff0000, v37
v_lshlrev_b32 v20, 16, v38
v_and_b32 v21, 0xffff0000, v38
v_lshlrev_b32 v22, 16, v39
v_and_b32 v23, 0xffff0000, v39
v_lshlrev_b32 v24, 16, v40
v_and_b32 v25, 0xffff0000, v40
v_lshlrev_b32 v26, 16, v41
v_and_b32 v27, 0xffff0000, v41
v_lshlrev_b32 v28, 16, v42
v_and_b32 v29, 0xffff0000, v42
v_lshlrev_b32 v30, 16, v43
v_and_b32 v31, 0xffff0000, v43
v_lshlrev_b32 v32, 16, v44
v_and_b32 v33, 0xffff0000, v44
v_lshlrev_b32 v34, 16, v45
v_and_b32 v35, 0xffff0000, v45
ds_read_b128 a[232:235], v160 offset:0
ds_read_b128 a[236:239], v161 offset:0
ds_read_b128 a[240:243], v162 offset:0
ds_read_b128 a[244:247], v163 offset:0
ds_read_b128 a[248:251], v160 offset:4096
ds_read_b128 a[252:255], v161 offset:4096
ds_read_b128 v[240:243], v162 offset:4096
ds_read_b128 v[244:247], v163 offset:4096
s_waitcnt lgkmcnt(0)
v_mov_b32 v6, 0
s_barrier
v_mov_b32 v248, v238
s_mov_b64 exec, 1
buffer_store_dwordx2 v[238:239], v6, s[4:7], s100 offen sc1
s_mov_b64 exec, -1
s_mul_i32 s36, s26, 132608
s_mul_i32 s38, s24, 9216
s_add_u32 m0, s38, 49152
s_add_u32 s39, s38, s36
s_add_u32 s39, s39, 49152
buffer_load_dwordx4 v1, s[4:7], s39 offen offset:0 sc1 lds
buffer_load_dwordx4 v1, s[4:7], s39 offen offset:1024 sc1 lds
buffer_load_dwordx4 v1, s[4:7], s39 offen offset:2048 sc1 lds
buffer_load_dwordx4 v1, s[4:7], s39 offen offset:3072 sc1 lds
s_add_u32 m0, m0, 4096
s_add_u32 s39, s39, 4096
buffer_load_dwordx4 v1, s[4:7], s39 offen offset:0 sc1 lds
buffer_load_dwordx4 v1, s[4:7], s39 offen offset:1024 sc1 lds
buffer_load_dwordx4 v1, s[4:7], s39 offen offset:2048 sc1 lds
buffer_load_dwordx4 v1, s[4:7], s39 offen offset:3072 sc1 lds
s_add_u32 m0, m0, 4096
s_add_u32 s39, s39, 4096
buffer_load_dwordx4 v1, s[4:7], s39 offen offset:0 sc1 lds
s_lshl_b32 s60, s25, 3
s_sub_u32 s61, s60, 1
s_max_i32 s61, s61, 0
s_lshl_b32 s30, s24, 1
s_add_u32 s60, s60, s30
s_mul_i32 s30, s61, 18432
s_mul_i32 s62, s60, 18432
v_add_u32 v237, 18432, v1
s_mul_i32 s38, s24, 5120
s_add_u32 m0, s38, 135168
s_add_u32 s39, s38, s30
L_layer:
buffer_load_dwordx4 v1, s[8:11], s39 offen offset:0 sc1 lds
buffer_load_dwordx4 v1, s[8:11], s39 offen offset:1024 sc1 lds
buffer_load_dwordx4 v1, s[8:11], s39 offen offset:2048 sc1 lds
buffer_load_dwordx4 v1, s[8:11], s39 offen offset:3072 sc1 lds
s_add_u32 m0, m0, 4096
s_add_u32 s39, s39, 4096
buffer_load_dwordx4 v1, s[8:11], s39 offen offset:0 sc1 lds
s_barrier
buffer_load_dwordx4 a[0:3], v1, s[8:11], s62 offen offset:0 sc1
buffer_load_dwordx4 a[4:7], v237, s[8:11], s62 offen offset:0 sc1
s_barrier
buffer_load_dwordx4 a[8:11], v1, s[8:11], s62 offen offset:1024 sc1
buffer_load_dwordx4 a[12:15], v237, s[8:11], s62 offen offset:1024 sc1
s_barrier
buffer_load_dwordx4 a[16:19], v1, s[8:11], s62 offen offset:2048 sc1
buffer_load_dwordx4 a[20:23], v237, s[8:11], s62 offen offset:2048 sc1
s_barrier
buffer_load_dwordx4 a[24:27], v1, s[8:11], s62 offen offset:3072 sc1
buffer_load_dwordx4 a[28:31], v237, s[8:11], s62 offen offset:3072 sc1
s_barrier
s_add_u32 s62, s62, 4096
buffer_load_dwordx4 a[32:35], v1, s[8:11], s62 offen offset:0 sc1
buffer_load_dwordx4 a[36:39], v237, s[8:11], s62 offen offset:0 sc1
s_barrier
buffer_load_dwordx4 a[40:43], v1, s[8:11], s62 offen offset:1024 sc1
buffer_load_dwordx4 a[44:47], v237, s[8:11], s62 offen offset:1024 sc1
s_sub_u32 s30, s60, 2
v_add_u32 v6, s30, v3
v_max_i32 v6, 0, v6
v_mov_b32 v7, s61
v_cndmask_b32 v6, v6, v7, s[46:47]
v_lshl_add_u32 v6, v6, 4, v2
v_lshlrev_b32 v129, 3, v6
s_lshl_b32 s30, s24, 10
v_add_u32 v125, s30, v1
v_add_u32 v126, 135168, v1
v_lshrrev_b32 v127, 1, v1
v_add_u32 v127, 129024, v127
s_lshl_b32 s30, s24, 9
v_add_u32 v128, s30, v127
v_add_u32 v8, 64512, v1
s_waitcnt vmcnt(12)
s_barrier
ds_read_b128 a[144:147], v1 offset:0
ds_read_b128 a[148:151], v1 offset:1024
ds_read_b128 a[152:155], v1 offset:2048
ds_read_b128 a[156:159], v1 offset:3072
ds_read_b128 a[160:163], v1 offset:4096
ds_read_b128 a[164:167], v1 offset:5120
ds_read_b128 a[168:171], v1 offset:6144
ds_read_b128 a[172:175], v125 offset:0
ds_read_b128 a[176:179], v126 offset:0
v_lshrrev_b32 v146, 1, v1
s_lshl_b32 s66, s24, 9
s_add_u32 s66, s66, 19316736
s_waitcnt lgkmcnt(0)
s_waitcnt vmcnt(10)
v_mfma_f32_16x16x32_bf16 v[36:39], a[144:147], a[0:3], 0
ds_read_b128 a[180:183], v1 offset:7168
buffer_load_dwordx4 a[48:51], v1, s[8:11], s62 offen offset:2048 sc1
v_mfma_f32_16x16x32_bf16 v[64:67], a[144:147], a[4:7], 0
ds_read_b128 a[184:187], v1 offset:8192
v_mfma_f32_16x16x32_bf16 v[40:43], a[148:151], a[0:3], 0
ds_read_b128 a[188:191], v1 offset:9216
v_mfma_f32_16x16x32_bf16 v[68:71], a[148:151], a[4:7], 0
ds_read_b128 a[192:195], v1 offset:10240
v_mfma_f32_16x16x32_bf16 v[44:47], a[152:155], a[0:3], 0
ds_read_b128 a[196:199], v1 offset:11264
buffer_load_dwordx4 a[52:55], v237, s[8:11], s62 offen offset:2048 sc1
v_mfma_f32_16x16x32_bf16 v[72:75], a[152:155], a[4:7], 0
ds_read_b128 a[200:203], v1 offset:12288
v_mfma_f32_16x16x32_bf16 v[48:51], a[156:159], a[0:3], 0
ds_read_b128 a[204:207], v1 offset:13312
v_mfma_f32_16x16x32_bf16 v[76:79], a[156:159], a[4:7], 0
ds_read_b128 a[208:211], v125 offset:7168
v_mfma_f32_16x16x32_bf16 v[52:55], a[160:163], a[0:3], 0
ds_read_b128 a[212:215], v126 offset:1024
buffer_load_dwordx4 a[56:59], v1, s[8:11], s62 offen offset:3072 sc1
v_mfma_f32_16x16x32_bf16 v[80:83], a[160:163], a[4:7], 0
v_mfma_f32_16x16x32_bf16 v[92:95], a[172:175], a[176:179], 0
v_mfma_f32_16x16x32_bf16 v[96:99], a[160:163], a[176:179], 0
v_mfma_f32_16x16x32_bf16 v[56:59], a[164:167], a[0:3], 0
buffer_load_dwordx4 a[60:63], v237, s[8:11], s62 offen offset:3072 sc1
v_mfma_f32_16x16x32_bf16 v[84:87], a[164:167], a[4:7], 0
s_add_u32 s62, s62, 4096
v_mfma_f32_16x16x32_bf16 v[60:63], a[168:171], a[0:3], 0
v_mfma_f32_16x16x32_bf16 v[88:91], a[168:171], a[4:7], 0
s_waitcnt lgkmcnt(0)
s_waitcnt vmcnt(12)
v_mfma_f32_16x16x32_bf16 v[36:39], a[180:183], a[8:11], v[36:39]
ds_read_b128 a[144:147], v1 offset:14336
v_lshlrev_b32 v124, 2, v2
v_mfma_f32_16x16x32_bf16 v[64:67], a[180:183], a[12:15], v[64:67]
ds_read_b128 a[148:151], v1 offset:15360
v_mfma_f32_16x16x32_bf16 v[40:43], a[184:187], a[8:11], v[40:43]
ds_read_b128 a[152:155], v1 offset:16384
v_and_b32 v6, 1, v2
v_mfma_f32_16x16x32_bf16 v[68:71], a[184:187], a[12:15], v[68:71]
ds_read_b128 a[156:159], v1 offset:17408
v_mfma_f32_16x16x32_bf16 v[44:47], a[188:191], a[8:11], v[44:47]
ds_read_b128 a[160:163], v1 offset:18432
v_mfma_f32_16x16x32_bf16 v[72:75], a[188:191], a[12:15], v[72:75]
ds_read_b128 a[164:167], v1 offset:19456
buffer_load_dwordx4 a[64:67], v1, s[8:11], s62 offen offset:0 sc1
v_mfma_f32_16x16x32_bf16 v[48:51], a[192:195], a[8:11], v[48:51]
ds_read_b128 a[168:171], v1 offset:20480
v_lshl_add_u32 v6, v3, 2, v6
v_mfma_f32_16x16x32_bf16 v[76:79], a[192:195], a[12:15], v[76:79]
ds_read_b128 a[172:175], v125 offset:14336
v_lshlrev_b32 v6, 2, v6
v_mfma_f32_16x16x32_bf16 v[52:55], a[196:199], a[8:11], v[52:55]
ds_read_b128 a[176:179], v126 offset:2048
v_mfma_f32_16x16x32_bf16 v[80:83], a[196:199], a[12:15], v[80:83]
buffer_load_dwordx4 a[68:71], v237, s[8:11], s62 offen offset:0 sc1
v_mfma_f32_16x16x32_bf16 v[92:95], a[208:211], a[212:215], v[92:95]
v_add_u32 v122, 64, v6
v_mfma_f32_16x16x32_bf16 v[96:99], a[196:199], a[212:215], v[96:99]
v_mfma_f32_16x16x32_bf16 v[56:59], a[200:203], a[8:11], v[56:59]
v_mfma_f32_16x16x32_bf16 v[84:87], a[200:203], a[12:15], v[84:87]
v_add_u32 v7, 128, v6
v_mfma_f32_16x16x32_bf16 v[60:63], a[204:207], a[8:11], v[60:63]
buffer_load_dwordx4 a[72:75], v1, s[8:11], s62 offen offset:1024 sc1
v_mfma_f32_16x16x32_bf16 v[88:91], a[204:207], a[12:15], v[88:91]
s_mov_b32 s63, 2359296
s_waitcnt lgkmcnt(0)
s_waitcnt vmcnt(13)
v_mfma_f32_16x16x32_bf16 v[36:39], a[144:147], a[16:19], v[36:39]
ds_read_b128 a[180:183], v1 offset:21504
v_cndmask_b32 v122, v122, v7, s[42:43]
v_mfma_f32_16x16x32_bf16 v[64:67], a[144:147], a[20:23], v[64:67]
ds_read_b128 a[184:187], v1 offset:22528
v_mfma_f32_16x16x32_bf16 v[40:43], a[148:151], a[16:19], v[40:43]
ds_read_b128 a[188:191], v1 offset:23552
v_add_u32 v123, 72, v6
v_mfma_f32_16x16x32_bf16 v[68:71], a[148:151], a[20:23], v[68:71]
ds_read_b128 a[192:195], v1 offset:24576
v_mfma_f32_16x16x32_bf16 v[44:47], a[152:155], a[16:19], v[44:47]
ds_read_b128 a[196:199], v1 offset:25600
v_mfma_f32_16x16x32_bf16 v[72:75], a[152:155], a[20:23], v[72:75]
ds_read_b128 a[200:203], v1 offset:26624
v_add_u32 v7, 136, v6
v_mfma_f32_16x16x32_bf16 v[48:51], a[156:159], a[16:19], v[48:51]
ds_read_b128 a[204:207], v1 offset:27648
buffer_load_dwordx2 v[100:101], v129, s[8:11], s63 offen sc1
v_mfma_f32_16x16x32_bf16 v[76:79], a[156:159], a[20:23], v[76:79]
ds_read_b128 a[208:211], v125 offset:21504
v_cndmask_b32 v123, v123, v7, s[44:45]
v_mfma_f32_16x16x32_bf16 v[52:55], a[160:163], a[16:19], v[52:55]
ds_read_b128 a[212:215], v126 offset:3072
s_mul_i32 s36, s26, 132608
v_mfma_f32_16x16x32_bf16 v[80:83], a[160:163], a[20:23], v[80:83]
s_mov_b32 s63, 2375680
v_mfma_f32_16x16x32_bf16 v[92:95], a[172:175], a[176:179], v[92:95]
s_mul_i32 s38, s24, 12288
s_lshl_b32 s31, s24, 5
v_mfma_f32_16x16x32_bf16 v[96:99], a[160:163], a[176:179], v[96:99]
s_add_u32 m0, s38, 86016
v_mfma_f32_16x16x32_bf16 v[56:59], a[164:167], a[16:19], v[56:59]
s_add_u32 s39, s38, s36
v_add_u32 v6, s31, v2
v_mfma_f32_16x16x32_bf16 v[84:87], a[164:167], a[20:23], v[84:87]
s_add_u32 s39, s39, 86016
v_mfma_f32_16x16x32_bf16 v[60:63], a[168:171], a[16:19], v[60:63]
v_mfma_f32_16x16x32_bf16 v[88:91], a[168:171], a[20:23], v[88:91]
s_waitcnt lgkmcnt(0)
s_waitcnt vmcnt(12)
v_mfma_f32_16x16x32_bf16 v[36:39], a[180:183], a[24:27], v[36:39]
ds_read_b128 a[144:147], v1 offset:28672
buffer_load_dwordx2 v[102:103], v129, s[8:11], s63 offen sc1
v_mfma_f32_16x16x32_bf16 v[64:67], a[180:183], a[28:31], v[64:67]
ds_read_b128 a[148:151], v1 offset:29696
v_mul_u32_u24 v220, 176, v6
v_mfma_f32_16x16x32_bf16 v[40:43], a[184:187], a[24:27], v[40:43]
ds_read_b128 a[152:155], v1 offset:30720
v_add_u32 v220, 0, v220
v_mfma_f32_16x16x32_bf16 v[68:71], a[184:187], a[28:31], v[68:71]
ds_read_b128 a[156:159], v1 offset:31744
s_mov_b32 s63, 2392064
v_mfma_f32_16x16x32_bf16 v[44:47], a[188:191], a[24:27], v[44:47]
ds_read_b128 a[160:163], v1 offset:32768
v_lshl_add_u32 v218, v3, 3, v220
v_mfma_f32_16x16x32_bf16 v[72:75], a[188:191], a[28:31], v[72:75]
ds_read_b128 a[164:167], v1 offset:33792
v_mfma_f32_16x16x32_bf16 v[48:51], a[192:195], a[24:27], v[48:51]
ds_read_b128 a[168:171], v1 offset:34816
v_mfma_f32_16x16x32_bf16 v[76:79], a[192:195], a[28:31], v[76:79]
ds_read_b128 a[172:175], v125 offset:28672
buffer_load_dwordx2 v[104:105], v129, s[8:11], s63 offen sc1
v_mfma_f32_16x16x32_bf16 v[52:55], a[196:199], a[24:27], v[52:55]
ds_read_b128 a[176:179], v126 offset:4096
v_mul_u32_u24 v219, 176, v2
v_mfma_f32_16x16x32_bf16 v[80:83], a[196:199], a[28:31], v[80:83]
s_mov_b32 s63, 2408448
v_mfma_f32_16x16x32_bf16 v[92:95], a[208:211], a[212:215], v[92:95]
v_lshl_add_u32 v219, v3, 3, v219
v_mfma_f32_16x16x32_bf16 v[96:99], a[196:199], a[212:215], v[96:99]
v_mfma_f32_16x16x32_bf16 v[56:59], a[200:203], a[24:27], v[56:59]
buffer_load_dwordx4 v1, s[4:7], s39 offen offset:0 sc1 lds
v_add_u32 v219, 0, v219
v_mfma_f32_16x16x32_bf16 v[84:87], a[200:203], a[28:31], v[84:87]
v_mfma_f32_16x16x32_bf16 v[60:63], a[204:207], a[24:27], v[60:63]
v_mfma_f32_16x16x32_bf16 v[88:91], a[204:207], a[28:31], v[88:91]
s_waitcnt lgkmcnt(0)
s_waitcnt vmcnt(13)
v_mfma_f32_16x16x32_bf16 v[36:39], a[144:147], a[32:35], v[36:39]
ds_read_b128 a[180:183], v1 offset:35840
buffer_load_dwordx2 v[106:107], v129, s[8:11], s63 offen sc1
v_mfma_f32_16x16x32_bf16 v[64:67], a[144:147], a[36:39], v[64:67]
ds_read_b128 a[184:187], v1 offset:36864
buffer_load_dwordx4 v1, s[4:7], s39 offen offset:1024 sc1 lds
v_mfma_f32_16x16x32_bf16 v[40:43], a[148:151], a[32:35], v[40:43]
ds_read_b128 a[188:191], v1 offset:37888
v_add_u32 v222, s31, v219
v_mfma_f32_16x16x32_bf16 v[68:71], a[148:151], a[36:39], v[68:71]
ds_read_b128 a[192:195], v1 offset:38912
v_lshrrev_b32 v6, 2, v2
v_mfma_f32_16x16x32_bf16 v[44:47], a[152:155], a[32:35], v[44:47]
ds_read_b128 a[196:199], v1 offset:39936
buffer_load_dwordx4 v1, s[4:7], s39 offen offset:2048 sc1 lds
v_mfma_f32_16x16x32_bf16 v[72:75], a[152:155], a[36:39], v[72:75]
ds_read_b128 a[200:203], v1 offset:40960
s_mov_b32 s63, 2424832
v_mfma_f32_16x16x32_bf16 v[48:51], a[156:159], a[32:35], v[48:51]
ds_read_b128 a[204:207], v1 offset:41984
v_lshl_add_u32 v6, v3, 2, v6
v_mfma_f32_16x16x32_bf16 v[76:79], a[156:159], a[36:39], v[76:79]
ds_read_b128 a[208:211], v125 offset:35840
v_add_u32 v6, s31, v6
v_mfma_f32_16x16x32_bf16 v[52:55], a[160:163], a[32:35], v[52:55]
ds_read_b128 a[212:215], v126 offset:5120
buffer_load_dwordx2 v[108:109], v129, s[8:11], s63 offen sc1
v_mfma_f32_16x16x32_bf16 v[80:83], a[160:163], a[36:39], v[80:83]
buffer_load_dwordx4 v1, s[4:7], s39 offen offset:3072 sc1 lds
v_mul_u32_u24 v221, 176, v6
v_mfma_f32_16x16x32_bf16 v[92:95], a[172:175], a[176:179], v[92:95]
s_mov_b32 s63, 2441216
v_mfma_f32_16x16x32_bf16 v[96:99], a[160:163], a[176:179], v[96:99]
s_add_u32 m0, m0, 4096
v_mfma_f32_16x16x32_bf16 v[56:59], a[164:167], a[32:35], v[56:59]
s_add_u32 s39, s39, 4096
v_and_b32 v6, 3, v2
v_mfma_f32_16x16x32_bf16 v[84:87], a[164:167], a[36:39], v[84:87]
v_mfma_f32_16x16x32_bf16 v[60:63], a[168:171], a[32:35], v[60:63]
v_mfma_f32_16x16x32_bf16 v[88:91], a[168:171], a[36:39], v[88:91]
s_waitcnt lgkmcnt(0)
s_waitcnt vmcnt(16)
v_mfma_f32_16x16x32_bf16 v[36:39], a[180:183], a[40:43], v[36:39]
ds_read_b128 a[144:147], v1 offset:43008
v_lshl_add_u32 v221, v6, 3, v221
v_mfma_f32_16x16x32_bf16 v[64:67], a[180:183], a[44:47], v[64:67]
ds_read_b128 a[148:151], v1 offset:44032
buffer_load_dwordx2 v[110:111], v129, s[8:11], s63 offen sc1
v_mfma_f32_16x16x32_bf16 v[40:43], a[184:187], a[40:43], v[40:43]
ds_read_b128 a[152:155], v1 offset:45056
v_add_u32 v221, 0, v221
v_mfma_f32_16x16x32_bf16 v[68:71], a[184:187], a[44:47], v[68:71]
ds_read_b128 a[156:159], v1 offset:46080
v_mfma_f32_16x16x32_bf16 v[44:47], a[188:191], a[40:43], v[44:47]
ds_read_b128 a[160:163], v1 offset:47104
buffer_load_dwordx4 v1, s[4:7], s39 offen offset:0 sc1 lds
v_mfma_f32_16x16x32_bf16 v[72:75], a[188:191], a[44:47], v[72:75]
ds_read_b128 a[164:167], v1 offset:48128
s_mov_b32 s63, 2457600
v_mfma_f32_16x16x32_bf16 v[48:51], a[192:195], a[40:43], v[48:51]
ds_read_b128 a[168:171], v1 offset:49152
v_mov_b32 v171, 0
v_mfma_f32_16x16x32_bf16 v[76:79], a[192:195], a[44:47], v[76:79]
ds_read_b128 a[172:175], v125 offset:43008
v_mov_b32 v172, 0
v_mfma_f32_16x16x32_bf16 v[52:55], a[196:199], a[40:43], v[52:55]
ds_read_b128 a[176:179], v126 offset:6144
buffer_load_dwordx4 v1, s[4:7], s39 offen offset:1024 sc1 lds
v_mfma_f32_16x16x32_bf16 v[80:83], a[196:199], a[44:47], v[80:83]
v_mov_b32 v179, 0
v_mfma_f32_16x16x32_bf16 v[92:95], a[208:211], a[212:215], v[92:95]
buffer_load_dwordx2 v[112:113], v129, s[8:11], s63 offen sc1
v_mfma_f32_16x16x32_bf16 v[96:99], a[196:199], a[212:215], v[96:99]
s_mov_b32 s63, 2473984
v_mfma_f32_16x16x32_bf16 v[56:59], a[200:203], a[40:43], v[56:59]
buffer_load_dwordx4 v1, s[4:7], s39 offen offset:2048 sc1 lds
v_mov_b32 v180, 0
v_mfma_f32_16x16x32_bf16 v[84:87], a[200:203], a[44:47], v[84:87]
s_lshr_b32 s30, s26, 1
v_mfma_f32_16x16x32_bf16 v[60:63], a[204:207], a[40:43], v[60:63]
s_mul_i32 s30, s30, 2304
v_mfma_f32_16x16x32_bf16 v[88:91], a[204:207], a[44:47], v[88:91]
s_mul_i32 s64, s60, 18432
s_waitcnt lgkmcnt(0)
s_waitcnt vmcnt(19)
v_mfma_f32_16x16x32_bf16 v[36:39], a[144:147], a[48:51], v[36:39]
ds_read_b128 a[180:183], v1 offset:50176
buffer_load_dwordx4 v1, s[4:7], s39 offen offset:3072 sc1 lds
v_mfma_f32_16x16x32_bf16 v[64:67], a[144:147], a[52:55], v[64:67]
ds_read_b128 a[184:187], v1 offset:51200
v_mfma_f32_16x16x32_bf16 v[40:43], a[148:151], a[48:51], v[40:43]
ds_read_b128 a[188:191], v1 offset:52224
buffer_load_dwordx2 v[114:115], v129, s[8:11], s63 offen sc1
v_mfma_f32_16x16x32_bf16 v[68:71], a[148:151], a[52:55], v[68:71]
ds_read_b128 a[192:195], v1 offset:53248
v_mfma_f32_16x16x32_bf16 v[44:47], a[152:155], a[48:51], v[44:47]
ds_read_b128 a[196:199], v1 offset:54272
s_add_u32 m0, m0, 4096
v_mfma_f32_16x16x32_bf16 v[72:75], a[152:155], a[52:55], v[72:75]
ds_read_b128 a[200:203], v1 offset:55296
v_mfma_f32_16x16x32_bf16 v[48:51], a[156:159], a[48:51], v[48:51]
ds_read_b128 a[204:207], v1 offset:56320
buffer_load_dwordx4 a[76:79], v237, s[8:11], s62 offen offset:1024 sc1
v_mfma_f32_16x16x32_bf16 v[76:79], a[156:159], a[52:55], v[76:79]
ds_read_b128 a[208:211], v125 offset:50176
s_add_u32 s30, s30, s64
v_mfma_f32_16x16x32_bf16 v[52:55], a[160:163], a[48:51], v[52:55]
ds_read_b128 a[212:215], v126 offset:7168
s_add_u32 s39, s39, 4096
v_mfma_f32_16x16x32_bf16 v[80:83], a[160:163], a[52:55], v[80:83]
s_add_u32 s30, s30, 2490368
v_mfma_f32_16x16x32_bf16 v[92:95], a[172:175], a[176:179], v[92:95]
s_and_b32 s65, s26, 1
v_mfma_f32_16x16x32_bf16 v[96:99], a[160:163], a[176:179], v[96:99]
buffer_load_dwordx4 a[80:83], v1, s[8:11], s62 offen offset:2048 sc1
v_mfma_f32_16x16x32_bf16 v[56:59], a[164:167], a[48:51], v[56:59]
buffer_load_dwordx4 v1, s[4:7], s39 offen offset:0 sc1 lds
v_mfma_f32_16x16x32_bf16 v[84:87], a[164:167], a[52:55], v[84:87]
s_lshl_b32 s64, s65, 10
v_mfma_f32_16x16x32_bf16 v[60:63], a[168:171], a[48:51], v[60:63]
s_add_u32 s64, s64, s30
v_mfma_f32_16x16x32_bf16 v[88:91], a[168:171], a[52:55], v[88:91]
s_lshl_b32 s65, s65, 3
s_waitcnt lgkmcnt(0)
s_waitcnt vmcnt(22)
v_mfma_f32_16x16x32_bf16 v[36:39], a[180:183], a[56:59], v[36:39]
ds_read_b128 a[144:147], v1 offset:57344
buffer_load_dwordx4 a[84:87], v237, s[8:11], s62 offen offset:2048 sc1
v_mfma_f32_16x16x32_bf16 v[64:67], a[180:183], a[60:63], v[64:67]
ds_read_b128 a[148:151], v1 offset:58368
buffer_load_dwordx4 v1, s[4:7], s39 offen offset:1024 sc1 lds
v_mfma_f32_16x16x32_bf16 v[40:43], a[184:187], a[56:59], v[40:43]
ds_read_b128 a[152:155], v1 offset:59392
v_mfma_f32_16x16x32_bf16 v[68:71], a[184:187], a[60:63], v[68:71]
ds_read_b128 a[156:159], v1 offset:60416
buffer_load_dwordx4 a[88:91], v1, s[8:11], s62 offen offset:3072 sc1
v_mfma_f32_16x16x32_bf16 v[44:47], a[188:191], a[56:59], v[44:47]
ds_read_b128 a[160:163], v1 offset:61440
buffer_load_dwordx4 v1, s[4:7], s39 offen offset:2048 sc1 lds
v_mfma_f32_16x16x32_bf16 v[72:75], a[188:191], a[60:63], v[72:75]
ds_read_b128 a[164:167], v1 offset:62464
v_mfma_f32_16x16x32_bf16 v[48:51], a[192:195], a[56:59], v[48:51]
ds_read_b128 a[168:171], v1 offset:63488
s_add_u32 s65, s65, s30
v_mfma_f32_16x16x32_bf16 v[76:79], a[192:195], a[60:63], v[76:79]
ds_read_b128 a[172:175], v125 offset:57344
v_mfma_f32_16x16x32_bf16 v[52:55], a[196:199], a[56:59], v[52:55]
ds_read_b128 a[176:179], v126 offset:8192
buffer_load_dwordx4 a[92:95], v237, s[8:11], s62 offen offset:3072 sc1
v_mfma_f32_16x16x32_bf16 v[80:83], a[196:199], a[60:63], v[80:83]
buffer_load_dwordx4 v1, s[4:7], s39 offen offset:3072 sc1 lds
v_mov_b32 v224, 1073741824
v_mfma_f32_16x16x32_bf16 v[92:95], a[208:211], a[212:215], v[92:95]
s_add_u32 s62, s62, 4096
v_mfma_f32_16x16x32_bf16 v[96:99], a[196:199], a[212:215], v[96:99]
v_cndmask_b32 v224, v224, v1, s[46:47]
v_mfma_f32_16x16x32_bf16 v[56:59], a[200:203], a[56:59], v[56:59]
buffer_load_dwordx2 v[148:149], v146, s[4:7], s66 offen sc1
v_mfma_f32_16x16x32_bf16 v[84:87], a[200:203], a[60:63], v[84:87]
v_mfma_f32_16x16x32_bf16 v[60:63], a[204:207], a[56:59], v[60:63]
v_add_u32 v225, 18432, v224
v_mfma_f32_16x16x32_bf16 v[88:91], a[204:207], a[60:63], v[88:91]
s_waitcnt lgkmcnt(0)
s_waitcnt vmcnt(27)
v_add_u32 v125, 64512, v125
v_mfma_f32_16x16x32_bf16 v[36:39], a[144:147], a[64:67], v[36:39]
ds_read_b128 a[180:183], v8 offset:0
buffer_load_dwordx4 a[96:99], v1, s[8:11], s62 offen offset:0 sc1
v_mfma_f32_16x16x32_bf16 v[64:67], a[144:147], a[68:71], v[64:67]
ds_read_b128 a[184:187], v8 offset:1024
v_mfma_f32_16x16x32_bf16 v[40:43], a[148:151], a[64:67], v[40:43]
ds_read_b128 a[188:191], v8 offset:2048
v_mfma_f32_16x16x32_bf16 v[68:71], a[148:151], a[68:71], v[68:71]
ds_read_b128 a[192:195], v8 offset:3072
v_mfma_f32_16x16x32_bf16 v[44:47], a[152:155], a[64:67], v[44:47]
ds_read_b128 a[196:199], v8 offset:4096
buffer_load_dwordx4 a[100:103], v237, s[8:11], s62 offen offset:0 sc1
v_mfma_f32_16x16x32_bf16 v[72:75], a[152:155], a[68:71], v[72:75]
ds_read_b128 a[200:203], v8 offset:5120
v_mfma_f32_16x16x32_bf16 v[48:51], a[156:159], a[64:67], v[48:51]
ds_read_b128 a[204:207], v8 offset:6144
v_mfma_f32_16x16x32_bf16 v[76:79], a[156:159], a[68:71], v[76:79]
ds_read_b128 a[208:211], v125 offset:0
v_mfma_f32_16x16x32_bf16 v[52:55], a[160:163], a[64:67], v[52:55]
ds_read_b128 a[212:215], v126 offset:9216
v_mfma_f32_16x16x32_bf16 v[80:83], a[160:163], a[68:71], v[80:83]
buffer_load_dwordx4 a[104:107], v1, s[8:11], s62 offen offset:1024 sc1
v_mfma_f32_16x16x32_bf16 v[92:95], a[172:175], a[176:179], v[92:95]
v_mfma_f32_16x16x32_bf16 v[96:99], a[160:163], a[176:179], v[96:99]
v_mfma_f32_16x16x32_bf16 v[56:59], a[164:167], a[64:67], v[56:59]
v_mfma_f32_16x16x32_bf16 v[84:87], a[164:167], a[68:71], v[84:87]
buffer_load_dwordx4 a[108:111], v237, s[8:11], s62 offen offset:1024 sc1
v_mfma_f32_16x16x32_bf16 v[60:63], a[168:171], a[64:67], v[60:63]
v_mfma_f32_16x16x32_bf16 v[88:91], a[168:171], a[68:71], v[88:91]
s_waitcnt lgkmcnt(0)
s_waitcnt vmcnt(13)
v_mfma_f32_16x16x32_bf16 v[36:39], a[180:183], a[72:75], v[36:39]
ds_read_b128 a[144:147], v8 offset:7168
v_mfma_f32_16x16x32_bf16 v[64:67], a[180:183], a[76:79], v[64:67]
ds_read_b128 a[148:151], v8 offset:8192
buffer_load_dwordx4 a[112:115], v1, s[8:11], s62 offen offset:2048 sc1
v_mfma_f32_16x16x32_bf16 v[40:43], a[184:187], a[72:75], v[40:43]
ds_read_b128 a[152:155], v8 offset:9216
v_add_f32 v130, v100, v102
v_mfma_f32_16x16x32_bf16 v[68:71], a[184:187], a[76:79], v[68:71]
ds_read_b128 a[156:159], v8 offset:10240
v_add_f32 v131, v101, v103
v_mfma_f32_16x16x32_bf16 v[44:47], a[188:191], a[72:75], v[44:47]
ds_read_b128 a[160:163], v8 offset:11264
v_add_f32 v130, v130, v104
v_mfma_f32_16x16x32_bf16 v[72:75], a[188:191], a[76:79], v[72:75]
ds_read_b128 a[164:167], v8 offset:12288
v_add_f32 v131, v131, v105
v_mfma_f32_16x16x32_bf16 v[48:51], a[192:195], a[72:75], v[48:51]
ds_read_b128 a[168:171], v8 offset:13312
buffer_load_dwordx4 a[116:119], v237, s[8:11], s62 offen offset:2048 sc1
v_mfma_f32_16x16x32_bf16 v[76:79], a[192:195], a[76:79], v[76:79]
ds_read_b128 a[172:175], v125 offset:7168
v_add_f32 v130, v130, v106
v_mfma_f32_16x16x32_bf16 v[52:55], a[196:199], a[72:75], v[52:55]
ds_read_b128 a[176:179], v126 offset:10240
v_add_f32 v131, v131, v107
v_mfma_f32_16x16x32_bf16 v[80:83], a[196:199], a[76:79], v[80:83]
v_add_f32 v130, v130, v108
v_add_f32 v131, v131, v109
v_mfma_f32_16x16x32_bf16 v[92:95], a[208:211], a[212:215], v[92:95]
buffer_load_dwordx4 a[120:123], v1, s[8:11], s62 offen offset:3072 sc1
v_add_f32 v130, v130, v110
v_mfma_f32_16x16x32_bf16 v[96:99], a[196:199], a[212:215], v[96:99]
v_add_f32 v131, v131, v111
v_mfma_f32_16x16x32_bf16 v[56:59], a[200:203], a[72:75], v[56:59]
v_add_f32 v130, v130, v112
v_mfma_f32_16x16x32_bf16 v[84:87], a[200:203], a[76:79], v[84:87]
v_add_f32 v131, v131, v113
v_mfma_f32_16x16x32_bf16 v[60:63], a[204:207], a[72:75], v[60:63]
buffer_load_dwordx4 a[124:127], v237, s[8:11], s62 offen offset:3072 sc1
v_add_f32 v130, v130, v114
v_mfma_f32_16x16x32_bf16 v[88:91], a[204:207], a[76:79], v[88:91]
s_add_u32 s62, s62, 4096
s_waitcnt lgkmcnt(0)
s_waitcnt vmcnt(14)
v_mfma_f32_16x16x32_bf16 v[36:39], a[144:147], a[80:83], v[36:39]
ds_read_b128 a[180:183], v8 offset:14336
v_add_f32 v131, v131, v115
v_mfma_f32_16x16x32_bf16 v[64:67], a[144:147], a[84:87], v[64:67]
ds_read_b128 a[184:187], v8 offset:15360
v_mul_f32 v130, 0x3ae38e39, v130
v_mfma_f32_16x16x32_bf16 v[40:43], a[148:151], a[80:83], v[40:43]
ds_read_b128 a[188:191], v8 offset:16384
v_mul_f32 v6, v130, v130
v_mfma_f32_16x16x32_bf16 v[68:71], a[148:151], a[84:87], v[68:71]
ds_read_b128 a[192:195], v8 offset:17408
v_mul_f32 v131, 0x3ae38e39, v131
v_mfma_f32_16x16x32_bf16 v[44:47], a[152:155], a[80:83], v[44:47]
ds_read_b128 a[196:199], v8 offset:18432
v_sub_f32 v131, v131, v6
v_mfma_f32_16x16x32_bf16 v[72:75], a[152:155], a[84:87], v[72:75]
ds_read_b128 a[200:203], v8 offset:19456
v_max_f32 v131, 0, v131
v_mfma_f32_16x16x32_bf16 v[48:51], a[156:159], a[80:83], v[48:51]
ds_read_b128 a[204:207], v8 offset:20480
v_add_f32 v131, 0x3727c5ac, v131
v_mfma_f32_16x16x32_bf16 v[76:79], a[156:159], a[84:87], v[76:79]
ds_read_b128 a[208:211], v125 offset:14336
buffer_load_dwordx4 a[128:131], v1, s[8:11], s62 offen offset:0 sc1
v_mfma_f32_16x16x32_bf16 v[52:55], a[160:163], a[80:83], v[52:55]
ds_read_b128 a[212:215], v126 offset:11264
v_mfma_f32_16x16x32_bf16 v[80:83], a[160:163], a[84:87], v[80:83]
v_rsq_f32 v132, v131
v_mfma_f32_16x16x32_bf16 v[92:95], a[172:175], a[176:179], v[92:95]
v_cvt_pk_bf16_f32 v6, -v130, -v130
v_and_b32 v6, 0xffff0000, v6
v_mfma_f32_16x16x32_bf16 v[96:99], a[160:163], a[176:179], v[96:99]
buffer_load_dwordx4 a[132:135], v237, s[8:11], s62 offen offset:0 sc1
v_add_f32 v6, v130, v6
v_mfma_f32_16x16x32_bf16 v[56:59], a[164:167], a[80:83], v[56:59]
v_cvt_pk_bf16_f32 v133, -v130, -v6
v_mfma_f32_16x16x32_bf16 v[84:87], a[164:167], a[84:87], v[84:87]
v_mfma_f32_16x16x32_bf16 v[60:63], a[168:171], a[80:83], v[60:63]
v_mfma_f32_16x16x32_bf16 v[88:91], a[168:171], a[84:87], v[88:91]
s_waitcnt lgkmcnt(0)
s_waitcnt vmcnt(12)
s_waitcnt vmcnt(10)
v_cmp_ne_u64 vcc, v[148:149], v[238:239]
s_cmp_eq_u32 s29, 0
s_cselect_b64 vcc, vcc, 0
s_cbranch_vccnz L_dbslow_11
L_dbback_12:
s_barrier
v_mfma_f32_16x16x32_bf16 v[36:39], a[180:183], a[88:91], v[36:39]
ds_read_b128 a[144:147], v8 offset:21504
buffer_load_dwordx4 a[136:139], v1, s[8:11], s62 offen offset:1024 sc1
v_mfma_f32_16x16x32_bf16 v[64:67], a[180:183], a[92:95], v[64:67]
ds_read_b128 a[148:151], v8 offset:22528
v_mfma_f32_16x16x32_bf16 v[40:43], a[184:187], a[88:91], v[40:43]
ds_read_b128 a[152:155], v8 offset:23552
v_mfma_f32_16x16x32_bf16 v[68:71], a[184:187], a[92:95], v[68:71]
ds_read_b128 a[156:159], v8 offset:24576
v_mfma_f32_16x16x32_bf16 v[44:47], a[188:191], a[88:91], v[44:47]
ds_read_b128 a[160:163], v8 offset:25600
buffer_load_dwordx4 a[140:143], v237, s[8:11], s62 offen offset:1024 sc1
v_mfma_f32_16x16x32_bf16 v[72:75], a[188:191], a[92:95], v[72:75]
ds_read_b128 a[164:167], v8 offset:26624
v_mfma_f32_16x16x32_bf16 v[48:51], a[192:195], a[88:91], v[48:51]
ds_read_b128 a[168:171], v8 offset:27648
v_mfma_f32_16x16x32_bf16 v[76:79], a[192:195], a[92:95], v[76:79]
ds_read_b128 a[172:175], v125 offset:21504
v_mfma_f32_16x16x32_bf16 v[52:55], a[196:199], a[88:91], v[52:55]
ds_read_b128 a[176:179], v126 offset:12288
s_mov_b32 s37, L_c2-L_pc
v_mfma_f32_16x16x32_bf16 v[80:83], a[196:199], a[92:95], v[80:83]
ds_bpermute_b32 v116, v124, v133 offset:128
v_mfma_f32_16x16x32_bf16 v[92:95], a[208:211], a[212:215], v[92:95]
ds_bpermute_b32 v118, v124, v133 offset:192
v_mfma_f32_16x16x32_bf16 v[96:99], a[196:199], a[212:215], v[96:99]
ds_bpermute_b32 v120, v124, v133
v_mfma_f32_16x16x32_bf16 v[56:59], a[200:203], a[88:91], v[56:59]
buffer_load_dword v15, v14, s[88:91], s37 offen
ds_bpermute_b32 v134, v124, v132 offset:128
v_mfma_f32_16x16x32_bf16 v[84:87], a[200:203], a[92:95], v[84:87]
ds_bpermute_b32 v135, v124, v132 offset:192
v_mfma_f32_16x16x32_bf16 v[60:63], a[204:207], a[88:91], v[60:63]
v_mfma_f32_16x16x32_bf16 v[88:91], a[204:207], a[92:95], v[88:91]
s_waitcnt lgkmcnt(0)
s_waitcnt vmcnt(11)
v_mfma_f32_16x16x32_bf16 v[36:39], a[144:147], a[96:99], v[36:39]
ds_read_b128 a[180:183], v8 offset:28672
v_mfma_f32_16x16x32_bf16 v[64:67], a[144:147], a[100:103], v[64:67]
ds_read_b128 a[184:187], v8 offset:29696
v_mfma_f32_16x16x32_bf16 v[40:43], a[148:151], a[96:99], v[40:43]
ds_read_b128 a[188:191], v8 offset:30720
v_mfma_f32_16x16x32_bf16 v[68:71], a[148:151], a[100:103], v[68:71]
ds_read_b128 a[192:195], v8 offset:31744
v_mfma_f32_16x16x32_bf16 v[44:47], a[152:155], a[96:99], v[44:47]
ds_read_b128 a[196:199], v8 offset:32768
s_mul_i32 s36, s28, 82944
v_mfma_f32_16x16x32_bf16 v[72:75], a[152:155], a[100:103], v[72:75]
ds_read_b128 a[200:203], v8 offset:33792
v_mfma_f32_16x16x32_bf16 v[48:51], a[156:159], a[96:99], v[48:51]
ds_read_b128 a[204:207], v8 offset:34816
buffer_store_dwordx4 a[232:235], v1, s[4:7], s101 offen offset:0 sc1
v_mfma_f32_16x16x32_bf16 v[76:79], a[156:159], a[100:103], v[76:79]
ds_read_b128 a[208:211], v125 offset:28672
s_mul_i32 s38, s24, 10240
v_mfma_f32_16x16x32_bf16 v[52:55], a[160:163], a[96:99], v[52:55]
ds_read_b128 a[212:215], v126 offset:13312
v_mfma_f32_16x16x32_bf16 v[80:83], a[160:163], a[100:103], v[80:83]
ds_bpermute_b32 v136, v122, v132 offset:0
v_mfma_f32_16x16x32_bf16 v[92:95], a[172:175], a[176:179], v[92:95]
ds_bpermute_b32 v137, v123, v132 offset:0
v_mfma_f32_16x16x32_bf16 v[96:99], a[160:163], a[176:179], v[96:99]
ds_bpermute_b32 v138, v122, v132 offset:64
s_add_u32 m0, s38, 37888
v_mfma_f32_16x16x32_bf16 v[56:59], a[164:167], a[96:99], v[56:59]
ds_bpermute_b32 v139, v123, v132 offset:64
v_mfma_f32_16x16x32_bf16 v[84:87], a[164:167], a[100:103], v[84:87]
s_add_u32 s39, s38, s36
v_mfma_f32_16x16x32_bf16 v[60:63], a[168:171], a[96:99], v[60:63]
buffer_store_dwordx4 a[236:239], v1, s[4:7], s101 offen offset:1024 sc1
v_mfma_f32_16x16x32_bf16 v[88:91], a[168:171], a[100:103], v[88:91]
s_add_u32 s39, s39, 2121728
s_waitcnt lgkmcnt(0)
s_waitcnt vmcnt(11)
v_mfma_f32_16x16x32_bf16 v[36:39], a[180:183], a[104:107], v[36:39]
ds_read_b128 a[144:147], v8 offset:35840
v_mov_b32 v117, v116
v_mfma_f32_16x16x32_bf16 v[64:67], a[180:183], a[108:111], v[64:67]
ds_read_b128 a[148:151], v8 offset:36864
v_mfma_f32_16x16x32_bf16 v[40:43], a[184:187], a[104:107], v[40:43]
ds_read_b128 a[152:155], v8 offset:37888
v_mov_b32 v119, v118
v_mfma_f32_16x16x32_bf16 v[68:71], a[184:187], a[108:111], v[68:71]
ds_read_b128 a[156:159], v8 offset:38912
v_mfma_f32_16x16x32_bf16 v[44:47], a[188:191], a[104:107], v[44:47]
ds_read_b128 a[160:163], v8 offset:39936
v_mov_b32 v121, v120
v_mfma_f32_16x16x32_bf16 v[72:75], a[188:191], a[108:111], v[72:75]
ds_read_b128 a[164:167], v8 offset:40960
v_mfma_f32_16x16x32_bf16 v[48:51], a[192:195], a[104:107], v[48:51]
ds_read_b128 a[168:171], v8 offset:41984
v_mfma_f32_16x16x32_bf16 v[76:79], a[192:195], a[108:111], v[76:79]
ds_read_b128 a[172:175], v125 offset:35840
buffer_load_dwordx4 v1, s[4:7], s39 offen offset:0 sc1 lds
v_mfma_f32_16x16x32_bf16 v[52:55], a[196:199], a[104:107], v[52:55]
ds_read_b128 a[176:179], v126 offset:14336
buffer_store_dwordx4 a[240:243], v1, s[4:7], s101 offen offset:2048 sc1
v_mfma_f32_16x16x32_bf16 v[80:83], a[196:199], a[108:111], v[80:83]
v_mul_f32 v134, 0x3eae1a93, v134
v_mul_f32 v135, 0x3eae1a93, v135
v_mfma_f32_16x16x32_bf16 v[92:95], a[208:211], a[212:215], v[92:95]
v_mfma_f32_16x16x32_bf16 v[96:99], a[196:199], a[212:215], v[96:99]
buffer_load_dwordx4 v1, s[4:7], s39 offen offset:1024 sc1 lds
v_mul_f32 v140, v134, v136
v_mfma_f32_16x16x32_bf16 v[56:59], a[200:203], a[104:107], v[56:59]
v_mfma_f32_16x16x32_bf16 v[84:87], a[200:203], a[108:111], v[84:87]
v_mfma_f32_16x16x32_bf16 v[60:63], a[204:207], a[104:107], v[60:63]
v_mul_f32 v141, v134, v137
v_mfma_f32_16x16x32_bf16 v[88:91], a[204:207], a[108:111], v[88:91]
s_waitcnt lgkmcnt(0)
s_waitcnt vmcnt(12)
v_mfma_f32_16x16x32_bf16 v[36:39], a[144:147], a[112:115], v[36:39]
ds_read_b128 a[180:183], v8 offset:43008
buffer_load_dwordx4 v1, s[4:7], s39 offen offset:2048 sc1 lds
v_mfma_f32_16x16x32_bf16 v[64:67], a[144:147], a[116:119], v[64:67]
ds_read_b128 a[184:187], v8 offset:44032
buffer_store_dwordx4 a[244:247], v1, s[4:7], s101 offen offset:3072 sc1
v_mfma_f32_16x16x32_bf16 v[40:43], a[148:151], a[112:115], v[40:43]
ds_read_b128 a[188:191], v8 offset:45056
v_mul_f32 v142, v135, v138
v_mfma_f32_16x16x32_bf16 v[68:71], a[148:151], a[116:119], v[68:71]
ds_read_b128 a[192:195], v8 offset:46080
buffer_load_dwordx4 v1, s[4:7], s39 offen offset:3072 sc1 lds
v_mfma_f32_16x16x32_bf16 v[44:47], a[152:155], a[112:115], v[44:47]
ds_read_b128 a[196:199], v8 offset:47104
v_mul_f32 v143, v135, v139
v_mfma_f32_16x16x32_bf16 v[72:75], a[152:155], a[116:119], v[72:75]
ds_read_b128 a[200:203], v8 offset:48128
v_mfma_f32_16x16x32_bf16 v[48:51], a[156:159], a[112:115], v[48:51]
ds_read_b128 a[204:207], v8 offset:49152
v_mfma_f32_16x16x32_bf16 v[76:79], a[156:159], a[116:119], v[76:79]
ds_read_b128 a[208:211], v125 offset:43008
s_add_u32 m0, m0, 4096
v_mfma_f32_16x16x32_bf16 v[52:55], a[160:163], a[112:115], v[52:55]
ds_read_b128 a[212:215], v126 offset:15360
v_mfma_f32_16x16x32_bf16 v[80:83], a[160:163], a[116:119], v[80:83]
ds_read_b64 a[216:217], v127 offset:0
buffer_store_dwordx4 a[248:251], v9, s[4:7], s101 offen offset:0 sc1
v_mfma_f32_16x16x32_bf16 v[92:95], a[172:175], a[176:179], v[92:95]
ds_read_b64 a[218:219], v127 offset:512
v_mfma_f32_16x16x32_bf16 v[96:99], a[160:163], a[176:179], v[96:99]
s_cmp_eq_u32 s60, 0
s_cselect_b32 s30, 0xf149f2ca, 0
s_add_u32 s39, s39, 4096
v_mfma_f32_16x16x32_bf16 v[56:59], a[164:167], a[112:115], v[56:59]
ds_read_b64 a[220:221], v127 offset:1024
v_mov_b32 v6, s30
v_mfma_f32_16x16x32_bf16 v[84:87], a[164:167], a[116:119], v[84:87]
ds_read_b64 a[222:223], v127 offset:1536
v_cndmask_b32 v144, v6, 0, s[42:43]
v_mfma_f32_16x16x32_bf16 v[60:63], a[168:171], a[112:115], v[60:63]
v_cndmask_b32 v145, v6, 0, s[44:45]
v_mfma_f32_16x16x32_bf16 v[88:91], a[168:171], a[116:119], v[88:91]
s_waitcnt lgkmcnt(0)
s_waitcnt vmcnt(14)
v_mfma_f32_16x16x32_bf16 v[36:39], a[180:183], a[120:123], v[36:39]
ds_read_b128 a[144:147], v8 offset:50176
buffer_load_dwordx4 v1, s[4:7], s39 offen offset:0 sc1 lds
v_mfma_f32_16x16x32_bf16 v[64:67], a[180:183], a[124:127], v[64:67]
ds_read_b128 a[148:151], v8 offset:51200
buffer_store_dwordx4 a[252:255], v9, s[4:7], s101 offen offset:1024 sc1
v_mfma_f32_16x16x32_bf16 v[40:43], a[184:187], a[120:123], v[40:43]
ds_read_b128 a[152:155], v8 offset:52224
v_mfma_f32_16x16x32_bf16 v[68:71], a[184:187], a[124:127], v[68:71]
ds_read_b128 a[156:159], v8 offset:53248
buffer_load_dwordx4 v1, s[4:7], s39 offen offset:1024 sc1 lds
v_mfma_f32_16x16x32_bf16 v[44:47], a[188:191], a[120:123], v[44:47]
ds_read_b128 a[160:163], v8 offset:54272
v_mfma_f32_16x16x32_bf16 v[72:75], a[188:191], a[124:127], v[72:75]
ds_read_b128 a[164:167], v8 offset:55296
v_mfma_f32_16x16x32_bf16 v[48:51], a[192:195], a[120:123], v[48:51]
ds_read_b128 a[168:171], v8 offset:56320
v_mfma_f32_16x16x32_bf16 v[76:79], a[192:195], a[124:127], v[76:79]
ds_read_b128 a[172:175], v125 offset:50176
buffer_load_dwordx4 v1, s[4:7], s39 offen offset:2048 sc1 lds
v_mfma_f32_16x16x32_bf16 v[52:55], a[196:199], a[120:123], v[52:55]
ds_read_b128 a[176:179], v126 offset:16384
v_mfma_f32_16x16x32_bf16 v[80:83], a[196:199], a[124:127], v[80:83]
ds_read_b64 a[224:225], v127 offset:2048
v_mfma_f32_16x16x32_bf16 v[92:95], a[208:211], a[212:215], v[92:95]
ds_read_b64 a[226:227], v127 offset:2560
buffer_store_dwordx4 v[240:243], v9, s[4:7], s101 offen offset:2048 sc1
v_mfma_f32_16x16x32_bf16 v[96:99], a[196:199], a[212:215], v[96:99]
buffer_load_dwordx4 v1, s[4:7], s39 offen offset:3072 sc1 lds
v_mfma_f32_16x16x32_bf16 v[56:59], a[200:203], a[120:123], v[56:59]
ds_read_b64 a[228:229], v127 offset:3072
v_mfma_f32_16x16x32_bf16 v[84:87], a[200:203], a[124:127], v[84:87]
ds_read_b64 a[230:231], v128
v_mfma_f32_16x16x32_bf16 v[60:63], a[204:207], a[120:123], v[60:63]
s_add_u32 m0, m0, 4096
v_mfma_f32_16x16x32_bf16 v[88:91], a[204:207], a[124:127], v[88:91]
s_add_u32 s39, s39, 4096
s_waitcnt lgkmcnt(0)
s_waitcnt vmcnt(18)
v_mfma_f32_16x16x32_bf16 v[36:39], a[144:147], a[128:131], v[36:39]
ds_read_b128 a[180:183], v8 offset:57344
v_mfma_f32_16x16x32_bf16 v[64:67], a[144:147], a[132:135], v[64:67]
ds_read_b128 a[184:187], v8 offset:58368
v_mfma_f32_16x16x32_bf16 v[40:43], a[148:151], a[128:131], v[40:43]
ds_read_b128 a[188:191], v8 offset:59392
v_mfma_f32_16x16x32_bf16 v[68:71], a[148:151], a[132:135], v[68:71]
ds_read_b128 a[192:195], v8 offset:60416
buffer_store_dwordx4 v[244:247], v9, s[4:7], s101 offen offset:3072 sc1
v_mfma_f32_16x16x32_bf16 v[44:47], a[152:155], a[128:131], v[44:47]
ds_read_b128 a[196:199], v8 offset:61440
v_mfma_f32_16x16x32_bf16 v[72:75], a[152:155], a[132:135], v[72:75]
ds_read_b128 a[200:203], v8 offset:62464
v_mfma_f32_16x16x32_bf16 v[48:51], a[156:159], a[128:131], v[48:51]
ds_read_b128 a[204:207], v8 offset:63488
v_mfma_f32_16x16x32_bf16 v[76:79], a[156:159], a[132:135], v[76:79]
ds_read_b128 a[208:211], v125 offset:57344
buffer_load_dwordx4 v1, s[4:7], s39 offen offset:0 sc1 lds
v_mfma_f32_16x16x32_bf16 v[52:55], a[160:163], a[128:131], v[52:55]
ds_read_b128 a[212:215], v126 offset:17408
v_mfma_f32_16x16x32_bf16 v[80:83], a[160:163], a[132:135], v[80:83]
s_mov_b32 s101, 1073741824
v_mfma_f32_16x16x32_bf16 v[92:95], a[172:175], a[176:179], v[92:95]
v_mfma_f32_16x16x32_bf16 v[96:99], a[160:163], a[176:179], v[96:99]
buffer_load_dwordx4 v1, s[4:7], s39 offen offset:1024 sc1 lds
v_mfma_f32_16x16x32_bf16 v[56:59], a[164:167], a[128:131], v[56:59]
v_mfma_f32_16x16x32_bf16 v[84:87], a[164:167], a[132:135], v[84:87]
v_mfma_f32_16x16x32_bf16 v[60:63], a[168:171], a[128:131], v[60:63]
v_mfma_f32_16x16x32_bf16 v[88:91], a[168:171], a[132:135], v[88:91]
s_waitcnt lgkmcnt(0)
s_waitcnt vmcnt(19)
v_mfma_f32_16x16x32_bf16 v[36:39], a[180:183], a[136:139], v[36:39]
v_mfma_f32_16x16x32_bf16 v[64:67], a[180:183], a[140:143], v[64:67]
v_mfma_f32_16x16x16_bf16 v[36:39], a[216:217], v[116:117], v[36:39]
v_mfma_f32_16x16x16_bf16 v[64:67], a[216:217], v[118:119], v[64:67]
v_mfma_f32_16x16x32_bf16 v[40:43], a[184:187], a[136:139], v[40:43]
v_mfma_f32_16x16x32_bf16 v[68:71], a[184:187], a[140:143], v[68:71]
s_nop 1
v_mfma_f32_16x16x16_bf16 v[40:43], a[218:219], v[116:117], v[40:43]
s_nop 1
v_mfma_f32_16x16x16_bf16 v[68:71], a[218:219], v[118:119], v[68:71]
v_cvt_pk_bf16_f32 v156, v36, v37
v_cvt_pk_bf16_f32 v157, v38, v39
v_mfma_f32_16x16x32_bf16 v[44:47], a[188:191], a[136:139], v[44:47]
ds_write_b64 v218, v[156:157] offset:2816
v_mfma_f32_16x16x32_bf16 v[72:75], a[188:191], a[140:143], v[72:75]
v_cvt_pk_bf16_f32 v162, v64, v65
v_cvt_pk_bf16_f32 v163, v66, v67
v_mfma_f32_16x16x16_bf16 v[44:47], a[220:221], v[116:117], v[44:47]
ds_write_b64 v218, v[162:163] offset:5632
v_mfma_f32_16x16x16_bf16 v[72:75], a[220:221], v[118:119], v[72:75]
v_cvt_pk_bf16_f32 v160, v40, v41
v_cvt_pk_bf16_f32 v161, v42, v43
v_mfma_f32_16x16x32_bf16 v[48:51], a[192:195], a[136:139], v[48:51]
ds_write_b64 v218, v[160:161] offset:2848
v_mfma_f32_16x16x32_bf16 v[76:79], a[192:195], a[140:143], v[76:79]
v_cvt_pk_bf16_f32 v166, v68, v69
v_cvt_pk_bf16_f32 v167, v70, v71
v_mfma_f32_16x16x16_bf16 v[48:51], a[222:223], v[116:117], v[48:51]
ds_write_b64 v218, v[166:167] offset:5664
v_mfma_f32_16x16x16_bf16 v[76:79], a[222:223], v[118:119], v[76:79]
v_cvt_pk_bf16_f32 v202, v44, v45
v_cvt_pk_bf16_f32 v203, v46, v47
v_mfma_f32_16x16x32_bf16 v[52:55], a[196:199], a[136:139], v[52:55]
ds_write_b64 v218, v[202:203] offset:2880
v_mfma_f32_16x16x32_bf16 v[80:83], a[196:199], a[140:143], v[80:83]
v_cvt_pk_bf16_f32 v204, v72, v73
v_cvt_pk_bf16_f32 v205, v74, v75
v_mfma_f32_16x16x16_bf16 v[52:55], a[224:225], v[116:117], v[52:55]
ds_write_b64 v218, v[204:205] offset:5696
v_mfma_f32_16x16x16_bf16 v[80:83], a[224:225], v[118:119], v[80:83]
v_cvt_pk_bf16_f32 v206, v48, v49
v_cvt_pk_bf16_f32 v207, v50, v51
v_mfma_f32_16x16x32_bf16 v[92:95], a[208:211], a[212:215], v[92:95]
ds_write_b64 v218, v[206:207] offset:2912
v_mfma_f32_16x16x32_bf16 v[96:99], a[196:199], a[212:215], v[96:99]
v_cvt_pk_bf16_f32 v208, v76, v77
v_cvt_pk_bf16_f32 v209, v78, v79
v_mfma_f32_16x16x16_bf16 v[92:95], a[230:231], v[120:121], v[92:95]
ds_write_b64 v218, v[208:209] offset:5728
v_mfma_f32_16x16x16_bf16 v[96:99], a[224:225], v[120:121], v[96:99]
v_cvt_pk_bf16_f32 v210, v52, v53
v_cvt_pk_bf16_f32 v211, v54, v55
v_mfma_f32_16x16x32_bf16 v[56:59], a[200:203], a[136:139], v[56:59]
ds_write_b64 v218, v[210:211] offset:2944
v_mfma_f32_16x16x32_bf16 v[84:87], a[200:203], a[140:143], v[84:87]
v_cvt_pk_bf16_f32 v212, v80, v81
v_cvt_pk_bf16_f32 v213, v82, v83
v_mfma_f32_16x16x16_bf16 v[56:59], a[226:227], v[116:117], v[56:59]
ds_write_b64 v218, v[212:213] offset:5760
v_mfma_f32_16x16x16_bf16 v[84:87], a[226:227], v[118:119], v[84:87]
v_cvt_pk_bf16_f32 v214, v92, v93
v_cvt_pk_bf16_f32 v215, v94, v95
v_mfma_f32_16x16x32_bf16 v[60:63], a[204:207], a[136:139], v[60:63]
ds_write_b64 v222, v[214:215]
v_mfma_f32_16x16x32_bf16 v[88:91], a[204:207], a[140:143], v[88:91]
v_cvt_pk_bf16_f32 v216, v96, v97
v_cvt_pk_bf16_f32 v217, v98, v99
v_mfma_f32_16x16x16_bf16 v[60:63], a[228:229], v[116:117], v[60:63]
ds_write_b64 v219, v[216:217] offset:128
v_mfma_f32_16x16x16_bf16 v[88:91], a[228:229], v[118:119], v[88:91]
s_waitcnt lgkmcnt(0)
s_barrier
ds_read_b64 v[150:151], v218
ds_read_b64 v[154:155], v218 offset:32
ds_read_b64 v[152:153], v220 offset:136
ds_read_b64 v[158:159], v220 offset:2952
ds_read_b64 v[164:165], v220 offset:5768
s_mul_i32 s36, s28, 82944
s_mul_i32 s38, s24, 11264
s_add_u32 m0, s38, 78848
s_add_u32 s39, s38, s36
s_add_u32 s39, s39, 2162688
buffer_load_dwordx4 v1, s[4:7], s39 offen offset:0 sc1 lds
buffer_load_dwordx4 v1, s[4:7], s39 offen offset:1024 sc1 lds
v_cndmask_b32 v170, 0, v210, s[48:49]
v_cndmask_b32 v173, 0, v211, s[48:49]
v_cndmask_b32 v178, 0, v212, s[48:49]
v_cndmask_b32 v181, 0, v213, s[48:49]
v_cvt_pk_bf16_f32 v168, v56, v57
v_cvt_pk_bf16_f32 v169, v58, v59
v_cvt_pk_bf16_f32 v176, v84, v85
v_cvt_pk_bf16_f32 v177, v86, v87
v_cvt_pk_bf16_f32 v174, v60, v61
v_cvt_pk_bf16_f32 v175, v62, v63
v_cvt_pk_bf16_f32 v182, v88, v89
v_cvt_pk_bf16_f32 v183, v90, v91
s_waitcnt lgkmcnt(0)
ds_read_b64_tr_b16 v[184:185], v221 offset:64
v_mfma_f32_16x16x32_bf16 v[36:39], v[150:153], v[168:171], 0
ds_read_b64_tr_b16 v[186:187], v221 offset:2880
v_mfma_f32_16x16x32_bf16 v[40:43], v[156:159], v[168:171], 0
ds_read_b64_tr_b16 v[188:189], v221 offset:5696
buffer_load_dwordx4 v1, s[4:7], s39 offen offset:2048 sc1 lds
v_mfma_f32_16x16x32_bf16 v[44:47], v[152:155], v[172:175], 0
ds_read_b64_tr_b16 v[190:191], v221 offset:96
v_mfma_f32_16x16x32_bf16 v[48:51], v[158:161], v[172:175], 0
ds_read_b64_tr_b16 v[192:193], v221 offset:2912
buffer_load_dwordx4 v1, s[4:7], s39 offen offset:3072 sc1 lds
v_mfma_f32_16x16x32_bf16 v[52:55], v[156:159], v[176:179], 0
ds_read_b64_tr_b16 v[194:195], v221 offset:5728
v_mfma_f32_16x16x32_bf16 v[56:59], v[162:165], v[176:179], 0
ds_read_b64_tr_b16 v[196:197], v221 offset:128
s_add_u32 m0, m0, 4096
s_add_u32 s39, s39, 4096
buffer_load_dwordx4 v1, s[4:7], s39 offen offset:0 sc1 lds
v_mfma_f32_16x16x32_bf16 v[60:63], v[158:161], v[180:183], 0
ds_read_b64_tr_b16 v[198:199], v221 offset:2944
v_mfma_f32_16x16x32_bf16 v[64:67], v[164:167], v[180:183], 0
ds_read_b64_tr_b16 v[200:201], v221 offset:5760
buffer_load_dwordx4 v1, s[4:7], s39 offen offset:1024 sc1 lds
v_cndmask_b32 v36, v36, v37, s[40:41]
v_cndmask_b32 v40, v40, v41, s[40:41]
v_cndmask_b32 v36, v36, v40, s[42:43]
v_fma_f32 v68, v36, v140, v144
v_cndmask_b32 v38, v38, v39, s[40:41]
v_cndmask_b32 v42, v42, v43, s[40:41]
v_cndmask_b32 v38, v38, v42, s[44:45]
v_fma_f32 v69, v38, v141, v145
v_max_f32 v76, v68, v69
v_cndmask_b32 v44, v44, v45, s[40:41]
buffer_load_dwordx4 v1, s[4:7], s39 offen offset:2048 sc1 lds
v_cndmask_b32 v48, v48, v49, s[40:41]
v_cndmask_b32 v44, v44, v48, s[42:43]
v_fma_f32 v70, v44, v140, v144
v_cndmask_b32 v46, v46, v47, s[40:41]
v_cndmask_b32 v50, v50, v51, s[40:41]
v_cndmask_b32 v46, v46, v50, s[44:45]
v_fma_f32 v71, v46, v141, v145
v_max_f32 v77, v70, v71
v_cndmask_b32 v52, v52, v53, s[40:41]
v_cndmask_b32 v56, v56, v57, s[40:41]
buffer_load_dwordx4 v1, s[4:7], s39 offen offset:3072 sc1 lds
v_cndmask_b32 v52, v52, v56, s[42:43]
v_mul_f32 v72, v52, v142
v_cndmask_b32 v54, v54, v55, s[40:41]
v_cndmask_b32 v58, v58, v59, s[40:41]
v_cndmask_b32 v54, v54, v58, s[44:45]
v_mul_f32 v73, v54, v143
v_max_f32 v78, v72, v73
v_cndmask_b32 v60, v60, v61, s[40:41]
v_cndmask_b32 v64, v64, v65, s[40:41]
v_cndmask_b32 v60, v60, v64, s[42:43]
s_add_u32 m0, m0, 4096
v_mul_f32 v74, v60, v142
v_cndmask_b32 v62, v62, v63, s[40:41]
v_cndmask_b32 v66, v66, v67, s[40:41]
v_cndmask_b32 v62, v62, v66, s[44:45]
v_mul_f32 v75, v62, v143
v_max_f32 v79, v74, v75
s_nop 1
v_permlane32_swap_b32 v76, v77
v_permlane32_swap_b32 v78, v79
s_add_u32 s39, s39, 4096
v_max_f32 v76, v76, v77
v_max_f32 v78, v78, v79
s_nop 1
v_permlane16_swap_b32 v76, v78
v_max_f32 v76, v76, v78
v_mov_b32 v78, v76
s_nop 1
v_permlane16_swap_b32 v76, v78
v_mov_b32 v77, v76
v_mov_b32 v79, v78
buffer_load_dwordx4 v1, s[4:7], s39 offen offset:0 sc1 lds
s_nop 0
v_permlane32_swap_b32 v76, v77
v_permlane32_swap_b32 v78, v79
v_sub_f32 v68, v68, v76
v_sub_f32 v69, v69, v76
v_sub_f32 v70, v70, v77
v_sub_f32 v71, v71, v77
v_sub_f32 v72, v72, v78
v_sub_f32 v73, v73, v78
v_sub_f32 v74, v74, v79
buffer_load_dwordx4 v1, s[4:7], s39 offen offset:1024 sc1 lds
v_sub_f32 v75, v75, v79
v_exp_f32 v68, v68
v_exp_f32 v69, v69
v_exp_f32 v70, v70
v_exp_f32 v71, v71
v_exp_f32 v72, v72
v_exp_f32 v73, v73
v_exp_f32 v74, v74
v_exp_f32 v75, v75
buffer_load_dwordx4 v1, s[4:7], s39 offen offset:2048 sc1 lds
v_add_f32 v76, v68, v69
v_add_f32 v77, v70, v71
v_add_f32 v78, v72, v73
v_add_f32 v79, v74, v75
v_mul_f32 v68, v68, v136
v_mul_f32 v69, v69, v137
v_mul_f32 v70, v70, v136
v_mul_f32 v71, v71, v137
v_mul_f32 v72, v72, v138
v_mul_f32 v73, v73, v139
v_mul_f32 v74, v74, v138
v_mul_f32 v75, v75, v139
s_nop 1
v_permlane32_swap_b32 v76, v77
v_permlane32_swap_b32 v78, v79
v_add_f32 v76, v76, v77
v_add_f32 v78, v78, v79
s_nop 1
v_permlane16_swap_b32 v76, v78
v_add_f32 v76, v76, v78
v_rcp_f32 v76, v76
s_nop 0
v_mov_b32 v78, v76
s_nop 1
v_permlane16_swap_b32 v76, v78
v_mov_b32 v77, v76
v_mov_b32 v79, v78
s_nop 0
v_permlane32_swap_b32 v76, v77
v_permlane32_swap_b32 v78, v79
s_waitcnt lgkmcnt(0)
v_mul_f32 v68, v68, v76
v_mul_f32 v69, v69, v76
v_cvt_pk_bf16_f32 v68, v68, v69
v_perm_b32 v84, v68, v68, v10
v_perm_b32 v85, v68, v68, v11
v_perm_b32 v86, v68, v68, v12
v_perm_b32 v87, v68, v68, v13
v_mul_f32 v70, v70, v77
v_mul_f32 v71, v71, v77
v_mfma_f32_16x16x32_bf16 v[36:39], v[184:187], v[84:87], 0
v_cvt_pk_bf16_f32 v70, v70, v71
v_perm_b32 v88, v70, v70, v10
v_mfma_f32_16x16x32_bf16 v[40:43], v[196:199], v[84:87], 0
v_perm_b32 v89, v70, v70, v11
v_perm_b32 v90, v70, v70, v12
v_perm_b32 v91, v70, v70, v13
v_mul_f32 v72, v72, v78
v_mul_f32 v73, v73, v78
v_mfma_f32_16x16x32_bf16 v[44:47], v[190:193], v[88:91], 0
v_cvt_pk_bf16_f32 v72, v72, v73
v_perm_b32 v92, v72, v72, v10
v_mfma_f32_16x16x32_bf16 v[48:51], v[196:199], v[88:91], 0
v_perm_b32 v93, v72, v72, v11
v_perm_b32 v94, v72, v72, v12
v_perm_b32 v95, v72, v72, v13
v_mul_f32 v74, v74, v79
v_mul_f32 v75, v75, v79
v_mfma_f32_16x16x32_bf16 v[52:55], v[186:189], v[92:95], 0
v_cvt_pk_bf16_f32 v74, v74, v75
v_perm_b32 v96, v74, v74, v10
v_mfma_f32_16x16x32_bf16 v[56:59], v[198:201], v[92:95], 0
v_perm_b32 v97, v74, v74, v11
v_perm_b32 v98, v74, v74, v12
v_perm_b32 v99, v74, v74, v13
v_cvt_pk_bf16_f32 v168, v36, v37
v_cvt_pk_bf16_f32 v169, v38, v39
v_mfma_f32_16x16x32_bf16 v[60:63], v[192:195], v[96:99], 0
v_mfma_f32_16x16x32_bf16 v[64:67], v[198:201], v[96:99], 0
v_cvt_pk_bf16_f32 v172, v40, v41
v_cvt_pk_bf16_f32 v170, v44, v45
v_cvt_pk_bf16_f32 v171, v46, v47
v_cvt_pk_bf16_f32 v173, v50, v51
buffer_store_dwordx4 v[168:171], v1, s[8:11], s64 offen sc1
buffer_store_dwordx2 v[172:173], v224, s[8:11], s65 offen offset:2048 sc1
v_cvt_pk_bf16_f32 v176, v52, v53
v_cvt_pk_bf16_f32 v177, v54, v55
v_cvt_pk_bf16_f32 v180, v56, v57
v_cvt_pk_bf16_f32 v178, v60, v61
v_cvt_pk_bf16_f32 v179, v62, v63
v_cvt_pk_bf16_f32 v181, v66, v67
buffer_store_dwordx4 v[176:179], v237, s[8:11], s64 offen sc1
buffer_store_dwordx2 v[180:181], v225, s[8:11], s65 offen offset:2048 sc1
L_c2:
s_mul_i32 s38, s24, 9216
s_add_u32 m0, s38, 123904
s_add_u32 s39, s38, s82
buffer_load_dwordx4 v1, s[4:7], s39 offen offset:0 sc1 lds
buffer_load_dwordx4 v1, s[4:7], s39 offen offset:1024 sc1 lds
buffer_load_dwordx4 v1, s[4:7], s39 offen offset:2048 sc1 lds
buffer_load_dwordx4 v1, s[4:7], s39 offen offset:3072 sc1 lds
s_add_u32 m0, m0, 4096
s_add_u32 s39, s39, 4096
buffer_load_dwordx4 v1, s[4:7], s39 offen offset:0 sc1 lds
buffer_load_dwordx4 v1, s[4:7], s39 offen offset:1024 sc1 lds
buffer_load_dwordx4 v1, s[4:7], s39 offen offset:2048 sc1 lds
buffer_load_dwordx4 v1, s[4:7], s39 offen offset:3072 sc1 lds
s_add_u32 m0, m0, 4096
s_add_u32 s39, s39, 4096
buffer_load_dwordx4 v1, s[4:7], s39 offen offset:0 sc1 lds
s_lshl_b32 s38, s24, 8
s_add_u32 m0, s38, 160768
s_add_u32 s39, s38, s82
s_add_u32 s39, s39, 36864
s_mov_b64 exec, 0xffff
buffer_load_dwordx4 v1, s[4:7], s39 offen sc1 lds
s_mov_b64 exec, -1
v_lshlrev_b32 v7, 3, v1
s_lshl_b32 s31, s25, 11
v_add_u32 v7, s31, v7
s_cmp_eq_u32 s24, 0
s_cselect_b32 s30, 0, 1073741824
s_add_u32 s30, s30, 26476544
s_waitcnt vmcnt(10)
s_barrier
s_mov_b64 exec, 0xffff
buffer_atomic_add v4, v7, s[8:11], s30 offen sc1
s_mov_b64 exec, -1
s_lshl_b32 s35, s81, 7
s_add_u32 s35, s35, 26476544
s_cmp_eq_u32 s24, 1
s_cselect_b32 s35, s35, 1073741824
v_mov_b32 v6, 0
s_mul_i32 s38, s24, 9216
s_add_u32 m0, s38, 0
s_add_u32 s39, s38, s82
s_add_u32 s39, s39, 37888
buffer_load_dwordx4 v1, s[4:7], s39 offen offset:0 sc1 lds
buffer_load_dwordx4 v1, s[4:7], s39 offen offset:1024 sc1 lds
v_mov_b32 v249, 0
s_mov_b64 exec, 1
buffer_atomic_add v249, v6, s[8:11], s35 offen sc0 sc1
s_mov_b64 exec, -1
buffer_load_dwordx4 v1, s[4:7], s39 offen offset:2048 sc1 lds
buffer_load_dwordx4 v1, s[4:7], s39 offen offset:3072 sc1 lds
s_add_u32 m0, m0, 4096
s_add_u32 s39, s39, 4096
buffer_load_dwordx4 v1, s[4:7], s39 offen offset:0 sc1 lds
v_mov_b32 v250, 0
s_mov_b64 exec, 1
buffer_atomic_add v250, v6, s[8:11], s35 offen sc0 sc1
s_mov_b64 exec, -1
buffer_load_dwordx4 v1, s[4:7], s39 offen offset:1024 sc1 lds
buffer_load_dwordx4 v1, s[4:7], s39 offen offset:2048 sc1 lds
buffer_load_dwordx4 v1, s[4:7], s39 offen offset:3072 sc1 lds
s_add_u32 m0, m0, 4096
s_add_u32 s39, s39, 4096
v_mov_b32 v251, 0
s_mov_b64 exec, 1
buffer_atomic_add v251, v6, s[8:11], s35 offen sc0 sc1
s_mov_b64 exec, -1
buffer_load_dwordx4 v1, s[4:7], s39 offen offset:0 sc1 lds
s_lshl_b32 s38, s24, 8
s_add_u32 m0, s38, 36864
s_add_u32 s39, s38, s82
s_add_u32 s39, s39, 74752
s_mov_b64 exec, 0xffff
buffer_load_dwordx4 v1, s[4:7], s39 offen sc1 lds
s_mov_b64 exec, -1
s_lshl_b32 s60, s27, 2
s_add_u32 s60, s60, s24
s_mul_i32 s60, s60, 18432
s_add_u32 s60, s60, 2490368
s_cmp_eq_u32 s24, 1
s_cbranch_scc0 L_other_15
s_mov_b32 s31, 0
s_mov_b64 exec, 1
v_mov_b32 v252, 0
buffer_atomic_add v252, v6, s[8:11], s35 offen sc0 sc1
s_waitcnt vmcnt(11)
v_cmp_gt_u32 vcc, 16, v249
s_nop 0
s_cbranch_vccz L_polled_14
s_waitcnt vmcnt(7)
v_cmp_gt_u32 vcc, 16, v250
s_nop 0
s_cbranch_vccz L_polled_14
v_mov_b32 v249, 0
buffer_atomic_add v249, v6, s[8:11], s35 offen sc0 sc1
s_waitcnt vmcnt(4)
v_cmp_gt_u32 vcc, 16, v251
s_nop 0
s_cbranch_vccz L_polled_14
v_mov_b32 v250, 0
buffer_atomic_add v250, v6, s[8:11], s35 offen sc0 sc1
L_poll_13:
s_add_u32 s31, s31, 1
s_cmp_gt_u32 s31, 100000
s_cbranch_scc1 L_polled_14
v_mov_b32 v251, 0
buffer_atomic_add v251, v6, s[8:11], s35 offen sc0 sc1
s_waitcnt vmcnt(3)
v_cmp_gt_u32 vcc, 16, v252
s_nop 0
s_cbranch_vccz L_polled_14
v_mov_b32 v252, 0
buffer_atomic_add v252, v6, s[8:11], s35 offen sc0 sc1
s_waitcnt vmcnt(3)
v_cmp_gt_u32 vcc, 16, v249
s_nop 0
s_cbranch_vccz L_polled_14
v_mov_b32 v249, 0
buffer_atomic_add v249, v6, s[8:11], s35 offen sc0 sc1
s_waitcnt vmcnt(3)
v_cmp_gt_u32 vcc, 16, v250
s_nop 0
s_cbranch_vccz L_polled_14
v_mov_b32 v250, 0
buffer_atomic_add v250, v6, s[8:11], s35 offen sc0 sc1
s_waitcnt vmcnt(3)
v_cmp_gt_u32 vcc, 16, v251
s_nop 0
s_cbranch_vccz L_polled_14
s_branch L_poll_13
L_polled_14:
s_mov_b64 exec, -1
L_other_15:
s_barrier
buffer_load_dwordx4 a[0:3], v1, s[8:11], s60 offen offset:0 sc1
buffer_load_dwordx4 a[4:7], v1, s[8:11], s60 offen offset:1024 sc1
s_barrier
buffer_load_dwordx4 a[8:11], v1, s[8:11], s60 offen offset:2048 sc1
buffer_load_dwordx4 a[12:15], v1, s[8:11], s60 offen offset:3072 sc1
s_barrier
s_add_u32 s60, s60, 4096
buffer_load_dwordx4 a[16:19], v1, s[8:11], s60 offen offset:0 sc1
buffer_load_dwordx4 a[20:23], v1, s[8:11], s60 offen offset:1024 sc1
s_barrier
buffer_load_dwordx4 a[24:27], v1, s[8:11], s60 offen offset:2048 sc1
buffer_load_dwordx4 a[28:31], v1, s[8:11], s60 offen offset:3072 sc1
s_barrier
s_add_u32 s60, s60, 4096
buffer_load_dwordx4 a[32:35], v1, s[8:11], s60 offen offset:0 sc1
v_and_b32 v36, 7, v2
v_lshlrev_b32 v36, 4, v36
v_lshl_add_u32 v36, v3, 7, v36
v_add_u32 v36, 4096, v36
v_add_u32 v36, 37888, v36
v_add_u32 v39, 37888, v1
v_add_u32 v37, 79360, v1
v_add_u32 v38, 41472, v36
ds_read_b128 a[72:75], v39 offset:0
ds_read_b128 a[76:79], v39 offset:1024
ds_read_b128 a[80:83], v39 offset:2048
ds_read_b128 a[84:87], v39 offset:3072
ds_read_b128 a[88:91], v36 offset:0
ds_read_b128 a[92:95], v39 offset:4608
ds_read_b128 a[96:99], v39 offset:5632
ds_read_b128 a[100:103], v39 offset:6656
ds_read_b128 a[104:107], v39 offset:7680
ds_read_b128 a[108:111], v36 offset:4608
s_lshl_b32 s30, s27, 2
s_add_u32 s30, s30, s24
v_mov_b32 v54, 1073741824
s_lshr_b32 s62, s30, 1
s_mul_i32 s62, s62, 36864
s_and_b32 s32, s30, 1
s_lshl_b32 s32, s32, 8
s_add_u32 s62, s62, s32
s_mul_i32 s32, s28, 4608
s_add_u32 s62, s62, s32
s_add_u32 s62, s62, 4849664
v_lshlrev_b32 v56, 4, v2
v_lshl_add_u32 v56, v3, 9, v56
v_add_u32 v57, 4096, v56
v_cndmask_b32 v57, v54, v57, s[46:47]
s_lshl_b32 s63, s30, 7
s_lshl_b32 s32, s28, 14
s_add_u32 s63, s63, s32
s_add_u32 s63, s63, 7208960
v_lshlrev_b32 v55, 3, v2
v_cndmask_b32 v54, v54, v55, s[46:47]
s_waitcnt vmcnt(8)
s_waitcnt lgkmcnt(5)
v_mfma_f32_16x16x32_bf16 v[16:19], a[72:75], a[0:3], v[16:19]
ds_read_b128 a[112:115], v39 offset:9216
buffer_load_dwordx4 a[36:39], v1, s[8:11], s60 offen offset:1024 sc1
v_mfma_f32_16x16x32_bf16 v[20:23], a[76:79], a[0:3], v[20:23]
ds_read_b128 a[116:119], v39 offset:10240
v_mfma_f32_16x16x32_bf16 v[24:27], a[80:83], a[0:3], v[24:27]
ds_read_b128 a[120:123], v39 offset:11264
v_mfma_f32_16x16x32_bf16 v[28:31], a[84:87], a[0:3], v[28:31]
ds_read_b128 a[124:127], v39 offset:12288
v_mfma_f32_16x16x32_bf16 v[32:35], a[88:91], a[0:3], v[32:35]
ds_read_b128 a[128:131], v36 offset:9216
s_waitcnt vmcnt(8)
s_waitcnt lgkmcnt(5)
v_mfma_f32_16x16x32_bf16 v[16:19], a[92:95], a[4:7], v[16:19]
ds_read_b128 a[72:75], v39 offset:13824
buffer_load_dwordx4 a[40:43], v1, s[8:11], s60 offen offset:2048 sc1
v_mfma_f32_16x16x32_bf16 v[20:23], a[96:99], a[4:7], v[20:23]
ds_read_b128 a[76:79], v39 offset:14848
v_mfma_f32_16x16x32_bf16 v[24:27], a[100:103], a[4:7], v[24:27]
ds_read_b128 a[80:83], v39 offset:15872
v_mfma_f32_16x16x32_bf16 v[28:31], a[104:107], a[4:7], v[28:31]
ds_read_b128 a[84:87], v39 offset:16896
v_mfma_f32_16x16x32_bf16 v[32:35], a[108:111], a[4:7], v[32:35]
ds_read_b128 a[88:91], v36 offset:13824
s_waitcnt vmcnt(8)
s_waitcnt lgkmcnt(5)
v_mfma_f32_16x16x32_bf16 v[16:19], a[112:115], a[8:11], v[16:19]
ds_read_b128 a[92:95], v39 offset:18432
buffer_load_dwordx4 a[44:47], v1, s[8:11], s60 offen offset:3072 sc1
v_mfma_f32_16x16x32_bf16 v[20:23], a[116:119], a[8:11], v[20:23]
ds_read_b128 a[96:99], v39 offset:19456
v_mfma_f32_16x16x32_bf16 v[24:27], a[120:123], a[8:11], v[24:27]
ds_read_b128 a[100:103], v39 offset:20480
v_mfma_f32_16x16x32_bf16 v[28:31], a[124:127], a[8:11], v[28:31]
ds_read_b128 a[104:107], v39 offset:21504
v_mfma_f32_16x16x32_bf16 v[32:35], a[128:131], a[8:11], v[32:35]
ds_read_b128 a[108:111], v36 offset:18432
s_waitcnt vmcnt(8)
s_waitcnt lgkmcnt(5)
v_mfma_f32_16x16x32_bf16 v[16:19], a[72:75], a[12:15], v[16:19]
ds_read_b128 a[112:115], v39 offset:23040
s_add_u32 s60, s60, 4096
buffer_load_dwordx4 a[48:51], v1, s[8:11], s60 offen offset:0 sc1
v_mfma_f32_16x16x32_bf16 v[20:23], a[76:79], a[12:15], v[20:23]
ds_read_b128 a[116:119], v39 offset:24064
v_mfma_f32_16x16x32_bf16 v[24:27], a[80:83], a[12:15], v[24:27]
ds_read_b128 a[120:123], v39 offset:25088
v_mfma_f32_16x16x32_bf16 v[28:31], a[84:87], a[12:15], v[28:31]
ds_read_b128 a[124:127], v39 offset:26112
v_mfma_f32_16x16x32_bf16 v[32:35], a[88:91], a[12:15], v[32:35]
ds_read_b128 a[128:131], v36 offset:23040
s_waitcnt vmcnt(8)
s_waitcnt lgkmcnt(5)
v_mfma_f32_16x16x32_bf16 v[16:19], a[92:95], a[16:19], v[16:19]
ds_read_b128 a[72:75], v39 offset:27648
buffer_load_dwordx4 a[52:55], v1, s[8:11], s60 offen offset:1024 sc1
v_mfma_f32_16x16x32_bf16 v[20:23], a[96:99], a[16:19], v[20:23]
ds_read_b128 a[76:79], v39 offset:28672
v_mfma_f32_16x16x32_bf16 v[24:27], a[100:103], a[16:19], v[24:27]
ds_read_b128 a[80:83], v39 offset:29696
v_mfma_f32_16x16x32_bf16 v[28:31], a[104:107], a[16:19], v[28:31]
ds_read_b128 a[84:87], v39 offset:30720
v_mfma_f32_16x16x32_bf16 v[32:35], a[108:111], a[16:19], v[32:35]
ds_read_b128 a[88:91], v36 offset:27648
s_waitcnt vmcnt(8)
s_waitcnt lgkmcnt(5)
v_mfma_f32_16x16x32_bf16 v[16:19], a[112:115], a[20:23], v[16:19]
ds_read_b128 a[92:95], v39 offset:32256
buffer_load_dwordx4 a[56:59], v1, s[8:11], s60 offen offset:2048 sc1
v_mfma_f32_16x16x32_bf16 v[20:23], a[116:119], a[20:23], v[20:23]
ds_read_b128 a[96:99], v39 offset:33280
v_mfma_f32_16x16x32_bf16 v[24:27], a[120:123], a[20:23], v[24:27]
ds_read_b128 a[100:103], v39 offset:34304
v_mfma_f32_16x16x32_bf16 v[28:31], a[124:127], a[20:23], v[28:31]
ds_read_b128 a[104:107], v39 offset:35328
v_mfma_f32_16x16x32_bf16 v[32:35], a[128:131], a[20:23], v[32:35]
ds_read_b128 a[108:111], v36 offset:32256
s_waitcnt vmcnt(8)
s_waitcnt lgkmcnt(5)
v_mfma_f32_16x16x32_bf16 v[16:19], a[72:75], a[24:27], v[16:19]
ds_read_b128 a[112:115], v39 offset:36864
buffer_load_dwordx4 a[60:63], v1, s[8:11], s60 offen offset:3072 sc1
v_mfma_f32_16x16x32_bf16 v[20:23], a[76:79], a[24:27], v[20:23]
ds_read_b128 a[116:119], v39 offset:37888
v_mfma_f32_16x16x32_bf16 v[24:27], a[80:83], a[24:27], v[24:27]
ds_read_b128 a[120:123], v39 offset:38912
v_mfma_f32_16x16x32_bf16 v[28:31], a[84:87], a[24:27], v[28:31]
ds_read_b128 a[124:127], v39 offset:39936
v_mfma_f32_16x16x32_bf16 v[32:35], a[88:91], a[24:27], v[32:35]
ds_read_b128 a[128:131], v36 offset:36864
s_waitcnt vmcnt(8)
s_waitcnt lgkmcnt(5)
v_mfma_f32_16x16x32_bf16 v[16:19], a[92:95], a[28:31], v[16:19]
ds_read_b128 a[72:75], v37 offset:0
s_add_u32 s60, s60, 4096
buffer_load_dwordx4 a[64:67], v1, s[8:11], s60 offen offset:0 sc1
v_mfma_f32_16x16x32_bf16 v[20:23], a[96:99], a[28:31], v[20:23]
ds_read_b128 a[76:79], v37 offset:1024
v_mfma_f32_16x16x32_bf16 v[24:27], a[100:103], a[28:31], v[24:27]
ds_read_b128 a[80:83], v37 offset:2048
v_mfma_f32_16x16x32_bf16 v[28:31], a[104:107], a[28:31], v[28:31]
ds_read_b128 a[84:87], v37 offset:3072
v_mfma_f32_16x16x32_bf16 v[32:35], a[108:111], a[28:31], v[32:35]
ds_read_b128 a[88:91], v38 offset:0
s_waitcnt vmcnt(8)
s_waitcnt lgkmcnt(5)
v_mfma_f32_16x16x32_bf16 v[16:19], a[112:115], a[32:35], v[16:19]
ds_read_b128 a[92:95], v37 offset:4608
buffer_load_dwordx4 a[68:71], v1, s[8:11], s60 offen offset:1024 sc1
v_mfma_f32_16x16x32_bf16 v[20:23], a[116:119], a[32:35], v[20:23]
ds_read_b128 a[96:99], v37 offset:5632
v_mfma_f32_16x16x32_bf16 v[24:27], a[120:123], a[32:35], v[24:27]
ds_read_b128 a[100:103], v37 offset:6656
v_mfma_f32_16x16x32_bf16 v[28:31], a[124:127], a[32:35], v[28:31]
ds_read_b128 a[104:107], v37 offset:7680
v_mfma_f32_16x16x32_bf16 v[32:35], a[128:131], a[32:35], v[32:35]
ds_read_b128 a[108:111], v38 offset:4608
s_waitcnt vmcnt(8)
s_waitcnt lgkmcnt(5)
v_mfma_f32_16x16x32_bf16 v[16:19], a[72:75], a[36:39], v[16:19]
ds_read_b128 a[112:115], v37 offset:9216
v_mfma_f32_16x16x32_bf16 v[20:23], a[76:79], a[36:39], v[20:23]
ds_read_b128 a[116:119], v37 offset:10240
v_mfma_f32_16x16x32_bf16 v[24:27], a[80:83], a[36:39], v[24:27]
ds_read_b128 a[120:123], v37 offset:11264
v_mfma_f32_16x16x32_bf16 v[28:31], a[84:87], a[36:39], v[28:31]
ds_read_b128 a[124:127], v37 offset:12288
v_mfma_f32_16x16x32_bf16 v[32:35], a[88:91], a[36:39], v[32:35]
ds_read_b128 a[128:131], v38 offset:9216
s_waitcnt vmcnt(7)
s_waitcnt lgkmcnt(5)
v_mfma_f32_16x16x32_bf16 v[16:19], a[92:95], a[40:43], v[16:19]
ds_read_b128 a[72:75], v37 offset:13824
v_mfma_f32_16x16x32_bf16 v[20:23], a[96:99], a[40:43], v[20:23]
ds_read_b128 a[76:79], v37 offset:14848
v_mfma_f32_16x16x32_bf16 v[24:27], a[100:103], a[40:43], v[24:27]
ds_read_b128 a[80:83], v37 offset:15872
v_mfma_f32_16x16x32_bf16 v[28:31], a[104:107], a[40:43], v[28:31]
ds_read_b128 a[84:87], v37 offset:16896
v_mfma_f32_16x16x32_bf16 v[32:35], a[108:111], a[40:43], v[32:35]
ds_read_b128 a[88:91], v38 offset:13824
s_waitcnt vmcnt(6)
s_waitcnt lgkmcnt(5)
v_mfma_f32_16x16x32_bf16 v[16:19], a[112:115], a[44:47], v[16:19]
ds_read_b128 a[92:95], v37 offset:18432
v_mfma_f32_16x16x32_bf16 v[20:23], a[116:119], a[44:47], v[20:23]
ds_read_b128 a[96:99], v37 offset:19456
v_mfma_f32_16x16x32_bf16 v[24:27], a[120:123], a[44:47], v[24:27]
ds_read_b128 a[100:103], v37 offset:20480
v_mfma_f32_16x16x32_bf16 v[28:31], a[124:127], a[44:47], v[28:31]
ds_read_b128 a[104:107], v37 offset:21504
v_mfma_f32_16x16x32_bf16 v[32:35], a[128:131], a[44:47], v[32:35]
ds_read_b128 a[108:111], v38 offset:18432
s_waitcnt vmcnt(5)
s_waitcnt lgkmcnt(5)
v_mfma_f32_16x16x32_bf16 v[16:19], a[72:75], a[48:51], v[16:19]
ds_read_b128 a[112:115], v37 offset:23040
v_mfma_f32_16x16x32_bf16 v[20:23], a[76:79], a[48:51], v[20:23]
ds_read_b128 a[116:119], v37 offset:24064
v_mfma_f32_16x16x32_bf16 v[24:27], a[80:83], a[48:51], v[24:27]
ds_read_b128 a[120:123], v37 offset:25088
v_mfma_f32_16x16x32_bf16 v[28:31], a[84:87], a[48:51], v[28:31]
ds_read_b128 a[124:127], v37 offset:26112
v_mfma_f32_16x16x32_bf16 v[32:35], a[88:91], a[48:51], v[32:35]
ds_read_b128 a[128:131], v38 offset:23040
s_waitcnt vmcnt(4)
s_waitcnt lgkmcnt(5)
v_mfma_f32_16x16x32_bf16 v[16:19], a[92:95], a[52:55], v[16:19]
ds_read_b128 a[72:75], v37 offset:27648
v_mfma_f32_16x16x32_bf16 v[20:23], a[96:99], a[52:55], v[20:23]
ds_read_b128 a[76:79], v37 offset:28672
v_mfma_f32_16x16x32_bf16 v[24:27], a[100:103], a[52:55], v[24:27]
ds_read_b128 a[80:83], v37 offset:29696
v_mfma_f32_16x16x32_bf16 v[28:31], a[104:107], a[52:55], v[28:31]
ds_read_b128 a[84:87], v37 offset:30720
v_mfma_f32_16x16x32_bf16 v[32:35], a[108:111], a[52:55], v[32:35]
ds_read_b128 a[88:91], v38 offset:27648
s_waitcnt vmcnt(3)
s_waitcnt lgkmcnt(5)
v_mfma_f32_16x16x32_bf16 v[16:19], a[112:115], a[56:59], v[16:19]
ds_read_b128 a[92:95], v37 offset:32256
v_mfma_f32_16x16x32_bf16 v[20:23], a[116:119], a[56:59], v[20:23]
ds_read_b128 a[96:99], v37 offset:33280
v_mfma_f32_16x16x32_bf16 v[24:27], a[120:123], a[56:59], v[24:27]
ds_read_b128 a[100:103], v37 offset:34304
v_mfma_f32_16x16x32_bf16 v[28:31], a[124:127], a[56:59], v[28:31]
ds_read_b128 a[104:107], v37 offset:35328
v_mfma_f32_16x16x32_bf16 v[32:35], a[128:131], a[56:59], v[32:35]
ds_read_b128 a[108:111], v38 offset:32256
s_waitcnt vmcnt(2)
s_waitcnt lgkmcnt(5)
v_mfma_f32_16x16x32_bf16 v[16:19], a[72:75], a[60:63], v[16:19]
ds_read_b128 a[112:115], v37 offset:36864
v_mfma_f32_16x16x32_bf16 v[20:23], a[76:79], a[60:63], v[20:23]
ds_read_b128 a[116:119], v37 offset:37888
v_mfma_f32_16x16x32_bf16 v[24:27], a[80:83], a[60:63], v[24:27]
ds_read_b128 a[120:123], v37 offset:38912
v_mfma_f32_16x16x32_bf16 v[28:31], a[84:87], a[60:63], v[28:31]
ds_read_b128 a[124:127], v37 offset:39936
v_mfma_f32_16x16x32_bf16 v[32:35], a[88:91], a[60:63], v[32:35]
ds_read_b128 a[128:131], v38 offset:36864
s_waitcnt vmcnt(1)
s_waitcnt lgkmcnt(5)
v_mfma_f32_16x16x32_bf16 v[16:19], a[92:95], a[64:67], v[16:19]
v_mfma_f32_16x16x32_bf16 v[20:23], a[96:99], a[64:67], v[20:23]
v_mfma_f32_16x16x32_bf16 v[24:27], a[100:103], a[64:67], v[24:27]
v_mfma_f32_16x16x32_bf16 v[28:31], a[104:107], a[64:67], v[28:31]
v_mfma_f32_16x16x32_bf16 v[32:35], a[108:111], a[64:67], v[32:35]
s_waitcnt vmcnt(0)
s_waitcnt lgkmcnt(0)
v_mfma_f32_16x16x32_bf16 v[16:19], a[112:115], a[68:71], v[16:19]
v_mfma_f32_16x16x32_bf16 v[20:23], a[116:119], a[68:71], v[20:23]
v_mfma_f32_16x16x32_bf16 v[24:27], a[120:123], a[68:71], v[24:27]
v_mfma_f32_16x16x32_bf16 v[28:31], a[124:127], a[68:71], v[28:31]
v_mfma_f32_16x16x32_bf16 v[32:35], a[128:131], a[68:71], v[32:35]
s_nop 3
v_pk_add_f32 v[58:59], v[16:17], v[18:19]
v_pk_mul_f32 v[60:61], v[16:17], v[16:17]
v_pk_fma_f32 v[60:61], v[18:19], v[18:19], v[60:61]
v_pk_add_f32 v[58:59], v[58:59], v[20:21]
v_pk_fma_f32 v[60:61], v[20:21], v[20:21], v[60:61]
v_pk_add_f32 v[58:59], v[58:59], v[22:23]
v_pk_fma_f32 v[60:61], v[22:23], v[22:23], v[60:61]
v_pk_add_f32 v[58:59], v[58:59], v[24:25]
v_pk_fma_f32 v[60:61], v[24:25], v[24:25], v[60:61]
v_pk_add_f32 v[58:59], v[58:59], v[26:27]
v_pk_fma_f32 v[60:61], v[26:27], v[26:27], v[60:61]
v_pk_add_f32 v[58:59], v[58:59], v[28:29]
v_pk_fma_f32 v[60:61], v[28:29], v[28:29], v[60:61]
v_pk_add_f32 v[58:59], v[58:59], v[30:31]
v_pk_fma_f32 v[60:61], v[30:31], v[30:31], v[60:61]
s_mov_b32 exec_hi, 0
v_pk_add_f32 v[58:59], v[58:59], v[32:33]
v_pk_fma_f32 v[60:61], v[32:33], v[32:33], v[60:61]
v_pk_add_f32 v[58:59], v[58:59], v[34:35]
v_pk_fma_f32 v[60:61], v[34:35], v[34:35], v[60:61]
s_mov_b64 exec, -1
v_add_f32 v52, v58, v59
v_add_f32 v53, v60, v61
v_cvt_pk_bf16_f32 v48, v32, v33
v_cvt_pk_bf16_f32 v49, v34, v35
v_permlane32_swap_b32 v52, v53
v_add_f32 v52, v52, v53
v_mov_b32 v53, v52
v_cvt_pk_bf16_f32 v40, v16, v17
v_cvt_pk_bf16_f32 v41, v18, v19
v_permlane16_swap_b32 v52, v53
v_add_f32 v52, v52, v53
v_mov_b32 v53, v52
v_cvt_pk_bf16_f32 v42, v20, v21
v_cvt_pk_bf16_f32 v43, v22, v23
v_permlane32_swap_b32 v52, v53
buffer_store_dwordx4 v[40:43], v56, s[8:11], s62 offen sc1
buffer_store_dwordx2 v[52:53], v54, s[8:11], s63 offen sc1
v_cvt_pk_bf16_f32 v44, v24, v25
v_cvt_pk_bf16_f32 v45, v26, v27
v_cvt_pk_bf16_f32 v46, v28, v29
v_cvt_pk_bf16_f32 v47, v30, v31
v_permlane16_swap_b32 v48, v50
v_permlane16_swap_b32 v49, v51
buffer_store_dwordx4 v[44:47], v56, s[8:11], s62 offen offset:2048 sc1
buffer_store_dwordx4 v[48:51], v57, s[8:11], s62 offen sc1
s_barrier
s_mul_i32 s38, s24, 9216
s_add_u32 m0, s38, 37888
s_add_u32 s39, s38, s82
s_add_u32 s39, s39, 75776
buffer_load_dwordx4 v1, s[4:7], s39 offen offset:0 sc1 lds
buffer_load_dwordx4 v1, s[4:7], s39 offen offset:1024 sc1 lds
buffer_load_dwordx4 v1, s[4:7], s39 offen offset:2048 sc1 lds
buffer_load_dwordx4 v1, s[4:7], s39 offen offset:3072 sc1 lds
s_add_u32 m0, m0, 4096
s_add_u32 s39, s39, 4096
buffer_load_dwordx4 v1, s[4:7], s39 offen offset:0 sc1 lds
buffer_load_dwordx4 v1, s[4:7], s39 offen offset:1024 sc1 lds
buffer_load_dwordx4 v1, s[4:7], s39 offen offset:2048 sc1 lds
buffer_load_dwordx4 v1, s[4:7], s39 offen offset:3072 sc1 lds
s_add_u32 m0, m0, 4096
s_add_u32 s39, s39, 4096
buffer_load_dwordx4 v1, s[4:7], s39 offen offset:0 sc1 lds
s_lshl_b32 s38, s24, 8
s_add_u32 m0, s38, 74752
s_add_u32 s39, s38, s82
s_add_u32 s39, s39, 112640
s_mov_b64 exec, 0xffff
buffer_load_dwordx4 v1, s[4:7], s39 offen sc1 lds
s_mov_b64 exec, -1
v_lshlrev_b32 v7, 3, v1
s_lshr_b32 s31, s81, 4
s_lshl_b32 s31, s31, 11
v_add_u32 v7, s31, v7
s_cmp_eq_u32 s24, 0
s_cselect_b32 s30, 0, 1073741824
s_add_u32 s30, s30, 26509312
s_waitcnt vmcnt(10)
s_barrier
s_mov_b64 exec, 0xffff
buffer_atomic_add v4, v7, s[8:11], s30 offen sc1
s_mov_b64 exec, -1
s_lshl_b32 s35, s80, 7
s_add_u32 s35, s35, 26509312
s_cmp_eq_u32 s24, 1
s_cselect_b32 s35, s35, 1073741824
v_mov_b32 v6, 0
s_mul_i32 s38, s24, 9216
s_add_u32 m0, s38, 75776
s_add_u32 s39, s38, s82
s_add_u32 s39, s39, 113664
buffer_load_dwordx4 v1, s[4:7], s39 offen offset:0 sc1 lds
buffer_load_dwordx4 v1, s[4:7], s39 offen offset:1024 sc1 lds
v_mov_b32 v249, 0
s_mov_b64 exec, 1
buffer_atomic_add v249, v6, s[8:11], s35 offen sc0 sc1
s_mov_b64 exec, -1
buffer_load_dwordx4 v1, s[4:7], s39 offen offset:2048 sc1 lds
buffer_load_dwordx4 v1, s[4:7], s39 offen offset:3072 sc1 lds
s_add_u32 m0, m0, 4096
s_add_u32 s39, s39, 4096
buffer_load_dwordx4 v1, s[4:7], s39 offen offset:0 sc1 lds
v_mov_b32 v250, 0
s_mov_b64 exec, 1
buffer_atomic_add v250, v6, s[8:11], s35 offen sc0 sc1
s_mov_b64 exec, -1
buffer_load_dwordx4 v1, s[4:7], s39 offen offset:1024 sc1 lds
buffer_load_dwordx4 v1, s[4:7], s39 offen offset:2048 sc1 lds
buffer_load_dwordx4 v1, s[4:7], s39 offen offset:3072 sc1 lds
s_add_u32 m0, m0, 4096
s_add_u32 s39, s39, 4096
v_mov_b32 v251, 0
s_mov_b64 exec, 1
buffer_atomic_add v251, v6, s[8:11], s35 offen sc0 sc1
s_mov_b64 exec, -1
buffer_load_dwordx4 v1, s[4:7], s39 offen offset:0 sc1 lds
s_lshl_b32 s38, s24, 8
s_add_u32 m0, s38, 112640
s_add_u32 s39, s38, s82
s_add_u32 s39, s39, 150528
s_mov_b64 exec, 0xffff
buffer_load_dwordx4 v1, s[4:7], s39 offen sc1 lds
s_mov_b64 exec, -1
s_lshl_b32 s60, s25, 2
s_add_u32 s60, s60, s24
s_mul_i32 s62, s60, 36864
s_add_u32 s62, s62, 4849664
s_cmp_eq_u32 s24, 1
s_cbranch_scc0 L_other_20
s_mov_b32 s31, 0
s_mov_b64 exec, 1
v_mov_b32 v252, 0
buffer_atomic_add v252, v6, s[8:11], s35 offen sc0 sc1
s_waitcnt vmcnt(11)
v_cmp_gt_u32 vcc, 16, v249
s_nop 0
s_cbranch_vccz L_polled_19
s_waitcnt vmcnt(7)
v_cmp_gt_u32 vcc, 16, v250
s_nop 0
s_cbranch_vccz L_polled_19
v_mov_b32 v249, 0
buffer_atomic_add v249, v6, s[8:11], s35 offen sc0 sc1
s_waitcnt vmcnt(4)
v_cmp_gt_u32 vcc, 16, v251
s_nop 0
s_cbranch_vccz L_polled_19
v_mov_b32 v250, 0
buffer_atomic_add v250, v6, s[8:11], s35 offen sc0 sc1
L_poll_18:
s_add_u32 s31, s31, 1
s_cmp_gt_u32 s31, 100000
s_cbranch_scc1 L_polled_19
v_mov_b32 v251, 0
buffer_atomic_add v251, v6, s[8:11], s35 offen sc0 sc1
s_waitcnt vmcnt(3)
v_cmp_gt_u32 vcc, 16, v252
s_nop 0
s_cbranch_vccz L_polled_19
v_mov_b32 v252, 0
buffer_atomic_add v252, v6, s[8:11], s35 offen sc0 sc1
s_waitcnt vmcnt(3)
v_cmp_gt_u32 vcc, 16, v249
s_nop 0
s_cbranch_vccz L_polled_19
v_mov_b32 v249, 0
buffer_atomic_add v249, v6, s[8:11], s35 offen sc0 sc1
s_waitcnt vmcnt(3)
v_cmp_gt_u32 vcc, 16, v250
s_nop 0
s_cbranch_vccz L_polled_19
v_mov_b32 v250, 0
buffer_atomic_add v250, v6, s[8:11], s35 offen sc0 sc1
s_waitcnt vmcnt(3)
v_cmp_gt_u32 vcc, 16, v251
s_nop 0
s_cbranch_vccz L_polled_19
s_branch L_poll_18
L_polled_19:
s_mov_b64 exec, -1
L_other_20:
s_cmp_eq_u32 s24, 1
s_cbranch_scc1 L_join_22
s_waitcnt vmcnt(14)
L_join_22:
s_barrier
buffer_load_dwordx4 a[0:3], v1, s[8:11], s62 offen offset:0 sc1
buffer_load_dwordx4 a[4:7], v1, s[8:11], s62 offen offset:1024 sc1
s_barrier
buffer_load_dwordx4 a[8:11], v1, s[8:11], s62 offen offset:2048 sc1
buffer_load_dwordx4 a[12:15], v1, s[8:11], s62 offen offset:3072 sc1
s_barrier
s_add_u32 s62, s62, 4096
buffer_load_dwordx4 a[16:19], v1, s[8:11], s62 offen offset:0 sc1
buffer_load_dwordx4 a[20:23], v1, s[8:11], s62 offen offset:1024 sc1
s_barrier
buffer_load_dwordx4 a[24:27], v1, s[8:11], s62 offen offset:2048 sc1
buffer_load_dwordx4 a[28:31], v1, s[8:11], s62 offen offset:3072 sc1
s_barrier
s_add_u32 s62, s62, 4096
buffer_load_dwordx4 a[32:35], v1, s[8:11], s62 offen offset:0 sc1
buffer_load_dwordx4 a[36:39], v1, s[8:11], s62 offen offset:1024 sc1
s_barrier
buffer_load_dwordx4 a[40:43], v1, s[8:11], s62 offen offset:2048 sc1
buffer_load_dwordx4 a[44:47], v1, s[8:11], s62 offen offset:3072 sc1
s_lshl_b32 s52, s25, 19
s_lshl_b32 s38, s24, 17
s_add_u32 s52, s52, s38
s_add_u32 s52, s52, 10895360
v_lshrrev_b32 v6, 1, v1
v_and_b32 v6, 0xf8, v6
v_lshrrev_b32 v7, 1, v3
v_lshl_add_u32 v232, v7, 16, v6
s_lshl_b32 s63, s60, 8
s_add_u32 s63, s63, 7208960
v_add_u32 v206, 123904, v1
v_add_u32 v207, 0, v1
v_add_u32 v208, 37888, v1
v_add_u32 v209, 75776, v1
ds_read_b128 a[144:147], v206 offset:0
ds_read_b128 a[148:151], v207 offset:0
ds_read_b128 a[152:155], v206 offset:1024
ds_read_b128 a[156:159], v207 offset:1024
ds_read_b128 a[160:163], v206 offset:2048
ds_read_b128 a[164:167], v207 offset:2048
ds_read_b128 a[168:171], v206 offset:3072
s_waitcnt vmcnt(11)
s_waitcnt lgkmcnt(3)
v_mfma_f32_32x32x16_bf16 v[36:51], a[144:147], a[0:3], 0
ds_read_b128 a[172:175], v207 offset:3072
s_add_u32 s62, s62, 4096
v_mfma_f32_32x32x16_bf16 v[52:67], a[148:151], a[0:3], 0
ds_read_b128 a[144:147], v206 offset:4096
buffer_load_dwordx4 a[48:51], v1, s[8:11], s62 offen offset:0 sc1
s_waitcnt vmcnt(11)
v_mfma_f32_32x32x16_bf16 v[36:51], a[152:155], a[4:7], v[36:51]
ds_read_b128 a[148:151], v207 offset:4096
buffer_load_dwordx4 a[52:55], v1, s[8:11], s62 offen offset:1024 sc1
v_lshl_add_u32 v234, v7, 13, v6
v_mfma_f32_32x32x16_bf16 v[52:67], a[156:159], a[4:7], v[52:67]
ds_read_b128 a[152:155], v206 offset:5120
buffer_load_dwordx4 a[56:59], v1, s[8:11], s62 offen offset:2048 sc1
v_add_u32 v235, 4096, v234
s_waitcnt vmcnt(12)
s_waitcnt lgkmcnt(3)
v_mfma_f32_32x32x16_bf16 v[36:51], a[160:163], a[8:11], v[36:51]
ds_read_b128 a[156:159], v207 offset:5120
s_mul_i32 s30, s24, 9216
v_mfma_f32_32x32x16_bf16 v[52:67], a[164:167], a[8:11], v[52:67]
ds_read_b128 a[160:163], v206 offset:6144
buffer_load_dwordx4 a[60:63], v1, s[8:11], s62 offen offset:3072 sc1
s_add_u32 s30, s30, 0
s_waitcnt vmcnt(12)
v_mfma_f32_32x32x16_bf16 v[36:51], a[168:171], a[12:15], v[36:51]
ds_read_b128 a[164:167], v207 offset:6144
s_add_u32 s62, s62, 4096
v_mfma_f32_32x32x16_bf16 v[52:67], a[172:175], a[12:15], v[52:67]
ds_read_b128 a[168:171], v206 offset:7168
buffer_load_dwordx2 v[180:181], v232, s[8:11], s63 offen sc1
v_bfe_u32 v8, v1, 4, 5
s_waitcnt vmcnt(12)
s_waitcnt lgkmcnt(3)
v_mfma_f32_32x32x16_bf16 v[36:51], a[144:147], a[16:19], v[36:51]
ds_read_b128 a[172:175], v207 offset:7168
v_mul_u32_u24 v237, 288, v8
v_mfma_f32_32x32x16_bf16 v[52:67], a[148:151], a[16:19], v[52:67]
ds_read_b128 a[144:147], v206 offset:8192
s_add_u32 s63, s63, 16384
v_add_u32 v237, s30, v237
s_waitcnt vmcnt(11)
v_mfma_f32_32x32x16_bf16 v[36:51], a[152:155], a[20:23], v[36:51]
ds_read_b128 a[148:151], v207 offset:8192
buffer_load_dwordx2 v[182:183], v232, s[8:11], s63 offen sc1
v_lshl_add_u32 v239, v7, 4, v237
v_mfma_f32_32x32x16_bf16 v[52:67], a[156:159], a[20:23], v[52:67]
ds_read_b128 a[152:155], v206 offset:9216
s_add_u32 s63, s63, 16384
s_waitcnt vmcnt(11)
s_waitcnt lgkmcnt(3)
v_mfma_f32_32x32x16_bf16 v[36:51], a[160:163], a[24:27], v[36:51]
ds_read_b128 a[156:159], v207 offset:9216
buffer_load_dwordx2 v[184:185], v232, s[8:11], s63 offen sc1
v_lshl_add_u32 v237, v7, 5, v237
v_mfma_f32_32x32x16_bf16 v[52:67], a[164:167], a[24:27], v[52:67]
ds_read_b128 a[160:163], v206 offset:10240
v_lshrrev_b32 v8, 2, v2
s_waitcnt vmcnt(11)
v_mfma_f32_32x32x16_bf16 v[36:51], a[168:171], a[28:31], v[36:51]
ds_read_b128 a[164:167], v207 offset:10240
s_add_u32 s63, s63, 16384
v_lshl_add_u32 v8, v3, 3, v8
v_mfma_f32_32x32x16_bf16 v[52:67], a[172:175], a[28:31], v[52:67]
ds_read_b128 a[168:171], v206 offset:11264
buffer_load_dwordx2 v[186:187], v232, s[8:11], s63 offen sc1
s_waitcnt vmcnt(11)
s_waitcnt lgkmcnt(3)
v_mfma_f32_32x32x16_bf16 v[36:51], a[144:147], a[32:35], v[36:51]
ds_read_b128 a[172:175], v207 offset:11264
s_add_u32 s63, s63, 16384
v_mul_u32_u24 v238, 288, v8
v_mfma_f32_32x32x16_bf16 v[52:67], a[148:151], a[32:35], v[52:67]
ds_read_b128 a[144:147], v206 offset:12288
v_and_b32 v8, 3, v2
s_waitcnt vmcnt(10)
v_mfma_f32_32x32x16_bf16 v[36:51], a[152:155], a[36:39], v[36:51]
ds_read_b128 a[148:151], v207 offset:12288
buffer_load_dwordx4 a[64:67], v1, s[8:11], s62 offen offset:0 sc1
v_lshl_add_u32 v238, v8, 3, v238
v_mfma_f32_32x32x16_bf16 v[52:67], a[156:159], a[36:39], v[52:67]
ds_read_b128 a[152:155], v206 offset:13312
buffer_load_dwordx4 a[68:71], v1, s[8:11], s62 offen offset:1024 sc1
v_add_u32 v238, s30, v238
s_waitcnt vmcnt(11)
s_waitcnt lgkmcnt(3)
v_mfma_f32_32x32x16_bf16 v[36:51], a[160:163], a[40:43], v[36:51]
ds_read_b128 a[156:159], v207 offset:13312
buffer_load_dwordx4 a[72:75], v1, s[8:11], s62 offen offset:2048 sc1
v_mfma_f32_32x32x16_bf16 v[52:67], a[164:167], a[40:43], v[52:67]
ds_read_b128 a[160:163], v206 offset:14336
buffer_load_dwordx4 a[76:79], v1, s[8:11], s62 offen offset:3072 sc1
s_mul_i32 s66, s26, 589824
s_waitcnt vmcnt(12)
v_mfma_f32_32x32x16_bf16 v[36:51], a[168:171], a[44:47], v[36:51]
ds_read_b128 a[164:167], v207 offset:14336
s_mul_i32 s31, s60, 9216
v_mfma_f32_32x32x16_bf16 v[52:67], a[172:175], a[44:47], v[52:67]
ds_read_b128 a[168:171], v206 offset:15360
s_add_u32 s62, s62, 4096
s_add_u32 s66, s66, s31
s_waitcnt vmcnt(11)
s_waitcnt lgkmcnt(3)
v_mfma_f32_32x32x16_bf16 v[36:51], a[144:147], a[48:51], v[36:51]
ds_read_b128 a[172:175], v207 offset:15360
buffer_load_dwordx4 a[80:83], v1, s[8:11], s62 offen offset:0 sc1
s_add_u32 s66, s66, 7340032
v_mfma_f32_32x32x16_bf16 v[52:67], a[148:151], a[48:51], v[52:67]
ds_read_b128 a[144:147], v206 offset:16384
buffer_load_dwordx4 a[84:87], v1, s[8:11], s62 offen offset:1024 sc1
s_waitcnt vmcnt(12)
v_mfma_f32_32x32x16_bf16 v[36:51], a[152:155], a[52:55], v[36:51]
ds_read_b128 a[148:151], v207 offset:16384
v_lshlrev_b32 v236, 7, v1
v_mfma_f32_32x32x16_bf16 v[52:67], a[156:159], a[52:55], v[52:67]
ds_read_b128 a[152:155], v206 offset:17408
buffer_load_dwordx4 a[88:91], v1, s[8:11], s62 offen offset:2048 sc1
s_lshl_b32 s31, s26, 7
s_waitcnt vmcnt(12)
s_waitcnt lgkmcnt(3)
v_mfma_f32_32x32x16_bf16 v[36:51], a[160:163], a[56:59], v[36:51]
ds_read_b128 a[156:159], v207 offset:17408
buffer_load_dwordx4 a[92:95], v1, s[8:11], s62 offen offset:3072 sc1
v_add_u32 v236, s31, v236
v_mfma_f32_32x32x16_bf16 v[52:67], a[164:167], a[56:59], v[52:67]
ds_read_b128 a[160:163], v206 offset:18432
s_add_u32 s62, s62, 4096
s_waitcnt vmcnt(12)
v_mfma_f32_32x32x16_bf16 v[36:51], a[168:171], a[60:63], v[36:51]
ds_read_b128 a[164:167], v207 offset:18432
buffer_load_dwordx4 a[96:99], v1, s[8:11], s62 offen offset:0 sc1
s_lshl_b32 s61, s25, 14
v_mfma_f32_32x32x16_bf16 v[52:67], a[172:175], a[60:63], v[52:67]
ds_read_b128 a[168:171], v206 offset:19456
s_lshl_b32 s30, s24, 8
s_waitcnt vmcnt(8)
s_waitcnt lgkmcnt(3)
v_mfma_f32_32x32x16_bf16 v[36:51], a[144:147], a[64:67], v[36:51]
ds_read_b128 a[172:175], v207 offset:19456
buffer_load_dwordx4 a[100:103], v1, s[8:11], s62 offen offset:1024 sc1
s_add_u32 s61, s61, s30
v_mfma_f32_32x32x16_bf16 v[52:67], a[148:151], a[64:67], v[52:67]
ds_read_b128 a[144:147], v206 offset:20480
buffer_load_dwordx4 a[104:107], v1, s[8:11], s62 offen offset:2048 sc1
s_add_u32 s61, s61, 26214400
s_waitcnt vmcnt(9)
v_mfma_f32_32x32x16_bf16 v[36:51], a[152:155], a[68:71], v[36:51]
ds_read_b128 a[148:151], v207 offset:20480
buffer_load_dwordx4 a[108:111], v1, s[8:11], s62 offen offset:3072 sc1
v_mfma_f32_32x32x16_bf16 v[52:67], a[156:159], a[68:71], v[52:67]
ds_read_b128 a[152:155], v206 offset:21504
s_lshl_b32 s30, s26, 10
s_waitcnt vmcnt(9)
s_waitcnt lgkmcnt(3)
v_mfma_f32_32x32x16_bf16 v[36:51], a[160:163], a[72:75], v[36:51]
ds_read_b128 a[156:159], v207 offset:21504
s_add_u32 s62, s62, 4096
s_add_u32 s30, s30, s61
v_mfma_f32_32x32x16_bf16 v[52:67], a[164:167], a[72:75], v[52:67]
ds_read_b128 a[160:163], v206 offset:22528
buffer_load_dwordx4 a[112:115], v1, s[8:11], s62 offen offset:0 sc1
v_lshrrev_b32 v6, 1, v1
s_waitcnt vmcnt(9)
v_mfma_f32_32x32x16_bf16 v[36:51], a[168:171], a[76:79], v[36:51]
ds_read_b128 a[164:167], v207 offset:22528
buffer_load_dwordx4 a[116:119], v1, s[8:11], s62 offen offset:1024 sc1
v_mfma_f32_32x32x16_bf16 v[52:67], a[172:175], a[76:79], v[52:67]
ds_read_b128 a[168:171], v206 offset:23552
buffer_load_dwordx4 a[120:123], v1, s[8:11], s62 offen offset:2048 sc1
s_waitcnt vmcnt(10)
s_waitcnt lgkmcnt(3)
v_mfma_f32_32x32x16_bf16 v[36:51], a[144:147], a[80:83], v[36:51]
ds_read_b128 a[172:175], v207 offset:23552
v_add_f32 v196, v180, v182
v_mfma_f32_32x32x16_bf16 v[52:67], a[148:151], a[80:83], v[52:67]
ds_read_b128 a[144:147], v206 offset:24576
buffer_load_dwordx4 a[124:127], v1, s[8:11], s62 offen offset:3072 sc1
v_add_f32 v197, v181, v183
s_waitcnt vmcnt(10)
v_mfma_f32_32x32x16_bf16 v[36:51], a[152:155], a[84:87], v[36:51]
ds_read_b128 a[148:151], v207 offset:24576
s_add_u32 s62, s62, 4096
v_add_f32 v196, v196, v184
v_mfma_f32_32x32x16_bf16 v[52:67], a[156:159], a[84:87], v[52:67]
ds_read_b128 a[152:155], v206 offset:25600
buffer_load_dwordx4 a[128:131], v1, s[8:11], s62 offen offset:0 sc1
v_add_f32 v197, v197, v185
v_add_f32 v196, v196, v186
s_waitcnt vmcnt(10)
s_waitcnt lgkmcnt(3)
v_mfma_f32_32x32x16_bf16 v[36:51], a[160:163], a[88:91], v[36:51]
ds_read_b128 a[156:159], v207 offset:25600
v_add_f32 v197, v197, v187
v_mfma_f32_32x32x16_bf16 v[52:67], a[164:167], a[88:91], v[52:67]
ds_read_b128 a[160:163], v206 offset:26624
buffer_load_dwordx4 a[132:135], v1, s[8:11], s62 offen offset:1024 sc1
v_mov_b32 v198, v196
s_waitcnt vmcnt(10)
v_mfma_f32_32x32x16_bf16 v[36:51], a[168:171], a[92:95], v[36:51]
ds_read_b128 a[164:167], v207 offset:26624
buffer_load_dwordx4 a[136:139], v1, s[8:11], s62 offen offset:2048 sc1
v_mov_b32 v199, v197
v_mov_b32 v204, 0
v_mfma_f32_32x32x16_bf16 v[52:67], a[172:175], a[92:95], v[52:67]
ds_read_b128 a[168:171], v206 offset:27648
buffer_load_dwordx4 a[140:143], v1, s[8:11], s62 offen offset:3072 sc1
v_mov_b32 v205, 0
s_waitcnt vmcnt(11)
s_waitcnt lgkmcnt(3)
v_mfma_f32_32x32x16_bf16 v[36:51], a[144:147], a[96:99], v[36:51]
ds_read_b128 a[172:175], v207 offset:27648
v_permlane32_swap_b32 v196, v198
v_mfma_f32_32x32x16_bf16 v[52:67], a[148:151], a[96:99], v[52:67]
ds_read_b128 a[144:147], v206 offset:28672
s_waitcnt vmcnt(10)
v_mfma_f32_32x32x16_bf16 v[36:51], a[152:155], a[100:103], v[36:51]
ds_read_b128 a[148:151], v207 offset:28672
v_permlane32_swap_b32 v197, v199
v_mfma_f32_32x32x16_bf16 v[52:67], a[156:159], a[100:103], v[52:67]
ds_read_b128 a[152:155], v206 offset:29696
v_add_f32 v196, v196, v198
s_waitcnt vmcnt(9)
s_waitcnt lgkmcnt(3)
v_mfma_f32_32x32x16_bf16 v[36:51], a[160:163], a[104:107], v[36:51]
ds_read_b128 a[156:159], v207 offset:29696
v_add_f32 v197, v197, v199
v_mfma_f32_32x32x16_bf16 v[52:67], a[164:167], a[104:107], v[52:67]
ds_read_b128 a[160:163], v206 offset:30720
v_mul_f32 v196, 0x3ae38e39, v196
v_mul_f32 v198, v196, v196
s_waitcnt vmcnt(8)
v_mfma_f32_32x32x16_bf16 v[36:51], a[168:171], a[108:111], v[36:51]
ds_read_b128 a[164:167], v207 offset:30720
v_mul_f32 v197, 0x3ae38e39, v197
v_mfma_f32_32x32x16_bf16 v[52:67], a[172:175], a[108:111], v[52:67]
ds_read_b128 a[168:171], v206 offset:31744
v_sub_f32 v197, v197, v198
s_waitcnt vmcnt(7)
s_waitcnt lgkmcnt(3)
v_mfma_f32_32x32x16_bf16 v[36:51], a[144:147], a[112:115], v[36:51]
ds_read_b128 a[172:175], v207 offset:31744
v_max_f32 v197, 0, v197
v_mfma_f32_32x32x16_bf16 v[52:67], a[148:151], a[112:115], v[52:67]
ds_read_b128 a[144:147], v206 offset:32768
v_add_f32 v197, 0x3727c5ac, v197
v_rsq_f32 v253, v197
s_waitcnt vmcnt(6)
v_mfma_f32_32x32x16_bf16 v[36:51], a[152:155], a[116:119], v[36:51]
ds_read_b128 a[148:151], v207 offset:32768
v_mfma_f32_32x32x16_bf16 v[52:67], a[156:159], a[116:119], v[52:67]
ds_read_b128 a[152:155], v206 offset:33792
v_sqrt_f32 v255, v197
s_waitcnt vmcnt(5)
s_waitcnt lgkmcnt(3)
v_mfma_f32_32x32x16_bf16 v[36:51], a[160:163], a[120:123], v[36:51]
ds_read_b128 a[156:159], v207 offset:33792
v_cvt_pk_bf16_f32 v198, -v196, -v196
v_mfma_f32_32x32x16_bf16 v[52:67], a[164:167], a[120:123], v[52:67]
ds_read_b128 a[160:163], v206 offset:34816
v_and_b32 v198, 0xffff0000, v198
s_waitcnt vmcnt(4)
v_mfma_f32_32x32x16_bf16 v[36:51], a[168:171], a[124:127], v[36:51]
ds_read_b128 a[164:167], v207 offset:34816
v_add_f32 v198, v196, v198
v_mfma_f32_32x32x16_bf16 v[52:67], a[172:175], a[124:127], v[52:67]
ds_read_b128 a[168:171], v206 offset:35840
v_cvt_pk_bf16_f32 v212, -v196, -v198
s_waitcnt vmcnt(3)
s_waitcnt lgkmcnt(3)
v_mfma_f32_32x32x16_bf16 v[36:51], a[144:147], a[128:131], v[36:51]
ds_read_b128 a[172:175], v207 offset:35840
v_mov_b32 v213, v212
v_mov_b32 v214, v212
v_mfma_f32_32x32x16_bf16 v[52:67], a[148:151], a[128:131], v[52:67]
ds_read_b128 a[144:147], v206 offset:36864
v_mov_b32 v215, v212
s_waitcnt vmcnt(2)
v_mfma_f32_32x32x16_bf16 v[36:51], a[152:155], a[132:135], v[36:51]
ds_read_b128 a[148:151], v207 offset:36864
v_mul_f32 v254, v253, v253
v_mfma_f32_32x32x16_bf16 v[52:67], a[156:159], a[132:135], v[52:67]
ds_read_b128 a[152:155], v208 offset:0
v_mul_f32 v254, v254, v253
v_mul_f32 v254, 0xbdd2d3e8, v254
s_waitcnt vmcnt(1)
s_waitcnt lgkmcnt(3)
v_mfma_f32_32x32x16_bf16 v[36:51], a[160:163], a[136:139], v[36:51]
ds_read_b128 a[156:159], v208 offset:1024
v_mul_f32 v253, 0xc0135761, v253
v_mfma_f32_32x32x16_bf16 v[52:67], a[164:167], a[136:139], v[52:67]
ds_read_b128 a[160:163], v208 offset:2048
v_mov_b32 v240, v253
s_waitcnt vmcnt(0)
v_mfma_f32_32x32x16_bf16 v[36:51], a[168:171], a[140:143], v[36:51]
ds_read_b128 a[164:167], v208 offset:3072
v_mov_b32 v242, v254
v_mfma_f32_32x32x16_bf16 v[52:67], a[172:175], a[140:143], v[52:67]
ds_read_b128 a[168:171], v208 offset:4096
s_waitcnt lgkmcnt(3)
v_mfma_f32_32x32x16_bf16 v[36:51], a[144:147], v[212:215], v[36:51]
ds_read_b128 a[172:175], v208 offset:5120
v_mfma_f32_32x32x16_bf16 v[52:67], a[148:151], v[212:215], v[52:67]
ds_read_b128 a[144:147], v208 offset:6144
s_barrier
v_mfma_f32_32x32x16_bf16 v[68:83], a[152:155], a[0:3], 0
ds_read_b128 a[148:151], v208 offset:7168
s_mul_i32 s38, s24, 9216
s_add_u32 m0, s38, 123904
v_mfma_f32_32x32x16_bf16 v[68:83], a[156:159], a[4:7], v[68:83]
ds_read_b128 a[152:155], v208 offset:8192
s_add_u32 s39, s38, s82
s_waitcnt lgkmcnt(3)
v_mfma_f32_32x32x16_bf16 v[68:83], a[160:163], a[8:11], v[68:83]
ds_read_b128 a[156:159], v208 offset:9216
s_add_u32 s39, s39, 151552
v_mfma_f32_32x32x16_bf16 v[68:83], a[164:167], a[12:15], v[68:83]
ds_read_b128 a[160:163], v208 offset:10240
buffer_load_dwordx4 v1, s[4:7], s39 offen offset:0 sc1 lds
v_mfma_f32_32x32x16_bf16 v[68:83], a[168:171], a[16:19], v[68:83]
ds_read_b128 a[164:167], v208 offset:11264
buffer_load_dwordx4 v1, s[4:7], s39 offen offset:1024 sc1 lds
v_pk_mul_f32 v[216:217], v[36:37], v[36:37]
v_pk_mul_f32 v[218:219], v[38:39], v[38:39]
v_pk_mul_f32 v[220:221], v[40:41], v[40:41]
v_pk_mul_f32 v[222:223], v[42:43], v[42:43]
v_pk_fma_f32 v[216:217], v[216:217], v[242:243], v[240:241] op_sel_hi:[1,0,0]
v_pk_fma_f32 v[218:219], v[218:219], v[242:243], v[240:241] op_sel_hi:[1,0,0]
v_pk_fma_f32 v[220:221], v[220:221], v[242:243], v[240:241] op_sel_hi:[1,0,0]
v_pk_fma_f32 v[222:223], v[222:223], v[242:243], v[240:241] op_sel_hi:[1,0,0]
v_pk_mul_f32 v[216:217], v[216:217], v[36:37]
v_pk_mul_f32 v[218:219], v[218:219], v[38:39]
v_pk_mul_f32 v[220:221], v[220:221], v[40:41]
v_pk_mul_f32 v[222:223], v[222:223], v[42:43]
v_mfma_f32_32x32x16_bf16 v[68:83], a[172:175], a[20:23], v[68:83]
ds_read_b128 a[168:171], v208 offset:12288
buffer_load_dwordx4 v1, s[4:7], s39 offen offset:2048 sc1 lds
v_exp_f32 v216, v216
v_exp_f32 v217, v217
v_exp_f32 v218, v218
s_waitcnt lgkmcnt(3)
v_mfma_f32_32x32x16_bf16 v[68:83], a[144:147], a[24:27], v[68:83]
ds_read_b128 a[172:175], v208 offset:13312
buffer_load_dwordx4 v1, s[4:7], s39 offen offset:3072 sc1 lds
s_add_u32 m0, m0, 4096
v_exp_f32 v219, v219
v_fma_f32 v216, v216, v255, v255
v_mfma_f32_32x32x16_bf16 v[68:83], a[148:151], a[28:31], v[68:83]
ds_read_b128 a[144:147], v208 offset:14336
s_add_u32 s39, s39, 4096
v_fma_f32 v217, v217, v255, v255
v_fma_f32 v218, v218, v255, v255
v_fma_f32 v219, v219, v255, v255
v_mfma_f32_32x32x16_bf16 v[68:83], a[152:155], a[32:35], v[68:83]
ds_read_b128 a[148:151], v208 offset:15360
buffer_load_dwordx4 v1, s[4:7], s39 offen offset:0 sc1 lds
v_rcp_f32 v216, v216
v_rcp_f32 v217, v217
v_mfma_f32_32x32x16_bf16 v[68:83], a[156:159], a[36:39], v[68:83]
ds_read_b128 a[152:155], v208 offset:16384
buffer_load_dwordx4 v1, s[4:7], s39 offen offset:1024 sc1 lds
v_rcp_f32 v218, v218
v_rcp_f32 v219, v219
s_waitcnt lgkmcnt(3)
v_mfma_f32_32x32x16_bf16 v[68:83], a[160:163], a[40:43], v[68:83]
ds_read_b128 a[156:159], v208 offset:17408
buffer_load_dwordx4 v1, s[4:7], s39 offen offset:2048 sc1 lds
v_mul_f32 v36, v36, v216
v_mul_f32 v37, v37, v217
v_mul_f32 v38, v38, v218
v_mul_f32 v39, v39, v219
v_mfma_f32_32x32x16_bf16 v[68:83], a[164:167], a[44:47], v[68:83]
ds_read_b128 a[160:163], v208 offset:18432
buffer_load_dwordx4 v1, s[4:7], s39 offen offset:3072 sc1 lds
s_add_u32 m0, m0, 4096
v_exp_f32 v220, v220
v_mfma_f32_32x32x16_bf16 v[68:83], a[168:171], a[48:51], v[68:83]
ds_read_b128 a[164:167], v208 offset:19456
s_add_u32 s39, s39, 4096
v_exp_f32 v221, v221
v_exp_f32 v222, v222
v_mfma_f32_32x32x16_bf16 v[68:83], a[172:175], a[52:55], v[68:83]
ds_read_b128 a[168:171], v208 offset:20480
buffer_load_dwordx4 v1, s[4:7], s39 offen offset:0 sc1 lds
v_exp_f32 v223, v223
v_fma_f32 v220, v220, v255, v255
s_waitcnt lgkmcnt(3)
v_mfma_f32_32x32x16_bf16 v[68:83], a[144:147], a[56:59], v[68:83]
ds_read_b128 a[172:175], v208 offset:21504
s_lshl_b32 s38, s24, 8
v_fma_f32 v221, v221, v255, v255
v_fma_f32 v222, v222, v255, v255
v_fma_f32 v223, v223, v255, v255
v_mfma_f32_32x32x16_bf16 v[68:83], a[148:151], a[60:63], v[68:83]
ds_read_b128 a[144:147], v208 offset:22528
s_add_u32 m0, s38, 160768
s_add_u32 s39, s38, s82
v_rcp_f32 v220, v220
v_rcp_f32 v221, v221
v_mfma_f32_32x32x16_bf16 v[68:83], a[152:155], a[64:67], v[68:83]
ds_read_b128 a[148:151], v208 offset:23552
s_add_u32 s39, s39, 188416
v_rcp_f32 v222, v222
v_rcp_f32 v223, v223
v_mfma_f32_32x32x16_bf16 v[68:83], a[156:159], a[68:71], v[68:83]
ds_read_b128 a[152:155], v208 offset:24576
s_mov_b64 exec, 0xffff
buffer_load_dwordx4 v1, s[4:7], s39 offen sc1 lds
s_mov_b64 exec, -1
v_mul_f32 v40, v40, v220
v_mul_f32 v41, v41, v221
v_mul_f32 v42, v42, v222
v_mul_f32 v43, v43, v223
s_waitcnt lgkmcnt(3)
v_mfma_f32_32x32x16_bf16 v[68:83], a[160:163], a[72:75], v[68:83]
ds_read_b128 a[156:159], v208 offset:25600
v_pk_mul_f32 v[224:225], v[44:45], v[44:45]
v_pk_mul_f32 v[226:227], v[46:47], v[46:47]
v_pk_mul_f32 v[228:229], v[48:49], v[48:49]
v_pk_mul_f32 v[230:231], v[50:51], v[50:51]
v_pk_fma_f32 v[224:225], v[224:225], v[242:243], v[240:241] op_sel_hi:[1,0,0]
v_pk_fma_f32 v[226:227], v[226:227], v[242:243], v[240:241] op_sel_hi:[1,0,0]
v_pk_fma_f32 v[228:229], v[228:229], v[242:243], v[240:241] op_sel_hi:[1,0,0]
v_pk_fma_f32 v[230:231], v[230:231], v[242:243], v[240:241] op_sel_hi:[1,0,0]
v_pk_mul_f32 v[224:225], v[224:225], v[44:45]
v_pk_mul_f32 v[226:227], v[226:227], v[46:47]
v_pk_mul_f32 v[228:229], v[228:229], v[48:49]
v_pk_mul_f32 v[230:231], v[230:231], v[50:51]
v_mfma_f32_32x32x16_bf16 v[68:83], a[164:167], a[76:79], v[68:83]
ds_read_b128 a[160:163], v208 offset:26624
v_exp_f32 v224, v224
v_exp_f32 v225, v225
v_exp_f32 v226, v226
v_mfma_f32_32x32x16_bf16 v[68:83], a[168:171], a[80:83], v[68:83]
ds_read_b128 a[164:167], v208 offset:27648
s_mul_i32 s38, s24, 9216
v_exp_f32 v227, v227
v_fma_f32 v224, v224, v255, v255
v_fma_f32 v225, v225, v255, v255
v_mfma_f32_32x32x16_bf16 v[68:83], a[172:175], a[84:87], v[68:83]
ds_read_b128 a[168:171], v208 offset:28672
s_add_u32 m0, s38, 0
v_fma_f32 v226, v226, v255, v255
v_fma_f32 v227, v227, v255, v255
v_rcp_f32 v224, v224
s_waitcnt lgkmcnt(3)
v_mfma_f32_32x32x16_bf16 v[68:83], a[144:147], a[88:91], v[68:83]
ds_read_b128 a[172:175], v208 offset:29696
v_rcp_f32 v225, v225
v_rcp_f32 v226, v226
v_mfma_f32_32x32x16_bf16 v[68:83], a[148:151], a[92:95], v[68:83]
ds_read_b128 a[144:147], v208 offset:30720
s_add_u32 s39, s38, s82
v_rcp_f32 v227, v227
v_mul_f32 v44, v44, v224
v_mul_f32 v45, v45, v225
v_mul_f32 v46, v46, v226
v_mul_f32 v47, v47, v227
v_mfma_f32_32x32x16_bf16 v[68:83], a[152:155], a[96:99], v[68:83]
ds_read_b128 a[148:151], v208 offset:31744
s_add_u32 s39, s39, 189440
v_exp_f32 v228, v228
v_exp_f32 v229, v229
v_mfma_f32_32x32x16_bf16 v[68:83], a[156:159], a[100:103], v[68:83]
ds_read_b128 a[152:155], v208 offset:32768
v_exp_f32 v230, v230
v_exp_f32 v231, v231
s_waitcnt lgkmcnt(3)
v_mfma_f32_32x32x16_bf16 v[68:83], a[160:163], a[104:107], v[68:83]
ds_read_b128 a[156:159], v208 offset:33792
buffer_load_dwordx4 v1, s[4:7], s39 offen offset:0 sc1 lds
v_fma_f32 v228, v228, v255, v255
v_fma_f32 v229, v229, v255, v255
v_fma_f32 v230, v230, v255, v255
v_mfma_f32_32x32x16_bf16 v[68:83], a[164:167], a[108:111], v[68:83]
ds_read_b128 a[160:163], v208 offset:34816
buffer_load_dwordx4 v1, s[4:7], s39 offen offset:1024 sc1 lds
v_fma_f32 v231, v231, v255, v255
v_rcp_f32 v228, v228
v_mfma_f32_32x32x16_bf16 v[68:83], a[168:171], a[112:115], v[68:83]
ds_read_b128 a[164:167], v208 offset:35840
v_rcp_f32 v229, v229
v_rcp_f32 v230, v230
v_mfma_f32_32x32x16_bf16 v[68:83], a[172:175], a[116:119], v[68:83]
ds_read_b128 a[168:171], v208 offset:36864
buffer_load_dwordx4 v1, s[4:7], s39 offen offset:2048 sc1 lds
v_rcp_f32 v231, v231
v_mul_f32 v48, v48, v228
s_waitcnt lgkmcnt(3)
v_mfma_f32_32x32x16_bf16 v[68:83], a[144:147], a[120:123], v[68:83]
ds_read_b128 a[172:175], v209 offset:0
buffer_load_dwordx4 v1, s[4:7], s39 offen offset:3072 sc1 lds
v_mul_f32 v49, v49, v229
v_mul_f32 v50, v50, v230
v_mul_f32 v51, v51, v231
v_mfma_f32_32x32x16_bf16 v[68:83], a[148:151], a[124:127], v[68:83]
ds_read_b128 a[144:147], v209 offset:1024
v_pk_mul_f32 v[216:217], v[52:53], v[52:53]
v_pk_mul_f32 v[218:219], v[54:55], v[54:55]
v_pk_mul_f32 v[220:221], v[56:57], v[56:57]
v_pk_mul_f32 v[222:223], v[58:59], v[58:59]
v_pk_fma_f32 v[216:217], v[216:217], v[242:243], v[240:241] op_sel_hi:[1,0,0]
v_pk_fma_f32 v[218:219], v[218:219], v[242:243], v[240:241] op_sel_hi:[1,0,0]
v_pk_fma_f32 v[220:221], v[220:221], v[242:243], v[240:241] op_sel_hi:[1,0,0]
v_pk_fma_f32 v[222:223], v[222:223], v[242:243], v[240:241] op_sel_hi:[1,0,0]
v_pk_mul_f32 v[216:217], v[216:217], v[52:53]
v_pk_mul_f32 v[218:219], v[218:219], v[54:55]
v_pk_mul_f32 v[220:221], v[220:221], v[56:57]
v_pk_mul_f32 v[222:223], v[222:223], v[58:59]
v_mfma_f32_32x32x16_bf16 v[68:83], a[152:155], a[128:131], v[68:83]
ds_read_b128 a[148:151], v209 offset:2048
s_add_u32 m0, m0, 4096
v_exp_f32 v216, v216
v_exp_f32 v217, v217
v_exp_f32 v218, v218
v_mfma_f32_32x32x16_bf16 v[68:83], a[156:159], a[132:135], v[68:83]
ds_read_b128 a[152:155], v209 offset:3072
s_add_u32 s39, s39, 4096
v_exp_f32 v219, v219
v_fma_f32 v216, v216, v255, v255
s_waitcnt lgkmcnt(3)
v_mfma_f32_32x32x16_bf16 v[68:83], a[160:163], a[136:139], v[68:83]
ds_read_b128 a[156:159], v209 offset:4096
v_fma_f32 v217, v217, v255, v255
v_fma_f32 v218, v218, v255, v255
v_fma_f32 v219, v219, v255, v255
v_rcp_f32 v216, v216
v_mfma_f32_32x32x16_bf16 v[68:83], a[164:167], a[140:143], v[68:83]
ds_read_b128 a[160:163], v209 offset:5120
buffer_load_dwordx4 v1, s[4:7], s39 offen offset:0 sc1 lds
v_rcp_f32 v217, v217
v_rcp_f32 v218, v218
v_mfma_f32_32x32x16_bf16 v[68:83], a[168:171], v[212:215], v[68:83]
ds_read_b128 a[164:167], v209 offset:6144
buffer_load_dwordx4 v1, s[4:7], s39 offen offset:1024 sc1 lds
v_rcp_f32 v219, v219
s_waitcnt vmcnt(6)
s_barrier
v_mfma_f32_32x32x16_bf16 v[84:99], a[172:175], a[0:3], 0
ds_read_b128 a[168:171], v209 offset:7168
buffer_load_dwordx4 a[176:179], v1, s[4:7], s52 offen offset:0 sc1
v_mul_f32 v52, v52, v216
v_mul_f32 v53, v53, v217
v_mul_f32 v54, v54, v218
v_mul_f32 v55, v55, v219
s_waitcnt lgkmcnt(3)
v_mfma_f32_32x32x16_bf16 v[84:99], a[144:147], a[4:7], v[84:99]
ds_read_b128 a[172:175], v209 offset:8192
buffer_load_dwordx4 v1, s[4:7], s39 offen offset:2048 sc1 lds
v_exp_f32 v220, v220
v_exp_f32 v221, v221
v_mfma_f32_32x32x16_bf16 v[84:99], a[148:151], a[8:11], v[84:99]
ds_read_b128 a[144:147], v209 offset:9216
buffer_load_dwordx4 v1, s[4:7], s39 offen offset:3072 sc1 lds
v_exp_f32 v222, v222
v_exp_f32 v223, v223
v_mfma_f32_32x32x16_bf16 v[84:99], a[152:155], a[12:15], v[84:99]
ds_read_b128 a[148:151], v209 offset:10240
buffer_load_dwordx4 a[180:183], v9, s[4:7], s52 offen offset:0 sc1
v_fma_f32 v220, v220, v255, v255
v_fma_f32 v221, v221, v255, v255
v_fma_f32 v222, v222, v255, v255
v_fma_f32 v223, v223, v255, v255
v_mfma_f32_32x32x16_bf16 v[84:99], a[156:159], a[16:19], v[84:99]
ds_read_b128 a[152:155], v209 offset:11264
s_add_u32 m0, m0, 4096
v_rcp_f32 v220, v220
s_waitcnt lgkmcnt(3)
v_mfma_f32_32x32x16_bf16 v[84:99], a[160:163], a[20:23], v[84:99]
ds_read_b128 a[156:159], v209 offset:12288
s_add_u32 s39, s39, 4096
v_rcp_f32 v221, v221
v_rcp_f32 v222, v222
v_mfma_f32_32x32x16_bf16 v[84:99], a[164:167], a[24:27], v[84:99]
ds_read_b128 a[160:163], v209 offset:13312
buffer_load_dwordx4 a[184:187], v1, s[4:7], s52 offen offset:1024 sc1
v_rcp_f32 v223, v223
v_mul_f32 v56, v56, v220
v_mul_f32 v57, v57, v221
v_mul_f32 v58, v58, v222
v_mul_f32 v59, v59, v223
v_mfma_f32_32x32x16_bf16 v[84:99], a[168:171], a[28:31], v[84:99]
ds_read_b128 a[164:167], v209 offset:14336
buffer_load_dwordx4 v1, s[4:7], s39 offen offset:0 sc1 lds
v_pk_mul_f32 v[224:225], v[60:61], v[60:61]
v_pk_mul_f32 v[226:227], v[62:63], v[62:63]
v_pk_mul_f32 v[228:229], v[64:65], v[64:65]
v_pk_mul_f32 v[230:231], v[66:67], v[66:67]
v_pk_fma_f32 v[224:225], v[224:225], v[242:243], v[240:241] op_sel_hi:[1,0,0]
v_pk_fma_f32 v[226:227], v[226:227], v[242:243], v[240:241] op_sel_hi:[1,0,0]
v_pk_fma_f32 v[228:229], v[228:229], v[242:243], v[240:241] op_sel_hi:[1,0,0]
v_pk_fma_f32 v[230:231], v[230:231], v[242:243], v[240:241] op_sel_hi:[1,0,0]
v_pk_mul_f32 v[224:225], v[224:225], v[60:61]
v_pk_mul_f32 v[226:227], v[226:227], v[62:63]
v_pk_mul_f32 v[228:229], v[228:229], v[64:65]
v_pk_mul_f32 v[230:231], v[230:231], v[66:67]
v_mfma_f32_32x32x16_bf16 v[84:99], a[172:175], a[32:35], v[84:99]
ds_read_b128 a[168:171], v209 offset:15360
s_lshl_b32 s38, s24, 8
v_exp_f32 v224, v224
v_exp_f32 v225, v225
v_exp_f32 v226, v226
s_waitcnt lgkmcnt(3)
v_mfma_f32_32x32x16_bf16 v[84:99], a[144:147], a[36:39], v[84:99]
ds_read_b128 a[172:175], v209 offset:16384
v_exp_f32 v227, v227
v_fma_f32 v224, v224, v255, v255
v_fma_f32 v225, v225, v255, v255
v_fma_f32 v226, v226, v255, v255
v_mfma_f32_32x32x16_bf16 v[84:99], a[148:151], a[40:43], v[84:99]
ds_read_b128 a[144:147], v209 offset:17408
buffer_load_dwordx4 a[188:191], v9, s[4:7], s52 offen offset:1024 sc1
s_add_u32 m0, s38, 36864
v_fma_f32 v227, v227, v255, v255
v_rcp_f32 v224, v224
v_mfma_f32_32x32x16_bf16 v[84:99], a[152:155], a[44:47], v[84:99]
ds_read_b128 a[148:151], v209 offset:18432
s_add_u32 s39, s38, s82
v_rcp_f32 v225, v225
v_rcp_f32 v226, v226
v_mfma_f32_32x32x16_bf16 v[84:99], a[156:159], a[48:51], v[84:99]
ds_read_b128 a[152:155], v209 offset:19456
v_rcp_f32 v227, v227
v_mul_f32 v60, v60, v224
s_waitcnt lgkmcnt(3)
v_mfma_f32_32x32x16_bf16 v[84:99], a[160:163], a[52:55], v[84:99]
ds_read_b128 a[156:159], v209 offset:20480
buffer_load_dwordx4 a[192:195], v1, s[4:7], s52 offen offset:2048 sc1
s_add_u32 s39, s39, 226304
v_mul_f32 v61, v61, v225
v_mul_f32 v62, v62, v226
v_mul_f32 v63, v63, v227
v_mfma_f32_32x32x16_bf16 v[84:99], a[164:167], a[56:59], v[84:99]
ds_read_b128 a[160:163], v209 offset:21504
s_mov_b64 exec, 0xffff
buffer_load_dwordx4 v1, s[4:7], s39 offen sc1 lds
s_mov_b64 exec, -1
v_exp_f32 v228, v228
v_mfma_f32_32x32x16_bf16 v[84:99], a[168:171], a[60:63], v[84:99]
ds_read_b128 a[164:167], v209 offset:22528
v_exp_f32 v229, v229
v_exp_f32 v230, v230
v_mfma_f32_32x32x16_bf16 v[84:99], a[172:175], a[64:67], v[84:99]
ds_read_b128 a[168:171], v209 offset:23552
v_exp_f32 v231, v231
v_fma_f32 v228, v228, v255, v255
v_fma_f32 v229, v229, v255, v255
s_waitcnt lgkmcnt(3)
v_mfma_f32_32x32x16_bf16 v[84:99], a[144:147], a[68:71], v[84:99]
ds_read_b128 a[172:175], v209 offset:24576
buffer_load_dwordx4 a[196:199], v9, s[4:7], s52 offen offset:2048 sc1
v_fma_f32 v230, v230, v255, v255
v_fma_f32 v231, v231, v255, v255
v_rcp_f32 v228, v228
v_mfma_f32_32x32x16_bf16 v[84:99], a[148:151], a[72:75], v[84:99]
ds_read_b128 a[144:147], v209 offset:25600
v_rcp_f32 v229, v229
v_rcp_f32 v230, v230
v_mfma_f32_32x32x16_bf16 v[84:99], a[152:155], a[76:79], v[84:99]
ds_read_b128 a[148:151], v209 offset:26624
s_mul_i32 s38, s24, 9216
v_rcp_f32 v231, v231
v_mul_f32 v64, v64, v228
v_mul_f32 v65, v65, v229
v_mul_f32 v66, v66, v230
v_mul_f32 v67, v67, v231
v_mfma_f32_32x32x16_bf16 v[84:99], a[156:159], a[80:83], v[84:99]
ds_read_b128 a[152:155], v209 offset:27648
buffer_load_dwordx4 a[200:203], v1, s[4:7], s52 offen offset:3072 sc1
s_add_u32 m0, s38, 37888
v_pk_mul_f32 v[216:217], v[68:69], v[68:69]
v_pk_mul_f32 v[218:219], v[70:71], v[70:71]
v_pk_mul_f32 v[220:221], v[72:73], v[72:73]
v_pk_mul_f32 v[222:223], v[74:75], v[74:75]
v_pk_fma_f32 v[216:217], v[216:217], v[242:243], v[240:241] op_sel_hi:[1,0,0]
v_pk_fma_f32 v[218:219], v[218:219], v[242:243], v[240:241] op_sel_hi:[1,0,0]
v_pk_fma_f32 v[220:221], v[220:221], v[242:243], v[240:241] op_sel_hi:[1,0,0]
v_pk_fma_f32 v[222:223], v[222:223], v[242:243], v[240:241] op_sel_hi:[1,0,0]
v_pk_mul_f32 v[216:217], v[216:217], v[68:69]
v_pk_mul_f32 v[218:219], v[218:219], v[70:71]
v_pk_mul_f32 v[220:221], v[220:221], v[72:73]
v_pk_mul_f32 v[222:223], v[222:223], v[74:75]
s_waitcnt lgkmcnt(3)
v_mfma_f32_32x32x16_bf16 v[84:99], a[160:163], a[84:87], v[84:99]
ds_read_b128 a[156:159], v209 offset:28672
v_exp_f32 v216, v216
v_exp_f32 v217, v217
v_exp_f32 v218, v218
v_mfma_f32_32x32x16_bf16 v[84:99], a[164:167], a[88:91], v[84:99]
ds_read_b128 a[160:163], v209 offset:29696
s_add_u32 s39, s38, s82
v_exp_f32 v219, v219
v_fma_f32 v216, v216, v255, v255
v_fma_f32 v217, v217, v255, v255
v_mfma_f32_32x32x16_bf16 v[84:99], a[168:171], a[92:95], v[84:99]
ds_read_b128 a[164:167], v209 offset:30720
s_add_u32 s39, s39, 227328
v_fma_f32 v218, v218, v255, v255
v_fma_f32 v219, v219, v255, v255
v_rcp_f32 v216, v216
v_mfma_f32_32x32x16_bf16 v[84:99], a[172:175], a[96:99], v[84:99]
ds_read_b128 a[168:171], v209 offset:31744
buffer_load_dwordx4 a[204:207], v9, s[4:7], s52 offen offset:3072 sc1
v_rcp_f32 v217, v217
s_waitcnt lgkmcnt(3)
v_mfma_f32_32x32x16_bf16 v[84:99], a[144:147], a[100:103], v[84:99]
ds_read_b128 a[172:175], v209 offset:32768
buffer_load_dwordx4 v1, s[4:7], s39 offen offset:0 sc1 lds
v_rcp_f32 v218, v218
v_rcp_f32 v219, v219
v_mfma_f32_32x32x16_bf16 v[84:99], a[148:151], a[104:107], v[84:99]
ds_read_b128 a[144:147], v209 offset:33792
buffer_load_dwordx4 v1, s[4:7], s39 offen offset:1024 sc1 lds
v_mul_f32 v68, v68, v216
v_mul_f32 v69, v69, v217
v_mul_f32 v70, v70, v218
v_mul_f32 v71, v71, v219
v_mfma_f32_32x32x16_bf16 v[84:99], a[152:155], a[108:111], v[84:99]
ds_read_b128 a[148:151], v209 offset:34816
s_add_u32 s52, s52, 4096
v_exp_f32 v220, v220
v_exp_f32 v221, v221
v_mfma_f32_32x32x16_bf16 v[84:99], a[156:159], a[112:115], v[84:99]
ds_read_b128 a[152:155], v209 offset:35840
buffer_load_dwordx4 v1, s[4:7], s39 offen offset:2048 sc1 lds
v_exp_f32 v222, v222
s_waitcnt lgkmcnt(3)
v_mfma_f32_32x32x16_bf16 v[84:99], a[160:163], a[116:119], v[84:99]
ds_read_b128 a[156:159], v209 offset:36864
buffer_load_dwordx4 v1, s[4:7], s39 offen offset:3072 sc1 lds
v_exp_f32 v223, v223
v_fma_f32 v220, v220, v255, v255
v_fma_f32 v221, v221, v255, v255
v_mfma_f32_32x32x16_bf16 v[84:99], a[164:167], a[120:123], v[84:99]
ds_read_b128 a[160:163], v206 offset:0
v_fma_f32 v222, v222, v255, v255
v_fma_f32 v223, v223, v255, v255
v_rcp_f32 v220, v220
v_mfma_f32_32x32x16_bf16 v[84:99], a[168:171], a[124:127], v[84:99]
ds_read_b128 a[164:167], v206 offset:1024
buffer_load_dwordx4 a[208:211], v1, s[4:7], s52 offen offset:0 sc1
s_add_u32 m0, m0, 4096
v_rcp_f32 v221, v221
v_mfma_f32_32x32x16_bf16 v[84:99], a[172:175], a[128:131], v[84:99]
ds_read_b128 a[168:171], v206 offset:2048
s_add_u32 s39, s39, 4096
v_rcp_f32 v222, v222
v_rcp_f32 v223, v223
s_waitcnt lgkmcnt(3)
v_mfma_f32_32x32x16_bf16 v[84:99], a[144:147], a[132:135], v[84:99]
ds_read_b128 a[172:175], v206 offset:3072
v_mul_f32 v72, v72, v220
v_mul_f32 v73, v73, v221
v_mul_f32 v74, v74, v222
v_mul_f32 v75, v75, v223
v_mfma_f32_32x32x16_bf16 v[84:99], a[148:151], a[136:139], v[84:99]
ds_read_b128 a[144:147], v206 offset:4096
buffer_load_dwordx4 v1, s[4:7], s39 offen offset:0 sc1 lds
buffer_load_dwordx4 a[212:215], v9, s[4:7], s52 offen offset:0 sc1
v_pk_mul_f32 v[224:225], v[76:77], v[76:77]
v_pk_mul_f32 v[226:227], v[78:79], v[78:79]
v_pk_mul_f32 v[228:229], v[80:81], v[80:81]
v_pk_mul_f32 v[230:231], v[82:83], v[82:83]
v_pk_fma_f32 v[224:225], v[224:225], v[242:243], v[240:241] op_sel_hi:[1,0,0]
v_pk_fma_f32 v[226:227], v[226:227], v[242:243], v[240:241] op_sel_hi:[1,0,0]
v_pk_fma_f32 v[228:229], v[228:229], v[242:243], v[240:241] op_sel_hi:[1,0,0]
v_pk_fma_f32 v[230:231], v[230:231], v[242:243], v[240:241] op_sel_hi:[1,0,0]
v_pk_mul_f32 v[224:225], v[224:225], v[76:77]
v_pk_mul_f32 v[226:227], v[226:227], v[78:79]
v_pk_mul_f32 v[228:229], v[228:229], v[80:81]
v_pk_mul_f32 v[230:231], v[230:231], v[82:83]
v_mfma_f32_32x32x16_bf16 v[84:99], a[152:155], a[140:143], v[84:99]
ds_read_b128 a[148:151], v206 offset:5120
buffer_load_dwordx4 v1, s[4:7], s39 offen offset:1024 sc1 lds
v_exp_f32 v224, v224
v_exp_f32 v225, v225
v_exp_f32 v226, v226
v_mfma_f32_32x32x16_bf16 v[84:99], a[156:159], v[212:215], v[84:99]
ds_read_b128 a[152:155], v206 offset:6144
v_exp_f32 v227, v227
v_fma_f32 v224, v224, v255, v255
v_fma_f32 v225, v225, v255, v255
s_waitcnt vmcnt(11)
s_barrier
s_waitcnt lgkmcnt(3)
v_mfma_f32_32x32x16_bf16 v[100:115], a[160:163], a[0:3], 0
ds_read_b128 a[156:159], v206 offset:7168
buffer_load_dwordx4 v1, s[4:7], s39 offen offset:2048 sc1 lds
v_fma_f32 v226, v226, v255, v255
v_fma_f32 v227, v227, v255, v255
v_rcp_f32 v224, v224
v_mfma_f32_32x32x16_bf16 v[100:115], a[164:167], a[4:7], v[100:115]
ds_read_b128 a[160:163], v206 offset:8192
buffer_load_dwordx4 v1, s[4:7], s39 offen offset:3072 sc1 lds
buffer_load_dwordx4 a[216:219], v1, s[4:7], s52 offen offset:1024 sc1
v_rcp_f32 v225, v225
v_rcp_f32 v226, v226
v_mfma_f32_32x32x16_bf16 v[100:115], a[168:171], a[8:11], v[100:115]
ds_read_b128 a[164:167], v206 offset:9216
v_rcp_f32 v227, v227
v_mul_f32 v76, v76, v224
v_mul_f32 v77, v77, v225
v_mul_f32 v78, v78, v226
v_mul_f32 v79, v79, v227
v_mfma_f32_32x32x16_bf16 v[100:115], a[172:175], a[12:15], v[100:115]
ds_read_b128 a[168:171], v206 offset:10240
s_add_u32 m0, m0, 4096
v_exp_f32 v228, v228
s_waitcnt lgkmcnt(3)
v_mfma_f32_32x32x16_bf16 v[100:115], a[144:147], a[16:19], v[100:115]
ds_read_b128 a[172:175], v206 offset:11264
buffer_load_dwordx4 a[220:223], v9, s[4:7], s52 offen offset:1024 sc1
s_add_u32 s39, s39, 4096
v_exp_f32 v229, v229
v_exp_f32 v230, v230
v_mfma_f32_32x32x16_bf16 v[100:115], a[148:151], a[20:23], v[100:115]
ds_read_b128 a[144:147], v206 offset:12288
v_exp_f32 v231, v231
v_fma_f32 v228, v228, v255, v255
v_fma_f32 v229, v229, v255, v255
v_fma_f32 v230, v230, v255, v255
v_mfma_f32_32x32x16_bf16 v[100:115], a[152:155], a[24:27], v[100:115]
ds_read_b128 a[148:151], v206 offset:13312
buffer_load_dwordx4 v1, s[4:7], s39 offen offset:0 sc1 lds
v_fma_f32 v231, v231, v255, v255
v_rcp_f32 v228, v228
v_mfma_f32_32x32x16_bf16 v[100:115], a[156:159], a[28:31], v[100:115]
ds_read_b128 a[152:155], v206 offset:14336
buffer_load_dwordx4 a[224:227], v1, s[4:7], s52 offen offset:2048 sc1
s_lshl_b32 s38, s24, 8
v_rcp_f32 v229, v229
s_waitcnt lgkmcnt(3)
v_mfma_f32_32x32x16_bf16 v[100:115], a[160:163], a[32:35], v[100:115]
ds_read_b128 a[156:159], v206 offset:15360
v_rcp_f32 v230, v230
v_rcp_f32 v231, v231
v_mul_f32 v80, v80, v228
v_mfma_f32_32x32x16_bf16 v[100:115], a[164:167], a[36:39], v[100:115]
ds_read_b128 a[160:163], v206 offset:16384
s_add_u32 m0, s38, 74752
v_mul_f32 v81, v81, v229
v_mul_f32 v82, v82, v230
v_mul_f32 v83, v83, v231
v_mfma_f32_32x32x16_bf16 v[100:115], a[168:171], a[40:43], v[100:115]
ds_read_b128 a[164:167], v206 offset:17408
s_add_u32 s39, s38, s82
v_pk_mul_f32 v[216:217], v[84:85], v[84:85]
v_pk_mul_f32 v[218:219], v[86:87], v[86:87]
v_pk_mul_f32 v[220:221], v[88:89], v[88:89]
v_pk_mul_f32 v[222:223], v[90:91], v[90:91]
v_pk_fma_f32 v[216:217], v[216:217], v[242:243], v[240:241] op_sel_hi:[1,0,0]
v_pk_fma_f32 v[218:219], v[218:219], v[242:243], v[240:241] op_sel_hi:[1,0,0]
v_pk_fma_f32 v[220:221], v[220:221], v[242:243], v[240:241] op_sel_hi:[1,0,0]
v_pk_fma_f32 v[222:223], v[222:223], v[242:243], v[240:241] op_sel_hi:[1,0,0]
v_pk_mul_f32 v[216:217], v[216:217], v[84:85]
v_pk_mul_f32 v[218:219], v[218:219], v[86:87]
v_pk_mul_f32 v[220:221], v[220:221], v[88:89]
v_pk_mul_f32 v[222:223], v[222:223], v[90:91]
v_mfma_f32_32x32x16_bf16 v[100:115], a[172:175], a[44:47], v[100:115]
ds_read_b128 a[168:171], v206 offset:18432
buffer_load_dwordx4 a[228:231], v9, s[4:7], s52 offen offset:2048 sc1
v_exp_f32 v216, v216
v_exp_f32 v217, v217
v_exp_f32 v218, v218
s_waitcnt lgkmcnt(3)
v_mfma_f32_32x32x16_bf16 v[100:115], a[144:147], a[48:51], v[100:115]
ds_read_b128 a[172:175], v206 offset:19456
s_add_u32 s39, s39, 264192
v_exp_f32 v219, v219
v_fma_f32 v216, v216, v255, v255
v_fma_f32 v217, v217, v255, v255
v_mfma_f32_32x32x16_bf16 v[100:115], a[148:151], a[52:55], v[100:115]
ds_read_b128 a[144:147], v206 offset:20480
s_mov_b64 exec, 0xffff
buffer_load_dwordx4 v1, s[4:7], s39 offen sc1 lds
s_mov_b64 exec, -1
v_fma_f32 v218, v218, v255, v255
v_fma_f32 v219, v219, v255, v255
v_rcp_f32 v216, v216
v_mfma_f32_32x32x16_bf16 v[100:115], a[152:155], a[56:59], v[100:115]
ds_read_b128 a[148:151], v206 offset:21504
buffer_load_dwordx4 a[232:235], v1, s[4:7], s52 offen offset:3072 sc1
v_rcp_f32 v217, v217
v_rcp_f32 v218, v218
v_mfma_f32_32x32x16_bf16 v[100:115], a[156:159], a[60:63], v[100:115]
ds_read_b128 a[152:155], v206 offset:22528
v_rcp_f32 v219, v219
v_mul_f32 v84, v84, v216
v_mul_f32 v85, v85, v217
v_mul_f32 v86, v86, v218
v_mul_f32 v87, v87, v219
s_waitcnt lgkmcnt(3)
v_mfma_f32_32x32x16_bf16 v[100:115], a[160:163], a[64:67], v[100:115]
ds_read_b128 a[156:159], v206 offset:23552
v_exp_f32 v220, v220
v_exp_f32 v221, v221
v_mfma_f32_32x32x16_bf16 v[100:115], a[164:167], a[68:71], v[100:115]
ds_read_b128 a[160:163], v206 offset:24576
v_exp_f32 v222, v222
v_exp_f32 v223, v223
v_mfma_f32_32x32x16_bf16 v[100:115], a[168:171], a[72:75], v[100:115]
ds_read_b128 a[164:167], v206 offset:25600
buffer_load_dwordx4 a[236:239], v9, s[4:7], s52 offen offset:3072 sc1
s_mul_i32 s38, s24, 9216
v_fma_f32 v220, v220, v255, v255
v_fma_f32 v221, v221, v255, v255
v_fma_f32 v222, v222, v255, v255
v_mfma_f32_32x32x16_bf16 v[100:115], a[172:175], a[76:79], v[100:115]
ds_read_b128 a[168:171], v206 offset:26624
s_add_u32 m0, s38, 75776
v_fma_f32 v223, v223, v255, v255
v_rcp_f32 v220, v220
s_waitcnt lgkmcnt(3)
v_mfma_f32_32x32x16_bf16 v[100:115], a[144:147], a[80:83], v[100:115]
ds_read_b128 a[172:175], v206 offset:27648
v_rcp_f32 v221, v221
v_rcp_f32 v222, v222
v_mfma_f32_32x32x16_bf16 v[100:115], a[148:151], a[84:87], v[100:115]
ds_read_b128 a[144:147], v206 offset:28672
s_add_u32 s39, s38, s82
s_add_u32 s52, s52, 4096
v_rcp_f32 v223, v223
v_mul_f32 v88, v88, v220
v_mfma_f32_32x32x16_bf16 v[100:115], a[152:155], a[88:91], v[100:115]
ds_read_b128 a[148:151], v206 offset:29696
s_add_u32 s39, s39, 265216
v_mul_f32 v89, v89, v221
v_mul_f32 v90, v90, v222
v_mul_f32 v91, v91, v223
v_mfma_f32_32x32x16_bf16 v[100:115], a[156:159], a[92:95], v[100:115]
ds_read_b128 a[152:155], v206 offset:30720
v_pk_mul_f32 v[224:225], v[92:93], v[92:93]
v_pk_mul_f32 v[226:227], v[94:95], v[94:95]
v_pk_mul_f32 v[228:229], v[96:97], v[96:97]
v_pk_mul_f32 v[230:231], v[98:99], v[98:99]
v_pk_fma_f32 v[224:225], v[224:225], v[242:243], v[240:241] op_sel_hi:[1,0,0]
v_pk_fma_f32 v[226:227], v[226:227], v[242:243], v[240:241] op_sel_hi:[1,0,0]
v_pk_fma_f32 v[228:229], v[228:229], v[242:243], v[240:241] op_sel_hi:[1,0,0]
v_pk_fma_f32 v[230:231], v[230:231], v[242:243], v[240:241] op_sel_hi:[1,0,0]
v_pk_mul_f32 v[224:225], v[224:225], v[92:93]
v_pk_mul_f32 v[226:227], v[226:227], v[94:95]
v_pk_mul_f32 v[228:229], v[228:229], v[96:97]
v_pk_mul_f32 v[230:231], v[230:231], v[98:99]
s_waitcnt lgkmcnt(3)
v_mfma_f32_32x32x16_bf16 v[100:115], a[160:163], a[96:99], v[100:115]
ds_read_b128 a[156:159], v206 offset:31744
buffer_load_dwordx4 v1, s[4:7], s39 offen offset:0 sc1 lds
v_exp_f32 v224, v224
v_exp_f32 v225, v225
v_exp_f32 v226, v226
v_mfma_f32_32x32x16_bf16 v[100:115], a[164:167], a[100:103], v[100:115]
ds_read_b128 a[160:163], v206 offset:32768
buffer_load_dwordx4 v1, s[4:7], s39 offen offset:1024 sc1 lds
buffer_load_dwordx4 a[240:243], v1, s[4:7], s52 offen offset:0 sc1
v_exp_f32 v227, v227
v_fma_f32 v224, v224, v255, v255
v_mfma_f32_32x32x16_bf16 v[100:115], a[168:171], a[104:107], v[100:115]
ds_read_b128 a[164:167], v206 offset:33792
v_fma_f32 v225, v225, v255, v255
v_fma_f32 v226, v226, v255, v255
v_fma_f32 v227, v227, v255, v255
v_rcp_f32 v224, v224
v_mfma_f32_32x32x16_bf16 v[100:115], a[172:175], a[108:111], v[100:115]
ds_read_b128 a[168:171], v206 offset:34816
buffer_load_dwordx4 v1, s[4:7], s39 offen offset:2048 sc1 lds
v_rcp_f32 v225, v225
s_waitcnt lgkmcnt(3)
v_mfma_f32_32x32x16_bf16 v[100:115], a[144:147], a[112:115], v[100:115]
ds_read_b128 a[172:175], v206 offset:35840
buffer_load_dwordx4 v1, s[4:7], s39 offen offset:3072 sc1 lds
buffer_load_dwordx4 a[244:247], v9, s[4:7], s52 offen offset:0 sc1
v_rcp_f32 v226, v226
v_rcp_f32 v227, v227
v_mfma_f32_32x32x16_bf16 v[100:115], a[148:151], a[116:119], v[100:115]
ds_read_b128 a[144:147], v206 offset:36864
v_mul_f32 v92, v92, v224
v_mul_f32 v93, v93, v225
v_mul_f32 v94, v94, v226
v_mul_f32 v95, v95, v227
v_mfma_f32_32x32x16_bf16 v[100:115], a[152:155], a[120:123], v[100:115]
ds_read_b128 a[148:151], v207 offset:0
s_add_u32 m0, m0, 4096
v_exp_f32 v228, v228
v_exp_f32 v229, v229
v_mfma_f32_32x32x16_bf16 v[100:115], a[156:159], a[124:127], v[100:115]
ds_read_b128 a[152:155], v207 offset:1024
s_add_u32 s39, s39, 4096
v_exp_f32 v230, v230
s_waitcnt lgkmcnt(3)
v_mfma_f32_32x32x16_bf16 v[100:115], a[160:163], a[128:131], v[100:115]
ds_read_b128 a[156:159], v207 offset:2048
buffer_load_dwordx4 a[248:251], v1, s[4:7], s52 offen offset:1024 sc1
v_exp_f32 v231, v231
v_fma_f32 v228, v228, v255, v255
v_fma_f32 v229, v229, v255, v255
v_mfma_f32_32x32x16_bf16 v[100:115], a[164:167], a[132:135], v[100:115]
ds_read_b128 a[160:163], v207 offset:3072
buffer_load_dwordx4 v1, s[4:7], s39 offen offset:0 sc1 lds
v_fma_f32 v230, v230, v255, v255
v_fma_f32 v231, v231, v255, v255
v_rcp_f32 v228, v228
v_mfma_f32_32x32x16_bf16 v[100:115], a[168:171], a[136:139], v[100:115]
ds_read_b128 a[164:167], v207 offset:4096
buffer_load_dwordx4 v1, s[4:7], s39 offen offset:1024 sc1 lds
v_rcp_f32 v229, v229
v_rcp_f32 v230, v230
v_mfma_f32_32x32x16_bf16 v[100:115], a[172:175], a[140:143], v[100:115]
ds_read_b128 a[168:171], v207 offset:5120
buffer_load_dwordx4 a[252:255], v9, s[4:7], s52 offen offset:1024 sc1
v_rcp_f32 v231, v231
v_mul_f32 v96, v96, v228
v_mul_f32 v97, v97, v229
v_mul_f32 v98, v98, v230
v_mul_f32 v99, v99, v231
s_waitcnt lgkmcnt(3)
v_mfma_f32_32x32x16_bf16 v[100:115], a[144:147], v[212:215], v[100:115]
ds_read_b128 a[172:175], v207 offset:6144
buffer_load_dwordx4 v1, s[4:7], s39 offen offset:2048 sc1 lds
s_waitcnt vmcnt(13)
s_barrier
v_mfma_f32_32x32x16_bf16 v[116:131], a[148:151], a[0:3], 0
ds_read_b128 a[144:147], v207 offset:7168
buffer_load_dwordx4 v1, s[4:7], s39 offen offset:3072 sc1 lds
v_mfma_f32_32x32x16_bf16 v[116:131], a[152:155], a[4:7], v[116:131]
ds_read_b128 a[148:151], v207 offset:8192
v_mfma_f32_32x32x16_bf16 v[116:131], a[156:159], a[8:11], v[116:131]
ds_read_b128 a[152:155], v207 offset:9216
s_add_u32 m0, m0, 4096
s_mov_b32 s37, L_c4-L_pc
s_waitcnt lgkmcnt(3)
v_mfma_f32_32x32x16_bf16 v[116:131], a[160:163], a[12:15], v[116:131]
ds_read_b128 a[156:159], v207 offset:10240
s_add_u32 s39, s39, 4096
v_mfma_f32_32x32x16_bf16 v[116:131], a[164:167], a[16:19], v[116:131]
ds_read_b128 a[160:163], v207 offset:11264
v_pk_mul_f32 v[216:217], v[100:101], v[100:101]
v_pk_mul_f32 v[218:219], v[102:103], v[102:103]
v_pk_mul_f32 v[220:221], v[104:105], v[104:105]
v_pk_mul_f32 v[222:223], v[106:107], v[106:107]
v_pk_fma_f32 v[216:217], v[216:217], v[242:243], v[240:241] op_sel_hi:[1,0,0]
v_pk_fma_f32 v[218:219], v[218:219], v[242:243], v[240:241] op_sel_hi:[1,0,0]
v_pk_fma_f32 v[220:221], v[220:221], v[242:243], v[240:241] op_sel_hi:[1,0,0]
v_pk_fma_f32 v[222:223], v[222:223], v[242:243], v[240:241] op_sel_hi:[1,0,0]
v_pk_mul_f32 v[216:217], v[216:217], v[100:101]
v_pk_mul_f32 v[218:219], v[218:219], v[102:103]
v_pk_mul_f32 v[220:221], v[220:221], v[104:105]
v_pk_mul_f32 v[222:223], v[222:223], v[106:107]
v_mfma_f32_32x32x16_bf16 v[116:131], a[168:171], a[20:23], v[116:131]
ds_read_b128 a[164:167], v207 offset:12288
buffer_load_dwordx4 v1, s[4:7], s39 offen offset:0 sc1 lds
buffer_load_dword v15, v14, s[88:91], s37 offen
v_exp_f32 v216, v216
v_exp_f32 v217, v217
v_exp_f32 v218, v218
v_exp_f32 v219, v219
v_mfma_f32_32x32x16_bf16 v[116:131], a[172:175], a[24:27], v[116:131]
ds_read_b128 a[168:171], v207 offset:13312
s_lshl_b32 s38, s24, 8
v_fma_f32 v216, v216, v255, v255
v_fma_f32 v217, v217, v255, v255
v_fma_f32 v218, v218, v255, v255
v_fma_f32 v219, v219, v255, v255
v_rcp_f32 v216, v216
s_waitcnt lgkmcnt(3)
v_mfma_f32_32x32x16_bf16 v[116:131], a[144:147], a[28:31], v[116:131]
ds_read_b128 a[172:175], v207 offset:14336
v_rcp_f32 v217, v217
v_rcp_f32 v218, v218
v_mfma_f32_32x32x16_bf16 v[116:131], a[148:151], a[32:35], v[116:131]
ds_read_b128 a[144:147], v207 offset:15360
s_add_u32 m0, s38, 112640
v_rcp_f32 v219, v219
v_mul_f32 v100, v100, v216
v_mul_f32 v101, v101, v217
v_mul_f32 v102, v102, v218
v_mul_f32 v103, v103, v219
v_mfma_f32_32x32x16_bf16 v[116:131], a[152:155], a[36:39], v[116:131]
ds_read_b128 a[148:151], v207 offset:16384
s_add_u32 s39, s38, s82
v_exp_f32 v220, v220
v_exp_f32 v221, v221
v_mfma_f32_32x32x16_bf16 v[116:131], a[156:159], a[40:43], v[116:131]
ds_read_b128 a[152:155], v207 offset:17408
v_exp_f32 v222, v222
v_exp_f32 v223, v223
v_fma_f32 v220, v220, v255, v255
v_fma_f32 v221, v221, v255, v255
s_waitcnt lgkmcnt(3)
v_mfma_f32_32x32x16_bf16 v[116:131], a[160:163], a[44:47], v[116:131]
ds_read_b128 a[156:159], v207 offset:18432
s_add_u32 s39, s39, 302080
v_fma_f32 v222, v222, v255, v255
v_fma_f32 v223, v223, v255, v255
v_rcp_f32 v220, v220
v_rcp_f32 v221, v221
v_mfma_f32_32x32x16_bf16 v[116:131], a[164:167], a[48:51], v[116:131]
ds_read_b128 a[160:163], v207 offset:19456
s_mov_b64 exec, 0xffff
buffer_load_dwordx4 v1, s[4:7], s39 offen sc1 lds
s_mov_b64 exec, -1
v_rcp_f32 v222, v222
v_rcp_f32 v223, v223
v_mul_f32 v104, v104, v220
v_mul_f32 v105, v105, v221
v_mul_f32 v106, v106, v222
v_mul_f32 v107, v107, v223
v_mfma_f32_32x32x16_bf16 v[116:131], a[168:171], a[52:55], v[116:131]
ds_read_b128 a[164:167], v207 offset:20480
v_pk_add_f32 v[196:197], v[36:37], v[38:39]
v_pk_mul_f32 v[198:199], v[36:37], v[36:37]
v_pk_add_f32 v[200:201], v[40:41], v[42:43]
v_pk_mul_f32 v[202:203], v[38:39], v[38:39]
v_pk_fma_f32 v[198:199], v[40:41], v[40:41], v[198:199]
v_pk_fma_f32 v[202:203], v[42:43], v[42:43], v[202:203]
v_pk_add_f32 v[196:197], v[196:197], v[44:45]
v_pk_fma_f32 v[198:199], v[44:45], v[44:45], v[198:199]
v_pk_add_f32 v[200:201], v[200:201], v[46:47]
v_pk_fma_f32 v[202:203], v[46:47], v[46:47], v[202:203]
v_pk_add_f32 v[196:197], v[196:197], v[48:49]
v_pk_fma_f32 v[198:199], v[48:49], v[48:49], v[198:199]
v_pk_add_f32 v[200:201], v[200:201], v[50:51]
v_pk_fma_f32 v[202:203], v[50:51], v[50:51], v[202:203]
v_pk_add_f32 v[196:197], v[196:197], v[52:53]
v_pk_fma_f32 v[198:199], v[52:53], v[52:53], v[198:199]
v_pk_add_f32 v[200:201], v[200:201], v[54:55]
v_pk_fma_f32 v[202:203], v[54:55], v[54:55], v[202:203]
v_pk_add_f32 v[196:197], v[196:197], v[56:57]
v_pk_fma_f32 v[198:199], v[56:57], v[56:57], v[198:199]
v_pk_add_f32 v[200:201], v[200:201], v[58:59]
v_pk_fma_f32 v[202:203], v[58:59], v[58:59], v[202:203]
v_pk_add_f32 v[196:197], v[196:197], v[60:61]
v_pk_fma_f32 v[198:199], v[60:61], v[60:61], v[198:199]
v_pk_add_f32 v[200:201], v[200:201], v[62:63]
v_pk_fma_f32 v[202:203], v[62:63], v[62:63], v[202:203]
v_pk_add_f32 v[196:197], v[196:197], v[64:65]
v_pk_fma_f32 v[198:199], v[64:65], v[64:65], v[198:199]
v_pk_add_f32 v[200:201], v[200:201], v[66:67]
v_pk_fma_f32 v[202:203], v[66:67], v[66:67], v[202:203]
v_pk_add_f32 v[196:197], v[196:197], v[68:69]
v_pk_fma_f32 v[198:199], v[68:69], v[68:69], v[198:199]
v_pk_add_f32 v[200:201], v[200:201], v[70:71]
v_pk_fma_f32 v[202:203], v[70:71], v[70:71], v[202:203]
v_pk_add_f32 v[196:197], v[196:197], v[72:73]
v_pk_fma_f32 v[198:199], v[72:73], v[72:73], v[198:199]
v_pk_add_f32 v[200:201], v[200:201], v[74:75]
v_pk_fma_f32 v[202:203], v[74:75], v[74:75], v[202:203]
v_pk_add_f32 v[196:197], v[196:197], v[76:77]
v_pk_fma_f32 v[198:199], v[76:77], v[76:77], v[198:199]
v_pk_add_f32 v[200:201], v[200:201], v[78:79]
v_pk_fma_f32 v[202:203], v[78:79], v[78:79], v[202:203]
v_pk_add_f32 v[196:197], v[196:197], v[80:81]
v_pk_fma_f32 v[198:199], v[80:81], v[80:81], v[198:199]
v_pk_add_f32 v[200:201], v[200:201], v[82:83]
v_pk_fma_f32 v[202:203], v[82:83], v[82:83], v[202:203]
v_pk_add_f32 v[196:197], v[196:197], v[84:85]
v_pk_fma_f32 v[198:199], v[84:85], v[84:85], v[198:199]
v_pk_add_f32 v[200:201], v[200:201], v[86:87]
v_pk_fma_f32 v[202:203], v[86:87], v[86:87], v[202:203]
v_pk_add_f32 v[196:197], v[196:197], v[88:89]
v_pk_fma_f32 v[198:199], v[88:89], v[88:89], v[198:199]
v_pk_add_f32 v[200:201], v[200:201], v[90:91]
v_pk_fma_f32 v[202:203], v[90:91], v[90:91], v[202:203]
v_pk_add_f32 v[196:197], v[196:197], v[92:93]
v_pk_fma_f32 v[198:199], v[92:93], v[92:93], v[198:199]
v_pk_add_f32 v[200:201], v[200:201], v[94:95]
v_pk_fma_f32 v[202:203], v[94:95], v[94:95], v[202:203]
v_pk_add_f32 v[196:197], v[196:197], v[96:97]
v_pk_fma_f32 v[198:199], v[96:97], v[96:97], v[198:199]
v_pk_add_f32 v[200:201], v[200:201], v[98:99]
v_pk_fma_f32 v[202:203], v[98:99], v[98:99], v[202:203]
v_pk_add_f32 v[196:197], v[196:197], v[100:101]
v_pk_fma_f32 v[198:199], v[100:101], v[100:101], v[198:199]
v_pk_add_f32 v[200:201], v[200:201], v[102:103]
v_pk_fma_f32 v[202:203], v[102:103], v[102:103], v[202:203]
v_pk_add_f32 v[196:197], v[196:197], v[104:105]
v_pk_fma_f32 v[198:199], v[104:105], v[104:105], v[198:199]
v_pk_add_f32 v[200:201], v[200:201], v[106:107]
v_pk_fma_f32 v[202:203], v[106:107], v[106:107], v[202:203]
v_pk_add_f32 v[196:197], v[196:197], v[200:201]
v_pk_add_f32 v[198:199], v[198:199], v[202:203]
v_mfma_f32_32x32x16_bf16 v[116:131], a[172:175], a[56:59], v[116:131]
ds_read_b128 a[168:171], v207 offset:21504
v_add_f32 v204, v196, v197
v_add_f32 v205, v198, v199
v_mov_b32 v180, v204
v_mov_b32 v181, v205
s_nop 0
v_permlane32_swap_b32 v204, v180
v_permlane32_swap_b32 v205, v181
s_waitcnt lgkmcnt(3)
v_mfma_f32_32x32x16_bf16 v[116:131], a[144:147], a[60:63], v[116:131]
ds_read_b128 a[172:175], v207 offset:22528
v_add_f32 v204, v204, v180
v_add_f32 v205, v205, v181
s_mov_b32 exec_hi, 0
buffer_store_dwordx2 v[204:205], v6, s[8:11], s30 offen sc1
s_mov_b64 exec, -1
v_mfma_f32_32x32x16_bf16 v[116:131], a[148:151], a[64:67], v[116:131]
ds_read_b128 a[144:147], v207 offset:23552
v_mfma_f32_32x32x16_bf16 v[116:131], a[152:155], a[68:71], v[116:131]
ds_read_b128 a[148:151], v207 offset:24576
s_mul_i32 s38, s24, 9216
v_mfma_f32_32x32x16_bf16 v[116:131], a[156:159], a[72:75], v[116:131]
ds_read_b128 a[152:155], v207 offset:25600
s_add_u32 m0, s38, 123904
s_waitcnt lgkmcnt(3)
v_mfma_f32_32x32x16_bf16 v[116:131], a[160:163], a[76:79], v[116:131]
ds_read_b128 a[156:159], v207 offset:26624
v_mfma_f32_32x32x16_bf16 v[116:131], a[164:167], a[80:83], v[116:131]
ds_read_b128 a[160:163], v207 offset:27648
s_add_u32 s39, s38, s82
v_mfma_f32_32x32x16_bf16 v[116:131], a[168:171], a[84:87], v[116:131]
ds_read_b128 a[164:167], v207 offset:28672
s_add_u32 s39, s39, 303104
v_mfma_f32_32x32x16_bf16 v[116:131], a[172:175], a[88:91], v[116:131]
ds_read_b128 a[168:171], v207 offset:29696
s_waitcnt lgkmcnt(3)
v_mfma_f32_32x32x16_bf16 v[116:131], a[144:147], a[92:95], v[116:131]
ds_read_b128 a[172:175], v207 offset:30720
buffer_load_dwordx4 v1, s[4:7], s39 offen offset:0 sc1 lds
v_mfma_f32_32x32x16_bf16 v[116:131], a[148:151], a[96:99], v[116:131]
ds_read_b128 a[144:147], v207 offset:31744
buffer_load_dwordx4 v1, s[4:7], s39 offen offset:1024 sc1 lds
v_mfma_f32_32x32x16_bf16 v[116:131], a[152:155], a[100:103], v[116:131]
ds_read_b128 a[148:151], v207 offset:32768
v_mfma_f32_32x32x16_bf16 v[116:131], a[156:159], a[104:107], v[116:131]
ds_read_b128 a[152:155], v207 offset:33792
buffer_load_dwordx4 v1, s[4:7], s39 offen offset:2048 sc1 lds
s_waitcnt lgkmcnt(3)
v_mfma_f32_32x32x16_bf16 v[116:131], a[160:163], a[108:111], v[116:131]
ds_read_b128 a[156:159], v207 offset:34816
buffer_load_dwordx4 v1, s[4:7], s39 offen offset:3072 sc1 lds
v_mfma_f32_32x32x16_bf16 v[116:131], a[164:167], a[112:115], v[116:131]
ds_read_b128 a[160:163], v207 offset:35840
v_mfma_f32_32x32x16_bf16 v[116:131], a[168:171], a[116:119], v[116:131]
ds_read_b128 a[164:167], v207 offset:36864
s_add_u32 m0, m0, 4096
v_mfma_f32_32x32x16_bf16 v[116:131], a[172:175], a[120:123], v[116:131]
ds_read_b128 a[168:171], v208 offset:0
s_add_u32 s39, s39, 4096
s_waitcnt lgkmcnt(3)
v_mfma_f32_32x32x16_bf16 v[116:131], a[144:147], a[124:127], v[116:131]
ds_read_b128 a[172:175], v208 offset:1024
v_mfma_f32_32x32x16_bf16 v[116:131], a[148:151], a[128:131], v[116:131]
ds_read_b128 a[144:147], v208 offset:2048
buffer_load_dwordx4 v1, s[4:7], s39 offen offset:0 sc1 lds
v_mfma_f32_32x32x16_bf16 v[116:131], a[152:155], a[132:135], v[116:131]
ds_read_b128 a[148:151], v208 offset:3072
buffer_load_dwordx4 v1, s[4:7], s39 offen offset:1024 sc1 lds
v_mfma_f32_32x32x16_bf16 v[116:131], a[156:159], a[136:139], v[116:131]
ds_read_b128 a[152:155], v208 offset:4096
s_waitcnt lgkmcnt(3)
v_mfma_f32_32x32x16_bf16 v[116:131], a[160:163], a[140:143], v[116:131]
ds_read_b128 a[156:159], v208 offset:5120
buffer_load_dwordx4 v1, s[4:7], s39 offen offset:2048 sc1 lds
v_mfma_f32_32x32x16_bf16 v[116:131], a[164:167], v[212:215], v[116:131]
ds_read_b128 a[160:163], v208 offset:6144
buffer_load_dwordx4 v1, s[4:7], s39 offen offset:3072 sc1 lds
s_waitcnt vmcnt(9)
s_barrier
v_mfma_f32_32x32x16_bf16 v[132:147], a[168:171], a[0:3], 0
ds_read_b128 a[164:167], v208 offset:7168
v_mfma_f32_32x32x16_bf16 v[132:147], a[172:175], a[4:7], v[132:147]
ds_read_b128 a[168:171], v208 offset:8192
buffer_load_dwordx2 v[180:181], v234, s[8:11], s61 offen offset:0 sc1
s_add_u32 m0, m0, 4096
s_waitcnt lgkmcnt(3)
v_mfma_f32_32x32x16_bf16 v[132:147], a[144:147], a[8:11], v[132:147]
ds_read_b128 a[172:175], v208 offset:9216
buffer_load_dwordx2 v[182:183], v234, s[8:11], s61 offen offset:1024 sc1
s_add_u32 s39, s39, 4096
v_mfma_f32_32x32x16_bf16 v[132:147], a[148:151], a[12:15], v[132:147]
ds_read_b128 a[144:147], v208 offset:10240
buffer_load_dwordx2 v[184:185], v234, s[8:11], s61 offen offset:2048 sc1
v_mfma_f32_32x32x16_bf16 v[132:147], a[152:155], a[16:19], v[132:147]
ds_read_b128 a[148:151], v208 offset:11264
buffer_load_dwordx4 v1, s[4:7], s39 offen offset:0 sc1 lds
buffer_load_dwordx2 v[186:187], v234, s[8:11], s61 offen offset:3072 sc1
v_mfma_f32_32x32x16_bf16 v[132:147], a[156:159], a[20:23], v[132:147]
ds_read_b128 a[152:155], v208 offset:12288
buffer_load_dwordx2 v[188:189], v235, s[8:11], s61 offen offset:0 sc1
s_lshl_b32 s38, s24, 8
s_waitcnt lgkmcnt(3)
v_mfma_f32_32x32x16_bf16 v[132:147], a[160:163], a[24:27], v[132:147]
ds_read_b128 a[156:159], v208 offset:13312
buffer_load_dwordx2 v[190:191], v235, s[8:11], s61 offen offset:1024 sc1
v_mfma_f32_32x32x16_bf16 v[132:147], a[164:167], a[28:31], v[132:147]
ds_read_b128 a[160:163], v208 offset:14336
buffer_load_dwordx2 v[192:193], v235, s[8:11], s61 offen offset:2048 sc1
s_add_u32 m0, s38, 160768
v_mfma_f32_32x32x16_bf16 v[132:147], a[168:171], a[32:35], v[132:147]
ds_read_b128 a[164:167], v208 offset:15360
buffer_load_dwordx2 v[194:195], v235, s[8:11], s61 offen offset:3072 sc1
s_add_u32 s39, s38, s82
v_mfma_f32_32x32x16_bf16 v[132:147], a[172:175], a[36:39], v[132:147]
ds_read_b128 a[168:171], v208 offset:16384
s_waitcnt lgkmcnt(3)
v_mfma_f32_32x32x16_bf16 v[132:147], a[144:147], a[40:43], v[132:147]
ds_read_b128 a[172:175], v208 offset:17408
s_add_u32 s39, s39, 339968
v_mfma_f32_32x32x16_bf16 v[132:147], a[148:151], a[44:47], v[132:147]
ds_read_b128 a[144:147], v208 offset:18432
s_mov_b64 exec, 0xffff
buffer_load_dwordx4 v1, s[4:7], s39 offen sc1 lds
s_mov_b64 exec, -1
v_mfma_f32_32x32x16_bf16 v[132:147], a[152:155], a[48:51], v[132:147]
ds_read_b128 a[148:151], v208 offset:19456
v_mfma_f32_32x32x16_bf16 v[132:147], a[156:159], a[52:55], v[132:147]
ds_read_b128 a[152:155], v208 offset:20480
s_waitcnt lgkmcnt(3)
v_mfma_f32_32x32x16_bf16 v[132:147], a[160:163], a[56:59], v[132:147]
ds_read_b128 a[156:159], v208 offset:21504
v_mfma_f32_32x32x16_bf16 v[132:147], a[164:167], a[60:63], v[132:147]
ds_read_b128 a[160:163], v208 offset:22528
v_mfma_f32_32x32x16_bf16 v[132:147], a[168:171], a[64:67], v[132:147]
ds_read_b128 a[164:167], v208 offset:23552
v_mfma_f32_32x32x16_bf16 v[132:147], a[172:175], a[68:71], v[132:147]
ds_read_b128 a[168:171], v208 offset:24576
s_waitcnt lgkmcnt(3)
v_mfma_f32_32x32x16_bf16 v[132:147], a[144:147], a[72:75], v[132:147]
ds_read_b128 a[172:175], v208 offset:25600
v_mfma_f32_32x32x16_bf16 v[132:147], a[148:151], a[76:79], v[132:147]
ds_read_b128 a[144:147], v208 offset:26624
v_mfma_f32_32x32x16_bf16 v[132:147], a[152:155], a[80:83], v[132:147]
ds_read_b128 a[148:151], v208 offset:27648
v_mfma_f32_32x32x16_bf16 v[132:147], a[156:159], a[84:87], v[132:147]
ds_read_b128 a[152:155], v208 offset:28672
s_waitcnt vmcnt(1)
v_min3_f32 v198, v181, v183, v185
v_min3_f32 v199, v187, v189, v191
v_min3_f32 v198, v198, v193, v195
s_waitcnt lgkmcnt(3)
v_mfma_f32_32x32x16_bf16 v[132:147], a[160:163], a[88:91], v[132:147]
ds_read_b128 a[156:159], v208 offset:29696
v_min_f32 v198, v198, v199
v_cmp_gt_f32 vcc, 0, v198
s_nop 0
s_cbranch_vccnz L_stzslow_23
L_stzback_24:
v_mfma_f32_32x32x16_bf16 v[132:147], a[164:167], a[92:95], v[132:147]
ds_read_b128 a[160:163], v208 offset:30720
v_add_f32 v196, v180, v182
v_add_f32 v197, v181, v183
v_add_f32 v196, v196, v184
v_mfma_f32_32x32x16_bf16 v[132:147], a[168:171], a[96:99], v[132:147]
ds_read_b128 a[164:167], v208 offset:31744
v_add_f32 v197, v197, v185
v_add_f32 v196, v196, v186
v_add_f32 v197, v197, v187
v_add_f32 v196, v196, v188
v_mfma_f32_32x32x16_bf16 v[132:147], a[172:175], a[100:103], v[132:147]
ds_read_b128 a[168:171], v208 offset:32768
v_add_f32 v197, v197, v189
v_add_f32 v196, v196, v190
v_add_f32 v197, v197, v191
s_waitcnt lgkmcnt(3)
v_mfma_f32_32x32x16_bf16 v[132:147], a[144:147], a[104:107], v[132:147]
ds_read_b128 a[172:175], v208 offset:33792
v_add_f32 v196, v196, v192
v_add_f32 v197, v197, v193
v_add_f32 v196, v196, v194
v_add_f32 v197, v197, v195
v_mfma_f32_32x32x16_bf16 v[132:147], a[148:151], a[108:111], v[132:147]
ds_read_b128 a[144:147], v208 offset:34816
v_mov_b32 v198, v196
v_mov_b32 v199, v197
s_nop 0
v_permlane32_swap_b32 v196, v198
v_mfma_f32_32x32x16_bf16 v[132:147], a[152:155], a[112:115], v[132:147]
ds_read_b128 a[148:151], v208 offset:35840
v_permlane32_swap_b32 v197, v199
v_add_f32 v196, v196, v198
v_mfma_f32_32x32x16_bf16 v[132:147], a[156:159], a[116:119], v[132:147]
ds_read_b128 a[152:155], v208 offset:36864
v_add_f32 v197, v197, v199
v_mul_f32 v196, 0x39e38e39, v196
v_mul_f32 v198, v196, v196
v_mul_f32 v197, 0x39e38e39, v197
s_waitcnt lgkmcnt(3)
v_mfma_f32_32x32x16_bf16 v[132:147], a[160:163], a[120:123], v[132:147]
ds_read_b128 a[156:159], v209 offset:0
v_sub_f32 v197, v197, v198
v_max_f32 v197, 0, v197
v_add_f32 v197, 0x3727c5ac, v197
v_mfma_f32_32x32x16_bf16 v[132:147], a[164:167], a[124:127], v[132:147]
ds_read_b128 a[160:163], v209 offset:1024
v_rsq_f32 v198, v197
s_nop 0
v_mul_f32 v200, v196, v198
v_mfma_f32_32x32x16_bf16 v[132:147], a[168:171], a[128:131], v[132:147]
ds_read_b128 a[164:167], v209 offset:2048
v_fma_f32 v36, v36, v198, -v200
v_fma_f32 v37, v37, v198, -v200
v_fma_f32 v38, v38, v198, -v200
v_fma_f32 v39, v39, v198, -v200
v_mfma_f32_32x32x16_bf16 v[132:147], a[172:175], a[132:135], v[132:147]
ds_read_b128 a[168:171], v209 offset:3072
v_fma_f32 v40, v40, v198, -v200
v_fma_f32 v41, v41, v198, -v200
v_fma_f32 v42, v42, v198, -v200
v_fma_f32 v43, v43, v198, -v200
s_waitcnt lgkmcnt(3)
v_mfma_f32_32x32x16_bf16 v[132:147], a[144:147], a[136:139], v[132:147]
ds_read_b128 a[172:175], v209 offset:4096
v_cvt_pk_bf16_f32 v216, v36, v37
v_cvt_pk_bf16_f32 v217, v38, v39
v_cvt_pk_bf16_f32 v218, v40, v41
v_cvt_pk_bf16_f32 v219, v42, v43
v_mfma_f32_32x32x16_bf16 v[132:147], a[148:151], a[140:143], v[132:147]
ds_read_b128 a[144:147], v209 offset:5120
ds_write_b128 v237, v[216:219] offset:0
v_mfma_f32_32x32x16_bf16 v[132:147], a[152:155], v[212:215], v[132:147]
ds_read_b128 a[148:151], v209 offset:6144
v_fma_f32 v44, v44, v198, -v200
v_fma_f32 v45, v45, v198, -v200
v_fma_f32 v46, v46, v198, -v200
v_fma_f32 v47, v47, v198, -v200
s_waitcnt vmcnt(0)
s_barrier
v_mfma_f32_32x32x16_bf16 v[148:163], a[156:159], a[0:3], 0
ds_read_b128 a[152:155], v209 offset:7168
v_fma_f32 v48, v48, v198, -v200
v_fma_f32 v49, v49, v198, -v200
v_fma_f32 v50, v50, v198, -v200
v_fma_f32 v51, v51, v198, -v200
s_waitcnt lgkmcnt(4)
v_mfma_f32_32x32x16_bf16 v[148:163], a[160:163], a[4:7], v[148:163]
ds_read_b128 a[156:159], v209 offset:8192
v_cvt_pk_bf16_f32 v220, v44, v45
v_cvt_pk_bf16_f32 v221, v46, v47
v_cvt_pk_bf16_f32 v222, v48, v49
v_cvt_pk_bf16_f32 v223, v50, v51
v_mfma_f32_32x32x16_bf16 v[148:163], a[164:167], a[8:11], v[148:163]
ds_read_b128 a[160:163], v209 offset:9216
ds_write_b128 v237, v[220:223] offset:16
ds_read_b64_tr_b16 v[36:37], v238 offset:0
ds_read_b64_tr_b16 v[38:39], v238 offset:1152
ds_read_b64_tr_b16 v[40:41], v238 offset:32
ds_read_b64_tr_b16 v[42:43], v238 offset:1184
v_mfma_f32_32x32x16_bf16 v[148:163], a[168:171], a[12:15], v[148:163]
ds_read_b128 a[164:167], v209 offset:10240
v_fma_f32 v52, v52, v198, -v200
v_fma_f32 v53, v53, v198, -v200
v_fma_f32 v54, v54, v198, -v200
v_mfma_f32_32x32x16_bf16 v[148:163], a[172:175], a[16:19], v[148:163]
ds_read_b128 a[168:171], v209 offset:11264
v_fma_f32 v55, v55, v198, -v200
v_fma_f32 v56, v56, v198, -v200
s_waitcnt lgkmcnt(8)
v_mfma_f32_32x32x16_bf16 v[148:163], a[144:147], a[20:23], v[148:163]
ds_read_b128 a[172:175], v209 offset:12288
v_fma_f32 v57, v57, v198, -v200
v_fma_f32 v58, v58, v198, -v200
v_fma_f32 v59, v59, v198, -v200
v_mfma_f32_32x32x16_bf16 v[148:163], a[148:151], a[24:27], v[148:163]
ds_read_b128 a[144:147], v209 offset:13312
v_cvt_pk_bf16_f32 v224, v52, v53
v_cvt_pk_bf16_f32 v225, v54, v55
v_mfma_f32_32x32x16_bf16 v[148:163], a[152:155], a[28:31], v[148:163]
ds_read_b128 a[148:151], v209 offset:14336
v_cvt_pk_bf16_f32 v226, v56, v57
v_cvt_pk_bf16_f32 v227, v58, v59
v_mfma_f32_32x32x16_bf16 v[148:163], a[156:159], a[32:35], v[148:163]
ds_read_b128 a[152:155], v209 offset:15360
ds_write_b128 v237, v[224:227] offset:64
s_waitcnt lgkmcnt(9)
buffer_store_dwordx4 v[36:39], v1, s[8:11], s66 offen offset:0 sc1
s_waitcnt lgkmcnt(4)
v_mfma_f32_32x32x16_bf16 v[148:163], a[160:163], a[36:39], v[148:163]
ds_read_b128 a[156:159], v209 offset:16384
v_fma_f32 v60, v60, v198, -v200
v_fma_f32 v61, v61, v198, -v200
v_fma_f32 v62, v62, v198, -v200
v_fma_f32 v63, v63, v198, -v200
v_mfma_f32_32x32x16_bf16 v[148:163], a[164:167], a[40:43], v[148:163]
ds_read_b128 a[160:163], v209 offset:17408
v_fma_f32 v64, v64, v198, -v200
v_fma_f32 v65, v65, v198, -v200
v_fma_f32 v66, v66, v198, -v200
v_mfma_f32_32x32x16_bf16 v[148:163], a[168:171], a[44:47], v[148:163]
ds_read_b128 a[164:167], v209 offset:18432
v_fma_f32 v67, v67, v198, -v200
v_cvt_pk_bf16_f32 v228, v60, v61
v_cvt_pk_bf16_f32 v229, v62, v63
v_mfma_f32_32x32x16_bf16 v[148:163], a[172:175], a[48:51], v[148:163]
ds_read_b128 a[168:171], v209 offset:19456
v_cvt_pk_bf16_f32 v230, v64, v65
v_cvt_pk_bf16_f32 v231, v66, v67
s_waitcnt lgkmcnt(3)
v_mfma_f32_32x32x16_bf16 v[148:163], a[144:147], a[52:55], v[148:163]
ds_read_b128 a[172:175], v209 offset:20480
ds_write_b128 v237, v[228:231] offset:80
v_mfma_f32_32x32x16_bf16 v[148:163], a[148:151], a[56:59], v[148:163]
ds_read_b128 a[144:147], v209 offset:21504
ds_read_b64_tr_b16 v[44:45], v238 offset:64
ds_read_b64_tr_b16 v[46:47], v238 offset:1216
ds_read_b64_tr_b16 v[48:49], v238 offset:96
ds_read_b64_tr_b16 v[50:51], v238 offset:1248
buffer_store_dwordx4 v[40:43], v1, s[8:11], s66 offen offset:1024 sc1
v_mfma_f32_32x32x16_bf16 v[148:163], a[152:155], a[60:63], v[148:163]
ds_read_b128 a[148:151], v209 offset:22528
v_fma_f32 v68, v68, v198, -v200
v_fma_f32 v69, v69, v198, -v200
v_fma_f32 v70, v70, v198, -v200
v_mfma_f32_32x32x16_bf16 v[148:163], a[156:159], a[64:67], v[148:163]
ds_read_b128 a[152:155], v209 offset:23552
v_fma_f32 v71, v71, v198, -v200
v_fma_f32 v72, v72, v198, -v200
s_waitcnt lgkmcnt(8)
v_mfma_f32_32x32x16_bf16 v[148:163], a[160:163], a[68:71], v[148:163]
ds_read_b128 a[156:159], v209 offset:24576
v_fma_f32 v73, v73, v198, -v200
v_fma_f32 v74, v74, v198, -v200
v_fma_f32 v75, v75, v198, -v200
v_mfma_f32_32x32x16_bf16 v[148:163], a[164:167], a[72:75], v[148:163]
ds_read_b128 a[160:163], v209 offset:25600
v_cvt_pk_bf16_f32 v216, v68, v69
v_cvt_pk_bf16_f32 v217, v70, v71
v_mfma_f32_32x32x16_bf16 v[148:163], a[168:171], a[76:79], v[148:163]
ds_read_b128 a[164:167], v209 offset:26624
v_cvt_pk_bf16_f32 v218, v72, v73
v_cvt_pk_bf16_f32 v219, v74, v75
v_mfma_f32_32x32x16_bf16 v[148:163], a[172:175], a[80:83], v[148:163]
ds_read_b128 a[168:171], v209 offset:27648
ds_write_b128 v237, v[216:219] offset:128
s_waitcnt lgkmcnt(9)
buffer_store_dwordx4 v[44:47], v1, s[8:11], s66 offen offset:2048 sc1
s_waitcnt lgkmcnt(4)
v_mfma_f32_32x32x16_bf16 v[148:163], a[144:147], a[84:87], v[148:163]
ds_read_b128 a[172:175], v209 offset:28672
v_fma_f32 v76, v76, v198, -v200
v_fma_f32 v77, v77, v198, -v200
v_fma_f32 v78, v78, v198, -v200
v_fma_f32 v79, v79, v198, -v200
v_mfma_f32_32x32x16_bf16 v[148:163], a[148:151], a[88:91], v[148:163]
ds_read_b128 a[144:147], v209 offset:29696
v_fma_f32 v80, v80, v198, -v200
v_fma_f32 v81, v81, v198, -v200
v_fma_f32 v82, v82, v198, -v200
v_mfma_f32_32x32x16_bf16 v[148:163], a[152:155], a[92:95], v[148:163]
ds_read_b128 a[148:151], v209 offset:30720
v_fma_f32 v83, v83, v198, -v200
v_cvt_pk_bf16_f32 v220, v76, v77
v_cvt_pk_bf16_f32 v221, v78, v79
v_mfma_f32_32x32x16_bf16 v[148:163], a[156:159], a[96:99], v[148:163]
ds_read_b128 a[152:155], v209 offset:31744
v_cvt_pk_bf16_f32 v222, v80, v81
v_cvt_pk_bf16_f32 v223, v82, v83
s_waitcnt lgkmcnt(3)
v_mfma_f32_32x32x16_bf16 v[148:163], a[160:163], a[100:103], v[148:163]
ds_read_b128 a[156:159], v209 offset:32768
ds_write_b128 v237, v[220:223] offset:144
v_mfma_f32_32x32x16_bf16 v[148:163], a[164:167], a[104:107], v[148:163]
ds_read_b128 a[160:163], v209 offset:33792
ds_read_b64_tr_b16 v[52:53], v238 offset:128
ds_read_b64_tr_b16 v[54:55], v238 offset:1280
ds_read_b64_tr_b16 v[56:57], v238 offset:160
ds_read_b64_tr_b16 v[58:59], v238 offset:1312
buffer_store_dwordx4 v[48:51], v1, s[8:11], s66 offen offset:3072 sc1
v_mfma_f32_32x32x16_bf16 v[148:163], a[168:171], a[108:111], v[148:163]
ds_read_b128 a[164:167], v209 offset:34816
v_fma_f32 v84, v84, v198, -v200
v_fma_f32 v85, v85, v198, -v200
v_fma_f32 v86, v86, v198, -v200
v_mfma_f32_32x32x16_bf16 v[148:163], a[172:175], a[112:115], v[148:163]
ds_read_b128 a[168:171], v209 offset:35840
v_fma_f32 v87, v87, v198, -v200
v_fma_f32 v88, v88, v198, -v200
v_fma_f32 v89, v89, v198, -v200
s_waitcnt lgkmcnt(8)
v_mfma_f32_32x32x16_bf16 v[148:163], a[144:147], a[116:119], v[148:163]
ds_read_b128 a[172:175], v209 offset:36864
v_fma_f32 v90, v90, v198, -v200
v_fma_f32 v91, v91, v198, -v200
v_mfma_f32_32x32x16_bf16 v[148:163], a[148:151], a[120:123], v[148:163]
ds_read_b128 a[144:147], v206 offset:0
v_cvt_pk_bf16_f32 v224, v84, v85
v_cvt_pk_bf16_f32 v225, v86, v87
v_cvt_pk_bf16_f32 v226, v88, v89
v_mfma_f32_32x32x16_bf16 v[148:163], a[152:155], a[124:127], v[148:163]
ds_read_b128 a[148:151], v206 offset:1024
v_cvt_pk_bf16_f32 v227, v90, v91
v_mfma_f32_32x32x16_bf16 v[148:163], a[156:159], a[128:131], v[148:163]
ds_read_b128 a[152:155], v206 offset:2048
ds_write_b128 v237, v[224:227] offset:192
s_add_u32 s66, s66, 4096
s_waitcnt lgkmcnt(9)
buffer_store_dwordx4 v[52:55], v1, s[8:11], s66 offen offset:0 sc1
s_waitcnt lgkmcnt(4)
v_mfma_f32_32x32x16_bf16 v[148:163], a[160:163], a[132:135], v[148:163]
ds_read_b128 a[156:159], v206 offset:3072
v_fma_f32 v92, v92, v198, -v200
v_fma_f32 v93, v93, v198, -v200
v_fma_f32 v94, v94, v198, -v200
v_fma_f32 v95, v95, v198, -v200
v_mfma_f32_32x32x16_bf16 v[148:163], a[164:167], a[136:139], v[148:163]
ds_read_b128 a[160:163], v206 offset:4096
v_fma_f32 v96, v96, v198, -v200
v_fma_f32 v97, v97, v198, -v200
v_fma_f32 v98, v98, v198, -v200
v_mfma_f32_32x32x16_bf16 v[148:163], a[168:171], a[140:143], v[148:163]
ds_read_b128 a[164:167], v206 offset:5120
v_fma_f32 v99, v99, v198, -v200
v_cvt_pk_bf16_f32 v228, v92, v93
v_cvt_pk_bf16_f32 v229, v94, v95
v_mfma_f32_32x32x16_bf16 v[148:163], a[172:175], v[212:215], v[148:163]
ds_read_b128 a[168:171], v206 offset:6144
v_cvt_pk_bf16_f32 v230, v96, v97
v_cvt_pk_bf16_f32 v231, v98, v99
s_waitcnt lgkmcnt(3)
v_mfma_f32_32x32x16_bf16 v[164:179], a[144:147], a[0:3], 0
ds_read_b128 a[172:175], v206 offset:7168
ds_write_b128 v237, v[228:231] offset:208
v_mfma_f32_32x32x16_bf16 v[164:179], a[148:151], a[4:7], v[164:179]
ds_read_b128 a[144:147], v206 offset:8192
ds_read_b64_tr_b16 v[60:61], v238 offset:192
ds_read_b64_tr_b16 v[62:63], v238 offset:1344
ds_read_b64_tr_b16 v[64:65], v238 offset:224
ds_read_b64_tr_b16 v[66:67], v238 offset:1376
buffer_store_dwordx4 v[56:59], v1, s[8:11], s66 offen offset:1024 sc1
v_mfma_f32_32x32x16_bf16 v[164:179], a[152:155], a[8:11], v[164:179]
ds_read_b128 a[148:151], v206 offset:9216
v_fma_f32 v100, v100, v198, -v200
v_fma_f32 v101, v101, v198, -v200
v_fma_f32 v102, v102, v198, -v200
v_mfma_f32_32x32x16_bf16 v[164:179], a[156:159], a[12:15], v[164:179]
ds_read_b128 a[152:155], v206 offset:10240
v_fma_f32 v103, v103, v198, -v200
v_fma_f32 v104, v104, v198, -v200
v_fma_f32 v105, v105, v198, -v200
s_waitcnt lgkmcnt(8)
v_mfma_f32_32x32x16_bf16 v[164:179], a[160:163], a[16:19], v[164:179]
ds_read_b128 a[156:159], v206 offset:11264
v_fma_f32 v106, v106, v198, -v200
v_fma_f32 v107, v107, v198, -v200
v_cvt_pk_bf16_f32 v216, v100, v101
v_mfma_f32_32x32x16_bf16 v[164:179], a[164:167], a[20:23], v[164:179]
ds_read_b128 a[160:163], v206 offset:12288
v_cvt_pk_bf16_f32 v217, v102, v103
v_cvt_pk_bf16_f32 v218, v104, v105
v_cvt_pk_bf16_f32 v219, v106, v107
v_mfma_f32_32x32x16_bf16 v[164:179], a[168:171], a[24:27], v[164:179]
ds_read_b128 a[164:167], v206 offset:13312
ds_write_b128 v239, v[216:219] offset:256
v_mfma_f32_32x32x16_bf16 v[164:179], a[172:175], a[28:31], v[164:179]
ds_read_b128 a[168:171], v206 offset:14336
ds_read_b64_tr_b16 v[68:69], v238 offset:256
ds_read_b64_tr_b16 v[70:71], v238 offset:1408
s_waitcnt lgkmcnt(11)
buffer_store_dwordx4 v[60:63], v1, s[8:11], s66 offen offset:2048 sc1
s_waitcnt lgkmcnt(6)
v_mfma_f32_32x32x16_bf16 v[164:179], a[144:147], a[32:35], v[164:179]
ds_read_b128 a[172:175], v206 offset:15360
v_mfma_f32_32x32x16_bf16 v[164:179], a[148:151], a[36:39], v[164:179]
ds_read_b128 a[144:147], v206 offset:16384
v_mfma_f32_32x32x16_bf16 v[164:179], a[152:155], a[40:43], v[164:179]
ds_read_b128 a[148:151], v206 offset:17408
v_mfma_f32_32x32x16_bf16 v[164:179], a[156:159], a[44:47], v[164:179]
ds_read_b128 a[152:155], v206 offset:18432
s_waitcnt lgkmcnt(3)
v_mfma_f32_32x32x16_bf16 v[164:179], a[160:163], a[48:51], v[164:179]
ds_read_b128 a[156:159], v206 offset:19456
v_mfma_f32_32x32x16_bf16 v[164:179], a[164:167], a[52:55], v[164:179]
ds_read_b128 a[160:163], v206 offset:20480
buffer_store_dwordx4 v[64:67], v1, s[8:11], s66 offen offset:3072 sc1
v_mfma_f32_32x32x16_bf16 v[164:179], a[168:171], a[56:59], v[164:179]
ds_read_b128 a[164:167], v206 offset:21504
v_mfma_f32_32x32x16_bf16 v[164:179], a[172:175], a[60:63], v[164:179]
ds_read_b128 a[168:171], v206 offset:22528
s_waitcnt lgkmcnt(3)
v_mfma_f32_32x32x16_bf16 v[164:179], a[144:147], a[64:67], v[164:179]
ds_read_b128 a[172:175], v206 offset:23552
v_mfma_f32_32x32x16_bf16 v[164:179], a[148:151], a[68:71], v[164:179]
ds_read_b128 a[144:147], v206 offset:24576
v_mfma_f32_32x32x16_bf16 v[164:179], a[152:155], a[72:75], v[164:179]
ds_read_b128 a[148:151], v206 offset:25600
s_add_u32 s66, s66, 4096
v_mfma_f32_32x32x16_bf16 v[164:179], a[156:159], a[76:79], v[164:179]
ds_read_b128 a[152:155], v206 offset:26624
buffer_store_dwordx4 v[68:71], v1, s[8:11], s66 offen offset:0 sc1
s_waitcnt lgkmcnt(3)
v_mfma_f32_32x32x16_bf16 v[164:179], a[160:163], a[80:83], v[164:179]
ds_read_b128 a[156:159], v206 offset:27648
v_mfma_f32_32x32x16_bf16 v[164:179], a[164:167], a[84:87], v[164:179]
ds_read_b128 a[160:163], v206 offset:28672
v_mfma_f32_32x32x16_bf16 v[164:179], a[168:171], a[88:91], v[164:179]
ds_read_b128 a[164:167], v206 offset:29696
v_mfma_f32_32x32x16_bf16 v[164:179], a[172:175], a[92:95], v[164:179]
ds_read_b128 a[168:171], v206 offset:30720
s_waitcnt lgkmcnt(3)
v_mfma_f32_32x32x16_bf16 v[164:179], a[144:147], a[96:99], v[164:179]
ds_read_b128 a[172:175], v206 offset:31744
v_mfma_f32_32x32x16_bf16 v[164:179], a[148:151], a[100:103], v[164:179]
ds_read_b128 a[144:147], v206 offset:32768
v_mfma_f32_32x32x16_bf16 v[164:179], a[152:155], a[104:107], v[164:179]
ds_read_b128 a[148:151], v206 offset:33792
v_mfma_f32_32x32x16_bf16 v[164:179], a[156:159], a[108:111], v[164:179]
ds_read_b128 a[152:155], v206 offset:34816
s_waitcnt lgkmcnt(3)
v_mfma_f32_32x32x16_bf16 v[164:179], a[160:163], a[112:115], v[164:179]
ds_read_b128 a[156:159], v206 offset:35840
v_mfma_f32_32x32x16_bf16 v[164:179], a[164:167], a[116:119], v[164:179]
ds_read_b128 a[160:163], v206 offset:36864
v_mfma_f32_32x32x16_bf16 v[164:179], a[168:171], a[120:123], v[164:179]
v_mfma_f32_32x32x16_bf16 v[164:179], a[172:175], a[124:127], v[164:179]
s_waitcnt lgkmcnt(1)
v_mfma_f32_32x32x16_bf16 v[164:179], a[144:147], a[128:131], v[164:179]
v_mfma_f32_32x32x16_bf16 v[164:179], a[148:151], a[132:135], v[164:179]
v_mfma_f32_32x32x16_bf16 v[164:179], a[152:155], a[136:139], v[164:179]
v_mfma_f32_32x32x16_bf16 v[164:179], a[156:159], a[140:143], v[164:179]
s_waitcnt lgkmcnt(0)
v_mfma_f32_32x32x16_bf16 v[164:179], a[160:163], v[212:215], v[164:179]
s_cmp_eq_u32 s24, 0
s_cselect_b32 s67, 0, 1073741824
s_add_u32 s67, s67, 26542080
s_waitcnt vmcnt(0)
s_barrier
s_mov_b64 exec, 0xffff
buffer_atomic_add v4, v236, s[8:11], s67 offen sc1
s_mov_b64 exec, -1
L_c4:
s_lshl_b32 s35, s80, 7
s_add_u32 s35, s35, 26542080
s_cmp_eq_u32 s24, 1
s_cselect_b32 s35, s35, 1073741824
v_mov_b32 v6, 0
s_lshl_b32 s31, s25, 8
s_lshl_b32 s32, s24, 6
s_add_u32 s31, s31, s32
v_lshlrev_b32 v8, 1, v2
buffer_load_ushort v180, v8, s[20:23], s31 offen
buffer_load_ushort v181, v8, s[20:23], s31 offen offset:32
buffer_load_dwordx4 a[80:83], v1, s[4:7], s52 offen offset:2048 sc1
buffer_load_dwordx4 a[84:87], v9, s[4:7], s52 offen offset:2048 sc1
v_mov_b32 v249, 0
s_mov_b64 exec, 1
buffer_atomic_add v249, v6, s[8:11], s35 offen sc0 sc1
s_mov_b64 exec, -1
buffer_load_dwordx4 a[88:91], v1, s[4:7], s52 offen offset:3072 sc1
buffer_load_dwordx4 a[92:95], v9, s[4:7], s52 offen offset:3072 sc1
s_add_u32 s52, s52, 4096
buffer_load_dwordx4 a[96:99], v1, s[4:7], s52 offen offset:0 sc1
buffer_load_dwordx4 a[100:103], v9, s[4:7], s52 offen offset:0 sc1
buffer_load_dwordx4 a[104:107], v1, s[4:7], s52 offen offset:1024 sc1
v_mov_b32 v250, 0
s_mov_b64 exec, 1
buffer_atomic_add v250, v6, s[8:11], s35 offen sc0 sc1
s_mov_b64 exec, -1
buffer_load_dwordx4 a[108:111], v9, s[4:7], s52 offen offset:1024 sc1
buffer_load_dwordx4 a[112:115], v1, s[4:7], s52 offen offset:2048 sc1
buffer_load_dwordx4 a[116:119], v9, s[4:7], s52 offen offset:2048 sc1
buffer_load_dwordx4 a[120:123], v1, s[4:7], s52 offen offset:3072 sc1
buffer_load_dwordx4 a[124:127], v9, s[4:7], s52 offen offset:3072 sc1
s_add_u32 s52, s52, 4096
v_mov_b32 v251, 0
s_mov_b64 exec, 1
buffer_atomic_add v251, v6, s[8:11], s35 offen sc0 sc1
s_mov_b64 exec, -1
buffer_load_dwordx4 a[128:131], v1, s[4:7], s52 offen offset:0 sc1
buffer_load_dwordx4 a[132:135], v9, s[4:7], s52 offen offset:0 sc1
buffer_load_dwordx4 a[136:139], v1, s[4:7], s52 offen offset:1024 sc1
buffer_load_dwordx4 a[140:143], v9, s[4:7], s52 offen offset:1024 sc1
s_mul_i32 s30, s26, 589824
s_add_u32 s30, s30, 7340032
s_lshl_b32 s62, s24, 12
s_lshl_b32 s63, s24, 10
s_add_u32 s60, s30, s62
s_add_u32 s61, s30, s63
s_add_u32 s61, s61, 16384
s_cmp_eq_u32 s24, 1
s_cbranch_scc0 L_other_28
s_mov_b32 s31, 0
s_mov_b64 exec, 1
v_mov_b32 v252, 0
buffer_atomic_add v252, v6, s[8:11], s35 offen sc0 sc1
s_waitcnt vmcnt(17)
v_cmp_gt_u32 vcc, 16, v249
s_nop 0
s_cbranch_vccz L_polled_27
s_waitcnt vmcnt(11)
v_cmp_gt_u32 vcc, 16, v250
s_nop 0
s_cbranch_vccz L_polled_27
v_mov_b32 v249, 0
buffer_atomic_add v249, v6, s[8:11], s35 offen sc0 sc1
s_waitcnt vmcnt(6)
v_cmp_gt_u32 vcc, 16, v251
s_nop 0
s_cbranch_vccz L_polled_27
v_mov_b32 v250, 0
buffer_atomic_add v250, v6, s[8:11], s35 offen sc0 sc1
L_poll_26:
s_add_u32 s31, s31, 1
s_cmp_gt_u32 s31, 100000
s_cbranch_scc1 L_polled_27
v_mov_b32 v251, 0
buffer_atomic_add v251, v6, s[8:11], s35 offen sc0 sc1
s_waitcnt vmcnt(3)
v_cmp_gt_u32 vcc, 16, v252
s_nop 0
s_cbranch_vccz L_polled_27
v_mov_b32 v252, 0
buffer_atomic_add v252, v6, s[8:11], s35 offen sc0 sc1
s_waitcnt vmcnt(3)
v_cmp_gt_u32 vcc, 16, v249
s_nop 0
s_cbranch_vccz L_polled_27
v_mov_b32 v249, 0
buffer_atomic_add v249, v6, s[8:11], s35 offen sc0 sc1
s_waitcnt vmcnt(3)
v_cmp_gt_u32 vcc, 16, v250
s_nop 0
s_cbranch_vccz L_polled_27
v_mov_b32 v250, 0
buffer_atomic_add v250, v6, s[8:11], s35 offen sc0 sc1
s_waitcnt vmcnt(3)
v_cmp_gt_u32 vcc, 16, v251
s_nop 0
s_cbranch_vccz L_polled_27
s_branch L_poll_26
L_polled_27:
s_mov_b64 exec, -1
L_other_28:
s_barrier
s_add_u32 m0, s62, 126976
s_add_u32 s60, s60, 0
buffer_load_dwordx4 v1, s[8:11], s60 offen offset:0 sc1 lds
buffer_load_dwordx4 v1, s[8:11], s60 offen offset:1024 sc1 lds
buffer_load_dwordx4 v1, s[8:11], s60 offen offset:2048 sc1 lds
buffer_load_dwordx4 v1, s[8:11], s60 offen offset:3072 sc1 lds
s_add_u32 m0, s63, 143360
s_add_u32 s61, s61, 0
buffer_load_dwordx4 v1, s[8:11], s61 offen offset:0 sc1 lds
s_barrier
s_add_u32 m0, s62, 147456
s_add_u32 s60, s60, 20480
buffer_load_dwordx4 v1, s[8:11], s60 offen offset:0 sc1 lds
buffer_load_dwordx4 v1, s[8:11], s60 offen offset:1024 sc1 lds
buffer_load_dwordx4 v1, s[8:11], s60 offen offset:2048 sc1 lds
buffer_load_dwordx4 v1, s[8:11], s60 offen offset:3072 sc1 lds
v_add_u32 v190, 53248, v1
v_add_u32 v191, 90112, v1
v_add_u32 v192, 126976, v1
s_waitcnt vmcnt(28)
v_lshlrev_b32 v180, 16, v180
v_lshlrev_b32 v181, 16, v181
v_mov_b32 v36, v180
v_mov_b32 v37, v180
v_mov_b32 v38, v180
v_mov_b32 v39, v180
v_mov_b32 v40, v181
v_mov_b32 v41, v181
v_mov_b32 v42, v181
v_mov_b32 v43, v181
v_mov_b32 v44, v180
v_mov_b32 v45, v180
v_mov_b32 v46, v180
v_mov_b32 v47, v180
v_mov_b32 v48, v181
v_mov_b32 v49, v181
v_mov_b32 v50, v181
v_mov_b32 v51, v181
v_mov_b32 v52, v180
v_mov_b32 v53, v180
v_mov_b32 v54, v180
v_mov_b32 v55, v180
v_mov_b32 v56, v181
v_mov_b32 v57, v181
v_mov_b32 v58, v181
v_mov_b32 v59, v181
v_mov_b32 v60, v180
v_mov_b32 v61, v180
v_mov_b32 v62, v180
v_mov_b32 v63, v180
v_mov_b32 v64, v181
v_mov_b32 v65, v181
v_mov_b32 v66, v181
v_mov_b32 v67, v181
v_mov_b32 v68, v180
v_mov_b32 v69, v180
v_mov_b32 v70, v180
v_mov_b32 v71, v180
v_mov_b32 v72, v181
v_mov_b32 v73, v181
v_mov_b32 v74, v181
v_mov_b32 v75, v181
v_mov_b32 v76, v180
v_mov_b32 v77, v180
v_mov_b32 v78, v180
v_mov_b32 v79, v180
v_mov_b32 v80, v181
v_mov_b32 v81, v181
v_mov_b32 v82, v181
v_mov_b32 v83, v181
v_mov_b32 v84, v180
v_mov_b32 v85, v180
v_mov_b32 v86, v180
v_mov_b32 v87, v180
v_mov_b32 v88, v181
v_mov_b32 v89, v181
v_mov_b32 v90, v181
v_mov_b32 v91, v181
v_mov_b32 v92, v180
v_mov_b32 v93, v180
v_mov_b32 v94, v180
v_mov_b32 v95, v180
v_mov_b32 v96, v181
v_mov_b32 v97, v181
v_mov_b32 v98, v181
v_mov_b32 v99, v181
v_mov_b32 v100, v180
v_mov_b32 v101, v180
v_mov_b32 v102, v180
v_mov_b32 v103, v180
v_mov_b32 v104, v181
v_mov_b32 v105, v181
v_mov_b32 v106, v181
v_mov_b32 v107, v181
s_waitcnt vmcnt(4)
s_barrier
ds_read_b128 a[0:3], v192 offset:0
ds_read_b128 a[4:7], v192 offset:1024
ds_read_b128 a[8:11], v192 offset:2048
ds_read_b128 a[12:15], v192 offset:3072
ds_read_b128 a[16:19], v192 offset:4096
ds_read_b128 a[20:23], v192 offset:5120
ds_read_b128 a[24:27], v192 offset:6144
ds_read_b128 a[28:31], v192 offset:7168
ds_read_b128 a[32:35], v192 offset:8192
s_waitcnt lgkmcnt(0)
v_mfma_f32_16x16x32_bf16 v[36:39], a[0:3], a[176:179], v[36:39]
ds_read_b128 a[36:39], v192 offset:9216
s_add_u32 m0, s62, 53248
v_mfma_f32_16x16x32_bf16 v[40:43], a[0:3], a[180:183], v[40:43]
ds_read_b128 a[40:43], v192 offset:10240
v_mul_f32 v182, v108, v108
v_mfma_f32_16x16x32_bf16 v[44:47], a[4:7], a[176:179], v[44:47]
ds_read_b128 a[44:47], v192 offset:11264
s_add_u32 s60, s60, 16384
v_mfma_f32_16x16x32_bf16 v[48:51], a[4:7], a[180:183], v[48:51]
ds_read_b128 a[48:51], v192 offset:12288
v_mul_f32 v183, v109, v109
v_mfma_f32_16x16x32_bf16 v[52:55], a[8:11], a[176:179], v[52:55]
ds_read_b128 a[52:55], v192 offset:13312
v_mul_f32 v184, v110, v110
v_mfma_f32_16x16x32_bf16 v[56:59], a[8:11], a[180:183], v[56:59]
ds_read_b128 a[56:59], v192 offset:14336
buffer_load_dwordx4 v1, s[8:11], s60 offen offset:0 sc1 lds
v_mfma_f32_16x16x32_bf16 v[60:63], a[12:15], a[176:179], v[60:63]
ds_read_b128 a[60:63], v192 offset:15360
v_mul_f32 v185, v111, v111
v_mfma_f32_16x16x32_bf16 v[64:67], a[12:15], a[180:183], v[64:67]
ds_read_b128 a[64:67], v192 offset:16384
v_fma_f32 v182, v182, v254, v253
v_mfma_f32_16x16x32_bf16 v[68:71], a[16:19], a[176:179], v[68:71]
ds_read_b128 a[68:71], v192 offset:17408
buffer_load_dwordx4 v1, s[8:11], s60 offen offset:1024 sc1 lds
v_mfma_f32_16x16x32_bf16 v[72:75], a[16:19], a[180:183], v[72:75]
v_fma_f32 v183, v183, v254, v253
v_fma_f32 v184, v184, v254, v253
v_mfma_f32_16x16x32_bf16 v[76:79], a[20:23], a[176:179], v[76:79]
v_fma_f32 v185, v185, v254, v253
v_mfma_f32_16x16x32_bf16 v[80:83], a[20:23], a[180:183], v[80:83]
buffer_load_dwordx4 v1, s[8:11], s60 offen offset:2048 sc1 lds
v_mul_f32 v182, v182, v108
v_mfma_f32_16x16x32_bf16 v[84:87], a[24:27], a[176:179], v[84:87]
v_mul_f32 v183, v183, v109
v_mfma_f32_16x16x32_bf16 v[88:91], a[24:27], a[180:183], v[88:91]
v_mfma_f32_16x16x32_bf16 v[92:95], a[28:31], a[176:179], v[92:95]
buffer_load_dwordx4 v1, s[8:11], s60 offen offset:3072 sc1 lds
v_mul_f32 v184, v184, v110
v_mfma_f32_16x16x32_bf16 v[96:99], a[28:31], a[180:183], v[96:99]
v_mul_f32 v185, v185, v111
v_mfma_f32_16x16x32_bf16 v[100:103], a[32:35], a[176:179], v[100:103]
v_mfma_f32_16x16x32_bf16 v[104:107], a[32:35], a[180:183], v[104:107]
s_waitcnt vmcnt(4)
s_waitcnt lgkmcnt(0)
s_barrier
v_mfma_f32_16x16x32_bf16 v[36:39], a[36:39], a[184:187], v[36:39]
ds_read_b128 a[0:3], v192 offset:18432
s_add_u32 m0, s63, 69632
v_mfma_f32_16x16x32_bf16 v[40:43], a[36:39], a[188:191], v[40:43]
ds_read_b128 a[4:7], v192 offset:19456
v_mfma_f32_16x16x32_bf16 v[44:47], a[40:43], a[184:187], v[44:47]
ds_read_b128 a[8:11], v192 offset:20480
s_add_u32 s61, s61, 36864
v_mfma_f32_16x16x32_bf16 v[48:51], a[40:43], a[188:191], v[48:51]
ds_read_b128 a[12:15], v192 offset:21504
v_mfma_f32_16x16x32_bf16 v[52:55], a[44:47], a[184:187], v[52:55]
ds_read_b128 a[16:19], v192 offset:22528
buffer_load_dwordx4 v1, s[8:11], s61 offen offset:0 sc1 lds
v_mfma_f32_16x16x32_bf16 v[56:59], a[44:47], a[188:191], v[56:59]
ds_read_b128 a[20:23], v192 offset:23552
v_mfma_f32_16x16x32_bf16 v[60:63], a[48:51], a[184:187], v[60:63]
ds_read_b128 a[24:27], v192 offset:24576
s_add_u32 m0, s62, 73728
v_mfma_f32_16x16x32_bf16 v[64:67], a[48:51], a[188:191], v[64:67]
ds_read_b128 a[28:31], v192 offset:25600
v_mfma_f32_16x16x32_bf16 v[68:71], a[52:55], a[184:187], v[68:71]
ds_read_b128 a[32:35], v192 offset:26624
s_add_u32 s60, s60, 20480
v_mfma_f32_16x16x32_bf16 v[72:75], a[52:55], a[188:191], v[72:75]
v_exp_f32 v182, v182
v_mfma_f32_16x16x32_bf16 v[76:79], a[56:59], a[184:187], v[76:79]
buffer_load_dwordx4 v1, s[8:11], s60 offen offset:0 sc1 lds
v_mfma_f32_16x16x32_bf16 v[80:83], a[56:59], a[188:191], v[80:83]
v_exp_f32 v183, v183
v_mfma_f32_16x16x32_bf16 v[84:87], a[60:63], a[184:187], v[84:87]
buffer_load_dwordx4 v1, s[8:11], s60 offen offset:1024 sc1 lds
v_mfma_f32_16x16x32_bf16 v[88:91], a[60:63], a[188:191], v[88:91]
v_exp_f32 v184, v184
v_mfma_f32_16x16x32_bf16 v[92:95], a[64:67], a[184:187], v[92:95]
buffer_load_dwordx4 v1, s[8:11], s60 offen offset:2048 sc1 lds
v_mfma_f32_16x16x32_bf16 v[96:99], a[64:67], a[188:191], v[96:99]
v_exp_f32 v185, v185
v_mfma_f32_16x16x32_bf16 v[100:103], a[68:71], a[184:187], v[100:103]
v_fma_f32 v182, v182, v255, v255
v_fma_f32 v183, v183, v255, v255
v_mfma_f32_16x16x32_bf16 v[104:107], a[68:71], a[188:191], v[104:107]
v_fma_f32 v184, v184, v255, v255
s_waitcnt lgkmcnt(0)
v_mfma_f32_16x16x32_bf16 v[36:39], a[0:3], a[192:195], v[36:39]
ds_read_b128 a[36:39], v192 offset:27648
buffer_load_dwordx4 v1, s[8:11], s60 offen offset:3072 sc1 lds
v_mfma_f32_16x16x32_bf16 v[40:43], a[0:3], a[196:199], v[40:43]
ds_read_b128 a[40:43], v192 offset:28672
v_fma_f32 v185, v185, v255, v255
v_mfma_f32_16x16x32_bf16 v[44:47], a[4:7], a[192:195], v[44:47]
ds_read_b128 a[44:47], v192 offset:29696
s_add_u32 m0, s62, 90112
v_mfma_f32_16x16x32_bf16 v[48:51], a[4:7], a[196:199], v[48:51]
ds_read_b128 a[48:51], v192 offset:30720
v_mfma_f32_16x16x32_bf16 v[52:55], a[8:11], a[192:195], v[52:55]
ds_read_b128 a[52:55], v192 offset:31744
v_mfma_f32_16x16x32_bf16 v[56:59], a[8:11], a[196:199], v[56:59]
ds_read_b128 a[56:59], v192 offset:32768
s_add_u32 s60, s60, 16384
v_mfma_f32_16x16x32_bf16 v[60:63], a[12:15], a[192:195], v[60:63]
ds_read_b128 a[60:63], v192 offset:33792
v_mfma_f32_16x16x32_bf16 v[64:67], a[12:15], a[196:199], v[64:67]
ds_read_b128 a[64:67], v192 offset:34816
v_mfma_f32_16x16x32_bf16 v[68:71], a[16:19], a[192:195], v[68:71]
ds_read_b128 a[68:71], v192 offset:35840
buffer_load_dwordx4 v1, s[8:11], s60 offen offset:0 sc1 lds
v_mfma_f32_16x16x32_bf16 v[72:75], a[16:19], a[196:199], v[72:75]
v_rcp_f32 v182, v182
v_mfma_f32_16x16x32_bf16 v[76:79], a[20:23], a[192:195], v[76:79]
v_rcp_f32 v183, v183
v_mfma_f32_16x16x32_bf16 v[80:83], a[20:23], a[196:199], v[80:83]
buffer_load_dwordx4 v1, s[8:11], s60 offen offset:1024 sc1 lds
v_mfma_f32_16x16x32_bf16 v[84:87], a[24:27], a[192:195], v[84:87]
v_rcp_f32 v184, v184
v_mfma_f32_16x16x32_bf16 v[88:91], a[24:27], a[196:199], v[88:91]
v_rcp_f32 v185, v185
v_mfma_f32_16x16x32_bf16 v[92:95], a[28:31], a[192:195], v[92:95]
buffer_load_dwordx4 v1, s[8:11], s60 offen offset:2048 sc1 lds
v_mul_f32 v108, v108, v182
v_mfma_f32_16x16x32_bf16 v[96:99], a[28:31], a[196:199], v[96:99]
v_mul_f32 v109, v109, v183
v_mul_f32 v110, v110, v184
v_mfma_f32_16x16x32_bf16 v[100:103], a[32:35], a[192:195], v[100:103]
v_mul_f32 v111, v111, v185
v_mul_f32 v186, v112, v112
v_mfma_f32_16x16x32_bf16 v[104:107], a[32:35], a[196:199], v[104:107]
s_waitcnt vmcnt(7)
s_waitcnt lgkmcnt(0)
s_barrier
v_mfma_f32_16x16x32_bf16 v[36:39], a[36:39], a[200:203], v[36:39]
ds_read_b128 a[0:3], v190 offset:0
buffer_load_dwordx4 v1, s[8:11], s60 offen offset:3072 sc1 lds
v_mfma_f32_16x16x32_bf16 v[40:43], a[36:39], a[204:207], v[40:43]
ds_read_b128 a[4:7], v190 offset:1024
v_mul_f32 v187, v113, v113
v_mfma_f32_16x16x32_bf16 v[44:47], a[40:43], a[200:203], v[44:47]
ds_read_b128 a[8:11], v190 offset:2048
s_add_u32 m0, s63, 106496
v_mfma_f32_16x16x32_bf16 v[48:51], a[40:43], a[204:207], v[48:51]
ds_read_b128 a[12:15], v190 offset:3072
v_mul_f32 v188, v114, v114
v_mfma_f32_16x16x32_bf16 v[52:55], a[44:47], a[200:203], v[52:55]
ds_read_b128 a[16:19], v190 offset:4096
s_add_u32 s61, s61, 36864
v_mfma_f32_16x16x32_bf16 v[56:59], a[44:47], a[204:207], v[56:59]
ds_read_b128 a[20:23], v190 offset:5120
v_mul_f32 v189, v115, v115
v_mfma_f32_16x16x32_bf16 v[60:63], a[48:51], a[200:203], v[60:63]
ds_read_b128 a[24:27], v190 offset:6144
buffer_load_dwordx4 v1, s[8:11], s61 offen offset:0 sc1 lds
v_mfma_f32_16x16x32_bf16 v[64:67], a[48:51], a[204:207], v[64:67]
ds_read_b128 a[28:31], v190 offset:7168
v_fma_f32 v186, v186, v254, v253
v_mfma_f32_16x16x32_bf16 v[68:71], a[52:55], a[200:203], v[68:71]
ds_read_b128 a[32:35], v190 offset:8192
s_add_u32 m0, s62, 110592
v_mfma_f32_16x16x32_bf16 v[72:75], a[52:55], a[204:207], v[72:75]
s_add_u32 s60, s60, 20480
v_fma_f32 v187, v187, v254, v253
v_fma_f32 v188, v188, v254, v253
v_mfma_f32_16x16x32_bf16 v[76:79], a[56:59], a[200:203], v[76:79]
v_fma_f32 v189, v189, v254, v253
v_mul_f32 v186, v186, v112
v_mfma_f32_16x16x32_bf16 v[80:83], a[56:59], a[204:207], v[80:83]
v_mul_f32 v187, v187, v113
v_mfma_f32_16x16x32_bf16 v[84:87], a[60:63], a[200:203], v[84:87]
buffer_load_dwordx4 v1, s[8:11], s60 offen offset:0 sc1 lds
v_mul_f32 v188, v188, v114
v_mfma_f32_16x16x32_bf16 v[88:91], a[60:63], a[204:207], v[88:91]
v_mul_f32 v189, v189, v115
v_mfma_f32_16x16x32_bf16 v[92:95], a[64:67], a[200:203], v[92:95]
buffer_load_dwordx4 v1, s[8:11], s60 offen offset:1024 sc1 lds
v_mfma_f32_16x16x32_bf16 v[96:99], a[64:67], a[204:207], v[96:99]
v_exp_f32 v186, v186
v_mfma_f32_16x16x32_bf16 v[100:103], a[68:71], a[200:203], v[100:103]
v_mfma_f32_16x16x32_bf16 v[104:107], a[68:71], a[204:207], v[104:107]
s_waitcnt lgkmcnt(0)
v_mfma_f32_16x16x32_bf16 v[36:39], a[0:3], a[208:211], v[36:39]
ds_read_b128 a[36:39], v190 offset:9216
buffer_load_dwordx4 v1, s[8:11], s60 offen offset:2048 sc1 lds
v_mfma_f32_16x16x32_bf16 v[40:43], a[0:3], a[212:215], v[40:43]
ds_read_b128 a[40:43], v190 offset:10240
v_mfma_f32_16x16x32_bf16 v[44:47], a[4:7], a[208:211], v[44:47]
ds_read_b128 a[44:47], v190 offset:11264
buffer_load_dwordx4 v1, s[8:11], s60 offen offset:3072 sc1 lds
v_mfma_f32_16x16x32_bf16 v[48:51], a[4:7], a[212:215], v[48:51]
ds_read_b128 a[48:51], v190 offset:12288
v_mfma_f32_16x16x32_bf16 v[52:55], a[8:11], a[208:211], v[52:55]
ds_read_b128 a[52:55], v190 offset:13312
v_mfma_f32_16x16x32_bf16 v[56:59], a[8:11], a[212:215], v[56:59]
ds_read_b128 a[56:59], v190 offset:14336
s_add_u32 m0, s62, 126976
v_mfma_f32_16x16x32_bf16 v[60:63], a[12:15], a[208:211], v[60:63]
ds_read_b128 a[60:63], v190 offset:15360
v_mfma_f32_16x16x32_bf16 v[64:67], a[12:15], a[212:215], v[64:67]
ds_read_b128 a[64:67], v190 offset:16384
v_mfma_f32_16x16x32_bf16 v[68:71], a[16:19], a[208:211], v[68:71]
ds_read_b128 a[68:71], v190 offset:17408
s_add_u32 s60, s60, 16384
v_mfma_f32_16x16x32_bf16 v[72:75], a[16:19], a[212:215], v[72:75]
v_exp_f32 v187, v187
v_mfma_f32_16x16x32_bf16 v[76:79], a[20:23], a[208:211], v[76:79]
v_exp_f32 v188, v188
v_mfma_f32_16x16x32_bf16 v[80:83], a[20:23], a[212:215], v[80:83]
buffer_load_dwordx4 v1, s[8:11], s60 offen offset:0 sc1 lds
v_mfma_f32_16x16x32_bf16 v[84:87], a[24:27], a[208:211], v[84:87]
v_exp_f32 v189, v189
v_mfma_f32_16x16x32_bf16 v[88:91], a[24:27], a[212:215], v[88:91]
v_fma_f32 v186, v186, v255, v255
v_fma_f32 v187, v187, v255, v255
v_mfma_f32_16x16x32_bf16 v[92:95], a[28:31], a[208:211], v[92:95]
buffer_load_dwordx4 v1, s[8:11], s60 offen offset:1024 sc1 lds
v_fma_f32 v188, v188, v255, v255
v_mfma_f32_16x16x32_bf16 v[96:99], a[28:31], a[212:215], v[96:99]
v_fma_f32 v189, v189, v255, v255
v_mfma_f32_16x16x32_bf16 v[100:103], a[32:35], a[208:211], v[100:103]
v_rcp_f32 v186, v186
v_mfma_f32_16x16x32_bf16 v[104:107], a[32:35], a[212:215], v[104:107]
s_waitcnt vmcnt(11)
s_waitcnt lgkmcnt(0)
s_barrier
v_mfma_f32_16x16x32_bf16 v[36:39], a[36:39], a[216:219], v[36:39]
ds_read_b128 a[0:3], v190 offset:18432
buffer_load_dwordx4 v1, s[8:11], s60 offen offset:2048 sc1 lds
v_mfma_f32_16x16x32_bf16 v[40:43], a[36:39], a[220:223], v[40:43]
ds_read_b128 a[4:7], v190 offset:19456
v_mfma_f32_16x16x32_bf16 v[44:47], a[40:43], a[216:219], v[44:47]
ds_read_b128 a[8:11], v190 offset:20480
buffer_load_dwordx4 v1, s[8:11], s60 offen offset:3072 sc1 lds
v_mfma_f32_16x16x32_bf16 v[48:51], a[40:43], a[220:223], v[48:51]
ds_read_b128 a[12:15], v190 offset:21504
v_mfma_f32_16x16x32_bf16 v[52:55], a[44:47], a[216:219], v[52:55]
ds_read_b128 a[16:19], v190 offset:22528
s_add_u32 m0, s63, 143360
v_mfma_f32_16x16x32_bf16 v[56:59], a[44:47], a[220:223], v[56:59]
ds_read_b128 a[20:23], v190 offset:23552
v_mfma_f32_16x16x32_bf16 v[60:63], a[48:51], a[216:219], v[60:63]
ds_read_b128 a[24:27], v190 offset:24576
s_add_u32 s61, s61, 36864
v_mfma_f32_16x16x32_bf16 v[64:67], a[48:51], a[220:223], v[64:67]
ds_read_b128 a[28:31], v190 offset:25600
v_mfma_f32_16x16x32_bf16 v[68:71], a[52:55], a[216:219], v[68:71]
ds_read_b128 a[32:35], v190 offset:26624
buffer_load_dwordx4 v1, s[8:11], s61 offen offset:0 sc1 lds
v_mfma_f32_16x16x32_bf16 v[72:75], a[52:55], a[220:223], v[72:75]
s_add_u32 m0, s62, 147456
v_rcp_f32 v187, v187
v_mfma_f32_16x16x32_bf16 v[76:79], a[56:59], a[216:219], v[76:79]
s_add_u32 s60, s60, 20480
v_rcp_f32 v188, v188
v_mfma_f32_16x16x32_bf16 v[80:83], a[56:59], a[220:223], v[80:83]
v_rcp_f32 v189, v189
v_mfma_f32_16x16x32_bf16 v[84:87], a[60:63], a[216:219], v[84:87]
v_mul_f32 v112, v112, v186
v_mul_f32 v113, v113, v187
v_mfma_f32_16x16x32_bf16 v[88:91], a[60:63], a[220:223], v[88:91]
v_mul_f32 v114, v114, v188
v_mul_f32 v115, v115, v189
v_mfma_f32_16x16x32_bf16 v[92:95], a[64:67], a[216:219], v[92:95]
buffer_load_dwordx4 v1, s[8:11], s60 offen offset:0 sc1 lds
v_mul_f32 v182, v116, v116
v_mfma_f32_16x16x32_bf16 v[96:99], a[64:67], a[220:223], v[96:99]
v_mul_f32 v183, v117, v117
v_mfma_f32_16x16x32_bf16 v[100:103], a[68:71], a[216:219], v[100:103]
v_mul_f32 v184, v118, v118
v_mfma_f32_16x16x32_bf16 v[104:107], a[68:71], a[220:223], v[104:107]
v_mul_f32 v185, v119, v119
s_waitcnt lgkmcnt(0)
v_mfma_f32_16x16x32_bf16 v[36:39], a[0:3], a[224:227], v[36:39]
ds_read_b128 a[36:39], v190 offset:27648
buffer_load_dwordx4 v1, s[8:11], s60 offen offset:1024 sc1 lds
v_mfma_f32_16x16x32_bf16 v[40:43], a[0:3], a[228:231], v[40:43]
ds_read_b128 a[40:43], v190 offset:28672
v_fma_f32 v182, v182, v254, v253
v_mfma_f32_16x16x32_bf16 v[44:47], a[4:7], a[224:227], v[44:47]
ds_read_b128 a[44:47], v190 offset:29696
v_fma_f32 v183, v183, v254, v253
v_mfma_f32_16x16x32_bf16 v[48:51], a[4:7], a[228:231], v[48:51]
ds_read_b128 a[48:51], v190 offset:30720
v_mfma_f32_16x16x32_bf16 v[52:55], a[8:11], a[224:227], v[52:55]
ds_read_b128 a[52:55], v190 offset:31744
buffer_load_dwordx4 v1, s[8:11], s60 offen offset:2048 sc1 lds
v_mfma_f32_16x16x32_bf16 v[56:59], a[8:11], a[228:231], v[56:59]
ds_read_b128 a[56:59], v190 offset:32768
v_fma_f32 v184, v184, v254, v253
v_mfma_f32_16x16x32_bf16 v[60:63], a[12:15], a[224:227], v[60:63]
ds_read_b128 a[60:63], v190 offset:33792
v_fma_f32 v185, v185, v254, v253
v_mfma_f32_16x16x32_bf16 v[64:67], a[12:15], a[228:231], v[64:67]
ds_read_b128 a[64:67], v190 offset:34816
v_mul_f32 v182, v182, v116
v_mfma_f32_16x16x32_bf16 v[68:71], a[16:19], a[224:227], v[68:71]
ds_read_b128 a[68:71], v190 offset:35840
buffer_load_dwordx4 v1, s[8:11], s60 offen offset:3072 sc1 lds
v_mfma_f32_16x16x32_bf16 v[72:75], a[16:19], a[228:231], v[72:75]
v_mul_f32 v183, v183, v117
v_mul_f32 v184, v184, v118
v_mfma_f32_16x16x32_bf16 v[76:79], a[20:23], a[224:227], v[76:79]
v_mfma_f32_16x16x32_bf16 v[80:83], a[20:23], a[228:231], v[80:83]
v_mul_f32 v185, v185, v119
v_mfma_f32_16x16x32_bf16 v[84:87], a[24:27], a[224:227], v[84:87]
buffer_load_dwordx4 a[144:147], v1, s[4:7], s52 offen offset:2048 sc1
v_mfma_f32_16x16x32_bf16 v[88:91], a[24:27], a[228:231], v[88:91]
v_exp_f32 v182, v182
v_mfma_f32_16x16x32_bf16 v[92:95], a[28:31], a[224:227], v[92:95]
v_mfma_f32_16x16x32_bf16 v[96:99], a[28:31], a[228:231], v[96:99]
v_exp_f32 v183, v183
v_mfma_f32_16x16x32_bf16 v[100:103], a[32:35], a[224:227], v[100:103]
v_mfma_f32_16x16x32_bf16 v[104:107], a[32:35], a[228:231], v[104:107]
s_waitcnt vmcnt(10)
s_waitcnt lgkmcnt(0)
s_barrier
v_mfma_f32_16x16x32_bf16 v[36:39], a[36:39], a[232:235], v[36:39]
ds_read_b128 a[0:3], v191 offset:0
buffer_load_dwordx4 a[148:151], v9, s[4:7], s52 offen offset:2048 sc1
v_mfma_f32_16x16x32_bf16 v[40:43], a[36:39], a[236:239], v[40:43]
ds_read_b128 a[4:7], v191 offset:1024
v_mfma_f32_16x16x32_bf16 v[44:47], a[40:43], a[232:235], v[44:47]
ds_read_b128 a[8:11], v191 offset:2048
buffer_load_dwordx4 a[152:155], v1, s[4:7], s52 offen offset:3072 sc1
v_mfma_f32_16x16x32_bf16 v[48:51], a[40:43], a[236:239], v[48:51]
ds_read_b128 a[12:15], v191 offset:3072
v_mfma_f32_16x16x32_bf16 v[52:55], a[44:47], a[232:235], v[52:55]
ds_read_b128 a[16:19], v191 offset:4096
v_mfma_f32_16x16x32_bf16 v[56:59], a[44:47], a[236:239], v[56:59]
ds_read_b128 a[20:23], v191 offset:5120
buffer_load_dwordx4 a[156:159], v9, s[4:7], s52 offen offset:3072 sc1
v_mfma_f32_16x16x32_bf16 v[60:63], a[48:51], a[232:235], v[60:63]
ds_read_b128 a[24:27], v191 offset:6144
v_mfma_f32_16x16x32_bf16 v[64:67], a[48:51], a[236:239], v[64:67]
ds_read_b128 a[28:31], v191 offset:7168
v_mfma_f32_16x16x32_bf16 v[68:71], a[52:55], a[232:235], v[68:71]
ds_read_b128 a[32:35], v191 offset:8192
s_add_u32 m0, s62, 53248
v_mfma_f32_16x16x32_bf16 v[72:75], a[52:55], a[236:239], v[72:75]
s_add_u32 s60, s60, 16384
v_exp_f32 v184, v184
v_mfma_f32_16x16x32_bf16 v[76:79], a[56:59], a[232:235], v[76:79]
v_exp_f32 v185, v185
v_mfma_f32_16x16x32_bf16 v[80:83], a[56:59], a[236:239], v[80:83]
v_fma_f32 v182, v182, v255, v255
v_fma_f32 v183, v183, v255, v255
v_mfma_f32_16x16x32_bf16 v[84:87], a[60:63], a[232:235], v[84:87]
v_fma_f32 v184, v184, v255, v255
v_fma_f32 v185, v185, v255, v255
v_mfma_f32_16x16x32_bf16 v[88:91], a[60:63], a[236:239], v[88:91]
v_rcp_f32 v182, v182
v_mfma_f32_16x16x32_bf16 v[92:95], a[64:67], a[232:235], v[92:95]
buffer_load_dwordx4 v1, s[8:11], s60 offen offset:0 sc1 lds
v_mfma_f32_16x16x32_bf16 v[96:99], a[64:67], a[236:239], v[96:99]
v_rcp_f32 v183, v183
v_mfma_f32_16x16x32_bf16 v[100:103], a[68:71], a[232:235], v[100:103]
v_mfma_f32_16x16x32_bf16 v[104:107], a[68:71], a[236:239], v[104:107]
s_waitcnt lgkmcnt(0)
v_mfma_f32_16x16x32_bf16 v[36:39], a[0:3], a[240:243], v[36:39]
ds_read_b128 a[36:39], v191 offset:9216
buffer_load_dwordx4 v1, s[8:11], s60 offen offset:1024 sc1 lds
v_mfma_f32_16x16x32_bf16 v[40:43], a[0:3], a[244:247], v[40:43]
ds_read_b128 a[40:43], v191 offset:10240
v_mfma_f32_16x16x32_bf16 v[44:47], a[4:7], a[240:243], v[44:47]
ds_read_b128 a[44:47], v191 offset:11264
buffer_load_dwordx4 v1, s[8:11], s60 offen offset:2048 sc1 lds
v_mfma_f32_16x16x32_bf16 v[48:51], a[4:7], a[244:247], v[48:51]
ds_read_b128 a[48:51], v191 offset:12288
v_mfma_f32_16x16x32_bf16 v[52:55], a[8:11], a[240:243], v[52:55]
ds_read_b128 a[52:55], v191 offset:13312
v_mfma_f32_16x16x32_bf16 v[56:59], a[8:11], a[244:247], v[56:59]
ds_read_b128 a[56:59], v191 offset:14336
buffer_load_dwordx4 v1, s[8:11], s60 offen offset:3072 sc1 lds
v_mfma_f32_16x16x32_bf16 v[60:63], a[12:15], a[240:243], v[60:63]
ds_read_b128 a[60:63], v191 offset:15360
v_mfma_f32_16x16x32_bf16 v[64:67], a[12:15], a[244:247], v[64:67]
ds_read_b128 a[64:67], v191 offset:16384
v_mfma_f32_16x16x32_bf16 v[68:71], a[16:19], a[240:243], v[68:71]
ds_read_b128 a[68:71], v191 offset:17408
s_add_u32 m0, s63, 69632
v_mfma_f32_16x16x32_bf16 v[72:75], a[16:19], a[244:247], v[72:75]
s_add_u32 s61, s61, 36864
v_rcp_f32 v184, v184
v_mfma_f32_16x16x32_bf16 v[76:79], a[20:23], a[240:243], v[76:79]
v_rcp_f32 v185, v185
v_mfma_f32_16x16x32_bf16 v[80:83], a[20:23], a[244:247], v[80:83]
v_mul_f32 v116, v116, v182
v_mul_f32 v117, v117, v183
v_mfma_f32_16x16x32_bf16 v[84:87], a[24:27], a[240:243], v[84:87]
v_mul_f32 v118, v118, v184
v_mul_f32 v119, v119, v185
v_mfma_f32_16x16x32_bf16 v[88:91], a[24:27], a[244:247], v[88:91]
v_permlane16_swap_b32 v108, v112
v_mfma_f32_16x16x32_bf16 v[92:95], a[28:31], a[240:243], v[92:95]
buffer_load_dwordx4 v1, s[8:11], s61 offen offset:0 sc1 lds
v_mfma_f32_16x16x32_bf16 v[96:99], a[28:31], a[244:247], v[96:99]
v_permlane16_swap_b32 v109, v113
v_mfma_f32_16x16x32_bf16 v[100:103], a[32:35], a[240:243], v[100:103]
v_mfma_f32_16x16x32_bf16 v[104:107], a[32:35], a[244:247], v[104:107]
s_waitcnt lgkmcnt(0)
v_mfma_f32_16x16x32_bf16 v[36:39], a[36:39], a[248:251], v[36:39]
ds_read_b128 a[0:3], v191 offset:18432
s_add_u32 m0, s62, 73728
v_mfma_f32_16x16x32_bf16 v[40:43], a[36:39], a[252:255], v[40:43]
ds_read_b128 a[4:7], v191 offset:19456
v_mfma_f32_16x16x32_bf16 v[44:47], a[40:43], a[248:251], v[44:47]
ds_read_b128 a[8:11], v191 offset:20480
s_add_u32 s60, s60, 20480
v_mfma_f32_16x16x32_bf16 v[48:51], a[40:43], a[252:255], v[48:51]
ds_read_b128 a[12:15], v191 offset:21504
v_mfma_f32_16x16x32_bf16 v[52:55], a[44:47], a[248:251], v[52:55]
ds_read_b128 a[16:19], v191 offset:22528
v_mfma_f32_16x16x32_bf16 v[56:59], a[44:47], a[252:255], v[56:59]
ds_read_b128 a[20:23], v191 offset:23552
buffer_load_dwordx4 v1, s[8:11], s60 offen offset:0 sc1 lds
v_mfma_f32_16x16x32_bf16 v[60:63], a[48:51], a[248:251], v[60:63]
ds_read_b128 a[24:27], v191 offset:24576
v_mfma_f32_16x16x32_bf16 v[64:67], a[48:51], a[252:255], v[64:67]
ds_read_b128 a[28:31], v191 offset:25600
v_mfma_f32_16x16x32_bf16 v[68:71], a[52:55], a[248:251], v[68:71]
ds_read_b128 a[32:35], v191 offset:26624
buffer_load_dwordx4 v1, s[8:11], s60 offen offset:1024 sc1 lds
v_mfma_f32_16x16x32_bf16 v[72:75], a[52:55], a[252:255], v[72:75]
v_permlane16_swap_b32 v110, v114
v_mfma_f32_16x16x32_bf16 v[76:79], a[56:59], a[248:251], v[76:79]
v_permlane16_swap_b32 v111, v115
v_mfma_f32_16x16x32_bf16 v[80:83], a[56:59], a[252:255], v[80:83]
buffer_load_dwordx4 v1, s[8:11], s60 offen offset:2048 sc1 lds
v_mul_f32 v186, v120, v120
v_mfma_f32_16x16x32_bf16 v[84:87], a[60:63], a[248:251], v[84:87]
v_mul_f32 v187, v121, v121
v_mul_f32 v188, v122, v122
v_mfma_f32_16x16x32_bf16 v[88:91], a[60:63], a[252:255], v[88:91]
v_mul_f32 v189, v123, v123
v_fma_f32 v186, v186, v254, v253
v_mfma_f32_16x16x32_bf16 v[92:95], a[64:67], a[248:251], v[92:95]
buffer_load_dwordx4 v1, s[8:11], s60 offen offset:3072 sc1 lds
v_fma_f32 v187, v187, v254, v253
v_mfma_f32_16x16x32_bf16 v[96:99], a[64:67], a[252:255], v[96:99]
v_fma_f32 v188, v188, v254, v253
v_fma_f32 v189, v189, v254, v253
v_mfma_f32_16x16x32_bf16 v[100:103], a[68:71], a[248:251], v[100:103]
v_mul_f32 v186, v186, v120
v_mfma_f32_16x16x32_bf16 v[104:107], a[68:71], a[252:255], v[104:107]
v_mul_f32 v187, v187, v121
s_waitcnt lgkmcnt(0)
v_mfma_f32_16x16x32_bf16 v[36:39], a[0:3], a[80:83], v[36:39]
ds_read_b128 a[36:39], v191 offset:27648
s_add_u32 s52, s52, 4096
v_mfma_f32_16x16x32_bf16 v[40:43], a[0:3], a[84:87], v[40:43]
ds_read_b128 a[40:43], v191 offset:28672
v_mul_f32 v188, v188, v122
v_mfma_f32_16x16x32_bf16 v[44:47], a[4:7], a[80:83], v[44:47]
ds_read_b128 a[44:47], v191 offset:29696
v_mul_f32 v189, v189, v123
v_mfma_f32_16x16x32_bf16 v[48:51], a[4:7], a[84:87], v[48:51]
ds_read_b128 a[48:51], v191 offset:30720
buffer_load_dwordx4 a[160:163], v1, s[4:7], s52 offen offset:0 sc1
v_mfma_f32_16x16x32_bf16 v[52:55], a[8:11], a[80:83], v[52:55]
ds_read_b128 a[52:55], v191 offset:31744
v_mfma_f32_16x16x32_bf16 v[56:59], a[8:11], a[84:87], v[56:59]
ds_read_b128 a[56:59], v191 offset:32768
v_mfma_f32_16x16x32_bf16 v[60:63], a[12:15], a[80:83], v[60:63]
ds_read_b128 a[60:63], v191 offset:33792
buffer_load_dwordx4 a[164:167], v9, s[4:7], s52 offen offset:0 sc1
v_mfma_f32_16x16x32_bf16 v[64:67], a[12:15], a[84:87], v[64:67]
ds_read_b128 a[64:67], v191 offset:34816
v_mfma_f32_16x16x32_bf16 v[68:71], a[16:19], a[80:83], v[68:71]
ds_read_b128 a[68:71], v191 offset:35840
v_mfma_f32_16x16x32_bf16 v[72:75], a[16:19], a[84:87], v[72:75]
v_exp_f32 v186, v186
v_mfma_f32_16x16x32_bf16 v[76:79], a[20:23], a[80:83], v[76:79]
buffer_load_dwordx4 a[168:171], v1, s[4:7], s52 offen offset:1024 sc1
v_mfma_f32_16x16x32_bf16 v[80:83], a[20:23], a[84:87], v[80:83]
v_exp_f32 v187, v187
v_mfma_f32_16x16x32_bf16 v[84:87], a[24:27], a[80:83], v[84:87]
v_exp_f32 v188, v188
v_mfma_f32_16x16x32_bf16 v[88:91], a[24:27], a[84:87], v[88:91]
buffer_load_dwordx4 a[172:175], v9, s[4:7], s52 offen offset:1024 sc1
v_mfma_f32_16x16x32_bf16 v[92:95], a[28:31], a[80:83], v[92:95]
v_exp_f32 v189, v189
v_mfma_f32_16x16x32_bf16 v[96:99], a[28:31], a[84:87], v[96:99]
v_fma_f32 v186, v186, v255, v255
v_mfma_f32_16x16x32_bf16 v[100:103], a[32:35], a[80:83], v[100:103]
v_mfma_f32_16x16x32_bf16 v[104:107], a[32:35], a[84:87], v[104:107]
s_waitcnt vmcnt(17)
s_waitcnt lgkmcnt(0)
s_barrier
v_mfma_f32_16x16x32_bf16 v[36:39], a[36:39], a[88:91], v[36:39]
ds_read_b128 a[0:3], v192 offset:0
s_add_u32 m0, s62, 90112
v_mfma_f32_16x16x32_bf16 v[40:43], a[36:39], a[92:95], v[40:43]
ds_read_b128 a[4:7], v192 offset:1024
v_fma_f32 v187, v187, v255, v255
v_mfma_f32_16x16x32_bf16 v[44:47], a[40:43], a[88:91], v[44:47]
ds_read_b128 a[8:11], v192 offset:2048
s_add_u32 s60, s60, 16384
v_mfma_f32_16x16x32_bf16 v[48:51], a[40:43], a[92:95], v[48:51]
ds_read_b128 a[12:15], v192 offset:3072
v_fma_f32 v188, v188, v255, v255
v_mfma_f32_16x16x32_bf16 v[52:55], a[44:47], a[88:91], v[52:55]
ds_read_b128 a[16:19], v192 offset:4096
v_fma_f32 v189, v189, v255, v255
v_mfma_f32_16x16x32_bf16 v[56:59], a[44:47], a[92:95], v[56:59]
ds_read_b128 a[20:23], v192 offset:5120
buffer_load_dwordx4 v1, s[8:11], s60 offen offset:0 sc1 lds
v_mfma_f32_16x16x32_bf16 v[60:63], a[48:51], a[88:91], v[60:63]
ds_read_b128 a[24:27], v192 offset:6144
v_mfma_f32_16x16x32_bf16 v[64:67], a[48:51], a[92:95], v[64:67]
ds_read_b128 a[28:31], v192 offset:7168
v_mfma_f32_16x16x32_bf16 v[68:71], a[52:55], a[88:91], v[68:71]
ds_read_b128 a[32:35], v192 offset:8192
buffer_load_dwordx4 v1, s[8:11], s60 offen offset:1024 sc1 lds
v_mfma_f32_16x16x32_bf16 v[72:75], a[52:55], a[92:95], v[72:75]
v_rcp_f32 v186, v186
v_mfma_f32_16x16x32_bf16 v[76:79], a[56:59], a[88:91], v[76:79]
v_rcp_f32 v187, v187
v_mfma_f32_16x16x32_bf16 v[80:83], a[56:59], a[92:95], v[80:83]
buffer_load_dwordx4 v1, s[8:11], s60 offen offset:2048 sc1 lds
v_mfma_f32_16x16x32_bf16 v[84:87], a[60:63], a[88:91], v[84:87]
v_rcp_f32 v188, v188
v_mfma_f32_16x16x32_bf16 v[88:91], a[60:63], a[92:95], v[88:91]
v_rcp_f32 v189, v189
v_mfma_f32_16x16x32_bf16 v[92:95], a[64:67], a[88:91], v[92:95]
buffer_load_dwordx4 v1, s[8:11], s60 offen offset:3072 sc1 lds
v_mul_f32 v120, v120, v186
v_mfma_f32_16x16x32_bf16 v[96:99], a[64:67], a[92:95], v[96:99]
v_mfma_f32_16x16x32_bf16 v[100:103], a[68:71], a[88:91], v[100:103]
v_mul_f32 v121, v121, v187
v_mfma_f32_16x16x32_bf16 v[104:107], a[68:71], a[92:95], v[104:107]
v_mul_f32 v122, v122, v188
s_waitcnt lgkmcnt(0)
v_mfma_f32_16x16x32_bf16 v[36:39], a[0:3], a[96:99], v[36:39]
ds_read_b128 a[36:39], v192 offset:9216
s_add_u32 m0, s63, 106496
v_mfma_f32_16x16x32_bf16 v[40:43], a[0:3], a[100:103], v[40:43]
ds_read_b128 a[40:43], v192 offset:10240
v_mul_f32 v123, v123, v189
v_mfma_f32_16x16x32_bf16 v[44:47], a[4:7], a[96:99], v[44:47]
ds_read_b128 a[44:47], v192 offset:11264
s_add_u32 s61, s61, 36864
v_mfma_f32_16x16x32_bf16 v[48:51], a[4:7], a[100:103], v[48:51]
ds_read_b128 a[48:51], v192 offset:12288
v_mul_f32 v182, v124, v124
v_mfma_f32_16x16x32_bf16 v[52:55], a[8:11], a[96:99], v[52:55]
ds_read_b128 a[52:55], v192 offset:13312
buffer_load_dwordx4 v1, s[8:11], s61 offen offset:0 sc1 lds
v_mfma_f32_16x16x32_bf16 v[56:59], a[8:11], a[100:103], v[56:59]
ds_read_b128 a[56:59], v192 offset:14336
v_mul_f32 v183, v125, v125
v_mfma_f32_16x16x32_bf16 v[60:63], a[12:15], a[96:99], v[60:63]
ds_read_b128 a[60:63], v192 offset:15360
s_add_u32 m0, s62, 110592
v_mfma_f32_16x16x32_bf16 v[64:67], a[12:15], a[100:103], v[64:67]
ds_read_b128 a[64:67], v192 offset:16384
v_mul_f32 v184, v126, v126
v_mfma_f32_16x16x32_bf16 v[68:71], a[16:19], a[96:99], v[68:71]
ds_read_b128 a[68:71], v192 offset:17408
s_add_u32 s60, s60, 20480
v_mfma_f32_16x16x32_bf16 v[72:75], a[16:19], a[100:103], v[72:75]
v_mul_f32 v185, v127, v127
v_fma_f32 v182, v182, v254, v253
v_mfma_f32_16x16x32_bf16 v[76:79], a[20:23], a[96:99], v[76:79]
buffer_load_dwordx4 v1, s[8:11], s60 offen offset:0 sc1 lds
v_fma_f32 v183, v183, v254, v253
v_mfma_f32_16x16x32_bf16 v[80:83], a[20:23], a[100:103], v[80:83]
v_fma_f32 v184, v184, v254, v253
v_mfma_f32_16x16x32_bf16 v[84:87], a[24:27], a[96:99], v[84:87]
buffer_load_dwordx4 v1, s[8:11], s60 offen offset:1024 sc1 lds
v_fma_f32 v185, v185, v254, v253
v_mfma_f32_16x16x32_bf16 v[88:91], a[24:27], a[100:103], v[88:91]
v_mfma_f32_16x16x32_bf16 v[92:95], a[28:31], a[96:99], v[92:95]
buffer_load_dwordx4 v1, s[8:11], s60 offen offset:2048 sc1 lds
v_mul_f32 v182, v182, v124
v_mfma_f32_16x16x32_bf16 v[96:99], a[28:31], a[100:103], v[96:99]
v_mul_f32 v183, v183, v125
v_mfma_f32_16x16x32_bf16 v[100:103], a[32:35], a[96:99], v[100:103]
v_mfma_f32_16x16x32_bf16 v[104:107], a[32:35], a[100:103], v[104:107]
s_waitcnt lgkmcnt(0)
v_mfma_f32_16x16x32_bf16 v[36:39], a[36:39], a[104:107], v[36:39]
ds_read_b128 a[0:3], v192 offset:18432
buffer_load_dwordx4 v1, s[8:11], s60 offen offset:3072 sc1 lds
v_mfma_f32_16x16x32_bf16 v[40:43], a[36:39], a[108:111], v[40:43]
ds_read_b128 a[4:7], v192 offset:19456
v_mul_f32 v184, v184, v126
v_mfma_f32_16x16x32_bf16 v[44:47], a[40:43], a[104:107], v[44:47]
ds_read_b128 a[8:11], v192 offset:20480
v_mul_f32 v185, v185, v127
v_mfma_f32_16x16x32_bf16 v[48:51], a[40:43], a[108:111], v[48:51]
ds_read_b128 a[12:15], v192 offset:21504
v_mfma_f32_16x16x32_bf16 v[52:55], a[44:47], a[104:107], v[52:55]
ds_read_b128 a[16:19], v192 offset:22528
buffer_load_dwordx4 a[176:179], v1, s[4:7], s52 offen offset:2048 sc1
v_mfma_f32_16x16x32_bf16 v[56:59], a[44:47], a[108:111], v[56:59]
ds_read_b128 a[20:23], v192 offset:23552
v_mfma_f32_16x16x32_bf16 v[60:63], a[48:51], a[104:107], v[60:63]
ds_read_b128 a[24:27], v192 offset:24576
v_mfma_f32_16x16x32_bf16 v[64:67], a[48:51], a[108:111], v[64:67]
ds_read_b128 a[28:31], v192 offset:25600
v_mfma_f32_16x16x32_bf16 v[68:71], a[52:55], a[104:107], v[68:71]
ds_read_b128 a[32:35], v192 offset:26624
buffer_load_dwordx4 a[180:183], v9, s[4:7], s52 offen offset:2048 sc1
v_mfma_f32_16x16x32_bf16 v[72:75], a[52:55], a[108:111], v[72:75]
v_exp_f32 v182, v182
v_mfma_f32_16x16x32_bf16 v[76:79], a[56:59], a[104:107], v[76:79]
v_exp_f32 v183, v183
v_mfma_f32_16x16x32_bf16 v[80:83], a[56:59], a[108:111], v[80:83]
v_exp_f32 v184, v184
v_mfma_f32_16x16x32_bf16 v[84:87], a[60:63], a[104:107], v[84:87]
buffer_load_dwordx4 a[184:187], v1, s[4:7], s52 offen offset:3072 sc1
v_mfma_f32_16x16x32_bf16 v[88:91], a[60:63], a[108:111], v[88:91]
v_exp_f32 v185, v185
v_mfma_f32_16x16x32_bf16 v[92:95], a[64:67], a[104:107], v[92:95]
v_fma_f32 v182, v182, v255, v255
v_fma_f32 v183, v183, v255, v255
v_mfma_f32_16x16x32_bf16 v[96:99], a[64:67], a[108:111], v[96:99]
v_mfma_f32_16x16x32_bf16 v[100:103], a[68:71], a[104:107], v[100:103]
v_fma_f32 v184, v184, v255, v255
v_mfma_f32_16x16x32_bf16 v[104:107], a[68:71], a[108:111], v[104:107]
v_fma_f32 v185, v185, v255, v255
s_waitcnt lgkmcnt(0)
v_mfma_f32_16x16x32_bf16 v[36:39], a[0:3], a[112:115], v[36:39]
ds_read_b128 a[36:39], v192 offset:27648
buffer_load_dwordx4 a[188:191], v9, s[4:7], s52 offen offset:3072 sc1
v_mfma_f32_16x16x32_bf16 v[40:43], a[0:3], a[116:119], v[40:43]
ds_read_b128 a[40:43], v192 offset:28672
v_mfma_f32_16x16x32_bf16 v[44:47], a[4:7], a[112:115], v[44:47]
ds_read_b128 a[44:47], v192 offset:29696
v_mfma_f32_16x16x32_bf16 v[48:51], a[4:7], a[116:119], v[48:51]
ds_read_b128 a[48:51], v192 offset:30720
s_add_u32 s52, s52, 4096
v_mfma_f32_16x16x32_bf16 v[52:55], a[8:11], a[112:115], v[52:55]
ds_read_b128 a[52:55], v192 offset:31744
v_mfma_f32_16x16x32_bf16 v[56:59], a[8:11], a[116:119], v[56:59]
ds_read_b128 a[56:59], v192 offset:32768
v_mfma_f32_16x16x32_bf16 v[60:63], a[12:15], a[112:115], v[60:63]
ds_read_b128 a[60:63], v192 offset:33792
buffer_load_dwordx4 a[192:195], v1, s[4:7], s52 offen offset:0 sc1
v_mfma_f32_16x16x32_bf16 v[64:67], a[12:15], a[116:119], v[64:67]
ds_read_b128 a[64:67], v192 offset:34816
v_mfma_f32_16x16x32_bf16 v[68:71], a[16:19], a[112:115], v[68:71]
ds_read_b128 a[68:71], v192 offset:35840
v_mfma_f32_16x16x32_bf16 v[72:75], a[16:19], a[116:119], v[72:75]
v_rcp_f32 v182, v182
v_mfma_f32_16x16x32_bf16 v[76:79], a[20:23], a[112:115], v[76:79]
buffer_load_dwordx4 a[196:199], v9, s[4:7], s52 offen offset:0 sc1
v_mfma_f32_16x16x32_bf16 v[80:83], a[20:23], a[116:119], v[80:83]
v_rcp_f32 v183, v183
v_mfma_f32_16x16x32_bf16 v[84:87], a[24:27], a[112:115], v[84:87]
v_rcp_f32 v184, v184
v_mfma_f32_16x16x32_bf16 v[88:91], a[24:27], a[116:119], v[88:91]
buffer_load_dwordx4 a[200:203], v1, s[4:7], s52 offen offset:1024 sc1
v_mfma_f32_16x16x32_bf16 v[92:95], a[28:31], a[112:115], v[92:95]
v_rcp_f32 v185, v185
v_mfma_f32_16x16x32_bf16 v[96:99], a[28:31], a[116:119], v[96:99]
v_mul_f32 v124, v124, v182
v_mul_f32 v125, v125, v183
v_mfma_f32_16x16x32_bf16 v[100:103], a[32:35], a[112:115], v[100:103]
v_mul_f32 v126, v126, v184
v_mul_f32 v127, v127, v185
v_mfma_f32_16x16x32_bf16 v[104:107], a[32:35], a[116:119], v[104:107]
s_waitcnt vmcnt(20)
s_waitcnt lgkmcnt(0)
s_barrier
v_mfma_f32_16x16x32_bf16 v[36:39], a[36:39], a[120:123], v[36:39]
ds_read_b128 a[0:3], v190 offset:0
buffer_load_dwordx4 a[204:207], v9, s[4:7], s52 offen offset:1024 sc1
v_mfma_f32_16x16x32_bf16 v[40:43], a[36:39], a[124:127], v[40:43]
ds_read_b128 a[4:7], v190 offset:1024
v_mfma_f32_16x16x32_bf16 v[44:47], a[40:43], a[120:123], v[44:47]
ds_read_b128 a[8:11], v190 offset:2048
s_add_u32 m0, s62, 126976
v_mfma_f32_16x16x32_bf16 v[48:51], a[40:43], a[124:127], v[48:51]
ds_read_b128 a[12:15], v190 offset:3072
v_mfma_f32_16x16x32_bf16 v[52:55], a[44:47], a[120:123], v[52:55]
ds_read_b128 a[16:19], v190 offset:4096
v_mfma_f32_16x16x32_bf16 v[56:59], a[44:47], a[124:127], v[56:59]
ds_read_b128 a[20:23], v190 offset:5120
s_add_u32 s60, s60, 16384
v_mfma_f32_16x16x32_bf16 v[60:63], a[48:51], a[120:123], v[60:63]
ds_read_b128 a[24:27], v190 offset:6144
v_mfma_f32_16x16x32_bf16 v[64:67], a[48:51], a[124:127], v[64:67]
ds_read_b128 a[28:31], v190 offset:7168
v_mfma_f32_16x16x32_bf16 v[68:71], a[52:55], a[120:123], v[68:71]
ds_read_b128 a[32:35], v190 offset:8192
buffer_load_dwordx4 v1, s[8:11], s60 offen offset:0 sc1 lds
v_mfma_f32_16x16x32_bf16 v[72:75], a[52:55], a[124:127], v[72:75]
v_permlane16_swap_b32 v116, v120
v_mfma_f32_16x16x32_bf16 v[76:79], a[56:59], a[120:123], v[76:79]
v_permlane16_swap_b32 v117, v121
v_mfma_f32_16x16x32_bf16 v[80:83], a[56:59], a[124:127], v[80:83]
buffer_load_dwordx4 v1, s[8:11], s60 offen offset:1024 sc1 lds
v_mfma_f32_16x16x32_bf16 v[84:87], a[60:63], a[120:123], v[84:87]
v_permlane16_swap_b32 v118, v122
v_mfma_f32_16x16x32_bf16 v[88:91], a[60:63], a[124:127], v[88:91]
v_permlane16_swap_b32 v119, v123
v_mfma_f32_16x16x32_bf16 v[92:95], a[64:67], a[120:123], v[92:95]
buffer_load_dwordx4 v1, s[8:11], s60 offen offset:2048 sc1 lds
v_mul_f32 v186, v128, v128
v_mfma_f32_16x16x32_bf16 v[96:99], a[64:67], a[124:127], v[96:99]
v_mul_f32 v187, v129, v129
v_mul_f32 v188, v130, v130
v_mfma_f32_16x16x32_bf16 v[100:103], a[68:71], a[120:123], v[100:103]
v_mul_f32 v189, v131, v131
v_mfma_f32_16x16x32_bf16 v[104:107], a[68:71], a[124:127], v[104:107]
v_fma_f32 v186, v186, v254, v253
s_waitcnt lgkmcnt(0)
v_mfma_f32_16x16x32_bf16 v[36:39], a[0:3], a[128:131], v[36:39]
ds_read_b128 a[36:39], v190 offset:9216
buffer_load_dwordx4 v1, s[8:11], s60 offen offset:3072 sc1 lds
v_mfma_f32_16x16x32_bf16 v[40:43], a[0:3], a[132:135], v[40:43]
ds_read_b128 a[40:43], v190 offset:10240
v_fma_f32 v187, v187, v254, v253
v_mfma_f32_16x16x32_bf16 v[44:47], a[4:7], a[128:131], v[44:47]
ds_read_b128 a[44:47], v190 offset:11264
s_add_u32 m0, s63, 143360
v_mfma_f32_16x16x32_bf16 v[48:51], a[4:7], a[132:135], v[48:51]
ds_read_b128 a[48:51], v190 offset:12288
v_fma_f32 v188, v188, v254, v253
v_mfma_f32_16x16x32_bf16 v[52:55], a[8:11], a[128:131], v[52:55]
ds_read_b128 a[52:55], v190 offset:13312
s_add_u32 s61, s61, 36864
v_mfma_f32_16x16x32_bf16 v[56:59], a[8:11], a[132:135], v[56:59]
ds_read_b128 a[56:59], v190 offset:14336
v_fma_f32 v189, v189, v254, v253
v_mfma_f32_16x16x32_bf16 v[60:63], a[12:15], a[128:131], v[60:63]
ds_read_b128 a[60:63], v190 offset:15360
buffer_load_dwordx4 v1, s[8:11], s61 offen offset:0 sc1 lds
v_mfma_f32_16x16x32_bf16 v[64:67], a[12:15], a[132:135], v[64:67]
ds_read_b128 a[64:67], v190 offset:16384
v_mul_f32 v186, v186, v128
v_mfma_f32_16x16x32_bf16 v[68:71], a[16:19], a[128:131], v[68:71]
ds_read_b128 a[68:71], v190 offset:17408
s_add_u32 m0, s62, 147456
v_mfma_f32_16x16x32_bf16 v[72:75], a[16:19], a[132:135], v[72:75]
s_add_u32 s60, s60, 20480
v_mul_f32 v187, v187, v129
v_mul_f32 v188, v188, v130
v_mfma_f32_16x16x32_bf16 v[76:79], a[20:23], a[128:131], v[76:79]
v_mul_f32 v189, v189, v131
v_mfma_f32_16x16x32_bf16 v[80:83], a[20:23], a[132:135], v[80:83]
v_exp_f32 v186, v186
v_mfma_f32_16x16x32_bf16 v[84:87], a[24:27], a[128:131], v[84:87]
buffer_load_dwordx4 v1, s[8:11], s60 offen offset:0 sc1 lds
v_mfma_f32_16x16x32_bf16 v[88:91], a[24:27], a[132:135], v[88:91]
v_mfma_f32_16x16x32_bf16 v[92:95], a[28:31], a[128:131], v[92:95]
buffer_load_dwordx4 v1, s[8:11], s60 offen offset:1024 sc1 lds
v_mfma_f32_16x16x32_bf16 v[96:99], a[28:31], a[132:135], v[96:99]
v_exp_f32 v187, v187
v_mfma_f32_16x16x32_bf16 v[100:103], a[32:35], a[128:131], v[100:103]
v_exp_f32 v188, v188
v_mfma_f32_16x16x32_bf16 v[104:107], a[32:35], a[132:135], v[104:107]
s_waitcnt lgkmcnt(0)
v_mfma_f32_16x16x32_bf16 v[36:39], a[36:39], a[136:139], v[36:39]
ds_read_b128 a[0:3], v190 offset:18432
buffer_load_dwordx4 v1, s[8:11], s60 offen offset:2048 sc1 lds
v_mfma_f32_16x16x32_bf16 v[40:43], a[36:39], a[140:143], v[40:43]
ds_read_b128 a[4:7], v190 offset:19456
v_mfma_f32_16x16x32_bf16 v[44:47], a[40:43], a[136:139], v[44:47]
ds_read_b128 a[8:11], v190 offset:20480
v_mfma_f32_16x16x32_bf16 v[48:51], a[40:43], a[140:143], v[48:51]
ds_read_b128 a[12:15], v190 offset:21504
v_mfma_f32_16x16x32_bf16 v[52:55], a[44:47], a[136:139], v[52:55]
ds_read_b128 a[16:19], v190 offset:22528
buffer_load_dwordx4 v1, s[8:11], s60 offen offset:3072 sc1 lds
v_mfma_f32_16x16x32_bf16 v[56:59], a[44:47], a[140:143], v[56:59]
ds_read_b128 a[20:23], v190 offset:23552
v_mfma_f32_16x16x32_bf16 v[60:63], a[48:51], a[136:139], v[60:63]
ds_read_b128 a[24:27], v190 offset:24576
v_mfma_f32_16x16x32_bf16 v[64:67], a[48:51], a[140:143], v[64:67]
ds_read_b128 a[28:31], v190 offset:25600
v_mfma_f32_16x16x32_bf16 v[68:71], a[52:55], a[136:139], v[68:71]
ds_read_b128 a[32:35], v190 offset:26624
buffer_load_dwordx4 a[208:211], v1, s[4:7], s52 offen offset:2048 sc1
v_mfma_f32_16x16x32_bf16 v[72:75], a[52:55], a[140:143], v[72:75]
v_exp_f32 v189, v189
v_mfma_f32_16x16x32_bf16 v[76:79], a[56:59], a[136:139], v[76:79]
v_fma_f32 v186, v186, v255, v255
v_fma_f32 v187, v187, v255, v255
v_mfma_f32_16x16x32_bf16 v[80:83], a[56:59], a[140:143], v[80:83]
v_fma_f32 v188, v188, v255, v255
v_fma_f32 v189, v189, v255, v255
v_mfma_f32_16x16x32_bf16 v[84:87], a[60:63], a[136:139], v[84:87]
buffer_load_dwordx4 a[212:215], v9, s[4:7], s52 offen offset:2048 sc1
v_mfma_f32_16x16x32_bf16 v[88:91], a[60:63], a[140:143], v[88:91]
v_rcp_f32 v186, v186
v_mfma_f32_16x16x32_bf16 v[92:95], a[64:67], a[136:139], v[92:95]
v_rcp_f32 v187, v187
v_mfma_f32_16x16x32_bf16 v[96:99], a[64:67], a[140:143], v[96:99]
v_mfma_f32_16x16x32_bf16 v[100:103], a[68:71], a[136:139], v[100:103]
v_rcp_f32 v188, v188
v_mfma_f32_16x16x32_bf16 v[104:107], a[68:71], a[140:143], v[104:107]
s_waitcnt lgkmcnt(0)
v_mfma_f32_16x16x32_bf16 v[36:39], a[0:3], a[144:147], v[36:39]
ds_read_b128 a[36:39], v190 offset:27648
buffer_load_dwordx4 a[216:219], v1, s[4:7], s52 offen offset:3072 sc1
v_mfma_f32_16x16x32_bf16 v[40:43], a[0:3], a[148:151], v[40:43]
ds_read_b128 a[40:43], v190 offset:28672
v_mfma_f32_16x16x32_bf16 v[44:47], a[4:7], a[144:147], v[44:47]
ds_read_b128 a[44:47], v190 offset:29696
v_mfma_f32_16x16x32_bf16 v[48:51], a[4:7], a[148:151], v[48:51]
ds_read_b128 a[48:51], v190 offset:30720
buffer_load_dwordx4 a[220:223], v9, s[4:7], s52 offen offset:3072 sc1
v_mfma_f32_16x16x32_bf16 v[52:55], a[8:11], a[144:147], v[52:55]
ds_read_b128 a[52:55], v190 offset:31744
v_mfma_f32_16x16x32_bf16 v[56:59], a[8:11], a[148:151], v[56:59]
ds_read_b128 a[56:59], v190 offset:32768
v_mfma_f32_16x16x32_bf16 v[60:63], a[12:15], a[144:147], v[60:63]
ds_read_b128 a[60:63], v190 offset:33792
s_add_u32 s52, s52, 4096
v_mfma_f32_16x16x32_bf16 v[64:67], a[12:15], a[148:151], v[64:67]
ds_read_b128 a[64:67], v190 offset:34816
v_mfma_f32_16x16x32_bf16 v[68:71], a[16:19], a[144:147], v[68:71]
ds_read_b128 a[68:71], v190 offset:35840
v_mfma_f32_16x16x32_bf16 v[72:75], a[16:19], a[148:151], v[72:75]
v_rcp_f32 v189, v189
v_mfma_f32_16x16x32_bf16 v[76:79], a[20:23], a[144:147], v[76:79]
buffer_load_dwordx4 a[224:227], v1, s[4:7], s52 offen offset:0 sc1
v_mul_f32 v128, v128, v186
v_mfma_f32_16x16x32_bf16 v[80:83], a[20:23], a[148:151], v[80:83]
v_mul_f32 v129, v129, v187
v_mul_f32 v130, v130, v188
v_mfma_f32_16x16x32_bf16 v[84:87], a[24:27], a[144:147], v[84:87]
v_mul_f32 v131, v131, v189
v_mul_f32 v182, v132, v132
v_mfma_f32_16x16x32_bf16 v[88:91], a[24:27], a[148:151], v[88:91]
buffer_load_dwordx4 a[228:231], v9, s[4:7], s52 offen offset:0 sc1
v_mul_f32 v183, v133, v133
v_mfma_f32_16x16x32_bf16 v[92:95], a[28:31], a[144:147], v[92:95]
v_mul_f32 v184, v134, v134
v_mul_f32 v185, v135, v135
v_mfma_f32_16x16x32_bf16 v[96:99], a[28:31], a[148:151], v[96:99]
v_fma_f32 v182, v182, v254, v253
v_mfma_f32_16x16x32_bf16 v[100:103], a[32:35], a[144:147], v[100:103]
v_fma_f32 v183, v183, v254, v253
v_mfma_f32_16x16x32_bf16 v[104:107], a[32:35], a[148:151], v[104:107]
s_waitcnt vmcnt(23)
s_waitcnt lgkmcnt(0)
s_barrier
v_mfma_f32_16x16x32_bf16 v[36:39], a[36:39], a[152:155], v[36:39]
ds_read_b128 a[0:3], v191 offset:0
buffer_load_dwordx4 a[232:235], v1, s[4:7], s52 offen offset:1024 sc1
v_mfma_f32_16x16x32_bf16 v[40:43], a[36:39], a[156:159], v[40:43]
ds_read_b128 a[4:7], v191 offset:1024
v_fma_f32 v184, v184, v254, v253
v_mfma_f32_16x16x32_bf16 v[44:47], a[40:43], a[152:155], v[44:47]
ds_read_b128 a[8:11], v191 offset:2048
buffer_load_dwordx4 a[236:239], v9, s[4:7], s52 offen offset:1024 sc1
v_mfma_f32_16x16x32_bf16 v[48:51], a[40:43], a[156:159], v[48:51]
ds_read_b128 a[12:15], v191 offset:3072
v_fma_f32 v185, v185, v254, v253
v_mfma_f32_16x16x32_bf16 v[52:55], a[44:47], a[152:155], v[52:55]
ds_read_b128 a[16:19], v191 offset:4096
v_mul_f32 v182, v182, v132
v_mfma_f32_16x16x32_bf16 v[56:59], a[44:47], a[156:159], v[56:59]
ds_read_b128 a[20:23], v191 offset:5120
s_add_u32 m0, s62, 53248
v_mfma_f32_16x16x32_bf16 v[60:63], a[48:51], a[152:155], v[60:63]
ds_read_b128 a[24:27], v191 offset:6144
v_mul_f32 v183, v183, v133
v_mfma_f32_16x16x32_bf16 v[64:67], a[48:51], a[156:159], v[64:67]
ds_read_b128 a[28:31], v191 offset:7168
v_mul_f32 v184, v184, v134
v_mfma_f32_16x16x32_bf16 v[68:71], a[52:55], a[152:155], v[68:71]
ds_read_b128 a[32:35], v191 offset:8192
s_add_u32 s60, s60, 16384
v_mfma_f32_16x16x32_bf16 v[72:75], a[52:55], a[156:159], v[72:75]
v_mul_f32 v185, v185, v135
v_mfma_f32_16x16x32_bf16 v[76:79], a[56:59], a[152:155], v[76:79]
v_exp_f32 v182, v182
v_mfma_f32_16x16x32_bf16 v[80:83], a[56:59], a[156:159], v[80:83]
buffer_load_dwordx4 v1, s[8:11], s60 offen offset:0 sc1 lds
v_mfma_f32_16x16x32_bf16 v[84:87], a[60:63], a[152:155], v[84:87]
v_exp_f32 v183, v183
v_mfma_f32_16x16x32_bf16 v[88:91], a[60:63], a[156:159], v[88:91]
v_mfma_f32_16x16x32_bf16 v[92:95], a[64:67], a[152:155], v[92:95]
buffer_load_dwordx4 v1, s[8:11], s60 offen offset:1024 sc1 lds
v_mfma_f32_16x16x32_bf16 v[96:99], a[64:67], a[156:159], v[96:99]
v_exp_f32 v184, v184
v_mfma_f32_16x16x32_bf16 v[100:103], a[68:71], a[152:155], v[100:103]
v_mfma_f32_16x16x32_bf16 v[104:107], a[68:71], a[156:159], v[104:107]
s_waitcnt lgkmcnt(0)
v_mfma_f32_16x16x32_bf16 v[36:39], a[0:3], a[160:163], v[36:39]
ds_read_b128 a[36:39], v191 offset:9216
buffer_load_dwordx4 v1, s[8:11], s60 offen offset:2048 sc1 lds
v_mfma_f32_16x16x32_bf16 v[40:43], a[0:3], a[164:167], v[40:43]
ds_read_b128 a[40:43], v191 offset:10240
v_mfma_f32_16x16x32_bf16 v[44:47], a[4:7], a[160:163], v[44:47]
ds_read_b128 a[44:47], v191 offset:11264
buffer_load_dwordx4 v1, s[8:11], s60 offen offset:3072 sc1 lds
v_mfma_f32_16x16x32_bf16 v[48:51], a[4:7], a[164:167], v[48:51]
ds_read_b128 a[48:51], v191 offset:12288
v_mfma_f32_16x16x32_bf16 v[52:55], a[8:11], a[160:163], v[52:55]
ds_read_b128 a[52:55], v191 offset:13312
s_add_u32 m0, s63, 69632
v_mfma_f32_16x16x32_bf16 v[56:59], a[8:11], a[164:167], v[56:59]
ds_read_b128 a[56:59], v191 offset:14336
v_mfma_f32_16x16x32_bf16 v[60:63], a[12:15], a[160:163], v[60:63]
ds_read_b128 a[60:63], v191 offset:15360
s_add_u32 s61, s61, 36864
v_mfma_f32_16x16x32_bf16 v[64:67], a[12:15], a[164:167], v[64:67]
ds_read_b128 a[64:67], v191 offset:16384
v_mfma_f32_16x16x32_bf16 v[68:71], a[16:19], a[160:163], v[68:71]
ds_read_b128 a[68:71], v191 offset:17408
buffer_load_dwordx4 v1, s[8:11], s61 offen offset:0 sc1 lds
v_mfma_f32_16x16x32_bf16 v[72:75], a[16:19], a[164:167], v[72:75]
s_add_u32 m0, s62, 73728
v_exp_f32 v185, v185
v_mfma_f32_16x16x32_bf16 v[76:79], a[20:23], a[160:163], v[76:79]
s_add_u32 s60, s60, 20480
v_fma_f32 v182, v182, v255, v255
v_fma_f32 v183, v183, v255, v255
v_mfma_f32_16x16x32_bf16 v[80:83], a[20:23], a[164:167], v[80:83]
v_fma_f32 v184, v184, v255, v255
v_fma_f32 v185, v185, v255, v255
v_mfma_f32_16x16x32_bf16 v[84:87], a[24:27], a[160:163], v[84:87]
v_rcp_f32 v182, v182
v_mfma_f32_16x16x32_bf16 v[88:91], a[24:27], a[164:167], v[88:91]
v_rcp_f32 v183, v183
v_mfma_f32_16x16x32_bf16 v[92:95], a[28:31], a[160:163], v[92:95]
buffer_load_dwordx4 v1, s[8:11], s60 offen offset:0 sc1 lds
v_mfma_f32_16x16x32_bf16 v[96:99], a[28:31], a[164:167], v[96:99]
v_rcp_f32 v184, v184
v_mfma_f32_16x16x32_bf16 v[100:103], a[32:35], a[160:163], v[100:103]
v_rcp_f32 v185, v185
v_mfma_f32_16x16x32_bf16 v[104:107], a[32:35], a[164:167], v[104:107]
s_waitcnt vmcnt(27)
s_waitcnt lgkmcnt(0)
v_mfma_f32_16x16x32_bf16 v[36:39], a[36:39], a[168:171], v[36:39]
ds_read_b128 a[0:3], v191 offset:18432
buffer_load_dwordx4 v1, s[8:11], s60 offen offset:1024 sc1 lds
v_mfma_f32_16x16x32_bf16 v[40:43], a[36:39], a[172:175], v[40:43]
ds_read_b128 a[4:7], v191 offset:19456
v_mul_f32 v132, v132, v182
v_mfma_f32_16x16x32_bf16 v[44:47], a[40:43], a[168:171], v[44:47]
ds_read_b128 a[8:11], v191 offset:20480
v_mfma_f32_16x16x32_bf16 v[48:51], a[40:43], a[172:175], v[48:51]
ds_read_b128 a[12:15], v191 offset:21504
v_mul_f32 v133, v133, v183
v_mfma_f32_16x16x32_bf16 v[52:55], a[44:47], a[168:171], v[52:55]
ds_read_b128 a[16:19], v191 offset:22528
buffer_load_dwordx4 v1, s[8:11], s60 offen offset:2048 sc1 lds
v_mfma_f32_16x16x32_bf16 v[56:59], a[44:47], a[172:175], v[56:59]
ds_read_b128 a[20:23], v191 offset:23552
v_mul_f32 v134, v134, v184
v_mfma_f32_16x16x32_bf16 v[60:63], a[48:51], a[168:171], v[60:63]
ds_read_b128 a[24:27], v191 offset:24576
v_mul_f32 v135, v135, v185
v_mfma_f32_16x16x32_bf16 v[64:67], a[48:51], a[172:175], v[64:67]
ds_read_b128 a[28:31], v191 offset:25600
v_mfma_f32_16x16x32_bf16 v[68:71], a[52:55], a[168:171], v[68:71]
ds_read_b128 a[32:35], v191 offset:26624
buffer_load_dwordx4 v1, s[8:11], s60 offen offset:3072 sc1 lds
v_mfma_f32_16x16x32_bf16 v[72:75], a[52:55], a[172:175], v[72:75]
v_permlane16_swap_b32 v124, v128
v_mfma_f32_16x16x32_bf16 v[76:79], a[56:59], a[168:171], v[76:79]
v_permlane16_swap_b32 v125, v129
v_mfma_f32_16x16x32_bf16 v[80:83], a[56:59], a[172:175], v[80:83]
v_mfma_f32_16x16x32_bf16 v[84:87], a[60:63], a[168:171], v[84:87]
buffer_load_dwordx4 a[240:243], v1, s[4:7], s52 offen offset:2048 sc1
v_mfma_f32_16x16x32_bf16 v[88:91], a[60:63], a[172:175], v[88:91]
v_permlane16_swap_b32 v126, v130
v_mfma_f32_16x16x32_bf16 v[92:95], a[64:67], a[168:171], v[92:95]
v_mfma_f32_16x16x32_bf16 v[96:99], a[64:67], a[172:175], v[96:99]
v_mfma_f32_16x16x32_bf16 v[100:103], a[68:71], a[168:171], v[100:103]
v_permlane16_swap_b32 v127, v131
v_mfma_f32_16x16x32_bf16 v[104:107], a[68:71], a[172:175], v[104:107]
s_waitcnt lgkmcnt(0)
v_mfma_f32_16x16x32_bf16 v[36:39], a[0:3], a[176:179], v[36:39]
ds_read_b128 a[36:39], v191 offset:27648
buffer_load_dwordx4 a[244:247], v9, s[4:7], s52 offen offset:2048 sc1
v_mfma_f32_16x16x32_bf16 v[40:43], a[0:3], a[180:183], v[40:43]
ds_read_b128 a[40:43], v191 offset:28672
v_mul_f32 v186, v136, v136
v_mfma_f32_16x16x32_bf16 v[44:47], a[4:7], a[176:179], v[44:47]
ds_read_b128 a[44:47], v191 offset:29696
v_mul_f32 v187, v137, v137
v_mfma_f32_16x16x32_bf16 v[48:51], a[4:7], a[180:183], v[48:51]
ds_read_b128 a[48:51], v191 offset:30720
buffer_load_dwordx4 a[248:251], v1, s[4:7], s52 offen offset:3072 sc1
v_mfma_f32_16x16x32_bf16 v[52:55], a[8:11], a[176:179], v[52:55]
ds_read_b128 a[52:55], v191 offset:31744
v_mul_f32 v188, v138, v138
v_mfma_f32_16x16x32_bf16 v[56:59], a[8:11], a[180:183], v[56:59]
ds_read_b128 a[56:59], v191 offset:32768
v_mul_f32 v189, v139, v139
v_mfma_f32_16x16x32_bf16 v[60:63], a[12:15], a[176:179], v[60:63]
ds_read_b128 a[60:63], v191 offset:33792
buffer_load_dwordx4 a[252:255], v9, s[4:7], s52 offen offset:3072 sc1
v_mfma_f32_16x16x32_bf16 v[64:67], a[12:15], a[180:183], v[64:67]
ds_read_b128 a[64:67], v191 offset:34816
v_fma_f32 v186, v186, v254, v253
v_mfma_f32_16x16x32_bf16 v[68:71], a[16:19], a[176:179], v[68:71]
ds_read_b128 a[68:71], v191 offset:35840
v_fma_f32 v187, v187, v254, v253
v_mfma_f32_16x16x32_bf16 v[72:75], a[16:19], a[180:183], v[72:75]
s_add_u32 s52, s52, 4096
v_fma_f32 v188, v188, v254, v253
v_mfma_f32_16x16x32_bf16 v[76:79], a[20:23], a[176:179], v[76:79]
v_mfma_f32_16x16x32_bf16 v[80:83], a[20:23], a[180:183], v[80:83]
v_fma_f32 v189, v189, v254, v253
v_mfma_f32_16x16x32_bf16 v[84:87], a[24:27], a[176:179], v[84:87]
v_mul_f32 v186, v186, v136
v_mfma_f32_16x16x32_bf16 v[88:91], a[24:27], a[180:183], v[88:91]
buffer_load_dwordx4 a[80:83], v1, s[4:7], s52 offen offset:0 sc1
v_mul_f32 v187, v187, v137
v_mfma_f32_16x16x32_bf16 v[92:95], a[28:31], a[176:179], v[92:95]
v_mfma_f32_16x16x32_bf16 v[96:99], a[28:31], a[180:183], v[96:99]
v_mul_f32 v188, v188, v138
v_mfma_f32_16x16x32_bf16 v[100:103], a[32:35], a[176:179], v[100:103]
v_mul_f32 v189, v189, v139
v_mfma_f32_16x16x32_bf16 v[104:107], a[32:35], a[180:183], v[104:107]
s_waitcnt vmcnt(22)
s_waitcnt lgkmcnt(0)
s_barrier
v_mfma_f32_16x16x32_bf16 v[36:39], a[36:39], a[184:187], v[36:39]
ds_read_b128 a[0:3], v192 offset:0
buffer_load_dwordx4 a[84:87], v9, s[4:7], s52 offen offset:0 sc1
v_mfma_f32_16x16x32_bf16 v[40:43], a[36:39], a[188:191], v[40:43]
ds_read_b128 a[4:7], v192 offset:1024
v_mfma_f32_16x16x32_bf16 v[44:47], a[40:43], a[184:187], v[44:47]
ds_read_b128 a[8:11], v192 offset:2048
buffer_load_dwordx4 a[88:91], v1, s[4:7], s52 offen offset:1024 sc1
v_mfma_f32_16x16x32_bf16 v[48:51], a[40:43], a[188:191], v[48:51]
ds_read_b128 a[12:15], v192 offset:3072
v_mfma_f32_16x16x32_bf16 v[52:55], a[44:47], a[184:187], v[52:55]
ds_read_b128 a[16:19], v192 offset:4096
v_mfma_f32_16x16x32_bf16 v[56:59], a[44:47], a[188:191], v[56:59]
ds_read_b128 a[20:23], v192 offset:5120
buffer_load_dwordx4 a[92:95], v9, s[4:7], s52 offen offset:1024 sc1
v_mfma_f32_16x16x32_bf16 v[60:63], a[48:51], a[184:187], v[60:63]
ds_read_b128 a[24:27], v192 offset:6144
v_mfma_f32_16x16x32_bf16 v[64:67], a[48:51], a[188:191], v[64:67]
ds_read_b128 a[28:31], v192 offset:7168
v_mfma_f32_16x16x32_bf16 v[68:71], a[52:55], a[184:187], v[68:71]
ds_read_b128 a[32:35], v192 offset:8192
s_add_u32 m0, s62, 90112
v_mfma_f32_16x16x32_bf16 v[72:75], a[52:55], a[188:191], v[72:75]
s_add_u32 s60, s60, 16384
v_exp_f32 v186, v186
v_mfma_f32_16x16x32_bf16 v[76:79], a[56:59], a[184:187], v[76:79]
v_exp_f32 v187, v187
v_mfma_f32_16x16x32_bf16 v[80:83], a[56:59], a[188:191], v[80:83]
v_exp_f32 v188, v188
v_mfma_f32_16x16x32_bf16 v[84:87], a[60:63], a[184:187], v[84:87]
v_exp_f32 v189, v189
v_mfma_f32_16x16x32_bf16 v[88:91], a[60:63], a[188:191], v[88:91]
v_fma_f32 v186, v186, v255, v255
v_fma_f32 v187, v187, v255, v255
v_mfma_f32_16x16x32_bf16 v[92:95], a[64:67], a[184:187], v[92:95]
buffer_load_dwordx4 v1, s[8:11], s60 offen offset:0 sc1 lds
v_fma_f32 v188, v188, v255, v255
v_mfma_f32_16x16x32_bf16 v[96:99], a[64:67], a[188:191], v[96:99]
v_mfma_f32_16x16x32_bf16 v[100:103], a[68:71], a[184:187], v[100:103]
v_fma_f32 v189, v189, v255, v255
v_mfma_f32_16x16x32_bf16 v[104:107], a[68:71], a[188:191], v[104:107]
s_waitcnt lgkmcnt(0)
v_mfma_f32_16x16x32_bf16 v[36:39], a[0:3], a[192:195], v[36:39]
ds_read_b128 a[36:39], v192 offset:9216
buffer_load_dwordx4 v1, s[8:11], s60 offen offset:1024 sc1 lds
v_mfma_f32_16x16x32_bf16 v[40:43], a[0:3], a[196:199], v[40:43]
ds_read_b128 a[40:43], v192 offset:10240
v_mfma_f32_16x16x32_bf16 v[44:47], a[4:7], a[192:195], v[44:47]
ds_read_b128 a[44:47], v192 offset:11264
buffer_load_dwordx4 v1, s[8:11], s60 offen offset:2048 sc1 lds
v_mfma_f32_16x16x32_bf16 v[48:51], a[4:7], a[196:199], v[48:51]
ds_read_b128 a[48:51], v192 offset:12288
v_mfma_f32_16x16x32_bf16 v[52:55], a[8:11], a[192:195], v[52:55]
ds_read_b128 a[52:55], v192 offset:13312
v_mfma_f32_16x16x32_bf16 v[56:59], a[8:11], a[196:199], v[56:59]
ds_read_b128 a[56:59], v192 offset:14336
buffer_load_dwordx4 v1, s[8:11], s60 offen offset:3072 sc1 lds
v_mfma_f32_16x16x32_bf16 v[60:63], a[12:15], a[192:195], v[60:63]
ds_read_b128 a[60:63], v192 offset:15360
v_mfma_f32_16x16x32_bf16 v[64:67], a[12:15], a[196:199], v[64:67]
ds_read_b128 a[64:67], v192 offset:16384
v_mfma_f32_16x16x32_bf16 v[68:71], a[16:19], a[192:195], v[68:71]
ds_read_b128 a[68:71], v192 offset:17408
s_add_u32 m0, s63, 106496
v_mfma_f32_16x16x32_bf16 v[72:75], a[16:19], a[196:199], v[72:75]
s_add_u32 s61, s61, 36864
v_rcp_f32 v186, v186
v_mfma_f32_16x16x32_bf16 v[76:79], a[20:23], a[192:195], v[76:79]
v_rcp_f32 v187, v187
v_mfma_f32_16x16x32_bf16 v[80:83], a[20:23], a[196:199], v[80:83]
v_rcp_f32 v188, v188
v_mfma_f32_16x16x32_bf16 v[84:87], a[24:27], a[192:195], v[84:87]
v_rcp_f32 v189, v189
v_mfma_f32_16x16x32_bf16 v[88:91], a[24:27], a[196:199], v[88:91]
v_mul_f32 v136, v136, v186
v_mul_f32 v137, v137, v187
v_mfma_f32_16x16x32_bf16 v[92:95], a[28:31], a[192:195], v[92:95]
buffer_load_dwordx4 v1, s[8:11], s61 offen offset:0 sc1 lds
v_mul_f32 v138, v138, v188
v_mfma_f32_16x16x32_bf16 v[96:99], a[28:31], a[196:199], v[96:99]
v_mul_f32 v139, v139, v189
v_mfma_f32_16x16x32_bf16 v[100:103], a[32:35], a[192:195], v[100:103]
v_mul_f32 v182, v140, v140
v_mfma_f32_16x16x32_bf16 v[104:107], a[32:35], a[196:199], v[104:107]
s_waitcnt vmcnt(26)
s_waitcnt lgkmcnt(0)
v_mfma_f32_16x16x32_bf16 v[36:39], a[36:39], a[200:203], v[36:39]
ds_read_b128 a[0:3], v192 offset:18432
s_add_u32 m0, s62, 110592
v_mfma_f32_16x16x32_bf16 v[40:43], a[36:39], a[204:207], v[40:43]
ds_read_b128 a[4:7], v192 offset:19456
v_mul_f32 v183, v141, v141
v_mfma_f32_16x16x32_bf16 v[44:47], a[40:43], a[200:203], v[44:47]
ds_read_b128 a[8:11], v192 offset:20480
s_add_u32 s60, s60, 20480
v_mfma_f32_16x16x32_bf16 v[48:51], a[40:43], a[204:207], v[48:51]
ds_read_b128 a[12:15], v192 offset:21504
v_mul_f32 v184, v142, v142
v_mfma_f32_16x16x32_bf16 v[52:55], a[44:47], a[200:203], v[52:55]
ds_read_b128 a[16:19], v192 offset:22528
v_mul_f32 v185, v143, v143
v_mfma_f32_16x16x32_bf16 v[56:59], a[44:47], a[204:207], v[56:59]
ds_read_b128 a[20:23], v192 offset:23552
buffer_load_dwordx4 v1, s[8:11], s60 offen offset:0 sc1 lds
v_mfma_f32_16x16x32_bf16 v[60:63], a[48:51], a[200:203], v[60:63]
ds_read_b128 a[24:27], v192 offset:24576
v_fma_f32 v182, v182, v254, v253
v_mfma_f32_16x16x32_bf16 v[64:67], a[48:51], a[204:207], v[64:67]
ds_read_b128 a[28:31], v192 offset:25600
v_fma_f32 v183, v183, v254, v253
v_mfma_f32_16x16x32_bf16 v[68:71], a[52:55], a[200:203], v[68:71]
ds_read_b128 a[32:35], v192 offset:26624
buffer_load_dwordx4 v1, s[8:11], s60 offen offset:1024 sc1 lds
v_mfma_f32_16x16x32_bf16 v[72:75], a[52:55], a[204:207], v[72:75]
v_fma_f32 v184, v184, v254, v253
v_fma_f32 v185, v185, v254, v253
v_mfma_f32_16x16x32_bf16 v[76:79], a[56:59], a[200:203], v[76:79]
v_mul_f32 v182, v182, v140
v_mfma_f32_16x16x32_bf16 v[80:83], a[56:59], a[204:207], v[80:83]
buffer_load_dwordx4 v1, s[8:11], s60 offen offset:2048 sc1 lds
v_mul_f32 v183, v183, v141
v_mfma_f32_16x16x32_bf16 v[84:87], a[60:63], a[200:203], v[84:87]
v_mfma_f32_16x16x32_bf16 v[88:91], a[60:63], a[204:207], v[88:91]
v_mul_f32 v184, v184, v142
v_mfma_f32_16x16x32_bf16 v[92:95], a[64:67], a[200:203], v[92:95]
buffer_load_dwordx4 v1, s[8:11], s60 offen offset:3072 sc1 lds
v_mul_f32 v185, v185, v143
v_mfma_f32_16x16x32_bf16 v[96:99], a[64:67], a[204:207], v[96:99]
v_mfma_f32_16x16x32_bf16 v[100:103], a[68:71], a[200:203], v[100:103]
v_exp_f32 v182, v182
v_mfma_f32_16x16x32_bf16 v[104:107], a[68:71], a[204:207], v[104:107]
s_waitcnt lgkmcnt(0)
v_mfma_f32_16x16x32_bf16 v[36:39], a[0:3], a[208:211], v[36:39]
ds_read_b128 a[36:39], v192 offset:27648
buffer_load_dwordx4 a[96:99], v1, s[4:7], s52 offen offset:2048 sc1
v_mfma_f32_16x16x32_bf16 v[40:43], a[0:3], a[212:215], v[40:43]
ds_read_b128 a[40:43], v192 offset:28672
v_mfma_f32_16x16x32_bf16 v[44:47], a[4:7], a[208:211], v[44:47]
ds_read_b128 a[44:47], v192 offset:29696
v_mfma_f32_16x16x32_bf16 v[48:51], a[4:7], a[212:215], v[48:51]
ds_read_b128 a[48:51], v192 offset:30720
v_mfma_f32_16x16x32_bf16 v[52:55], a[8:11], a[208:211], v[52:55]
ds_read_b128 a[52:55], v192 offset:31744
buffer_load_dwordx4 a[100:103], v9, s[4:7], s52 offen offset:2048 sc1
v_mfma_f32_16x16x32_bf16 v[56:59], a[8:11], a[212:215], v[56:59]
ds_read_b128 a[56:59], v192 offset:32768
v_mfma_f32_16x16x32_bf16 v[60:63], a[12:15], a[208:211], v[60:63]
ds_read_b128 a[60:63], v192 offset:33792
v_mfma_f32_16x16x32_bf16 v[64:67], a[12:15], a[212:215], v[64:67]
ds_read_b128 a[64:67], v192 offset:34816
v_mfma_f32_16x16x32_bf16 v[68:71], a[16:19], a[208:211], v[68:71]
ds_read_b128 a[68:71], v192 offset:35840
buffer_load_dwordx4 a[104:107], v1, s[4:7], s52 offen offset:3072 sc1
v_mfma_f32_16x16x32_bf16 v[72:75], a[16:19], a[212:215], v[72:75]
v_exp_f32 v183, v183
v_mfma_f32_16x16x32_bf16 v[76:79], a[20:23], a[208:211], v[76:79]
v_exp_f32 v184, v184
v_mfma_f32_16x16x32_bf16 v[80:83], a[20:23], a[212:215], v[80:83]
v_exp_f32 v185, v185
v_mfma_f32_16x16x32_bf16 v[84:87], a[24:27], a[208:211], v[84:87]
buffer_load_dwordx4 a[108:111], v9, s[4:7], s52 offen offset:3072 sc1
v_fma_f32 v182, v182, v255, v255
v_mfma_f32_16x16x32_bf16 v[88:91], a[24:27], a[212:215], v[88:91]
v_fma_f32 v183, v183, v255, v255
v_fma_f32 v184, v184, v255, v255
v_mfma_f32_16x16x32_bf16 v[92:95], a[28:31], a[208:211], v[92:95]
v_fma_f32 v185, v185, v255, v255
v_mfma_f32_16x16x32_bf16 v[96:99], a[28:31], a[212:215], v[96:99]
v_rcp_f32 v182, v182
v_mfma_f32_16x16x32_bf16 v[100:103], a[32:35], a[208:211], v[100:103]
v_mfma_f32_16x16x32_bf16 v[104:107], a[32:35], a[212:215], v[104:107]
s_waitcnt vmcnt(21)
s_waitcnt lgkmcnt(0)
s_barrier
v_mfma_f32_16x16x32_bf16 v[36:39], a[36:39], a[216:219], v[36:39]
ds_read_b128 a[0:3], v190 offset:0
s_add_u32 m0, s62, 126976
v_mfma_f32_16x16x32_bf16 v[40:43], a[36:39], a[220:223], v[40:43]
ds_read_b128 a[4:7], v190 offset:1024
v_mfma_f32_16x16x32_bf16 v[44:47], a[40:43], a[216:219], v[44:47]
ds_read_b128 a[8:11], v190 offset:2048
s_add_u32 s60, s60, 16384
v_mfma_f32_16x16x32_bf16 v[48:51], a[40:43], a[220:223], v[48:51]
ds_read_b128 a[12:15], v190 offset:3072
v_mfma_f32_16x16x32_bf16 v[52:55], a[44:47], a[216:219], v[52:55]
ds_read_b128 a[16:19], v190 offset:4096
v_mfma_f32_16x16x32_bf16 v[56:59], a[44:47], a[220:223], v[56:59]
ds_read_b128 a[20:23], v190 offset:5120
buffer_load_dwordx4 v1, s[8:11], s60 offen offset:0 sc1 lds
v_mfma_f32_16x16x32_bf16 v[60:63], a[48:51], a[216:219], v[60:63]
ds_read_b128 a[24:27], v190 offset:6144
v_mfma_f32_16x16x32_bf16 v[64:67], a[48:51], a[220:223], v[64:67]
ds_read_b128 a[28:31], v190 offset:7168
v_mfma_f32_16x16x32_bf16 v[68:71], a[52:55], a[216:219], v[68:71]
ds_read_b128 a[32:35], v190 offset:8192
buffer_load_dwordx4 v1, s[8:11], s60 offen offset:1024 sc1 lds
v_mfma_f32_16x16x32_bf16 v[72:75], a[52:55], a[220:223], v[72:75]
v_rcp_f32 v183, v183
v_mfma_f32_16x16x32_bf16 v[76:79], a[56:59], a[216:219], v[76:79]
v_rcp_f32 v184, v184
v_mfma_f32_16x16x32_bf16 v[80:83], a[56:59], a[220:223], v[80:83]
buffer_load_dwordx4 v1, s[8:11], s60 offen offset:2048 sc1 lds
v_mfma_f32_16x16x32_bf16 v[84:87], a[60:63], a[216:219], v[84:87]
v_rcp_f32 v185, v185
v_mfma_f32_16x16x32_bf16 v[88:91], a[60:63], a[220:223], v[88:91]
v_mul_f32 v140, v140, v182
v_mul_f32 v141, v141, v183
v_mfma_f32_16x16x32_bf16 v[92:95], a[64:67], a[216:219], v[92:95]
buffer_load_dwordx4 v1, s[8:11], s60 offen offset:3072 sc1 lds
v_mul_f32 v142, v142, v184
v_mfma_f32_16x16x32_bf16 v[96:99], a[64:67], a[220:223], v[96:99]
v_mul_f32 v143, v143, v185
v_mfma_f32_16x16x32_bf16 v[100:103], a[68:71], a[216:219], v[100:103]
v_permlane16_swap_b32 v132, v136
v_mfma_f32_16x16x32_bf16 v[104:107], a[68:71], a[220:223], v[104:107]
s_waitcnt lgkmcnt(0)
v_mfma_f32_16x16x32_bf16 v[36:39], a[0:3], a[224:227], v[36:39]
ds_read_b128 a[36:39], v190 offset:9216
s_add_u32 m0, s63, 143360
v_mfma_f32_16x16x32_bf16 v[40:43], a[0:3], a[228:231], v[40:43]
ds_read_b128 a[40:43], v190 offset:10240
v_mfma_f32_16x16x32_bf16 v[44:47], a[4:7], a[224:227], v[44:47]
ds_read_b128 a[44:47], v190 offset:11264
s_add_u32 s61, s61, 36864
v_mfma_f32_16x16x32_bf16 v[48:51], a[4:7], a[228:231], v[48:51]
ds_read_b128 a[48:51], v190 offset:12288
v_mfma_f32_16x16x32_bf16 v[52:55], a[8:11], a[224:227], v[52:55]
ds_read_b128 a[52:55], v190 offset:13312
buffer_load_dwordx4 v1, s[8:11], s61 offen offset:0 sc1 lds
v_mfma_f32_16x16x32_bf16 v[56:59], a[8:11], a[228:231], v[56:59]
ds_read_b128 a[56:59], v190 offset:14336
v_mfma_f32_16x16x32_bf16 v[60:63], a[12:15], a[224:227], v[60:63]
ds_read_b128 a[60:63], v190 offset:15360
s_add_u32 m0, s62, 147456
v_mfma_f32_16x16x32_bf16 v[64:67], a[12:15], a[228:231], v[64:67]
ds_read_b128 a[64:67], v190 offset:16384
v_mfma_f32_16x16x32_bf16 v[68:71], a[16:19], a[224:227], v[68:71]
ds_read_b128 a[68:71], v190 offset:17408
s_add_u32 s60, s60, 20480
v_mfma_f32_16x16x32_bf16 v[72:75], a[16:19], a[228:231], v[72:75]
v_permlane16_swap_b32 v133, v137
v_mfma_f32_16x16x32_bf16 v[76:79], a[20:23], a[224:227], v[76:79]
buffer_load_dwordx4 v1, s[8:11], s60 offen offset:0 sc1 lds
v_mfma_f32_16x16x32_bf16 v[80:83], a[20:23], a[228:231], v[80:83]
v_permlane16_swap_b32 v134, v138
v_mfma_f32_16x16x32_bf16 v[84:87], a[24:27], a[224:227], v[84:87]
buffer_load_dwordx4 v1, s[8:11], s60 offen offset:1024 sc1 lds
v_mfma_f32_16x16x32_bf16 v[88:91], a[24:27], a[228:231], v[88:91]
v_permlane16_swap_b32 v135, v139
v_mfma_f32_16x16x32_bf16 v[92:95], a[28:31], a[224:227], v[92:95]
buffer_load_dwordx4 v1, s[8:11], s60 offen offset:2048 sc1 lds
v_mul_f32 v186, v144, v144
v_mfma_f32_16x16x32_bf16 v[96:99], a[28:31], a[228:231], v[96:99]
v_mul_f32 v187, v145, v145
v_mul_f32 v188, v146, v146
v_mfma_f32_16x16x32_bf16 v[100:103], a[32:35], a[224:227], v[100:103]
v_mul_f32 v189, v147, v147
v_fma_f32 v186, v186, v254, v253
v_mfma_f32_16x16x32_bf16 v[104:107], a[32:35], a[228:231], v[104:107]
s_waitcnt vmcnt(25)
s_waitcnt lgkmcnt(0)
v_mfma_f32_16x16x32_bf16 v[36:39], a[36:39], a[232:235], v[36:39]
ds_read_b128 a[0:3], v190 offset:18432
buffer_load_dwordx4 v1, s[8:11], s60 offen offset:3072 sc1 lds
v_mfma_f32_16x16x32_bf16 v[40:43], a[36:39], a[236:239], v[40:43]
ds_read_b128 a[4:7], v190 offset:19456
v_fma_f32 v187, v187, v254, v253
v_mfma_f32_16x16x32_bf16 v[44:47], a[40:43], a[232:235], v[44:47]
ds_read_b128 a[8:11], v190 offset:20480
v_fma_f32 v188, v188, v254, v253
v_mfma_f32_16x16x32_bf16 v[48:51], a[40:43], a[236:239], v[48:51]
ds_read_b128 a[12:15], v190 offset:21504
s_add_u32 s52, s52, 4096
v_mfma_f32_16x16x32_bf16 v[52:55], a[44:47], a[232:235], v[52:55]
ds_read_b128 a[16:19], v190 offset:22528
v_fma_f32 v189, v189, v254, v253
v_mfma_f32_16x16x32_bf16 v[56:59], a[44:47], a[236:239], v[56:59]
ds_read_b128 a[20:23], v190 offset:23552
v_mul_f32 v186, v186, v144
v_mfma_f32_16x16x32_bf16 v[60:63], a[48:51], a[232:235], v[60:63]
ds_read_b128 a[24:27], v190 offset:24576
buffer_load_dwordx4 a[112:115], v1, s[4:7], s52 offen offset:0 sc1
v_mfma_f32_16x16x32_bf16 v[64:67], a[48:51], a[236:239], v[64:67]
ds_read_b128 a[28:31], v190 offset:25600
v_mul_f32 v187, v187, v145
v_mfma_f32_16x16x32_bf16 v[68:71], a[52:55], a[232:235], v[68:71]
ds_read_b128 a[32:35], v190 offset:26624
v_mul_f32 v188, v188, v146
v_mfma_f32_16x16x32_bf16 v[72:75], a[52:55], a[236:239], v[72:75]
v_mul_f32 v189, v189, v147
v_mfma_f32_16x16x32_bf16 v[76:79], a[56:59], a[232:235], v[76:79]
buffer_load_dwordx4 a[116:119], v9, s[4:7], s52 offen offset:0 sc1
v_mfma_f32_16x16x32_bf16 v[80:83], a[56:59], a[236:239], v[80:83]
v_exp_f32 v186, v186
v_mfma_f32_16x16x32_bf16 v[84:87], a[60:63], a[232:235], v[84:87]
v_exp_f32 v187, v187
v_mfma_f32_16x16x32_bf16 v[88:91], a[60:63], a[236:239], v[88:91]
buffer_load_dwordx4 a[120:123], v1, s[4:7], s52 offen offset:1024 sc1
v_mfma_f32_16x16x32_bf16 v[92:95], a[64:67], a[232:235], v[92:95]
v_exp_f32 v188, v188
v_mfma_f32_16x16x32_bf16 v[96:99], a[64:67], a[236:239], v[96:99]
v_exp_f32 v189, v189
v_mfma_f32_16x16x32_bf16 v[100:103], a[68:71], a[232:235], v[100:103]
v_mfma_f32_16x16x32_bf16 v[104:107], a[68:71], a[236:239], v[104:107]
s_waitcnt lgkmcnt(0)
v_mfma_f32_16x16x32_bf16 v[36:39], a[0:3], a[240:243], v[36:39]
ds_read_b128 a[36:39], v190 offset:27648
buffer_load_dwordx4 a[124:127], v9, s[4:7], s52 offen offset:1024 sc1
v_mfma_f32_16x16x32_bf16 v[40:43], a[0:3], a[244:247], v[40:43]
ds_read_b128 a[40:43], v190 offset:28672
v_fma_f32 v186, v186, v255, v255
v_mfma_f32_16x16x32_bf16 v[44:47], a[4:7], a[240:243], v[44:47]
ds_read_b128 a[44:47], v190 offset:29696
v_fma_f32 v187, v187, v255, v255
v_mfma_f32_16x16x32_bf16 v[48:51], a[4:7], a[244:247], v[48:51]
ds_read_b128 a[48:51], v190 offset:30720
v_fma_f32 v188, v188, v255, v255
v_mfma_f32_16x16x32_bf16 v[52:55], a[8:11], a[240:243], v[52:55]
ds_read_b128 a[52:55], v190 offset:31744
buffer_load_dwordx4 a[128:131], v1, s[4:7], s52 offen offset:2048 sc1
v_mfma_f32_16x16x32_bf16 v[56:59], a[8:11], a[244:247], v[56:59]
ds_read_b128 a[56:59], v190 offset:32768
v_fma_f32 v189, v189, v255, v255
v_mfma_f32_16x16x32_bf16 v[60:63], a[12:15], a[240:243], v[60:63]
ds_read_b128 a[60:63], v190 offset:33792
v_mfma_f32_16x16x32_bf16 v[64:67], a[12:15], a[244:247], v[64:67]
ds_read_b128 a[64:67], v190 offset:34816
v_mfma_f32_16x16x32_bf16 v[68:71], a[16:19], a[240:243], v[68:71]
ds_read_b128 a[68:71], v190 offset:35840
buffer_load_dwordx4 a[132:135], v9, s[4:7], s52 offen offset:2048 sc1
v_mfma_f32_16x16x32_bf16 v[72:75], a[16:19], a[244:247], v[72:75]
v_rcp_f32 v186, v186
v_mfma_f32_16x16x32_bf16 v[76:79], a[20:23], a[240:243], v[76:79]
v_rcp_f32 v187, v187
v_mfma_f32_16x16x32_bf16 v[80:83], a[20:23], a[244:247], v[80:83]
v_mfma_f32_16x16x32_bf16 v[84:87], a[24:27], a[240:243], v[84:87]
buffer_load_dwordx4 a[136:139], v1, s[4:7], s52 offen offset:3072 sc1
v_mfma_f32_16x16x32_bf16 v[88:91], a[24:27], a[244:247], v[88:91]
v_rcp_f32 v188, v188
v_mfma_f32_16x16x32_bf16 v[92:95], a[28:31], a[240:243], v[92:95]
v_mfma_f32_16x16x32_bf16 v[96:99], a[28:31], a[244:247], v[96:99]
v_rcp_f32 v189, v189
v_mfma_f32_16x16x32_bf16 v[100:103], a[32:35], a[240:243], v[100:103]
v_mfma_f32_16x16x32_bf16 v[104:107], a[32:35], a[244:247], v[104:107]
s_waitcnt vmcnt(20)
s_waitcnt lgkmcnt(0)
s_barrier
v_mfma_f32_16x16x32_bf16 v[36:39], a[36:39], a[248:251], v[36:39]
ds_read_b128 a[0:3], v191 offset:0
buffer_load_dwordx4 a[140:143], v9, s[4:7], s52 offen offset:3072 sc1
v_mfma_f32_16x16x32_bf16 v[40:43], a[36:39], a[252:255], v[40:43]
ds_read_b128 a[4:7], v191 offset:1024
v_mul_f32 v144, v144, v186
v_mfma_f32_16x16x32_bf16 v[44:47], a[40:43], a[248:251], v[44:47]
ds_read_b128 a[8:11], v191 offset:2048
s_add_u32 m0, s62, 53248
v_mfma_f32_16x16x32_bf16 v[48:51], a[40:43], a[252:255], v[48:51]
ds_read_b128 a[12:15], v191 offset:3072
v_mul_f32 v145, v145, v187
v_mfma_f32_16x16x32_bf16 v[52:55], a[44:47], a[248:251], v[52:55]
ds_read_b128 a[16:19], v191 offset:4096
v_mul_f32 v146, v146, v188
v_mfma_f32_16x16x32_bf16 v[56:59], a[44:47], a[252:255], v[56:59]
ds_read_b128 a[20:23], v191 offset:5120
s_add_u32 s60, s60, 16384
v_mfma_f32_16x16x32_bf16 v[60:63], a[48:51], a[248:251], v[60:63]
ds_read_b128 a[24:27], v191 offset:6144
v_mul_f32 v147, v147, v189
v_mfma_f32_16x16x32_bf16 v[64:67], a[48:51], a[252:255], v[64:67]
ds_read_b128 a[28:31], v191 offset:7168
v_mul_f32 v182, v148, v148
v_mfma_f32_16x16x32_bf16 v[68:71], a[52:55], a[248:251], v[68:71]
ds_read_b128 a[32:35], v191 offset:8192
buffer_load_dwordx4 v1, s[8:11], s60 offen offset:0 sc1 lds
v_mfma_f32_16x16x32_bf16 v[72:75], a[52:55], a[252:255], v[72:75]
v_mul_f32 v183, v149, v149
v_mul_f32 v184, v150, v150
v_mfma_f32_16x16x32_bf16 v[76:79], a[56:59], a[248:251], v[76:79]
v_mul_f32 v185, v151, v151
v_mfma_f32_16x16x32_bf16 v[80:83], a[56:59], a[252:255], v[80:83]
buffer_load_dwordx4 v1, s[8:11], s60 offen offset:1024 sc1 lds
v_fma_f32 v182, v182, v254, v253
v_mfma_f32_16x16x32_bf16 v[84:87], a[60:63], a[248:251], v[84:87]
v_mfma_f32_16x16x32_bf16 v[88:91], a[60:63], a[252:255], v[88:91]
v_fma_f32 v183, v183, v254, v253
v_mfma_f32_16x16x32_bf16 v[92:95], a[64:67], a[248:251], v[92:95]
buffer_load_dwordx4 v1, s[8:11], s60 offen offset:2048 sc1 lds
v_fma_f32 v184, v184, v254, v253
v_mfma_f32_16x16x32_bf16 v[96:99], a[64:67], a[252:255], v[96:99]
v_fma_f32 v185, v185, v254, v253
v_mfma_f32_16x16x32_bf16 v[100:103], a[68:71], a[248:251], v[100:103]
v_mfma_f32_16x16x32_bf16 v[104:107], a[68:71], a[252:255], v[104:107]
v_mul_f32 v182, v182, v148
s_waitcnt lgkmcnt(0)
v_mfma_f32_16x16x32_bf16 v[36:39], a[0:3], a[80:83], v[36:39]
ds_read_b128 a[36:39], v191 offset:9216
buffer_load_dwordx4 v1, s[8:11], s60 offen offset:3072 sc1 lds
v_mfma_f32_16x16x32_bf16 v[40:43], a[0:3], a[84:87], v[40:43]
ds_read_b128 a[40:43], v191 offset:10240
v_mul_f32 v183, v183, v149
v_mfma_f32_16x16x32_bf16 v[44:47], a[4:7], a[80:83], v[44:47]
ds_read_b128 a[44:47], v191 offset:11264
s_add_u32 m0, s63, 69632
v_mfma_f32_16x16x32_bf16 v[48:51], a[4:7], a[84:87], v[48:51]
ds_read_b128 a[48:51], v191 offset:12288
v_mul_f32 v184, v184, v150
v_mfma_f32_16x16x32_bf16 v[52:55], a[8:11], a[80:83], v[52:55]
ds_read_b128 a[52:55], v191 offset:13312
s_add_u32 s61, s61, 36864
v_mfma_f32_16x16x32_bf16 v[56:59], a[8:11], a[84:87], v[56:59]
ds_read_b128 a[56:59], v191 offset:14336
v_mul_f32 v185, v185, v151
v_mfma_f32_16x16x32_bf16 v[60:63], a[12:15], a[80:83], v[60:63]
ds_read_b128 a[60:63], v191 offset:15360
buffer_load_dwordx4 v1, s[8:11], s61 offen offset:0 sc1 lds
v_mfma_f32_16x16x32_bf16 v[64:67], a[12:15], a[84:87], v[64:67]
ds_read_b128 a[64:67], v191 offset:16384
v_mfma_f32_16x16x32_bf16 v[68:71], a[16:19], a[80:83], v[68:71]
ds_read_b128 a[68:71], v191 offset:17408
s_add_u32 m0, s62, 73728
v_mfma_f32_16x16x32_bf16 v[72:75], a[16:19], a[84:87], v[72:75]
s_add_u32 s60, s60, 20480
v_exp_f32 v182, v182
v_mfma_f32_16x16x32_bf16 v[76:79], a[20:23], a[80:83], v[76:79]
v_exp_f32 v183, v183
v_mfma_f32_16x16x32_bf16 v[80:83], a[20:23], a[84:87], v[80:83]
v_exp_f32 v184, v184
v_mfma_f32_16x16x32_bf16 v[84:87], a[24:27], a[80:83], v[84:87]
buffer_load_dwordx4 v1, s[8:11], s60 offen offset:0 sc1 lds
v_mfma_f32_16x16x32_bf16 v[88:91], a[24:27], a[84:87], v[88:91]
v_exp_f32 v185, v185
v_mfma_f32_16x16x32_bf16 v[92:95], a[28:31], a[80:83], v[92:95]
buffer_load_dwordx4 v1, s[8:11], s60 offen offset:1024 sc1 lds
v_mfma_f32_16x16x32_bf16 v[96:99], a[28:31], a[84:87], v[96:99]
v_mfma_f32_16x16x32_bf16 v[100:103], a[32:35], a[80:83], v[100:103]
v_fma_f32 v182, v182, v255, v255
v_mfma_f32_16x16x32_bf16 v[104:107], a[32:35], a[84:87], v[104:107]
s_waitcnt vmcnt(24)
s_waitcnt lgkmcnt(0)
v_mfma_f32_16x16x32_bf16 v[36:39], a[36:39], a[88:91], v[36:39]
ds_read_b128 a[0:3], v191 offset:18432
buffer_load_dwordx4 v1, s[8:11], s60 offen offset:2048 sc1 lds
v_mfma_f32_16x16x32_bf16 v[40:43], a[36:39], a[92:95], v[40:43]
ds_read_b128 a[4:7], v191 offset:19456
v_fma_f32 v183, v183, v255, v255
v_mfma_f32_16x16x32_bf16 v[44:47], a[40:43], a[88:91], v[44:47]
ds_read_b128 a[8:11], v191 offset:20480
v_fma_f32 v184, v184, v255, v255
v_mfma_f32_16x16x32_bf16 v[48:51], a[40:43], a[92:95], v[48:51]
ds_read_b128 a[12:15], v191 offset:21504
buffer_load_dwordx4 v1, s[8:11], s60 offen offset:3072 sc1 lds
v_mfma_f32_16x16x32_bf16 v[52:55], a[44:47], a[88:91], v[52:55]
ds_read_b128 a[16:19], v191 offset:22528
v_fma_f32 v185, v185, v255, v255
v_mfma_f32_16x16x32_bf16 v[56:59], a[44:47], a[92:95], v[56:59]
ds_read_b128 a[20:23], v191 offset:23552
v_mfma_f32_16x16x32_bf16 v[60:63], a[48:51], a[88:91], v[60:63]
ds_read_b128 a[24:27], v191 offset:24576
s_add_u32 s52, s52, 4096
v_mfma_f32_16x16x32_bf16 v[64:67], a[48:51], a[92:95], v[64:67]
ds_read_b128 a[28:31], v191 offset:25600
v_mfma_f32_16x16x32_bf16 v[68:71], a[52:55], a[88:91], v[68:71]
ds_read_b128 a[32:35], v191 offset:26624
v_mfma_f32_16x16x32_bf16 v[72:75], a[52:55], a[92:95], v[72:75]
v_rcp_f32 v182, v182
v_mfma_f32_16x16x32_bf16 v[76:79], a[56:59], a[88:91], v[76:79]
buffer_load_dwordx4 a[144:147], v1, s[4:7], s52 offen offset:0 sc1
v_mfma_f32_16x16x32_bf16 v[80:83], a[56:59], a[92:95], v[80:83]
v_rcp_f32 v183, v183
v_mfma_f32_16x16x32_bf16 v[84:87], a[60:63], a[88:91], v[84:87]
v_rcp_f32 v184, v184
v_mfma_f32_16x16x32_bf16 v[88:91], a[60:63], a[92:95], v[88:91]
buffer_load_dwordx4 a[148:151], v9, s[4:7], s52 offen offset:0 sc1
v_mfma_f32_16x16x32_bf16 v[92:95], a[64:67], a[88:91], v[92:95]
v_rcp_f32 v185, v185
v_mfma_f32_16x16x32_bf16 v[96:99], a[64:67], a[92:95], v[96:99]
v_mul_f32 v148, v148, v182
v_mfma_f32_16x16x32_bf16 v[100:103], a[68:71], a[88:91], v[100:103]
v_mfma_f32_16x16x32_bf16 v[104:107], a[68:71], a[92:95], v[104:107]
v_mul_f32 v149, v149, v183
s_waitcnt lgkmcnt(0)
v_mfma_f32_16x16x32_bf16 v[36:39], a[0:3], a[96:99], v[36:39]
ds_read_b128 a[36:39], v191 offset:27648
buffer_load_dwordx4 a[152:155], v1, s[4:7], s52 offen offset:1024 sc1
v_mfma_f32_16x16x32_bf16 v[40:43], a[0:3], a[100:103], v[40:43]
ds_read_b128 a[40:43], v191 offset:28672
v_mul_f32 v150, v150, v184
v_mfma_f32_16x16x32_bf16 v[44:47], a[4:7], a[96:99], v[44:47]
ds_read_b128 a[44:47], v191 offset:29696
v_mul_f32 v151, v151, v185
v_mfma_f32_16x16x32_bf16 v[48:51], a[4:7], a[100:103], v[48:51]
ds_read_b128 a[48:51], v191 offset:30720
v_mfma_f32_16x16x32_bf16 v[52:55], a[8:11], a[96:99], v[52:55]
ds_read_b128 a[52:55], v191 offset:31744
buffer_load_dwordx4 a[156:159], v9, s[4:7], s52 offen offset:1024 sc1
v_mfma_f32_16x16x32_bf16 v[56:59], a[8:11], a[100:103], v[56:59]
ds_read_b128 a[56:59], v191 offset:32768
v_mfma_f32_16x16x32_bf16 v[60:63], a[12:15], a[96:99], v[60:63]
ds_read_b128 a[60:63], v191 offset:33792
v_mfma_f32_16x16x32_bf16 v[64:67], a[12:15], a[100:103], v[64:67]
ds_read_b128 a[64:67], v191 offset:34816
v_mfma_f32_16x16x32_bf16 v[68:71], a[16:19], a[96:99], v[68:71]
ds_read_b128 a[68:71], v191 offset:35840
buffer_load_dwordx4 a[160:163], v1, s[4:7], s52 offen offset:2048 sc1
v_mfma_f32_16x16x32_bf16 v[72:75], a[16:19], a[100:103], v[72:75]
v_permlane16_swap_b32 v140, v144
v_mfma_f32_16x16x32_bf16 v[76:79], a[20:23], a[96:99], v[76:79]
v_permlane16_swap_b32 v141, v145
v_mfma_f32_16x16x32_bf16 v[80:83], a[20:23], a[100:103], v[80:83]
v_permlane16_swap_b32 v142, v146
v_mfma_f32_16x16x32_bf16 v[84:87], a[24:27], a[96:99], v[84:87]
buffer_load_dwordx4 a[164:167], v9, s[4:7], s52 offen offset:2048 sc1
v_mfma_f32_16x16x32_bf16 v[88:91], a[24:27], a[100:103], v[88:91]
v_permlane16_swap_b32 v143, v147
v_mfma_f32_16x16x32_bf16 v[92:95], a[28:31], a[96:99], v[92:95]
v_mfma_f32_16x16x32_bf16 v[96:99], a[28:31], a[100:103], v[96:99]
v_mul_f32 v186, v152, v152
v_mfma_f32_16x16x32_bf16 v[100:103], a[32:35], a[96:99], v[100:103]
v_mul_f32 v187, v153, v153
v_mfma_f32_16x16x32_bf16 v[104:107], a[32:35], a[100:103], v[104:107]
s_waitcnt vmcnt(19)
s_waitcnt lgkmcnt(0)
s_barrier
v_mfma_f32_16x16x32_bf16 v[36:39], a[36:39], a[104:107], v[36:39]
ds_read_b128 a[0:3], v192 offset:0
buffer_load_dwordx4 a[168:171], v1, s[4:7], s52 offen offset:3072 sc1
v_mfma_f32_16x16x32_bf16 v[40:43], a[36:39], a[108:111], v[40:43]
ds_read_b128 a[4:7], v192 offset:1024
v_mul_f32 v188, v154, v154
v_mfma_f32_16x16x32_bf16 v[44:47], a[40:43], a[104:107], v[44:47]
ds_read_b128 a[8:11], v192 offset:2048
buffer_load_dwordx4 a[172:175], v9, s[4:7], s52 offen offset:3072 sc1
v_mfma_f32_16x16x32_bf16 v[48:51], a[40:43], a[108:111], v[48:51]
ds_read_b128 a[12:15], v192 offset:3072
v_mul_f32 v189, v155, v155
v_mfma_f32_16x16x32_bf16 v[52:55], a[44:47], a[104:107], v[52:55]
ds_read_b128 a[16:19], v192 offset:4096
v_fma_f32 v186, v186, v254, v253
v_mfma_f32_16x16x32_bf16 v[56:59], a[44:47], a[108:111], v[56:59]
ds_read_b128 a[20:23], v192 offset:5120
s_add_u32 m0, s62, 90112
v_mfma_f32_16x16x32_bf16 v[60:63], a[48:51], a[104:107], v[60:63]
ds_read_b128 a[24:27], v192 offset:6144
v_fma_f32 v187, v187, v254, v253
v_mfma_f32_16x16x32_bf16 v[64:67], a[48:51], a[108:111], v[64:67]
ds_read_b128 a[28:31], v192 offset:7168
v_fma_f32 v188, v188, v254, v253
v_mfma_f32_16x16x32_bf16 v[68:71], a[52:55], a[104:107], v[68:71]
ds_read_b128 a[32:35], v192 offset:8192
s_add_u32 s60, s60, 16384
v_mfma_f32_16x16x32_bf16 v[72:75], a[52:55], a[108:111], v[72:75]
v_fma_f32 v189, v189, v254, v253
v_mul_f32 v186, v186, v152
v_mfma_f32_16x16x32_bf16 v[76:79], a[56:59], a[104:107], v[76:79]
v_mul_f32 v187, v187, v153
v_mfma_f32_16x16x32_bf16 v[80:83], a[56:59], a[108:111], v[80:83]
buffer_load_dwordx4 v1, s[8:11], s60 offen offset:0 sc1 lds
v_mul_f32 v188, v188, v154
v_mfma_f32_16x16x32_bf16 v[84:87], a[60:63], a[104:107], v[84:87]
v_mul_f32 v189, v189, v155
v_mfma_f32_16x16x32_bf16 v[88:91], a[60:63], a[108:111], v[88:91]
v_mfma_f32_16x16x32_bf16 v[92:95], a[64:67], a[104:107], v[92:95]
buffer_load_dwordx4 v1, s[8:11], s60 offen offset:1024 sc1 lds
v_mfma_f32_16x16x32_bf16 v[96:99], a[64:67], a[108:111], v[96:99]
v_exp_f32 v186, v186
v_mfma_f32_16x16x32_bf16 v[100:103], a[68:71], a[104:107], v[100:103]
v_mfma_f32_16x16x32_bf16 v[104:107], a[68:71], a[108:111], v[104:107]
s_waitcnt lgkmcnt(0)
v_mfma_f32_16x16x32_bf16 v[36:39], a[0:3], a[112:115], v[36:39]
ds_read_b128 a[36:39], v192 offset:9216
buffer_load_dwordx4 v1, s[8:11], s60 offen offset:2048 sc1 lds
v_mfma_f32_16x16x32_bf16 v[40:43], a[0:3], a[116:119], v[40:43]
ds_read_b128 a[40:43], v192 offset:10240
v_mfma_f32_16x16x32_bf16 v[44:47], a[4:7], a[112:115], v[44:47]
ds_read_b128 a[44:47], v192 offset:11264
buffer_load_dwordx4 v1, s[8:11], s60 offen offset:3072 sc1 lds
v_mfma_f32_16x16x32_bf16 v[48:51], a[4:7], a[116:119], v[48:51]
ds_read_b128 a[48:51], v192 offset:12288
v_mfma_f32_16x16x32_bf16 v[52:55], a[8:11], a[112:115], v[52:55]
ds_read_b128 a[52:55], v192 offset:13312
s_add_u32 m0, s63, 106496
v_mfma_f32_16x16x32_bf16 v[56:59], a[8:11], a[116:119], v[56:59]
ds_read_b128 a[56:59], v192 offset:14336
v_mfma_f32_16x16x32_bf16 v[60:63], a[12:15], a[112:115], v[60:63]
ds_read_b128 a[60:63], v192 offset:15360
s_add_u32 s61, s61, 36864
v_mfma_f32_16x16x32_bf16 v[64:67], a[12:15], a[116:119], v[64:67]
ds_read_b128 a[64:67], v192 offset:16384
v_mfma_f32_16x16x32_bf16 v[68:71], a[16:19], a[112:115], v[68:71]
ds_read_b128 a[68:71], v192 offset:17408
buffer_load_dwordx4 v1, s[8:11], s61 offen offset:0 sc1 lds
v_mfma_f32_16x16x32_bf16 v[72:75], a[16:19], a[116:119], v[72:75]
s_add_u32 m0, s62, 110592
v_exp_f32 v187, v187
v_mfma_f32_16x16x32_bf16 v[76:79], a[20:23], a[112:115], v[76:79]
s_add_u32 s60, s60, 20480
v_exp_f32 v188, v188
v_mfma_f32_16x16x32_bf16 v[80:83], a[20:23], a[116:119], v[80:83]
v_exp_f32 v189, v189
v_mfma_f32_16x16x32_bf16 v[84:87], a[24:27], a[112:115], v[84:87]
v_fma_f32 v186, v186, v255, v255
v_fma_f32 v187, v187, v255, v255
v_mfma_f32_16x16x32_bf16 v[88:91], a[24:27], a[116:119], v[88:91]
v_fma_f32 v188, v188, v255, v255
v_fma_f32 v189, v189, v255, v255
v_mfma_f32_16x16x32_bf16 v[92:95], a[28:31], a[112:115], v[92:95]
buffer_load_dwordx4 v1, s[8:11], s60 offen offset:0 sc1 lds
v_mfma_f32_16x16x32_bf16 v[96:99], a[28:31], a[116:119], v[96:99]
v_rcp_f32 v186, v186
v_mfma_f32_16x16x32_bf16 v[100:103], a[32:35], a[112:115], v[100:103]
v_rcp_f32 v187, v187
v_mfma_f32_16x16x32_bf16 v[104:107], a[32:35], a[116:119], v[104:107]
s_waitcnt vmcnt(23)
s_waitcnt lgkmcnt(0)
v_mfma_f32_16x16x32_bf16 v[36:39], a[36:39], a[120:123], v[36:39]
ds_read_b128 a[0:3], v192 offset:18432
buffer_load_dwordx4 v1, s[8:11], s60 offen offset:1024 sc1 lds
v_mfma_f32_16x16x32_bf16 v[40:43], a[36:39], a[124:127], v[40:43]
ds_read_b128 a[4:7], v192 offset:19456
v_mfma_f32_16x16x32_bf16 v[44:47], a[40:43], a[120:123], v[44:47]
ds_read_b128 a[8:11], v192 offset:20480
v_mfma_f32_16x16x32_bf16 v[48:51], a[40:43], a[124:127], v[48:51]
ds_read_b128 a[12:15], v192 offset:21504
buffer_load_dwordx4 v1, s[8:11], s60 offen offset:2048 sc1 lds
v_mfma_f32_16x16x32_bf16 v[52:55], a[44:47], a[120:123], v[52:55]
ds_read_b128 a[16:19], v192 offset:22528
v_mfma_f32_16x16x32_bf16 v[56:59], a[44:47], a[124:127], v[56:59]
ds_read_b128 a[20:23], v192 offset:23552
v_mfma_f32_16x16x32_bf16 v[60:63], a[48:51], a[120:123], v[60:63]
ds_read_b128 a[24:27], v192 offset:24576
buffer_load_dwordx4 v1, s[8:11], s60 offen offset:3072 sc1 lds
v_mfma_f32_16x16x32_bf16 v[64:67], a[48:51], a[124:127], v[64:67]
ds_read_b128 a[28:31], v192 offset:25600
v_mfma_f32_16x16x32_bf16 v[68:71], a[52:55], a[120:123], v[68:71]
ds_read_b128 a[32:35], v192 offset:26624
v_mfma_f32_16x16x32_bf16 v[72:75], a[52:55], a[124:127], v[72:75]
s_add_u32 s52, s52, 4096
v_rcp_f32 v188, v188
v_mfma_f32_16x16x32_bf16 v[76:79], a[56:59], a[120:123], v[76:79]
v_rcp_f32 v189, v189
v_mfma_f32_16x16x32_bf16 v[80:83], a[56:59], a[124:127], v[80:83]
v_mul_f32 v152, v152, v186
v_mul_f32 v153, v153, v187
v_mfma_f32_16x16x32_bf16 v[84:87], a[60:63], a[120:123], v[84:87]
v_mul_f32 v154, v154, v188
v_mul_f32 v155, v155, v189
v_mfma_f32_16x16x32_bf16 v[88:91], a[60:63], a[124:127], v[88:91]
buffer_load_dwordx4 a[176:179], v1, s[4:7], s52 offen offset:0 sc1
v_mul_f32 v182, v156, v156
v_mfma_f32_16x16x32_bf16 v[92:95], a[64:67], a[120:123], v[92:95]
v_mul_f32 v183, v157, v157
v_mfma_f32_16x16x32_bf16 v[96:99], a[64:67], a[124:127], v[96:99]
v_mul_f32 v184, v158, v158
v_mfma_f32_16x16x32_bf16 v[100:103], a[68:71], a[120:123], v[100:103]
v_mfma_f32_16x16x32_bf16 v[104:107], a[68:71], a[124:127], v[104:107]
v_mul_f32 v185, v159, v159
s_waitcnt lgkmcnt(0)
v_mfma_f32_16x16x32_bf16 v[36:39], a[0:3], a[128:131], v[36:39]
ds_read_b128 a[36:39], v192 offset:27648
buffer_load_dwordx4 a[180:183], v9, s[4:7], s52 offen offset:0 sc1
v_mfma_f32_16x16x32_bf16 v[40:43], a[0:3], a[132:135], v[40:43]
ds_read_b128 a[40:43], v192 offset:28672
v_fma_f32 v182, v182, v254, v253
v_mfma_f32_16x16x32_bf16 v[44:47], a[4:7], a[128:131], v[44:47]
ds_read_b128 a[44:47], v192 offset:29696
v_fma_f32 v183, v183, v254, v253
v_mfma_f32_16x16x32_bf16 v[48:51], a[4:7], a[132:135], v[48:51]
ds_read_b128 a[48:51], v192 offset:30720
v_fma_f32 v184, v184, v254, v253
v_mfma_f32_16x16x32_bf16 v[52:55], a[8:11], a[128:131], v[52:55]
ds_read_b128 a[52:55], v192 offset:31744
buffer_load_dwordx4 a[184:187], v1, s[4:7], s52 offen offset:1024 sc1
v_mfma_f32_16x16x32_bf16 v[56:59], a[8:11], a[132:135], v[56:59]
ds_read_b128 a[56:59], v192 offset:32768
v_fma_f32 v185, v185, v254, v253
v_mfma_f32_16x16x32_bf16 v[60:63], a[12:15], a[128:131], v[60:63]
ds_read_b128 a[60:63], v192 offset:33792
v_mul_f32 v182, v182, v156
v_mfma_f32_16x16x32_bf16 v[64:67], a[12:15], a[132:135], v[64:67]
ds_read_b128 a[64:67], v192 offset:34816
v_mul_f32 v183, v183, v157
v_mfma_f32_16x16x32_bf16 v[68:71], a[16:19], a[128:131], v[68:71]
ds_read_b128 a[68:71], v192 offset:35840
buffer_load_dwordx4 a[188:191], v9, s[4:7], s52 offen offset:1024 sc1
v_mfma_f32_16x16x32_bf16 v[72:75], a[16:19], a[132:135], v[72:75]
v_mul_f32 v184, v184, v158
v_mfma_f32_16x16x32_bf16 v[76:79], a[20:23], a[128:131], v[76:79]
v_mul_f32 v185, v185, v159
v_mfma_f32_16x16x32_bf16 v[80:83], a[20:23], a[132:135], v[80:83]
v_mfma_f32_16x16x32_bf16 v[84:87], a[24:27], a[128:131], v[84:87]
buffer_load_dwordx4 a[192:195], v1, s[4:7], s52 offen offset:2048 sc1
v_mfma_f32_16x16x32_bf16 v[88:91], a[24:27], a[132:135], v[88:91]
v_exp_f32 v182, v182
v_mfma_f32_16x16x32_bf16 v[92:95], a[28:31], a[128:131], v[92:95]
v_mfma_f32_16x16x32_bf16 v[96:99], a[28:31], a[132:135], v[96:99]
v_exp_f32 v183, v183
v_mfma_f32_16x16x32_bf16 v[100:103], a[32:35], a[128:131], v[100:103]
v_mfma_f32_16x16x32_bf16 v[104:107], a[32:35], a[132:135], v[104:107]
s_waitcnt vmcnt(18)
s_waitcnt lgkmcnt(0)
s_barrier
v_mfma_f32_16x16x32_bf16 v[36:39], a[36:39], a[136:139], v[36:39]
ds_read_b128 a[0:3], v190 offset:0
buffer_load_dwordx4 a[196:199], v9, s[4:7], s52 offen offset:2048 sc1
v_mfma_f32_16x16x32_bf16 v[40:43], a[36:39], a[140:143], v[40:43]
ds_read_b128 a[4:7], v190 offset:1024
v_mfma_f32_16x16x32_bf16 v[44:47], a[40:43], a[136:139], v[44:47]
ds_read_b128 a[8:11], v190 offset:2048
buffer_load_dwordx4 a[200:203], v1, s[4:7], s52 offen offset:3072 sc1
v_mfma_f32_16x16x32_bf16 v[48:51], a[40:43], a[140:143], v[48:51]
ds_read_b128 a[12:15], v190 offset:3072
v_mfma_f32_16x16x32_bf16 v[52:55], a[44:47], a[136:139], v[52:55]
ds_read_b128 a[16:19], v190 offset:4096
v_mfma_f32_16x16x32_bf16 v[56:59], a[44:47], a[140:143], v[56:59]
ds_read_b128 a[20:23], v190 offset:5120
buffer_load_dwordx4 a[204:207], v9, s[4:7], s52 offen offset:3072 sc1
v_mfma_f32_16x16x32_bf16 v[60:63], a[48:51], a[136:139], v[60:63]
ds_read_b128 a[24:27], v190 offset:6144
v_mfma_f32_16x16x32_bf16 v[64:67], a[48:51], a[140:143], v[64:67]
ds_read_b128 a[28:31], v190 offset:7168
v_mfma_f32_16x16x32_bf16 v[68:71], a[52:55], a[136:139], v[68:71]
ds_read_b128 a[32:35], v190 offset:8192
s_add_u32 m0, s62, 126976
v_mfma_f32_16x16x32_bf16 v[72:75], a[52:55], a[140:143], v[72:75]
s_add_u32 s60, s60, 16384
v_exp_f32 v184, v184
v_mfma_f32_16x16x32_bf16 v[76:79], a[56:59], a[136:139], v[76:79]
v_exp_f32 v185, v185
v_mfma_f32_16x16x32_bf16 v[80:83], a[56:59], a[140:143], v[80:83]
v_fma_f32 v182, v182, v255, v255
v_fma_f32 v183, v183, v255, v255
v_mfma_f32_16x16x32_bf16 v[84:87], a[60:63], a[136:139], v[84:87]
v_fma_f32 v184, v184, v255, v255
v_fma_f32 v185, v185, v255, v255
v_mfma_f32_16x16x32_bf16 v[88:91], a[60:63], a[140:143], v[88:91]
v_rcp_f32 v182, v182
v_mfma_f32_16x16x32_bf16 v[92:95], a[64:67], a[136:139], v[92:95]
buffer_load_dwordx4 v1, s[8:11], s60 offen offset:0 sc1 lds
v_mfma_f32_16x16x32_bf16 v[96:99], a[64:67], a[140:143], v[96:99]
v_rcp_f32 v183, v183
v_mfma_f32_16x16x32_bf16 v[100:103], a[68:71], a[136:139], v[100:103]
v_mfma_f32_16x16x32_bf16 v[104:107], a[68:71], a[140:143], v[104:107]
s_waitcnt lgkmcnt(0)
v_mfma_f32_16x16x32_bf16 v[36:39], a[0:3], a[144:147], v[36:39]
ds_read_b128 a[36:39], v190 offset:9216
buffer_load_dwordx4 v1, s[8:11], s60 offen offset:1024 sc1 lds
v_mfma_f32_16x16x32_bf16 v[40:43], a[0:3], a[148:151], v[40:43]
ds_read_b128 a[40:43], v190 offset:10240
v_mfma_f32_16x16x32_bf16 v[44:47], a[4:7], a[144:147], v[44:47]
ds_read_b128 a[44:47], v190 offset:11264
buffer_load_dwordx4 v1, s[8:11], s60 offen offset:2048 sc1 lds
v_mfma_f32_16x16x32_bf16 v[48:51], a[4:7], a[148:151], v[48:51]
ds_read_b128 a[48:51], v190 offset:12288
v_mfma_f32_16x16x32_bf16 v[52:55], a[8:11], a[144:147], v[52:55]
ds_read_b128 a[52:55], v190 offset:13312
v_mfma_f32_16x16x32_bf16 v[56:59], a[8:11], a[148:151], v[56:59]
ds_read_b128 a[56:59], v190 offset:14336
buffer_load_dwordx4 v1, s[8:11], s60 offen offset:3072 sc1 lds
v_mfma_f32_16x16x32_bf16 v[60:63], a[12:15], a[144:147], v[60:63]
ds_read_b128 a[60:63], v190 offset:15360
v_mfma_f32_16x16x32_bf16 v[64:67], a[12:15], a[148:151], v[64:67]
ds_read_b128 a[64:67], v190 offset:16384
v_mfma_f32_16x16x32_bf16 v[68:71], a[16:19], a[144:147], v[68:71]
ds_read_b128 a[68:71], v190 offset:17408
s_add_u32 m0, s63, 143360
v_mfma_f32_16x16x32_bf16 v[72:75], a[16:19], a[148:151], v[72:75]
s_add_u32 s61, s61, 36864
v_rcp_f32 v184, v184
v_mfma_f32_16x16x32_bf16 v[76:79], a[20:23], a[144:147], v[76:79]
v_rcp_f32 v185, v185
v_mfma_f32_16x16x32_bf16 v[80:83], a[20:23], a[148:151], v[80:83]
v_mul_f32 v156, v156, v182
v_mul_f32 v157, v157, v183
v_mfma_f32_16x16x32_bf16 v[84:87], a[24:27], a[144:147], v[84:87]
v_mul_f32 v158, v158, v184
v_mul_f32 v159, v159, v185
v_mfma_f32_16x16x32_bf16 v[88:91], a[24:27], a[148:151], v[88:91]
v_permlane16_swap_b32 v148, v152
v_mfma_f32_16x16x32_bf16 v[92:95], a[28:31], a[144:147], v[92:95]
buffer_load_dwordx4 v1, s[8:11], s61 offen offset:0 sc1 lds
v_mfma_f32_16x16x32_bf16 v[96:99], a[28:31], a[148:151], v[96:99]
v_permlane16_swap_b32 v149, v153
v_mfma_f32_16x16x32_bf16 v[100:103], a[32:35], a[144:147], v[100:103]
v_permlane16_swap_b32 v150, v154
v_mfma_f32_16x16x32_bf16 v[104:107], a[32:35], a[148:151], v[104:107]
s_waitcnt vmcnt(22)
s_waitcnt lgkmcnt(0)
v_mfma_f32_16x16x32_bf16 v[36:39], a[36:39], a[152:155], v[36:39]
ds_read_b128 a[0:3], v190 offset:18432
s_add_u32 m0, s62, 147456
v_mfma_f32_16x16x32_bf16 v[40:43], a[36:39], a[156:159], v[40:43]
ds_read_b128 a[4:7], v190 offset:19456
v_mfma_f32_16x16x32_bf16 v[44:47], a[40:43], a[152:155], v[44:47]
ds_read_b128 a[8:11], v190 offset:20480
s_add_u32 s60, s60, 20480
v_mfma_f32_16x16x32_bf16 v[48:51], a[40:43], a[156:159], v[48:51]
ds_read_b128 a[12:15], v190 offset:21504
v_mfma_f32_16x16x32_bf16 v[52:55], a[44:47], a[152:155], v[52:55]
ds_read_b128 a[16:19], v190 offset:22528
v_mfma_f32_16x16x32_bf16 v[56:59], a[44:47], a[156:159], v[56:59]
ds_read_b128 a[20:23], v190 offset:23552
buffer_load_dwordx4 v1, s[8:11], s60 offen offset:0 sc1 lds
v_mfma_f32_16x16x32_bf16 v[60:63], a[48:51], a[152:155], v[60:63]
ds_read_b128 a[24:27], v190 offset:24576
v_mfma_f32_16x16x32_bf16 v[64:67], a[48:51], a[156:159], v[64:67]
ds_read_b128 a[28:31], v190 offset:25600
v_mfma_f32_16x16x32_bf16 v[68:71], a[52:55], a[152:155], v[68:71]
ds_read_b128 a[32:35], v190 offset:26624
buffer_load_dwordx4 v1, s[8:11], s60 offen offset:1024 sc1 lds
v_mfma_f32_16x16x32_bf16 v[72:75], a[52:55], a[156:159], v[72:75]
v_permlane16_swap_b32 v151, v155
v_mfma_f32_16x16x32_bf16 v[76:79], a[56:59], a[152:155], v[76:79]
v_mul_f32 v186, v160, v160
v_mul_f32 v187, v161, v161
v_mfma_f32_16x16x32_bf16 v[80:83], a[56:59], a[156:159], v[80:83]
buffer_load_dwordx4 v1, s[8:11], s60 offen offset:2048 sc1 lds
v_mul_f32 v188, v162, v162
v_mfma_f32_16x16x32_bf16 v[84:87], a[60:63], a[152:155], v[84:87]
v_mul_f32 v189, v163, v163
v_fma_f32 v186, v186, v254, v253
v_mfma_f32_16x16x32_bf16 v[88:91], a[60:63], a[156:159], v[88:91]
v_fma_f32 v187, v187, v254, v253
v_fma_f32 v188, v188, v254, v253
v_mfma_f32_16x16x32_bf16 v[92:95], a[64:67], a[152:155], v[92:95]
buffer_load_dwordx4 v1, s[8:11], s60 offen offset:3072 sc1 lds
v_fma_f32 v189, v189, v254, v253
v_mfma_f32_16x16x32_bf16 v[96:99], a[64:67], a[156:159], v[96:99]
v_mul_f32 v186, v186, v160
v_mfma_f32_16x16x32_bf16 v[100:103], a[68:71], a[152:155], v[100:103]
v_mfma_f32_16x16x32_bf16 v[104:107], a[68:71], a[156:159], v[104:107]
v_mul_f32 v187, v187, v161
s_waitcnt lgkmcnt(0)
v_mfma_f32_16x16x32_bf16 v[36:39], a[0:3], a[160:163], v[36:39]
ds_read_b128 a[36:39], v190 offset:27648
s_add_u32 s52, s52, 4096
v_mfma_f32_16x16x32_bf16 v[40:43], a[0:3], a[164:167], v[40:43]
ds_read_b128 a[40:43], v190 offset:28672
v_mul_f32 v188, v188, v162
v_mfma_f32_16x16x32_bf16 v[44:47], a[4:7], a[160:163], v[44:47]
ds_read_b128 a[44:47], v190 offset:29696
v_mul_f32 v189, v189, v163
v_mfma_f32_16x16x32_bf16 v[48:51], a[4:7], a[164:167], v[48:51]
ds_read_b128 a[48:51], v190 offset:30720
buffer_load_dwordx4 a[208:211], v1, s[4:7], s52 offen offset:0 sc1
v_mfma_f32_16x16x32_bf16 v[52:55], a[8:11], a[160:163], v[52:55]
ds_read_b128 a[52:55], v190 offset:31744
v_mfma_f32_16x16x32_bf16 v[56:59], a[8:11], a[164:167], v[56:59]
ds_read_b128 a[56:59], v190 offset:32768
v_mfma_f32_16x16x32_bf16 v[60:63], a[12:15], a[160:163], v[60:63]
ds_read_b128 a[60:63], v190 offset:33792
buffer_load_dwordx4 a[212:215], v9, s[4:7], s52 offen offset:0 sc1
v_mfma_f32_16x16x32_bf16 v[64:67], a[12:15], a[164:167], v[64:67]
ds_read_b128 a[64:67], v190 offset:34816
v_mfma_f32_16x16x32_bf16 v[68:71], a[16:19], a[160:163], v[68:71]
ds_read_b128 a[68:71], v190 offset:35840
v_mfma_f32_16x16x32_bf16 v[72:75], a[16:19], a[164:167], v[72:75]
v_exp_f32 v186, v186
v_mfma_f32_16x16x32_bf16 v[76:79], a[20:23], a[160:163], v[76:79]
buffer_load_dwordx4 a[216:219], v1, s[4:7], s52 offen offset:1024 sc1
v_mfma_f32_16x16x32_bf16 v[80:83], a[20:23], a[164:167], v[80:83]
v_exp_f32 v187, v187
v_mfma_f32_16x16x32_bf16 v[84:87], a[24:27], a[160:163], v[84:87]
v_exp_f32 v188, v188
v_mfma_f32_16x16x32_bf16 v[88:91], a[24:27], a[164:167], v[88:91]
buffer_load_dwordx4 a[220:223], v9, s[4:7], s52 offen offset:1024 sc1
v_mfma_f32_16x16x32_bf16 v[92:95], a[28:31], a[160:163], v[92:95]
v_exp_f32 v189, v189
v_mfma_f32_16x16x32_bf16 v[96:99], a[28:31], a[164:167], v[96:99]
v_fma_f32 v186, v186, v255, v255
v_mfma_f32_16x16x32_bf16 v[100:103], a[32:35], a[160:163], v[100:103]
v_fma_f32 v187, v187, v255, v255
v_mfma_f32_16x16x32_bf16 v[104:107], a[32:35], a[164:167], v[104:107]
s_waitcnt vmcnt(17)
s_waitcnt lgkmcnt(0)
s_barrier
v_mfma_f32_16x16x32_bf16 v[36:39], a[36:39], a[168:171], v[36:39]
ds_read_b128 a[0:3], v191 offset:0
s_add_u32 m0, s62, 53248
v_mfma_f32_16x16x32_bf16 v[40:43], a[36:39], a[172:175], v[40:43]
ds_read_b128 a[4:7], v191 offset:1024
v_fma_f32 v188, v188, v255, v255
v_mfma_f32_16x16x32_bf16 v[44:47], a[40:43], a[168:171], v[44:47]
ds_read_b128 a[8:11], v191 offset:2048
s_add_u32 s60, s60, 16384
v_mfma_f32_16x16x32_bf16 v[48:51], a[40:43], a[172:175], v[48:51]
ds_read_b128 a[12:15], v191 offset:3072
v_fma_f32 v189, v189, v255, v255
v_mfma_f32_16x16x32_bf16 v[52:55], a[44:47], a[168:171], v[52:55]
ds_read_b128 a[16:19], v191 offset:4096
v_mfma_f32_16x16x32_bf16 v[56:59], a[44:47], a[172:175], v[56:59]
ds_read_b128 a[20:23], v191 offset:5120
buffer_load_dwordx4 v1, s[8:11], s60 offen offset:0 sc1 lds
v_mfma_f32_16x16x32_bf16 v[60:63], a[48:51], a[168:171], v[60:63]
ds_read_b128 a[24:27], v191 offset:6144
v_mfma_f32_16x16x32_bf16 v[64:67], a[48:51], a[172:175], v[64:67]
ds_read_b128 a[28:31], v191 offset:7168
v_mfma_f32_16x16x32_bf16 v[68:71], a[52:55], a[168:171], v[68:71]
ds_read_b128 a[32:35], v191 offset:8192
buffer_load_dwordx4 v1, s[8:11], s60 offen offset:1024 sc1 lds
v_mfma_f32_16x16x32_bf16 v[72:75], a[52:55], a[172:175], v[72:75]
v_rcp_f32 v186, v186
v_mfma_f32_16x16x32_bf16 v[76:79], a[56:59], a[168:171], v[76:79]
v_rcp_f32 v187, v187
v_mfma_f32_16x16x32_bf16 v[80:83], a[56:59], a[172:175], v[80:83]
buffer_load_dwordx4 v1, s[8:11], s60 offen offset:2048 sc1 lds
v_mfma_f32_16x16x32_bf16 v[84:87], a[60:63], a[168:171], v[84:87]
v_rcp_f32 v188, v188
v_mfma_f32_16x16x32_bf16 v[88:91], a[60:63], a[172:175], v[88:91]
v_rcp_f32 v189, v189
v_mfma_f32_16x16x32_bf16 v[92:95], a[64:67], a[168:171], v[92:95]
buffer_load_dwordx4 v1, s[8:11], s60 offen offset:3072 sc1 lds
v_mul_f32 v160, v160, v186
v_mfma_f32_16x16x32_bf16 v[96:99], a[64:67], a[172:175], v[96:99]
v_mul_f32 v161, v161, v187
v_mfma_f32_16x16x32_bf16 v[100:103], a[68:71], a[168:171], v[100:103]
v_mfma_f32_16x16x32_bf16 v[104:107], a[68:71], a[172:175], v[104:107]
v_mul_f32 v162, v162, v188
s_waitcnt lgkmcnt(0)
v_mfma_f32_16x16x32_bf16 v[36:39], a[0:3], a[176:179], v[36:39]
ds_read_b128 a[36:39], v191 offset:9216
s_add_u32 m0, s63, 69632
v_mfma_f32_16x16x32_bf16 v[40:43], a[0:3], a[180:183], v[40:43]
ds_read_b128 a[40:43], v191 offset:10240
v_mul_f32 v163, v163, v189
v_mfma_f32_16x16x32_bf16 v[44:47], a[4:7], a[176:179], v[44:47]
ds_read_b128 a[44:47], v191 offset:11264
s_add_u32 s61, s61, 36864
v_mfma_f32_16x16x32_bf16 v[48:51], a[4:7], a[180:183], v[48:51]
ds_read_b128 a[48:51], v191 offset:12288
v_mul_f32 v182, v164, v164
v_mfma_f32_16x16x32_bf16 v[52:55], a[8:11], a[176:179], v[52:55]
ds_read_b128 a[52:55], v191 offset:13312
buffer_load_dwordx4 v1, s[8:11], s61 offen offset:0 sc1 lds
v_mfma_f32_16x16x32_bf16 v[56:59], a[8:11], a[180:183], v[56:59]
ds_read_b128 a[56:59], v191 offset:14336
v_mul_f32 v183, v165, v165
v_mfma_f32_16x16x32_bf16 v[60:63], a[12:15], a[176:179], v[60:63]
ds_read_b128 a[60:63], v191 offset:15360
s_add_u32 m0, s62, 73728
v_mfma_f32_16x16x32_bf16 v[64:67], a[12:15], a[180:183], v[64:67]
ds_read_b128 a[64:67], v191 offset:16384
v_mul_f32 v184, v166, v166
v_mfma_f32_16x16x32_bf16 v[68:71], a[16:19], a[176:179], v[68:71]
ds_read_b128 a[68:71], v191 offset:17408
s_add_u32 s60, s60, 20480
v_mfma_f32_16x16x32_bf16 v[72:75], a[16:19], a[180:183], v[72:75]
v_mul_f32 v185, v167, v167
v_fma_f32 v182, v182, v254, v253
v_mfma_f32_16x16x32_bf16 v[76:79], a[20:23], a[176:179], v[76:79]
buffer_load_dwordx4 v1, s[8:11], s60 offen offset:0 sc1 lds
v_fma_f32 v183, v183, v254, v253
v_mfma_f32_16x16x32_bf16 v[80:83], a[20:23], a[180:183], v[80:83]
v_fma_f32 v184, v184, v254, v253
v_mfma_f32_16x16x32_bf16 v[84:87], a[24:27], a[176:179], v[84:87]
buffer_load_dwordx4 v1, s[8:11], s60 offen offset:1024 sc1 lds
v_fma_f32 v185, v185, v254, v253
v_mfma_f32_16x16x32_bf16 v[88:91], a[24:27], a[180:183], v[88:91]
v_mul_f32 v182, v182, v164
v_mfma_f32_16x16x32_bf16 v[92:95], a[28:31], a[176:179], v[92:95]
buffer_load_dwordx4 v1, s[8:11], s60 offen offset:2048 sc1 lds
v_mul_f32 v183, v183, v165
v_mfma_f32_16x16x32_bf16 v[96:99], a[28:31], a[180:183], v[96:99]
v_mfma_f32_16x16x32_bf16 v[100:103], a[32:35], a[176:179], v[100:103]
v_mul_f32 v184, v184, v166
v_mfma_f32_16x16x32_bf16 v[104:107], a[32:35], a[180:183], v[104:107]
s_waitcnt vmcnt(21)
s_waitcnt lgkmcnt(0)
v_mfma_f32_16x16x32_bf16 v[36:39], a[36:39], a[184:187], v[36:39]
ds_read_b128 a[0:3], v191 offset:18432
buffer_load_dwordx4 v1, s[8:11], s60 offen offset:3072 sc1 lds
v_mfma_f32_16x16x32_bf16 v[40:43], a[36:39], a[188:191], v[40:43]
ds_read_b128 a[4:7], v191 offset:19456
v_mul_f32 v185, v185, v167
v_mfma_f32_16x16x32_bf16 v[44:47], a[40:43], a[184:187], v[44:47]
ds_read_b128 a[8:11], v191 offset:20480
v_mfma_f32_16x16x32_bf16 v[48:51], a[40:43], a[188:191], v[48:51]
ds_read_b128 a[12:15], v191 offset:21504
v_mfma_f32_16x16x32_bf16 v[52:55], a[44:47], a[184:187], v[52:55]
ds_read_b128 a[16:19], v191 offset:22528
buffer_load_dwordx4 a[224:227], v1, s[4:7], s52 offen offset:2048 sc1
v_mfma_f32_16x16x32_bf16 v[56:59], a[44:47], a[188:191], v[56:59]
ds_read_b128 a[20:23], v191 offset:23552
v_mfma_f32_16x16x32_bf16 v[60:63], a[48:51], a[184:187], v[60:63]
ds_read_b128 a[24:27], v191 offset:24576
v_mfma_f32_16x16x32_bf16 v[64:67], a[48:51], a[188:191], v[64:67]
ds_read_b128 a[28:31], v191 offset:25600
v_mfma_f32_16x16x32_bf16 v[68:71], a[52:55], a[184:187], v[68:71]
ds_read_b128 a[32:35], v191 offset:26624
buffer_load_dwordx4 a[228:231], v9, s[4:7], s52 offen offset:2048 sc1
v_mfma_f32_16x16x32_bf16 v[72:75], a[52:55], a[188:191], v[72:75]
v_exp_f32 v182, v182
v_mfma_f32_16x16x32_bf16 v[76:79], a[56:59], a[184:187], v[76:79]
v_exp_f32 v183, v183
v_mfma_f32_16x16x32_bf16 v[80:83], a[56:59], a[188:191], v[80:83]
v_exp_f32 v184, v184
v_mfma_f32_16x16x32_bf16 v[84:87], a[60:63], a[184:187], v[84:87]
buffer_load_dwordx4 a[232:235], v1, s[4:7], s52 offen offset:3072 sc1
v_mfma_f32_16x16x32_bf16 v[88:91], a[60:63], a[188:191], v[88:91]
v_exp_f32 v185, v185
v_mfma_f32_16x16x32_bf16 v[92:95], a[64:67], a[184:187], v[92:95]
v_fma_f32 v182, v182, v255, v255
v_fma_f32 v183, v183, v255, v255
v_mfma_f32_16x16x32_bf16 v[96:99], a[64:67], a[188:191], v[96:99]
v_fma_f32 v184, v184, v255, v255
v_mfma_f32_16x16x32_bf16 v[100:103], a[68:71], a[184:187], v[100:103]
v_mfma_f32_16x16x32_bf16 v[104:107], a[68:71], a[188:191], v[104:107]
v_fma_f32 v185, v185, v255, v255
s_waitcnt lgkmcnt(0)
v_mfma_f32_16x16x32_bf16 v[36:39], a[0:3], a[192:195], v[36:39]
ds_read_b128 a[36:39], v191 offset:27648
buffer_load_dwordx4 a[236:239], v9, s[4:7], s52 offen offset:3072 sc1
v_mfma_f32_16x16x32_bf16 v[40:43], a[0:3], a[196:199], v[40:43]
ds_read_b128 a[40:43], v191 offset:28672
v_mfma_f32_16x16x32_bf16 v[44:47], a[4:7], a[192:195], v[44:47]
ds_read_b128 a[44:47], v191 offset:29696
v_mfma_f32_16x16x32_bf16 v[48:51], a[4:7], a[196:199], v[48:51]
ds_read_b128 a[48:51], v191 offset:30720
s_add_u32 s52, s52, 4096
v_mfma_f32_16x16x32_bf16 v[52:55], a[8:11], a[192:195], v[52:55]
ds_read_b128 a[52:55], v191 offset:31744
v_mfma_f32_16x16x32_bf16 v[56:59], a[8:11], a[196:199], v[56:59]
ds_read_b128 a[56:59], v191 offset:32768
v_mfma_f32_16x16x32_bf16 v[60:63], a[12:15], a[192:195], v[60:63]
ds_read_b128 a[60:63], v191 offset:33792
buffer_load_dwordx4 a[240:243], v1, s[4:7], s52 offen offset:0 sc1
v_mfma_f32_16x16x32_bf16 v[64:67], a[12:15], a[196:199], v[64:67]
ds_read_b128 a[64:67], v191 offset:34816
v_mfma_f32_16x16x32_bf16 v[68:71], a[16:19], a[192:195], v[68:71]
ds_read_b128 a[68:71], v191 offset:35840
v_mfma_f32_16x16x32_bf16 v[72:75], a[16:19], a[196:199], v[72:75]
v_rcp_f32 v182, v182
v_mfma_f32_16x16x32_bf16 v[76:79], a[20:23], a[192:195], v[76:79]
buffer_load_dwordx4 a[244:247], v9, s[4:7], s52 offen offset:0 sc1
v_mfma_f32_16x16x32_bf16 v[80:83], a[20:23], a[196:199], v[80:83]
v_rcp_f32 v183, v183
v_mfma_f32_16x16x32_bf16 v[84:87], a[24:27], a[192:195], v[84:87]
v_rcp_f32 v184, v184
v_mfma_f32_16x16x32_bf16 v[88:91], a[24:27], a[196:199], v[88:91]
buffer_load_dwordx4 a[248:251], v1, s[4:7], s52 offen offset:1024 sc1
v_mfma_f32_16x16x32_bf16 v[92:95], a[28:31], a[192:195], v[92:95]
v_rcp_f32 v185, v185
v_mfma_f32_16x16x32_bf16 v[96:99], a[28:31], a[196:199], v[96:99]
v_mul_f32 v164, v164, v182
v_mul_f32 v165, v165, v183
v_mfma_f32_16x16x32_bf16 v[100:103], a[32:35], a[192:195], v[100:103]
v_mul_f32 v166, v166, v184
v_mul_f32 v167, v167, v185
v_mfma_f32_16x16x32_bf16 v[104:107], a[32:35], a[196:199], v[104:107]
s_waitcnt vmcnt(16)
s_waitcnt lgkmcnt(0)
s_barrier
v_mfma_f32_16x16x32_bf16 v[36:39], a[36:39], a[200:203], v[36:39]
ds_read_b128 a[0:3], v192 offset:0
buffer_load_dwordx4 a[252:255], v9, s[4:7], s52 offen offset:1024 sc1
v_mfma_f32_16x16x32_bf16 v[40:43], a[36:39], a[204:207], v[40:43]
ds_read_b128 a[4:7], v192 offset:1024
v_mfma_f32_16x16x32_bf16 v[44:47], a[40:43], a[200:203], v[44:47]
ds_read_b128 a[8:11], v192 offset:2048
s_add_u32 m0, s62, 90112
v_mfma_f32_16x16x32_bf16 v[48:51], a[40:43], a[204:207], v[48:51]
ds_read_b128 a[12:15], v192 offset:3072
v_mfma_f32_16x16x32_bf16 v[52:55], a[44:47], a[200:203], v[52:55]
ds_read_b128 a[16:19], v192 offset:4096
v_mfma_f32_16x16x32_bf16 v[56:59], a[44:47], a[204:207], v[56:59]
ds_read_b128 a[20:23], v192 offset:5120
s_add_u32 s60, s60, 16384
v_mfma_f32_16x16x32_bf16 v[60:63], a[48:51], a[200:203], v[60:63]
ds_read_b128 a[24:27], v192 offset:6144
v_mfma_f32_16x16x32_bf16 v[64:67], a[48:51], a[204:207], v[64:67]
ds_read_b128 a[28:31], v192 offset:7168
v_mfma_f32_16x16x32_bf16 v[68:71], a[52:55], a[200:203], v[68:71]
ds_read_b128 a[32:35], v192 offset:8192
buffer_load_dwordx4 v1, s[8:11], s60 offen offset:0 sc1 lds
v_mfma_f32_16x16x32_bf16 v[72:75], a[52:55], a[204:207], v[72:75]
v_permlane16_swap_b32 v156, v160
v_mfma_f32_16x16x32_bf16 v[76:79], a[56:59], a[200:203], v[76:79]
v_permlane16_swap_b32 v157, v161
v_mfma_f32_16x16x32_bf16 v[80:83], a[56:59], a[204:207], v[80:83]
buffer_load_dwordx4 v1, s[8:11], s60 offen offset:1024 sc1 lds
v_mfma_f32_16x16x32_bf16 v[84:87], a[60:63], a[200:203], v[84:87]
v_permlane16_swap_b32 v158, v162
v_mfma_f32_16x16x32_bf16 v[88:91], a[60:63], a[204:207], v[88:91]
v_permlane16_swap_b32 v159, v163
v_mfma_f32_16x16x32_bf16 v[92:95], a[64:67], a[200:203], v[92:95]
buffer_load_dwordx4 v1, s[8:11], s60 offen offset:2048 sc1 lds
v_mul_f32 v186, v168, v168
v_mfma_f32_16x16x32_bf16 v[96:99], a[64:67], a[204:207], v[96:99]
v_mul_f32 v187, v169, v169
v_mul_f32 v188, v170, v170
v_mfma_f32_16x16x32_bf16 v[100:103], a[68:71], a[200:203], v[100:103]
v_mul_f32 v189, v171, v171
v_mfma_f32_16x16x32_bf16 v[104:107], a[68:71], a[204:207], v[104:107]
v_fma_f32 v186, v186, v254, v253
s_waitcnt lgkmcnt(0)
v_mfma_f32_16x16x32_bf16 v[36:39], a[0:3], a[208:211], v[36:39]
ds_read_b128 a[36:39], v192 offset:9216
buffer_load_dwordx4 v1, s[8:11], s60 offen offset:3072 sc1 lds
v_mfma_f32_16x16x32_bf16 v[40:43], a[0:3], a[212:215], v[40:43]
ds_read_b128 a[40:43], v192 offset:10240
v_fma_f32 v187, v187, v254, v253
v_mfma_f32_16x16x32_bf16 v[44:47], a[4:7], a[208:211], v[44:47]
ds_read_b128 a[44:47], v192 offset:11264
s_add_u32 m0, s63, 106496
v_mfma_f32_16x16x32_bf16 v[48:51], a[4:7], a[212:215], v[48:51]
ds_read_b128 a[48:51], v192 offset:12288
v_fma_f32 v188, v188, v254, v253
v_mfma_f32_16x16x32_bf16 v[52:55], a[8:11], a[208:211], v[52:55]
ds_read_b128 a[52:55], v192 offset:13312
s_add_u32 s61, s61, 36864
v_mfma_f32_16x16x32_bf16 v[56:59], a[8:11], a[212:215], v[56:59]
ds_read_b128 a[56:59], v192 offset:14336
v_fma_f32 v189, v189, v254, v253
v_mfma_f32_16x16x32_bf16 v[60:63], a[12:15], a[208:211], v[60:63]
ds_read_b128 a[60:63], v192 offset:15360
buffer_load_dwordx4 v1, s[8:11], s61 offen offset:0 sc1 lds
v_mfma_f32_16x16x32_bf16 v[64:67], a[12:15], a[212:215], v[64:67]
ds_read_b128 a[64:67], v192 offset:16384
v_mul_f32 v186, v186, v168
v_mfma_f32_16x16x32_bf16 v[68:71], a[16:19], a[208:211], v[68:71]
ds_read_b128 a[68:71], v192 offset:17408
s_add_u32 m0, s62, 110592
v_mfma_f32_16x16x32_bf16 v[72:75], a[16:19], a[212:215], v[72:75]
s_add_u32 s60, s60, 20480
v_mul_f32 v187, v187, v169
v_mul_f32 v188, v188, v170
v_mfma_f32_16x16x32_bf16 v[76:79], a[20:23], a[208:211], v[76:79]
v_mul_f32 v189, v189, v171
v_mfma_f32_16x16x32_bf16 v[80:83], a[20:23], a[212:215], v[80:83]
v_exp_f32 v186, v186
v_mfma_f32_16x16x32_bf16 v[84:87], a[24:27], a[208:211], v[84:87]
buffer_load_dwordx4 v1, s[8:11], s60 offen offset:0 sc1 lds
v_mfma_f32_16x16x32_bf16 v[88:91], a[24:27], a[212:215], v[88:91]
v_exp_f32 v187, v187
v_mfma_f32_16x16x32_bf16 v[92:95], a[28:31], a[208:211], v[92:95]
buffer_load_dwordx4 v1, s[8:11], s60 offen offset:1024 sc1 lds
v_mfma_f32_16x16x32_bf16 v[96:99], a[28:31], a[212:215], v[96:99]
v_mfma_f32_16x16x32_bf16 v[100:103], a[32:35], a[208:211], v[100:103]
v_exp_f32 v188, v188
v_mfma_f32_16x16x32_bf16 v[104:107], a[32:35], a[212:215], v[104:107]
s_waitcnt vmcnt(11)
s_waitcnt lgkmcnt(0)
v_mfma_f32_16x16x32_bf16 v[36:39], a[36:39], a[216:219], v[36:39]
ds_read_b128 a[0:3], v192 offset:18432
buffer_load_dwordx4 v1, s[8:11], s60 offen offset:2048 sc1 lds
v_mfma_f32_16x16x32_bf16 v[40:43], a[36:39], a[220:223], v[40:43]
ds_read_b128 a[4:7], v192 offset:19456
v_mfma_f32_16x16x32_bf16 v[44:47], a[40:43], a[216:219], v[44:47]
ds_read_b128 a[8:11], v192 offset:20480
v_mfma_f32_16x16x32_bf16 v[48:51], a[40:43], a[220:223], v[48:51]
ds_read_b128 a[12:15], v192 offset:21504
v_mfma_f32_16x16x32_bf16 v[52:55], a[44:47], a[216:219], v[52:55]
ds_read_b128 a[16:19], v192 offset:22528
buffer_load_dwordx4 v1, s[8:11], s60 offen offset:3072 sc1 lds
v_mfma_f32_16x16x32_bf16 v[56:59], a[44:47], a[220:223], v[56:59]
ds_read_b128 a[20:23], v192 offset:23552
v_mfma_f32_16x16x32_bf16 v[60:63], a[48:51], a[216:219], v[60:63]
ds_read_b128 a[24:27], v192 offset:24576
v_mfma_f32_16x16x32_bf16 v[64:67], a[48:51], a[220:223], v[64:67]
ds_read_b128 a[28:31], v192 offset:25600
v_mfma_f32_16x16x32_bf16 v[68:71], a[52:55], a[216:219], v[68:71]
ds_read_b128 a[32:35], v192 offset:26624
buffer_load_dwordx4 a[80:83], v1, s[4:7], s52 offen offset:2048 sc1
v_mfma_f32_16x16x32_bf16 v[72:75], a[52:55], a[220:223], v[72:75]
v_exp_f32 v189, v189
v_mfma_f32_16x16x32_bf16 v[76:79], a[56:59], a[216:219], v[76:79]
v_fma_f32 v186, v186, v255, v255
v_fma_f32 v187, v187, v255, v255
v_mfma_f32_16x16x32_bf16 v[80:83], a[56:59], a[220:223], v[80:83]
v_fma_f32 v188, v188, v255, v255
v_fma_f32 v189, v189, v255, v255
v_mfma_f32_16x16x32_bf16 v[84:87], a[60:63], a[216:219], v[84:87]
buffer_load_dwordx4 a[84:87], v9, s[4:7], s52 offen offset:2048 sc1
v_mfma_f32_16x16x32_bf16 v[88:91], a[60:63], a[220:223], v[88:91]
v_rcp_f32 v186, v186
v_mfma_f32_16x16x32_bf16 v[92:95], a[64:67], a[216:219], v[92:95]
v_rcp_f32 v187, v187
v_mfma_f32_16x16x32_bf16 v[96:99], a[64:67], a[220:223], v[96:99]
v_rcp_f32 v188, v188
v_mfma_f32_16x16x32_bf16 v[100:103], a[68:71], a[216:219], v[100:103]
v_mfma_f32_16x16x32_bf16 v[104:107], a[68:71], a[220:223], v[104:107]
s_waitcnt lgkmcnt(0)
v_mfma_f32_16x16x32_bf16 v[36:39], a[0:3], a[224:227], v[36:39]
ds_read_b128 a[36:39], v192 offset:27648
buffer_load_dwordx4 a[88:91], v1, s[4:7], s52 offen offset:3072 sc1
v_mfma_f32_16x16x32_bf16 v[40:43], a[0:3], a[228:231], v[40:43]
ds_read_b128 a[40:43], v192 offset:28672
s_mov_b32 s37, L_c5-L_pc
v_mfma_f32_16x16x32_bf16 v[44:47], a[4:7], a[224:227], v[44:47]
ds_read_b128 a[44:47], v192 offset:29696
v_mfma_f32_16x16x32_bf16 v[48:51], a[4:7], a[228:231], v[48:51]
ds_read_b128 a[48:51], v192 offset:30720
buffer_load_dwordx4 a[92:95], v9, s[4:7], s52 offen offset:3072 sc1
v_mfma_f32_16x16x32_bf16 v[52:55], a[8:11], a[224:227], v[52:55]
ds_read_b128 a[52:55], v192 offset:31744
buffer_load_dword v15, v14, s[88:91], s37 offen
v_mfma_f32_16x16x32_bf16 v[56:59], a[8:11], a[228:231], v[56:59]
ds_read_b128 a[56:59], v192 offset:32768
v_mfma_f32_16x16x32_bf16 v[60:63], a[12:15], a[224:227], v[60:63]
ds_read_b128 a[60:63], v192 offset:33792
s_add_u32 s52, s52, 4096
v_mfma_f32_16x16x32_bf16 v[64:67], a[12:15], a[228:231], v[64:67]
ds_read_b128 a[64:67], v192 offset:34816
v_mfma_f32_16x16x32_bf16 v[68:71], a[16:19], a[224:227], v[68:71]
ds_read_b128 a[68:71], v192 offset:35840
v_mfma_f32_16x16x32_bf16 v[72:75], a[16:19], a[228:231], v[72:75]
v_rcp_f32 v189, v189
v_mfma_f32_16x16x32_bf16 v[76:79], a[20:23], a[224:227], v[76:79]
buffer_load_dwordx4 a[96:99], v1, s[4:7], s52 offen offset:0 sc1
v_mul_f32 v168, v168, v186
v_mfma_f32_16x16x32_bf16 v[80:83], a[20:23], a[228:231], v[80:83]
v_mul_f32 v169, v169, v187
v_mul_f32 v170, v170, v188
v_mfma_f32_16x16x32_bf16 v[84:87], a[24:27], a[224:227], v[84:87]
v_mul_f32 v171, v171, v189
v_mul_f32 v182, v172, v172
v_mfma_f32_16x16x32_bf16 v[88:91], a[24:27], a[228:231], v[88:91]
buffer_load_dwordx4 a[100:103], v9, s[4:7], s52 offen offset:0 sc1
v_mul_f32 v183, v173, v173
v_mfma_f32_16x16x32_bf16 v[92:95], a[28:31], a[224:227], v[92:95]
v_mul_f32 v184, v174, v174
v_mul_f32 v185, v175, v175
v_mfma_f32_16x16x32_bf16 v[96:99], a[28:31], a[228:231], v[96:99]
v_fma_f32 v182, v182, v254, v253
v_mfma_f32_16x16x32_bf16 v[100:103], a[32:35], a[224:227], v[100:103]
v_fma_f32 v183, v183, v254, v253
v_mfma_f32_16x16x32_bf16 v[104:107], a[32:35], a[228:231], v[104:107]
s_waitcnt vmcnt(16)
s_waitcnt lgkmcnt(0)
s_barrier
v_mfma_f32_16x16x32_bf16 v[36:39], a[36:39], a[232:235], v[36:39]
ds_read_b128 a[0:3], v190 offset:0
buffer_load_dwordx4 a[104:107], v1, s[4:7], s52 offen offset:1024 sc1
v_mfma_f32_16x16x32_bf16 v[40:43], a[36:39], a[236:239], v[40:43]
ds_read_b128 a[4:7], v190 offset:1024
v_fma_f32 v184, v184, v254, v253
v_mfma_f32_16x16x32_bf16 v[44:47], a[40:43], a[232:235], v[44:47]
ds_read_b128 a[8:11], v190 offset:2048
buffer_load_dwordx4 a[108:111], v9, s[4:7], s52 offen offset:1024 sc1
v_mfma_f32_16x16x32_bf16 v[48:51], a[40:43], a[236:239], v[48:51]
ds_read_b128 a[12:15], v190 offset:3072
v_fma_f32 v185, v185, v254, v253
v_mfma_f32_16x16x32_bf16 v[52:55], a[44:47], a[232:235], v[52:55]
ds_read_b128 a[16:19], v190 offset:4096
v_mul_f32 v182, v182, v172
v_mfma_f32_16x16x32_bf16 v[56:59], a[44:47], a[236:239], v[56:59]
ds_read_b128 a[20:23], v190 offset:5120
s_add_u32 m0, s62, 126976
v_mfma_f32_16x16x32_bf16 v[60:63], a[48:51], a[232:235], v[60:63]
ds_read_b128 a[24:27], v190 offset:6144
v_mul_f32 v183, v183, v173
v_mfma_f32_16x16x32_bf16 v[64:67], a[48:51], a[236:239], v[64:67]
ds_read_b128 a[28:31], v190 offset:7168
v_mul_f32 v184, v184, v174
v_mfma_f32_16x16x32_bf16 v[68:71], a[52:55], a[232:235], v[68:71]
ds_read_b128 a[32:35], v190 offset:8192
s_add_u32 s60, s60, 16384
v_mfma_f32_16x16x32_bf16 v[72:75], a[52:55], a[236:239], v[72:75]
v_mul_f32 v185, v185, v175
v_mfma_f32_16x16x32_bf16 v[76:79], a[56:59], a[232:235], v[76:79]
v_exp_f32 v182, v182
v_mfma_f32_16x16x32_bf16 v[80:83], a[56:59], a[236:239], v[80:83]
buffer_load_dwordx4 v1, s[8:11], s60 offen offset:0 sc1 lds
v_mfma_f32_16x16x32_bf16 v[84:87], a[60:63], a[232:235], v[84:87]
v_exp_f32 v183, v183
v_mfma_f32_16x16x32_bf16 v[88:91], a[60:63], a[236:239], v[88:91]
v_mfma_f32_16x16x32_bf16 v[92:95], a[64:67], a[232:235], v[92:95]
buffer_load_dwordx4 v1, s[8:11], s60 offen offset:1024 sc1 lds
v_mfma_f32_16x16x32_bf16 v[96:99], a[64:67], a[236:239], v[96:99]
v_exp_f32 v184, v184
v_mfma_f32_16x16x32_bf16 v[100:103], a[68:71], a[232:235], v[100:103]
v_exp_f32 v185, v185
v_mfma_f32_16x16x32_bf16 v[104:107], a[68:71], a[236:239], v[104:107]
s_waitcnt lgkmcnt(0)
v_mfma_f32_16x16x32_bf16 v[36:39], a[0:3], a[240:243], v[36:39]
ds_read_b128 a[36:39], v190 offset:9216
buffer_load_dwordx4 v1, s[8:11], s60 offen offset:2048 sc1 lds
v_mfma_f32_16x16x32_bf16 v[40:43], a[0:3], a[244:247], v[40:43]
ds_read_b128 a[40:43], v190 offset:10240
v_fma_f32 v182, v182, v255, v255
v_mfma_f32_16x16x32_bf16 v[44:47], a[4:7], a[240:243], v[44:47]
ds_read_b128 a[44:47], v190 offset:11264
buffer_load_dwordx4 v1, s[8:11], s60 offen offset:3072 sc1 lds
v_mfma_f32_16x16x32_bf16 v[48:51], a[4:7], a[244:247], v[48:51]
ds_read_b128 a[48:51], v190 offset:12288
v_fma_f32 v183, v183, v255, v255
v_mfma_f32_16x16x32_bf16 v[52:55], a[8:11], a[240:243], v[52:55]
ds_read_b128 a[52:55], v190 offset:13312
s_add_u32 m0, s63, 143360
v_mfma_f32_16x16x32_bf16 v[56:59], a[8:11], a[244:247], v[56:59]
ds_read_b128 a[56:59], v190 offset:14336
v_fma_f32 v184, v184, v255, v255
v_mfma_f32_16x16x32_bf16 v[60:63], a[12:15], a[240:243], v[60:63]
ds_read_b128 a[60:63], v190 offset:15360
s_add_u32 s61, s61, 36864
v_mfma_f32_16x16x32_bf16 v[64:67], a[12:15], a[244:247], v[64:67]
ds_read_b128 a[64:67], v190 offset:16384
v_fma_f32 v185, v185, v255, v255
v_mfma_f32_16x16x32_bf16 v[68:71], a[16:19], a[240:243], v[68:71]
ds_read_b128 a[68:71], v190 offset:17408
buffer_load_dwordx4 v1, s[8:11], s61 offen offset:0 sc1 lds
v_mfma_f32_16x16x32_bf16 v[72:75], a[16:19], a[244:247], v[72:75]
s_add_u32 m0, s62, 147456
v_rcp_f32 v182, v182
v_mfma_f32_16x16x32_bf16 v[76:79], a[20:23], a[240:243], v[76:79]
s_add_u32 s60, s60, 20480
v_rcp_f32 v183, v183
v_mfma_f32_16x16x32_bf16 v[80:83], a[20:23], a[244:247], v[80:83]
v_mfma_f32_16x16x32_bf16 v[84:87], a[24:27], a[240:243], v[84:87]
v_mfma_f32_16x16x32_bf16 v[88:91], a[24:27], a[244:247], v[88:91]
v_rcp_f32 v184, v184
v_mfma_f32_16x16x32_bf16 v[92:95], a[28:31], a[240:243], v[92:95]
buffer_load_dwordx4 v1, s[8:11], s60 offen offset:0 sc1 lds
v_mfma_f32_16x16x32_bf16 v[96:99], a[28:31], a[244:247], v[96:99]
v_mfma_f32_16x16x32_bf16 v[100:103], a[32:35], a[240:243], v[100:103]
v_rcp_f32 v185, v185
v_mfma_f32_16x16x32_bf16 v[104:107], a[32:35], a[244:247], v[104:107]
s_waitcnt vmcnt(11)
s_waitcnt lgkmcnt(0)
v_mfma_f32_16x16x32_bf16 v[36:39], a[36:39], a[248:251], v[36:39]
ds_read_b128 a[0:3], v190 offset:18432
buffer_load_dwordx4 v1, s[8:11], s60 offen offset:1024 sc1 lds
v_mfma_f32_16x16x32_bf16 v[40:43], a[36:39], a[252:255], v[40:43]
ds_read_b128 a[4:7], v190 offset:19456
v_mul_f32 v172, v172, v182
v_mfma_f32_16x16x32_bf16 v[44:47], a[40:43], a[248:251], v[44:47]
ds_read_b128 a[8:11], v190 offset:20480
v_mul_f32 v173, v173, v183
v_mfma_f32_16x16x32_bf16 v[48:51], a[40:43], a[252:255], v[48:51]
ds_read_b128 a[12:15], v190 offset:21504
v_mul_f32 v174, v174, v184
v_mfma_f32_16x16x32_bf16 v[52:55], a[44:47], a[248:251], v[52:55]
ds_read_b128 a[16:19], v190 offset:22528
buffer_load_dwordx4 v1, s[8:11], s60 offen offset:2048 sc1 lds
v_mfma_f32_16x16x32_bf16 v[56:59], a[44:47], a[252:255], v[56:59]
ds_read_b128 a[20:23], v190 offset:23552
v_mul_f32 v175, v175, v185
v_mfma_f32_16x16x32_bf16 v[60:63], a[48:51], a[248:251], v[60:63]
ds_read_b128 a[24:27], v190 offset:24576
v_mfma_f32_16x16x32_bf16 v[64:67], a[48:51], a[252:255], v[64:67]
ds_read_b128 a[28:31], v190 offset:25600
v_mfma_f32_16x16x32_bf16 v[68:71], a[52:55], a[248:251], v[68:71]
ds_read_b128 a[32:35], v190 offset:26624
buffer_load_dwordx4 v1, s[8:11], s60 offen offset:3072 sc1 lds
v_mfma_f32_16x16x32_bf16 v[72:75], a[52:55], a[252:255], v[72:75]
v_permlane16_swap_b32 v164, v168
v_mfma_f32_16x16x32_bf16 v[76:79], a[56:59], a[248:251], v[76:79]
v_permlane16_swap_b32 v165, v169
v_mfma_f32_16x16x32_bf16 v[80:83], a[56:59], a[252:255], v[80:83]
v_mfma_f32_16x16x32_bf16 v[84:87], a[60:63], a[248:251], v[84:87]
buffer_load_dwordx4 a[112:115], v1, s[4:7], s52 offen offset:2048 sc1
v_mfma_f32_16x16x32_bf16 v[88:91], a[60:63], a[252:255], v[88:91]
v_permlane16_swap_b32 v166, v170
v_mfma_f32_16x16x32_bf16 v[92:95], a[64:67], a[248:251], v[92:95]
v_mfma_f32_16x16x32_bf16 v[96:99], a[64:67], a[252:255], v[96:99]
v_permlane16_swap_b32 v167, v171
v_mfma_f32_16x16x32_bf16 v[100:103], a[68:71], a[248:251], v[100:103]
v_mfma_f32_16x16x32_bf16 v[104:107], a[68:71], a[252:255], v[104:107]
s_waitcnt lgkmcnt(0)
v_mfma_f32_16x16x32_bf16 v[36:39], a[0:3], a[80:83], v[36:39]
ds_read_b128 a[36:39], v190 offset:27648
buffer_load_dwordx4 a[116:119], v9, s[4:7], s52 offen offset:2048 sc1
v_mfma_f32_16x16x32_bf16 v[40:43], a[0:3], a[84:87], v[40:43]
ds_read_b128 a[40:43], v190 offset:28672
v_mul_f32 v186, v176, v176
v_mfma_f32_16x16x32_bf16 v[44:47], a[4:7], a[80:83], v[44:47]
ds_read_b128 a[44:47], v190 offset:29696
v_mul_f32 v187, v177, v177
v_mfma_f32_16x16x32_bf16 v[48:51], a[4:7], a[84:87], v[48:51]
ds_read_b128 a[48:51], v190 offset:30720
buffer_load_dwordx4 a[120:123], v1, s[4:7], s52 offen offset:3072 sc1
v_mfma_f32_16x16x32_bf16 v[52:55], a[8:11], a[80:83], v[52:55]
ds_read_b128 a[52:55], v190 offset:31744
v_mul_f32 v188, v178, v178
v_mfma_f32_16x16x32_bf16 v[56:59], a[8:11], a[84:87], v[56:59]
ds_read_b128 a[56:59], v190 offset:32768
v_mul_f32 v189, v179, v179
v_mfma_f32_16x16x32_bf16 v[60:63], a[12:15], a[80:83], v[60:63]
ds_read_b128 a[60:63], v190 offset:33792
buffer_load_dwordx4 a[124:127], v9, s[4:7], s52 offen offset:3072 sc1
v_mfma_f32_16x16x32_bf16 v[64:67], a[12:15], a[84:87], v[64:67]
ds_read_b128 a[64:67], v190 offset:34816
v_fma_f32 v186, v186, v254, v253
v_mfma_f32_16x16x32_bf16 v[68:71], a[16:19], a[80:83], v[68:71]
ds_read_b128 a[68:71], v190 offset:35840
v_fma_f32 v187, v187, v254, v253
v_mfma_f32_16x16x32_bf16 v[72:75], a[16:19], a[84:87], v[72:75]
s_add_u32 s52, s52, 4096
v_fma_f32 v188, v188, v254, v253
v_mfma_f32_16x16x32_bf16 v[76:79], a[20:23], a[80:83], v[76:79]
v_fma_f32 v189, v189, v254, v253
v_mfma_f32_16x16x32_bf16 v[80:83], a[20:23], a[84:87], v[80:83]
v_mul_f32 v186, v186, v176
v_mfma_f32_16x16x32_bf16 v[84:87], a[24:27], a[80:83], v[84:87]
v_mfma_f32_16x16x32_bf16 v[88:91], a[24:27], a[84:87], v[88:91]
buffer_load_dwordx4 a[128:131], v1, s[4:7], s52 offen offset:0 sc1
v_mul_f32 v187, v187, v177
v_mfma_f32_16x16x32_bf16 v[92:95], a[28:31], a[80:83], v[92:95]
v_mul_f32 v188, v188, v178
v_mfma_f32_16x16x32_bf16 v[96:99], a[28:31], a[84:87], v[96:99]
v_mfma_f32_16x16x32_bf16 v[100:103], a[32:35], a[80:83], v[100:103]
v_mul_f32 v189, v189, v179
v_mfma_f32_16x16x32_bf16 v[104:107], a[32:35], a[84:87], v[104:107]
s_waitcnt vmcnt(14)
s_waitcnt lgkmcnt(0)
s_barrier
v_mfma_f32_16x16x32_bf16 v[36:39], a[36:39], a[88:91], v[36:39]
ds_read_b128 a[0:3], v191 offset:0
buffer_load_dwordx4 a[132:135], v9, s[4:7], s52 offen offset:0 sc1
v_mfma_f32_16x16x32_bf16 v[40:43], a[36:39], a[92:95], v[40:43]
ds_read_b128 a[4:7], v191 offset:1024
v_mfma_f32_16x16x32_bf16 v[44:47], a[40:43], a[88:91], v[44:47]
ds_read_b128 a[8:11], v191 offset:2048
v_mfma_f32_16x16x32_bf16 v[48:51], a[40:43], a[92:95], v[48:51]
ds_read_b128 a[12:15], v191 offset:3072
v_mfma_f32_16x16x32_bf16 v[52:55], a[44:47], a[88:91], v[52:55]
ds_read_b128 a[16:19], v191 offset:4096
buffer_load_dwordx4 a[136:139], v1, s[4:7], s52 offen offset:1024 sc1
v_mfma_f32_16x16x32_bf16 v[56:59], a[44:47], a[92:95], v[56:59]
ds_read_b128 a[20:23], v191 offset:5120
v_mfma_f32_16x16x32_bf16 v[60:63], a[48:51], a[88:91], v[60:63]
ds_read_b128 a[24:27], v191 offset:6144
v_mfma_f32_16x16x32_bf16 v[64:67], a[48:51], a[92:95], v[64:67]
ds_read_b128 a[28:31], v191 offset:7168
v_mfma_f32_16x16x32_bf16 v[68:71], a[52:55], a[88:91], v[68:71]
ds_read_b128 a[32:35], v191 offset:8192
buffer_load_dwordx4 a[140:143], v9, s[4:7], s52 offen offset:1024 sc1
v_mfma_f32_16x16x32_bf16 v[72:75], a[52:55], a[92:95], v[72:75]
v_exp_f32 v186, v186
v_mfma_f32_16x16x32_bf16 v[76:79], a[56:59], a[88:91], v[76:79]
v_exp_f32 v187, v187
v_mfma_f32_16x16x32_bf16 v[80:83], a[56:59], a[92:95], v[80:83]
v_exp_f32 v188, v188
v_mfma_f32_16x16x32_bf16 v[84:87], a[60:63], a[88:91], v[84:87]
buffer_load_dwordx4 a[144:147], v1, s[4:7], s52 offen offset:2048 sc1
v_mfma_f32_16x16x32_bf16 v[88:91], a[60:63], a[92:95], v[88:91]
v_exp_f32 v189, v189
v_mfma_f32_16x16x32_bf16 v[92:95], a[64:67], a[88:91], v[92:95]
v_fma_f32 v186, v186, v255, v255
v_fma_f32 v187, v187, v255, v255
v_mfma_f32_16x16x32_bf16 v[96:99], a[64:67], a[92:95], v[96:99]
v_fma_f32 v188, v188, v255, v255
v_fma_f32 v189, v189, v255, v255
v_mfma_f32_16x16x32_bf16 v[100:103], a[68:71], a[88:91], v[100:103]
v_rcp_f32 v186, v186
v_mfma_f32_16x16x32_bf16 v[104:107], a[68:71], a[92:95], v[104:107]
s_waitcnt lgkmcnt(0)
v_mfma_f32_16x16x32_bf16 v[36:39], a[0:3], a[96:99], v[36:39]
ds_read_b128 a[36:39], v191 offset:9216
buffer_load_dwordx4 a[148:151], v9, s[4:7], s52 offen offset:2048 sc1
v_mfma_f32_16x16x32_bf16 v[40:43], a[0:3], a[100:103], v[40:43]
ds_read_b128 a[40:43], v191 offset:10240
v_mfma_f32_16x16x32_bf16 v[44:47], a[4:7], a[96:99], v[44:47]
ds_read_b128 a[44:47], v191 offset:11264
buffer_load_dwordx4 a[152:155], v1, s[4:7], s52 offen offset:3072 sc1
v_mfma_f32_16x16x32_bf16 v[48:51], a[4:7], a[100:103], v[48:51]
ds_read_b128 a[48:51], v191 offset:12288
v_mfma_f32_16x16x32_bf16 v[52:55], a[8:11], a[96:99], v[52:55]
ds_read_b128 a[52:55], v191 offset:13312
buffer_load_dwordx4 a[156:159], v9, s[4:7], s52 offen offset:3072 sc1
v_mfma_f32_16x16x32_bf16 v[56:59], a[8:11], a[100:103], v[56:59]
ds_read_b128 a[56:59], v191 offset:14336
v_mfma_f32_16x16x32_bf16 v[60:63], a[12:15], a[96:99], v[60:63]
ds_read_b128 a[60:63], v191 offset:15360
v_mfma_f32_16x16x32_bf16 v[64:67], a[12:15], a[100:103], v[64:67]
ds_read_b128 a[64:67], v191 offset:16384
s_mul_i32 s38, s24, 13312
v_mfma_f32_16x16x32_bf16 v[68:71], a[16:19], a[96:99], v[68:71]
ds_read_b128 a[68:71], v191 offset:17408
v_mfma_f32_16x16x32_bf16 v[72:75], a[16:19], a[100:103], v[72:75]
s_add_u32 m0, s38, 0
v_rcp_f32 v187, v187
v_mfma_f32_16x16x32_bf16 v[76:79], a[20:23], a[96:99], v[76:79]
s_add_u32 s39, s38, s83
v_rcp_f32 v188, v188
v_mfma_f32_16x16x32_bf16 v[80:83], a[20:23], a[100:103], v[80:83]
v_rcp_f32 v189, v189
v_mfma_f32_16x16x32_bf16 v[84:87], a[24:27], a[96:99], v[84:87]
v_mul_f32 v176, v176, v186
v_mul_f32 v177, v177, v187
v_mfma_f32_16x16x32_bf16 v[88:91], a[24:27], a[100:103], v[88:91]
v_mul_f32 v178, v178, v188
v_mfma_f32_16x16x32_bf16 v[92:95], a[28:31], a[96:99], v[92:95]
buffer_load_dwordx4 v1, s[4:7], s39 offen offset:0 sc1 lds
v_mul_f32 v179, v179, v189
v_mfma_f32_16x16x32_bf16 v[96:99], a[28:31], a[100:103], v[96:99]
s_lshl_b32 s30, s25, 3
v_mfma_f32_16x16x32_bf16 v[100:103], a[32:35], a[96:99], v[100:103]
s_lshl_b32 s31, s24, 1
v_mfma_f32_16x16x32_bf16 v[104:107], a[32:35], a[100:103], v[104:107]
s_add_u32 s30, s30, s31
s_waitcnt vmcnt(9)
s_waitcnt lgkmcnt(0)
v_mfma_f32_16x16x32_bf16 v[36:39], a[36:39], a[104:107], v[36:39]
ds_read_b128 a[0:3], v191 offset:18432
buffer_load_dwordx4 v1, s[4:7], s39 offen offset:1024 sc1 lds
v_mfma_f32_16x16x32_bf16 v[40:43], a[36:39], a[108:111], v[40:43]
ds_read_b128 a[4:7], v191 offset:19456
v_mfma_f32_16x16x32_bf16 v[44:47], a[40:43], a[104:107], v[44:47]
ds_read_b128 a[8:11], v191 offset:20480
buffer_load_dwordx4 v1, s[4:7], s39 offen offset:2048 sc1 lds
v_mfma_f32_16x16x32_bf16 v[48:51], a[40:43], a[108:111], v[48:51]
ds_read_b128 a[12:15], v191 offset:21504
s_mul_i32 s30, s30, 73728
v_mfma_f32_16x16x32_bf16 v[52:55], a[44:47], a[104:107], v[52:55]
ds_read_b128 a[16:19], v191 offset:22528
s_add_u32 s30, s30, 16777216
v_mfma_f32_16x16x32_bf16 v[56:59], a[44:47], a[108:111], v[56:59]
ds_read_b128 a[20:23], v191 offset:23552
buffer_load_dwordx4 v1, s[4:7], s39 offen offset:3072 sc1 lds
v_mfma_f32_16x16x32_bf16 v[60:63], a[48:51], a[104:107], v[60:63]
ds_read_b128 a[24:27], v191 offset:24576
s_mul_i32 s31, s26, 4608
v_mfma_f32_16x16x32_bf16 v[64:67], a[48:51], a[108:111], v[64:67]
ds_read_b128 a[28:31], v191 offset:25600
s_add_u32 s30, s30, s31
v_mfma_f32_16x16x32_bf16 v[68:71], a[52:55], a[104:107], v[68:71]
ds_read_b128 a[32:35], v191 offset:26624
s_add_u32 m0, m0, 4096
v_mfma_f32_16x16x32_bf16 v[72:75], a[52:55], a[108:111], v[72:75]
s_add_u32 s39, s39, 4096
s_and_b32 s65, s26, 1
s_lshl_b32 s64, s65, 9
v_mfma_f32_16x16x32_bf16 v[76:79], a[56:59], a[104:107], v[76:79]
s_add_u32 s64, s64, s30
v_mfma_f32_16x16x32_bf16 v[80:83], a[56:59], a[108:111], v[80:83]
s_xor_b32 s65, s65, 1
v_mfma_f32_16x16x32_bf16 v[84:87], a[60:63], a[104:107], v[84:87]
s_lshl_b32 s65, s65, 12
v_mfma_f32_16x16x32_bf16 v[88:91], a[60:63], a[108:111], v[88:91]
s_add_u32 s65, s65, s30
v_mfma_f32_16x16x32_bf16 v[92:95], a[64:67], a[104:107], v[92:95]
buffer_load_dwordx4 v1, s[4:7], s39 offen offset:0 sc1 lds
v_mfma_f32_16x16x32_bf16 v[96:99], a[64:67], a[108:111], v[96:99]
v_mfma_f32_16x16x32_bf16 v[100:103], a[68:71], a[104:107], v[100:103]
v_permlane16_swap_b32 v172, v176
v_mfma_f32_16x16x32_bf16 v[104:107], a[68:71], a[108:111], v[104:107]
s_waitcnt lgkmcnt(0)
v_mfma_f32_16x16x32_bf16 v[36:39], a[0:3], a[112:115], v[36:39]
ds_read_b128 a[36:39], v191 offset:27648
buffer_load_dwordx4 v1, s[4:7], s39 offen offset:1024 sc1 lds
v_mfma_f32_16x16x32_bf16 v[40:43], a[0:3], a[116:119], v[40:43]
ds_read_b128 a[40:43], v191 offset:28672
v_mfma_f32_16x16x32_bf16 v[44:47], a[4:7], a[112:115], v[44:47]
ds_read_b128 a[44:47], v191 offset:29696
buffer_load_dwordx4 v1, s[4:7], s39 offen offset:2048 sc1 lds
v_mfma_f32_16x16x32_bf16 v[48:51], a[4:7], a[116:119], v[48:51]
ds_read_b128 a[48:51], v191 offset:30720
v_mfma_f32_16x16x32_bf16 v[52:55], a[8:11], a[112:115], v[52:55]
ds_read_b128 a[52:55], v191 offset:31744
v_mfma_f32_16x16x32_bf16 v[56:59], a[8:11], a[116:119], v[56:59]
ds_read_b128 a[56:59], v191 offset:32768
buffer_load_dwordx4 v1, s[4:7], s39 offen offset:3072 sc1 lds
v_mfma_f32_16x16x32_bf16 v[60:63], a[12:15], a[112:115], v[60:63]
ds_read_b128 a[60:63], v191 offset:33792
v_mfma_f32_16x16x32_bf16 v[64:67], a[12:15], a[116:119], v[64:67]
ds_read_b128 a[64:67], v191 offset:34816
v_mfma_f32_16x16x32_bf16 v[68:71], a[16:19], a[112:115], v[68:71]
ds_read_b128 a[68:71], v191 offset:35840
s_add_u32 m0, m0, 4096
v_mfma_f32_16x16x32_bf16 v[72:75], a[16:19], a[116:119], v[72:75]
s_add_u32 s39, s39, 4096
v_permlane16_swap_b32 v173, v177
v_mfma_f32_16x16x32_bf16 v[76:79], a[20:23], a[112:115], v[76:79]
v_permlane16_swap_b32 v174, v178
v_mfma_f32_16x16x32_bf16 v[80:83], a[20:23], a[116:119], v[80:83]
v_permlane16_swap_b32 v175, v179
v_mfma_f32_16x16x32_bf16 v[84:87], a[24:27], a[112:115], v[84:87]
v_add_u32 v237, 73728, v1
v_and_b32 v236, 1, v3
v_mfma_f32_16x16x32_bf16 v[88:91], a[24:27], a[116:119], v[88:91]
v_mul_u32_u24 v236, 73728, v236
v_mfma_f32_16x16x32_bf16 v[92:95], a[28:31], a[112:115], v[92:95]
buffer_load_dwordx4 v1, s[4:7], s39 offen offset:0 sc1 lds
v_lshrrev_b32 v8, 1, v3
v_mfma_f32_16x16x32_bf16 v[96:99], a[28:31], a[116:119], v[96:99]
v_mfma_f32_16x16x32_bf16 v[100:103], a[32:35], a[112:115], v[100:103]
v_lshl_add_u32 v236, v8, 8, v236
v_mfma_f32_16x16x32_bf16 v[104:107], a[32:35], a[116:119], v[104:107]
s_waitcnt vmcnt(9)
s_waitcnt lgkmcnt(0)
s_barrier
v_mfma_f32_16x16x32_bf16 v[36:39], a[36:39], a[120:123], v[36:39]
ds_read_b128 a[0:3], v192 offset:8192
buffer_load_dwordx4 v1, s[4:7], s39 offen offset:1024 sc1 lds
v_lshl_add_u32 v236, v2, 4, v236
v_mfma_f32_16x16x32_bf16 v[40:43], a[36:39], a[124:127], v[40:43]
ds_read_b128 a[4:7], v192 offset:17408
v_mfma_f32_16x16x32_bf16 v[44:47], a[40:43], a[120:123], v[44:47]
ds_read_b128 a[8:11], v192 offset:26624
buffer_load_dwordx4 v1, s[4:7], s39 offen offset:2048 sc1 lds
v_mfma_f32_16x16x32_bf16 v[48:51], a[40:43], a[124:127], v[48:51]
ds_read_b128 a[12:15], v192 offset:35840
v_mfma_f32_16x16x32_bf16 v[52:55], a[44:47], a[120:123], v[52:55]
ds_read_b128 a[16:19], v192 offset:0
v_mfma_f32_16x16x32_bf16 v[56:59], a[44:47], a[124:127], v[56:59]
ds_read_b128 a[20:23], v192 offset:1024
buffer_load_dwordx4 v1, s[4:7], s39 offen offset:3072 sc1 lds
v_mfma_f32_16x16x32_bf16 v[60:63], a[48:51], a[120:123], v[60:63]
ds_read_b128 a[24:27], v192 offset:9216
v_mfma_f32_16x16x32_bf16 v[64:67], a[48:51], a[124:127], v[64:67]
ds_read_b128 a[28:31], v192 offset:10240
v_mfma_f32_16x16x32_bf16 v[68:71], a[52:55], a[120:123], v[68:71]
ds_read_b128 a[32:35], v192 offset:18432
s_add_u32 m0, m0, 4096
v_mfma_f32_16x16x32_bf16 v[72:75], a[52:55], a[124:127], v[72:75]
s_add_u32 s39, s39, 4096
v_mfma_f32_16x16x32_bf16 v[76:79], a[56:59], a[120:123], v[76:79]
v_mfma_f32_16x16x32_bf16 v[80:83], a[56:59], a[124:127], v[80:83]
v_mfma_f32_16x16x32_bf16 v[84:87], a[60:63], a[120:123], v[84:87]
v_mfma_f32_16x16x32_bf16 v[88:91], a[60:63], a[124:127], v[88:91]
v_mfma_f32_16x16x32_bf16 v[92:95], a[64:67], a[120:123], v[92:95]
buffer_load_dwordx4 v1, s[4:7], s39 offen offset:0 sc1 lds
v_mfma_f32_16x16x32_bf16 v[96:99], a[64:67], a[124:127], v[96:99]
v_mfma_f32_16x16x32_bf16 v[100:103], a[68:71], a[120:123], v[100:103]
v_mfma_f32_16x16x32_bf16 v[104:107], a[68:71], a[124:127], v[104:107]
s_waitcnt lgkmcnt(7)
v_mfma_f32_16x16x32_bf16 v[100:103], a[0:3], a[128:131], v[100:103]
ds_read_b128 a[36:39], v192 offset:19456
v_mfma_f32_16x16x32_bf16 v[104:107], a[0:3], a[132:135], v[104:107]
v_mfma_f32_16x16x32_bf16 v[100:103], a[4:7], a[136:139], v[100:103]
ds_read_b128 a[40:43], v192 offset:27648
v_mfma_f32_16x16x32_bf16 v[104:107], a[4:7], a[140:143], v[104:107]
s_waitcnt lgkmcnt(7)
v_mfma_f32_16x16x32_bf16 v[100:103], a[8:11], a[144:147], v[100:103]
ds_read_b128 a[44:47], v192 offset:28672
v_mfma_f32_16x16x32_bf16 v[104:107], a[8:11], a[148:151], v[104:107]
v_mfma_f32_16x16x32_bf16 v[100:103], a[12:15], a[152:155], v[100:103]
ds_read_b128 a[48:51], v192 offset:2048
v_mfma_f32_16x16x32_bf16 v[104:107], a[12:15], a[156:159], v[104:107]
s_waitcnt lgkmcnt(7)
v_mfma_f32_16x16x32_bf16 v[36:39], a[16:19], a[128:131], v[36:39]
ds_read_b128 a[52:55], v192 offset:3072
v_mfma_f32_16x16x32_bf16 v[40:43], a[16:19], a[132:135], v[40:43]
v_mfma_f32_16x16x32_bf16 v[44:47], a[20:23], a[128:131], v[44:47]
ds_read_b128 a[56:59], v192 offset:11264
v_mfma_f32_16x16x32_bf16 v[48:51], a[20:23], a[132:135], v[48:51]
v_mul_f32 v100, v100, v108
s_waitcnt lgkmcnt(7)
v_mfma_f32_16x16x32_bf16 v[36:39], a[24:27], a[136:139], v[36:39]
ds_read_b128 a[60:63], v192 offset:12288
v_mul_f32 v101, v101, v109
v_mfma_f32_16x16x32_bf16 v[40:43], a[24:27], a[140:143], v[40:43]
v_mul_f32 v102, v102, v110
v_mul_f32 v103, v103, v111
v_mfma_f32_16x16x32_bf16 v[44:47], a[28:31], a[136:139], v[44:47]
ds_read_b128 a[64:67], v192 offset:20480
v_cvt_pk_bf16_f32 v228, v100, v101
v_mfma_f32_16x16x32_bf16 v[48:51], a[28:31], a[140:143], v[48:51]
v_cvt_pk_bf16_f32 v229, v102, v103
s_waitcnt lgkmcnt(7)
v_mfma_f32_16x16x32_bf16 v[36:39], a[32:35], a[144:147], v[36:39]
ds_read_b128 a[68:71], v192 offset:21504
v_mul_f32 v104, v104, v112
v_mfma_f32_16x16x32_bf16 v[40:43], a[32:35], a[148:151], v[40:43]
v_mul_f32 v105, v105, v113
v_mfma_f32_16x16x32_bf16 v[44:47], a[36:39], a[144:147], v[44:47]
ds_read_b128 a[0:3], v192 offset:29696
v_mul_f32 v106, v106, v114
v_mfma_f32_16x16x32_bf16 v[48:51], a[36:39], a[148:151], v[48:51]
v_mul_f32 v107, v107, v115
s_waitcnt lgkmcnt(7)
v_mfma_f32_16x16x32_bf16 v[36:39], a[40:43], a[152:155], v[36:39]
ds_read_b128 a[4:7], v192 offset:30720
v_cvt_pk_bf16_f32 v230, v104, v105
v_mfma_f32_16x16x32_bf16 v[40:43], a[40:43], a[156:159], v[40:43]
v_cvt_pk_bf16_f32 v231, v106, v107
s_nop 0
v_mfma_f32_16x16x32_bf16 v[44:47], a[44:47], a[152:155], v[44:47]
ds_read_b128 a[8:11], v192 offset:4096
v_mfma_f32_16x16x32_bf16 v[48:51], a[44:47], a[156:159], v[48:51]
s_waitcnt lgkmcnt(7)
v_mfma_f32_16x16x32_bf16 v[52:55], a[48:51], a[128:131], v[52:55]
ds_read_b128 a[12:15], v192 offset:5120
v_permlane16_swap_b32 v228, v230
v_mfma_f32_16x16x32_bf16 v[56:59], a[48:51], a[132:135], v[56:59]
v_permlane16_swap_b32 v229, v231
v_mfma_f32_16x16x32_bf16 v[60:63], a[52:55], a[128:131], v[60:63]
ds_read_b128 a[16:19], v192 offset:13312
buffer_store_dwordx4 v[228:231], v236, s[8:11], s65 offen sc1
v_mfma_f32_16x16x32_bf16 v[64:67], a[52:55], a[132:135], v[64:67]
v_mul_f32 v36, v36, v116
s_waitcnt lgkmcnt(7)
v_mfma_f32_16x16x32_bf16 v[52:55], a[56:59], a[136:139], v[52:55]
ds_read_b128 a[20:23], v192 offset:14336
v_mul_f32 v37, v37, v117
v_mfma_f32_16x16x32_bf16 v[56:59], a[56:59], a[140:143], v[56:59]
v_mul_f32 v38, v38, v118
v_mul_f32 v39, v39, v119
v_mfma_f32_16x16x32_bf16 v[60:63], a[60:63], a[136:139], v[60:63]
ds_read_b128 a[24:27], v192 offset:22528
v_cvt_pk_bf16_f32 v196, v36, v37
v_mfma_f32_16x16x32_bf16 v[64:67], a[60:63], a[140:143], v[64:67]
v_cvt_pk_bf16_f32 v197, v38, v39
v_mul_f32 v44, v44, v124
s_waitcnt lgkmcnt(7)
v_mfma_f32_16x16x32_bf16 v[52:55], a[64:67], a[144:147], v[52:55]
ds_read_b128 a[28:31], v192 offset:23552
v_mul_f32 v45, v45, v125
v_mfma_f32_16x16x32_bf16 v[56:59], a[64:67], a[148:151], v[56:59]
v_mul_f32 v46, v46, v126
v_mul_f32 v47, v47, v127
v_mfma_f32_16x16x32_bf16 v[60:63], a[68:71], a[144:147], v[60:63]
ds_read_b128 a[32:35], v192 offset:31744
v_cvt_pk_bf16_f32 v198, v44, v45
v_mfma_f32_16x16x32_bf16 v[64:67], a[68:71], a[148:151], v[64:67]
v_cvt_pk_bf16_f32 v199, v46, v47
s_waitcnt lgkmcnt(7)
v_mfma_f32_16x16x32_bf16 v[52:55], a[0:3], a[152:155], v[52:55]
ds_read_b128 a[36:39], v192 offset:32768
buffer_store_dwordx4 v[196:199], v1, s[8:11], s64 offen offset:0 sc1
v_mul_f32 v40, v40, v120
v_mul_f32 v41, v41, v121
v_mfma_f32_16x16x32_bf16 v[56:59], a[0:3], a[156:159], v[56:59]
v_mul_f32 v42, v42, v122
v_mul_f32 v43, v43, v123
v_mfma_f32_16x16x32_bf16 v[60:63], a[4:7], a[152:155], v[60:63]
ds_read_b128 a[40:43], v192 offset:6144
v_cvt_pk_bf16_f32 v200, v40, v41
v_mfma_f32_16x16x32_bf16 v[64:67], a[4:7], a[156:159], v[64:67]
v_cvt_pk_bf16_f32 v201, v42, v43
v_mul_f32 v48, v48, v128
s_waitcnt lgkmcnt(7)
v_mfma_f32_16x16x32_bf16 v[68:71], a[8:11], a[128:131], v[68:71]
ds_read_b128 a[44:47], v192 offset:7168
v_mul_f32 v49, v49, v129
v_mfma_f32_16x16x32_bf16 v[72:75], a[8:11], a[132:135], v[72:75]
v_mul_f32 v50, v50, v130
v_mul_f32 v51, v51, v131
v_mfma_f32_16x16x32_bf16 v[76:79], a[12:15], a[128:131], v[76:79]
ds_read_b128 a[48:51], v192 offset:15360
v_cvt_pk_bf16_f32 v202, v48, v49
v_cvt_pk_bf16_f32 v203, v50, v51
buffer_store_dwordx4 v[200:203], v237, s[8:11], s64 offen offset:0 sc1
v_mfma_f32_16x16x32_bf16 v[80:83], a[12:15], a[132:135], v[80:83]
v_mul_f32 v52, v52, v132
s_waitcnt lgkmcnt(7)
v_mfma_f32_16x16x32_bf16 v[68:71], a[16:19], a[136:139], v[68:71]
ds_read_b128 a[52:55], v192 offset:16384
v_mul_f32 v53, v53, v133
v_mfma_f32_16x16x32_bf16 v[72:75], a[16:19], a[140:143], v[72:75]
v_mul_f32 v54, v54, v134
v_mul_f32 v55, v55, v135
v_mfma_f32_16x16x32_bf16 v[76:79], a[20:23], a[136:139], v[76:79]
ds_read_b128 a[56:59], v192 offset:24576
v_cvt_pk_bf16_f32 v204, v52, v53
v_mfma_f32_16x16x32_bf16 v[80:83], a[20:23], a[140:143], v[80:83]
v_cvt_pk_bf16_f32 v205, v54, v55
v_mul_f32 v60, v60, v140
s_waitcnt lgkmcnt(7)
v_mfma_f32_16x16x32_bf16 v[68:71], a[24:27], a[144:147], v[68:71]
ds_read_b128 a[60:63], v192 offset:25600
v_mul_f32 v61, v61, v141
v_mfma_f32_16x16x32_bf16 v[72:75], a[24:27], a[148:151], v[72:75]
v_mul_f32 v62, v62, v142
v_mul_f32 v63, v63, v143
v_mfma_f32_16x16x32_bf16 v[76:79], a[28:31], a[144:147], v[76:79]
ds_read_b128 a[64:67], v192 offset:33792
v_cvt_pk_bf16_f32 v206, v60, v61
v_mfma_f32_16x16x32_bf16 v[80:83], a[28:31], a[148:151], v[80:83]
v_cvt_pk_bf16_f32 v207, v62, v63
s_waitcnt lgkmcnt(7)
v_mfma_f32_16x16x32_bf16 v[68:71], a[32:35], a[152:155], v[68:71]
ds_read_b128 a[68:71], v192 offset:34816
buffer_store_dwordx4 v[204:207], v1, s[8:11], s64 offen offset:1024 sc1
v_mul_f32 v56, v56, v136
v_mul_f32 v57, v57, v137
v_mfma_f32_16x16x32_bf16 v[72:75], a[32:35], a[156:159], v[72:75]
v_mul_f32 v58, v58, v138
v_mul_f32 v59, v59, v139
v_mfma_f32_16x16x32_bf16 v[76:79], a[36:39], a[152:155], v[76:79]
v_cvt_pk_bf16_f32 v208, v56, v57
v_cvt_pk_bf16_f32 v209, v58, v59
v_mfma_f32_16x16x32_bf16 v[80:83], a[36:39], a[156:159], v[80:83]
v_mul_f32 v64, v64, v144
s_waitcnt lgkmcnt(6)
v_mfma_f32_16x16x32_bf16 v[84:87], a[40:43], a[128:131], v[84:87]
v_mul_f32 v65, v65, v145
v_mul_f32 v66, v66, v146
v_mfma_f32_16x16x32_bf16 v[88:91], a[40:43], a[132:135], v[88:91]
v_mul_f32 v67, v67, v147
v_cvt_pk_bf16_f32 v210, v64, v65
v_mfma_f32_16x16x32_bf16 v[92:95], a[44:47], a[128:131], v[92:95]
v_cvt_pk_bf16_f32 v211, v66, v67
buffer_store_dwordx4 v[208:211], v237, s[8:11], s64 offen offset:1024 sc1
v_mfma_f32_16x16x32_bf16 v[96:99], a[44:47], a[132:135], v[96:99]
v_mul_f32 v68, v68, v148
s_waitcnt lgkmcnt(4)
v_mfma_f32_16x16x32_bf16 v[84:87], a[48:51], a[136:139], v[84:87]
v_mul_f32 v69, v69, v149
v_mul_f32 v70, v70, v150
v_mfma_f32_16x16x32_bf16 v[88:91], a[48:51], a[140:143], v[88:91]
v_mul_f32 v71, v71, v151
v_cvt_pk_bf16_f32 v212, v68, v69
v_mfma_f32_16x16x32_bf16 v[92:95], a[52:55], a[136:139], v[92:95]
v_cvt_pk_bf16_f32 v213, v70, v71
v_mul_f32 v76, v76, v156
v_mfma_f32_16x16x32_bf16 v[96:99], a[52:55], a[140:143], v[96:99]
v_mul_f32 v77, v77, v157
s_waitcnt lgkmcnt(2)
v_mfma_f32_16x16x32_bf16 v[84:87], a[56:59], a[144:147], v[84:87]
v_mul_f32 v78, v78, v158
v_mul_f32 v79, v79, v159
v_mfma_f32_16x16x32_bf16 v[88:91], a[56:59], a[148:151], v[88:91]
v_cvt_pk_bf16_f32 v214, v76, v77
v_cvt_pk_bf16_f32 v215, v78, v79
v_mfma_f32_16x16x32_bf16 v[92:95], a[60:63], a[144:147], v[92:95]
buffer_store_dwordx4 v[212:215], v1, s[8:11], s64 offen offset:2048 sc1
v_mul_f32 v72, v72, v152
v_mfma_f32_16x16x32_bf16 v[96:99], a[60:63], a[148:151], v[96:99]
v_mul_f32 v73, v73, v153
v_mul_f32 v74, v74, v154
s_waitcnt lgkmcnt(0)
v_mfma_f32_16x16x32_bf16 v[84:87], a[64:67], a[152:155], v[84:87]
v_mul_f32 v75, v75, v155
v_cvt_pk_bf16_f32 v216, v72, v73
v_mfma_f32_16x16x32_bf16 v[88:91], a[64:67], a[156:159], v[88:91]
v_cvt_pk_bf16_f32 v217, v74, v75
v_mul_f32 v80, v80, v160
v_mfma_f32_16x16x32_bf16 v[92:95], a[68:71], a[152:155], v[92:95]
v_mul_f32 v81, v81, v161
v_mul_f32 v82, v82, v162
v_mfma_f32_16x16x32_bf16 v[96:99], a[68:71], a[156:159], v[96:99]
v_mul_f32 v83, v83, v163
v_cvt_pk_bf16_f32 v218, v80, v81
v_cvt_pk_bf16_f32 v219, v82, v83
buffer_store_dwordx4 v[216:219], v237, s[8:11], s64 offen offset:2048 sc1
s_nop 1
v_pk_mul_f32 v[84:85], v[84:85], v[164:165]
v_pk_mul_f32 v[86:87], v[86:87], v[166:167]
v_cvt_pk_bf16_f32 v220, v84, v85
v_cvt_pk_bf16_f32 v221, v86, v87
v_pk_mul_f32 v[92:93], v[92:93], v[172:173]
v_pk_mul_f32 v[94:95], v[94:95], v[174:175]
v_cvt_pk_bf16_f32 v222, v92, v93
v_cvt_pk_bf16_f32 v223, v94, v95
buffer_store_dwordx4 v[220:223], v1, s[8:11], s64 offen offset:3072 sc1
v_pk_mul_f32 v[88:89], v[88:89], v[168:169]
v_pk_mul_f32 v[90:91], v[90:91], v[170:171]
v_cvt_pk_bf16_f32 v224, v88, v89
v_cvt_pk_bf16_f32 v225, v90, v91
v_pk_mul_f32 v[96:97], v[96:97], v[176:177]
v_pk_mul_f32 v[98:99], v[98:99], v[178:179]
v_cvt_pk_bf16_f32 v226, v96, v97
v_cvt_pk_bf16_f32 v227, v98, v99
buffer_store_dwordx4 v[224:227], v237, s[8:11], s64 offen offset:3072 sc1
L_c5:
s_mul_i32 s38, s24, 9216
s_add_u32 m0, s38, 53248
s_add_u32 s39, s38, s83
s_add_u32 s39, s39, 53248
buffer_load_dwordx4 v1, s[4:7], s39 offen offset:0 sc1 lds
buffer_load_dwordx4 v1, s[4:7], s39 offen offset:1024 sc1 lds
buffer_load_dwordx4 v1, s[4:7], s39 offen offset:2048 sc1 lds
buffer_load_dwordx4 v1, s[4:7], s39 offen offset:3072 sc1 lds
s_add_u32 m0, m0, 4096
s_add_u32 s39, s39, 4096
buffer_load_dwordx4 v1, s[4:7], s39 offen offset:0 sc1 lds
buffer_load_dwordx4 v1, s[4:7], s39 offen offset:1024 sc1 lds
buffer_load_dwordx4 v1, s[4:7], s39 offen offset:2048 sc1 lds
buffer_load_dwordx4 v1, s[4:7], s39 offen offset:3072 sc1 lds
s_add_u32 m0, m0, 4096
s_add_u32 s39, s39, 4096
buffer_load_dwordx4 v1, s[4:7], s39 offen offset:0 sc1 lds
v_lshlrev_b32 v7, 3, v1
s_lshl_b32 s31, s25, 11
v_add_u32 v7, s31, v7
s_cmp_eq_u32 s24, 0
s_cselect_b32 s30, 0, 1073741824
s_add_u32 s30, s30, 26574848
s_waitcnt vmcnt(9)
s_barrier
s_mov_b64 exec, 0xffff
buffer_atomic_add v4, v7, s[8:11], s30 offen sc1
s_mov_b64 exec, -1
s_lshl_b32 s35, s81, 7
s_add_u32 s35, s35, 26574848
s_cmp_eq_u32 s24, 1
s_cselect_b32 s35, s35, 1073741824
v_mov_b32 v6, 0
s_mul_i32 s38, s24, 9216
s_add_u32 m0, s38, 90112
s_add_u32 s39, s38, s83
s_add_u32 s39, s39, 90112
buffer_load_dwordx4 v1, s[4:7], s39 offen offset:0 sc1 lds
buffer_load_dwordx4 v1, s[4:7], s39 offen offset:1024 sc1 lds
buffer_load_dwordx4 v1, s[4:7], s39 offen offset:2048 sc1 lds
buffer_load_dwordx4 v1, s[4:7], s39 offen offset:3072 sc1 lds
s_add_u32 m0, m0, 4096
s_add_u32 s39, s39, 4096
v_mov_b32 v249, 0
s_mov_b64 exec, 1
buffer_atomic_add v249, v6, s[8:11], s35 offen sc0 sc1
s_mov_b64 exec, -1
buffer_load_dwordx4 v1, s[4:7], s39 offen offset:0 sc1 lds
buffer_load_dwordx4 v1, s[4:7], s39 offen offset:1024 sc1 lds
buffer_load_dwordx4 v1, s[4:7], s39 offen offset:2048 sc1 lds
buffer_load_dwordx4 v1, s[4:7], s39 offen offset:3072 sc1 lds
s_add_u32 m0, m0, 4096
s_add_u32 s39, s39, 4096
buffer_load_dwordx4 v1, s[4:7], s39 offen offset:0 sc1 lds
s_mul_i32 s38, s24, 9216
s_add_u32 m0, s38, 126976
s_add_u32 s39, s38, s83
s_add_u32 s39, s39, 126976
v_mov_b32 v250, 0
s_mov_b64 exec, 1
buffer_atomic_add v250, v6, s[8:11], s35 offen sc0 sc1
s_mov_b64 exec, -1
buffer_load_dwordx4 v1, s[4:7], s39 offen offset:0 sc1 lds
buffer_load_dwordx4 v1, s[4:7], s39 offen offset:1024 sc1 lds
buffer_load_dwordx4 v1, s[4:7], s39 offen offset:2048 sc1 lds
buffer_load_dwordx4 v1, s[4:7], s39 offen offset:3072 sc1 lds
s_add_u32 m0, m0, 4096
s_add_u32 s39, s39, 4096
buffer_load_dwordx4 v1, s[4:7], s39 offen offset:0 sc1 lds
v_mov_b32 v251, 0
s_mov_b64 exec, 1
buffer_atomic_add v251, v6, s[8:11], s35 offen sc0 sc1
s_mov_b64 exec, -1
buffer_load_dwordx4 v1, s[4:7], s39 offen offset:1024 sc1 lds
buffer_load_dwordx4 v1, s[4:7], s39 offen offset:2048 sc1 lds
buffer_load_dwordx4 v1, s[4:7], s39 offen offset:3072 sc1 lds
s_add_u32 m0, m0, 4096
s_add_u32 s39, s39, 4096
buffer_load_dwordx4 v1, s[4:7], s39 offen offset:0 sc1 lds
s_xor_b32 s30, s27, 1
s_lshl_b32 s60, s30, 2
s_add_u32 s60, s60, s24
s_mul_i32 s60, s60, 73728
s_and_b32 s32, s27, 1
s_mul_i32 s32, s32, 36864
s_add_u32 s32, s32, 16777216
s_add_u32 s60, s60, s32
s_lshl_b32 s61, s27, 2
s_add_u32 s61, s61, s24
s_mul_i32 s61, s61, 73728
s_add_u32 s61, s61, s32
s_cmp_eq_u32 s24, 1
s_cbranch_scc0 L_other_33
s_mov_b32 s31, 0
s_mov_b64 exec, 1
v_mov_b32 v252, 0
buffer_atomic_add v252, v6, s[8:11], s35 offen sc0 sc1
s_waitcnt vmcnt(17)
v_cmp_gt_u32 vcc, 16, v249
s_nop 0
s_cbranch_vccz L_polled_32
s_waitcnt vmcnt(11)
v_cmp_gt_u32 vcc, 16, v250
s_nop 0
s_cbranch_vccz L_polled_32
v_mov_b32 v249, 0
buffer_atomic_add v249, v6, s[8:11], s35 offen sc0 sc1
s_waitcnt vmcnt(6)
v_cmp_gt_u32 vcc, 16, v251
s_nop 0
s_cbranch_vccz L_polled_32
v_mov_b32 v250, 0
buffer_atomic_add v250, v6, s[8:11], s35 offen sc0 sc1
L_poll_31:
s_add_u32 s31, s31, 1
s_cmp_gt_u32 s31, 100000
s_cbranch_scc1 L_polled_32
v_mov_b32 v251, 0
buffer_atomic_add v251, v6, s[8:11], s35 offen sc0 sc1
s_waitcnt vmcnt(3)
v_cmp_gt_u32 vcc, 16, v252
s_nop 0
s_cbranch_vccz L_polled_32
v_mov_b32 v252, 0
buffer_atomic_add v252, v6, s[8:11], s35 offen sc0 sc1
s_waitcnt vmcnt(3)
v_cmp_gt_u32 vcc, 16, v249
s_nop 0
s_cbranch_vccz L_polled_32
v_mov_b32 v249, 0
buffer_atomic_add v249, v6, s[8:11], s35 offen sc0 sc1
s_waitcnt vmcnt(3)
v_cmp_gt_u32 vcc, 16, v250
s_nop 0
s_cbranch_vccz L_polled_32
v_mov_b32 v250, 0
buffer_atomic_add v250, v6, s[8:11], s35 offen sc0 sc1
s_waitcnt vmcnt(3)
v_cmp_gt_u32 vcc, 16, v251
s_nop 0
s_cbranch_vccz L_polled_32
s_branch L_poll_31
L_polled_32:
s_mov_b64 exec, -1
L_other_33:
s_barrier
buffer_load_dwordx4 a[0:3], v1, s[8:11], s60 offen offset:0 sc1
buffer_load_dwordx4 a[4:7], v1, s[8:11], s60 offen offset:1024 sc1
s_barrier
buffer_load_dwordx4 a[8:11], v1, s[8:11], s60 offen offset:2048 sc1
buffer_load_dwordx4 a[12:15], v1, s[8:11], s60 offen offset:3072 sc1
s_barrier
s_add_u32 s60, s60, 4096
buffer_load_dwordx4 a[16:19], v1, s[8:11], s60 offen offset:0 sc1
buffer_load_dwordx4 a[20:23], v1, s[8:11], s60 offen offset:1024 sc1
s_barrier
buffer_load_dwordx4 a[24:27], v1, s[8:11], s60 offen offset:2048 sc1
buffer_load_dwordx4 a[28:31], v1, s[8:11], s60 offen offset:3072 sc1
s_barrier
s_add_u32 s60, s60, 4096
buffer_load_dwordx4 a[32:35], v1, s[8:11], s60 offen offset:0 sc1
buffer_load_dwordx4 a[36:39], v1, s[8:11], s60 offen offset:1024 sc1
v_and_b32 v40, 7, v2
v_lshlrev_b32 v40, 4, v40
v_lshl_add_u32 v40, v3, 7, v40
v_add_u32 v40, 4096, v40
s_lshl_b32 s63, s81, 14
s_lshl_b32 s30, s24, 12
s_add_u32 s63, s63, s30
s_xor_b32 s62, s63, 131072
s_add_u32 s63, s63, 26640384
s_add_u32 s62, s62, 26640384
s_add_u32 s64, s83, 161280
v_mov_b32 v116, v40
v_add_u32 v36, 0, v1
v_add_u32 v37, 55296, v1
v_add_u32 v41, 55296, v40
v_add_u32 v38, 110592, v1
v_add_u32 v42, 110592, v40
ds_read_b128 a[160:163], v36 offset:0
ds_read_b128 a[164:167], v36 offset:1024
ds_read_b128 a[168:171], v36 offset:2048
ds_read_b128 a[172:175], v36 offset:3072
ds_read_b128 a[176:179], v40 offset:0
ds_read_b128 a[180:183], v36 offset:4608
ds_read_b128 a[184:187], v36 offset:5632
ds_read_b128 a[188:191], v36 offset:6656
ds_read_b128 a[192:195], v36 offset:7680
ds_read_b128 a[196:199], v40 offset:4608
s_lshl_b32 s30, s27, 2
s_add_u32 s30, s30, s24
v_mov_b32 v138, 1073741824
s_mul_i32 s66, s30, 18432
s_mul_i32 s32, s28, 2304
s_add_u32 s66, s66, s32
s_add_u32 s66, s66, 30834688
v_mov_b32 v140, v1
v_add_u32 v141, 2048, v140
v_cndmask_b32 v141, v138, v141, s[46:47]
s_lshl_b32 s67, s30, 7
s_lshl_b32 s32, s28, 14
s_add_u32 s67, s67, s32
s_add_u32 s67, s67, 33193984
v_lshlrev_b32 v139, 3, v2
v_cndmask_b32 v138, v138, v139, s[46:47]
s_lshl_b32 s30, s27, 2
s_add_u32 s30, s30, s24
v_mov_b32 v162, 1073741824
s_mul_i32 s68, s30, 18432
s_mul_i32 s32, s28, 144
s_add_u32 s68, s68, s32
v_mul_u32_u24 v164, 1152, v2
v_lshl_add_u32 v164, v3, 4, v164
v_add_u32 v165, 128, v164
v_cndmask_b32 v165, v162, v165, s[46:47]
s_waitcnt vmcnt(9)
s_waitcnt lgkmcnt(5)
v_mfma_f32_16x16x32_bf16 v[44:47], a[160:163], a[0:3], 0
ds_read_b128 a[200:203], v36 offset:9216
buffer_load_dwordx4 a[40:43], v1, s[8:11], s60 offen offset:2048 sc1
v_mfma_f32_16x16x32_bf16 v[48:51], a[164:167], a[0:3], 0
ds_read_b128 a[204:207], v36 offset:10240
v_mfma_f32_16x16x32_bf16 v[52:55], a[168:171], a[0:3], 0
ds_read_b128 a[208:211], v36 offset:11264
v_mfma_f32_16x16x32_bf16 v[56:59], a[172:175], a[0:3], 0
ds_read_b128 a[212:215], v36 offset:12288
v_mfma_f32_16x16x32_bf16 v[60:63], a[176:179], a[0:3], 0
ds_read_b128 a[216:219], v40 offset:9216
s_waitcnt vmcnt(9)
s_waitcnt lgkmcnt(5)
v_mfma_f32_16x16x32_bf16 v[44:47], a[180:183], a[4:7], v[44:47]
ds_read_b128 a[160:163], v36 offset:13824
buffer_load_dwordx4 a[0:3], v1, s[8:11], s60 offen offset:3072 sc1
v_mfma_f32_16x16x32_bf16 v[48:51], a[184:187], a[4:7], v[48:51]
ds_read_b128 a[164:167], v36 offset:14848
v_mfma_f32_16x16x32_bf16 v[52:55], a[188:191], a[4:7], v[52:55]
ds_read_b128 a[168:171], v36 offset:15872
v_mfma_f32_16x16x32_bf16 v[56:59], a[192:195], a[4:7], v[56:59]
ds_read_b128 a[172:175], v36 offset:16896
v_mfma_f32_16x16x32_bf16 v[60:63], a[196:199], a[4:7], v[60:63]
ds_read_b128 a[176:179], v40 offset:13824
s_waitcnt vmcnt(9)
s_waitcnt lgkmcnt(5)
v_mfma_f32_16x16x32_bf16 v[44:47], a[200:203], a[8:11], v[44:47]
ds_read_b128 a[180:183], v36 offset:18432
s_add_u32 s60, s60, 4096
buffer_load_dwordx4 a[4:7], v1, s[8:11], s60 offen offset:0 sc1
v_mfma_f32_16x16x32_bf16 v[48:51], a[204:207], a[8:11], v[48:51]
ds_read_b128 a[184:187], v36 offset:19456
v_mov_b32 v67, v248
v_mfma_f32_16x16x32_bf16 v[52:55], a[208:211], a[8:11], v[52:55]
ds_read_b128 a[188:191], v36 offset:20480
v_mfma_f32_16x16x32_bf16 v[56:59], a[212:215], a[8:11], v[56:59]
ds_read_b128 a[192:195], v36 offset:21504
v_mfma_f32_16x16x32_bf16 v[60:63], a[216:219], a[8:11], v[60:63]
ds_read_b128 a[196:199], v40 offset:18432
s_waitcnt vmcnt(9)
s_waitcnt lgkmcnt(5)
v_mfma_f32_16x16x32_bf16 v[44:47], a[160:163], a[12:15], v[44:47]
ds_read_b128 a[200:203], v36 offset:23040
buffer_load_dwordx4 a[8:11], v1, s[8:11], s60 offen offset:1024 sc1
v_mfma_f32_16x16x32_bf16 v[48:51], a[164:167], a[12:15], v[48:51]
ds_read_b128 a[204:207], v36 offset:24064
v_mfma_f32_16x16x32_bf16 v[52:55], a[168:171], a[12:15], v[52:55]
ds_read_b128 a[208:211], v36 offset:25088
v_mov_b32 v71, v248
v_mfma_f32_16x16x32_bf16 v[56:59], a[172:175], a[12:15], v[56:59]
ds_read_b128 a[212:215], v36 offset:26112
v_mfma_f32_16x16x32_bf16 v[60:63], a[176:179], a[12:15], v[60:63]
ds_read_b128 a[216:219], v40 offset:23040
s_waitcnt vmcnt(9)
s_waitcnt lgkmcnt(5)
v_mfma_f32_16x16x32_bf16 v[44:47], a[180:183], a[16:19], v[44:47]
ds_read_b128 a[160:163], v36 offset:27648
buffer_load_dwordx4 a[12:15], v1, s[8:11], s60 offen offset:2048 sc1
v_mfma_f32_16x16x32_bf16 v[48:51], a[184:187], a[16:19], v[48:51]
ds_read_b128 a[164:167], v36 offset:28672
v_mfma_f32_16x16x32_bf16 v[52:55], a[188:191], a[16:19], v[52:55]
ds_read_b128 a[168:171], v36 offset:29696
v_mfma_f32_16x16x32_bf16 v[56:59], a[192:195], a[16:19], v[56:59]
ds_read_b128 a[172:175], v36 offset:30720
v_mfma_f32_16x16x32_bf16 v[60:63], a[196:199], a[16:19], v[60:63]
ds_read_b128 a[176:179], v40 offset:27648
s_waitcnt vmcnt(9)
s_waitcnt lgkmcnt(5)
v_mfma_f32_16x16x32_bf16 v[44:47], a[200:203], a[20:23], v[44:47]
ds_read_b128 a[180:183], v36 offset:32256
buffer_load_dwordx4 a[16:19], v1, s[8:11], s60 offen offset:3072 sc1
v_mfma_f32_16x16x32_bf16 v[48:51], a[204:207], a[20:23], v[48:51]
ds_read_b128 a[184:187], v36 offset:33280
v_mov_b32 v75, v248
v_mfma_f32_16x16x32_bf16 v[52:55], a[208:211], a[20:23], v[52:55]
ds_read_b128 a[188:191], v36 offset:34304
v_mfma_f32_16x16x32_bf16 v[56:59], a[212:215], a[20:23], v[56:59]
ds_read_b128 a[192:195], v36 offset:35328
v_mfma_f32_16x16x32_bf16 v[60:63], a[216:219], a[20:23], v[60:63]
ds_read_b128 a[196:199], v40 offset:32256
s_waitcnt vmcnt(9)
s_waitcnt lgkmcnt(5)
v_mfma_f32_16x16x32_bf16 v[44:47], a[160:163], a[24:27], v[44:47]
ds_read_b128 a[200:203], v36 offset:36864
s_add_u32 s60, s60, 4096
buffer_load_dwordx4 a[20:23], v1, s[8:11], s60 offen offset:0 sc1
v_mfma_f32_16x16x32_bf16 v[48:51], a[164:167], a[24:27], v[48:51]
ds_read_b128 a[204:207], v36 offset:37888
v_mfma_f32_16x16x32_bf16 v[52:55], a[168:171], a[24:27], v[52:55]
ds_read_b128 a[208:211], v36 offset:38912
v_mfma_f32_16x16x32_bf16 v[56:59], a[172:175], a[24:27], v[56:59]
ds_read_b128 a[212:215], v36 offset:39936
v_mov_b32 v79, v248
v_mfma_f32_16x16x32_bf16 v[60:63], a[176:179], a[24:27], v[60:63]
ds_read_b128 a[216:219], v40 offset:36864
s_waitcnt vmcnt(9)
s_waitcnt lgkmcnt(5)
v_mfma_f32_16x16x32_bf16 v[44:47], a[180:183], a[28:31], v[44:47]
ds_read_b128 a[160:163], v36 offset:41472
buffer_load_dwordx4 a[24:27], v1, s[8:11], s60 offen offset:1024 sc1
v_mfma_f32_16x16x32_bf16 v[48:51], a[184:187], a[28:31], v[48:51]
ds_read_b128 a[164:167], v36 offset:42496
v_mfma_f32_16x16x32_bf16 v[52:55], a[188:191], a[28:31], v[52:55]
ds_read_b128 a[168:171], v36 offset:43520
v_mfma_f32_16x16x32_bf16 v[56:59], a[192:195], a[28:31], v[56:59]
ds_read_b128 a[172:175], v36 offset:44544
v_mfma_f32_16x16x32_bf16 v[60:63], a[196:199], a[28:31], v[60:63]
ds_read_b128 a[176:179], v40 offset:41472
s_waitcnt vmcnt(9)
s_waitcnt lgkmcnt(5)
v_mfma_f32_16x16x32_bf16 v[44:47], a[200:203], a[32:35], v[44:47]
ds_read_b128 a[180:183], v36 offset:46080
buffer_load_dwordx4 a[28:31], v1, s[8:11], s60 offen offset:2048 sc1
v_mfma_f32_16x16x32_bf16 v[48:51], a[204:207], a[32:35], v[48:51]
ds_read_b128 a[184:187], v36 offset:47104
v_mfma_f32_16x16x32_bf16 v[52:55], a[208:211], a[32:35], v[52:55]
ds_read_b128 a[188:191], v36 offset:48128
v_mfma_f32_16x16x32_bf16 v[56:59], a[212:215], a[32:35], v[56:59]
ds_read_b128 a[192:195], v36 offset:49152
v_mfma_f32_16x16x32_bf16 v[60:63], a[216:219], a[32:35], v[60:63]
ds_read_b128 a[196:199], v40 offset:46080
s_barrier
s_waitcnt vmcnt(9)
s_waitcnt lgkmcnt(5)
v_mfma_f32_16x16x32_bf16 v[44:47], a[160:163], a[36:39], v[44:47]
ds_read_b128 a[200:203], v36 offset:50688
buffer_load_dwordx4 a[32:35], v1, s[8:11], s60 offen offset:3072 sc1
v_mfma_f32_16x16x32_bf16 v[48:51], a[164:167], a[36:39], v[48:51]
ds_read_b128 a[204:207], v36 offset:51712
v_mfma_f32_16x16x32_bf16 v[52:55], a[168:171], a[36:39], v[52:55]
ds_read_b128 a[208:211], v36 offset:52736
v_mfma_f32_16x16x32_bf16 v[56:59], a[172:175], a[36:39], v[56:59]
ds_read_b128 a[212:215], v36 offset:53760
v_mfma_f32_16x16x32_bf16 v[60:63], a[176:179], a[36:39], v[60:63]
ds_read_b128 a[216:219], v40 offset:50688
s_waitcnt vmcnt(9)
s_waitcnt lgkmcnt(5)
v_mfma_f32_16x16x32_bf16 v[44:47], a[180:183], a[40:43], v[44:47]
ds_read_b128 a[160:163], v37 offset:0
s_add_u32 s60, s60, 4096
buffer_load_dwordx4 a[36:39], v1, s[8:11], s60 offen offset:0 sc1
v_mfma_f32_16x16x32_bf16 v[48:51], a[184:187], a[40:43], v[48:51]
ds_read_b128 a[164:167], v37 offset:1024
v_mfma_f32_16x16x32_bf16 v[52:55], a[188:191], a[40:43], v[52:55]
ds_read_b128 a[168:171], v37 offset:2048
v_mfma_f32_16x16x32_bf16 v[56:59], a[192:195], a[40:43], v[56:59]
ds_read_b128 a[172:175], v37 offset:3072
v_mfma_f32_16x16x32_bf16 v[60:63], a[196:199], a[40:43], v[60:63]
ds_read_b128 a[176:179], v41 offset:0
s_waitcnt vmcnt(9)
s_waitcnt lgkmcnt(5)
v_mfma_f32_16x16x32_bf16 v[44:47], a[200:203], a[0:3], v[44:47]
ds_read_b128 a[180:183], v37 offset:4608
buffer_load_dwordx4 a[40:43], v1, s[8:11], s60 offen offset:1024 sc1
v_mfma_f32_16x16x32_bf16 v[48:51], a[204:207], a[0:3], v[48:51]
ds_read_b128 a[184:187], v37 offset:5632
v_mfma_f32_16x16x32_bf16 v[52:55], a[208:211], a[0:3], v[52:55]
ds_read_b128 a[188:191], v37 offset:6656
v_mfma_f32_16x16x32_bf16 v[56:59], a[212:215], a[0:3], v[56:59]
ds_read_b128 a[192:195], v37 offset:7680
v_mfma_f32_16x16x32_bf16 v[60:63], a[216:219], a[0:3], v[60:63]
ds_read_b128 a[196:199], v41 offset:4608
s_waitcnt vmcnt(9)
s_waitcnt lgkmcnt(5)
v_mfma_f32_16x16x32_bf16 v[44:47], a[160:163], a[4:7], v[44:47]
ds_read_b128 a[200:203], v37 offset:9216
buffer_load_dwordx4 a[0:3], v1, s[8:11], s60 offen offset:2048 sc1
v_mfma_f32_16x16x32_bf16 v[48:51], a[164:167], a[4:7], v[48:51]
ds_read_b128 a[204:207], v37 offset:10240
v_mfma_f32_16x16x32_bf16 v[52:55], a[168:171], a[4:7], v[52:55]
ds_read_b128 a[208:211], v37 offset:11264
v_mfma_f32_16x16x32_bf16 v[56:59], a[172:175], a[4:7], v[56:59]
ds_read_b128 a[212:215], v37 offset:12288
v_mfma_f32_16x16x32_bf16 v[60:63], a[176:179], a[4:7], v[60:63]
ds_read_b128 a[216:219], v41 offset:9216
s_waitcnt vmcnt(9)
s_waitcnt lgkmcnt(5)
v_mfma_f32_16x16x32_bf16 v[44:47], a[180:183], a[8:11], v[44:47]
ds_read_b128 a[160:163], v37 offset:13824
buffer_load_dwordx4 a[4:7], v1, s[8:11], s60 offen offset:3072 sc1
v_mfma_f32_16x16x32_bf16 v[48:51], a[184:187], a[8:11], v[48:51]
ds_read_b128 a[164:167], v37 offset:14848
v_mfma_f32_16x16x32_bf16 v[52:55], a[188:191], a[8:11], v[52:55]
ds_read_b128 a[168:171], v37 offset:15872
v_mfma_f32_16x16x32_bf16 v[56:59], a[192:195], a[8:11], v[56:59]
ds_read_b128 a[172:175], v37 offset:16896
v_mfma_f32_16x16x32_bf16 v[60:63], a[196:199], a[8:11], v[60:63]
ds_read_b128 a[176:179], v41 offset:13824
s_waitcnt vmcnt(9)
s_waitcnt lgkmcnt(5)
v_mfma_f32_16x16x32_bf16 v[44:47], a[200:203], a[12:15], v[44:47]
ds_read_b128 a[180:183], v37 offset:18432
s_add_u32 s60, s60, 4096
buffer_load_dwordx4 a[8:11], v1, s[8:11], s60 offen offset:0 sc1
v_mfma_f32_16x16x32_bf16 v[48:51], a[204:207], a[12:15], v[48:51]
ds_read_b128 a[184:187], v37 offset:19456
v_mfma_f32_16x16x32_bf16 v[52:55], a[208:211], a[12:15], v[52:55]
ds_read_b128 a[188:191], v37 offset:20480
v_mfma_f32_16x16x32_bf16 v[56:59], a[212:215], a[12:15], v[56:59]
ds_read_b128 a[192:195], v37 offset:21504
v_mfma_f32_16x16x32_bf16 v[60:63], a[216:219], a[12:15], v[60:63]
ds_read_b128 a[196:199], v41 offset:18432
s_waitcnt vmcnt(9)
s_waitcnt lgkmcnt(5)
v_mfma_f32_16x16x32_bf16 v[44:47], a[160:163], a[16:19], v[44:47]
ds_read_b128 a[200:203], v37 offset:23040
buffer_load_dwordx4 a[12:15], v1, s[8:11], s60 offen offset:1024 sc1
v_mfma_f32_16x16x32_bf16 v[48:51], a[164:167], a[16:19], v[48:51]
ds_read_b128 a[204:207], v37 offset:24064
v_mfma_f32_16x16x32_bf16 v[52:55], a[168:171], a[16:19], v[52:55]
ds_read_b128 a[208:211], v37 offset:25088
v_mfma_f32_16x16x32_bf16 v[56:59], a[172:175], a[16:19], v[56:59]
ds_read_b128 a[212:215], v37 offset:26112
v_mfma_f32_16x16x32_bf16 v[60:63], a[176:179], a[16:19], v[60:63]
ds_read_b128 a[216:219], v41 offset:23040
s_waitcnt vmcnt(9)
s_waitcnt lgkmcnt(5)
v_mfma_f32_16x16x32_bf16 v[44:47], a[180:183], a[20:23], v[44:47]
ds_read_b128 a[160:163], v37 offset:27648
buffer_load_dwordx4 a[16:19], v1, s[8:11], s60 offen offset:2048 sc1
v_mfma_f32_16x16x32_bf16 v[48:51], a[184:187], a[20:23], v[48:51]
ds_read_b128 a[164:167], v37 offset:28672
buffer_load_dwordx4 a[228:231], v1, s[4:7], s64 offen offset:2048 sc1
v_mfma_f32_16x16x32_bf16 v[52:55], a[188:191], a[20:23], v[52:55]
ds_read_b128 a[168:171], v37 offset:29696
v_mfma_f32_16x16x32_bf16 v[56:59], a[192:195], a[20:23], v[56:59]
ds_read_b128 a[172:175], v37 offset:30720
v_mfma_f32_16x16x32_bf16 v[60:63], a[196:199], a[20:23], v[60:63]
ds_read_b128 a[176:179], v41 offset:27648
s_waitcnt vmcnt(10)
s_waitcnt lgkmcnt(5)
v_mfma_f32_16x16x32_bf16 v[44:47], a[200:203], a[24:27], v[44:47]
ds_read_b128 a[180:183], v37 offset:32256
buffer_load_dwordx4 a[20:23], v1, s[8:11], s60 offen offset:3072 sc1
v_mfma_f32_16x16x32_bf16 v[48:51], a[204:207], a[24:27], v[48:51]
ds_read_b128 a[184:187], v37 offset:33280
v_mfma_f32_16x16x32_bf16 v[52:55], a[208:211], a[24:27], v[52:55]
ds_read_b128 a[188:191], v37 offset:34304
v_mfma_f32_16x16x32_bf16 v[56:59], a[212:215], a[24:27], v[56:59]
ds_read_b128 a[192:195], v37 offset:35328
v_mfma_f32_16x16x32_bf16 v[60:63], a[216:219], a[24:27], v[60:63]
ds_read_b128 a[196:199], v41 offset:32256
s_waitcnt vmcnt(10)
s_waitcnt lgkmcnt(5)
v_mfma_f32_16x16x32_bf16 v[44:47], a[160:163], a[28:31], v[44:47]
ds_read_b128 a[200:203], v37 offset:36864
s_add_u32 s60, s60, 4096
buffer_load_dwordx4 a[24:27], v1, s[8:11], s60 offen offset:0 sc1
v_mfma_f32_16x16x32_bf16 v[48:51], a[164:167], a[28:31], v[48:51]
ds_read_b128 a[204:207], v37 offset:37888
v_mfma_f32_16x16x32_bf16 v[52:55], a[168:171], a[28:31], v[52:55]
ds_read_b128 a[208:211], v37 offset:38912
v_mfma_f32_16x16x32_bf16 v[56:59], a[172:175], a[28:31], v[56:59]
ds_read_b128 a[212:215], v37 offset:39936
buffer_load_dwordx4 a[232:235], v1, s[4:7], s64 offen offset:3072 sc1
v_mfma_f32_16x16x32_bf16 v[60:63], a[176:179], a[28:31], v[60:63]
ds_read_b128 a[216:219], v41 offset:36864
s_waitcnt vmcnt(11)
s_waitcnt lgkmcnt(5)
v_mfma_f32_16x16x32_bf16 v[44:47], a[180:183], a[32:35], v[44:47]
ds_read_b128 a[160:163], v37 offset:41472
buffer_load_dwordx4 a[28:31], v1, s[8:11], s60 offen offset:1024 sc1
v_mfma_f32_16x16x32_bf16 v[48:51], a[184:187], a[32:35], v[48:51]
ds_read_b128 a[164:167], v37 offset:42496
v_mfma_f32_16x16x32_bf16 v[52:55], a[188:191], a[32:35], v[52:55]
ds_read_b128 a[168:171], v37 offset:43520
v_mfma_f32_16x16x32_bf16 v[56:59], a[192:195], a[32:35], v[56:59]
ds_read_b128 a[172:175], v37 offset:44544
v_mfma_f32_16x16x32_bf16 v[60:63], a[196:199], a[32:35], v[60:63]
ds_read_b128 a[176:179], v41 offset:41472
s_waitcnt vmcnt(11)
s_waitcnt lgkmcnt(5)
v_mfma_f32_16x16x32_bf16 v[44:47], a[200:203], a[36:39], v[44:47]
ds_read_b128 a[180:183], v37 offset:46080
buffer_load_dwordx4 a[32:35], v1, s[8:11], s60 offen offset:2048 sc1
v_mfma_f32_16x16x32_bf16 v[48:51], a[204:207], a[36:39], v[48:51]
ds_read_b128 a[184:187], v37 offset:47104
v_mfma_f32_16x16x32_bf16 v[52:55], a[208:211], a[36:39], v[52:55]
ds_read_b128 a[188:191], v37 offset:48128
v_mfma_f32_16x16x32_bf16 v[56:59], a[212:215], a[36:39], v[56:59]
ds_read_b128 a[192:195], v37 offset:49152
v_mfma_f32_16x16x32_bf16 v[60:63], a[216:219], a[36:39], v[60:63]
ds_read_b128 a[196:199], v41 offset:46080
s_waitcnt vmcnt(11)
s_waitcnt lgkmcnt(5)
v_mfma_f32_16x16x32_bf16 v[44:47], a[160:163], a[40:43], v[44:47]
ds_read_b128 a[200:203], v37 offset:50688
buffer_load_dwordx4 a[36:39], v1, s[8:11], s60 offen offset:3072 sc1
v_mfma_f32_16x16x32_bf16 v[48:51], a[164:167], a[40:43], v[48:51]
ds_read_b128 a[204:207], v37 offset:51712
v_mfma_f32_16x16x32_bf16 v[52:55], a[168:171], a[40:43], v[52:55]
ds_read_b128 a[208:211], v37 offset:52736
buffer_load_dwordx4 a[236:239], v116, s[4:7], s64 offen sc1
v_mfma_f32_16x16x32_bf16 v[56:59], a[172:175], a[40:43], v[56:59]
ds_read_b128 a[212:215], v37 offset:53760
v_mfma_f32_16x16x32_bf16 v[60:63], a[176:179], a[40:43], v[60:63]
ds_read_b128 a[216:219], v41 offset:50688
s_waitcnt vmcnt(12)
s_waitcnt lgkmcnt(5)
v_mfma_f32_16x16x32_bf16 v[44:47], a[180:183], a[0:3], v[44:47]
ds_read_b128 a[160:163], v38 offset:0
s_add_u32 s60, s60, 4096
buffer_load_dwordx4 a[40:43], v1, s[8:11], s60 offen offset:0 sc1
v_mfma_f32_16x16x32_bf16 v[48:51], a[184:187], a[0:3], v[48:51]
ds_read_b128 a[164:167], v38 offset:1024
v_mfma_f32_16x16x32_bf16 v[52:55], a[188:191], a[0:3], v[52:55]
ds_read_b128 a[168:171], v38 offset:2048
v_mfma_f32_16x16x32_bf16 v[56:59], a[192:195], a[0:3], v[56:59]
ds_read_b128 a[172:175], v38 offset:3072
v_mfma_f32_16x16x32_bf16 v[60:63], a[196:199], a[0:3], v[60:63]
ds_read_b128 a[176:179], v42 offset:0
s_waitcnt vmcnt(12)
s_waitcnt lgkmcnt(5)
v_mfma_f32_16x16x32_bf16 v[44:47], a[200:203], a[4:7], v[44:47]
ds_read_b128 a[180:183], v38 offset:4608
buffer_load_dwordx4 a[0:3], v1, s[8:11], s60 offen offset:1024 sc1
v_mfma_f32_16x16x32_bf16 v[48:51], a[204:207], a[4:7], v[48:51]
ds_read_b128 a[184:187], v38 offset:5632
v_mfma_f32_16x16x32_bf16 v[52:55], a[208:211], a[4:7], v[52:55]
ds_read_b128 a[188:191], v38 offset:6656
v_mfma_f32_16x16x32_bf16 v[56:59], a[212:215], a[4:7], v[56:59]
ds_read_b128 a[192:195], v38 offset:7680
v_mfma_f32_16x16x32_bf16 v[60:63], a[216:219], a[4:7], v[60:63]
ds_read_b128 a[196:199], v42 offset:4608
s_waitcnt vmcnt(12)
s_waitcnt lgkmcnt(5)
v_mfma_f32_16x16x32_bf16 v[44:47], a[160:163], a[8:11], v[44:47]
ds_read_b128 a[200:203], v38 offset:9216
buffer_load_dwordx4 a[4:7], v1, s[8:11], s60 offen offset:2048 sc1
v_mfma_f32_16x16x32_bf16 v[48:51], a[164:167], a[8:11], v[48:51]
ds_read_b128 a[204:207], v38 offset:10240
v_mfma_f32_16x16x32_bf16 v[52:55], a[168:171], a[8:11], v[52:55]
ds_read_b128 a[208:211], v38 offset:11264
v_mfma_f32_16x16x32_bf16 v[56:59], a[172:175], a[8:11], v[56:59]
ds_read_b128 a[212:215], v38 offset:12288
v_mfma_f32_16x16x32_bf16 v[60:63], a[176:179], a[8:11], v[60:63]
ds_read_b128 a[216:219], v42 offset:9216
s_waitcnt vmcnt(12)
s_waitcnt lgkmcnt(5)
v_mfma_f32_16x16x32_bf16 v[44:47], a[180:183], a[12:15], v[44:47]
ds_read_b128 a[160:163], v38 offset:13824
buffer_load_dwordx4 a[8:11], v1, s[8:11], s60 offen offset:3072 sc1
v_mfma_f32_16x16x32_bf16 v[48:51], a[184:187], a[12:15], v[48:51]
ds_read_b128 a[164:167], v38 offset:14848
v_mfma_f32_16x16x32_bf16 v[52:55], a[188:191], a[12:15], v[52:55]
ds_read_b128 a[168:171], v38 offset:15872
v_mfma_f32_16x16x32_bf16 v[56:59], a[192:195], a[12:15], v[56:59]
ds_read_b128 a[172:175], v38 offset:16896
v_mfma_f32_16x16x32_bf16 v[60:63], a[196:199], a[12:15], v[60:63]
ds_read_b128 a[176:179], v42 offset:13824
s_waitcnt vmcnt(12)
s_waitcnt lgkmcnt(5)
v_mfma_f32_16x16x32_bf16 v[44:47], a[200:203], a[16:19], v[44:47]
ds_read_b128 a[180:183], v38 offset:18432
s_mov_b32 s60, s61
buffer_load_dwordx4 a[12:15], v1, s[8:11], s60 offen offset:0 sc1
v_mfma_f32_16x16x32_bf16 v[48:51], a[204:207], a[16:19], v[48:51]
ds_read_b128 a[184:187], v38 offset:19456
v_mfma_f32_16x16x32_bf16 v[52:55], a[208:211], a[16:19], v[52:55]
ds_read_b128 a[188:191], v38 offset:20480
v_mfma_f32_16x16x32_bf16 v[56:59], a[212:215], a[16:19], v[56:59]
ds_read_b128 a[192:195], v38 offset:21504
v_mfma_f32_16x16x32_bf16 v[60:63], a[216:219], a[16:19], v[60:63]
ds_read_b128 a[196:199], v42 offset:18432
s_waitcnt vmcnt(11)
s_waitcnt lgkmcnt(5)
v_mfma_f32_16x16x32_bf16 v[44:47], a[160:163], a[20:23], v[44:47]
ds_read_b128 a[200:203], v38 offset:23040
buffer_load_dwordx4 a[16:19], v1, s[8:11], s60 offen offset:1024 sc1
v_mfma_f32_16x16x32_bf16 v[48:51], a[164:167], a[20:23], v[48:51]
ds_read_b128 a[204:207], v38 offset:24064
v_mfma_f32_16x16x32_bf16 v[52:55], a[168:171], a[20:23], v[52:55]
ds_read_b128 a[208:211], v38 offset:25088
v_mfma_f32_16x16x32_bf16 v[56:59], a[172:175], a[20:23], v[56:59]
ds_read_b128 a[212:215], v38 offset:26112
v_mfma_f32_16x16x32_bf16 v[60:63], a[176:179], a[20:23], v[60:63]
ds_read_b128 a[216:219], v42 offset:23040
s_waitcnt vmcnt(11)
s_waitcnt lgkmcnt(5)
v_mfma_f32_16x16x32_bf16 v[44:47], a[180:183], a[24:27], v[44:47]
ds_read_b128 a[160:163], v38 offset:27648
buffer_load_dwordx4 a[20:23], v1, s[8:11], s60 offen offset:2048 sc1
v_mfma_f32_16x16x32_bf16 v[48:51], a[184:187], a[24:27], v[48:51]
ds_read_b128 a[164:167], v38 offset:28672
v_mfma_f32_16x16x32_bf16 v[52:55], a[188:191], a[24:27], v[52:55]
ds_read_b128 a[168:171], v38 offset:29696
v_mfma_f32_16x16x32_bf16 v[56:59], a[192:195], a[24:27], v[56:59]
ds_read_b128 a[172:175], v38 offset:30720
v_mfma_f32_16x16x32_bf16 v[60:63], a[196:199], a[24:27], v[60:63]
ds_read_b128 a[176:179], v42 offset:27648
s_waitcnt vmcnt(10)
s_waitcnt lgkmcnt(5)
v_mfma_f32_16x16x32_bf16 v[44:47], a[200:203], a[28:31], v[44:47]
ds_read_b128 a[180:183], v38 offset:32256
buffer_load_dwordx4 a[24:27], v1, s[8:11], s60 offen offset:3072 sc1
v_mfma_f32_16x16x32_bf16 v[48:51], a[204:207], a[28:31], v[48:51]
ds_read_b128 a[184:187], v38 offset:33280
v_mfma_f32_16x16x32_bf16 v[52:55], a[208:211], a[28:31], v[52:55]
ds_read_b128 a[188:191], v38 offset:34304
v_mfma_f32_16x16x32_bf16 v[56:59], a[212:215], a[28:31], v[56:59]
ds_read_b128 a[192:195], v38 offset:35328
v_mfma_f32_16x16x32_bf16 v[60:63], a[216:219], a[28:31], v[60:63]
ds_read_b128 a[196:199], v42 offset:32256
s_waitcnt vmcnt(10)
s_waitcnt lgkmcnt(5)
v_mfma_f32_16x16x32_bf16 v[44:47], a[160:163], a[32:35], v[44:47]
ds_read_b128 a[200:203], v38 offset:36864
s_add_u32 s60, s60, 4096
buffer_load_dwordx4 a[28:31], v1, s[8:11], s60 offen offset:0 sc1
v_mfma_f32_16x16x32_bf16 v[48:51], a[164:167], a[32:35], v[48:51]
ds_read_b128 a[204:207], v38 offset:37888
v_mfma_f32_16x16x32_bf16 v[52:55], a[168:171], a[32:35], v[52:55]
ds_read_b128 a[208:211], v38 offset:38912
v_mfma_f32_16x16x32_bf16 v[56:59], a[172:175], a[32:35], v[56:59]
ds_read_b128 a[212:215], v38 offset:39936
v_mfma_f32_16x16x32_bf16 v[60:63], a[176:179], a[32:35], v[60:63]
ds_read_b128 a[216:219], v42 offset:36864
s_waitcnt vmcnt(10)
s_waitcnt lgkmcnt(5)
v_mfma_f32_16x16x32_bf16 v[44:47], a[180:183], a[36:39], v[44:47]
ds_read_b128 a[160:163], v38 offset:41472
buffer_load_dwordx4 a[32:35], v1, s[8:11], s60 offen offset:1024 sc1
v_mfma_f32_16x16x32_bf16 v[48:51], a[184:187], a[36:39], v[48:51]
ds_read_b128 a[164:167], v38 offset:42496
v_mfma_f32_16x16x32_bf16 v[52:55], a[188:191], a[36:39], v[52:55]
ds_read_b128 a[168:171], v38 offset:43520
v_mfma_f32_16x16x32_bf16 v[56:59], a[192:195], a[36:39], v[56:59]
ds_read_b128 a[172:175], v38 offset:44544
v_mfma_f32_16x16x32_bf16 v[60:63], a[196:199], a[36:39], v[60:63]
ds_read_b128 a[176:179], v42 offset:41472
s_waitcnt vmcnt(9)
s_waitcnt lgkmcnt(5)
v_mfma_f32_16x16x32_bf16 v[44:47], a[200:203], a[40:43], v[44:47]
ds_read_b128 a[180:183], v38 offset:46080
buffer_load_dwordx4 a[36:39], v1, s[8:11], s60 offen offset:2048 sc1
v_mfma_f32_16x16x32_bf16 v[48:51], a[204:207], a[40:43], v[48:51]
ds_read_b128 a[184:187], v38 offset:47104
v_mfma_f32_16x16x32_bf16 v[52:55], a[208:211], a[40:43], v[52:55]
ds_read_b128 a[188:191], v38 offset:48128
v_mfma_f32_16x16x32_bf16 v[56:59], a[212:215], a[40:43], v[56:59]
ds_read_b128 a[192:195], v38 offset:49152
v_mfma_f32_16x16x32_bf16 v[60:63], a[216:219], a[40:43], v[60:63]
ds_read_b128 a[196:199], v42 offset:46080
s_waitcnt vmcnt(9)
s_waitcnt lgkmcnt(5)
v_mfma_f32_16x16x32_bf16 v[44:47], a[160:163], a[0:3], v[44:47]
ds_read_b128 a[200:203], v38 offset:50688
buffer_load_dwordx4 a[40:43], v1, s[8:11], s60 offen offset:3072 sc1
v_mfma_f32_16x16x32_bf16 v[48:51], a[164:167], a[0:3], v[48:51]
ds_read_b128 a[204:207], v38 offset:51712
v_mfma_f32_16x16x32_bf16 v[52:55], a[168:171], a[0:3], v[52:55]
v_mfma_f32_16x16x32_bf16 v[56:59], a[172:175], a[0:3], v[56:59]
v_mfma_f32_16x16x32_bf16 v[60:63], a[176:179], a[0:3], v[60:63]
s_waitcnt vmcnt(9)
s_waitcnt lgkmcnt(2)
v_mfma_f32_16x16x32_bf16 v[44:47], a[180:183], a[4:7], v[44:47]
ds_read_b128 a[160:163], v36 offset:0
s_add_u32 s60, s60, 4096
buffer_load_dwordx4 a[0:3], v1, s[8:11], s60 offen offset:0 sc1
v_mfma_f32_16x16x32_bf16 v[48:51], a[184:187], a[4:7], v[48:51]
ds_read_b128 a[164:167], v36 offset:1024
v_mfma_f32_16x16x32_bf16 v[52:55], a[188:191], a[4:7], v[52:55]
ds_read_b128 a[168:171], v36 offset:2048
v_mfma_f32_16x16x32_bf16 v[56:59], a[192:195], a[4:7], v[56:59]
ds_read_b128 a[172:175], v36 offset:3072
v_mfma_f32_16x16x32_bf16 v[60:63], a[196:199], a[4:7], v[60:63]
ds_read_b128 a[176:179], v40 offset:0
s_waitcnt vmcnt(9)
s_waitcnt lgkmcnt(5)
v_mfma_f32_16x16x32_bf16 v[44:47], a[200:203], a[8:11], v[44:47]
ds_read_b128 a[180:183], v36 offset:4608
buffer_load_dwordx4 a[4:7], v1, s[8:11], s60 offen offset:1024 sc1
v_mfma_f32_16x16x32_bf16 v[48:51], a[204:207], a[8:11], v[48:51]
ds_read_b128 a[184:187], v36 offset:5632
v_mfma_f32_16x16x32_bf16 v[52:55], a[228:231], a[8:11], v[52:55]
ds_read_b128 a[188:191], v36 offset:6656
v_mfma_f32_16x16x32_bf16 v[56:59], a[232:235], a[8:11], v[56:59]
ds_read_b128 a[192:195], v36 offset:7680
v_mfma_f32_16x16x32_bf16 v[60:63], a[236:239], a[8:11], v[60:63]
ds_read_b128 a[196:199], v40 offset:4608
s_waitcnt vmcnt(9)
s_waitcnt lgkmcnt(5)
v_mfma_f32_16x16x32_bf16 v[16:19], a[160:163], a[12:15], v[16:19]
ds_read_b128 a[200:203], v36 offset:9216
buffer_load_dwordx4 a[8:11], v1, s[8:11], s60 offen offset:2048 sc1
v_mfma_f32_16x16x32_bf16 v[20:23], a[164:167], a[12:15], v[20:23]
ds_read_b128 a[204:207], v36 offset:10240
v_mfma_f32_16x16x32_bf16 v[24:27], a[168:171], a[12:15], v[24:27]
ds_read_b128 a[208:211], v36 offset:11264
v_mfma_f32_16x16x32_bf16 v[28:31], a[172:175], a[12:15], v[28:31]
ds_read_b128 a[212:215], v36 offset:12288
v_mfma_f32_16x16x32_bf16 v[32:35], a[176:179], a[12:15], v[32:35]
ds_read_b128 a[216:219], v40 offset:9216
s_waitcnt vmcnt(9)
s_waitcnt lgkmcnt(5)
v_mfma_f32_16x16x32_bf16 v[16:19], a[180:183], a[16:19], v[16:19]
ds_read_b128 a[160:163], v36 offset:13824
buffer_load_dwordx4 a[12:15], v1, s[8:11], s60 offen offset:3072 sc1
v_mfma_f32_16x16x32_bf16 v[20:23], a[184:187], a[16:19], v[20:23]
ds_read_b128 a[164:167], v36 offset:14848
v_mfma_f32_16x16x32_bf16 v[24:27], a[188:191], a[16:19], v[24:27]
ds_read_b128 a[168:171], v36 offset:15872
v_mfma_f32_16x16x32_bf16 v[28:31], a[192:195], a[16:19], v[28:31]
ds_read_b128 a[172:175], v36 offset:16896
v_cvt_pk_bf16_f32 v64, v44, v45
v_mfma_f32_16x16x32_bf16 v[32:35], a[196:199], a[16:19], v[32:35]
ds_read_b128 a[176:179], v40 offset:13824
s_waitcnt vmcnt(9)
s_waitcnt lgkmcnt(5)
v_mfma_f32_16x16x32_bf16 v[16:19], a[200:203], a[20:23], v[16:19]
ds_read_b128 a[180:183], v36 offset:18432
s_add_u32 s60, s60, 4096
buffer_load_dwordx4 a[16:19], v1, s[8:11], s60 offen offset:0 sc1
v_mfma_f32_16x16x32_bf16 v[20:23], a[204:207], a[20:23], v[20:23]
ds_read_b128 a[184:187], v36 offset:19456
v_cvt_pk_bf16_f32 v65, v46, v47
v_mfma_f32_16x16x32_bf16 v[24:27], a[208:211], a[20:23], v[24:27]
ds_read_b128 a[188:191], v36 offset:20480
v_mfma_f32_16x16x32_bf16 v[28:31], a[212:215], a[20:23], v[28:31]
ds_read_b128 a[192:195], v36 offset:21504
v_mfma_f32_16x16x32_bf16 v[32:35], a[216:219], a[20:23], v[32:35]
ds_read_b128 a[196:199], v40 offset:18432
s_waitcnt vmcnt(9)
s_waitcnt lgkmcnt(5)
v_mfma_f32_16x16x32_bf16 v[16:19], a[160:163], a[24:27], v[16:19]
ds_read_b128 a[200:203], v36 offset:23040
buffer_load_dwordx4 a[20:23], v1, s[8:11], s60 offen offset:1024 sc1
v_mfma_f32_16x16x32_bf16 v[20:23], a[164:167], a[24:27], v[20:23]
ds_read_b128 a[204:207], v36 offset:24064
v_cvt_pk_bf16_f32 v66, v48, v49
v_mfma_f32_16x16x32_bf16 v[24:27], a[168:171], a[24:27], v[24:27]
ds_read_b128 a[208:211], v36 offset:25088
buffer_store_dwordx4 v[64:67], v1, s[8:11], s62 offen offset:0 sc1
v_mfma_f32_16x16x32_bf16 v[28:31], a[172:175], a[24:27], v[28:31]
ds_read_b128 a[212:215], v36 offset:26112
v_mfma_f32_16x16x32_bf16 v[32:35], a[176:179], a[24:27], v[32:35]
ds_read_b128 a[216:219], v40 offset:23040
s_waitcnt vmcnt(10)
s_waitcnt lgkmcnt(5)
v_mfma_f32_16x16x32_bf16 v[16:19], a[180:183], a[28:31], v[16:19]
ds_read_b128 a[160:163], v36 offset:27648
buffer_load_dwordx4 a[24:27], v1, s[8:11], s60 offen offset:2048 sc1
v_mfma_f32_16x16x32_bf16 v[20:23], a[184:187], a[28:31], v[20:23]
ds_read_b128 a[164:167], v36 offset:28672
v_cvt_pk_bf16_f32 v68, v50, v51
v_mfma_f32_16x16x32_bf16 v[24:27], a[188:191], a[28:31], v[24:27]
ds_read_b128 a[168:171], v36 offset:29696
v_mfma_f32_16x16x32_bf16 v[28:31], a[192:195], a[28:31], v[28:31]
ds_read_b128 a[172:175], v36 offset:30720
v_cvt_pk_bf16_f32 v69, v52, v53
v_mfma_f32_16x16x32_bf16 v[32:35], a[196:199], a[28:31], v[32:35]
ds_read_b128 a[176:179], v40 offset:27648
s_waitcnt vmcnt(10)
s_waitcnt lgkmcnt(5)
v_mfma_f32_16x16x32_bf16 v[16:19], a[200:203], a[32:35], v[16:19]
ds_read_b128 a[180:183], v36 offset:32256
buffer_load_dwordx4 a[28:31], v1, s[8:11], s60 offen offset:3072 sc1
v_mfma_f32_16x16x32_bf16 v[20:23], a[204:207], a[32:35], v[20:23]
ds_read_b128 a[184:187], v36 offset:33280
v_cvt_pk_bf16_f32 v70, v54, v55
v_mfma_f32_16x16x32_bf16 v[24:27], a[208:211], a[32:35], v[24:27]
ds_read_b128 a[188:191], v36 offset:34304
v_mfma_f32_16x16x32_bf16 v[28:31], a[212:215], a[32:35], v[28:31]
ds_read_b128 a[192:195], v36 offset:35328
v_mfma_f32_16x16x32_bf16 v[32:35], a[216:219], a[32:35], v[32:35]
ds_read_b128 a[196:199], v40 offset:32256
s_waitcnt vmcnt(10)
s_waitcnt lgkmcnt(5)
v_mfma_f32_16x16x32_bf16 v[16:19], a[160:163], a[36:39], v[16:19]
ds_read_b128 a[200:203], v36 offset:36864
s_add_u32 s60, s60, 4096
buffer_load_dwordx4 a[32:35], v1, s[8:11], s60 offen offset:0 sc1
v_mfma_f32_16x16x32_bf16 v[20:23], a[164:167], a[36:39], v[20:23]
ds_read_b128 a[204:207], v36 offset:37888
buffer_store_dwordx4 v[68:71], v1, s[8:11], s62 offen offset:1024 sc1
v_mfma_f32_16x16x32_bf16 v[24:27], a[168:171], a[36:39], v[24:27]
ds_read_b128 a[208:211], v36 offset:38912
v_cvt_pk_bf16_f32 v72, v56, v57
v_mfma_f32_16x16x32_bf16 v[28:31], a[172:175], a[36:39], v[28:31]
ds_read_b128 a[212:215], v36 offset:39936
v_mfma_f32_16x16x32_bf16 v[32:35], a[176:179], a[36:39], v[32:35]
ds_read_b128 a[216:219], v40 offset:36864
s_waitcnt vmcnt(11)
s_waitcnt lgkmcnt(5)
v_mfma_f32_16x16x32_bf16 v[16:19], a[180:183], a[40:43], v[16:19]
ds_read_b128 a[160:163], v36 offset:41472
buffer_load_dwordx4 a[36:39], v1, s[8:11], s60 offen offset:1024 sc1
v_mfma_f32_16x16x32_bf16 v[20:23], a[184:187], a[40:43], v[20:23]
ds_read_b128 a[164:167], v36 offset:42496
v_cvt_pk_bf16_f32 v73, v58, v59
v_mfma_f32_16x16x32_bf16 v[24:27], a[188:191], a[40:43], v[24:27]
ds_read_b128 a[168:171], v36 offset:43520
v_mfma_f32_16x16x32_bf16 v[28:31], a[192:195], a[40:43], v[28:31]
ds_read_b128 a[172:175], v36 offset:44544
v_cvt_pk_bf16_f32 v74, v60, v61
v_mfma_f32_16x16x32_bf16 v[32:35], a[196:199], a[40:43], v[32:35]
ds_read_b128 a[176:179], v40 offset:41472
s_waitcnt vmcnt(11)
s_waitcnt lgkmcnt(5)
v_mfma_f32_16x16x32_bf16 v[16:19], a[200:203], a[0:3], v[16:19]
ds_read_b128 a[180:183], v36 offset:46080
buffer_load_dwordx4 a[40:43], v1, s[8:11], s60 offen offset:2048 sc1
v_mfma_f32_16x16x32_bf16 v[20:23], a[204:207], a[0:3], v[20:23]
ds_read_b128 a[184:187], v36 offset:47104
buffer_store_dwordx4 v[72:75], v1, s[8:11], s62 offen offset:2048 sc1
v_mfma_f32_16x16x32_bf16 v[24:27], a[208:211], a[0:3], v[24:27]
ds_read_b128 a[188:191], v36 offset:48128
v_mfma_f32_16x16x32_bf16 v[28:31], a[212:215], a[0:3], v[28:31]
ds_read_b128 a[192:195], v36 offset:49152
v_mfma_f32_16x16x32_bf16 v[32:35], a[216:219], a[0:3], v[32:35]
ds_read_b128 a[196:199], v40 offset:46080
s_waitcnt vmcnt(12)
s_waitcnt lgkmcnt(5)
v_mfma_f32_16x16x32_bf16 v[16:19], a[160:163], a[4:7], v[16:19]
ds_read_b128 a[200:203], v36 offset:50688
buffer_load_dwordx4 a[0:3], v1, s[8:11], s60 offen offset:3072 sc1
v_mfma_f32_16x16x32_bf16 v[20:23], a[164:167], a[4:7], v[20:23]
ds_read_b128 a[204:207], v36 offset:51712
v_cvt_pk_bf16_f32 v76, v62, v63
v_mfma_f32_16x16x32_bf16 v[24:27], a[168:171], a[4:7], v[24:27]
ds_read_b128 a[208:211], v36 offset:52736
buffer_store_dwordx4 v[76:79], v1, s[8:11], s62 offen offset:3072 sc1
v_mfma_f32_16x16x32_bf16 v[28:31], a[172:175], a[4:7], v[28:31]
ds_read_b128 a[212:215], v36 offset:53760
v_mfma_f32_16x16x32_bf16 v[32:35], a[176:179], a[4:7], v[32:35]
ds_read_b128 a[216:219], v40 offset:50688
s_waitcnt vmcnt(13)
s_waitcnt lgkmcnt(5)
v_mfma_f32_16x16x32_bf16 v[16:19], a[180:183], a[8:11], v[16:19]
ds_read_b128 a[160:163], v37 offset:0
s_add_u32 s60, s60, 4096
buffer_load_dwordx4 a[4:7], v1, s[8:11], s60 offen offset:0 sc1
v_mfma_f32_16x16x32_bf16 v[20:23], a[184:187], a[8:11], v[20:23]
ds_read_b128 a[164:167], v37 offset:1024
v_mfma_f32_16x16x32_bf16 v[24:27], a[188:191], a[8:11], v[24:27]
ds_read_b128 a[168:171], v37 offset:2048
v_mfma_f32_16x16x32_bf16 v[28:31], a[192:195], a[8:11], v[28:31]
ds_read_b128 a[172:175], v37 offset:3072
v_mfma_f32_16x16x32_bf16 v[32:35], a[196:199], a[8:11], v[32:35]
ds_read_b128 a[176:179], v41 offset:0
s_waitcnt vmcnt(13)
s_waitcnt lgkmcnt(5)
v_mfma_f32_16x16x32_bf16 v[16:19], a[200:203], a[12:15], v[16:19]
ds_read_b128 a[180:183], v37 offset:4608
buffer_load_dwordx4 a[8:11], v1, s[8:11], s60 offen offset:1024 sc1
v_mfma_f32_16x16x32_bf16 v[20:23], a[204:207], a[12:15], v[20:23]
ds_read_b128 a[184:187], v37 offset:5632
v_mfma_f32_16x16x32_bf16 v[24:27], a[208:211], a[12:15], v[24:27]
ds_read_b128 a[188:191], v37 offset:6656
v_mfma_f32_16x16x32_bf16 v[28:31], a[212:215], a[12:15], v[28:31]
ds_read_b128 a[192:195], v37 offset:7680
v_mfma_f32_16x16x32_bf16 v[32:35], a[216:219], a[12:15], v[32:35]
ds_read_b128 a[196:199], v41 offset:4608
s_waitcnt vmcnt(13)
s_waitcnt lgkmcnt(5)
v_mfma_f32_16x16x32_bf16 v[16:19], a[160:163], a[16:19], v[16:19]
ds_read_b128 a[200:203], v37 offset:9216
buffer_load_dwordx4 a[12:15], v1, s[8:11], s60 offen offset:2048 sc1
v_mfma_f32_16x16x32_bf16 v[20:23], a[164:167], a[16:19], v[20:23]
ds_read_b128 a[204:207], v37 offset:10240
v_mfma_f32_16x16x32_bf16 v[24:27], a[168:171], a[16:19], v[24:27]
ds_read_b128 a[208:211], v37 offset:11264
v_mfma_f32_16x16x32_bf16 v[28:31], a[172:175], a[16:19], v[28:31]
ds_read_b128 a[212:215], v37 offset:12288
v_mfma_f32_16x16x32_bf16 v[32:35], a[176:179], a[16:19], v[32:35]
ds_read_b128 a[216:219], v41 offset:9216
s_waitcnt vmcnt(13)
s_waitcnt lgkmcnt(5)
v_mfma_f32_16x16x32_bf16 v[16:19], a[180:183], a[20:23], v[16:19]
ds_read_b128 a[160:163], v37 offset:13824
buffer_load_dwordx4 a[16:19], v1, s[8:11], s60 offen offset:3072 sc1
v_mfma_f32_16x16x32_bf16 v[20:23], a[184:187], a[20:23], v[20:23]
ds_read_b128 a[164:167], v37 offset:14848
v_mfma_f32_16x16x32_bf16 v[24:27], a[188:191], a[20:23], v[24:27]
ds_read_b128 a[168:171], v37 offset:15872
v_mfma_f32_16x16x32_bf16 v[28:31], a[192:195], a[20:23], v[28:31]
ds_read_b128 a[172:175], v37 offset:16896
v_mfma_f32_16x16x32_bf16 v[32:35], a[196:199], a[20:23], v[32:35]
ds_read_b128 a[176:179], v41 offset:13824
s_waitcnt vmcnt(12)
s_waitcnt lgkmcnt(5)
v_mfma_f32_16x16x32_bf16 v[16:19], a[200:203], a[24:27], v[16:19]
ds_read_b128 a[180:183], v37 offset:18432
s_add_u32 s60, s60, 4096
buffer_load_dwordx4 a[20:23], v1, s[8:11], s60 offen offset:0 sc1
v_mfma_f32_16x16x32_bf16 v[20:23], a[204:207], a[24:27], v[20:23]
ds_read_b128 a[184:187], v37 offset:19456
v_mfma_f32_16x16x32_bf16 v[24:27], a[208:211], a[24:27], v[24:27]
ds_read_b128 a[188:191], v37 offset:20480
v_mfma_f32_16x16x32_bf16 v[28:31], a[212:215], a[24:27], v[28:31]
ds_read_b128 a[192:195], v37 offset:21504
v_mfma_f32_16x16x32_bf16 v[32:35], a[216:219], a[24:27], v[32:35]
ds_read_b128 a[196:199], v41 offset:18432
s_waitcnt vmcnt(12)
s_waitcnt lgkmcnt(5)
v_mfma_f32_16x16x32_bf16 v[16:19], a[160:163], a[28:31], v[16:19]
ds_read_b128 a[200:203], v37 offset:23040
buffer_load_dwordx4 a[24:27], v1, s[8:11], s60 offen offset:1024 sc1
v_mfma_f32_16x16x32_bf16 v[20:23], a[164:167], a[28:31], v[20:23]
ds_read_b128 a[204:207], v37 offset:24064
v_mfma_f32_16x16x32_bf16 v[24:27], a[168:171], a[28:31], v[24:27]
ds_read_b128 a[208:211], v37 offset:25088
v_mfma_f32_16x16x32_bf16 v[28:31], a[172:175], a[28:31], v[28:31]
ds_read_b128 a[212:215], v37 offset:26112
v_mfma_f32_16x16x32_bf16 v[32:35], a[176:179], a[28:31], v[32:35]
ds_read_b128 a[216:219], v41 offset:23040
s_waitcnt vmcnt(12)
s_waitcnt lgkmcnt(5)
v_mfma_f32_16x16x32_bf16 v[16:19], a[180:183], a[32:35], v[16:19]
ds_read_b128 a[160:163], v37 offset:27648
buffer_load_dwordx4 a[28:31], v1, s[8:11], s60 offen offset:2048 sc1
v_mfma_f32_16x16x32_bf16 v[20:23], a[184:187], a[32:35], v[20:23]
ds_read_b128 a[164:167], v37 offset:28672
v_mfma_f32_16x16x32_bf16 v[24:27], a[188:191], a[32:35], v[24:27]
ds_read_b128 a[168:171], v37 offset:29696
v_mfma_f32_16x16x32_bf16 v[28:31], a[192:195], a[32:35], v[28:31]
ds_read_b128 a[172:175], v37 offset:30720
v_mfma_f32_16x16x32_bf16 v[32:35], a[196:199], a[32:35], v[32:35]
ds_read_b128 a[176:179], v41 offset:27648
s_waitcnt vmcnt(11)
s_waitcnt lgkmcnt(5)
v_mfma_f32_16x16x32_bf16 v[16:19], a[200:203], a[36:39], v[16:19]
ds_read_b128 a[180:183], v37 offset:32256
buffer_load_dwordx4 a[32:35], v1, s[8:11], s60 offen offset:3072 sc1
v_mfma_f32_16x16x32_bf16 v[20:23], a[204:207], a[36:39], v[20:23]
ds_read_b128 a[184:187], v37 offset:33280
v_mfma_f32_16x16x32_bf16 v[24:27], a[208:211], a[36:39], v[24:27]
ds_read_b128 a[188:191], v37 offset:34304
v_mfma_f32_16x16x32_bf16 v[28:31], a[212:215], a[36:39], v[28:31]
ds_read_b128 a[192:195], v37 offset:35328
v_mfma_f32_16x16x32_bf16 v[32:35], a[216:219], a[36:39], v[32:35]
ds_read_b128 a[196:199], v41 offset:32256
s_waitcnt vmcnt(11)
s_waitcnt lgkmcnt(5)
v_mfma_f32_16x16x32_bf16 v[16:19], a[160:163], a[40:43], v[16:19]
ds_read_b128 a[200:203], v37 offset:36864
s_add_u32 s60, s60, 4096
buffer_load_dwordx4 a[36:39], v1, s[8:11], s60 offen offset:0 sc1
v_mfma_f32_16x16x32_bf16 v[20:23], a[164:167], a[40:43], v[20:23]
ds_read_b128 a[204:207], v37 offset:37888
v_mfma_f32_16x16x32_bf16 v[24:27], a[168:171], a[40:43], v[24:27]
ds_read_b128 a[208:211], v37 offset:38912
v_mfma_f32_16x16x32_bf16 v[28:31], a[172:175], a[40:43], v[28:31]
ds_read_b128 a[212:215], v37 offset:39936
v_mfma_f32_16x16x32_bf16 v[32:35], a[176:179], a[40:43], v[32:35]
ds_read_b128 a[216:219], v41 offset:36864
s_waitcnt vmcnt(10)
s_waitcnt lgkmcnt(5)
v_mfma_f32_16x16x32_bf16 v[16:19], a[180:183], a[0:3], v[16:19]
ds_read_b128 a[160:163], v37 offset:41472
buffer_load_dwordx4 a[40:43], v1, s[8:11], s60 offen offset:1024 sc1
v_mfma_f32_16x16x32_bf16 v[20:23], a[184:187], a[0:3], v[20:23]
ds_read_b128 a[164:167], v37 offset:42496
v_mfma_f32_16x16x32_bf16 v[24:27], a[188:191], a[0:3], v[24:27]
ds_read_b128 a[168:171], v37 offset:43520
v_mfma_f32_16x16x32_bf16 v[28:31], a[192:195], a[0:3], v[28:31]
ds_read_b128 a[172:175], v37 offset:44544
v_mfma_f32_16x16x32_bf16 v[32:35], a[196:199], a[0:3], v[32:35]
ds_read_b128 a[176:179], v41 offset:41472
s_waitcnt vmcnt(9)
s_waitcnt lgkmcnt(5)
v_mfma_f32_16x16x32_bf16 v[16:19], a[200:203], a[4:7], v[16:19]
ds_read_b128 a[180:183], v37 offset:46080
buffer_load_dwordx4 a[0:3], v1, s[8:11], s60 offen offset:2048 sc1
v_mfma_f32_16x16x32_bf16 v[20:23], a[204:207], a[4:7], v[20:23]
ds_read_b128 a[184:187], v37 offset:47104
buffer_load_dwordx4 v[80:83], v1, s[8:11], s63 offen offset:0 sc1
v_mfma_f32_16x16x32_bf16 v[24:27], a[208:211], a[4:7], v[24:27]
ds_read_b128 a[188:191], v37 offset:48128
v_mfma_f32_16x16x32_bf16 v[28:31], a[212:215], a[4:7], v[28:31]
ds_read_b128 a[192:195], v37 offset:49152
v_mfma_f32_16x16x32_bf16 v[32:35], a[216:219], a[4:7], v[32:35]
ds_read_b128 a[196:199], v41 offset:46080
s_waitcnt vmcnt(10)
s_waitcnt lgkmcnt(5)
v_mfma_f32_16x16x32_bf16 v[16:19], a[160:163], a[8:11], v[16:19]
ds_read_b128 a[200:203], v37 offset:50688
buffer_load_dwordx4 a[4:7], v1, s[8:11], s60 offen offset:3072 sc1
v_mfma_f32_16x16x32_bf16 v[20:23], a[164:167], a[8:11], v[20:23]
ds_read_b128 a[204:207], v37 offset:51712
buffer_load_dwordx4 v[84:87], v1, s[8:11], s63 offen offset:1024 sc1
v_mfma_f32_16x16x32_bf16 v[24:27], a[168:171], a[8:11], v[24:27]
ds_read_b128 a[208:211], v37 offset:52736
v_mfma_f32_16x16x32_bf16 v[28:31], a[172:175], a[8:11], v[28:31]
ds_read_b128 a[212:215], v37 offset:53760
v_mfma_f32_16x16x32_bf16 v[32:35], a[176:179], a[8:11], v[32:35]
ds_read_b128 a[216:219], v41 offset:50688
s_waitcnt vmcnt(11)
s_waitcnt lgkmcnt(5)
v_mfma_f32_16x16x32_bf16 v[16:19], a[180:183], a[12:15], v[16:19]
ds_read_b128 a[160:163], v38 offset:0
s_add_u32 s60, s60, 4096
buffer_load_dwordx4 a[8:11], v1, s[8:11], s60 offen offset:0 sc1
v_mfma_f32_16x16x32_bf16 v[20:23], a[184:187], a[12:15], v[20:23]
ds_read_b128 a[164:167], v38 offset:1024
buffer_load_dwordx4 v[88:91], v1, s[8:11], s63 offen offset:2048 sc1
v_mfma_f32_16x16x32_bf16 v[24:27], a[188:191], a[12:15], v[24:27]
ds_read_b128 a[168:171], v38 offset:2048
v_mfma_f32_16x16x32_bf16 v[28:31], a[192:195], a[12:15], v[28:31]
ds_read_b128 a[172:175], v38 offset:3072
v_mfma_f32_16x16x32_bf16 v[32:35], a[196:199], a[12:15], v[32:35]
ds_read_b128 a[176:179], v42 offset:0
s_waitcnt vmcnt(12)
s_waitcnt lgkmcnt(5)
v_mfma_f32_16x16x32_bf16 v[16:19], a[200:203], a[16:19], v[16:19]
ds_read_b128 a[180:183], v38 offset:4608
buffer_load_dwordx4 a[12:15], v1, s[8:11], s60 offen offset:1024 sc1
v_mfma_f32_16x16x32_bf16 v[20:23], a[204:207], a[16:19], v[20:23]
ds_read_b128 a[184:187], v38 offset:5632
buffer_load_dwordx4 v[92:95], v1, s[8:11], s63 offen offset:3072 sc1
v_mfma_f32_16x16x32_bf16 v[24:27], a[208:211], a[16:19], v[24:27]
ds_read_b128 a[188:191], v38 offset:6656
v_mfma_f32_16x16x32_bf16 v[28:31], a[212:215], a[16:19], v[28:31]
ds_read_b128 a[192:195], v38 offset:7680
v_mfma_f32_16x16x32_bf16 v[32:35], a[216:219], a[16:19], v[32:35]
ds_read_b128 a[196:199], v42 offset:4608
s_waitcnt vmcnt(13)
s_waitcnt lgkmcnt(5)
v_mfma_f32_16x16x32_bf16 v[16:19], a[160:163], a[20:23], v[16:19]
ds_read_b128 a[200:203], v38 offset:9216
buffer_load_dwordx4 a[16:19], v1, s[8:11], s60 offen offset:2048 sc1
v_mfma_f32_16x16x32_bf16 v[20:23], a[164:167], a[20:23], v[20:23]
ds_read_b128 a[204:207], v38 offset:10240
v_mfma_f32_16x16x32_bf16 v[24:27], a[168:171], a[20:23], v[24:27]
ds_read_b128 a[208:211], v38 offset:11264
v_mfma_f32_16x16x32_bf16 v[28:31], a[172:175], a[20:23], v[28:31]
ds_read_b128 a[212:215], v38 offset:12288
v_mfma_f32_16x16x32_bf16 v[32:35], a[176:179], a[20:23], v[32:35]
ds_read_b128 a[216:219], v42 offset:9216
s_waitcnt vmcnt(13)
s_waitcnt lgkmcnt(5)
v_mfma_f32_16x16x32_bf16 v[16:19], a[180:183], a[24:27], v[16:19]
ds_read_b128 a[160:163], v38 offset:13824
buffer_load_dwordx4 a[20:23], v1, s[8:11], s60 offen offset:3072 sc1
v_mfma_f32_16x16x32_bf16 v[20:23], a[184:187], a[24:27], v[20:23]
ds_read_b128 a[164:167], v38 offset:14848
v_mfma_f32_16x16x32_bf16 v[24:27], a[188:191], a[24:27], v[24:27]
ds_read_b128 a[168:171], v38 offset:15872
v_mfma_f32_16x16x32_bf16 v[28:31], a[192:195], a[24:27], v[28:31]
ds_read_b128 a[172:175], v38 offset:16896
v_mfma_f32_16x16x32_bf16 v[32:35], a[196:199], a[24:27], v[32:35]
ds_read_b128 a[176:179], v42 offset:13824
s_waitcnt vmcnt(13)
s_waitcnt lgkmcnt(5)
v_mfma_f32_16x16x32_bf16 v[16:19], a[200:203], a[28:31], v[16:19]
ds_read_b128 a[180:183], v38 offset:18432
v_mfma_f32_16x16x32_bf16 v[20:23], a[204:207], a[28:31], v[20:23]
ds_read_b128 a[184:187], v38 offset:19456
v_mfma_f32_16x16x32_bf16 v[24:27], a[208:211], a[28:31], v[24:27]
ds_read_b128 a[188:191], v38 offset:20480
v_mfma_f32_16x16x32_bf16 v[28:31], a[212:215], a[28:31], v[28:31]
ds_read_b128 a[192:195], v38 offset:21504
v_mfma_f32_16x16x32_bf16 v[32:35], a[216:219], a[28:31], v[32:35]
ds_read_b128 a[196:199], v42 offset:18432
s_waitcnt vmcnt(12)
s_waitcnt lgkmcnt(5)
v_mfma_f32_16x16x32_bf16 v[16:19], a[160:163], a[32:35], v[16:19]
ds_read_b128 a[200:203], v38 offset:23040
v_mfma_f32_16x16x32_bf16 v[20:23], a[164:167], a[32:35], v[20:23]
ds_read_b128 a[204:207], v38 offset:24064
v_mfma_f32_16x16x32_bf16 v[24:27], a[168:171], a[32:35], v[24:27]
ds_read_b128 a[208:211], v38 offset:25088
v_mfma_f32_16x16x32_bf16 v[28:31], a[172:175], a[32:35], v[28:31]
ds_read_b128 a[212:215], v38 offset:26112
v_mfma_f32_16x16x32_bf16 v[32:35], a[176:179], a[32:35], v[32:35]
ds_read_b128 a[216:219], v42 offset:23040
s_waitcnt vmcnt(11)
s_waitcnt lgkmcnt(5)
v_mfma_f32_16x16x32_bf16 v[16:19], a[180:183], a[36:39], v[16:19]
ds_read_b128 a[160:163], v38 offset:27648
v_mfma_f32_16x16x32_bf16 v[20:23], a[184:187], a[36:39], v[20:23]
ds_read_b128 a[164:167], v38 offset:28672
v_mfma_f32_16x16x32_bf16 v[24:27], a[188:191], a[36:39], v[24:27]
ds_read_b128 a[168:171], v38 offset:29696
v_mfma_f32_16x16x32_bf16 v[28:31], a[192:195], a[36:39], v[28:31]
ds_read_b128 a[172:175], v38 offset:30720
v_mfma_f32_16x16x32_bf16 v[32:35], a[196:199], a[36:39], v[32:35]
ds_read_b128 a[176:179], v42 offset:27648
s_waitcnt vmcnt(10)
s_waitcnt lgkmcnt(5)
v_mfma_f32_16x16x32_bf16 v[16:19], a[200:203], a[40:43], v[16:19]
ds_read_b128 a[180:183], v38 offset:32256
s_waitcnt vmcnt(2)
v_mfma_f32_16x16x32_bf16 v[20:23], a[204:207], a[40:43], v[20:23]
ds_read_b128 a[184:187], v38 offset:33280
v_xor_b32 v118, v248, v83
v_mfma_f32_16x16x32_bf16 v[24:27], a[208:211], a[40:43], v[24:27]
ds_read_b128 a[188:191], v38 offset:34304
v_xor_b32 v119, v248, v87
v_mfma_f32_16x16x32_bf16 v[28:31], a[212:215], a[40:43], v[28:31]
ds_read_b128 a[192:195], v38 offset:35328
v_xor_b32 v120, v248, v91
v_mfma_f32_16x16x32_bf16 v[32:35], a[216:219], a[40:43], v[32:35]
ds_read_b128 a[196:199], v42 offset:32256
s_waitcnt lgkmcnt(5)
v_mfma_f32_16x16x32_bf16 v[16:19], a[160:163], a[0:3], v[16:19]
ds_read_b128 a[200:203], v38 offset:36864
v_xor_b32 v121, v248, v95
v_mfma_f32_16x16x32_bf16 v[20:23], a[164:167], a[0:3], v[20:23]
ds_read_b128 a[204:207], v38 offset:37888
v_or3_b32 v118, v118, v119, v120
v_mfma_f32_16x16x32_bf16 v[24:27], a[168:171], a[0:3], v[24:27]
ds_read_b128 a[208:211], v38 offset:38912
v_or_b32 v118, v118, v121
v_mfma_f32_16x16x32_bf16 v[28:31], a[172:175], a[0:3], v[28:31]
ds_read_b128 a[212:215], v38 offset:39936
v_cmp_ne_u32 vcc, 0, v118
v_mfma_f32_16x16x32_bf16 v[32:35], a[176:179], a[0:3], v[32:35]
ds_read_b128 a[216:219], v42 offset:36864
s_waitcnt lgkmcnt(5)
v_mfma_f32_16x16x32_bf16 v[16:19], a[180:183], a[4:7], v[16:19]
ds_read_b128 a[160:163], v38 offset:41472
v_mfma_f32_16x16x32_bf16 v[20:23], a[184:187], a[4:7], v[20:23]
ds_read_b128 a[164:167], v38 offset:42496
s_nop 0
s_cbranch_vccnz L_xslow_36
L_xback_37:
v_mfma_f32_16x16x32_bf16 v[24:27], a[188:191], a[4:7], v[24:27]
ds_read_b128 a[168:171], v38 offset:43520
v_lshlrev_b32 v96, 16, v80
v_mfma_f32_16x16x32_bf16 v[28:31], a[192:195], a[4:7], v[28:31]
ds_read_b128 a[172:175], v38 offset:44544
v_and_b32 v97, 0xffff0000, v80
v_mfma_f32_16x16x32_bf16 v[32:35], a[196:199], a[4:7], v[32:35]
ds_read_b128 a[176:179], v42 offset:41472
s_waitcnt lgkmcnt(5)
v_mfma_f32_16x16x32_bf16 v[16:19], a[200:203], a[8:11], v[16:19]
ds_read_b128 a[180:183], v38 offset:46080
v_lshlrev_b32 v98, 16, v81
v_mfma_f32_16x16x32_bf16 v[20:23], a[204:207], a[8:11], v[20:23]
ds_read_b128 a[184:187], v38 offset:47104
v_and_b32 v99, 0xffff0000, v81
v_mfma_f32_16x16x32_bf16 v[24:27], a[208:211], a[8:11], v[24:27]
ds_read_b128 a[188:191], v38 offset:48128
v_lshlrev_b32 v100, 16, v82
v_mfma_f32_16x16x32_bf16 v[28:31], a[212:215], a[8:11], v[28:31]
ds_read_b128 a[192:195], v38 offset:49152
v_and_b32 v101, 0xffff0000, v82
v_mfma_f32_16x16x32_bf16 v[32:35], a[216:219], a[8:11], v[32:35]
ds_read_b128 a[196:199], v42 offset:46080
s_waitcnt lgkmcnt(5)
v_mfma_f32_16x16x32_bf16 v[16:19], a[160:163], a[12:15], v[16:19]
ds_read_b128 a[200:203], v38 offset:50688
v_lshlrev_b32 v102, 16, v84
v_mfma_f32_16x16x32_bf16 v[20:23], a[164:167], a[12:15], v[20:23]
ds_read_b128 a[204:207], v38 offset:51712
v_and_b32 v103, 0xffff0000, v84
v_mfma_f32_16x16x32_bf16 v[24:27], a[168:171], a[12:15], v[24:27]
v_lshlrev_b32 v104, 16, v85
v_and_b32 v105, 0xffff0000, v85
v_mfma_f32_16x16x32_bf16 v[28:31], a[172:175], a[12:15], v[28:31]
v_lshlrev_b32 v106, 16, v86
v_mfma_f32_16x16x32_bf16 v[32:35], a[176:179], a[12:15], v[32:35]
s_waitcnt vmcnt(1)
s_waitcnt lgkmcnt(2)
v_mfma_f32_16x16x32_bf16 v[16:19], a[180:183], a[16:19], v[16:19]
v_and_b32 v107, 0xffff0000, v86
v_lshlrev_b32 v108, 16, v88
v_mfma_f32_16x16x32_bf16 v[20:23], a[184:187], a[16:19], v[20:23]
v_mfma_f32_16x16x32_bf16 v[24:27], a[188:191], a[16:19], v[24:27]
v_and_b32 v109, 0xffff0000, v88
v_mfma_f32_16x16x32_bf16 v[28:31], a[192:195], a[16:19], v[28:31]
v_lshlrev_b32 v110, 16, v89
v_mfma_f32_16x16x32_bf16 v[32:35], a[196:199], a[16:19], v[32:35]
s_waitcnt vmcnt(0)
s_waitcnt lgkmcnt(0)
v_mfma_f32_16x16x32_bf16 v[16:19], a[200:203], a[20:23], v[16:19]
v_and_b32 v111, 0xffff0000, v89
v_lshlrev_b32 v112, 16, v90
v_mfma_f32_16x16x32_bf16 v[20:23], a[204:207], a[20:23], v[20:23]
v_and_b32 v113, 0xffff0000, v90
v_mfma_f32_16x16x32_bf16 v[24:27], a[228:231], a[20:23], v[24:27]
v_lshlrev_b32 v114, 16, v92
v_mfma_f32_16x16x32_bf16 v[28:31], a[232:235], a[20:23], v[28:31]
v_and_b32 v115, 0xffff0000, v92
v_mfma_f32_16x16x32_bf16 v[32:35], a[236:239], a[20:23], v[32:35]
s_nop 3
v_pk_add_f32 v[16:17], v[16:17], v[96:97]
v_pk_add_f32 v[18:19], v[18:19], v[98:99]
v_pk_add_f32 v[20:21], v[20:21], v[100:101]
v_pk_add_f32 v[22:23], v[22:23], v[102:103]
v_pk_add_f32 v[24:25], v[24:25], v[104:105]
v_pk_add_f32 v[26:27], v[26:27], v[106:107]
v_pk_add_f32 v[28:29], v[28:29], v[108:109]
v_pk_add_f32 v[30:31], v[30:31], v[110:111]
v_pk_add_f32 v[32:33], v[32:33], v[112:113]
v_pk_add_f32 v[34:35], v[34:35], v[114:115]
s_cmp_eq_u32 s29, 1
s_cbranch_scc1 L_last
v_pk_add_f32 v[142:143], v[16:17], v[18:19]
v_pk_mul_f32 v[144:145], v[16:17], v[16:17]
v_pk_fma_f32 v[144:145], v[18:19], v[18:19], v[144:145]
v_pk_add_f32 v[142:143], v[142:143], v[20:21]
v_pk_fma_f32 v[144:145], v[20:21], v[20:21], v[144:145]
v_pk_add_f32 v[142:143], v[142:143], v[22:23]
v_pk_fma_f32 v[144:145], v[22:23], v[22:23], v[144:145]
v_pk_add_f32 v[142:143], v[142:143], v[24:25]
v_pk_fma_f32 v[144:145], v[24:25], v[24:25], v[144:145]
v_pk_add_f32 v[142:143], v[142:143], v[26:27]
v_pk_fma_f32 v[144:145], v[26:27], v[26:27], v[144:145]
v_pk_add_f32 v[142:143], v[142:143], v[28:29]
v_pk_fma_f32 v[144:145], v[28:29], v[28:29], v[144:145]
v_pk_add_f32 v[142:143], v[142:143], v[30:31]
v_pk_fma_f32 v[144:145], v[30:31], v[30:31], v[144:145]
s_mov_b32 exec_hi, 0
v_pk_add_f32 v[142:143], v[142:143], v[32:33]
v_pk_fma_f32 v[144:145], v[32:33], v[32:33], v[144:145]
v_pk_add_f32 v[142:143], v[142:143], v[34:35]
v_pk_fma_f32 v[144:145], v[34:35], v[34:35], v[144:145]
s_mov_b64 exec, -1
v_add_f32 v136, v142, v143
v_add_f32 v137, v144, v145
v_cvt_pk_bf16_f32 v132, v32, v33
v_cvt_pk_bf16_f32 v133, v34, v35
v_permlane32_swap_b32 v136, v137
v_add_f32 v136, v136, v137
v_mov_b32 v137, v136
v_cvt_pk_bf16_f32 v124, v16, v17
v_cvt_pk_bf16_f32 v125, v18, v19
v_permlane16_swap_b32 v136, v137
v_add_f32 v136, v136, v137
v_mov_b32 v137, v136
v_cvt_pk_bf16_f32 v126, v20, v21
v_cvt_pk_bf16_f32 v127, v22, v23
v_permlane32_swap_b32 v136, v137
buffer_store_dwordx4 v[124:127], v140, s[8:11], s66 offen sc1
buffer_store_dwordx2 v[136:137], v138, s[8:11], s67 offen sc1
v_cvt_pk_bf16_f32 v128, v24, v25
v_cvt_pk_bf16_f32 v129, v26, v27
v_cvt_pk_bf16_f32 v130, v28, v29
v_cvt_pk_bf16_f32 v131, v30, v31
v_permlane16_swap_b32 v132, v134
v_permlane16_swap_b32 v133, v135
buffer_store_dwordx4 v[128:131], v140, s[8:11], s66 offen offset:1024 sc1
buffer_store_dwordx4 v[132:135], v141, s[8:11], s66 offen sc1
s_barrier
s_mul_i32 s36, s26, 132608
s_mul_i32 s38, s24, 12288
s_add_u32 m0, s38, 0
s_add_u32 s39, s38, s36
buffer_load_dwordx4 v1, s[4:7], s39 offen offset:0 sc1 lds
buffer_load_dwordx4 v1, s[4:7], s39 offen offset:1024 sc1 lds
buffer_load_dwordx4 v1, s[4:7], s39 offen offset:2048 sc1 lds
buffer_load_dwordx4 v1, s[4:7], s39 offen offset:3072 sc1 lds
s_add_u32 m0, m0, 4096
s_add_u32 s39, s39, 4096
buffer_load_dwordx4 v1, s[4:7], s39 offen offset:0 sc1 lds
buffer_load_dwordx4 v1, s[4:7], s39 offen offset:1024 sc1 lds
buffer_load_dwordx4 v1, s[4:7], s39 offen offset:2048 sc1 lds
buffer_load_dwordx4 v1, s[4:7], s39 offen offset:3072 sc1 lds
s_add_u32 m0, m0, 4096
s_add_u32 s39, s39, 4096
buffer_load_dwordx4 v1, s[4:7], s39 offen offset:0 sc1 lds
buffer_load_dwordx4 v1, s[4:7], s39 offen offset:1024 sc1 lds
buffer_load_dwordx4 v1, s[4:7], s39 offen offset:2048 sc1 lds
buffer_load_dwordx4 v1, s[4:7], s39 offen offset:3072 sc1 lds
s_and_b32 s33, s27, 1
s_cmp_lt_u32 s27, 31
s_cselect_b32 s33, s33, 0
s_cmp_eq_u32 s33, 1
s_cselect_b32 s34, -1, 0xffff
s_mov_b32 s35, 0
v_lshlrev_b32 v7, 3, v1
s_lshr_b32 s31, s81, 4
s_lshl_b32 s31, s31, 11
v_add_u32 v7, s31, v7
s_cmp_eq_u32 s24, 0
s_cselect_b32 s30, 0, 1073741824
s_add_u32 s30, s30, 26607616
s_waitcnt vmcnt(12)
s_barrier
s_mov_b64 exec, s[34:35]
buffer_atomic_add v4, v7, s[8:11], s30 offen sc1
s_mov_b64 exec, -1
s_cmp_eq_u32 s29, 1
s_cbranch_scc1 L_main_fin
s_cmp_eq_u32 s25, 0
s_cselect_b32 s34, 16, 24
s_lshl_b32 s35, s80, 7
s_add_u32 s35, s35, 26607616
s_cmp_eq_u32 s24, 1
s_cselect_b32 s35, s35, 1073741824
v_mov_b32 v6, 0
s_mul_i32 s36, s26, 132608
s_mul_i32 s38, s24, 9216
s_add_u32 m0, s38, 49152
s_add_u32 s39, s38, s36
s_add_u32 s39, s39, 49152
buffer_load_dwordx4 v1, s[4:7], s39 offen offset:0 sc1 lds
buffer_load_dwordx4 v1, s[4:7], s39 offen offset:1024 sc1 lds
v_mov_b32 v249, 0
s_mov_b64 exec, 1
buffer_atomic_add v249, v6, s[8:11], s35 offen sc0 sc1
s_mov_b64 exec, -1
buffer_load_dwordx4 v1, s[4:7], s39 offen offset:2048 sc1 lds
buffer_load_dwordx4 v1, s[4:7], s39 offen offset:3072 sc1 lds
s_add_u32 m0, m0, 4096
s_add_u32 s39, s39, 4096
v_mov_b32 v250, 0
s_mov_b64 exec, 1
buffer_atomic_add v250, v6, s[8:11], s35 offen sc0 sc1
s_mov_b64 exec, -1
buffer_load_dwordx4 v1, s[4:7], s39 offen offset:0 sc1 lds
buffer_load_dwordx4 v1, s[4:7], s39 offen offset:1024 sc1 lds
buffer_load_dwordx4 v1, s[4:7], s39 offen offset:2048 sc1 lds
v_mov_b32 v251, 0
s_mov_b64 exec, 1
buffer_atomic_add v251, v6, s[8:11], s35 offen sc0 sc1
s_mov_b64 exec, -1
buffer_load_dwordx4 v1, s[4:7], s39 offen offset:3072 sc1 lds
s_add_u32 m0, m0, 4096
s_add_u32 s39, s39, 4096
buffer_load_dwordx4 v1, s[4:7], s39 offen offset:0 sc1 lds
s_lshl_b32 s60, s25, 3
s_sub_u32 s61, s60, 1
s_max_i32 s61, s61, 0
s_lshl_b32 s30, s24, 1
s_add_u32 s60, s60, s30
s_mul_i32 s30, s61, 18432
s_mul_i32 s62, s60, 18432
v_add_u32 v237, 18432, v1
s_mul_i32 s38, s24, 5120
s_add_u32 m0, s38, 135168
s_add_u32 s39, s38, s30
s_cmp_eq_u32 s24, 1
s_cbranch_scc0 L_other_41
s_mov_b32 s31, 0
s_mov_b64 exec, 1
v_mov_b32 v252, 0
buffer_atomic_add v252, v6, s[8:11], s35 offen sc0 sc1
s_waitcnt vmcnt(10)
v_cmp_gt_u32 vcc, s34, v249
s_nop 0
s_cbranch_vccz L_polled_40
s_waitcnt vmcnt(7)
v_cmp_gt_u32 vcc, s34, v250
s_nop 0
s_cbranch_vccz L_polled_40
v_mov_b32 v249, 0
buffer_atomic_add v249, v6, s[8:11], s35 offen sc0 sc1
s_waitcnt vmcnt(4)
v_cmp_gt_u32 vcc, s34, v251
s_nop 0
s_cbranch_vccz L_polled_40
v_mov_b32 v250, 0
buffer_atomic_add v250, v6, s[8:11], s35 offen sc0 sc1
L_poll_39:
s_add_u32 s31, s31, 1
s_cmp_gt_u32 s31, 100000
s_cbranch_scc1 L_polled_40
v_mov_b32 v251, 0
buffer_atomic_add v251, v6, s[8:11], s35 offen sc0 sc1
s_waitcnt vmcnt(3)
v_cmp_gt_u32 vcc, s34, v252
s_nop 0
s_cbranch_vccz L_polled_40
v_mov_b32 v252, 0
buffer_atomic_add v252, v6, s[8:11], s35 offen sc0 sc1
s_waitcnt vmcnt(3)
v_cmp_gt_u32 vcc, s34, v249
s_nop 0
s_cbranch_vccz L_polled_40
v_mov_b32 v249, 0
buffer_atomic_add v249, v6, s[8:11], s35 offen sc0 sc1
s_waitcnt vmcnt(3)
v_cmp_gt_u32 vcc, s34, v250
s_nop 0
s_cbranch_vccz L_polled_40
v_mov_b32 v250, 0
buffer_atomic_add v250, v6, s[8:11], s35 offen sc0 sc1
s_waitcnt vmcnt(3)
v_cmp_gt_u32 vcc, s34, v251
s_nop 0
s_cbranch_vccz L_polled_40
s_branch L_poll_39
L_polled_40:
s_mov_b64 exec, -1
L_other_41:
s_barrier
s_mov_b32 s29, 1
s_add_u32 s8, s8, 30834688
s_addc_u32 s9, s9, 0
s_mov_b32 s10, 30834688
s_branch L_layer
L_last:
v_cvt_pk_bf16_f32 v148, v16, v17
v_cvt_pk_bf16_f32 v149, v18, v19
v_cvt_pk_bf16_f32 v150, v20, v21
v_cvt_pk_bf16_f32 v151, v22, v23
v_cvt_pk_bf16_f32 v152, v24, v25
v_cvt_pk_bf16_f32 v153, v26, v27
v_cvt_pk_bf16_f32 v154, v28, v29
v_cvt_pk_bf16_f32 v155, v30, v31
v_cvt_pk_bf16_f32 v156, v32, v33
v_cvt_pk_bf16_f32 v157, v34, v35
buffer_store_dwordx4 v[148:151], v164, s[16:19], s68 offen
buffer_store_dwordx4 v[152:155], v164, s[16:19], s68 offen offset:64
v_permlane16_swap_b32 v156, v158
v_permlane16_swap_b32 v157, v159
buffer_store_dwordx4 v[156:159], v165, s[16:19], s68 offen
L_main_fin:
L_main_end:
s_endpgm
L_tagslow_1:
buffer_load_dwordx2 v[238:239], v48, s[84:87], 0 offen sc1
s_add_u32 s31, s31, 1
s_waitcnt vmcnt(0)
v_cmp_eq_u32 vcc, 0, v238
s_cmp_gt_u32 s31, 200000
s_cbranch_scc1 L_tagback_2
s_cbranch_vccnz L_tagslow_1
s_branch L_tagback_2
L_dbslow_11:
s_mov_b32 s67, 0
L_dbslow_11x:
buffer_load_dwordx2 v[148:149], v146, s[4:7], s66 offen sc1
s_add_u32 s67, s67, 1
s_waitcnt vmcnt(0)
v_cmp_ne_u64 vcc, v[148:149], v[238:239]
s_cmp_gt_u32 s67, 200000
s_cbranch_scc1 L_dbback_12
s_cbranch_vccnz L_dbslow_11x
s_branch L_dbback_12
L_stzslow_23:
s_mov_b32 s31, 0
L_stzloop_25:
buffer_load_dwordx2 v[180:181], v234, s[8:11], s61 offen offset:0 sc1
buffer_load_dwordx2 v[182:183], v234, s[8:11], s61 offen offset:1024 sc1
buffer_load_dwordx2 v[184:185], v234, s[8:11], s61 offen offset:2048 sc1
buffer_load_dwordx2 v[186:187], v234, s[8:11], s61 offen offset:3072 sc1
buffer_load_dwordx2 v[188:189], v235, s[8:11], s61 offen offset:0 sc1
buffer_load_dwordx2 v[190:191], v235, s[8:11], s61 offen offset:1024 sc1
buffer_load_dwordx2 v[192:193], v235, s[8:11], s61 offen offset:2048 sc1
buffer_load_dwordx2 v[194:195], v235, s[8:11], s61 offen offset:3072 sc1
s_add_u32 s31, s31, 1
s_waitcnt vmcnt(0)
v_min3_f32 v198, v181, v183, v185
v_min3_f32 v199, v187, v189, v191
v_min3_f32 v198, v198, v193, v195
v_min_f32 v198, v198, v199
v_cmp_gt_f32 vcc, 0, v198
s_cmp_gt_u32 s31, 200000
s_cbranch_scc1 L_stzback_24
s_cbranch_vccnz L_stzloop_25
s_branch L_stzback_24
L_xslow_36:
s_mov_b32 s31, 0
L_xloop_38:
buffer_load_dwordx4 v[80:83], v1, s[8:11], s63 offen offset:0 sc1
buffer_load_dwordx4 v[84:87], v1, s[8:11], s63 offen offset:1024 sc1
buffer_load_dwordx4 v[88:91], v1, s[8:11], s63 offen offset:2048 sc1
buffer_load_dwordx4 v[92:95], v1, s[8:11], s63 offen offset:3072 sc1
s_add_u32 s31, s31, 1
s_waitcnt vmcnt(0)
v_xor_b32 v118, v248, v83
v_xor_b32 v119, v248, v87
v_xor_b32 v120, v248, v91
v_xor_b32 v121, v248, v95
v_or3_b32 v118, v118, v119, v120
v_or_b32 v118, v118, v121
v_cmp_ne_u32 vcc, 0, v118
s_cmp_gt_u32 s31, 200000
s_cbranch_scc1 L_xback_37
s_cbranch_vccnz L_xloop_38
s_branch L_xback_37
L_code_end:
.section .rodata,"a"
.p2align 6
.amdhsa_kernel main_kernel
  .amdhsa_next_free_vgpr 512
  .amdhsa_next_free_sgpr 102
  .amdhsa_accum_offset 256
  .amdhsa_group_segment_fixed_size 0
  .amdhsa_kernarg_size 88
  .amdhsa_user_sgpr_count 2
  .amdhsa_user_sgpr_kernarg_segment_ptr 1
  .amdhsa_system_sgpr_workgroup_id_x 1
  .amdhsa_float_denorm_mode_32 3
.end_amdhsa_kernel
```

```asm
; @launch kernel=main_kernel grid=(256,1,1) block=(256,1,1) lds=163840
.amdgcn_target "amdgcn-amd-amdhsa--gfx950"
.text
.globl main_kernel
.p2align 8
.type main_kernel,@function
main_kernel:
s_cmp_ge_u32 s2, 256
s_cbranch_scc1 L_main_exit
s_load_dwordx16 s[64:79], s[0:1], 0
s_load_dwordx2 s[4:5], s[0:1], 80
s_load_dwordx2 s[16:17], s[0:1], 64
s_load_dwordx2 s[84:85], s[0:1], 72
v_lshrrev_b32 v6, 6, v0
v_and_b32 v0, 63, v0
v_readfirstlane_b32 s24, v6
v_lshlrev_b32 v1, 4, v0
v_and_b32 v2, 15, v0
v_lshrrev_b32 v3, 4, v0
v_mov_b32 v4, 1
v_mov_b32 v5, 0
s_mov_b32 s56, 0
s_mov_b32 s29, 0
v_add_u32 v9, 65536, v1
v_cmp_eq_u32 s[46:47], 0, v3
v_cmp_eq_u32 s[48:49], 2, v3
v_cmp_gt_u32 s[50:51], 2, v3
s_mov_b32 s6, 19320832
s_mov_b32 s7, 0x20000
s_mov_b32 s10, 61669376
s_mov_b32 s11, 0x20000
s_mov_b32 s18, 2359296
s_mov_b32 s19, 0x20000
s_mov_b32 s22, 4096
s_mov_b32 s23, 0x20000
s_mov_b32 s86, 256
s_mov_b32 s87, 0x20000
s_and_b32 s30, s2, 7
s_lshr_b32 s31, s2, 3
s_lshr_b32 s32, s31, 2
s_and_b32 s33, s31, 3
s_lshr_b32 s25, s30, 2
s_lshl_b32 s25, s25, 3
s_add_u32 s25, s25, s32
s_and_b32 s26, s30, 3
s_lshl_b32 s26, s26, 2
s_add_u32 s26, s26, s33
s_branch L_main_go
L_main_exit:
s_endpgm
L_main_go:
s_lshr_b32 s27, s30, 1
s_lshl_b32 s27, s27, 3
s_add_u32 s27, s27, s32
s_and_b32 s28, s30, 1
s_lshl_b32 s28, s28, 2
s_add_u32 s28, s28, s33
s_lshr_b32 s27, s30, 1
s_lshl_b32 s27, s27, 2
s_lshr_b32 s32, s31, 3
s_add_u32 s27, s27, s32
s_lshl_b32 s27, s27, 1
s_and_b32 s32, s30, 1
s_add_u32 s27, s27, s32
s_and_b32 s28, s31, 7
s_lshl_b32 s80, s25, 4
s_add_u32 s80, s80, s26
s_lshl_b32 s81, s27, 3
s_add_u32 s81, s81, s28
s_getpc_b64 s[88:89]
L_pc:
s_mov_b32 s90, L_code_end-L_pc
s_mov_b32 s91, 0x20000
s_lshl_b32 s31, s31, 10
s_lshl_b32 s32, s24, 8
s_add_u32 s31, s31, s32
v_lshrrev_b32 v14, 2, v1
v_add_u32 v14, s31, v14
s_waitcnt lgkmcnt(0)
s_add_u32 s8, s4, 19320832
s_addc_u32 s9, s5, 0
s_mov_b32 s20, s76
s_mov_b32 s21, s77
s_memrealtime s[54:55]
s_or_b32 s30, s2, s24
s_cmp_eq_u32 s30, 0
s_cselect_b32 s30, 0, 1073741824
v_mov_b32 v48, 0
s_waitcnt lgkmcnt(0)
s_or_b32 s54, s54, 1
v_mov_b32 v238, s54
v_mov_b32 v239, s55
s_mov_b64 exec, 1
buffer_store_dwordx2 v[238:239], v48, s[84:87], s30 offen sc1
s_mov_b64 exec, -1
s_cmp_lt_u32 s2, 128
s_cbranch_scc1 L_p0_x1
s_mov_b32 s12, s66
s_mov_b32 s13, s67
s_mov_b32 s14, 1990656
s_mov_b32 s15, 0x20000
s_sub_u32 s30, s2, 128
s_cmp_lt_u32 s30, 108
s_cselect_b32 s62, 0, 1073741824
s_cselect_b32 s30, s30, 0
s_and_b32 s60, s30, 3
s_lshr_b32 s61, s30, 2
s_mul_i32 s30, s60, 497664
s_lshl_b32 s31, s61, 7
s_add_u32 s30, s30, s31
s_mul_i32 s31, s24, 27648
s_add_u32 s30, s30, s31
s_add_u32 s30, s30, s62
v_lshrrev_b32 v36, 7, v1
v_mul_u32_u24 v42, 3456, v36
v_and_b32 v36, 0x70, v1
v_add_u32 v42, v36, v42
s_lshl_b32 s32, s24, 10
s_add_u32 m0, s32, 0
s_add_u32 s31, s30, 0
buffer_load_dwordx4 v42, s[12:15], s31 offen nt lds
s_add_u32 m0, s32, 4096
s_add_u32 s31, s30, 110592
buffer_load_dwordx4 v42, s[12:15], s31 offen nt lds
s_add_u32 m0, s32, 8192
s_add_u32 s31, s30, 221184
buffer_load_dwordx4 v42, s[12:15], s31 offen nt lds
s_add_u32 m0, s32, 12288
s_add_u32 s31, s30, 331776
buffer_load_dwordx4 v42, s[12:15], s31 offen nt lds
s_add_u32 m0, s32, 16384
s_add_u32 s31, s30, 442368
s_cmp_lt_u32 s24, 2
s_cselect_b32 s31, s31, 1073741824
buffer_load_dwordx4 v42, s[12:15], s31 offen nt lds
s_branch L_p0_j1
L_p0_x1:
s_mov_b32 s12, s64
s_mov_b32 s13, s65
s_mov_b32 s14, 2359296
s_mov_b32 s15, 0x20000
s_mul_i32 s30, s24, 18
v_add_u32 v36, s30, v3
v_mul_u32_u24 v42, 1152, v2
v_lshl_add_u32 v42, v36, 4, v42
s_mul_i32 s30, s2, 18432
v_mov_b32 v37, 1073741824
v_cndmask_b32 v37, v37, v42, s[50:51]
buffer_load_dwordx4 v[64:67], v42, s[12:15], s30 offen offset:0
buffer_load_dwordx4 v[68:71], v42, s[12:15], s30 offen offset:64
buffer_load_dwordx4 v[72:75], v42, s[12:15], s30 offen offset:128
buffer_load_dwordx4 v[76:79], v42, s[12:15], s30 offen offset:192
buffer_load_dwordx4 v[80:83], v37, s[12:15], s30 offen offset:256
L_p0_j1:
s_mov_b32 s37, L_pc-L_pc
buffer_load_dword v15, v14, s[88:91], s37 offen
s_mov_b32 s37, L_pc+32768-L_pc
buffer_load_dword v15, v14, s[88:91], s37 offen
v_lshrrev_b32 v36, 2, v2
v_lshl_add_u32 v36, v3, 3, v36
v_lshlrev_b32 v45, 7, v36
v_and_b32 v36, 3, v2
v_lshl_add_u32 v45, v36, 3, v45
s_lshl_b32 s31, s24, 5
v_add_u32 v45, s31, v45
v_mov_b32 v164, 3212836864
v_mov_b32 v165, 3212836864
v_mov_b32 v166, 3212836864
v_mov_b32 v167, 3212836864
s_lshl_b32 s30, s80, 10
s_lshl_b32 s31, s24, 8
s_add_u32 s30, s30, s31
s_add_u32 s30, s30, 26214400
s_mov_b32 s31, 30834688
v_mul_lo_u32 v36, v3, s31
v_lshl_add_u32 v37, v2, 4, v36
s_mov_b32 exec_hi, 0
buffer_store_dwordx4 v[164:167], v37, s[8:11], s30 offen sc1
s_mov_b64 exec, -1
v_lshl_add_u32 v37, v2, 15, v36
s_lshl_b32 s30, s2, 7
s_add_u32 s30, s30, 26476544
s_cmp_eq_u32 s24, 0
s_cselect_b32 s30, s30, 1073741824
s_mov_b64 exec, 0x001f001f
buffer_store_dword v48, v37, s[8:11], s30 offen sc1
s_mov_b64 exec, -1
s_cmp_lt_u32 s2, 128
s_cbranch_scc1 L_p0_x2
s_mul_i32 s92, s61, 29
s_lshr_b32 s92, s92, 8
s_mul_i32 s33, s92, 9
s_sub_u32 s33, s61, s33
s_lshl_b32 s33, s33, 6
s_lshl_b32 s31, s24, 4
s_add_u32 s33, s33, s31
v_add_u32 v36, s33, v2
v_mul_u32_u24 v37, 911, v36
v_lshrrev_b32 v37, 14, v37
v_mul_u32_u24 v38, 18, v37
v_sub_u32 v36, v36, v38
v_and_b32 v38, 1, v37
v_lshrrev_b32 v37, 1, v37
s_mov_b32 s31, 132608
v_mul_lo_u32 v37, v37, s31
s_cmp_eq_u32 s92, 0
s_cselect_b32 s93, 5, 0
s_cselect_b32 s94, 8, 4
s_cmp_eq_u32 s92, 2
s_cselect_b32 s93, 2, s93
s_cselect_b32 s94, 0, s94
s_sub_u32 s94, s94, 16
v_add_u32 v39, s93, v38
v_lshl_add_u32 v40, v38, 1, v36
v_add_u32 v40, s94, v40
v_cmp_gt_u32 vcc, 16, v36
s_nop 1
v_cndmask_b32 v39, 4, v39, vcc
v_cndmask_b32 v40, v40, v36, vcc
v_lshl_add_u32 v43, v39, 10, v37
v_lshl_add_u32 v43, v40, 4, v43
v_lshl_add_u32 v44, v39, 9, v37
v_lshl_add_u32 v44, v40, 3, v44
s_lshl_b32 s31, s60, 7
s_add_u32 s31, s31, 129024
v_add_u32 v44, s31, v44
s_mul_i32 s31, s60, 18
v_add_u32 v37, s31, v3
v_and_b32 v38, 3, v37
v_lshrrev_b32 v37, 2, v37
v_mul_u32_u24 v37, 7168, v37
v_add_u32 v43, v43, v37
v_lshl_add_u32 v43, v38, 8, v43
s_waitcnt vmcnt(4)
s_barrier
ds_read_b64_tr_b16 v[64:65], v45 offset:0
ds_read_b64_tr_b16 v[66:67], v45 offset:512
ds_read_b64_tr_b16 v[68:69], v45 offset:4096
ds_read_b64_tr_b16 v[70:71], v45 offset:4608
ds_read_b64_tr_b16 v[72:73], v45 offset:8192
ds_read_b64_tr_b16 v[74:75], v45 offset:8704
ds_read_b64_tr_b16 v[76:77], v45 offset:12288
ds_read_b64_tr_b16 v[78:79], v45 offset:12800
ds_read_b64_tr_b16 v[80:81], v45 offset:16384
ds_read_b64_tr_b16 v[82:83], v45 offset:16896
v_mov_b32 v36, 1073741824
v_mov_b32 v46, 0
v_cndmask_b32 v37, v36, v43, s[50:51]
s_add_u32 s31, s62, 0
s_waitcnt lgkmcnt(8)
buffer_store_dwordx4 v[64:67], v43, s[4:7], s31 offen sc1
s_add_u32 s31, s62, 7168
s_waitcnt lgkmcnt(6)
buffer_store_dwordx4 v[68:71], v43, s[4:7], s31 offen sc1
s_add_u32 s31, s62, 14336
s_waitcnt lgkmcnt(4)
buffer_store_dwordx4 v[72:75], v43, s[4:7], s31 offen sc1
s_add_u32 s31, s62, 21504
s_waitcnt lgkmcnt(2)
buffer_store_dwordx4 v[76:79], v43, s[4:7], s31 offen sc1
s_add_u32 s31, s62, 28672
s_waitcnt lgkmcnt(0)
buffer_store_dwordx4 v[80:83], v37, s[4:7], s31 offen sc1
v_mov_b32 v37, 0x3f803f80
v_dot2c_f32_bf16 v46, v64, v37
v_dot2c_f32_bf16 v46, v65, v37
v_dot2c_f32_bf16 v46, v66, v37
v_dot2c_f32_bf16 v46, v67, v37
v_dot2c_f32_bf16 v46, v68, v37
v_dot2c_f32_bf16 v46, v69, v37
v_dot2c_f32_bf16 v46, v70, v37
v_dot2c_f32_bf16 v46, v71, v37
v_dot2c_f32_bf16 v46, v72, v37
v_dot2c_f32_bf16 v46, v73, v37
v_dot2c_f32_bf16 v46, v74, v37
v_dot2c_f32_bf16 v46, v75, v37
v_dot2c_f32_bf16 v46, v76, v37
v_dot2c_f32_bf16 v46, v77, v37
v_dot2c_f32_bf16 v46, v78, v37
v_dot2c_f32_bf16 v46, v79, v37
v_dot2c_f32_bf16 v46, v80, v37
v_dot2c_f32_bf16 v46, v81, v37
v_dot2c_f32_bf16 v46, v82, v37
v_dot2c_f32_bf16 v46, v83, v37
s_nop 2
v_mov_b32 v37, v46
s_nop 1
v_permlane32_swap_b32 v46, v37
v_add_f32 v46, v46, v37
v_mov_b32 v37, v46
s_nop 1
v_permlane16_swap_b32 v46, v37
v_add_f32 v46, v46, v37
v_cvt_pk_bf16_f32 v50, v46, v46
v_and_b32 v37, 0xffff0000, v50
v_sub_f32 v37, v46, v37
v_cvt_pk_bf16_f32 v51, v37, v37
v_cndmask_b32 v36, v36, v44, s[46:47]
buffer_store_dwordx2 v[50:51], v36, s[4:7], s62 offen sc1
s_branch L_p0_j2
L_p0_x2:
s_mul_i32 s30, s24, 4608
s_mul_i32 s31, s2, 18432
s_add_u32 s31, s31, s30
s_add_u32 s31, s31, 0
v_mov_b32 v36, 1073741824
v_add_u32 v38, 4096, v1
v_cndmask_b32 v38, v36, v38, s[50:51]
v_mov_b32 v46, 0
v_mov_b32 v47, 0
v_mov_b32 v39, 0x3f803f80
s_waitcnt vmcnt(4)
buffer_store_dwordx4 v[64:67], v1, s[8:11], s31 offen offset:0 sc1
buffer_store_dwordx4 v[68:71], v1, s[8:11], s31 offen offset:1024 sc1
buffer_store_dwordx4 v[72:75], v1, s[8:11], s31 offen offset:2048 sc1
buffer_store_dwordx4 v[76:79], v1, s[8:11], s31 offen offset:3072 sc1
buffer_store_dwordx4 v[80:83], v38, s[8:11], s31 offen offset:0 sc1
v_dot2c_f32_bf16 v46, v64, v39
v_dot2c_f32_bf16 v46, v65, v39
v_dot2c_f32_bf16 v46, v66, v39
v_dot2c_f32_bf16 v46, v67, v39
v_dot2c_f32_bf16 v46, v68, v39
v_dot2c_f32_bf16 v46, v69, v39
v_dot2c_f32_bf16 v46, v70, v39
v_dot2c_f32_bf16 v46, v71, v39
v_dot2c_f32_bf16 v46, v72, v39
v_dot2c_f32_bf16 v46, v73, v39
v_dot2c_f32_bf16 v46, v74, v39
v_dot2c_f32_bf16 v46, v75, v39
v_dot2c_f32_bf16 v46, v76, v39
v_dot2c_f32_bf16 v46, v77, v39
v_dot2c_f32_bf16 v46, v78, v39
v_dot2c_f32_bf16 v46, v79, v39
v_dot2c_f32_bf16 v46, v80, v39
v_dot2c_f32_bf16 v46, v81, v39
v_dot2c_f32_bf16 v46, v82, v39
v_dot2c_f32_bf16 v46, v83, v39
v_dot2c_f32_bf16 v47, v64, v64
v_dot2c_f32_bf16 v47, v65, v65
v_dot2c_f32_bf16 v47, v66, v66
v_dot2c_f32_bf16 v47, v67, v67
v_dot2c_f32_bf16 v47, v68, v68
v_dot2c_f32_bf16 v47, v69, v69
v_dot2c_f32_bf16 v47, v70, v70
v_dot2c_f32_bf16 v47, v71, v71
v_dot2c_f32_bf16 v47, v72, v72
v_dot2c_f32_bf16 v47, v73, v73
v_dot2c_f32_bf16 v47, v74, v74
v_dot2c_f32_bf16 v47, v75, v75
v_dot2c_f32_bf16 v47, v76, v76
v_dot2c_f32_bf16 v47, v77, v77
v_dot2c_f32_bf16 v47, v78, v78
v_dot2c_f32_bf16 v47, v79, v79
v_dot2c_f32_bf16 v47, v80, v80
v_dot2c_f32_bf16 v47, v81, v81
v_dot2c_f32_bf16 v47, v82, v82
v_dot2c_f32_bf16 v47, v83, v83
v_mov_b32 v37, v46
s_nop 1
v_permlane32_swap_b32 v46, v37
v_add_f32 v46, v46, v37
v_mov_b32 v37, v46
s_nop 1
v_permlane16_swap_b32 v46, v37
v_add_f32 v46, v46, v37
v_mov_b32 v37, v47
s_nop 1
v_permlane32_swap_b32 v47, v37
v_add_f32 v47, v47, v37
v_mov_b32 v37, v47
s_nop 1
v_permlane16_swap_b32 v47, v37
v_add_f32 v47, v47, v37
s_lshl_b32 s30, s2, 7
s_lshl_b32 s31, s24, 14
s_add_u32 s30, s30, s31
s_add_u32 s30, s30, 2359296
v_cndmask_b32 v50, 0, v46, s[46:47]
v_cndmask_b32 v51, 0, v47, s[46:47]
v_lshlrev_b32 v37, 3, v2
v_lshl_add_u32 v37, v3, 16, v37
v_cndmask_b32 v37, v36, v37, s[50:51]
buffer_store_dwordx2 v[50:51], v37, s[8:11], s30 offen sc1
L_p0_j2:
buffer_load_dwordx2 v[238:239], v48, s[84:87], 0 offen sc1
s_mov_b32 s12, s72
s_mov_b32 s13, s73
s_mov_b32 s14, 5308416
s_mov_b32 s15, 0x20000
s_sub_u32 s30, s2, 0
s_cmp_lt_u32 s30, 256
s_cselect_b32 s36, 0, 1073741824
s_cselect_b32 s30, s30, 0
s_and_b32 s34, s30, 3
s_lshr_b32 s35, s30, 2
s_mul_i32 s30, s34, 1327104
s_lshl_b32 s31, s35, 7
s_add_u32 s30, s30, s31
s_mul_i32 s31, s24, 73728
s_add_u32 s30, s30, s31
s_add_u32 s30, s30, s36
v_lshrrev_b32 v36, 7, v1
v_mul_u32_u24 v42, 9216, v36
v_and_b32 v36, 0x70, v1
v_add_u32 v42, v36, v42
s_lshl_b32 s32, s24, 10
s_add_u32 m0, s32, 20480
s_add_u32 s31, s30, 0
buffer_load_dwordx4 v42, s[12:15], s31 offen nt lds
s_add_u32 m0, s32, 24576
s_add_u32 s31, s30, 294912
buffer_load_dwordx4 v42, s[12:15], s31 offen nt lds
s_add_u32 m0, s32, 28672
s_add_u32 s31, s30, 589824
buffer_load_dwordx4 v42, s[12:15], s31 offen nt lds
s_add_u32 m0, s32, 32768
s_add_u32 s31, s30, 884736
buffer_load_dwordx4 v42, s[12:15], s31 offen nt lds
s_add_u32 m0, s32, 36864
s_add_u32 s31, s30, 1179648
s_cmp_lt_u32 s24, 2
s_cselect_b32 s31, s31, 1073741824
buffer_load_dwordx4 v42, s[12:15], s31 offen nt lds
s_lshl_b32 s30, s2, 7
s_add_u32 s30, s30, 19283968
s_lshl_b32 s32, s2, 3
s_add_u32 s32, s32, 19316736
s_cmp_eq_u32 s24, 0
s_cselect_b32 s30, s30, 1073741824
s_cselect_b32 s100, s32, 1073741824
s_waitcnt vmcnt(5)
v_cmp_eq_u32 vcc, 0, v238
s_mov_b32 s31, 0
s_cbranch_vccnz L_tagslow_1
L_tagback_2:
s_barrier
s_mov_b64 exec, 1
buffer_store_dwordx2 v[238:239], v48, s[4:7], s30 offen sc1
s_mov_b64 exec, -1
s_cmp_lt_u32 s2, 32
s_cbranch_scc1 L_p0_a3
s_cmp_lt_u32 s2, 176
s_cbranch_scc1 L_p0_b3
s_mov_b32 s12, s68
s_mov_b32 s13, s69
s_mov_b32 s14, 663552
s_mov_b32 s15, 0x20000
s_sub_u32 s30, s2, 176
s_cmp_lt_u32 s30, 36
s_cselect_b32 s53, 0, 1073741824
s_cselect_b32 s30, s30, 0
s_and_b32 s37, s30, 3
s_lshr_b32 s52, s30, 2
s_mul_i32 s30, s37, 165888
s_lshl_b32 s31, s52, 7
s_add_u32 s30, s30, s31
s_mul_i32 s31, s24, 9216
s_add_u32 s30, s30, s31
s_add_u32 s30, s30, s53
v_lshrrev_b32 v36, 7, v1
v_mul_u32_u24 v42, 1152, v36
v_and_b32 v36, 0x70, v1
v_add_u32 v42, v36, v42
s_lshl_b32 s32, s24, 10
s_add_u32 m0, s32, 40960
s_add_u32 s31, s30, 0
buffer_load_dwordx4 v42, s[12:15], s31 offen nt lds
s_add_u32 m0, s32, 45056
s_add_u32 s31, s30, 36864
buffer_load_dwordx4 v42, s[12:15], s31 offen nt lds
s_add_u32 m0, s32, 49152
s_add_u32 s31, s30, 73728
buffer_load_dwordx4 v42, s[12:15], s31 offen nt lds
s_add_u32 m0, s32, 53248
s_add_u32 s31, s30, 110592
buffer_load_dwordx4 v42, s[12:15], s31 offen nt lds
s_add_u32 m0, s32, 57344
s_add_u32 s31, s30, 147456
s_cmp_lt_u32 s24, 2
s_cselect_b32 s31, s31, 1073741824
buffer_load_dwordx4 v42, s[12:15], s31 offen nt lds
s_branch L_p0_j3
L_p0_b3:
s_mov_b32 s12, s78
s_mov_b32 s13, s79
s_mov_b32 s14, 2654208
s_mov_b32 s15, 0x20000
s_sub_u32 s30, s2, 32
s_cmp_lt_u32 s30, 144
s_cselect_b32 s53, 0, 1073741824
s_cselect_b32 s30, s30, 0
s_and_b32 s37, s30, 15
s_lshr_b32 s52, s30, 4
s_mul_i32 s30, s37, 165888
s_lshl_b32 s31, s52, 7
s_add_u32 s30, s30, s31
s_mul_i32 s31, s24, 9216
s_add_u32 s30, s30, s31
s_add_u32 s30, s30, s53
v_lshrrev_b32 v36, 7, v1
v_mul_u32_u24 v42, 1152, v36
v_and_b32 v36, 0x70, v1
v_add_u32 v42, v36, v42
s_lshl_b32 s32, s24, 10
s_add_u32 m0, s32, 40960
s_add_u32 s31, s30, 0
buffer_load_dwordx4 v42, s[12:15], s31 offen nt lds
s_add_u32 m0, s32, 45056
s_add_u32 s31, s30, 36864
buffer_load_dwordx4 v42, s[12:15], s31 offen nt lds
s_add_u32 m0, s32, 49152
s_add_u32 s31, s30, 73728
buffer_load_dwordx4 v42, s[12:15], s31 offen nt lds
s_add_u32 m0, s32, 53248
s_add_u32 s31, s30, 110592
buffer_load_dwordx4 v42, s[12:15], s31 offen nt lds
s_add_u32 m0, s32, 57344
s_add_u32 s31, s30, 147456
s_cmp_lt_u32 s24, 2
s_cselect_b32 s31, s31, 1073741824
buffer_load_dwordx4 v42, s[12:15], s31 offen nt lds
s_branch L_p0_j3
L_p0_a3:
s_mov_b32 s12, s72
s_mov_b32 s13, s73
s_mov_b32 s14, 5308416
s_mov_b32 s15, 0x20000
s_add_u32 s30, s2, 256
s_cmp_lt_u32 s30, 288
s_cselect_b32 s53, 0, 1073741824
s_cselect_b32 s30, s30, 0
s_and_b32 s37, s30, 3
s_lshr_b32 s52, s30, 2
s_mul_i32 s30, s37, 1327104
s_lshl_b32 s31, s52, 7
s_add_u32 s30, s30, s31
s_mul_i32 s31, s24, 73728
s_add_u32 s30, s30, s31
s_add_u32 s30, s30, s53
v_lshrrev_b32 v36, 7, v1
v_mul_u32_u24 v42, 9216, v36
v_and_b32 v36, 0x70, v1
v_add_u32 v42, v36, v42
s_lshl_b32 s32, s24, 10
s_add_u32 m0, s32, 40960
s_add_u32 s31, s30, 0
buffer_load_dwordx4 v42, s[12:15], s31 offen nt lds
s_add_u32 m0, s32, 45056
s_add_u32 s31, s30, 294912
buffer_load_dwordx4 v42, s[12:15], s31 offen nt lds
s_add_u32 m0, s32, 49152
s_add_u32 s31, s30, 589824
buffer_load_dwordx4 v42, s[12:15], s31 offen nt lds
s_add_u32 m0, s32, 53248
s_add_u32 s31, s30, 884736
buffer_load_dwordx4 v42, s[12:15], s31 offen nt lds
s_add_u32 m0, s32, 57344
s_add_u32 s31, s30, 1179648
s_cmp_lt_u32 s24, 2
s_cselect_b32 s31, s31, 1073741824
buffer_load_dwordx4 v42, s[12:15], s31 offen nt lds
L_p0_j3:
s_lshl_b32 s92, s35, 6
s_lshl_b32 s33, s24, 4
s_add_u32 s92, s92, s33
s_cmp_ge_u32 s92, 2304
s_cselect_b32 s93, 1, 0
s_cselect_b32 s33, 2304, 0
s_sub_u32 s92, s92, s33
s_mul_i32 s94, s92, 1821
s_lshr_b32 s94, s94, 19
s_mul_i32 s33, s94, 288
s_sub_u32 s92, s92, s33
s_lshr_b32 s95, s92, 5
s_bfe_u32 s96, s92, 0x10004
s_lshl_b32 s94, s94, 1
s_cmp_ge_u32 s92, 144
s_addc_u32 s94, s94, 0
s_cmp_gt_u32 s95, 4
s_cselect_b32 s33, 5, 0
s_sub_u32 s97, s95, s33
s_cmp_eq_u32 s93, 0
s_cselect_b32 s33, 5, 0
s_add_u32 s97, s97, s33
s_cmp_eq_u32 s95, 4
s_cselect_b32 s97, 4, s97
s_mul_i32 s94, s94, 9
s_add_u32 s94, s94, s97
s_mul_i32 s94, s94, 37888
s_add_u32 s94, s94, 2785280
v_and_b32 v36, 3, v2
v_bfe_u32 v37, v2, 2, 1
v_bfe_u32 v38, v2, 3, 1
v_lshl_add_u32 v36, v38, 2, v36
s_lshl_b32 s33, s96, 3
v_add_u32 v36, s33, v36
s_cmp_eq_u32 s95, 4
s_cbranch_scc0 L_w3j_5
s_xor_b32 s33, s93, 1
v_mov_b32 v36, v2
v_mov_b32 v37, s33
L_w3j_5:
v_mul_u32_u24 v43, 18432, v37
v_lshl_add_u32 v43, v36, 4, v43
v_lshl_add_u32 v43, v3, 8, v43
s_mul_i32 s31, s34, 4608
s_add_u32 s31, s31, s94
v_add_u32 v43, s31, v43
v_lshlrev_b32 v44, 9, v37
v_lshl_add_u32 v44, v36, 3, v44
s_lshl_b32 s31, s34, 7
s_add_u32 s31, s31, s94
s_add_u32 s31, s31, 36864
v_add_u32 v44, s31, v44
s_waitcnt vmcnt(6)
s_barrier
ds_read_b64_tr_b16 v[84:85], v45 offset:20480
ds_read_b64_tr_b16 v[86:87], v45 offset:20992
ds_read_b64_tr_b16 v[88:89], v45 offset:24576
ds_read_b64_tr_b16 v[90:91], v45 offset:25088
ds_read_b64_tr_b16 v[92:93], v45 offset:28672
ds_read_b64_tr_b16 v[94:95], v45 offset:29184
ds_read_b64_tr_b16 v[96:97], v45 offset:32768
ds_read_b64_tr_b16 v[98:99], v45 offset:33280
ds_read_b64_tr_b16 v[100:101], v45 offset:36864
ds_read_b64_tr_b16 v[102:103], v45 offset:37376
v_mov_b32 v36, 1073741824
v_mov_b32 v46, 0
v_cndmask_b32 v37, v36, v43, s[50:51]
s_add_u32 s31, s36, 0
s_waitcnt lgkmcnt(8)
buffer_store_dwordx4 v[84:87], v43, s[4:7], s31 offen sc1
s_add_u32 s31, s36, 1024
s_waitcnt lgkmcnt(6)
buffer_store_dwordx4 v[88:91], v43, s[4:7], s31 offen sc1
s_add_u32 s31, s36, 2048
s_waitcnt lgkmcnt(4)
buffer_store_dwordx4 v[92:95], v43, s[4:7], s31 offen sc1
s_add_u32 s31, s36, 3072
s_waitcnt lgkmcnt(2)
buffer_store_dwordx4 v[96:99], v43, s[4:7], s31 offen sc1
s_add_u32 s31, s36, 4096
s_waitcnt lgkmcnt(0)
buffer_store_dwordx4 v[100:103], v37, s[4:7], s31 offen sc1
v_mov_b32 v37, 0x3f803f80
v_dot2c_f32_bf16 v46, v84, v37
v_dot2c_f32_bf16 v46, v85, v37
v_dot2c_f32_bf16 v46, v86, v37
v_dot2c_f32_bf16 v46, v87, v37
v_dot2c_f32_bf16 v46, v88, v37
v_dot2c_f32_bf16 v46, v89, v37
v_dot2c_f32_bf16 v46, v90, v37
v_dot2c_f32_bf16 v46, v91, v37
v_dot2c_f32_bf16 v46, v92, v37
v_dot2c_f32_bf16 v46, v93, v37
v_dot2c_f32_bf16 v46, v94, v37
v_dot2c_f32_bf16 v46, v95, v37
v_dot2c_f32_bf16 v46, v96, v37
v_dot2c_f32_bf16 v46, v97, v37
v_dot2c_f32_bf16 v46, v98, v37
v_dot2c_f32_bf16 v46, v99, v37
v_dot2c_f32_bf16 v46, v100, v37
v_dot2c_f32_bf16 v46, v101, v37
v_dot2c_f32_bf16 v46, v102, v37
v_dot2c_f32_bf16 v46, v103, v37
s_nop 2
v_mov_b32 v37, v46
s_nop 1
v_permlane32_swap_b32 v46, v37
v_add_f32 v46, v46, v37
v_mov_b32 v37, v46
s_nop 1
v_permlane16_swap_b32 v46, v37
v_add_f32 v46, v46, v37
v_cvt_pk_bf16_f32 v50, v46, v46
v_and_b32 v37, 0xffff0000, v50
v_sub_f32 v37, v46, v37
v_cvt_pk_bf16_f32 v51, v37, v37
v_cndmask_b32 v36, v36, v44, s[46:47]
buffer_store_dwordx2 v[50:51], v36, s[4:7], s36 offen sc1
s_cmp_lt_u32 s2, 32
s_cbranch_scc1 L_p0_a4
s_cmp_lt_u32 s2, 176
s_cbranch_scc1 L_p0_b4
v_lshrrev_b32 v39, 2, v2
v_and_b32 v40, 3, v2
v_lshlrev_b32 v40, 3, v40
s_lshl_b32 s31, s24, 5
v_add_u32 v40, s31, v40
v_lshl_add_u32 v36, v3, 2, v39
v_lshl_add_u32 v52, v36, 7, v40
v_lshrrev_b32 v36, 1, v39
v_mul_u32_u24 v36, 18, v36
v_and_b32 v41, 1, v39
v_add3_u32 v36, v36, v41, 16
v_and_b32 v41, 1, v3
v_mul_u32_u24 v41, 72, v41
v_add_u32 v36, v36, v41
v_lshl_add_u32 v53, v36, 7, v40
s_lshl_b32 s31, s52, 6
s_lshl_b32 s33, s24, 4
s_add_u32 s31, s31, s33
v_add_u32 v36, s31, v2
v_mul_u32_u24 v37, 911, v36
v_lshrrev_b32 v37, 16, v37
v_mul_u32_u24 v38, 72, v37
v_sub_u32 v36, v36, v38
s_mov_b32 s31, 82944
v_mul_lo_u32 v41, v37, s31
v_add_u32 v41, 2121728, v41
v_lshrrev_b32 v39, 5, v36
v_lshlrev_b32 v39, 11, v39
v_bfe_u32 v40, v36, 2, 1
v_lshl_add_u32 v39, v40, 10, v39
v_bfe_u32 v40, v36, 3, 2
v_lshl_add_u32 v39, v40, 6, v39
v_and_b32 v40, 3, v36
v_lshl_add_u32 v39, v40, 4, v39
v_lshlrev_b32 v40, 4, v36
v_add_u32 v40, 3072, v40
v_cmp_gt_u32 vcc, 64, v36
v_mov_b32 v47, 7
s_nop 0
v_cndmask_b32 v39, v40, v39, vcc
v_cndmask_b32 v47, v47, 8, vcc
v_add_u32 v41, v41, v39
s_mul_i32 s31, s37, 16
s_add_u32 s31, s31, 0
v_add_u32 v37, s31, v3
v_and_b32 v38, 3, v37
v_lshrrev_b32 v37, 2, v37
v_mul_u32_u24 v37, 4608, v37
v_lshlrev_b32 v38, v47, v38
v_add3_u32 v43, v41, v37, v38
s_mul_i32 s31, s37, 2
s_add_u32 s31, s31, 64
v_add_u32 v37, s31, v3
v_and_b32 v38, 3, v37
v_lshrrev_b32 v37, 2, v37
v_mul_u32_u24 v37, 4608, v37
v_lshlrev_b32 v38, v47, v38
v_add3_u32 v44, v41, v37, v38
s_waitcnt vmcnt(6)
s_barrier
ds_read_b64_tr_b16 v[104:105], v52 offset:40960
ds_read_b64_tr_b16 v[106:107], v52 offset:43264
ds_read_b64_tr_b16 v[108:109], v52 offset:45568
ds_read_b64_tr_b16 v[110:111], v52 offset:47872
ds_read_b64_tr_b16 v[112:113], v52 offset:50176
ds_read_b64_tr_b16 v[114:115], v52 offset:52480
ds_read_b64_tr_b16 v[116:117], v52 offset:54784
ds_read_b64_tr_b16 v[118:119], v52 offset:57088
ds_read_b64_tr_b16 v[120:121], v53 offset:40960
ds_read_b64_tr_b16 v[122:123], v53 offset:45568
v_mov_b32 v36, 1073741824
v_mov_b32 v46, 0
v_cndmask_b32 v37, v36, v44, s[50:51]
s_add_u32 s31, s53, 0
s_waitcnt lgkmcnt(8)
buffer_store_dwordx4 v[104:107], v43, s[4:7], s31 offen sc1
s_add_u32 s31, s53, 4608
s_waitcnt lgkmcnt(6)
buffer_store_dwordx4 v[108:111], v43, s[4:7], s31 offen sc1
s_add_u32 s31, s53, 9216
s_waitcnt lgkmcnt(4)
buffer_store_dwordx4 v[112:115], v43, s[4:7], s31 offen sc1
s_add_u32 s31, s53, 13824
s_waitcnt lgkmcnt(2)
buffer_store_dwordx4 v[116:119], v43, s[4:7], s31 offen sc1
s_add_u32 s31, s53, 0
s_waitcnt lgkmcnt(0)
buffer_store_dwordx4 v[120:123], v37, s[4:7], s31 offen sc1
buffer_store_dwordx2 v[50:51], v36, s[4:7], s53 offen sc1
s_branch L_p0_j4
L_p0_b4:
s_lshl_b32 s31, s52, 6
s_lshl_b32 s33, s24, 4
s_add_u32 s31, s31, s33
v_add_u32 v36, s31, v2
v_mul_u32_u24 v37, 911, v36
v_lshrrev_b32 v37, 16, v37
v_mul_u32_u24 v38, 72, v37
v_sub_u32 v36, v36, v38
s_mov_b32 s31, 331776
v_mul_lo_u32 v41, v37, s31
v_add_u32 v41, 8241152, v41
v_lshrrev_b32 v39, 5, v36
v_lshlrev_b32 v39, 11, v39
v_bfe_u32 v40, v36, 2, 1
v_lshl_add_u32 v39, v40, 10, v39
v_bfe_u32 v40, v36, 3, 2
v_lshl_add_u32 v39, v40, 6, v39
v_and_b32 v40, 3, v36
v_lshl_add_u32 v39, v40, 4, v39
v_lshlrev_b32 v40, 4, v36
v_add_u32 v40, 3072, v40
v_cmp_gt_u32 vcc, 64, v36
v_mov_b32 v47, 7
s_nop 0
v_cndmask_b32 v39, v40, v39, vcc
v_cndmask_b32 v47, v47, 8, vcc
v_add_u32 v41, v41, v39
s_mul_i32 s31, s37, 18
s_add_u32 s31, s31, 0
v_add_u32 v37, s31, v3
v_and_b32 v38, 3, v37
v_lshrrev_b32 v37, 2, v37
v_mul_u32_u24 v37, 4608, v37
v_lshlrev_b32 v38, v47, v38
v_add3_u32 v43, v41, v37, v38
s_waitcnt vmcnt(6)
s_barrier
ds_read_b64_tr_b16 v[104:105], v45 offset:40960
ds_read_b64_tr_b16 v[106:107], v45 offset:41472
ds_read_b64_tr_b16 v[108:109], v45 offset:45056
ds_read_b64_tr_b16 v[110:111], v45 offset:45568
ds_read_b64_tr_b16 v[112:113], v45 offset:49152
ds_read_b64_tr_b16 v[114:115], v45 offset:49664
ds_read_b64_tr_b16 v[116:117], v45 offset:53248
ds_read_b64_tr_b16 v[118:119], v45 offset:53760
ds_read_b64_tr_b16 v[120:121], v45 offset:57344
ds_read_b64_tr_b16 v[122:123], v45 offset:57856
v_mov_b32 v36, 1073741824
v_mov_b32 v46, 0
v_cndmask_b32 v37, v36, v43, s[50:51]
s_add_u32 s31, s53, 0
s_waitcnt lgkmcnt(8)
buffer_store_dwordx4 v[104:107], v43, s[4:7], s31 offen sc1
s_add_u32 s31, s53, 4608
s_waitcnt lgkmcnt(6)
buffer_store_dwordx4 v[108:111], v43, s[4:7], s31 offen sc1
s_add_u32 s31, s53, 9216
s_waitcnt lgkmcnt(4)
buffer_store_dwordx4 v[112:115], v43, s[4:7], s31 offen sc1
s_add_u32 s31, s53, 13824
s_waitcnt lgkmcnt(2)
buffer_store_dwordx4 v[116:119], v43, s[4:7], s31 offen sc1
s_add_u32 s31, s53, 18432
s_waitcnt lgkmcnt(0)
buffer_store_dwordx4 v[120:123], v37, s[4:7], s31 offen sc1
buffer_store_dwordx2 v[50:51], v36, s[4:7], s53 offen sc1
s_branch L_p0_j4
L_p0_a4:
s_lshl_b32 s92, s52, 6
s_lshl_b32 s33, s24, 4
s_add_u32 s92, s92, s33
s_cmp_ge_u32 s92, 2304
s_cselect_b32 s93, 1, 0
s_cselect_b32 s33, 2304, 0
s_sub_u32 s92, s92, s33
s_mul_i32 s94, s92, 1821
s_lshr_b32 s94, s94, 19
s_mul_i32 s33, s94, 288
s_sub_u32 s92, s92, s33
s_lshr_b32 s95, s92, 5
s_bfe_u32 s96, s92, 0x10004
s_lshl_b32 s94, s94, 1
s_cmp_ge_u32 s92, 144
s_addc_u32 s94, s94, 0
s_cmp_gt_u32 s95, 4
s_cselect_b32 s33, 5, 0
s_sub_u32 s97, s95, s33
s_cmp_eq_u32 s93, 0
s_cselect_b32 s33, 5, 0
s_add_u32 s97, s97, s33
s_cmp_eq_u32 s95, 4
s_cselect_b32 s97, 4, s97
s_mul_i32 s94, s94, 9
s_add_u32 s94, s94, s97
s_mul_i32 s94, s94, 37888
s_add_u32 s94, s94, 2785280
v_and_b32 v36, 3, v2
v_bfe_u32 v37, v2, 2, 1
v_bfe_u32 v38, v2, 3, 1
v_lshl_add_u32 v36, v38, 2, v36
s_lshl_b32 s33, s96, 3
v_add_u32 v36, s33, v36
s_cmp_eq_u32 s95, 4
s_cbranch_scc0 L_w3j_8
s_xor_b32 s33, s93, 1
v_mov_b32 v36, v2
v_mov_b32 v37, s33
L_w3j_8:
v_mul_u32_u24 v43, 18432, v37
v_lshl_add_u32 v43, v36, 4, v43
v_lshl_add_u32 v43, v3, 8, v43
s_mul_i32 s31, s37, 4608
s_add_u32 s31, s31, s94
v_add_u32 v43, s31, v43
v_lshlrev_b32 v44, 9, v37
v_lshl_add_u32 v44, v36, 3, v44
s_lshl_b32 s31, s37, 7
s_add_u32 s31, s31, s94
s_add_u32 s31, s31, 36864
v_add_u32 v44, s31, v44
s_waitcnt vmcnt(6)
s_barrier
ds_read_b64_tr_b16 v[104:105], v45 offset:40960
ds_read_b64_tr_b16 v[106:107], v45 offset:41472
ds_read_b64_tr_b16 v[108:109], v45 offset:45056
ds_read_b64_tr_b16 v[110:111], v45 offset:45568
ds_read_b64_tr_b16 v[112:113], v45 offset:49152
ds_read_b64_tr_b16 v[114:115], v45 offset:49664
ds_read_b64_tr_b16 v[116:117], v45 offset:53248
ds_read_b64_tr_b16 v[118:119], v45 offset:53760
ds_read_b64_tr_b16 v[120:121], v45 offset:57344
ds_read_b64_tr_b16 v[122:123], v45 offset:57856
v_mov_b32 v36, 1073741824
v_mov_b32 v46, 0
v_cndmask_b32 v37, v36, v43, s[50:51]
s_add_u32 s31, s53, 0
s_waitcnt lgkmcnt(8)
buffer_store_dwordx4 v[104:107], v43, s[4:7], s31 offen sc1
s_add_u32 s31, s53, 1024
s_waitcnt lgkmcnt(6)
buffer_store_dwordx4 v[108:111], v43, s[4:7], s31 offen sc1
s_add_u32 s31, s53, 2048
s_waitcnt lgkmcnt(4)
buffer_store_dwordx4 v[112:115], v43, s[4:7], s31 offen sc1
s_add_u32 s31, s53, 3072
s_waitcnt lgkmcnt(2)
buffer_store_dwordx4 v[116:119], v43, s[4:7], s31 offen sc1
s_add_u32 s31, s53, 4096
s_waitcnt lgkmcnt(0)
buffer_store_dwordx4 v[120:123], v37, s[4:7], s31 offen sc1
v_mov_b32 v37, 0x3f803f80
v_dot2c_f32_bf16 v46, v104, v37
v_dot2c_f32_bf16 v46, v105, v37
v_dot2c_f32_bf16 v46, v106, v37
v_dot2c_f32_bf16 v46, v107, v37
v_dot2c_f32_bf16 v46, v108, v37
v_dot2c_f32_bf16 v46, v109, v37
v_dot2c_f32_bf16 v46, v110, v37
v_dot2c_f32_bf16 v46, v111, v37
v_dot2c_f32_bf16 v46, v112, v37
v_dot2c_f32_bf16 v46, v113, v37
v_dot2c_f32_bf16 v46, v114, v37
v_dot2c_f32_bf16 v46, v115, v37
v_dot2c_f32_bf16 v46, v116, v37
v_dot2c_f32_bf16 v46, v117, v37
v_dot2c_f32_bf16 v46, v118, v37
v_dot2c_f32_bf16 v46, v119, v37
v_dot2c_f32_bf16 v46, v120, v37
v_dot2c_f32_bf16 v46, v121, v37
v_dot2c_f32_bf16 v46, v122, v37
v_dot2c_f32_bf16 v46, v123, v37
s_nop 2
v_mov_b32 v37, v46
s_nop 1
v_permlane32_swap_b32 v46, v37
v_add_f32 v46, v46, v37
v_mov_b32 v37, v46
s_nop 1
v_permlane16_swap_b32 v46, v37
v_add_f32 v46, v46, v37
v_cvt_pk_bf16_f32 v50, v46, v46
v_and_b32 v37, 0xffff0000, v50
v_sub_f32 v37, v46, v37
v_cvt_pk_bf16_f32 v51, v37, v37
v_cndmask_b32 v36, v36, v44, s[46:47]
buffer_store_dwordx2 v[50:51], v36, s[4:7], s53 offen sc1
L_p0_j4:
s_mov_b32 s12, s74
s_mov_b32 s13, s75
s_mov_b32 s14, 8388608
s_mov_b32 s15, 0x20000
s_lshl_b32 s30, s25, 2
s_add_u32 s30, s30, s24
s_lshl_b32 s30, s30, 17
s_lshl_b32 s98, s26, 8
s_add_u32 s98, s98, s30
s_lshl_b32 s101, s26, 12
s_add_u32 s101, s101, s30
s_add_u32 s101, s101, 10895360
s_lshl_b32 s63, s24, 13
s_add_u32 s63, s63, 61440
s_mov_b32 m0, s63
v_add_u32 v36, 0, v3
v_xor_b32 v37, v36, v2
v_lshlrev_b32 v36, 12, v36
v_lshl_add_u32 v156, v37, 4, v36
v_lshlrev_b32 v37, 4, v37
v_lshl_add_u32 v37, v2, 8, v37
v_add_u32 v160, s63, v37
v_add_u32 v36, 4, v3
v_xor_b32 v37, v36, v2
v_lshlrev_b32 v36, 12, v36
v_lshl_add_u32 v157, v37, 4, v36
v_lshlrev_b32 v37, 4, v37
v_lshl_add_u32 v37, v2, 8, v37
v_add_u32 v161, s63, v37
v_subrev_u32 v157, 1024, v157
v_add_u32 v36, 8, v3
v_xor_b32 v37, v36, v2
v_lshlrev_b32 v36, 12, v36
v_lshl_add_u32 v158, v37, 4, v36
v_lshlrev_b32 v37, 4, v37
v_lshl_add_u32 v37, v2, 8, v37
v_add_u32 v162, s63, v37
v_subrev_u32 v158, 2048, v158
v_add_u32 v36, 12, v3
v_xor_b32 v37, v36, v2
v_lshlrev_b32 v36, 12, v36
v_lshl_add_u32 v159, v37, 4, v36
v_lshlrev_b32 v37, 4, v37
v_lshl_add_u32 v37, v2, 8, v37
v_add_u32 v163, s63, v37
v_subrev_u32 v159, 3072, v159
buffer_load_dwordx4 v156, s[12:15], s98 offen offset:0 nt lds
buffer_load_dwordx4 v157, s[12:15], s98 offen offset:1024 nt lds
buffer_load_dwordx4 v158, s[12:15], s98 offen offset:2048 nt lds
buffer_load_dwordx4 v159, s[12:15], s98 offen offset:3072 nt lds
s_add_u32 m0, s63, 4096
s_add_u32 s98, s98, 65536
buffer_load_dwordx4 v156, s[12:15], s98 offen offset:0 nt lds
buffer_load_dwordx4 v157, s[12:15], s98 offen offset:1024 nt lds
buffer_load_dwordx4 v158, s[12:15], s98 offen offset:2048 nt lds
buffer_load_dwordx4 v159, s[12:15], s98 offen offset:3072 nt lds
s_cmp_eq_u32 s24, 1
s_cbranch_scc0 L_p0done_10
v_lshrrev_b32 v41, 4, v1
s_lshl_b32 s30, s25, 3
s_sub_u32 s30, s30, 1
v_add_u32 v36, s30, v41
v_max_i32 v36, 0, v36
s_lshl_b32 s30, s27, 2
v_add_u32 v37, s30, v2
v_cndmask_b32 v36, v37, v36, s[46:47]
v_bfe_u32 v37, v41, 2, 1
v_mul_u32_u24 v37, 35, v37
s_mul_i32 s30, s26, 36
v_add_u32 v37, s30, v37
v_lshrrev_b32 v37, 6, v37
v_bfe_u32 v38, v41, 3, 2
v_mad_u32_u24 v37, v38, 9, v37
v_and_b32 v38, 3, v41
v_lshl_add_u32 v37, v37, 2, v38
v_add_u32 v37, 128, v37
v_cndmask_b32 v36, v37, v36, s[50:51]
v_lshlrev_b32 v36, 7, v36
s_mov_b32 s30, 19283968
s_mov_b32 s31, 0
s_mov_b32 exec_lo, 0x000f01ff
s_mov_b32 exec_hi, 0x00ffffff
L_p0poll_9:
buffer_load_dwordx2 v[50:51], v36, s[4:7], s30 offen sc1
s_add_u32 s31, s31, 1
s_waitcnt vmcnt(0)
v_cmp_ne_u64 vcc, v[50:51], v[238:239]
s_cmp_gt_u32 s31, 200000
s_cbranch_scc1 L_p0done_10
s_cbranch_vccnz L_p0poll_9
L_p0done_10:
s_mov_b64 exec, -1
s_barrier
s_lshl_b32 s30, s27, 2
s_add_u32 s30, s30, s24
s_mul_i32 s30, s30, 18432
s_mul_i32 s31, s28, 2304
s_add_u32 s30, s30, s31
s_add_u32 s30, s30, 0
v_and_b32 v6, 1, v3
v_lshlrev_b32 v6, 3, v6
v_lshl_add_u32 v6, v2, 4, v6
buffer_load_dwordx4 v[36:39], v1, s[8:11], s30 offen sc1
buffer_load_dwordx4 v[40:43], v1, s[8:11], s30 offen offset:1024 sc1
buffer_load_dwordx2 v[44:45], v6, s[8:11], s30 offen offset:2048 sc1
s_mul_i32 s36, s26, 132608
s_mul_i32 s38, s24, 12288
s_add_u32 m0, s38, 0
s_add_u32 s39, s38, s36
buffer_load_dwordx4 v1, s[4:7], s39 offen offset:0 sc1 lds
buffer_load_dwordx4 v1, s[4:7], s39 offen offset:1024 sc1 lds
buffer_load_dwordx4 v1, s[4:7], s39 offen offset:2048 sc1 lds
buffer_load_dwordx4 v1, s[4:7], s39 offen offset:3072 sc1 lds
s_add_u32 m0, m0, 4096
s_add_u32 s39, s39, 4096
buffer_load_dwordx4 v1, s[4:7], s39 offen offset:0 sc1 lds
buffer_load_dwordx4 v1, s[4:7], s39 offen offset:1024 sc1 lds
buffer_load_dwordx4 v1, s[4:7], s39 offen offset:2048 sc1 lds
buffer_load_dwordx4 v1, s[4:7], s39 offen offset:3072 sc1 lds
s_add_u32 m0, m0, 4096
s_add_u32 s39, s39, 4096
buffer_load_dwordx4 v1, s[4:7], s39 offen offset:0 sc1 lds
buffer_load_dwordx4 v1, s[4:7], s39 offen offset:1024 sc1 lds
buffer_load_dwordx4 v1, s[4:7], s39 offen offset:2048 sc1 lds
buffer_load_dwordx4 v1, s[4:7], s39 offen offset:3072 sc1 lds
v_and_b32 v6, 1, v2
v_cmp_eq_u32 s[40:41], 1, v6
v_lshl_add_u32 v6, v3, 2, v6
v_cmp_le_u32 s[42:43], v6, v2
v_add_u32 v6, 2, v6
v_cmp_le_u32 s[44:45], v6, v2
v_mov_b32 v6, 0x0c0c0100
v_mov_b32 v7, 0x01000c0c
v_cndmask_b32 v6, v6, v7, s[40:41]
v_mov_b32 v8, 0x0c0c0c0c
v_cndmask_b32 v10, v6, v8, s[42:43]
v_cndmask_b32 v12, v8, v6, s[42:43]
v_mov_b32 v6, 0x0c0c0302
v_mov_b32 v7, 0x03020c0c
v_cndmask_b32 v6, v6, v7, s[40:41]
v_cndmask_b32 v11, v6, v8, s[44:45]
v_cndmask_b32 v13, v8, v6, s[44:45]
s_mul_i32 s82, s26, 340992
s_add_u32 s82, s82, 2785280
s_mul_i32 s83, s28, 331776
s_add_u32 s83, s83, 8241152
s_and_b32 s30, s27, 1
s_mul_i32 s30, s30, 165888
s_add_u32 s83, s83, s30
s_waitcnt vmcnt(12)
v_lshlrev_b32 v16, 16, v36
v_and_b32 v17, 0xffff0000, v36
v_lshlrev_b32 v18, 16, v37
v_and_b32 v19, 0xffff0000, v37
v_lshlrev_b32 v20, 16, v38
v_and_b32 v21, 0xffff0000, v38
v_lshlrev_b32 v22, 16, v39
v_and_b32 v23, 0xffff0000, v39
v_lshlrev_b32 v24, 16, v40
v_and_b32 v25, 0xffff0000, v40
v_lshlrev_b32 v26, 16, v41
v_and_b32 v27, 0xffff0000, v41
v_lshlrev_b32 v28, 16, v42
v_and_b32 v29, 0xffff0000, v42
v_lshlrev_b32 v30, 16, v43
v_and_b32 v31, 0xffff0000, v43
v_lshlrev_b32 v32, 16, v44
v_and_b32 v33, 0xffff0000, v44
v_lshlrev_b32 v34, 16, v45
v_and_b32 v35, 0xffff0000, v45
ds_read_b128 a[232:235], v160 offset:0
ds_read_b128 a[236:239], v161 offset:0
ds_read_b128 a[240:243], v162 offset:0
ds_read_b128 a[244:247], v163 offset:0
ds_read_b128 a[248:251], v160 offset:4096
ds_read_b128 a[252:255], v161 offset:4096
ds_read_b128 v[240:243], v162 offset:4096
ds_read_b128 v[244:247], v163 offset:4096
s_waitcnt lgkmcnt(0)
v_mov_b32 v6, 0
s_barrier
v_mov_b32 v248, v238
s_mov_b64 exec, 1
buffer_store_dwordx2 v[238:239], v6, s[4:7], s100 offen sc1
s_mov_b64 exec, -1
s_mul_i32 s36, s26, 132608
s_mul_i32 s38, s24, 9216
s_add_u32 m0, s38, 49152
s_add_u32 s39, s38, s36
s_add_u32 s39, s39, 49152
buffer_load_dwordx4 v1, s[4:7], s39 offen offset:0 sc1 lds
buffer_load_dwordx4 v1, s[4:7], s39 offen offset:1024 sc1 lds
buffer_load_dwordx4 v1, s[4:7], s39 offen offset:2048 sc1 lds
buffer_load_dwordx4 v1, s[4:7], s39 offen offset:3072 sc1 lds
s_add_u32 m0, m0, 4096
s_add_u32 s39, s39, 4096
buffer_load_dwordx4 v1, s[4:7], s39 offen offset:0 sc1 lds
buffer_load_dwordx4 v1, s[4:7], s39 offen offset:1024 sc1 lds
buffer_load_dwordx4 v1, s[4:7], s39 offen offset:2048 sc1 lds
buffer_load_dwordx4 v1, s[4:7], s39 offen offset:3072 sc1 lds
s_add_u32 m0, m0, 4096
s_add_u32 s39, s39, 4096
buffer_load_dwordx4 v1, s[4:7], s39 offen offset:0 sc1 lds
s_lshl_b32 s60, s25, 3
s_sub_u32 s61, s60, 1
s_max_i32 s61, s61, 0
s_lshl_b32 s30, s24, 1
s_add_u32 s60, s60, s30
s_mul_i32 s30, s61, 18432
s_mul_i32 s62, s60, 18432
v_add_u32 v237, 18432, v1
s_mul_i32 s38, s24, 5120
s_add_u32 m0, s38, 135168
s_add_u32 s39, s38, s30
L_layer:
buffer_load_dwordx4 v1, s[8:11], s39 offen offset:0 sc1 lds
buffer_load_dwordx4 v1, s[8:11], s39 offen offset:1024 sc1 lds
buffer_load_dwordx4 v1, s[8:11], s39 offen offset:2048 sc1 lds
buffer_load_dwordx4 v1, s[8:11], s39 offen offset:3072 sc1 lds
s_add_u32 m0, m0, 4096
s_add_u32 s39, s39, 4096
buffer_load_dwordx4 v1, s[8:11], s39 offen offset:0 sc1 lds
s_barrier
buffer_load_dwordx4 a[0:3], v1, s[8:11], s62 offen offset:0 sc1
buffer_load_dwordx4 a[4:7], v237, s[8:11], s62 offen offset:0 sc1
s_barrier
buffer_load_dwordx4 a[8:11], v1, s[8:11], s62 offen offset:1024 sc1
buffer_load_dwordx4 a[12:15], v237, s[8:11], s62 offen offset:1024 sc1
s_barrier
buffer_load_dwordx4 a[16:19], v1, s[8:11], s62 offen offset:2048 sc1
buffer_load_dwordx4 a[20:23], v237, s[8:11], s62 offen offset:2048 sc1
s_barrier
buffer_load_dwordx4 a[24:27], v1, s[8:11], s62 offen offset:3072 sc1
buffer_load_dwordx4 a[28:31], v237, s[8:11], s62 offen offset:3072 sc1
s_barrier
s_add_u32 s62, s62, 4096
buffer_load_dwordx4 a[32:35], v1, s[8:11], s62 offen offset:0 sc1
buffer_load_dwordx4 a[36:39], v237, s[8:11], s62 offen offset:0 sc1
s_barrier
buffer_load_dwordx4 a[40:43], v1, s[8:11], s62 offen offset:1024 sc1
buffer_load_dwordx4 a[44:47], v237, s[8:11], s62 offen offset:1024 sc1
s_sub_u32 s30, s60, 2
v_add_u32 v6, s30, v3
v_max_i32 v6, 0, v6
v_mov_b32 v7, s61
v_cndmask_b32 v6, v6, v7, s[46:47]
v_lshl_add_u32 v6, v6, 4, v2
v_lshlrev_b32 v129, 3, v6
s_lshl_b32 s30, s24, 10
v_add_u32 v125, s30, v1
v_add_u32 v126, 135168, v1
v_lshrrev_b32 v127, 1, v1
v_add_u32 v127, 129024, v127
s_lshl_b32 s30, s24, 9
v_add_u32 v128, s30, v127
v_add_u32 v8, 64512, v1
s_waitcnt vmcnt(12)
s_barrier
ds_read_b128 a[144:147], v1 offset:0
ds_read_b128 a[148:151], v1 offset:1024
ds_read_b128 a[152:155], v1 offset:2048
ds_read_b128 a[156:159], v1 offset:3072
ds_read_b128 a[160:163], v1 offset:4096
ds_read_b128 a[164:167], v1 offset:5120
ds_read_b128 a[168:171], v1 offset:6144
ds_read_b128 a[172:175], v125 offset:0
ds_read_b128 a[176:179], v126 offset:0
v_lshrrev_b32 v146, 1, v1
s_lshl_b32 s66, s24, 9
s_add_u32 s66, s66, 19316736
s_waitcnt vmcnt(10) lgkmcnt(0)
v_mfma_f32_16x16x32_bf16 v[36:39], a[144:147], a[0:3], 0
ds_read_b128 a[180:183], v1 offset:7168
buffer_load_dwordx4 a[48:51], v1, s[8:11], s62 offen offset:2048 sc1
v_mfma_f32_16x16x32_bf16 v[64:67], a[144:147], a[4:7], 0
ds_read_b128 a[184:187], v1 offset:8192
v_mfma_f32_16x16x32_bf16 v[40:43], a[148:151], a[0:3], 0
ds_read_b128 a[188:191], v1 offset:9216
v_mfma_f32_16x16x32_bf16 v[68:71], a[148:151], a[4:7], 0
ds_read_b128 a[192:195], v1 offset:10240
v_mfma_f32_16x16x32_bf16 v[44:47], a[152:155], a[0:3], 0
ds_read_b128 a[196:199], v1 offset:11264
buffer_load_dwordx4 a[52:55], v237, s[8:11], s62 offen offset:2048 sc1
v_mfma_f32_16x16x32_bf16 v[72:75], a[152:155], a[4:7], 0
ds_read_b128 a[200:203], v1 offset:12288
v_mfma_f32_16x16x32_bf16 v[48:51], a[156:159], a[0:3], 0
ds_read_b128 a[204:207], v1 offset:13312
v_mfma_f32_16x16x32_bf16 v[76:79], a[156:159], a[4:7], 0
ds_read_b128 a[208:211], v125 offset:7168
v_mfma_f32_16x16x32_bf16 v[52:55], a[160:163], a[0:3], 0
ds_read_b128 a[212:215], v126 offset:1024
buffer_load_dwordx4 a[56:59], v1, s[8:11], s62 offen offset:3072 sc1
v_mfma_f32_16x16x32_bf16 v[80:83], a[160:163], a[4:7], 0
v_mfma_f32_16x16x32_bf16 v[92:95], a[172:175], a[176:179], 0
v_mfma_f32_16x16x32_bf16 v[96:99], a[160:163], a[176:179], 0
v_mfma_f32_16x16x32_bf16 v[56:59], a[164:167], a[0:3], 0
buffer_load_dwordx4 a[60:63], v237, s[8:11], s62 offen offset:3072 sc1
v_mfma_f32_16x16x32_bf16 v[84:87], a[164:167], a[4:7], 0
s_add_u32 s62, s62, 4096
v_mfma_f32_16x16x32_bf16 v[60:63], a[168:171], a[0:3], 0
v_mfma_f32_16x16x32_bf16 v[88:91], a[168:171], a[4:7], 0
s_waitcnt vmcnt(12) lgkmcnt(0)
v_mfma_f32_16x16x32_bf16 v[36:39], a[180:183], a[8:11], v[36:39]
ds_read_b128 a[144:147], v1 offset:14336
v_lshlrev_b32 v124, 2, v2
v_mfma_f32_16x16x32_bf16 v[64:67], a[180:183], a[12:15], v[64:67]
ds_read_b128 a[148:151], v1 offset:15360
v_mfma_f32_16x16x32_bf16 v[40:43], a[184:187], a[8:11], v[40:43]
ds_read_b128 a[152:155], v1 offset:16384
v_and_b32 v6, 1, v2
v_mfma_f32_16x16x32_bf16 v[68:71], a[184:187], a[12:15], v[68:71]
ds_read_b128 a[156:159], v1 offset:17408
v_mfma_f32_16x16x32_bf16 v[44:47], a[188:191], a[8:11], v[44:47]
ds_read_b128 a[160:163], v1 offset:18432
v_mfma_f32_16x16x32_bf16 v[72:75], a[188:191], a[12:15], v[72:75]
ds_read_b128 a[164:167], v1 offset:19456
buffer_load_dwordx4 a[64:67], v1, s[8:11], s62 offen offset:0 sc1
v_mfma_f32_16x16x32_bf16 v[48:51], a[192:195], a[8:11], v[48:51]
ds_read_b128 a[168:171], v1 offset:20480
v_lshl_add_u32 v6, v3, 2, v6
v_mfma_f32_16x16x32_bf16 v[76:79], a[192:195], a[12:15], v[76:79]
ds_read_b128 a[172:175], v125 offset:14336
v_lshlrev_b32 v6, 2, v6
v_mfma_f32_16x16x32_bf16 v[52:55], a[196:199], a[8:11], v[52:55]
ds_read_b128 a[176:179], v126 offset:2048
v_mfma_f32_16x16x32_bf16 v[80:83], a[196:199], a[12:15], v[80:83]
buffer_load_dwordx4 a[68:71], v237, s[8:11], s62 offen offset:0 sc1
v_mfma_f32_16x16x32_bf16 v[92:95], a[208:211], a[212:215], v[92:95]
v_add_u32 v122, 64, v6
v_mfma_f32_16x16x32_bf16 v[96:99], a[196:199], a[212:215], v[96:99]
v_mfma_f32_16x16x32_bf16 v[56:59], a[200:203], a[8:11], v[56:59]
v_add_u32 v7, 128, v6
v_mfma_f32_16x16x32_bf16 v[84:87], a[200:203], a[12:15], v[84:87]
v_mfma_f32_16x16x32_bf16 v[60:63], a[204:207], a[8:11], v[60:63]
buffer_load_dwordx4 a[72:75], v1, s[8:11], s62 offen offset:1024 sc1
v_mfma_f32_16x16x32_bf16 v[88:91], a[204:207], a[12:15], v[88:91]
s_mov_b32 s63, 2359296
v_cndmask_b32 v122, v122, v7, s[42:43]
s_waitcnt vmcnt(13) lgkmcnt(0)
v_mfma_f32_16x16x32_bf16 v[36:39], a[144:147], a[16:19], v[36:39]
ds_read_b128 a[180:183], v1 offset:21504
v_mfma_f32_16x16x32_bf16 v[64:67], a[144:147], a[20:23], v[64:67]
ds_read_b128 a[184:187], v1 offset:22528
v_add_u32 v123, 72, v6
v_mfma_f32_16x16x32_bf16 v[40:43], a[148:151], a[16:19], v[40:43]
ds_read_b128 a[188:191], v1 offset:23552
v_mfma_f32_16x16x32_bf16 v[68:71], a[148:151], a[20:23], v[68:71]
ds_read_b128 a[192:195], v1 offset:24576
v_mfma_f32_16x16x32_bf16 v[44:47], a[152:155], a[16:19], v[44:47]
ds_read_b128 a[196:199], v1 offset:25600
v_add_u32 v7, 136, v6
v_mfma_f32_16x16x32_bf16 v[72:75], a[152:155], a[20:23], v[72:75]
ds_read_b128 a[200:203], v1 offset:26624
v_mfma_f32_16x16x32_bf16 v[48:51], a[156:159], a[16:19], v[48:51]
ds_read_b128 a[204:207], v1 offset:27648
buffer_load_dwordx2 v[100:101], v129, s[8:11], s63 offen sc1
v_mfma_f32_16x16x32_bf16 v[76:79], a[156:159], a[20:23], v[76:79]
ds_read_b128 a[208:211], v125 offset:21504
v_cndmask_b32 v123, v123, v7, s[44:45]
v_mfma_f32_16x16x32_bf16 v[52:55], a[160:163], a[16:19], v[52:55]
ds_read_b128 a[212:215], v126 offset:3072
s_mul_i32 s36, s26, 132608
v_mfma_f32_16x16x32_bf16 v[80:83], a[160:163], a[20:23], v[80:83]
s_mov_b32 s63, 2375680
s_lshl_b32 s31, s24, 5
v_mfma_f32_16x16x32_bf16 v[92:95], a[172:175], a[176:179], v[92:95]
s_mul_i32 s38, s24, 12288
v_mfma_f32_16x16x32_bf16 v[96:99], a[160:163], a[176:179], v[96:99]
s_add_u32 m0, s38, 86016
v_add_u32 v6, s31, v2
v_mfma_f32_16x16x32_bf16 v[56:59], a[164:167], a[16:19], v[56:59]
s_add_u32 s39, s38, s36
v_mfma_f32_16x16x32_bf16 v[84:87], a[164:167], a[20:23], v[84:87]
s_add_u32 s39, s39, 86016
v_mfma_f32_16x16x32_bf16 v[60:63], a[168:171], a[16:19], v[60:63]
v_mul_u32_u24 v220, 176, v6
v_mfma_f32_16x16x32_bf16 v[88:91], a[168:171], a[20:23], v[88:91]
buffer_load_dwordx2 v[102:103], v129, s[8:11], s63 offen sc1
s_waitcnt vmcnt(13) lgkmcnt(0)
v_mfma_f32_16x16x32_bf16 v[36:39], a[180:183], a[24:27], v[36:39]
ds_read_b128 a[144:147], v1 offset:28672
v_add_u32 v220, 0, v220
v_mfma_f32_16x16x32_bf16 v[64:67], a[180:183], a[28:31], v[64:67]
ds_read_b128 a[148:151], v1 offset:29696
v_mfma_f32_16x16x32_bf16 v[40:43], a[184:187], a[24:27], v[40:43]
ds_read_b128 a[152:155], v1 offset:30720
v_mfma_f32_16x16x32_bf16 v[68:71], a[184:187], a[28:31], v[68:71]
ds_read_b128 a[156:159], v1 offset:31744
s_mov_b32 s63, 2392064
v_mfma_f32_16x16x32_bf16 v[44:47], a[188:191], a[24:27], v[44:47]
ds_read_b128 a[160:163], v1 offset:32768
v_lshl_add_u32 v218, v3, 3, v220
v_mfma_f32_16x16x32_bf16 v[72:75], a[188:191], a[28:31], v[72:75]
ds_read_b128 a[164:167], v1 offset:33792
v_mul_u32_u24 v219, 176, v2
v_mfma_f32_16x16x32_bf16 v[48:51], a[192:195], a[24:27], v[48:51]
ds_read_b128 a[168:171], v1 offset:34816
v_mfma_f32_16x16x32_bf16 v[76:79], a[192:195], a[28:31], v[76:79]
ds_read_b128 a[172:175], v125 offset:28672
buffer_load_dwordx2 v[104:105], v129, s[8:11], s63 offen sc1
v_mfma_f32_16x16x32_bf16 v[52:55], a[196:199], a[24:27], v[52:55]
ds_read_b128 a[176:179], v126 offset:4096
v_lshl_add_u32 v219, v3, 3, v219
v_mfma_f32_16x16x32_bf16 v[80:83], a[196:199], a[28:31], v[80:83]
s_mov_b32 s63, 2408448
v_mfma_f32_16x16x32_bf16 v[92:95], a[208:211], a[212:215], v[92:95]
v_add_u32 v219, 0, v219
v_mfma_f32_16x16x32_bf16 v[96:99], a[196:199], a[212:215], v[96:99]
v_mfma_f32_16x16x32_bf16 v[56:59], a[200:203], a[24:27], v[56:59]
buffer_load_dwordx4 v1, s[4:7], s39 offen offset:0 sc1 lds
v_mfma_f32_16x16x32_bf16 v[84:87], a[200:203], a[28:31], v[84:87]
v_add_u32 v222, s31, v219
v_mfma_f32_16x16x32_bf16 v[60:63], a[204:207], a[24:27], v[60:63]
v_mfma_f32_16x16x32_bf16 v[88:91], a[204:207], a[28:31], v[88:91]
v_lshrrev_b32 v6, 2, v2
s_waitcnt vmcnt(13) lgkmcnt(0)
v_mfma_f32_16x16x32_bf16 v[36:39], a[144:147], a[32:35], v[36:39]
ds_read_b128 a[180:183], v1 offset:35840
buffer_load_dwordx2 v[106:107], v129, s[8:11], s63 offen sc1
v_mfma_f32_16x16x32_bf16 v[64:67], a[144:147], a[36:39], v[64:67]
ds_read_b128 a[184:187], v1 offset:36864
buffer_load_dwordx4 v1, s[4:7], s39 offen offset:1024 sc1 lds
v_mfma_f32_16x16x32_bf16 v[40:43], a[148:151], a[32:35], v[40:43]
ds_read_b128 a[188:191], v1 offset:37888
v_lshl_add_u32 v6, v3, 2, v6
v_mfma_f32_16x16x32_bf16 v[68:71], a[148:151], a[36:39], v[68:71]
ds_read_b128 a[192:195], v1 offset:38912
v_mfma_f32_16x16x32_bf16 v[44:47], a[152:155], a[32:35], v[44:47]
ds_read_b128 a[196:199], v1 offset:39936
buffer_load_dwordx4 v1, s[4:7], s39 offen offset:2048 sc1 lds
v_mfma_f32_16x16x32_bf16 v[72:75], a[152:155], a[36:39], v[72:75]
ds_read_b128 a[200:203], v1 offset:40960
s_mov_b32 s63, 2424832
v_mfma_f32_16x16x32_bf16 v[48:51], a[156:159], a[32:35], v[48:51]
ds_read_b128 a[204:207], v1 offset:41984
v_add_u32 v6, s31, v6
v_mfma_f32_16x16x32_bf16 v[76:79], a[156:159], a[36:39], v[76:79]
ds_read_b128 a[208:211], v125 offset:35840
v_mul_u32_u24 v221, 176, v6
v_mfma_f32_16x16x32_bf16 v[52:55], a[160:163], a[32:35], v[52:55]
ds_read_b128 a[212:215], v126 offset:5120
buffer_load_dwordx2 v[108:109], v129, s[8:11], s63 offen sc1
v_mfma_f32_16x16x32_bf16 v[80:83], a[160:163], a[36:39], v[80:83]
buffer_load_dwordx4 v1, s[4:7], s39 offen offset:3072 sc1 lds
v_and_b32 v6, 3, v2
v_mfma_f32_16x16x32_bf16 v[92:95], a[172:175], a[176:179], v[92:95]
s_mov_b32 s63, 2441216
v_mfma_f32_16x16x32_bf16 v[96:99], a[160:163], a[176:179], v[96:99]
s_add_u32 m0, m0, 4096
v_mfma_f32_16x16x32_bf16 v[56:59], a[164:167], a[32:35], v[56:59]
s_add_u32 s39, s39, 4096
v_lshl_add_u32 v221, v6, 3, v221
v_mfma_f32_16x16x32_bf16 v[84:87], a[164:167], a[36:39], v[84:87]
v_mfma_f32_16x16x32_bf16 v[60:63], a[168:171], a[32:35], v[60:63]
v_add_u32 v221, 0, v221
v_mfma_f32_16x16x32_bf16 v[88:91], a[168:171], a[36:39], v[88:91]
s_waitcnt vmcnt(16) lgkmcnt(0)
v_mfma_f32_16x16x32_bf16 v[36:39], a[180:183], a[40:43], v[36:39]
ds_read_b128 a[144:147], v1 offset:43008
v_mfma_f32_16x16x32_bf16 v[64:67], a[180:183], a[44:47], v[64:67]
ds_read_b128 a[148:151], v1 offset:44032
buffer_load_dwordx2 v[110:111], v129, s[8:11], s63 offen sc1
v_mfma_f32_16x16x32_bf16 v[40:43], a[184:187], a[40:43], v[40:43]
ds_read_b128 a[152:155], v1 offset:45056
v_mov_b32 v171, 0
v_mfma_f32_16x16x32_bf16 v[68:71], a[184:187], a[44:47], v[68:71]
ds_read_b128 a[156:159], v1 offset:46080
v_mov_b32 v172, 0
v_mfma_f32_16x16x32_bf16 v[44:47], a[188:191], a[40:43], v[44:47]
ds_read_b128 a[160:163], v1 offset:47104
buffer_load_dwordx4 v1, s[4:7], s39 offen offset:0 sc1 lds
v_mfma_f32_16x16x32_bf16 v[72:75], a[188:191], a[44:47], v[72:75]
ds_read_b128 a[164:167], v1 offset:48128
s_mov_b32 s63, 2457600
v_mfma_f32_16x16x32_bf16 v[48:51], a[192:195], a[40:43], v[48:51]
ds_read_b128 a[168:171], v1 offset:49152
v_mov_b32 v179, 0
v_mfma_f32_16x16x32_bf16 v[76:79], a[192:195], a[44:47], v[76:79]
ds_read_b128 a[172:175], v125 offset:43008
v_mfma_f32_16x16x32_bf16 v[52:55], a[196:199], a[40:43], v[52:55]
ds_read_b128 a[176:179], v126 offset:6144
buffer_load_dwordx4 v1, s[4:7], s39 offen offset:1024 sc1 lds
v_mfma_f32_16x16x32_bf16 v[80:83], a[196:199], a[44:47], v[80:83]
v_mov_b32 v180, 0
v_mfma_f32_16x16x32_bf16 v[92:95], a[208:211], a[212:215], v[92:95]
buffer_load_dwordx2 v[112:113], v129, s[8:11], s63 offen sc1
v_mfma_f32_16x16x32_bf16 v[96:99], a[196:199], a[212:215], v[96:99]
s_mov_b32 s63, 2473984
s_mul_i32 s30, s60, 18432
v_mfma_f32_16x16x32_bf16 v[56:59], a[200:203], a[40:43], v[56:59]
buffer_load_dwordx4 v1, s[4:7], s39 offen offset:2048 sc1 lds
v_mfma_f32_16x16x32_bf16 v[84:87], a[200:203], a[44:47], v[84:87]
s_add_u32 s30, s30, 2490368
v_mfma_f32_16x16x32_bf16 v[60:63], a[204:207], a[40:43], v[60:63]
s_lshl_b32 s64, s26, 10
v_mfma_f32_16x16x32_bf16 v[88:91], a[204:207], a[44:47], v[88:91]
s_add_u32 s64, s64, s30
s_waitcnt vmcnt(19) lgkmcnt(0)
v_mfma_f32_16x16x32_bf16 v[36:39], a[144:147], a[48:51], v[36:39]
ds_read_b128 a[180:183], v1 offset:50176
buffer_load_dwordx4 v1, s[4:7], s39 offen offset:3072 sc1 lds
v_mfma_f32_16x16x32_bf16 v[64:67], a[144:147], a[52:55], v[64:67]
ds_read_b128 a[184:187], v1 offset:51200
v_mfma_f32_16x16x32_bf16 v[40:43], a[148:151], a[48:51], v[40:43]
ds_read_b128 a[188:191], v1 offset:52224
buffer_load_dwordx2 v[114:115], v129, s[8:11], s63 offen sc1
v_mfma_f32_16x16x32_bf16 v[68:71], a[148:151], a[52:55], v[68:71]
ds_read_b128 a[192:195], v1 offset:53248
v_mfma_f32_16x16x32_bf16 v[44:47], a[152:155], a[48:51], v[44:47]
ds_read_b128 a[196:199], v1 offset:54272
s_add_u32 m0, m0, 4096
v_mfma_f32_16x16x32_bf16 v[72:75], a[152:155], a[52:55], v[72:75]
ds_read_b128 a[200:203], v1 offset:55296
s_and_b32 s65, s26, 1
v_mfma_f32_16x16x32_bf16 v[48:51], a[156:159], a[48:51], v[48:51]
ds_read_b128 a[204:207], v1 offset:56320
buffer_load_dwordx4 a[76:79], v237, s[8:11], s62 offen offset:1024 sc1
v_mfma_f32_16x16x32_bf16 v[76:79], a[156:159], a[52:55], v[76:79]
ds_read_b128 a[208:211], v125 offset:50176
s_lshl_b32 s65, s65, 10
v_mfma_f32_16x16x32_bf16 v[52:55], a[160:163], a[48:51], v[52:55]
ds_read_b128 a[212:215], v126 offset:7168
s_add_u32 s39, s39, 4096
v_mfma_f32_16x16x32_bf16 v[80:83], a[160:163], a[52:55], v[80:83]
s_add_u32 s30, s30, s65
v_mfma_f32_16x16x32_bf16 v[92:95], a[172:175], a[176:179], v[92:95]
s_lshr_b32 s65, s26, 1
v_mfma_f32_16x16x32_bf16 v[96:99], a[160:163], a[176:179], v[96:99]
buffer_load_dwordx4 a[80:83], v1, s[8:11], s62 offen offset:2048 sc1
v_mfma_f32_16x16x32_bf16 v[56:59], a[164:167], a[48:51], v[56:59]
buffer_load_dwordx4 v1, s[4:7], s39 offen offset:0 sc1 lds
v_mfma_f32_16x16x32_bf16 v[84:87], a[164:167], a[52:55], v[84:87]
s_lshl_b32 s65, s65, 7
v_mfma_f32_16x16x32_bf16 v[60:63], a[168:171], a[48:51], v[60:63]
s_add_u32 s65, s65, s30
v_mfma_f32_16x16x32_bf16 v[88:91], a[168:171], a[52:55], v[88:91]
buffer_load_dwordx4 a[84:87], v237, s[8:11], s62 offen offset:2048 sc1
s_waitcnt vmcnt(23) lgkmcnt(0)
v_mfma_f32_16x16x32_bf16 v[36:39], a[180:183], a[56:59], v[36:39]
ds_read_b128 a[144:147], v1 offset:57344
buffer_load_dwordx4 v1, s[4:7], s39 offen offset:1024 sc1 lds
v_mfma_f32_16x16x32_bf16 v[64:67], a[180:183], a[60:63], v[64:67]
ds_read_b128 a[148:151], v1 offset:58368
v_mfma_f32_16x16x32_bf16 v[40:43], a[184:187], a[56:59], v[40:43]
ds_read_b128 a[152:155], v1 offset:59392
v_mfma_f32_16x16x32_bf16 v[68:71], a[184:187], a[60:63], v[68:71]
ds_read_b128 a[156:159], v1 offset:60416
buffer_load_dwordx4 a[88:91], v1, s[8:11], s62 offen offset:3072 sc1
v_mfma_f32_16x16x32_bf16 v[44:47], a[188:191], a[56:59], v[44:47]
ds_read_b128 a[160:163], v1 offset:61440
buffer_load_dwordx4 v1, s[4:7], s39 offen offset:2048 sc1 lds
v_mfma_f32_16x16x32_bf16 v[72:75], a[188:191], a[60:63], v[72:75]
ds_read_b128 a[164:167], v1 offset:62464
s_add_u32 s65, s65, 16384
v_mfma_f32_16x16x32_bf16 v[48:51], a[192:195], a[56:59], v[48:51]
ds_read_b128 a[168:171], v1 offset:63488
v_mov_b32 v224, 1073741824
v_mfma_f32_16x16x32_bf16 v[76:79], a[192:195], a[60:63], v[76:79]
ds_read_b128 a[172:175], v125 offset:57344
v_mfma_f32_16x16x32_bf16 v[52:55], a[196:199], a[56:59], v[52:55]
ds_read_b128 a[176:179], v126 offset:8192
buffer_load_dwordx4 a[92:95], v237, s[8:11], s62 offen offset:3072 sc1
v_mfma_f32_16x16x32_bf16 v[80:83], a[196:199], a[60:63], v[80:83]
buffer_load_dwordx4 v1, s[4:7], s39 offen offset:3072 sc1 lds
v_lshlrev_b32 v225, 3, v2
v_mfma_f32_16x16x32_bf16 v[92:95], a[208:211], a[212:215], v[92:95]
s_add_u32 s62, s62, 4096
v_mfma_f32_16x16x32_bf16 v[96:99], a[196:199], a[212:215], v[96:99]
v_cndmask_b32 v224, v224, v225, s[46:47]
v_mfma_f32_16x16x32_bf16 v[56:59], a[200:203], a[56:59], v[56:59]
buffer_load_dwordx2 v[148:149], v146, s[4:7], s66 offen sc1
v_mfma_f32_16x16x32_bf16 v[84:87], a[200:203], a[60:63], v[84:87]
v_mfma_f32_16x16x32_bf16 v[60:63], a[204:207], a[56:59], v[60:63]
v_add_u32 v225, 18432, v224
v_mfma_f32_16x16x32_bf16 v[88:91], a[204:207], a[60:63], v[88:91]
s_waitcnt vmcnt(27) lgkmcnt(0)
v_add_u32 v125, 64512, v125
v_mfma_f32_16x16x32_bf16 v[36:39], a[144:147], a[64:67], v[36:39]
ds_read_b128 a[180:183], v8 offset:0
buffer_load_dwordx4 a[96:99], v1, s[8:11], s62 offen offset:0 sc1
v_mfma_f32_16x16x32_bf16 v[64:67], a[144:147], a[68:71], v[64:67]
ds_read_b128 a[184:187], v8 offset:1024
v_mfma_f32_16x16x32_bf16 v[40:43], a[148:151], a[64:67], v[40:43]
ds_read_b128 a[188:191], v8 offset:2048
v_mfma_f32_16x16x32_bf16 v[68:71], a[148:151], a[68:71], v[68:71]
ds_read_b128 a[192:195], v8 offset:3072
v_mfma_f32_16x16x32_bf16 v[44:47], a[152:155], a[64:67], v[44:47]
ds_read_b128 a[196:199], v8 offset:4096
buffer_load_dwordx4 a[100:103], v237, s[8:11], s62 offen offset:0 sc1
v_mfma_f32_16x16x32_bf16 v[72:75], a[152:155], a[68:71], v[72:75]
ds_read_b128 a[200:203], v8 offset:5120
v_mfma_f32_16x16x32_bf16 v[48:51], a[156:159], a[64:67], v[48:51]
ds_read_b128 a[204:207], v8 offset:6144
v_mfma_f32_16x16x32_bf16 v[76:79], a[156:159], a[68:71], v[76:79]
ds_read_b128 a[208:211], v125 offset:0
v_mfma_f32_16x16x32_bf16 v[52:55], a[160:163], a[64:67], v[52:55]
ds_read_b128 a[212:215], v126 offset:9216
v_mfma_f32_16x16x32_bf16 v[80:83], a[160:163], a[68:71], v[80:83]
buffer_load_dwordx4 a[104:107], v1, s[8:11], s62 offen offset:1024 sc1
v_mfma_f32_16x16x32_bf16 v[92:95], a[172:175], a[176:179], v[92:95]
v_mfma_f32_16x16x32_bf16 v[96:99], a[160:163], a[176:179], v[96:99]
v_mfma_f32_16x16x32_bf16 v[56:59], a[164:167], a[64:67], v[56:59]
v_mfma_f32_16x16x32_bf16 v[84:87], a[164:167], a[68:71], v[84:87]
buffer_load_dwordx4 a[108:111], v237, s[8:11], s62 offen offset:1024 sc1
v_mfma_f32_16x16x32_bf16 v[60:63], a[168:171], a[64:67], v[60:63]
v_mfma_f32_16x16x32_bf16 v[88:91], a[168:171], a[68:71], v[88:91]
s_waitcnt vmcnt(13) lgkmcnt(0)
v_mfma_f32_16x16x32_bf16 v[36:39], a[180:183], a[72:75], v[36:39]
ds_read_b128 a[144:147], v8 offset:7168
v_mfma_f32_16x16x32_bf16 v[64:67], a[180:183], a[76:79], v[64:67]
ds_read_b128 a[148:151], v8 offset:8192
buffer_load_dwordx4 a[112:115], v1, s[8:11], s62 offen offset:2048 sc1
v_mfma_f32_16x16x32_bf16 v[40:43], a[184:187], a[72:75], v[40:43]
ds_read_b128 a[152:155], v8 offset:9216
v_add_f32 v130, v100, v102
v_mfma_f32_16x16x32_bf16 v[68:71], a[184:187], a[76:79], v[68:71]
ds_read_b128 a[156:159], v8 offset:10240
v_add_f32 v131, v101, v103
v_mfma_f32_16x16x32_bf16 v[44:47], a[188:191], a[72:75], v[44:47]
ds_read_b128 a[160:163], v8 offset:11264
v_add_f32 v130, v130, v104
v_mfma_f32_16x16x32_bf16 v[72:75], a[188:191], a[76:79], v[72:75]
ds_read_b128 a[164:167], v8 offset:12288
v_add_f32 v131, v131, v105
v_mfma_f32_16x16x32_bf16 v[48:51], a[192:195], a[72:75], v[48:51]
ds_read_b128 a[168:171], v8 offset:13312
buffer_load_dwordx4 a[116:119], v237, s[8:11], s62 offen offset:2048 sc1
v_mfma_f32_16x16x32_bf16 v[76:79], a[192:195], a[76:79], v[76:79]
ds_read_b128 a[172:175], v125 offset:7168
v_add_f32 v130, v130, v106
v_mfma_f32_16x16x32_bf16 v[52:55], a[196:199], a[72:75], v[52:55]
ds_read_b128 a[176:179], v126 offset:10240
v_add_f32 v131, v131, v107
v_mfma_f32_16x16x32_bf16 v[80:83], a[196:199], a[76:79], v[80:83]
v_add_f32 v130, v130, v108
v_add_f32 v131, v131, v109
v_mfma_f32_16x16x32_bf16 v[92:95], a[208:211], a[212:215], v[92:95]
buffer_load_dwordx4 a[120:123], v1, s[8:11], s62 offen offset:3072 sc1
v_add_f32 v130, v130, v110
v_mfma_f32_16x16x32_bf16 v[96:99], a[196:199], a[212:215], v[96:99]
v_add_f32 v131, v131, v111
v_mfma_f32_16x16x32_bf16 v[56:59], a[200:203], a[72:75], v[56:59]
v_add_f32 v130, v130, v112
v_mfma_f32_16x16x32_bf16 v[84:87], a[200:203], a[76:79], v[84:87]
v_add_f32 v131, v131, v113
v_mfma_f32_16x16x32_bf16 v[60:63], a[204:207], a[72:75], v[60:63]
buffer_load_dwordx4 a[124:127], v237, s[8:11], s62 offen offset:3072 sc1
v_add_f32 v130, v130, v114
v_mfma_f32_16x16x32_bf16 v[88:91], a[204:207], a[76:79], v[88:91]
s_add_u32 s62, s62, 4096
v_add_f32 v131, v131, v115
s_waitcnt vmcnt(14) lgkmcnt(0)
v_mfma_f32_16x16x32_bf16 v[36:39], a[144:147], a[80:83], v[36:39]
ds_read_b128 a[180:183], v8 offset:14336
v_mul_f32 v130, 0x3ae38e39, v130
v_mfma_f32_16x16x32_bf16 v[64:67], a[144:147], a[84:87], v[64:67]
ds_read_b128 a[184:187], v8 offset:15360
v_mul_f32 v6, v130, v130
v_mfma_f32_16x16x32_bf16 v[40:43], a[148:151], a[80:83], v[40:43]
ds_read_b128 a[188:191], v8 offset:16384
v_mul_f32 v131, 0x3ae38e39, v131
v_mfma_f32_16x16x32_bf16 v[68:71], a[148:151], a[84:87], v[68:71]
ds_read_b128 a[192:195], v8 offset:17408
v_mfma_f32_16x16x32_bf16 v[44:47], a[152:155], a[80:83], v[44:47]
ds_read_b128 a[196:199], v8 offset:18432
v_sub_f32 v131, v131, v6
v_mfma_f32_16x16x32_bf16 v[72:75], a[152:155], a[84:87], v[72:75]
ds_read_b128 a[200:203], v8 offset:19456
v_max_f32 v131, 0, v131
v_mfma_f32_16x16x32_bf16 v[48:51], a[156:159], a[80:83], v[48:51]
ds_read_b128 a[204:207], v8 offset:20480
v_add_f32 v131, 0x3727c5ac, v131
v_mfma_f32_16x16x32_bf16 v[76:79], a[156:159], a[84:87], v[76:79]
ds_read_b128 a[208:211], v125 offset:14336
buffer_load_dwordx4 a[128:131], v1, s[8:11], s62 offen offset:0 sc1
v_mfma_f32_16x16x32_bf16 v[52:55], a[160:163], a[80:83], v[52:55]
ds_read_b128 a[212:215], v126 offset:11264
v_mfma_f32_16x16x32_bf16 v[80:83], a[160:163], a[84:87], v[80:83]
v_rsq_f32 v132, v131
v_mfma_f32_16x16x32_bf16 v[92:95], a[172:175], a[176:179], v[92:95]
v_cvt_pk_bf16_f32 v6, -v130, -v130
v_and_b32 v6, 0xffff0000, v6
v_mfma_f32_16x16x32_bf16 v[96:99], a[160:163], a[176:179], v[96:99]
buffer_load_dwordx4 a[132:135], v237, s[8:11], s62 offen offset:0 sc1
v_add_f32 v6, v130, v6
v_mfma_f32_16x16x32_bf16 v[56:59], a[164:167], a[80:83], v[56:59]
v_cvt_pk_bf16_f32 v133, -v130, -v6
v_mfma_f32_16x16x32_bf16 v[84:87], a[164:167], a[84:87], v[84:87]
v_mfma_f32_16x16x32_bf16 v[60:63], a[168:171], a[80:83], v[60:63]
v_mfma_f32_16x16x32_bf16 v[88:91], a[168:171], a[84:87], v[88:91]
s_waitcnt vmcnt(10) lgkmcnt(0)
v_cmp_ne_u64 vcc, v[148:149], v[238:239]
s_cmp_eq_u32 s29, 0
s_cselect_b64 vcc, vcc, 0
s_cbranch_vccnz L_dbslow_11
L_dbback_12:
s_barrier
v_mfma_f32_16x16x32_bf16 v[36:39], a[180:183], a[88:91], v[36:39]
ds_read_b128 a[144:147], v8 offset:21504
buffer_load_dwordx4 a[136:139], v1, s[8:11], s62 offen offset:1024 sc1
v_mfma_f32_16x16x32_bf16 v[64:67], a[180:183], a[92:95], v[64:67]
ds_read_b128 a[148:151], v8 offset:22528
v_mfma_f32_16x16x32_bf16 v[40:43], a[184:187], a[88:91], v[40:43]
ds_read_b128 a[152:155], v8 offset:23552
v_mfma_f32_16x16x32_bf16 v[68:71], a[184:187], a[92:95], v[68:71]
ds_read_b128 a[156:159], v8 offset:24576
v_mfma_f32_16x16x32_bf16 v[44:47], a[188:191], a[88:91], v[44:47]
ds_read_b128 a[160:163], v8 offset:25600
buffer_load_dwordx4 a[140:143], v237, s[8:11], s62 offen offset:1024 sc1
v_mfma_f32_16x16x32_bf16 v[72:75], a[188:191], a[92:95], v[72:75]
ds_read_b128 a[164:167], v8 offset:26624
v_mfma_f32_16x16x32_bf16 v[48:51], a[192:195], a[88:91], v[48:51]
ds_read_b128 a[168:171], v8 offset:27648
v_mfma_f32_16x16x32_bf16 v[76:79], a[192:195], a[92:95], v[76:79]
ds_read_b128 a[172:175], v125 offset:21504
v_mfma_f32_16x16x32_bf16 v[52:55], a[196:199], a[88:91], v[52:55]
ds_read_b128 a[176:179], v126 offset:12288
s_mov_b32 s37, L_c2-L_pc
v_mfma_f32_16x16x32_bf16 v[80:83], a[196:199], a[92:95], v[80:83]
ds_bpermute_b32 v116, v124, v133 offset:128
v_mfma_f32_16x16x32_bf16 v[92:95], a[208:211], a[212:215], v[92:95]
ds_bpermute_b32 v118, v124, v133 offset:192
v_mfma_f32_16x16x32_bf16 v[96:99], a[196:199], a[212:215], v[96:99]
ds_bpermute_b32 v120, v124, v133
v_mfma_f32_16x16x32_bf16 v[56:59], a[200:203], a[88:91], v[56:59]
buffer_load_dword v15, v14, s[88:91], s37 offen
ds_bpermute_b32 v134, v124, v132 offset:128
v_mfma_f32_16x16x32_bf16 v[84:87], a[200:203], a[92:95], v[84:87]
ds_bpermute_b32 v135, v124, v132 offset:192
v_mfma_f32_16x16x32_bf16 v[60:63], a[204:207], a[88:91], v[60:63]
v_mfma_f32_16x16x32_bf16 v[88:91], a[204:207], a[92:95], v[88:91]
s_waitcnt vmcnt(11) lgkmcnt(0)
v_mfma_f32_16x16x32_bf16 v[36:39], a[144:147], a[96:99], v[36:39]
ds_read_b128 a[180:183], v8 offset:28672
v_mfma_f32_16x16x32_bf16 v[64:67], a[144:147], a[100:103], v[64:67]
ds_read_b128 a[184:187], v8 offset:29696
v_mfma_f32_16x16x32_bf16 v[40:43], a[148:151], a[96:99], v[40:43]
ds_read_b128 a[188:191], v8 offset:30720
v_mfma_f32_16x16x32_bf16 v[68:71], a[148:151], a[100:103], v[68:71]
ds_read_b128 a[192:195], v8 offset:31744
v_mfma_f32_16x16x32_bf16 v[44:47], a[152:155], a[96:99], v[44:47]
ds_read_b128 a[196:199], v8 offset:32768
s_mul_i32 s36, s28, 82944
v_mfma_f32_16x16x32_bf16 v[72:75], a[152:155], a[100:103], v[72:75]
ds_read_b128 a[200:203], v8 offset:33792
v_mfma_f32_16x16x32_bf16 v[48:51], a[156:159], a[96:99], v[48:51]
ds_read_b128 a[204:207], v8 offset:34816
buffer_store_dwordx4 a[232:235], v1, s[4:7], s101 offen offset:0 sc1
v_mfma_f32_16x16x32_bf16 v[76:79], a[156:159], a[100:103], v[76:79]
ds_read_b128 a[208:211], v125 offset:28672
s_mul_i32 s38, s24, 10240
v_mfma_f32_16x16x32_bf16 v[52:55], a[160:163], a[96:99], v[52:55]
ds_read_b128 a[212:215], v126 offset:13312
v_mfma_f32_16x16x32_bf16 v[80:83], a[160:163], a[100:103], v[80:83]
ds_bpermute_b32 v136, v122, v132 offset:0
v_mfma_f32_16x16x32_bf16 v[92:95], a[172:175], a[176:179], v[92:95]
ds_bpermute_b32 v137, v123, v132 offset:0
v_mfma_f32_16x16x32_bf16 v[96:99], a[160:163], a[176:179], v[96:99]
ds_bpermute_b32 v138, v122, v132 offset:64
s_add_u32 m0, s38, 37888
v_mfma_f32_16x16x32_bf16 v[56:59], a[164:167], a[96:99], v[56:59]
ds_bpermute_b32 v139, v123, v132 offset:64
v_mfma_f32_16x16x32_bf16 v[84:87], a[164:167], a[100:103], v[84:87]
s_add_u32 s39, s38, s36
v_mfma_f32_16x16x32_bf16 v[60:63], a[168:171], a[96:99], v[60:63]
buffer_store_dwordx4 a[236:239], v1, s[4:7], s101 offen offset:1024 sc1
v_mfma_f32_16x16x32_bf16 v[88:91], a[168:171], a[100:103], v[88:91]
s_add_u32 s39, s39, 2121728
s_waitcnt vmcnt(11) lgkmcnt(0)
v_mfma_f32_16x16x32_bf16 v[36:39], a[180:183], a[104:107], v[36:39]
ds_read_b128 a[144:147], v8 offset:35840
v_mov_b32 v117, v116
v_mfma_f32_16x16x32_bf16 v[64:67], a[180:183], a[108:111], v[64:67]
ds_read_b128 a[148:151], v8 offset:36864
v_mfma_f32_16x16x32_bf16 v[40:43], a[184:187], a[104:107], v[40:43]
ds_read_b128 a[152:155], v8 offset:37888
v_mov_b32 v119, v118
v_mfma_f32_16x16x32_bf16 v[68:71], a[184:187], a[108:111], v[68:71]
ds_read_b128 a[156:159], v8 offset:38912
v_mfma_f32_16x16x32_bf16 v[44:47], a[188:191], a[104:107], v[44:47]
ds_read_b128 a[160:163], v8 offset:39936
v_mov_b32 v121, v120
v_mfma_f32_16x16x32_bf16 v[72:75], a[188:191], a[108:111], v[72:75]
ds_read_b128 a[164:167], v8 offset:40960
v_mfma_f32_16x16x32_bf16 v[48:51], a[192:195], a[104:107], v[48:51]
ds_read_b128 a[168:171], v8 offset:41984
v_mfma_f32_16x16x32_bf16 v[76:79], a[192:195], a[108:111], v[76:79]
ds_read_b128 a[172:175], v125 offset:35840
buffer_load_dwordx4 v1, s[4:7], s39 offen offset:0 sc1 lds
v_mfma_f32_16x16x32_bf16 v[52:55], a[196:199], a[104:107], v[52:55]
ds_read_b128 a[176:179], v126 offset:14336
buffer_store_dwordx4 a[240:243], v1, s[4:7], s101 offen offset:2048 sc1
v_mfma_f32_16x16x32_bf16 v[80:83], a[196:199], a[108:111], v[80:83]
v_mul_f32 v134, 0x3eae1a93, v134
v_mul_f32 v135, 0x3eae1a93, v135
v_mfma_f32_16x16x32_bf16 v[92:95], a[208:211], a[212:215], v[92:95]
v_mfma_f32_16x16x32_bf16 v[96:99], a[196:199], a[212:215], v[96:99]
buffer_load_dwordx4 v1, s[4:7], s39 offen offset:1024 sc1 lds
v_mul_f32 v140, v134, v136
v_mfma_f32_16x16x32_bf16 v[56:59], a[200:203], a[104:107], v[56:59]
v_mfma_f32_16x16x32_bf16 v[84:87], a[200:203], a[108:111], v[84:87]
v_mfma_f32_16x16x32_bf16 v[60:63], a[204:207], a[104:107], v[60:63]
v_mul_f32 v141, v134, v137
v_mfma_f32_16x16x32_bf16 v[88:91], a[204:207], a[108:111], v[88:91]
buffer_load_dwordx4 v1, s[4:7], s39 offen offset:2048 sc1 lds
s_waitcnt vmcnt(13) lgkmcnt(0)
v_mfma_f32_16x16x32_bf16 v[36:39], a[144:147], a[112:115], v[36:39]
ds_read_b128 a[180:183], v8 offset:43008
buffer_store_dwordx4 a[244:247], v1, s[4:7], s101 offen offset:3072 sc1
v_mfma_f32_16x16x32_bf16 v[64:67], a[144:147], a[116:119], v[64:67]
ds_read_b128 a[184:187], v8 offset:44032
v_mul_f32 v142, v135, v138
v_mfma_f32_16x16x32_bf16 v[40:43], a[148:151], a[112:115], v[40:43]
ds_read_b128 a[188:191], v8 offset:45056
v_mul_f32 v143, v135, v139
v_mfma_f32_16x16x32_bf16 v[68:71], a[148:151], a[116:119], v[68:71]
ds_read_b128 a[192:195], v8 offset:46080
buffer_load_dwordx4 v1, s[4:7], s39 offen offset:3072 sc1 lds
v_mfma_f32_16x16x32_bf16 v[44:47], a[152:155], a[112:115], v[44:47]
ds_read_b128 a[196:199], v8 offset:47104
v_mfma_f32_16x16x32_bf16 v[72:75], a[152:155], a[116:119], v[72:75]
ds_read_b128 a[200:203], v8 offset:48128
v_mfma_f32_16x16x32_bf16 v[48:51], a[156:159], a[112:115], v[48:51]
ds_read_b128 a[204:207], v8 offset:49152
v_mfma_f32_16x16x32_bf16 v[76:79], a[156:159], a[116:119], v[76:79]
ds_read_b128 a[208:211], v125 offset:43008
s_add_u32 m0, m0, 4096
v_mfma_f32_16x16x32_bf16 v[52:55], a[160:163], a[112:115], v[52:55]
ds_read_b128 a[212:215], v126 offset:15360
v_mfma_f32_16x16x32_bf16 v[80:83], a[160:163], a[116:119], v[80:83]
ds_read_b64 a[216:217], v127 offset:0
buffer_store_dwordx4 a[248:251], v9, s[4:7], s101 offen offset:0 sc1
v_mfma_f32_16x16x32_bf16 v[92:95], a[172:175], a[176:179], v[92:95]
ds_read_b64 a[218:219], v127 offset:512
v_mfma_f32_16x16x32_bf16 v[96:99], a[160:163], a[176:179], v[96:99]
s_cmp_eq_u32 s60, 0
s_cselect_b32 s30, 0xf149f2ca, 0
s_add_u32 s39, s39, 4096
v_mfma_f32_16x16x32_bf16 v[56:59], a[164:167], a[112:115], v[56:59]
ds_read_b64 a[220:221], v127 offset:1024
v_mov_b32 v6, s30
v_mfma_f32_16x16x32_bf16 v[84:87], a[164:167], a[116:119], v[84:87]
ds_read_b64 a[222:223], v127 offset:1536
v_cndmask_b32 v144, v6, 0, s[42:43]
v_mfma_f32_16x16x32_bf16 v[60:63], a[168:171], a[112:115], v[60:63]
v_cndmask_b32 v145, v6, 0, s[44:45]
v_mfma_f32_16x16x32_bf16 v[88:91], a[168:171], a[116:119], v[88:91]
buffer_load_dwordx4 v1, s[4:7], s39 offen offset:0 sc1 lds
s_waitcnt vmcnt(15) lgkmcnt(0)
v_mfma_f32_16x16x32_bf16 v[36:39], a[180:183], a[120:123], v[36:39]
ds_read_b128 a[144:147], v8 offset:50176
v_mfma_f32_16x16x32_bf16 v[64:67], a[180:183], a[124:127], v[64:67]
ds_read_b128 a[148:151], v8 offset:51200
buffer_store_dwordx4 a[252:255], v9, s[4:7], s101 offen offset:1024 sc1
v_mfma_f32_16x16x32_bf16 v[40:43], a[184:187], a[120:123], v[40:43]
ds_read_b128 a[152:155], v8 offset:52224
v_mfma_f32_16x16x32_bf16 v[68:71], a[184:187], a[124:127], v[68:71]
ds_read_b128 a[156:159], v8 offset:53248
buffer_load_dwordx4 v1, s[4:7], s39 offen offset:1024 sc1 lds
v_mfma_f32_16x16x32_bf16 v[44:47], a[188:191], a[120:123], v[44:47]
ds_read_b128 a[160:163], v8 offset:54272
v_mfma_f32_16x16x32_bf16 v[72:75], a[188:191], a[124:127], v[72:75]
ds_read_b128 a[164:167], v8 offset:55296
v_mfma_f32_16x16x32_bf16 v[48:51], a[192:195], a[120:123], v[48:51]
ds_read_b128 a[168:171], v8 offset:56320
v_mfma_f32_16x16x32_bf16 v[76:79], a[192:195], a[124:127], v[76:79]
ds_read_b128 a[172:175], v125 offset:50176
buffer_load_dwordx4 v1, s[4:7], s39 offen offset:2048 sc1 lds
v_mfma_f32_16x16x32_bf16 v[52:55], a[196:199], a[120:123], v[52:55]
ds_read_b128 a[176:179], v126 offset:16384
v_mfma_f32_16x16x32_bf16 v[80:83], a[196:199], a[124:127], v[80:83]
ds_read_b64 a[224:225], v127 offset:2048
v_mfma_f32_16x16x32_bf16 v[92:95], a[208:211], a[212:215], v[92:95]
ds_read_b64 a[226:227], v127 offset:2560
buffer_store_dwordx4 v[240:243], v9, s[4:7], s101 offen offset:2048 sc1
v_mfma_f32_16x16x32_bf16 v[96:99], a[196:199], a[212:215], v[96:99]
buffer_load_dwordx4 v1, s[4:7], s39 offen offset:3072 sc1 lds
v_mfma_f32_16x16x32_bf16 v[56:59], a[200:203], a[120:123], v[56:59]
ds_read_b64 a[228:229], v127 offset:3072
v_mfma_f32_16x16x32_bf16 v[84:87], a[200:203], a[124:127], v[84:87]
ds_read_b64 a[230:231], v128
v_mfma_f32_16x16x32_bf16 v[60:63], a[204:207], a[120:123], v[60:63]
s_add_u32 m0, m0, 4096
v_mfma_f32_16x16x32_bf16 v[88:91], a[204:207], a[124:127], v[88:91]
s_add_u32 s39, s39, 4096
s_waitcnt vmcnt(18) lgkmcnt(0)
v_mfma_f32_16x16x32_bf16 v[36:39], a[144:147], a[128:131], v[36:39]
ds_read_b128 a[180:183], v8 offset:57344
v_mfma_f32_16x16x32_bf16 v[64:67], a[144:147], a[132:135], v[64:67]
ds_read_b128 a[184:187], v8 offset:58368
v_mfma_f32_16x16x32_bf16 v[40:43], a[148:151], a[128:131], v[40:43]
ds_read_b128 a[188:191], v8 offset:59392
v_mfma_f32_16x16x32_bf16 v[68:71], a[148:151], a[132:135], v[68:71]
ds_read_b128 a[192:195], v8 offset:60416
buffer_store_dwordx4 v[244:247], v9, s[4:7], s101 offen offset:3072 sc1
v_mfma_f32_16x16x32_bf16 v[44:47], a[152:155], a[128:131], v[44:47]
ds_read_b128 a[196:199], v8 offset:61440
v_mfma_f32_16x16x32_bf16 v[72:75], a[152:155], a[132:135], v[72:75]
ds_read_b128 a[200:203], v8 offset:62464
v_mfma_f32_16x16x32_bf16 v[48:51], a[156:159], a[128:131], v[48:51]
ds_read_b128 a[204:207], v8 offset:63488
v_mfma_f32_16x16x32_bf16 v[76:79], a[156:159], a[132:135], v[76:79]
ds_read_b128 a[208:211], v125 offset:57344
buffer_load_dwordx4 v1, s[4:7], s39 offen offset:0 sc1 lds
v_mfma_f32_16x16x32_bf16 v[52:55], a[160:163], a[128:131], v[52:55]
ds_read_b128 a[212:215], v126 offset:17408
v_mfma_f32_16x16x32_bf16 v[80:83], a[160:163], a[132:135], v[80:83]
s_mov_b32 s101, 1073741824
v_mfma_f32_16x16x32_bf16 v[92:95], a[172:175], a[176:179], v[92:95]
v_mfma_f32_16x16x32_bf16 v[96:99], a[160:163], a[176:179], v[96:99]
buffer_load_dwordx4 v1, s[4:7], s39 offen offset:1024 sc1 lds
v_mfma_f32_16x16x32_bf16 v[56:59], a[164:167], a[128:131], v[56:59]
v_mfma_f32_16x16x32_bf16 v[84:87], a[164:167], a[132:135], v[84:87]
v_mfma_f32_16x16x32_bf16 v[60:63], a[168:171], a[128:131], v[60:63]
v_mfma_f32_16x16x32_bf16 v[88:91], a[168:171], a[132:135], v[88:91]
s_waitcnt vmcnt(19) lgkmcnt(0)
v_mfma_f32_16x16x32_bf16 v[36:39], a[180:183], a[136:139], v[36:39]
v_mfma_f32_16x16x32_bf16 v[64:67], a[180:183], a[140:143], v[64:67]
v_mfma_f32_16x16x16_bf16 v[36:39], a[216:217], v[116:117], v[36:39]
v_mfma_f32_16x16x16_bf16 v[64:67], a[216:217], v[118:119], v[64:67]
v_mfma_f32_16x16x32_bf16 v[40:43], a[184:187], a[136:139], v[40:43]
v_mfma_f32_16x16x32_bf16 v[68:71], a[184:187], a[140:143], v[68:71]
s_nop 1
v_mfma_f32_16x16x16_bf16 v[40:43], a[218:219], v[116:117], v[40:43]
s_nop 1
v_mfma_f32_16x16x16_bf16 v[68:71], a[218:219], v[118:119], v[68:71]
v_cvt_pk_bf16_f32 v156, v36, v37
v_cvt_pk_bf16_f32 v157, v38, v39
v_mfma_f32_16x16x32_bf16 v[44:47], a[188:191], a[136:139], v[44:47]
ds_write_b64 v218, v[156:157] offset:2816
v_mfma_f32_16x16x32_bf16 v[72:75], a[188:191], a[140:143], v[72:75]
v_cvt_pk_bf16_f32 v162, v64, v65
v_cvt_pk_bf16_f32 v163, v66, v67
v_mfma_f32_16x16x16_bf16 v[44:47], a[220:221], v[116:117], v[44:47]
ds_write_b64 v218, v[162:163] offset:5632
v_mfma_f32_16x16x16_bf16 v[72:75], a[220:221], v[118:119], v[72:75]
v_cvt_pk_bf16_f32 v160, v40, v41
v_cvt_pk_bf16_f32 v161, v42, v43
v_mfma_f32_16x16x32_bf16 v[48:51], a[192:195], a[136:139], v[48:51]
ds_write_b64 v218, v[160:161] offset:2848
v_mfma_f32_16x16x32_bf16 v[76:79], a[192:195], a[140:143], v[76:79]
v_cvt_pk_bf16_f32 v166, v68, v69
v_cvt_pk_bf16_f32 v167, v70, v71
v_mfma_f32_16x16x16_bf16 v[48:51], a[222:223], v[116:117], v[48:51]
ds_write_b64 v218, v[166:167] offset:5664
v_mfma_f32_16x16x16_bf16 v[76:79], a[222:223], v[118:119], v[76:79]
v_cvt_pk_bf16_f32 v202, v44, v45
v_cvt_pk_bf16_f32 v203, v46, v47
v_mfma_f32_16x16x32_bf16 v[52:55], a[196:199], a[136:139], v[52:55]
ds_write_b64 v218, v[202:203] offset:2880
v_mfma_f32_16x16x32_bf16 v[80:83], a[196:199], a[140:143], v[80:83]
v_cvt_pk_bf16_f32 v204, v72, v73
v_cvt_pk_bf16_f32 v205, v74, v75
v_mfma_f32_16x16x16_bf16 v[52:55], a[224:225], v[116:117], v[52:55]
ds_write_b64 v218, v[204:205] offset:5696
v_mfma_f32_16x16x16_bf16 v[80:83], a[224:225], v[118:119], v[80:83]
v_cvt_pk_bf16_f32 v206, v48, v49
v_cvt_pk_bf16_f32 v207, v50, v51
v_mfma_f32_16x16x32_bf16 v[92:95], a[208:211], a[212:215], v[92:95]
ds_write_b64 v218, v[206:207] offset:2912
v_mfma_f32_16x16x32_bf16 v[96:99], a[196:199], a[212:215], v[96:99]
v_cvt_pk_bf16_f32 v208, v76, v77
v_cvt_pk_bf16_f32 v209, v78, v79
v_mfma_f32_16x16x16_bf16 v[92:95], a[230:231], v[120:121], v[92:95]
ds_write_b64 v218, v[208:209] offset:5728
v_mfma_f32_16x16x16_bf16 v[96:99], a[224:225], v[120:121], v[96:99]
v_cvt_pk_bf16_f32 v210, v52, v53
v_cvt_pk_bf16_f32 v211, v54, v55
v_mfma_f32_16x16x32_bf16 v[56:59], a[200:203], a[136:139], v[56:59]
ds_write_b64 v218, v[210:211] offset:2944
v_mfma_f32_16x16x32_bf16 v[84:87], a[200:203], a[140:143], v[84:87]
v_cvt_pk_bf16_f32 v212, v80, v81
v_cvt_pk_bf16_f32 v213, v82, v83
v_mfma_f32_16x16x16_bf16 v[56:59], a[226:227], v[116:117], v[56:59]
ds_write_b64 v218, v[212:213] offset:5760
v_mfma_f32_16x16x16_bf16 v[84:87], a[226:227], v[118:119], v[84:87]
v_cvt_pk_bf16_f32 v214, v92, v93
v_cvt_pk_bf16_f32 v215, v94, v95
v_mfma_f32_16x16x32_bf16 v[60:63], a[204:207], a[136:139], v[60:63]
ds_write_b64 v222, v[214:215]
v_mfma_f32_16x16x32_bf16 v[88:91], a[204:207], a[140:143], v[88:91]
v_cvt_pk_bf16_f32 v216, v96, v97
v_cvt_pk_bf16_f32 v217, v98, v99
v_mfma_f32_16x16x16_bf16 v[60:63], a[228:229], v[116:117], v[60:63]
ds_write_b64 v219, v[216:217] offset:128
v_mfma_f32_16x16x16_bf16 v[88:91], a[228:229], v[118:119], v[88:91]
s_waitcnt lgkmcnt(0)
s_barrier
ds_read_b64 v[150:151], v218
ds_read_b64 v[154:155], v218 offset:32
ds_read_b64 v[152:153], v220 offset:136
ds_read_b64 v[158:159], v220 offset:2952
ds_read_b64 v[164:165], v220 offset:5768
s_mul_i32 s36, s28, 82944
s_mul_i32 s38, s24, 11264
s_add_u32 m0, s38, 78848
s_add_u32 s39, s38, s36
s_add_u32 s39, s39, 2162688
buffer_load_dwordx4 v1, s[4:7], s39 offen offset:0 sc1 lds
buffer_load_dwordx4 v1, s[4:7], s39 offen offset:1024 sc1 lds
v_cndmask_b32 v170, 0, v210, s[48:49]
v_cndmask_b32 v173, 0, v211, s[48:49]
v_cndmask_b32 v178, 0, v212, s[48:49]
v_cndmask_b32 v181, 0, v213, s[48:49]
v_cvt_pk_bf16_f32 v168, v56, v57
v_cvt_pk_bf16_f32 v169, v58, v59
v_cvt_pk_bf16_f32 v176, v84, v85
v_cvt_pk_bf16_f32 v177, v86, v87
v_cvt_pk_bf16_f32 v174, v60, v61
v_cvt_pk_bf16_f32 v175, v62, v63
v_cvt_pk_bf16_f32 v182, v88, v89
v_cvt_pk_bf16_f32 v183, v90, v91
s_waitcnt lgkmcnt(0)
ds_read_b64_tr_b16 v[184:185], v221 offset:64
v_mfma_f32_16x16x32_bf16 v[36:39], v[150:153], v[168:171], 0
ds_read_b64_tr_b16 v[186:187], v221 offset:2880
v_mfma_f32_16x16x32_bf16 v[40:43], v[156:159], v[168:171], 0
ds_read_b64_tr_b16 v[188:189], v221 offset:5696
buffer_load_dwordx4 v1, s[4:7], s39 offen offset:2048 sc1 lds
v_mfma_f32_16x16x32_bf16 v[44:47], v[152:155], v[172:175], 0
ds_read_b64_tr_b16 v[190:191], v221 offset:96
v_mfma_f32_16x16x32_bf16 v[48:51], v[158:161], v[172:175], 0
ds_read_b64_tr_b16 v[192:193], v221 offset:2912
buffer_load_dwordx4 v1, s[4:7], s39 offen offset:3072 sc1 lds
v_mfma_f32_16x16x32_bf16 v[52:55], v[156:159], v[176:179], 0
ds_read_b64_tr_b16 v[194:195], v221 offset:5728
v_mfma_f32_16x16x32_bf16 v[56:59], v[162:165], v[176:179], 0
ds_read_b64_tr_b16 v[196:197], v221 offset:128
s_add_u32 m0, m0, 4096
s_add_u32 s39, s39, 4096
buffer_load_dwordx4 v1, s[4:7], s39 offen offset:0 sc1 lds
v_mfma_f32_16x16x32_bf16 v[60:63], v[158:161], v[180:183], 0
ds_read_b64_tr_b16 v[198:199], v221 offset:2944
v_mfma_f32_16x16x32_bf16 v[64:67], v[164:167], v[180:183], 0
ds_read_b64_tr_b16 v[200:201], v221 offset:5760
buffer_load_dwordx4 v1, s[4:7], s39 offen offset:1024 sc1 lds
v_cndmask_b32 v36, v36, v37, s[40:41]
v_cndmask_b32 v40, v40, v41, s[40:41]
v_cndmask_b32 v36, v36, v40, s[42:43]
v_fma_f32 v68, v36, v140, v144
v_cndmask_b32 v38, v38, v39, s[40:41]
v_cndmask_b32 v42, v42, v43, s[40:41]
v_cndmask_b32 v38, v38, v42, s[44:45]
v_fma_f32 v69, v38, v141, v145
v_max_f32 v76, v68, v69
v_cndmask_b32 v44, v44, v45, s[40:41]
buffer_load_dwordx4 v1, s[4:7], s39 offen offset:2048 sc1 lds
v_cndmask_b32 v48, v48, v49, s[40:41]
v_cndmask_b32 v44, v44, v48, s[42:43]
v_fma_f32 v70, v44, v140, v144
v_cndmask_b32 v46, v46, v47, s[40:41]
v_cndmask_b32 v50, v50, v51, s[40:41]
v_cndmask_b32 v46, v46, v50, s[44:45]
v_fma_f32 v71, v46, v141, v145
v_max_f32 v77, v70, v71
v_cndmask_b32 v52, v52, v53, s[40:41]
v_cndmask_b32 v56, v56, v57, s[40:41]
buffer_load_dwordx4 v1, s[4:7], s39 offen offset:3072 sc1 lds
v_cndmask_b32 v52, v52, v56, s[42:43]
v_mul_f32 v72, v52, v142
v_cndmask_b32 v54, v54, v55, s[40:41]
v_cndmask_b32 v58, v58, v59, s[40:41]
v_cndmask_b32 v54, v54, v58, s[44:45]
v_mul_f32 v73, v54, v143
v_max_f32 v78, v72, v73
v_cndmask_b32 v60, v60, v61, s[40:41]
v_cndmask_b32 v64, v64, v65, s[40:41]
v_cndmask_b32 v60, v60, v64, s[42:43]
s_add_u32 m0, m0, 4096
v_mul_f32 v74, v60, v142
v_cndmask_b32 v62, v62, v63, s[40:41]
v_cndmask_b32 v66, v66, v67, s[40:41]
v_cndmask_b32 v62, v62, v66, s[44:45]
v_mul_f32 v75, v62, v143
v_max_f32 v79, v74, v75
s_nop 1
v_permlane32_swap_b32 v76, v77
v_permlane32_swap_b32 v78, v79
s_add_u32 s39, s39, 4096
v_max_f32 v76, v76, v77
v_max_f32 v78, v78, v79
s_nop 1
v_permlane16_swap_b32 v76, v78
v_max_f32 v76, v76, v78
v_mov_b32 v78, v76
s_nop 1
v_permlane16_swap_b32 v76, v78
v_mov_b32 v77, v76
v_mov_b32 v79, v78
buffer_load_dwordx4 v1, s[4:7], s39 offen offset:0 sc1 lds
s_nop 0
v_permlane32_swap_b32 v76, v77
v_permlane32_swap_b32 v78, v79
v_sub_f32 v68, v68, v76
v_sub_f32 v69, v69, v76
v_sub_f32 v70, v70, v77
v_sub_f32 v71, v71, v77
v_sub_f32 v72, v72, v78
v_sub_f32 v73, v73, v78
v_sub_f32 v74, v74, v79
buffer_load_dwordx4 v1, s[4:7], s39 offen offset:1024 sc1 lds
v_sub_f32 v75, v75, v79
v_exp_f32 v68, v68
v_exp_f32 v69, v69
v_exp_f32 v70, v70
v_exp_f32 v71, v71
v_exp_f32 v72, v72
v_exp_f32 v73, v73
v_exp_f32 v74, v74
v_exp_f32 v75, v75
buffer_load_dwordx4 v1, s[4:7], s39 offen offset:2048 sc1 lds
v_add_f32 v76, v68, v69
v_add_f32 v77, v70, v71
v_add_f32 v78, v72, v73
v_add_f32 v79, v74, v75
v_mul_f32 v68, v68, v136
v_mul_f32 v69, v69, v137
v_mul_f32 v70, v70, v136
v_mul_f32 v71, v71, v137
v_mul_f32 v72, v72, v138
v_mul_f32 v73, v73, v139
v_mul_f32 v74, v74, v138
v_mul_f32 v75, v75, v139
s_nop 1
v_permlane32_swap_b32 v76, v77
v_permlane32_swap_b32 v78, v79
v_add_f32 v76, v76, v77
v_add_f32 v78, v78, v79
s_nop 1
v_permlane16_swap_b32 v76, v78
v_add_f32 v76, v76, v78
v_rcp_f32 v76, v76
s_nop 0
v_mov_b32 v78, v76
s_nop 1
v_permlane16_swap_b32 v76, v78
v_mov_b32 v77, v76
v_mov_b32 v79, v78
s_nop 0
v_permlane32_swap_b32 v76, v77
v_permlane32_swap_b32 v78, v79
s_waitcnt lgkmcnt(0)
v_mul_f32 v68, v68, v76
v_mul_f32 v69, v69, v76
v_cvt_pk_bf16_f32 v68, v68, v69
v_perm_b32 v84, v68, v68, v10
v_perm_b32 v85, v68, v68, v11
v_perm_b32 v86, v68, v68, v12
v_perm_b32 v87, v68, v68, v13
v_mul_f32 v70, v70, v77
v_mul_f32 v71, v71, v77
v_mfma_f32_16x16x32_bf16 v[36:39], v[184:187], v[84:87], 0
v_cvt_pk_bf16_f32 v70, v70, v71
v_perm_b32 v88, v70, v70, v10
v_mfma_f32_16x16x32_bf16 v[40:43], v[196:199], v[84:87], 0
v_perm_b32 v89, v70, v70, v11
v_perm_b32 v90, v70, v70, v12
v_perm_b32 v91, v70, v70, v13
v_mul_f32 v72, v72, v78
v_mul_f32 v73, v73, v78
v_mfma_f32_16x16x32_bf16 v[44:47], v[190:193], v[88:91], 0
v_cvt_pk_bf16_f32 v72, v72, v73
v_perm_b32 v92, v72, v72, v10
v_mfma_f32_16x16x32_bf16 v[48:51], v[196:199], v[88:91], 0
v_perm_b32 v93, v72, v72, v11
v_perm_b32 v94, v72, v72, v12
v_perm_b32 v95, v72, v72, v13
v_mul_f32 v74, v74, v79
v_mul_f32 v75, v75, v79
v_mfma_f32_16x16x32_bf16 v[52:55], v[186:189], v[92:95], 0
v_cvt_pk_bf16_f32 v74, v74, v75
v_perm_b32 v96, v74, v74, v10
v_mfma_f32_16x16x32_bf16 v[56:59], v[198:201], v[92:95], 0
v_perm_b32 v97, v74, v74, v11
v_perm_b32 v98, v74, v74, v12
v_perm_b32 v99, v74, v74, v13
v_cvt_pk_bf16_f32 v168, v36, v37
v_cvt_pk_bf16_f32 v169, v38, v39
v_mfma_f32_16x16x32_bf16 v[60:63], v[192:195], v[96:99], 0
v_mfma_f32_16x16x32_bf16 v[64:67], v[198:201], v[96:99], 0
v_cvt_pk_bf16_f32 v172, v40, v41
v_cvt_pk_bf16_f32 v170, v44, v45
v_cvt_pk_bf16_f32 v171, v46, v47
v_cvt_pk_bf16_f32 v173, v50, v51
buffer_store_dwordx4 v[168:171], v1, s[8:11], s64 offen sc1
buffer_store_dwordx2 v[172:173], v224, s[8:11], s65 offen sc1
v_cvt_pk_bf16_f32 v176, v52, v53
v_cvt_pk_bf16_f32 v177, v54, v55
v_cvt_pk_bf16_f32 v180, v56, v57
v_cvt_pk_bf16_f32 v178, v60, v61
v_cvt_pk_bf16_f32 v179, v62, v63
v_cvt_pk_bf16_f32 v181, v66, v67
buffer_store_dwordx4 v[176:179], v237, s[8:11], s64 offen sc1
buffer_store_dwordx2 v[180:181], v225, s[8:11], s65 offen sc1
L_c2:
s_mul_i32 s38, s24, 9216
s_add_u32 m0, s38, 123904
s_add_u32 s39, s38, s82
buffer_load_dwordx4 v1, s[4:7], s39 offen offset:0 sc1 lds
buffer_load_dwordx4 v1, s[4:7], s39 offen offset:1024 sc1 lds
buffer_load_dwordx4 v1, s[4:7], s39 offen offset:2048 sc1 lds
buffer_load_dwordx4 v1, s[4:7], s39 offen offset:3072 sc1 lds
s_add_u32 m0, m0, 4096
s_add_u32 s39, s39, 4096
buffer_load_dwordx4 v1, s[4:7], s39 offen offset:0 sc1 lds
buffer_load_dwordx4 v1, s[4:7], s39 offen offset:1024 sc1 lds
buffer_load_dwordx4 v1, s[4:7], s39 offen offset:2048 sc1 lds
v_lshlrev_b32 v7, 3, v1
s_lshl_b32 s31, s25, 11
v_add_u32 v7, s31, v7
s_cmp_eq_u32 s24, 0
s_cselect_b32 s30, 0, 1073741824
s_add_u32 s30, s30, 26476544
s_waitcnt vmcnt(7)
s_barrier
s_mov_b64 exec, 0xffff
buffer_atomic_add v4, v7, s[8:11], s30 offen sc1
s_mov_b64 exec, -1
s_lshl_b32 s35, s81, 7
s_add_u32 s35, s35, 26476544
s_cmp_eq_u32 s24, 1
s_cselect_b32 s35, s35, 1073741824
v_mov_b32 v6, 0
buffer_load_dwordx4 v1, s[4:7], s39 offen offset:3072 sc1 lds
s_add_u32 m0, m0, 4096
s_add_u32 s39, s39, 4096
buffer_load_dwordx4 v1, s[4:7], s39 offen offset:0 sc1 lds
s_lshl_b32 s38, s24, 8
s_add_u32 m0, s38, 160768
s_add_u32 s39, s38, s82
s_add_u32 s39, s39, 36864
s_mov_b64 exec, 0xffff
buffer_load_dwordx4 v1, s[4:7], s39 offen sc1 lds
s_mov_b64 exec, -1
s_mul_i32 s38, s24, 9216
s_add_u32 m0, s38, 0
s_add_u32 s39, s38, s82
s_add_u32 s39, s39, 37888
buffer_load_dwordx4 v1, s[4:7], s39 offen offset:0 sc1 lds
v_mov_b32 v244, 0
s_mov_b64 exec, 1
buffer_atomic_add v244, v6, s[8:11], s35 offen sc0 sc1
s_mov_b64 exec, -1
buffer_load_dwordx4 v1, s[4:7], s39 offen offset:1024 sc1 lds
buffer_load_dwordx4 v1, s[4:7], s39 offen offset:2048 sc1 lds
buffer_load_dwordx4 v1, s[4:7], s39 offen offset:3072 sc1 lds
s_add_u32 m0, m0, 4096
s_add_u32 s39, s39, 4096
v_mov_b32 v245, 0
s_mov_b64 exec, 1
buffer_atomic_add v245, v6, s[8:11], s35 offen sc0 sc1
s_mov_b64 exec, -1
buffer_load_dwordx4 v1, s[4:7], s39 offen offset:0 sc1 lds
buffer_load_dwordx4 v1, s[4:7], s39 offen offset:1024 sc1 lds
buffer_load_dwordx4 v1, s[4:7], s39 offen offset:2048 sc1 lds
v_mov_b32 v246, 0
s_mov_b64 exec, 1
buffer_atomic_add v246, v6, s[8:11], s35 offen sc0 sc1
s_mov_b64 exec, -1
buffer_load_dwordx4 v1, s[4:7], s39 offen offset:3072 sc1 lds
s_add_u32 m0, m0, 4096
s_add_u32 s39, s39, 4096
buffer_load_dwordx4 v1, s[4:7], s39 offen offset:0 sc1 lds
s_lshl_b32 s38, s24, 8
s_add_u32 m0, s38, 36864
s_add_u32 s39, s38, s82
s_add_u32 s39, s39, 74752
s_mov_b64 exec, 0xffff
buffer_load_dwordx4 v1, s[4:7], s39 offen sc1 lds
s_mov_b64 exec, -1
s_lshl_b32 s60, s27, 2
s_add_u32 s60, s60, s24
s_mul_i32 s60, s60, 18432
s_add_u32 s60, s60, 2490368
s_cmp_eq_u32 s24, 1
s_cbranch_scc0 L_other_15
s_mov_b32 s31, 0
s_mov_b64 exec, 1
v_mov_b32 v247, 0
buffer_atomic_add v247, v6, s[8:11], s35 offen sc0 sc1
s_waitcnt vmcnt(12)
v_cmp_gt_u32 vcc, 16, v244
s_nop 0
s_cbranch_vccz L_polled_14
s_waitcnt vmcnt(8)
v_cmp_gt_u32 vcc, 16, v245
s_nop 0
s_cbranch_vccz L_polled_14
v_mov_b32 v244, 0
buffer_atomic_add v244, v6, s[8:11], s35 offen sc0 sc1
s_waitcnt vmcnt(5)
v_cmp_gt_u32 vcc, 16, v246
s_nop 0
s_cbranch_vccz L_polled_14
v_mov_b32 v245, 0
buffer_atomic_add v245, v6, s[8:11], s35 offen sc0 sc1
L_poll_13:
s_add_u32 s31, s31, 1
s_cmp_gt_u32 s31, 100000
s_cbranch_scc1 L_polled_14
v_mov_b32 v246, 0
buffer_atomic_add v246, v6, s[8:11], s35 offen sc0 sc1
s_waitcnt vmcnt(3)
v_cmp_gt_u32 vcc, 16, v247
s_nop 0
s_cbranch_vccz L_polled_14
v_mov_b32 v247, 0
buffer_atomic_add v247, v6, s[8:11], s35 offen sc0 sc1
s_waitcnt vmcnt(3)
v_cmp_gt_u32 vcc, 16, v244
s_nop 0
s_cbranch_vccz L_polled_14
v_mov_b32 v244, 0
buffer_atomic_add v244, v6, s[8:11], s35 offen sc0 sc1
s_waitcnt vmcnt(3)
v_cmp_gt_u32 vcc, 16, v245
s_nop 0
s_cbranch_vccz L_polled_14
v_mov_b32 v245, 0
buffer_atomic_add v245, v6, s[8:11], s35 offen sc0 sc1
s_waitcnt vmcnt(3)
v_cmp_gt_u32 vcc, 16, v246
s_nop 0
s_cbranch_vccz L_polled_14
s_branch L_poll_13
L_polled_14:
s_mov_b64 exec, -1
L_other_15:
s_barrier
buffer_load_dwordx4 a[0:3], v1, s[8:11], s60 offen offset:0 sc1
buffer_load_dwordx4 a[4:7], v1, s[8:11], s60 offen offset:1024 sc1
s_barrier
buffer_load_dwordx4 a[8:11], v1, s[8:11], s60 offen offset:2048 sc1
buffer_load_dwordx4 a[12:15], v1, s[8:11], s60 offen offset:3072 sc1
s_barrier
s_add_u32 s60, s60, 4096
buffer_load_dwordx4 a[16:19], v1, s[8:11], s60 offen offset:0 sc1
buffer_load_dwordx4 a[20:23], v1, s[8:11], s60 offen offset:1024 sc1
s_barrier
buffer_load_dwordx4 a[24:27], v1, s[8:11], s60 offen offset:2048 sc1
buffer_load_dwordx4 a[28:31], v1, s[8:11], s60 offen offset:3072 sc1
s_barrier
s_add_u32 s60, s60, 4096
buffer_load_dwordx4 a[32:35], v1, s[8:11], s60 offen offset:0 sc1
v_lshrrev_b32 v40, 1, v1
v_and_b32 v36, 7, v2
v_lshlrev_b32 v36, 4, v36
v_lshl_add_u32 v36, v3, 7, v36
v_add_u32 v36, 4096, v36
v_add_u32 v36, 37888, v36
v_add_u32 v39, 37888, v1
v_add_u32 v37, 79360, v1
v_add_u32 v38, 41472, v36
ds_read_b128 a[72:75], v39 offset:0
ds_read_b128 a[76:79], v39 offset:1024
ds_read_b128 a[80:83], v39 offset:2048
ds_read_b128 a[84:87], v39 offset:3072
ds_read_b128 a[88:91], v36 offset:0
ds_read_b128 a[92:95], v39 offset:4608
ds_read_b128 a[96:99], v39 offset:5632
ds_read_b128 a[100:103], v39 offset:6656
ds_read_b128 a[104:107], v39 offset:7680
ds_read_b128 a[108:111], v36 offset:4608
s_lshl_b32 s30, s27, 2
s_add_u32 s30, s30, s24
v_mov_b32 v58, 1073741824
s_mul_i32 s62, s30, 18432
s_mul_i32 s32, s28, 2304
s_add_u32 s62, s62, s32
s_add_u32 s62, s62, 4849664
v_mov_b32 v60, v1
v_add_u32 v61, 2048, v60
v_cndmask_b32 v61, v58, v61, s[46:47]
s_lshl_b32 s63, s30, 7
s_lshl_b32 s32, s28, 14
s_add_u32 s63, s63, s32
s_add_u32 s63, s63, 7208960
v_lshlrev_b32 v59, 3, v2
v_cndmask_b32 v58, v58, v59, s[46:47]
s_waitcnt vmcnt(8) lgkmcnt(5)
v_mfma_f32_16x16x32_bf16 v[16:19], a[72:75], a[0:3], v[16:19]
ds_read_b128 a[112:115], v39 offset:9216
buffer_load_dwordx4 a[36:39], v1, s[8:11], s60 offen offset:1024 sc1
v_mfma_f32_16x16x32_bf16 v[20:23], a[76:79], a[0:3], v[20:23]
ds_read_b128 a[116:119], v39 offset:10240
v_mfma_f32_16x16x32_bf16 v[24:27], a[80:83], a[0:3], v[24:27]
ds_read_b128 a[120:123], v39 offset:11264
v_mfma_f32_16x16x32_bf16 v[28:31], a[84:87], a[0:3], v[28:31]
ds_read_b128 a[124:127], v39 offset:12288
v_mfma_f32_16x16x32_bf16 v[32:35], a[88:91], a[0:3], v[32:35]
ds_read_b128 a[128:131], v36 offset:9216
s_waitcnt vmcnt(8) lgkmcnt(5)
v_mfma_f32_16x16x32_bf16 v[16:19], a[92:95], a[4:7], v[16:19]
ds_read_b128 a[72:75], v39 offset:13824
buffer_load_dwordx4 a[40:43], v1, s[8:11], s60 offen offset:2048 sc1
v_mfma_f32_16x16x32_bf16 v[20:23], a[96:99], a[4:7], v[20:23]
ds_read_b128 a[76:79], v39 offset:14848
v_mfma_f32_16x16x32_bf16 v[24:27], a[100:103], a[4:7], v[24:27]
ds_read_b128 a[80:83], v39 offset:15872
v_mfma_f32_16x16x32_bf16 v[28:31], a[104:107], a[4:7], v[28:31]
ds_read_b128 a[84:87], v39 offset:16896
v_mfma_f32_16x16x32_bf16 v[32:35], a[108:111], a[4:7], v[32:35]
ds_read_b128 a[88:91], v36 offset:13824
s_waitcnt vmcnt(8) lgkmcnt(5)
v_mfma_f32_16x16x32_bf16 v[16:19], a[112:115], a[8:11], v[16:19]
ds_read_b128 a[92:95], v39 offset:18432
buffer_load_dwordx4 a[44:47], v1, s[8:11], s60 offen offset:3072 sc1
v_mfma_f32_16x16x32_bf16 v[20:23], a[116:119], a[8:11], v[20:23]
ds_read_b128 a[96:99], v39 offset:19456
v_mfma_f32_16x16x32_bf16 v[24:27], a[120:123], a[8:11], v[24:27]
ds_read_b128 a[100:103], v39 offset:20480
v_mfma_f32_16x16x32_bf16 v[28:31], a[124:127], a[8:11], v[28:31]
ds_read_b128 a[104:107], v39 offset:21504
v_mfma_f32_16x16x32_bf16 v[32:35], a[128:131], a[8:11], v[32:35]
ds_read_b128 a[108:111], v36 offset:18432
s_waitcnt vmcnt(8) lgkmcnt(5)
v_mfma_f32_16x16x32_bf16 v[16:19], a[72:75], a[12:15], v[16:19]
ds_read_b128 a[112:115], v39 offset:23040
s_add_u32 s60, s60, 4096
buffer_load_dwordx4 a[48:51], v1, s[8:11], s60 offen offset:0 sc1
v_mfma_f32_16x16x32_bf16 v[20:23], a[76:79], a[12:15], v[20:23]
ds_read_b128 a[116:119], v39 offset:24064
v_mfma_f32_16x16x32_bf16 v[24:27], a[80:83], a[12:15], v[24:27]
ds_read_b128 a[120:123], v39 offset:25088
v_mfma_f32_16x16x32_bf16 v[28:31], a[84:87], a[12:15], v[28:31]
ds_read_b128 a[124:127], v39 offset:26112
v_mfma_f32_16x16x32_bf16 v[32:35], a[88:91], a[12:15], v[32:35]
ds_read_b128 a[128:131], v36 offset:23040
s_waitcnt vmcnt(8) lgkmcnt(5)
v_mfma_f32_16x16x32_bf16 v[16:19], a[92:95], a[16:19], v[16:19]
ds_read_b128 a[72:75], v39 offset:27648
buffer_load_dwordx4 a[52:55], v1, s[8:11], s60 offen offset:1024 sc1
v_mfma_f32_16x16x32_bf16 v[20:23], a[96:99], a[16:19], v[20:23]
ds_read_b128 a[76:79], v39 offset:28672
v_mfma_f32_16x16x32_bf16 v[24:27], a[100:103], a[16:19], v[24:27]
ds_read_b128 a[80:83], v39 offset:29696
v_mfma_f32_16x16x32_bf16 v[28:31], a[104:107], a[16:19], v[28:31]
ds_read_b128 a[84:87], v39 offset:30720
v_mfma_f32_16x16x32_bf16 v[32:35], a[108:111], a[16:19], v[32:35]
ds_read_b128 a[88:91], v36 offset:27648
s_waitcnt vmcnt(8) lgkmcnt(5)
v_mfma_f32_16x16x32_bf16 v[16:19], a[112:115], a[20:23], v[16:19]
ds_read_b128 a[92:95], v39 offset:32256
buffer_load_dwordx4 a[56:59], v1, s[8:11], s60 offen offset:2048 sc1
v_mfma_f32_16x16x32_bf16 v[20:23], a[116:119], a[20:23], v[20:23]
ds_read_b128 a[96:99], v39 offset:33280
v_mfma_f32_16x16x32_bf16 v[24:27], a[120:123], a[20:23], v[24:27]
ds_read_b128 a[100:103], v39 offset:34304
v_mfma_f32_16x16x32_bf16 v[28:31], a[124:127], a[20:23], v[28:31]
ds_read_b128 a[104:107], v39 offset:35328
v_mfma_f32_16x16x32_bf16 v[32:35], a[128:131], a[20:23], v[32:35]
ds_read_b128 a[108:111], v36 offset:32256
s_waitcnt vmcnt(8) lgkmcnt(5)
v_mfma_f32_16x16x32_bf16 v[16:19], a[72:75], a[24:27], v[16:19]
ds_read_b128 a[112:115], v39 offset:36864
buffer_load_dwordx4 a[60:63], v1, s[8:11], s60 offen offset:3072 sc1
v_mfma_f32_16x16x32_bf16 v[20:23], a[76:79], a[24:27], v[20:23]
ds_read_b128 a[116:119], v39 offset:37888
v_mfma_f32_16x16x32_bf16 v[24:27], a[80:83], a[24:27], v[24:27]
ds_read_b128 a[120:123], v39 offset:38912
v_mfma_f32_16x16x32_bf16 v[28:31], a[84:87], a[24:27], v[28:31]
ds_read_b128 a[124:127], v39 offset:39936
v_mfma_f32_16x16x32_bf16 v[32:35], a[88:91], a[24:27], v[32:35]
ds_read_b128 a[128:131], v36 offset:36864
s_waitcnt vmcnt(8) lgkmcnt(5)
v_mfma_f32_16x16x32_bf16 v[16:19], a[92:95], a[28:31], v[16:19]
ds_read_b128 a[72:75], v37 offset:0
s_add_u32 s60, s60, 4096
buffer_load_dwordx2 a[64:65], v40, s[8:11], s60 offen offset:0 sc1
buffer_load_dwordx2 a[66:67], v40, s[8:11], s60 offen offset:1024 sc1
v_mfma_f32_16x16x32_bf16 v[20:23], a[96:99], a[28:31], v[20:23]
ds_read_b128 a[76:79], v37 offset:1024
v_mfma_f32_16x16x32_bf16 v[24:27], a[100:103], a[28:31], v[24:27]
ds_read_b128 a[80:83], v37 offset:2048
v_mfma_f32_16x16x32_bf16 v[28:31], a[104:107], a[28:31], v[28:31]
ds_read_b128 a[84:87], v37 offset:3072
v_mfma_f32_16x16x32_bf16 v[32:35], a[108:111], a[28:31], v[32:35]
ds_read_b128 a[88:91], v38 offset:0
s_waitcnt vmcnt(9) lgkmcnt(5)
v_mfma_f32_16x16x32_bf16 v[16:19], a[112:115], a[32:35], v[16:19]
ds_read_b128 a[92:95], v37 offset:4608
buffer_load_dwordx2 a[68:69], v40, s[8:11], s60 offen offset:512 sc1
buffer_load_dwordx2 a[70:71], v40, s[8:11], s60 offen offset:1536 sc1
v_mfma_f32_16x16x32_bf16 v[20:23], a[116:119], a[32:35], v[20:23]
ds_read_b128 a[96:99], v37 offset:5632
v_mfma_f32_16x16x32_bf16 v[24:27], a[120:123], a[32:35], v[24:27]
ds_read_b128 a[100:103], v37 offset:6656
v_mfma_f32_16x16x32_bf16 v[28:31], a[124:127], a[32:35], v[28:31]
ds_read_b128 a[104:107], v37 offset:7680
v_mfma_f32_16x16x32_bf16 v[32:35], a[128:131], a[32:35], v[32:35]
ds_read_b128 a[108:111], v38 offset:4608
s_waitcnt vmcnt(10) lgkmcnt(5)
v_mfma_f32_16x16x32_bf16 v[16:19], a[72:75], a[36:39], v[16:19]
ds_read_b128 a[112:115], v37 offset:9216
v_mfma_f32_16x16x32_bf16 v[20:23], a[76:79], a[36:39], v[20:23]
ds_read_b128 a[116:119], v37 offset:10240
v_mfma_f32_16x16x32_bf16 v[24:27], a[80:83], a[36:39], v[24:27]
ds_read_b128 a[120:123], v37 offset:11264
v_mfma_f32_16x16x32_bf16 v[28:31], a[84:87], a[36:39], v[28:31]
ds_read_b128 a[124:127], v37 offset:12288
v_mfma_f32_16x16x32_bf16 v[32:35], a[88:91], a[36:39], v[32:35]
ds_read_b128 a[128:131], v38 offset:9216
s_waitcnt vmcnt(9) lgkmcnt(5)
v_mfma_f32_16x16x32_bf16 v[16:19], a[92:95], a[40:43], v[16:19]
ds_read_b128 a[72:75], v37 offset:13824
v_mfma_f32_16x16x32_bf16 v[20:23], a[96:99], a[40:43], v[20:23]
ds_read_b128 a[76:79], v37 offset:14848
v_mfma_f32_16x16x32_bf16 v[24:27], a[100:103], a[40:43], v[24:27]
ds_read_b128 a[80:83], v37 offset:15872
v_mfma_f32_16x16x32_bf16 v[28:31], a[104:107], a[40:43], v[28:31]
ds_read_b128 a[84:87], v37 offset:16896
v_mfma_f32_16x16x32_bf16 v[32:35], a[108:111], a[40:43], v[32:35]
ds_read_b128 a[88:91], v38 offset:13824
s_waitcnt vmcnt(8) lgkmcnt(5)
v_mfma_f32_16x16x32_bf16 v[16:19], a[112:115], a[44:47], v[16:19]
ds_read_b128 a[92:95], v37 offset:18432
v_mfma_f32_16x16x32_bf16 v[20:23], a[116:119], a[44:47], v[20:23]
ds_read_b128 a[96:99], v37 offset:19456
v_mfma_f32_16x16x32_bf16 v[24:27], a[120:123], a[44:47], v[24:27]
ds_read_b128 a[100:103], v37 offset:20480
v_mfma_f32_16x16x32_bf16 v[28:31], a[124:127], a[44:47], v[28:31]
ds_read_b128 a[104:107], v37 offset:21504
v_mfma_f32_16x16x32_bf16 v[32:35], a[128:131], a[44:47], v[32:35]
ds_read_b128 a[108:111], v38 offset:18432
s_waitcnt vmcnt(7) lgkmcnt(5)
v_mfma_f32_16x16x32_bf16 v[16:19], a[72:75], a[48:51], v[16:19]
ds_read_b128 a[112:115], v37 offset:23040
v_mfma_f32_16x16x32_bf16 v[20:23], a[76:79], a[48:51], v[20:23]
ds_read_b128 a[116:119], v37 offset:24064
v_mfma_f32_16x16x32_bf16 v[24:27], a[80:83], a[48:51], v[24:27]
ds_read_b128 a[120:123], v37 offset:25088
v_mfma_f32_16x16x32_bf16 v[28:31], a[84:87], a[48:51], v[28:31]
ds_read_b128 a[124:127], v37 offset:26112
v_mfma_f32_16x16x32_bf16 v[32:35], a[88:91], a[48:51], v[32:35]
ds_read_b128 a[128:131], v38 offset:23040
s_waitcnt vmcnt(6) lgkmcnt(5)
v_mfma_f32_16x16x32_bf16 v[16:19], a[92:95], a[52:55], v[16:19]
ds_read_b128 a[72:75], v37 offset:27648
v_mfma_f32_16x16x32_bf16 v[20:23], a[96:99], a[52:55], v[20:23]
ds_read_b128 a[76:79], v37 offset:28672
v_mfma_f32_16x16x32_bf16 v[24:27], a[100:103], a[52:55], v[24:27]
ds_read_b128 a[80:83], v37 offset:29696
v_mfma_f32_16x16x32_bf16 v[28:31], a[104:107], a[52:55], v[28:31]
ds_read_b128 a[84:87], v37 offset:30720
v_mfma_f32_16x16x32_bf16 v[32:35], a[108:111], a[52:55], v[32:35]
ds_read_b128 a[88:91], v38 offset:27648
s_waitcnt vmcnt(5) lgkmcnt(5)
v_mfma_f32_16x16x32_bf16 v[16:19], a[112:115], a[56:59], v[16:19]
ds_read_b128 a[92:95], v37 offset:32256
v_mfma_f32_16x16x32_bf16 v[20:23], a[116:119], a[56:59], v[20:23]
ds_read_b128 a[96:99], v37 offset:33280
v_mfma_f32_16x16x32_bf16 v[24:27], a[120:123], a[56:59], v[24:27]
ds_read_b128 a[100:103], v37 offset:34304
v_mfma_f32_16x16x32_bf16 v[28:31], a[124:127], a[56:59], v[28:31]
ds_read_b128 a[104:107], v37 offset:35328
v_mfma_f32_16x16x32_bf16 v[32:35], a[128:131], a[56:59], v[32:35]
ds_read_b128 a[108:111], v38 offset:32256
s_waitcnt vmcnt(4) lgkmcnt(5)
v_mfma_f32_16x16x32_bf16 v[16:19], a[72:75], a[60:63], v[16:19]
ds_read_b128 a[112:115], v37 offset:36864
v_mfma_f32_16x16x32_bf16 v[20:23], a[76:79], a[60:63], v[20:23]
ds_read_b128 a[116:119], v37 offset:37888
v_mfma_f32_16x16x32_bf16 v[24:27], a[80:83], a[60:63], v[24:27]
ds_read_b128 a[120:123], v37 offset:38912
v_mfma_f32_16x16x32_bf16 v[28:31], a[84:87], a[60:63], v[28:31]
ds_read_b128 a[124:127], v37 offset:39936
v_mfma_f32_16x16x32_bf16 v[32:35], a[88:91], a[60:63], v[32:35]
ds_read_b128 a[128:131], v38 offset:36864
s_waitcnt vmcnt(2) lgkmcnt(5)
v_mfma_f32_16x16x32_bf16 v[16:19], a[92:95], a[64:67], v[16:19]
v_mfma_f32_16x16x32_bf16 v[20:23], a[96:99], a[64:67], v[20:23]
v_mfma_f32_16x16x32_bf16 v[24:27], a[100:103], a[64:67], v[24:27]
v_mfma_f32_16x16x32_bf16 v[28:31], a[104:107], a[64:67], v[28:31]
v_mfma_f32_16x16x32_bf16 v[32:35], a[108:111], a[64:67], v[32:35]
s_waitcnt vmcnt(0) lgkmcnt(0)
v_mfma_f32_16x16x32_bf16 v[16:19], a[112:115], a[68:71], v[16:19]
v_mfma_f32_16x16x32_bf16 v[20:23], a[116:119], a[68:71], v[20:23]
v_mfma_f32_16x16x32_bf16 v[24:27], a[120:123], a[68:71], v[24:27]
v_mfma_f32_16x16x32_bf16 v[28:31], a[124:127], a[68:71], v[28:31]
v_mfma_f32_16x16x32_bf16 v[32:35], a[128:131], a[68:71], v[32:35]
s_nop 3
v_pk_add_f32 v[62:63], v[16:17], v[18:19]
v_pk_mul_f32 v[64:65], v[16:17], v[16:17]
v_pk_fma_f32 v[64:65], v[18:19], v[18:19], v[64:65]
v_pk_add_f32 v[62:63], v[62:63], v[20:21]
v_pk_fma_f32 v[64:65], v[20:21], v[20:21], v[64:65]
v_pk_add_f32 v[62:63], v[62:63], v[22:23]
v_pk_fma_f32 v[64:65], v[22:23], v[22:23], v[64:65]
v_pk_add_f32 v[62:63], v[62:63], v[24:25]
v_pk_fma_f32 v[64:65], v[24:25], v[24:25], v[64:65]
v_pk_add_f32 v[62:63], v[62:63], v[26:27]
v_pk_fma_f32 v[64:65], v[26:27], v[26:27], v[64:65]
v_pk_add_f32 v[62:63], v[62:63], v[28:29]
v_pk_fma_f32 v[64:65], v[28:29], v[28:29], v[64:65]
v_pk_add_f32 v[62:63], v[62:63], v[30:31]
v_pk_fma_f32 v[64:65], v[30:31], v[30:31], v[64:65]
s_mov_b32 exec_hi, 0
v_pk_add_f32 v[62:63], v[62:63], v[32:33]
v_pk_fma_f32 v[64:65], v[32:33], v[32:33], v[64:65]
v_pk_add_f32 v[62:63], v[62:63], v[34:35]
v_pk_fma_f32 v[64:65], v[34:35], v[34:35], v[64:65]
s_mov_b64 exec, -1
v_add_f32 v56, v62, v63
v_add_f32 v57, v64, v65
v_cvt_pk_bf16_f32 v52, v32, v33
v_cvt_pk_bf16_f32 v53, v34, v35
v_permlane32_swap_b32 v56, v57
v_add_f32 v56, v56, v57
v_mov_b32 v57, v56
v_cvt_pk_bf16_f32 v44, v16, v17
v_cvt_pk_bf16_f32 v45, v18, v19
v_permlane16_swap_b32 v56, v57
v_add_f32 v56, v56, v57
v_mov_b32 v57, v56
v_cvt_pk_bf16_f32 v46, v20, v21
v_cvt_pk_bf16_f32 v47, v22, v23
v_permlane32_swap_b32 v56, v57
buffer_store_dwordx4 v[44:47], v60, s[8:11], s62 offen sc1
buffer_store_dwordx2 v[56:57], v58, s[8:11], s63 offen sc1
v_cvt_pk_bf16_f32 v48, v24, v25
v_cvt_pk_bf16_f32 v49, v26, v27
v_cvt_pk_bf16_f32 v50, v28, v29
v_cvt_pk_bf16_f32 v51, v30, v31
v_permlane16_swap_b32 v52, v54
v_permlane16_swap_b32 v53, v55
buffer_store_dwordx4 v[48:51], v60, s[8:11], s62 offen offset:1024 sc1
buffer_store_dwordx4 v[52:55], v61, s[8:11], s62 offen sc1
s_barrier
s_mul_i32 s38, s24, 9216
s_add_u32 m0, s38, 37888
s_add_u32 s39, s38, s82
s_add_u32 s39, s39, 75776
buffer_load_dwordx4 v1, s[4:7], s39 offen offset:0 sc1 lds
buffer_load_dwordx4 v1, s[4:7], s39 offen offset:1024 sc1 lds
buffer_load_dwordx4 v1, s[4:7], s39 offen offset:2048 sc1 lds
buffer_load_dwordx4 v1, s[4:7], s39 offen offset:3072 sc1 lds
s_add_u32 m0, m0, 4096
s_add_u32 s39, s39, 4096
buffer_load_dwordx4 v1, s[4:7], s39 offen offset:0 sc1 lds
buffer_load_dwordx4 v1, s[4:7], s39 offen offset:1024 sc1 lds
buffer_load_dwordx4 v1, s[4:7], s39 offen offset:2048 sc1 lds
v_lshlrev_b32 v7, 3, v1
s_lshr_b32 s31, s81, 4
s_lshl_b32 s31, s31, 11
v_add_u32 v7, s31, v7
s_cmp_eq_u32 s24, 0
s_cselect_b32 s30, 0, 1073741824
s_add_u32 s30, s30, 26509312
s_waitcnt vmcnt(7)
s_barrier
s_mov_b64 exec, 0xffff
buffer_atomic_add v4, v7, s[8:11], s30 offen sc1
s_mov_b64 exec, -1
s_lshl_b32 s35, s80, 7
s_add_u32 s35, s35, 26509312
s_cmp_eq_u32 s24, 1
s_cselect_b32 s35, s35, 1073741824
v_mov_b32 v6, 0
buffer_load_dwordx4 v1, s[4:7], s39 offen offset:3072 sc1 lds
s_add_u32 m0, m0, 4096
s_add_u32 s39, s39, 4096
buffer_load_dwordx4 v1, s[4:7], s39 offen offset:0 sc1 lds
s_lshl_b32 s38, s24, 8
s_add_u32 m0, s38, 74752
s_add_u32 s39, s38, s82
s_add_u32 s39, s39, 112640
s_mov_b64 exec, 0xffff
buffer_load_dwordx4 v1, s[4:7], s39 offen sc1 lds
s_mov_b64 exec, -1
s_mul_i32 s38, s24, 9216
s_add_u32 m0, s38, 75776
s_add_u32 s39, s38, s82
s_add_u32 s39, s39, 113664
buffer_load_dwordx4 v1, s[4:7], s39 offen offset:0 sc1 lds
v_mov_b32 v244, 0
s_mov_b64 exec, 1
buffer_atomic_add v244, v6, s[8:11], s35 offen sc0 sc1
s_mov_b64 exec, -1
buffer_load_dwordx4 v1, s[4:7], s39 offen offset:1024 sc1 lds
buffer_load_dwordx4 v1, s[4:7], s39 offen offset:2048 sc1 lds
buffer_load_dwordx4 v1, s[4:7], s39 offen offset:3072 sc1 lds
s_add_u32 m0, m0, 4096
s_add_u32 s39, s39, 4096
v_mov_b32 v245, 0
s_mov_b64 exec, 1
buffer_atomic_add v245, v6, s[8:11], s35 offen sc0 sc1
s_mov_b64 exec, -1
buffer_load_dwordx4 v1, s[4:7], s39 offen offset:0 sc1 lds
buffer_load_dwordx4 v1, s[4:7], s39 offen offset:1024 sc1 lds
buffer_load_dwordx4 v1, s[4:7], s39 offen offset:2048 sc1 lds
v_mov_b32 v246, 0
s_mov_b64 exec, 1
buffer_atomic_add v246, v6, s[8:11], s35 offen sc0 sc1
s_mov_b64 exec, -1
buffer_load_dwordx4 v1, s[4:7], s39 offen offset:3072 sc1 lds
s_add_u32 m0, m0, 4096
s_add_u32 s39, s39, 4096
buffer_load_dwordx4 v1, s[4:7], s39 offen offset:0 sc1 lds
s_lshl_b32 s38, s24, 8
s_add_u32 m0, s38, 112640
s_add_u32 s39, s38, s82
s_add_u32 s39, s39, 150528
s_mov_b64 exec, 0xffff
buffer_load_dwordx4 v1, s[4:7], s39 offen sc1 lds
s_mov_b64 exec, -1
s_lshl_b32 s60, s25, 2
s_add_u32 s60, s60, s24
s_mul_i32 s62, s60, 36864
s_add_u32 s62, s62, 4849664
v_add_u32 v180, 18432, v1
s_cmp_eq_u32 s24, 1
s_cbranch_scc0 L_other_20
s_mov_b32 s31, 0
s_mov_b64 exec, 1
v_mov_b32 v247, 0
buffer_atomic_add v247, v6, s[8:11], s35 offen sc0 sc1
s_waitcnt vmcnt(12)
v_cmp_gt_u32 vcc, 16, v244
s_nop 0
s_cbranch_vccz L_polled_19
s_waitcnt vmcnt(8)
v_cmp_gt_u32 vcc, 16, v245
s_nop 0
s_cbranch_vccz L_polled_19
v_mov_b32 v244, 0
buffer_atomic_add v244, v6, s[8:11], s35 offen sc0 sc1
s_waitcnt vmcnt(5)
v_cmp_gt_u32 vcc, 16, v246
s_nop 0
s_cbranch_vccz L_polled_19
v_mov_b32 v245, 0
buffer_atomic_add v245, v6, s[8:11], s35 offen sc0 sc1
L_poll_18:
s_add_u32 s31, s31, 1
s_cmp_gt_u32 s31, 100000
s_cbranch_scc1 L_polled_19
v_mov_b32 v246, 0
buffer_atomic_add v246, v6, s[8:11], s35 offen sc0 sc1
s_waitcnt vmcnt(3)
v_cmp_gt_u32 vcc, 16, v247
s_nop 0
s_cbranch_vccz L_polled_19
v_mov_b32 v247, 0
buffer_atomic_add v247, v6, s[8:11], s35 offen sc0 sc1
s_waitcnt vmcnt(3)
v_cmp_gt_u32 vcc, 16, v244
s_nop 0
s_cbranch_vccz L_polled_19
v_mov_b32 v244, 0
buffer_atomic_add v244, v6, s[8:11], s35 offen sc0 sc1
s_waitcnt vmcnt(3)
v_cmp_gt_u32 vcc, 16, v245
s_nop 0
s_cbranch_vccz L_polled_19
v_mov_b32 v245, 0
buffer_atomic_add v245, v6, s[8:11], s35 offen sc0 sc1
s_waitcnt vmcnt(3)
v_cmp_gt_u32 vcc, 16, v246
s_nop 0
s_cbranch_vccz L_polled_19
s_branch L_poll_18
L_polled_19:
s_mov_b64 exec, -1
L_other_20:
s_barrier
buffer_load_dwordx4 a[0:3], v1, s[8:11], s62 offen offset:0 sc1
buffer_load_dwordx4 a[4:7], v180, s[8:11], s62 offen offset:0 sc1
s_barrier
buffer_load_dwordx4 a[8:11], v1, s[8:11], s62 offen offset:1024 sc1
buffer_load_dwordx4 a[12:15], v180, s[8:11], s62 offen offset:1024 sc1
s_barrier
buffer_load_dwordx4 a[16:19], v1, s[8:11], s62 offen offset:2048 sc1
buffer_load_dwordx4 a[20:23], v180, s[8:11], s62 offen offset:2048 sc1
s_barrier
buffer_load_dwordx4 a[24:27], v1, s[8:11], s62 offen offset:3072 sc1
buffer_load_dwordx4 a[28:31], v180, s[8:11], s62 offen offset:3072 sc1
s_barrier
s_add_u32 s62, s62, 4096
buffer_load_dwordx4 a[32:35], v1, s[8:11], s62 offen offset:0 sc1
buffer_load_dwordx4 a[36:39], v180, s[8:11], s62 offen offset:0 sc1
s_barrier
buffer_load_dwordx4 a[40:43], v1, s[8:11], s62 offen offset:1024 sc1
buffer_load_dwordx4 a[44:47], v180, s[8:11], s62 offen offset:1024 sc1
s_lshl_b32 s52, s25, 19
s_lshl_b32 s38, s24, 17
s_add_u32 s52, s52, s38
s_add_u32 s52, s52, 10895360
v_lshrrev_b32 v239, 1, v1
v_and_b32 v6, 0xf8, v239
v_lshrrev_b32 v7, 1, v3
v_lshl_add_u32 v232, v7, 16, v6
s_lshl_b32 s63, s60, 8
s_add_u32 s63, s63, 7208960
v_add_u32 v208, 123904, v1
v_add_u32 v209, 0, v1
v_add_u32 v210, 37888, v1
v_add_u32 v211, 75776, v1
ds_read_b128 a[144:147], v208 offset:0
ds_read_b128 a[148:151], v208 offset:18432
ds_read_b128 a[152:155], v209 offset:0
ds_read_b128 a[156:159], v209 offset:18432
ds_read_b128 a[160:163], v208 offset:1024
ds_read_b128 a[164:167], v208 offset:19456
s_waitcnt vmcnt(10) lgkmcnt(4)
v_mfma_f32_16x16x32_bf16 v[36:39], a[144:147], a[0:3], 0
ds_read_b128 a[168:171], v209 offset:1024
ds_read_b128 a[172:175], v209 offset:19456
v_mfma_f32_16x16x32_bf16 v[40:43], a[144:147], a[4:7], 0
buffer_load_dwordx4 a[48:51], v1, s[8:11], s62 offen offset:2048 sc1
v_mfma_f32_16x16x32_bf16 v[44:47], a[148:151], a[0:3], 0
buffer_load_dwordx4 a[52:55], v180, s[8:11], s62 offen offset:2048 sc1
v_mfma_f32_16x16x32_bf16 v[48:51], a[148:151], a[4:7], 0
s_waitcnt lgkmcnt(4)
v_mfma_f32_16x16x32_bf16 v[52:55], a[152:155], a[0:3], 0
ds_read_b128 a[144:147], v208 offset:2048
ds_read_b128 a[148:151], v208 offset:20480
v_mfma_f32_16x16x32_bf16 v[56:59], a[152:155], a[4:7], 0
buffer_load_dwordx4 a[56:59], v1, s[8:11], s62 offen offset:3072 sc1
v_lshl_add_u32 v234, v7, 13, v6
v_mfma_f32_16x16x32_bf16 v[60:63], a[156:159], a[0:3], 0
v_add_u32 v235, 4096, v234
v_mfma_f32_16x16x32_bf16 v[64:67], a[156:159], a[4:7], 0
s_waitcnt vmcnt(11) lgkmcnt(4)
s_barrier
v_mfma_f32_16x16x32_bf16 v[36:39], a[160:163], a[8:11], v[36:39]
ds_read_b128 a[152:155], v209 offset:2048
ds_read_b128 a[156:159], v209 offset:20480
v_mfma_f32_16x16x32_bf16 v[40:43], a[160:163], a[12:15], v[40:43]
buffer_load_dwordx4 a[60:63], v180, s[8:11], s62 offen offset:3072 sc1
s_mul_i32 s30, s24, 9216
v_mfma_f32_16x16x32_bf16 v[44:47], a[164:167], a[8:11], v[44:47]
s_add_u32 s62, s62, 4096
v_mfma_f32_16x16x32_bf16 v[48:51], a[164:167], a[12:15], v[48:51]
s_waitcnt lgkmcnt(4)
s_add_u32 s30, s30, 0
v_mfma_f32_16x16x32_bf16 v[52:55], a[168:171], a[8:11], v[52:55]
ds_read_b128 a[160:163], v208 offset:3072
ds_read_b128 a[164:167], v208 offset:21504
v_mfma_f32_16x16x32_bf16 v[56:59], a[168:171], a[12:15], v[56:59]
buffer_load_dwordx4 a[64:67], v1, s[8:11], s62 offen offset:0 sc1
v_mfma_f32_16x16x32_bf16 v[60:63], a[172:175], a[8:11], v[60:63]
v_mul_u32_u24 v236, 288, v2
v_mfma_f32_16x16x32_bf16 v[64:67], a[172:175], a[12:15], v[64:67]
s_waitcnt vmcnt(11) lgkmcnt(4)
v_mfma_f32_16x16x32_bf16 v[36:39], a[144:147], a[16:19], v[36:39]
ds_read_b128 a[168:171], v209 offset:3072
ds_read_b128 a[172:175], v209 offset:21504
v_mfma_f32_16x16x32_bf16 v[40:43], a[144:147], a[20:23], v[40:43]
buffer_load_dwordx2 v[182:183], v232, s[8:11], s63 offen sc1
v_add_u32 v236, s30, v236
v_mfma_f32_16x16x32_bf16 v[44:47], a[148:151], a[16:19], v[44:47]
s_add_u32 s63, s63, 16384
v_mfma_f32_16x16x32_bf16 v[48:51], a[148:151], a[20:23], v[48:51]
s_waitcnt lgkmcnt(4)
v_lshl_add_u32 v7, v3, 3, v236
v_mfma_f32_16x16x32_bf16 v[52:55], a[152:155], a[16:19], v[52:55]
ds_read_b128 a[144:147], v208 offset:4096
ds_read_b128 a[148:151], v208 offset:22528
v_mfma_f32_16x16x32_bf16 v[56:59], a[152:155], a[20:23], v[56:59]
v_mfma_f32_16x16x32_bf16 v[60:63], a[156:159], a[16:19], v[60:63]
buffer_load_dwordx2 v[184:185], v232, s[8:11], s63 offen sc1
v_lshl_add_u32 v236, v3, 4, v236
v_mfma_f32_16x16x32_bf16 v[64:67], a[156:159], a[20:23], v[64:67]
s_waitcnt vmcnt(11) lgkmcnt(4)
v_mfma_f32_16x16x32_bf16 v[36:39], a[160:163], a[24:27], v[36:39]
ds_read_b128 a[152:155], v209 offset:4096
ds_read_b128 a[156:159], v209 offset:22528
v_mfma_f32_16x16x32_bf16 v[40:43], a[160:163], a[28:31], v[40:43]
s_add_u32 s63, s63, 16384
v_lshrrev_b32 v8, 2, v2
v_mfma_f32_16x16x32_bf16 v[44:47], a[164:167], a[24:27], v[44:47]
v_mfma_f32_16x16x32_bf16 v[48:51], a[164:167], a[28:31], v[48:51]
s_waitcnt lgkmcnt(4)
v_lshl_add_u32 v8, v3, 3, v8
v_mfma_f32_16x16x32_bf16 v[52:55], a[168:171], a[24:27], v[52:55]
ds_read_b128 a[160:163], v208 offset:5120
ds_read_b128 a[164:167], v208 offset:23552
v_mfma_f32_16x16x32_bf16 v[56:59], a[168:171], a[28:31], v[56:59]
buffer_load_dwordx2 v[186:187], v232, s[8:11], s63 offen sc1
v_mfma_f32_16x16x32_bf16 v[60:63], a[172:175], a[24:27], v[60:63]
s_add_u32 s63, s63, 16384
v_mul_u32_u24 v237, 288, v8
v_mfma_f32_16x16x32_bf16 v[64:67], a[172:175], a[28:31], v[64:67]
s_waitcnt vmcnt(10) lgkmcnt(4)
v_mfma_f32_16x16x32_bf16 v[36:39], a[144:147], a[32:35], v[36:39]
ds_read_b128 a[168:171], v209 offset:5120
ds_read_b128 a[172:175], v209 offset:23552
v_mfma_f32_16x16x32_bf16 v[40:43], a[144:147], a[36:39], v[40:43]
buffer_load_dwordx2 v[188:189], v232, s[8:11], s63 offen sc1
v_add_u32 v237, s30, v237
v_mfma_f32_16x16x32_bf16 v[44:47], a[148:151], a[32:35], v[44:47]
s_add_u32 s63, s63, 16384
v_mfma_f32_16x16x32_bf16 v[48:51], a[148:151], a[36:39], v[48:51]
s_waitcnt lgkmcnt(4)
v_and_b32 v8, 3, v2
v_mfma_f32_16x16x32_bf16 v[52:55], a[152:155], a[32:35], v[52:55]
ds_read_b128 a[144:147], v208 offset:6144
ds_read_b128 a[148:151], v208 offset:24576
v_mfma_f32_16x16x32_bf16 v[56:59], a[152:155], a[36:39], v[56:59]
v_lshl_add_u32 v238, v8, 3, v237
v_mfma_f32_16x16x32_bf16 v[60:63], a[156:159], a[32:35], v[60:63]
buffer_load_dwordx4 a[68:71], v180, s[8:11], s62 offen offset:0 sc1
v_mfma_f32_16x16x32_bf16 v[64:67], a[156:159], a[36:39], v[64:67]
s_waitcnt vmcnt(10) lgkmcnt(4)
v_mfma_f32_16x16x32_bf16 v[36:39], a[160:163], a[40:43], v[36:39]
ds_read_b128 a[152:155], v209 offset:6144
ds_read_b128 a[156:159], v209 offset:24576
v_mfma_f32_16x16x32_bf16 v[40:43], a[160:163], a[44:47], v[40:43]
buffer_load_dwordx4 a[72:75], v1, s[8:11], s62 offen offset:1024 sc1
v_lshl_add_u32 v237, v8, 4, v237
v_mfma_f32_16x16x32_bf16 v[44:47], a[164:167], a[40:43], v[44:47]
s_mul_i32 s66, s26, 589824
v_mfma_f32_16x16x32_bf16 v[48:51], a[164:167], a[44:47], v[48:51]
s_waitcnt lgkmcnt(4)
v_mfma_f32_16x16x32_bf16 v[52:55], a[168:171], a[40:43], v[52:55]
ds_read_b128 a[160:163], v208 offset:7168
ds_read_b128 a[164:167], v208 offset:25600
v_mfma_f32_16x16x32_bf16 v[56:59], a[168:171], a[44:47], v[56:59]
buffer_load_dwordx4 a[76:79], v180, s[8:11], s62 offen offset:1024 sc1
s_mul_i32 s31, s60, 9216
v_mfma_f32_16x16x32_bf16 v[60:63], a[172:175], a[40:43], v[60:63]
s_add_u32 s66, s66, s31
v_mfma_f32_16x16x32_bf16 v[64:67], a[172:175], a[44:47], v[64:67]
s_waitcnt vmcnt(10) lgkmcnt(4)
v_mfma_f32_16x16x32_bf16 v[36:39], a[144:147], a[48:51], v[36:39]
ds_read_b128 a[168:171], v209 offset:7168
ds_read_b128 a[172:175], v209 offset:25600
v_mfma_f32_16x16x32_bf16 v[40:43], a[144:147], a[52:55], v[40:43]
buffer_load_dwordx4 a[80:83], v1, s[8:11], s62 offen offset:2048 sc1
v_mfma_f32_16x16x32_bf16 v[44:47], a[148:151], a[48:51], v[44:47]
buffer_load_dwordx4 a[84:87], v180, s[8:11], s62 offen offset:2048 sc1
s_add_u32 s66, s66, 7340032
v_mfma_f32_16x16x32_bf16 v[48:51], a[148:151], a[52:55], v[48:51]
s_waitcnt lgkmcnt(4)
v_mfma_f32_16x16x32_bf16 v[52:55], a[152:155], a[48:51], v[52:55]
ds_read_b128 a[144:147], v208 offset:8192
ds_read_b128 a[148:151], v208 offset:26624
v_mfma_f32_16x16x32_bf16 v[56:59], a[152:155], a[52:55], v[56:59]
buffer_load_dwordx4 a[88:91], v1, s[8:11], s62 offen offset:3072 sc1
v_lshlrev_b32 v233, 7, v1
v_mfma_f32_16x16x32_bf16 v[60:63], a[156:159], a[48:51], v[60:63]
s_lshl_b32 s31, s26, 7
v_mfma_f32_16x16x32_bf16 v[64:67], a[156:159], a[52:55], v[64:67]
s_waitcnt vmcnt(11) lgkmcnt(4)
v_mfma_f32_16x16x32_bf16 v[36:39], a[160:163], a[56:59], v[36:39]
ds_read_b128 a[152:155], v209 offset:8192
ds_read_b128 a[156:159], v209 offset:26624
v_mfma_f32_16x16x32_bf16 v[40:43], a[160:163], a[60:63], v[40:43]
buffer_load_dwordx4 a[92:95], v180, s[8:11], s62 offen offset:3072 sc1
v_mfma_f32_16x16x32_bf16 v[44:47], a[164:167], a[56:59], v[44:47]
s_add_u32 s62, s62, 4096
v_add_u32 v233, s31, v233
v_mfma_f32_16x16x32_bf16 v[48:51], a[164:167], a[60:63], v[48:51]
s_waitcnt lgkmcnt(4)
v_mfma_f32_16x16x32_bf16 v[52:55], a[168:171], a[56:59], v[52:55]
ds_read_b128 a[160:163], v208 offset:9216
ds_read_b128 a[164:167], v208 offset:27648
v_mfma_f32_16x16x32_bf16 v[56:59], a[168:171], a[60:63], v[56:59]
buffer_load_dwordx4 a[96:99], v1, s[8:11], s62 offen offset:0 sc1
s_lshl_b32 s61, s25, 14
v_mfma_f32_16x16x32_bf16 v[60:63], a[172:175], a[56:59], v[60:63]
s_lshl_b32 s30, s24, 8
v_mfma_f32_16x16x32_bf16 v[64:67], a[172:175], a[60:63], v[64:67]
s_waitcnt vmcnt(7) lgkmcnt(4)
v_mfma_f32_16x16x32_bf16 v[36:39], a[144:147], a[64:67], v[36:39]
ds_read_b128 a[168:171], v209 offset:9216
ds_read_b128 a[172:175], v209 offset:27648
v_mfma_f32_16x16x32_bf16 v[40:43], a[144:147], a[68:71], v[40:43]
buffer_load_dwordx4 a[100:103], v180, s[8:11], s62 offen offset:0 sc1
v_mfma_f32_16x16x32_bf16 v[44:47], a[148:151], a[64:67], v[44:47]
buffer_load_dwordx4 a[104:107], v1, s[8:11], s62 offen offset:1024 sc1
s_add_u32 s61, s61, s30
v_mfma_f32_16x16x32_bf16 v[48:51], a[148:151], a[68:71], v[48:51]
s_waitcnt lgkmcnt(4)
v_mfma_f32_16x16x32_bf16 v[52:55], a[152:155], a[64:67], v[52:55]
ds_read_b128 a[144:147], v208 offset:10240
ds_read_b128 a[148:151], v208 offset:28672
v_mfma_f32_16x16x32_bf16 v[56:59], a[152:155], a[68:71], v[56:59]
buffer_load_dwordx4 a[108:111], v180, s[8:11], s62 offen offset:1024 sc1
s_add_u32 s61, s61, 26214400
v_mfma_f32_16x16x32_bf16 v[60:63], a[156:159], a[64:67], v[60:63]
s_lshl_b32 s30, s26, 10
v_mfma_f32_16x16x32_bf16 v[64:67], a[156:159], a[68:71], v[64:67]
s_waitcnt vmcnt(8) lgkmcnt(4)
v_mfma_f32_16x16x32_bf16 v[36:39], a[160:163], a[72:75], v[36:39]
ds_read_b128 a[152:155], v209 offset:10240
ds_read_b128 a[156:159], v209 offset:28672
v_mfma_f32_16x16x32_bf16 v[40:43], a[160:163], a[76:79], v[40:43]
buffer_load_dwordx4 a[112:115], v1, s[8:11], s62 offen offset:2048 sc1
v_mfma_f32_16x16x32_bf16 v[44:47], a[164:167], a[72:75], v[44:47]
buffer_load_dwordx4 a[116:119], v180, s[8:11], s62 offen offset:2048 sc1
s_add_u32 s30, s30, s61
v_mfma_f32_16x16x32_bf16 v[48:51], a[164:167], a[76:79], v[48:51]
s_waitcnt lgkmcnt(4)
v_mfma_f32_16x16x32_bf16 v[52:55], a[168:171], a[72:75], v[52:55]
ds_read_b128 a[160:163], v208 offset:11264
ds_read_b128 a[164:167], v208 offset:29696
v_mfma_f32_16x16x32_bf16 v[56:59], a[168:171], a[76:79], v[56:59]
buffer_load_dwordx4 a[120:123], v1, s[8:11], s62 offen offset:3072 sc1
v_mfma_f32_16x16x32_bf16 v[60:63], a[172:175], a[72:75], v[60:63]
v_mfma_f32_16x16x32_bf16 v[64:67], a[172:175], a[76:79], v[64:67]
s_waitcnt vmcnt(9) lgkmcnt(4)
v_mfma_f32_16x16x32_bf16 v[36:39], a[144:147], a[80:83], v[36:39]
ds_read_b128 a[168:171], v209 offset:11264
ds_read_b128 a[172:175], v209 offset:29696
v_mfma_f32_16x16x32_bf16 v[40:43], a[144:147], a[84:87], v[40:43]
buffer_load_dwordx4 a[124:127], v180, s[8:11], s62 offen offset:3072 sc1
v_mfma_f32_16x16x32_bf16 v[44:47], a[148:151], a[80:83], v[44:47]
s_add_u32 s62, s62, 4096
v_add_f32 v198, v182, v184
v_add_f32 v199, v183, v185
v_mfma_f32_16x16x32_bf16 v[48:51], a[148:151], a[84:87], v[48:51]
s_waitcnt lgkmcnt(4)
v_add_f32 v198, v198, v186
v_mfma_f32_16x16x32_bf16 v[52:55], a[152:155], a[80:83], v[52:55]
ds_read_b128 a[144:147], v208 offset:12288
ds_read_b128 a[148:151], v208 offset:30720
v_mfma_f32_16x16x32_bf16 v[56:59], a[152:155], a[84:87], v[56:59]
buffer_load_dwordx4 a[128:131], v1, s[8:11], s62 offen offset:0 sc1
v_add_f32 v199, v199, v187
v_mfma_f32_16x16x32_bf16 v[60:63], a[156:159], a[80:83], v[60:63]
v_add_f32 v198, v198, v188
v_mfma_f32_16x16x32_bf16 v[64:67], a[156:159], a[84:87], v[64:67]
s_waitcnt lgkmcnt(4)
v_add_f32 v199, v199, v189
s_waitcnt vmcnt(9)
v_mfma_f32_16x16x32_bf16 v[36:39], a[160:163], a[88:91], v[36:39]
ds_read_b128 a[152:155], v209 offset:12288
ds_read_b128 a[156:159], v209 offset:30720
v_mfma_f32_16x16x32_bf16 v[40:43], a[160:163], a[92:95], v[40:43]
buffer_load_dwordx4 a[132:135], v180, s[8:11], s62 offen offset:0 sc1
v_mov_b32 v200, v198
v_mfma_f32_16x16x32_bf16 v[44:47], a[164:167], a[88:91], v[44:47]
v_mov_b32 v201, v199
v_mfma_f32_16x16x32_bf16 v[48:51], a[164:167], a[92:95], v[48:51]
s_waitcnt lgkmcnt(4)
s_nop 0
v_mfma_f32_16x16x32_bf16 v[52:55], a[168:171], a[88:91], v[52:55]
ds_read_b128 a[160:163], v208 offset:13312
ds_read_b128 a[164:167], v208 offset:31744
v_mfma_f32_16x16x32_bf16 v[56:59], a[168:171], a[92:95], v[56:59]
buffer_load_dwordx4 a[136:139], v1, s[8:11], s62 offen offset:1024 sc1
v_mfma_f32_16x16x32_bf16 v[60:63], a[172:175], a[88:91], v[60:63]
buffer_load_dwordx4 a[140:143], v180, s[8:11], s62 offen offset:1024 sc1
v_mfma_f32_16x16x32_bf16 v[64:67], a[172:175], a[92:95], v[64:67]
s_waitcnt vmcnt(10) lgkmcnt(4)
v_mfma_f32_16x16x32_bf16 v[36:39], a[144:147], a[96:99], v[36:39]
ds_read_b128 a[168:171], v209 offset:13312
ds_read_b128 a[172:175], v209 offset:31744
v_mfma_f32_16x16x32_bf16 v[40:43], a[144:147], a[100:103], v[40:43]
v_permlane32_swap_b32 v198, v200
v_mfma_f32_16x16x32_bf16 v[44:47], a[148:151], a[96:99], v[44:47]
v_permlane32_swap_b32 v199, v201
v_mfma_f32_16x16x32_bf16 v[48:51], a[148:151], a[100:103], v[48:51]
s_waitcnt lgkmcnt(4)
v_add_f32 v198, v198, v200
v_add_f32 v199, v199, v201
v_mfma_f32_16x16x32_bf16 v[52:55], a[152:155], a[96:99], v[52:55]
ds_read_b128 a[144:147], v208 offset:14336
ds_read_b128 a[148:151], v208 offset:32768
v_mfma_f32_16x16x32_bf16 v[56:59], a[152:155], a[100:103], v[56:59]
v_mul_f32 v198, 0x3ae38e39, v198
v_mul_f32 v200, v198, v198
v_mfma_f32_16x16x32_bf16 v[60:63], a[156:159], a[96:99], v[60:63]
v_mul_f32 v199, 0x3ae38e39, v199
v_mfma_f32_16x16x32_bf16 v[64:67], a[156:159], a[100:103], v[64:67]
s_waitcnt vmcnt(8) lgkmcnt(4)
v_mfma_f32_16x16x32_bf16 v[36:39], a[160:163], a[104:107], v[36:39]
ds_read_b128 a[152:155], v209 offset:14336
ds_read_b128 a[156:159], v209 offset:32768
v_mfma_f32_16x16x32_bf16 v[40:43], a[160:163], a[108:111], v[40:43]
v_sub_f32 v199, v199, v200
v_max_f32 v199, 0, v199
v_mfma_f32_16x16x32_bf16 v[44:47], a[164:167], a[104:107], v[44:47]
v_add_f32 v199, 0x3727c5ac, v199
v_mfma_f32_16x16x32_bf16 v[48:51], a[164:167], a[108:111], v[48:51]
s_waitcnt lgkmcnt(4)
v_rsq_f32 v250, v199
v_mfma_f32_16x16x32_bf16 v[52:55], a[168:171], a[104:107], v[52:55]
ds_read_b128 a[160:163], v208 offset:15360
ds_read_b128 a[164:167], v208 offset:33792
v_mfma_f32_16x16x32_bf16 v[56:59], a[168:171], a[108:111], v[56:59]
v_mfma_f32_16x16x32_bf16 v[60:63], a[172:175], a[104:107], v[60:63]
v_sqrt_f32 v254, v199
v_mfma_f32_16x16x32_bf16 v[64:67], a[172:175], a[108:111], v[64:67]
s_waitcnt vmcnt(6) lgkmcnt(4)
v_mfma_f32_16x16x32_bf16 v[36:39], a[144:147], a[112:115], v[36:39]
ds_read_b128 a[168:171], v209 offset:15360
ds_read_b128 a[172:175], v209 offset:33792
v_mfma_f32_16x16x32_bf16 v[40:43], a[144:147], a[116:119], v[40:43]
v_cvt_pk_bf16_f32 v200, -v198, -v198
v_mfma_f32_16x16x32_bf16 v[44:47], a[148:151], a[112:115], v[44:47]
v_and_b32 v200, 0xffff0000, v200
v_mfma_f32_16x16x32_bf16 v[48:51], a[148:151], a[116:119], v[48:51]
s_waitcnt lgkmcnt(4)
v_add_f32 v200, v198, v200
v_mfma_f32_16x16x32_bf16 v[52:55], a[152:155], a[112:115], v[52:55]
ds_read_b128 a[144:147], v208 offset:16384
ds_read_b128 a[148:151], v208 offset:34816
v_mfma_f32_16x16x32_bf16 v[56:59], a[152:155], a[116:119], v[56:59]
v_cvt_pk_bf16_f32 v212, -v198, -v200
v_mfma_f32_16x16x32_bf16 v[60:63], a[156:159], a[112:115], v[60:63]
v_mul_f32 v252, v250, v250
v_mfma_f32_16x16x32_bf16 v[64:67], a[156:159], a[116:119], v[64:67]
s_waitcnt lgkmcnt(4)
v_mul_f32 v252, v252, v250
s_waitcnt vmcnt(4)
v_mfma_f32_16x16x32_bf16 v[36:39], a[160:163], a[120:123], v[36:39]
ds_read_b128 a[152:155], v209 offset:16384
ds_read_b128 a[156:159], v209 offset:34816
v_mfma_f32_16x16x32_bf16 v[40:43], a[160:163], a[124:127], v[40:43]
v_mul_f32 v252, 0xbdd2d3e8, v252
v_mul_f32 v250, 0xc0135761, v250
v_mfma_f32_16x16x32_bf16 v[44:47], a[164:167], a[120:123], v[44:47]
v_mfma_f32_16x16x32_bf16 v[48:51], a[164:167], a[124:127], v[48:51]
s_waitcnt lgkmcnt(4)
v_mov_b32 v214, v212
v_mfma_f32_16x16x32_bf16 v[52:55], a[168:171], a[120:123], v[52:55]
ds_read_b128 a[160:163], v208 offset:17408
ds_read_b128 a[164:167], v208 offset:35840
v_mfma_f32_16x16x32_bf16 v[56:59], a[168:171], a[124:127], v[56:59]
v_mov_b32 v255, v254
v_mov_b32 v253, v252
v_mfma_f32_16x16x32_bf16 v[60:63], a[172:175], a[120:123], v[60:63]
v_mfma_f32_16x16x32_bf16 v[64:67], a[172:175], a[124:127], v[64:67]
s_waitcnt lgkmcnt(4)
v_mov_b32 v251, v250
s_waitcnt vmcnt(2)
v_mfma_f32_16x16x32_bf16 v[36:39], a[144:147], a[128:131], v[36:39]
ds_read_b128 a[168:171], v209 offset:17408
ds_read_b128 a[172:175], v209 offset:35840
v_mfma_f32_16x16x32_bf16 v[40:43], a[144:147], a[132:135], v[40:43]
v_permlane16_swap_b32 v212, v214
v_mfma_f32_16x16x32_bf16 v[44:47], a[148:151], a[128:131], v[44:47]
v_permlane16_swap_b32 v254, v255
v_mfma_f32_16x16x32_bf16 v[48:51], a[148:151], a[132:135], v[48:51]
s_waitcnt lgkmcnt(4)
v_add_u32 v181, 160768, v239
v_mfma_f32_16x16x32_bf16 v[52:55], a[152:155], a[128:131], v[52:55]
ds_read_b64 a[144:145], v181 offset:0
ds_read_b64 a[148:149], v181 offset:512
v_mfma_f32_16x16x32_bf16 v[56:59], a[152:155], a[132:135], v[56:59]
v_permlane16_swap_b32 v252, v253
v_mfma_f32_16x16x32_bf16 v[60:63], a[156:159], a[128:131], v[60:63]
v_mfma_f32_16x16x32_bf16 v[64:67], a[156:159], a[132:135], v[64:67]
s_waitcnt vmcnt(0) lgkmcnt(4)
v_add_u32 v181, 36864, v239
v_mfma_f32_16x16x32_bf16 v[36:39], a[160:163], a[136:139], v[36:39]
ds_read_b64 a[152:153], v181 offset:0
ds_read_b64 a[156:157], v181 offset:512
v_mfma_f32_16x16x32_bf16 v[40:43], a[160:163], a[140:143], v[40:43]
v_permlane16_swap_b32 v250, v251
v_mfma_f32_16x16x32_bf16 v[44:47], a[164:167], a[136:139], v[44:47]
v_mov_b32 v213, v212
v_mfma_f32_16x16x32_bf16 v[48:51], a[164:167], a[140:143], v[48:51]
s_waitcnt lgkmcnt(4)
v_mov_b32 v215, v214
v_mfma_f32_16x16x32_bf16 v[52:55], a[168:171], a[136:139], v[52:55]
ds_read_b128 a[160:163], v210 offset:0
ds_read_b128 a[164:167], v210 offset:18432
v_mfma_f32_16x16x32_bf16 v[56:59], a[168:171], a[140:143], v[56:59]
v_mfma_f32_16x16x32_bf16 v[60:63], a[172:175], a[136:139], v[60:63]
v_mfma_f32_16x16x32_bf16 v[64:67], a[172:175], a[140:143], v[64:67]
s_waitcnt lgkmcnt(4)
v_mfma_f32_16x16x16_bf16 v[36:39], a[144:145], v[212:213], v[36:39]
ds_read_b128 a[168:171], v210 offset:1024
ds_read_b128 a[172:175], v210 offset:19456
v_mfma_f32_16x16x16_bf16 v[40:43], a[144:145], v[214:215], v[40:43]
v_mfma_f32_16x16x16_bf16 v[44:47], a[148:149], v[212:213], v[44:47]
v_mfma_f32_16x16x16_bf16 v[48:51], a[148:149], v[214:215], v[48:51]
s_waitcnt lgkmcnt(4)
v_mfma_f32_16x16x16_bf16 v[52:55], a[152:153], v[212:213], v[52:55]
ds_read_b128 a[144:147], v210 offset:2048
ds_read_b128 a[148:151], v210 offset:20480
v_mfma_f32_16x16x16_bf16 v[56:59], a[152:153], v[214:215], v[56:59]
v_mfma_f32_16x16x16_bf16 v[60:63], a[156:157], v[212:213], v[60:63]
v_mfma_f32_16x16x16_bf16 v[64:67], a[156:157], v[214:215], v[64:67]
s_waitcnt lgkmcnt(4)
s_barrier
v_mfma_f32_16x16x32_bf16 v[68:71], a[160:163], a[0:3], 0
ds_read_b128 a[152:155], v210 offset:3072
ds_read_b128 a[156:159], v210 offset:21504
v_mfma_f32_16x16x32_bf16 v[72:75], a[160:163], a[4:7], 0
s_mul_i32 s38, s24, 9216
s_add_u32 m0, s38, 123904
v_mfma_f32_16x16x32_bf16 v[76:79], a[164:167], a[0:3], 0
s_add_u32 s39, s38, s82
v_mfma_f32_16x16x32_bf16 v[80:83], a[164:167], a[4:7], 0
s_waitcnt lgkmcnt(4)
v_mfma_f32_16x16x32_bf16 v[68:71], a[168:171], a[8:11], v[68:71]
ds_read_b128 a[160:163], v210 offset:4096
ds_read_b128 a[164:167], v210 offset:22528
v_mfma_f32_16x16x32_bf16 v[72:75], a[168:171], a[12:15], v[72:75]
s_add_u32 s39, s39, 151552
v_mfma_f32_16x16x32_bf16 v[76:79], a[172:175], a[8:11], v[76:79]
buffer_load_dwordx4 v1, s[4:7], s39 offen offset:0 sc1 lds
buffer_load_dwordx4 v1, s[4:7], s39 offen offset:1024 sc1 lds
v_pk_mul_f32 v[216:217], v[36:37], v[36:37]
v_pk_mul_f32 v[218:219], v[38:39], v[38:39]
v_pk_mul_f32 v[220:221], v[40:41], v[40:41]
v_pk_mul_f32 v[222:223], v[42:43], v[42:43]
v_pk_fma_f32 v[216:217], v[216:217], v[252:253], v[250:251] op_sel:[0,0,0] op_sel_hi:[1,0,0]
v_pk_fma_f32 v[218:219], v[218:219], v[252:253], v[250:251] op_sel:[0,0,0] op_sel_hi:[1,0,0]
v_pk_fma_f32 v[220:221], v[220:221], v[252:253], v[250:251] op_sel:[0,1,1] op_sel_hi:[1,1,1]
v_pk_fma_f32 v[222:223], v[222:223], v[252:253], v[250:251] op_sel:[0,1,1] op_sel_hi:[1,1,1]
v_pk_mul_f32 v[216:217], v[216:217], v[36:37]
v_pk_mul_f32 v[218:219], v[218:219], v[38:39]
v_pk_mul_f32 v[220:221], v[220:221], v[40:41]
v_pk_mul_f32 v[222:223], v[222:223], v[42:43]
v_mfma_f32_16x16x32_bf16 v[80:83], a[172:175], a[12:15], v[80:83]
s_waitcnt lgkmcnt(4)
v_exp_f32 v216, v216
v_mfma_f32_16x16x32_bf16 v[68:71], a[144:147], a[16:19], v[68:71]
ds_read_b128 a[168:171], v210 offset:5120
ds_read_b128 a[172:175], v210 offset:23552
v_mfma_f32_16x16x32_bf16 v[72:75], a[144:147], a[20:23], v[72:75]
v_exp_f32 v217, v217
v_mfma_f32_16x16x32_bf16 v[76:79], a[148:151], a[16:19], v[76:79]
buffer_load_dwordx4 v1, s[4:7], s39 offen offset:2048 sc1 lds
buffer_load_dwordx4 v1, s[4:7], s39 offen offset:3072 sc1 lds
v_mfma_f32_16x16x32_bf16 v[80:83], a[148:151], a[20:23], v[80:83]
s_waitcnt lgkmcnt(4)
v_exp_f32 v218, v218
v_mfma_f32_16x16x32_bf16 v[68:71], a[152:155], a[24:27], v[68:71]
ds_read_b128 a[144:147], v210 offset:6144
ds_read_b128 a[148:151], v210 offset:24576
v_mfma_f32_16x16x32_bf16 v[72:75], a[152:155], a[28:31], v[72:75]
s_add_u32 m0, m0, 4096
v_fma_f32 v216, v216, v254, v254
v_fma_f32 v217, v217, v254, v254
v_mfma_f32_16x16x32_bf16 v[76:79], a[156:159], a[24:27], v[76:79]
s_add_u32 s39, s39, 4096
v_exp_f32 v219, v219
v_mfma_f32_16x16x32_bf16 v[80:83], a[156:159], a[28:31], v[80:83]
s_waitcnt lgkmcnt(4)
v_exp_f32 v220, v220
v_mfma_f32_16x16x32_bf16 v[68:71], a[160:163], a[32:35], v[68:71]
ds_read_b128 a[152:155], v210 offset:7168
ds_read_b128 a[156:159], v210 offset:25600
v_mfma_f32_16x16x32_bf16 v[72:75], a[160:163], a[36:39], v[72:75]
buffer_load_dwordx4 v1, s[4:7], s39 offen offset:0 sc1 lds
buffer_load_dwordx4 v1, s[4:7], s39 offen offset:1024 sc1 lds
v_mfma_f32_16x16x32_bf16 v[76:79], a[164:167], a[32:35], v[76:79]
v_fma_f32 v218, v218, v254, v254
v_fma_f32 v219, v219, v254, v254
v_mfma_f32_16x16x32_bf16 v[80:83], a[164:167], a[36:39], v[80:83]
s_waitcnt lgkmcnt(4)
v_exp_f32 v221, v221
v_mfma_f32_16x16x32_bf16 v[68:71], a[168:171], a[40:43], v[68:71]
ds_read_b128 a[160:163], v210 offset:8192
ds_read_b128 a[164:167], v210 offset:26624
v_exp_f32 v222, v222
v_mfma_f32_16x16x32_bf16 v[72:75], a[168:171], a[44:47], v[72:75]
buffer_load_dwordx4 v1, s[4:7], s39 offen offset:2048 sc1 lds
buffer_load_dwordx4 v1, s[4:7], s39 offen offset:3072 sc1 lds
v_mfma_f32_16x16x32_bf16 v[76:79], a[172:175], a[40:43], v[76:79]
s_add_u32 m0, m0, 4096
v_fma_f32 v220, v220, v255, v255
v_fma_f32 v221, v221, v255, v255
v_mfma_f32_16x16x32_bf16 v[80:83], a[172:175], a[44:47], v[80:83]
s_waitcnt lgkmcnt(4)
v_exp_f32 v223, v223
v_mfma_f32_16x16x32_bf16 v[68:71], a[144:147], a[48:51], v[68:71]
ds_read_b128 a[168:171], v210 offset:9216
ds_read_b128 a[172:175], v210 offset:27648
v_rcp_f32 v216, v216
v_mfma_f32_16x16x32_bf16 v[72:75], a[144:147], a[52:55], v[72:75]
s_add_u32 s39, s39, 4096
v_fma_f32 v222, v222, v255, v255
v_fma_f32 v223, v223, v255, v255
v_mfma_f32_16x16x32_bf16 v[76:79], a[148:151], a[48:51], v[76:79]
buffer_load_dwordx4 v1, s[4:7], s39 offen offset:0 sc1 lds
v_mfma_f32_16x16x32_bf16 v[80:83], a[148:151], a[52:55], v[80:83]
s_waitcnt lgkmcnt(4)
v_rcp_f32 v217, v217
v_mfma_f32_16x16x32_bf16 v[68:71], a[152:155], a[56:59], v[68:71]
ds_read_b128 a[144:147], v210 offset:10240
ds_read_b128 a[148:151], v210 offset:28672
v_rcp_f32 v218, v218
v_mfma_f32_16x16x32_bf16 v[72:75], a[152:155], a[60:63], v[72:75]
s_lshl_b32 s38, s24, 8
v_rcp_f32 v219, v219
v_mfma_f32_16x16x32_bf16 v[76:79], a[156:159], a[56:59], v[76:79]
s_add_u32 m0, s38, 160768
v_rcp_f32 v220, v220
v_mfma_f32_16x16x32_bf16 v[80:83], a[156:159], a[60:63], v[80:83]
s_waitcnt lgkmcnt(4)
s_add_u32 s39, s38, s82
v_mfma_f32_16x16x32_bf16 v[68:71], a[160:163], a[64:67], v[68:71]
ds_read_b128 a[152:155], v210 offset:11264
ds_read_b128 a[156:159], v210 offset:29696
v_mfma_f32_16x16x32_bf16 v[72:75], a[160:163], a[68:71], v[72:75]
s_add_u32 s39, s39, 188416
v_rcp_f32 v221, v221
v_mfma_f32_16x16x32_bf16 v[76:79], a[164:167], a[64:67], v[76:79]
v_rcp_f32 v222, v222
v_mfma_f32_16x16x32_bf16 v[80:83], a[164:167], a[68:71], v[80:83]
s_waitcnt lgkmcnt(4)
v_rcp_f32 v223, v223
v_mfma_f32_16x16x32_bf16 v[68:71], a[168:171], a[72:75], v[68:71]
ds_read_b128 a[160:163], v210 offset:12288
ds_read_b128 a[164:167], v210 offset:30720
v_pk_mul_f32 v[224:225], v[44:45], v[44:45]
v_pk_mul_f32 v[226:227], v[46:47], v[46:47]
v_pk_mul_f32 v[228:229], v[48:49], v[48:49]
v_pk_mul_f32 v[230:231], v[50:51], v[50:51]
v_pk_fma_f32 v[224:225], v[224:225], v[252:253], v[250:251] op_sel:[0,0,0] op_sel_hi:[1,0,0]
v_pk_fma_f32 v[226:227], v[226:227], v[252:253], v[250:251] op_sel:[0,0,0] op_sel_hi:[1,0,0]
v_pk_fma_f32 v[228:229], v[228:229], v[252:253], v[250:251] op_sel:[0,1,1] op_sel_hi:[1,1,1]
v_pk_fma_f32 v[230:231], v[230:231], v[252:253], v[250:251] op_sel:[0,1,1] op_sel_hi:[1,1,1]
v_pk_mul_f32 v[36:37], v[36:37], v[216:217]
v_pk_mul_f32 v[38:39], v[38:39], v[218:219]
v_pk_mul_f32 v[40:41], v[40:41], v[220:221]
v_pk_mul_f32 v[42:43], v[42:43], v[222:223]
v_pk_mul_f32 v[224:225], v[224:225], v[44:45]
v_pk_mul_f32 v[226:227], v[226:227], v[46:47]
v_pk_mul_f32 v[228:229], v[228:229], v[48:49]
v_pk_mul_f32 v[230:231], v[230:231], v[50:51]
v_mfma_f32_16x16x32_bf16 v[72:75], a[168:171], a[76:79], v[72:75]
s_mov_b64 exec, 0xffff
buffer_load_dwordx4 v1, s[4:7], s39 offen sc1 lds
s_mov_b64 exec, -1
v_exp_f32 v224, v224
v_mfma_f32_16x16x32_bf16 v[76:79], a[172:175], a[72:75], v[76:79]
v_exp_f32 v225, v225
v_mfma_f32_16x16x32_bf16 v[80:83], a[172:175], a[76:79], v[80:83]
s_waitcnt lgkmcnt(4)
v_exp_f32 v226, v226
v_mfma_f32_16x16x32_bf16 v[68:71], a[144:147], a[80:83], v[68:71]
ds_read_b128 a[168:171], v210 offset:13312
ds_read_b128 a[172:175], v210 offset:31744
v_mfma_f32_16x16x32_bf16 v[72:75], a[144:147], a[84:87], v[72:75]
s_mul_i32 s38, s24, 9216
v_fma_f32 v224, v224, v254, v254
v_fma_f32 v225, v225, v254, v254
v_mfma_f32_16x16x32_bf16 v[76:79], a[148:151], a[80:83], v[76:79]
s_add_u32 m0, s38, 0
v_exp_f32 v227, v227
v_mfma_f32_16x16x32_bf16 v[80:83], a[148:151], a[84:87], v[80:83]
s_waitcnt lgkmcnt(4)
v_exp_f32 v228, v228
v_mfma_f32_16x16x32_bf16 v[68:71], a[152:155], a[88:91], v[68:71]
ds_read_b128 a[144:147], v210 offset:14336
ds_read_b128 a[148:151], v210 offset:32768
v_mfma_f32_16x16x32_bf16 v[72:75], a[152:155], a[92:95], v[72:75]
s_add_u32 s39, s38, s82
v_fma_f32 v226, v226, v254, v254
v_fma_f32 v227, v227, v254, v254
v_mfma_f32_16x16x32_bf16 v[76:79], a[156:159], a[88:91], v[76:79]
s_add_u32 s39, s39, 189440
v_exp_f32 v229, v229
v_mfma_f32_16x16x32_bf16 v[80:83], a[156:159], a[92:95], v[80:83]
s_waitcnt lgkmcnt(4)
v_exp_f32 v230, v230
v_mfma_f32_16x16x32_bf16 v[68:71], a[160:163], a[96:99], v[68:71]
ds_read_b128 a[152:155], v210 offset:15360
ds_read_b128 a[156:159], v210 offset:33792
v_mfma_f32_16x16x32_bf16 v[72:75], a[160:163], a[100:103], v[72:75]
v_fma_f32 v228, v228, v255, v255
v_fma_f32 v229, v229, v255, v255
v_mfma_f32_16x16x32_bf16 v[76:79], a[164:167], a[96:99], v[76:79]
buffer_load_dwordx4 v1, s[4:7], s39 offen offset:0 sc1 lds
buffer_load_dwordx4 v1, s[4:7], s39 offen offset:1024 sc1 lds
v_exp_f32 v231, v231
v_mfma_f32_16x16x32_bf16 v[80:83], a[164:167], a[100:103], v[80:83]
s_waitcnt lgkmcnt(4)
v_rcp_f32 v224, v224
v_mfma_f32_16x16x32_bf16 v[68:71], a[168:171], a[104:107], v[68:71]
ds_read_b128 a[160:163], v210 offset:16384
ds_read_b128 a[164:167], v210 offset:34816
v_mfma_f32_16x16x32_bf16 v[72:75], a[168:171], a[108:111], v[72:75]
v_fma_f32 v230, v230, v255, v255
v_fma_f32 v231, v231, v255, v255
v_mfma_f32_16x16x32_bf16 v[76:79], a[172:175], a[104:107], v[76:79]
v_rcp_f32 v225, v225
v_mfma_f32_16x16x32_bf16 v[80:83], a[172:175], a[108:111], v[80:83]
s_waitcnt lgkmcnt(4)
v_rcp_f32 v226, v226
v_mfma_f32_16x16x32_bf16 v[68:71], a[144:147], a[112:115], v[68:71]
ds_read_b128 a[168:171], v210 offset:17408
ds_read_b128 a[172:175], v210 offset:35840
v_mfma_f32_16x16x32_bf16 v[72:75], a[144:147], a[116:119], v[72:75]
buffer_load_dwordx4 v1, s[4:7], s39 offen offset:2048 sc1 lds
buffer_load_dwordx4 v1, s[4:7], s39 offen offset:3072 sc1 lds
v_rcp_f32 v227, v227
v_mfma_f32_16x16x32_bf16 v[76:79], a[148:151], a[112:115], v[76:79]
s_add_u32 m0, m0, 4096
v_rcp_f32 v228, v228
v_mfma_f32_16x16x32_bf16 v[80:83], a[148:151], a[116:119], v[80:83]
s_waitcnt lgkmcnt(4)
v_add_u32 v181, 74752, v239
v_mfma_f32_16x16x32_bf16 v[68:71], a[152:155], a[120:123], v[68:71]
ds_read_b64 a[144:145], v181 offset:0
ds_read_b64 a[148:149], v181 offset:512
v_rcp_f32 v229, v229
v_mfma_f32_16x16x32_bf16 v[72:75], a[152:155], a[124:127], v[72:75]
s_add_u32 s39, s39, 4096
v_rcp_f32 v230, v230
v_mfma_f32_16x16x32_bf16 v[76:79], a[156:159], a[120:123], v[76:79]
v_rcp_f32 v231, v231
v_mfma_f32_16x16x32_bf16 v[80:83], a[156:159], a[124:127], v[80:83]
s_waitcnt lgkmcnt(4)
v_pk_mul_f32 v[216:217], v[52:53], v[52:53]
v_pk_mul_f32 v[218:219], v[54:55], v[54:55]
v_pk_mul_f32 v[220:221], v[56:57], v[56:57]
v_pk_mul_f32 v[222:223], v[58:59], v[58:59]
v_pk_fma_f32 v[216:217], v[216:217], v[252:253], v[250:251] op_sel:[0,0,0] op_sel_hi:[1,0,0]
v_pk_fma_f32 v[218:219], v[218:219], v[252:253], v[250:251] op_sel:[0,0,0] op_sel_hi:[1,0,0]
v_pk_fma_f32 v[220:221], v[220:221], v[252:253], v[250:251] op_sel:[0,1,1] op_sel_hi:[1,1,1]
v_pk_fma_f32 v[222:223], v[222:223], v[252:253], v[250:251] op_sel:[0,1,1] op_sel_hi:[1,1,1]
v_pk_mul_f32 v[44:45], v[44:45], v[224:225]
v_pk_mul_f32 v[46:47], v[46:47], v[226:227]
v_pk_mul_f32 v[48:49], v[48:49], v[228:229]
v_pk_mul_f32 v[50:51], v[50:51], v[230:231]
v_pk_mul_f32 v[216:217], v[216:217], v[52:53]
v_pk_mul_f32 v[218:219], v[218:219], v[54:55]
v_pk_mul_f32 v[220:221], v[220:221], v[56:57]
v_pk_mul_f32 v[222:223], v[222:223], v[58:59]
v_mfma_f32_16x16x32_bf16 v[68:71], a[160:163], a[128:131], v[68:71]
ds_read_b128 a[152:155], v211 offset:0
ds_read_b128 a[156:159], v211 offset:18432
v_exp_f32 v216, v216
v_mfma_f32_16x16x32_bf16 v[72:75], a[160:163], a[132:135], v[72:75]
buffer_load_dwordx4 v1, s[4:7], s39 offen offset:0 sc1 lds
buffer_load_dwordx4 v1, s[4:7], s39 offen offset:1024 sc1 lds
v_exp_f32 v217, v217
v_mfma_f32_16x16x32_bf16 v[76:79], a[164:167], a[128:131], v[76:79]
v_exp_f32 v218, v218
v_mfma_f32_16x16x32_bf16 v[80:83], a[164:167], a[132:135], v[80:83]
s_waitcnt lgkmcnt(4)
v_fma_f32 v216, v216, v254, v254
v_fma_f32 v217, v217, v254, v254
v_mfma_f32_16x16x32_bf16 v[68:71], a[168:171], a[136:139], v[68:71]
ds_read_b128 a[160:163], v211 offset:1024
ds_read_b128 a[164:167], v211 offset:19456
v_mfma_f32_16x16x32_bf16 v[72:75], a[168:171], a[140:143], v[72:75]
v_exp_f32 v219, v219
v_mfma_f32_16x16x32_bf16 v[76:79], a[172:175], a[136:139], v[76:79]
v_exp_f32 v220, v220
v_mfma_f32_16x16x32_bf16 v[80:83], a[172:175], a[140:143], v[80:83]
s_waitcnt lgkmcnt(4)
v_fma_f32 v218, v218, v254, v254
v_fma_f32 v219, v219, v254, v254
v_mfma_f32_16x16x16_bf16 v[68:71], a[144:145], v[212:213], v[68:71]
ds_read_b128 a[168:171], v211 offset:2048
ds_read_b128 a[172:175], v211 offset:20480
v_mfma_f32_16x16x16_bf16 v[72:75], a[144:145], v[214:215], v[72:75]
buffer_load_dwordx4 v1, s[4:7], s39 offen offset:2048 sc1 lds
buffer_load_dwordx4 v1, s[4:7], s39 offen offset:3072 sc1 lds
v_exp_f32 v221, v221
v_mfma_f32_16x16x16_bf16 v[76:79], a[148:149], v[212:213], v[76:79]
s_add_u32 m0, m0, 4096
v_exp_f32 v222, v222
v_mfma_f32_16x16x16_bf16 v[80:83], a[148:149], v[214:215], v[80:83]
s_waitcnt vmcnt(8) lgkmcnt(4)
s_barrier
v_mfma_f32_16x16x32_bf16 v[84:87], a[152:155], a[0:3], 0
ds_read_b128 a[144:147], v211 offset:3072
ds_read_b128 a[148:151], v211 offset:21504
v_fma_f32 v220, v220, v255, v255
v_fma_f32 v221, v221, v255, v255
v_mfma_f32_16x16x32_bf16 v[88:91], a[152:155], a[4:7], 0
buffer_load_dwordx4 a[176:179], v1, s[4:7], s52 offen offset:0 sc1
buffer_load_dwordx4 a[180:183], v9, s[4:7], s52 offen offset:0 sc1
v_exp_f32 v223, v223
v_mfma_f32_16x16x32_bf16 v[92:95], a[156:159], a[0:3], 0
s_add_u32 s39, s39, 4096
v_rcp_f32 v216, v216
v_mfma_f32_16x16x32_bf16 v[96:99], a[156:159], a[4:7], 0
s_waitcnt lgkmcnt(4)
v_fma_f32 v222, v222, v255, v255
v_fma_f32 v223, v223, v255, v255
v_mfma_f32_16x16x32_bf16 v[84:87], a[160:163], a[8:11], v[84:87]
ds_read_b128 a[152:155], v211 offset:4096
ds_read_b128 a[156:159], v211 offset:22528
v_mfma_f32_16x16x32_bf16 v[88:91], a[160:163], a[12:15], v[88:91]
buffer_load_dwordx4 v1, s[4:7], s39 offen offset:0 sc1 lds
v_rcp_f32 v217, v217
v_mfma_f32_16x16x32_bf16 v[92:95], a[164:167], a[8:11], v[92:95]
s_lshl_b32 s38, s24, 8
v_rcp_f32 v218, v218
v_mfma_f32_16x16x32_bf16 v[96:99], a[164:167], a[12:15], v[96:99]
s_waitcnt lgkmcnt(4)
v_rcp_f32 v219, v219
v_mfma_f32_16x16x32_bf16 v[84:87], a[168:171], a[16:19], v[84:87]
ds_read_b128 a[160:163], v211 offset:5120
ds_read_b128 a[164:167], v211 offset:23552
v_mfma_f32_16x16x32_bf16 v[88:91], a[168:171], a[20:23], v[88:91]
s_add_u32 m0, s38, 36864
v_rcp_f32 v220, v220
v_mfma_f32_16x16x32_bf16 v[92:95], a[172:175], a[16:19], v[92:95]
s_add_u32 s39, s38, s82
v_rcp_f32 v221, v221
v_mfma_f32_16x16x32_bf16 v[96:99], a[172:175], a[20:23], v[96:99]
s_waitcnt lgkmcnt(4)
v_rcp_f32 v222, v222
v_mfma_f32_16x16x32_bf16 v[84:87], a[144:147], a[24:27], v[84:87]
ds_read_b128 a[168:171], v211 offset:6144
ds_read_b128 a[172:175], v211 offset:24576
v_mfma_f32_16x16x32_bf16 v[88:91], a[144:147], a[28:31], v[88:91]
buffer_load_dwordx4 a[184:187], v1, s[4:7], s52 offen offset:1024 sc1
buffer_load_dwordx4 a[188:191], v9, s[4:7], s52 offen offset:1024 sc1
v_rcp_f32 v223, v223
v_mfma_f32_16x16x32_bf16 v[92:95], a[148:151], a[24:27], v[92:95]
s_add_u32 s39, s39, 226304
v_pk_mul_f32 v[224:225], v[60:61], v[60:61]
v_pk_mul_f32 v[226:227], v[62:63], v[62:63]
v_pk_mul_f32 v[228:229], v[64:65], v[64:65]
v_pk_mul_f32 v[230:231], v[66:67], v[66:67]
v_pk_fma_f32 v[224:225], v[224:225], v[252:253], v[250:251] op_sel:[0,0,0] op_sel_hi:[1,0,0]
v_pk_fma_f32 v[226:227], v[226:227], v[252:253], v[250:251] op_sel:[0,0,0] op_sel_hi:[1,0,0]
v_pk_fma_f32 v[228:229], v[228:229], v[252:253], v[250:251] op_sel:[0,1,1] op_sel_hi:[1,1,1]
v_pk_fma_f32 v[230:231], v[230:231], v[252:253], v[250:251] op_sel:[0,1,1] op_sel_hi:[1,1,1]
v_pk_mul_f32 v[52:53], v[52:53], v[216:217]
v_pk_mul_f32 v[54:55], v[54:55], v[218:219]
v_pk_mul_f32 v[56:57], v[56:57], v[220:221]
v_pk_mul_f32 v[58:59], v[58:59], v[222:223]
v_pk_mul_f32 v[224:225], v[224:225], v[60:61]
v_pk_mul_f32 v[226:227], v[226:227], v[62:63]
v_pk_mul_f32 v[228:229], v[228:229], v[64:65]
v_pk_mul_f32 v[230:231], v[230:231], v[66:67]
v_mfma_f32_16x16x32_bf16 v[96:99], a[148:151], a[28:31], v[96:99]
s_waitcnt lgkmcnt(4)
v_exp_f32 v224, v224
v_mfma_f32_16x16x32_bf16 v[84:87], a[152:155], a[32:35], v[84:87]
ds_read_b128 a[144:147], v211 offset:7168
ds_read_b128 a[148:151], v211 offset:25600
v_exp_f32 v225, v225
v_mfma_f32_16x16x32_bf16 v[88:91], a[152:155], a[36:39], v[88:91]
v_exp_f32 v226, v226
v_mfma_f32_16x16x32_bf16 v[92:95], a[156:159], a[32:35], v[92:95]
s_mov_b64 exec, 0xffff
buffer_load_dwordx4 v1, s[4:7], s39 offen sc1 lds
s_mov_b64 exec, -1
v_mfma_f32_16x16x32_bf16 v[96:99], a[156:159], a[36:39], v[96:99]
s_waitcnt lgkmcnt(4)
v_fma_f32 v224, v224, v254, v254
v_fma_f32 v225, v225, v254, v254
v_mfma_f32_16x16x32_bf16 v[84:87], a[160:163], a[40:43], v[84:87]
ds_read_b128 a[152:155], v211 offset:8192
ds_read_b128 a[156:159], v211 offset:26624
v_exp_f32 v227, v227
v_mfma_f32_16x16x32_bf16 v[88:91], a[160:163], a[44:47], v[88:91]
v_exp_f32 v228, v228
v_mfma_f32_16x16x32_bf16 v[92:95], a[164:167], a[40:43], v[92:95]
v_fma_f32 v226, v226, v254, v254
v_fma_f32 v227, v227, v254, v254
v_mfma_f32_16x16x32_bf16 v[96:99], a[164:167], a[44:47], v[96:99]
s_waitcnt lgkmcnt(4)
v_exp_f32 v229, v229
v_mfma_f32_16x16x32_bf16 v[84:87], a[168:171], a[48:51], v[84:87]
ds_read_b128 a[160:163], v211 offset:9216
ds_read_b128 a[164:167], v211 offset:27648
v_mfma_f32_16x16x32_bf16 v[88:91], a[168:171], a[52:55], v[88:91]
v_exp_f32 v230, v230
v_mfma_f32_16x16x32_bf16 v[92:95], a[172:175], a[48:51], v[92:95]
buffer_load_dwordx4 a[192:195], v1, s[4:7], s52 offen offset:2048 sc1
buffer_load_dwordx4 a[196:199], v9, s[4:7], s52 offen offset:2048 sc1
v_mfma_f32_16x16x32_bf16 v[96:99], a[172:175], a[52:55], v[96:99]
s_waitcnt lgkmcnt(4)
s_mul_i32 s38, s24, 9216
v_fma_f32 v228, v228, v255, v255
v_fma_f32 v229, v229, v255, v255
v_mfma_f32_16x16x32_bf16 v[84:87], a[144:147], a[56:59], v[84:87]
ds_read_b128 a[168:171], v211 offset:10240
ds_read_b128 a[172:175], v211 offset:28672
v_exp_f32 v231, v231
v_mfma_f32_16x16x32_bf16 v[88:91], a[144:147], a[60:63], v[88:91]
s_add_u32 m0, s38, 37888
v_rcp_f32 v224, v224
v_mfma_f32_16x16x32_bf16 v[92:95], a[148:151], a[56:59], v[92:95]
s_add_u32 s39, s38, s82
v_fma_f32 v230, v230, v255, v255
v_fma_f32 v231, v231, v255, v255
v_mfma_f32_16x16x32_bf16 v[96:99], a[148:151], a[60:63], v[96:99]
s_waitcnt lgkmcnt(4)
v_rcp_f32 v225, v225
v_mfma_f32_16x16x32_bf16 v[84:87], a[152:155], a[64:67], v[84:87]
ds_read_b128 a[144:147], v211 offset:11264
ds_read_b128 a[148:151], v211 offset:29696
v_mfma_f32_16x16x32_bf16 v[88:91], a[152:155], a[68:71], v[88:91]
s_add_u32 s39, s39, 227328
v_rcp_f32 v226, v226
v_mfma_f32_16x16x32_bf16 v[92:95], a[156:159], a[64:67], v[92:95]
v_rcp_f32 v227, v227
v_mfma_f32_16x16x32_bf16 v[96:99], a[156:159], a[68:71], v[96:99]
s_waitcnt lgkmcnt(4)
v_rcp_f32 v228, v228
v_mfma_f32_16x16x32_bf16 v[84:87], a[160:163], a[72:75], v[84:87]
ds_read_b128 a[152:155], v211 offset:12288
ds_read_b128 a[156:159], v211 offset:30720
v_mfma_f32_16x16x32_bf16 v[88:91], a[160:163], a[76:79], v[88:91]
buffer_load_dwordx4 v1, s[4:7], s39 offen offset:0 sc1 lds
buffer_load_dwordx4 v1, s[4:7], s39 offen offset:1024 sc1 lds
v_mfma_f32_16x16x32_bf16 v[92:95], a[164:167], a[72:75], v[92:95]
v_rcp_f32 v229, v229
v_mfma_f32_16x16x32_bf16 v[96:99], a[164:167], a[76:79], v[96:99]
s_waitcnt lgkmcnt(4)
v_rcp_f32 v230, v230
v_mfma_f32_16x16x32_bf16 v[84:87], a[168:171], a[80:83], v[84:87]
ds_read_b128 a[160:163], v211 offset:13312
ds_read_b128 a[164:167], v211 offset:31744
v_rcp_f32 v231, v231
v_mfma_f32_16x16x32_bf16 v[88:91], a[168:171], a[84:87], v[88:91]
buffer_load_dwordx4 v1, s[4:7], s39 offen offset:2048 sc1 lds
buffer_load_dwordx4 v1, s[4:7], s39 offen offset:3072 sc1 lds
v_pk_mul_f32 v[216:217], v[68:69], v[68:69]
v_pk_mul_f32 v[218:219], v[70:71], v[70:71]
v_pk_mul_f32 v[220:221], v[72:73], v[72:73]
v_pk_mul_f32 v[222:223], v[74:75], v[74:75]
v_pk_fma_f32 v[216:217], v[216:217], v[252:253], v[250:251] op_sel:[0,0,0] op_sel_hi:[1,0,0]
v_pk_fma_f32 v[218:219], v[218:219], v[252:253], v[250:251] op_sel:[0,0,0] op_sel_hi:[1,0,0]
v_pk_fma_f32 v[220:221], v[220:221], v[252:253], v[250:251] op_sel:[0,1,1] op_sel_hi:[1,1,1]
v_pk_fma_f32 v[222:223], v[222:223], v[252:253], v[250:251] op_sel:[0,1,1] op_sel_hi:[1,1,1]
v_pk_mul_f32 v[60:61], v[60:61], v[224:225]
v_pk_mul_f32 v[62:63], v[62:63], v[226:227]
v_pk_mul_f32 v[64:65], v[64:65], v[228:229]
v_pk_mul_f32 v[66:67], v[66:67], v[230:231]
v_pk_mul_f32 v[216:217], v[216:217], v[68:69]
v_pk_mul_f32 v[218:219], v[218:219], v[70:71]
v_pk_mul_f32 v[220:221], v[220:221], v[72:73]
v_pk_mul_f32 v[222:223], v[222:223], v[74:75]
v_mfma_f32_16x16x32_bf16 v[92:95], a[172:175], a[80:83], v[92:95]
buffer_load_dwordx4 a[200:203], v1, s[4:7], s52 offen offset:3072 sc1
buffer_load_dwordx4 a[204:207], v9, s[4:7], s52 offen offset:3072 sc1
v_exp_f32 v216, v216
v_mfma_f32_16x16x32_bf16 v[96:99], a[172:175], a[84:87], v[96:99]
s_waitcnt lgkmcnt(4)
v_exp_f32 v217, v217
v_mfma_f32_16x16x32_bf16 v[84:87], a[144:147], a[88:91], v[84:87]
ds_read_b128 a[168:171], v211 offset:14336
ds_read_b128 a[172:175], v211 offset:32768
v_exp_f32 v218, v218
v_mfma_f32_16x16x32_bf16 v[88:91], a[144:147], a[92:95], v[88:91]
s_add_u32 m0, m0, 4096
v_fma_f32 v216, v216, v254, v254
v_fma_f32 v217, v217, v254, v254
v_mfma_f32_16x16x32_bf16 v[92:95], a[148:151], a[88:91], v[92:95]
s_add_u32 s39, s39, 4096
v_exp_f32 v219, v219
v_mfma_f32_16x16x32_bf16 v[96:99], a[148:151], a[92:95], v[96:99]
s_waitcnt lgkmcnt(4)
v_exp_f32 v220, v220
v_mfma_f32_16x16x32_bf16 v[84:87], a[152:155], a[96:99], v[84:87]
ds_read_b128 a[144:147], v211 offset:15360
ds_read_b128 a[148:151], v211 offset:33792
v_mfma_f32_16x16x32_bf16 v[88:91], a[152:155], a[100:103], v[88:91]
s_add_u32 s52, s52, 4096
v_fma_f32 v218, v218, v254, v254
v_fma_f32 v219, v219, v254, v254
v_mfma_f32_16x16x32_bf16 v[92:95], a[156:159], a[96:99], v[92:95]
v_exp_f32 v221, v221
v_mfma_f32_16x16x32_bf16 v[96:99], a[156:159], a[100:103], v[96:99]
s_waitcnt lgkmcnt(4)
v_exp_f32 v222, v222
v_mfma_f32_16x16x32_bf16 v[84:87], a[160:163], a[104:107], v[84:87]
ds_read_b128 a[152:155], v211 offset:16384
ds_read_b128 a[156:159], v211 offset:34816
v_mfma_f32_16x16x32_bf16 v[88:91], a[160:163], a[108:111], v[88:91]
buffer_load_dwordx4 v1, s[4:7], s39 offen offset:0 sc1 lds
buffer_load_dwordx4 v1, s[4:7], s39 offen offset:1024 sc1 lds
v_mfma_f32_16x16x32_bf16 v[92:95], a[164:167], a[104:107], v[92:95]
v_fma_f32 v220, v220, v255, v255
v_fma_f32 v221, v221, v255, v255
v_mfma_f32_16x16x32_bf16 v[96:99], a[164:167], a[108:111], v[96:99]
s_waitcnt lgkmcnt(4)
v_exp_f32 v223, v223
v_mfma_f32_16x16x32_bf16 v[84:87], a[168:171], a[112:115], v[84:87]
ds_read_b128 a[160:163], v211 offset:17408
ds_read_b128 a[164:167], v211 offset:35840
v_rcp_f32 v216, v216
v_mfma_f32_16x16x32_bf16 v[88:91], a[168:171], a[116:119], v[88:91]
buffer_load_dwordx4 v1, s[4:7], s39 offen offset:2048 sc1 lds
buffer_load_dwordx4 v1, s[4:7], s39 offen offset:3072 sc1 lds
v_mfma_f32_16x16x32_bf16 v[92:95], a[172:175], a[112:115], v[92:95]
s_add_u32 m0, m0, 4096
v_fma_f32 v222, v222, v255, v255
v_fma_f32 v223, v223, v255, v255
v_mfma_f32_16x16x32_bf16 v[96:99], a[172:175], a[116:119], v[96:99]
s_waitcnt lgkmcnt(4)
v_rcp_f32 v217, v217
v_add_u32 v181, 112640, v239
v_mfma_f32_16x16x32_bf16 v[84:87], a[144:147], a[120:123], v[84:87]
ds_read_b64 a[168:169], v181 offset:0
ds_read_b64 a[172:173], v181 offset:512
v_rcp_f32 v218, v218
v_mfma_f32_16x16x32_bf16 v[88:91], a[144:147], a[124:127], v[88:91]
buffer_load_dwordx4 a[208:211], v1, s[4:7], s52 offen offset:0 sc1
buffer_load_dwordx4 a[212:215], v9, s[4:7], s52 offen offset:0 sc1
v_mfma_f32_16x16x32_bf16 v[92:95], a[148:151], a[120:123], v[92:95]
s_add_u32 s39, s39, 4096
v_rcp_f32 v219, v219
v_mfma_f32_16x16x32_bf16 v[96:99], a[148:151], a[124:127], v[96:99]
s_waitcnt lgkmcnt(4)
v_rcp_f32 v220, v220
v_mfma_f32_16x16x32_bf16 v[84:87], a[152:155], a[128:131], v[84:87]
ds_read_b128 a[144:147], v208 offset:0
ds_read_b128 a[148:151], v208 offset:18432
v_mfma_f32_16x16x32_bf16 v[88:91], a[152:155], a[132:135], v[88:91]
v_rcp_f32 v221, v221
v_mfma_f32_16x16x32_bf16 v[92:95], a[156:159], a[128:131], v[92:95]
v_rcp_f32 v222, v222
v_mfma_f32_16x16x32_bf16 v[96:99], a[156:159], a[132:135], v[96:99]
s_waitcnt lgkmcnt(4)
v_rcp_f32 v223, v223
v_mfma_f32_16x16x32_bf16 v[84:87], a[160:163], a[136:139], v[84:87]
ds_read_b128 a[152:155], v208 offset:1024
ds_read_b128 a[156:159], v208 offset:19456
v_pk_mul_f32 v[224:225], v[76:77], v[76:77]
v_pk_mul_f32 v[226:227], v[78:79], v[78:79]
v_pk_mul_f32 v[228:229], v[80:81], v[80:81]
v_pk_mul_f32 v[230:231], v[82:83], v[82:83]
v_pk_fma_f32 v[224:225], v[224:225], v[252:253], v[250:251] op_sel:[0,0,0] op_sel_hi:[1,0,0]
v_pk_fma_f32 v[226:227], v[226:227], v[252:253], v[250:251] op_sel:[0,0,0] op_sel_hi:[1,0,0]
v_pk_fma_f32 v[228:229], v[228:229], v[252:253], v[250:251] op_sel:[0,1,1] op_sel_hi:[1,1,1]
v_pk_fma_f32 v[230:231], v[230:231], v[252:253], v[250:251] op_sel:[0,1,1] op_sel_hi:[1,1,1]
v_pk_mul_f32 v[68:69], v[68:69], v[216:217]
v_pk_mul_f32 v[70:71], v[70:71], v[218:219]
v_pk_mul_f32 v[72:73], v[72:73], v[220:221]
v_pk_mul_f32 v[74:75], v[74:75], v[222:223]
v_pk_mul_f32 v[224:225], v[224:225], v[76:77]
v_pk_mul_f32 v[226:227], v[226:227], v[78:79]
v_pk_mul_f32 v[228:229], v[228:229], v[80:81]
v_pk_mul_f32 v[230:231], v[230:231], v[82:83]
v_mfma_f32_16x16x32_bf16 v[88:91], a[160:163], a[140:143], v[88:91]
buffer_load_dwordx4 v1, s[4:7], s39 offen offset:0 sc1 lds
s_lshl_b32 s38, s24, 8
v_exp_f32 v224, v224
v_mfma_f32_16x16x32_bf16 v[92:95], a[164:167], a[136:139], v[92:95]
s_add_u32 m0, s38, 74752
v_exp_f32 v225, v225
v_mfma_f32_16x16x32_bf16 v[96:99], a[164:167], a[140:143], v[96:99]
s_waitcnt lgkmcnt(4)
v_exp_f32 v226, v226
v_mfma_f32_16x16x16_bf16 v[84:87], a[168:169], v[212:213], v[84:87]
ds_read_b128 a[160:163], v208 offset:2048
ds_read_b128 a[164:167], v208 offset:20480
v_mfma_f32_16x16x16_bf16 v[88:91], a[168:169], v[214:215], v[88:91]
buffer_load_dwordx4 a[216:219], v1, s[4:7], s52 offen offset:1024 sc1
buffer_load_dwordx4 a[220:223], v9, s[4:7], s52 offen offset:1024 sc1
v_fma_f32 v224, v224, v254, v254
v_fma_f32 v225, v225, v254, v254
v_mfma_f32_16x16x16_bf16 v[92:95], a[172:173], v[212:213], v[92:95]
s_add_u32 s39, s38, s82
v_exp_f32 v227, v227
v_mfma_f32_16x16x16_bf16 v[96:99], a[172:173], v[214:215], v[96:99]
s_waitcnt lgkmcnt(4)
v_exp_f32 v228, v228
s_waitcnt vmcnt(17)
s_barrier
v_mfma_f32_16x16x32_bf16 v[100:103], a[144:147], a[0:3], 0
ds_read_b128 a[168:171], v208 offset:3072
ds_read_b128 a[172:175], v208 offset:21504
v_mfma_f32_16x16x32_bf16 v[104:107], a[144:147], a[4:7], 0
s_add_u32 s39, s39, 264192
v_fma_f32 v226, v226, v254, v254
v_fma_f32 v227, v227, v254, v254
v_mfma_f32_16x16x32_bf16 v[108:111], a[148:151], a[0:3], 0
v_exp_f32 v229, v229
v_mfma_f32_16x16x32_bf16 v[112:115], a[148:151], a[4:7], 0
s_waitcnt lgkmcnt(4)
v_exp_f32 v230, v230
v_mfma_f32_16x16x32_bf16 v[100:103], a[152:155], a[8:11], v[100:103]
ds_read_b128 a[144:147], v208 offset:4096
ds_read_b128 a[148:151], v208 offset:22528
v_mfma_f32_16x16x32_bf16 v[104:107], a[152:155], a[12:15], v[104:107]
s_mov_b64 exec, 0xffff
buffer_load_dwordx4 v1, s[4:7], s39 offen sc1 lds
s_mov_b64 exec, -1
v_fma_f32 v228, v228, v255, v255
v_fma_f32 v229, v229, v255, v255
v_mfma_f32_16x16x32_bf16 v[108:111], a[156:159], a[8:11], v[108:111]
v_exp_f32 v231, v231
v_mfma_f32_16x16x32_bf16 v[112:115], a[156:159], a[12:15], v[112:115]
s_waitcnt lgkmcnt(4)
v_rcp_f32 v224, v224
v_mfma_f32_16x16x32_bf16 v[100:103], a[160:163], a[16:19], v[100:103]
ds_read_b128 a[152:155], v208 offset:5120
ds_read_b128 a[156:159], v208 offset:23552
v_mfma_f32_16x16x32_bf16 v[104:107], a[160:163], a[20:23], v[104:107]
v_fma_f32 v230, v230, v255, v255
v_fma_f32 v231, v231, v255, v255
v_mfma_f32_16x16x32_bf16 v[108:111], a[164:167], a[16:19], v[108:111]
v_rcp_f32 v225, v225
v_mfma_f32_16x16x32_bf16 v[112:115], a[164:167], a[20:23], v[112:115]
s_waitcnt lgkmcnt(4)
v_rcp_f32 v226, v226
v_mfma_f32_16x16x32_bf16 v[100:103], a[168:171], a[24:27], v[100:103]
ds_read_b128 a[160:163], v208 offset:6144
ds_read_b128 a[164:167], v208 offset:24576
v_mfma_f32_16x16x32_bf16 v[104:107], a[168:171], a[28:31], v[104:107]
buffer_load_dwordx4 a[224:227], v1, s[4:7], s52 offen offset:2048 sc1
buffer_load_dwordx4 a[228:231], v9, s[4:7], s52 offen offset:2048 sc1
v_rcp_f32 v227, v227
v_mfma_f32_16x16x32_bf16 v[108:111], a[172:175], a[24:27], v[108:111]
s_mul_i32 s38, s24, 9216
s_add_u32 m0, s38, 75776
v_rcp_f32 v228, v228
v_mfma_f32_16x16x32_bf16 v[112:115], a[172:175], a[28:31], v[112:115]
s_waitcnt lgkmcnt(4)
v_rcp_f32 v229, v229
v_mfma_f32_16x16x32_bf16 v[100:103], a[144:147], a[32:35], v[100:103]
ds_read_b128 a[168:171], v208 offset:7168
ds_read_b128 a[172:175], v208 offset:25600
v_mfma_f32_16x16x32_bf16 v[104:107], a[144:147], a[36:39], v[104:107]
s_add_u32 s39, s38, s82
v_rcp_f32 v230, v230
v_mfma_f32_16x16x32_bf16 v[108:111], a[148:151], a[32:35], v[108:111]
s_add_u32 s39, s39, 265216
v_rcp_f32 v231, v231
v_mfma_f32_16x16x32_bf16 v[112:115], a[148:151], a[36:39], v[112:115]
s_waitcnt lgkmcnt(4)
v_pk_mul_f32 v[216:217], v[84:85], v[84:85]
v_pk_mul_f32 v[218:219], v[86:87], v[86:87]
v_pk_mul_f32 v[220:221], v[88:89], v[88:89]
v_pk_mul_f32 v[222:223], v[90:91], v[90:91]
v_pk_fma_f32 v[216:217], v[216:217], v[252:253], v[250:251] op_sel:[0,0,0] op_sel_hi:[1,0,0]
v_pk_fma_f32 v[218:219], v[218:219], v[252:253], v[250:251] op_sel:[0,0,0] op_sel_hi:[1,0,0]
v_pk_fma_f32 v[220:221], v[220:221], v[252:253], v[250:251] op_sel:[0,1,1] op_sel_hi:[1,1,1]
v_pk_fma_f32 v[222:223], v[222:223], v[252:253], v[250:251] op_sel:[0,1,1] op_sel_hi:[1,1,1]
v_pk_mul_f32 v[76:77], v[76:77], v[224:225]
v_pk_mul_f32 v[78:79], v[78:79], v[226:227]
v_pk_mul_f32 v[80:81], v[80:81], v[228:229]
v_pk_mul_f32 v[82:83], v[82:83], v[230:231]
v_pk_mul_f32 v[216:217], v[216:217], v[84:85]
v_pk_mul_f32 v[218:219], v[218:219], v[86:87]
v_pk_mul_f32 v[220:221], v[220:221], v[88:89]
v_pk_mul_f32 v[222:223], v[222:223], v[90:91]
v_mfma_f32_16x16x32_bf16 v[100:103], a[152:155], a[40:43], v[100:103]
ds_read_b128 a[144:147], v208 offset:8192
ds_read_b128 a[148:151], v208 offset:26624
v_exp_f32 v216, v216
v_mfma_f32_16x16x32_bf16 v[104:107], a[152:155], a[44:47], v[104:107]
v_exp_f32 v217, v217
v_mfma_f32_16x16x32_bf16 v[108:111], a[156:159], a[40:43], v[108:111]
buffer_load_dwordx4 v1, s[4:7], s39 offen offset:0 sc1 lds
buffer_load_dwordx4 v1, s[4:7], s39 offen offset:1024 sc1 lds
v_exp_f32 v218, v218
v_mfma_f32_16x16x32_bf16 v[112:115], a[156:159], a[44:47], v[112:115]
s_waitcnt lgkmcnt(4)
v_fma_f32 v216, v216, v254, v254
v_fma_f32 v217, v217, v254, v254
v_mfma_f32_16x16x32_bf16 v[100:103], a[160:163], a[48:51], v[100:103]
ds_read_b128 a[152:155], v208 offset:9216
ds_read_b128 a[156:159], v208 offset:27648
v_mfma_f32_16x16x32_bf16 v[104:107], a[160:163], a[52:55], v[104:107]
buffer_load_dwordx4 a[232:235], v1, s[4:7], s52 offen offset:3072 sc1
buffer_load_dwordx4 a[236:239], v9, s[4:7], s52 offen offset:3072 sc1
v_exp_f32 v219, v219
v_mfma_f32_16x16x32_bf16 v[108:111], a[164:167], a[48:51], v[108:111]
s_add_u32 s52, s52, 4096
v_exp_f32 v220, v220
v_mfma_f32_16x16x32_bf16 v[112:115], a[164:167], a[52:55], v[112:115]
s_waitcnt lgkmcnt(4)
v_fma_f32 v218, v218, v254, v254
v_fma_f32 v219, v219, v254, v254
v_mfma_f32_16x16x32_bf16 v[100:103], a[168:171], a[56:59], v[100:103]
ds_read_b128 a[160:163], v208 offset:10240
ds_read_b128 a[164:167], v208 offset:28672
v_mfma_f32_16x16x32_bf16 v[104:107], a[168:171], a[60:63], v[104:107]
buffer_load_dwordx4 v1, s[4:7], s39 offen offset:2048 sc1 lds
buffer_load_dwordx4 v1, s[4:7], s39 offen offset:3072 sc1 lds
v_exp_f32 v221, v221
v_mfma_f32_16x16x32_bf16 v[108:111], a[172:175], a[56:59], v[108:111]
s_add_u32 m0, m0, 4096
v_exp_f32 v222, v222
v_mfma_f32_16x16x32_bf16 v[112:115], a[172:175], a[60:63], v[112:115]
s_waitcnt lgkmcnt(4)
v_fma_f32 v220, v220, v255, v255
v_fma_f32 v221, v221, v255, v255
v_mfma_f32_16x16x32_bf16 v[100:103], a[144:147], a[64:67], v[100:103]
ds_read_b128 a[168:171], v208 offset:11264
ds_read_b128 a[172:175], v208 offset:29696
v_mfma_f32_16x16x32_bf16 v[104:107], a[144:147], a[68:71], v[104:107]
s_add_u32 s39, s39, 4096
v_exp_f32 v223, v223
v_mfma_f32_16x16x32_bf16 v[108:111], a[148:151], a[64:67], v[108:111]
v_rcp_f32 v216, v216
v_mfma_f32_16x16x32_bf16 v[112:115], a[148:151], a[68:71], v[112:115]
s_waitcnt lgkmcnt(4)
v_fma_f32 v222, v222, v255, v255
v_fma_f32 v223, v223, v255, v255
v_mfma_f32_16x16x32_bf16 v[100:103], a[152:155], a[72:75], v[100:103]
ds_read_b128 a[144:147], v208 offset:12288
ds_read_b128 a[148:151], v208 offset:30720
v_mfma_f32_16x16x32_bf16 v[104:107], a[152:155], a[76:79], v[104:107]
buffer_load_dwordx4 v1, s[4:7], s39 offen offset:0 sc1 lds
buffer_load_dwordx4 v1, s[4:7], s39 offen offset:1024 sc1 lds
v_rcp_f32 v217, v217
v_mfma_f32_16x16x32_bf16 v[108:111], a[156:159], a[72:75], v[108:111]
v_rcp_f32 v218, v218
v_mfma_f32_16x16x32_bf16 v[112:115], a[156:159], a[76:79], v[112:115]
s_waitcnt lgkmcnt(4)
v_rcp_f32 v219, v219
v_mfma_f32_16x16x32_bf16 v[100:103], a[160:163], a[80:83], v[100:103]
ds_read_b128 a[152:155], v208 offset:13312
ds_read_b128 a[156:159], v208 offset:31744
v_mfma_f32_16x16x32_bf16 v[104:107], a[160:163], a[84:87], v[104:107]
v_rcp_f32 v220, v220
v_mfma_f32_16x16x32_bf16 v[108:111], a[164:167], a[80:83], v[108:111]
v_rcp_f32 v221, v221
v_mfma_f32_16x16x32_bf16 v[112:115], a[164:167], a[84:87], v[112:115]
s_waitcnt lgkmcnt(4)
v_rcp_f32 v222, v222
v_mfma_f32_16x16x32_bf16 v[100:103], a[168:171], a[88:91], v[100:103]
ds_read_b128 a[160:163], v208 offset:14336
ds_read_b128 a[164:167], v208 offset:32768
v_mfma_f32_16x16x32_bf16 v[104:107], a[168:171], a[92:95], v[104:107]
buffer_load_dwordx4 v1, s[4:7], s39 offen offset:2048 sc1 lds
buffer_load_dwordx4 v1, s[4:7], s39 offen offset:3072 sc1 lds
v_rcp_f32 v223, v223
v_mfma_f32_16x16x32_bf16 v[108:111], a[172:175], a[88:91], v[108:111]
buffer_load_dwordx4 a[240:243], v1, s[4:7], s52 offen offset:0 sc1
buffer_load_dwordx4 a[244:247], v9, s[4:7], s52 offen offset:0 sc1
v_pk_mul_f32 v[224:225], v[92:93], v[92:93]
v_pk_mul_f32 v[226:227], v[94:95], v[94:95]
v_pk_mul_f32 v[228:229], v[96:97], v[96:97]
v_pk_mul_f32 v[230:231], v[98:99], v[98:99]
v_pk_fma_f32 v[224:225], v[224:225], v[252:253], v[250:251] op_sel:[0,0,0] op_sel_hi:[1,0,0]
v_pk_fma_f32 v[226:227], v[226:227], v[252:253], v[250:251] op_sel:[0,0,0] op_sel_hi:[1,0,0]
v_pk_fma_f32 v[228:229], v[228:229], v[252:253], v[250:251] op_sel:[0,1,1] op_sel_hi:[1,1,1]
v_pk_fma_f32 v[230:231], v[230:231], v[252:253], v[250:251] op_sel:[0,1,1] op_sel_hi:[1,1,1]
v_pk_mul_f32 v[84:85], v[84:85], v[216:217]
v_pk_mul_f32 v[86:87], v[86:87], v[218:219]
v_pk_mul_f32 v[88:89], v[88:89], v[220:221]
v_pk_mul_f32 v[90:91], v[90:91], v[222:223]
v_pk_mul_f32 v[224:225], v[224:225], v[92:93]
v_pk_mul_f32 v[226:227], v[226:227], v[94:95]
v_pk_mul_f32 v[228:229], v[228:229], v[96:97]
v_pk_mul_f32 v[230:231], v[230:231], v[98:99]
v_mfma_f32_16x16x32_bf16 v[112:115], a[172:175], a[92:95], v[112:115]
s_waitcnt lgkmcnt(4)
v_exp_f32 v224, v224
v_mfma_f32_16x16x32_bf16 v[100:103], a[144:147], a[96:99], v[100:103]
ds_read_b128 a[168:171], v208 offset:15360
ds_read_b128 a[172:175], v208 offset:33792
v_exp_f32 v225, v225
v_mfma_f32_16x16x32_bf16 v[104:107], a[144:147], a[100:103], v[104:107]
s_add_u32 m0, m0, 4096
v_exp_f32 v226, v226
v_mfma_f32_16x16x32_bf16 v[108:111], a[148:151], a[96:99], v[108:111]
s_add_u32 s39, s39, 4096
v_fma_f32 v224, v224, v254, v254
v_fma_f32 v225, v225, v254, v254
v_mfma_f32_16x16x32_bf16 v[112:115], a[148:151], a[100:103], v[112:115]
s_waitcnt lgkmcnt(4)
v_exp_f32 v227, v227
v_mfma_f32_16x16x32_bf16 v[100:103], a[152:155], a[104:107], v[100:103]
ds_read_b128 a[144:147], v208 offset:16384
ds_read_b128 a[148:151], v208 offset:34816
v_mfma_f32_16x16x32_bf16 v[104:107], a[152:155], a[108:111], v[104:107]
buffer_load_dwordx4 v1, s[4:7], s39 offen offset:0 sc1 lds
v_exp_f32 v228, v228
v_mfma_f32_16x16x32_bf16 v[108:111], a[156:159], a[104:107], v[108:111]
s_lshl_b32 s38, s24, 8
v_fma_f32 v226, v226, v254, v254
v_fma_f32 v227, v227, v254, v254
v_mfma_f32_16x16x32_bf16 v[112:115], a[156:159], a[108:111], v[112:115]
s_waitcnt lgkmcnt(4)
v_exp_f32 v229, v229
v_mfma_f32_16x16x32_bf16 v[100:103], a[160:163], a[112:115], v[100:103]
ds_read_b128 a[152:155], v208 offset:17408
ds_read_b128 a[156:159], v208 offset:35840
v_mfma_f32_16x16x32_bf16 v[104:107], a[160:163], a[116:119], v[104:107]
s_add_u32 m0, s38, 112640
v_exp_f32 v230, v230
v_mfma_f32_16x16x32_bf16 v[108:111], a[164:167], a[112:115], v[108:111]
buffer_load_dwordx4 a[248:251], v1, s[4:7], s52 offen offset:1024 sc1
buffer_load_dwordx4 a[252:255], v9, s[4:7], s52 offen offset:1024 sc1
v_mfma_f32_16x16x32_bf16 v[112:115], a[164:167], a[116:119], v[112:115]
s_waitcnt lgkmcnt(4)
v_fma_f32 v228, v228, v255, v255
v_fma_f32 v229, v229, v255, v255
v_add_u32 v181, 160768, v239
v_mfma_f32_16x16x32_bf16 v[100:103], a[168:171], a[120:123], v[100:103]
ds_read_b64 a[160:161], v181 offset:0
ds_read_b64 a[164:165], v181 offset:512
v_exp_f32 v231, v231
v_mfma_f32_16x16x32_bf16 v[104:107], a[168:171], a[124:127], v[104:107]
s_add_u32 s39, s38, s82
v_rcp_f32 v224, v224
v_mfma_f32_16x16x32_bf16 v[108:111], a[172:175], a[120:123], v[108:111]
s_add_u32 s39, s39, 302080
v_fma_f32 v230, v230, v255, v255
v_fma_f32 v231, v231, v255, v255
v_mfma_f32_16x16x32_bf16 v[112:115], a[172:175], a[124:127], v[112:115]
s_waitcnt lgkmcnt(4)
v_rcp_f32 v225, v225
v_mfma_f32_16x16x32_bf16 v[100:103], a[144:147], a[128:131], v[100:103]
ds_read_b128 a[168:171], v209 offset:0
ds_read_b128 a[172:175], v209 offset:18432
v_mfma_f32_16x16x32_bf16 v[104:107], a[144:147], a[132:135], v[104:107]
s_mov_b32 s37, L_c4-L_pc
v_rcp_f32 v226, v226
v_mfma_f32_16x16x32_bf16 v[108:111], a[148:151], a[128:131], v[108:111]
s_mov_b64 exec, 0xffff
buffer_load_dwordx4 v1, s[4:7], s39 offen sc1 lds
s_mov_b64 exec, -1
v_mfma_f32_16x16x32_bf16 v[112:115], a[148:151], a[132:135], v[112:115]
s_waitcnt lgkmcnt(4)
v_rcp_f32 v227, v227
v_mfma_f32_16x16x32_bf16 v[100:103], a[152:155], a[136:139], v[100:103]
ds_read_b128 a[144:147], v209 offset:1024
ds_read_b128 a[148:151], v209 offset:19456
v_rcp_f32 v228, v228
v_mfma_f32_16x16x32_bf16 v[104:107], a[152:155], a[140:143], v[104:107]
v_rcp_f32 v229, v229
v_mfma_f32_16x16x32_bf16 v[108:111], a[156:159], a[136:139], v[108:111]
v_rcp_f32 v230, v230
v_mfma_f32_16x16x32_bf16 v[112:115], a[156:159], a[140:143], v[112:115]
s_waitcnt lgkmcnt(4)
v_rcp_f32 v231, v231
v_mfma_f32_16x16x16_bf16 v[100:103], a[160:161], v[212:213], v[100:103]
ds_read_b128 a[152:155], v209 offset:2048
ds_read_b128 a[156:159], v209 offset:20480
v_mfma_f32_16x16x16_bf16 v[104:107], a[160:161], v[214:215], v[104:107]
v_mfma_f32_16x16x16_bf16 v[108:111], a[164:165], v[212:213], v[108:111]
v_mfma_f32_16x16x16_bf16 v[112:115], a[164:165], v[214:215], v[112:115]
s_waitcnt vmcnt(18) lgkmcnt(4)
s_barrier
v_mfma_f32_16x16x32_bf16 v[116:119], a[168:171], a[0:3], 0
ds_read_b128 a[160:163], v209 offset:3072
ds_read_b128 a[164:167], v209 offset:21504
v_mfma_f32_16x16x32_bf16 v[120:123], a[168:171], a[4:7], 0
s_mul_i32 s38, s24, 9216
s_add_u32 m0, s38, 123904
v_mfma_f32_16x16x32_bf16 v[124:127], a[172:175], a[0:3], 0
buffer_load_dword v15, v14, s[88:91], s37 offen
s_add_u32 s39, s38, s82
v_mfma_f32_16x16x32_bf16 v[128:131], a[172:175], a[4:7], 0
s_waitcnt lgkmcnt(4)
s_add_u32 s39, s39, 303104
v_mfma_f32_16x16x32_bf16 v[116:119], a[144:147], a[8:11], v[116:119]
ds_read_b128 a[168:171], v209 offset:4096
ds_read_b128 a[172:175], v209 offset:22528
v_mfma_f32_16x16x32_bf16 v[120:123], a[144:147], a[12:15], v[120:123]
buffer_load_dwordx4 v1, s[4:7], s39 offen offset:0 sc1 lds
buffer_load_dwordx4 v1, s[4:7], s39 offen offset:1024 sc1 lds
v_mfma_f32_16x16x32_bf16 v[124:127], a[148:151], a[8:11], v[124:127]
v_pk_mul_f32 v[216:217], v[100:101], v[100:101]
v_pk_mul_f32 v[218:219], v[102:103], v[102:103]
v_pk_mul_f32 v[220:221], v[104:105], v[104:105]
v_pk_mul_f32 v[222:223], v[106:107], v[106:107]
v_pk_fma_f32 v[216:217], v[216:217], v[252:253], v[250:251] op_sel:[0,0,0] op_sel_hi:[1,0,0]
v_pk_fma_f32 v[218:219], v[218:219], v[252:253], v[250:251] op_sel:[0,0,0] op_sel_hi:[1,0,0]
v_pk_fma_f32 v[220:221], v[220:221], v[252:253], v[250:251] op_sel:[0,1,1] op_sel_hi:[1,1,1]
v_pk_fma_f32 v[222:223], v[222:223], v[252:253], v[250:251] op_sel:[0,1,1] op_sel_hi:[1,1,1]
v_pk_mul_f32 v[92:93], v[92:93], v[224:225]
v_pk_mul_f32 v[94:95], v[94:95], v[226:227]
v_pk_mul_f32 v[96:97], v[96:97], v[228:229]
v_pk_mul_f32 v[98:99], v[98:99], v[230:231]
v_pk_mul_f32 v[216:217], v[216:217], v[100:101]
v_pk_mul_f32 v[218:219], v[218:219], v[102:103]
v_pk_mul_f32 v[220:221], v[220:221], v[104:105]
v_pk_mul_f32 v[222:223], v[222:223], v[106:107]
v_mfma_f32_16x16x32_bf16 v[128:131], a[148:151], a[12:15], v[128:131]
s_waitcnt lgkmcnt(4)
v_exp_f32 v216, v216
v_exp_f32 v217, v217
v_exp_f32 v218, v218
v_fma_f32 v216, v216, v254, v254
v_fma_f32 v217, v217, v254, v254
v_exp_f32 v219, v219
v_exp_f32 v220, v220
v_fma_f32 v218, v218, v254, v254
v_fma_f32 v219, v219, v254, v254
v_exp_f32 v221, v221
v_mfma_f32_16x16x32_bf16 v[116:119], a[152:155], a[16:19], v[116:119]
ds_read_b128 a[144:147], v209 offset:5120
ds_read_b128 a[148:151], v209 offset:23552
v_exp_f32 v222, v222
v_mfma_f32_16x16x32_bf16 v[120:123], a[152:155], a[20:23], v[120:123]
buffer_load_dwordx4 v1, s[4:7], s39 offen offset:2048 sc1 lds
buffer_load_dwordx4 v1, s[4:7], s39 offen offset:3072 sc1 lds
v_mfma_f32_16x16x32_bf16 v[124:127], a[156:159], a[16:19], v[124:127]
s_add_u32 m0, m0, 4096
v_fma_f32 v220, v220, v255, v255
v_fma_f32 v221, v221, v255, v255
v_mfma_f32_16x16x32_bf16 v[128:131], a[156:159], a[20:23], v[128:131]
s_waitcnt lgkmcnt(4)
s_add_u32 s39, s39, 4096
v_exp_f32 v223, v223
v_mfma_f32_16x16x32_bf16 v[116:119], a[160:163], a[24:27], v[116:119]
ds_read_b128 a[152:155], v209 offset:6144
ds_read_b128 a[156:159], v209 offset:24576
v_rcp_f32 v216, v216
v_mfma_f32_16x16x32_bf16 v[120:123], a[160:163], a[28:31], v[120:123]
buffer_load_dwordx4 v1, s[4:7], s39 offen offset:0 sc1 lds
buffer_load_dwordx4 v1, s[4:7], s39 offen offset:1024 sc1 lds
v_mfma_f32_16x16x32_bf16 v[124:127], a[164:167], a[24:27], v[124:127]
v_fma_f32 v222, v222, v255, v255
v_fma_f32 v223, v223, v255, v255
v_mfma_f32_16x16x32_bf16 v[128:131], a[164:167], a[28:31], v[128:131]
s_waitcnt lgkmcnt(4)
v_rcp_f32 v217, v217
v_mfma_f32_16x16x32_bf16 v[116:119], a[168:171], a[32:35], v[116:119]
ds_read_b128 a[160:163], v209 offset:7168
ds_read_b128 a[164:167], v209 offset:25600
v_rcp_f32 v218, v218
v_mfma_f32_16x16x32_bf16 v[120:123], a[168:171], a[36:39], v[120:123]
buffer_load_dwordx4 v1, s[4:7], s39 offen offset:2048 sc1 lds
buffer_load_dwordx4 v1, s[4:7], s39 offen offset:3072 sc1 lds
v_mfma_f32_16x16x32_bf16 v[124:127], a[172:175], a[32:35], v[124:127]
s_add_u32 m0, m0, 4096
s_add_u32 s39, s39, 4096
v_rcp_f32 v219, v219
v_mfma_f32_16x16x32_bf16 v[128:131], a[172:175], a[36:39], v[128:131]
s_waitcnt lgkmcnt(4)
v_rcp_f32 v220, v220
v_mfma_f32_16x16x32_bf16 v[116:119], a[144:147], a[40:43], v[116:119]
ds_read_b128 a[168:171], v209 offset:8192
ds_read_b128 a[172:175], v209 offset:26624
v_rcp_f32 v221, v221
v_rcp_f32 v222, v222
v_rcp_f32 v223, v223
v_mfma_f32_16x16x32_bf16 v[120:123], a[144:147], a[44:47], v[120:123]
buffer_load_dwordx4 v1, s[4:7], s39 offen offset:0 sc1 lds
s_lshl_b32 s38, s24, 8
s_nop 0
v_pk_mul_f32 v[100:101], v[100:101], v[216:217]
v_pk_mul_f32 v[102:103], v[102:103], v[218:219]
v_pk_mul_f32 v[104:105], v[104:105], v[220:221]
v_pk_mul_f32 v[106:107], v[106:107], v[222:223]
v_pk_add_f32 v[198:199], v[36:37], v[38:39]
v_pk_mul_f32 v[200:201], v[36:37], v[36:37]
v_pk_fma_f32 v[200:201], v[38:39], v[38:39], v[200:201]
v_pk_add_f32 v[202:203], v[40:41], v[42:43]
v_pk_mul_f32 v[204:205], v[40:41], v[40:41]
v_pk_fma_f32 v[204:205], v[42:43], v[42:43], v[204:205]
v_pk_add_f32 v[198:199], v[198:199], v[44:45]
v_pk_fma_f32 v[200:201], v[44:45], v[44:45], v[200:201]
v_pk_add_f32 v[198:199], v[198:199], v[46:47]
v_pk_fma_f32 v[200:201], v[46:47], v[46:47], v[200:201]
v_pk_add_f32 v[202:203], v[202:203], v[48:49]
v_pk_fma_f32 v[204:205], v[48:49], v[48:49], v[204:205]
v_pk_add_f32 v[202:203], v[202:203], v[50:51]
v_pk_fma_f32 v[204:205], v[50:51], v[50:51], v[204:205]
v_pk_add_f32 v[198:199], v[198:199], v[52:53]
v_pk_fma_f32 v[200:201], v[52:53], v[52:53], v[200:201]
v_pk_add_f32 v[198:199], v[198:199], v[54:55]
v_pk_fma_f32 v[200:201], v[54:55], v[54:55], v[200:201]
v_pk_add_f32 v[202:203], v[202:203], v[56:57]
v_pk_fma_f32 v[204:205], v[56:57], v[56:57], v[204:205]
v_pk_add_f32 v[202:203], v[202:203], v[58:59]
v_pk_fma_f32 v[204:205], v[58:59], v[58:59], v[204:205]
v_pk_add_f32 v[198:199], v[198:199], v[60:61]
v_pk_fma_f32 v[200:201], v[60:61], v[60:61], v[200:201]
v_pk_add_f32 v[198:199], v[198:199], v[62:63]
v_pk_fma_f32 v[200:201], v[62:63], v[62:63], v[200:201]
v_pk_add_f32 v[202:203], v[202:203], v[64:65]
v_pk_fma_f32 v[204:205], v[64:65], v[64:65], v[204:205]
v_pk_add_f32 v[202:203], v[202:203], v[66:67]
v_pk_fma_f32 v[204:205], v[66:67], v[66:67], v[204:205]
v_pk_add_f32 v[198:199], v[198:199], v[68:69]
v_pk_fma_f32 v[200:201], v[68:69], v[68:69], v[200:201]
v_pk_add_f32 v[198:199], v[198:199], v[70:71]
v_pk_fma_f32 v[200:201], v[70:71], v[70:71], v[200:201]
v_pk_add_f32 v[202:203], v[202:203], v[72:73]
v_pk_fma_f32 v[204:205], v[72:73], v[72:73], v[204:205]
v_pk_add_f32 v[202:203], v[202:203], v[74:75]
v_pk_fma_f32 v[204:205], v[74:75], v[74:75], v[204:205]
v_pk_add_f32 v[198:199], v[198:199], v[76:77]
v_pk_fma_f32 v[200:201], v[76:77], v[76:77], v[200:201]
v_pk_add_f32 v[198:199], v[198:199], v[78:79]
v_pk_fma_f32 v[200:201], v[78:79], v[78:79], v[200:201]
v_pk_add_f32 v[202:203], v[202:203], v[80:81]
v_pk_fma_f32 v[204:205], v[80:81], v[80:81], v[204:205]
v_pk_add_f32 v[202:203], v[202:203], v[82:83]
v_pk_fma_f32 v[204:205], v[82:83], v[82:83], v[204:205]
v_pk_add_f32 v[198:199], v[198:199], v[84:85]
v_pk_fma_f32 v[200:201], v[84:85], v[84:85], v[200:201]
v_pk_add_f32 v[198:199], v[198:199], v[86:87]
v_pk_fma_f32 v[200:201], v[86:87], v[86:87], v[200:201]
v_pk_add_f32 v[202:203], v[202:203], v[88:89]
v_pk_fma_f32 v[204:205], v[88:89], v[88:89], v[204:205]
v_pk_add_f32 v[202:203], v[202:203], v[90:91]
v_pk_fma_f32 v[204:205], v[90:91], v[90:91], v[204:205]
v_pk_add_f32 v[198:199], v[198:199], v[92:93]
v_pk_fma_f32 v[200:201], v[92:93], v[92:93], v[200:201]
v_pk_add_f32 v[198:199], v[198:199], v[94:95]
v_pk_fma_f32 v[200:201], v[94:95], v[94:95], v[200:201]
v_pk_add_f32 v[202:203], v[202:203], v[96:97]
v_pk_fma_f32 v[204:205], v[96:97], v[96:97], v[204:205]
v_pk_add_f32 v[202:203], v[202:203], v[98:99]
v_pk_fma_f32 v[204:205], v[98:99], v[98:99], v[204:205]
v_pk_add_f32 v[198:199], v[198:199], v[100:101]
v_pk_fma_f32 v[200:201], v[100:101], v[100:101], v[200:201]
v_pk_add_f32 v[198:199], v[198:199], v[102:103]
v_pk_fma_f32 v[200:201], v[102:103], v[102:103], v[200:201]
v_pk_add_f32 v[202:203], v[202:203], v[104:105]
v_pk_fma_f32 v[204:205], v[104:105], v[104:105], v[204:205]
v_pk_add_f32 v[202:203], v[202:203], v[106:107]
v_pk_fma_f32 v[204:205], v[106:107], v[106:107], v[204:205]
v_mfma_f32_16x16x32_bf16 v[124:127], a[148:151], a[40:43], v[124:127]
s_add_u32 m0, s38, 160768
v_add_f32 v198, v198, v199
v_add_f32 v202, v202, v203
v_mfma_f32_16x16x32_bf16 v[128:131], a[148:151], a[44:47], v[128:131]
s_waitcnt lgkmcnt(4)
s_add_u32 s39, s38, s82
v_add_f32 v200, v200, v201
v_add_f32 v204, v204, v205
v_permlane16_swap_b32 v198, v202
v_mfma_f32_16x16x32_bf16 v[116:119], a[152:155], a[48:51], v[116:119]
ds_read_b128 a[144:147], v209 offset:9216
ds_read_b128 a[148:151], v209 offset:27648
s_nop 0
v_mfma_f32_16x16x32_bf16 v[120:123], a[152:155], a[52:55], v[120:123]
s_add_u32 s39, s39, 339968
v_permlane16_swap_b32 v200, v204
v_mfma_f32_16x16x32_bf16 v[124:127], a[156:159], a[48:51], v[124:127]
s_mov_b64 exec, 0xffff
buffer_load_dwordx4 v1, s[4:7], s39 offen sc1 lds
s_mov_b64 exec, -1
v_add_f32 v198, v198, v202
v_add_f32 v199, v200, v204
v_mov_b32 v200, v198
v_mfma_f32_16x16x32_bf16 v[128:131], a[156:159], a[52:55], v[128:131]
s_waitcnt lgkmcnt(4)
v_mov_b32 v201, v199
s_nop 0
v_mfma_f32_16x16x32_bf16 v[116:119], a[160:163], a[56:59], v[116:119]
ds_read_b128 a[152:155], v209 offset:10240
ds_read_b128 a[156:159], v209 offset:28672
v_permlane32_swap_b32 v198, v200
v_permlane32_swap_b32 v199, v201
v_mfma_f32_16x16x32_bf16 v[120:123], a[160:163], a[60:63], v[120:123]
v_add_f32 v198, v198, v200
v_add_f32 v199, v199, v201
v_mfma_f32_16x16x32_bf16 v[124:127], a[164:167], a[56:59], v[124:127]
s_mov_b32 exec_hi, 0
buffer_store_dwordx2 v[198:199], v239, s[8:11], s30 offen sc1
s_mov_b64 exec, -1
v_mfma_f32_16x16x32_bf16 v[128:131], a[164:167], a[60:63], v[128:131]
s_waitcnt lgkmcnt(4)
v_mfma_f32_16x16x32_bf16 v[116:119], a[168:171], a[64:67], v[116:119]
ds_read_b128 a[160:163], v209 offset:11264
ds_read_b128 a[164:167], v209 offset:29696
v_mfma_f32_16x16x32_bf16 v[120:123], a[168:171], a[68:71], v[120:123]
v_mfma_f32_16x16x32_bf16 v[124:127], a[172:175], a[64:67], v[124:127]
v_mfma_f32_16x16x32_bf16 v[128:131], a[172:175], a[68:71], v[128:131]
s_waitcnt lgkmcnt(4)
v_mfma_f32_16x16x32_bf16 v[116:119], a[144:147], a[72:75], v[116:119]
ds_read_b128 a[168:171], v209 offset:12288
ds_read_b128 a[172:175], v209 offset:30720
v_mfma_f32_16x16x32_bf16 v[120:123], a[144:147], a[76:79], v[120:123]
v_mfma_f32_16x16x32_bf16 v[124:127], a[148:151], a[72:75], v[124:127]
v_mfma_f32_16x16x32_bf16 v[128:131], a[148:151], a[76:79], v[128:131]
s_waitcnt lgkmcnt(4)
v_mfma_f32_16x16x32_bf16 v[116:119], a[152:155], a[80:83], v[116:119]
ds_read_b128 a[144:147], v209 offset:13312
ds_read_b128 a[148:151], v209 offset:31744
v_mfma_f32_16x16x32_bf16 v[120:123], a[152:155], a[84:87], v[120:123]
v_mfma_f32_16x16x32_bf16 v[124:127], a[156:159], a[80:83], v[124:127]
v_mfma_f32_16x16x32_bf16 v[128:131], a[156:159], a[84:87], v[128:131]
s_waitcnt lgkmcnt(4)
v_mfma_f32_16x16x32_bf16 v[116:119], a[160:163], a[88:91], v[116:119]
ds_read_b128 a[152:155], v209 offset:14336
ds_read_b128 a[156:159], v209 offset:32768
v_mfma_f32_16x16x32_bf16 v[120:123], a[160:163], a[92:95], v[120:123]
v_mfma_f32_16x16x32_bf16 v[124:127], a[164:167], a[88:91], v[124:127]
v_mfma_f32_16x16x32_bf16 v[128:131], a[164:167], a[92:95], v[128:131]
s_waitcnt lgkmcnt(4)
v_mfma_f32_16x16x32_bf16 v[116:119], a[168:171], a[96:99], v[116:119]
ds_read_b128 a[160:163], v209 offset:15360
ds_read_b128 a[164:167], v209 offset:33792
v_mfma_f32_16x16x32_bf16 v[120:123], a[168:171], a[100:103], v[120:123]
v_mfma_f32_16x16x32_bf16 v[124:127], a[172:175], a[96:99], v[124:127]
v_mfma_f32_16x16x32_bf16 v[128:131], a[172:175], a[100:103], v[128:131]
s_waitcnt lgkmcnt(4)
v_mfma_f32_16x16x32_bf16 v[116:119], a[144:147], a[104:107], v[116:119]
ds_read_b128 a[168:171], v209 offset:16384
ds_read_b128 a[172:175], v209 offset:34816
v_mfma_f32_16x16x32_bf16 v[120:123], a[144:147], a[108:111], v[120:123]
v_mfma_f32_16x16x32_bf16 v[124:127], a[148:151], a[104:107], v[124:127]
v_mfma_f32_16x16x32_bf16 v[128:131], a[148:151], a[108:111], v[128:131]
s_waitcnt lgkmcnt(4)
v_mfma_f32_16x16x32_bf16 v[116:119], a[152:155], a[112:115], v[116:119]
ds_read_b128 a[144:147], v209 offset:17408
ds_read_b128 a[148:151], v209 offset:35840
v_mfma_f32_16x16x32_bf16 v[120:123], a[152:155], a[116:119], v[120:123]
v_mfma_f32_16x16x32_bf16 v[124:127], a[156:159], a[112:115], v[124:127]
v_mfma_f32_16x16x32_bf16 v[128:131], a[156:159], a[116:119], v[128:131]
s_waitcnt lgkmcnt(4)
v_add_u32 v181, 36864, v239
v_mfma_f32_16x16x32_bf16 v[116:119], a[160:163], a[120:123], v[116:119]
ds_read_b64 a[152:153], v181 offset:0
ds_read_b64 a[156:157], v181 offset:512
v_mfma_f32_16x16x32_bf16 v[120:123], a[160:163], a[124:127], v[120:123]
v_mfma_f32_16x16x32_bf16 v[124:127], a[164:167], a[120:123], v[124:127]
v_mfma_f32_16x16x32_bf16 v[128:131], a[164:167], a[124:127], v[128:131]
s_waitcnt lgkmcnt(4)
v_mfma_f32_16x16x32_bf16 v[116:119], a[168:171], a[128:131], v[116:119]
ds_read_b128 a[160:163], v210 offset:0
ds_read_b128 a[164:167], v210 offset:18432
v_mfma_f32_16x16x32_bf16 v[120:123], a[168:171], a[132:135], v[120:123]
buffer_load_dwordx2 v[182:183], v234, s[8:11], s61 offen offset:0 sc1
v_mfma_f32_16x16x32_bf16 v[124:127], a[172:175], a[128:131], v[124:127]
buffer_load_dwordx2 v[184:185], v234, s[8:11], s61 offen offset:1024 sc1
v_mfma_f32_16x16x32_bf16 v[128:131], a[172:175], a[132:135], v[128:131]
s_waitcnt lgkmcnt(4)
v_mfma_f32_16x16x32_bf16 v[116:119], a[144:147], a[136:139], v[116:119]
ds_read_b128 a[168:171], v210 offset:1024
ds_read_b128 a[172:175], v210 offset:19456
v_mfma_f32_16x16x32_bf16 v[120:123], a[144:147], a[140:143], v[120:123]
buffer_load_dwordx2 v[186:187], v234, s[8:11], s61 offen offset:2048 sc1
v_mfma_f32_16x16x32_bf16 v[124:127], a[148:151], a[136:139], v[124:127]
buffer_load_dwordx2 v[188:189], v234, s[8:11], s61 offen offset:3072 sc1
v_mfma_f32_16x16x32_bf16 v[128:131], a[148:151], a[140:143], v[128:131]
s_waitcnt lgkmcnt(4)
v_mfma_f32_16x16x16_bf16 v[116:119], a[152:153], v[212:213], v[116:119]
ds_read_b128 a[144:147], v210 offset:2048
ds_read_b128 a[148:151], v210 offset:20480
v_mfma_f32_16x16x16_bf16 v[120:123], a[152:153], v[214:215], v[120:123]
buffer_load_dwordx2 v[190:191], v235, s[8:11], s61 offen offset:0 sc1
v_mfma_f32_16x16x16_bf16 v[124:127], a[156:157], v[212:213], v[124:127]
buffer_load_dwordx2 v[192:193], v235, s[8:11], s61 offen offset:1024 sc1
v_mfma_f32_16x16x16_bf16 v[128:131], a[156:157], v[214:215], v[128:131]
s_waitcnt vmcnt(18) lgkmcnt(4)
s_barrier
v_mfma_f32_16x16x32_bf16 v[132:135], a[160:163], a[0:3], 0
ds_read_b128 a[152:155], v210 offset:3072
ds_read_b128 a[156:159], v210 offset:21504
v_mfma_f32_16x16x32_bf16 v[136:139], a[160:163], a[4:7], 0
buffer_load_dwordx2 v[194:195], v235, s[8:11], s61 offen offset:2048 sc1
v_mfma_f32_16x16x32_bf16 v[140:143], a[164:167], a[0:3], 0
buffer_load_dwordx2 v[196:197], v235, s[8:11], s61 offen offset:3072 sc1
v_mfma_f32_16x16x32_bf16 v[144:147], a[164:167], a[4:7], 0
s_waitcnt lgkmcnt(4)
v_mfma_f32_16x16x32_bf16 v[132:135], a[168:171], a[8:11], v[132:135]
ds_read_b128 a[160:163], v210 offset:4096
ds_read_b128 a[164:167], v210 offset:22528
v_mfma_f32_16x16x32_bf16 v[136:139], a[168:171], a[12:15], v[136:139]
v_mfma_f32_16x16x32_bf16 v[140:143], a[172:175], a[8:11], v[140:143]
v_mfma_f32_16x16x32_bf16 v[144:147], a[172:175], a[12:15], v[144:147]
s_waitcnt lgkmcnt(4)
v_mfma_f32_16x16x32_bf16 v[132:135], a[144:147], a[16:19], v[132:135]
ds_read_b128 a[168:171], v210 offset:5120
ds_read_b128 a[172:175], v210 offset:23552
v_mfma_f32_16x16x32_bf16 v[136:139], a[144:147], a[20:23], v[136:139]
v_mfma_f32_16x16x32_bf16 v[140:143], a[148:151], a[16:19], v[140:143]
v_mfma_f32_16x16x32_bf16 v[144:147], a[148:151], a[20:23], v[144:147]
s_waitcnt lgkmcnt(4)
v_mfma_f32_16x16x32_bf16 v[132:135], a[152:155], a[24:27], v[132:135]
ds_read_b128 a[144:147], v210 offset:6144
ds_read_b128 a[148:151], v210 offset:24576
v_mfma_f32_16x16x32_bf16 v[136:139], a[152:155], a[28:31], v[136:139]
v_mfma_f32_16x16x32_bf16 v[140:143], a[156:159], a[24:27], v[140:143]
v_mfma_f32_16x16x32_bf16 v[144:147], a[156:159], a[28:31], v[144:147]
s_waitcnt lgkmcnt(4)
v_mfma_f32_16x16x32_bf16 v[132:135], a[160:163], a[32:35], v[132:135]
ds_read_b128 a[152:155], v210 offset:7168
ds_read_b128 a[156:159], v210 offset:25600
v_mfma_f32_16x16x32_bf16 v[136:139], a[160:163], a[36:39], v[136:139]
v_mfma_f32_16x16x32_bf16 v[140:143], a[164:167], a[32:35], v[140:143]
v_mfma_f32_16x16x32_bf16 v[144:147], a[164:167], a[36:39], v[144:147]
s_waitcnt lgkmcnt(4)
v_mfma_f32_16x16x32_bf16 v[132:135], a[168:171], a[40:43], v[132:135]
ds_read_b128 a[160:163], v210 offset:8192
ds_read_b128 a[164:167], v210 offset:26624
v_mfma_f32_16x16x32_bf16 v[136:139], a[168:171], a[44:47], v[136:139]
v_mfma_f32_16x16x32_bf16 v[140:143], a[172:175], a[40:43], v[140:143]
v_mfma_f32_16x16x32_bf16 v[144:147], a[172:175], a[44:47], v[144:147]
s_waitcnt lgkmcnt(4)
v_mfma_f32_16x16x32_bf16 v[132:135], a[144:147], a[48:51], v[132:135]
ds_read_b128 a[168:171], v210 offset:9216
ds_read_b128 a[172:175], v210 offset:27648
v_mfma_f32_16x16x32_bf16 v[136:139], a[144:147], a[52:55], v[136:139]
v_mfma_f32_16x16x32_bf16 v[140:143], a[148:151], a[48:51], v[140:143]
v_mfma_f32_16x16x32_bf16 v[144:147], a[148:151], a[52:55], v[144:147]
s_waitcnt lgkmcnt(4)
v_mfma_f32_16x16x32_bf16 v[132:135], a[152:155], a[56:59], v[132:135]
ds_read_b128 a[144:147], v210 offset:10240
ds_read_b128 a[148:151], v210 offset:28672
v_mfma_f32_16x16x32_bf16 v[136:139], a[152:155], a[60:63], v[136:139]
v_mfma_f32_16x16x32_bf16 v[140:143], a[156:159], a[56:59], v[140:143]
v_mfma_f32_16x16x32_bf16 v[144:147], a[156:159], a[60:63], v[144:147]
s_waitcnt lgkmcnt(4)
v_mfma_f32_16x16x32_bf16 v[132:135], a[160:163], a[64:67], v[132:135]
ds_read_b128 a[152:155], v210 offset:11264
ds_read_b128 a[156:159], v210 offset:29696
v_mfma_f32_16x16x32_bf16 v[136:139], a[160:163], a[68:71], v[136:139]
v_mfma_f32_16x16x32_bf16 v[140:143], a[164:167], a[64:67], v[140:143]
v_mfma_f32_16x16x32_bf16 v[144:147], a[164:167], a[68:71], v[144:147]
s_waitcnt lgkmcnt(4)
v_mfma_f32_16x16x32_bf16 v[132:135], a[168:171], a[72:75], v[132:135]
ds_read_b128 a[160:163], v210 offset:12288
ds_read_b128 a[164:167], v210 offset:30720
v_mfma_f32_16x16x32_bf16 v[136:139], a[168:171], a[76:79], v[136:139]
v_mfma_f32_16x16x32_bf16 v[140:143], a[172:175], a[72:75], v[140:143]
s_waitcnt vmcnt(0)
v_min3_f32 v200, v183, v185, v187
v_mfma_f32_16x16x32_bf16 v[144:147], a[172:175], a[76:79], v[144:147]
s_waitcnt lgkmcnt(4)
v_min3_f32 v201, v189, v191, v193
v_min3_f32 v200, v200, v195, v197
v_mfma_f32_16x16x32_bf16 v[132:135], a[144:147], a[80:83], v[132:135]
ds_read_b128 a[168:171], v210 offset:13312
ds_read_b128 a[172:175], v210 offset:31744
v_mfma_f32_16x16x32_bf16 v[136:139], a[144:147], a[84:87], v[136:139]
v_min_f32 v200, v200, v201
v_cmp_gt_f32 vcc, 0, v200
v_mfma_f32_16x16x32_bf16 v[140:143], a[148:151], a[80:83], v[140:143]
s_nop 0
s_cbranch_vccnz L_stzslow_23
L_stzback_24:
v_mfma_f32_16x16x32_bf16 v[144:147], a[148:151], a[84:87], v[144:147]
s_waitcnt lgkmcnt(4)
v_add_f32 v198, v182, v184
v_add_f32 v199, v183, v185
v_mfma_f32_16x16x32_bf16 v[132:135], a[152:155], a[88:91], v[132:135]
ds_read_b128 a[144:147], v210 offset:14336
ds_read_b128 a[148:151], v210 offset:32768
v_mfma_f32_16x16x32_bf16 v[136:139], a[152:155], a[92:95], v[136:139]
v_add_f32 v198, v198, v186
v_add_f32 v199, v199, v187
v_mfma_f32_16x16x32_bf16 v[140:143], a[156:159], a[88:91], v[140:143]
v_add_f32 v198, v198, v188
v_add_f32 v199, v199, v189
v_mfma_f32_16x16x32_bf16 v[144:147], a[156:159], a[92:95], v[144:147]
s_waitcnt lgkmcnt(4)
v_add_f32 v198, v198, v190
v_add_f32 v199, v199, v191
v_mfma_f32_16x16x32_bf16 v[132:135], a[160:163], a[96:99], v[132:135]
ds_read_b128 a[152:155], v210 offset:15360
ds_read_b128 a[156:159], v210 offset:33792
v_add_f32 v198, v198, v192
v_mfma_f32_16x16x32_bf16 v[136:139], a[160:163], a[100:103], v[136:139]
v_add_f32 v199, v199, v193
v_add_f32 v198, v198, v194
v_mfma_f32_16x16x32_bf16 v[140:143], a[164:167], a[96:99], v[140:143]
v_add_f32 v199, v199, v195
v_add_f32 v198, v198, v196
v_mfma_f32_16x16x32_bf16 v[144:147], a[164:167], a[100:103], v[144:147]
s_waitcnt lgkmcnt(4)
v_add_f32 v199, v199, v197
v_mov_b32 v200, v198
v_mfma_f32_16x16x32_bf16 v[132:135], a[168:171], a[104:107], v[132:135]
ds_read_b128 a[160:163], v210 offset:16384
ds_read_b128 a[164:167], v210 offset:34816
v_mov_b32 v201, v199
v_mfma_f32_16x16x32_bf16 v[136:139], a[168:171], a[108:111], v[136:139]
s_nop 0
v_permlane32_swap_b32 v198, v200
v_mfma_f32_16x16x32_bf16 v[140:143], a[172:175], a[104:107], v[140:143]
v_permlane32_swap_b32 v199, v201
v_mfma_f32_16x16x32_bf16 v[144:147], a[172:175], a[108:111], v[144:147]
s_waitcnt lgkmcnt(4)
v_add_f32 v198, v198, v200
v_add_f32 v199, v199, v201
v_mfma_f32_16x16x32_bf16 v[132:135], a[144:147], a[112:115], v[132:135]
ds_read_b128 a[168:171], v210 offset:17408
ds_read_b128 a[172:175], v210 offset:35840
v_mfma_f32_16x16x32_bf16 v[136:139], a[144:147], a[116:119], v[136:139]
v_mul_f32 v198, 0x39e38e39, v198
v_mul_f32 v200, v198, v198
v_mfma_f32_16x16x32_bf16 v[140:143], a[148:151], a[112:115], v[140:143]
v_mul_f32 v199, 0x39e38e39, v199
v_sub_f32 v199, v199, v200
v_mfma_f32_16x16x32_bf16 v[144:147], a[148:151], a[116:119], v[144:147]
s_waitcnt lgkmcnt(4)
v_max_f32 v199, 0, v199
v_add_u32 v181, 74752, v239
v_mfma_f32_16x16x32_bf16 v[132:135], a[152:155], a[120:123], v[132:135]
ds_read_b64 a[144:145], v181 offset:0
ds_read_b64 a[148:149], v181 offset:512
v_add_f32 v199, 0x3727c5ac, v199
v_rsq_f32 v202, v199
v_mfma_f32_16x16x32_bf16 v[136:139], a[152:155], a[124:127], v[136:139]
s_nop 0
v_mul_f32 v204, v198, v202
v_mov_b32 v203, v202
v_mfma_f32_16x16x32_bf16 v[140:143], a[156:159], a[120:123], v[140:143]
v_mov_b32 v205, v204
v_mfma_f32_16x16x32_bf16 v[144:147], a[156:159], a[124:127], v[144:147]
s_waitcnt lgkmcnt(4)
s_nop 0
v_mfma_f32_16x16x32_bf16 v[132:135], a[160:163], a[128:131], v[132:135]
ds_read_b128 a[152:155], v211 offset:0
ds_read_b128 a[156:159], v211 offset:18432
v_permlane16_swap_b32 v202, v203
v_mfma_f32_16x16x32_bf16 v[136:139], a[160:163], a[132:135], v[136:139]
v_permlane16_swap_b32 v204, v205
v_mfma_f32_16x16x32_bf16 v[140:143], a[164:167], a[128:131], v[140:143]
v_fma_f32 v36, v36, v202, -v204
v_fma_f32 v37, v37, v202, -v204
v_mfma_f32_16x16x32_bf16 v[144:147], a[164:167], a[132:135], v[144:147]
s_waitcnt lgkmcnt(4)
v_fma_f32 v38, v38, v202, -v204
v_fma_f32 v39, v39, v202, -v204
v_mfma_f32_16x16x32_bf16 v[132:135], a[168:171], a[136:139], v[132:135]
ds_read_b128 a[160:163], v211 offset:1024
ds_read_b128 a[164:167], v211 offset:19456
v_mfma_f32_16x16x32_bf16 v[136:139], a[168:171], a[140:143], v[136:139]
v_fma_f32 v44, v44, v202, -v204
v_fma_f32 v45, v45, v202, -v204
v_mfma_f32_16x16x32_bf16 v[140:143], a[172:175], a[136:139], v[140:143]
v_fma_f32 v46, v46, v202, -v204
v_fma_f32 v47, v47, v202, -v204
v_mfma_f32_16x16x32_bf16 v[144:147], a[172:175], a[140:143], v[144:147]
s_waitcnt lgkmcnt(4)
v_cvt_pk_bf16_f32 v216, v36, v37
v_cvt_pk_bf16_f32 v217, v38, v39
v_mfma_f32_16x16x16_bf16 v[132:135], a[144:145], v[212:213], v[132:135]
ds_read_b128 a[168:171], v211 offset:2048
ds_read_b128 a[172:175], v211 offset:20480
v_cvt_pk_bf16_f32 v218, v44, v45
v_mfma_f32_16x16x16_bf16 v[136:139], a[144:145], v[214:215], v[136:139]
v_cvt_pk_bf16_f32 v219, v46, v47
v_mfma_f32_16x16x16_bf16 v[140:143], a[148:149], v[212:213], v[140:143]
ds_write_b128 v236, v[216:219] offset:0
v_fma_f32 v40, v40, v203, -v205
v_mfma_f32_16x16x16_bf16 v[144:147], a[148:149], v[214:215], v[144:147]
s_waitcnt lgkmcnt(5)
v_fma_f32 v41, v41, v203, -v205
v_fma_f32 v42, v42, v203, -v205
s_barrier
v_mfma_f32_16x16x32_bf16 v[148:151], a[152:155], a[0:3], 0
ds_read_b128 a[144:147], v211 offset:3072
ds_read_b128 a[148:151], v211 offset:21504
v_fma_f32 v43, v43, v203, -v205
v_fma_f32 v48, v48, v203, -v205
v_mfma_f32_16x16x32_bf16 v[152:155], a[152:155], a[4:7], 0
v_fma_f32 v49, v49, v203, -v205
v_fma_f32 v50, v50, v203, -v205
v_mfma_f32_16x16x32_bf16 v[156:159], a[156:159], a[0:3], 0
v_fma_f32 v51, v51, v203, -v205
v_cvt_pk_bf16_f32 v220, v40, v41
v_mfma_f32_16x16x32_bf16 v[160:163], a[156:159], a[4:7], 0
s_waitcnt lgkmcnt(5)
v_cvt_pk_bf16_f32 v221, v42, v43
v_cvt_pk_bf16_f32 v222, v48, v49
v_mfma_f32_16x16x32_bf16 v[148:151], a[160:163], a[8:11], v[148:151]
ds_read_b128 a[152:155], v211 offset:4096
ds_read_b128 a[156:159], v211 offset:22528
v_cvt_pk_bf16_f32 v223, v50, v51
v_mfma_f32_16x16x32_bf16 v[152:155], a[160:163], a[12:15], v[152:155]
ds_write_b128 v236, v[220:223] offset:4608
v_mfma_f32_16x16x32_bf16 v[156:159], a[164:167], a[8:11], v[156:159]
ds_read_b64_tr_b16 v[36:37], v237 offset:0
ds_read_b64_tr_b16 v[38:39], v237 offset:1152
ds_read_b64_tr_b16 v[40:41], v237 offset:8
ds_read_b64_tr_b16 v[42:43], v237 offset:1160
v_mfma_f32_16x16x32_bf16 v[160:163], a[164:167], a[12:15], v[160:163]
s_waitcnt lgkmcnt(10)
v_fma_f32 v52, v52, v202, -v204
v_fma_f32 v53, v53, v202, -v204
v_mfma_f32_16x16x32_bf16 v[148:151], a[168:171], a[16:19], v[148:151]
ds_read_b128 a[160:163], v211 offset:5120
ds_read_b128 a[164:167], v211 offset:23552
v_mfma_f32_16x16x32_bf16 v[152:155], a[168:171], a[20:23], v[152:155]
v_fma_f32 v54, v54, v202, -v204
v_fma_f32 v55, v55, v202, -v204
v_mfma_f32_16x16x32_bf16 v[156:159], a[172:175], a[16:19], v[156:159]
v_fma_f32 v60, v60, v202, -v204
v_mfma_f32_16x16x32_bf16 v[160:163], a[172:175], a[20:23], v[160:163]
s_waitcnt lgkmcnt(9)
v_fma_f32 v61, v61, v202, -v204
v_mfma_f32_16x16x32_bf16 v[148:151], a[144:147], a[24:27], v[148:151]
ds_read_b128 a[168:171], v211 offset:6144
ds_read_b128 a[172:175], v211 offset:24576
v_mfma_f32_16x16x32_bf16 v[152:155], a[144:147], a[28:31], v[152:155]
v_fma_f32 v62, v62, v202, -v204
v_fma_f32 v63, v63, v202, -v204
v_mfma_f32_16x16x32_bf16 v[156:159], a[148:151], a[24:27], v[156:159]
v_cvt_pk_bf16_f32 v224, v52, v53
v_cvt_pk_bf16_f32 v225, v54, v55
v_mfma_f32_16x16x32_bf16 v[160:163], a[148:151], a[28:31], v[160:163]
s_waitcnt lgkmcnt(9)
v_cvt_pk_bf16_f32 v226, v60, v61
v_mfma_f32_16x16x32_bf16 v[148:151], a[152:155], a[32:35], v[148:151]
ds_read_b128 a[144:147], v211 offset:7168
ds_read_b128 a[148:151], v211 offset:25600
v_mfma_f32_16x16x32_bf16 v[152:155], a[152:155], a[36:39], v[152:155]
v_cvt_pk_bf16_f32 v227, v62, v63
v_mfma_f32_16x16x32_bf16 v[156:159], a[156:159], a[32:35], v[156:159]
ds_write_b128 v236, v[224:227] offset:64
v_mfma_f32_16x16x32_bf16 v[160:163], a[156:159], a[36:39], v[160:163]
s_waitcnt lgkmcnt(5)
buffer_store_dwordx4 v[36:39], v1, s[8:11], s66 offen offset:0 sc1
v_mfma_f32_16x16x32_bf16 v[148:151], a[160:163], a[40:43], v[148:151]
ds_read_b128 a[152:155], v211 offset:8192
ds_read_b128 a[156:159], v211 offset:26624
v_mfma_f32_16x16x32_bf16 v[152:155], a[160:163], a[44:47], v[152:155]
v_fma_f32 v56, v56, v203, -v205
v_fma_f32 v57, v57, v203, -v205
v_mfma_f32_16x16x32_bf16 v[156:159], a[164:167], a[40:43], v[156:159]
v_fma_f32 v58, v58, v203, -v205
v_fma_f32 v59, v59, v203, -v205
v_mfma_f32_16x16x32_bf16 v[160:163], a[164:167], a[44:47], v[160:163]
s_waitcnt lgkmcnt(5)
v_fma_f32 v64, v64, v203, -v205
v_fma_f32 v65, v65, v203, -v205
v_mfma_f32_16x16x32_bf16 v[148:151], a[168:171], a[48:51], v[148:151]
ds_read_b128 a[160:163], v211 offset:9216
ds_read_b128 a[164:167], v211 offset:27648
v_mfma_f32_16x16x32_bf16 v[152:155], a[168:171], a[52:55], v[152:155]
v_fma_f32 v66, v66, v203, -v205
v_fma_f32 v67, v67, v203, -v205
v_mfma_f32_16x16x32_bf16 v[156:159], a[172:175], a[48:51], v[156:159]
v_cvt_pk_bf16_f32 v228, v56, v57
v_cvt_pk_bf16_f32 v229, v58, v59
v_mfma_f32_16x16x32_bf16 v[160:163], a[172:175], a[52:55], v[160:163]
s_waitcnt lgkmcnt(5)
v_cvt_pk_bf16_f32 v230, v64, v65
v_cvt_pk_bf16_f32 v231, v66, v67
v_mfma_f32_16x16x32_bf16 v[148:151], a[144:147], a[56:59], v[148:151]
ds_read_b128 a[168:171], v211 offset:10240
ds_read_b128 a[172:175], v211 offset:28672
v_mfma_f32_16x16x32_bf16 v[152:155], a[144:147], a[60:63], v[152:155]
ds_write_b128 v236, v[228:231] offset:4672
v_mfma_f32_16x16x32_bf16 v[156:159], a[148:151], a[56:59], v[156:159]
ds_read_b64_tr_b16 v[52:53], v237 offset:64
ds_read_b64_tr_b16 v[54:55], v237 offset:1216
v_mfma_f32_16x16x32_bf16 v[160:163], a[148:151], a[60:63], v[160:163]
s_waitcnt lgkmcnt(7)
v_mfma_f32_16x16x32_bf16 v[148:151], a[152:155], a[64:67], v[148:151]
ds_read_b128 a[144:147], v211 offset:11264
ds_read_b128 a[148:151], v211 offset:29696
ds_read_b64_tr_b16 v[56:57], v237 offset:72
ds_read_b64_tr_b16 v[58:59], v237 offset:1224
buffer_store_dwordx4 v[40:43], v1, s[8:11], s66 offen offset:1024 sc1
v_mfma_f32_16x16x32_bf16 v[152:155], a[152:155], a[68:71], v[152:155]
v_fma_f32 v68, v68, v202, -v204
v_fma_f32 v69, v69, v202, -v204
v_mfma_f32_16x16x32_bf16 v[156:159], a[156:159], a[64:67], v[156:159]
v_fma_f32 v70, v70, v202, -v204
v_mfma_f32_16x16x32_bf16 v[160:163], a[156:159], a[68:71], v[160:163]
s_waitcnt lgkmcnt(9)
v_fma_f32 v71, v71, v202, -v204
v_mfma_f32_16x16x32_bf16 v[148:151], a[160:163], a[72:75], v[148:151]
ds_read_b128 a[152:155], v211 offset:12288
ds_read_b128 a[156:159], v211 offset:30720
v_mfma_f32_16x16x32_bf16 v[152:155], a[160:163], a[76:79], v[152:155]
v_fma_f32 v76, v76, v202, -v204
v_fma_f32 v77, v77, v202, -v204
v_mfma_f32_16x16x32_bf16 v[156:159], a[164:167], a[72:75], v[156:159]
v_fma_f32 v78, v78, v202, -v204
v_mfma_f32_16x16x32_bf16 v[160:163], a[164:167], a[76:79], v[160:163]
s_waitcnt lgkmcnt(9)
v_fma_f32 v79, v79, v202, -v204
v_cvt_pk_bf16_f32 v216, v68, v69
v_mfma_f32_16x16x32_bf16 v[148:151], a[168:171], a[80:83], v[148:151]
ds_read_b128 a[160:163], v211 offset:13312
ds_read_b128 a[164:167], v211 offset:31744
v_mfma_f32_16x16x32_bf16 v[152:155], a[168:171], a[84:87], v[152:155]
v_cvt_pk_bf16_f32 v217, v70, v71
v_cvt_pk_bf16_f32 v218, v76, v77
v_mfma_f32_16x16x32_bf16 v[156:159], a[172:175], a[80:83], v[156:159]
v_cvt_pk_bf16_f32 v219, v78, v79
v_mfma_f32_16x16x32_bf16 v[160:163], a[172:175], a[84:87], v[160:163]
s_waitcnt lgkmcnt(6)
v_mfma_f32_16x16x32_bf16 v[148:151], a[144:147], a[88:91], v[148:151]
ds_read_b128 a[168:171], v211 offset:14336
ds_read_b128 a[172:175], v211 offset:32768
v_mfma_f32_16x16x32_bf16 v[152:155], a[144:147], a[92:95], v[152:155]
ds_write_b128 v236, v[216:219] offset:128
buffer_store_dwordx4 v[52:55], v1, s[8:11], s66 offen offset:2048 sc1
v_mfma_f32_16x16x32_bf16 v[156:159], a[148:151], a[88:91], v[156:159]
v_fma_f32 v72, v72, v203, -v205
v_fma_f32 v73, v73, v203, -v205
v_mfma_f32_16x16x32_bf16 v[160:163], a[148:151], a[92:95], v[160:163]
s_waitcnt lgkmcnt(5)
v_fma_f32 v74, v74, v203, -v205
v_mfma_f32_16x16x32_bf16 v[148:151], a[152:155], a[96:99], v[148:151]
ds_read_b128 a[144:147], v211 offset:15360
ds_read_b128 a[148:151], v211 offset:33792
v_mfma_f32_16x16x32_bf16 v[152:155], a[152:155], a[100:103], v[152:155]
v_fma_f32 v75, v75, v203, -v205
v_fma_f32 v80, v80, v203, -v205
v_mfma_f32_16x16x32_bf16 v[156:159], a[156:159], a[96:99], v[156:159]
v_fma_f32 v81, v81, v203, -v205
v_fma_f32 v82, v82, v203, -v205
v_mfma_f32_16x16x32_bf16 v[160:163], a[156:159], a[100:103], v[160:163]
s_waitcnt lgkmcnt(5)
v_fma_f32 v83, v83, v203, -v205
v_cvt_pk_bf16_f32 v220, v72, v73
v_mfma_f32_16x16x32_bf16 v[148:151], a[160:163], a[104:107], v[148:151]
ds_read_b128 a[152:155], v211 offset:16384
ds_read_b128 a[156:159], v211 offset:34816
v_mfma_f32_16x16x32_bf16 v[152:155], a[160:163], a[108:111], v[152:155]
v_cvt_pk_bf16_f32 v221, v74, v75
v_cvt_pk_bf16_f32 v222, v80, v81
v_mfma_f32_16x16x32_bf16 v[156:159], a[164:167], a[104:107], v[156:159]
v_cvt_pk_bf16_f32 v223, v82, v83
v_mfma_f32_16x16x32_bf16 v[160:163], a[164:167], a[108:111], v[160:163]
s_waitcnt lgkmcnt(5)
v_mfma_f32_16x16x32_bf16 v[148:151], a[168:171], a[112:115], v[148:151]
ds_read_b128 a[160:163], v211 offset:17408
ds_read_b128 a[164:167], v211 offset:35840
v_mfma_f32_16x16x32_bf16 v[152:155], a[168:171], a[116:119], v[152:155]
ds_write_b128 v236, v[220:223] offset:4736
v_mfma_f32_16x16x32_bf16 v[156:159], a[172:175], a[112:115], v[156:159]
ds_read_b64_tr_b16 v[68:69], v237 offset:128
ds_read_b64_tr_b16 v[70:71], v237 offset:1280
ds_read_b64_tr_b16 v[72:73], v237 offset:136
ds_read_b64_tr_b16 v[74:75], v237 offset:1288
buffer_store_dwordx4 v[56:59], v1, s[8:11], s66 offen offset:3072 sc1
v_mfma_f32_16x16x32_bf16 v[160:163], a[172:175], a[116:119], v[160:163]
s_waitcnt lgkmcnt(9)
v_fma_f32 v84, v84, v202, -v204
v_add_u32 v181, 112640, v239
v_mfma_f32_16x16x32_bf16 v[148:151], a[144:147], a[120:123], v[148:151]
ds_read_b64 a[168:169], v181 offset:0
ds_read_b64 a[172:173], v181 offset:512
v_mfma_f32_16x16x32_bf16 v[152:155], a[144:147], a[124:127], v[152:155]
v_fma_f32 v85, v85, v202, -v204
v_fma_f32 v86, v86, v202, -v204
v_mfma_f32_16x16x32_bf16 v[156:159], a[148:151], a[120:123], v[156:159]
v_fma_f32 v87, v87, v202, -v204
v_fma_f32 v92, v92, v202, -v204
v_mfma_f32_16x16x32_bf16 v[160:163], a[148:151], a[124:127], v[160:163]
s_waitcnt lgkmcnt(9)
v_fma_f32 v93, v93, v202, -v204
v_fma_f32 v94, v94, v202, -v204
v_mfma_f32_16x16x32_bf16 v[148:151], a[152:155], a[128:131], v[148:151]
ds_read_b128 a[144:147], v208 offset:0
ds_read_b128 a[148:151], v208 offset:18432
v_mfma_f32_16x16x32_bf16 v[152:155], a[152:155], a[132:135], v[152:155]
v_fma_f32 v95, v95, v202, -v204
v_cvt_pk_bf16_f32 v224, v84, v85
v_mfma_f32_16x16x32_bf16 v[156:159], a[156:159], a[128:131], v[156:159]
v_cvt_pk_bf16_f32 v225, v86, v87
v_mfma_f32_16x16x32_bf16 v[160:163], a[156:159], a[132:135], v[160:163]
s_waitcnt lgkmcnt(9)
v_cvt_pk_bf16_f32 v226, v92, v93
v_cvt_pk_bf16_f32 v227, v94, v95
v_mfma_f32_16x16x32_bf16 v[148:151], a[160:163], a[136:139], v[148:151]
ds_read_b128 a[152:155], v208 offset:1024
ds_read_b128 a[156:159], v208 offset:19456
v_mfma_f32_16x16x32_bf16 v[152:155], a[160:163], a[140:143], v[152:155]
ds_write_b128 v236, v[224:227] offset:192
v_mfma_f32_16x16x32_bf16 v[156:159], a[164:167], a[136:139], v[156:159]
s_add_u32 s66, s66, 4096
s_waitcnt lgkmcnt(9)
v_mfma_f32_16x16x32_bf16 v[160:163], a[164:167], a[140:143], v[160:163]
s_waitcnt lgkmcnt(5)
buffer_store_dwordx4 v[68:71], v1, s[8:11], s66 offen offset:0 sc1
v_mfma_f32_16x16x16_bf16 v[148:151], a[168:169], v[212:213], v[148:151]
ds_read_b128 a[160:163], v208 offset:2048
ds_read_b128 a[164:167], v208 offset:20480
v_mfma_f32_16x16x16_bf16 v[152:155], a[168:169], v[214:215], v[152:155]
v_fma_f32 v88, v88, v203, -v205
v_fma_f32 v89, v89, v203, -v205
v_mfma_f32_16x16x16_bf16 v[156:159], a[172:173], v[212:213], v[156:159]
v_fma_f32 v90, v90, v203, -v205
v_fma_f32 v91, v91, v203, -v205
v_mfma_f32_16x16x16_bf16 v[160:163], a[172:173], v[214:215], v[160:163]
s_waitcnt lgkmcnt(5)
v_fma_f32 v96, v96, v203, -v205
v_fma_f32 v97, v97, v203, -v205
v_mfma_f32_16x16x32_bf16 v[164:167], a[144:147], a[0:3], 0
ds_read_b128 a[168:171], v208 offset:3072
ds_read_b128 a[172:175], v208 offset:21504
v_mfma_f32_16x16x32_bf16 v[168:171], a[144:147], a[4:7], 0
v_fma_f32 v98, v98, v203, -v205
v_fma_f32 v99, v99, v203, -v205
v_mfma_f32_16x16x32_bf16 v[172:175], a[148:151], a[0:3], 0
v_cvt_pk_bf16_f32 v228, v88, v89
v_cvt_pk_bf16_f32 v229, v90, v91
v_mfma_f32_16x16x32_bf16 v[176:179], a[148:151], a[4:7], 0
s_waitcnt lgkmcnt(5)
v_cvt_pk_bf16_f32 v230, v96, v97
v_cvt_pk_bf16_f32 v231, v98, v99
v_mfma_f32_16x16x32_bf16 v[164:167], a[152:155], a[8:11], v[164:167]
ds_read_b128 a[144:147], v208 offset:4096
ds_read_b128 a[148:151], v208 offset:22528
v_mfma_f32_16x16x32_bf16 v[168:171], a[152:155], a[12:15], v[168:171]
ds_write_b128 v236, v[228:231] offset:4800
v_mfma_f32_16x16x32_bf16 v[172:175], a[156:159], a[8:11], v[172:175]
ds_read_b64_tr_b16 v[84:85], v237 offset:192
ds_read_b64_tr_b16 v[86:87], v237 offset:1344
v_mfma_f32_16x16x32_bf16 v[176:179], a[156:159], a[12:15], v[176:179]
s_waitcnt lgkmcnt(7)
v_mfma_f32_16x16x32_bf16 v[164:167], a[160:163], a[16:19], v[164:167]
ds_read_b128 a[152:155], v208 offset:5120
ds_read_b128 a[156:159], v208 offset:23552
ds_read_b64_tr_b16 v[88:89], v237 offset:200
ds_read_b64_tr_b16 v[90:91], v237 offset:1352
buffer_store_dwordx4 v[72:75], v1, s[8:11], s66 offen offset:1024 sc1
v_mfma_f32_16x16x32_bf16 v[168:171], a[160:163], a[20:23], v[168:171]
v_fma_f32 v100, v100, v202, -v204
v_fma_f32 v101, v101, v202, -v204
v_mfma_f32_16x16x32_bf16 v[172:175], a[164:167], a[16:19], v[172:175]
v_fma_f32 v102, v102, v202, -v204
v_mfma_f32_16x16x32_bf16 v[176:179], a[164:167], a[20:23], v[176:179]
s_waitcnt lgkmcnt(9)
v_fma_f32 v103, v103, v202, -v204
v_fma_f32 v104, v104, v203, -v205
v_mfma_f32_16x16x32_bf16 v[164:167], a[168:171], a[24:27], v[164:167]
ds_read_b128 a[160:163], v208 offset:6144
ds_read_b128 a[164:167], v208 offset:24576
v_mfma_f32_16x16x32_bf16 v[168:171], a[168:171], a[28:31], v[168:171]
v_fma_f32 v105, v105, v203, -v205
v_fma_f32 v106, v106, v203, -v205
v_mfma_f32_16x16x32_bf16 v[172:175], a[172:175], a[24:27], v[172:175]
v_fma_f32 v107, v107, v203, -v205
v_cvt_pk_bf16_f32 v216, v100, v101
v_mfma_f32_16x16x32_bf16 v[176:179], a[172:175], a[28:31], v[176:179]
s_waitcnt lgkmcnt(9)
v_cvt_pk_bf16_f32 v217, v102, v103
v_mfma_f32_16x16x32_bf16 v[164:167], a[144:147], a[32:35], v[164:167]
ds_read_b128 a[168:171], v208 offset:7168
ds_read_b128 a[172:175], v208 offset:25600
v_mfma_f32_16x16x32_bf16 v[168:171], a[144:147], a[36:39], v[168:171]
v_cvt_pk_bf16_f32 v218, v104, v105
v_cvt_pk_bf16_f32 v219, v106, v107
v_mfma_f32_16x16x32_bf16 v[172:175], a[148:151], a[32:35], v[172:175]
ds_write_b64 v7, v[216:217] offset:256
v_mfma_f32_16x16x32_bf16 v[176:179], a[148:151], a[36:39], v[176:179]
s_waitcnt lgkmcnt(7)
v_mfma_f32_16x16x32_bf16 v[164:167], a[152:155], a[40:43], v[164:167]
ds_read_b128 a[144:147], v208 offset:8192
ds_read_b128 a[148:151], v208 offset:26624
v_mfma_f32_16x16x32_bf16 v[168:171], a[152:155], a[44:47], v[168:171]
ds_write_b64 v7, v[218:219] offset:4864
ds_read_b64_tr_b16 v[100:101], v238 offset:256
ds_read_b64_tr_b16 v[102:103], v238 offset:1408
buffer_store_dwordx4 v[84:87], v1, s[8:11], s66 offen offset:2048 sc1
v_mfma_f32_16x16x32_bf16 v[172:175], a[156:159], a[40:43], v[172:175]
v_mfma_f32_16x16x32_bf16 v[176:179], a[156:159], a[44:47], v[176:179]
s_waitcnt lgkmcnt(8)
v_mfma_f32_16x16x32_bf16 v[164:167], a[160:163], a[48:51], v[164:167]
ds_read_b128 a[152:155], v208 offset:9216
ds_read_b128 a[156:159], v208 offset:27648
v_mfma_f32_16x16x32_bf16 v[168:171], a[160:163], a[52:55], v[168:171]
v_mfma_f32_16x16x32_bf16 v[172:175], a[164:167], a[48:51], v[172:175]
v_mfma_f32_16x16x32_bf16 v[176:179], a[164:167], a[52:55], v[176:179]
s_waitcnt lgkmcnt(8)
v_mfma_f32_16x16x32_bf16 v[164:167], a[168:171], a[56:59], v[164:167]
ds_read_b128 a[160:163], v208 offset:10240
ds_read_b128 a[164:167], v208 offset:28672
v_mfma_f32_16x16x32_bf16 v[168:171], a[168:171], a[60:63], v[168:171]
v_mfma_f32_16x16x32_bf16 v[172:175], a[172:175], a[56:59], v[172:175]
v_mfma_f32_16x16x32_bf16 v[176:179], a[172:175], a[60:63], v[176:179]
s_waitcnt lgkmcnt(7)
v_mfma_f32_16x16x32_bf16 v[164:167], a[144:147], a[64:67], v[164:167]
ds_read_b128 a[168:171], v208 offset:11264
ds_read_b128 a[172:175], v208 offset:29696
v_mfma_f32_16x16x32_bf16 v[168:171], a[144:147], a[68:71], v[168:171]
v_mfma_f32_16x16x32_bf16 v[172:175], a[148:151], a[64:67], v[172:175]
buffer_store_dwordx4 v[88:91], v1, s[8:11], s66 offen offset:3072 sc1
v_mfma_f32_16x16x32_bf16 v[176:179], a[148:151], a[68:71], v[176:179]
s_waitcnt lgkmcnt(4)
v_mfma_f32_16x16x32_bf16 v[164:167], a[152:155], a[72:75], v[164:167]
ds_read_b128 a[144:147], v208 offset:12288
ds_read_b128 a[148:151], v208 offset:30720
v_mfma_f32_16x16x32_bf16 v[168:171], a[152:155], a[76:79], v[168:171]
v_mfma_f32_16x16x32_bf16 v[172:175], a[156:159], a[72:75], v[172:175]
v_mfma_f32_16x16x32_bf16 v[176:179], a[156:159], a[76:79], v[176:179]
s_waitcnt lgkmcnt(4)
v_mfma_f32_16x16x32_bf16 v[164:167], a[160:163], a[80:83], v[164:167]
ds_read_b128 a[152:155], v208 offset:13312
ds_read_b128 a[156:159], v208 offset:31744
v_mfma_f32_16x16x32_bf16 v[168:171], a[160:163], a[84:87], v[168:171]
v_mfma_f32_16x16x32_bf16 v[172:175], a[164:167], a[80:83], v[172:175]
v_mfma_f32_16x16x32_bf16 v[176:179], a[164:167], a[84:87], v[176:179]
s_waitcnt lgkmcnt(4)
v_mfma_f32_16x16x32_bf16 v[164:167], a[168:171], a[88:91], v[164:167]
ds_read_b128 a[160:163], v208 offset:14336
ds_read_b128 a[164:167], v208 offset:32768
v_mfma_f32_16x16x32_bf16 v[168:171], a[168:171], a[92:95], v[168:171]
v_mfma_f32_16x16x32_bf16 v[172:175], a[172:175], a[88:91], v[172:175]
s_add_u32 s66, s66, 4096
v_mfma_f32_16x16x32_bf16 v[176:179], a[172:175], a[92:95], v[176:179]
s_waitcnt lgkmcnt(4)
buffer_store_dwordx4 v[100:103], v1, s[8:11], s66 offen offset:0 sc1
v_mfma_f32_16x16x32_bf16 v[164:167], a[144:147], a[96:99], v[164:167]
ds_read_b128 a[168:171], v208 offset:15360
ds_read_b128 a[172:175], v208 offset:33792
v_mfma_f32_16x16x32_bf16 v[168:171], a[144:147], a[100:103], v[168:171]
v_mfma_f32_16x16x32_bf16 v[172:175], a[148:151], a[96:99], v[172:175]
v_mfma_f32_16x16x32_bf16 v[176:179], a[148:151], a[100:103], v[176:179]
s_waitcnt lgkmcnt(4)
v_mfma_f32_16x16x32_bf16 v[164:167], a[152:155], a[104:107], v[164:167]
ds_read_b128 a[144:147], v208 offset:16384
ds_read_b128 a[148:151], v208 offset:34816
v_mfma_f32_16x16x32_bf16 v[168:171], a[152:155], a[108:111], v[168:171]
v_mfma_f32_16x16x32_bf16 v[172:175], a[156:159], a[104:107], v[172:175]
v_mfma_f32_16x16x32_bf16 v[176:179], a[156:159], a[108:111], v[176:179]
s_waitcnt lgkmcnt(4)
v_mfma_f32_16x16x32_bf16 v[164:167], a[160:163], a[112:115], v[164:167]
ds_read_b128 a[152:155], v208 offset:17408
ds_read_b128 a[156:159], v208 offset:35840
v_mfma_f32_16x16x32_bf16 v[168:171], a[160:163], a[116:119], v[168:171]
v_mfma_f32_16x16x32_bf16 v[172:175], a[164:167], a[112:115], v[172:175]
v_mfma_f32_16x16x32_bf16 v[176:179], a[164:167], a[116:119], v[176:179]
s_waitcnt lgkmcnt(4)
v_add_u32 v181, 160768, v239
v_mfma_f32_16x16x32_bf16 v[164:167], a[168:171], a[120:123], v[164:167]
ds_read_b64 a[160:161], v181 offset:0
ds_read_b64 a[164:165], v181 offset:512
v_mfma_f32_16x16x32_bf16 v[168:171], a[168:171], a[124:127], v[168:171]
v_mfma_f32_16x16x32_bf16 v[172:175], a[172:175], a[120:123], v[172:175]
v_mfma_f32_16x16x32_bf16 v[176:179], a[172:175], a[124:127], v[176:179]
s_waitcnt lgkmcnt(4)
v_mfma_f32_16x16x32_bf16 v[164:167], a[144:147], a[128:131], v[164:167]
v_mfma_f32_16x16x32_bf16 v[168:171], a[144:147], a[132:135], v[168:171]
v_mfma_f32_16x16x32_bf16 v[172:175], a[148:151], a[128:131], v[172:175]
v_mfma_f32_16x16x32_bf16 v[176:179], a[148:151], a[132:135], v[176:179]
s_waitcnt lgkmcnt(2)
v_mfma_f32_16x16x32_bf16 v[164:167], a[152:155], a[136:139], v[164:167]
v_mfma_f32_16x16x32_bf16 v[168:171], a[152:155], a[140:143], v[168:171]
v_mfma_f32_16x16x32_bf16 v[172:175], a[156:159], a[136:139], v[172:175]
v_mfma_f32_16x16x32_bf16 v[176:179], a[156:159], a[140:143], v[176:179]
s_waitcnt lgkmcnt(0)
v_mfma_f32_16x16x16_bf16 v[164:167], a[160:161], v[212:213], v[164:167]
v_mfma_f32_16x16x16_bf16 v[168:171], a[160:161], v[214:215], v[168:171]
v_mfma_f32_16x16x16_bf16 v[172:175], a[164:165], v[212:213], v[172:175]
v_mfma_f32_16x16x16_bf16 v[176:179], a[164:165], v[214:215], v[176:179]
s_cmp_eq_u32 s24, 0
s_cselect_b32 s67, 0, 1073741824
s_add_u32 s67, s67, 26542080
s_waitcnt vmcnt(0)
s_barrier
s_mov_b64 exec, 0xffff
buffer_atomic_add v4, v233, s[8:11], s67 offen sc1
s_mov_b64 exec, -1
L_c4:
s_lshl_b32 s35, s80, 7
s_add_u32 s35, s35, 26542080
s_cmp_eq_u32 s24, 1
s_cselect_b32 s35, s35, 1073741824
v_mov_b32 v6, 0
s_lshl_b32 s31, s25, 8
s_lshl_b32 s32, s24, 6
s_add_u32 s31, s31, s32
v_lshlrev_b32 v8, 1, v2
buffer_load_ushort v180, v8, s[20:23], s31 offen
buffer_load_ushort v181, v8, s[20:23], s31 offen offset:32
buffer_load_dwordx4 a[80:83], v1, s[4:7], s52 offen offset:2048 sc1
buffer_load_dwordx4 a[84:87], v9, s[4:7], s52 offen offset:2048 sc1
buffer_load_dwordx4 a[88:91], v1, s[4:7], s52 offen offset:3072 sc1
v_mov_b32 v244, 0
s_mov_b64 exec, 1
buffer_atomic_add v244, v6, s[8:11], s35 offen sc0 sc1
s_mov_b64 exec, -1
buffer_load_dwordx4 a[92:95], v9, s[4:7], s52 offen offset:3072 sc1
s_add_u32 s52, s52, 4096
buffer_load_dwordx4 a[96:99], v1, s[4:7], s52 offen offset:0 sc1
buffer_load_dwordx4 a[100:103], v9, s[4:7], s52 offen offset:0 sc1
buffer_load_dwordx4 a[104:107], v1, s[4:7], s52 offen offset:1024 sc1
buffer_load_dwordx4 a[108:111], v9, s[4:7], s52 offen offset:1024 sc1
v_mov_b32 v245, 0
s_mov_b64 exec, 1
buffer_atomic_add v245, v6, s[8:11], s35 offen sc0 sc1
s_mov_b64 exec, -1
buffer_load_dwordx4 a[112:115], v1, s[4:7], s52 offen offset:2048 sc1
buffer_load_dwordx4 a[116:119], v9, s[4:7], s52 offen offset:2048 sc1
buffer_load_dwordx4 a[120:123], v1, s[4:7], s52 offen offset:3072 sc1
buffer_load_dwordx4 a[124:127], v9, s[4:7], s52 offen offset:3072 sc1
s_add_u32 s52, s52, 4096
v_mov_b32 v246, 0
s_mov_b64 exec, 1
buffer_atomic_add v246, v6, s[8:11], s35 offen sc0 sc1
s_mov_b64 exec, -1
buffer_load_dwordx4 a[128:131], v1, s[4:7], s52 offen offset:0 sc1
buffer_load_dwordx4 a[132:135], v9, s[4:7], s52 offen offset:0 sc1
buffer_load_dwordx4 a[136:139], v1, s[4:7], s52 offen offset:1024 sc1
buffer_load_dwordx4 a[140:143], v9, s[4:7], s52 offen offset:1024 sc1
s_mul_i32 s30, s26, 589824
s_add_u32 s30, s30, 7340032
s_lshl_b32 s62, s24, 12
s_lshl_b32 s63, s24, 10
s_add_u32 s60, s30, s62
s_add_u32 s61, s30, s63
s_add_u32 s61, s61, 16384
s_cmp_eq_u32 s24, 1
s_cbranch_scc0 L_other_28
s_mov_b32 s31, 0
s_mov_b64 exec, 1
v_mov_b32 v247, 0
buffer_atomic_add v247, v6, s[8:11], s35 offen sc0 sc1
s_waitcnt vmcnt(16)
v_cmp_gt_u32 vcc, 16, v244
s_nop 0
s_cbranch_vccz L_polled_27
s_waitcnt vmcnt(10)
v_cmp_gt_u32 vcc, 16, v245
s_nop 0
s_cbranch_vccz L_polled_27
v_mov_b32 v244, 0
buffer_atomic_add v244, v6, s[8:11], s35 offen sc0 sc1
s_waitcnt vmcnt(6)
v_cmp_gt_u32 vcc, 16, v246
s_nop 0
s_cbranch_vccz L_polled_27
v_mov_b32 v245, 0
buffer_atomic_add v245, v6, s[8:11], s35 offen sc0 sc1
L_poll_26:
s_add_u32 s31, s31, 1
s_cmp_gt_u32 s31, 100000
s_cbranch_scc1 L_polled_27
v_mov_b32 v246, 0
buffer_atomic_add v246, v6, s[8:11], s35 offen sc0 sc1
s_waitcnt vmcnt(3)
v_cmp_gt_u32 vcc, 16, v247
s_nop 0
s_cbranch_vccz L_polled_27
v_mov_b32 v247, 0
buffer_atomic_add v247, v6, s[8:11], s35 offen sc0 sc1
s_waitcnt vmcnt(3)
v_cmp_gt_u32 vcc, 16, v244
s_nop 0
s_cbranch_vccz L_polled_27
v_mov_b32 v244, 0
buffer_atomic_add v244, v6, s[8:11], s35 offen sc0 sc1
s_waitcnt vmcnt(3)
v_cmp_gt_u32 vcc, 16, v245
s_nop 0
s_cbranch_vccz L_polled_27
v_mov_b32 v245, 0
buffer_atomic_add v245, v6, s[8:11], s35 offen sc0 sc1
s_waitcnt vmcnt(3)
v_cmp_gt_u32 vcc, 16, v246
s_nop 0
s_cbranch_vccz L_polled_27
s_branch L_poll_26
L_polled_27:
s_mov_b64 exec, -1
L_other_28:
s_barrier
s_add_u32 m0, s62, 126976
s_add_u32 s60, s60, 0
buffer_load_dwordx4 v1, s[8:11], s60 offen offset:0 sc1 lds
buffer_load_dwordx4 v1, s[8:11], s60 offen offset:1024 sc1 lds
buffer_load_dwordx4 v1, s[8:11], s60 offen offset:2048 sc1 lds
buffer_load_dwordx4 v1, s[8:11], s60 offen offset:3072 sc1 lds
s_add_u32 m0, s63, 143360
s_add_u32 s61, s61, 0
buffer_load_dwordx4 v1, s[8:11], s61 offen offset:0 sc1 lds
s_barrier
s_add_u32 m0, s62, 147456
s_add_u32 s60, s60, 20480
buffer_load_dwordx4 v1, s[8:11], s60 offen offset:0 sc1 lds
buffer_load_dwordx4 v1, s[8:11], s60 offen offset:1024 sc1 lds
buffer_load_dwordx4 v1, s[8:11], s60 offen offset:2048 sc1 lds
buffer_load_dwordx4 v1, s[8:11], s60 offen offset:3072 sc1 lds
v_add_u32 v190, 53248, v1
v_add_u32 v191, 90112, v1
v_add_u32 v192, 126976, v1
s_waitcnt vmcnt(28)
v_lshlrev_b32 v180, 16, v180
v_lshlrev_b32 v181, 16, v181
v_mov_b32 v36, v180
v_mov_b32 v37, v180
v_mov_b32 v38, v180
v_mov_b32 v39, v180
v_mov_b32 v40, v181
v_mov_b32 v41, v181
v_mov_b32 v42, v181
v_mov_b32 v43, v181
v_mov_b32 v44, v180
v_mov_b32 v45, v180
v_mov_b32 v46, v180
v_mov_b32 v47, v180
v_mov_b32 v48, v181
v_mov_b32 v49, v181
v_mov_b32 v50, v181
v_mov_b32 v51, v181
v_mov_b32 v52, v180
v_mov_b32 v53, v180
v_mov_b32 v54, v180
v_mov_b32 v55, v180
v_mov_b32 v56, v181
v_mov_b32 v57, v181
v_mov_b32 v58, v181
v_mov_b32 v59, v181
v_mov_b32 v60, v180
v_mov_b32 v61, v180
v_mov_b32 v62, v180
v_mov_b32 v63, v180
v_mov_b32 v64, v181
v_mov_b32 v65, v181
v_mov_b32 v66, v181
v_mov_b32 v67, v181
v_mov_b32 v68, v180
v_mov_b32 v69, v180
v_mov_b32 v70, v180
v_mov_b32 v71, v180
v_mov_b32 v72, v181
v_mov_b32 v73, v181
v_mov_b32 v74, v181
v_mov_b32 v75, v181
v_mov_b32 v76, v180
v_mov_b32 v77, v180
v_mov_b32 v78, v180
v_mov_b32 v79, v180
v_mov_b32 v80, v181
v_mov_b32 v81, v181
v_mov_b32 v82, v181
v_mov_b32 v83, v181
v_mov_b32 v84, v180
v_mov_b32 v85, v180
v_mov_b32 v86, v180
v_mov_b32 v87, v180
v_mov_b32 v88, v181
v_mov_b32 v89, v181
v_mov_b32 v90, v181
v_mov_b32 v91, v181
v_mov_b32 v92, v180
v_mov_b32 v93, v180
v_mov_b32 v94, v180
v_mov_b32 v95, v180
v_mov_b32 v96, v181
v_mov_b32 v97, v181
v_mov_b32 v98, v181
v_mov_b32 v99, v181
v_mov_b32 v100, v180
v_mov_b32 v101, v180
v_mov_b32 v102, v180
v_mov_b32 v103, v180
v_mov_b32 v104, v181
v_mov_b32 v105, v181
v_mov_b32 v106, v181
v_mov_b32 v107, v181
s_waitcnt vmcnt(4)
s_barrier
ds_read_b128 a[0:3], v192 offset:0
ds_read_b128 a[4:7], v192 offset:1024
ds_read_b128 a[8:11], v192 offset:2048
ds_read_b128 a[12:15], v192 offset:3072
ds_read_b128 a[16:19], v192 offset:4096
ds_read_b128 a[20:23], v192 offset:5120
ds_read_b128 a[24:27], v192 offset:6144
ds_read_b128 a[28:31], v192 offset:7168
ds_read_b128 a[32:35], v192 offset:8192
s_waitcnt lgkmcnt(0)
v_mfma_f32_16x16x32_bf16 v[36:39], a[0:3], a[176:179], v[36:39]
ds_read_b128 a[36:39], v192 offset:9216
s_add_u32 m0, s62, 53248
v_mfma_f32_16x16x32_bf16 v[40:43], a[0:3], a[180:183], v[40:43]
ds_read_b128 a[40:43], v192 offset:10240
v_mul_f32 v182, v108, v108
v_mfma_f32_16x16x32_bf16 v[44:47], a[4:7], a[176:179], v[44:47]
ds_read_b128 a[44:47], v192 offset:11264
s_add_u32 s60, s60, 16384
v_mfma_f32_16x16x32_bf16 v[48:51], a[4:7], a[180:183], v[48:51]
ds_read_b128 a[48:51], v192 offset:12288
v_mul_f32 v183, v109, v109
v_mfma_f32_16x16x32_bf16 v[52:55], a[8:11], a[176:179], v[52:55]
ds_read_b128 a[52:55], v192 offset:13312
v_mul_f32 v184, v110, v110
v_mfma_f32_16x16x32_bf16 v[56:59], a[8:11], a[180:183], v[56:59]
ds_read_b128 a[56:59], v192 offset:14336
buffer_load_dwordx4 v1, s[8:11], s60 offen offset:0 sc1 lds
v_mfma_f32_16x16x32_bf16 v[60:63], a[12:15], a[176:179], v[60:63]
ds_read_b128 a[60:63], v192 offset:15360
v_mul_f32 v185, v111, v111
v_mfma_f32_16x16x32_bf16 v[64:67], a[12:15], a[180:183], v[64:67]
ds_read_b128 a[64:67], v192 offset:16384
v_fma_f32 v182, v182, v252, v250
v_mfma_f32_16x16x32_bf16 v[68:71], a[16:19], a[176:179], v[68:71]
ds_read_b128 a[68:71], v192 offset:17408
buffer_load_dwordx4 v1, s[8:11], s60 offen offset:1024 sc1 lds
v_mfma_f32_16x16x32_bf16 v[72:75], a[16:19], a[180:183], v[72:75]
v_fma_f32 v183, v183, v252, v250
v_fma_f32 v184, v184, v252, v250
v_mfma_f32_16x16x32_bf16 v[76:79], a[20:23], a[176:179], v[76:79]
v_mfma_f32_16x16x32_bf16 v[80:83], a[20:23], a[180:183], v[80:83]
buffer_load_dwordx4 v1, s[8:11], s60 offen offset:2048 sc1 lds
v_fma_f32 v185, v185, v252, v250
v_mfma_f32_16x16x32_bf16 v[84:87], a[24:27], a[176:179], v[84:87]
v_mul_f32 v182, v182, v108
v_mfma_f32_16x16x32_bf16 v[88:91], a[24:27], a[180:183], v[88:91]
v_mfma_f32_16x16x32_bf16 v[92:95], a[28:31], a[176:179], v[92:95]
buffer_load_dwordx4 v1, s[8:11], s60 offen offset:3072 sc1 lds
v_mul_f32 v183, v183, v109
v_mfma_f32_16x16x32_bf16 v[96:99], a[28:31], a[180:183], v[96:99]
v_mul_f32 v184, v184, v110
v_mfma_f32_16x16x32_bf16 v[100:103], a[32:35], a[176:179], v[100:103]
v_mfma_f32_16x16x32_bf16 v[104:107], a[32:35], a[180:183], v[104:107]
s_waitcnt vmcnt(4) lgkmcnt(0)
s_barrier
v_mfma_f32_16x16x32_bf16 v[36:39], a[36:39], a[184:187], v[36:39]
ds_read_b128 a[0:3], v192 offset:18432
s_add_u32 m0, s63, 69632
v_mfma_f32_16x16x32_bf16 v[40:43], a[36:39], a[188:191], v[40:43]
ds_read_b128 a[4:7], v192 offset:19456
v_mul_f32 v185, v185, v111
v_mfma_f32_16x16x32_bf16 v[44:47], a[40:43], a[184:187], v[44:47]
ds_read_b128 a[8:11], v192 offset:20480
s_add_u32 s61, s61, 36864
v_mfma_f32_16x16x32_bf16 v[48:51], a[40:43], a[188:191], v[48:51]
ds_read_b128 a[12:15], v192 offset:21504
v_mfma_f32_16x16x32_bf16 v[52:55], a[44:47], a[184:187], v[52:55]
ds_read_b128 a[16:19], v192 offset:22528
buffer_load_dwordx4 v1, s[8:11], s61 offen offset:0 sc1 lds
v_mfma_f32_16x16x32_bf16 v[56:59], a[44:47], a[188:191], v[56:59]
ds_read_b128 a[20:23], v192 offset:23552
v_mfma_f32_16x16x32_bf16 v[60:63], a[48:51], a[184:187], v[60:63]
ds_read_b128 a[24:27], v192 offset:24576
s_add_u32 m0, s62, 73728
v_mfma_f32_16x16x32_bf16 v[64:67], a[48:51], a[188:191], v[64:67]
ds_read_b128 a[28:31], v192 offset:25600
v_mfma_f32_16x16x32_bf16 v[68:71], a[52:55], a[184:187], v[68:71]
ds_read_b128 a[32:35], v192 offset:26624
s_add_u32 s60, s60, 20480
v_mfma_f32_16x16x32_bf16 v[72:75], a[52:55], a[188:191], v[72:75]
v_exp_f32 v182, v182
v_mfma_f32_16x16x32_bf16 v[76:79], a[56:59], a[184:187], v[76:79]
buffer_load_dwordx4 v1, s[8:11], s60 offen offset:0 sc1 lds
v_mfma_f32_16x16x32_bf16 v[80:83], a[56:59], a[188:191], v[80:83]
v_exp_f32 v183, v183
v_mfma_f32_16x16x32_bf16 v[84:87], a[60:63], a[184:187], v[84:87]
buffer_load_dwordx4 v1, s[8:11], s60 offen offset:1024 sc1 lds
v_mfma_f32_16x16x32_bf16 v[88:91], a[60:63], a[188:191], v[88:91]
v_exp_f32 v184, v184
v_mfma_f32_16x16x32_bf16 v[92:95], a[64:67], a[184:187], v[92:95]
buffer_load_dwordx4 v1, s[8:11], s60 offen offset:2048 sc1 lds
v_mfma_f32_16x16x32_bf16 v[96:99], a[64:67], a[188:191], v[96:99]
v_exp_f32 v185, v185
v_mfma_f32_16x16x32_bf16 v[100:103], a[68:71], a[184:187], v[100:103]
v_fma_f32 v182, v182, v254, v254
v_fma_f32 v183, v183, v254, v254
v_mfma_f32_16x16x32_bf16 v[104:107], a[68:71], a[188:191], v[104:107]
v_fma_f32 v184, v184, v254, v254
s_waitcnt lgkmcnt(0)
v_mfma_f32_16x16x32_bf16 v[36:39], a[0:3], a[192:195], v[36:39]
ds_read_b128 a[36:39], v192 offset:27648
buffer_load_dwordx4 v1, s[8:11], s60 offen offset:3072 sc1 lds
v_mfma_f32_16x16x32_bf16 v[40:43], a[0:3], a[196:199], v[40:43]
ds_read_b128 a[40:43], v192 offset:28672
v_fma_f32 v185, v185, v254, v254
v_mfma_f32_16x16x32_bf16 v[44:47], a[4:7], a[192:195], v[44:47]
ds_read_b128 a[44:47], v192 offset:29696
s_add_u32 m0, s62, 90112
v_mfma_f32_16x16x32_bf16 v[48:51], a[4:7], a[196:199], v[48:51]
ds_read_b128 a[48:51], v192 offset:30720
v_mfma_f32_16x16x32_bf16 v[52:55], a[8:11], a[192:195], v[52:55]
ds_read_b128 a[52:55], v192 offset:31744
v_mfma_f32_16x16x32_bf16 v[56:59], a[8:11], a[196:199], v[56:59]
ds_read_b128 a[56:59], v192 offset:32768
s_add_u32 s60, s60, 16384
v_mfma_f32_16x16x32_bf16 v[60:63], a[12:15], a[192:195], v[60:63]
ds_read_b128 a[60:63], v192 offset:33792
v_mfma_f32_16x16x32_bf16 v[64:67], a[12:15], a[196:199], v[64:67]
ds_read_b128 a[64:67], v192 offset:34816
v_mfma_f32_16x16x32_bf16 v[68:71], a[16:19], a[192:195], v[68:71]
ds_read_b128 a[68:71], v192 offset:35840
buffer_load_dwordx4 v1, s[8:11], s60 offen offset:0 sc1 lds
v_mfma_f32_16x16x32_bf16 v[72:75], a[16:19], a[196:199], v[72:75]
v_rcp_f32 v182, v182
v_mfma_f32_16x16x32_bf16 v[76:79], a[20:23], a[192:195], v[76:79]
v_rcp_f32 v183, v183
v_mfma_f32_16x16x32_bf16 v[80:83], a[20:23], a[196:199], v[80:83]
buffer_load_dwordx4 v1, s[8:11], s60 offen offset:1024 sc1 lds
v_mfma_f32_16x16x32_bf16 v[84:87], a[24:27], a[192:195], v[84:87]
v_rcp_f32 v184, v184
v_mfma_f32_16x16x32_bf16 v[88:91], a[24:27], a[196:199], v[88:91]
v_rcp_f32 v185, v185
v_mfma_f32_16x16x32_bf16 v[92:95], a[28:31], a[192:195], v[92:95]
buffer_load_dwordx4 v1, s[8:11], s60 offen offset:2048 sc1 lds
v_mul_f32 v108, v108, v182
v_mfma_f32_16x16x32_bf16 v[96:99], a[28:31], a[196:199], v[96:99]
v_mfma_f32_16x16x32_bf16 v[100:103], a[32:35], a[192:195], v[100:103]
v_mul_f32 v109, v109, v183
v_mfma_f32_16x16x32_bf16 v[104:107], a[32:35], a[196:199], v[104:107]
s_waitcnt vmcnt(7) lgkmcnt(0)
s_barrier
v_mfma_f32_16x16x32_bf16 v[36:39], a[36:39], a[200:203], v[36:39]
ds_read_b128 a[0:3], v190 offset:0
buffer_load_dwordx4 v1, s[8:11], s60 offen offset:3072 sc1 lds
v_mfma_f32_16x16x32_bf16 v[40:43], a[36:39], a[204:207], v[40:43]
ds_read_b128 a[4:7], v190 offset:1024
v_mul_f32 v110, v110, v184
v_mfma_f32_16x16x32_bf16 v[44:47], a[40:43], a[200:203], v[44:47]
ds_read_b128 a[8:11], v190 offset:2048
s_add_u32 m0, s63, 106496
v_mfma_f32_16x16x32_bf16 v[48:51], a[40:43], a[204:207], v[48:51]
ds_read_b128 a[12:15], v190 offset:3072
v_mul_f32 v111, v111, v185
v_mfma_f32_16x16x32_bf16 v[52:55], a[44:47], a[200:203], v[52:55]
ds_read_b128 a[16:19], v190 offset:4096
s_add_u32 s61, s61, 36864
v_mfma_f32_16x16x32_bf16 v[56:59], a[44:47], a[204:207], v[56:59]
ds_read_b128 a[20:23], v190 offset:5120
v_mul_f32 v186, v112, v112
v_mfma_f32_16x16x32_bf16 v[60:63], a[48:51], a[200:203], v[60:63]
ds_read_b128 a[24:27], v190 offset:6144
buffer_load_dwordx4 v1, s[8:11], s61 offen offset:0 sc1 lds
v_mfma_f32_16x16x32_bf16 v[64:67], a[48:51], a[204:207], v[64:67]
ds_read_b128 a[28:31], v190 offset:7168
v_mul_f32 v187, v113, v113
v_mfma_f32_16x16x32_bf16 v[68:71], a[52:55], a[200:203], v[68:71]
ds_read_b128 a[32:35], v190 offset:8192
s_add_u32 m0, s62, 110592
v_mfma_f32_16x16x32_bf16 v[72:75], a[52:55], a[204:207], v[72:75]
s_add_u32 s60, s60, 20480
v_mul_f32 v188, v114, v114
v_mul_f32 v189, v115, v115
v_mfma_f32_16x16x32_bf16 v[76:79], a[56:59], a[200:203], v[76:79]
v_fma_f32 v186, v186, v253, v251
v_mfma_f32_16x16x32_bf16 v[80:83], a[56:59], a[204:207], v[80:83]
v_fma_f32 v187, v187, v253, v251
v_mfma_f32_16x16x32_bf16 v[84:87], a[60:63], a[200:203], v[84:87]
buffer_load_dwordx4 v1, s[8:11], s60 offen offset:0 sc1 lds
v_fma_f32 v188, v188, v253, v251
v_mfma_f32_16x16x32_bf16 v[88:91], a[60:63], a[204:207], v[88:91]
v_mfma_f32_16x16x32_bf16 v[92:95], a[64:67], a[200:203], v[92:95]
buffer_load_dwordx4 v1, s[8:11], s60 offen offset:1024 sc1 lds
v_fma_f32 v189, v189, v253, v251
v_mfma_f32_16x16x32_bf16 v[96:99], a[64:67], a[204:207], v[96:99]
v_mfma_f32_16x16x32_bf16 v[100:103], a[68:71], a[200:203], v[100:103]
v_mul_f32 v186, v186, v112
v_mfma_f32_16x16x32_bf16 v[104:107], a[68:71], a[204:207], v[104:107]
v_mul_f32 v187, v187, v113
s_waitcnt lgkmcnt(0)
v_mfma_f32_16x16x32_bf16 v[36:39], a[0:3], a[208:211], v[36:39]
ds_read_b128 a[36:39], v190 offset:9216
buffer_load_dwordx4 v1, s[8:11], s60 offen offset:2048 sc1 lds
v_mfma_f32_16x16x32_bf16 v[40:43], a[0:3], a[212:215], v[40:43]
ds_read_b128 a[40:43], v190 offset:10240
v_mul_f32 v188, v188, v114
v_mfma_f32_16x16x32_bf16 v[44:47], a[4:7], a[208:211], v[44:47]
ds_read_b128 a[44:47], v190 offset:11264
buffer_load_dwordx4 v1, s[8:11], s60 offen offset:3072 sc1 lds
v_mfma_f32_16x16x32_bf16 v[48:51], a[4:7], a[212:215], v[48:51]
ds_read_b128 a[48:51], v190 offset:12288
v_mul_f32 v189, v189, v115
v_mfma_f32_16x16x32_bf16 v[52:55], a[8:11], a[208:211], v[52:55]
ds_read_b128 a[52:55], v190 offset:13312
v_mfma_f32_16x16x32_bf16 v[56:59], a[8:11], a[212:215], v[56:59]
ds_read_b128 a[56:59], v190 offset:14336
s_add_u32 m0, s62, 126976
v_mfma_f32_16x16x32_bf16 v[60:63], a[12:15], a[208:211], v[60:63]
ds_read_b128 a[60:63], v190 offset:15360
v_mfma_f32_16x16x32_bf16 v[64:67], a[12:15], a[212:215], v[64:67]
ds_read_b128 a[64:67], v190 offset:16384
v_mfma_f32_16x16x32_bf16 v[68:71], a[16:19], a[208:211], v[68:71]
ds_read_b128 a[68:71], v190 offset:17408
s_add_u32 s60, s60, 16384
v_mfma_f32_16x16x32_bf16 v[72:75], a[16:19], a[212:215], v[72:75]
v_exp_f32 v186, v186
v_mfma_f32_16x16x32_bf16 v[76:79], a[20:23], a[208:211], v[76:79]
v_exp_f32 v187, v187
v_mfma_f32_16x16x32_bf16 v[80:83], a[20:23], a[212:215], v[80:83]
buffer_load_dwordx4 v1, s[8:11], s60 offen offset:0 sc1 lds
v_mfma_f32_16x16x32_bf16 v[84:87], a[24:27], a[208:211], v[84:87]
v_exp_f32 v188, v188
v_mfma_f32_16x16x32_bf16 v[88:91], a[24:27], a[212:215], v[88:91]
v_mfma_f32_16x16x32_bf16 v[92:95], a[28:31], a[208:211], v[92:95]
buffer_load_dwordx4 v1, s[8:11], s60 offen offset:1024 sc1 lds
v_mfma_f32_16x16x32_bf16 v[96:99], a[28:31], a[212:215], v[96:99]
v_exp_f32 v189, v189
v_mfma_f32_16x16x32_bf16 v[100:103], a[32:35], a[208:211], v[100:103]
v_mfma_f32_16x16x32_bf16 v[104:107], a[32:35], a[212:215], v[104:107]
s_waitcnt vmcnt(11) lgkmcnt(0)
s_barrier
v_mfma_f32_16x16x32_bf16 v[36:39], a[36:39], a[216:219], v[36:39]
ds_read_b128 a[0:3], v190 offset:18432
buffer_load_dwordx4 v1, s[8:11], s60 offen offset:2048 sc1 lds
v_mfma_f32_16x16x32_bf16 v[40:43], a[36:39], a[220:223], v[40:43]
ds_read_b128 a[4:7], v190 offset:19456
v_fma_f32 v186, v186, v255, v255
v_mfma_f32_16x16x32_bf16 v[44:47], a[40:43], a[216:219], v[44:47]
ds_read_b128 a[8:11], v190 offset:20480
buffer_load_dwordx4 v1, s[8:11], s60 offen offset:3072 sc1 lds
v_mfma_f32_16x16x32_bf16 v[48:51], a[40:43], a[220:223], v[48:51]
ds_read_b128 a[12:15], v190 offset:21504
v_fma_f32 v187, v187, v255, v255
v_mfma_f32_16x16x32_bf16 v[52:55], a[44:47], a[216:219], v[52:55]
ds_read_b128 a[16:19], v190 offset:22528
s_add_u32 m0, s63, 143360
v_mfma_f32_16x16x32_bf16 v[56:59], a[44:47], a[220:223], v[56:59]
ds_read_b128 a[20:23], v190 offset:23552
v_fma_f32 v188, v188, v255, v255
v_mfma_f32_16x16x32_bf16 v[60:63], a[48:51], a[216:219], v[60:63]
ds_read_b128 a[24:27], v190 offset:24576
s_add_u32 s61, s61, 36864
v_mfma_f32_16x16x32_bf16 v[64:67], a[48:51], a[220:223], v[64:67]
ds_read_b128 a[28:31], v190 offset:25600
v_fma_f32 v189, v189, v255, v255
v_mfma_f32_16x16x32_bf16 v[68:71], a[52:55], a[216:219], v[68:71]
ds_read_b128 a[32:35], v190 offset:26624
buffer_load_dwordx4 v1, s[8:11], s61 offen offset:0 sc1 lds
v_mfma_f32_16x16x32_bf16 v[72:75], a[52:55], a[220:223], v[72:75]
s_add_u32 m0, s62, 147456
v_rcp_f32 v186, v186
v_mfma_f32_16x16x32_bf16 v[76:79], a[56:59], a[216:219], v[76:79]
s_add_u32 s60, s60, 20480
v_rcp_f32 v187, v187
v_mfma_f32_16x16x32_bf16 v[80:83], a[56:59], a[220:223], v[80:83]
v_rcp_f32 v188, v188
v_mfma_f32_16x16x32_bf16 v[84:87], a[60:63], a[216:219], v[84:87]
v_mfma_f32_16x16x32_bf16 v[88:91], a[60:63], a[220:223], v[88:91]
v_mfma_f32_16x16x32_bf16 v[92:95], a[64:67], a[216:219], v[92:95]
buffer_load_dwordx4 v1, s[8:11], s60 offen offset:0 sc1 lds
v_mfma_f32_16x16x32_bf16 v[96:99], a[64:67], a[220:223], v[96:99]
v_rcp_f32 v189, v189
v_mfma_f32_16x16x32_bf16 v[100:103], a[68:71], a[216:219], v[100:103]
v_mfma_f32_16x16x32_bf16 v[104:107], a[68:71], a[220:223], v[104:107]
s_waitcnt lgkmcnt(0)
v_mfma_f32_16x16x32_bf16 v[36:39], a[0:3], a[224:227], v[36:39]
ds_read_b128 a[36:39], v190 offset:27648
buffer_load_dwordx4 v1, s[8:11], s60 offen offset:1024 sc1 lds
v_mfma_f32_16x16x32_bf16 v[40:43], a[0:3], a[228:231], v[40:43]
ds_read_b128 a[40:43], v190 offset:28672
v_mul_f32 v112, v112, v186
v_mfma_f32_16x16x32_bf16 v[44:47], a[4:7], a[224:227], v[44:47]
ds_read_b128 a[44:47], v190 offset:29696
v_mul_f32 v113, v113, v187
v_mfma_f32_16x16x32_bf16 v[48:51], a[4:7], a[228:231], v[48:51]
ds_read_b128 a[48:51], v190 offset:30720
v_mul_f32 v114, v114, v188
v_mfma_f32_16x16x32_bf16 v[52:55], a[8:11], a[224:227], v[52:55]
ds_read_b128 a[52:55], v190 offset:31744
buffer_load_dwordx4 v1, s[8:11], s60 offen offset:2048 sc1 lds
v_mfma_f32_16x16x32_bf16 v[56:59], a[8:11], a[228:231], v[56:59]
ds_read_b128 a[56:59], v190 offset:32768
v_mul_f32 v115, v115, v189
v_mfma_f32_16x16x32_bf16 v[60:63], a[12:15], a[224:227], v[60:63]
ds_read_b128 a[60:63], v190 offset:33792
v_mul_f32 v182, v116, v116
v_mfma_f32_16x16x32_bf16 v[64:67], a[12:15], a[228:231], v[64:67]
ds_read_b128 a[64:67], v190 offset:34816
v_mfma_f32_16x16x32_bf16 v[68:71], a[16:19], a[224:227], v[68:71]
ds_read_b128 a[68:71], v190 offset:35840
buffer_load_dwordx4 v1, s[8:11], s60 offen offset:3072 sc1 lds
v_mfma_f32_16x16x32_bf16 v[72:75], a[16:19], a[228:231], v[72:75]
v_mul_f32 v183, v117, v117
v_mul_f32 v184, v118, v118
v_mfma_f32_16x16x32_bf16 v[76:79], a[20:23], a[224:227], v[76:79]
v_mfma_f32_16x16x32_bf16 v[80:83], a[20:23], a[228:231], v[80:83]
v_mul_f32 v185, v119, v119
v_mfma_f32_16x16x32_bf16 v[84:87], a[24:27], a[224:227], v[84:87]
buffer_load_dwordx4 a[144:147], v1, s[4:7], s52 offen offset:2048 sc1
v_mfma_f32_16x16x32_bf16 v[88:91], a[24:27], a[228:231], v[88:91]
v_fma_f32 v182, v182, v252, v250
v_mfma_f32_16x16x32_bf16 v[92:95], a[28:31], a[224:227], v[92:95]
v_fma_f32 v183, v183, v252, v250
v_mfma_f32_16x16x32_bf16 v[96:99], a[28:31], a[228:231], v[96:99]
v_mfma_f32_16x16x32_bf16 v[100:103], a[32:35], a[224:227], v[100:103]
v_fma_f32 v184, v184, v252, v250
v_mfma_f32_16x16x32_bf16 v[104:107], a[32:35], a[228:231], v[104:107]
s_waitcnt vmcnt(10) lgkmcnt(0)
s_barrier
v_mfma_f32_16x16x32_bf16 v[36:39], a[36:39], a[232:235], v[36:39]
ds_read_b128 a[0:3], v191 offset:0
buffer_load_dwordx4 a[148:151], v9, s[4:7], s52 offen offset:2048 sc1
v_mfma_f32_16x16x32_bf16 v[40:43], a[36:39], a[236:239], v[40:43]
ds_read_b128 a[4:7], v191 offset:1024
v_fma_f32 v185, v185, v252, v250
v_mfma_f32_16x16x32_bf16 v[44:47], a[40:43], a[232:235], v[44:47]
ds_read_b128 a[8:11], v191 offset:2048
buffer_load_dwordx4 a[152:155], v1, s[4:7], s52 offen offset:3072 sc1
v_mfma_f32_16x16x32_bf16 v[48:51], a[40:43], a[236:239], v[48:51]
ds_read_b128 a[12:15], v191 offset:3072
v_mul_f32 v182, v182, v116
v_mfma_f32_16x16x32_bf16 v[52:55], a[44:47], a[232:235], v[52:55]
ds_read_b128 a[16:19], v191 offset:4096
v_mul_f32 v183, v183, v117
v_mfma_f32_16x16x32_bf16 v[56:59], a[44:47], a[236:239], v[56:59]
ds_read_b128 a[20:23], v191 offset:5120
buffer_load_dwordx4 a[156:159], v9, s[4:7], s52 offen offset:3072 sc1
v_mfma_f32_16x16x32_bf16 v[60:63], a[48:51], a[232:235], v[60:63]
ds_read_b128 a[24:27], v191 offset:6144
v_mul_f32 v184, v184, v118
v_mfma_f32_16x16x32_bf16 v[64:67], a[48:51], a[236:239], v[64:67]
ds_read_b128 a[28:31], v191 offset:7168
v_mul_f32 v185, v185, v119
v_mfma_f32_16x16x32_bf16 v[68:71], a[52:55], a[232:235], v[68:71]
ds_read_b128 a[32:35], v191 offset:8192
s_add_u32 m0, s62, 53248
v_mfma_f32_16x16x32_bf16 v[72:75], a[52:55], a[236:239], v[72:75]
s_add_u32 s60, s60, 16384
v_exp_f32 v182, v182
v_mfma_f32_16x16x32_bf16 v[76:79], a[56:59], a[232:235], v[76:79]
v_mfma_f32_16x16x32_bf16 v[80:83], a[56:59], a[236:239], v[80:83]
v_exp_f32 v183, v183
v_mfma_f32_16x16x32_bf16 v[84:87], a[60:63], a[232:235], v[84:87]
v_mfma_f32_16x16x32_bf16 v[88:91], a[60:63], a[236:239], v[88:91]
v_mfma_f32_16x16x32_bf16 v[92:95], a[64:67], a[232:235], v[92:95]
buffer_load_dwordx4 v1, s[8:11], s60 offen offset:0 sc1 lds
v_mfma_f32_16x16x32_bf16 v[96:99], a[64:67], a[236:239], v[96:99]
v_exp_f32 v184, v184
v_mfma_f32_16x16x32_bf16 v[100:103], a[68:71], a[232:235], v[100:103]
v_mfma_f32_16x16x32_bf16 v[104:107], a[68:71], a[236:239], v[104:107]
s_waitcnt lgkmcnt(0)
v_mfma_f32_16x16x32_bf16 v[36:39], a[0:3], a[240:243], v[36:39]
ds_read_b128 a[36:39], v191 offset:9216
buffer_load_dwordx4 v1, s[8:11], s60 offen offset:1024 sc1 lds
v_mfma_f32_16x16x32_bf16 v[40:43], a[0:3], a[244:247], v[40:43]
ds_read_b128 a[40:43], v191 offset:10240
v_mfma_f32_16x16x32_bf16 v[44:47], a[4:7], a[240:243], v[44:47]
ds_read_b128 a[44:47], v191 offset:11264
buffer_load_dwordx4 v1, s[8:11], s60 offen offset:2048 sc1 lds
v_mfma_f32_16x16x32_bf16 v[48:51], a[4:7], a[244:247], v[48:51]
ds_read_b128 a[48:51], v191 offset:12288
v_mfma_f32_16x16x32_bf16 v[52:55], a[8:11], a[240:243], v[52:55]
ds_read_b128 a[52:55], v191 offset:13312
v_mfma_f32_16x16x32_bf16 v[56:59], a[8:11], a[244:247], v[56:59]
ds_read_b128 a[56:59], v191 offset:14336
buffer_load_dwordx4 v1, s[8:11], s60 offen offset:3072 sc1 lds
v_mfma_f32_16x16x32_bf16 v[60:63], a[12:15], a[240:243], v[60:63]
ds_read_b128 a[60:63], v191 offset:15360
v_mfma_f32_16x16x32_bf16 v[64:67], a[12:15], a[244:247], v[64:67]
ds_read_b128 a[64:67], v191 offset:16384
v_mfma_f32_16x16x32_bf16 v[68:71], a[16:19], a[240:243], v[68:71]
ds_read_b128 a[68:71], v191 offset:17408
s_add_u32 m0, s63, 69632
v_mfma_f32_16x16x32_bf16 v[72:75], a[16:19], a[244:247], v[72:75]
s_add_u32 s61, s61, 36864
v_exp_f32 v185, v185
v_mfma_f32_16x16x32_bf16 v[76:79], a[20:23], a[240:243], v[76:79]
v_fma_f32 v182, v182, v254, v254
v_fma_f32 v183, v183, v254, v254
v_mfma_f32_16x16x32_bf16 v[80:83], a[20:23], a[244:247], v[80:83]
v_fma_f32 v184, v184, v254, v254
v_fma_f32 v185, v185, v254, v254
v_mfma_f32_16x16x32_bf16 v[84:87], a[24:27], a[240:243], v[84:87]
v_rcp_f32 v182, v182
v_mfma_f32_16x16x32_bf16 v[88:91], a[24:27], a[244:247], v[88:91]
v_rcp_f32 v183, v183
v_mfma_f32_16x16x32_bf16 v[92:95], a[28:31], a[240:243], v[92:95]
buffer_load_dwordx4 v1, s[8:11], s61 offen offset:0 sc1 lds
v_mfma_f32_16x16x32_bf16 v[96:99], a[28:31], a[244:247], v[96:99]
v_rcp_f32 v184, v184
v_mfma_f32_16x16x32_bf16 v[100:103], a[32:35], a[240:243], v[100:103]
v_mfma_f32_16x16x32_bf16 v[104:107], a[32:35], a[244:247], v[104:107]
s_waitcnt lgkmcnt(0)
v_mfma_f32_16x16x32_bf16 v[36:39], a[36:39], a[248:251], v[36:39]
ds_read_b128 a[0:3], v191 offset:18432
s_add_u32 m0, s62, 73728
v_mfma_f32_16x16x32_bf16 v[40:43], a[36:39], a[252:255], v[40:43]
ds_read_b128 a[4:7], v191 offset:19456
v_mfma_f32_16x16x32_bf16 v[44:47], a[40:43], a[248:251], v[44:47]
ds_read_b128 a[8:11], v191 offset:20480
s_add_u32 s60, s60, 20480
v_mfma_f32_16x16x32_bf16 v[48:51], a[40:43], a[252:255], v[48:51]
ds_read_b128 a[12:15], v191 offset:21504
v_mfma_f32_16x16x32_bf16 v[52:55], a[44:47], a[248:251], v[52:55]
ds_read_b128 a[16:19], v191 offset:22528
v_mfma_f32_16x16x32_bf16 v[56:59], a[44:47], a[252:255], v[56:59]
ds_read_b128 a[20:23], v191 offset:23552
buffer_load_dwordx4 v1, s[8:11], s60 offen offset:0 sc1 lds
v_mfma_f32_16x16x32_bf16 v[60:63], a[48:51], a[248:251], v[60:63]
ds_read_b128 a[24:27], v191 offset:24576
v_mfma_f32_16x16x32_bf16 v[64:67], a[48:51], a[252:255], v[64:67]
ds_read_b128 a[28:31], v191 offset:25600
v_mfma_f32_16x16x32_bf16 v[68:71], a[52:55], a[248:251], v[68:71]
ds_read_b128 a[32:35], v191 offset:26624
buffer_load_dwordx4 v1, s[8:11], s60 offen offset:1024 sc1 lds
v_mfma_f32_16x16x32_bf16 v[72:75], a[52:55], a[252:255], v[72:75]
v_rcp_f32 v185, v185
v_mfma_f32_16x16x32_bf16 v[76:79], a[56:59], a[248:251], v[76:79]
v_mul_f32 v116, v116, v182
v_mul_f32 v117, v117, v183
v_mfma_f32_16x16x32_bf16 v[80:83], a[56:59], a[252:255], v[80:83]
buffer_load_dwordx4 v1, s[8:11], s60 offen offset:2048 sc1 lds
v_mul_f32 v118, v118, v184
v_mfma_f32_16x16x32_bf16 v[84:87], a[60:63], a[248:251], v[84:87]
v_mul_f32 v119, v119, v185
v_mul_f32 v186, v120, v120
v_mfma_f32_16x16x32_bf16 v[88:91], a[60:63], a[252:255], v[88:91]
v_mul_f32 v187, v121, v121
v_mul_f32 v188, v122, v122
v_mfma_f32_16x16x32_bf16 v[92:95], a[64:67], a[248:251], v[92:95]
buffer_load_dwordx4 v1, s[8:11], s60 offen offset:3072 sc1 lds
v_mul_f32 v189, v123, v123
v_mfma_f32_16x16x32_bf16 v[96:99], a[64:67], a[252:255], v[96:99]
v_mfma_f32_16x16x32_bf16 v[100:103], a[68:71], a[248:251], v[100:103]
v_fma_f32 v186, v186, v253, v251
v_mfma_f32_16x16x32_bf16 v[104:107], a[68:71], a[252:255], v[104:107]
s_waitcnt lgkmcnt(0)
v_mfma_f32_16x16x32_bf16 v[36:39], a[0:3], a[80:83], v[36:39]
ds_read_b128 a[36:39], v191 offset:27648
s_add_u32 s52, s52, 4096
v_mfma_f32_16x16x32_bf16 v[40:43], a[0:3], a[84:87], v[40:43]
ds_read_b128 a[40:43], v191 offset:28672
v_fma_f32 v187, v187, v253, v251
v_mfma_f32_16x16x32_bf16 v[44:47], a[4:7], a[80:83], v[44:47]
ds_read_b128 a[44:47], v191 offset:29696
v_fma_f32 v188, v188, v253, v251
v_mfma_f32_16x16x32_bf16 v[48:51], a[4:7], a[84:87], v[48:51]
ds_read_b128 a[48:51], v191 offset:30720
buffer_load_dwordx4 a[160:163], v1, s[4:7], s52 offen offset:0 sc1
v_mfma_f32_16x16x32_bf16 v[52:55], a[8:11], a[80:83], v[52:55]
ds_read_b128 a[52:55], v191 offset:31744
v_fma_f32 v189, v189, v253, v251
v_mfma_f32_16x16x32_bf16 v[56:59], a[8:11], a[84:87], v[56:59]
ds_read_b128 a[56:59], v191 offset:32768
v_mul_f32 v186, v186, v120
v_mfma_f32_16x16x32_bf16 v[60:63], a[12:15], a[80:83], v[60:63]
ds_read_b128 a[60:63], v191 offset:33792
buffer_load_dwordx4 a[164:167], v9, s[4:7], s52 offen offset:0 sc1
v_mfma_f32_16x16x32_bf16 v[64:67], a[12:15], a[84:87], v[64:67]
ds_read_b128 a[64:67], v191 offset:34816
v_mul_f32 v187, v187, v121
v_mfma_f32_16x16x32_bf16 v[68:71], a[16:19], a[80:83], v[68:71]
ds_read_b128 a[68:71], v191 offset:35840
v_mul_f32 v188, v188, v122
v_mfma_f32_16x16x32_bf16 v[72:75], a[16:19], a[84:87], v[72:75]
v_mul_f32 v189, v189, v123
v_mfma_f32_16x16x32_bf16 v[76:79], a[20:23], a[80:83], v[76:79]
buffer_load_dwordx4 a[168:171], v1, s[4:7], s52 offen offset:1024 sc1
v_mfma_f32_16x16x32_bf16 v[80:83], a[20:23], a[84:87], v[80:83]
v_exp_f32 v186, v186
v_mfma_f32_16x16x32_bf16 v[84:87], a[24:27], a[80:83], v[84:87]
v_mfma_f32_16x16x32_bf16 v[88:91], a[24:27], a[84:87], v[88:91]
buffer_load_dwordx4 a[172:175], v9, s[4:7], s52 offen offset:1024 sc1
v_mfma_f32_16x16x32_bf16 v[92:95], a[28:31], a[80:83], v[92:95]
v_exp_f32 v187, v187
v_mfma_f32_16x16x32_bf16 v[96:99], a[28:31], a[84:87], v[96:99]
v_mfma_f32_16x16x32_bf16 v[100:103], a[32:35], a[80:83], v[100:103]
v_mfma_f32_16x16x32_bf16 v[104:107], a[32:35], a[84:87], v[104:107]
s_waitcnt vmcnt(17) lgkmcnt(0)
s_barrier
v_mfma_f32_16x16x32_bf16 v[36:39], a[36:39], a[88:91], v[36:39]
ds_read_b128 a[0:3], v192 offset:0
s_add_u32 m0, s62, 90112
v_mfma_f32_16x16x32_bf16 v[40:43], a[36:39], a[92:95], v[40:43]
ds_read_b128 a[4:7], v192 offset:1024
v_mfma_f32_16x16x32_bf16 v[44:47], a[40:43], a[88:91], v[44:47]
ds_read_b128 a[8:11], v192 offset:2048
s_add_u32 s60, s60, 16384
v_mfma_f32_16x16x32_bf16 v[48:51], a[40:43], a[92:95], v[48:51]
ds_read_b128 a[12:15], v192 offset:3072
v_mfma_f32_16x16x32_bf16 v[52:55], a[44:47], a[88:91], v[52:55]
ds_read_b128 a[16:19], v192 offset:4096
v_mfma_f32_16x16x32_bf16 v[56:59], a[44:47], a[92:95], v[56:59]
ds_read_b128 a[20:23], v192 offset:5120
buffer_load_dwordx4 v1, s[8:11], s60 offen offset:0 sc1 lds
v_mfma_f32_16x16x32_bf16 v[60:63], a[48:51], a[88:91], v[60:63]
ds_read_b128 a[24:27], v192 offset:6144
v_mfma_f32_16x16x32_bf16 v[64:67], a[48:51], a[92:95], v[64:67]
ds_read_b128 a[28:31], v192 offset:7168
v_mfma_f32_16x16x32_bf16 v[68:71], a[52:55], a[88:91], v[68:71]
ds_read_b128 a[32:35], v192 offset:8192
buffer_load_dwordx4 v1, s[8:11], s60 offen offset:1024 sc1 lds
v_mfma_f32_16x16x32_bf16 v[72:75], a[52:55], a[92:95], v[72:75]
v_exp_f32 v188, v188
v_mfma_f32_16x16x32_bf16 v[76:79], a[56:59], a[88:91], v[76:79]
v_exp_f32 v189, v189
v_mfma_f32_16x16x32_bf16 v[80:83], a[56:59], a[92:95], v[80:83]
buffer_load_dwordx4 v1, s[8:11], s60 offen offset:2048 sc1 lds
v_fma_f32 v186, v186, v255, v255
v_mfma_f32_16x16x32_bf16 v[84:87], a[60:63], a[88:91], v[84:87]
v_fma_f32 v187, v187, v255, v255
v_fma_f32 v188, v188, v255, v255
v_mfma_f32_16x16x32_bf16 v[88:91], a[60:63], a[92:95], v[88:91]
v_fma_f32 v189, v189, v255, v255
v_mfma_f32_16x16x32_bf16 v[92:95], a[64:67], a[88:91], v[92:95]
buffer_load_dwordx4 v1, s[8:11], s60 offen offset:3072 sc1 lds
v_mfma_f32_16x16x32_bf16 v[96:99], a[64:67], a[92:95], v[96:99]
v_rcp_f32 v186, v186
v_mfma_f32_16x16x32_bf16 v[100:103], a[68:71], a[88:91], v[100:103]
v_rcp_f32 v187, v187
v_mfma_f32_16x16x32_bf16 v[104:107], a[68:71], a[92:95], v[104:107]
s_waitcnt lgkmcnt(0)
v_mfma_f32_16x16x32_bf16 v[36:39], a[0:3], a[96:99], v[36:39]
ds_read_b128 a[36:39], v192 offset:9216
s_add_u32 m0, s63, 106496
v_mfma_f32_16x16x32_bf16 v[40:43], a[0:3], a[100:103], v[40:43]
ds_read_b128 a[40:43], v192 offset:10240
v_mfma_f32_16x16x32_bf16 v[44:47], a[4:7], a[96:99], v[44:47]
ds_read_b128 a[44:47], v192 offset:11264
s_add_u32 s61, s61, 36864
v_mfma_f32_16x16x32_bf16 v[48:51], a[4:7], a[100:103], v[48:51]
ds_read_b128 a[48:51], v192 offset:12288
v_mfma_f32_16x16x32_bf16 v[52:55], a[8:11], a[96:99], v[52:55]
ds_read_b128 a[52:55], v192 offset:13312
buffer_load_dwordx4 v1, s[8:11], s61 offen offset:0 sc1 lds
v_mfma_f32_16x16x32_bf16 v[56:59], a[8:11], a[100:103], v[56:59]
ds_read_b128 a[56:59], v192 offset:14336
v_mfma_f32_16x16x32_bf16 v[60:63], a[12:15], a[96:99], v[60:63]
ds_read_b128 a[60:63], v192 offset:15360
s_add_u32 m0, s62, 110592
v_mfma_f32_16x16x32_bf16 v[64:67], a[12:15], a[100:103], v[64:67]
ds_read_b128 a[64:67], v192 offset:16384
v_mfma_f32_16x16x32_bf16 v[68:71], a[16:19], a[96:99], v[68:71]
ds_read_b128 a[68:71], v192 offset:17408
s_add_u32 s60, s60, 20480
v_mfma_f32_16x16x32_bf16 v[72:75], a[16:19], a[100:103], v[72:75]
v_rcp_f32 v188, v188
v_mfma_f32_16x16x32_bf16 v[76:79], a[20:23], a[96:99], v[76:79]
buffer_load_dwordx4 v1, s[8:11], s60 offen offset:0 sc1 lds
v_mfma_f32_16x16x32_bf16 v[80:83], a[20:23], a[100:103], v[80:83]
v_rcp_f32 v189, v189
v_mfma_f32_16x16x32_bf16 v[84:87], a[24:27], a[96:99], v[84:87]
buffer_load_dwordx4 v1, s[8:11], s60 offen offset:1024 sc1 lds
v_mul_f32 v120, v120, v186
v_mfma_f32_16x16x32_bf16 v[88:91], a[24:27], a[100:103], v[88:91]
v_mul_f32 v121, v121, v187
v_mul_f32 v122, v122, v188
v_mfma_f32_16x16x32_bf16 v[92:95], a[28:31], a[96:99], v[92:95]
buffer_load_dwordx4 v1, s[8:11], s60 offen offset:2048 sc1 lds
v_mul_f32 v123, v123, v189
v_mfma_f32_16x16x32_bf16 v[96:99], a[28:31], a[100:103], v[96:99]
v_mul_f32 v182, v124, v124
v_mul_f32 v183, v125, v125
v_mfma_f32_16x16x32_bf16 v[100:103], a[32:35], a[96:99], v[100:103]
v_mul_f32 v184, v126, v126
v_mfma_f32_16x16x32_bf16 v[104:107], a[32:35], a[100:103], v[104:107]
s_waitcnt lgkmcnt(0)
v_mfma_f32_16x16x32_bf16 v[36:39], a[36:39], a[104:107], v[36:39]
ds_read_b128 a[0:3], v192 offset:18432
buffer_load_dwordx4 v1, s[8:11], s60 offen offset:3072 sc1 lds
v_mfma_f32_16x16x32_bf16 v[40:43], a[36:39], a[108:111], v[40:43]
ds_read_b128 a[4:7], v192 offset:19456
v_mul_f32 v185, v127, v127
v_mfma_f32_16x16x32_bf16 v[44:47], a[40:43], a[104:107], v[44:47]
ds_read_b128 a[8:11], v192 offset:20480
v_fma_f32 v182, v182, v252, v250
v_mfma_f32_16x16x32_bf16 v[48:51], a[40:43], a[108:111], v[48:51]
ds_read_b128 a[12:15], v192 offset:21504
v_fma_f32 v183, v183, v252, v250
v_mfma_f32_16x16x32_bf16 v[52:55], a[44:47], a[104:107], v[52:55]
ds_read_b128 a[16:19], v192 offset:22528
buffer_load_dwordx4 a[176:179], v1, s[4:7], s52 offen offset:2048 sc1
v_mfma_f32_16x16x32_bf16 v[56:59], a[44:47], a[108:111], v[56:59]
ds_read_b128 a[20:23], v192 offset:23552
v_fma_f32 v184, v184, v252, v250
v_mfma_f32_16x16x32_bf16 v[60:63], a[48:51], a[104:107], v[60:63]
ds_read_b128 a[24:27], v192 offset:24576
v_fma_f32 v185, v185, v252, v250
v_mfma_f32_16x16x32_bf16 v[64:67], a[48:51], a[108:111], v[64:67]
ds_read_b128 a[28:31], v192 offset:25600
v_mfma_f32_16x16x32_bf16 v[68:71], a[52:55], a[104:107], v[68:71]
ds_read_b128 a[32:35], v192 offset:26624
buffer_load_dwordx4 a[180:183], v9, s[4:7], s52 offen offset:2048 sc1
v_mfma_f32_16x16x32_bf16 v[72:75], a[52:55], a[108:111], v[72:75]
v_mul_f32 v182, v182, v124
v_mul_f32 v183, v183, v125
v_mfma_f32_16x16x32_bf16 v[76:79], a[56:59], a[104:107], v[76:79]
v_mfma_f32_16x16x32_bf16 v[80:83], a[56:59], a[108:111], v[80:83]
v_mul_f32 v184, v184, v126
v_mfma_f32_16x16x32_bf16 v[84:87], a[60:63], a[104:107], v[84:87]
buffer_load_dwordx4 a[184:187], v1, s[4:7], s52 offen offset:3072 sc1
v_mfma_f32_16x16x32_bf16 v[88:91], a[60:63], a[108:111], v[88:91]
v_mul_f32 v185, v185, v127
v_mfma_f32_16x16x32_bf16 v[92:95], a[64:67], a[104:107], v[92:95]
v_exp_f32 v182, v182
v_mfma_f32_16x16x32_bf16 v[96:99], a[64:67], a[108:111], v[96:99]
v_mfma_f32_16x16x32_bf16 v[100:103], a[68:71], a[104:107], v[100:103]
v_mfma_f32_16x16x32_bf16 v[104:107], a[68:71], a[108:111], v[104:107]
s_waitcnt lgkmcnt(0)
v_mfma_f32_16x16x32_bf16 v[36:39], a[0:3], a[112:115], v[36:39]
ds_read_b128 a[36:39], v192 offset:27648
buffer_load_dwordx4 a[188:191], v9, s[4:7], s52 offen offset:3072 sc1
v_mfma_f32_16x16x32_bf16 v[40:43], a[0:3], a[116:119], v[40:43]
ds_read_b128 a[40:43], v192 offset:28672
v_mfma_f32_16x16x32_bf16 v[44:47], a[4:7], a[112:115], v[44:47]
ds_read_b128 a[44:47], v192 offset:29696
v_mfma_f32_16x16x32_bf16 v[48:51], a[4:7], a[116:119], v[48:51]
ds_read_b128 a[48:51], v192 offset:30720
s_add_u32 s52, s52, 4096
v_mfma_f32_16x16x32_bf16 v[52:55], a[8:11], a[112:115], v[52:55]
ds_read_b128 a[52:55], v192 offset:31744
v_mfma_f32_16x16x32_bf16 v[56:59], a[8:11], a[116:119], v[56:59]
ds_read_b128 a[56:59], v192 offset:32768
v_mfma_f32_16x16x32_bf16 v[60:63], a[12:15], a[112:115], v[60:63]
ds_read_b128 a[60:63], v192 offset:33792
buffer_load_dwordx4 a[192:195], v1, s[4:7], s52 offen offset:0 sc1
v_mfma_f32_16x16x32_bf16 v[64:67], a[12:15], a[116:119], v[64:67]
ds_read_b128 a[64:67], v192 offset:34816
v_mfma_f32_16x16x32_bf16 v[68:71], a[16:19], a[112:115], v[68:71]
ds_read_b128 a[68:71], v192 offset:35840
v_mfma_f32_16x16x32_bf16 v[72:75], a[16:19], a[116:119], v[72:75]
v_exp_f32 v183, v183
v_mfma_f32_16x16x32_bf16 v[76:79], a[20:23], a[112:115], v[76:79]
buffer_load_dwordx4 a[196:199], v9, s[4:7], s52 offen offset:0 sc1
v_mfma_f32_16x16x32_bf16 v[80:83], a[20:23], a[116:119], v[80:83]
v_exp_f32 v184, v184
v_mfma_f32_16x16x32_bf16 v[84:87], a[24:27], a[112:115], v[84:87]
v_exp_f32 v185, v185
v_mfma_f32_16x16x32_bf16 v[88:91], a[24:27], a[116:119], v[88:91]
buffer_load_dwordx4 a[200:203], v1, s[4:7], s52 offen offset:1024 sc1
v_fma_f32 v182, v182, v254, v254
v_mfma_f32_16x16x32_bf16 v[92:95], a[28:31], a[112:115], v[92:95]
v_fma_f32 v183, v183, v254, v254
v_fma_f32 v184, v184, v254, v254
v_mfma_f32_16x16x32_bf16 v[96:99], a[28:31], a[116:119], v[96:99]
v_fma_f32 v185, v185, v254, v254
v_mfma_f32_16x16x32_bf16 v[100:103], a[32:35], a[112:115], v[100:103]
v_rcp_f32 v182, v182
v_mfma_f32_16x16x32_bf16 v[104:107], a[32:35], a[116:119], v[104:107]
s_waitcnt vmcnt(20) lgkmcnt(0)
s_barrier
v_mfma_f32_16x16x32_bf16 v[36:39], a[36:39], a[120:123], v[36:39]
ds_read_b128 a[0:3], v190 offset:0
buffer_load_dwordx4 a[204:207], v9, s[4:7], s52 offen offset:1024 sc1
v_mfma_f32_16x16x32_bf16 v[40:43], a[36:39], a[124:127], v[40:43]
ds_read_b128 a[4:7], v190 offset:1024
v_mfma_f32_16x16x32_bf16 v[44:47], a[40:43], a[120:123], v[44:47]
ds_read_b128 a[8:11], v190 offset:2048
s_add_u32 m0, s62, 126976
v_mfma_f32_16x16x32_bf16 v[48:51], a[40:43], a[124:127], v[48:51]
ds_read_b128 a[12:15], v190 offset:3072
v_mfma_f32_16x16x32_bf16 v[52:55], a[44:47], a[120:123], v[52:55]
ds_read_b128 a[16:19], v190 offset:4096
v_mfma_f32_16x16x32_bf16 v[56:59], a[44:47], a[124:127], v[56:59]
ds_read_b128 a[20:23], v190 offset:5120
s_add_u32 s60, s60, 16384
v_mfma_f32_16x16x32_bf16 v[60:63], a[48:51], a[120:123], v[60:63]
ds_read_b128 a[24:27], v190 offset:6144
v_mfma_f32_16x16x32_bf16 v[64:67], a[48:51], a[124:127], v[64:67]
ds_read_b128 a[28:31], v190 offset:7168
v_mfma_f32_16x16x32_bf16 v[68:71], a[52:55], a[120:123], v[68:71]
ds_read_b128 a[32:35], v190 offset:8192
buffer_load_dwordx4 v1, s[8:11], s60 offen offset:0 sc1 lds
v_mfma_f32_16x16x32_bf16 v[72:75], a[52:55], a[124:127], v[72:75]
v_rcp_f32 v183, v183
v_mfma_f32_16x16x32_bf16 v[76:79], a[56:59], a[120:123], v[76:79]
v_rcp_f32 v184, v184
v_mfma_f32_16x16x32_bf16 v[80:83], a[56:59], a[124:127], v[80:83]
buffer_load_dwordx4 v1, s[8:11], s60 offen offset:1024 sc1 lds
v_mfma_f32_16x16x32_bf16 v[84:87], a[60:63], a[120:123], v[84:87]
v_rcp_f32 v185, v185
v_mfma_f32_16x16x32_bf16 v[88:91], a[60:63], a[124:127], v[88:91]
v_mul_f32 v124, v124, v182
v_mul_f32 v125, v125, v183
v_mfma_f32_16x16x32_bf16 v[92:95], a[64:67], a[120:123], v[92:95]
buffer_load_dwordx4 v1, s[8:11], s60 offen offset:2048 sc1 lds
v_mul_f32 v126, v126, v184
v_mfma_f32_16x16x32_bf16 v[96:99], a[64:67], a[124:127], v[96:99]
v_mul_f32 v127, v127, v185
v_mfma_f32_16x16x32_bf16 v[100:103], a[68:71], a[120:123], v[100:103]
v_mul_f32 v186, v128, v128
v_mfma_f32_16x16x32_bf16 v[104:107], a[68:71], a[124:127], v[104:107]
s_waitcnt lgkmcnt(0)
v_mfma_f32_16x16x32_bf16 v[36:39], a[0:3], a[128:131], v[36:39]
ds_read_b128 a[36:39], v190 offset:9216
buffer_load_dwordx4 v1, s[8:11], s60 offen offset:3072 sc1 lds
v_mfma_f32_16x16x32_bf16 v[40:43], a[0:3], a[132:135], v[40:43]
ds_read_b128 a[40:43], v190 offset:10240
v_mul_f32 v187, v129, v129
v_mfma_f32_16x16x32_bf16 v[44:47], a[4:7], a[128:131], v[44:47]
ds_read_b128 a[44:47], v190 offset:11264
s_add_u32 m0, s63, 143360
v_mfma_f32_16x16x32_bf16 v[48:51], a[4:7], a[132:135], v[48:51]
ds_read_b128 a[48:51], v190 offset:12288
v_mul_f32 v188, v130, v130
v_mfma_f32_16x16x32_bf16 v[52:55], a[8:11], a[128:131], v[52:55]
ds_read_b128 a[52:55], v190 offset:13312
s_add_u32 s61, s61, 36864
v_mfma_f32_16x16x32_bf16 v[56:59], a[8:11], a[132:135], v[56:59]
ds_read_b128 a[56:59], v190 offset:14336
v_mul_f32 v189, v131, v131
v_mfma_f32_16x16x32_bf16 v[60:63], a[12:15], a[128:131], v[60:63]
ds_read_b128 a[60:63], v190 offset:15360
buffer_load_dwordx4 v1, s[8:11], s61 offen offset:0 sc1 lds
v_mfma_f32_16x16x32_bf16 v[64:67], a[12:15], a[132:135], v[64:67]
ds_read_b128 a[64:67], v190 offset:16384
v_fma_f32 v186, v186, v253, v251
v_mfma_f32_16x16x32_bf16 v[68:71], a[16:19], a[128:131], v[68:71]
ds_read_b128 a[68:71], v190 offset:17408
s_add_u32 m0, s62, 147456
v_mfma_f32_16x16x32_bf16 v[72:75], a[16:19], a[132:135], v[72:75]
s_add_u32 s60, s60, 20480
v_fma_f32 v187, v187, v253, v251
v_fma_f32 v188, v188, v253, v251
v_mfma_f32_16x16x32_bf16 v[76:79], a[20:23], a[128:131], v[76:79]
v_fma_f32 v189, v189, v253, v251
v_mfma_f32_16x16x32_bf16 v[80:83], a[20:23], a[132:135], v[80:83]
v_mul_f32 v186, v186, v128
v_mfma_f32_16x16x32_bf16 v[84:87], a[24:27], a[128:131], v[84:87]
buffer_load_dwordx4 v1, s[8:11], s60 offen offset:0 sc1 lds
v_mfma_f32_16x16x32_bf16 v[88:91], a[24:27], a[132:135], v[88:91]
v_mul_f32 v187, v187, v129
v_mfma_f32_16x16x32_bf16 v[92:95], a[28:31], a[128:131], v[92:95]
buffer_load_dwordx4 v1, s[8:11], s60 offen offset:1024 sc1 lds
v_mul_f32 v188, v188, v130
v_mfma_f32_16x16x32_bf16 v[96:99], a[28:31], a[132:135], v[96:99]
v_mfma_f32_16x16x32_bf16 v[100:103], a[32:35], a[128:131], v[100:103]
v_mul_f32 v189, v189, v131
v_mfma_f32_16x16x32_bf16 v[104:107], a[32:35], a[132:135], v[104:107]
s_waitcnt lgkmcnt(0)
v_mfma_f32_16x16x32_bf16 v[36:39], a[36:39], a[136:139], v[36:39]
ds_read_b128 a[0:3], v190 offset:18432
buffer_load_dwordx4 v1, s[8:11], s60 offen offset:2048 sc1 lds
v_mfma_f32_16x16x32_bf16 v[40:43], a[36:39], a[140:143], v[40:43]
ds_read_b128 a[4:7], v190 offset:19456
v_mfma_f32_16x16x32_bf16 v[44:47], a[40:43], a[136:139], v[44:47]
ds_read_b128 a[8:11], v190 offset:20480
v_mfma_f32_16x16x32_bf16 v[48:51], a[40:43], a[140:143], v[48:51]
ds_read_b128 a[12:15], v190 offset:21504
v_mfma_f32_16x16x32_bf16 v[52:55], a[44:47], a[136:139], v[52:55]
ds_read_b128 a[16:19], v190 offset:22528
buffer_load_dwordx4 v1, s[8:11], s60 offen offset:3072 sc1 lds
v_mfma_f32_16x16x32_bf16 v[56:59], a[44:47], a[140:143], v[56:59]
ds_read_b128 a[20:23], v190 offset:23552
v_mfma_f32_16x16x32_bf16 v[60:63], a[48:51], a[136:139], v[60:63]
ds_read_b128 a[24:27], v190 offset:24576
v_mfma_f32_16x16x32_bf16 v[64:67], a[48:51], a[140:143], v[64:67]
ds_read_b128 a[28:31], v190 offset:25600
v_mfma_f32_16x16x32_bf16 v[68:71], a[52:55], a[136:139], v[68:71]
ds_read_b128 a[32:35], v190 offset:26624
buffer_load_dwordx4 a[208:211], v1, s[4:7], s52 offen offset:2048 sc1
v_mfma_f32_16x16x32_bf16 v[72:75], a[52:55], a[140:143], v[72:75]
v_exp_f32 v186, v186
v_mfma_f32_16x16x32_bf16 v[76:79], a[56:59], a[136:139], v[76:79]
v_exp_f32 v187, v187
v_mfma_f32_16x16x32_bf16 v[80:83], a[56:59], a[140:143], v[80:83]
v_exp_f32 v188, v188
v_mfma_f32_16x16x32_bf16 v[84:87], a[60:63], a[136:139], v[84:87]
buffer_load_dwordx4 a[212:215], v9, s[4:7], s52 offen offset:2048 sc1
v_mfma_f32_16x16x32_bf16 v[88:91], a[60:63], a[140:143], v[88:91]
v_exp_f32 v189, v189
v_mfma_f32_16x16x32_bf16 v[92:95], a[64:67], a[136:139], v[92:95]
v_fma_f32 v186, v186, v255, v255
v_fma_f32 v187, v187, v255, v255
v_mfma_f32_16x16x32_bf16 v[96:99], a[64:67], a[140:143], v[96:99]
v_fma_f32 v188, v188, v255, v255
v_mfma_f32_16x16x32_bf16 v[100:103], a[68:71], a[136:139], v[100:103]
v_mfma_f32_16x16x32_bf16 v[104:107], a[68:71], a[140:143], v[104:107]
v_fma_f32 v189, v189, v255, v255
s_waitcnt lgkmcnt(0)
v_mfma_f32_16x16x32_bf16 v[36:39], a[0:3], a[144:147], v[36:39]
ds_read_b128 a[36:39], v190 offset:27648
buffer_load_dwordx4 a[216:219], v1, s[4:7], s52 offen offset:3072 sc1
v_mfma_f32_16x16x32_bf16 v[40:43], a[0:3], a[148:151], v[40:43]
ds_read_b128 a[40:43], v190 offset:28672
v_mfma_f32_16x16x32_bf16 v[44:47], a[4:7], a[144:147], v[44:47]
ds_read_b128 a[44:47], v190 offset:29696
v_mfma_f32_16x16x32_bf16 v[48:51], a[4:7], a[148:151], v[48:51]
ds_read_b128 a[48:51], v190 offset:30720
buffer_load_dwordx4 a[220:223], v9, s[4:7], s52 offen offset:3072 sc1
v_mfma_f32_16x16x32_bf16 v[52:55], a[8:11], a[144:147], v[52:55]
ds_read_b128 a[52:55], v190 offset:31744
v_mfma_f32_16x16x32_bf16 v[56:59], a[8:11], a[148:151], v[56:59]
ds_read_b128 a[56:59], v190 offset:32768
v_mfma_f32_16x16x32_bf16 v[60:63], a[12:15], a[144:147], v[60:63]
ds_read_b128 a[60:63], v190 offset:33792
s_add_u32 s52, s52, 4096
v_mfma_f32_16x16x32_bf16 v[64:67], a[12:15], a[148:151], v[64:67]
ds_read_b128 a[64:67], v190 offset:34816
v_mfma_f32_16x16x32_bf16 v[68:71], a[16:19], a[144:147], v[68:71]
ds_read_b128 a[68:71], v190 offset:35840
v_mfma_f32_16x16x32_bf16 v[72:75], a[16:19], a[148:151], v[72:75]
v_rcp_f32 v186, v186
v_mfma_f32_16x16x32_bf16 v[76:79], a[20:23], a[144:147], v[76:79]
buffer_load_dwordx4 a[224:227], v1, s[4:7], s52 offen offset:0 sc1
v_mfma_f32_16x16x32_bf16 v[80:83], a[20:23], a[148:151], v[80:83]
v_rcp_f32 v187, v187
v_mfma_f32_16x16x32_bf16 v[84:87], a[24:27], a[144:147], v[84:87]
v_rcp_f32 v188, v188
v_mfma_f32_16x16x32_bf16 v[88:91], a[24:27], a[148:151], v[88:91]
buffer_load_dwordx4 a[228:231], v9, s[4:7], s52 offen offset:0 sc1
v_mfma_f32_16x16x32_bf16 v[92:95], a[28:31], a[144:147], v[92:95]
v_rcp_f32 v189, v189
v_mfma_f32_16x16x32_bf16 v[96:99], a[28:31], a[148:151], v[96:99]
v_mul_f32 v128, v128, v186
v_mul_f32 v129, v129, v187
v_mfma_f32_16x16x32_bf16 v[100:103], a[32:35], a[144:147], v[100:103]
v_mfma_f32_16x16x32_bf16 v[104:107], a[32:35], a[148:151], v[104:107]
s_waitcnt vmcnt(23) lgkmcnt(0)
s_barrier
v_mfma_f32_16x16x32_bf16 v[36:39], a[36:39], a[152:155], v[36:39]
ds_read_b128 a[0:3], v191 offset:0
buffer_load_dwordx4 a[232:235], v1, s[4:7], s52 offen offset:1024 sc1
v_mfma_f32_16x16x32_bf16 v[40:43], a[36:39], a[156:159], v[40:43]
ds_read_b128 a[4:7], v191 offset:1024
v_mul_f32 v130, v130, v188
v_mfma_f32_16x16x32_bf16 v[44:47], a[40:43], a[152:155], v[44:47]
ds_read_b128 a[8:11], v191 offset:2048
buffer_load_dwordx4 a[236:239], v9, s[4:7], s52 offen offset:1024 sc1
v_mfma_f32_16x16x32_bf16 v[48:51], a[40:43], a[156:159], v[48:51]
ds_read_b128 a[12:15], v191 offset:3072
v_mul_f32 v131, v131, v189
v_mfma_f32_16x16x32_bf16 v[52:55], a[44:47], a[152:155], v[52:55]
ds_read_b128 a[16:19], v191 offset:4096
v_mul_f32 v182, v132, v132
v_mfma_f32_16x16x32_bf16 v[56:59], a[44:47], a[156:159], v[56:59]
ds_read_b128 a[20:23], v191 offset:5120
s_add_u32 m0, s62, 53248
v_mfma_f32_16x16x32_bf16 v[60:63], a[48:51], a[152:155], v[60:63]
ds_read_b128 a[24:27], v191 offset:6144
v_mul_f32 v183, v133, v133
v_mfma_f32_16x16x32_bf16 v[64:67], a[48:51], a[156:159], v[64:67]
ds_read_b128 a[28:31], v191 offset:7168
v_mul_f32 v184, v134, v134
v_mfma_f32_16x16x32_bf16 v[68:71], a[52:55], a[152:155], v[68:71]
ds_read_b128 a[32:35], v191 offset:8192
s_add_u32 s60, s60, 16384
v_mfma_f32_16x16x32_bf16 v[72:75], a[52:55], a[156:159], v[72:75]
v_mul_f32 v185, v135, v135
v_fma_f32 v182, v182, v252, v250
v_mfma_f32_16x16x32_bf16 v[76:79], a[56:59], a[152:155], v[76:79]
v_fma_f32 v183, v183, v252, v250
v_mfma_f32_16x16x32_bf16 v[80:83], a[56:59], a[156:159], v[80:83]
buffer_load_dwordx4 v1, s[8:11], s60 offen offset:0 sc1 lds
v_fma_f32 v184, v184, v252, v250
v_mfma_f32_16x16x32_bf16 v[84:87], a[60:63], a[152:155], v[84:87]
v_mfma_f32_16x16x32_bf16 v[88:91], a[60:63], a[156:159], v[88:91]
v_fma_f32 v185, v185, v252, v250
v_mfma_f32_16x16x32_bf16 v[92:95], a[64:67], a[152:155], v[92:95]
buffer_load_dwordx4 v1, s[8:11], s60 offen offset:1024 sc1 lds
v_mul_f32 v182, v182, v132
v_mfma_f32_16x16x32_bf16 v[96:99], a[64:67], a[156:159], v[96:99]
v_mfma_f32_16x16x32_bf16 v[100:103], a[68:71], a[152:155], v[100:103]
v_mul_f32 v183, v183, v133
v_mfma_f32_16x16x32_bf16 v[104:107], a[68:71], a[156:159], v[104:107]
s_waitcnt lgkmcnt(0)
v_mfma_f32_16x16x32_bf16 v[36:39], a[0:3], a[160:163], v[36:39]
ds_read_b128 a[36:39], v191 offset:9216
buffer_load_dwordx4 v1, s[8:11], s60 offen offset:2048 sc1 lds
v_mfma_f32_16x16x32_bf16 v[40:43], a[0:3], a[164:167], v[40:43]
ds_read_b128 a[40:43], v191 offset:10240
v_mul_f32 v184, v184, v134
v_mfma_f32_16x16x32_bf16 v[44:47], a[4:7], a[160:163], v[44:47]
ds_read_b128 a[44:47], v191 offset:11264
buffer_load_dwordx4 v1, s[8:11], s60 offen offset:3072 sc1 lds
v_mfma_f32_16x16x32_bf16 v[48:51], a[4:7], a[164:167], v[48:51]
ds_read_b128 a[48:51], v191 offset:12288
v_mul_f32 v185, v185, v135
v_mfma_f32_16x16x32_bf16 v[52:55], a[8:11], a[160:163], v[52:55]
ds_read_b128 a[52:55], v191 offset:13312
s_add_u32 m0, s63, 69632
v_mfma_f32_16x16x32_bf16 v[56:59], a[8:11], a[164:167], v[56:59]
ds_read_b128 a[56:59], v191 offset:14336
v_mfma_f32_16x16x32_bf16 v[60:63], a[12:15], a[160:163], v[60:63]
ds_read_b128 a[60:63], v191 offset:15360
s_add_u32 s61, s61, 36864
v_mfma_f32_16x16x32_bf16 v[64:67], a[12:15], a[164:167], v[64:67]
ds_read_b128 a[64:67], v191 offset:16384
v_mfma_f32_16x16x32_bf16 v[68:71], a[16:19], a[160:163], v[68:71]
ds_read_b128 a[68:71], v191 offset:17408
buffer_load_dwordx4 v1, s[8:11], s61 offen offset:0 sc1 lds
v_mfma_f32_16x16x32_bf16 v[72:75], a[16:19], a[164:167], v[72:75]
s_add_u32 m0, s62, 73728
v_exp_f32 v182, v182
v_mfma_f32_16x16x32_bf16 v[76:79], a[20:23], a[160:163], v[76:79]
s_add_u32 s60, s60, 20480
v_exp_f32 v183, v183
v_mfma_f32_16x16x32_bf16 v[80:83], a[20:23], a[164:167], v[80:83]
v_exp_f32 v184, v184
v_mfma_f32_16x16x32_bf16 v[84:87], a[24:27], a[160:163], v[84:87]
v_exp_f32 v185, v185
v_mfma_f32_16x16x32_bf16 v[88:91], a[24:27], a[164:167], v[88:91]
v_mfma_f32_16x16x32_bf16 v[92:95], a[28:31], a[160:163], v[92:95]
buffer_load_dwordx4 v1, s[8:11], s60 offen offset:0 sc1 lds
v_mfma_f32_16x16x32_bf16 v[96:99], a[28:31], a[164:167], v[96:99]
v_mfma_f32_16x16x32_bf16 v[100:103], a[32:35], a[160:163], v[100:103]
v_fma_f32 v182, v182, v254, v254
v_mfma_f32_16x16x32_bf16 v[104:107], a[32:35], a[164:167], v[104:107]
v_fma_f32 v183, v183, v254, v254
s_waitcnt vmcnt(27) lgkmcnt(0)
v_mfma_f32_16x16x32_bf16 v[36:39], a[36:39], a[168:171], v[36:39]
ds_read_b128 a[0:3], v191 offset:18432
buffer_load_dwordx4 v1, s[8:11], s60 offen offset:1024 sc1 lds
v_mfma_f32_16x16x32_bf16 v[40:43], a[36:39], a[172:175], v[40:43]
ds_read_b128 a[4:7], v191 offset:19456
v_fma_f32 v184, v184, v254, v254
v_mfma_f32_16x16x32_bf16 v[44:47], a[40:43], a[168:171], v[44:47]
ds_read_b128 a[8:11], v191 offset:20480
v_fma_f32 v185, v185, v254, v254
v_mfma_f32_16x16x32_bf16 v[48:51], a[40:43], a[172:175], v[48:51]
ds_read_b128 a[12:15], v191 offset:21504
v_mfma_f32_16x16x32_bf16 v[52:55], a[44:47], a[168:171], v[52:55]
ds_read_b128 a[16:19], v191 offset:22528
buffer_load_dwordx4 v1, s[8:11], s60 offen offset:2048 sc1 lds
v_mfma_f32_16x16x32_bf16 v[56:59], a[44:47], a[172:175], v[56:59]
ds_read_b128 a[20:23], v191 offset:23552
v_mfma_f32_16x16x32_bf16 v[60:63], a[48:51], a[168:171], v[60:63]
ds_read_b128 a[24:27], v191 offset:24576
v_mfma_f32_16x16x32_bf16 v[64:67], a[48:51], a[172:175], v[64:67]
ds_read_b128 a[28:31], v191 offset:25600
v_mfma_f32_16x16x32_bf16 v[68:71], a[52:55], a[168:171], v[68:71]
ds_read_b128 a[32:35], v191 offset:26624
buffer_load_dwordx4 v1, s[8:11], s60 offen offset:3072 sc1 lds
v_mfma_f32_16x16x32_bf16 v[72:75], a[52:55], a[172:175], v[72:75]
v_rcp_f32 v182, v182
v_mfma_f32_16x16x32_bf16 v[76:79], a[56:59], a[168:171], v[76:79]
v_rcp_f32 v183, v183
v_mfma_f32_16x16x32_bf16 v[80:83], a[56:59], a[172:175], v[80:83]
v_rcp_f32 v184, v184
v_mfma_f32_16x16x32_bf16 v[84:87], a[60:63], a[168:171], v[84:87]
buffer_load_dwordx4 a[240:243], v1, s[4:7], s52 offen offset:2048 sc1
v_mfma_f32_16x16x32_bf16 v[88:91], a[60:63], a[172:175], v[88:91]
v_mfma_f32_16x16x32_bf16 v[92:95], a[64:67], a[168:171], v[92:95]
v_rcp_f32 v185, v185
v_mfma_f32_16x16x32_bf16 v[96:99], a[64:67], a[172:175], v[96:99]
v_mfma_f32_16x16x32_bf16 v[100:103], a[68:71], a[168:171], v[100:103]
v_mfma_f32_16x16x32_bf16 v[104:107], a[68:71], a[172:175], v[104:107]
v_mul_f32 v132, v132, v182
s_waitcnt lgkmcnt(0)
v_mfma_f32_16x16x32_bf16 v[36:39], a[0:3], a[176:179], v[36:39]
ds_read_b128 a[36:39], v191 offset:27648
buffer_load_dwordx4 a[244:247], v9, s[4:7], s52 offen offset:2048 sc1
v_mfma_f32_16x16x32_bf16 v[40:43], a[0:3], a[180:183], v[40:43]
ds_read_b128 a[40:43], v191 offset:28672
v_mul_f32 v133, v133, v183
v_mfma_f32_16x16x32_bf16 v[44:47], a[4:7], a[176:179], v[44:47]
ds_read_b128 a[44:47], v191 offset:29696
v_mul_f32 v134, v134, v184
v_mfma_f32_16x16x32_bf16 v[48:51], a[4:7], a[180:183], v[48:51]
ds_read_b128 a[48:51], v191 offset:30720
buffer_load_dwordx4 a[248:251], v1, s[4:7], s52 offen offset:3072 sc1
v_mfma_f32_16x16x32_bf16 v[52:55], a[8:11], a[176:179], v[52:55]
ds_read_b128 a[52:55], v191 offset:31744
v_mul_f32 v135, v135, v185
v_mfma_f32_16x16x32_bf16 v[56:59], a[8:11], a[180:183], v[56:59]
ds_read_b128 a[56:59], v191 offset:32768
v_mul_f32 v186, v136, v136
v_mfma_f32_16x16x32_bf16 v[60:63], a[12:15], a[176:179], v[60:63]
ds_read_b128 a[60:63], v191 offset:33792
buffer_load_dwordx4 a[252:255], v9, s[4:7], s52 offen offset:3072 sc1
v_mfma_f32_16x16x32_bf16 v[64:67], a[12:15], a[180:183], v[64:67]
ds_read_b128 a[64:67], v191 offset:34816
v_mul_f32 v187, v137, v137
v_mfma_f32_16x16x32_bf16 v[68:71], a[16:19], a[176:179], v[68:71]
ds_read_b128 a[68:71], v191 offset:35840
v_mul_f32 v188, v138, v138
v_mfma_f32_16x16x32_bf16 v[72:75], a[16:19], a[180:183], v[72:75]
s_add_u32 s52, s52, 4096
v_mfma_f32_16x16x32_bf16 v[76:79], a[20:23], a[176:179], v[76:79]
v_mul_f32 v189, v139, v139
v_mfma_f32_16x16x32_bf16 v[80:83], a[20:23], a[180:183], v[80:83]
v_fma_f32 v186, v186, v253, v251
v_mfma_f32_16x16x32_bf16 v[84:87], a[24:27], a[176:179], v[84:87]
v_mfma_f32_16x16x32_bf16 v[88:91], a[24:27], a[180:183], v[88:91]
buffer_load_dwordx4 a[80:83], v1, s[4:7], s52 offen offset:0 sc1
v_fma_f32 v187, v187, v253, v251
v_mfma_f32_16x16x32_bf16 v[92:95], a[28:31], a[176:179], v[92:95]
v_mfma_f32_16x16x32_bf16 v[96:99], a[28:31], a[180:183], v[96:99]
v_fma_f32 v188, v188, v253, v251
v_mfma_f32_16x16x32_bf16 v[100:103], a[32:35], a[176:179], v[100:103]
v_fma_f32 v189, v189, v253, v251
v_mfma_f32_16x16x32_bf16 v[104:107], a[32:35], a[180:183], v[104:107]
s_waitcnt vmcnt(22) lgkmcnt(0)
s_barrier
v_mfma_f32_16x16x32_bf16 v[36:39], a[36:39], a[184:187], v[36:39]
ds_read_b128 a[0:3], v192 offset:0
buffer_load_dwordx4 a[84:87], v9, s[4:7], s52 offen offset:0 sc1
v_mfma_f32_16x16x32_bf16 v[40:43], a[36:39], a[188:191], v[40:43]
ds_read_b128 a[4:7], v192 offset:1024
v_mul_f32 v186, v186, v136
v_mfma_f32_16x16x32_bf16 v[44:47], a[40:43], a[184:187], v[44:47]
ds_read_b128 a[8:11], v192 offset:2048
buffer_load_dwordx4 a[88:91], v1, s[4:7], s52 offen offset:1024 sc1
v_mfma_f32_16x16x32_bf16 v[48:51], a[40:43], a[188:191], v[48:51]
ds_read_b128 a[12:15], v192 offset:3072
v_mul_f32 v187, v187, v137
v_mfma_f32_16x16x32_bf16 v[52:55], a[44:47], a[184:187], v[52:55]
ds_read_b128 a[16:19], v192 offset:4096
v_mul_f32 v188, v188, v138
v_mfma_f32_16x16x32_bf16 v[56:59], a[44:47], a[188:191], v[56:59]
ds_read_b128 a[20:23], v192 offset:5120
buffer_load_dwordx4 a[92:95], v9, s[4:7], s52 offen offset:1024 sc1
v_mfma_f32_16x16x32_bf16 v[60:63], a[48:51], a[184:187], v[60:63]
ds_read_b128 a[24:27], v192 offset:6144
v_mul_f32 v189, v189, v139
v_mfma_f32_16x16x32_bf16 v[64:67], a[48:51], a[188:191], v[64:67]
ds_read_b128 a[28:31], v192 offset:7168
v_mfma_f32_16x16x32_bf16 v[68:71], a[52:55], a[184:187], v[68:71]
ds_read_b128 a[32:35], v192 offset:8192
s_add_u32 m0, s62, 90112
v_mfma_f32_16x16x32_bf16 v[72:75], a[52:55], a[188:191], v[72:75]
s_add_u32 s60, s60, 16384
v_exp_f32 v186, v186
v_mfma_f32_16x16x32_bf16 v[76:79], a[56:59], a[184:187], v[76:79]
v_exp_f32 v187, v187
v_mfma_f32_16x16x32_bf16 v[80:83], a[56:59], a[188:191], v[80:83]
v_mfma_f32_16x16x32_bf16 v[84:87], a[60:63], a[184:187], v[84:87]
v_mfma_f32_16x16x32_bf16 v[88:91], a[60:63], a[188:191], v[88:91]
v_exp_f32 v188, v188
v_mfma_f32_16x16x32_bf16 v[92:95], a[64:67], a[184:187], v[92:95]
buffer_load_dwordx4 v1, s[8:11], s60 offen offset:0 sc1 lds
v_mfma_f32_16x16x32_bf16 v[96:99], a[64:67], a[188:191], v[96:99]
v_mfma_f32_16x16x32_bf16 v[100:103], a[68:71], a[184:187], v[100:103]
v_exp_f32 v189, v189
v_mfma_f32_16x16x32_bf16 v[104:107], a[68:71], a[188:191], v[104:107]
s_waitcnt lgkmcnt(0)
v_mfma_f32_16x16x32_bf16 v[36:39], a[0:3], a[192:195], v[36:39]
ds_read_b128 a[36:39], v192 offset:9216
buffer_load_dwordx4 v1, s[8:11], s60 offen offset:1024 sc1 lds
v_mfma_f32_16x16x32_bf16 v[40:43], a[0:3], a[196:199], v[40:43]
ds_read_b128 a[40:43], v192 offset:10240
v_fma_f32 v186, v186, v255, v255
v_mfma_f32_16x16x32_bf16 v[44:47], a[4:7], a[192:195], v[44:47]
ds_read_b128 a[44:47], v192 offset:11264
buffer_load_dwordx4 v1, s[8:11], s60 offen offset:2048 sc1 lds
v_mfma_f32_16x16x32_bf16 v[48:51], a[4:7], a[196:199], v[48:51]
ds_read_b128 a[48:51], v192 offset:12288
v_fma_f32 v187, v187, v255, v255
v_mfma_f32_16x16x32_bf16 v[52:55], a[8:11], a[192:195], v[52:55]
ds_read_b128 a[52:55], v192 offset:13312
v_fma_f32 v188, v188, v255, v255
v_mfma_f32_16x16x32_bf16 v[56:59], a[8:11], a[196:199], v[56:59]
ds_read_b128 a[56:59], v192 offset:14336
buffer_load_dwordx4 v1, s[8:11], s60 offen offset:3072 sc1 lds
v_mfma_f32_16x16x32_bf16 v[60:63], a[12:15], a[192:195], v[60:63]
ds_read_b128 a[60:63], v192 offset:15360
v_fma_f32 v189, v189, v255, v255
v_mfma_f32_16x16x32_bf16 v[64:67], a[12:15], a[196:199], v[64:67]
ds_read_b128 a[64:67], v192 offset:16384
v_mfma_f32_16x16x32_bf16 v[68:71], a[16:19], a[192:195], v[68:71]
ds_read_b128 a[68:71], v192 offset:17408
s_add_u32 m0, s63, 106496
v_mfma_f32_16x16x32_bf16 v[72:75], a[16:19], a[196:199], v[72:75]
s_add_u32 s61, s61, 36864
v_rcp_f32 v186, v186
v_mfma_f32_16x16x32_bf16 v[76:79], a[20:23], a[192:195], v[76:79]
v_mfma_f32_16x16x32_bf16 v[80:83], a[20:23], a[196:199], v[80:83]
v_rcp_f32 v187, v187
v_mfma_f32_16x16x32_bf16 v[84:87], a[24:27], a[192:195], v[84:87]
v_mfma_f32_16x16x32_bf16 v[88:91], a[24:27], a[196:199], v[88:91]
v_mfma_f32_16x16x32_bf16 v[92:95], a[28:31], a[192:195], v[92:95]
buffer_load_dwordx4 v1, s[8:11], s61 offen offset:0 sc1 lds
v_mfma_f32_16x16x32_bf16 v[96:99], a[28:31], a[196:199], v[96:99]
v_rcp_f32 v188, v188
v_mfma_f32_16x16x32_bf16 v[100:103], a[32:35], a[192:195], v[100:103]
v_mfma_f32_16x16x32_bf16 v[104:107], a[32:35], a[196:199], v[104:107]
s_waitcnt vmcnt(26) lgkmcnt(0)
v_mfma_f32_16x16x32_bf16 v[36:39], a[36:39], a[200:203], v[36:39]
ds_read_b128 a[0:3], v192 offset:18432
s_add_u32 m0, s62, 110592
v_mfma_f32_16x16x32_bf16 v[40:43], a[36:39], a[204:207], v[40:43]
ds_read_b128 a[4:7], v192 offset:19456
v_mfma_f32_16x16x32_bf16 v[44:47], a[40:43], a[200:203], v[44:47]
ds_read_b128 a[8:11], v192 offset:20480
s_add_u32 s60, s60, 20480
v_mfma_f32_16x16x32_bf16 v[48:51], a[40:43], a[204:207], v[48:51]
ds_read_b128 a[12:15], v192 offset:21504
v_mfma_f32_16x16x32_bf16 v[52:55], a[44:47], a[200:203], v[52:55]
ds_read_b128 a[16:19], v192 offset:22528
v_mfma_f32_16x16x32_bf16 v[56:59], a[44:47], a[204:207], v[56:59]
ds_read_b128 a[20:23], v192 offset:23552
buffer_load_dwordx4 v1, s[8:11], s60 offen offset:0 sc1 lds
v_mfma_f32_16x16x32_bf16 v[60:63], a[48:51], a[200:203], v[60:63]
ds_read_b128 a[24:27], v192 offset:24576
v_mfma_f32_16x16x32_bf16 v[64:67], a[48:51], a[204:207], v[64:67]
ds_read_b128 a[28:31], v192 offset:25600
v_mfma_f32_16x16x32_bf16 v[68:71], a[52:55], a[200:203], v[68:71]
ds_read_b128 a[32:35], v192 offset:26624
buffer_load_dwordx4 v1, s[8:11], s60 offen offset:1024 sc1 lds
v_mfma_f32_16x16x32_bf16 v[72:75], a[52:55], a[204:207], v[72:75]
v_rcp_f32 v189, v189
v_mfma_f32_16x16x32_bf16 v[76:79], a[56:59], a[200:203], v[76:79]
v_mul_f32 v136, v136, v186
v_mul_f32 v137, v137, v187
v_mfma_f32_16x16x32_bf16 v[80:83], a[56:59], a[204:207], v[80:83]
buffer_load_dwordx4 v1, s[8:11], s60 offen offset:2048 sc1 lds
v_mul_f32 v138, v138, v188
v_mfma_f32_16x16x32_bf16 v[84:87], a[60:63], a[200:203], v[84:87]
v_mul_f32 v139, v139, v189
v_mul_f32 v182, v140, v140
v_mfma_f32_16x16x32_bf16 v[88:91], a[60:63], a[204:207], v[88:91]
v_mul_f32 v183, v141, v141
v_mul_f32 v184, v142, v142
v_mfma_f32_16x16x32_bf16 v[92:95], a[64:67], a[200:203], v[92:95]
buffer_load_dwordx4 v1, s[8:11], s60 offen offset:3072 sc1 lds
v_mul_f32 v185, v143, v143
v_mfma_f32_16x16x32_bf16 v[96:99], a[64:67], a[204:207], v[96:99]
v_fma_f32 v182, v182, v252, v250
v_mfma_f32_16x16x32_bf16 v[100:103], a[68:71], a[200:203], v[100:103]
v_fma_f32 v183, v183, v252, v250
v_mfma_f32_16x16x32_bf16 v[104:107], a[68:71], a[204:207], v[104:107]
s_waitcnt lgkmcnt(0)
v_mfma_f32_16x16x32_bf16 v[36:39], a[0:3], a[208:211], v[36:39]
ds_read_b128 a[36:39], v192 offset:27648
buffer_load_dwordx4 a[96:99], v1, s[4:7], s52 offen offset:2048 sc1
v_mfma_f32_16x16x32_bf16 v[40:43], a[0:3], a[212:215], v[40:43]
ds_read_b128 a[40:43], v192 offset:28672
v_fma_f32 v184, v184, v252, v250
v_mfma_f32_16x16x32_bf16 v[44:47], a[4:7], a[208:211], v[44:47]
ds_read_b128 a[44:47], v192 offset:29696
v_fma_f32 v185, v185, v252, v250
v_mfma_f32_16x16x32_bf16 v[48:51], a[4:7], a[212:215], v[48:51]
ds_read_b128 a[48:51], v192 offset:30720
v_mul_f32 v182, v182, v140
v_mfma_f32_16x16x32_bf16 v[52:55], a[8:11], a[208:211], v[52:55]
ds_read_b128 a[52:55], v192 offset:31744
buffer_load_dwordx4 a[100:103], v9, s[4:7], s52 offen offset:2048 sc1
v_mfma_f32_16x16x32_bf16 v[56:59], a[8:11], a[212:215], v[56:59]
ds_read_b128 a[56:59], v192 offset:32768
v_mul_f32 v183, v183, v141
v_mfma_f32_16x16x32_bf16 v[60:63], a[12:15], a[208:211], v[60:63]
ds_read_b128 a[60:63], v192 offset:33792
v_mul_f32 v184, v184, v142
v_mfma_f32_16x16x32_bf16 v[64:67], a[12:15], a[212:215], v[64:67]
ds_read_b128 a[64:67], v192 offset:34816
v_mfma_f32_16x16x32_bf16 v[68:71], a[16:19], a[208:211], v[68:71]
ds_read_b128 a[68:71], v192 offset:35840
buffer_load_dwordx4 a[104:107], v1, s[4:7], s52 offen offset:3072 sc1
v_mfma_f32_16x16x32_bf16 v[72:75], a[16:19], a[212:215], v[72:75]
v_mul_f32 v185, v185, v143
v_mfma_f32_16x16x32_bf16 v[76:79], a[20:23], a[208:211], v[76:79]
v_exp_f32 v182, v182
v_mfma_f32_16x16x32_bf16 v[80:83], a[20:23], a[212:215], v[80:83]
v_mfma_f32_16x16x32_bf16 v[84:87], a[24:27], a[208:211], v[84:87]
buffer_load_dwordx4 a[108:111], v9, s[4:7], s52 offen offset:3072 sc1
v_mfma_f32_16x16x32_bf16 v[88:91], a[24:27], a[212:215], v[88:91]
v_exp_f32 v183, v183
v_mfma_f32_16x16x32_bf16 v[92:95], a[28:31], a[208:211], v[92:95]
v_mfma_f32_16x16x32_bf16 v[96:99], a[28:31], a[212:215], v[96:99]
v_mfma_f32_16x16x32_bf16 v[100:103], a[32:35], a[208:211], v[100:103]
v_exp_f32 v184, v184
v_mfma_f32_16x16x32_bf16 v[104:107], a[32:35], a[212:215], v[104:107]
s_waitcnt vmcnt(21) lgkmcnt(0)
s_barrier
v_mfma_f32_16x16x32_bf16 v[36:39], a[36:39], a[216:219], v[36:39]
ds_read_b128 a[0:3], v190 offset:0
s_add_u32 m0, s62, 126976
v_mfma_f32_16x16x32_bf16 v[40:43], a[36:39], a[220:223], v[40:43]
ds_read_b128 a[4:7], v190 offset:1024
v_mfma_f32_16x16x32_bf16 v[44:47], a[40:43], a[216:219], v[44:47]
ds_read_b128 a[8:11], v190 offset:2048
s_add_u32 s60, s60, 16384
v_mfma_f32_16x16x32_bf16 v[48:51], a[40:43], a[220:223], v[48:51]
ds_read_b128 a[12:15], v190 offset:3072
v_mfma_f32_16x16x32_bf16 v[52:55], a[44:47], a[216:219], v[52:55]
ds_read_b128 a[16:19], v190 offset:4096
v_mfma_f32_16x16x32_bf16 v[56:59], a[44:47], a[220:223], v[56:59]
ds_read_b128 a[20:23], v190 offset:5120
buffer_load_dwordx4 v1, s[8:11], s60 offen offset:0 sc1 lds
v_mfma_f32_16x16x32_bf16 v[60:63], a[48:51], a[216:219], v[60:63]
ds_read_b128 a[24:27], v190 offset:6144
v_mfma_f32_16x16x32_bf16 v[64:67], a[48:51], a[220:223], v[64:67]
ds_read_b128 a[28:31], v190 offset:7168
v_mfma_f32_16x16x32_bf16 v[68:71], a[52:55], a[216:219], v[68:71]
ds_read_b128 a[32:35], v190 offset:8192
buffer_load_dwordx4 v1, s[8:11], s60 offen offset:1024 sc1 lds
v_mfma_f32_16x16x32_bf16 v[72:75], a[52:55], a[220:223], v[72:75]
v_exp_f32 v185, v185
v_mfma_f32_16x16x32_bf16 v[76:79], a[56:59], a[216:219], v[76:79]
v_fma_f32 v182, v182, v254, v254
v_fma_f32 v183, v183, v254, v254
v_mfma_f32_16x16x32_bf16 v[80:83], a[56:59], a[220:223], v[80:83]
buffer_load_dwordx4 v1, s[8:11], s60 offen offset:2048 sc1 lds
v_fma_f32 v184, v184, v254, v254
v_mfma_f32_16x16x32_bf16 v[84:87], a[60:63], a[216:219], v[84:87]
v_fma_f32 v185, v185, v254, v254
v_mfma_f32_16x16x32_bf16 v[88:91], a[60:63], a[220:223], v[88:91]
v_rcp_f32 v182, v182
v_mfma_f32_16x16x32_bf16 v[92:95], a[64:67], a[216:219], v[92:95]
buffer_load_dwordx4 v1, s[8:11], s60 offen offset:3072 sc1 lds
v_mfma_f32_16x16x32_bf16 v[96:99], a[64:67], a[220:223], v[96:99]
v_rcp_f32 v183, v183
v_mfma_f32_16x16x32_bf16 v[100:103], a[68:71], a[216:219], v[100:103]
v_mfma_f32_16x16x32_bf16 v[104:107], a[68:71], a[220:223], v[104:107]
s_waitcnt lgkmcnt(0)
v_mfma_f32_16x16x32_bf16 v[36:39], a[0:3], a[224:227], v[36:39]
ds_read_b128 a[36:39], v190 offset:9216
s_add_u32 m0, s63, 143360
v_mfma_f32_16x16x32_bf16 v[40:43], a[0:3], a[228:231], v[40:43]
ds_read_b128 a[40:43], v190 offset:10240
v_mfma_f32_16x16x32_bf16 v[44:47], a[4:7], a[224:227], v[44:47]
ds_read_b128 a[44:47], v190 offset:11264
s_add_u32 s61, s61, 36864
v_mfma_f32_16x16x32_bf16 v[48:51], a[4:7], a[228:231], v[48:51]
ds_read_b128 a[48:51], v190 offset:12288
v_mfma_f32_16x16x32_bf16 v[52:55], a[8:11], a[224:227], v[52:55]
ds_read_b128 a[52:55], v190 offset:13312
buffer_load_dwordx4 v1, s[8:11], s61 offen offset:0 sc1 lds
v_mfma_f32_16x16x32_bf16 v[56:59], a[8:11], a[228:231], v[56:59]
ds_read_b128 a[56:59], v190 offset:14336
v_mfma_f32_16x16x32_bf16 v[60:63], a[12:15], a[224:227], v[60:63]
ds_read_b128 a[60:63], v190 offset:15360
s_add_u32 m0, s62, 147456
v_mfma_f32_16x16x32_bf16 v[64:67], a[12:15], a[228:231], v[64:67]
ds_read_b128 a[64:67], v190 offset:16384
v_mfma_f32_16x16x32_bf16 v[68:71], a[16:19], a[224:227], v[68:71]
ds_read_b128 a[68:71], v190 offset:17408
s_add_u32 s60, s60, 20480
v_mfma_f32_16x16x32_bf16 v[72:75], a[16:19], a[228:231], v[72:75]
v_rcp_f32 v184, v184
v_mfma_f32_16x16x32_bf16 v[76:79], a[20:23], a[224:227], v[76:79]
buffer_load_dwordx4 v1, s[8:11], s60 offen offset:0 sc1 lds
v_mfma_f32_16x16x32_bf16 v[80:83], a[20:23], a[228:231], v[80:83]
v_rcp_f32 v185, v185
v_mfma_f32_16x16x32_bf16 v[84:87], a[24:27], a[224:227], v[84:87]
buffer_load_dwordx4 v1, s[8:11], s60 offen offset:1024 sc1 lds
v_mul_f32 v140, v140, v182
v_mfma_f32_16x16x32_bf16 v[88:91], a[24:27], a[228:231], v[88:91]
v_mul_f32 v141, v141, v183
v_mul_f32 v142, v142, v184
v_mfma_f32_16x16x32_bf16 v[92:95], a[28:31], a[224:227], v[92:95]
buffer_load_dwordx4 v1, s[8:11], s60 offen offset:2048 sc1 lds
v_mul_f32 v143, v143, v185
v_mfma_f32_16x16x32_bf16 v[96:99], a[28:31], a[228:231], v[96:99]
v_mul_f32 v186, v144, v144
v_mul_f32 v187, v145, v145
v_mfma_f32_16x16x32_bf16 v[100:103], a[32:35], a[224:227], v[100:103]
v_mul_f32 v188, v146, v146
v_mfma_f32_16x16x32_bf16 v[104:107], a[32:35], a[228:231], v[104:107]
v_mul_f32 v189, v147, v147
s_waitcnt vmcnt(25) lgkmcnt(0)
v_mfma_f32_16x16x32_bf16 v[36:39], a[36:39], a[232:235], v[36:39]
ds_read_b128 a[0:3], v190 offset:18432
buffer_load_dwordx4 v1, s[8:11], s60 offen offset:3072 sc1 lds
v_mfma_f32_16x16x32_bf16 v[40:43], a[36:39], a[236:239], v[40:43]
ds_read_b128 a[4:7], v190 offset:19456
v_fma_f32 v186, v186, v253, v251
v_mfma_f32_16x16x32_bf16 v[44:47], a[40:43], a[232:235], v[44:47]
ds_read_b128 a[8:11], v190 offset:20480
v_fma_f32 v187, v187, v253, v251
v_mfma_f32_16x16x32_bf16 v[48:51], a[40:43], a[236:239], v[48:51]
ds_read_b128 a[12:15], v190 offset:21504
s_add_u32 s52, s52, 4096
v_mfma_f32_16x16x32_bf16 v[52:55], a[44:47], a[232:235], v[52:55]
ds_read_b128 a[16:19], v190 offset:22528
v_fma_f32 v188, v188, v253, v251
v_mfma_f32_16x16x32_bf16 v[56:59], a[44:47], a[236:239], v[56:59]
ds_read_b128 a[20:23], v190 offset:23552
v_fma_f32 v189, v189, v253, v251
v_mfma_f32_16x16x32_bf16 v[60:63], a[48:51], a[232:235], v[60:63]
ds_read_b128 a[24:27], v190 offset:24576
buffer_load_dwordx4 a[112:115], v1, s[4:7], s52 offen offset:0 sc1
v_mfma_f32_16x16x32_bf16 v[64:67], a[48:51], a[236:239], v[64:67]
ds_read_b128 a[28:31], v190 offset:25600
v_mul_f32 v186, v186, v144
v_mfma_f32_16x16x32_bf16 v[68:71], a[52:55], a[232:235], v[68:71]
ds_read_b128 a[32:35], v190 offset:26624
v_mul_f32 v187, v187, v145
v_mfma_f32_16x16x32_bf16 v[72:75], a[52:55], a[236:239], v[72:75]
v_mfma_f32_16x16x32_bf16 v[76:79], a[56:59], a[232:235], v[76:79]
buffer_load_dwordx4 a[116:119], v9, s[4:7], s52 offen offset:0 sc1
v_mul_f32 v188, v188, v146
v_mfma_f32_16x16x32_bf16 v[80:83], a[56:59], a[236:239], v[80:83]
v_mul_f32 v189, v189, v147
v_mfma_f32_16x16x32_bf16 v[84:87], a[60:63], a[232:235], v[84:87]
v_mfma_f32_16x16x32_bf16 v[88:91], a[60:63], a[236:239], v[88:91]
buffer_load_dwordx4 a[120:123], v1, s[4:7], s52 offen offset:1024 sc1
v_mfma_f32_16x16x32_bf16 v[92:95], a[64:67], a[232:235], v[92:95]
v_exp_f32 v186, v186
v_mfma_f32_16x16x32_bf16 v[96:99], a[64:67], a[236:239], v[96:99]
v_mfma_f32_16x16x32_bf16 v[100:103], a[68:71], a[232:235], v[100:103]
v_exp_f32 v187, v187
v_mfma_f32_16x16x32_bf16 v[104:107], a[68:71], a[236:239], v[104:107]
s_waitcnt lgkmcnt(0)
v_mfma_f32_16x16x32_bf16 v[36:39], a[0:3], a[240:243], v[36:39]
ds_read_b128 a[36:39], v190 offset:27648
buffer_load_dwordx4 a[124:127], v9, s[4:7], s52 offen offset:1024 sc1
v_mfma_f32_16x16x32_bf16 v[40:43], a[0:3], a[244:247], v[40:43]
ds_read_b128 a[40:43], v190 offset:28672
v_mfma_f32_16x16x32_bf16 v[44:47], a[4:7], a[240:243], v[44:47]
ds_read_b128 a[44:47], v190 offset:29696
v_mfma_f32_16x16x32_bf16 v[48:51], a[4:7], a[244:247], v[48:51]
ds_read_b128 a[48:51], v190 offset:30720
v_mfma_f32_16x16x32_bf16 v[52:55], a[8:11], a[240:243], v[52:55]
ds_read_b128 a[52:55], v190 offset:31744
buffer_load_dwordx4 a[128:131], v1, s[4:7], s52 offen offset:2048 sc1
v_mfma_f32_16x16x32_bf16 v[56:59], a[8:11], a[244:247], v[56:59]
ds_read_b128 a[56:59], v190 offset:32768
v_mfma_f32_16x16x32_bf16 v[60:63], a[12:15], a[240:243], v[60:63]
ds_read_b128 a[60:63], v190 offset:33792
v_mfma_f32_16x16x32_bf16 v[64:67], a[12:15], a[244:247], v[64:67]
ds_read_b128 a[64:67], v190 offset:34816
v_mfma_f32_16x16x32_bf16 v[68:71], a[16:19], a[240:243], v[68:71]
ds_read_b128 a[68:71], v190 offset:35840
buffer_load_dwordx4 a[132:135], v9, s[4:7], s52 offen offset:2048 sc1
v_mfma_f32_16x16x32_bf16 v[72:75], a[16:19], a[244:247], v[72:75]
v_exp_f32 v188, v188
v_mfma_f32_16x16x32_bf16 v[76:79], a[20:23], a[240:243], v[76:79]
v_exp_f32 v189, v189
v_mfma_f32_16x16x32_bf16 v[80:83], a[20:23], a[244:247], v[80:83]
v_fma_f32 v186, v186, v255, v255
v_fma_f32 v187, v187, v255, v255
v_mfma_f32_16x16x32_bf16 v[84:87], a[24:27], a[240:243], v[84:87]
buffer_load_dwordx4 a[136:139], v1, s[4:7], s52 offen offset:3072 sc1
v_fma_f32 v188, v188, v255, v255
v_mfma_f32_16x16x32_bf16 v[88:91], a[24:27], a[244:247], v[88:91]
v_fma_f32 v189, v189, v255, v255
v_mfma_f32_16x16x32_bf16 v[92:95], a[28:31], a[240:243], v[92:95]
v_rcp_f32 v186, v186
v_mfma_f32_16x16x32_bf16 v[96:99], a[28:31], a[244:247], v[96:99]
v_mfma_f32_16x16x32_bf16 v[100:103], a[32:35], a[240:243], v[100:103]
v_mfma_f32_16x16x32_bf16 v[104:107], a[32:35], a[244:247], v[104:107]
s_waitcnt vmcnt(20) lgkmcnt(0)
s_barrier
v_mfma_f32_16x16x32_bf16 v[36:39], a[36:39], a[248:251], v[36:39]
ds_read_b128 a[0:3], v191 offset:0
buffer_load_dwordx4 a[140:143], v9, s[4:7], s52 offen offset:3072 sc1
v_mfma_f32_16x16x32_bf16 v[40:43], a[36:39], a[252:255], v[40:43]
ds_read_b128 a[4:7], v191 offset:1024
v_mfma_f32_16x16x32_bf16 v[44:47], a[40:43], a[248:251], v[44:47]
ds_read_b128 a[8:11], v191 offset:2048
s_add_u32 m0, s62, 53248
v_mfma_f32_16x16x32_bf16 v[48:51], a[40:43], a[252:255], v[48:51]
ds_read_b128 a[12:15], v191 offset:3072
v_mfma_f32_16x16x32_bf16 v[52:55], a[44:47], a[248:251], v[52:55]
ds_read_b128 a[16:19], v191 offset:4096
v_mfma_f32_16x16x32_bf16 v[56:59], a[44:47], a[252:255], v[56:59]
ds_read_b128 a[20:23], v191 offset:5120
s_add_u32 s60, s60, 16384
v_mfma_f32_16x16x32_bf16 v[60:63], a[48:51], a[248:251], v[60:63]
ds_read_b128 a[24:27], v191 offset:6144
v_mfma_f32_16x16x32_bf16 v[64:67], a[48:51], a[252:255], v[64:67]
ds_read_b128 a[28:31], v191 offset:7168
v_mfma_f32_16x16x32_bf16 v[68:71], a[52:55], a[248:251], v[68:71]
ds_read_b128 a[32:35], v191 offset:8192
buffer_load_dwordx4 v1, s[8:11], s60 offen offset:0 sc1 lds
v_mfma_f32_16x16x32_bf16 v[72:75], a[52:55], a[252:255], v[72:75]
v_rcp_f32 v187, v187
v_mfma_f32_16x16x32_bf16 v[76:79], a[56:59], a[248:251], v[76:79]
v_rcp_f32 v188, v188
v_mfma_f32_16x16x32_bf16 v[80:83], a[56:59], a[252:255], v[80:83]
buffer_load_dwordx4 v1, s[8:11], s60 offen offset:1024 sc1 lds
v_mfma_f32_16x16x32_bf16 v[84:87], a[60:63], a[248:251], v[84:87]
v_rcp_f32 v189, v189
v_mfma_f32_16x16x32_bf16 v[88:91], a[60:63], a[252:255], v[88:91]
v_mul_f32 v144, v144, v186
v_mul_f32 v145, v145, v187
v_mfma_f32_16x16x32_bf16 v[92:95], a[64:67], a[248:251], v[92:95]
buffer_load_dwordx4 v1, s[8:11], s60 offen offset:2048 sc1 lds
v_mul_f32 v146, v146, v188
v_mfma_f32_16x16x32_bf16 v[96:99], a[64:67], a[252:255], v[96:99]
v_mul_f32 v147, v147, v189
v_mul_f32 v182, v148, v148
v_mfma_f32_16x16x32_bf16 v[100:103], a[68:71], a[248:251], v[100:103]
v_mfma_f32_16x16x32_bf16 v[104:107], a[68:71], a[252:255], v[104:107]
v_mul_f32 v183, v149, v149
s_waitcnt lgkmcnt(0)
v_mfma_f32_16x16x32_bf16 v[36:39], a[0:3], a[80:83], v[36:39]
ds_read_b128 a[36:39], v191 offset:9216
buffer_load_dwordx4 v1, s[8:11], s60 offen offset:3072 sc1 lds
v_mfma_f32_16x16x32_bf16 v[40:43], a[0:3], a[84:87], v[40:43]
ds_read_b128 a[40:43], v191 offset:10240
v_mul_f32 v184, v150, v150
v_mfma_f32_16x16x32_bf16 v[44:47], a[4:7], a[80:83], v[44:47]
ds_read_b128 a[44:47], v191 offset:11264
s_add_u32 m0, s63, 69632
v_mfma_f32_16x16x32_bf16 v[48:51], a[4:7], a[84:87], v[48:51]
ds_read_b128 a[48:51], v191 offset:12288
v_mul_f32 v185, v151, v151
v_mfma_f32_16x16x32_bf16 v[52:55], a[8:11], a[80:83], v[52:55]
ds_read_b128 a[52:55], v191 offset:13312
s_add_u32 s61, s61, 36864
v_mfma_f32_16x16x32_bf16 v[56:59], a[8:11], a[84:87], v[56:59]
ds_read_b128 a[56:59], v191 offset:14336
v_fma_f32 v182, v182, v252, v250
v_mfma_f32_16x16x32_bf16 v[60:63], a[12:15], a[80:83], v[60:63]
ds_read_b128 a[60:63], v191 offset:15360
buffer_load_dwordx4 v1, s[8:11], s61 offen offset:0 sc1 lds
v_mfma_f32_16x16x32_bf16 v[64:67], a[12:15], a[84:87], v[64:67]
ds_read_b128 a[64:67], v191 offset:16384
v_fma_f32 v183, v183, v252, v250
v_mfma_f32_16x16x32_bf16 v[68:71], a[16:19], a[80:83], v[68:71]
ds_read_b128 a[68:71], v191 offset:17408
s_add_u32 m0, s62, 73728
v_mfma_f32_16x16x32_bf16 v[72:75], a[16:19], a[84:87], v[72:75]
s_add_u32 s60, s60, 20480
v_fma_f32 v184, v184, v252, v250
v_fma_f32 v185, v185, v252, v250
v_mfma_f32_16x16x32_bf16 v[76:79], a[20:23], a[80:83], v[76:79]
v_mul_f32 v182, v182, v148
v_mfma_f32_16x16x32_bf16 v[80:83], a[20:23], a[84:87], v[80:83]
v_mfma_f32_16x16x32_bf16 v[84:87], a[24:27], a[80:83], v[84:87]
buffer_load_dwordx4 v1, s[8:11], s60 offen offset:0 sc1 lds
v_mul_f32 v183, v183, v149
v_mfma_f32_16x16x32_bf16 v[88:91], a[24:27], a[84:87], v[88:91]
v_mul_f32 v184, v184, v150
v_mfma_f32_16x16x32_bf16 v[92:95], a[28:31], a[80:83], v[92:95]
buffer_load_dwordx4 v1, s[8:11], s60 offen offset:1024 sc1 lds
v_mfma_f32_16x16x32_bf16 v[96:99], a[28:31], a[84:87], v[96:99]
v_mul_f32 v185, v185, v151
v_mfma_f32_16x16x32_bf16 v[100:103], a[32:35], a[80:83], v[100:103]
v_exp_f32 v182, v182
v_mfma_f32_16x16x32_bf16 v[104:107], a[32:35], a[84:87], v[104:107]
s_waitcnt vmcnt(24) lgkmcnt(0)
v_mfma_f32_16x16x32_bf16 v[36:39], a[36:39], a[88:91], v[36:39]
ds_read_b128 a[0:3], v191 offset:18432
buffer_load_dwordx4 v1, s[8:11], s60 offen offset:2048 sc1 lds
v_mfma_f32_16x16x32_bf16 v[40:43], a[36:39], a[92:95], v[40:43]
ds_read_b128 a[4:7], v191 offset:19456
v_mfma_f32_16x16x32_bf16 v[44:47], a[40:43], a[88:91], v[44:47]
ds_read_b128 a[8:11], v191 offset:20480
v_mfma_f32_16x16x32_bf16 v[48:51], a[40:43], a[92:95], v[48:51]
ds_read_b128 a[12:15], v191 offset:21504
buffer_load_dwordx4 v1, s[8:11], s60 offen offset:3072 sc1 lds
v_mfma_f32_16x16x32_bf16 v[52:55], a[44:47], a[88:91], v[52:55]
ds_read_b128 a[16:19], v191 offset:22528
v_mfma_f32_16x16x32_bf16 v[56:59], a[44:47], a[92:95], v[56:59]
ds_read_b128 a[20:23], v191 offset:23552
v_mfma_f32_16x16x32_bf16 v[60:63], a[48:51], a[88:91], v[60:63]
ds_read_b128 a[24:27], v191 offset:24576
s_add_u32 s52, s52, 4096
v_mfma_f32_16x16x32_bf16 v[64:67], a[48:51], a[92:95], v[64:67]
ds_read_b128 a[28:31], v191 offset:25600
v_mfma_f32_16x16x32_bf16 v[68:71], a[52:55], a[88:91], v[68:71]
ds_read_b128 a[32:35], v191 offset:26624
v_mfma_f32_16x16x32_bf16 v[72:75], a[52:55], a[92:95], v[72:75]
v_exp_f32 v183, v183
v_mfma_f32_16x16x32_bf16 v[76:79], a[56:59], a[88:91], v[76:79]
buffer_load_dwordx4 a[144:147], v1, s[4:7], s52 offen offset:0 sc1
v_mfma_f32_16x16x32_bf16 v[80:83], a[56:59], a[92:95], v[80:83]
v_exp_f32 v184, v184
v_mfma_f32_16x16x32_bf16 v[84:87], a[60:63], a[88:91], v[84:87]
v_exp_f32 v185, v185
v_mfma_f32_16x16x32_bf16 v[88:91], a[60:63], a[92:95], v[88:91]
buffer_load_dwordx4 a[148:151], v9, s[4:7], s52 offen offset:0 sc1
v_fma_f32 v182, v182, v254, v254
v_mfma_f32_16x16x32_bf16 v[92:95], a[64:67], a[88:91], v[92:95]
v_fma_f32 v183, v183, v254, v254
v_fma_f32 v184, v184, v254, v254
v_mfma_f32_16x16x32_bf16 v[96:99], a[64:67], a[92:95], v[96:99]
v_mfma_f32_16x16x32_bf16 v[100:103], a[68:71], a[88:91], v[100:103]
v_fma_f32 v185, v185, v254, v254
v_mfma_f32_16x16x32_bf16 v[104:107], a[68:71], a[92:95], v[104:107]
s_waitcnt lgkmcnt(0)
v_mfma_f32_16x16x32_bf16 v[36:39], a[0:3], a[96:99], v[36:39]
ds_read_b128 a[36:39], v191 offset:27648
buffer_load_dwordx4 a[152:155], v1, s[4:7], s52 offen offset:1024 sc1
v_mfma_f32_16x16x32_bf16 v[40:43], a[0:3], a[100:103], v[40:43]
ds_read_b128 a[40:43], v191 offset:28672
v_mfma_f32_16x16x32_bf16 v[44:47], a[4:7], a[96:99], v[44:47]
ds_read_b128 a[44:47], v191 offset:29696
v_mfma_f32_16x16x32_bf16 v[48:51], a[4:7], a[100:103], v[48:51]
ds_read_b128 a[48:51], v191 offset:30720
v_mfma_f32_16x16x32_bf16 v[52:55], a[8:11], a[96:99], v[52:55]
ds_read_b128 a[52:55], v191 offset:31744
buffer_load_dwordx4 a[156:159], v9, s[4:7], s52 offen offset:1024 sc1
v_mfma_f32_16x16x32_bf16 v[56:59], a[8:11], a[100:103], v[56:59]
ds_read_b128 a[56:59], v191 offset:32768
v_mfma_f32_16x16x32_bf16 v[60:63], a[12:15], a[96:99], v[60:63]
ds_read_b128 a[60:63], v191 offset:33792
v_mfma_f32_16x16x32_bf16 v[64:67], a[12:15], a[100:103], v[64:67]
ds_read_b128 a[64:67], v191 offset:34816
v_mfma_f32_16x16x32_bf16 v[68:71], a[16:19], a[96:99], v[68:71]
ds_read_b128 a[68:71], v191 offset:35840
buffer_load_dwordx4 a[160:163], v1, s[4:7], s52 offen offset:2048 sc1
v_mfma_f32_16x16x32_bf16 v[72:75], a[16:19], a[100:103], v[72:75]
v_rcp_f32 v182, v182
v_mfma_f32_16x16x32_bf16 v[76:79], a[20:23], a[96:99], v[76:79]
v_rcp_f32 v183, v183
v_mfma_f32_16x16x32_bf16 v[80:83], a[20:23], a[100:103], v[80:83]
v_rcp_f32 v184, v184
v_mfma_f32_16x16x32_bf16 v[84:87], a[24:27], a[96:99], v[84:87]
buffer_load_dwordx4 a[164:167], v9, s[4:7], s52 offen offset:2048 sc1
v_mfma_f32_16x16x32_bf16 v[88:91], a[24:27], a[100:103], v[88:91]
v_rcp_f32 v185, v185
v_mfma_f32_16x16x32_bf16 v[92:95], a[28:31], a[96:99], v[92:95]
v_mul_f32 v148, v148, v182
v_mul_f32 v149, v149, v183
v_mfma_f32_16x16x32_bf16 v[96:99], a[28:31], a[100:103], v[96:99]
v_mul_f32 v150, v150, v184
v_mfma_f32_16x16x32_bf16 v[100:103], a[32:35], a[96:99], v[100:103]
v_mfma_f32_16x16x32_bf16 v[104:107], a[32:35], a[100:103], v[104:107]
s_waitcnt vmcnt(19) lgkmcnt(0)
s_barrier
v_mfma_f32_16x16x32_bf16 v[36:39], a[36:39], a[104:107], v[36:39]
ds_read_b128 a[0:3], v192 offset:0
buffer_load_dwordx4 a[168:171], v1, s[4:7], s52 offen offset:3072 sc1
v_mfma_f32_16x16x32_bf16 v[40:43], a[36:39], a[108:111], v[40:43]
ds_read_b128 a[4:7], v192 offset:1024
v_mul_f32 v151, v151, v185
v_mfma_f32_16x16x32_bf16 v[44:47], a[40:43], a[104:107], v[44:47]
ds_read_b128 a[8:11], v192 offset:2048
buffer_load_dwordx4 a[172:175], v9, s[4:7], s52 offen offset:3072 sc1
v_mfma_f32_16x16x32_bf16 v[48:51], a[40:43], a[108:111], v[48:51]
ds_read_b128 a[12:15], v192 offset:3072
v_mul_f32 v186, v152, v152
v_mfma_f32_16x16x32_bf16 v[52:55], a[44:47], a[104:107], v[52:55]
ds_read_b128 a[16:19], v192 offset:4096
v_mul_f32 v187, v153, v153
v_mfma_f32_16x16x32_bf16 v[56:59], a[44:47], a[108:111], v[56:59]
ds_read_b128 a[20:23], v192 offset:5120
s_add_u32 m0, s62, 90112
v_mfma_f32_16x16x32_bf16 v[60:63], a[48:51], a[104:107], v[60:63]
ds_read_b128 a[24:27], v192 offset:6144
v_mul_f32 v188, v154, v154
v_mfma_f32_16x16x32_bf16 v[64:67], a[48:51], a[108:111], v[64:67]
ds_read_b128 a[28:31], v192 offset:7168
v_mul_f32 v189, v155, v155
v_mfma_f32_16x16x32_bf16 v[68:71], a[52:55], a[104:107], v[68:71]
ds_read_b128 a[32:35], v192 offset:8192
s_add_u32 s60, s60, 16384
v_mfma_f32_16x16x32_bf16 v[72:75], a[52:55], a[108:111], v[72:75]
v_fma_f32 v186, v186, v253, v251
v_fma_f32 v187, v187, v253, v251
v_mfma_f32_16x16x32_bf16 v[76:79], a[56:59], a[104:107], v[76:79]
v_fma_f32 v188, v188, v253, v251
v_mfma_f32_16x16x32_bf16 v[80:83], a[56:59], a[108:111], v[80:83]
buffer_load_dwordx4 v1, s[8:11], s60 offen offset:0 sc1 lds
v_mfma_f32_16x16x32_bf16 v[84:87], a[60:63], a[104:107], v[84:87]
v_fma_f32 v189, v189, v253, v251
v_mfma_f32_16x16x32_bf16 v[88:91], a[60:63], a[108:111], v[88:91]
v_mul_f32 v186, v186, v152
v_mfma_f32_16x16x32_bf16 v[92:95], a[64:67], a[104:107], v[92:95]
buffer_load_dwordx4 v1, s[8:11], s60 offen offset:1024 sc1 lds
v_mfma_f32_16x16x32_bf16 v[96:99], a[64:67], a[108:111], v[96:99]
v_mul_f32 v187, v187, v153
v_mfma_f32_16x16x32_bf16 v[100:103], a[68:71], a[104:107], v[100:103]
v_mfma_f32_16x16x32_bf16 v[104:107], a[68:71], a[108:111], v[104:107]
v_mul_f32 v188, v188, v154
s_waitcnt lgkmcnt(0)
v_mfma_f32_16x16x32_bf16 v[36:39], a[0:3], a[112:115], v[36:39]
ds_read_b128 a[36:39], v192 offset:9216
buffer_load_dwordx4 v1, s[8:11], s60 offen offset:2048 sc1 lds
v_mfma_f32_16x16x32_bf16 v[40:43], a[0:3], a[116:119], v[40:43]
ds_read_b128 a[40:43], v192 offset:10240
v_mul_f32 v189, v189, v155
v_mfma_f32_16x16x32_bf16 v[44:47], a[4:7], a[112:115], v[44:47]
ds_read_b128 a[44:47], v192 offset:11264
buffer_load_dwordx4 v1, s[8:11], s60 offen offset:3072 sc1 lds
v_mfma_f32_16x16x32_bf16 v[48:51], a[4:7], a[116:119], v[48:51]
ds_read_b128 a[48:51], v192 offset:12288
v_mfma_f32_16x16x32_bf16 v[52:55], a[8:11], a[112:115], v[52:55]
ds_read_b128 a[52:55], v192 offset:13312
s_add_u32 m0, s63, 106496
v_mfma_f32_16x16x32_bf16 v[56:59], a[8:11], a[116:119], v[56:59]
ds_read_b128 a[56:59], v192 offset:14336
v_mfma_f32_16x16x32_bf16 v[60:63], a[12:15], a[112:115], v[60:63]
ds_read_b128 a[60:63], v192 offset:15360
s_add_u32 s61, s61, 36864
v_mfma_f32_16x16x32_bf16 v[64:67], a[12:15], a[116:119], v[64:67]
ds_read_b128 a[64:67], v192 offset:16384
v_mfma_f32_16x16x32_bf16 v[68:71], a[16:19], a[112:115], v[68:71]
ds_read_b128 a[68:71], v192 offset:17408
buffer_load_dwordx4 v1, s[8:11], s61 offen offset:0 sc1 lds
v_mfma_f32_16x16x32_bf16 v[72:75], a[16:19], a[116:119], v[72:75]
s_add_u32 m0, s62, 110592
v_exp_f32 v186, v186
v_mfma_f32_16x16x32_bf16 v[76:79], a[20:23], a[112:115], v[76:79]
s_add_u32 s60, s60, 20480
v_exp_f32 v187, v187
v_mfma_f32_16x16x32_bf16 v[80:83], a[20:23], a[116:119], v[80:83]
v_exp_f32 v188, v188
v_mfma_f32_16x16x32_bf16 v[84:87], a[24:27], a[112:115], v[84:87]
v_exp_f32 v189, v189
v_mfma_f32_16x16x32_bf16 v[88:91], a[24:27], a[116:119], v[88:91]
v_mfma_f32_16x16x32_bf16 v[92:95], a[28:31], a[112:115], v[92:95]
buffer_load_dwordx4 v1, s[8:11], s60 offen offset:0 sc1 lds
v_fma_f32 v186, v186, v255, v255
v_mfma_f32_16x16x32_bf16 v[96:99], a[28:31], a[116:119], v[96:99]
v_mfma_f32_16x16x32_bf16 v[100:103], a[32:35], a[112:115], v[100:103]
v_fma_f32 v187, v187, v255, v255
v_mfma_f32_16x16x32_bf16 v[104:107], a[32:35], a[116:119], v[104:107]
s_waitcnt vmcnt(23) lgkmcnt(0)
v_mfma_f32_16x16x32_bf16 v[36:39], a[36:39], a[120:123], v[36:39]
ds_read_b128 a[0:3], v192 offset:18432
buffer_load_dwordx4 v1, s[8:11], s60 offen offset:1024 sc1 lds
v_mfma_f32_16x16x32_bf16 v[40:43], a[36:39], a[124:127], v[40:43]
ds_read_b128 a[4:7], v192 offset:19456
v_fma_f32 v188, v188, v255, v255
v_mfma_f32_16x16x32_bf16 v[44:47], a[40:43], a[120:123], v[44:47]
ds_read_b128 a[8:11], v192 offset:20480
v_fma_f32 v189, v189, v255, v255
v_mfma_f32_16x16x32_bf16 v[48:51], a[40:43], a[124:127], v[48:51]
ds_read_b128 a[12:15], v192 offset:21504
buffer_load_dwordx4 v1, s[8:11], s60 offen offset:2048 sc1 lds
v_mfma_f32_16x16x32_bf16 v[52:55], a[44:47], a[120:123], v[52:55]
ds_read_b128 a[16:19], v192 offset:22528
v_mfma_f32_16x16x32_bf16 v[56:59], a[44:47], a[124:127], v[56:59]
ds_read_b128 a[20:23], v192 offset:23552
v_mfma_f32_16x16x32_bf16 v[60:63], a[48:51], a[120:123], v[60:63]
ds_read_b128 a[24:27], v192 offset:24576
buffer_load_dwordx4 v1, s[8:11], s60 offen offset:3072 sc1 lds
v_mfma_f32_16x16x32_bf16 v[64:67], a[48:51], a[124:127], v[64:67]
ds_read_b128 a[28:31], v192 offset:25600
v_mfma_f32_16x16x32_bf16 v[68:71], a[52:55], a[120:123], v[68:71]
ds_read_b128 a[32:35], v192 offset:26624
v_mfma_f32_16x16x32_bf16 v[72:75], a[52:55], a[124:127], v[72:75]
s_add_u32 s52, s52, 4096
v_rcp_f32 v186, v186
v_mfma_f32_16x16x32_bf16 v[76:79], a[56:59], a[120:123], v[76:79]
v_rcp_f32 v187, v187
v_mfma_f32_16x16x32_bf16 v[80:83], a[56:59], a[124:127], v[80:83]
v_rcp_f32 v188, v188
v_mfma_f32_16x16x32_bf16 v[84:87], a[60:63], a[120:123], v[84:87]
v_rcp_f32 v189, v189
v_mfma_f32_16x16x32_bf16 v[88:91], a[60:63], a[124:127], v[88:91]
buffer_load_dwordx4 a[176:179], v1, s[4:7], s52 offen offset:0 sc1
v_mfma_f32_16x16x32_bf16 v[92:95], a[64:67], a[120:123], v[92:95]
v_mfma_f32_16x16x32_bf16 v[96:99], a[64:67], a[124:127], v[96:99]
v_mfma_f32_16x16x32_bf16 v[100:103], a[68:71], a[120:123], v[100:103]
v_mul_f32 v152, v152, v186
v_mfma_f32_16x16x32_bf16 v[104:107], a[68:71], a[124:127], v[104:107]
v_mul_f32 v153, v153, v187
s_waitcnt lgkmcnt(0)
v_mfma_f32_16x16x32_bf16 v[36:39], a[0:3], a[128:131], v[36:39]
ds_read_b128 a[36:39], v192 offset:27648
buffer_load_dwordx4 a[180:183], v9, s[4:7], s52 offen offset:0 sc1
v_mfma_f32_16x16x32_bf16 v[40:43], a[0:3], a[132:135], v[40:43]
ds_read_b128 a[40:43], v192 offset:28672
v_mul_f32 v154, v154, v188
v_mfma_f32_16x16x32_bf16 v[44:47], a[4:7], a[128:131], v[44:47]
ds_read_b128 a[44:47], v192 offset:29696
v_mul_f32 v155, v155, v189
v_mfma_f32_16x16x32_bf16 v[48:51], a[4:7], a[132:135], v[48:51]
ds_read_b128 a[48:51], v192 offset:30720
v_mfma_f32_16x16x32_bf16 v[52:55], a[8:11], a[128:131], v[52:55]
ds_read_b128 a[52:55], v192 offset:31744
buffer_load_dwordx4 a[184:187], v1, s[4:7], s52 offen offset:1024 sc1
v_mfma_f32_16x16x32_bf16 v[56:59], a[8:11], a[132:135], v[56:59]
ds_read_b128 a[56:59], v192 offset:32768
v_mul_f32 v182, v156, v156
v_mfma_f32_16x16x32_bf16 v[60:63], a[12:15], a[128:131], v[60:63]
ds_read_b128 a[60:63], v192 offset:33792
v_mul_f32 v183, v157, v157
v_mfma_f32_16x16x32_bf16 v[64:67], a[12:15], a[132:135], v[64:67]
ds_read_b128 a[64:67], v192 offset:34816
v_mul_f32 v184, v158, v158
v_mfma_f32_16x16x32_bf16 v[68:71], a[16:19], a[128:131], v[68:71]
ds_read_b128 a[68:71], v192 offset:35840
buffer_load_dwordx4 a[188:191], v9, s[4:7], s52 offen offset:1024 sc1
v_mfma_f32_16x16x32_bf16 v[72:75], a[16:19], a[132:135], v[72:75]
v_mul_f32 v185, v159, v159
v_mfma_f32_16x16x32_bf16 v[76:79], a[20:23], a[128:131], v[76:79]
v_fma_f32 v182, v182, v252, v250
v_mfma_f32_16x16x32_bf16 v[80:83], a[20:23], a[132:135], v[80:83]
v_mfma_f32_16x16x32_bf16 v[84:87], a[24:27], a[128:131], v[84:87]
buffer_load_dwordx4 a[192:195], v1, s[4:7], s52 offen offset:2048 sc1
v_fma_f32 v183, v183, v252, v250
v_mfma_f32_16x16x32_bf16 v[88:91], a[24:27], a[132:135], v[88:91]
v_mfma_f32_16x16x32_bf16 v[92:95], a[28:31], a[128:131], v[92:95]
v_fma_f32 v184, v184, v252, v250
v_mfma_f32_16x16x32_bf16 v[96:99], a[28:31], a[132:135], v[96:99]
v_fma_f32 v185, v185, v252, v250
v_mfma_f32_16x16x32_bf16 v[100:103], a[32:35], a[128:131], v[100:103]
v_mfma_f32_16x16x32_bf16 v[104:107], a[32:35], a[132:135], v[104:107]
s_waitcnt vmcnt(18) lgkmcnt(0)
s_barrier
v_mfma_f32_16x16x32_bf16 v[36:39], a[36:39], a[136:139], v[36:39]
ds_read_b128 a[0:3], v190 offset:0
buffer_load_dwordx4 a[196:199], v9, s[4:7], s52 offen offset:2048 sc1
v_mfma_f32_16x16x32_bf16 v[40:43], a[36:39], a[140:143], v[40:43]
ds_read_b128 a[4:7], v190 offset:1024
v_mul_f32 v182, v182, v156
v_mfma_f32_16x16x32_bf16 v[44:47], a[40:43], a[136:139], v[44:47]
ds_read_b128 a[8:11], v190 offset:2048
buffer_load_dwordx4 a[200:203], v1, s[4:7], s52 offen offset:3072 sc1
v_mfma_f32_16x16x32_bf16 v[48:51], a[40:43], a[140:143], v[48:51]
ds_read_b128 a[12:15], v190 offset:3072
v_mul_f32 v183, v183, v157
v_mfma_f32_16x16x32_bf16 v[52:55], a[44:47], a[136:139], v[52:55]
ds_read_b128 a[16:19], v190 offset:4096
v_mul_f32 v184, v184, v158
v_mfma_f32_16x16x32_bf16 v[56:59], a[44:47], a[140:143], v[56:59]
ds_read_b128 a[20:23], v190 offset:5120
buffer_load_dwordx4 a[204:207], v9, s[4:7], s52 offen offset:3072 sc1
v_mfma_f32_16x16x32_bf16 v[60:63], a[48:51], a[136:139], v[60:63]
ds_read_b128 a[24:27], v190 offset:6144
v_mul_f32 v185, v185, v159
v_mfma_f32_16x16x32_bf16 v[64:67], a[48:51], a[140:143], v[64:67]
ds_read_b128 a[28:31], v190 offset:7168
v_mfma_f32_16x16x32_bf16 v[68:71], a[52:55], a[136:139], v[68:71]
ds_read_b128 a[32:35], v190 offset:8192
s_add_u32 m0, s62, 126976
v_mfma_f32_16x16x32_bf16 v[72:75], a[52:55], a[140:143], v[72:75]
s_add_u32 s60, s60, 16384
v_exp_f32 v182, v182
v_mfma_f32_16x16x32_bf16 v[76:79], a[56:59], a[136:139], v[76:79]
v_exp_f32 v183, v183
v_mfma_f32_16x16x32_bf16 v[80:83], a[56:59], a[140:143], v[80:83]
v_exp_f32 v184, v184
v_mfma_f32_16x16x32_bf16 v[84:87], a[60:63], a[136:139], v[84:87]
v_mfma_f32_16x16x32_bf16 v[88:91], a[60:63], a[140:143], v[88:91]
v_mfma_f32_16x16x32_bf16 v[92:95], a[64:67], a[136:139], v[92:95]
buffer_load_dwordx4 v1, s[8:11], s60 offen offset:0 sc1 lds
v_mfma_f32_16x16x32_bf16 v[96:99], a[64:67], a[140:143], v[96:99]
v_exp_f32 v185, v185
v_mfma_f32_16x16x32_bf16 v[100:103], a[68:71], a[136:139], v[100:103]
v_mfma_f32_16x16x32_bf16 v[104:107], a[68:71], a[140:143], v[104:107]
s_waitcnt lgkmcnt(0)
v_mfma_f32_16x16x32_bf16 v[36:39], a[0:3], a[144:147], v[36:39]
ds_read_b128 a[36:39], v190 offset:9216
buffer_load_dwordx4 v1, s[8:11], s60 offen offset:1024 sc1 lds
v_mfma_f32_16x16x32_bf16 v[40:43], a[0:3], a[148:151], v[40:43]
ds_read_b128 a[40:43], v190 offset:10240
v_fma_f32 v182, v182, v254, v254
v_mfma_f32_16x16x32_bf16 v[44:47], a[4:7], a[144:147], v[44:47]
ds_read_b128 a[44:47], v190 offset:11264
buffer_load_dwordx4 v1, s[8:11], s60 offen offset:2048 sc1 lds
v_mfma_f32_16x16x32_bf16 v[48:51], a[4:7], a[148:151], v[48:51]
ds_read_b128 a[48:51], v190 offset:12288
v_fma_f32 v183, v183, v254, v254
v_mfma_f32_16x16x32_bf16 v[52:55], a[8:11], a[144:147], v[52:55]
ds_read_b128 a[52:55], v190 offset:13312
v_fma_f32 v184, v184, v254, v254
v_mfma_f32_16x16x32_bf16 v[56:59], a[8:11], a[148:151], v[56:59]
ds_read_b128 a[56:59], v190 offset:14336
buffer_load_dwordx4 v1, s[8:11], s60 offen offset:3072 sc1 lds
v_mfma_f32_16x16x32_bf16 v[60:63], a[12:15], a[144:147], v[60:63]
ds_read_b128 a[60:63], v190 offset:15360
v_fma_f32 v185, v185, v254, v254
v_mfma_f32_16x16x32_bf16 v[64:67], a[12:15], a[148:151], v[64:67]
ds_read_b128 a[64:67], v190 offset:16384
v_mfma_f32_16x16x32_bf16 v[68:71], a[16:19], a[144:147], v[68:71]
ds_read_b128 a[68:71], v190 offset:17408
s_add_u32 m0, s63, 143360
v_mfma_f32_16x16x32_bf16 v[72:75], a[16:19], a[148:151], v[72:75]
s_add_u32 s61, s61, 36864
v_rcp_f32 v182, v182
v_mfma_f32_16x16x32_bf16 v[76:79], a[20:23], a[144:147], v[76:79]
v_rcp_f32 v183, v183
v_mfma_f32_16x16x32_bf16 v[80:83], a[20:23], a[148:151], v[80:83]
v_mfma_f32_16x16x32_bf16 v[84:87], a[24:27], a[144:147], v[84:87]
v_mfma_f32_16x16x32_bf16 v[88:91], a[24:27], a[148:151], v[88:91]
v_rcp_f32 v184, v184
v_mfma_f32_16x16x32_bf16 v[92:95], a[28:31], a[144:147], v[92:95]
buffer_load_dwordx4 v1, s[8:11], s61 offen offset:0 sc1 lds
v_mfma_f32_16x16x32_bf16 v[96:99], a[28:31], a[148:151], v[96:99]
v_mfma_f32_16x16x32_bf16 v[100:103], a[32:35], a[144:147], v[100:103]
v_rcp_f32 v185, v185
v_mfma_f32_16x16x32_bf16 v[104:107], a[32:35], a[148:151], v[104:107]
s_waitcnt vmcnt(22) lgkmcnt(0)
v_mfma_f32_16x16x32_bf16 v[36:39], a[36:39], a[152:155], v[36:39]
ds_read_b128 a[0:3], v190 offset:18432
s_add_u32 m0, s62, 147456
v_mfma_f32_16x16x32_bf16 v[40:43], a[36:39], a[156:159], v[40:43]
ds_read_b128 a[4:7], v190 offset:19456
v_mul_f32 v156, v156, v182
v_mfma_f32_16x16x32_bf16 v[44:47], a[40:43], a[152:155], v[44:47]
ds_read_b128 a[8:11], v190 offset:20480
s_add_u32 s60, s60, 20480
v_mfma_f32_16x16x32_bf16 v[48:51], a[40:43], a[156:159], v[48:51]
ds_read_b128 a[12:15], v190 offset:21504
v_mul_f32 v157, v157, v183
v_mfma_f32_16x16x32_bf16 v[52:55], a[44:47], a[152:155], v[52:55]
ds_read_b128 a[16:19], v190 offset:22528
v_mul_f32 v158, v158, v184
v_mfma_f32_16x16x32_bf16 v[56:59], a[44:47], a[156:159], v[56:59]
ds_read_b128 a[20:23], v190 offset:23552
buffer_load_dwordx4 v1, s[8:11], s60 offen offset:0 sc1 lds
v_mfma_f32_16x16x32_bf16 v[60:63], a[48:51], a[152:155], v[60:63]
ds_read_b128 a[24:27], v190 offset:24576
v_mul_f32 v159, v159, v185
v_mfma_f32_16x16x32_bf16 v[64:67], a[48:51], a[156:159], v[64:67]
ds_read_b128 a[28:31], v190 offset:25600
v_mul_f32 v186, v160, v160
v_mfma_f32_16x16x32_bf16 v[68:71], a[52:55], a[152:155], v[68:71]
ds_read_b128 a[32:35], v190 offset:26624
buffer_load_dwordx4 v1, s[8:11], s60 offen offset:1024 sc1 lds
v_mfma_f32_16x16x32_bf16 v[72:75], a[52:55], a[156:159], v[72:75]
v_mul_f32 v187, v161, v161
v_mfma_f32_16x16x32_bf16 v[76:79], a[56:59], a[152:155], v[76:79]
v_mfma_f32_16x16x32_bf16 v[80:83], a[56:59], a[156:159], v[80:83]
buffer_load_dwordx4 v1, s[8:11], s60 offen offset:2048 sc1 lds
v_mul_f32 v188, v162, v162
v_mfma_f32_16x16x32_bf16 v[84:87], a[60:63], a[152:155], v[84:87]
v_mul_f32 v189, v163, v163
v_mfma_f32_16x16x32_bf16 v[88:91], a[60:63], a[156:159], v[88:91]
v_mfma_f32_16x16x32_bf16 v[92:95], a[64:67], a[152:155], v[92:95]
buffer_load_dwordx4 v1, s[8:11], s60 offen offset:3072 sc1 lds
v_fma_f32 v186, v186, v253, v251
v_mfma_f32_16x16x32_bf16 v[96:99], a[64:67], a[156:159], v[96:99]
v_fma_f32 v187, v187, v253, v251
v_mfma_f32_16x16x32_bf16 v[100:103], a[68:71], a[152:155], v[100:103]
v_mfma_f32_16x16x32_bf16 v[104:107], a[68:71], a[156:159], v[104:107]
v_fma_f32 v188, v188, v253, v251
s_waitcnt lgkmcnt(0)
v_mfma_f32_16x16x32_bf16 v[36:39], a[0:3], a[160:163], v[36:39]
ds_read_b128 a[36:39], v190 offset:27648
s_add_u32 s52, s52, 4096
v_mfma_f32_16x16x32_bf16 v[40:43], a[0:3], a[164:167], v[40:43]
ds_read_b128 a[40:43], v190 offset:28672
v_fma_f32 v189, v189, v253, v251
v_mfma_f32_16x16x32_bf16 v[44:47], a[4:7], a[160:163], v[44:47]
ds_read_b128 a[44:47], v190 offset:29696
v_mul_f32 v186, v186, v160
v_mfma_f32_16x16x32_bf16 v[48:51], a[4:7], a[164:167], v[48:51]
ds_read_b128 a[48:51], v190 offset:30720
buffer_load_dwordx4 a[208:211], v1, s[4:7], s52 offen offset:0 sc1
v_mfma_f32_16x16x32_bf16 v[52:55], a[8:11], a[160:163], v[52:55]
ds_read_b128 a[52:55], v190 offset:31744
v_mul_f32 v187, v187, v161
v_mfma_f32_16x16x32_bf16 v[56:59], a[8:11], a[164:167], v[56:59]
ds_read_b128 a[56:59], v190 offset:32768
v_mul_f32 v188, v188, v162
v_mfma_f32_16x16x32_bf16 v[60:63], a[12:15], a[160:163], v[60:63]
ds_read_b128 a[60:63], v190 offset:33792
buffer_load_dwordx4 a[212:215], v9, s[4:7], s52 offen offset:0 sc1
v_mfma_f32_16x16x32_bf16 v[64:67], a[12:15], a[164:167], v[64:67]
ds_read_b128 a[64:67], v190 offset:34816
v_mul_f32 v189, v189, v163
v_mfma_f32_16x16x32_bf16 v[68:71], a[16:19], a[160:163], v[68:71]
ds_read_b128 a[68:71], v190 offset:35840
v_mfma_f32_16x16x32_bf16 v[72:75], a[16:19], a[164:167], v[72:75]
v_exp_f32 v186, v186
v_mfma_f32_16x16x32_bf16 v[76:79], a[20:23], a[160:163], v[76:79]
buffer_load_dwordx4 a[216:219], v1, s[4:7], s52 offen offset:1024 sc1
v_mfma_f32_16x16x32_bf16 v[80:83], a[20:23], a[164:167], v[80:83]
v_mfma_f32_16x16x32_bf16 v[84:87], a[24:27], a[160:163], v[84:87]
v_exp_f32 v187, v187
v_mfma_f32_16x16x32_bf16 v[88:91], a[24:27], a[164:167], v[88:91]
buffer_load_dwordx4 a[220:223], v9, s[4:7], s52 offen offset:1024 sc1
v_mfma_f32_16x16x32_bf16 v[92:95], a[28:31], a[160:163], v[92:95]
v_mfma_f32_16x16x32_bf16 v[96:99], a[28:31], a[164:167], v[96:99]
v_exp_f32 v188, v188
v_mfma_f32_16x16x32_bf16 v[100:103], a[32:35], a[160:163], v[100:103]
v_mfma_f32_16x16x32_bf16 v[104:107], a[32:35], a[164:167], v[104:107]
s_waitcnt vmcnt(17) lgkmcnt(0)
s_barrier
v_mfma_f32_16x16x32_bf16 v[36:39], a[36:39], a[168:171], v[36:39]
ds_read_b128 a[0:3], v191 offset:0
s_add_u32 m0, s62, 53248
v_mfma_f32_16x16x32_bf16 v[40:43], a[36:39], a[172:175], v[40:43]
ds_read_b128 a[4:7], v191 offset:1024
v_mfma_f32_16x16x32_bf16 v[44:47], a[40:43], a[168:171], v[44:47]
ds_read_b128 a[8:11], v191 offset:2048
s_add_u32 s60, s60, 16384
v_mfma_f32_16x16x32_bf16 v[48:51], a[40:43], a[172:175], v[48:51]
ds_read_b128 a[12:15], v191 offset:3072
v_mfma_f32_16x16x32_bf16 v[52:55], a[44:47], a[168:171], v[52:55]
ds_read_b128 a[16:19], v191 offset:4096
v_mfma_f32_16x16x32_bf16 v[56:59], a[44:47], a[172:175], v[56:59]
ds_read_b128 a[20:23], v191 offset:5120
buffer_load_dwordx4 v1, s[8:11], s60 offen offset:0 sc1 lds
v_mfma_f32_16x16x32_bf16 v[60:63], a[48:51], a[168:171], v[60:63]
ds_read_b128 a[24:27], v191 offset:6144
v_mfma_f32_16x16x32_bf16 v[64:67], a[48:51], a[172:175], v[64:67]
ds_read_b128 a[28:31], v191 offset:7168
v_mfma_f32_16x16x32_bf16 v[68:71], a[52:55], a[168:171], v[68:71]
ds_read_b128 a[32:35], v191 offset:8192
buffer_load_dwordx4 v1, s[8:11], s60 offen offset:1024 sc1 lds
v_mfma_f32_16x16x32_bf16 v[72:75], a[52:55], a[172:175], v[72:75]
v_exp_f32 v189, v189
v_mfma_f32_16x16x32_bf16 v[76:79], a[56:59], a[168:171], v[76:79]
v_fma_f32 v186, v186, v255, v255
v_fma_f32 v187, v187, v255, v255
v_mfma_f32_16x16x32_bf16 v[80:83], a[56:59], a[172:175], v[80:83]
buffer_load_dwordx4 v1, s[8:11], s60 offen offset:2048 sc1 lds
v_fma_f32 v188, v188, v255, v255
v_mfma_f32_16x16x32_bf16 v[84:87], a[60:63], a[168:171], v[84:87]
v_fma_f32 v189, v189, v255, v255
v_mfma_f32_16x16x32_bf16 v[88:91], a[60:63], a[172:175], v[88:91]
v_rcp_f32 v186, v186
v_mfma_f32_16x16x32_bf16 v[92:95], a[64:67], a[168:171], v[92:95]
buffer_load_dwordx4 v1, s[8:11], s60 offen offset:3072 sc1 lds
v_mfma_f32_16x16x32_bf16 v[96:99], a[64:67], a[172:175], v[96:99]
v_rcp_f32 v187, v187
v_mfma_f32_16x16x32_bf16 v[100:103], a[68:71], a[168:171], v[100:103]
v_rcp_f32 v188, v188
v_mfma_f32_16x16x32_bf16 v[104:107], a[68:71], a[172:175], v[104:107]
s_waitcnt lgkmcnt(0)
v_mfma_f32_16x16x32_bf16 v[36:39], a[0:3], a[176:179], v[36:39]
ds_read_b128 a[36:39], v191 offset:9216
s_add_u32 m0, s63, 69632
v_mfma_f32_16x16x32_bf16 v[40:43], a[0:3], a[180:183], v[40:43]
ds_read_b128 a[40:43], v191 offset:10240
v_mfma_f32_16x16x32_bf16 v[44:47], a[4:7], a[176:179], v[44:47]
ds_read_b128 a[44:47], v191 offset:11264
s_add_u32 s61, s61, 36864
v_mfma_f32_16x16x32_bf16 v[48:51], a[4:7], a[180:183], v[48:51]
ds_read_b128 a[48:51], v191 offset:12288
v_mfma_f32_16x16x32_bf16 v[52:55], a[8:11], a[176:179], v[52:55]
ds_read_b128 a[52:55], v191 offset:13312
buffer_load_dwordx4 v1, s[8:11], s61 offen offset:0 sc1 lds
v_mfma_f32_16x16x32_bf16 v[56:59], a[8:11], a[180:183], v[56:59]
ds_read_b128 a[56:59], v191 offset:14336
v_mfma_f32_16x16x32_bf16 v[60:63], a[12:15], a[176:179], v[60:63]
ds_read_b128 a[60:63], v191 offset:15360
s_add_u32 m0, s62, 73728
v_mfma_f32_16x16x32_bf16 v[64:67], a[12:15], a[180:183], v[64:67]
ds_read_b128 a[64:67], v191 offset:16384
v_mfma_f32_16x16x32_bf16 v[68:71], a[16:19], a[176:179], v[68:71]
ds_read_b128 a[68:71], v191 offset:17408
s_add_u32 s60, s60, 20480
v_mfma_f32_16x16x32_bf16 v[72:75], a[16:19], a[180:183], v[72:75]
v_rcp_f32 v189, v189
v_mfma_f32_16x16x32_bf16 v[76:79], a[20:23], a[176:179], v[76:79]
buffer_load_dwordx4 v1, s[8:11], s60 offen offset:0 sc1 lds
v_mul_f32 v160, v160, v186
v_mfma_f32_16x16x32_bf16 v[80:83], a[20:23], a[180:183], v[80:83]
v_mul_f32 v161, v161, v187
v_mul_f32 v162, v162, v188
v_mfma_f32_16x16x32_bf16 v[84:87], a[24:27], a[176:179], v[84:87]
buffer_load_dwordx4 v1, s[8:11], s60 offen offset:1024 sc1 lds
v_mul_f32 v163, v163, v189
v_mfma_f32_16x16x32_bf16 v[88:91], a[24:27], a[180:183], v[88:91]
v_mul_f32 v182, v164, v164
v_mul_f32 v183, v165, v165
v_mfma_f32_16x16x32_bf16 v[92:95], a[28:31], a[176:179], v[92:95]
buffer_load_dwordx4 v1, s[8:11], s60 offen offset:2048 sc1 lds
v_mul_f32 v184, v166, v166
v_mfma_f32_16x16x32_bf16 v[96:99], a[28:31], a[180:183], v[96:99]
v_mfma_f32_16x16x32_bf16 v[100:103], a[32:35], a[176:179], v[100:103]
v_mul_f32 v185, v167, v167
v_mfma_f32_16x16x32_bf16 v[104:107], a[32:35], a[180:183], v[104:107]
v_fma_f32 v182, v182, v252, v250
s_waitcnt vmcnt(21) lgkmcnt(0)
v_mfma_f32_16x16x32_bf16 v[36:39], a[36:39], a[184:187], v[36:39]
ds_read_b128 a[0:3], v191 offset:18432
buffer_load_dwordx4 v1, s[8:11], s60 offen offset:3072 sc1 lds
v_mfma_f32_16x16x32_bf16 v[40:43], a[36:39], a[188:191], v[40:43]
ds_read_b128 a[4:7], v191 offset:19456
v_fma_f32 v183, v183, v252, v250
v_mfma_f32_16x16x32_bf16 v[44:47], a[40:43], a[184:187], v[44:47]
ds_read_b128 a[8:11], v191 offset:20480
v_fma_f32 v184, v184, v252, v250
v_mfma_f32_16x16x32_bf16 v[48:51], a[40:43], a[188:191], v[48:51]
ds_read_b128 a[12:15], v191 offset:21504
v_mfma_f32_16x16x32_bf16 v[52:55], a[44:47], a[184:187], v[52:55]
ds_read_b128 a[16:19], v191 offset:22528
buffer_load_dwordx4 a[224:227], v1, s[4:7], s52 offen offset:2048 sc1
v_mfma_f32_16x16x32_bf16 v[56:59], a[44:47], a[188:191], v[56:59]
ds_read_b128 a[20:23], v191 offset:23552
v_fma_f32 v185, v185, v252, v250
v_mfma_f32_16x16x32_bf16 v[60:63], a[48:51], a[184:187], v[60:63]
ds_read_b128 a[24:27], v191 offset:24576
v_mul_f32 v182, v182, v164
v_mfma_f32_16x16x32_bf16 v[64:67], a[48:51], a[188:191], v[64:67]
ds_read_b128 a[28:31], v191 offset:25600
v_mul_f32 v183, v183, v165
v_mfma_f32_16x16x32_bf16 v[68:71], a[52:55], a[184:187], v[68:71]
ds_read_b128 a[32:35], v191 offset:26624
buffer_load_dwordx4 a[228:231], v9, s[4:7], s52 offen offset:2048 sc1
v_mfma_f32_16x16x32_bf16 v[72:75], a[52:55], a[188:191], v[72:75]
v_mul_f32 v184, v184, v166
v_mfma_f32_16x16x32_bf16 v[76:79], a[56:59], a[184:187], v[76:79]
v_mul_f32 v185, v185, v167
v_mfma_f32_16x16x32_bf16 v[80:83], a[56:59], a[188:191], v[80:83]
v_mfma_f32_16x16x32_bf16 v[84:87], a[60:63], a[184:187], v[84:87]
buffer_load_dwordx4 a[232:235], v1, s[4:7], s52 offen offset:3072 sc1
v_mfma_f32_16x16x32_bf16 v[88:91], a[60:63], a[188:191], v[88:91]
v_exp_f32 v182, v182
v_mfma_f32_16x16x32_bf16 v[92:95], a[64:67], a[184:187], v[92:95]
v_mfma_f32_16x16x32_bf16 v[96:99], a[64:67], a[188:191], v[96:99]
v_exp_f32 v183, v183
v_mfma_f32_16x16x32_bf16 v[100:103], a[68:71], a[184:187], v[100:103]
v_mfma_f32_16x16x32_bf16 v[104:107], a[68:71], a[188:191], v[104:107]
s_waitcnt lgkmcnt(0)
v_mfma_f32_16x16x32_bf16 v[36:39], a[0:3], a[192:195], v[36:39]
ds_read_b128 a[36:39], v191 offset:27648
buffer_load_dwordx4 a[236:239], v9, s[4:7], s52 offen offset:3072 sc1
v_mfma_f32_16x16x32_bf16 v[40:43], a[0:3], a[196:199], v[40:43]
ds_read_b128 a[40:43], v191 offset:28672
v_mfma_f32_16x16x32_bf16 v[44:47], a[4:7], a[192:195], v[44:47]
ds_read_b128 a[44:47], v191 offset:29696
v_mfma_f32_16x16x32_bf16 v[48:51], a[4:7], a[196:199], v[48:51]
ds_read_b128 a[48:51], v191 offset:30720
s_add_u32 s52, s52, 4096
v_mfma_f32_16x16x32_bf16 v[52:55], a[8:11], a[192:195], v[52:55]
ds_read_b128 a[52:55], v191 offset:31744
v_mfma_f32_16x16x32_bf16 v[56:59], a[8:11], a[196:199], v[56:59]
ds_read_b128 a[56:59], v191 offset:32768
v_mfma_f32_16x16x32_bf16 v[60:63], a[12:15], a[192:195], v[60:63]
ds_read_b128 a[60:63], v191 offset:33792
buffer_load_dwordx4 a[240:243], v1, s[4:7], s52 offen offset:0 sc1
v_mfma_f32_16x16x32_bf16 v[64:67], a[12:15], a[196:199], v[64:67]
ds_read_b128 a[64:67], v191 offset:34816
v_mfma_f32_16x16x32_bf16 v[68:71], a[16:19], a[192:195], v[68:71]
ds_read_b128 a[68:71], v191 offset:35840
v_mfma_f32_16x16x32_bf16 v[72:75], a[16:19], a[196:199], v[72:75]
v_exp_f32 v184, v184
v_mfma_f32_16x16x32_bf16 v[76:79], a[20:23], a[192:195], v[76:79]
buffer_load_dwordx4 a[244:247], v9, s[4:7], s52 offen offset:0 sc1
v_mfma_f32_16x16x32_bf16 v[80:83], a[20:23], a[196:199], v[80:83]
v_exp_f32 v185, v185
v_mfma_f32_16x16x32_bf16 v[84:87], a[24:27], a[192:195], v[84:87]
v_fma_f32 v182, v182, v254, v254
v_fma_f32 v183, v183, v254, v254
v_mfma_f32_16x16x32_bf16 v[88:91], a[24:27], a[196:199], v[88:91]
buffer_load_dwordx4 a[248:251], v1, s[4:7], s52 offen offset:1024 sc1
v_fma_f32 v184, v184, v254, v254
v_mfma_f32_16x16x32_bf16 v[92:95], a[28:31], a[192:195], v[92:95]
v_fma_f32 v185, v185, v254, v254
v_mfma_f32_16x16x32_bf16 v[96:99], a[28:31], a[196:199], v[96:99]
v_rcp_f32 v182, v182
v_mfma_f32_16x16x32_bf16 v[100:103], a[32:35], a[192:195], v[100:103]
v_rcp_f32 v183, v183
v_mfma_f32_16x16x32_bf16 v[104:107], a[32:35], a[196:199], v[104:107]
s_waitcnt vmcnt(16) lgkmcnt(0)
s_barrier
v_mfma_f32_16x16x32_bf16 v[36:39], a[36:39], a[200:203], v[36:39]
ds_read_b128 a[0:3], v192 offset:0
buffer_load_dwordx4 a[252:255], v9, s[4:7], s52 offen offset:1024 sc1
v_mfma_f32_16x16x32_bf16 v[40:43], a[36:39], a[204:207], v[40:43]
ds_read_b128 a[4:7], v192 offset:1024
v_mfma_f32_16x16x32_bf16 v[44:47], a[40:43], a[200:203], v[44:47]
ds_read_b128 a[8:11], v192 offset:2048
s_add_u32 m0, s62, 90112
v_mfma_f32_16x16x32_bf16 v[48:51], a[40:43], a[204:207], v[48:51]
ds_read_b128 a[12:15], v192 offset:3072
v_mfma_f32_16x16x32_bf16 v[52:55], a[44:47], a[200:203], v[52:55]
ds_read_b128 a[16:19], v192 offset:4096
v_mfma_f32_16x16x32_bf16 v[56:59], a[44:47], a[204:207], v[56:59]
ds_read_b128 a[20:23], v192 offset:5120
s_add_u32 s60, s60, 16384
v_mfma_f32_16x16x32_bf16 v[60:63], a[48:51], a[200:203], v[60:63]
ds_read_b128 a[24:27], v192 offset:6144
v_mfma_f32_16x16x32_bf16 v[64:67], a[48:51], a[204:207], v[64:67]
ds_read_b128 a[28:31], v192 offset:7168
v_mfma_f32_16x16x32_bf16 v[68:71], a[52:55], a[200:203], v[68:71]
ds_read_b128 a[32:35], v192 offset:8192
buffer_load_dwordx4 v1, s[8:11], s60 offen offset:0 sc1 lds
v_mfma_f32_16x16x32_bf16 v[72:75], a[52:55], a[204:207], v[72:75]
v_rcp_f32 v184, v184
v_mfma_f32_16x16x32_bf16 v[76:79], a[56:59], a[200:203], v[76:79]
v_rcp_f32 v185, v185
v_mfma_f32_16x16x32_bf16 v[80:83], a[56:59], a[204:207], v[80:83]
buffer_load_dwordx4 v1, s[8:11], s60 offen offset:1024 sc1 lds
v_mul_f32 v164, v164, v182
v_mfma_f32_16x16x32_bf16 v[84:87], a[60:63], a[200:203], v[84:87]
v_mul_f32 v165, v165, v183
v_mul_f32 v166, v166, v184
v_mfma_f32_16x16x32_bf16 v[88:91], a[60:63], a[204:207], v[88:91]
v_mul_f32 v167, v167, v185
v_mfma_f32_16x16x32_bf16 v[92:95], a[64:67], a[200:203], v[92:95]
buffer_load_dwordx4 v1, s[8:11], s60 offen offset:2048 sc1 lds
v_mul_f32 v186, v168, v168
v_mfma_f32_16x16x32_bf16 v[96:99], a[64:67], a[204:207], v[96:99]
v_mfma_f32_16x16x32_bf16 v[100:103], a[68:71], a[200:203], v[100:103]
v_mul_f32 v187, v169, v169
v_mfma_f32_16x16x32_bf16 v[104:107], a[68:71], a[204:207], v[104:107]
v_mul_f32 v188, v170, v170
s_waitcnt lgkmcnt(0)
v_mfma_f32_16x16x32_bf16 v[36:39], a[0:3], a[208:211], v[36:39]
ds_read_b128 a[36:39], v192 offset:9216
buffer_load_dwordx4 v1, s[8:11], s60 offen offset:3072 sc1 lds
v_mfma_f32_16x16x32_bf16 v[40:43], a[0:3], a[212:215], v[40:43]
ds_read_b128 a[40:43], v192 offset:10240
v_mul_f32 v189, v171, v171
v_mfma_f32_16x16x32_bf16 v[44:47], a[4:7], a[208:211], v[44:47]
ds_read_b128 a[44:47], v192 offset:11264
s_add_u32 m0, s63, 106496
v_mfma_f32_16x16x32_bf16 v[48:51], a[4:7], a[212:215], v[48:51]
ds_read_b128 a[48:51], v192 offset:12288
v_fma_f32 v186, v186, v253, v251
v_mfma_f32_16x16x32_bf16 v[52:55], a[8:11], a[208:211], v[52:55]
ds_read_b128 a[52:55], v192 offset:13312
s_add_u32 s61, s61, 36864
v_mfma_f32_16x16x32_bf16 v[56:59], a[8:11], a[212:215], v[56:59]
ds_read_b128 a[56:59], v192 offset:14336
v_fma_f32 v187, v187, v253, v251
v_mfma_f32_16x16x32_bf16 v[60:63], a[12:15], a[208:211], v[60:63]
ds_read_b128 a[60:63], v192 offset:15360
buffer_load_dwordx4 v1, s[8:11], s61 offen offset:0 sc1 lds
v_mfma_f32_16x16x32_bf16 v[64:67], a[12:15], a[212:215], v[64:67]
ds_read_b128 a[64:67], v192 offset:16384
v_fma_f32 v188, v188, v253, v251
v_mfma_f32_16x16x32_bf16 v[68:71], a[16:19], a[208:211], v[68:71]
ds_read_b128 a[68:71], v192 offset:17408
s_add_u32 m0, s62, 110592
v_mfma_f32_16x16x32_bf16 v[72:75], a[16:19], a[212:215], v[72:75]
s_add_u32 s60, s60, 20480
v_fma_f32 v189, v189, v253, v251
v_mul_f32 v186, v186, v168
v_mfma_f32_16x16x32_bf16 v[76:79], a[20:23], a[208:211], v[76:79]
v_mul_f32 v187, v187, v169
v_mfma_f32_16x16x32_bf16 v[80:83], a[20:23], a[212:215], v[80:83]
v_mfma_f32_16x16x32_bf16 v[84:87], a[24:27], a[208:211], v[84:87]
buffer_load_dwordx4 v1, s[8:11], s60 offen offset:0 sc1 lds
v_mul_f32 v188, v188, v170
v_mfma_f32_16x16x32_bf16 v[88:91], a[24:27], a[212:215], v[88:91]
v_mfma_f32_16x16x32_bf16 v[92:95], a[28:31], a[208:211], v[92:95]
buffer_load_dwordx4 v1, s[8:11], s60 offen offset:1024 sc1 lds
v_mul_f32 v189, v189, v171
v_mfma_f32_16x16x32_bf16 v[96:99], a[28:31], a[212:215], v[96:99]
v_exp_f32 v186, v186
v_mfma_f32_16x16x32_bf16 v[100:103], a[32:35], a[208:211], v[100:103]
v_mfma_f32_16x16x32_bf16 v[104:107], a[32:35], a[212:215], v[104:107]
s_waitcnt vmcnt(11) lgkmcnt(0)
v_mfma_f32_16x16x32_bf16 v[36:39], a[36:39], a[216:219], v[36:39]
ds_read_b128 a[0:3], v192 offset:18432
buffer_load_dwordx4 v1, s[8:11], s60 offen offset:2048 sc1 lds
v_mfma_f32_16x16x32_bf16 v[40:43], a[36:39], a[220:223], v[40:43]
ds_read_b128 a[4:7], v192 offset:19456
v_mfma_f32_16x16x32_bf16 v[44:47], a[40:43], a[216:219], v[44:47]
ds_read_b128 a[8:11], v192 offset:20480
v_mfma_f32_16x16x32_bf16 v[48:51], a[40:43], a[220:223], v[48:51]
ds_read_b128 a[12:15], v192 offset:21504
v_mfma_f32_16x16x32_bf16 v[52:55], a[44:47], a[216:219], v[52:55]
ds_read_b128 a[16:19], v192 offset:22528
buffer_load_dwordx4 v1, s[8:11], s60 offen offset:3072 sc1 lds
v_mfma_f32_16x16x32_bf16 v[56:59], a[44:47], a[220:223], v[56:59]
ds_read_b128 a[20:23], v192 offset:23552
v_mfma_f32_16x16x32_bf16 v[60:63], a[48:51], a[216:219], v[60:63]
ds_read_b128 a[24:27], v192 offset:24576
v_mfma_f32_16x16x32_bf16 v[64:67], a[48:51], a[220:223], v[64:67]
ds_read_b128 a[28:31], v192 offset:25600
v_mfma_f32_16x16x32_bf16 v[68:71], a[52:55], a[216:219], v[68:71]
ds_read_b128 a[32:35], v192 offset:26624
buffer_load_dwordx4 a[80:83], v1, s[4:7], s52 offen offset:2048 sc1
v_mfma_f32_16x16x32_bf16 v[72:75], a[52:55], a[220:223], v[72:75]
v_exp_f32 v187, v187
v_mfma_f32_16x16x32_bf16 v[76:79], a[56:59], a[216:219], v[76:79]
v_exp_f32 v188, v188
v_mfma_f32_16x16x32_bf16 v[80:83], a[56:59], a[220:223], v[80:83]
v_exp_f32 v189, v189
v_mfma_f32_16x16x32_bf16 v[84:87], a[60:63], a[216:219], v[84:87]
buffer_load_dwordx4 a[84:87], v9, s[4:7], s52 offen offset:2048 sc1
v_fma_f32 v186, v186, v255, v255
v_mfma_f32_16x16x32_bf16 v[88:91], a[60:63], a[220:223], v[88:91]
v_fma_f32 v187, v187, v255, v255
v_fma_f32 v188, v188, v255, v255
v_mfma_f32_16x16x32_bf16 v[92:95], a[64:67], a[216:219], v[92:95]
v_mfma_f32_16x16x32_bf16 v[96:99], a[64:67], a[220:223], v[96:99]
v_fma_f32 v189, v189, v255, v255
v_mfma_f32_16x16x32_bf16 v[100:103], a[68:71], a[216:219], v[100:103]
v_rcp_f32 v186, v186
v_mfma_f32_16x16x32_bf16 v[104:107], a[68:71], a[220:223], v[104:107]
s_waitcnt lgkmcnt(0)
v_mfma_f32_16x16x32_bf16 v[36:39], a[0:3], a[224:227], v[36:39]
ds_read_b128 a[36:39], v192 offset:27648
buffer_load_dwordx4 a[88:91], v1, s[4:7], s52 offen offset:3072 sc1
v_mfma_f32_16x16x32_bf16 v[40:43], a[0:3], a[228:231], v[40:43]
ds_read_b128 a[40:43], v192 offset:28672
s_mov_b32 s37, L_c5-L_pc
v_mfma_f32_16x16x32_bf16 v[44:47], a[4:7], a[224:227], v[44:47]
ds_read_b128 a[44:47], v192 offset:29696
v_mfma_f32_16x16x32_bf16 v[48:51], a[4:7], a[228:231], v[48:51]
ds_read_b128 a[48:51], v192 offset:30720
buffer_load_dwordx4 a[92:95], v9, s[4:7], s52 offen offset:3072 sc1
v_mfma_f32_16x16x32_bf16 v[52:55], a[8:11], a[224:227], v[52:55]
ds_read_b128 a[52:55], v192 offset:31744
buffer_load_dword v15, v14, s[88:91], s37 offen
v_mfma_f32_16x16x32_bf16 v[56:59], a[8:11], a[228:231], v[56:59]
ds_read_b128 a[56:59], v192 offset:32768
v_mfma_f32_16x16x32_bf16 v[60:63], a[12:15], a[224:227], v[60:63]
ds_read_b128 a[60:63], v192 offset:33792
s_add_u32 s52, s52, 4096
v_mfma_f32_16x16x32_bf16 v[64:67], a[12:15], a[228:231], v[64:67]
ds_read_b128 a[64:67], v192 offset:34816
v_mfma_f32_16x16x32_bf16 v[68:71], a[16:19], a[224:227], v[68:71]
ds_read_b128 a[68:71], v192 offset:35840
v_mfma_f32_16x16x32_bf16 v[72:75], a[16:19], a[228:231], v[72:75]
v_rcp_f32 v187, v187
v_mfma_f32_16x16x32_bf16 v[76:79], a[20:23], a[224:227], v[76:79]
buffer_load_dwordx4 a[96:99], v1, s[4:7], s52 offen offset:0 sc1
v_mfma_f32_16x16x32_bf16 v[80:83], a[20:23], a[228:231], v[80:83]
v_rcp_f32 v188, v188
v_mfma_f32_16x16x32_bf16 v[84:87], a[24:27], a[224:227], v[84:87]
v_rcp_f32 v189, v189
v_mfma_f32_16x16x32_bf16 v[88:91], a[24:27], a[228:231], v[88:91]
buffer_load_dwordx4 a[100:103], v9, s[4:7], s52 offen offset:0 sc1
v_mul_f32 v168, v168, v186
v_mfma_f32_16x16x32_bf16 v[92:95], a[28:31], a[224:227], v[92:95]
v_mul_f32 v169, v169, v187
v_mul_f32 v170, v170, v188
v_mfma_f32_16x16x32_bf16 v[96:99], a[28:31], a[228:231], v[96:99]
v_mfma_f32_16x16x32_bf16 v[100:103], a[32:35], a[224:227], v[100:103]
v_mul_f32 v171, v171, v189
v_mfma_f32_16x16x32_bf16 v[104:107], a[32:35], a[228:231], v[104:107]
s_waitcnt vmcnt(16) lgkmcnt(0)
s_barrier
v_mfma_f32_16x16x32_bf16 v[36:39], a[36:39], a[232:235], v[36:39]
ds_read_b128 a[0:3], v190 offset:0
buffer_load_dwordx4 a[104:107], v1, s[4:7], s52 offen offset:1024 sc1
v_mfma_f32_16x16x32_bf16 v[40:43], a[36:39], a[236:239], v[40:43]
ds_read_b128 a[4:7], v190 offset:1024
v_mul_f32 v182, v172, v172
v_mfma_f32_16x16x32_bf16 v[44:47], a[40:43], a[232:235], v[44:47]
ds_read_b128 a[8:11], v190 offset:2048
buffer_load_dwordx4 a[108:111], v9, s[4:7], s52 offen offset:1024 sc1
v_mfma_f32_16x16x32_bf16 v[48:51], a[40:43], a[236:239], v[48:51]
ds_read_b128 a[12:15], v190 offset:3072
v_mul_f32 v183, v173, v173
v_mfma_f32_16x16x32_bf16 v[52:55], a[44:47], a[232:235], v[52:55]
ds_read_b128 a[16:19], v190 offset:4096
v_mul_f32 v184, v174, v174
v_mfma_f32_16x16x32_bf16 v[56:59], a[44:47], a[236:239], v[56:59]
ds_read_b128 a[20:23], v190 offset:5120
s_add_u32 m0, s62, 126976
v_mfma_f32_16x16x32_bf16 v[60:63], a[48:51], a[232:235], v[60:63]
ds_read_b128 a[24:27], v190 offset:6144
v_mul_f32 v185, v175, v175
v_mfma_f32_16x16x32_bf16 v[64:67], a[48:51], a[236:239], v[64:67]
ds_read_b128 a[28:31], v190 offset:7168
v_fma_f32 v182, v182, v252, v250
v_mfma_f32_16x16x32_bf16 v[68:71], a[52:55], a[232:235], v[68:71]
ds_read_b128 a[32:35], v190 offset:8192
s_add_u32 s60, s60, 16384
v_mfma_f32_16x16x32_bf16 v[72:75], a[52:55], a[236:239], v[72:75]
v_fma_f32 v183, v183, v252, v250
v_fma_f32 v184, v184, v252, v250
v_mfma_f32_16x16x32_bf16 v[76:79], a[56:59], a[232:235], v[76:79]
v_mfma_f32_16x16x32_bf16 v[80:83], a[56:59], a[236:239], v[80:83]
buffer_load_dwordx4 v1, s[8:11], s60 offen offset:0 sc1 lds
v_fma_f32 v185, v185, v252, v250
v_mfma_f32_16x16x32_bf16 v[84:87], a[60:63], a[232:235], v[84:87]
v_mul_f32 v182, v182, v172
v_mfma_f32_16x16x32_bf16 v[88:91], a[60:63], a[236:239], v[88:91]
v_mfma_f32_16x16x32_bf16 v[92:95], a[64:67], a[232:235], v[92:95]
buffer_load_dwordx4 v1, s[8:11], s60 offen offset:1024 sc1 lds
v_mul_f32 v183, v183, v173
v_mfma_f32_16x16x32_bf16 v[96:99], a[64:67], a[236:239], v[96:99]
v_mul_f32 v184, v184, v174
v_mfma_f32_16x16x32_bf16 v[100:103], a[68:71], a[232:235], v[100:103]
v_mfma_f32_16x16x32_bf16 v[104:107], a[68:71], a[236:239], v[104:107]
v_mul_f32 v185, v185, v175
s_waitcnt lgkmcnt(0)
v_mfma_f32_16x16x32_bf16 v[36:39], a[0:3], a[240:243], v[36:39]
ds_read_b128 a[36:39], v190 offset:9216
buffer_load_dwordx4 v1, s[8:11], s60 offen offset:2048 sc1 lds
v_mfma_f32_16x16x32_bf16 v[40:43], a[0:3], a[244:247], v[40:43]
ds_read_b128 a[40:43], v190 offset:10240
v_mfma_f32_16x16x32_bf16 v[44:47], a[4:7], a[240:243], v[44:47]
ds_read_b128 a[44:47], v190 offset:11264
buffer_load_dwordx4 v1, s[8:11], s60 offen offset:3072 sc1 lds
v_mfma_f32_16x16x32_bf16 v[48:51], a[4:7], a[244:247], v[48:51]
ds_read_b128 a[48:51], v190 offset:12288
v_mfma_f32_16x16x32_bf16 v[52:55], a[8:11], a[240:243], v[52:55]
ds_read_b128 a[52:55], v190 offset:13312
s_add_u32 m0, s63, 143360
v_mfma_f32_16x16x32_bf16 v[56:59], a[8:11], a[244:247], v[56:59]
ds_read_b128 a[56:59], v190 offset:14336
v_mfma_f32_16x16x32_bf16 v[60:63], a[12:15], a[240:243], v[60:63]
ds_read_b128 a[60:63], v190 offset:15360
s_add_u32 s61, s61, 36864
v_mfma_f32_16x16x32_bf16 v[64:67], a[12:15], a[244:247], v[64:67]
ds_read_b128 a[64:67], v190 offset:16384
v_mfma_f32_16x16x32_bf16 v[68:71], a[16:19], a[240:243], v[68:71]
ds_read_b128 a[68:71], v190 offset:17408
buffer_load_dwordx4 v1, s[8:11], s61 offen offset:0 sc1 lds
v_mfma_f32_16x16x32_bf16 v[72:75], a[16:19], a[244:247], v[72:75]
s_add_u32 m0, s62, 147456
v_exp_f32 v182, v182
v_mfma_f32_16x16x32_bf16 v[76:79], a[20:23], a[240:243], v[76:79]
s_add_u32 s60, s60, 20480
v_exp_f32 v183, v183
v_mfma_f32_16x16x32_bf16 v[80:83], a[20:23], a[244:247], v[80:83]
v_exp_f32 v184, v184
v_mfma_f32_16x16x32_bf16 v[84:87], a[24:27], a[240:243], v[84:87]
v_exp_f32 v185, v185
v_mfma_f32_16x16x32_bf16 v[88:91], a[24:27], a[244:247], v[88:91]
v_fma_f32 v182, v182, v254, v254
v_mfma_f32_16x16x32_bf16 v[92:95], a[28:31], a[240:243], v[92:95]
buffer_load_dwordx4 v1, s[8:11], s60 offen offset:0 sc1 lds
v_mfma_f32_16x16x32_bf16 v[96:99], a[28:31], a[244:247], v[96:99]
v_fma_f32 v183, v183, v254, v254
v_mfma_f32_16x16x32_bf16 v[100:103], a[32:35], a[240:243], v[100:103]
v_mfma_f32_16x16x32_bf16 v[104:107], a[32:35], a[244:247], v[104:107]
v_fma_f32 v184, v184, v254, v254
s_waitcnt vmcnt(11) lgkmcnt(0)
v_mfma_f32_16x16x32_bf16 v[36:39], a[36:39], a[248:251], v[36:39]
ds_read_b128 a[0:3], v190 offset:18432
buffer_load_dwordx4 v1, s[8:11], s60 offen offset:1024 sc1 lds
v_mfma_f32_16x16x32_bf16 v[40:43], a[36:39], a[252:255], v[40:43]
ds_read_b128 a[4:7], v190 offset:19456
v_fma_f32 v185, v185, v254, v254
v_mfma_f32_16x16x32_bf16 v[44:47], a[40:43], a[248:251], v[44:47]
ds_read_b128 a[8:11], v190 offset:20480
v_mfma_f32_16x16x32_bf16 v[48:51], a[40:43], a[252:255], v[48:51]
ds_read_b128 a[12:15], v190 offset:21504
v_mfma_f32_16x16x32_bf16 v[52:55], a[44:47], a[248:251], v[52:55]
ds_read_b128 a[16:19], v190 offset:22528
buffer_load_dwordx4 v1, s[8:11], s60 offen offset:2048 sc1 lds
v_mfma_f32_16x16x32_bf16 v[56:59], a[44:47], a[252:255], v[56:59]
ds_read_b128 a[20:23], v190 offset:23552
v_mfma_f32_16x16x32_bf16 v[60:63], a[48:51], a[248:251], v[60:63]
ds_read_b128 a[24:27], v190 offset:24576
v_mfma_f32_16x16x32_bf16 v[64:67], a[48:51], a[252:255], v[64:67]
ds_read_b128 a[28:31], v190 offset:25600
v_mfma_f32_16x16x32_bf16 v[68:71], a[52:55], a[248:251], v[68:71]
ds_read_b128 a[32:35], v190 offset:26624
buffer_load_dwordx4 v1, s[8:11], s60 offen offset:3072 sc1 lds
v_mfma_f32_16x16x32_bf16 v[72:75], a[52:55], a[252:255], v[72:75]
v_rcp_f32 v182, v182
v_mfma_f32_16x16x32_bf16 v[76:79], a[56:59], a[248:251], v[76:79]
v_rcp_f32 v183, v183
v_mfma_f32_16x16x32_bf16 v[80:83], a[56:59], a[252:255], v[80:83]
v_rcp_f32 v184, v184
v_mfma_f32_16x16x32_bf16 v[84:87], a[60:63], a[248:251], v[84:87]
buffer_load_dwordx4 a[112:115], v1, s[4:7], s52 offen offset:2048 sc1
v_mfma_f32_16x16x32_bf16 v[88:91], a[60:63], a[252:255], v[88:91]
v_rcp_f32 v185, v185
v_mfma_f32_16x16x32_bf16 v[92:95], a[64:67], a[248:251], v[92:95]
v_mul_f32 v172, v172, v182
v_mfma_f32_16x16x32_bf16 v[96:99], a[64:67], a[252:255], v[96:99]
v_mfma_f32_16x16x32_bf16 v[100:103], a[68:71], a[248:251], v[100:103]
v_mul_f32 v173, v173, v183
v_mfma_f32_16x16x32_bf16 v[104:107], a[68:71], a[252:255], v[104:107]
s_waitcnt lgkmcnt(0)
v_mfma_f32_16x16x32_bf16 v[36:39], a[0:3], a[80:83], v[36:39]
ds_read_b128 a[36:39], v190 offset:27648
buffer_load_dwordx4 a[116:119], v9, s[4:7], s52 offen offset:2048 sc1
v_mfma_f32_16x16x32_bf16 v[40:43], a[0:3], a[84:87], v[40:43]
ds_read_b128 a[40:43], v190 offset:28672
v_mul_f32 v174, v174, v184
v_mfma_f32_16x16x32_bf16 v[44:47], a[4:7], a[80:83], v[44:47]
ds_read_b128 a[44:47], v190 offset:29696
v_mul_f32 v175, v175, v185
v_mfma_f32_16x16x32_bf16 v[48:51], a[4:7], a[84:87], v[48:51]
ds_read_b128 a[48:51], v190 offset:30720
buffer_load_dwordx4 a[120:123], v1, s[4:7], s52 offen offset:3072 sc1
v_mfma_f32_16x16x32_bf16 v[52:55], a[8:11], a[80:83], v[52:55]
ds_read_b128 a[52:55], v190 offset:31744
v_mul_f32 v186, v176, v176
v_mfma_f32_16x16x32_bf16 v[56:59], a[8:11], a[84:87], v[56:59]
ds_read_b128 a[56:59], v190 offset:32768
v_mul_f32 v187, v177, v177
v_mfma_f32_16x16x32_bf16 v[60:63], a[12:15], a[80:83], v[60:63]
ds_read_b128 a[60:63], v190 offset:33792
buffer_load_dwordx4 a[124:127], v9, s[4:7], s52 offen offset:3072 sc1
v_mfma_f32_16x16x32_bf16 v[64:67], a[12:15], a[84:87], v[64:67]
ds_read_b128 a[64:67], v190 offset:34816
v_mul_f32 v188, v178, v178
v_mfma_f32_16x16x32_bf16 v[68:71], a[16:19], a[80:83], v[68:71]
ds_read_b128 a[68:71], v190 offset:35840
v_mul_f32 v189, v179, v179
v_mfma_f32_16x16x32_bf16 v[72:75], a[16:19], a[84:87], v[72:75]
s_add_u32 s52, s52, 4096
v_fma_f32 v186, v186, v253, v251
v_mfma_f32_16x16x32_bf16 v[76:79], a[20:23], a[80:83], v[76:79]
v_mfma_f32_16x16x32_bf16 v[80:83], a[20:23], a[84:87], v[80:83]
v_fma_f32 v187, v187, v253, v251
v_mfma_f32_16x16x32_bf16 v[84:87], a[24:27], a[80:83], v[84:87]
v_fma_f32 v188, v188, v253, v251
v_mfma_f32_16x16x32_bf16 v[88:91], a[24:27], a[84:87], v[88:91]
buffer_load_dwordx4 a[128:131], v1, s[4:7], s52 offen offset:0 sc1
v_mfma_f32_16x16x32_bf16 v[92:95], a[28:31], a[80:83], v[92:95]
v_fma_f32 v189, v189, v253, v251
v_mfma_f32_16x16x32_bf16 v[96:99], a[28:31], a[84:87], v[96:99]
v_mfma_f32_16x16x32_bf16 v[100:103], a[32:35], a[80:83], v[100:103]
v_mul_f32 v186, v186, v176
v_mfma_f32_16x16x32_bf16 v[104:107], a[32:35], a[84:87], v[104:107]
s_waitcnt vmcnt(14) lgkmcnt(0)
s_barrier
v_mfma_f32_16x16x32_bf16 v[36:39], a[36:39], a[88:91], v[36:39]
ds_read_b128 a[0:3], v191 offset:0
buffer_load_dwordx4 a[132:135], v9, s[4:7], s52 offen offset:0 sc1
v_mfma_f32_16x16x32_bf16 v[40:43], a[36:39], a[92:95], v[40:43]
ds_read_b128 a[4:7], v191 offset:1024
v_mul_f32 v187, v187, v177
v_mfma_f32_16x16x32_bf16 v[44:47], a[40:43], a[88:91], v[44:47]
ds_read_b128 a[8:11], v191 offset:2048
v_mul_f32 v188, v188, v178
v_mfma_f32_16x16x32_bf16 v[48:51], a[40:43], a[92:95], v[48:51]
ds_read_b128 a[12:15], v191 offset:3072
v_mul_f32 v189, v189, v179
v_mfma_f32_16x16x32_bf16 v[52:55], a[44:47], a[88:91], v[52:55]
ds_read_b128 a[16:19], v191 offset:4096
buffer_load_dwordx4 a[136:139], v1, s[4:7], s52 offen offset:1024 sc1
v_mfma_f32_16x16x32_bf16 v[56:59], a[44:47], a[92:95], v[56:59]
ds_read_b128 a[20:23], v191 offset:5120
v_mfma_f32_16x16x32_bf16 v[60:63], a[48:51], a[88:91], v[60:63]
ds_read_b128 a[24:27], v191 offset:6144
v_mfma_f32_16x16x32_bf16 v[64:67], a[48:51], a[92:95], v[64:67]
ds_read_b128 a[28:31], v191 offset:7168
v_mfma_f32_16x16x32_bf16 v[68:71], a[52:55], a[88:91], v[68:71]
ds_read_b128 a[32:35], v191 offset:8192
buffer_load_dwordx4 a[140:143], v9, s[4:7], s52 offen offset:1024 sc1
v_mfma_f32_16x16x32_bf16 v[72:75], a[52:55], a[92:95], v[72:75]
v_exp_f32 v186, v186
v_mfma_f32_16x16x32_bf16 v[76:79], a[56:59], a[88:91], v[76:79]
v_exp_f32 v187, v187
v_mfma_f32_16x16x32_bf16 v[80:83], a[56:59], a[92:95], v[80:83]
v_exp_f32 v188, v188
v_mfma_f32_16x16x32_bf16 v[84:87], a[60:63], a[88:91], v[84:87]
buffer_load_dwordx4 a[144:147], v1, s[4:7], s52 offen offset:2048 sc1
v_mfma_f32_16x16x32_bf16 v[88:91], a[60:63], a[92:95], v[88:91]
v_mfma_f32_16x16x32_bf16 v[92:95], a[64:67], a[88:91], v[92:95]
v_exp_f32 v189, v189
v_mfma_f32_16x16x32_bf16 v[96:99], a[64:67], a[92:95], v[96:99]
v_mfma_f32_16x16x32_bf16 v[100:103], a[68:71], a[88:91], v[100:103]
v_mfma_f32_16x16x32_bf16 v[104:107], a[68:71], a[92:95], v[104:107]
v_fma_f32 v186, v186, v255, v255
s_waitcnt lgkmcnt(0)
v_mfma_f32_16x16x32_bf16 v[36:39], a[0:3], a[96:99], v[36:39]
ds_read_b128 a[36:39], v191 offset:9216
buffer_load_dwordx4 a[148:151], v9, s[4:7], s52 offen offset:2048 sc1
v_mfma_f32_16x16x32_bf16 v[40:43], a[0:3], a[100:103], v[40:43]
ds_read_b128 a[40:43], v191 offset:10240
v_fma_f32 v187, v187, v255, v255
v_mfma_f32_16x16x32_bf16 v[44:47], a[4:7], a[96:99], v[44:47]
ds_read_b128 a[44:47], v191 offset:11264
buffer_load_dwordx4 a[152:155], v1, s[4:7], s52 offen offset:3072 sc1
v_mfma_f32_16x16x32_bf16 v[48:51], a[4:7], a[100:103], v[48:51]
ds_read_b128 a[48:51], v191 offset:12288
v_fma_f32 v188, v188, v255, v255
v_mfma_f32_16x16x32_bf16 v[52:55], a[8:11], a[96:99], v[52:55]
ds_read_b128 a[52:55], v191 offset:13312
buffer_load_dwordx4 a[156:159], v9, s[4:7], s52 offen offset:3072 sc1
v_mfma_f32_16x16x32_bf16 v[56:59], a[8:11], a[100:103], v[56:59]
ds_read_b128 a[56:59], v191 offset:14336
v_fma_f32 v189, v189, v255, v255
v_mfma_f32_16x16x32_bf16 v[60:63], a[12:15], a[96:99], v[60:63]
ds_read_b128 a[60:63], v191 offset:15360
v_mfma_f32_16x16x32_bf16 v[64:67], a[12:15], a[100:103], v[64:67]
ds_read_b128 a[64:67], v191 offset:16384
s_mul_i32 s38, s24, 13312
v_mfma_f32_16x16x32_bf16 v[68:71], a[16:19], a[96:99], v[68:71]
ds_read_b128 a[68:71], v191 offset:17408
v_mfma_f32_16x16x32_bf16 v[72:75], a[16:19], a[100:103], v[72:75]
s_add_u32 m0, s38, 0
v_rcp_f32 v186, v186
v_mfma_f32_16x16x32_bf16 v[76:79], a[20:23], a[96:99], v[76:79]
s_add_u32 s39, s38, s83
v_rcp_f32 v187, v187
v_mfma_f32_16x16x32_bf16 v[80:83], a[20:23], a[100:103], v[80:83]
v_rcp_f32 v188, v188
v_mfma_f32_16x16x32_bf16 v[84:87], a[24:27], a[96:99], v[84:87]
v_mfma_f32_16x16x32_bf16 v[88:91], a[24:27], a[100:103], v[88:91]
v_mfma_f32_16x16x32_bf16 v[92:95], a[28:31], a[96:99], v[92:95]
buffer_load_dwordx4 v1, s[4:7], s39 offen offset:0 sc1 lds
v_mfma_f32_16x16x32_bf16 v[96:99], a[28:31], a[100:103], v[96:99]
v_rcp_f32 v189, v189
v_mfma_f32_16x16x32_bf16 v[100:103], a[32:35], a[96:99], v[100:103]
v_mfma_f32_16x16x32_bf16 v[104:107], a[32:35], a[100:103], v[104:107]
s_waitcnt vmcnt(9) lgkmcnt(0)
v_mfma_f32_16x16x32_bf16 v[36:39], a[36:39], a[104:107], v[36:39]
ds_read_b128 a[0:3], v191 offset:18432
buffer_load_dwordx4 v1, s[4:7], s39 offen offset:1024 sc1 lds
v_mfma_f32_16x16x32_bf16 v[40:43], a[36:39], a[108:111], v[40:43]
ds_read_b128 a[4:7], v191 offset:19456
v_mul_f32 v176, v176, v186
v_mfma_f32_16x16x32_bf16 v[44:47], a[40:43], a[104:107], v[44:47]
ds_read_b128 a[8:11], v191 offset:20480
buffer_load_dwordx4 v1, s[4:7], s39 offen offset:2048 sc1 lds
v_mfma_f32_16x16x32_bf16 v[48:51], a[40:43], a[108:111], v[48:51]
ds_read_b128 a[12:15], v191 offset:21504
v_mul_f32 v177, v177, v187
v_mfma_f32_16x16x32_bf16 v[52:55], a[44:47], a[104:107], v[52:55]
ds_read_b128 a[16:19], v191 offset:22528
v_mul_f32 v178, v178, v188
v_mfma_f32_16x16x32_bf16 v[56:59], a[44:47], a[108:111], v[56:59]
ds_read_b128 a[20:23], v191 offset:23552
buffer_load_dwordx4 v1, s[4:7], s39 offen offset:3072 sc1 lds
v_mfma_f32_16x16x32_bf16 v[60:63], a[48:51], a[104:107], v[60:63]
ds_read_b128 a[24:27], v191 offset:24576
v_mul_f32 v179, v179, v189
v_mfma_f32_16x16x32_bf16 v[64:67], a[48:51], a[108:111], v[64:67]
ds_read_b128 a[28:31], v191 offset:25600
s_lshl_b32 s30, s25, 3
v_mfma_f32_16x16x32_bf16 v[68:71], a[52:55], a[104:107], v[68:71]
ds_read_b128 a[32:35], v191 offset:26624
s_add_u32 m0, m0, 4096
v_mfma_f32_16x16x32_bf16 v[72:75], a[52:55], a[108:111], v[72:75]
s_add_u32 s39, s39, 4096
s_lshl_b32 s31, s24, 1
s_add_u32 s30, s30, s31
v_mfma_f32_16x16x32_bf16 v[76:79], a[56:59], a[104:107], v[76:79]
s_mul_i32 s30, s30, 73728
v_mfma_f32_16x16x32_bf16 v[80:83], a[56:59], a[108:111], v[80:83]
s_add_u32 s30, s30, 16777216
v_mfma_f32_16x16x32_bf16 v[84:87], a[60:63], a[104:107], v[84:87]
s_mul_i32 s31, s26, 4608
v_mfma_f32_16x16x32_bf16 v[88:91], a[60:63], a[108:111], v[88:91]
s_add_u32 s30, s30, s31
v_mfma_f32_16x16x32_bf16 v[92:95], a[64:67], a[104:107], v[92:95]
buffer_load_dwordx4 v1, s[4:7], s39 offen offset:0 sc1 lds
v_mfma_f32_16x16x32_bf16 v[96:99], a[64:67], a[108:111], v[96:99]
s_and_b32 s65, s26, 1
v_mfma_f32_16x16x32_bf16 v[100:103], a[68:71], a[104:107], v[100:103]
s_lshl_b32 s64, s65, 9
v_mfma_f32_16x16x32_bf16 v[104:107], a[68:71], a[108:111], v[104:107]
s_add_u32 s64, s64, s30
s_waitcnt lgkmcnt(0)
v_mfma_f32_16x16x32_bf16 v[36:39], a[0:3], a[112:115], v[36:39]
ds_read_b128 a[36:39], v191 offset:27648
buffer_load_dwordx4 v1, s[4:7], s39 offen offset:1024 sc1 lds
v_mfma_f32_16x16x32_bf16 v[40:43], a[0:3], a[116:119], v[40:43]
ds_read_b128 a[40:43], v191 offset:28672
v_mfma_f32_16x16x32_bf16 v[44:47], a[4:7], a[112:115], v[44:47]
ds_read_b128 a[44:47], v191 offset:29696
buffer_load_dwordx4 v1, s[4:7], s39 offen offset:2048 sc1 lds
v_mfma_f32_16x16x32_bf16 v[48:51], a[4:7], a[116:119], v[48:51]
ds_read_b128 a[48:51], v191 offset:30720
v_mfma_f32_16x16x32_bf16 v[52:55], a[8:11], a[112:115], v[52:55]
ds_read_b128 a[52:55], v191 offset:31744
s_xor_b32 s65, s65, 1
v_mfma_f32_16x16x32_bf16 v[56:59], a[8:11], a[116:119], v[56:59]
ds_read_b128 a[56:59], v191 offset:32768
buffer_load_dwordx4 v1, s[4:7], s39 offen offset:3072 sc1 lds
v_mfma_f32_16x16x32_bf16 v[60:63], a[12:15], a[112:115], v[60:63]
ds_read_b128 a[60:63], v191 offset:33792
s_lshl_b32 s65, s65, 12
v_mfma_f32_16x16x32_bf16 v[64:67], a[12:15], a[116:119], v[64:67]
ds_read_b128 a[64:67], v191 offset:34816
s_add_u32 s65, s65, s30
v_mfma_f32_16x16x32_bf16 v[68:71], a[16:19], a[112:115], v[68:71]
ds_read_b128 a[68:71], v191 offset:35840
s_add_u32 m0, m0, 4096
v_mfma_f32_16x16x32_bf16 v[72:75], a[16:19], a[116:119], v[72:75]
s_add_u32 s39, s39, 4096
v_add_u32 v237, 73728, v1
v_mfma_f32_16x16x32_bf16 v[76:79], a[20:23], a[112:115], v[76:79]
v_mfma_f32_16x16x32_bf16 v[80:83], a[20:23], a[116:119], v[80:83]
v_and_b32 v236, 1, v3
v_mfma_f32_16x16x32_bf16 v[84:87], a[24:27], a[112:115], v[84:87]
v_mul_u32_u24 v236, 73728, v236
v_mfma_f32_16x16x32_bf16 v[88:91], a[24:27], a[116:119], v[88:91]
v_mfma_f32_16x16x32_bf16 v[92:95], a[28:31], a[112:115], v[92:95]
buffer_load_dwordx4 v1, s[4:7], s39 offen offset:0 sc1 lds
v_lshrrev_b32 v8, 1, v3
v_mfma_f32_16x16x32_bf16 v[96:99], a[28:31], a[116:119], v[96:99]
v_lshl_add_u32 v236, v8, 8, v236
v_mfma_f32_16x16x32_bf16 v[100:103], a[32:35], a[112:115], v[100:103]
v_mfma_f32_16x16x32_bf16 v[104:107], a[32:35], a[116:119], v[104:107]
s_waitcnt vmcnt(9) lgkmcnt(0)
s_barrier
v_mfma_f32_16x16x32_bf16 v[36:39], a[36:39], a[120:123], v[36:39]
ds_read_b128 a[0:3], v192 offset:8192
buffer_load_dwordx4 v1, s[4:7], s39 offen offset:1024 sc1 lds
v_lshl_add_u32 v236, v2, 4, v236
v_mfma_f32_16x16x32_bf16 v[40:43], a[36:39], a[124:127], v[40:43]
ds_read_b128 a[4:7], v192 offset:17408
v_mfma_f32_16x16x32_bf16 v[44:47], a[40:43], a[120:123], v[44:47]
ds_read_b128 a[8:11], v192 offset:26624
buffer_load_dwordx4 v1, s[4:7], s39 offen offset:2048 sc1 lds
v_mfma_f32_16x16x32_bf16 v[48:51], a[40:43], a[124:127], v[48:51]
ds_read_b128 a[12:15], v192 offset:35840
v_mfma_f32_16x16x32_bf16 v[52:55], a[44:47], a[120:123], v[52:55]
ds_read_b128 a[16:19], v192 offset:0
v_mfma_f32_16x16x32_bf16 v[56:59], a[44:47], a[124:127], v[56:59]
ds_read_b128 a[20:23], v192 offset:1024
buffer_load_dwordx4 v1, s[4:7], s39 offen offset:3072 sc1 lds
v_mfma_f32_16x16x32_bf16 v[60:63], a[48:51], a[120:123], v[60:63]
ds_read_b128 a[24:27], v192 offset:9216
v_mfma_f32_16x16x32_bf16 v[64:67], a[48:51], a[124:127], v[64:67]
ds_read_b128 a[28:31], v192 offset:10240
v_mfma_f32_16x16x32_bf16 v[68:71], a[52:55], a[120:123], v[68:71]
ds_read_b128 a[32:35], v192 offset:18432
s_add_u32 m0, m0, 4096
v_mfma_f32_16x16x32_bf16 v[72:75], a[52:55], a[124:127], v[72:75]
s_add_u32 s39, s39, 4096
v_mfma_f32_16x16x32_bf16 v[76:79], a[56:59], a[120:123], v[76:79]
v_mfma_f32_16x16x32_bf16 v[80:83], a[56:59], a[124:127], v[80:83]
v_mfma_f32_16x16x32_bf16 v[84:87], a[60:63], a[120:123], v[84:87]
v_mfma_f32_16x16x32_bf16 v[88:91], a[60:63], a[124:127], v[88:91]
v_mfma_f32_16x16x32_bf16 v[92:95], a[64:67], a[120:123], v[92:95]
buffer_load_dwordx4 v1, s[4:7], s39 offen offset:0 sc1 lds
v_mfma_f32_16x16x32_bf16 v[96:99], a[64:67], a[124:127], v[96:99]
v_mfma_f32_16x16x32_bf16 v[100:103], a[68:71], a[120:123], v[100:103]
v_mfma_f32_16x16x32_bf16 v[104:107], a[68:71], a[124:127], v[104:107]
s_waitcnt lgkmcnt(7)
v_mfma_f32_16x16x32_bf16 v[100:103], a[0:3], a[128:131], v[100:103]
ds_read_b128 a[36:39], v192 offset:19456
v_mfma_f32_16x16x32_bf16 v[104:107], a[0:3], a[132:135], v[104:107]
v_mfma_f32_16x16x32_bf16 v[100:103], a[4:7], a[136:139], v[100:103]
ds_read_b128 a[40:43], v192 offset:27648
v_mfma_f32_16x16x32_bf16 v[104:107], a[4:7], a[140:143], v[104:107]
s_waitcnt lgkmcnt(7)
v_mfma_f32_16x16x32_bf16 v[100:103], a[8:11], a[144:147], v[100:103]
ds_read_b128 a[44:47], v192 offset:28672
v_mfma_f32_16x16x32_bf16 v[104:107], a[8:11], a[148:151], v[104:107]
v_mfma_f32_16x16x32_bf16 v[100:103], a[12:15], a[152:155], v[100:103]
ds_read_b128 a[48:51], v192 offset:2048
v_mfma_f32_16x16x32_bf16 v[104:107], a[12:15], a[156:159], v[104:107]
s_waitcnt lgkmcnt(7)
v_mfma_f32_16x16x32_bf16 v[36:39], a[16:19], a[128:131], v[36:39]
ds_read_b128 a[52:55], v192 offset:3072
v_mfma_f32_16x16x32_bf16 v[40:43], a[16:19], a[132:135], v[40:43]
v_mfma_f32_16x16x32_bf16 v[44:47], a[20:23], a[128:131], v[44:47]
ds_read_b128 a[56:59], v192 offset:11264
v_mfma_f32_16x16x32_bf16 v[48:51], a[20:23], a[132:135], v[48:51]
v_mul_f32 v100, v100, v108
s_waitcnt lgkmcnt(7)
v_mfma_f32_16x16x32_bf16 v[36:39], a[24:27], a[136:139], v[36:39]
ds_read_b128 a[60:63], v192 offset:12288
v_mul_f32 v101, v101, v109
v_mfma_f32_16x16x32_bf16 v[40:43], a[24:27], a[140:143], v[40:43]
v_mul_f32 v102, v102, v110
v_mul_f32 v103, v103, v111
v_mfma_f32_16x16x32_bf16 v[44:47], a[28:31], a[136:139], v[44:47]
ds_read_b128 a[64:67], v192 offset:20480
v_cvt_pk_bf16_f32 v228, v100, v101
v_mfma_f32_16x16x32_bf16 v[48:51], a[28:31], a[140:143], v[48:51]
v_cvt_pk_bf16_f32 v229, v102, v103
s_waitcnt lgkmcnt(7)
v_mfma_f32_16x16x32_bf16 v[36:39], a[32:35], a[144:147], v[36:39]
ds_read_b128 a[68:71], v192 offset:21504
v_mul_f32 v104, v104, v112
v_mfma_f32_16x16x32_bf16 v[40:43], a[32:35], a[148:151], v[40:43]
v_mul_f32 v105, v105, v113
v_mfma_f32_16x16x32_bf16 v[44:47], a[36:39], a[144:147], v[44:47]
ds_read_b128 a[0:3], v192 offset:29696
v_mul_f32 v106, v106, v114
v_mfma_f32_16x16x32_bf16 v[48:51], a[36:39], a[148:151], v[48:51]
v_mul_f32 v107, v107, v115
s_waitcnt lgkmcnt(7)
v_mfma_f32_16x16x32_bf16 v[36:39], a[40:43], a[152:155], v[36:39]
ds_read_b128 a[4:7], v192 offset:30720
v_cvt_pk_bf16_f32 v230, v104, v105
v_mfma_f32_16x16x32_bf16 v[40:43], a[40:43], a[156:159], v[40:43]
v_cvt_pk_bf16_f32 v231, v106, v107
s_nop 0
v_mfma_f32_16x16x32_bf16 v[44:47], a[44:47], a[152:155], v[44:47]
ds_read_b128 a[8:11], v192 offset:4096
v_mfma_f32_16x16x32_bf16 v[48:51], a[44:47], a[156:159], v[48:51]
s_waitcnt lgkmcnt(7)
v_mfma_f32_16x16x32_bf16 v[52:55], a[48:51], a[128:131], v[52:55]
ds_read_b128 a[12:15], v192 offset:5120
v_permlane16_swap_b32 v228, v230
v_mfma_f32_16x16x32_bf16 v[56:59], a[48:51], a[132:135], v[56:59]
v_permlane16_swap_b32 v229, v231
v_mfma_f32_16x16x32_bf16 v[60:63], a[52:55], a[128:131], v[60:63]
ds_read_b128 a[16:19], v192 offset:13312
buffer_store_dwordx4 v[228:231], v236, s[8:11], s65 offen sc1
v_mfma_f32_16x16x32_bf16 v[64:67], a[52:55], a[132:135], v[64:67]
v_mul_f32 v36, v36, v116
s_waitcnt lgkmcnt(7)
v_mfma_f32_16x16x32_bf16 v[52:55], a[56:59], a[136:139], v[52:55]
ds_read_b128 a[20:23], v192 offset:14336
v_mul_f32 v37, v37, v117
v_mfma_f32_16x16x32_bf16 v[56:59], a[56:59], a[140:143], v[56:59]
v_mul_f32 v38, v38, v118
v_mul_f32 v39, v39, v119
v_mfma_f32_16x16x32_bf16 v[60:63], a[60:63], a[136:139], v[60:63]
ds_read_b128 a[24:27], v192 offset:22528
v_cvt_pk_bf16_f32 v196, v36, v37
v_mfma_f32_16x16x32_bf16 v[64:67], a[60:63], a[140:143], v[64:67]
v_cvt_pk_bf16_f32 v197, v38, v39
v_mul_f32 v44, v44, v124
s_waitcnt lgkmcnt(7)
v_mfma_f32_16x16x32_bf16 v[52:55], a[64:67], a[144:147], v[52:55]
ds_read_b128 a[28:31], v192 offset:23552
v_mul_f32 v45, v45, v125
v_mfma_f32_16x16x32_bf16 v[56:59], a[64:67], a[148:151], v[56:59]
v_mul_f32 v46, v46, v126
v_mul_f32 v47, v47, v127
v_mfma_f32_16x16x32_bf16 v[60:63], a[68:71], a[144:147], v[60:63]
ds_read_b128 a[32:35], v192 offset:31744
v_cvt_pk_bf16_f32 v198, v44, v45
v_mfma_f32_16x16x32_bf16 v[64:67], a[68:71], a[148:151], v[64:67]
v_cvt_pk_bf16_f32 v199, v46, v47
s_waitcnt lgkmcnt(7)
v_mfma_f32_16x16x32_bf16 v[52:55], a[0:3], a[152:155], v[52:55]
ds_read_b128 a[36:39], v192 offset:32768
buffer_store_dwordx4 v[196:199], v1, s[8:11], s64 offen offset:0 sc1
v_mul_f32 v40, v40, v120
v_mul_f32 v41, v41, v121
v_mfma_f32_16x16x32_bf16 v[56:59], a[0:3], a[156:159], v[56:59]
v_mul_f32 v42, v42, v122
v_mul_f32 v43, v43, v123
v_mfma_f32_16x16x32_bf16 v[60:63], a[4:7], a[152:155], v[60:63]
ds_read_b128 a[40:43], v192 offset:6144
v_cvt_pk_bf16_f32 v200, v40, v41
v_mfma_f32_16x16x32_bf16 v[64:67], a[4:7], a[156:159], v[64:67]
v_cvt_pk_bf16_f32 v201, v42, v43
v_mul_f32 v48, v48, v128
s_waitcnt lgkmcnt(7)
v_mfma_f32_16x16x32_bf16 v[68:71], a[8:11], a[128:131], v[68:71]
ds_read_b128 a[44:47], v192 offset:7168
v_mul_f32 v49, v49, v129
v_mfma_f32_16x16x32_bf16 v[72:75], a[8:11], a[132:135], v[72:75]
v_mul_f32 v50, v50, v130
v_mul_f32 v51, v51, v131
v_mfma_f32_16x16x32_bf16 v[76:79], a[12:15], a[128:131], v[76:79]
ds_read_b128 a[48:51], v192 offset:15360
v_cvt_pk_bf16_f32 v202, v48, v49
v_cvt_pk_bf16_f32 v203, v50, v51
buffer_store_dwordx4 v[200:203], v237, s[8:11], s64 offen offset:0 sc1
v_mfma_f32_16x16x32_bf16 v[80:83], a[12:15], a[132:135], v[80:83]
v_mul_f32 v52, v52, v132
s_waitcnt lgkmcnt(7)
v_mfma_f32_16x16x32_bf16 v[68:71], a[16:19], a[136:139], v[68:71]
ds_read_b128 a[52:55], v192 offset:16384
v_mul_f32 v53, v53, v133
v_mfma_f32_16x16x32_bf16 v[72:75], a[16:19], a[140:143], v[72:75]
v_mul_f32 v54, v54, v134
v_mul_f32 v55, v55, v135
v_mfma_f32_16x16x32_bf16 v[76:79], a[20:23], a[136:139], v[76:79]
ds_read_b128 a[56:59], v192 offset:24576
v_cvt_pk_bf16_f32 v204, v52, v53
v_mfma_f32_16x16x32_bf16 v[80:83], a[20:23], a[140:143], v[80:83]
v_cvt_pk_bf16_f32 v205, v54, v55
v_mul_f32 v60, v60, v140
s_waitcnt lgkmcnt(7)
v_mfma_f32_16x16x32_bf16 v[68:71], a[24:27], a[144:147], v[68:71]
ds_read_b128 a[60:63], v192 offset:25600
v_mul_f32 v61, v61, v141
v_mfma_f32_16x16x32_bf16 v[72:75], a[24:27], a[148:151], v[72:75]
v_mul_f32 v62, v62, v142
v_mul_f32 v63, v63, v143
v_mfma_f32_16x16x32_bf16 v[76:79], a[28:31], a[144:147], v[76:79]
ds_read_b128 a[64:67], v192 offset:33792
v_cvt_pk_bf16_f32 v206, v60, v61
v_mfma_f32_16x16x32_bf16 v[80:83], a[28:31], a[148:151], v[80:83]
v_cvt_pk_bf16_f32 v207, v62, v63
s_waitcnt lgkmcnt(7)
v_mfma_f32_16x16x32_bf16 v[68:71], a[32:35], a[152:155], v[68:71]
ds_read_b128 a[68:71], v192 offset:34816
buffer_store_dwordx4 v[204:207], v1, s[8:11], s64 offen offset:1024 sc1
v_mul_f32 v56, v56, v136
v_mul_f32 v57, v57, v137
v_mfma_f32_16x16x32_bf16 v[72:75], a[32:35], a[156:159], v[72:75]
v_mul_f32 v58, v58, v138
v_mul_f32 v59, v59, v139
v_mfma_f32_16x16x32_bf16 v[76:79], a[36:39], a[152:155], v[76:79]
v_cvt_pk_bf16_f32 v208, v56, v57
v_cvt_pk_bf16_f32 v209, v58, v59
v_mfma_f32_16x16x32_bf16 v[80:83], a[36:39], a[156:159], v[80:83]
v_mul_f32 v64, v64, v144
s_waitcnt lgkmcnt(6)
v_mfma_f32_16x16x32_bf16 v[84:87], a[40:43], a[128:131], v[84:87]
v_mul_f32 v65, v65, v145
v_mul_f32 v66, v66, v146
v_mfma_f32_16x16x32_bf16 v[88:91], a[40:43], a[132:135], v[88:91]
v_mul_f32 v67, v67, v147
v_cvt_pk_bf16_f32 v210, v64, v65
v_mfma_f32_16x16x32_bf16 v[92:95], a[44:47], a[128:131], v[92:95]
v_cvt_pk_bf16_f32 v211, v66, v67
buffer_store_dwordx4 v[208:211], v237, s[8:11], s64 offen offset:1024 sc1
v_mfma_f32_16x16x32_bf16 v[96:99], a[44:47], a[132:135], v[96:99]
v_mul_f32 v68, v68, v148
s_waitcnt lgkmcnt(4)
v_mfma_f32_16x16x32_bf16 v[84:87], a[48:51], a[136:139], v[84:87]
v_mul_f32 v69, v69, v149
v_mul_f32 v70, v70, v150
v_mfma_f32_16x16x32_bf16 v[88:91], a[48:51], a[140:143], v[88:91]
v_mul_f32 v71, v71, v151
v_cvt_pk_bf16_f32 v212, v68, v69
v_mfma_f32_16x16x32_bf16 v[92:95], a[52:55], a[136:139], v[92:95]
v_cvt_pk_bf16_f32 v213, v70, v71
v_mul_f32 v76, v76, v156
v_mfma_f32_16x16x32_bf16 v[96:99], a[52:55], a[140:143], v[96:99]
v_mul_f32 v77, v77, v157
s_waitcnt lgkmcnt(2)
v_mfma_f32_16x16x32_bf16 v[84:87], a[56:59], a[144:147], v[84:87]
v_mul_f32 v78, v78, v158
v_mul_f32 v79, v79, v159
v_mfma_f32_16x16x32_bf16 v[88:91], a[56:59], a[148:151], v[88:91]
v_cvt_pk_bf16_f32 v214, v76, v77
v_cvt_pk_bf16_f32 v215, v78, v79
v_mfma_f32_16x16x32_bf16 v[92:95], a[60:63], a[144:147], v[92:95]
buffer_store_dwordx4 v[212:215], v1, s[8:11], s64 offen offset:2048 sc1
v_mul_f32 v72, v72, v152
v_mfma_f32_16x16x32_bf16 v[96:99], a[60:63], a[148:151], v[96:99]
v_mul_f32 v73, v73, v153
v_mul_f32 v74, v74, v154
s_waitcnt lgkmcnt(0)
v_mfma_f32_16x16x32_bf16 v[84:87], a[64:67], a[152:155], v[84:87]
v_mul_f32 v75, v75, v155
v_cvt_pk_bf16_f32 v216, v72, v73
v_mfma_f32_16x16x32_bf16 v[88:91], a[64:67], a[156:159], v[88:91]
v_cvt_pk_bf16_f32 v217, v74, v75
v_mul_f32 v80, v80, v160
v_mfma_f32_16x16x32_bf16 v[92:95], a[68:71], a[152:155], v[92:95]
v_mul_f32 v81, v81, v161
v_mul_f32 v82, v82, v162
v_mfma_f32_16x16x32_bf16 v[96:99], a[68:71], a[156:159], v[96:99]
v_mul_f32 v83, v83, v163
v_cvt_pk_bf16_f32 v218, v80, v81
v_cvt_pk_bf16_f32 v219, v82, v83
buffer_store_dwordx4 v[216:219], v237, s[8:11], s64 offen offset:2048 sc1
s_nop 1
v_pk_mul_f32 v[84:85], v[84:85], v[164:165]
v_pk_mul_f32 v[86:87], v[86:87], v[166:167]
v_cvt_pk_bf16_f32 v220, v84, v85
v_cvt_pk_bf16_f32 v221, v86, v87
v_pk_mul_f32 v[92:93], v[92:93], v[172:173]
v_pk_mul_f32 v[94:95], v[94:95], v[174:175]
v_cvt_pk_bf16_f32 v222, v92, v93
v_cvt_pk_bf16_f32 v223, v94, v95
buffer_store_dwordx4 v[220:223], v1, s[8:11], s64 offen offset:3072 sc1
v_pk_mul_f32 v[88:89], v[88:89], v[168:169]
v_pk_mul_f32 v[90:91], v[90:91], v[170:171]
v_cvt_pk_bf16_f32 v224, v88, v89
v_cvt_pk_bf16_f32 v225, v90, v91
v_pk_mul_f32 v[96:97], v[96:97], v[176:177]
v_pk_mul_f32 v[98:99], v[98:99], v[178:179]
v_cvt_pk_bf16_f32 v226, v96, v97
v_cvt_pk_bf16_f32 v227, v98, v99
buffer_store_dwordx4 v[224:227], v237, s[8:11], s64 offen offset:3072 sc1
L_c5:
s_mul_i32 s38, s24, 9216
s_add_u32 m0, s38, 53248
s_add_u32 s39, s38, s83
s_add_u32 s39, s39, 53248
buffer_load_dwordx4 v1, s[4:7], s39 offen offset:0 sc1 lds
buffer_load_dwordx4 v1, s[4:7], s39 offen offset:1024 sc1 lds
buffer_load_dwordx4 v1, s[4:7], s39 offen offset:2048 sc1 lds
buffer_load_dwordx4 v1, s[4:7], s39 offen offset:3072 sc1 lds
s_add_u32 m0, m0, 4096
s_add_u32 s39, s39, 4096
buffer_load_dwordx4 v1, s[4:7], s39 offen offset:0 sc1 lds
buffer_load_dwordx4 v1, s[4:7], s39 offen offset:1024 sc1 lds
buffer_load_dwordx4 v1, s[4:7], s39 offen offset:2048 sc1 lds
v_lshlrev_b32 v7, 3, v1
s_lshl_b32 s31, s25, 11
v_add_u32 v7, s31, v7
s_cmp_eq_u32 s24, 0
s_cselect_b32 s30, 0, 1073741824
s_add_u32 s30, s30, 26574848
s_waitcnt vmcnt(7)
s_barrier
s_mov_b64 exec, 0xffff
buffer_atomic_add v4, v7, s[8:11], s30 offen sc1
s_mov_b64 exec, -1
s_lshl_b32 s35, s81, 7
s_add_u32 s35, s35, 26574848
s_cmp_eq_u32 s24, 1
s_cselect_b32 s35, s35, 1073741824
v_mov_b32 v6, 0
buffer_load_dwordx4 v1, s[4:7], s39 offen offset:3072 sc1 lds
s_add_u32 m0, m0, 4096
s_add_u32 s39, s39, 4096
buffer_load_dwordx4 v1, s[4:7], s39 offen offset:0 sc1 lds
s_mul_i32 s38, s24, 9216
s_add_u32 m0, s38, 90112
s_add_u32 s39, s38, s83
s_add_u32 s39, s39, 90112
buffer_load_dwordx4 v1, s[4:7], s39 offen offset:0 sc1 lds
buffer_load_dwordx4 v1, s[4:7], s39 offen offset:1024 sc1 lds
buffer_load_dwordx4 v1, s[4:7], s39 offen offset:2048 sc1 lds
buffer_load_dwordx4 v1, s[4:7], s39 offen offset:3072 sc1 lds
s_add_u32 m0, m0, 4096
s_add_u32 s39, s39, 4096
v_mov_b32 v244, 0
s_mov_b64 exec, 1
buffer_atomic_add v244, v6, s[8:11], s35 offen sc0 sc1
s_mov_b64 exec, -1
buffer_load_dwordx4 v1, s[4:7], s39 offen offset:0 sc1 lds
buffer_load_dwordx4 v1, s[4:7], s39 offen offset:1024 sc1 lds
buffer_load_dwordx4 v1, s[4:7], s39 offen offset:2048 sc1 lds
buffer_load_dwordx4 v1, s[4:7], s39 offen offset:3072 sc1 lds
s_add_u32 m0, m0, 4096
s_add_u32 s39, s39, 4096
buffer_load_dwordx4 v1, s[4:7], s39 offen offset:0 sc1 lds
s_mul_i32 s38, s24, 9216
s_add_u32 m0, s38, 126976
s_add_u32 s39, s38, s83
s_add_u32 s39, s39, 126976
v_mov_b32 v245, 0
s_mov_b64 exec, 1
buffer_atomic_add v245, v6, s[8:11], s35 offen sc0 sc1
s_mov_b64 exec, -1
buffer_load_dwordx4 v1, s[4:7], s39 offen offset:0 sc1 lds
buffer_load_dwordx4 v1, s[4:7], s39 offen offset:1024 sc1 lds
buffer_load_dwordx4 v1, s[4:7], s39 offen offset:2048 sc1 lds
buffer_load_dwordx4 v1, s[4:7], s39 offen offset:3072 sc1 lds
s_add_u32 m0, m0, 4096
s_add_u32 s39, s39, 4096
buffer_load_dwordx4 v1, s[4:7], s39 offen offset:0 sc1 lds
v_mov_b32 v246, 0
s_mov_b64 exec, 1
buffer_atomic_add v246, v6, s[8:11], s35 offen sc0 sc1
s_mov_b64 exec, -1
buffer_load_dwordx4 v1, s[4:7], s39 offen offset:1024 sc1 lds
buffer_load_dwordx4 v1, s[4:7], s39 offen offset:2048 sc1 lds
buffer_load_dwordx4 v1, s[4:7], s39 offen offset:3072 sc1 lds
s_add_u32 m0, m0, 4096
s_add_u32 s39, s39, 4096
buffer_load_dwordx4 v1, s[4:7], s39 offen offset:0 sc1 lds
s_xor_b32 s30, s27, 1
s_lshl_b32 s60, s30, 2
s_add_u32 s60, s60, s24
s_mul_i32 s60, s60, 73728
s_and_b32 s32, s27, 1
s_mul_i32 s32, s32, 36864
s_add_u32 s32, s32, 16777216
s_add_u32 s60, s60, s32
s_lshl_b32 s61, s27, 2
s_add_u32 s61, s61, s24
s_mul_i32 s61, s61, 73728
s_add_u32 s61, s61, s32
s_cmp_eq_u32 s24, 1
s_cbranch_scc0 L_other_33
s_mov_b32 s31, 0
s_mov_b64 exec, 1
v_mov_b32 v247, 0
buffer_atomic_add v247, v6, s[8:11], s35 offen sc0 sc1
s_waitcnt vmcnt(17)
v_cmp_gt_u32 vcc, 16, v244
s_nop 0
s_cbranch_vccz L_polled_32
s_waitcnt vmcnt(11)
v_cmp_gt_u32 vcc, 16, v245
s_nop 0
s_cbranch_vccz L_polled_32
v_mov_b32 v244, 0
buffer_atomic_add v244, v6, s[8:11], s35 offen sc0 sc1
s_waitcnt vmcnt(6)
v_cmp_gt_u32 vcc, 16, v246
s_nop 0
s_cbranch_vccz L_polled_32
v_mov_b32 v245, 0
buffer_atomic_add v245, v6, s[8:11], s35 offen sc0 sc1
L_poll_31:
s_add_u32 s31, s31, 1
s_cmp_gt_u32 s31, 100000
s_cbranch_scc1 L_polled_32
v_mov_b32 v246, 0
buffer_atomic_add v246, v6, s[8:11], s35 offen sc0 sc1
s_waitcnt vmcnt(3)
v_cmp_gt_u32 vcc, 16, v247
s_nop 0
s_cbranch_vccz L_polled_32
v_mov_b32 v247, 0
buffer_atomic_add v247, v6, s[8:11], s35 offen sc0 sc1
s_waitcnt vmcnt(3)
v_cmp_gt_u32 vcc, 16, v244
s_nop 0
s_cbranch_vccz L_polled_32
v_mov_b32 v244, 0
buffer_atomic_add v244, v6, s[8:11], s35 offen sc0 sc1
s_waitcnt vmcnt(3)
v_cmp_gt_u32 vcc, 16, v245
s_nop 0
s_cbranch_vccz L_polled_32
v_mov_b32 v245, 0
buffer_atomic_add v245, v6, s[8:11], s35 offen sc0 sc1
s_waitcnt vmcnt(3)
v_cmp_gt_u32 vcc, 16, v246
s_nop 0
s_cbranch_vccz L_polled_32
s_branch L_poll_31
L_polled_32:
s_mov_b64 exec, -1
L_other_33:
s_barrier
buffer_load_dwordx4 a[0:3], v1, s[8:11], s60 offen offset:0 sc1
buffer_load_dwordx4 a[4:7], v1, s[8:11], s60 offen offset:1024 sc1
s_barrier
buffer_load_dwordx4 a[8:11], v1, s[8:11], s60 offen offset:2048 sc1
buffer_load_dwordx4 a[12:15], v1, s[8:11], s60 offen offset:3072 sc1
s_barrier
s_add_u32 s60, s60, 4096
buffer_load_dwordx4 a[16:19], v1, s[8:11], s60 offen offset:0 sc1
buffer_load_dwordx4 a[20:23], v1, s[8:11], s60 offen offset:1024 sc1
s_barrier
buffer_load_dwordx4 a[24:27], v1, s[8:11], s60 offen offset:2048 sc1
buffer_load_dwordx4 a[28:31], v1, s[8:11], s60 offen offset:3072 sc1
s_barrier
s_add_u32 s60, s60, 4096
buffer_load_dwordx4 a[32:35], v1, s[8:11], s60 offen offset:0 sc1
buffer_load_dwordx4 a[36:39], v1, s[8:11], s60 offen offset:1024 sc1
v_and_b32 v40, 7, v2
v_lshlrev_b32 v40, 4, v40
v_lshl_add_u32 v40, v3, 7, v40
v_add_u32 v40, 4096, v40
s_lshl_b32 s63, s81, 14
s_lshl_b32 s30, s24, 12
s_add_u32 s63, s63, s30
s_xor_b32 s62, s63, 131072
s_add_u32 s63, s63, 26640384
s_add_u32 s62, s62, 26640384
s_add_u32 s64, s83, 161280
v_mov_b32 v116, v40
v_add_u32 v36, 0, v1
v_add_u32 v37, 55296, v1
v_add_u32 v41, 55296, v40
v_add_u32 v38, 110592, v1
v_add_u32 v42, 110592, v40
ds_read_b128 a[160:163], v36 offset:0
ds_read_b128 a[164:167], v36 offset:1024
ds_read_b128 a[168:171], v36 offset:2048
ds_read_b128 a[172:175], v36 offset:3072
ds_read_b128 a[176:179], v40 offset:0
ds_read_b128 a[180:183], v36 offset:4608
ds_read_b128 a[184:187], v36 offset:5632
ds_read_b128 a[188:191], v36 offset:6656
ds_read_b128 a[192:195], v36 offset:7680
ds_read_b128 a[196:199], v40 offset:4608
s_lshl_b32 s30, s27, 2
s_add_u32 s30, s30, s24
v_mov_b32 v138, 1073741824
s_mul_i32 s66, s30, 18432
s_mul_i32 s32, s28, 2304
s_add_u32 s66, s66, s32
s_add_u32 s66, s66, 30834688
v_mov_b32 v140, v1
v_add_u32 v141, 2048, v140
v_cndmask_b32 v141, v138, v141, s[46:47]
s_lshl_b32 s67, s30, 7
s_lshl_b32 s32, s28, 14
s_add_u32 s67, s67, s32
s_add_u32 s67, s67, 33193984
v_lshlrev_b32 v139, 3, v2
v_cndmask_b32 v138, v138, v139, s[46:47]
s_lshl_b32 s30, s27, 2
s_add_u32 s30, s30, s24
v_mov_b32 v162, 1073741824
s_mul_i32 s68, s30, 18432
s_mul_i32 s32, s28, 144
s_add_u32 s68, s68, s32
v_mul_u32_u24 v164, 1152, v2
v_lshl_add_u32 v164, v3, 4, v164
v_add_u32 v165, 128, v164
v_cndmask_b32 v165, v162, v165, s[46:47]
s_waitcnt vmcnt(9) lgkmcnt(5)
v_mfma_f32_16x16x32_bf16 v[44:47], a[160:163], a[0:3], 0
ds_read_b128 a[200:203], v36 offset:9216
buffer_load_dwordx4 a[40:43], v1, s[8:11], s60 offen offset:2048 sc1
v_mfma_f32_16x16x32_bf16 v[48:51], a[164:167], a[0:3], 0
ds_read_b128 a[204:207], v36 offset:10240
v_mfma_f32_16x16x32_bf16 v[52:55], a[168:171], a[0:3], 0
ds_read_b128 a[208:211], v36 offset:11264
v_mfma_f32_16x16x32_bf16 v[56:59], a[172:175], a[0:3], 0
ds_read_b128 a[212:215], v36 offset:12288
v_mfma_f32_16x16x32_bf16 v[60:63], a[176:179], a[0:3], 0
ds_read_b128 a[216:219], v40 offset:9216
s_waitcnt vmcnt(9) lgkmcnt(5)
v_mfma_f32_16x16x32_bf16 v[44:47], a[180:183], a[4:7], v[44:47]
ds_read_b128 a[160:163], v36 offset:13824
buffer_load_dwordx4 a[0:3], v1, s[8:11], s60 offen offset:3072 sc1
v_mfma_f32_16x16x32_bf16 v[48:51], a[184:187], a[4:7], v[48:51]
ds_read_b128 a[164:167], v36 offset:14848
v_mfma_f32_16x16x32_bf16 v[52:55], a[188:191], a[4:7], v[52:55]
ds_read_b128 a[168:171], v36 offset:15872
v_mfma_f32_16x16x32_bf16 v[56:59], a[192:195], a[4:7], v[56:59]
ds_read_b128 a[172:175], v36 offset:16896
v_mfma_f32_16x16x32_bf16 v[60:63], a[196:199], a[4:7], v[60:63]
ds_read_b128 a[176:179], v40 offset:13824
s_waitcnt vmcnt(9) lgkmcnt(5)
v_mfma_f32_16x16x32_bf16 v[44:47], a[200:203], a[8:11], v[44:47]
ds_read_b128 a[180:183], v36 offset:18432
s_add_u32 s60, s60, 4096
buffer_load_dwordx4 a[4:7], v1, s[8:11], s60 offen offset:0 sc1
v_mfma_f32_16x16x32_bf16 v[48:51], a[204:207], a[8:11], v[48:51]
ds_read_b128 a[184:187], v36 offset:19456
v_mov_b32 v67, v248
v_mfma_f32_16x16x32_bf16 v[52:55], a[208:211], a[8:11], v[52:55]
ds_read_b128 a[188:191], v36 offset:20480
v_mfma_f32_16x16x32_bf16 v[56:59], a[212:215], a[8:11], v[56:59]
ds_read_b128 a[192:195], v36 offset:21504
v_mfma_f32_16x16x32_bf16 v[60:63], a[216:219], a[8:11], v[60:63]
ds_read_b128 a[196:199], v40 offset:18432
s_waitcnt vmcnt(9) lgkmcnt(5)
v_mfma_f32_16x16x32_bf16 v[44:47], a[160:163], a[12:15], v[44:47]
ds_read_b128 a[200:203], v36 offset:23040
buffer_load_dwordx4 a[8:11], v1, s[8:11], s60 offen offset:1024 sc1
v_mfma_f32_16x16x32_bf16 v[48:51], a[164:167], a[12:15], v[48:51]
ds_read_b128 a[204:207], v36 offset:24064
v_mfma_f32_16x16x32_bf16 v[52:55], a[168:171], a[12:15], v[52:55]
ds_read_b128 a[208:211], v36 offset:25088
v_mov_b32 v71, v248
v_mfma_f32_16x16x32_bf16 v[56:59], a[172:175], a[12:15], v[56:59]
ds_read_b128 a[212:215], v36 offset:26112
v_mfma_f32_16x16x32_bf16 v[60:63], a[176:179], a[12:15], v[60:63]
ds_read_b128 a[216:219], v40 offset:23040
s_waitcnt vmcnt(9) lgkmcnt(5)
v_mfma_f32_16x16x32_bf16 v[44:47], a[180:183], a[16:19], v[44:47]
ds_read_b128 a[160:163], v36 offset:27648
buffer_load_dwordx4 a[12:15], v1, s[8:11], s60 offen offset:2048 sc1
v_mfma_f32_16x16x32_bf16 v[48:51], a[184:187], a[16:19], v[48:51]
ds_read_b128 a[164:167], v36 offset:28672
v_mfma_f32_16x16x32_bf16 v[52:55], a[188:191], a[16:19], v[52:55]
ds_read_b128 a[168:171], v36 offset:29696
v_mfma_f32_16x16x32_bf16 v[56:59], a[192:195], a[16:19], v[56:59]
ds_read_b128 a[172:175], v36 offset:30720
v_mfma_f32_16x16x32_bf16 v[60:63], a[196:199], a[16:19], v[60:63]
ds_read_b128 a[176:179], v40 offset:27648
s_waitcnt vmcnt(9) lgkmcnt(5)
v_mfma_f32_16x16x32_bf16 v[44:47], a[200:203], a[20:23], v[44:47]
ds_read_b128 a[180:183], v36 offset:32256
buffer_load_dwordx4 a[16:19], v1, s[8:11], s60 offen offset:3072 sc1
v_mfma_f32_16x16x32_bf16 v[48:51], a[204:207], a[20:23], v[48:51]
ds_read_b128 a[184:187], v36 offset:33280
v_mov_b32 v75, v248
v_mfma_f32_16x16x32_bf16 v[52:55], a[208:211], a[20:23], v[52:55]
ds_read_b128 a[188:191], v36 offset:34304
v_mfma_f32_16x16x32_bf16 v[56:59], a[212:215], a[20:23], v[56:59]
ds_read_b128 a[192:195], v36 offset:35328
v_mfma_f32_16x16x32_bf16 v[60:63], a[216:219], a[20:23], v[60:63]
ds_read_b128 a[196:199], v40 offset:32256
s_waitcnt vmcnt(9) lgkmcnt(5)
v_mfma_f32_16x16x32_bf16 v[44:47], a[160:163], a[24:27], v[44:47]
ds_read_b128 a[200:203], v36 offset:36864
s_add_u32 s60, s60, 4096
buffer_load_dwordx4 a[20:23], v1, s[8:11], s60 offen offset:0 sc1
v_mfma_f32_16x16x32_bf16 v[48:51], a[164:167], a[24:27], v[48:51]
ds_read_b128 a[204:207], v36 offset:37888
v_mfma_f32_16x16x32_bf16 v[52:55], a[168:171], a[24:27], v[52:55]
ds_read_b128 a[208:211], v36 offset:38912
v_mfma_f32_16x16x32_bf16 v[56:59], a[172:175], a[24:27], v[56:59]
ds_read_b128 a[212:215], v36 offset:39936
v_mov_b32 v79, v248
v_mfma_f32_16x16x32_bf16 v[60:63], a[176:179], a[24:27], v[60:63]
ds_read_b128 a[216:219], v40 offset:36864
s_waitcnt vmcnt(9) lgkmcnt(5)
v_mfma_f32_16x16x32_bf16 v[44:47], a[180:183], a[28:31], v[44:47]
ds_read_b128 a[160:163], v36 offset:41472
buffer_load_dwordx4 a[24:27], v1, s[8:11], s60 offen offset:1024 sc1
v_mfma_f32_16x16x32_bf16 v[48:51], a[184:187], a[28:31], v[48:51]
ds_read_b128 a[164:167], v36 offset:42496
v_mfma_f32_16x16x32_bf16 v[52:55], a[188:191], a[28:31], v[52:55]
ds_read_b128 a[168:171], v36 offset:43520
v_mfma_f32_16x16x32_bf16 v[56:59], a[192:195], a[28:31], v[56:59]
ds_read_b128 a[172:175], v36 offset:44544
v_mfma_f32_16x16x32_bf16 v[60:63], a[196:199], a[28:31], v[60:63]
ds_read_b128 a[176:179], v40 offset:41472
s_waitcnt vmcnt(9) lgkmcnt(5)
v_mfma_f32_16x16x32_bf16 v[44:47], a[200:203], a[32:35], v[44:47]
ds_read_b128 a[180:183], v36 offset:46080
buffer_load_dwordx4 a[28:31], v1, s[8:11], s60 offen offset:2048 sc1
v_mfma_f32_16x16x32_bf16 v[48:51], a[204:207], a[32:35], v[48:51]
ds_read_b128 a[184:187], v36 offset:47104
v_mfma_f32_16x16x32_bf16 v[52:55], a[208:211], a[32:35], v[52:55]
ds_read_b128 a[188:191], v36 offset:48128
v_mfma_f32_16x16x32_bf16 v[56:59], a[212:215], a[32:35], v[56:59]
ds_read_b128 a[192:195], v36 offset:49152
v_mfma_f32_16x16x32_bf16 v[60:63], a[216:219], a[32:35], v[60:63]
ds_read_b128 a[196:199], v40 offset:46080
s_barrier
s_waitcnt vmcnt(9) lgkmcnt(5)
v_mfma_f32_16x16x32_bf16 v[44:47], a[160:163], a[36:39], v[44:47]
ds_read_b128 a[200:203], v36 offset:50688
buffer_load_dwordx4 a[32:35], v1, s[8:11], s60 offen offset:3072 sc1
v_mfma_f32_16x16x32_bf16 v[48:51], a[164:167], a[36:39], v[48:51]
ds_read_b128 a[204:207], v36 offset:51712
v_mfma_f32_16x16x32_bf16 v[52:55], a[168:171], a[36:39], v[52:55]
ds_read_b128 a[208:211], v36 offset:52736
v_mfma_f32_16x16x32_bf16 v[56:59], a[172:175], a[36:39], v[56:59]
ds_read_b128 a[212:215], v36 offset:53760
v_mfma_f32_16x16x32_bf16 v[60:63], a[176:179], a[36:39], v[60:63]
ds_read_b128 a[216:219], v40 offset:50688
s_waitcnt vmcnt(9) lgkmcnt(5)
v_mfma_f32_16x16x32_bf16 v[44:47], a[180:183], a[40:43], v[44:47]
ds_read_b128 a[160:163], v37 offset:0
s_add_u32 s60, s60, 4096
buffer_load_dwordx4 a[36:39], v1, s[8:11], s60 offen offset:0 sc1
v_mfma_f32_16x16x32_bf16 v[48:51], a[184:187], a[40:43], v[48:51]
ds_read_b128 a[164:167], v37 offset:1024
v_mfma_f32_16x16x32_bf16 v[52:55], a[188:191], a[40:43], v[52:55]
ds_read_b128 a[168:171], v37 offset:2048
v_mfma_f32_16x16x32_bf16 v[56:59], a[192:195], a[40:43], v[56:59]
ds_read_b128 a[172:175], v37 offset:3072
v_mfma_f32_16x16x32_bf16 v[60:63], a[196:199], a[40:43], v[60:63]
ds_read_b128 a[176:179], v41 offset:0
s_waitcnt vmcnt(9) lgkmcnt(5)
v_mfma_f32_16x16x32_bf16 v[44:47], a[200:203], a[0:3], v[44:47]
ds_read_b128 a[180:183], v37 offset:4608
buffer_load_dwordx4 a[40:43], v1, s[8:11], s60 offen offset:1024 sc1
v_mfma_f32_16x16x32_bf16 v[48:51], a[204:207], a[0:3], v[48:51]
ds_read_b128 a[184:187], v37 offset:5632
v_mfma_f32_16x16x32_bf16 v[52:55], a[208:211], a[0:3], v[52:55]
ds_read_b128 a[188:191], v37 offset:6656
v_mfma_f32_16x16x32_bf16 v[56:59], a[212:215], a[0:3], v[56:59]
ds_read_b128 a[192:195], v37 offset:7680
v_mfma_f32_16x16x32_bf16 v[60:63], a[216:219], a[0:3], v[60:63]
ds_read_b128 a[196:199], v41 offset:4608
s_waitcnt vmcnt(9) lgkmcnt(5)
v_mfma_f32_16x16x32_bf16 v[44:47], a[160:163], a[4:7], v[44:47]
ds_read_b128 a[200:203], v37 offset:9216
buffer_load_dwordx4 a[0:3], v1, s[8:11], s60 offen offset:2048 sc1
v_mfma_f32_16x16x32_bf16 v[48:51], a[164:167], a[4:7], v[48:51]
ds_read_b128 a[204:207], v37 offset:10240
v_mfma_f32_16x16x32_bf16 v[52:55], a[168:171], a[4:7], v[52:55]
ds_read_b128 a[208:211], v37 offset:11264
v_mfma_f32_16x16x32_bf16 v[56:59], a[172:175], a[4:7], v[56:59]
ds_read_b128 a[212:215], v37 offset:12288
v_mfma_f32_16x16x32_bf16 v[60:63], a[176:179], a[4:7], v[60:63]
ds_read_b128 a[216:219], v41 offset:9216
s_waitcnt vmcnt(9) lgkmcnt(5)
v_mfma_f32_16x16x32_bf16 v[44:47], a[180:183], a[8:11], v[44:47]
ds_read_b128 a[160:163], v37 offset:13824
buffer_load_dwordx4 a[4:7], v1, s[8:11], s60 offen offset:3072 sc1
v_mfma_f32_16x16x32_bf16 v[48:51], a[184:187], a[8:11], v[48:51]
ds_read_b128 a[164:167], v37 offset:14848
v_mfma_f32_16x16x32_bf16 v[52:55], a[188:191], a[8:11], v[52:55]
ds_read_b128 a[168:171], v37 offset:15872
v_mfma_f32_16x16x32_bf16 v[56:59], a[192:195], a[8:11], v[56:59]
ds_read_b128 a[172:175], v37 offset:16896
v_mfma_f32_16x16x32_bf16 v[60:63], a[196:199], a[8:11], v[60:63]
ds_read_b128 a[176:179], v41 offset:13824
s_waitcnt vmcnt(9) lgkmcnt(5)
v_mfma_f32_16x16x32_bf16 v[44:47], a[200:203], a[12:15], v[44:47]
ds_read_b128 a[180:183], v37 offset:18432
s_add_u32 s60, s60, 4096
buffer_load_dwordx4 a[8:11], v1, s[8:11], s60 offen offset:0 sc1
v_mfma_f32_16x16x32_bf16 v[48:51], a[204:207], a[12:15], v[48:51]
ds_read_b128 a[184:187], v37 offset:19456
v_mfma_f32_16x16x32_bf16 v[52:55], a[208:211], a[12:15], v[52:55]
ds_read_b128 a[188:191], v37 offset:20480
v_mfma_f32_16x16x32_bf16 v[56:59], a[212:215], a[12:15], v[56:59]
ds_read_b128 a[192:195], v37 offset:21504
v_mfma_f32_16x16x32_bf16 v[60:63], a[216:219], a[12:15], v[60:63]
ds_read_b128 a[196:199], v41 offset:18432
s_waitcnt vmcnt(9) lgkmcnt(5)
v_mfma_f32_16x16x32_bf16 v[44:47], a[160:163], a[16:19], v[44:47]
ds_read_b128 a[200:203], v37 offset:23040
buffer_load_dwordx4 a[12:15], v1, s[8:11], s60 offen offset:1024 sc1
v_mfma_f32_16x16x32_bf16 v[48:51], a[164:167], a[16:19], v[48:51]
ds_read_b128 a[204:207], v37 offset:24064
v_mfma_f32_16x16x32_bf16 v[52:55], a[168:171], a[16:19], v[52:55]
ds_read_b128 a[208:211], v37 offset:25088
v_mfma_f32_16x16x32_bf16 v[56:59], a[172:175], a[16:19], v[56:59]
ds_read_b128 a[212:215], v37 offset:26112
v_mfma_f32_16x16x32_bf16 v[60:63], a[176:179], a[16:19], v[60:63]
ds_read_b128 a[216:219], v41 offset:23040
s_waitcnt vmcnt(9) lgkmcnt(5)
v_mfma_f32_16x16x32_bf16 v[44:47], a[180:183], a[20:23], v[44:47]
ds_read_b128 a[160:163], v37 offset:27648
buffer_load_dwordx4 a[16:19], v1, s[8:11], s60 offen offset:2048 sc1
v_mfma_f32_16x16x32_bf16 v[48:51], a[184:187], a[20:23], v[48:51]
ds_read_b128 a[164:167], v37 offset:28672
buffer_load_dwordx4 a[228:231], v1, s[4:7], s64 offen offset:2048 sc1
v_mfma_f32_16x16x32_bf16 v[52:55], a[188:191], a[20:23], v[52:55]
ds_read_b128 a[168:171], v37 offset:29696
v_mfma_f32_16x16x32_bf16 v[56:59], a[192:195], a[20:23], v[56:59]
ds_read_b128 a[172:175], v37 offset:30720
v_mfma_f32_16x16x32_bf16 v[60:63], a[196:199], a[20:23], v[60:63]
ds_read_b128 a[176:179], v41 offset:27648
s_waitcnt vmcnt(10) lgkmcnt(5)
v_mfma_f32_16x16x32_bf16 v[44:47], a[200:203], a[24:27], v[44:47]
ds_read_b128 a[180:183], v37 offset:32256
buffer_load_dwordx4 a[20:23], v1, s[8:11], s60 offen offset:3072 sc1
v_mfma_f32_16x16x32_bf16 v[48:51], a[204:207], a[24:27], v[48:51]
ds_read_b128 a[184:187], v37 offset:33280
v_mfma_f32_16x16x32_bf16 v[52:55], a[208:211], a[24:27], v[52:55]
ds_read_b128 a[188:191], v37 offset:34304
v_mfma_f32_16x16x32_bf16 v[56:59], a[212:215], a[24:27], v[56:59]
ds_read_b128 a[192:195], v37 offset:35328
v_mfma_f32_16x16x32_bf16 v[60:63], a[216:219], a[24:27], v[60:63]
ds_read_b128 a[196:199], v41 offset:32256
s_waitcnt vmcnt(10) lgkmcnt(5)
v_mfma_f32_16x16x32_bf16 v[44:47], a[160:163], a[28:31], v[44:47]
ds_read_b128 a[200:203], v37 offset:36864
s_add_u32 s60, s60, 4096
buffer_load_dwordx4 a[24:27], v1, s[8:11], s60 offen offset:0 sc1
v_mfma_f32_16x16x32_bf16 v[48:51], a[164:167], a[28:31], v[48:51]
ds_read_b128 a[204:207], v37 offset:37888
v_mfma_f32_16x16x32_bf16 v[52:55], a[168:171], a[28:31], v[52:55]
ds_read_b128 a[208:211], v37 offset:38912
v_mfma_f32_16x16x32_bf16 v[56:59], a[172:175], a[28:31], v[56:59]
ds_read_b128 a[212:215], v37 offset:39936
buffer_load_dwordx4 a[232:235], v1, s[4:7], s64 offen offset:3072 sc1
v_mfma_f32_16x16x32_bf16 v[60:63], a[176:179], a[28:31], v[60:63]
ds_read_b128 a[216:219], v41 offset:36864
s_waitcnt vmcnt(11) lgkmcnt(5)
v_mfma_f32_16x16x32_bf16 v[44:47], a[180:183], a[32:35], v[44:47]
ds_read_b128 a[160:163], v37 offset:41472
buffer_load_dwordx4 a[28:31], v1, s[8:11], s60 offen offset:1024 sc1
v_mfma_f32_16x16x32_bf16 v[48:51], a[184:187], a[32:35], v[48:51]
ds_read_b128 a[164:167], v37 offset:42496
v_mfma_f32_16x16x32_bf16 v[52:55], a[188:191], a[32:35], v[52:55]
ds_read_b128 a[168:171], v37 offset:43520
v_mfma_f32_16x16x32_bf16 v[56:59], a[192:195], a[32:35], v[56:59]
ds_read_b128 a[172:175], v37 offset:44544
v_mfma_f32_16x16x32_bf16 v[60:63], a[196:199], a[32:35], v[60:63]
ds_read_b128 a[176:179], v41 offset:41472
s_waitcnt vmcnt(11) lgkmcnt(5)
v_mfma_f32_16x16x32_bf16 v[44:47], a[200:203], a[36:39], v[44:47]
ds_read_b128 a[180:183], v37 offset:46080
buffer_load_dwordx4 a[32:35], v1, s[8:11], s60 offen offset:2048 sc1
v_mfma_f32_16x16x32_bf16 v[48:51], a[204:207], a[36:39], v[48:51]
ds_read_b128 a[184:187], v37 offset:47104
v_mfma_f32_16x16x32_bf16 v[52:55], a[208:211], a[36:39], v[52:55]
ds_read_b128 a[188:191], v37 offset:48128
v_mfma_f32_16x16x32_bf16 v[56:59], a[212:215], a[36:39], v[56:59]
ds_read_b128 a[192:195], v37 offset:49152
v_mfma_f32_16x16x32_bf16 v[60:63], a[216:219], a[36:39], v[60:63]
ds_read_b128 a[196:199], v41 offset:46080
s_waitcnt vmcnt(11) lgkmcnt(5)
v_mfma_f32_16x16x32_bf16 v[44:47], a[160:163], a[40:43], v[44:47]
ds_read_b128 a[200:203], v37 offset:50688
buffer_load_dwordx4 a[36:39], v1, s[8:11], s60 offen offset:3072 sc1
v_mfma_f32_16x16x32_bf16 v[48:51], a[164:167], a[40:43], v[48:51]
ds_read_b128 a[204:207], v37 offset:51712
v_mfma_f32_16x16x32_bf16 v[52:55], a[168:171], a[40:43], v[52:55]
ds_read_b128 a[208:211], v37 offset:52736
buffer_load_dwordx4 a[236:239], v116, s[4:7], s64 offen sc1
v_mfma_f32_16x16x32_bf16 v[56:59], a[172:175], a[40:43], v[56:59]
ds_read_b128 a[212:215], v37 offset:53760
v_mfma_f32_16x16x32_bf16 v[60:63], a[176:179], a[40:43], v[60:63]
ds_read_b128 a[216:219], v41 offset:50688
s_waitcnt vmcnt(12) lgkmcnt(5)
v_mfma_f32_16x16x32_bf16 v[44:47], a[180:183], a[0:3], v[44:47]
ds_read_b128 a[160:163], v38 offset:0
s_add_u32 s60, s60, 4096
buffer_load_dwordx4 a[40:43], v1, s[8:11], s60 offen offset:0 sc1
v_mfma_f32_16x16x32_bf16 v[48:51], a[184:187], a[0:3], v[48:51]
ds_read_b128 a[164:167], v38 offset:1024
v_mfma_f32_16x16x32_bf16 v[52:55], a[188:191], a[0:3], v[52:55]
ds_read_b128 a[168:171], v38 offset:2048
v_mfma_f32_16x16x32_bf16 v[56:59], a[192:195], a[0:3], v[56:59]
ds_read_b128 a[172:175], v38 offset:3072
v_mfma_f32_16x16x32_bf16 v[60:63], a[196:199], a[0:3], v[60:63]
ds_read_b128 a[176:179], v42 offset:0
s_waitcnt vmcnt(12) lgkmcnt(5)
v_mfma_f32_16x16x32_bf16 v[44:47], a[200:203], a[4:7], v[44:47]
ds_read_b128 a[180:183], v38 offset:4608
buffer_load_dwordx4 a[0:3], v1, s[8:11], s60 offen offset:1024 sc1
v_mfma_f32_16x16x32_bf16 v[48:51], a[204:207], a[4:7], v[48:51]
ds_read_b128 a[184:187], v38 offset:5632
v_mfma_f32_16x16x32_bf16 v[52:55], a[208:211], a[4:7], v[52:55]
ds_read_b128 a[188:191], v38 offset:6656
v_mfma_f32_16x16x32_bf16 v[56:59], a[212:215], a[4:7], v[56:59]
ds_read_b128 a[192:195], v38 offset:7680
v_mfma_f32_16x16x32_bf16 v[60:63], a[216:219], a[4:7], v[60:63]
ds_read_b128 a[196:199], v42 offset:4608
s_waitcnt vmcnt(12) lgkmcnt(5)
v_mfma_f32_16x16x32_bf16 v[44:47], a[160:163], a[8:11], v[44:47]
ds_read_b128 a[200:203], v38 offset:9216
buffer_load_dwordx4 a[4:7], v1, s[8:11], s60 offen offset:2048 sc1
v_mfma_f32_16x16x32_bf16 v[48:51], a[164:167], a[8:11], v[48:51]
ds_read_b128 a[204:207], v38 offset:10240
v_mfma_f32_16x16x32_bf16 v[52:55], a[168:171], a[8:11], v[52:55]
ds_read_b128 a[208:211], v38 offset:11264
v_mfma_f32_16x16x32_bf16 v[56:59], a[172:175], a[8:11], v[56:59]
ds_read_b128 a[212:215], v38 offset:12288
v_mfma_f32_16x16x32_bf16 v[60:63], a[176:179], a[8:11], v[60:63]
ds_read_b128 a[216:219], v42 offset:9216
s_waitcnt vmcnt(12) lgkmcnt(5)
v_mfma_f32_16x16x32_bf16 v[44:47], a[180:183], a[12:15], v[44:47]
ds_read_b128 a[160:163], v38 offset:13824
buffer_load_dwordx4 a[8:11], v1, s[8:11], s60 offen offset:3072 sc1
v_mfma_f32_16x16x32_bf16 v[48:51], a[184:187], a[12:15], v[48:51]
ds_read_b128 a[164:167], v38 offset:14848
v_mfma_f32_16x16x32_bf16 v[52:55], a[188:191], a[12:15], v[52:55]
ds_read_b128 a[168:171], v38 offset:15872
v_mfma_f32_16x16x32_bf16 v[56:59], a[192:195], a[12:15], v[56:59]
ds_read_b128 a[172:175], v38 offset:16896
v_mfma_f32_16x16x32_bf16 v[60:63], a[196:199], a[12:15], v[60:63]
ds_read_b128 a[176:179], v42 offset:13824
s_waitcnt vmcnt(12) lgkmcnt(5)
v_mfma_f32_16x16x32_bf16 v[44:47], a[200:203], a[16:19], v[44:47]
ds_read_b128 a[180:183], v38 offset:18432
s_mov_b32 s60, s61
buffer_load_dwordx4 a[12:15], v1, s[8:11], s60 offen offset:0 sc1
v_mfma_f32_16x16x32_bf16 v[48:51], a[204:207], a[16:19], v[48:51]
ds_read_b128 a[184:187], v38 offset:19456
v_mfma_f32_16x16x32_bf16 v[52:55], a[208:211], a[16:19], v[52:55]
ds_read_b128 a[188:191], v38 offset:20480
v_mfma_f32_16x16x32_bf16 v[56:59], a[212:215], a[16:19], v[56:59]
ds_read_b128 a[192:195], v38 offset:21504
v_mfma_f32_16x16x32_bf16 v[60:63], a[216:219], a[16:19], v[60:63]
ds_read_b128 a[196:199], v42 offset:18432
s_waitcnt vmcnt(11) lgkmcnt(5)
v_mfma_f32_16x16x32_bf16 v[44:47], a[160:163], a[20:23], v[44:47]
ds_read_b128 a[200:203], v38 offset:23040
buffer_load_dwordx4 a[16:19], v1, s[8:11], s60 offen offset:1024 sc1
v_mfma_f32_16x16x32_bf16 v[48:51], a[164:167], a[20:23], v[48:51]
ds_read_b128 a[204:207], v38 offset:24064
v_mfma_f32_16x16x32_bf16 v[52:55], a[168:171], a[20:23], v[52:55]
ds_read_b128 a[208:211], v38 offset:25088
v_mfma_f32_16x16x32_bf16 v[56:59], a[172:175], a[20:23], v[56:59]
ds_read_b128 a[212:215], v38 offset:26112
v_mfma_f32_16x16x32_bf16 v[60:63], a[176:179], a[20:23], v[60:63]
ds_read_b128 a[216:219], v42 offset:23040
s_waitcnt vmcnt(11) lgkmcnt(5)
v_mfma_f32_16x16x32_bf16 v[44:47], a[180:183], a[24:27], v[44:47]
ds_read_b128 a[160:163], v38 offset:27648
buffer_load_dwordx4 a[20:23], v1, s[8:11], s60 offen offset:2048 sc1
v_mfma_f32_16x16x32_bf16 v[48:51], a[184:187], a[24:27], v[48:51]
ds_read_b128 a[164:167], v38 offset:28672
v_mfma_f32_16x16x32_bf16 v[52:55], a[188:191], a[24:27], v[52:55]
ds_read_b128 a[168:171], v38 offset:29696
v_mfma_f32_16x16x32_bf16 v[56:59], a[192:195], a[24:27], v[56:59]
ds_read_b128 a[172:175], v38 offset:30720
v_mfma_f32_16x16x32_bf16 v[60:63], a[196:199], a[24:27], v[60:63]
ds_read_b128 a[176:179], v42 offset:27648
s_waitcnt vmcnt(10) lgkmcnt(5)
v_mfma_f32_16x16x32_bf16 v[44:47], a[200:203], a[28:31], v[44:47]
ds_read_b128 a[180:183], v38 offset:32256
buffer_load_dwordx4 a[24:27], v1, s[8:11], s60 offen offset:3072 sc1
v_mfma_f32_16x16x32_bf16 v[48:51], a[204:207], a[28:31], v[48:51]
ds_read_b128 a[184:187], v38 offset:33280
v_mfma_f32_16x16x32_bf16 v[52:55], a[208:211], a[28:31], v[52:55]
ds_read_b128 a[188:191], v38 offset:34304
v_mfma_f32_16x16x32_bf16 v[56:59], a[212:215], a[28:31], v[56:59]
ds_read_b128 a[192:195], v38 offset:35328
v_mfma_f32_16x16x32_bf16 v[60:63], a[216:219], a[28:31], v[60:63]
ds_read_b128 a[196:199], v42 offset:32256
s_waitcnt vmcnt(10) lgkmcnt(5)
v_mfma_f32_16x16x32_bf16 v[44:47], a[160:163], a[32:35], v[44:47]
ds_read_b128 a[200:203], v38 offset:36864
s_add_u32 s60, s60, 4096
buffer_load_dwordx4 a[28:31], v1, s[8:11], s60 offen offset:0 sc1
v_mfma_f32_16x16x32_bf16 v[48:51], a[164:167], a[32:35], v[48:51]
ds_read_b128 a[204:207], v38 offset:37888
v_mfma_f32_16x16x32_bf16 v[52:55], a[168:171], a[32:35], v[52:55]
ds_read_b128 a[208:211], v38 offset:38912
v_mfma_f32_16x16x32_bf16 v[56:59], a[172:175], a[32:35], v[56:59]
ds_read_b128 a[212:215], v38 offset:39936
v_mfma_f32_16x16x32_bf16 v[60:63], a[176:179], a[32:35], v[60:63]
ds_read_b128 a[216:219], v42 offset:36864
s_waitcnt vmcnt(10) lgkmcnt(5)
v_mfma_f32_16x16x32_bf16 v[44:47], a[180:183], a[36:39], v[44:47]
ds_read_b128 a[160:163], v38 offset:41472
buffer_load_dwordx4 a[32:35], v1, s[8:11], s60 offen offset:1024 sc1
v_mfma_f32_16x16x32_bf16 v[48:51], a[184:187], a[36:39], v[48:51]
ds_read_b128 a[164:167], v38 offset:42496
v_mfma_f32_16x16x32_bf16 v[52:55], a[188:191], a[36:39], v[52:55]
ds_read_b128 a[168:171], v38 offset:43520
v_mfma_f32_16x16x32_bf16 v[56:59], a[192:195], a[36:39], v[56:59]
ds_read_b128 a[172:175], v38 offset:44544
v_mfma_f32_16x16x32_bf16 v[60:63], a[196:199], a[36:39], v[60:63]
ds_read_b128 a[176:179], v42 offset:41472
s_waitcnt vmcnt(9) lgkmcnt(5)
v_mfma_f32_16x16x32_bf16 v[44:47], a[200:203], a[40:43], v[44:47]
ds_read_b128 a[180:183], v38 offset:46080
buffer_load_dwordx4 a[36:39], v1, s[8:11], s60 offen offset:2048 sc1
v_mfma_f32_16x16x32_bf16 v[48:51], a[204:207], a[40:43], v[48:51]
ds_read_b128 a[184:187], v38 offset:47104
v_mfma_f32_16x16x32_bf16 v[52:55], a[208:211], a[40:43], v[52:55]
ds_read_b128 a[188:191], v38 offset:48128
v_mfma_f32_16x16x32_bf16 v[56:59], a[212:215], a[40:43], v[56:59]
ds_read_b128 a[192:195], v38 offset:49152
v_mfma_f32_16x16x32_bf16 v[60:63], a[216:219], a[40:43], v[60:63]
ds_read_b128 a[196:199], v42 offset:46080
s_waitcnt vmcnt(9) lgkmcnt(5)
v_mfma_f32_16x16x32_bf16 v[44:47], a[160:163], a[0:3], v[44:47]
ds_read_b128 a[200:203], v38 offset:50688
buffer_load_dwordx4 a[40:43], v1, s[8:11], s60 offen offset:3072 sc1
v_mfma_f32_16x16x32_bf16 v[48:51], a[164:167], a[0:3], v[48:51]
ds_read_b128 a[204:207], v38 offset:51712
v_mfma_f32_16x16x32_bf16 v[52:55], a[168:171], a[0:3], v[52:55]
v_mfma_f32_16x16x32_bf16 v[56:59], a[172:175], a[0:3], v[56:59]
v_mfma_f32_16x16x32_bf16 v[60:63], a[176:179], a[0:3], v[60:63]
s_waitcnt vmcnt(9) lgkmcnt(2)
v_mfma_f32_16x16x32_bf16 v[44:47], a[180:183], a[4:7], v[44:47]
ds_read_b128 a[160:163], v36 offset:0
s_add_u32 s60, s60, 4096
buffer_load_dwordx4 a[0:3], v1, s[8:11], s60 offen offset:0 sc1
v_mfma_f32_16x16x32_bf16 v[48:51], a[184:187], a[4:7], v[48:51]
ds_read_b128 a[164:167], v36 offset:1024
v_mfma_f32_16x16x32_bf16 v[52:55], a[188:191], a[4:7], v[52:55]
ds_read_b128 a[168:171], v36 offset:2048
v_mfma_f32_16x16x32_bf16 v[56:59], a[192:195], a[4:7], v[56:59]
ds_read_b128 a[172:175], v36 offset:3072
v_mfma_f32_16x16x32_bf16 v[60:63], a[196:199], a[4:7], v[60:63]
ds_read_b128 a[176:179], v40 offset:0
s_waitcnt vmcnt(9) lgkmcnt(5)
v_mfma_f32_16x16x32_bf16 v[44:47], a[200:203], a[8:11], v[44:47]
ds_read_b128 a[180:183], v36 offset:4608
buffer_load_dwordx4 a[4:7], v1, s[8:11], s60 offen offset:1024 sc1
v_mfma_f32_16x16x32_bf16 v[48:51], a[204:207], a[8:11], v[48:51]
ds_read_b128 a[184:187], v36 offset:5632
v_mfma_f32_16x16x32_bf16 v[52:55], a[228:231], a[8:11], v[52:55]
ds_read_b128 a[188:191], v36 offset:6656
v_mfma_f32_16x16x32_bf16 v[56:59], a[232:235], a[8:11], v[56:59]
ds_read_b128 a[192:195], v36 offset:7680
v_mfma_f32_16x16x32_bf16 v[60:63], a[236:239], a[8:11], v[60:63]
ds_read_b128 a[196:199], v40 offset:4608
s_waitcnt vmcnt(9) lgkmcnt(5)
v_mfma_f32_16x16x32_bf16 v[16:19], a[160:163], a[12:15], v[16:19]
ds_read_b128 a[200:203], v36 offset:9216
buffer_load_dwordx4 a[8:11], v1, s[8:11], s60 offen offset:2048 sc1
v_mfma_f32_16x16x32_bf16 v[20:23], a[164:167], a[12:15], v[20:23]
ds_read_b128 a[204:207], v36 offset:10240
v_mfma_f32_16x16x32_bf16 v[24:27], a[168:171], a[12:15], v[24:27]
ds_read_b128 a[208:211], v36 offset:11264
v_mfma_f32_16x16x32_bf16 v[28:31], a[172:175], a[12:15], v[28:31]
ds_read_b128 a[212:215], v36 offset:12288
v_mfma_f32_16x16x32_bf16 v[32:35], a[176:179], a[12:15], v[32:35]
ds_read_b128 a[216:219], v40 offset:9216
s_waitcnt vmcnt(9) lgkmcnt(5)
v_mfma_f32_16x16x32_bf16 v[16:19], a[180:183], a[16:19], v[16:19]
ds_read_b128 a[160:163], v36 offset:13824
buffer_load_dwordx4 a[12:15], v1, s[8:11], s60 offen offset:3072 sc1
v_mfma_f32_16x16x32_bf16 v[20:23], a[184:187], a[16:19], v[20:23]
ds_read_b128 a[164:167], v36 offset:14848
v_mfma_f32_16x16x32_bf16 v[24:27], a[188:191], a[16:19], v[24:27]
ds_read_b128 a[168:171], v36 offset:15872
v_mfma_f32_16x16x32_bf16 v[28:31], a[192:195], a[16:19], v[28:31]
ds_read_b128 a[172:175], v36 offset:16896
v_cvt_pk_bf16_f32 v64, v44, v45
v_mfma_f32_16x16x32_bf16 v[32:35], a[196:199], a[16:19], v[32:35]
ds_read_b128 a[176:179], v40 offset:13824
s_waitcnt vmcnt(9) lgkmcnt(5)
v_mfma_f32_16x16x32_bf16 v[16:19], a[200:203], a[20:23], v[16:19]
ds_read_b128 a[180:183], v36 offset:18432
s_add_u32 s60, s60, 4096
buffer_load_dwordx4 a[16:19], v1, s[8:11], s60 offen offset:0 sc1
v_mfma_f32_16x16x32_bf16 v[20:23], a[204:207], a[20:23], v[20:23]
ds_read_b128 a[184:187], v36 offset:19456
v_cvt_pk_bf16_f32 v65, v46, v47
v_mfma_f32_16x16x32_bf16 v[24:27], a[208:211], a[20:23], v[24:27]
ds_read_b128 a[188:191], v36 offset:20480
v_mfma_f32_16x16x32_bf16 v[28:31], a[212:215], a[20:23], v[28:31]
ds_read_b128 a[192:195], v36 offset:21504
v_mfma_f32_16x16x32_bf16 v[32:35], a[216:219], a[20:23], v[32:35]
ds_read_b128 a[196:199], v40 offset:18432
s_waitcnt vmcnt(9) lgkmcnt(5)
v_mfma_f32_16x16x32_bf16 v[16:19], a[160:163], a[24:27], v[16:19]
ds_read_b128 a[200:203], v36 offset:23040
buffer_load_dwordx4 a[20:23], v1, s[8:11], s60 offen offset:1024 sc1
v_mfma_f32_16x16x32_bf16 v[20:23], a[164:167], a[24:27], v[20:23]
ds_read_b128 a[204:207], v36 offset:24064
v_cvt_pk_bf16_f32 v66, v48, v49
v_mfma_f32_16x16x32_bf16 v[24:27], a[168:171], a[24:27], v[24:27]
ds_read_b128 a[208:211], v36 offset:25088
buffer_store_dwordx4 v[64:67], v1, s[8:11], s62 offen offset:0 sc1
v_mfma_f32_16x16x32_bf16 v[28:31], a[172:175], a[24:27], v[28:31]
ds_read_b128 a[212:215], v36 offset:26112
v_mfma_f32_16x16x32_bf16 v[32:35], a[176:179], a[24:27], v[32:35]
ds_read_b128 a[216:219], v40 offset:23040
s_waitcnt vmcnt(10) lgkmcnt(5)
v_mfma_f32_16x16x32_bf16 v[16:19], a[180:183], a[28:31], v[16:19]
ds_read_b128 a[160:163], v36 offset:27648
buffer_load_dwordx4 a[24:27], v1, s[8:11], s60 offen offset:2048 sc1
v_mfma_f32_16x16x32_bf16 v[20:23], a[184:187], a[28:31], v[20:23]
ds_read_b128 a[164:167], v36 offset:28672
v_cvt_pk_bf16_f32 v68, v50, v51
v_mfma_f32_16x16x32_bf16 v[24:27], a[188:191], a[28:31], v[24:27]
ds_read_b128 a[168:171], v36 offset:29696
v_mfma_f32_16x16x32_bf16 v[28:31], a[192:195], a[28:31], v[28:31]
ds_read_b128 a[172:175], v36 offset:30720
v_cvt_pk_bf16_f32 v69, v52, v53
v_mfma_f32_16x16x32_bf16 v[32:35], a[196:199], a[28:31], v[32:35]
ds_read_b128 a[176:179], v40 offset:27648
s_waitcnt vmcnt(10) lgkmcnt(5)
v_mfma_f32_16x16x32_bf16 v[16:19], a[200:203], a[32:35], v[16:19]
ds_read_b128 a[180:183], v36 offset:32256
buffer_load_dwordx4 a[28:31], v1, s[8:11], s60 offen offset:3072 sc1
v_mfma_f32_16x16x32_bf16 v[20:23], a[204:207], a[32:35], v[20:23]
ds_read_b128 a[184:187], v36 offset:33280
v_cvt_pk_bf16_f32 v70, v54, v55
v_mfma_f32_16x16x32_bf16 v[24:27], a[208:211], a[32:35], v[24:27]
ds_read_b128 a[188:191], v36 offset:34304
v_mfma_f32_16x16x32_bf16 v[28:31], a[212:215], a[32:35], v[28:31]
ds_read_b128 a[192:195], v36 offset:35328
v_mfma_f32_16x16x32_bf16 v[32:35], a[216:219], a[32:35], v[32:35]
ds_read_b128 a[196:199], v40 offset:32256
s_waitcnt vmcnt(10) lgkmcnt(5)
v_mfma_f32_16x16x32_bf16 v[16:19], a[160:163], a[36:39], v[16:19]
ds_read_b128 a[200:203], v36 offset:36864
s_add_u32 s60, s60, 4096
buffer_load_dwordx4 a[32:35], v1, s[8:11], s60 offen offset:0 sc1
v_mfma_f32_16x16x32_bf16 v[20:23], a[164:167], a[36:39], v[20:23]
ds_read_b128 a[204:207], v36 offset:37888
buffer_store_dwordx4 v[68:71], v1, s[8:11], s62 offen offset:1024 sc1
v_mfma_f32_16x16x32_bf16 v[24:27], a[168:171], a[36:39], v[24:27]
ds_read_b128 a[208:211], v36 offset:38912
v_cvt_pk_bf16_f32 v72, v56, v57
v_mfma_f32_16x16x32_bf16 v[28:31], a[172:175], a[36:39], v[28:31]
ds_read_b128 a[212:215], v36 offset:39936
v_mfma_f32_16x16x32_bf16 v[32:35], a[176:179], a[36:39], v[32:35]
ds_read_b128 a[216:219], v40 offset:36864
s_waitcnt vmcnt(11) lgkmcnt(5)
v_mfma_f32_16x16x32_bf16 v[16:19], a[180:183], a[40:43], v[16:19]
ds_read_b128 a[160:163], v36 offset:41472
buffer_load_dwordx4 a[36:39], v1, s[8:11], s60 offen offset:1024 sc1
v_mfma_f32_16x16x32_bf16 v[20:23], a[184:187], a[40:43], v[20:23]
ds_read_b128 a[164:167], v36 offset:42496
v_cvt_pk_bf16_f32 v73, v58, v59
v_mfma_f32_16x16x32_bf16 v[24:27], a[188:191], a[40:43], v[24:27]
ds_read_b128 a[168:171], v36 offset:43520
v_mfma_f32_16x16x32_bf16 v[28:31], a[192:195], a[40:43], v[28:31]
ds_read_b128 a[172:175], v36 offset:44544
v_cvt_pk_bf16_f32 v74, v60, v61
v_mfma_f32_16x16x32_bf16 v[32:35], a[196:199], a[40:43], v[32:35]
ds_read_b128 a[176:179], v40 offset:41472
s_waitcnt vmcnt(11) lgkmcnt(5)
v_mfma_f32_16x16x32_bf16 v[16:19], a[200:203], a[0:3], v[16:19]
ds_read_b128 a[180:183], v36 offset:46080
buffer_load_dwordx4 a[40:43], v1, s[8:11], s60 offen offset:2048 sc1
v_mfma_f32_16x16x32_bf16 v[20:23], a[204:207], a[0:3], v[20:23]
ds_read_b128 a[184:187], v36 offset:47104
buffer_store_dwordx4 v[72:75], v1, s[8:11], s62 offen offset:2048 sc1
v_mfma_f32_16x16x32_bf16 v[24:27], a[208:211], a[0:3], v[24:27]
ds_read_b128 a[188:191], v36 offset:48128
v_mfma_f32_16x16x32_bf16 v[28:31], a[212:215], a[0:3], v[28:31]
ds_read_b128 a[192:195], v36 offset:49152
v_mfma_f32_16x16x32_bf16 v[32:35], a[216:219], a[0:3], v[32:35]
ds_read_b128 a[196:199], v40 offset:46080
s_waitcnt vmcnt(12) lgkmcnt(5)
v_mfma_f32_16x16x32_bf16 v[16:19], a[160:163], a[4:7], v[16:19]
ds_read_b128 a[200:203], v36 offset:50688
buffer_load_dwordx4 a[0:3], v1, s[8:11], s60 offen offset:3072 sc1
v_mfma_f32_16x16x32_bf16 v[20:23], a[164:167], a[4:7], v[20:23]
ds_read_b128 a[204:207], v36 offset:51712
v_cvt_pk_bf16_f32 v76, v62, v63
v_mfma_f32_16x16x32_bf16 v[24:27], a[168:171], a[4:7], v[24:27]
ds_read_b128 a[208:211], v36 offset:52736
buffer_store_dwordx4 v[76:79], v1, s[8:11], s62 offen offset:3072 sc1
v_mfma_f32_16x16x32_bf16 v[28:31], a[172:175], a[4:7], v[28:31]
ds_read_b128 a[212:215], v36 offset:53760
v_mfma_f32_16x16x32_bf16 v[32:35], a[176:179], a[4:7], v[32:35]
ds_read_b128 a[216:219], v40 offset:50688
s_waitcnt vmcnt(13) lgkmcnt(5)
v_mfma_f32_16x16x32_bf16 v[16:19], a[180:183], a[8:11], v[16:19]
ds_read_b128 a[160:163], v37 offset:0
s_add_u32 s60, s60, 4096
buffer_load_dwordx4 a[4:7], v1, s[8:11], s60 offen offset:0 sc1
v_mfma_f32_16x16x32_bf16 v[20:23], a[184:187], a[8:11], v[20:23]
ds_read_b128 a[164:167], v37 offset:1024
v_mfma_f32_16x16x32_bf16 v[24:27], a[188:191], a[8:11], v[24:27]
ds_read_b128 a[168:171], v37 offset:2048
v_mfma_f32_16x16x32_bf16 v[28:31], a[192:195], a[8:11], v[28:31]
ds_read_b128 a[172:175], v37 offset:3072
v_mfma_f32_16x16x32_bf16 v[32:35], a[196:199], a[8:11], v[32:35]
ds_read_b128 a[176:179], v41 offset:0
s_waitcnt vmcnt(13) lgkmcnt(5)
v_mfma_f32_16x16x32_bf16 v[16:19], a[200:203], a[12:15], v[16:19]
ds_read_b128 a[180:183], v37 offset:4608
buffer_load_dwordx4 a[8:11], v1, s[8:11], s60 offen offset:1024 sc1
v_mfma_f32_16x16x32_bf16 v[20:23], a[204:207], a[12:15], v[20:23]
ds_read_b128 a[184:187], v37 offset:5632
v_mfma_f32_16x16x32_bf16 v[24:27], a[208:211], a[12:15], v[24:27]
ds_read_b128 a[188:191], v37 offset:6656
v_mfma_f32_16x16x32_bf16 v[28:31], a[212:215], a[12:15], v[28:31]
ds_read_b128 a[192:195], v37 offset:7680
v_mfma_f32_16x16x32_bf16 v[32:35], a[216:219], a[12:15], v[32:35]
ds_read_b128 a[196:199], v41 offset:4608
s_waitcnt vmcnt(13) lgkmcnt(5)
v_mfma_f32_16x16x32_bf16 v[16:19], a[160:163], a[16:19], v[16:19]
ds_read_b128 a[200:203], v37 offset:9216
buffer_load_dwordx4 a[12:15], v1, s[8:11], s60 offen offset:2048 sc1
v_mfma_f32_16x16x32_bf16 v[20:23], a[164:167], a[16:19], v[20:23]
ds_read_b128 a[204:207], v37 offset:10240
v_mfma_f32_16x16x32_bf16 v[24:27], a[168:171], a[16:19], v[24:27]
ds_read_b128 a[208:211], v37 offset:11264
v_mfma_f32_16x16x32_bf16 v[28:31], a[172:175], a[16:19], v[28:31]
ds_read_b128 a[212:215], v37 offset:12288
v_mfma_f32_16x16x32_bf16 v[32:35], a[176:179], a[16:19], v[32:35]
ds_read_b128 a[216:219], v41 offset:9216
s_waitcnt vmcnt(13) lgkmcnt(5)
v_mfma_f32_16x16x32_bf16 v[16:19], a[180:183], a[20:23], v[16:19]
ds_read_b128 a[160:163], v37 offset:13824
buffer_load_dwordx4 a[16:19], v1, s[8:11], s60 offen offset:3072 sc1
v_mfma_f32_16x16x32_bf16 v[20:23], a[184:187], a[20:23], v[20:23]
ds_read_b128 a[164:167], v37 offset:14848
v_mfma_f32_16x16x32_bf16 v[24:27], a[188:191], a[20:23], v[24:27]
ds_read_b128 a[168:171], v37 offset:15872
v_mfma_f32_16x16x32_bf16 v[28:31], a[192:195], a[20:23], v[28:31]
ds_read_b128 a[172:175], v37 offset:16896
v_mfma_f32_16x16x32_bf16 v[32:35], a[196:199], a[20:23], v[32:35]
ds_read_b128 a[176:179], v41 offset:13824
s_waitcnt vmcnt(12) lgkmcnt(5)
v_mfma_f32_16x16x32_bf16 v[16:19], a[200:203], a[24:27], v[16:19]
ds_read_b128 a[180:183], v37 offset:18432
s_add_u32 s60, s60, 4096
buffer_load_dwordx4 a[20:23], v1, s[8:11], s60 offen offset:0 sc1
v_mfma_f32_16x16x32_bf16 v[20:23], a[204:207], a[24:27], v[20:23]
ds_read_b128 a[184:187], v37 offset:19456
v_mfma_f32_16x16x32_bf16 v[24:27], a[208:211], a[24:27], v[24:27]
ds_read_b128 a[188:191], v37 offset:20480
v_mfma_f32_16x16x32_bf16 v[28:31], a[212:215], a[24:27], v[28:31]
ds_read_b128 a[192:195], v37 offset:21504
v_mfma_f32_16x16x32_bf16 v[32:35], a[216:219], a[24:27], v[32:35]
ds_read_b128 a[196:199], v41 offset:18432
s_waitcnt vmcnt(12) lgkmcnt(5)
v_mfma_f32_16x16x32_bf16 v[16:19], a[160:163], a[28:31], v[16:19]
ds_read_b128 a[200:203], v37 offset:23040
buffer_load_dwordx4 a[24:27], v1, s[8:11], s60 offen offset:1024 sc1
v_mfma_f32_16x16x32_bf16 v[20:23], a[164:167], a[28:31], v[20:23]
ds_read_b128 a[204:207], v37 offset:24064
v_mfma_f32_16x16x32_bf16 v[24:27], a[168:171], a[28:31], v[24:27]
ds_read_b128 a[208:211], v37 offset:25088
v_mfma_f32_16x16x32_bf16 v[28:31], a[172:175], a[28:31], v[28:31]
ds_read_b128 a[212:215], v37 offset:26112
v_mfma_f32_16x16x32_bf16 v[32:35], a[176:179], a[28:31], v[32:35]
ds_read_b128 a[216:219], v41 offset:23040
s_waitcnt vmcnt(12) lgkmcnt(5)
v_mfma_f32_16x16x32_bf16 v[16:19], a[180:183], a[32:35], v[16:19]
ds_read_b128 a[160:163], v37 offset:27648
buffer_load_dwordx4 a[28:31], v1, s[8:11], s60 offen offset:2048 sc1
v_mfma_f32_16x16x32_bf16 v[20:23], a[184:187], a[32:35], v[20:23]
ds_read_b128 a[164:167], v37 offset:28672
v_mfma_f32_16x16x32_bf16 v[24:27], a[188:191], a[32:35], v[24:27]
ds_read_b128 a[168:171], v37 offset:29696
v_mfma_f32_16x16x32_bf16 v[28:31], a[192:195], a[32:35], v[28:31]
ds_read_b128 a[172:175], v37 offset:30720
v_mfma_f32_16x16x32_bf16 v[32:35], a[196:199], a[32:35], v[32:35]
ds_read_b128 a[176:179], v41 offset:27648
s_waitcnt vmcnt(11) lgkmcnt(5)
v_mfma_f32_16x16x32_bf16 v[16:19], a[200:203], a[36:39], v[16:19]
ds_read_b128 a[180:183], v37 offset:32256
buffer_load_dwordx4 a[32:35], v1, s[8:11], s60 offen offset:3072 sc1
v_mfma_f32_16x16x32_bf16 v[20:23], a[204:207], a[36:39], v[20:23]
ds_read_b128 a[184:187], v37 offset:33280
v_mfma_f32_16x16x32_bf16 v[24:27], a[208:211], a[36:39], v[24:27]
ds_read_b128 a[188:191], v37 offset:34304
v_mfma_f32_16x16x32_bf16 v[28:31], a[212:215], a[36:39], v[28:31]
ds_read_b128 a[192:195], v37 offset:35328
v_mfma_f32_16x16x32_bf16 v[32:35], a[216:219], a[36:39], v[32:35]
ds_read_b128 a[196:199], v41 offset:32256
s_waitcnt vmcnt(11) lgkmcnt(5)
v_mfma_f32_16x16x32_bf16 v[16:19], a[160:163], a[40:43], v[16:19]
ds_read_b128 a[200:203], v37 offset:36864
s_add_u32 s60, s60, 4096
buffer_load_dwordx4 a[36:39], v1, s[8:11], s60 offen offset:0 sc1
v_mfma_f32_16x16x32_bf16 v[20:23], a[164:167], a[40:43], v[20:23]
ds_read_b128 a[204:207], v37 offset:37888
v_mfma_f32_16x16x32_bf16 v[24:27], a[168:171], a[40:43], v[24:27]
ds_read_b128 a[208:211], v37 offset:38912
v_mfma_f32_16x16x32_bf16 v[28:31], a[172:175], a[40:43], v[28:31]
ds_read_b128 a[212:215], v37 offset:39936
v_mfma_f32_16x16x32_bf16 v[32:35], a[176:179], a[40:43], v[32:35]
ds_read_b128 a[216:219], v41 offset:36864
s_waitcnt vmcnt(10) lgkmcnt(5)
v_mfma_f32_16x16x32_bf16 v[16:19], a[180:183], a[0:3], v[16:19]
ds_read_b128 a[160:163], v37 offset:41472
buffer_load_dwordx4 a[40:43], v1, s[8:11], s60 offen offset:1024 sc1
v_mfma_f32_16x16x32_bf16 v[20:23], a[184:187], a[0:3], v[20:23]
ds_read_b128 a[164:167], v37 offset:42496
v_mfma_f32_16x16x32_bf16 v[24:27], a[188:191], a[0:3], v[24:27]
ds_read_b128 a[168:171], v37 offset:43520
v_mfma_f32_16x16x32_bf16 v[28:31], a[192:195], a[0:3], v[28:31]
ds_read_b128 a[172:175], v37 offset:44544
v_mfma_f32_16x16x32_bf16 v[32:35], a[196:199], a[0:3], v[32:35]
ds_read_b128 a[176:179], v41 offset:41472
s_waitcnt vmcnt(9) lgkmcnt(5)
v_mfma_f32_16x16x32_bf16 v[16:19], a[200:203], a[4:7], v[16:19]
ds_read_b128 a[180:183], v37 offset:46080
buffer_load_dwordx4 a[0:3], v1, s[8:11], s60 offen offset:2048 sc1
v_mfma_f32_16x16x32_bf16 v[20:23], a[204:207], a[4:7], v[20:23]
ds_read_b128 a[184:187], v37 offset:47104
v_mfma_f32_16x16x32_bf16 v[24:27], a[208:211], a[4:7], v[24:27]
ds_read_b128 a[188:191], v37 offset:48128
v_mfma_f32_16x16x32_bf16 v[28:31], a[212:215], a[4:7], v[28:31]
ds_read_b128 a[192:195], v37 offset:49152
v_mfma_f32_16x16x32_bf16 v[32:35], a[216:219], a[4:7], v[32:35]
ds_read_b128 a[196:199], v41 offset:46080
s_waitcnt vmcnt(9) lgkmcnt(5)
v_mfma_f32_16x16x32_bf16 v[16:19], a[160:163], a[8:11], v[16:19]
ds_read_b128 a[200:203], v37 offset:50688
buffer_load_dwordx4 a[4:7], v1, s[8:11], s60 offen offset:3072 sc1
v_mfma_f32_16x16x32_bf16 v[20:23], a[164:167], a[8:11], v[20:23]
ds_read_b128 a[204:207], v37 offset:51712
v_mfma_f32_16x16x32_bf16 v[24:27], a[168:171], a[8:11], v[24:27]
ds_read_b128 a[208:211], v37 offset:52736
v_mfma_f32_16x16x32_bf16 v[28:31], a[172:175], a[8:11], v[28:31]
ds_read_b128 a[212:215], v37 offset:53760
v_mfma_f32_16x16x32_bf16 v[32:35], a[176:179], a[8:11], v[32:35]
ds_read_b128 a[216:219], v41 offset:50688
s_waitcnt vmcnt(9) lgkmcnt(5)
v_mfma_f32_16x16x32_bf16 v[16:19], a[180:183], a[12:15], v[16:19]
ds_read_b128 a[160:163], v38 offset:0
s_add_u32 s60, s60, 4096
buffer_load_dwordx4 a[8:11], v1, s[8:11], s60 offen offset:0 sc1
v_mfma_f32_16x16x32_bf16 v[20:23], a[184:187], a[12:15], v[20:23]
ds_read_b128 a[164:167], v38 offset:1024
v_mfma_f32_16x16x32_bf16 v[24:27], a[188:191], a[12:15], v[24:27]
ds_read_b128 a[168:171], v38 offset:2048
v_mfma_f32_16x16x32_bf16 v[28:31], a[192:195], a[12:15], v[28:31]
ds_read_b128 a[172:175], v38 offset:3072
v_mfma_f32_16x16x32_bf16 v[32:35], a[196:199], a[12:15], v[32:35]
ds_read_b128 a[176:179], v42 offset:0
s_waitcnt vmcnt(9) lgkmcnt(5)
v_mfma_f32_16x16x32_bf16 v[16:19], a[200:203], a[16:19], v[16:19]
ds_read_b128 a[180:183], v38 offset:4608
buffer_load_dwordx4 a[12:15], v1, s[8:11], s60 offen offset:1024 sc1
v_mfma_f32_16x16x32_bf16 v[20:23], a[204:207], a[16:19], v[20:23]
ds_read_b128 a[184:187], v38 offset:5632
v_mfma_f32_16x16x32_bf16 v[24:27], a[208:211], a[16:19], v[24:27]
ds_read_b128 a[188:191], v38 offset:6656
v_mfma_f32_16x16x32_bf16 v[28:31], a[212:215], a[16:19], v[28:31]
ds_read_b128 a[192:195], v38 offset:7680
v_mfma_f32_16x16x32_bf16 v[32:35], a[216:219], a[16:19], v[32:35]
ds_read_b128 a[196:199], v42 offset:4608
s_waitcnt vmcnt(9) lgkmcnt(5)
v_mfma_f32_16x16x32_bf16 v[16:19], a[160:163], a[20:23], v[16:19]
ds_read_b128 a[200:203], v38 offset:9216
buffer_load_dwordx4 a[16:19], v1, s[8:11], s60 offen offset:2048 sc1
v_mfma_f32_16x16x32_bf16 v[20:23], a[164:167], a[20:23], v[20:23]
ds_read_b128 a[204:207], v38 offset:10240
v_mfma_f32_16x16x32_bf16 v[24:27], a[168:171], a[20:23], v[24:27]
ds_read_b128 a[208:211], v38 offset:11264
v_mfma_f32_16x16x32_bf16 v[28:31], a[172:175], a[20:23], v[28:31]
ds_read_b128 a[212:215], v38 offset:12288
v_mfma_f32_16x16x32_bf16 v[32:35], a[176:179], a[20:23], v[32:35]
ds_read_b128 a[216:219], v42 offset:9216
s_waitcnt vmcnt(9) lgkmcnt(5)
v_mfma_f32_16x16x32_bf16 v[16:19], a[180:183], a[24:27], v[16:19]
ds_read_b128 a[160:163], v38 offset:13824
buffer_load_dwordx4 a[20:23], v1, s[8:11], s60 offen offset:3072 sc1
v_mfma_f32_16x16x32_bf16 v[20:23], a[184:187], a[24:27], v[20:23]
ds_read_b128 a[164:167], v38 offset:14848
v_mfma_f32_16x16x32_bf16 v[24:27], a[188:191], a[24:27], v[24:27]
ds_read_b128 a[168:171], v38 offset:15872
v_mfma_f32_16x16x32_bf16 v[28:31], a[192:195], a[24:27], v[28:31]
ds_read_b128 a[172:175], v38 offset:16896
v_mfma_f32_16x16x32_bf16 v[32:35], a[196:199], a[24:27], v[32:35]
ds_read_b128 a[176:179], v42 offset:13824
s_waitcnt vmcnt(9) lgkmcnt(5)
v_mfma_f32_16x16x32_bf16 v[16:19], a[200:203], a[28:31], v[16:19]
ds_read_b128 a[180:183], v38 offset:18432
buffer_load_dwordx4 v[80:83], v1, s[8:11], s63 offen offset:0 sc1
v_mfma_f32_16x16x32_bf16 v[20:23], a[204:207], a[28:31], v[20:23]
ds_read_b128 a[184:187], v38 offset:19456
v_mfma_f32_16x16x32_bf16 v[24:27], a[208:211], a[28:31], v[24:27]
ds_read_b128 a[188:191], v38 offset:20480
v_mfma_f32_16x16x32_bf16 v[28:31], a[212:215], a[28:31], v[28:31]
ds_read_b128 a[192:195], v38 offset:21504
v_mfma_f32_16x16x32_bf16 v[32:35], a[216:219], a[28:31], v[32:35]
ds_read_b128 a[196:199], v42 offset:18432
s_waitcnt vmcnt(9) lgkmcnt(5)
v_mfma_f32_16x16x32_bf16 v[16:19], a[160:163], a[32:35], v[16:19]
ds_read_b128 a[200:203], v38 offset:23040
buffer_load_dwordx4 v[84:87], v1, s[8:11], s63 offen offset:1024 sc1
v_mfma_f32_16x16x32_bf16 v[20:23], a[164:167], a[32:35], v[20:23]
ds_read_b128 a[204:207], v38 offset:24064
v_mfma_f32_16x16x32_bf16 v[24:27], a[168:171], a[32:35], v[24:27]
ds_read_b128 a[208:211], v38 offset:25088
v_mfma_f32_16x16x32_bf16 v[28:31], a[172:175], a[32:35], v[28:31]
ds_read_b128 a[212:215], v38 offset:26112
v_mfma_f32_16x16x32_bf16 v[32:35], a[176:179], a[32:35], v[32:35]
ds_read_b128 a[216:219], v42 offset:23040
s_waitcnt vmcnt(9) lgkmcnt(5)
v_mfma_f32_16x16x32_bf16 v[16:19], a[180:183], a[36:39], v[16:19]
ds_read_b128 a[160:163], v38 offset:27648
buffer_load_dwordx4 v[88:91], v1, s[8:11], s63 offen offset:2048 sc1
v_mfma_f32_16x16x32_bf16 v[20:23], a[184:187], a[36:39], v[20:23]
ds_read_b128 a[164:167], v38 offset:28672
v_mfma_f32_16x16x32_bf16 v[24:27], a[188:191], a[36:39], v[24:27]
ds_read_b128 a[168:171], v38 offset:29696
v_mfma_f32_16x16x32_bf16 v[28:31], a[192:195], a[36:39], v[28:31]
ds_read_b128 a[172:175], v38 offset:30720
v_mfma_f32_16x16x32_bf16 v[32:35], a[196:199], a[36:39], v[32:35]
ds_read_b128 a[176:179], v42 offset:27648
s_waitcnt vmcnt(9) lgkmcnt(5)
v_mfma_f32_16x16x32_bf16 v[16:19], a[200:203], a[40:43], v[16:19]
ds_read_b128 a[180:183], v38 offset:32256
buffer_load_dwordx4 v[92:95], v1, s[8:11], s63 offen offset:3072 sc1
v_mfma_f32_16x16x32_bf16 v[20:23], a[204:207], a[40:43], v[20:23]
ds_read_b128 a[184:187], v38 offset:33280
v_mfma_f32_16x16x32_bf16 v[24:27], a[208:211], a[40:43], v[24:27]
ds_read_b128 a[188:191], v38 offset:34304
v_mfma_f32_16x16x32_bf16 v[28:31], a[212:215], a[40:43], v[28:31]
ds_read_b128 a[192:195], v38 offset:35328
v_mfma_f32_16x16x32_bf16 v[32:35], a[216:219], a[40:43], v[32:35]
ds_read_b128 a[196:199], v42 offset:32256
s_waitcnt vmcnt(9) lgkmcnt(5)
v_mfma_f32_16x16x32_bf16 v[16:19], a[160:163], a[0:3], v[16:19]
ds_read_b128 a[200:203], v38 offset:36864
v_mfma_f32_16x16x32_bf16 v[20:23], a[164:167], a[0:3], v[20:23]
ds_read_b128 a[204:207], v38 offset:37888
v_mfma_f32_16x16x32_bf16 v[24:27], a[168:171], a[0:3], v[24:27]
ds_read_b128 a[208:211], v38 offset:38912
v_mfma_f32_16x16x32_bf16 v[28:31], a[172:175], a[0:3], v[28:31]
ds_read_b128 a[212:215], v38 offset:39936
v_mfma_f32_16x16x32_bf16 v[32:35], a[176:179], a[0:3], v[32:35]
ds_read_b128 a[216:219], v42 offset:36864
s_waitcnt vmcnt(8) lgkmcnt(5)
v_mfma_f32_16x16x32_bf16 v[16:19], a[180:183], a[4:7], v[16:19]
ds_read_b128 a[160:163], v38 offset:41472
v_mfma_f32_16x16x32_bf16 v[20:23], a[184:187], a[4:7], v[20:23]
ds_read_b128 a[164:167], v38 offset:42496
v_mfma_f32_16x16x32_bf16 v[24:27], a[188:191], a[4:7], v[24:27]
ds_read_b128 a[168:171], v38 offset:43520
v_mfma_f32_16x16x32_bf16 v[28:31], a[192:195], a[4:7], v[28:31]
ds_read_b128 a[172:175], v38 offset:44544
v_mfma_f32_16x16x32_bf16 v[32:35], a[196:199], a[4:7], v[32:35]
ds_read_b128 a[176:179], v42 offset:41472
s_waitcnt vmcnt(7) lgkmcnt(5)
v_mfma_f32_16x16x32_bf16 v[16:19], a[200:203], a[8:11], v[16:19]
ds_read_b128 a[180:183], v38 offset:46080
v_mfma_f32_16x16x32_bf16 v[20:23], a[204:207], a[8:11], v[20:23]
ds_read_b128 a[184:187], v38 offset:47104
v_mfma_f32_16x16x32_bf16 v[24:27], a[208:211], a[8:11], v[24:27]
ds_read_b128 a[188:191], v38 offset:48128
v_mfma_f32_16x16x32_bf16 v[28:31], a[212:215], a[8:11], v[28:31]
ds_read_b128 a[192:195], v38 offset:49152
v_mfma_f32_16x16x32_bf16 v[32:35], a[216:219], a[8:11], v[32:35]
ds_read_b128 a[196:199], v42 offset:46080
s_waitcnt vmcnt(6) lgkmcnt(5)
v_mfma_f32_16x16x32_bf16 v[16:19], a[160:163], a[12:15], v[16:19]
ds_read_b128 a[200:203], v38 offset:50688
v_mfma_f32_16x16x32_bf16 v[20:23], a[164:167], a[12:15], v[20:23]
ds_read_b128 a[204:207], v38 offset:51712
v_mfma_f32_16x16x32_bf16 v[24:27], a[168:171], a[12:15], v[24:27]
v_mfma_f32_16x16x32_bf16 v[28:31], a[172:175], a[12:15], v[28:31]
v_mfma_f32_16x16x32_bf16 v[32:35], a[176:179], a[12:15], v[32:35]
s_waitcnt vmcnt(5) lgkmcnt(2)
v_mfma_f32_16x16x32_bf16 v[16:19], a[180:183], a[16:19], v[16:19]
v_mfma_f32_16x16x32_bf16 v[20:23], a[184:187], a[16:19], v[20:23]
v_mfma_f32_16x16x32_bf16 v[24:27], a[188:191], a[16:19], v[24:27]
v_mfma_f32_16x16x32_bf16 v[28:31], a[192:195], a[16:19], v[28:31]
v_mfma_f32_16x16x32_bf16 v[32:35], a[196:199], a[16:19], v[32:35]
s_waitcnt vmcnt(4) lgkmcnt(0)
v_mfma_f32_16x16x32_bf16 v[16:19], a[200:203], a[20:23], v[16:19]
s_waitcnt vmcnt(0)
v_xor_b32 v118, v248, v83
v_xor_b32 v119, v248, v87
v_xor_b32 v120, v248, v91
v_xor_b32 v121, v248, v95
v_mfma_f32_16x16x32_bf16 v[20:23], a[204:207], a[20:23], v[20:23]
v_or3_b32 v118, v118, v119, v120
v_or_b32 v118, v118, v121
v_cmp_ne_u32 vcc, 0, v118
s_nop 0
s_cbranch_vccnz L_xslow_36
L_xback_37:
v_mfma_f32_16x16x32_bf16 v[24:27], a[228:231], a[20:23], v[24:27]
v_lshlrev_b32 v96, 16, v80
v_and_b32 v97, 0xffff0000, v80
v_lshlrev_b32 v98, 16, v81
v_and_b32 v99, 0xffff0000, v81
v_lshlrev_b32 v100, 16, v82
v_and_b32 v101, 0xffff0000, v82
v_mfma_f32_16x16x32_bf16 v[28:31], a[232:235], a[20:23], v[28:31]
v_lshlrev_b32 v102, 16, v84
v_and_b32 v103, 0xffff0000, v84
v_lshlrev_b32 v104, 16, v85
v_and_b32 v105, 0xffff0000, v85
v_lshlrev_b32 v106, 16, v86
v_and_b32 v107, 0xffff0000, v86
v_mfma_f32_16x16x32_bf16 v[32:35], a[236:239], a[20:23], v[32:35]
v_lshlrev_b32 v108, 16, v88
v_and_b32 v109, 0xffff0000, v88
v_lshlrev_b32 v110, 16, v89
v_and_b32 v111, 0xffff0000, v89
v_lshlrev_b32 v112, 16, v90
v_and_b32 v113, 0xffff0000, v90
v_lshlrev_b32 v114, 16, v92
v_and_b32 v115, 0xffff0000, v92
s_nop 3
v_pk_add_f32 v[16:17], v[16:17], v[96:97]
v_pk_add_f32 v[18:19], v[18:19], v[98:99]
v_pk_add_f32 v[20:21], v[20:21], v[100:101]
v_pk_add_f32 v[22:23], v[22:23], v[102:103]
v_pk_add_f32 v[24:25], v[24:25], v[104:105]
v_pk_add_f32 v[26:27], v[26:27], v[106:107]
v_pk_add_f32 v[28:29], v[28:29], v[108:109]
v_pk_add_f32 v[30:31], v[30:31], v[110:111]
v_pk_add_f32 v[32:33], v[32:33], v[112:113]
v_pk_add_f32 v[34:35], v[34:35], v[114:115]
s_cmp_eq_u32 s29, 1
s_cbranch_scc1 L_last
v_pk_add_f32 v[142:143], v[16:17], v[18:19]
v_pk_mul_f32 v[144:145], v[16:17], v[16:17]
v_pk_fma_f32 v[144:145], v[18:19], v[18:19], v[144:145]
v_pk_add_f32 v[142:143], v[142:143], v[20:21]
v_pk_fma_f32 v[144:145], v[20:21], v[20:21], v[144:145]
v_pk_add_f32 v[142:143], v[142:143], v[22:23]
v_pk_fma_f32 v[144:145], v[22:23], v[22:23], v[144:145]
v_pk_add_f32 v[142:143], v[142:143], v[24:25]
v_pk_fma_f32 v[144:145], v[24:25], v[24:25], v[144:145]
v_pk_add_f32 v[142:143], v[142:143], v[26:27]
v_pk_fma_f32 v[144:145], v[26:27], v[26:27], v[144:145]
v_pk_add_f32 v[142:143], v[142:143], v[28:29]
v_pk_fma_f32 v[144:145], v[28:29], v[28:29], v[144:145]
v_pk_add_f32 v[142:143], v[142:143], v[30:31]
v_pk_fma_f32 v[144:145], v[30:31], v[30:31], v[144:145]
s_mov_b32 exec_hi, 0
v_pk_add_f32 v[142:143], v[142:143], v[32:33]
v_pk_fma_f32 v[144:145], v[32:33], v[32:33], v[144:145]
v_pk_add_f32 v[142:143], v[142:143], v[34:35]
v_pk_fma_f32 v[144:145], v[34:35], v[34:35], v[144:145]
s_mov_b64 exec, -1
v_add_f32 v136, v142, v143
v_add_f32 v137, v144, v145
v_cvt_pk_bf16_f32 v132, v32, v33
v_cvt_pk_bf16_f32 v133, v34, v35
v_permlane32_swap_b32 v136, v137
v_add_f32 v136, v136, v137
v_mov_b32 v137, v136
v_cvt_pk_bf16_f32 v124, v16, v17
v_cvt_pk_bf16_f32 v125, v18, v19
v_permlane16_swap_b32 v136, v137
v_add_f32 v136, v136, v137
v_mov_b32 v137, v136
v_cvt_pk_bf16_f32 v126, v20, v21
v_cvt_pk_bf16_f32 v127, v22, v23
v_permlane32_swap_b32 v136, v137
buffer_store_dwordx4 v[124:127], v140, s[8:11], s66 offen sc1
buffer_store_dwordx2 v[136:137], v138, s[8:11], s67 offen sc1
v_cvt_pk_bf16_f32 v128, v24, v25
v_cvt_pk_bf16_f32 v129, v26, v27
v_cvt_pk_bf16_f32 v130, v28, v29
v_cvt_pk_bf16_f32 v131, v30, v31
v_permlane16_swap_b32 v132, v134
v_permlane16_swap_b32 v133, v135
buffer_store_dwordx4 v[128:131], v140, s[8:11], s66 offen offset:1024 sc1
buffer_store_dwordx4 v[132:135], v141, s[8:11], s66 offen sc1
s_barrier
s_mul_i32 s36, s26, 132608
s_mul_i32 s38, s24, 12288
s_add_u32 m0, s38, 0
s_add_u32 s39, s38, s36
buffer_load_dwordx4 v1, s[4:7], s39 offen offset:0 sc1 lds
buffer_load_dwordx4 v1, s[4:7], s39 offen offset:1024 sc1 lds
buffer_load_dwordx4 v1, s[4:7], s39 offen offset:2048 sc1 lds
buffer_load_dwordx4 v1, s[4:7], s39 offen offset:3072 sc1 lds
s_add_u32 m0, m0, 4096
s_add_u32 s39, s39, 4096
buffer_load_dwordx4 v1, s[4:7], s39 offen offset:0 sc1 lds
buffer_load_dwordx4 v1, s[4:7], s39 offen offset:1024 sc1 lds
buffer_load_dwordx4 v1, s[4:7], s39 offen offset:2048 sc1 lds
buffer_load_dwordx4 v1, s[4:7], s39 offen offset:3072 sc1 lds
s_and_b32 s33, s27, 1
s_cmp_lt_u32 s27, 31
s_cselect_b32 s33, s33, 0
s_cmp_eq_u32 s33, 1
s_cselect_b32 s34, -1, 0xffff
s_mov_b32 s35, 0
v_lshlrev_b32 v7, 3, v1
s_lshr_b32 s31, s81, 4
s_lshl_b32 s31, s31, 11
v_add_u32 v7, s31, v7
s_cmp_eq_u32 s24, 0
s_cselect_b32 s30, 0, 1073741824
s_add_u32 s30, s30, 26607616
s_waitcnt vmcnt(8)
s_barrier
s_mov_b64 exec, s[34:35]
buffer_atomic_add v4, v7, s[8:11], s30 offen sc1
s_mov_b64 exec, -1
s_cmp_eq_u32 s29, 1
s_cbranch_scc1 L_main_fin
s_cmp_eq_u32 s25, 0
s_cselect_b32 s34, 16, 24
s_lshl_b32 s35, s80, 7
s_add_u32 s35, s35, 26607616
s_cmp_eq_u32 s24, 1
s_cselect_b32 s35, s35, 1073741824
v_mov_b32 v6, 0
s_add_u32 m0, m0, 4096
s_add_u32 s39, s39, 4096
buffer_load_dwordx4 v1, s[4:7], s39 offen offset:0 sc1 lds
buffer_load_dwordx4 v1, s[4:7], s39 offen offset:1024 sc1 lds
buffer_load_dwordx4 v1, s[4:7], s39 offen offset:2048 sc1 lds
buffer_load_dwordx4 v1, s[4:7], s39 offen offset:3072 sc1 lds
s_mul_i32 s36, s26, 132608
s_mul_i32 s38, s24, 9216
s_add_u32 m0, s38, 49152
s_add_u32 s39, s38, s36
s_add_u32 s39, s39, 49152
v_mov_b32 v244, 0
s_mov_b64 exec, 1
buffer_atomic_add v244, v6, s[8:11], s35 offen sc0 sc1
s_mov_b64 exec, -1
buffer_load_dwordx4 v1, s[4:7], s39 offen offset:0 sc1 lds
buffer_load_dwordx4 v1, s[4:7], s39 offen offset:1024 sc1 lds
buffer_load_dwordx4 v1, s[4:7], s39 offen offset:2048 sc1 lds
v_mov_b32 v245, 0
s_mov_b64 exec, 1
buffer_atomic_add v245, v6, s[8:11], s35 offen sc0 sc1
s_mov_b64 exec, -1
buffer_load_dwordx4 v1, s[4:7], s39 offen offset:3072 sc1 lds
s_add_u32 m0, m0, 4096
s_add_u32 s39, s39, 4096
buffer_load_dwordx4 v1, s[4:7], s39 offen offset:0 sc1 lds
buffer_load_dwordx4 v1, s[4:7], s39 offen offset:1024 sc1 lds
v_mov_b32 v246, 0
s_mov_b64 exec, 1
buffer_atomic_add v246, v6, s[8:11], s35 offen sc0 sc1
s_mov_b64 exec, -1
buffer_load_dwordx4 v1, s[4:7], s39 offen offset:2048 sc1 lds
buffer_load_dwordx4 v1, s[4:7], s39 offen offset:3072 sc1 lds
s_add_u32 m0, m0, 4096
s_add_u32 s39, s39, 4096
buffer_load_dwordx4 v1, s[4:7], s39 offen offset:0 sc1 lds
s_lshl_b32 s60, s25, 3
s_sub_u32 s61, s60, 1
s_max_i32 s61, s61, 0
s_lshl_b32 s30, s24, 1
s_add_u32 s60, s60, s30
s_mul_i32 s30, s61, 18432
s_mul_i32 s62, s60, 18432
v_add_u32 v237, 18432, v1
s_mul_i32 s38, s24, 5120
s_add_u32 m0, s38, 135168
s_add_u32 s39, s38, s30
s_cmp_eq_u32 s24, 1
s_cbranch_scc0 L_other_41
s_mov_b32 s31, 0
s_mov_b64 exec, 1
v_mov_b32 v247, 0
buffer_atomic_add v247, v6, s[8:11], s35 offen sc0 sc1
s_waitcnt vmcnt(12)
v_cmp_gt_u32 vcc, s34, v244
s_nop 0
s_cbranch_vccz L_polled_40
s_waitcnt vmcnt(8)
v_cmp_gt_u32 vcc, s34, v245
s_nop 0
s_cbranch_vccz L_polled_40
v_mov_b32 v244, 0
buffer_atomic_add v244, v6, s[8:11], s35 offen sc0 sc1
s_waitcnt vmcnt(5)
v_cmp_gt_u32 vcc, s34, v246
s_nop 0
s_cbranch_vccz L_polled_40
v_mov_b32 v245, 0
buffer_atomic_add v245, v6, s[8:11], s35 offen sc0 sc1
L_poll_39:
s_add_u32 s31, s31, 1
s_cmp_gt_u32 s31, 100000
s_cbranch_scc1 L_polled_40
v_mov_b32 v246, 0
buffer_atomic_add v246, v6, s[8:11], s35 offen sc0 sc1
s_waitcnt vmcnt(3)
v_cmp_gt_u32 vcc, s34, v247
s_nop 0
s_cbranch_vccz L_polled_40
v_mov_b32 v247, 0
buffer_atomic_add v247, v6, s[8:11], s35 offen sc0 sc1
s_waitcnt vmcnt(3)
v_cmp_gt_u32 vcc, s34, v244
s_nop 0
s_cbranch_vccz L_polled_40
v_mov_b32 v244, 0
buffer_atomic_add v244, v6, s[8:11], s35 offen sc0 sc1
s_waitcnt vmcnt(3)
v_cmp_gt_u32 vcc, s34, v245
s_nop 0
s_cbranch_vccz L_polled_40
v_mov_b32 v245, 0
buffer_atomic_add v245, v6, s[8:11], s35 offen sc0 sc1
s_waitcnt vmcnt(3)
v_cmp_gt_u32 vcc, s34, v246
s_nop 0
s_cbranch_vccz L_polled_40
s_branch L_poll_39
L_polled_40:
s_mov_b64 exec, -1
L_other_41:
s_barrier
s_mov_b32 s29, 1
s_add_u32 s8, s8, 30834688
s_addc_u32 s9, s9, 0
s_mov_b32 s10, 30834688
s_branch L_layer
L_last:
v_cvt_pk_bf16_f32 v148, v16, v17
v_cvt_pk_bf16_f32 v149, v18, v19
v_cvt_pk_bf16_f32 v150, v20, v21
v_cvt_pk_bf16_f32 v151, v22, v23
v_cvt_pk_bf16_f32 v152, v24, v25
v_cvt_pk_bf16_f32 v153, v26, v27
v_cvt_pk_bf16_f32 v154, v28, v29
v_cvt_pk_bf16_f32 v155, v30, v31
v_cvt_pk_bf16_f32 v156, v32, v33
v_cvt_pk_bf16_f32 v157, v34, v35
buffer_store_dwordx4 v[148:151], v164, s[16:19], s68 offen
buffer_store_dwordx4 v[152:155], v164, s[16:19], s68 offen offset:64
v_permlane16_swap_b32 v156, v158
v_permlane16_swap_b32 v157, v159
buffer_store_dwordx4 v[156:159], v165, s[16:19], s68 offen
L_main_fin:
L_main_end:
s_endpgm
L_tagslow_1:
buffer_load_dwordx2 v[238:239], v48, s[84:87], 0 offen sc1
s_add_u32 s31, s31, 1
s_waitcnt vmcnt(0)
v_cmp_eq_u32 vcc, 0, v238
s_cmp_gt_u32 s31, 200000
s_cbranch_scc1 L_tagback_2
s_cbranch_vccnz L_tagslow_1
s_branch L_tagback_2
L_dbslow_11:
s_mov_b32 s67, 0
L_dbslow_11x:
buffer_load_dwordx2 v[148:149], v146, s[4:7], s66 offen sc1
s_add_u32 s67, s67, 1
s_waitcnt vmcnt(0)
v_cmp_ne_u64 vcc, v[148:149], v[238:239]
s_cmp_gt_u32 s67, 200000
s_cbranch_scc1 L_dbback_12
s_cbranch_vccnz L_dbslow_11x
s_branch L_dbback_12
L_stzslow_23:
s_mov_b32 s31, 0
L_stzloop_25:
buffer_load_dwordx2 v[182:183], v234, s[8:11], s61 offen offset:0 sc1
buffer_load_dwordx2 v[184:185], v234, s[8:11], s61 offen offset:1024 sc1
buffer_load_dwordx2 v[186:187], v234, s[8:11], s61 offen offset:2048 sc1
buffer_load_dwordx2 v[188:189], v234, s[8:11], s61 offen offset:3072 sc1
buffer_load_dwordx2 v[190:191], v235, s[8:11], s61 offen offset:0 sc1
buffer_load_dwordx2 v[192:193], v235, s[8:11], s61 offen offset:1024 sc1
buffer_load_dwordx2 v[194:195], v235, s[8:11], s61 offen offset:2048 sc1
buffer_load_dwordx2 v[196:197], v235, s[8:11], s61 offen offset:3072 sc1
s_add_u32 s31, s31, 1
s_waitcnt vmcnt(0)
v_min3_f32 v200, v183, v185, v187
v_min3_f32 v201, v189, v191, v193
v_min3_f32 v200, v200, v195, v197
v_min_f32 v200, v200, v201
v_cmp_gt_f32 vcc, 0, v200
s_cmp_gt_u32 s31, 200000
s_cbranch_scc1 L_stzback_24
s_cbranch_vccnz L_stzloop_25
s_branch L_stzback_24
L_xslow_36:
s_mov_b32 s31, 0
L_xloop_38:
buffer_load_dwordx4 v[80:83], v1, s[8:11], s63 offen offset:0 sc1
buffer_load_dwordx4 v[84:87], v1, s[8:11], s63 offen offset:1024 sc1
buffer_load_dwordx4 v[88:91], v1, s[8:11], s63 offen offset:2048 sc1
buffer_load_dwordx4 v[92:95], v1, s[8:11], s63 offen offset:3072 sc1
s_add_u32 s31, s31, 1
s_waitcnt vmcnt(0)
v_xor_b32 v118, v248, v83
v_xor_b32 v119, v248, v87
v_xor_b32 v120, v248, v91
v_xor_b32 v121, v248, v95
v_or3_b32 v118, v118, v119, v120
v_or_b32 v118, v118, v121
v_cmp_ne_u32 vcc, 0, v118
s_cmp_gt_u32 s31, 200000
s_cbranch_scc1 L_xback_37
s_cbranch_vccnz L_xloop_38
s_branch L_xback_37
L_code_end:
.section .rodata,"a"
.p2align 6
.amdhsa_kernel main_kernel
  .amdhsa_next_free_vgpr 512
  .amdhsa_next_free_sgpr 102
  .amdhsa_accum_offset 256
  .amdhsa_group_segment_fixed_size 0
  .amdhsa_kernarg_size 88
  .amdhsa_user_sgpr_count 2
  .amdhsa_user_sgpr_kernarg_segment_ptr 1
  .amdhsa_system_sgpr_workgroup_id_x 1
  .amdhsa_float_denorm_mode_32 3
.end_amdhsa_kernel
```

```asm
; @launch kernel=main_kernel grid=(256,1,1) block=(256,1,1) lds=163840
.amdgcn_target "amdgcn-amd-amdhsa--gfx950"
.text
.globl main_kernel
.p2align 8
.type main_kernel,@function
main_kernel:
s_cmp_ge_u32 s2, 256
s_cbranch_scc1 L_main_end
s_load_dwordx16 s[64:79], s[0:1], 0
s_memrealtime s[96:97]
s_load_dwordx2 s[4:5], s[0:1], 80
s_load_dwordx2 s[16:17], s[0:1], 64
s_load_dwordx2 s[84:85], s[0:1], 72
v_lshrrev_b32 v6, 6, v0
v_and_b32 v0, 63, v0
v_readfirstlane_b32 s24, v6
v_lshlrev_b32 v1, 4, v0
v_and_b32 v2, 15, v0
v_lshrrev_b32 v3, 4, v0
v_cmp_gt_u32 s[50:51], 2, v3
s_nop 0
s_cmp_lt_u32 s2, 128
s_cbranch_scc1 L_p0_x1
s_mov_b32 s14, 1990656
s_mov_b32 s15, 0x20000
s_sub_u32 s30, s2, 128
s_cmp_lt_u32 s30, 108
s_cselect_b32 s62, 0, 1073741824
s_cselect_b32 s30, s30, 0
s_and_b32 s60, s30, 3
s_lshr_b32 s61, s30, 2
s_mul_i32 s30, s60, 497664
s_lshl_b32 s31, s61, 7
s_add_u32 s30, s30, s31
s_mul_i32 s31, s24, 27648
s_add_u32 s30, s30, s31
s_add_u32 s30, s30, s62
v_lshrrev_b32 v36, 7, v1
v_mul_u32_u24 v42, 3456, v36
v_and_b32 v36, 0x70, v1
v_add_u32 v42, v36, v42
s_lshl_b32 s32, s24, 10
s_waitcnt lgkmcnt(0)
s_mov_b32 s12, s66
s_mov_b32 s13, s67
s_add_u32 m0, s32, 0
s_add_u32 s31, s30, 0
buffer_load_dwordx4 v42, s[12:15], s31 offen nt lds
s_add_u32 m0, s32, 4096
s_add_u32 s31, s30, 110592
buffer_load_dwordx4 v42, s[12:15], s31 offen nt lds
s_add_u32 m0, s32, 8192
s_add_u32 s31, s30, 221184
buffer_load_dwordx4 v42, s[12:15], s31 offen nt lds
s_add_u32 m0, s32, 12288
s_add_u32 s31, s30, 331776
buffer_load_dwordx4 v42, s[12:15], s31 offen nt lds
s_add_u32 m0, s32, 16384
s_add_u32 s31, s30, 442368
s_cmp_lt_u32 s24, 2
s_cselect_b32 s31, s31, 1073741824
buffer_load_dwordx4 v42, s[12:15], s31 offen nt lds
s_branch L_p0_j1
L_p0_x1:
s_mov_b32 s14, 2359296
s_mov_b32 s15, 0x20000
s_mul_i32 s30, s24, 18
v_add_u32 v36, s30, v3
v_mul_u32_u24 v42, 1152, v2
v_lshl_add_u32 v42, v36, 4, v42
s_mul_i32 s30, s2, 18432
v_mov_b32 v37, 1073741824
v_cndmask_b32 v37, v37, v42, s[50:51]
s_waitcnt lgkmcnt(0)
s_mov_b32 s12, s64
s_mov_b32 s13, s65
buffer_load_dwordx4 v[64:67], v42, s[12:15], s30 offen offset:0
buffer_load_dwordx4 v[68:71], v42, s[12:15], s30 offen offset:64
buffer_load_dwordx4 v[72:75], v42, s[12:15], s30 offen offset:128
buffer_load_dwordx4 v[76:79], v42, s[12:15], s30 offen offset:192
buffer_load_dwordx4 v[80:83], v37, s[12:15], s30 offen offset:256
L_p0_j1:
v_mov_b32 v4, 1
v_mov_b32 v5, 0
s_mov_b32 s56, 0
s_mov_b32 s29, 0
v_add_u32 v9, 66560, v1
v_cmp_eq_u32 s[46:47], 0, v3
v_cmp_eq_u32 s[48:49], 2, v3
s_mov_b32 s6, 19451904
s_mov_b32 s7, 0x20000
s_mov_b32 s10, 61669376
s_mov_b32 s11, 0x20000
s_mov_b32 s18, 2359296
s_mov_b32 s19, 0x20000
s_mov_b32 s22, 4096
s_mov_b32 s23, 0x20000
s_mov_b32 s86, 256
s_mov_b32 s87, 0x20000
s_and_b32 s30, s2, 7
s_lshr_b32 s31, s2, 3
s_lshr_b32 s32, s31, 2
s_and_b32 s33, s31, 3
s_lshr_b32 s25, s30, 2
s_lshl_b32 s25, s25, 3
s_add_u32 s25, s25, s32
s_and_b32 s26, s30, 3
s_lshl_b32 s26, s26, 2
s_add_u32 s26, s26, s33
s_lshr_b32 s27, s30, 1
s_lshl_b32 s27, s27, 3
s_add_u32 s27, s27, s32
s_and_b32 s28, s30, 1
s_lshl_b32 s28, s28, 2
s_add_u32 s28, s28, s33
s_lshr_b32 s27, s30, 1
s_lshl_b32 s27, s27, 2
s_lshr_b32 s32, s31, 3
s_add_u32 s27, s27, s32
s_lshl_b32 s27, s27, 1
s_and_b32 s32, s30, 1
s_add_u32 s27, s27, s32
s_and_b32 s28, s31, 7
s_lshl_b32 s80, s25, 4
s_add_u32 s80, s80, s26
s_lshl_b32 s81, s27, 3
s_add_u32 s81, s81, s28
s_getpc_b64 s[88:89]
L_pc:
s_mov_b32 s90, L_code_end-L_pc
s_mov_b32 s91, 0x20000
s_lshl_b32 s31, s31, 10
s_lshl_b32 s32, s24, 8
s_add_u32 s31, s31, s32
v_lshrrev_b32 v14, 2, v1
v_add_u32 v14, s31, v14
s_add_u32 s8, s4, 19451904
s_addc_u32 s9, s5, 0
s_mov_b32 s20, s76
s_mov_b32 s21, s77
s_or_b32 s30, s2, s24
s_cmp_eq_u32 s30, 0
s_cselect_b32 s30, 0, 1073741824
v_mov_b32 v48, 0
s_or_b32 s96, s96, 1
v_mov_b32 v238, s96
v_mov_b32 v239, s97
s_mov_b64 exec, 1
buffer_store_dwordx2 v[238:239], v48, s[84:87], s30 offen sc1
s_mov_b64 exec, -1
s_mov_b32 s37, L_pc-L_pc
buffer_load_dword v15, v14, s[88:91], s37 offen
s_mov_b32 s37, L_pc+32768-L_pc
buffer_load_dword v15, v14, s[88:91], s37 offen
v_lshrrev_b32 v36, 2, v2
v_lshl_add_u32 v36, v3, 3, v36
v_lshlrev_b32 v45, 7, v36
v_and_b32 v36, 3, v2
v_lshl_add_u32 v45, v36, 3, v45
s_lshl_b32 s31, s24, 5
v_add_u32 v45, s31, v45
v_mov_b32 v164, 3212836864
v_mov_b32 v165, 3212836864
v_mov_b32 v166, 3212836864
v_mov_b32 v167, 3212836864
s_lshl_b32 s30, s80, 10
s_lshl_b32 s31, s24, 8
s_add_u32 s30, s30, s31
s_add_u32 s30, s30, 26214400
s_mov_b32 s31, 30834688
v_mul_lo_u32 v36, v3, s31
v_lshl_add_u32 v37, v2, 4, v36
s_mov_b32 exec_hi, 0
buffer_store_dwordx4 v[164:167], v37, s[8:11], s30 offen sc1
s_mov_b64 exec, -1
v_lshl_add_u32 v37, v2, 15, v36
s_lshl_b32 s30, s2, 7
s_add_u32 s30, s30, 26476544
s_cmp_eq_u32 s24, 0
s_cselect_b32 s30, s30, 1073741824
s_mov_b64 exec, 0x001f001f
buffer_store_dword v48, v37, s[8:11], s30 offen sc1
s_mov_b64 exec, -1
s_cmp_lt_u32 s2, 128
s_cbranch_scc1 L_p0_x2
s_mul_i32 s92, s61, 29
s_lshr_b32 s92, s92, 8
s_mul_i32 s33, s92, 9
s_sub_u32 s33, s61, s33
s_lshl_b32 s33, s33, 6
s_lshl_b32 s31, s24, 4
s_add_u32 s33, s33, s31
v_add_u32 v36, s33, v2
v_mul_u32_u24 v37, 911, v36
v_lshrrev_b32 v37, 14, v37
v_mul_u32_u24 v38, 18, v37
v_sub_u32 v36, v36, v38
v_and_b32 v38, 1, v37
v_lshrrev_b32 v37, 1, v37
s_mov_b32 s31, 132608
v_mul_lo_u32 v37, v37, s31
s_cmp_eq_u32 s92, 0
s_cselect_b32 s93, 5, 0
s_cselect_b32 s94, 8, 4
s_cmp_eq_u32 s92, 2
s_cselect_b32 s93, 2, s93
s_cselect_b32 s94, 0, s94
s_sub_u32 s94, s94, 16
v_add_u32 v39, s93, v38
v_lshl_add_u32 v40, v38, 1, v36
v_add_u32 v40, s94, v40
v_cmp_gt_u32 vcc, 16, v36
s_nop 1
v_cndmask_b32 v39, 4, v39, vcc
v_cndmask_b32 v40, v40, v36, vcc
v_lshl_add_u32 v43, v39, 10, v37
v_lshl_add_u32 v43, v40, 4, v43
v_lshl_add_u32 v44, v39, 9, v37
v_lshl_add_u32 v44, v40, 3, v44
s_lshl_b32 s31, s60, 7
s_add_u32 s31, s31, 129024
v_add_u32 v44, s31, v44
s_mul_i32 s31, s60, 18
v_add_u32 v37, s31, v3
v_and_b32 v38, 3, v37
v_lshrrev_b32 v37, 2, v37
v_mul_u32_u24 v37, 7168, v37
v_add_u32 v43, v43, v37
v_lshl_add_u32 v43, v38, 8, v43
s_waitcnt vmcnt(5)
s_barrier
ds_read_b64_tr_b16 v[64:65], v45 offset:0
ds_read_b64_tr_b16 v[66:67], v45 offset:512
ds_read_b64_tr_b16 v[68:69], v45 offset:4096
ds_read_b64_tr_b16 v[70:71], v45 offset:4608
ds_read_b64_tr_b16 v[72:73], v45 offset:8192
ds_read_b64_tr_b16 v[74:75], v45 offset:8704
ds_read_b64_tr_b16 v[76:77], v45 offset:12288
ds_read_b64_tr_b16 v[78:79], v45 offset:12800
ds_read_b64_tr_b16 v[80:81], v45 offset:16384
ds_read_b64_tr_b16 v[82:83], v45 offset:16896
v_mov_b32 v36, 1073741824
v_mov_b32 v46, 0
v_cndmask_b32 v37, v36, v43, s[50:51]
s_add_u32 s31, s62, 0
s_waitcnt lgkmcnt(8)
buffer_store_dwordx4 v[64:67], v43, s[4:7], s31 offen sc1
s_add_u32 s31, s62, 7168
s_waitcnt lgkmcnt(6)
buffer_store_dwordx4 v[68:71], v43, s[4:7], s31 offen sc1
s_add_u32 s31, s62, 14336
s_waitcnt lgkmcnt(4)
buffer_store_dwordx4 v[72:75], v43, s[4:7], s31 offen sc1
s_add_u32 s31, s62, 21504
s_waitcnt lgkmcnt(2)
buffer_store_dwordx4 v[76:79], v43, s[4:7], s31 offen sc1
s_add_u32 s31, s62, 28672
s_waitcnt lgkmcnt(0)
buffer_store_dwordx4 v[80:83], v37, s[4:7], s31 offen sc1
v_mov_b32 v37, 0x3f803f80
v_dot2c_f32_bf16 v46, v64, v37
v_dot2c_f32_bf16 v46, v65, v37
v_dot2c_f32_bf16 v46, v66, v37
v_dot2c_f32_bf16 v46, v67, v37
v_dot2c_f32_bf16 v46, v68, v37
v_dot2c_f32_bf16 v46, v69, v37
v_dot2c_f32_bf16 v46, v70, v37
v_dot2c_f32_bf16 v46, v71, v37
v_dot2c_f32_bf16 v46, v72, v37
v_dot2c_f32_bf16 v46, v73, v37
v_dot2c_f32_bf16 v46, v74, v37
v_dot2c_f32_bf16 v46, v75, v37
v_dot2c_f32_bf16 v46, v76, v37
v_dot2c_f32_bf16 v46, v77, v37
v_dot2c_f32_bf16 v46, v78, v37
v_dot2c_f32_bf16 v46, v79, v37
v_dot2c_f32_bf16 v46, v80, v37
v_dot2c_f32_bf16 v46, v81, v37
v_dot2c_f32_bf16 v46, v82, v37
v_dot2c_f32_bf16 v46, v83, v37
s_nop 2
v_mov_b32 v37, v46
s_nop 1
v_permlane32_swap_b32 v46, v37
v_add_f32 v46, v46, v37
v_mov_b32 v37, v46
s_nop 1
v_permlane16_swap_b32 v46, v37
v_add_f32 v46, v46, v37
v_cvt_pk_bf16_f32 v50, v46, v46
v_and_b32 v37, 0xffff0000, v50
v_sub_f32 v37, v46, v37
v_cvt_pk_bf16_f32 v51, v37, v37
v_cndmask_b32 v36, v36, v44, s[46:47]
buffer_store_dwordx2 v[50:51], v36, s[4:7], s62 offen sc1
s_branch L_p0_j2
L_p0_x2:
s_mul_i32 s30, s24, 4608
s_mul_i32 s31, s2, 18432
s_add_u32 s31, s31, s30
s_add_u32 s31, s31, 0
v_mov_b32 v36, 1073741824
v_add_u32 v38, 4096, v1
v_cndmask_b32 v38, v36, v38, s[50:51]
v_mov_b32 v46, 0
v_mov_b32 v47, 0
v_mov_b32 v39, 0x3f803f80
s_waitcnt vmcnt(5)
buffer_store_dwordx4 v[64:67], v1, s[8:11], s31 offen offset:0 sc1
buffer_store_dwordx4 v[68:71], v1, s[8:11], s31 offen offset:1024 sc1
buffer_store_dwordx4 v[72:75], v1, s[8:11], s31 offen offset:2048 sc1
buffer_store_dwordx4 v[76:79], v1, s[8:11], s31 offen offset:3072 sc1
buffer_store_dwordx4 v[80:83], v38, s[8:11], s31 offen offset:0 sc1
v_dot2c_f32_bf16 v46, v64, v39
v_dot2c_f32_bf16 v46, v65, v39
v_dot2c_f32_bf16 v46, v66, v39
v_dot2c_f32_bf16 v46, v67, v39
v_dot2c_f32_bf16 v46, v68, v39
v_dot2c_f32_bf16 v46, v69, v39
v_dot2c_f32_bf16 v46, v70, v39
v_dot2c_f32_bf16 v46, v71, v39
v_dot2c_f32_bf16 v46, v72, v39
v_dot2c_f32_bf16 v46, v73, v39
v_dot2c_f32_bf16 v46, v74, v39
v_dot2c_f32_bf16 v46, v75, v39
v_dot2c_f32_bf16 v46, v76, v39
v_dot2c_f32_bf16 v46, v77, v39
v_dot2c_f32_bf16 v46, v78, v39
v_dot2c_f32_bf16 v46, v79, v39
v_dot2c_f32_bf16 v46, v80, v39
v_dot2c_f32_bf16 v46, v81, v39
v_dot2c_f32_bf16 v46, v82, v39
v_dot2c_f32_bf16 v46, v83, v39
v_dot2c_f32_bf16 v47, v64, v64
v_dot2c_f32_bf16 v47, v65, v65
v_dot2c_f32_bf16 v47, v66, v66
v_dot2c_f32_bf16 v47, v67, v67
v_dot2c_f32_bf16 v47, v68, v68
v_dot2c_f32_bf16 v47, v69, v69
v_dot2c_f32_bf16 v47, v70, v70
v_dot2c_f32_bf16 v47, v71, v71
v_dot2c_f32_bf16 v47, v72, v72
v_dot2c_f32_bf16 v47, v73, v73
v_dot2c_f32_bf16 v47, v74, v74
v_dot2c_f32_bf16 v47, v75, v75
v_dot2c_f32_bf16 v47, v76, v76
v_dot2c_f32_bf16 v47, v77, v77
v_dot2c_f32_bf16 v47, v78, v78
v_dot2c_f32_bf16 v47, v79, v79
v_dot2c_f32_bf16 v47, v80, v80
v_dot2c_f32_bf16 v47, v81, v81
v_dot2c_f32_bf16 v47, v82, v82
v_dot2c_f32_bf16 v47, v83, v83
v_mov_b32 v37, v46
s_nop 1
v_permlane32_swap_b32 v46, v37
v_add_f32 v46, v46, v37
v_mov_b32 v37, v46
s_nop 1
v_permlane16_swap_b32 v46, v37
v_add_f32 v46, v46, v37
v_mov_b32 v37, v47
s_nop 1
v_permlane32_swap_b32 v47, v37
v_add_f32 v47, v47, v37
v_mov_b32 v37, v47
s_nop 1
v_permlane16_swap_b32 v47, v37
v_add_f32 v47, v47, v37
s_lshl_b32 s30, s2, 7
s_lshl_b32 s31, s24, 14
s_add_u32 s30, s30, s31
s_add_u32 s30, s30, 2359296
v_cndmask_b32 v50, 0, v46, s[46:47]
v_cndmask_b32 v51, 0, v47, s[46:47]
v_lshlrev_b32 v37, 3, v2
v_lshl_add_u32 v37, v3, 16, v37
v_cndmask_b32 v37, v36, v37, s[50:51]
buffer_store_dwordx2 v[50:51], v37, s[8:11], s30 offen sc1
L_p0_j2:
buffer_load_dwordx2 v[238:239], v48, s[84:87], 0 offen sc1
s_mov_b32 s14, 5308416
s_mov_b32 s15, 0x20000
s_sub_u32 s30, s2, 0
s_cmp_lt_u32 s30, 256
s_cselect_b32 s36, 0, 1073741824
s_cselect_b32 s30, s30, 0
s_and_b32 s34, s30, 3
s_lshr_b32 s35, s30, 2
s_mul_i32 s30, s34, 1327104
s_lshl_b32 s31, s35, 7
s_add_u32 s30, s30, s31
s_mul_i32 s31, s24, 73728
s_add_u32 s30, s30, s31
s_add_u32 s30, s30, s36
v_lshrrev_b32 v36, 7, v1
v_mul_u32_u24 v42, 9216, v36
v_and_b32 v36, 0x70, v1
v_add_u32 v42, v36, v42
s_lshl_b32 s32, s24, 10
s_mov_b32 s12, s72
s_mov_b32 s13, s73
s_add_u32 m0, s32, 20480
s_add_u32 s31, s30, 0
buffer_load_dwordx4 v42, s[12:15], s31 offen nt lds
s_add_u32 m0, s32, 24576
s_add_u32 s31, s30, 294912
buffer_load_dwordx4 v42, s[12:15], s31 offen nt lds
s_add_u32 m0, s32, 28672
s_add_u32 s31, s30, 589824
buffer_load_dwordx4 v42, s[12:15], s31 offen nt lds
s_add_u32 m0, s32, 32768
s_add_u32 s31, s30, 884736
buffer_load_dwordx4 v42, s[12:15], s31 offen nt lds
s_add_u32 m0, s32, 36864
s_add_u32 s31, s30, 1179648
s_cmp_lt_u32 s24, 2
s_cselect_b32 s31, s31, 1073741824
buffer_load_dwordx4 v42, s[12:15], s31 offen nt lds
s_lshl_b32 s30, s2, 7
s_add_u32 s30, s30, 19415040
s_lshl_b32 s32, s2, 3
s_add_u32 s32, s32, 19447808
s_cmp_eq_u32 s24, 0
s_cselect_b32 s30, s30, 1073741824
s_cselect_b32 s100, s32, 1073741824
s_waitcnt vmcnt(5)
v_cmp_eq_u32 vcc, 0, v238
s_mov_b32 s31, 0
s_cbranch_vccnz L_tagslow_1
L_tagback_2:
s_barrier
s_mov_b64 exec, 1
buffer_store_dwordx2 v[238:239], v48, s[4:7], s30 offen sc1
s_mov_b64 exec, -1
s_cmp_lt_u32 s2, 32
s_cbranch_scc1 L_p0_a3
s_cmp_lt_u32 s2, 176
s_cbranch_scc1 L_p0_b3
s_mov_b32 s14, 663552
s_mov_b32 s15, 0x20000
s_sub_u32 s30, s2, 176
s_cmp_lt_u32 s30, 36
s_cselect_b32 s53, 0, 1073741824
s_cselect_b32 s30, s30, 0
s_and_b32 s37, s30, 3
s_lshr_b32 s52, s30, 2
s_mul_i32 s30, s37, 165888
s_lshl_b32 s31, s52, 7
s_add_u32 s30, s30, s31
s_mul_i32 s31, s24, 9216
s_add_u32 s30, s30, s31
s_add_u32 s30, s30, s53
v_lshrrev_b32 v36, 7, v1
v_mul_u32_u24 v42, 1152, v36
v_and_b32 v36, 0x70, v1
v_add_u32 v42, v36, v42
s_lshl_b32 s32, s24, 10
s_mov_b32 s12, s68
s_mov_b32 s13, s69
s_add_u32 m0, s32, 40960
s_add_u32 s31, s30, 0
buffer_load_dwordx4 v42, s[12:15], s31 offen nt lds
s_add_u32 m0, s32, 45056
s_add_u32 s31, s30, 36864
buffer_load_dwordx4 v42, s[12:15], s31 offen nt lds
s_add_u32 m0, s32, 49152
s_add_u32 s31, s30, 73728
buffer_load_dwordx4 v42, s[12:15], s31 offen nt lds
s_add_u32 m0, s32, 53248
s_add_u32 s31, s30, 110592
buffer_load_dwordx4 v42, s[12:15], s31 offen nt lds
s_add_u32 m0, s32, 57344
s_add_u32 s31, s30, 147456
s_cmp_lt_u32 s24, 2
s_cselect_b32 s31, s31, 1073741824
buffer_load_dwordx4 v42, s[12:15], s31 offen nt lds
s_branch L_p0_j3
L_p0_b3:
s_mov_b32 s14, 2654208
s_mov_b32 s15, 0x20000
s_sub_u32 s30, s2, 32
s_cmp_lt_u32 s30, 144
s_cselect_b32 s53, 0, 1073741824
s_cselect_b32 s30, s30, 0
s_and_b32 s37, s30, 15
s_lshr_b32 s52, s30, 4
s_mul_i32 s30, s37, 165888
s_lshl_b32 s31, s52, 7
s_add_u32 s30, s30, s31
s_mul_i32 s31, s24, 9216
s_add_u32 s30, s30, s31
s_add_u32 s30, s30, s53
v_lshrrev_b32 v36, 7, v1
v_mul_u32_u24 v42, 1152, v36
v_and_b32 v36, 0x70, v1
v_add_u32 v42, v36, v42
s_lshl_b32 s32, s24, 10
s_mov_b32 s12, s78
s_mov_b32 s13, s79
s_add_u32 m0, s32, 40960
s_add_u32 s31, s30, 0
buffer_load_dwordx4 v42, s[12:15], s31 offen nt lds
s_add_u32 m0, s32, 45056
s_add_u32 s31, s30, 36864
buffer_load_dwordx4 v42, s[12:15], s31 offen nt lds
s_add_u32 m0, s32, 49152
s_add_u32 s31, s30, 73728
buffer_load_dwordx4 v42, s[12:15], s31 offen nt lds
s_add_u32 m0, s32, 53248
s_add_u32 s31, s30, 110592
buffer_load_dwordx4 v42, s[12:15], s31 offen nt lds
s_add_u32 m0, s32, 57344
s_add_u32 s31, s30, 147456
s_cmp_lt_u32 s24, 2
s_cselect_b32 s31, s31, 1073741824
buffer_load_dwordx4 v42, s[12:15], s31 offen nt lds
s_branch L_p0_j3
L_p0_a3:
s_mov_b32 s14, 5308416
s_mov_b32 s15, 0x20000
s_add_u32 s30, s2, 256
s_cmp_lt_u32 s30, 288
s_cselect_b32 s53, 0, 1073741824
s_cselect_b32 s30, s30, 0
s_and_b32 s37, s30, 3
s_lshr_b32 s52, s30, 2
s_mul_i32 s30, s37, 1327104
s_lshl_b32 s31, s52, 7
s_add_u32 s30, s30, s31
s_mul_i32 s31, s24, 73728
s_add_u32 s30, s30, s31
s_add_u32 s30, s30, s53
v_lshrrev_b32 v36, 7, v1
v_mul_u32_u24 v42, 9216, v36
v_and_b32 v36, 0x70, v1
v_add_u32 v42, v36, v42
s_lshl_b32 s32, s24, 10
s_mov_b32 s12, s72
s_mov_b32 s13, s73
s_add_u32 m0, s32, 40960
s_add_u32 s31, s30, 0
buffer_load_dwordx4 v42, s[12:15], s31 offen nt lds
s_add_u32 m0, s32, 45056
s_add_u32 s31, s30, 294912
buffer_load_dwordx4 v42, s[12:15], s31 offen nt lds
s_add_u32 m0, s32, 49152
s_add_u32 s31, s30, 589824
buffer_load_dwordx4 v42, s[12:15], s31 offen nt lds
s_add_u32 m0, s32, 53248
s_add_u32 s31, s30, 884736
buffer_load_dwordx4 v42, s[12:15], s31 offen nt lds
s_add_u32 m0, s32, 57344
s_add_u32 s31, s30, 1179648
s_cmp_lt_u32 s24, 2
s_cselect_b32 s31, s31, 1073741824
buffer_load_dwordx4 v42, s[12:15], s31 offen nt lds
L_p0_j3:
s_lshl_b32 s92, s35, 6
s_lshl_b32 s33, s24, 4
s_add_u32 s92, s92, s33
s_cmp_ge_u32 s92, 2304
s_cselect_b32 s93, 1, 0
s_cselect_b32 s33, 2304, 0
s_sub_u32 s92, s92, s33
s_mul_i32 s94, s92, 1821
s_lshr_b32 s94, s94, 19
s_mul_i32 s33, s94, 288
s_sub_u32 s92, s92, s33
s_lshr_b32 s95, s92, 5
s_bfe_u32 s96, s92, 0x10004
s_lshl_b32 s94, s94, 1
s_cmp_ge_u32 s92, 144
s_addc_u32 s94, s94, 0
s_cmp_gt_u32 s95, 4
s_cselect_b32 s33, 5, 0
s_sub_u32 s97, s95, s33
s_cmp_eq_u32 s93, 0
s_cselect_b32 s33, 5, 0
s_add_u32 s97, s97, s33
s_cmp_eq_u32 s95, 4
s_cselect_b32 s97, 4, s97
s_mul_i32 s94, s94, 9
s_add_u32 s94, s94, s97
s_mul_i32 s94, s94, 37888
s_add_u32 s94, s94, 2785280
v_and_b32 v36, 3, v2
v_bfe_u32 v37, v2, 2, 1
v_bfe_u32 v38, v2, 3, 1
v_lshl_add_u32 v36, v38, 2, v36
s_lshl_b32 s33, s96, 3
v_add_u32 v36, s33, v36
s_cmp_eq_u32 s95, 4
s_cbranch_scc0 L_w3j_5
s_xor_b32 s33, s93, 1
v_mov_b32 v36, v2
v_mov_b32 v37, s33
L_w3j_5:
v_mul_u32_u24 v43, 18432, v37
v_lshl_add_u32 v43, v36, 4, v43
v_lshl_add_u32 v43, v3, 8, v43
s_mul_i32 s31, s34, 4608
s_add_u32 s31, s31, s94
v_add_u32 v43, s31, v43
v_lshlrev_b32 v44, 9, v37
v_lshl_add_u32 v44, v36, 3, v44
s_lshl_b32 s31, s34, 7
s_add_u32 s31, s31, s94
s_add_u32 s31, s31, 36864
v_add_u32 v44, s31, v44
s_waitcnt vmcnt(6)
s_barrier
ds_read_b64_tr_b16 v[84:85], v45 offset:20480
ds_read_b64_tr_b16 v[86:87], v45 offset:20992
ds_read_b64_tr_b16 v[88:89], v45 offset:24576
ds_read_b64_tr_b16 v[90:91], v45 offset:25088
ds_read_b64_tr_b16 v[92:93], v45 offset:28672
ds_read_b64_tr_b16 v[94:95], v45 offset:29184
ds_read_b64_tr_b16 v[96:97], v45 offset:32768
ds_read_b64_tr_b16 v[98:99], v45 offset:33280
ds_read_b64_tr_b16 v[100:101], v45 offset:36864
ds_read_b64_tr_b16 v[102:103], v45 offset:37376
v_mov_b32 v36, 1073741824
v_mov_b32 v46, 0
v_cndmask_b32 v37, v36, v43, s[50:51]
s_add_u32 s31, s36, 0
s_waitcnt lgkmcnt(8)
buffer_store_dwordx4 v[84:87], v43, s[4:7], s31 offen sc1
s_add_u32 s31, s36, 1024
s_waitcnt lgkmcnt(6)
buffer_store_dwordx4 v[88:91], v43, s[4:7], s31 offen sc1
s_add_u32 s31, s36, 2048
s_waitcnt lgkmcnt(4)
buffer_store_dwordx4 v[92:95], v43, s[4:7], s31 offen sc1
s_add_u32 s31, s36, 3072
s_waitcnt lgkmcnt(2)
buffer_store_dwordx4 v[96:99], v43, s[4:7], s31 offen sc1
s_add_u32 s31, s36, 4096
s_waitcnt lgkmcnt(0)
buffer_store_dwordx4 v[100:103], v37, s[4:7], s31 offen sc1
v_mov_b32 v37, 0x3f803f80
v_dot2c_f32_bf16 v46, v84, v37
v_dot2c_f32_bf16 v46, v85, v37
v_dot2c_f32_bf16 v46, v86, v37
v_dot2c_f32_bf16 v46, v87, v37
v_dot2c_f32_bf16 v46, v88, v37
v_dot2c_f32_bf16 v46, v89, v37
v_dot2c_f32_bf16 v46, v90, v37
v_dot2c_f32_bf16 v46, v91, v37
v_dot2c_f32_bf16 v46, v92, v37
v_dot2c_f32_bf16 v46, v93, v37
v_dot2c_f32_bf16 v46, v94, v37
v_dot2c_f32_bf16 v46, v95, v37
v_dot2c_f32_bf16 v46, v96, v37
v_dot2c_f32_bf16 v46, v97, v37
v_dot2c_f32_bf16 v46, v98, v37
v_dot2c_f32_bf16 v46, v99, v37
v_dot2c_f32_bf16 v46, v100, v37
v_dot2c_f32_bf16 v46, v101, v37
v_dot2c_f32_bf16 v46, v102, v37
v_dot2c_f32_bf16 v46, v103, v37
s_nop 2
v_mov_b32 v37, v46
s_nop 1
v_permlane32_swap_b32 v46, v37
v_add_f32 v46, v46, v37
v_mov_b32 v37, v46
s_nop 1
v_permlane16_swap_b32 v46, v37
v_add_f32 v46, v46, v37
v_cvt_pk_bf16_f32 v50, v46, v46
v_and_b32 v37, 0xffff0000, v50
v_sub_f32 v37, v46, v37
v_cvt_pk_bf16_f32 v51, v37, v37
v_cndmask_b32 v36, v36, v44, s[46:47]
buffer_store_dwordx2 v[50:51], v36, s[4:7], s36 offen sc1
s_cmp_lt_u32 s2, 32
s_cbranch_scc1 L_p0_a4
s_cmp_lt_u32 s2, 176
s_cbranch_scc1 L_p0_b4
v_lshrrev_b32 v39, 2, v2
v_and_b32 v40, 3, v2
v_lshlrev_b32 v40, 3, v40
s_lshl_b32 s31, s24, 5
v_add_u32 v40, s31, v40
v_lshl_add_u32 v36, v3, 2, v39
v_lshl_add_u32 v52, v36, 7, v40
v_lshrrev_b32 v36, 1, v39
v_mul_u32_u24 v36, 18, v36
v_and_b32 v41, 1, v39
v_add3_u32 v36, v36, v41, 16
v_and_b32 v41, 1, v3
v_mul_u32_u24 v41, 72, v41
v_add_u32 v36, v36, v41
v_lshl_add_u32 v53, v36, 7, v40
s_lshl_b32 s31, s52, 6
s_lshl_b32 s33, s24, 4
s_add_u32 s31, s31, s33
v_add_u32 v36, s31, v2
v_mul_u32_u24 v37, 911, v36
v_lshrrev_b32 v37, 16, v37
v_mul_u32_u24 v38, 72, v37
v_sub_u32 v36, v36, v38
s_mov_b32 s31, 82944
v_mul_lo_u32 v41, v37, s31
v_add_u32 v41, 2121728, v41
v_lshrrev_b32 v39, 5, v36
v_lshlrev_b32 v39, 11, v39
v_bfe_u32 v40, v36, 2, 1
v_lshl_add_u32 v39, v40, 10, v39
v_bfe_u32 v40, v36, 3, 2
v_lshl_add_u32 v39, v40, 6, v39
v_and_b32 v40, 3, v36
v_lshl_add_u32 v39, v40, 4, v39
v_lshlrev_b32 v40, 4, v36
v_add_u32 v40, 3072, v40
v_cmp_gt_u32 vcc, 64, v36
v_mov_b32 v47, 7
s_nop 0
v_cndmask_b32 v39, v40, v39, vcc
v_cndmask_b32 v47, v47, 8, vcc
v_add_u32 v41, v41, v39
s_mul_i32 s31, s37, 16
s_add_u32 s31, s31, 0
v_add_u32 v37, s31, v3
v_and_b32 v38, 3, v37
v_lshrrev_b32 v37, 2, v37
v_mul_u32_u24 v37, 4608, v37
v_lshlrev_b32 v38, v47, v38
v_add3_u32 v43, v41, v37, v38
s_mul_i32 s31, s37, 2
s_add_u32 s31, s31, 64
v_add_u32 v37, s31, v3
v_and_b32 v38, 3, v37
v_lshrrev_b32 v37, 2, v37
v_mul_u32_u24 v37, 4608, v37
v_lshlrev_b32 v38, v47, v38
v_add3_u32 v44, v41, v37, v38
s_waitcnt vmcnt(6)
s_barrier
ds_read_b64_tr_b16 v[104:105], v52 offset:40960
ds_read_b64_tr_b16 v[106:107], v52 offset:43264
ds_read_b64_tr_b16 v[108:109], v52 offset:45568
ds_read_b64_tr_b16 v[110:111], v52 offset:47872
ds_read_b64_tr_b16 v[112:113], v52 offset:50176
ds_read_b64_tr_b16 v[114:115], v52 offset:52480
ds_read_b64_tr_b16 v[116:117], v52 offset:54784
ds_read_b64_tr_b16 v[118:119], v52 offset:57088
ds_read_b64_tr_b16 v[120:121], v53 offset:40960
ds_read_b64_tr_b16 v[122:123], v53 offset:45568
v_mov_b32 v36, 1073741824
v_mov_b32 v46, 0
v_cndmask_b32 v37, v36, v44, s[50:51]
s_add_u32 s31, s53, 0
s_waitcnt lgkmcnt(8)
buffer_store_dwordx4 v[104:107], v43, s[4:7], s31 offen sc1
s_add_u32 s31, s53, 4608
s_waitcnt lgkmcnt(6)
buffer_store_dwordx4 v[108:111], v43, s[4:7], s31 offen sc1
s_add_u32 s31, s53, 9216
s_waitcnt lgkmcnt(4)
buffer_store_dwordx4 v[112:115], v43, s[4:7], s31 offen sc1
s_add_u32 s31, s53, 13824
s_waitcnt lgkmcnt(2)
buffer_store_dwordx4 v[116:119], v43, s[4:7], s31 offen sc1
s_add_u32 s31, s53, 0
s_waitcnt lgkmcnt(0)
buffer_store_dwordx4 v[120:123], v37, s[4:7], s31 offen sc1
buffer_store_dwordx2 v[50:51], v36, s[4:7], s53 offen sc1
s_branch L_p0_j4
L_p0_b4:
s_lshl_b32 s31, s52, 6
s_lshl_b32 s33, s24, 4
s_add_u32 s31, s31, s33
v_add_u32 v36, s31, v2
v_mul_u32_u24 v37, 911, v36
v_lshrrev_b32 v37, 16, v37
v_mul_u32_u24 v38, 72, v37
v_sub_u32 v36, v36, v38
s_mov_b32 s31, 331776
v_mul_lo_u32 v41, v37, s31
v_add_u32 v41, 8241152, v41
v_lshrrev_b32 v39, 5, v36
v_lshlrev_b32 v39, 11, v39
v_bfe_u32 v40, v36, 2, 1
v_lshl_add_u32 v39, v40, 10, v39
v_bfe_u32 v40, v36, 3, 2
v_lshl_add_u32 v39, v40, 6, v39
v_and_b32 v40, 3, v36
v_lshl_add_u32 v39, v40, 4, v39
v_lshlrev_b32 v40, 4, v36
v_add_u32 v40, 3072, v40
v_cmp_gt_u32 vcc, 64, v36
v_mov_b32 v47, 7
s_nop 0
v_cndmask_b32 v39, v40, v39, vcc
v_cndmask_b32 v47, v47, 8, vcc
v_add_u32 v41, v41, v39
s_mul_i32 s31, s37, 18
s_add_u32 s31, s31, 0
v_add_u32 v37, s31, v3
v_and_b32 v38, 3, v37
v_lshrrev_b32 v37, 2, v37
v_mul_u32_u24 v37, 4608, v37
v_lshlrev_b32 v38, v47, v38
v_add3_u32 v43, v41, v37, v38
s_waitcnt vmcnt(6)
s_barrier
ds_read_b64_tr_b16 v[104:105], v45 offset:40960
ds_read_b64_tr_b16 v[106:107], v45 offset:41472
ds_read_b64_tr_b16 v[108:109], v45 offset:45056
ds_read_b64_tr_b16 v[110:111], v45 offset:45568
ds_read_b64_tr_b16 v[112:113], v45 offset:49152
ds_read_b64_tr_b16 v[114:115], v45 offset:49664
ds_read_b64_tr_b16 v[116:117], v45 offset:53248
ds_read_b64_tr_b16 v[118:119], v45 offset:53760
ds_read_b64_tr_b16 v[120:121], v45 offset:57344
ds_read_b64_tr_b16 v[122:123], v45 offset:57856
v_mov_b32 v36, 1073741824
v_mov_b32 v46, 0
v_cndmask_b32 v37, v36, v43, s[50:51]
s_add_u32 s31, s53, 0
s_waitcnt lgkmcnt(8)
buffer_store_dwordx4 v[104:107], v43, s[4:7], s31 offen sc1
s_add_u32 s31, s53, 4608
s_waitcnt lgkmcnt(6)
buffer_store_dwordx4 v[108:111], v43, s[4:7], s31 offen sc1
s_add_u32 s31, s53, 9216
s_waitcnt lgkmcnt(4)
buffer_store_dwordx4 v[112:115], v43, s[4:7], s31 offen sc1
s_add_u32 s31, s53, 13824
s_waitcnt lgkmcnt(2)
buffer_store_dwordx4 v[116:119], v43, s[4:7], s31 offen sc1
s_add_u32 s31, s53, 18432
s_waitcnt lgkmcnt(0)
buffer_store_dwordx4 v[120:123], v37, s[4:7], s31 offen sc1
buffer_store_dwordx2 v[50:51], v36, s[4:7], s53 offen sc1
s_branch L_p0_j4
L_p0_a4:
s_lshl_b32 s92, s52, 6
s_lshl_b32 s33, s24, 4
s_add_u32 s92, s92, s33
s_cmp_ge_u32 s92, 2304
s_cselect_b32 s93, 1, 0
s_cselect_b32 s33, 2304, 0
s_sub_u32 s92, s92, s33
s_mul_i32 s94, s92, 1821
s_lshr_b32 s94, s94, 19
s_mul_i32 s33, s94, 288
s_sub_u32 s92, s92, s33
s_lshr_b32 s95, s92, 5
s_bfe_u32 s96, s92, 0x10004
s_lshl_b32 s94, s94, 1
s_cmp_ge_u32 s92, 144
s_addc_u32 s94, s94, 0
s_cmp_gt_u32 s95, 4
s_cselect_b32 s33, 5, 0
s_sub_u32 s97, s95, s33
s_cmp_eq_u32 s93, 0
s_cselect_b32 s33, 5, 0
s_add_u32 s97, s97, s33
s_cmp_eq_u32 s95, 4
s_cselect_b32 s97, 4, s97
s_mul_i32 s94, s94, 9
s_add_u32 s94, s94, s97
s_mul_i32 s94, s94, 37888
s_add_u32 s94, s94, 2785280
v_and_b32 v36, 3, v2
v_bfe_u32 v37, v2, 2, 1
v_bfe_u32 v38, v2, 3, 1
v_lshl_add_u32 v36, v38, 2, v36
s_lshl_b32 s33, s96, 3
v_add_u32 v36, s33, v36
s_cmp_eq_u32 s95, 4
s_cbranch_scc0 L_w3j_8
s_xor_b32 s33, s93, 1
v_mov_b32 v36, v2
v_mov_b32 v37, s33
L_w3j_8:
v_mul_u32_u24 v43, 18432, v37
v_lshl_add_u32 v43, v36, 4, v43
v_lshl_add_u32 v43, v3, 8, v43
s_mul_i32 s31, s37, 4608
s_add_u32 s31, s31, s94
v_add_u32 v43, s31, v43
v_lshlrev_b32 v44, 9, v37
v_lshl_add_u32 v44, v36, 3, v44
s_lshl_b32 s31, s37, 7
s_add_u32 s31, s31, s94
s_add_u32 s31, s31, 36864
v_add_u32 v44, s31, v44
s_waitcnt vmcnt(6)
s_barrier
ds_read_b64_tr_b16 v[104:105], v45 offset:40960
ds_read_b64_tr_b16 v[106:107], v45 offset:41472
ds_read_b64_tr_b16 v[108:109], v45 offset:45056
ds_read_b64_tr_b16 v[110:111], v45 offset:45568
ds_read_b64_tr_b16 v[112:113], v45 offset:49152
ds_read_b64_tr_b16 v[114:115], v45 offset:49664
ds_read_b64_tr_b16 v[116:117], v45 offset:53248
ds_read_b64_tr_b16 v[118:119], v45 offset:53760
ds_read_b64_tr_b16 v[120:121], v45 offset:57344
ds_read_b64_tr_b16 v[122:123], v45 offset:57856
v_mov_b32 v36, 1073741824
v_mov_b32 v46, 0
v_cndmask_b32 v37, v36, v43, s[50:51]
s_add_u32 s31, s53, 0
s_waitcnt lgkmcnt(8)
buffer_store_dwordx4 v[104:107], v43, s[4:7], s31 offen sc1
s_add_u32 s31, s53, 1024
s_waitcnt lgkmcnt(6)
buffer_store_dwordx4 v[108:111], v43, s[4:7], s31 offen sc1
s_add_u32 s31, s53, 2048
s_waitcnt lgkmcnt(4)
buffer_store_dwordx4 v[112:115], v43, s[4:7], s31 offen sc1
s_add_u32 s31, s53, 3072
s_waitcnt lgkmcnt(2)
buffer_store_dwordx4 v[116:119], v43, s[4:7], s31 offen sc1
s_add_u32 s31, s53, 4096
s_waitcnt lgkmcnt(0)
buffer_store_dwordx4 v[120:123], v37, s[4:7], s31 offen sc1
v_mov_b32 v37, 0x3f803f80
v_dot2c_f32_bf16 v46, v104, v37
v_dot2c_f32_bf16 v46, v105, v37
v_dot2c_f32_bf16 v46, v106, v37
v_dot2c_f32_bf16 v46, v107, v37
v_dot2c_f32_bf16 v46, v108, v37
v_dot2c_f32_bf16 v46, v109, v37
v_dot2c_f32_bf16 v46, v110, v37
v_dot2c_f32_bf16 v46, v111, v37
v_dot2c_f32_bf16 v46, v112, v37
v_dot2c_f32_bf16 v46, v113, v37
v_dot2c_f32_bf16 v46, v114, v37
v_dot2c_f32_bf16 v46, v115, v37
v_dot2c_f32_bf16 v46, v116, v37
v_dot2c_f32_bf16 v46, v117, v37
v_dot2c_f32_bf16 v46, v118, v37
v_dot2c_f32_bf16 v46, v119, v37
v_dot2c_f32_bf16 v46, v120, v37
v_dot2c_f32_bf16 v46, v121, v37
v_dot2c_f32_bf16 v46, v122, v37
v_dot2c_f32_bf16 v46, v123, v37
s_nop 2
v_mov_b32 v37, v46
s_nop 1
v_permlane32_swap_b32 v46, v37
v_add_f32 v46, v46, v37
v_mov_b32 v37, v46
s_nop 1
v_permlane16_swap_b32 v46, v37
v_add_f32 v46, v46, v37
v_cvt_pk_bf16_f32 v50, v46, v46
v_and_b32 v37, 0xffff0000, v50
v_sub_f32 v37, v46, v37
v_cvt_pk_bf16_f32 v51, v37, v37
v_cndmask_b32 v36, v36, v44, s[46:47]
buffer_store_dwordx2 v[50:51], v36, s[4:7], s53 offen sc1
L_p0_j4:
s_mov_b32 s12, s74
s_mov_b32 s13, s75
s_mov_b32 s14, 8388608
s_mov_b32 s15, 0x20000
s_lshl_b32 s30, s25, 2
s_add_u32 s30, s30, s24
s_mul_i32 s31, s30, 133120
s_lshl_b32 s30, s30, 17
s_lshl_b32 s98, s26, 8
s_add_u32 s98, s98, s30
s_lshl_b32 s101, s26, 12
s_add_u32 s101, s101, s31
s_add_u32 s101, s101, 10895360
s_lshl_b32 s63, s24, 13
s_add_u32 s63, s63, 61440
s_mov_b32 m0, s63
v_add_u32 v36, 0, v3
v_xor_b32 v37, v36, v2
v_lshlrev_b32 v36, 12, v36
v_lshl_add_u32 v156, v37, 4, v36
v_lshlrev_b32 v37, 4, v37
v_lshl_add_u32 v37, v2, 8, v37
v_add_u32 v160, s63, v37
v_add_u32 v36, 4, v3
v_xor_b32 v37, v36, v2
v_lshlrev_b32 v36, 12, v36
v_lshl_add_u32 v157, v37, 4, v36
v_lshlrev_b32 v37, 4, v37
v_lshl_add_u32 v37, v2, 8, v37
v_add_u32 v161, s63, v37
v_subrev_u32 v157, 1024, v157
v_add_u32 v36, 8, v3
v_xor_b32 v37, v36, v2
v_lshlrev_b32 v36, 12, v36
v_lshl_add_u32 v158, v37, 4, v36
v_lshlrev_b32 v37, 4, v37
v_lshl_add_u32 v37, v2, 8, v37
v_add_u32 v162, s63, v37
v_subrev_u32 v158, 2048, v158
v_add_u32 v36, 12, v3
v_xor_b32 v37, v36, v2
v_lshlrev_b32 v36, 12, v36
v_lshl_add_u32 v159, v37, 4, v36
v_lshlrev_b32 v37, 4, v37
v_lshl_add_u32 v37, v2, 8, v37
v_add_u32 v163, s63, v37
v_subrev_u32 v159, 3072, v159
buffer_load_dwordx4 v156, s[12:15], s98 offen offset:0 nt lds
buffer_load_dwordx4 v157, s[12:15], s98 offen offset:1024 nt lds
buffer_load_dwordx4 v158, s[12:15], s98 offen offset:2048 nt lds
buffer_load_dwordx4 v159, s[12:15], s98 offen offset:3072 nt lds
s_add_u32 m0, s63, 4096
s_add_u32 s98, s98, 65536
buffer_load_dwordx4 v156, s[12:15], s98 offen offset:0 nt lds
buffer_load_dwordx4 v157, s[12:15], s98 offen offset:1024 nt lds
buffer_load_dwordx4 v158, s[12:15], s98 offen offset:2048 nt lds
buffer_load_dwordx4 v159, s[12:15], s98 offen offset:3072 nt lds
s_cmp_eq_u32 s24, 1
s_cbranch_scc0 L_p0done_10
v_lshrrev_b32 v41, 4, v1
s_lshl_b32 s30, s25, 3
s_sub_u32 s30, s30, 1
v_add_u32 v36, s30, v41
v_max_i32 v36, 0, v36
s_lshl_b32 s30, s27, 2
v_add_u32 v37, s30, v2
v_cndmask_b32 v36, v37, v36, s[46:47]
v_bfe_u32 v37, v41, 2, 1
v_mul_u32_u24 v37, 35, v37
s_mul_i32 s30, s26, 36
v_add_u32 v37, s30, v37
v_lshrrev_b32 v37, 6, v37
v_bfe_u32 v38, v41, 3, 2
v_mad_u32_u24 v37, v38, 9, v37
v_and_b32 v38, 3, v41
v_lshl_add_u32 v37, v37, 2, v38
v_add_u32 v37, 128, v37
v_cndmask_b32 v36, v37, v36, s[50:51]
v_lshlrev_b32 v36, 7, v36
s_mov_b32 s30, 19415040
s_mov_b32 s31, 0
s_mov_b32 exec_lo, 0x000f01ff
s_mov_b32 exec_hi, 0x00ffffff
L_p0poll_9:
buffer_load_dwordx2 v[50:51], v36, s[4:7], s30 offen sc1
s_add_u32 s31, s31, 1
s_waitcnt vmcnt(0)
v_cmp_ne_u64 vcc, v[50:51], v[238:239]
s_cmp_gt_u32 s31, 200000
s_cbranch_scc1 L_p0done_10
s_cbranch_vccnz L_p0poll_9
L_p0done_10:
s_mov_b64 exec, -1
s_barrier
s_lshl_b32 s33, s25, 8
s_lshl_b32 s32, s24, 6
s_add_u32 s33, s33, s32
v_lshlrev_b32 v8, 1, v2
buffer_load_ushort v0, v8, s[20:23], s33 offen
buffer_load_ushort v249, v8, s[20:23], s33 offen offset:32
s_lshl_b32 s30, s27, 2
s_add_u32 s30, s30, s24
s_mul_i32 s30, s30, 18432
s_mul_i32 s31, s28, 2304
s_add_u32 s30, s30, s31
s_add_u32 s30, s30, 0
v_and_b32 v6, 1, v3
v_lshlrev_b32 v6, 3, v6
v_lshl_add_u32 v6, v2, 4, v6
buffer_load_dwordx4 v[36:39], v1, s[8:11], s30 offen sc1
buffer_load_dwordx4 v[40:43], v1, s[8:11], s30 offen offset:1024 sc1
buffer_load_dwordx2 v[44:45], v6, s[8:11], s30 offen offset:2048 sc1
s_mul_i32 s36, s26, 132608
s_mul_i32 s38, s24, 12288
s_add_u32 m0, s38, 0
s_add_u32 s39, s38, s36
buffer_load_dwordx4 v1, s[4:7], s39 offen offset:0 sc1 lds
buffer_load_dwordx4 v1, s[4:7], s39 offen offset:1024 sc1 lds
buffer_load_dwordx4 v1, s[4:7], s39 offen offset:2048 sc1 lds
buffer_load_dwordx4 v1, s[4:7], s39 offen offset:3072 sc1 lds
s_add_u32 m0, m0, 4096
s_add_u32 s39, s39, 4096
buffer_load_dwordx4 v1, s[4:7], s39 offen offset:0 sc1 lds
buffer_load_dwordx4 v1, s[4:7], s39 offen offset:1024 sc1 lds
buffer_load_dwordx4 v1, s[4:7], s39 offen offset:2048 sc1 lds
buffer_load_dwordx4 v1, s[4:7], s39 offen offset:3072 sc1 lds
s_add_u32 m0, m0, 4096
s_add_u32 s39, s39, 4096
buffer_load_dwordx4 v1, s[4:7], s39 offen offset:0 sc1 lds
buffer_load_dwordx4 v1, s[4:7], s39 offen offset:1024 sc1 lds
buffer_load_dwordx4 v1, s[4:7], s39 offen offset:2048 sc1 lds
buffer_load_dwordx4 v1, s[4:7], s39 offen offset:3072 sc1 lds
v_and_b32 v6, 1, v2
v_cmp_eq_u32 s[40:41], 1, v6
v_lshl_add_u32 v6, v3, 2, v6
v_cmp_le_u32 s[42:43], v6, v2
v_add_u32 v6, 2, v6
v_cmp_le_u32 s[44:45], v6, v2
v_mov_b32 v6, 0x0c0c0100
v_mov_b32 v7, 0x01000c0c
v_cndmask_b32 v6, v6, v7, s[40:41]
v_mov_b32 v8, 0x0c0c0c0c
v_cndmask_b32 v10, v6, v8, s[42:43]
v_cndmask_b32 v12, v8, v6, s[42:43]
v_mov_b32 v6, 0x0c0c0302
v_mov_b32 v7, 0x03020c0c
v_cndmask_b32 v6, v6, v7, s[40:41]
v_cndmask_b32 v11, v6, v8, s[44:45]
v_cndmask_b32 v13, v8, v6, s[44:45]
s_mul_i32 s82, s26, 340992
s_add_u32 s82, s82, 2785280
s_mul_i32 s83, s28, 331776
s_add_u32 s83, s83, 8241152
s_and_b32 s30, s27, 1
s_mul_i32 s30, s30, 165888
s_add_u32 s83, s83, s30
s_waitcnt vmcnt(12)
v_lshlrev_b32 v16, 16, v36
v_and_b32 v17, 0xffff0000, v36
v_lshlrev_b32 v18, 16, v37
v_and_b32 v19, 0xffff0000, v37
v_lshlrev_b32 v20, 16, v38
v_and_b32 v21, 0xffff0000, v38
v_lshlrev_b32 v22, 16, v39
v_and_b32 v23, 0xffff0000, v39
v_lshlrev_b32 v24, 16, v40
v_and_b32 v25, 0xffff0000, v40
v_lshlrev_b32 v26, 16, v41
v_and_b32 v27, 0xffff0000, v41
v_lshlrev_b32 v28, 16, v42
v_and_b32 v29, 0xffff0000, v42
v_lshlrev_b32 v30, 16, v43
v_and_b32 v31, 0xffff0000, v43
v_lshlrev_b32 v32, 16, v44
v_and_b32 v33, 0xffff0000, v44
v_lshlrev_b32 v34, 16, v45
v_and_b32 v35, 0xffff0000, v45
ds_read_b128 a[232:235], v160 offset:0
ds_read_b128 a[236:239], v161 offset:0
ds_read_b128 a[240:243], v162 offset:0
ds_read_b128 a[244:247], v163 offset:0
ds_read_b128 a[248:251], v160 offset:4096
ds_read_b128 a[252:255], v161 offset:4096
ds_read_b128 v[240:243], v162 offset:4096
ds_read_b128 v[244:247], v163 offset:4096
s_waitcnt lgkmcnt(0)
v_mov_b32 v6, 0
s_barrier
v_mov_b32 v248, v238
s_mov_b64 exec, 1
buffer_store_dwordx2 v[238:239], v6, s[4:7], s100 offen sc1
s_mov_b64 exec, -1
s_mul_i32 s36, s26, 132608
s_mul_i32 s38, s24, 9216
s_add_u32 m0, s38, 49152
s_add_u32 s39, s38, s36
s_add_u32 s39, s39, 49152
buffer_load_dwordx4 v1, s[4:7], s39 offen offset:0 sc1 lds
buffer_load_dwordx4 v1, s[4:7], s39 offen offset:1024 sc1 lds
buffer_load_dwordx4 v1, s[4:7], s39 offen offset:2048 sc1 lds
buffer_load_dwordx4 v1, s[4:7], s39 offen offset:3072 sc1 lds
s_add_u32 m0, m0, 4096
s_add_u32 s39, s39, 4096
buffer_load_dwordx4 v1, s[4:7], s39 offen offset:0 sc1 lds
buffer_load_dwordx4 v1, s[4:7], s39 offen offset:1024 sc1 lds
buffer_load_dwordx4 v1, s[4:7], s39 offen offset:2048 sc1 lds
buffer_load_dwordx4 v1, s[4:7], s39 offen offset:3072 sc1 lds
s_add_u32 m0, m0, 4096
s_add_u32 s39, s39, 4096
buffer_load_dwordx4 v1, s[4:7], s39 offen offset:0 sc1 lds
s_lshl_b32 s60, s25, 3
s_sub_u32 s61, s60, 1
s_max_i32 s61, s61, 0
s_lshl_b32 s30, s24, 1
s_add_u32 s60, s60, s30
s_mul_i32 s30, s61, 18432
s_mul_i32 s62, s60, 18432
v_add_u32 v237, 18432, v1
s_mul_i32 s38, s24, 5120
s_add_u32 m0, s38, 135168
s_add_u32 s39, s38, s30
L_layer:
buffer_load_dwordx4 v1, s[8:11], s39 offen offset:0 sc1 lds
buffer_load_dwordx4 v1, s[8:11], s39 offen offset:1024 sc1 lds
buffer_load_dwordx4 v1, s[8:11], s39 offen offset:2048 sc1 lds
buffer_load_dwordx4 v1, s[8:11], s39 offen offset:3072 sc1 lds
s_add_u32 m0, m0, 4096
s_add_u32 s39, s39, 4096
buffer_load_dwordx4 v1, s[8:11], s39 offen offset:0 sc1 lds
s_barrier
buffer_load_dwordx4 a[0:3], v1, s[8:11], s62 offen offset:0 sc1
buffer_load_dwordx4 a[4:7], v237, s[8:11], s62 offen offset:0 sc1
s_barrier
buffer_load_dwordx4 a[8:11], v1, s[8:11], s62 offen offset:1024 sc1
buffer_load_dwordx4 a[12:15], v237, s[8:11], s62 offen offset:1024 sc1
s_barrier
buffer_load_dwordx4 a[16:19], v1, s[8:11], s62 offen offset:2048 sc1
buffer_load_dwordx4 a[20:23], v237, s[8:11], s62 offen offset:2048 sc1
s_barrier
buffer_load_dwordx4 a[24:27], v1, s[8:11], s62 offen offset:3072 sc1
buffer_load_dwordx4 a[28:31], v237, s[8:11], s62 offen offset:3072 sc1
s_barrier
s_add_u32 s62, s62, 4096
buffer_load_dwordx4 a[32:35], v1, s[8:11], s62 offen offset:0 sc1
buffer_load_dwordx4 a[36:39], v237, s[8:11], s62 offen offset:0 sc1
s_barrier
buffer_load_dwordx4 a[40:43], v1, s[8:11], s62 offen offset:1024 sc1
buffer_load_dwordx4 a[44:47], v237, s[8:11], s62 offen offset:1024 sc1
s_sub_u32 s30, s60, 2
v_add_u32 v6, s30, v3
v_max_i32 v6, 0, v6
v_mov_b32 v7, s61
v_cndmask_b32 v6, v6, v7, s[46:47]
v_lshl_add_u32 v6, v6, 4, v2
v_lshlrev_b32 v129, 3, v6
s_lshl_b32 s30, s24, 10
v_add_u32 v125, s30, v1
v_add_u32 v126, 135168, v1
v_lshrrev_b32 v127, 1, v1
v_add_u32 v127, 129024, v127
s_lshl_b32 s30, s24, 9
v_add_u32 v128, s30, v127
v_add_u32 v8, 64512, v1
s_waitcnt vmcnt(12)
s_barrier
ds_read_b128 a[144:147], v1 offset:0
ds_read_b128 a[148:151], v1 offset:1024
ds_read_b128 a[152:155], v1 offset:2048
ds_read_b128 a[156:159], v1 offset:3072
ds_read_b128 a[160:163], v1 offset:4096
ds_read_b128 a[164:167], v1 offset:5120
ds_read_b128 a[168:171], v1 offset:6144
ds_read_b128 a[172:175], v125 offset:0
ds_read_b128 a[176:179], v126 offset:0
v_lshrrev_b32 v146, 1, v1
s_lshl_b32 s66, s24, 9
s_add_u32 s66, s66, 19447808
s_waitcnt vmcnt(10) lgkmcnt(0)
v_mfma_f32_16x16x32_bf16 v[36:39], a[144:147], a[0:3], 0
ds_read_b128 a[180:183], v1 offset:7168
buffer_load_dwordx4 a[48:51], v1, s[8:11], s62 offen offset:2048 sc1
v_mfma_f32_16x16x32_bf16 v[64:67], a[144:147], a[4:7], 0
ds_read_b128 a[184:187], v1 offset:8192
v_mfma_f32_16x16x32_bf16 v[40:43], a[148:151], a[0:3], 0
ds_read_b128 a[188:191], v1 offset:9216
v_mfma_f32_16x16x32_bf16 v[68:71], a[148:151], a[4:7], 0
ds_read_b128 a[192:195], v1 offset:10240
v_mfma_f32_16x16x32_bf16 v[44:47], a[152:155], a[0:3], 0
ds_read_b128 a[196:199], v1 offset:11264
buffer_load_dwordx4 a[52:55], v237, s[8:11], s62 offen offset:2048 sc1
v_mfma_f32_16x16x32_bf16 v[72:75], a[152:155], a[4:7], 0
ds_read_b128 a[200:203], v1 offset:12288
v_mfma_f32_16x16x32_bf16 v[48:51], a[156:159], a[0:3], 0
ds_read_b128 a[204:207], v1 offset:13312
v_mfma_f32_16x16x32_bf16 v[76:79], a[156:159], a[4:7], 0
ds_read_b128 a[208:211], v125 offset:7168
v_mfma_f32_16x16x32_bf16 v[52:55], a[160:163], a[0:3], 0
ds_read_b128 a[212:215], v126 offset:1024
buffer_load_dwordx4 a[56:59], v1, s[8:11], s62 offen offset:3072 sc1
v_mfma_f32_16x16x32_bf16 v[80:83], a[160:163], a[4:7], 0
v_mfma_f32_16x16x32_bf16 v[92:95], a[172:175], a[176:179], 0
v_mfma_f32_16x16x32_bf16 v[96:99], a[160:163], a[176:179], 0
v_mfma_f32_16x16x32_bf16 v[56:59], a[164:167], a[0:3], 0
buffer_load_dwordx4 a[60:63], v237, s[8:11], s62 offen offset:3072 sc1
v_mfma_f32_16x16x32_bf16 v[84:87], a[164:167], a[4:7], 0
s_add_u32 s62, s62, 4096
v_mfma_f32_16x16x32_bf16 v[60:63], a[168:171], a[0:3], 0
v_mfma_f32_16x16x32_bf16 v[88:91], a[168:171], a[4:7], 0
s_waitcnt vmcnt(12) lgkmcnt(0)
v_mfma_f32_16x16x32_bf16 v[36:39], a[180:183], a[8:11], v[36:39]
ds_read_b128 a[144:147], v1 offset:14336
v_lshlrev_b32 v124, 2, v2
v_mfma_f32_16x16x32_bf16 v[64:67], a[180:183], a[12:15], v[64:67]
ds_read_b128 a[148:151], v1 offset:15360
v_mfma_f32_16x16x32_bf16 v[40:43], a[184:187], a[8:11], v[40:43]
ds_read_b128 a[152:155], v1 offset:16384
v_and_b32 v6, 1, v2
v_mfma_f32_16x16x32_bf16 v[68:71], a[184:187], a[12:15], v[68:71]
ds_read_b128 a[156:159], v1 offset:17408
v_mfma_f32_16x16x32_bf16 v[44:47], a[188:191], a[8:11], v[44:47]
ds_read_b128 a[160:163], v1 offset:18432
v_mfma_f32_16x16x32_bf16 v[72:75], a[188:191], a[12:15], v[72:75]
ds_read_b128 a[164:167], v1 offset:19456
buffer_load_dwordx4 a[64:67], v1, s[8:11], s62 offen offset:0 sc1
v_mfma_f32_16x16x32_bf16 v[48:51], a[192:195], a[8:11], v[48:51]
ds_read_b128 a[168:171], v1 offset:20480
v_lshl_add_u32 v6, v3, 2, v6
v_mfma_f32_16x16x32_bf16 v[76:79], a[192:195], a[12:15], v[76:79]
ds_read_b128 a[172:175], v125 offset:14336
v_lshlrev_b32 v6, 2, v6
v_mfma_f32_16x16x32_bf16 v[52:55], a[196:199], a[8:11], v[52:55]
ds_read_b128 a[176:179], v126 offset:2048
v_mfma_f32_16x16x32_bf16 v[80:83], a[196:199], a[12:15], v[80:83]
buffer_load_dwordx4 a[68:71], v237, s[8:11], s62 offen offset:0 sc1
v_mfma_f32_16x16x32_bf16 v[92:95], a[208:211], a[212:215], v[92:95]
v_add_u32 v122, 64, v6
v_mfma_f32_16x16x32_bf16 v[96:99], a[196:199], a[212:215], v[96:99]
v_mfma_f32_16x16x32_bf16 v[56:59], a[200:203], a[8:11], v[56:59]
v_add_u32 v7, 128, v6
v_mfma_f32_16x16x32_bf16 v[84:87], a[200:203], a[12:15], v[84:87]
v_mfma_f32_16x16x32_bf16 v[60:63], a[204:207], a[8:11], v[60:63]
buffer_load_dwordx4 a[72:75], v1, s[8:11], s62 offen offset:1024 sc1
v_mfma_f32_16x16x32_bf16 v[88:91], a[204:207], a[12:15], v[88:91]
s_mov_b32 s63, 2359296
v_cndmask_b32 v122, v122, v7, s[42:43]
s_waitcnt vmcnt(13) lgkmcnt(0)
v_mfma_f32_16x16x32_bf16 v[36:39], a[144:147], a[16:19], v[36:39]
ds_read_b128 a[180:183], v1 offset:21504
v_mfma_f32_16x16x32_bf16 v[64:67], a[144:147], a[20:23], v[64:67]
ds_read_b128 a[184:187], v1 offset:22528
v_add_u32 v123, 72, v6
v_mfma_f32_16x16x32_bf16 v[40:43], a[148:151], a[16:19], v[40:43]
ds_read_b128 a[188:191], v1 offset:23552
v_mfma_f32_16x16x32_bf16 v[68:71], a[148:151], a[20:23], v[68:71]
ds_read_b128 a[192:195], v1 offset:24576
v_mfma_f32_16x16x32_bf16 v[44:47], a[152:155], a[16:19], v[44:47]
ds_read_b128 a[196:199], v1 offset:25600
v_add_u32 v7, 136, v6
v_mfma_f32_16x16x32_bf16 v[72:75], a[152:155], a[20:23], v[72:75]
ds_read_b128 a[200:203], v1 offset:26624
v_mfma_f32_16x16x32_bf16 v[48:51], a[156:159], a[16:19], v[48:51]
ds_read_b128 a[204:207], v1 offset:27648
buffer_load_dwordx2 v[100:101], v129, s[8:11], s63 offen sc1
v_mfma_f32_16x16x32_bf16 v[76:79], a[156:159], a[20:23], v[76:79]
ds_read_b128 a[208:211], v125 offset:21504
v_cndmask_b32 v123, v123, v7, s[44:45]
v_mfma_f32_16x16x32_bf16 v[52:55], a[160:163], a[16:19], v[52:55]
ds_read_b128 a[212:215], v126 offset:3072
s_mul_i32 s36, s26, 132608
v_mfma_f32_16x16x32_bf16 v[80:83], a[160:163], a[20:23], v[80:83]
s_mov_b32 s63, 2375680
s_lshl_b32 s31, s24, 5
v_mfma_f32_16x16x32_bf16 v[92:95], a[172:175], a[176:179], v[92:95]
s_mul_i32 s38, s24, 12288
v_mfma_f32_16x16x32_bf16 v[96:99], a[160:163], a[176:179], v[96:99]
s_add_u32 m0, s38, 86016
v_add_u32 v6, s31, v2
v_mfma_f32_16x16x32_bf16 v[56:59], a[164:167], a[16:19], v[56:59]
s_add_u32 s39, s38, s36
v_mfma_f32_16x16x32_bf16 v[84:87], a[164:167], a[20:23], v[84:87]
s_add_u32 s39, s39, 86016
v_mfma_f32_16x16x32_bf16 v[60:63], a[168:171], a[16:19], v[60:63]
v_mul_u32_u24 v220, 176, v6
v_mfma_f32_16x16x32_bf16 v[88:91], a[168:171], a[20:23], v[88:91]
buffer_load_dwordx2 v[102:103], v129, s[8:11], s63 offen sc1
s_waitcnt vmcnt(13) lgkmcnt(0)
v_mfma_f32_16x16x32_bf16 v[36:39], a[180:183], a[24:27], v[36:39]
ds_read_b128 a[144:147], v1 offset:28672
v_add_u32 v220, 0, v220
v_mfma_f32_16x16x32_bf16 v[64:67], a[180:183], a[28:31], v[64:67]
ds_read_b128 a[148:151], v1 offset:29696
v_mfma_f32_16x16x32_bf16 v[40:43], a[184:187], a[24:27], v[40:43]
ds_read_b128 a[152:155], v1 offset:30720
v_mfma_f32_16x16x32_bf16 v[68:71], a[184:187], a[28:31], v[68:71]
ds_read_b128 a[156:159], v1 offset:31744
s_mov_b32 s63, 2392064
v_mfma_f32_16x16x32_bf16 v[44:47], a[188:191], a[24:27], v[44:47]
ds_read_b128 a[160:163], v1 offset:32768
v_lshl_add_u32 v218, v3, 3, v220
v_mfma_f32_16x16x32_bf16 v[72:75], a[188:191], a[28:31], v[72:75]
ds_read_b128 a[164:167], v1 offset:33792
v_mul_u32_u24 v219, 176, v2
v_mfma_f32_16x16x32_bf16 v[48:51], a[192:195], a[24:27], v[48:51]
ds_read_b128 a[168:171], v1 offset:34816
v_mfma_f32_16x16x32_bf16 v[76:79], a[192:195], a[28:31], v[76:79]
ds_read_b128 a[172:175], v125 offset:28672
buffer_load_dwordx2 v[104:105], v129, s[8:11], s63 offen sc1
v_mfma_f32_16x16x32_bf16 v[52:55], a[196:199], a[24:27], v[52:55]
ds_read_b128 a[176:179], v126 offset:4096
v_lshl_add_u32 v219, v3, 3, v219
v_mfma_f32_16x16x32_bf16 v[80:83], a[196:199], a[28:31], v[80:83]
s_mov_b32 s63, 2408448
v_mfma_f32_16x16x32_bf16 v[92:95], a[208:211], a[212:215], v[92:95]
v_add_u32 v219, 0, v219
v_mfma_f32_16x16x32_bf16 v[96:99], a[196:199], a[212:215], v[96:99]
v_mfma_f32_16x16x32_bf16 v[56:59], a[200:203], a[24:27], v[56:59]
buffer_load_dwordx4 v1, s[4:7], s39 offen offset:0 sc1 lds
v_mfma_f32_16x16x32_bf16 v[84:87], a[200:203], a[28:31], v[84:87]
v_add_u32 v222, s31, v219
v_mfma_f32_16x16x32_bf16 v[60:63], a[204:207], a[24:27], v[60:63]
v_mfma_f32_16x16x32_bf16 v[88:91], a[204:207], a[28:31], v[88:91]
v_lshrrev_b32 v6, 2, v2
s_waitcnt vmcnt(13) lgkmcnt(0)
v_mfma_f32_16x16x32_bf16 v[36:39], a[144:147], a[32:35], v[36:39]
ds_read_b128 a[180:183], v1 offset:35840
buffer_load_dwordx2 v[106:107], v129, s[8:11], s63 offen sc1
v_mfma_f32_16x16x32_bf16 v[64:67], a[144:147], a[36:39], v[64:67]
ds_read_b128 a[184:187], v1 offset:36864
buffer_load_dwordx4 v1, s[4:7], s39 offen offset:1024 sc1 lds
v_mfma_f32_16x16x32_bf16 v[40:43], a[148:151], a[32:35], v[40:43]
ds_read_b128 a[188:191], v1 offset:37888
v_lshl_add_u32 v6, v3, 2, v6
v_mfma_f32_16x16x32_bf16 v[68:71], a[148:151], a[36:39], v[68:71]
ds_read_b128 a[192:195], v1 offset:38912
v_mfma_f32_16x16x32_bf16 v[44:47], a[152:155], a[32:35], v[44:47]
ds_read_b128 a[196:199], v1 offset:39936
buffer_load_dwordx4 v1, s[4:7], s39 offen offset:2048 sc1 lds
v_mfma_f32_16x16x32_bf16 v[72:75], a[152:155], a[36:39], v[72:75]
ds_read_b128 a[200:203], v1 offset:40960
s_mov_b32 s63, 2424832
v_mfma_f32_16x16x32_bf16 v[48:51], a[156:159], a[32:35], v[48:51]
ds_read_b128 a[204:207], v1 offset:41984
v_add_u32 v6, s31, v6
v_mfma_f32_16x16x32_bf16 v[76:79], a[156:159], a[36:39], v[76:79]
ds_read_b128 a[208:211], v125 offset:35840
v_mul_u32_u24 v221, 176, v6
v_mfma_f32_16x16x32_bf16 v[52:55], a[160:163], a[32:35], v[52:55]
ds_read_b128 a[212:215], v126 offset:5120
buffer_load_dwordx2 v[108:109], v129, s[8:11], s63 offen sc1
v_mfma_f32_16x16x32_bf16 v[80:83], a[160:163], a[36:39], v[80:83]
buffer_load_dwordx4 v1, s[4:7], s39 offen offset:3072 sc1 lds
v_and_b32 v6, 3, v2
v_mfma_f32_16x16x32_bf16 v[92:95], a[172:175], a[176:179], v[92:95]
s_mov_b32 s63, 2441216
v_mfma_f32_16x16x32_bf16 v[96:99], a[160:163], a[176:179], v[96:99]
s_add_u32 m0, m0, 4096
v_mfma_f32_16x16x32_bf16 v[56:59], a[164:167], a[32:35], v[56:59]
s_add_u32 s39, s39, 4096
v_lshl_add_u32 v221, v6, 3, v221
v_mfma_f32_16x16x32_bf16 v[84:87], a[164:167], a[36:39], v[84:87]
v_mfma_f32_16x16x32_bf16 v[60:63], a[168:171], a[32:35], v[60:63]
v_add_u32 v221, 0, v221
v_mfma_f32_16x16x32_bf16 v[88:91], a[168:171], a[36:39], v[88:91]
s_waitcnt vmcnt(16) lgkmcnt(0)
v_mfma_f32_16x16x32_bf16 v[36:39], a[180:183], a[40:43], v[36:39]
ds_read_b128 a[144:147], v1 offset:43008
v_mfma_f32_16x16x32_bf16 v[64:67], a[180:183], a[44:47], v[64:67]
ds_read_b128 a[148:151], v1 offset:44032
buffer_load_dwordx2 v[110:111], v129, s[8:11], s63 offen sc1
v_mfma_f32_16x16x32_bf16 v[40:43], a[184:187], a[40:43], v[40:43]
ds_read_b128 a[152:155], v1 offset:45056
v_mov_b32 v171, 0
v_mfma_f32_16x16x32_bf16 v[68:71], a[184:187], a[44:47], v[68:71]
ds_read_b128 a[156:159], v1 offset:46080
v_mov_b32 v172, 0
v_mfma_f32_16x16x32_bf16 v[44:47], a[188:191], a[40:43], v[44:47]
ds_read_b128 a[160:163], v1 offset:47104
buffer_load_dwordx4 v1, s[4:7], s39 offen offset:0 sc1 lds
v_mfma_f32_16x16x32_bf16 v[72:75], a[188:191], a[44:47], v[72:75]
ds_read_b128 a[164:167], v1 offset:48128
s_mov_b32 s63, 2457600
v_mfma_f32_16x16x32_bf16 v[48:51], a[192:195], a[40:43], v[48:51]
ds_read_b128 a[168:171], v1 offset:49152
v_mov_b32 v179, 0
v_mfma_f32_16x16x32_bf16 v[76:79], a[192:195], a[44:47], v[76:79]
ds_read_b128 a[172:175], v125 offset:43008
v_mfma_f32_16x16x32_bf16 v[52:55], a[196:199], a[40:43], v[52:55]
ds_read_b128 a[176:179], v126 offset:6144
buffer_load_dwordx4 v1, s[4:7], s39 offen offset:1024 sc1 lds
v_mfma_f32_16x16x32_bf16 v[80:83], a[196:199], a[44:47], v[80:83]
v_mov_b32 v180, 0
v_mfma_f32_16x16x32_bf16 v[92:95], a[208:211], a[212:215], v[92:95]
buffer_load_dwordx2 v[112:113], v129, s[8:11], s63 offen sc1
v_mfma_f32_16x16x32_bf16 v[96:99], a[196:199], a[212:215], v[96:99]
s_mov_b32 s63, 2473984
s_mul_i32 s30, s60, 18432
v_mfma_f32_16x16x32_bf16 v[56:59], a[200:203], a[40:43], v[56:59]
buffer_load_dwordx4 v1, s[4:7], s39 offen offset:2048 sc1 lds
v_mfma_f32_16x16x32_bf16 v[84:87], a[200:203], a[44:47], v[84:87]
s_add_u32 s30, s30, 2490368
v_mfma_f32_16x16x32_bf16 v[60:63], a[204:207], a[40:43], v[60:63]
s_lshl_b32 s64, s26, 10
v_mfma_f32_16x16x32_bf16 v[88:91], a[204:207], a[44:47], v[88:91]
s_add_u32 s64, s64, s30
s_waitcnt vmcnt(19) lgkmcnt(0)
v_mfma_f32_16x16x32_bf16 v[36:39], a[144:147], a[48:51], v[36:39]
ds_read_b128 a[180:183], v1 offset:50176
buffer_load_dwordx4 v1, s[4:7], s39 offen offset:3072 sc1 lds
v_mfma_f32_16x16x32_bf16 v[64:67], a[144:147], a[52:55], v[64:67]
ds_read_b128 a[184:187], v1 offset:51200
v_mfma_f32_16x16x32_bf16 v[40:43], a[148:151], a[48:51], v[40:43]
ds_read_b128 a[188:191], v1 offset:52224
buffer_load_dwordx2 v[114:115], v129, s[8:11], s63 offen sc1
v_mfma_f32_16x16x32_bf16 v[68:71], a[148:151], a[52:55], v[68:71]
ds_read_b128 a[192:195], v1 offset:53248
v_mfma_f32_16x16x32_bf16 v[44:47], a[152:155], a[48:51], v[44:47]
ds_read_b128 a[196:199], v1 offset:54272
s_add_u32 m0, m0, 4096
v_mfma_f32_16x16x32_bf16 v[72:75], a[152:155], a[52:55], v[72:75]
ds_read_b128 a[200:203], v1 offset:55296
s_and_b32 s65, s26, 1
v_mfma_f32_16x16x32_bf16 v[48:51], a[156:159], a[48:51], v[48:51]
ds_read_b128 a[204:207], v1 offset:56320
buffer_load_dwordx4 a[76:79], v237, s[8:11], s62 offen offset:1024 sc1
v_mfma_f32_16x16x32_bf16 v[76:79], a[156:159], a[52:55], v[76:79]
ds_read_b128 a[208:211], v125 offset:50176
s_lshl_b32 s65, s65, 10
v_mfma_f32_16x16x32_bf16 v[52:55], a[160:163], a[48:51], v[52:55]
ds_read_b128 a[212:215], v126 offset:7168
s_add_u32 s39, s39, 4096
v_mfma_f32_16x16x32_bf16 v[80:83], a[160:163], a[52:55], v[80:83]
s_add_u32 s30, s30, s65
v_mfma_f32_16x16x32_bf16 v[92:95], a[172:175], a[176:179], v[92:95]
s_lshr_b32 s65, s26, 1
v_mfma_f32_16x16x32_bf16 v[96:99], a[160:163], a[176:179], v[96:99]
buffer_load_dwordx4 a[80:83], v1, s[8:11], s62 offen offset:2048 sc1
v_mfma_f32_16x16x32_bf16 v[56:59], a[164:167], a[48:51], v[56:59]
buffer_load_dwordx4 v1, s[4:7], s39 offen offset:0 sc1 lds
v_mfma_f32_16x16x32_bf16 v[84:87], a[164:167], a[52:55], v[84:87]
s_lshl_b32 s65, s65, 7
v_mfma_f32_16x16x32_bf16 v[60:63], a[168:171], a[48:51], v[60:63]
s_add_u32 s65, s65, s30
v_mfma_f32_16x16x32_bf16 v[88:91], a[168:171], a[52:55], v[88:91]
buffer_load_dwordx4 a[84:87], v237, s[8:11], s62 offen offset:2048 sc1
s_waitcnt vmcnt(23) lgkmcnt(0)
v_mfma_f32_16x16x32_bf16 v[36:39], a[180:183], a[56:59], v[36:39]
ds_read_b128 a[144:147], v1 offset:57344
buffer_load_dwordx4 v1, s[4:7], s39 offen offset:1024 sc1 lds
v_mfma_f32_16x16x32_bf16 v[64:67], a[180:183], a[60:63], v[64:67]
ds_read_b128 a[148:151], v1 offset:58368
v_mfma_f32_16x16x32_bf16 v[40:43], a[184:187], a[56:59], v[40:43]
ds_read_b128 a[152:155], v1 offset:59392
v_mfma_f32_16x16x32_bf16 v[68:71], a[184:187], a[60:63], v[68:71]
ds_read_b128 a[156:159], v1 offset:60416
buffer_load_dwordx4 a[88:91], v1, s[8:11], s62 offen offset:3072 sc1
v_mfma_f32_16x16x32_bf16 v[44:47], a[188:191], a[56:59], v[44:47]
ds_read_b128 a[160:163], v1 offset:61440
buffer_load_dwordx4 v1, s[4:7], s39 offen offset:2048 sc1 lds
v_mfma_f32_16x16x32_bf16 v[72:75], a[188:191], a[60:63], v[72:75]
ds_read_b128 a[164:167], v1 offset:62464
s_add_u32 s65, s65, 16384
v_mfma_f32_16x16x32_bf16 v[48:51], a[192:195], a[56:59], v[48:51]
ds_read_b128 a[168:171], v1 offset:63488
v_mov_b32 v224, 1073741824
v_mfma_f32_16x16x32_bf16 v[76:79], a[192:195], a[60:63], v[76:79]
ds_read_b128 a[172:175], v125 offset:57344
v_mfma_f32_16x16x32_bf16 v[52:55], a[196:199], a[56:59], v[52:55]
ds_read_b128 a[176:179], v126 offset:8192
buffer_load_dwordx4 a[92:95], v237, s[8:11], s62 offen offset:3072 sc1
v_mfma_f32_16x16x32_bf16 v[80:83], a[196:199], a[60:63], v[80:83]
buffer_load_dwordx4 v1, s[4:7], s39 offen offset:3072 sc1 lds
v_lshlrev_b32 v225, 3, v2
v_mfma_f32_16x16x32_bf16 v[92:95], a[208:211], a[212:215], v[92:95]
s_add_u32 s62, s62, 4096
v_mfma_f32_16x16x32_bf16 v[96:99], a[196:199], a[212:215], v[96:99]
v_cndmask_b32 v224, v224, v225, s[46:47]
v_mfma_f32_16x16x32_bf16 v[56:59], a[200:203], a[56:59], v[56:59]
buffer_load_dwordx2 v[148:149], v146, s[4:7], s66 offen sc1
v_mfma_f32_16x16x32_bf16 v[84:87], a[200:203], a[60:63], v[84:87]
v_mfma_f32_16x16x32_bf16 v[60:63], a[204:207], a[56:59], v[60:63]
v_add_u32 v225, 18432, v224
v_mfma_f32_16x16x32_bf16 v[88:91], a[204:207], a[60:63], v[88:91]
s_waitcnt vmcnt(27) lgkmcnt(0)
v_add_u32 v125, 64512, v125
v_mfma_f32_16x16x32_bf16 v[36:39], a[144:147], a[64:67], v[36:39]
ds_read_b128 a[180:183], v8 offset:0
buffer_load_dwordx4 a[96:99], v1, s[8:11], s62 offen offset:0 sc1
v_mfma_f32_16x16x32_bf16 v[64:67], a[144:147], a[68:71], v[64:67]
ds_read_b128 a[184:187], v8 offset:1024
v_mfma_f32_16x16x32_bf16 v[40:43], a[148:151], a[64:67], v[40:43]
ds_read_b128 a[188:191], v8 offset:2048
v_mfma_f32_16x16x32_bf16 v[68:71], a[148:151], a[68:71], v[68:71]
ds_read_b128 a[192:195], v8 offset:3072
v_mfma_f32_16x16x32_bf16 v[44:47], a[152:155], a[64:67], v[44:47]
ds_read_b128 a[196:199], v8 offset:4096
buffer_load_dwordx4 a[100:103], v237, s[8:11], s62 offen offset:0 sc1
v_mfma_f32_16x16x32_bf16 v[72:75], a[152:155], a[68:71], v[72:75]
ds_read_b128 a[200:203], v8 offset:5120
v_mfma_f32_16x16x32_bf16 v[48:51], a[156:159], a[64:67], v[48:51]
ds_read_b128 a[204:207], v8 offset:6144
v_mfma_f32_16x16x32_bf16 v[76:79], a[156:159], a[68:71], v[76:79]
ds_read_b128 a[208:211], v125 offset:0
v_mfma_f32_16x16x32_bf16 v[52:55], a[160:163], a[64:67], v[52:55]
ds_read_b128 a[212:215], v126 offset:9216
v_mfma_f32_16x16x32_bf16 v[80:83], a[160:163], a[68:71], v[80:83]
buffer_load_dwordx4 a[104:107], v1, s[8:11], s62 offen offset:1024 sc1
v_mfma_f32_16x16x32_bf16 v[92:95], a[172:175], a[176:179], v[92:95]
v_mfma_f32_16x16x32_bf16 v[96:99], a[160:163], a[176:179], v[96:99]
v_mfma_f32_16x16x32_bf16 v[56:59], a[164:167], a[64:67], v[56:59]
v_mfma_f32_16x16x32_bf16 v[84:87], a[164:167], a[68:71], v[84:87]
buffer_load_dwordx4 a[108:111], v237, s[8:11], s62 offen offset:1024 sc1
v_mfma_f32_16x16x32_bf16 v[60:63], a[168:171], a[64:67], v[60:63]
v_mfma_f32_16x16x32_bf16 v[88:91], a[168:171], a[68:71], v[88:91]
s_waitcnt vmcnt(13) lgkmcnt(0)
v_mfma_f32_16x16x32_bf16 v[36:39], a[180:183], a[72:75], v[36:39]
ds_read_b128 a[144:147], v8 offset:7168
v_mfma_f32_16x16x32_bf16 v[64:67], a[180:183], a[76:79], v[64:67]
ds_read_b128 a[148:151], v8 offset:8192
buffer_load_dwordx4 a[112:115], v1, s[8:11], s62 offen offset:2048 sc1
v_mfma_f32_16x16x32_bf16 v[40:43], a[184:187], a[72:75], v[40:43]
ds_read_b128 a[152:155], v8 offset:9216
v_add_f32 v130, v100, v102
v_mfma_f32_16x16x32_bf16 v[68:71], a[184:187], a[76:79], v[68:71]
ds_read_b128 a[156:159], v8 offset:10240
v_add_f32 v131, v101, v103
v_mfma_f32_16x16x32_bf16 v[44:47], a[188:191], a[72:75], v[44:47]
ds_read_b128 a[160:163], v8 offset:11264
v_add_f32 v130, v130, v104
v_mfma_f32_16x16x32_bf16 v[72:75], a[188:191], a[76:79], v[72:75]
ds_read_b128 a[164:167], v8 offset:12288
v_add_f32 v131, v131, v105
v_mfma_f32_16x16x32_bf16 v[48:51], a[192:195], a[72:75], v[48:51]
ds_read_b128 a[168:171], v8 offset:13312
buffer_load_dwordx4 a[116:119], v237, s[8:11], s62 offen offset:2048 sc1
v_mfma_f32_16x16x32_bf16 v[76:79], a[192:195], a[76:79], v[76:79]
ds_read_b128 a[172:175], v125 offset:7168
v_add_f32 v130, v130, v106
v_mfma_f32_16x16x32_bf16 v[52:55], a[196:199], a[72:75], v[52:55]
ds_read_b128 a[176:179], v126 offset:10240
v_add_f32 v131, v131, v107
v_mfma_f32_16x16x32_bf16 v[80:83], a[196:199], a[76:79], v[80:83]
v_add_f32 v130, v130, v108
v_add_f32 v131, v131, v109
v_mfma_f32_16x16x32_bf16 v[92:95], a[208:211], a[212:215], v[92:95]
buffer_load_dwordx4 a[120:123], v1, s[8:11], s62 offen offset:3072 sc1
v_add_f32 v130, v130, v110
v_mfma_f32_16x16x32_bf16 v[96:99], a[196:199], a[212:215], v[96:99]
v_add_f32 v131, v131, v111
v_mfma_f32_16x16x32_bf16 v[56:59], a[200:203], a[72:75], v[56:59]
v_add_f32 v130, v130, v112
v_mfma_f32_16x16x32_bf16 v[84:87], a[200:203], a[76:79], v[84:87]
v_add_f32 v131, v131, v113
v_mfma_f32_16x16x32_bf16 v[60:63], a[204:207], a[72:75], v[60:63]
buffer_load_dwordx4 a[124:127], v237, s[8:11], s62 offen offset:3072 sc1
v_add_f32 v130, v130, v114
v_mfma_f32_16x16x32_bf16 v[88:91], a[204:207], a[76:79], v[88:91]
s_add_u32 s62, s62, 4096
v_add_f32 v131, v131, v115
s_waitcnt vmcnt(14) lgkmcnt(0)
v_mfma_f32_16x16x32_bf16 v[36:39], a[144:147], a[80:83], v[36:39]
ds_read_b128 a[180:183], v8 offset:14336
v_mul_f32 v130, 0x3ae38e39, v130
v_mfma_f32_16x16x32_bf16 v[64:67], a[144:147], a[84:87], v[64:67]
ds_read_b128 a[184:187], v8 offset:15360
v_mul_f32 v6, v130, v130
v_mfma_f32_16x16x32_bf16 v[40:43], a[148:151], a[80:83], v[40:43]
ds_read_b128 a[188:191], v8 offset:16384
v_mul_f32 v131, 0x3ae38e39, v131
v_mfma_f32_16x16x32_bf16 v[68:71], a[148:151], a[84:87], v[68:71]
ds_read_b128 a[192:195], v8 offset:17408
v_mfma_f32_16x16x32_bf16 v[44:47], a[152:155], a[80:83], v[44:47]
ds_read_b128 a[196:199], v8 offset:18432
v_sub_f32 v131, v131, v6
v_mfma_f32_16x16x32_bf16 v[72:75], a[152:155], a[84:87], v[72:75]
ds_read_b128 a[200:203], v8 offset:19456
v_max_f32 v131, 0, v131
v_mfma_f32_16x16x32_bf16 v[48:51], a[156:159], a[80:83], v[48:51]
ds_read_b128 a[204:207], v8 offset:20480
v_add_f32 v131, 0x3727c5ac, v131
v_mfma_f32_16x16x32_bf16 v[76:79], a[156:159], a[84:87], v[76:79]
ds_read_b128 a[208:211], v125 offset:14336
buffer_load_dwordx4 a[128:131], v1, s[8:11], s62 offen offset:0 sc1
v_mfma_f32_16x16x32_bf16 v[52:55], a[160:163], a[80:83], v[52:55]
ds_read_b128 a[212:215], v126 offset:11264
v_mfma_f32_16x16x32_bf16 v[80:83], a[160:163], a[84:87], v[80:83]
v_rsq_f32 v132, v131
v_mfma_f32_16x16x32_bf16 v[92:95], a[172:175], a[176:179], v[92:95]
v_cvt_pk_bf16_f32 v6, -v130, -v130
v_and_b32 v6, 0xffff0000, v6
v_mfma_f32_16x16x32_bf16 v[96:99], a[160:163], a[176:179], v[96:99]
buffer_load_dwordx4 a[132:135], v237, s[8:11], s62 offen offset:0 sc1
v_add_f32 v6, v130, v6
v_mfma_f32_16x16x32_bf16 v[56:59], a[164:167], a[80:83], v[56:59]
v_cvt_pk_bf16_f32 v133, -v130, -v6
v_mfma_f32_16x16x32_bf16 v[84:87], a[164:167], a[84:87], v[84:87]
v_mfma_f32_16x16x32_bf16 v[60:63], a[168:171], a[80:83], v[60:63]
v_mfma_f32_16x16x32_bf16 v[88:91], a[168:171], a[84:87], v[88:91]
s_waitcnt vmcnt(10) lgkmcnt(0)
v_cmp_ne_u64 vcc, v[148:149], v[238:239]
s_cmp_eq_u32 s29, 0
s_cselect_b64 vcc, vcc, 0
s_cbranch_vccnz L_dbslow_11
L_dbback_12:
s_barrier
v_mfma_f32_16x16x32_bf16 v[36:39], a[180:183], a[88:91], v[36:39]
ds_read_b128 a[144:147], v8 offset:21504
buffer_load_dwordx4 a[136:139], v1, s[8:11], s62 offen offset:1024 sc1
v_mfma_f32_16x16x32_bf16 v[64:67], a[180:183], a[92:95], v[64:67]
ds_read_b128 a[148:151], v8 offset:22528
v_mfma_f32_16x16x32_bf16 v[40:43], a[184:187], a[88:91], v[40:43]
ds_read_b128 a[152:155], v8 offset:23552
v_mfma_f32_16x16x32_bf16 v[68:71], a[184:187], a[92:95], v[68:71]
ds_read_b128 a[156:159], v8 offset:24576
v_mfma_f32_16x16x32_bf16 v[44:47], a[188:191], a[88:91], v[44:47]
ds_read_b128 a[160:163], v8 offset:25600
buffer_load_dwordx4 a[140:143], v237, s[8:11], s62 offen offset:1024 sc1
v_mfma_f32_16x16x32_bf16 v[72:75], a[188:191], a[92:95], v[72:75]
ds_read_b128 a[164:167], v8 offset:26624
v_mfma_f32_16x16x32_bf16 v[48:51], a[192:195], a[88:91], v[48:51]
ds_read_b128 a[168:171], v8 offset:27648
v_mfma_f32_16x16x32_bf16 v[76:79], a[192:195], a[92:95], v[76:79]
ds_read_b128 a[172:175], v125 offset:21504
v_mfma_f32_16x16x32_bf16 v[52:55], a[196:199], a[88:91], v[52:55]
ds_read_b128 a[176:179], v126 offset:12288
s_mov_b32 s37, L_c2-L_pc
v_mfma_f32_16x16x32_bf16 v[80:83], a[196:199], a[92:95], v[80:83]
ds_bpermute_b32 v116, v124, v133 offset:128
v_mfma_f32_16x16x32_bf16 v[92:95], a[208:211], a[212:215], v[92:95]
ds_bpermute_b32 v118, v124, v133 offset:192
v_mfma_f32_16x16x32_bf16 v[96:99], a[196:199], a[212:215], v[96:99]
ds_bpermute_b32 v120, v124, v133
v_mfma_f32_16x16x32_bf16 v[56:59], a[200:203], a[88:91], v[56:59]
buffer_load_dword v15, v14, s[88:91], s37 offen
ds_bpermute_b32 v134, v124, v132 offset:128
v_mfma_f32_16x16x32_bf16 v[84:87], a[200:203], a[92:95], v[84:87]
ds_bpermute_b32 v135, v124, v132 offset:192
v_mfma_f32_16x16x32_bf16 v[60:63], a[204:207], a[88:91], v[60:63]
v_mfma_f32_16x16x32_bf16 v[88:91], a[204:207], a[92:95], v[88:91]
s_waitcnt vmcnt(11) lgkmcnt(0)
v_mfma_f32_16x16x32_bf16 v[36:39], a[144:147], a[96:99], v[36:39]
ds_read_b128 a[180:183], v8 offset:28672
v_mfma_f32_16x16x32_bf16 v[64:67], a[144:147], a[100:103], v[64:67]
ds_read_b128 a[184:187], v8 offset:29696
v_mfma_f32_16x16x32_bf16 v[40:43], a[148:151], a[96:99], v[40:43]
ds_read_b128 a[188:191], v8 offset:30720
v_mfma_f32_16x16x32_bf16 v[68:71], a[148:151], a[100:103], v[68:71]
ds_read_b128 a[192:195], v8 offset:31744
v_mfma_f32_16x16x32_bf16 v[44:47], a[152:155], a[96:99], v[44:47]
ds_read_b128 a[196:199], v8 offset:32768
s_mul_i32 s36, s28, 82944
v_mfma_f32_16x16x32_bf16 v[72:75], a[152:155], a[100:103], v[72:75]
ds_read_b128 a[200:203], v8 offset:33792
v_mfma_f32_16x16x32_bf16 v[48:51], a[156:159], a[96:99], v[48:51]
ds_read_b128 a[204:207], v8 offset:34816
buffer_store_dwordx4 a[232:235], v1, s[4:7], s101 offen offset:0 sc1
v_mfma_f32_16x16x32_bf16 v[76:79], a[156:159], a[100:103], v[76:79]
ds_read_b128 a[208:211], v125 offset:28672
s_mul_i32 s38, s24, 10240
v_mfma_f32_16x16x32_bf16 v[52:55], a[160:163], a[96:99], v[52:55]
ds_read_b128 a[212:215], v126 offset:13312
v_mfma_f32_16x16x32_bf16 v[80:83], a[160:163], a[100:103], v[80:83]
ds_bpermute_b32 v136, v122, v132 offset:0
v_mfma_f32_16x16x32_bf16 v[92:95], a[172:175], a[176:179], v[92:95]
ds_bpermute_b32 v137, v123, v132 offset:0
v_mfma_f32_16x16x32_bf16 v[96:99], a[160:163], a[176:179], v[96:99]
ds_bpermute_b32 v138, v122, v132 offset:64
s_add_u32 m0, s38, 37888
v_mfma_f32_16x16x32_bf16 v[56:59], a[164:167], a[96:99], v[56:59]
ds_bpermute_b32 v139, v123, v132 offset:64
v_mfma_f32_16x16x32_bf16 v[84:87], a[164:167], a[100:103], v[84:87]
s_add_u32 s39, s38, s36
v_mfma_f32_16x16x32_bf16 v[60:63], a[168:171], a[96:99], v[60:63]
buffer_store_dwordx4 a[236:239], v1, s[4:7], s101 offen offset:1024 sc1
v_mfma_f32_16x16x32_bf16 v[88:91], a[168:171], a[100:103], v[88:91]
s_add_u32 s39, s39, 2121728
s_waitcnt vmcnt(11) lgkmcnt(0)
v_mfma_f32_16x16x32_bf16 v[36:39], a[180:183], a[104:107], v[36:39]
ds_read_b128 a[144:147], v8 offset:35840
v_mov_b32 v117, v116
v_mfma_f32_16x16x32_bf16 v[64:67], a[180:183], a[108:111], v[64:67]
ds_read_b128 a[148:151], v8 offset:36864
v_mfma_f32_16x16x32_bf16 v[40:43], a[184:187], a[104:107], v[40:43]
ds_read_b128 a[152:155], v8 offset:37888
v_mov_b32 v119, v118
v_mfma_f32_16x16x32_bf16 v[68:71], a[184:187], a[108:111], v[68:71]
ds_read_b128 a[156:159], v8 offset:38912
v_mfma_f32_16x16x32_bf16 v[44:47], a[188:191], a[104:107], v[44:47]
ds_read_b128 a[160:163], v8 offset:39936
v_mov_b32 v121, v120
v_mfma_f32_16x16x32_bf16 v[72:75], a[188:191], a[108:111], v[72:75]
ds_read_b128 a[164:167], v8 offset:40960
v_mfma_f32_16x16x32_bf16 v[48:51], a[192:195], a[104:107], v[48:51]
ds_read_b128 a[168:171], v8 offset:41984
v_mfma_f32_16x16x32_bf16 v[76:79], a[192:195], a[108:111], v[76:79]
ds_read_b128 a[172:175], v125 offset:35840
buffer_load_dwordx4 v1, s[4:7], s39 offen offset:0 sc1 lds
v_mfma_f32_16x16x32_bf16 v[52:55], a[196:199], a[104:107], v[52:55]
ds_read_b128 a[176:179], v126 offset:14336
buffer_store_dwordx4 a[240:243], v1, s[4:7], s101 offen offset:2048 sc1
v_mfma_f32_16x16x32_bf16 v[80:83], a[196:199], a[108:111], v[80:83]
v_mul_f32 v134, 0x3eae1a93, v134
v_mul_f32 v135, 0x3eae1a93, v135
v_mfma_f32_16x16x32_bf16 v[92:95], a[208:211], a[212:215], v[92:95]
v_mfma_f32_16x16x32_bf16 v[96:99], a[196:199], a[212:215], v[96:99]
buffer_load_dwordx4 v1, s[4:7], s39 offen offset:1024 sc1 lds
v_mul_f32 v140, v134, v136
v_mfma_f32_16x16x32_bf16 v[56:59], a[200:203], a[104:107], v[56:59]
v_mfma_f32_16x16x32_bf16 v[84:87], a[200:203], a[108:111], v[84:87]
v_mfma_f32_16x16x32_bf16 v[60:63], a[204:207], a[104:107], v[60:63]
v_mul_f32 v141, v134, v137
v_mfma_f32_16x16x32_bf16 v[88:91], a[204:207], a[108:111], v[88:91]
buffer_load_dwordx4 v1, s[4:7], s39 offen offset:2048 sc1 lds
s_waitcnt vmcnt(13) lgkmcnt(0)
v_mfma_f32_16x16x32_bf16 v[36:39], a[144:147], a[112:115], v[36:39]
ds_read_b128 a[180:183], v8 offset:43008
buffer_store_dwordx4 a[244:247], v1, s[4:7], s101 offen offset:3072 sc1
v_mfma_f32_16x16x32_bf16 v[64:67], a[144:147], a[116:119], v[64:67]
ds_read_b128 a[184:187], v8 offset:44032
v_mul_f32 v142, v135, v138
v_mfma_f32_16x16x32_bf16 v[40:43], a[148:151], a[112:115], v[40:43]
ds_read_b128 a[188:191], v8 offset:45056
v_mul_f32 v143, v135, v139
v_mfma_f32_16x16x32_bf16 v[68:71], a[148:151], a[116:119], v[68:71]
ds_read_b128 a[192:195], v8 offset:46080
buffer_load_dwordx4 v1, s[4:7], s39 offen offset:3072 sc1 lds
v_mfma_f32_16x16x32_bf16 v[44:47], a[152:155], a[112:115], v[44:47]
ds_read_b128 a[196:199], v8 offset:47104
v_mfma_f32_16x16x32_bf16 v[72:75], a[152:155], a[116:119], v[72:75]
ds_read_b128 a[200:203], v8 offset:48128
v_mfma_f32_16x16x32_bf16 v[48:51], a[156:159], a[112:115], v[48:51]
ds_read_b128 a[204:207], v8 offset:49152
v_mfma_f32_16x16x32_bf16 v[76:79], a[156:159], a[116:119], v[76:79]
ds_read_b128 a[208:211], v125 offset:43008
s_add_u32 m0, m0, 4096
v_mfma_f32_16x16x32_bf16 v[52:55], a[160:163], a[112:115], v[52:55]
ds_read_b128 a[212:215], v126 offset:15360
v_mfma_f32_16x16x32_bf16 v[80:83], a[160:163], a[116:119], v[80:83]
ds_read_b64 a[216:217], v127 offset:0
buffer_store_dwordx4 a[248:251], v9, s[4:7], s101 offen offset:0 sc1
v_mfma_f32_16x16x32_bf16 v[92:95], a[172:175], a[176:179], v[92:95]
ds_read_b64 a[218:219], v127 offset:512
v_mfma_f32_16x16x32_bf16 v[96:99], a[160:163], a[176:179], v[96:99]
s_cmp_eq_u32 s60, 0
s_cselect_b32 s30, 0xf149f2ca, 0
s_add_u32 s39, s39, 4096
v_mfma_f32_16x16x32_bf16 v[56:59], a[164:167], a[112:115], v[56:59]
ds_read_b64 a[220:221], v127 offset:1024
v_mov_b32 v6, s30
v_mfma_f32_16x16x32_bf16 v[84:87], a[164:167], a[116:119], v[84:87]
ds_read_b64 a[222:223], v127 offset:1536
v_cndmask_b32 v144, v6, 0, s[42:43]
v_mfma_f32_16x16x32_bf16 v[60:63], a[168:171], a[112:115], v[60:63]
v_cndmask_b32 v145, v6, 0, s[44:45]
v_mfma_f32_16x16x32_bf16 v[88:91], a[168:171], a[116:119], v[88:91]
buffer_load_dwordx4 v1, s[4:7], s39 offen offset:0 sc1 lds
s_waitcnt vmcnt(15) lgkmcnt(0)
v_mfma_f32_16x16x32_bf16 v[36:39], a[180:183], a[120:123], v[36:39]
ds_read_b128 a[144:147], v8 offset:50176
v_mfma_f32_16x16x32_bf16 v[64:67], a[180:183], a[124:127], v[64:67]
ds_read_b128 a[148:151], v8 offset:51200
buffer_store_dwordx4 a[252:255], v9, s[4:7], s101 offen offset:1024 sc1
v_mfma_f32_16x16x32_bf16 v[40:43], a[184:187], a[120:123], v[40:43]
ds_read_b128 a[152:155], v8 offset:52224
v_mfma_f32_16x16x32_bf16 v[68:71], a[184:187], a[124:127], v[68:71]
ds_read_b128 a[156:159], v8 offset:53248
buffer_load_dwordx4 v1, s[4:7], s39 offen offset:1024 sc1 lds
v_mfma_f32_16x16x32_bf16 v[44:47], a[188:191], a[120:123], v[44:47]
ds_read_b128 a[160:163], v8 offset:54272
v_mfma_f32_16x16x32_bf16 v[72:75], a[188:191], a[124:127], v[72:75]
ds_read_b128 a[164:167], v8 offset:55296
v_mfma_f32_16x16x32_bf16 v[48:51], a[192:195], a[120:123], v[48:51]
ds_read_b128 a[168:171], v8 offset:56320
v_mfma_f32_16x16x32_bf16 v[76:79], a[192:195], a[124:127], v[76:79]
ds_read_b128 a[172:175], v125 offset:50176
buffer_load_dwordx4 v1, s[4:7], s39 offen offset:2048 sc1 lds
v_mfma_f32_16x16x32_bf16 v[52:55], a[196:199], a[120:123], v[52:55]
ds_read_b128 a[176:179], v126 offset:16384
v_mfma_f32_16x16x32_bf16 v[80:83], a[196:199], a[124:127], v[80:83]
ds_read_b64 a[224:225], v127 offset:2048
v_mfma_f32_16x16x32_bf16 v[92:95], a[208:211], a[212:215], v[92:95]
ds_read_b64 a[226:227], v127 offset:2560
buffer_store_dwordx4 v[240:243], v9, s[4:7], s101 offen offset:2048 sc1
v_mfma_f32_16x16x32_bf16 v[96:99], a[196:199], a[212:215], v[96:99]
buffer_load_dwordx4 v1, s[4:7], s39 offen offset:3072 sc1 lds
v_mfma_f32_16x16x32_bf16 v[56:59], a[200:203], a[120:123], v[56:59]
ds_read_b64 a[228:229], v127 offset:3072
v_mfma_f32_16x16x32_bf16 v[84:87], a[200:203], a[124:127], v[84:87]
ds_read_b64 a[230:231], v128
v_mfma_f32_16x16x32_bf16 v[60:63], a[204:207], a[120:123], v[60:63]
s_add_u32 m0, m0, 4096
v_mfma_f32_16x16x32_bf16 v[88:91], a[204:207], a[124:127], v[88:91]
s_add_u32 s39, s39, 4096
s_waitcnt vmcnt(18) lgkmcnt(0)
v_mfma_f32_16x16x32_bf16 v[36:39], a[144:147], a[128:131], v[36:39]
ds_read_b128 a[180:183], v8 offset:57344
v_mfma_f32_16x16x32_bf16 v[64:67], a[144:147], a[132:135], v[64:67]
ds_read_b128 a[184:187], v8 offset:58368
v_mfma_f32_16x16x32_bf16 v[40:43], a[148:151], a[128:131], v[40:43]
ds_read_b128 a[188:191], v8 offset:59392
v_mfma_f32_16x16x32_bf16 v[68:71], a[148:151], a[132:135], v[68:71]
ds_read_b128 a[192:195], v8 offset:60416
buffer_store_dwordx4 v[244:247], v9, s[4:7], s101 offen offset:3072 sc1
v_mfma_f32_16x16x32_bf16 v[44:47], a[152:155], a[128:131], v[44:47]
ds_read_b128 a[196:199], v8 offset:61440
v_mfma_f32_16x16x32_bf16 v[72:75], a[152:155], a[132:135], v[72:75]
ds_read_b128 a[200:203], v8 offset:62464
v_mfma_f32_16x16x32_bf16 v[48:51], a[156:159], a[128:131], v[48:51]
ds_read_b128 a[204:207], v8 offset:63488
v_mfma_f32_16x16x32_bf16 v[76:79], a[156:159], a[132:135], v[76:79]
ds_read_b128 a[208:211], v125 offset:57344
buffer_load_dwordx4 v1, s[4:7], s39 offen offset:0 sc1 lds
v_mfma_f32_16x16x32_bf16 v[52:55], a[160:163], a[128:131], v[52:55]
ds_read_b128 a[212:215], v126 offset:17408
v_mfma_f32_16x16x32_bf16 v[80:83], a[160:163], a[132:135], v[80:83]
s_mov_b32 s101, 1073741824
v_mfma_f32_16x16x32_bf16 v[92:95], a[172:175], a[176:179], v[92:95]
v_mfma_f32_16x16x32_bf16 v[96:99], a[160:163], a[176:179], v[96:99]
buffer_load_dwordx4 v1, s[4:7], s39 offen offset:1024 sc1 lds
v_mfma_f32_16x16x32_bf16 v[56:59], a[164:167], a[128:131], v[56:59]
v_mfma_f32_16x16x32_bf16 v[84:87], a[164:167], a[132:135], v[84:87]
v_mfma_f32_16x16x32_bf16 v[60:63], a[168:171], a[128:131], v[60:63]
v_mfma_f32_16x16x32_bf16 v[88:91], a[168:171], a[132:135], v[88:91]
s_waitcnt vmcnt(19) lgkmcnt(0)
v_mfma_f32_16x16x32_bf16 v[36:39], a[180:183], a[136:139], v[36:39]
v_mfma_f32_16x16x32_bf16 v[64:67], a[180:183], a[140:143], v[64:67]
v_mfma_f32_16x16x16_bf16 v[36:39], a[216:217], v[116:117], v[36:39]
v_mfma_f32_16x16x16_bf16 v[64:67], a[216:217], v[118:119], v[64:67]
v_mfma_f32_16x16x32_bf16 v[40:43], a[184:187], a[136:139], v[40:43]
v_mfma_f32_16x16x32_bf16 v[68:71], a[184:187], a[140:143], v[68:71]
s_nop 1
v_mfma_f32_16x16x16_bf16 v[40:43], a[218:219], v[116:117], v[40:43]
s_nop 1
v_mfma_f32_16x16x16_bf16 v[68:71], a[218:219], v[118:119], v[68:71]
v_cvt_pk_bf16_f32 v156, v36, v37
v_cvt_pk_bf16_f32 v157, v38, v39
v_mfma_f32_16x16x32_bf16 v[44:47], a[188:191], a[136:139], v[44:47]
ds_write_b64 v218, v[156:157] offset:2816
v_mfma_f32_16x16x32_bf16 v[72:75], a[188:191], a[140:143], v[72:75]
v_cvt_pk_bf16_f32 v162, v64, v65
v_cvt_pk_bf16_f32 v163, v66, v67
v_mfma_f32_16x16x16_bf16 v[44:47], a[220:221], v[116:117], v[44:47]
ds_write_b64 v218, v[162:163] offset:5632
v_mfma_f32_16x16x16_bf16 v[72:75], a[220:221], v[118:119], v[72:75]
v_cvt_pk_bf16_f32 v160, v40, v41
v_cvt_pk_bf16_f32 v161, v42, v43
v_mfma_f32_16x16x32_bf16 v[48:51], a[192:195], a[136:139], v[48:51]
ds_write_b64 v218, v[160:161] offset:2848
v_mfma_f32_16x16x32_bf16 v[76:79], a[192:195], a[140:143], v[76:79]
v_cvt_pk_bf16_f32 v166, v68, v69
v_cvt_pk_bf16_f32 v167, v70, v71
v_mfma_f32_16x16x16_bf16 v[48:51], a[222:223], v[116:117], v[48:51]
ds_write_b64 v218, v[166:167] offset:5664
v_mfma_f32_16x16x16_bf16 v[76:79], a[222:223], v[118:119], v[76:79]
v_cvt_pk_bf16_f32 v202, v44, v45
v_cvt_pk_bf16_f32 v203, v46, v47
v_mfma_f32_16x16x32_bf16 v[52:55], a[196:199], a[136:139], v[52:55]
ds_write_b64 v218, v[202:203] offset:2880
v_mfma_f32_16x16x32_bf16 v[80:83], a[196:199], a[140:143], v[80:83]
v_cvt_pk_bf16_f32 v204, v72, v73
v_cvt_pk_bf16_f32 v205, v74, v75
v_mfma_f32_16x16x16_bf16 v[52:55], a[224:225], v[116:117], v[52:55]
ds_write_b64 v218, v[204:205] offset:5696
v_mfma_f32_16x16x16_bf16 v[80:83], a[224:225], v[118:119], v[80:83]
v_cvt_pk_bf16_f32 v206, v48, v49
v_cvt_pk_bf16_f32 v207, v50, v51
v_mfma_f32_16x16x32_bf16 v[92:95], a[208:211], a[212:215], v[92:95]
ds_write_b64 v218, v[206:207] offset:2912
v_mfma_f32_16x16x32_bf16 v[96:99], a[196:199], a[212:215], v[96:99]
v_cvt_pk_bf16_f32 v208, v76, v77
v_cvt_pk_bf16_f32 v209, v78, v79
v_mfma_f32_16x16x16_bf16 v[92:95], a[230:231], v[120:121], v[92:95]
ds_write_b64 v218, v[208:209] offset:5728
v_mfma_f32_16x16x16_bf16 v[96:99], a[224:225], v[120:121], v[96:99]
v_cvt_pk_bf16_f32 v210, v52, v53
v_cvt_pk_bf16_f32 v211, v54, v55
v_mfma_f32_16x16x32_bf16 v[56:59], a[200:203], a[136:139], v[56:59]
ds_write_b64 v218, v[210:211] offset:2944
v_mfma_f32_16x16x32_bf16 v[84:87], a[200:203], a[140:143], v[84:87]
v_cvt_pk_bf16_f32 v212, v80, v81
v_cvt_pk_bf16_f32 v213, v82, v83
v_mfma_f32_16x16x16_bf16 v[56:59], a[226:227], v[116:117], v[56:59]
ds_write_b64 v218, v[212:213] offset:5760
v_mfma_f32_16x16x16_bf16 v[84:87], a[226:227], v[118:119], v[84:87]
v_cvt_pk_bf16_f32 v214, v92, v93
v_cvt_pk_bf16_f32 v215, v94, v95
v_mfma_f32_16x16x32_bf16 v[60:63], a[204:207], a[136:139], v[60:63]
ds_write_b64 v222, v[214:215]
v_mfma_f32_16x16x32_bf16 v[88:91], a[204:207], a[140:143], v[88:91]
v_cvt_pk_bf16_f32 v216, v96, v97
v_cvt_pk_bf16_f32 v217, v98, v99
v_mfma_f32_16x16x16_bf16 v[60:63], a[228:229], v[116:117], v[60:63]
ds_write_b64 v219, v[216:217] offset:128
v_mfma_f32_16x16x16_bf16 v[88:91], a[228:229], v[118:119], v[88:91]
s_waitcnt lgkmcnt(0)
s_barrier
ds_read_b64 v[150:151], v218
ds_read_b64 v[154:155], v218 offset:32
ds_read_b64 v[152:153], v220 offset:136
ds_read_b64 v[158:159], v220 offset:2952
ds_read_b64 v[164:165], v220 offset:5768
s_mul_i32 s36, s28, 82944
s_mul_i32 s38, s24, 11264
s_add_u32 m0, s38, 78848
s_add_u32 s39, s38, s36
s_add_u32 s39, s39, 2162688
buffer_load_dwordx4 v1, s[4:7], s39 offen offset:0 sc1 lds
buffer_load_dwordx4 v1, s[4:7], s39 offen offset:1024 sc1 lds
v_cndmask_b32 v170, 0, v210, s[48:49]
v_cndmask_b32 v173, 0, v211, s[48:49]
v_cndmask_b32 v178, 0, v212, s[48:49]
v_cndmask_b32 v181, 0, v213, s[48:49]
v_cvt_pk_bf16_f32 v168, v56, v57
v_cvt_pk_bf16_f32 v169, v58, v59
v_cvt_pk_bf16_f32 v176, v84, v85
v_cvt_pk_bf16_f32 v177, v86, v87
v_cvt_pk_bf16_f32 v174, v60, v61
v_cvt_pk_bf16_f32 v175, v62, v63
v_cvt_pk_bf16_f32 v182, v88, v89
v_cvt_pk_bf16_f32 v183, v90, v91
s_waitcnt lgkmcnt(0)
ds_read_b64_tr_b16 v[184:185], v221 offset:64
v_mfma_f32_16x16x32_bf16 v[36:39], v[150:153], v[168:171], 0
ds_read_b64_tr_b16 v[186:187], v221 offset:2880
v_mfma_f32_16x16x32_bf16 v[40:43], v[156:159], v[168:171], 0
ds_read_b64_tr_b16 v[188:189], v221 offset:5696
buffer_load_dwordx4 v1, s[4:7], s39 offen offset:2048 sc1 lds
v_mfma_f32_16x16x32_bf16 v[44:47], v[152:155], v[172:175], 0
ds_read_b64_tr_b16 v[190:191], v221 offset:96
v_mfma_f32_16x16x32_bf16 v[48:51], v[158:161], v[172:175], 0
ds_read_b64_tr_b16 v[192:193], v221 offset:2912
buffer_load_dwordx4 v1, s[4:7], s39 offen offset:3072 sc1 lds
v_mfma_f32_16x16x32_bf16 v[52:55], v[156:159], v[176:179], 0
ds_read_b64_tr_b16 v[194:195], v221 offset:5728
v_mfma_f32_16x16x32_bf16 v[56:59], v[162:165], v[176:179], 0
ds_read_b64_tr_b16 v[196:197], v221 offset:128
s_add_u32 m0, m0, 4096
s_add_u32 s39, s39, 4096
buffer_load_dwordx4 v1, s[4:7], s39 offen offset:0 sc1 lds
v_mfma_f32_16x16x32_bf16 v[60:63], v[158:161], v[180:183], 0
ds_read_b64_tr_b16 v[198:199], v221 offset:2944
v_mfma_f32_16x16x32_bf16 v[64:67], v[164:167], v[180:183], 0
ds_read_b64_tr_b16 v[200:201], v221 offset:5760
buffer_load_dwordx4 v1, s[4:7], s39 offen offset:1024 sc1 lds
v_cndmask_b32 v36, v36, v37, s[40:41]
v_cndmask_b32 v40, v40, v41, s[40:41]
v_cndmask_b32 v36, v36, v40, s[42:43]
v_fma_f32 v68, v36, v140, v144
v_cndmask_b32 v38, v38, v39, s[40:41]
v_cndmask_b32 v42, v42, v43, s[40:41]
v_cndmask_b32 v38, v38, v42, s[44:45]
v_fma_f32 v69, v38, v141, v145
v_max_f32 v76, v68, v69
v_cndmask_b32 v44, v44, v45, s[40:41]
buffer_load_dwordx4 v1, s[4:7], s39 offen offset:2048 sc1 lds
v_cndmask_b32 v48, v48, v49, s[40:41]
v_cndmask_b32 v44, v44, v48, s[42:43]
v_fma_f32 v70, v44, v140, v144
v_cndmask_b32 v46, v46, v47, s[40:41]
v_cndmask_b32 v50, v50, v51, s[40:41]
v_cndmask_b32 v46, v46, v50, s[44:45]
v_fma_f32 v71, v46, v141, v145
v_max_f32 v77, v70, v71
v_cndmask_b32 v52, v52, v53, s[40:41]
v_cndmask_b32 v56, v56, v57, s[40:41]
buffer_load_dwordx4 v1, s[4:7], s39 offen offset:3072 sc1 lds
v_cndmask_b32 v52, v52, v56, s[42:43]
v_mul_f32 v72, v52, v142
v_cndmask_b32 v54, v54, v55, s[40:41]
v_cndmask_b32 v58, v58, v59, s[40:41]
v_cndmask_b32 v54, v54, v58, s[44:45]
v_mul_f32 v73, v54, v143
v_max_f32 v78, v72, v73
v_cndmask_b32 v60, v60, v61, s[40:41]
v_cndmask_b32 v64, v64, v65, s[40:41]
v_cndmask_b32 v60, v60, v64, s[42:43]
s_add_u32 m0, m0, 4096
v_mul_f32 v74, v60, v142
v_cndmask_b32 v62, v62, v63, s[40:41]
v_cndmask_b32 v66, v66, v67, s[40:41]
v_cndmask_b32 v62, v62, v66, s[44:45]
v_mul_f32 v75, v62, v143
v_max_f32 v79, v74, v75
s_nop 1
v_permlane32_swap_b32 v76, v77
v_permlane32_swap_b32 v78, v79
s_add_u32 s39, s39, 4096
v_max_f32 v76, v76, v77
v_max_f32 v78, v78, v79
s_nop 1
v_permlane16_swap_b32 v76, v78
v_max_f32 v76, v76, v78
v_mov_b32 v78, v76
s_nop 1
v_permlane16_swap_b32 v76, v78
v_mov_b32 v77, v76
v_mov_b32 v79, v78
buffer_load_dwordx4 v1, s[4:7], s39 offen offset:0 sc1 lds
s_nop 0
v_permlane32_swap_b32 v76, v77
v_permlane32_swap_b32 v78, v79
v_sub_f32 v68, v68, v76
v_sub_f32 v69, v69, v76
v_sub_f32 v70, v70, v77
v_sub_f32 v71, v71, v77
v_sub_f32 v72, v72, v78
v_sub_f32 v73, v73, v78
v_sub_f32 v74, v74, v79
buffer_load_dwordx4 v1, s[4:7], s39 offen offset:1024 sc1 lds
v_sub_f32 v75, v75, v79
v_exp_f32 v68, v68
v_exp_f32 v69, v69
v_exp_f32 v70, v70
v_exp_f32 v71, v71
v_exp_f32 v72, v72
v_exp_f32 v73, v73
v_exp_f32 v74, v74
v_exp_f32 v75, v75
buffer_load_dwordx4 v1, s[4:7], s39 offen offset:2048 sc1 lds
v_add_f32 v76, v68, v69
v_add_f32 v77, v70, v71
v_add_f32 v78, v72, v73
v_add_f32 v79, v74, v75
v_mul_f32 v68, v68, v136
v_mul_f32 v69, v69, v137
v_mul_f32 v70, v70, v136
v_mul_f32 v71, v71, v137
v_mul_f32 v72, v72, v138
v_mul_f32 v73, v73, v139
v_mul_f32 v74, v74, v138
v_mul_f32 v75, v75, v139
s_nop 1
v_permlane32_swap_b32 v76, v77
v_permlane32_swap_b32 v78, v79
v_add_f32 v76, v76, v77
v_add_f32 v78, v78, v79
s_nop 1
v_permlane16_swap_b32 v76, v78
v_add_f32 v76, v76, v78
v_rcp_f32 v76, v76
s_nop 0
v_mov_b32 v78, v76
s_nop 1
v_permlane16_swap_b32 v76, v78
v_mov_b32 v77, v76
v_mov_b32 v79, v78
s_nop 0
v_permlane32_swap_b32 v76, v77
v_permlane32_swap_b32 v78, v79
s_waitcnt lgkmcnt(0)
v_mul_f32 v68, v68, v76
v_mul_f32 v69, v69, v76
v_cvt_pk_bf16_f32 v68, v68, v69
v_perm_b32 v84, v68, v68, v10
v_perm_b32 v85, v68, v68, v11
v_perm_b32 v86, v68, v68, v12
v_perm_b32 v87, v68, v68, v13
v_mul_f32 v70, v70, v77
v_mul_f32 v71, v71, v77
v_mfma_f32_16x16x32_bf16 v[36:39], v[184:187], v[84:87], 0
v_cvt_pk_bf16_f32 v70, v70, v71
v_perm_b32 v88, v70, v70, v10
v_mfma_f32_16x16x32_bf16 v[40:43], v[196:199], v[84:87], 0
v_perm_b32 v89, v70, v70, v11
v_perm_b32 v90, v70, v70, v12
v_perm_b32 v91, v70, v70, v13
v_mul_f32 v72, v72, v78
v_mul_f32 v73, v73, v78
v_mfma_f32_16x16x32_bf16 v[44:47], v[190:193], v[88:91], 0
v_cvt_pk_bf16_f32 v72, v72, v73
v_perm_b32 v92, v72, v72, v10
v_mfma_f32_16x16x32_bf16 v[48:51], v[196:199], v[88:91], 0
v_perm_b32 v93, v72, v72, v11
v_perm_b32 v94, v72, v72, v12
v_perm_b32 v95, v72, v72, v13
v_mul_f32 v74, v74, v79
v_mul_f32 v75, v75, v79
v_mfma_f32_16x16x32_bf16 v[52:55], v[186:189], v[92:95], 0
v_cvt_pk_bf16_f32 v74, v74, v75
v_perm_b32 v96, v74, v74, v10
v_mfma_f32_16x16x32_bf16 v[56:59], v[198:201], v[92:95], 0
v_perm_b32 v97, v74, v74, v11
v_perm_b32 v98, v74, v74, v12
v_perm_b32 v99, v74, v74, v13
v_cvt_pk_bf16_f32 v168, v36, v37
v_cvt_pk_bf16_f32 v169, v38, v39
v_mfma_f32_16x16x32_bf16 v[60:63], v[192:195], v[96:99], 0
v_mfma_f32_16x16x32_bf16 v[64:67], v[198:201], v[96:99], 0
v_cvt_pk_bf16_f32 v172, v40, v41
v_cvt_pk_bf16_f32 v170, v44, v45
v_cvt_pk_bf16_f32 v171, v46, v47
v_cvt_pk_bf16_f32 v173, v50, v51
buffer_store_dwordx4 v[168:171], v1, s[8:11], s64 offen sc1
buffer_store_dwordx2 v[172:173], v224, s[8:11], s65 offen sc1
v_cvt_pk_bf16_f32 v176, v52, v53
v_cvt_pk_bf16_f32 v177, v54, v55
v_cvt_pk_bf16_f32 v180, v56, v57
v_cvt_pk_bf16_f32 v178, v60, v61
v_cvt_pk_bf16_f32 v179, v62, v63
v_cvt_pk_bf16_f32 v181, v66, v67
buffer_store_dwordx4 v[176:179], v237, s[8:11], s64 offen sc1
buffer_store_dwordx2 v[180:181], v225, s[8:11], s65 offen sc1
L_c2:
s_mul_i32 s38, s24, 9216
s_add_u32 m0, s38, 123904
s_add_u32 s39, s38, s82
buffer_load_dwordx4 v1, s[4:7], s39 offen offset:0 sc1 lds
buffer_load_dwordx4 v1, s[4:7], s39 offen offset:1024 sc1 lds
buffer_load_dwordx4 v1, s[4:7], s39 offen offset:2048 sc1 lds
buffer_load_dwordx4 v1, s[4:7], s39 offen offset:3072 sc1 lds
s_add_u32 m0, m0, 4096
s_add_u32 s39, s39, 4096
buffer_load_dwordx4 v1, s[4:7], s39 offen offset:0 sc1 lds
buffer_load_dwordx4 v1, s[4:7], s39 offen offset:1024 sc1 lds
buffer_load_dwordx4 v1, s[4:7], s39 offen offset:2048 sc1 lds
v_lshlrev_b32 v7, 3, v1
s_lshl_b32 s31, s25, 11
v_add_u32 v7, s31, v7
s_cmp_eq_u32 s24, 0
s_cselect_b32 s30, 0, 1073741824
s_add_u32 s30, s30, 26476544
s_waitcnt vmcnt(7)
s_barrier
s_mov_b64 exec, 0xffff
buffer_atomic_add v4, v7, s[8:11], s30 offen sc1
s_mov_b64 exec, -1
s_lshl_b32 s35, s81, 7
s_add_u32 s35, s35, 26476544
s_cmp_eq_u32 s24, 1
s_cselect_b32 s35, s35, 1073741824
v_mov_b32 v6, 0
v_mov_b32 v244, 0
v_mov_b32 v245, 0
v_mov_b32 v246, 0
buffer_load_dwordx4 v1, s[4:7], s39 offen offset:3072 sc1 lds
s_add_u32 m0, m0, 4096
s_add_u32 s39, s39, 4096
buffer_load_dwordx4 v1, s[4:7], s39 offen offset:0 sc1 lds
s_lshl_b32 s38, s24, 8
s_add_u32 m0, s38, 160768
s_add_u32 s39, s38, s82
s_add_u32 s39, s39, 36864
s_mov_b64 exec, 0xffff
buffer_load_dwordx4 v1, s[4:7], s39 offen sc1 lds
s_mov_b64 exec, -1
s_mul_i32 s38, s24, 9216
s_add_u32 m0, s38, 0
s_add_u32 s39, s38, s82
s_add_u32 s39, s39, 37888
buffer_load_dwordx4 v1, s[4:7], s39 offen offset:0 sc1 lds
s_mov_b64 exec, 1
buffer_atomic_add v244, v6, s[8:11], s35 offen sc0 sc1
s_mov_b64 exec, -1
buffer_load_dwordx4 v1, s[4:7], s39 offen offset:1024 sc1 lds
buffer_load_dwordx4 v1, s[4:7], s39 offen offset:2048 sc1 lds
buffer_load_dwordx4 v1, s[4:7], s39 offen offset:3072 sc1 lds
s_add_u32 m0, m0, 4096
s_add_u32 s39, s39, 4096
s_mov_b64 exec, 1
buffer_atomic_add v245, v6, s[8:11], s35 offen sc0 sc1
s_mov_b64 exec, -1
buffer_load_dwordx4 v1, s[4:7], s39 offen offset:0 sc1 lds
buffer_load_dwordx4 v1, s[4:7], s39 offen offset:1024 sc1 lds
buffer_load_dwordx4 v1, s[4:7], s39 offen offset:2048 sc1 lds
s_mov_b64 exec, 1
buffer_atomic_add v246, v6, s[8:11], s35 offen sc0 sc1
s_mov_b64 exec, -1
buffer_load_dwordx4 v1, s[4:7], s39 offen offset:3072 sc1 lds
s_add_u32 m0, m0, 4096
s_add_u32 s39, s39, 4096
buffer_load_dwordx4 v1, s[4:7], s39 offen offset:0 sc1 lds
s_lshl_b32 s38, s24, 8
s_add_u32 m0, s38, 36864
s_add_u32 s39, s38, s82
s_add_u32 s39, s39, 74752
s_mov_b64 exec, 0xffff
buffer_load_dwordx4 v1, s[4:7], s39 offen sc1 lds
s_mov_b64 exec, -1
s_lshl_b32 s60, s27, 2
s_add_u32 s60, s60, s24
s_mul_i32 s60, s60, 18432
s_add_u32 s60, s60, 2490368
s_cmp_eq_u32 s24, 1
s_cbranch_scc0 L_other_15
s_mov_b32 s31, 0
s_mov_b64 exec, 1
v_mov_b32 v247, 0
buffer_atomic_add v247, v6, s[8:11], s35 offen sc0 sc1
s_waitcnt vmcnt(12)
v_cmp_gt_u32 vcc, 16, v244
s_nop 0
s_cbranch_vccz L_polled_14
s_waitcnt vmcnt(8)
v_cmp_gt_u32 vcc, 16, v245
s_nop 0
s_cbranch_vccz L_polled_14
v_mov_b32 v244, 0
buffer_atomic_add v244, v6, s[8:11], s35 offen sc0 sc1
s_waitcnt vmcnt(5)
v_cmp_gt_u32 vcc, 16, v246
s_nop 0
s_cbranch_vccz L_polled_14
v_mov_b32 v245, 0
buffer_atomic_add v245, v6, s[8:11], s35 offen sc0 sc1
L_poll_13:
s_add_u32 s31, s31, 1
s_cmp_gt_u32 s31, 100000
s_cbranch_scc1 L_polled_14
v_mov_b32 v246, 0
buffer_atomic_add v246, v6, s[8:11], s35 offen sc0 sc1
s_waitcnt vmcnt(3)
v_cmp_gt_u32 vcc, 16, v247
s_nop 0
s_cbranch_vccz L_polled_14
v_mov_b32 v247, 0
buffer_atomic_add v247, v6, s[8:11], s35 offen sc0 sc1
s_waitcnt vmcnt(3)
v_cmp_gt_u32 vcc, 16, v244
s_nop 0
s_cbranch_vccz L_polled_14
v_mov_b32 v244, 0
buffer_atomic_add v244, v6, s[8:11], s35 offen sc0 sc1
s_waitcnt vmcnt(3)
v_cmp_gt_u32 vcc, 16, v245
s_nop 0
s_cbranch_vccz L_polled_14
v_mov_b32 v245, 0
buffer_atomic_add v245, v6, s[8:11], s35 offen sc0 sc1
s_waitcnt vmcnt(3)
v_cmp_gt_u32 vcc, 16, v246
s_nop 0
s_cbranch_vccz L_polled_14
s_branch L_poll_13
L_polled_14:
s_mov_b64 exec, -1
L_other_15:
s_barrier
buffer_load_dwordx4 a[0:3], v1, s[8:11], s60 offen offset:0 sc1
buffer_load_dwordx4 a[4:7], v1, s[8:11], s60 offen offset:1024 sc1
s_barrier
buffer_load_dwordx4 a[8:11], v1, s[8:11], s60 offen offset:2048 sc1
buffer_load_dwordx4 a[12:15], v1, s[8:11], s60 offen offset:3072 sc1
s_barrier
s_add_u32 s60, s60, 4096
buffer_load_dwordx4 a[16:19], v1, s[8:11], s60 offen offset:0 sc1
buffer_load_dwordx4 a[20:23], v1, s[8:11], s60 offen offset:1024 sc1
s_barrier
buffer_load_dwordx4 a[24:27], v1, s[8:11], s60 offen offset:2048 sc1
buffer_load_dwordx4 a[28:31], v1, s[8:11], s60 offen offset:3072 sc1
s_barrier
s_add_u32 s60, s60, 4096
buffer_load_dwordx4 a[32:35], v1, s[8:11], s60 offen offset:0 sc1
v_lshrrev_b32 v40, 1, v1
v_and_b32 v36, 7, v2
v_lshlrev_b32 v36, 4, v36
v_lshl_add_u32 v36, v3, 7, v36
v_add_u32 v36, 4096, v36
v_add_u32 v36, 37888, v36
v_add_u32 v39, 37888, v1
v_add_u32 v37, 79360, v1
v_add_u32 v38, 41472, v36
ds_read_b128 a[72:75], v39 offset:0
ds_read_b128 a[76:79], v39 offset:1024
ds_read_b128 a[80:83], v39 offset:2048
ds_read_b128 a[84:87], v39 offset:3072
ds_read_b128 a[88:91], v36 offset:0
ds_read_b128 a[92:95], v39 offset:4608
ds_read_b128 a[96:99], v39 offset:5632
ds_read_b128 a[100:103], v39 offset:6656
ds_read_b128 a[104:107], v39 offset:7680
ds_read_b128 a[108:111], v36 offset:4608
s_lshl_b32 s30, s27, 2
s_add_u32 s30, s30, s24
v_mov_b32 v58, 1073741824
s_mul_i32 s62, s30, 18432
s_mul_i32 s32, s28, 2304
s_add_u32 s62, s62, s32
s_add_u32 s62, s62, 4849664
v_mov_b32 v60, v1
v_add_u32 v61, 2048, v60
v_cndmask_b32 v61, v58, v61, s[46:47]
s_lshl_b32 s63, s30, 7
s_lshl_b32 s32, s28, 14
s_add_u32 s63, s63, s32
s_add_u32 s63, s63, 7208960
v_lshlrev_b32 v59, 3, v2
v_cndmask_b32 v58, v58, v59, s[46:47]
s_waitcnt vmcnt(8) lgkmcnt(5)
v_mfma_f32_16x16x32_bf16 v[16:19], a[72:75], a[0:3], v[16:19]
ds_read_b128 a[112:115], v39 offset:9216
buffer_load_dwordx4 a[36:39], v1, s[8:11], s60 offen offset:1024 sc1
v_mfma_f32_16x16x32_bf16 v[20:23], a[76:79], a[0:3], v[20:23]
ds_read_b128 a[116:119], v39 offset:10240
v_mfma_f32_16x16x32_bf16 v[24:27], a[80:83], a[0:3], v[24:27]
ds_read_b128 a[120:123], v39 offset:11264
v_mfma_f32_16x16x32_bf16 v[28:31], a[84:87], a[0:3], v[28:31]
ds_read_b128 a[124:127], v39 offset:12288
v_mfma_f32_16x16x32_bf16 v[32:35], a[88:91], a[0:3], v[32:35]
ds_read_b128 a[128:131], v36 offset:9216
s_waitcnt vmcnt(8) lgkmcnt(5)
v_mfma_f32_16x16x32_bf16 v[16:19], a[92:95], a[4:7], v[16:19]
ds_read_b128 a[72:75], v39 offset:13824
buffer_load_dwordx4 a[40:43], v1, s[8:11], s60 offen offset:2048 sc1
v_mfma_f32_16x16x32_bf16 v[20:23], a[96:99], a[4:7], v[20:23]
ds_read_b128 a[76:79], v39 offset:14848
v_mfma_f32_16x16x32_bf16 v[24:27], a[100:103], a[4:7], v[24:27]
ds_read_b128 a[80:83], v39 offset:15872
v_mfma_f32_16x16x32_bf16 v[28:31], a[104:107], a[4:7], v[28:31]
ds_read_b128 a[84:87], v39 offset:16896
v_mfma_f32_16x16x32_bf16 v[32:35], a[108:111], a[4:7], v[32:35]
ds_read_b128 a[88:91], v36 offset:13824
s_waitcnt vmcnt(8) lgkmcnt(5)
v_mfma_f32_16x16x32_bf16 v[16:19], a[112:115], a[8:11], v[16:19]
ds_read_b128 a[92:95], v39 offset:18432
buffer_load_dwordx4 a[44:47], v1, s[8:11], s60 offen offset:3072 sc1
v_mfma_f32_16x16x32_bf16 v[20:23], a[116:119], a[8:11], v[20:23]
ds_read_b128 a[96:99], v39 offset:19456
v_mfma_f32_16x16x32_bf16 v[24:27], a[120:123], a[8:11], v[24:27]
ds_read_b128 a[100:103], v39 offset:20480
v_mfma_f32_16x16x32_bf16 v[28:31], a[124:127], a[8:11], v[28:31]
ds_read_b128 a[104:107], v39 offset:21504
v_mfma_f32_16x16x32_bf16 v[32:35], a[128:131], a[8:11], v[32:35]
ds_read_b128 a[108:111], v36 offset:18432
s_waitcnt vmcnt(8) lgkmcnt(5)
v_mfma_f32_16x16x32_bf16 v[16:19], a[72:75], a[12:15], v[16:19]
ds_read_b128 a[112:115], v39 offset:23040
s_add_u32 s60, s60, 4096
buffer_load_dwordx4 a[48:51], v1, s[8:11], s60 offen offset:0 sc1
v_mfma_f32_16x16x32_bf16 v[20:23], a[76:79], a[12:15], v[20:23]
ds_read_b128 a[116:119], v39 offset:24064
v_mfma_f32_16x16x32_bf16 v[24:27], a[80:83], a[12:15], v[24:27]
ds_read_b128 a[120:123], v39 offset:25088
v_mfma_f32_16x16x32_bf16 v[28:31], a[84:87], a[12:15], v[28:31]
ds_read_b128 a[124:127], v39 offset:26112
v_mfma_f32_16x16x32_bf16 v[32:35], a[88:91], a[12:15], v[32:35]
ds_read_b128 a[128:131], v36 offset:23040
s_waitcnt vmcnt(8) lgkmcnt(5)
v_mfma_f32_16x16x32_bf16 v[16:19], a[92:95], a[16:19], v[16:19]
ds_read_b128 a[72:75], v39 offset:27648
buffer_load_dwordx4 a[52:55], v1, s[8:11], s60 offen offset:1024 sc1
v_mfma_f32_16x16x32_bf16 v[20:23], a[96:99], a[16:19], v[20:23]
ds_read_b128 a[76:79], v39 offset:28672
v_mfma_f32_16x16x32_bf16 v[24:27], a[100:103], a[16:19], v[24:27]
ds_read_b128 a[80:83], v39 offset:29696
v_mfma_f32_16x16x32_bf16 v[28:31], a[104:107], a[16:19], v[28:31]
ds_read_b128 a[84:87], v39 offset:30720
v_mfma_f32_16x16x32_bf16 v[32:35], a[108:111], a[16:19], v[32:35]
ds_read_b128 a[88:91], v36 offset:27648
s_waitcnt vmcnt(8) lgkmcnt(5)
v_mfma_f32_16x16x32_bf16 v[16:19], a[112:115], a[20:23], v[16:19]
ds_read_b128 a[92:95], v39 offset:32256
buffer_load_dwordx4 a[56:59], v1, s[8:11], s60 offen offset:2048 sc1
v_mfma_f32_16x16x32_bf16 v[20:23], a[116:119], a[20:23], v[20:23]
ds_read_b128 a[96:99], v39 offset:33280
v_mfma_f32_16x16x32_bf16 v[24:27], a[120:123], a[20:23], v[24:27]
ds_read_b128 a[100:103], v39 offset:34304
v_mfma_f32_16x16x32_bf16 v[28:31], a[124:127], a[20:23], v[28:31]
ds_read_b128 a[104:107], v39 offset:35328
v_mfma_f32_16x16x32_bf16 v[32:35], a[128:131], a[20:23], v[32:35]
ds_read_b128 a[108:111], v36 offset:32256
s_waitcnt vmcnt(8) lgkmcnt(5)
v_mfma_f32_16x16x32_bf16 v[16:19], a[72:75], a[24:27], v[16:19]
ds_read_b128 a[112:115], v39 offset:36864
buffer_load_dwordx4 a[60:63], v1, s[8:11], s60 offen offset:3072 sc1
v_mfma_f32_16x16x32_bf16 v[20:23], a[76:79], a[24:27], v[20:23]
ds_read_b128 a[116:119], v39 offset:37888
v_mfma_f32_16x16x32_bf16 v[24:27], a[80:83], a[24:27], v[24:27]
ds_read_b128 a[120:123], v39 offset:38912
v_mfma_f32_16x16x32_bf16 v[28:31], a[84:87], a[24:27], v[28:31]
ds_read_b128 a[124:127], v39 offset:39936
v_mfma_f32_16x16x32_bf16 v[32:35], a[88:91], a[24:27], v[32:35]
ds_read_b128 a[128:131], v36 offset:36864
s_waitcnt vmcnt(8) lgkmcnt(5)
v_mfma_f32_16x16x32_bf16 v[16:19], a[92:95], a[28:31], v[16:19]
ds_read_b128 a[72:75], v37 offset:0
s_add_u32 s60, s60, 4096
buffer_load_dwordx2 a[64:65], v40, s[8:11], s60 offen offset:0 sc1
buffer_load_dwordx2 a[66:67], v40, s[8:11], s60 offen offset:1024 sc1
v_mfma_f32_16x16x32_bf16 v[20:23], a[96:99], a[28:31], v[20:23]
ds_read_b128 a[76:79], v37 offset:1024
v_mfma_f32_16x16x32_bf16 v[24:27], a[100:103], a[28:31], v[24:27]
ds_read_b128 a[80:83], v37 offset:2048
v_mfma_f32_16x16x32_bf16 v[28:31], a[104:107], a[28:31], v[28:31]
ds_read_b128 a[84:87], v37 offset:3072
v_mfma_f32_16x16x32_bf16 v[32:35], a[108:111], a[28:31], v[32:35]
ds_read_b128 a[88:91], v38 offset:0
s_waitcnt vmcnt(9) lgkmcnt(5)
v_mfma_f32_16x16x32_bf16 v[16:19], a[112:115], a[32:35], v[16:19]
ds_read_b128 a[92:95], v37 offset:4608
buffer_load_dwordx2 a[68:69], v40, s[8:11], s60 offen offset:512 sc1
buffer_load_dwordx2 a[70:71], v40, s[8:11], s60 offen offset:1536 sc1
v_mfma_f32_16x16x32_bf16 v[20:23], a[116:119], a[32:35], v[20:23]
ds_read_b128 a[96:99], v37 offset:5632
v_mfma_f32_16x16x32_bf16 v[24:27], a[120:123], a[32:35], v[24:27]
ds_read_b128 a[100:103], v37 offset:6656
v_mfma_f32_16x16x32_bf16 v[28:31], a[124:127], a[32:35], v[28:31]
ds_read_b128 a[104:107], v37 offset:7680
v_mfma_f32_16x16x32_bf16 v[32:35], a[128:131], a[32:35], v[32:35]
ds_read_b128 a[108:111], v38 offset:4608
s_waitcnt vmcnt(10) lgkmcnt(5)
v_mfma_f32_16x16x32_bf16 v[16:19], a[72:75], a[36:39], v[16:19]
ds_read_b128 a[112:115], v37 offset:9216
v_mfma_f32_16x16x32_bf16 v[20:23], a[76:79], a[36:39], v[20:23]
ds_read_b128 a[116:119], v37 offset:10240
v_mfma_f32_16x16x32_bf16 v[24:27], a[80:83], a[36:39], v[24:27]
ds_read_b128 a[120:123], v37 offset:11264
v_mfma_f32_16x16x32_bf16 v[28:31], a[84:87], a[36:39], v[28:31]
ds_read_b128 a[124:127], v37 offset:12288
v_mfma_f32_16x16x32_bf16 v[32:35], a[88:91], a[36:39], v[32:35]
ds_read_b128 a[128:131], v38 offset:9216
s_waitcnt vmcnt(9) lgkmcnt(5)
v_mfma_f32_16x16x32_bf16 v[16:19], a[92:95], a[40:43], v[16:19]
ds_read_b128 a[72:75], v37 offset:13824
v_mfma_f32_16x16x32_bf16 v[20:23], a[96:99], a[40:43], v[20:23]
ds_read_b128 a[76:79], v37 offset:14848
v_mfma_f32_16x16x32_bf16 v[24:27], a[100:103], a[40:43], v[24:27]
ds_read_b128 a[80:83], v37 offset:15872
v_mfma_f32_16x16x32_bf16 v[28:31], a[104:107], a[40:43], v[28:31]
ds_read_b128 a[84:87], v37 offset:16896
v_mfma_f32_16x16x32_bf16 v[32:35], a[108:111], a[40:43], v[32:35]
ds_read_b128 a[88:91], v38 offset:13824
s_waitcnt vmcnt(8) lgkmcnt(5)
v_mfma_f32_16x16x32_bf16 v[16:19], a[112:115], a[44:47], v[16:19]
ds_read_b128 a[92:95], v37 offset:18432
v_mfma_f32_16x16x32_bf16 v[20:23], a[116:119], a[44:47], v[20:23]
ds_read_b128 a[96:99], v37 offset:19456
v_mfma_f32_16x16x32_bf16 v[24:27], a[120:123], a[44:47], v[24:27]
ds_read_b128 a[100:103], v37 offset:20480
v_mfma_f32_16x16x32_bf16 v[28:31], a[124:127], a[44:47], v[28:31]
ds_read_b128 a[104:107], v37 offset:21504
v_mfma_f32_16x16x32_bf16 v[32:35], a[128:131], a[44:47], v[32:35]
ds_read_b128 a[108:111], v38 offset:18432
s_waitcnt vmcnt(7) lgkmcnt(5)
v_mfma_f32_16x16x32_bf16 v[16:19], a[72:75], a[48:51], v[16:19]
ds_read_b128 a[112:115], v37 offset:23040
v_mfma_f32_16x16x32_bf16 v[20:23], a[76:79], a[48:51], v[20:23]
ds_read_b128 a[116:119], v37 offset:24064
v_mfma_f32_16x16x32_bf16 v[24:27], a[80:83], a[48:51], v[24:27]
ds_read_b128 a[120:123], v37 offset:25088
v_mfma_f32_16x16x32_bf16 v[28:31], a[84:87], a[48:51], v[28:31]
ds_read_b128 a[124:127], v37 offset:26112
v_mfma_f32_16x16x32_bf16 v[32:35], a[88:91], a[48:51], v[32:35]
ds_read_b128 a[128:131], v38 offset:23040
s_waitcnt vmcnt(6) lgkmcnt(5)
v_mfma_f32_16x16x32_bf16 v[16:19], a[92:95], a[52:55], v[16:19]
ds_read_b128 a[72:75], v37 offset:27648
v_mfma_f32_16x16x32_bf16 v[20:23], a[96:99], a[52:55], v[20:23]
ds_read_b128 a[76:79], v37 offset:28672
v_mfma_f32_16x16x32_bf16 v[24:27], a[100:103], a[52:55], v[24:27]
ds_read_b128 a[80:83], v37 offset:29696
v_mfma_f32_16x16x32_bf16 v[28:31], a[104:107], a[52:55], v[28:31]
ds_read_b128 a[84:87], v37 offset:30720
v_mfma_f32_16x16x32_bf16 v[32:35], a[108:111], a[52:55], v[32:35]
ds_read_b128 a[88:91], v38 offset:27648
s_waitcnt vmcnt(5) lgkmcnt(5)
v_mfma_f32_16x16x32_bf16 v[16:19], a[112:115], a[56:59], v[16:19]
ds_read_b128 a[92:95], v37 offset:32256
v_mfma_f32_16x16x32_bf16 v[20:23], a[116:119], a[56:59], v[20:23]
ds_read_b128 a[96:99], v37 offset:33280
v_mfma_f32_16x16x32_bf16 v[24:27], a[120:123], a[56:59], v[24:27]
ds_read_b128 a[100:103], v37 offset:34304
v_mfma_f32_16x16x32_bf16 v[28:31], a[124:127], a[56:59], v[28:31]
ds_read_b128 a[104:107], v37 offset:35328
v_mfma_f32_16x16x32_bf16 v[32:35], a[128:131], a[56:59], v[32:35]
ds_read_b128 a[108:111], v38 offset:32256
s_waitcnt vmcnt(4) lgkmcnt(5)
v_mfma_f32_16x16x32_bf16 v[16:19], a[72:75], a[60:63], v[16:19]
ds_read_b128 a[112:115], v37 offset:36864
v_mfma_f32_16x16x32_bf16 v[20:23], a[76:79], a[60:63], v[20:23]
ds_read_b128 a[116:119], v37 offset:37888
v_mfma_f32_16x16x32_bf16 v[24:27], a[80:83], a[60:63], v[24:27]
ds_read_b128 a[120:123], v37 offset:38912
v_mfma_f32_16x16x32_bf16 v[28:31], a[84:87], a[60:63], v[28:31]
ds_read_b128 a[124:127], v37 offset:39936
v_mfma_f32_16x16x32_bf16 v[32:35], a[88:91], a[60:63], v[32:35]
ds_read_b128 a[128:131], v38 offset:36864
s_waitcnt vmcnt(2) lgkmcnt(5)
v_mfma_f32_16x16x32_bf16 v[16:19], a[92:95], a[64:67], v[16:19]
v_mfma_f32_16x16x32_bf16 v[20:23], a[96:99], a[64:67], v[20:23]
v_mfma_f32_16x16x32_bf16 v[24:27], a[100:103], a[64:67], v[24:27]
v_mfma_f32_16x16x32_bf16 v[28:31], a[104:107], a[64:67], v[28:31]
v_mfma_f32_16x16x32_bf16 v[32:35], a[108:111], a[64:67], v[32:35]
s_waitcnt vmcnt(0) lgkmcnt(0)
v_mfma_f32_16x16x32_bf16 v[16:19], a[112:115], a[68:71], v[16:19]
v_mfma_f32_16x16x32_bf16 v[20:23], a[116:119], a[68:71], v[20:23]
v_mfma_f32_16x16x32_bf16 v[24:27], a[120:123], a[68:71], v[24:27]
v_mfma_f32_16x16x32_bf16 v[28:31], a[124:127], a[68:71], v[28:31]
v_mfma_f32_16x16x32_bf16 v[32:35], a[128:131], a[68:71], v[32:35]
s_nop 3
v_pk_add_f32 v[62:63], v[16:17], v[18:19]
v_pk_mul_f32 v[64:65], v[16:17], v[16:17]
v_pk_fma_f32 v[64:65], v[18:19], v[18:19], v[64:65]
v_pk_add_f32 v[62:63], v[62:63], v[20:21]
v_pk_fma_f32 v[64:65], v[20:21], v[20:21], v[64:65]
v_pk_add_f32 v[62:63], v[62:63], v[22:23]
v_pk_fma_f32 v[64:65], v[22:23], v[22:23], v[64:65]
v_pk_add_f32 v[62:63], v[62:63], v[24:25]
v_pk_fma_f32 v[64:65], v[24:25], v[24:25], v[64:65]
v_pk_add_f32 v[62:63], v[62:63], v[26:27]
v_pk_fma_f32 v[64:65], v[26:27], v[26:27], v[64:65]
v_pk_add_f32 v[62:63], v[62:63], v[28:29]
v_pk_fma_f32 v[64:65], v[28:29], v[28:29], v[64:65]
v_pk_add_f32 v[62:63], v[62:63], v[30:31]
v_pk_fma_f32 v[64:65], v[30:31], v[30:31], v[64:65]
s_mov_b32 exec_hi, 0
v_pk_add_f32 v[62:63], v[62:63], v[32:33]
v_pk_fma_f32 v[64:65], v[32:33], v[32:33], v[64:65]
v_pk_add_f32 v[62:63], v[62:63], v[34:35]
v_pk_fma_f32 v[64:65], v[34:35], v[34:35], v[64:65]
s_mov_b64 exec, -1
v_add_f32 v56, v62, v63
v_add_f32 v57, v64, v65
v_cvt_pk_bf16_f32 v52, v32, v33
v_cvt_pk_bf16_f32 v53, v34, v35
v_permlane32_swap_b32 v56, v57
v_add_f32 v56, v56, v57
v_mov_b32 v57, v56
v_cvt_pk_bf16_f32 v44, v16, v17
v_cvt_pk_bf16_f32 v45, v18, v19
v_permlane16_swap_b32 v56, v57
v_add_f32 v56, v56, v57
v_mov_b32 v57, v56
v_cvt_pk_bf16_f32 v46, v20, v21
v_cvt_pk_bf16_f32 v47, v22, v23
v_permlane32_swap_b32 v56, v57
buffer_store_dwordx4 v[44:47], v60, s[8:11], s62 offen sc1
buffer_store_dwordx2 v[56:57], v58, s[8:11], s63 offen sc1
v_cvt_pk_bf16_f32 v48, v24, v25
v_cvt_pk_bf16_f32 v49, v26, v27
v_cvt_pk_bf16_f32 v50, v28, v29
v_cvt_pk_bf16_f32 v51, v30, v31
v_permlane16_swap_b32 v52, v54
v_permlane16_swap_b32 v53, v55
buffer_store_dwordx4 v[48:51], v60, s[8:11], s62 offen offset:1024 sc1
buffer_store_dwordx4 v[52:55], v61, s[8:11], s62 offen sc1
s_barrier
s_mul_i32 s38, s24, 9216
s_add_u32 m0, s38, 37888
s_add_u32 s39, s38, s82
s_add_u32 s39, s39, 75776
buffer_load_dwordx4 v1, s[4:7], s39 offen offset:0 sc1 lds
buffer_load_dwordx4 v1, s[4:7], s39 offen offset:1024 sc1 lds
buffer_load_dwordx4 v1, s[4:7], s39 offen offset:2048 sc1 lds
buffer_load_dwordx4 v1, s[4:7], s39 offen offset:3072 sc1 lds
s_add_u32 m0, m0, 4096
s_add_u32 s39, s39, 4096
buffer_load_dwordx4 v1, s[4:7], s39 offen offset:0 sc1 lds
buffer_load_dwordx4 v1, s[4:7], s39 offen offset:1024 sc1 lds
buffer_load_dwordx4 v1, s[4:7], s39 offen offset:2048 sc1 lds
v_lshlrev_b32 v7, 3, v1
s_lshr_b32 s31, s81, 4
s_lshl_b32 s31, s31, 11
v_add_u32 v7, s31, v7
s_cmp_eq_u32 s24, 0
s_cselect_b32 s30, 0, 1073741824
s_add_u32 s30, s30, 26509312
s_waitcnt vmcnt(7)
s_barrier
s_mov_b64 exec, 0xffff
buffer_atomic_add v4, v7, s[8:11], s30 offen sc1
s_mov_b64 exec, -1
s_lshl_b32 s35, s80, 7
s_add_u32 s35, s35, 26509312
s_cmp_eq_u32 s24, 1
s_cselect_b32 s35, s35, 1073741824
v_mov_b32 v6, 0
v_mov_b32 v244, 0
v_mov_b32 v245, 0
v_mov_b32 v246, 0
buffer_load_dwordx4 v1, s[4:7], s39 offen offset:3072 sc1 lds
s_add_u32 m0, m0, 4096
s_add_u32 s39, s39, 4096
buffer_load_dwordx4 v1, s[4:7], s39 offen offset:0 sc1 lds
s_lshl_b32 s38, s24, 8
s_add_u32 m0, s38, 74752
s_add_u32 s39, s38, s82
s_add_u32 s39, s39, 112640
s_mov_b64 exec, 0xffff
buffer_load_dwordx4 v1, s[4:7], s39 offen sc1 lds
s_mov_b64 exec, -1
s_mul_i32 s38, s24, 9216
s_add_u32 m0, s38, 75776
s_add_u32 s39, s38, s82
s_add_u32 s39, s39, 113664
buffer_load_dwordx4 v1, s[4:7], s39 offen offset:0 sc1 lds
s_mov_b64 exec, 1
buffer_atomic_add v244, v6, s[8:11], s35 offen sc0 sc1
s_mov_b64 exec, -1
buffer_load_dwordx4 v1, s[4:7], s39 offen offset:1024 sc1 lds
buffer_load_dwordx4 v1, s[4:7], s39 offen offset:2048 sc1 lds
buffer_load_dwordx4 v1, s[4:7], s39 offen offset:3072 sc1 lds
s_add_u32 m0, m0, 4096
s_add_u32 s39, s39, 4096
s_mov_b64 exec, 1
buffer_atomic_add v245, v6, s[8:11], s35 offen sc0 sc1
s_mov_b64 exec, -1
buffer_load_dwordx4 v1, s[4:7], s39 offen offset:0 sc1 lds
buffer_load_dwordx4 v1, s[4:7], s39 offen offset:1024 sc1 lds
buffer_load_dwordx4 v1, s[4:7], s39 offen offset:2048 sc1 lds
s_mov_b64 exec, 1
buffer_atomic_add v246, v6, s[8:11], s35 offen sc0 sc1
s_mov_b64 exec, -1
buffer_load_dwordx4 v1, s[4:7], s39 offen offset:3072 sc1 lds
s_add_u32 m0, m0, 4096
s_add_u32 s39, s39, 4096
buffer_load_dwordx4 v1, s[4:7], s39 offen offset:0 sc1 lds
s_lshl_b32 s38, s24, 8
s_add_u32 m0, s38, 112640
s_add_u32 s39, s38, s82
s_add_u32 s39, s39, 150528
s_mov_b64 exec, 0xffff
buffer_load_dwordx4 v1, s[4:7], s39 offen sc1 lds
s_mov_b64 exec, -1
s_lshl_b32 s60, s25, 2
s_add_u32 s60, s60, s24
s_mul_i32 s62, s60, 36864
s_add_u32 s62, s62, 4849664
v_add_u32 v180, 18432, v1
s_cmp_eq_u32 s24, 1
s_cbranch_scc0 L_other_20
s_mov_b32 s31, 0
s_mov_b64 exec, 1
v_mov_b32 v247, 0
buffer_atomic_add v247, v6, s[8:11], s35 offen sc0 sc1
s_waitcnt vmcnt(12)
v_cmp_gt_u32 vcc, 16, v244
s_nop 0
s_cbranch_vccz L_polled_19
s_waitcnt vmcnt(8)
v_cmp_gt_u32 vcc, 16, v245
s_nop 0
s_cbranch_vccz L_polled_19
v_mov_b32 v244, 0
buffer_atomic_add v244, v6, s[8:11], s35 offen sc0 sc1
s_waitcnt vmcnt(5)
v_cmp_gt_u32 vcc, 16, v246
s_nop 0
s_cbranch_vccz L_polled_19
v_mov_b32 v245, 0
buffer_atomic_add v245, v6, s[8:11], s35 offen sc0 sc1
L_poll_18:
s_add_u32 s31, s31, 1
s_cmp_gt_u32 s31, 100000
s_cbranch_scc1 L_polled_19
v_mov_b32 v246, 0
buffer_atomic_add v246, v6, s[8:11], s35 offen sc0 sc1
s_waitcnt vmcnt(3)
v_cmp_gt_u32 vcc, 16, v247
s_nop 0
s_cbranch_vccz L_polled_19
v_mov_b32 v247, 0
buffer_atomic_add v247, v6, s[8:11], s35 offen sc0 sc1
s_waitcnt vmcnt(3)
v_cmp_gt_u32 vcc, 16, v244
s_nop 0
s_cbranch_vccz L_polled_19
v_mov_b32 v244, 0
buffer_atomic_add v244, v6, s[8:11], s35 offen sc0 sc1
s_waitcnt vmcnt(3)
v_cmp_gt_u32 vcc, 16, v245
s_nop 0
s_cbranch_vccz L_polled_19
v_mov_b32 v245, 0
buffer_atomic_add v245, v6, s[8:11], s35 offen sc0 sc1
s_waitcnt vmcnt(3)
v_cmp_gt_u32 vcc, 16, v246
s_nop 0
s_cbranch_vccz L_polled_19
s_branch L_poll_18
L_polled_19:
s_mov_b64 exec, -1
L_other_20:
s_barrier
buffer_load_dwordx4 a[0:3], v1, s[8:11], s62 offen offset:0 sc1
buffer_load_dwordx4 a[4:7], v180, s[8:11], s62 offen offset:0 sc1
s_barrier
buffer_load_dwordx4 a[8:11], v1, s[8:11], s62 offen offset:1024 sc1
buffer_load_dwordx4 a[12:15], v180, s[8:11], s62 offen offset:1024 sc1
s_barrier
buffer_load_dwordx4 a[16:19], v1, s[8:11], s62 offen offset:2048 sc1
buffer_load_dwordx4 a[20:23], v180, s[8:11], s62 offen offset:2048 sc1
s_barrier
buffer_load_dwordx4 a[24:27], v1, s[8:11], s62 offen offset:3072 sc1
buffer_load_dwordx4 a[28:31], v180, s[8:11], s62 offen offset:3072 sc1
s_barrier
s_add_u32 s62, s62, 4096
buffer_load_dwordx4 a[32:35], v1, s[8:11], s62 offen offset:0 sc1
buffer_load_dwordx4 a[36:39], v180, s[8:11], s62 offen offset:0 sc1
s_barrier
buffer_load_dwordx4 a[40:43], v1, s[8:11], s62 offen offset:1024 sc1
buffer_load_dwordx4 a[44:47], v180, s[8:11], s62 offen offset:1024 sc1
s_lshl_b32 s53, s25, 2
s_add_u32 s53, s53, s24
s_mul_i32 s53, s53, 133120
s_add_u32 s53, s53, 10895360
s_lshl_b32 s52, s25, 12
s_add_u32 s52, s52, s53
v_lshrrev_b32 v239, 1, v1
v_and_b32 v6, 0xf8, v239
v_lshrrev_b32 v7, 1, v3
v_lshl_add_u32 v232, v7, 16, v6
s_lshl_b32 s63, s60, 8
s_add_u32 s63, s63, 7208960
v_add_u32 v208, 123904, v1
v_add_u32 v209, 0, v1
v_add_u32 v210, 37888, v1
v_add_u32 v211, 75776, v1
ds_read_b128 a[144:147], v208 offset:0
ds_read_b128 a[148:151], v208 offset:18432
ds_read_b128 a[152:155], v209 offset:0
ds_read_b128 a[156:159], v209 offset:18432
ds_read_b128 a[160:163], v208 offset:1024
ds_read_b128 a[164:167], v208 offset:19456
s_waitcnt vmcnt(10) lgkmcnt(4)
v_mfma_f32_16x16x32_bf16 v[36:39], a[144:147], a[0:3], 0
ds_read_b128 a[168:171], v209 offset:1024
ds_read_b128 a[172:175], v209 offset:19456
v_mfma_f32_16x16x32_bf16 v[40:43], a[144:147], a[4:7], 0
buffer_load_dwordx4 a[48:51], v1, s[8:11], s62 offen offset:2048 sc1
v_mfma_f32_16x16x32_bf16 v[44:47], a[148:151], a[0:3], 0
buffer_load_dwordx4 a[52:55], v180, s[8:11], s62 offen offset:2048 sc1
v_mfma_f32_16x16x32_bf16 v[48:51], a[148:151], a[4:7], 0
s_waitcnt lgkmcnt(4)
v_mfma_f32_16x16x32_bf16 v[52:55], a[152:155], a[0:3], 0
ds_read_b128 a[144:147], v208 offset:2048
ds_read_b128 a[148:151], v208 offset:20480
v_mfma_f32_16x16x32_bf16 v[56:59], a[152:155], a[4:7], 0
buffer_load_dwordx4 a[56:59], v1, s[8:11], s62 offen offset:3072 sc1
v_lshl_add_u32 v234, v7, 13, v6
v_mfma_f32_16x16x32_bf16 v[60:63], a[156:159], a[0:3], 0
v_add_u32 v235, 4096, v234
v_mfma_f32_16x16x32_bf16 v[64:67], a[156:159], a[4:7], 0
s_waitcnt vmcnt(11) lgkmcnt(4)
s_barrier
v_mfma_f32_16x16x32_bf16 v[36:39], a[160:163], a[8:11], v[36:39]
ds_read_b128 a[152:155], v209 offset:2048
ds_read_b128 a[156:159], v209 offset:20480
v_mfma_f32_16x16x32_bf16 v[40:43], a[160:163], a[12:15], v[40:43]
buffer_load_dwordx4 a[60:63], v180, s[8:11], s62 offen offset:3072 sc1
s_mul_i32 s30, s24, 9216
v_mfma_f32_16x16x32_bf16 v[44:47], a[164:167], a[8:11], v[44:47]
s_add_u32 s62, s62, 4096
v_mfma_f32_16x16x32_bf16 v[48:51], a[164:167], a[12:15], v[48:51]
s_waitcnt lgkmcnt(4)
s_add_u32 s30, s30, 0
v_mfma_f32_16x16x32_bf16 v[52:55], a[168:171], a[8:11], v[52:55]
ds_read_b128 a[160:163], v208 offset:3072
ds_read_b128 a[164:167], v208 offset:21504
v_mfma_f32_16x16x32_bf16 v[56:59], a[168:171], a[12:15], v[56:59]
buffer_load_dwordx4 a[64:67], v1, s[8:11], s62 offen offset:0 sc1
v_mul_u32_u24 v236, 288, v2
v_mfma_f32_16x16x32_bf16 v[60:63], a[172:175], a[8:11], v[60:63]
v_mfma_f32_16x16x32_bf16 v[64:67], a[172:175], a[12:15], v[64:67]
s_waitcnt lgkmcnt(4)
v_add_u32 v236, s30, v236
s_waitcnt vmcnt(11)
v_mfma_f32_16x16x32_bf16 v[36:39], a[144:147], a[16:19], v[36:39]
ds_read_b128 a[168:171], v209 offset:3072
ds_read_b128 a[172:175], v209 offset:21504
v_mfma_f32_16x16x32_bf16 v[40:43], a[144:147], a[20:23], v[40:43]
buffer_load_dwordx2 v[182:183], v232, s[8:11], s63 offen sc1
v_mfma_f32_16x16x32_bf16 v[44:47], a[148:151], a[16:19], v[44:47]
s_add_u32 s63, s63, 16384
v_lshl_add_u32 v7, v3, 3, v236
v_mfma_f32_16x16x32_bf16 v[48:51], a[148:151], a[20:23], v[48:51]
s_waitcnt lgkmcnt(4)
v_mfma_f32_16x16x32_bf16 v[52:55], a[152:155], a[16:19], v[52:55]
ds_read_b128 a[144:147], v208 offset:4096
ds_read_b128 a[148:151], v208 offset:22528
v_mfma_f32_16x16x32_bf16 v[56:59], a[152:155], a[20:23], v[56:59]
v_lshl_add_u32 v236, v3, 4, v236
v_mfma_f32_16x16x32_bf16 v[60:63], a[156:159], a[16:19], v[60:63]
buffer_load_dwordx2 v[184:185], v232, s[8:11], s63 offen sc1
v_lshrrev_b32 v8, 2, v2
v_mfma_f32_16x16x32_bf16 v[64:67], a[156:159], a[20:23], v[64:67]
s_waitcnt vmcnt(11) lgkmcnt(4)
v_mfma_f32_16x16x32_bf16 v[36:39], a[160:163], a[24:27], v[36:39]
ds_read_b128 a[152:155], v209 offset:4096
ds_read_b128 a[156:159], v209 offset:22528
v_mfma_f32_16x16x32_bf16 v[40:43], a[160:163], a[28:31], v[40:43]
s_add_u32 s63, s63, 16384
v_lshl_add_u32 v8, v3, 3, v8
v_mfma_f32_16x16x32_bf16 v[44:47], a[164:167], a[24:27], v[44:47]
v_mfma_f32_16x16x32_bf16 v[48:51], a[164:167], a[28:31], v[48:51]
s_waitcnt lgkmcnt(4)
v_mul_u32_u24 v237, 288, v8
v_mfma_f32_16x16x32_bf16 v[52:55], a[168:171], a[24:27], v[52:55]
ds_read_b128 a[160:163], v208 offset:5120
ds_read_b128 a[164:167], v208 offset:23552
v_mfma_f32_16x16x32_bf16 v[56:59], a[168:171], a[28:31], v[56:59]
buffer_load_dwordx2 v[186:187], v232, s[8:11], s63 offen sc1
v_add_u32 v237, s30, v237
v_mfma_f32_16x16x32_bf16 v[60:63], a[172:175], a[24:27], v[60:63]
s_add_u32 s63, s63, 16384
v_mfma_f32_16x16x32_bf16 v[64:67], a[172:175], a[28:31], v[64:67]
s_waitcnt vmcnt(10) lgkmcnt(4)
v_mfma_f32_16x16x32_bf16 v[36:39], a[144:147], a[32:35], v[36:39]
ds_read_b128 a[168:171], v209 offset:5120
ds_read_b128 a[172:175], v209 offset:23552
v_mfma_f32_16x16x32_bf16 v[40:43], a[144:147], a[36:39], v[40:43]
buffer_load_dwordx2 v[188:189], v232, s[8:11], s63 offen sc1
v_and_b32 v8, 3, v2
v_mfma_f32_16x16x32_bf16 v[44:47], a[148:151], a[32:35], v[44:47]
s_add_u32 s63, s63, 16384
v_lshl_add_u32 v238, v8, 3, v237
v_mfma_f32_16x16x32_bf16 v[48:51], a[148:151], a[36:39], v[48:51]
s_waitcnt lgkmcnt(4)
v_mfma_f32_16x16x32_bf16 v[52:55], a[152:155], a[32:35], v[52:55]
ds_read_b128 a[144:147], v208 offset:6144
ds_read_b128 a[148:151], v208 offset:24576
v_mfma_f32_16x16x32_bf16 v[56:59], a[152:155], a[36:39], v[56:59]
v_lshl_add_u32 v237, v8, 4, v237
v_mfma_f32_16x16x32_bf16 v[60:63], a[156:159], a[32:35], v[60:63]
buffer_load_dwordx4 a[68:71], v180, s[8:11], s62 offen offset:0 sc1
v_mfma_f32_16x16x32_bf16 v[64:67], a[156:159], a[36:39], v[64:67]
s_waitcnt lgkmcnt(4)
s_mul_i32 s66, s26, 589824
s_waitcnt vmcnt(10)
v_mfma_f32_16x16x32_bf16 v[36:39], a[160:163], a[40:43], v[36:39]
ds_read_b128 a[152:155], v209 offset:6144
ds_read_b128 a[156:159], v209 offset:24576
v_mfma_f32_16x16x32_bf16 v[40:43], a[160:163], a[44:47], v[40:43]
buffer_load_dwordx4 a[72:75], v1, s[8:11], s62 offen offset:1024 sc1
s_mul_i32 s31, s60, 9216
v_mfma_f32_16x16x32_bf16 v[44:47], a[164:167], a[40:43], v[44:47]
s_add_u32 s66, s66, s31
v_mfma_f32_16x16x32_bf16 v[48:51], a[164:167], a[44:47], v[48:51]
s_waitcnt lgkmcnt(4)
v_mfma_f32_16x16x32_bf16 v[52:55], a[168:171], a[40:43], v[52:55]
ds_read_b128 a[160:163], v208 offset:7168
ds_read_b128 a[164:167], v208 offset:25600
v_mfma_f32_16x16x32_bf16 v[56:59], a[168:171], a[44:47], v[56:59]
buffer_load_dwordx4 a[76:79], v180, s[8:11], s62 offen offset:1024 sc1
v_mfma_f32_16x16x32_bf16 v[60:63], a[172:175], a[40:43], v[60:63]
s_add_u32 s66, s66, 7340032
v_mfma_f32_16x16x32_bf16 v[64:67], a[172:175], a[44:47], v[64:67]
s_waitcnt vmcnt(10) lgkmcnt(4)
v_mfma_f32_16x16x32_bf16 v[36:39], a[144:147], a[48:51], v[36:39]
ds_read_b128 a[168:171], v209 offset:7168
ds_read_b128 a[172:175], v209 offset:25600
v_mfma_f32_16x16x32_bf16 v[40:43], a[144:147], a[52:55], v[40:43]
buffer_load_dwordx4 a[80:83], v1, s[8:11], s62 offen offset:2048 sc1
v_lshlrev_b32 v233, 7, v1
v_mfma_f32_16x16x32_bf16 v[44:47], a[148:151], a[48:51], v[44:47]
buffer_load_dwordx4 a[84:87], v180, s[8:11], s62 offen offset:2048 sc1
v_mfma_f32_16x16x32_bf16 v[48:51], a[148:151], a[52:55], v[48:51]
s_waitcnt lgkmcnt(4)
s_lshl_b32 s31, s26, 7
v_mfma_f32_16x16x32_bf16 v[52:55], a[152:155], a[48:51], v[52:55]
ds_read_b128 a[144:147], v208 offset:8192
ds_read_b128 a[148:151], v208 offset:26624
v_mfma_f32_16x16x32_bf16 v[56:59], a[152:155], a[52:55], v[56:59]
buffer_load_dwordx4 a[88:91], v1, s[8:11], s62 offen offset:3072 sc1
v_add_u32 v233, s31, v233
v_mfma_f32_16x16x32_bf16 v[60:63], a[156:159], a[48:51], v[60:63]
s_lshl_b32 s61, s25, 14
v_mfma_f32_16x16x32_bf16 v[64:67], a[156:159], a[52:55], v[64:67]
s_waitcnt vmcnt(11) lgkmcnt(4)
v_mfma_f32_16x16x32_bf16 v[36:39], a[160:163], a[56:59], v[36:39]
ds_read_b128 a[152:155], v209 offset:8192
ds_read_b128 a[156:159], v209 offset:26624
v_mfma_f32_16x16x32_bf16 v[40:43], a[160:163], a[60:63], v[40:43]
buffer_load_dwordx4 a[92:95], v180, s[8:11], s62 offen offset:3072 sc1
v_mfma_f32_16x16x32_bf16 v[44:47], a[164:167], a[56:59], v[44:47]
s_add_u32 s62, s62, 4096
s_lshl_b32 s30, s24, 8
v_mfma_f32_16x16x32_bf16 v[48:51], a[164:167], a[60:63], v[48:51]
s_waitcnt lgkmcnt(4)
v_mfma_f32_16x16x32_bf16 v[52:55], a[168:171], a[56:59], v[52:55]
ds_read_b128 a[160:163], v208 offset:9216
ds_read_b128 a[164:167], v208 offset:27648
v_mfma_f32_16x16x32_bf16 v[56:59], a[168:171], a[60:63], v[56:59]
buffer_load_dwordx4 a[96:99], v1, s[8:11], s62 offen offset:0 sc1
s_add_u32 s61, s61, s30
v_mfma_f32_16x16x32_bf16 v[60:63], a[172:175], a[56:59], v[60:63]
s_add_u32 s61, s61, 26214400
v_mfma_f32_16x16x32_bf16 v[64:67], a[172:175], a[60:63], v[64:67]
s_waitcnt vmcnt(7) lgkmcnt(4)
v_mfma_f32_16x16x32_bf16 v[36:39], a[144:147], a[64:67], v[36:39]
ds_read_b128 a[168:171], v209 offset:9216
ds_read_b128 a[172:175], v209 offset:27648
v_mfma_f32_16x16x32_bf16 v[40:43], a[144:147], a[68:71], v[40:43]
buffer_load_dwordx4 a[100:103], v180, s[8:11], s62 offen offset:0 sc1
s_mul_i32 s30, s24, 9216
v_mfma_f32_16x16x32_bf16 v[44:47], a[148:151], a[64:67], v[44:47]
buffer_load_dwordx4 a[104:107], v1, s[8:11], s62 offen offset:1024 sc1
v_mfma_f32_16x16x32_bf16 v[48:51], a[148:151], a[68:71], v[48:51]
s_waitcnt lgkmcnt(4)
s_add_u32 s30, s30, 0
v_mfma_f32_16x16x32_bf16 v[52:55], a[152:155], a[64:67], v[52:55]
ds_read_b128 a[144:147], v208 offset:10240
ds_read_b128 a[148:151], v208 offset:28672
v_mfma_f32_16x16x32_bf16 v[56:59], a[152:155], a[68:71], v[56:59]
buffer_load_dwordx4 a[108:111], v180, s[8:11], s62 offen offset:1024 sc1
v_add_u32 v240, s30, v1
v_mfma_f32_16x16x32_bf16 v[60:63], a[156:159], a[64:67], v[60:63]
s_lshl_b32 s30, s26, 10
v_mfma_f32_16x16x32_bf16 v[64:67], a[156:159], a[68:71], v[64:67]
s_waitcnt vmcnt(8) lgkmcnt(4)
v_mfma_f32_16x16x32_bf16 v[36:39], a[160:163], a[72:75], v[36:39]
ds_read_b128 a[152:155], v209 offset:10240
ds_read_b128 a[156:159], v209 offset:28672
v_mfma_f32_16x16x32_bf16 v[40:43], a[160:163], a[76:79], v[40:43]
buffer_load_dwordx4 a[112:115], v1, s[8:11], s62 offen offset:2048 sc1
v_mfma_f32_16x16x32_bf16 v[44:47], a[164:167], a[72:75], v[44:47]
buffer_load_dwordx4 a[116:119], v180, s[8:11], s62 offen offset:2048 sc1
s_add_u32 s30, s30, s61
v_mfma_f32_16x16x32_bf16 v[48:51], a[164:167], a[76:79], v[48:51]
s_waitcnt lgkmcnt(4)
v_mfma_f32_16x16x32_bf16 v[52:55], a[168:171], a[72:75], v[52:55]
ds_read_b128 a[160:163], v208 offset:11264
ds_read_b128 a[164:167], v208 offset:29696
v_mfma_f32_16x16x32_bf16 v[56:59], a[168:171], a[76:79], v[56:59]
buffer_load_dwordx4 a[120:123], v1, s[8:11], s62 offen offset:3072 sc1
v_mfma_f32_16x16x32_bf16 v[60:63], a[172:175], a[72:75], v[60:63]
v_mfma_f32_16x16x32_bf16 v[64:67], a[172:175], a[76:79], v[64:67]
s_waitcnt vmcnt(9) lgkmcnt(4)
v_mfma_f32_16x16x32_bf16 v[36:39], a[144:147], a[80:83], v[36:39]
ds_read_b128 a[168:171], v209 offset:11264
ds_read_b128 a[172:175], v209 offset:29696
v_mfma_f32_16x16x32_bf16 v[40:43], a[144:147], a[84:87], v[40:43]
buffer_load_dwordx4 a[124:127], v180, s[8:11], s62 offen offset:3072 sc1
v_mfma_f32_16x16x32_bf16 v[44:47], a[148:151], a[80:83], v[44:47]
s_add_u32 s62, s62, 4096
v_add_f32 v198, v182, v184
v_add_f32 v199, v183, v185
v_mfma_f32_16x16x32_bf16 v[48:51], a[148:151], a[84:87], v[48:51]
s_waitcnt lgkmcnt(4)
v_add_f32 v198, v198, v186
v_mfma_f32_16x16x32_bf16 v[52:55], a[152:155], a[80:83], v[52:55]
ds_read_b128 a[144:147], v208 offset:12288
ds_read_b128 a[148:151], v208 offset:30720
v_mfma_f32_16x16x32_bf16 v[56:59], a[152:155], a[84:87], v[56:59]
buffer_load_dwordx4 a[128:131], v1, s[8:11], s62 offen offset:0 sc1
v_add_f32 v199, v199, v187
v_mfma_f32_16x16x32_bf16 v[60:63], a[156:159], a[80:83], v[60:63]
v_add_f32 v198, v198, v188
v_mfma_f32_16x16x32_bf16 v[64:67], a[156:159], a[84:87], v[64:67]
s_waitcnt lgkmcnt(4)
v_add_f32 v199, v199, v189
s_waitcnt vmcnt(9)
v_mfma_f32_16x16x32_bf16 v[36:39], a[160:163], a[88:91], v[36:39]
ds_read_b128 a[152:155], v209 offset:12288
ds_read_b128 a[156:159], v209 offset:30720
v_mfma_f32_16x16x32_bf16 v[40:43], a[160:163], a[92:95], v[40:43]
buffer_load_dwordx4 a[132:135], v180, s[8:11], s62 offen offset:0 sc1
v_mov_b32 v200, v198
v_mfma_f32_16x16x32_bf16 v[44:47], a[164:167], a[88:91], v[44:47]
v_mov_b32 v201, v199
v_mfma_f32_16x16x32_bf16 v[48:51], a[164:167], a[92:95], v[48:51]
s_waitcnt lgkmcnt(4)
s_nop 0
v_mfma_f32_16x16x32_bf16 v[52:55], a[168:171], a[88:91], v[52:55]
ds_read_b128 a[160:163], v208 offset:13312
ds_read_b128 a[164:167], v208 offset:31744
v_mfma_f32_16x16x32_bf16 v[56:59], a[168:171], a[92:95], v[56:59]
buffer_load_dwordx4 a[136:139], v1, s[8:11], s62 offen offset:1024 sc1
v_mfma_f32_16x16x32_bf16 v[60:63], a[172:175], a[88:91], v[60:63]
buffer_load_dwordx4 a[140:143], v180, s[8:11], s62 offen offset:1024 sc1
v_mfma_f32_16x16x32_bf16 v[64:67], a[172:175], a[92:95], v[64:67]
s_waitcnt vmcnt(10) lgkmcnt(4)
v_mfma_f32_16x16x32_bf16 v[36:39], a[144:147], a[96:99], v[36:39]
ds_read_b128 a[168:171], v209 offset:13312
ds_read_b128 a[172:175], v209 offset:31744
v_mfma_f32_16x16x32_bf16 v[40:43], a[144:147], a[100:103], v[40:43]
v_permlane32_swap_b32 v198, v200
v_mfma_f32_16x16x32_bf16 v[44:47], a[148:151], a[96:99], v[44:47]
v_permlane32_swap_b32 v199, v201
v_mfma_f32_16x16x32_bf16 v[48:51], a[148:151], a[100:103], v[48:51]
s_waitcnt lgkmcnt(4)
v_add_f32 v198, v198, v200
v_add_f32 v199, v199, v201
v_mfma_f32_16x16x32_bf16 v[52:55], a[152:155], a[96:99], v[52:55]
ds_read_b128 a[144:147], v208 offset:14336
ds_read_b128 a[148:151], v208 offset:32768
v_mfma_f32_16x16x32_bf16 v[56:59], a[152:155], a[100:103], v[56:59]
v_mul_f32 v198, 0x3ae38e39, v198
v_mul_f32 v200, v198, v198
v_mfma_f32_16x16x32_bf16 v[60:63], a[156:159], a[96:99], v[60:63]
v_mul_f32 v199, 0x3ae38e39, v199
v_mfma_f32_16x16x32_bf16 v[64:67], a[156:159], a[100:103], v[64:67]
s_waitcnt vmcnt(8) lgkmcnt(4)
v_mfma_f32_16x16x32_bf16 v[36:39], a[160:163], a[104:107], v[36:39]
ds_read_b128 a[152:155], v209 offset:14336
ds_read_b128 a[156:159], v209 offset:32768
v_mfma_f32_16x16x32_bf16 v[40:43], a[160:163], a[108:111], v[40:43]
v_sub_f32 v199, v199, v200
v_max_f32 v199, 0, v199
v_mfma_f32_16x16x32_bf16 v[44:47], a[164:167], a[104:107], v[44:47]
v_add_f32 v199, 0x3727c5ac, v199
v_mfma_f32_16x16x32_bf16 v[48:51], a[164:167], a[108:111], v[48:51]
s_waitcnt lgkmcnt(4)
v_rsq_f32 v250, v199
v_mfma_f32_16x16x32_bf16 v[52:55], a[168:171], a[104:107], v[52:55]
ds_read_b128 a[160:163], v208 offset:15360
ds_read_b128 a[164:167], v208 offset:33792
v_mfma_f32_16x16x32_bf16 v[56:59], a[168:171], a[108:111], v[56:59]
v_mfma_f32_16x16x32_bf16 v[60:63], a[172:175], a[104:107], v[60:63]
v_sqrt_f32 v254, v199
v_mfma_f32_16x16x32_bf16 v[64:67], a[172:175], a[108:111], v[64:67]
s_waitcnt vmcnt(6) lgkmcnt(4)
v_mfma_f32_16x16x32_bf16 v[36:39], a[144:147], a[112:115], v[36:39]
ds_read_b128 a[168:171], v209 offset:15360
ds_read_b128 a[172:175], v209 offset:33792
v_mfma_f32_16x16x32_bf16 v[40:43], a[144:147], a[116:119], v[40:43]
v_cvt_pk_bf16_f32 v200, -v198, -v198
v_mfma_f32_16x16x32_bf16 v[44:47], a[148:151], a[112:115], v[44:47]
v_and_b32 v200, 0xffff0000, v200
v_mfma_f32_16x16x32_bf16 v[48:51], a[148:151], a[116:119], v[48:51]
s_waitcnt lgkmcnt(4)
v_add_f32 v200, v198, v200
v_mfma_f32_16x16x32_bf16 v[52:55], a[152:155], a[112:115], v[52:55]
ds_read_b128 a[144:147], v208 offset:16384
ds_read_b128 a[148:151], v208 offset:34816
v_mfma_f32_16x16x32_bf16 v[56:59], a[152:155], a[116:119], v[56:59]
v_cvt_pk_bf16_f32 v212, -v198, -v200
v_mfma_f32_16x16x32_bf16 v[60:63], a[156:159], a[112:115], v[60:63]
v_mul_f32 v252, v250, v250
v_mfma_f32_16x16x32_bf16 v[64:67], a[156:159], a[116:119], v[64:67]
s_waitcnt lgkmcnt(4)
v_mul_f32 v252, v252, v250
s_waitcnt vmcnt(4)
v_mfma_f32_16x16x32_bf16 v[36:39], a[160:163], a[120:123], v[36:39]
ds_read_b128 a[152:155], v209 offset:16384
ds_read_b128 a[156:159], v209 offset:34816
v_mfma_f32_16x16x32_bf16 v[40:43], a[160:163], a[124:127], v[40:43]
v_mul_f32 v252, 0xbdd2d3e8, v252
v_mul_f32 v250, 0xc0135761, v250
v_mfma_f32_16x16x32_bf16 v[44:47], a[164:167], a[120:123], v[44:47]
v_mfma_f32_16x16x32_bf16 v[48:51], a[164:167], a[124:127], v[48:51]
s_waitcnt lgkmcnt(4)
v_mov_b32 v214, v212
v_mfma_f32_16x16x32_bf16 v[52:55], a[168:171], a[120:123], v[52:55]
ds_read_b128 a[160:163], v208 offset:17408
ds_read_b128 a[164:167], v208 offset:35840
v_mfma_f32_16x16x32_bf16 v[56:59], a[168:171], a[124:127], v[56:59]
v_mov_b32 v255, v254
v_mov_b32 v253, v252
v_mfma_f32_16x16x32_bf16 v[60:63], a[172:175], a[120:123], v[60:63]
v_mfma_f32_16x16x32_bf16 v[64:67], a[172:175], a[124:127], v[64:67]
s_waitcnt lgkmcnt(4)
v_mov_b32 v251, v250
s_waitcnt vmcnt(2)
v_mfma_f32_16x16x32_bf16 v[36:39], a[144:147], a[128:131], v[36:39]
ds_read_b128 a[168:171], v209 offset:17408
ds_read_b128 a[172:175], v209 offset:35840
v_mfma_f32_16x16x32_bf16 v[40:43], a[144:147], a[132:135], v[40:43]
v_permlane16_swap_b32 v212, v214
v_mfma_f32_16x16x32_bf16 v[44:47], a[148:151], a[128:131], v[44:47]
v_permlane16_swap_b32 v254, v255
v_mfma_f32_16x16x32_bf16 v[48:51], a[148:151], a[132:135], v[48:51]
s_waitcnt lgkmcnt(4)
v_add_u32 v181, 160768, v239
v_mfma_f32_16x16x32_bf16 v[52:55], a[152:155], a[128:131], v[52:55]
ds_read_b64 a[144:145], v181 offset:0
ds_read_b64 a[148:149], v181 offset:512
v_mfma_f32_16x16x32_bf16 v[56:59], a[152:155], a[132:135], v[56:59]
v_permlane16_swap_b32 v252, v253
v_mfma_f32_16x16x32_bf16 v[60:63], a[156:159], a[128:131], v[60:63]
v_mfma_f32_16x16x32_bf16 v[64:67], a[156:159], a[132:135], v[64:67]
s_waitcnt vmcnt(0) lgkmcnt(4)
v_add_u32 v181, 36864, v239
v_mfma_f32_16x16x32_bf16 v[36:39], a[160:163], a[136:139], v[36:39]
ds_read_b64 a[152:153], v181 offset:0
ds_read_b64 a[156:157], v181 offset:512
v_mfma_f32_16x16x32_bf16 v[40:43], a[160:163], a[140:143], v[40:43]
v_permlane16_swap_b32 v250, v251
v_mfma_f32_16x16x32_bf16 v[44:47], a[164:167], a[136:139], v[44:47]
v_mov_b32 v213, v212
v_mfma_f32_16x16x32_bf16 v[48:51], a[164:167], a[140:143], v[48:51]
s_waitcnt lgkmcnt(4)
v_mov_b32 v215, v214
v_mfma_f32_16x16x32_bf16 v[52:55], a[168:171], a[136:139], v[52:55]
ds_read_b128 a[160:163], v210 offset:0
ds_read_b128 a[164:167], v210 offset:18432
v_mfma_f32_16x16x32_bf16 v[56:59], a[168:171], a[140:143], v[56:59]
v_mfma_f32_16x16x32_bf16 v[60:63], a[172:175], a[136:139], v[60:63]
v_mfma_f32_16x16x32_bf16 v[64:67], a[172:175], a[140:143], v[64:67]
s_waitcnt lgkmcnt(4)
v_mfma_f32_16x16x16_bf16 v[36:39], a[144:145], v[212:213], v[36:39]
ds_read_b128 a[168:171], v210 offset:1024
ds_read_b128 a[172:175], v210 offset:19456
v_mfma_f32_16x16x16_bf16 v[40:43], a[144:145], v[214:215], v[40:43]
v_mfma_f32_16x16x16_bf16 v[44:47], a[148:149], v[212:213], v[44:47]
v_mfma_f32_16x16x16_bf16 v[48:51], a[148:149], v[214:215], v[48:51]
s_waitcnt lgkmcnt(4)
v_mfma_f32_16x16x16_bf16 v[52:55], a[152:153], v[212:213], v[52:55]
ds_read_b128 a[144:147], v210 offset:2048
ds_read_b128 a[148:151], v210 offset:20480
v_mfma_f32_16x16x16_bf16 v[56:59], a[152:153], v[214:215], v[56:59]
v_mfma_f32_16x16x16_bf16 v[60:63], a[156:157], v[212:213], v[60:63]
v_mfma_f32_16x16x16_bf16 v[64:67], a[156:157], v[214:215], v[64:67]
s_waitcnt lgkmcnt(4)
s_barrier
v_mfma_f32_16x16x32_bf16 v[68:71], a[160:163], a[0:3], 0
ds_read_b128 a[152:155], v210 offset:3072
ds_read_b128 a[156:159], v210 offset:21504
v_mfma_f32_16x16x32_bf16 v[72:75], a[160:163], a[4:7], 0
s_mul_i32 s38, s24, 9216
s_add_u32 m0, s38, 123904
v_mfma_f32_16x16x32_bf16 v[76:79], a[164:167], a[0:3], 0
s_add_u32 s39, s38, s82
v_mfma_f32_16x16x32_bf16 v[80:83], a[164:167], a[4:7], 0
s_waitcnt lgkmcnt(4)
v_mfma_f32_16x16x32_bf16 v[68:71], a[168:171], a[8:11], v[68:71]
ds_read_b128 a[160:163], v210 offset:4096
ds_read_b128 a[164:167], v210 offset:22528
v_mfma_f32_16x16x32_bf16 v[72:75], a[168:171], a[12:15], v[72:75]
s_add_u32 s39, s39, 151552
v_mfma_f32_16x16x32_bf16 v[76:79], a[172:175], a[8:11], v[76:79]
buffer_load_dwordx4 v1, s[4:7], s39 offen offset:0 sc1 lds
buffer_load_dwordx4 v1, s[4:7], s39 offen offset:1024 sc1 lds
v_pk_mul_f32 v[216:217], v[36:37], v[36:37]
v_pk_mul_f32 v[218:219], v[38:39], v[38:39]
v_pk_mul_f32 v[220:221], v[40:41], v[40:41]
v_pk_mul_f32 v[222:223], v[42:43], v[42:43]
v_pk_fma_f32 v[216:217], v[216:217], v[252:253], v[250:251] op_sel:[0,0,0] op_sel_hi:[1,0,0]
v_pk_fma_f32 v[218:219], v[218:219], v[252:253], v[250:251] op_sel:[0,0,0] op_sel_hi:[1,0,0]
v_pk_fma_f32 v[220:221], v[220:221], v[252:253], v[250:251] op_sel:[0,1,1] op_sel_hi:[1,1,1]
v_pk_fma_f32 v[222:223], v[222:223], v[252:253], v[250:251] op_sel:[0,1,1] op_sel_hi:[1,1,1]
v_pk_mul_f32 v[216:217], v[216:217], v[36:37]
v_pk_mul_f32 v[218:219], v[218:219], v[38:39]
v_pk_mul_f32 v[220:221], v[220:221], v[40:41]
v_pk_mul_f32 v[222:223], v[222:223], v[42:43]
v_mfma_f32_16x16x32_bf16 v[80:83], a[172:175], a[12:15], v[80:83]
s_waitcnt lgkmcnt(4)
v_exp_f32 v216, v216
v_mfma_f32_16x16x32_bf16 v[68:71], a[144:147], a[16:19], v[68:71]
ds_read_b128 a[168:171], v210 offset:5120
ds_read_b128 a[172:175], v210 offset:23552
v_mfma_f32_16x16x32_bf16 v[72:75], a[144:147], a[20:23], v[72:75]
v_exp_f32 v217, v217
v_mfma_f32_16x16x32_bf16 v[76:79], a[148:151], a[16:19], v[76:79]
buffer_load_dwordx4 v1, s[4:7], s39 offen offset:2048 sc1 lds
buffer_load_dwordx4 v1, s[4:7], s39 offen offset:3072 sc1 lds
v_mfma_f32_16x16x32_bf16 v[80:83], a[148:151], a[20:23], v[80:83]
s_waitcnt lgkmcnt(4)
v_exp_f32 v218, v218
v_mfma_f32_16x16x32_bf16 v[68:71], a[152:155], a[24:27], v[68:71]
ds_read_b128 a[144:147], v210 offset:6144
ds_read_b128 a[148:151], v210 offset:24576
v_mfma_f32_16x16x32_bf16 v[72:75], a[152:155], a[28:31], v[72:75]
s_add_u32 m0, m0, 4096
v_fma_f32 v216, v216, v254, v254
v_fma_f32 v217, v217, v254, v254
v_mfma_f32_16x16x32_bf16 v[76:79], a[156:159], a[24:27], v[76:79]
s_add_u32 s39, s39, 4096
v_exp_f32 v219, v219
v_mfma_f32_16x16x32_bf16 v[80:83], a[156:159], a[28:31], v[80:83]
s_waitcnt lgkmcnt(4)
v_exp_f32 v220, v220
v_mfma_f32_16x16x32_bf16 v[68:71], a[160:163], a[32:35], v[68:71]
ds_read_b128 a[152:155], v210 offset:7168
ds_read_b128 a[156:159], v210 offset:25600
v_mfma_f32_16x16x32_bf16 v[72:75], a[160:163], a[36:39], v[72:75]
buffer_load_dwordx4 v1, s[4:7], s39 offen offset:0 sc1 lds
buffer_load_dwordx4 v1, s[4:7], s39 offen offset:1024 sc1 lds
v_mfma_f32_16x16x32_bf16 v[76:79], a[164:167], a[32:35], v[76:79]
v_fma_f32 v218, v218, v254, v254
v_fma_f32 v219, v219, v254, v254
v_mfma_f32_16x16x32_bf16 v[80:83], a[164:167], a[36:39], v[80:83]
s_waitcnt lgkmcnt(4)
v_exp_f32 v221, v221
v_mfma_f32_16x16x32_bf16 v[68:71], a[168:171], a[40:43], v[68:71]
ds_read_b128 a[160:163], v210 offset:8192
ds_read_b128 a[164:167], v210 offset:26624
v_exp_f32 v222, v222
v_mfma_f32_16x16x32_bf16 v[72:75], a[168:171], a[44:47], v[72:75]
buffer_load_dwordx4 v1, s[4:7], s39 offen offset:2048 sc1 lds
buffer_load_dwordx4 v1, s[4:7], s39 offen offset:3072 sc1 lds
v_mfma_f32_16x16x32_bf16 v[76:79], a[172:175], a[40:43], v[76:79]
s_add_u32 m0, m0, 4096
v_fma_f32 v220, v220, v255, v255
v_fma_f32 v221, v221, v255, v255
v_mfma_f32_16x16x32_bf16 v[80:83], a[172:175], a[44:47], v[80:83]
s_waitcnt lgkmcnt(4)
v_exp_f32 v223, v223
v_mfma_f32_16x16x32_bf16 v[68:71], a[144:147], a[48:51], v[68:71]
ds_read_b128 a[168:171], v210 offset:9216
ds_read_b128 a[172:175], v210 offset:27648
v_rcp_f32 v216, v216
v_mfma_f32_16x16x32_bf16 v[72:75], a[144:147], a[52:55], v[72:75]
s_add_u32 s39, s39, 4096
v_fma_f32 v222, v222, v255, v255
v_fma_f32 v223, v223, v255, v255
v_mfma_f32_16x16x32_bf16 v[76:79], a[148:151], a[48:51], v[76:79]
buffer_load_dwordx4 v1, s[4:7], s39 offen offset:0 sc1 lds
v_mfma_f32_16x16x32_bf16 v[80:83], a[148:151], a[52:55], v[80:83]
s_waitcnt lgkmcnt(4)
v_rcp_f32 v217, v217
v_mfma_f32_16x16x32_bf16 v[68:71], a[152:155], a[56:59], v[68:71]
ds_read_b128 a[144:147], v210 offset:10240
ds_read_b128 a[148:151], v210 offset:28672
v_rcp_f32 v218, v218
v_mfma_f32_16x16x32_bf16 v[72:75], a[152:155], a[60:63], v[72:75]
s_lshl_b32 s38, s24, 8
v_rcp_f32 v219, v219
v_mfma_f32_16x16x32_bf16 v[76:79], a[156:159], a[56:59], v[76:79]
s_add_u32 m0, s38, 160768
v_rcp_f32 v220, v220
v_mfma_f32_16x16x32_bf16 v[80:83], a[156:159], a[60:63], v[80:83]
s_waitcnt lgkmcnt(4)
s_add_u32 s39, s38, s82
v_mfma_f32_16x16x32_bf16 v[68:71], a[160:163], a[64:67], v[68:71]
ds_read_b128 a[152:155], v210 offset:11264
ds_read_b128 a[156:159], v210 offset:29696
v_mfma_f32_16x16x32_bf16 v[72:75], a[160:163], a[68:71], v[72:75]
s_add_u32 s39, s39, 188416
v_rcp_f32 v221, v221
v_mfma_f32_16x16x32_bf16 v[76:79], a[164:167], a[64:67], v[76:79]
v_rcp_f32 v222, v222
v_mfma_f32_16x16x32_bf16 v[80:83], a[164:167], a[68:71], v[80:83]
s_waitcnt lgkmcnt(4)
v_rcp_f32 v223, v223
v_mfma_f32_16x16x32_bf16 v[68:71], a[168:171], a[72:75], v[68:71]
ds_read_b128 a[160:163], v210 offset:12288
ds_read_b128 a[164:167], v210 offset:30720
v_pk_mul_f32 v[224:225], v[44:45], v[44:45]
v_pk_mul_f32 v[226:227], v[46:47], v[46:47]
v_pk_mul_f32 v[228:229], v[48:49], v[48:49]
v_pk_mul_f32 v[230:231], v[50:51], v[50:51]
v_pk_fma_f32 v[224:225], v[224:225], v[252:253], v[250:251] op_sel:[0,0,0] op_sel_hi:[1,0,0]
v_pk_fma_f32 v[226:227], v[226:227], v[252:253], v[250:251] op_sel:[0,0,0] op_sel_hi:[1,0,0]
v_pk_fma_f32 v[228:229], v[228:229], v[252:253], v[250:251] op_sel:[0,1,1] op_sel_hi:[1,1,1]
v_pk_fma_f32 v[230:231], v[230:231], v[252:253], v[250:251] op_sel:[0,1,1] op_sel_hi:[1,1,1]
v_pk_mul_f32 v[36:37], v[36:37], v[216:217]
v_pk_mul_f32 v[38:39], v[38:39], v[218:219]
v_pk_mul_f32 v[40:41], v[40:41], v[220:221]
v_pk_mul_f32 v[42:43], v[42:43], v[222:223]
v_pk_mul_f32 v[224:225], v[224:225], v[44:45]
v_pk_mul_f32 v[226:227], v[226:227], v[46:47]
v_pk_mul_f32 v[228:229], v[228:229], v[48:49]
v_pk_mul_f32 v[230:231], v[230:231], v[50:51]
v_mfma_f32_16x16x32_bf16 v[72:75], a[168:171], a[76:79], v[72:75]
s_mov_b64 exec, 0xffff
buffer_load_dwordx4 v1, s[4:7], s39 offen sc1 lds
s_mov_b64 exec, -1
v_exp_f32 v224, v224
v_mfma_f32_16x16x32_bf16 v[76:79], a[172:175], a[72:75], v[76:79]
v_exp_f32 v225, v225
v_mfma_f32_16x16x32_bf16 v[80:83], a[172:175], a[76:79], v[80:83]
s_waitcnt lgkmcnt(4)
v_exp_f32 v226, v226
v_mfma_f32_16x16x32_bf16 v[68:71], a[144:147], a[80:83], v[68:71]
ds_read_b128 a[168:171], v210 offset:13312
ds_read_b128 a[172:175], v210 offset:31744
v_mfma_f32_16x16x32_bf16 v[72:75], a[144:147], a[84:87], v[72:75]
s_mul_i32 s38, s24, 9216
v_fma_f32 v224, v224, v254, v254
v_fma_f32 v225, v225, v254, v254
v_mfma_f32_16x16x32_bf16 v[76:79], a[148:151], a[80:83], v[76:79]
s_add_u32 m0, s38, 0
v_exp_f32 v227, v227
v_mfma_f32_16x16x32_bf16 v[80:83], a[148:151], a[84:87], v[80:83]
s_waitcnt lgkmcnt(4)
v_exp_f32 v228, v228
v_mfma_f32_16x16x32_bf16 v[68:71], a[152:155], a[88:91], v[68:71]
ds_read_b128 a[144:147], v210 offset:14336
ds_read_b128 a[148:151], v210 offset:32768
v_mfma_f32_16x16x32_bf16 v[72:75], a[152:155], a[92:95], v[72:75]
s_add_u32 s39, s38, s82
v_fma_f32 v226, v226, v254, v254
v_fma_f32 v227, v227, v254, v254
v_mfma_f32_16x16x32_bf16 v[76:79], a[156:159], a[88:91], v[76:79]
s_add_u32 s39, s39, 189440
v_exp_f32 v229, v229
v_mfma_f32_16x16x32_bf16 v[80:83], a[156:159], a[92:95], v[80:83]
s_waitcnt lgkmcnt(4)
v_exp_f32 v230, v230
v_mfma_f32_16x16x32_bf16 v[68:71], a[160:163], a[96:99], v[68:71]
ds_read_b128 a[152:155], v210 offset:15360
ds_read_b128 a[156:159], v210 offset:33792
v_mfma_f32_16x16x32_bf16 v[72:75], a[160:163], a[100:103], v[72:75]
v_fma_f32 v228, v228, v255, v255
v_fma_f32 v229, v229, v255, v255
v_mfma_f32_16x16x32_bf16 v[76:79], a[164:167], a[96:99], v[76:79]
buffer_load_dwordx4 v1, s[4:7], s39 offen offset:0 sc1 lds
buffer_load_dwordx4 v1, s[4:7], s39 offen offset:1024 sc1 lds
v_exp_f32 v231, v231
v_mfma_f32_16x16x32_bf16 v[80:83], a[164:167], a[100:103], v[80:83]
s_waitcnt lgkmcnt(4)
v_rcp_f32 v224, v224
v_mfma_f32_16x16x32_bf16 v[68:71], a[168:171], a[104:107], v[68:71]
ds_read_b128 a[160:163], v210 offset:16384
ds_read_b128 a[164:167], v210 offset:34816
v_mfma_f32_16x16x32_bf16 v[72:75], a[168:171], a[108:111], v[72:75]
v_fma_f32 v230, v230, v255, v255
v_fma_f32 v231, v231, v255, v255
v_mfma_f32_16x16x32_bf16 v[76:79], a[172:175], a[104:107], v[76:79]
v_rcp_f32 v225, v225
v_mfma_f32_16x16x32_bf16 v[80:83], a[172:175], a[108:111], v[80:83]
s_waitcnt lgkmcnt(4)
v_rcp_f32 v226, v226
v_mfma_f32_16x16x32_bf16 v[68:71], a[144:147], a[112:115], v[68:71]
ds_read_b128 a[168:171], v210 offset:17408
ds_read_b128 a[172:175], v210 offset:35840
v_mfma_f32_16x16x32_bf16 v[72:75], a[144:147], a[116:119], v[72:75]
buffer_load_dwordx4 v1, s[4:7], s39 offen offset:2048 sc1 lds
buffer_load_dwordx4 v1, s[4:7], s39 offen offset:3072 sc1 lds
v_rcp_f32 v227, v227
v_mfma_f32_16x16x32_bf16 v[76:79], a[148:151], a[112:115], v[76:79]
s_add_u32 m0, m0, 4096
v_rcp_f32 v228, v228
v_mfma_f32_16x16x32_bf16 v[80:83], a[148:151], a[116:119], v[80:83]
s_waitcnt lgkmcnt(4)
v_add_u32 v181, 74752, v239
v_mfma_f32_16x16x32_bf16 v[68:71], a[152:155], a[120:123], v[68:71]
ds_read_b64 a[144:145], v181 offset:0
ds_read_b64 a[148:149], v181 offset:512
v_rcp_f32 v229, v229
v_mfma_f32_16x16x32_bf16 v[72:75], a[152:155], a[124:127], v[72:75]
s_add_u32 s39, s39, 4096
v_rcp_f32 v230, v230
v_mfma_f32_16x16x32_bf16 v[76:79], a[156:159], a[120:123], v[76:79]
v_rcp_f32 v231, v231
v_mfma_f32_16x16x32_bf16 v[80:83], a[156:159], a[124:127], v[80:83]
s_waitcnt lgkmcnt(4)
v_pk_mul_f32 v[216:217], v[52:53], v[52:53]
v_pk_mul_f32 v[218:219], v[54:55], v[54:55]
v_pk_mul_f32 v[220:221], v[56:57], v[56:57]
v_pk_mul_f32 v[222:223], v[58:59], v[58:59]
v_pk_fma_f32 v[216:217], v[216:217], v[252:253], v[250:251] op_sel:[0,0,0] op_sel_hi:[1,0,0]
v_pk_fma_f32 v[218:219], v[218:219], v[252:253], v[250:251] op_sel:[0,0,0] op_sel_hi:[1,0,0]
v_pk_fma_f32 v[220:221], v[220:221], v[252:253], v[250:251] op_sel:[0,1,1] op_sel_hi:[1,1,1]
v_pk_fma_f32 v[222:223], v[222:223], v[252:253], v[250:251] op_sel:[0,1,1] op_sel_hi:[1,1,1]
v_pk_mul_f32 v[44:45], v[44:45], v[224:225]
v_pk_mul_f32 v[46:47], v[46:47], v[226:227]
v_pk_mul_f32 v[48:49], v[48:49], v[228:229]
v_pk_mul_f32 v[50:51], v[50:51], v[230:231]
v_pk_mul_f32 v[216:217], v[216:217], v[52:53]
v_pk_mul_f32 v[218:219], v[218:219], v[54:55]
v_pk_mul_f32 v[220:221], v[220:221], v[56:57]
v_pk_mul_f32 v[222:223], v[222:223], v[58:59]
v_mfma_f32_16x16x32_bf16 v[68:71], a[160:163], a[128:131], v[68:71]
ds_read_b128 a[152:155], v211 offset:0
ds_read_b128 a[156:159], v211 offset:18432
v_exp_f32 v216, v216
v_mfma_f32_16x16x32_bf16 v[72:75], a[160:163], a[132:135], v[72:75]
buffer_load_dwordx4 v1, s[4:7], s39 offen offset:0 sc1 lds
buffer_load_dwordx4 v1, s[4:7], s39 offen offset:1024 sc1 lds
v_exp_f32 v217, v217
v_mfma_f32_16x16x32_bf16 v[76:79], a[164:167], a[128:131], v[76:79]
v_exp_f32 v218, v218
v_mfma_f32_16x16x32_bf16 v[80:83], a[164:167], a[132:135], v[80:83]
s_waitcnt lgkmcnt(4)
v_fma_f32 v216, v216, v254, v254
v_fma_f32 v217, v217, v254, v254
v_mfma_f32_16x16x32_bf16 v[68:71], a[168:171], a[136:139], v[68:71]
ds_read_b128 a[160:163], v211 offset:1024
ds_read_b128 a[164:167], v211 offset:19456
v_mfma_f32_16x16x32_bf16 v[72:75], a[168:171], a[140:143], v[72:75]
v_exp_f32 v219, v219
v_mfma_f32_16x16x32_bf16 v[76:79], a[172:175], a[136:139], v[76:79]
v_exp_f32 v220, v220
v_mfma_f32_16x16x32_bf16 v[80:83], a[172:175], a[140:143], v[80:83]
s_waitcnt lgkmcnt(4)
v_fma_f32 v218, v218, v254, v254
v_fma_f32 v219, v219, v254, v254
v_mfma_f32_16x16x16_bf16 v[68:71], a[144:145], v[212:213], v[68:71]
ds_read_b128 a[168:171], v211 offset:2048
ds_read_b128 a[172:175], v211 offset:20480
v_mfma_f32_16x16x16_bf16 v[72:75], a[144:145], v[214:215], v[72:75]
buffer_load_dwordx4 v1, s[4:7], s39 offen offset:2048 sc1 lds
buffer_load_dwordx4 v1, s[4:7], s39 offen offset:3072 sc1 lds
v_exp_f32 v221, v221
v_mfma_f32_16x16x16_bf16 v[76:79], a[148:149], v[212:213], v[76:79]
s_add_u32 m0, m0, 4096
v_exp_f32 v222, v222
v_mfma_f32_16x16x16_bf16 v[80:83], a[148:149], v[214:215], v[80:83]
s_waitcnt vmcnt(8) lgkmcnt(4)
s_barrier
v_mfma_f32_16x16x32_bf16 v[84:87], a[152:155], a[0:3], 0
ds_read_b128 a[144:147], v211 offset:3072
ds_read_b128 a[148:151], v211 offset:21504
v_fma_f32 v220, v220, v255, v255
v_fma_f32 v221, v221, v255, v255
v_mfma_f32_16x16x32_bf16 v[88:91], a[152:155], a[4:7], 0
buffer_load_dwordx4 a[176:179], v1, s[4:7], s52 offen offset:0 sc1
buffer_load_dwordx4 a[180:183], v9, s[4:7], s52 offen offset:0 sc1
v_exp_f32 v223, v223
v_mfma_f32_16x16x32_bf16 v[92:95], a[156:159], a[0:3], 0
s_add_u32 s39, s39, 4096
v_rcp_f32 v216, v216
v_mfma_f32_16x16x32_bf16 v[96:99], a[156:159], a[4:7], 0
s_waitcnt lgkmcnt(4)
v_fma_f32 v222, v222, v255, v255
v_fma_f32 v223, v223, v255, v255
v_mfma_f32_16x16x32_bf16 v[84:87], a[160:163], a[8:11], v[84:87]
ds_read_b128 a[152:155], v211 offset:4096
ds_read_b128 a[156:159], v211 offset:22528
v_mfma_f32_16x16x32_bf16 v[88:91], a[160:163], a[12:15], v[88:91]
buffer_load_dwordx4 v1, s[4:7], s39 offen offset:0 sc1 lds
v_rcp_f32 v217, v217
v_mfma_f32_16x16x32_bf16 v[92:95], a[164:167], a[8:11], v[92:95]
s_lshl_b32 s38, s24, 8
v_rcp_f32 v218, v218
v_mfma_f32_16x16x32_bf16 v[96:99], a[164:167], a[12:15], v[96:99]
s_waitcnt lgkmcnt(4)
v_rcp_f32 v219, v219
v_mfma_f32_16x16x32_bf16 v[84:87], a[168:171], a[16:19], v[84:87]
ds_read_b128 a[160:163], v211 offset:5120
ds_read_b128 a[164:167], v211 offset:23552
v_mfma_f32_16x16x32_bf16 v[88:91], a[168:171], a[20:23], v[88:91]
s_add_u32 m0, s38, 36864
v_rcp_f32 v220, v220
v_mfma_f32_16x16x32_bf16 v[92:95], a[172:175], a[16:19], v[92:95]
buffer_load_dwordx4 a[184:187], v1, s[4:7], s52 offen offset:1024 sc1
buffer_load_dwordx4 a[188:191], v9, s[4:7], s52 offen offset:1024 sc1
v_mfma_f32_16x16x32_bf16 v[96:99], a[172:175], a[20:23], v[96:99]
s_waitcnt lgkmcnt(4)
v_rcp_f32 v221, v221
v_mfma_f32_16x16x32_bf16 v[84:87], a[144:147], a[24:27], v[84:87]
ds_read_b128 a[168:171], v211 offset:6144
ds_read_b128 a[172:175], v211 offset:24576
v_rcp_f32 v222, v222
v_mfma_f32_16x16x32_bf16 v[88:91], a[144:147], a[28:31], v[88:91]
s_add_u32 s39, s38, s82
v_rcp_f32 v223, v223
v_mfma_f32_16x16x32_bf16 v[92:95], a[148:151], a[24:27], v[92:95]
s_add_u32 s39, s39, 226304
v_pk_mul_f32 v[224:225], v[60:61], v[60:61]
v_pk_mul_f32 v[226:227], v[62:63], v[62:63]
v_pk_mul_f32 v[228:229], v[64:65], v[64:65]
v_pk_mul_f32 v[230:231], v[66:67], v[66:67]
v_pk_fma_f32 v[224:225], v[224:225], v[252:253], v[250:251] op_sel:[0,0,0] op_sel_hi:[1,0,0]
v_pk_fma_f32 v[226:227], v[226:227], v[252:253], v[250:251] op_sel:[0,0,0] op_sel_hi:[1,0,0]
v_pk_fma_f32 v[228:229], v[228:229], v[252:253], v[250:251] op_sel:[0,1,1] op_sel_hi:[1,1,1]
v_pk_fma_f32 v[230:231], v[230:231], v[252:253], v[250:251] op_sel:[0,1,1] op_sel_hi:[1,1,1]
v_pk_mul_f32 v[52:53], v[52:53], v[216:217]
v_pk_mul_f32 v[54:55], v[54:55], v[218:219]
v_pk_mul_f32 v[56:57], v[56:57], v[220:221]
v_pk_mul_f32 v[58:59], v[58:59], v[222:223]
v_pk_mul_f32 v[224:225], v[224:225], v[60:61]
v_pk_mul_f32 v[226:227], v[226:227], v[62:63]
v_pk_mul_f32 v[228:229], v[228:229], v[64:65]
v_pk_mul_f32 v[230:231], v[230:231], v[66:67]
v_mfma_f32_16x16x32_bf16 v[96:99], a[148:151], a[28:31], v[96:99]
s_waitcnt lgkmcnt(4)
v_exp_f32 v224, v224
v_mfma_f32_16x16x32_bf16 v[84:87], a[152:155], a[32:35], v[84:87]
ds_read_b128 a[144:147], v211 offset:7168
ds_read_b128 a[148:151], v211 offset:25600
v_exp_f32 v225, v225
v_mfma_f32_16x16x32_bf16 v[88:91], a[152:155], a[36:39], v[88:91]
v_exp_f32 v226, v226
v_mfma_f32_16x16x32_bf16 v[92:95], a[156:159], a[32:35], v[92:95]
s_mov_b64 exec, 0xffff
buffer_load_dwordx4 v1, s[4:7], s39 offen sc1 lds
s_mov_b64 exec, -1
v_mfma_f32_16x16x32_bf16 v[96:99], a[156:159], a[36:39], v[96:99]
s_waitcnt lgkmcnt(4)
v_fma_f32 v224, v224, v254, v254
v_fma_f32 v225, v225, v254, v254
v_mfma_f32_16x16x32_bf16 v[84:87], a[160:163], a[40:43], v[84:87]
ds_read_b128 a[152:155], v211 offset:8192
ds_read_b128 a[156:159], v211 offset:26624
v_exp_f32 v227, v227
v_mfma_f32_16x16x32_bf16 v[88:91], a[160:163], a[44:47], v[88:91]
buffer_load_dwordx4 a[192:195], v1, s[4:7], s52 offen offset:2048 sc1
buffer_load_dwordx4 a[196:199], v9, s[4:7], s52 offen offset:2048 sc1
v_exp_f32 v228, v228
v_mfma_f32_16x16x32_bf16 v[92:95], a[164:167], a[40:43], v[92:95]
v_fma_f32 v226, v226, v254, v254
v_fma_f32 v227, v227, v254, v254
v_mfma_f32_16x16x32_bf16 v[96:99], a[164:167], a[44:47], v[96:99]
s_waitcnt lgkmcnt(4)
v_exp_f32 v229, v229
v_mfma_f32_16x16x32_bf16 v[84:87], a[168:171], a[48:51], v[84:87]
ds_read_b128 a[160:163], v211 offset:9216
ds_read_b128 a[164:167], v211 offset:27648
v_mfma_f32_16x16x32_bf16 v[88:91], a[168:171], a[52:55], v[88:91]
v_exp_f32 v230, v230
v_mfma_f32_16x16x32_bf16 v[92:95], a[172:175], a[48:51], v[92:95]
s_mul_i32 s38, s24, 9216
v_fma_f32 v228, v228, v255, v255
v_fma_f32 v229, v229, v255, v255
v_mfma_f32_16x16x32_bf16 v[96:99], a[172:175], a[52:55], v[96:99]
s_waitcnt lgkmcnt(4)
v_exp_f32 v231, v231
v_mfma_f32_16x16x32_bf16 v[84:87], a[144:147], a[56:59], v[84:87]
ds_read_b128 a[168:171], v211 offset:10240
ds_read_b128 a[172:175], v211 offset:28672
v_mfma_f32_16x16x32_bf16 v[88:91], a[144:147], a[60:63], v[88:91]
s_add_u32 m0, s38, 37888
v_rcp_f32 v224, v224
v_mfma_f32_16x16x32_bf16 v[92:95], a[148:151], a[56:59], v[92:95]
s_add_u32 s39, s38, s82
v_fma_f32 v230, v230, v255, v255
v_fma_f32 v231, v231, v255, v255
v_mfma_f32_16x16x32_bf16 v[96:99], a[148:151], a[60:63], v[96:99]
s_waitcnt lgkmcnt(4)
v_rcp_f32 v225, v225
v_mfma_f32_16x16x32_bf16 v[84:87], a[152:155], a[64:67], v[84:87]
ds_read_b128 a[144:147], v211 offset:11264
ds_read_b128 a[148:151], v211 offset:29696
v_mfma_f32_16x16x32_bf16 v[88:91], a[152:155], a[68:71], v[88:91]
buffer_load_dwordx4 a[200:203], v1, s[4:7], s52 offen offset:3072 sc1
buffer_load_dwordx4 a[204:207], v9, s[4:7], s52 offen offset:3072 sc1
v_rcp_f32 v226, v226
v_mfma_f32_16x16x32_bf16 v[92:95], a[156:159], a[64:67], v[92:95]
s_add_u32 s39, s39, 227328
v_rcp_f32 v227, v227
v_mfma_f32_16x16x32_bf16 v[96:99], a[156:159], a[68:71], v[96:99]
s_waitcnt lgkmcnt(4)
v_rcp_f32 v228, v228
v_mfma_f32_16x16x32_bf16 v[84:87], a[160:163], a[72:75], v[84:87]
ds_read_b128 a[152:155], v211 offset:12288
ds_read_b128 a[156:159], v211 offset:30720
v_mfma_f32_16x16x32_bf16 v[88:91], a[160:163], a[76:79], v[88:91]
buffer_load_dwordx4 v1, s[4:7], s39 offen offset:0 sc1 lds
buffer_load_dwordx4 v1, s[4:7], s39 offen offset:1024 sc1 lds
v_mfma_f32_16x16x32_bf16 v[92:95], a[164:167], a[72:75], v[92:95]
s_mov_b32 s52, s53
v_rcp_f32 v229, v229
v_mfma_f32_16x16x32_bf16 v[96:99], a[164:167], a[76:79], v[96:99]
s_waitcnt lgkmcnt(4)
v_rcp_f32 v230, v230
v_mfma_f32_16x16x32_bf16 v[84:87], a[168:171], a[80:83], v[84:87]
ds_read_b128 a[160:163], v211 offset:13312
ds_read_b128 a[164:167], v211 offset:31744
v_rcp_f32 v231, v231
v_mfma_f32_16x16x32_bf16 v[88:91], a[168:171], a[84:87], v[88:91]
buffer_load_dwordx4 v1, s[4:7], s39 offen offset:2048 sc1 lds
buffer_load_dwordx4 v1, s[4:7], s39 offen offset:3072 sc1 lds
v_pk_mul_f32 v[216:217], v[68:69], v[68:69]
v_pk_mul_f32 v[218:219], v[70:71], v[70:71]
v_pk_mul_f32 v[220:221], v[72:73], v[72:73]
v_pk_mul_f32 v[222:223], v[74:75], v[74:75]
v_pk_fma_f32 v[216:217], v[216:217], v[252:253], v[250:251] op_sel:[0,0,0] op_sel_hi:[1,0,0]
v_pk_fma_f32 v[218:219], v[218:219], v[252:253], v[250:251] op_sel:[0,0,0] op_sel_hi:[1,0,0]
v_pk_fma_f32 v[220:221], v[220:221], v[252:253], v[250:251] op_sel:[0,1,1] op_sel_hi:[1,1,1]
v_pk_fma_f32 v[222:223], v[222:223], v[252:253], v[250:251] op_sel:[0,1,1] op_sel_hi:[1,1,1]
v_pk_mul_f32 v[60:61], v[60:61], v[224:225]
v_pk_mul_f32 v[62:63], v[62:63], v[226:227]
v_pk_mul_f32 v[64:65], v[64:65], v[228:229]
v_pk_mul_f32 v[66:67], v[66:67], v[230:231]
v_pk_mul_f32 v[216:217], v[216:217], v[68:69]
v_pk_mul_f32 v[218:219], v[218:219], v[70:71]
v_pk_mul_f32 v[220:221], v[220:221], v[72:73]
v_pk_mul_f32 v[222:223], v[222:223], v[74:75]
v_mfma_f32_16x16x32_bf16 v[92:95], a[172:175], a[80:83], v[92:95]
s_add_u32 m0, m0, 4096
v_exp_f32 v216, v216
v_mfma_f32_16x16x32_bf16 v[96:99], a[172:175], a[84:87], v[96:99]
s_waitcnt lgkmcnt(4)
v_exp_f32 v217, v217
v_mfma_f32_16x16x32_bf16 v[84:87], a[144:147], a[88:91], v[84:87]
ds_read_b128 a[168:171], v211 offset:14336
ds_read_b128 a[172:175], v211 offset:32768
v_exp_f32 v218, v218
v_mfma_f32_16x16x32_bf16 v[88:91], a[144:147], a[92:95], v[88:91]
s_add_u32 s39, s39, 4096
v_fma_f32 v216, v216, v254, v254
v_fma_f32 v217, v217, v254, v254
v_mfma_f32_16x16x32_bf16 v[92:95], a[148:151], a[88:91], v[92:95]
s_cmp_eq_u32 s25, 0
s_cselect_b32 s98, 4096, 0
v_mfma_f32_16x16x32_bf16 v[96:99], a[148:151], a[92:95], v[96:99]
s_waitcnt lgkmcnt(4)
v_exp_f32 v219, v219
v_mfma_f32_16x16x32_bf16 v[84:87], a[152:155], a[96:99], v[84:87]
ds_read_b128 a[144:147], v211 offset:15360
ds_read_b128 a[148:151], v211 offset:33792
v_exp_f32 v220, v220
v_mfma_f32_16x16x32_bf16 v[88:91], a[152:155], a[100:103], v[88:91]
s_add_u32 s52, s52, s98
v_fma_f32 v218, v218, v254, v254
v_fma_f32 v219, v219, v254, v254
v_mfma_f32_16x16x32_bf16 v[92:95], a[156:159], a[96:99], v[92:95]
v_exp_f32 v221, v221
v_mfma_f32_16x16x32_bf16 v[96:99], a[156:159], a[100:103], v[96:99]
s_waitcnt lgkmcnt(4)
v_exp_f32 v222, v222
v_mfma_f32_16x16x32_bf16 v[84:87], a[160:163], a[104:107], v[84:87]
ds_read_b128 a[152:155], v211 offset:16384
ds_read_b128 a[156:159], v211 offset:34816
v_mfma_f32_16x16x32_bf16 v[88:91], a[160:163], a[108:111], v[88:91]
buffer_load_dwordx4 v1, s[4:7], s39 offen offset:0 sc1 lds
buffer_load_dwordx4 v1, s[4:7], s39 offen offset:1024 sc1 lds
v_mfma_f32_16x16x32_bf16 v[92:95], a[164:167], a[104:107], v[92:95]
v_fma_f32 v220, v220, v255, v255
v_fma_f32 v221, v221, v255, v255
v_mfma_f32_16x16x32_bf16 v[96:99], a[164:167], a[108:111], v[96:99]
s_waitcnt lgkmcnt(4)
v_exp_f32 v223, v223
v_mfma_f32_16x16x32_bf16 v[84:87], a[168:171], a[112:115], v[84:87]
ds_read_b128 a[160:163], v211 offset:17408
ds_read_b128 a[164:167], v211 offset:35840
v_rcp_f32 v216, v216
v_mfma_f32_16x16x32_bf16 v[88:91], a[168:171], a[116:119], v[88:91]
buffer_load_dwordx4 v1, s[4:7], s39 offen offset:2048 sc1 lds
buffer_load_dwordx4 v1, s[4:7], s39 offen offset:3072 sc1 lds
v_mfma_f32_16x16x32_bf16 v[92:95], a[172:175], a[112:115], v[92:95]
s_add_u32 m0, m0, 4096
v_fma_f32 v222, v222, v255, v255
v_fma_f32 v223, v223, v255, v255
v_mfma_f32_16x16x32_bf16 v[96:99], a[172:175], a[116:119], v[96:99]
s_waitcnt lgkmcnt(4)
v_rcp_f32 v217, v217
v_add_u32 v181, 112640, v239
v_mfma_f32_16x16x32_bf16 v[84:87], a[144:147], a[120:123], v[84:87]
ds_read_b64 a[168:169], v181 offset:0
ds_read_b64 a[172:173], v181 offset:512
v_rcp_f32 v218, v218
v_mfma_f32_16x16x32_bf16 v[88:91], a[144:147], a[124:127], v[88:91]
s_add_u32 s39, s39, 4096
v_rcp_f32 v219, v219
v_mfma_f32_16x16x32_bf16 v[92:95], a[148:151], a[120:123], v[92:95]
v_rcp_f32 v220, v220
v_mfma_f32_16x16x32_bf16 v[96:99], a[148:151], a[124:127], v[96:99]
s_waitcnt lgkmcnt(4)
v_rcp_f32 v221, v221
v_mfma_f32_16x16x32_bf16 v[84:87], a[152:155], a[128:131], v[84:87]
ds_read_b128 a[144:147], v208 offset:0
ds_read_b128 a[148:151], v208 offset:18432
v_mfma_f32_16x16x32_bf16 v[88:91], a[152:155], a[132:135], v[88:91]
buffer_load_dwordx4 a[208:211], v1, s[4:7], s52 offen offset:0 sc1
buffer_load_dwordx4 a[212:215], v9, s[4:7], s52 offen offset:0 sc1
v_mfma_f32_16x16x32_bf16 v[92:95], a[156:159], a[128:131], v[92:95]
v_rcp_f32 v222, v222
v_mfma_f32_16x16x32_bf16 v[96:99], a[156:159], a[132:135], v[96:99]
s_waitcnt lgkmcnt(4)
v_rcp_f32 v223, v223
v_mfma_f32_16x16x32_bf16 v[84:87], a[160:163], a[136:139], v[84:87]
ds_read_b128 a[152:155], v208 offset:1024
ds_read_b128 a[156:159], v208 offset:19456
v_pk_mul_f32 v[224:225], v[76:77], v[76:77]
v_pk_mul_f32 v[226:227], v[78:79], v[78:79]
v_pk_mul_f32 v[228:229], v[80:81], v[80:81]
v_pk_mul_f32 v[230:231], v[82:83], v[82:83]
v_pk_fma_f32 v[224:225], v[224:225], v[252:253], v[250:251] op_sel:[0,0,0] op_sel_hi:[1,0,0]
v_pk_fma_f32 v[226:227], v[226:227], v[252:253], v[250:251] op_sel:[0,0,0] op_sel_hi:[1,0,0]
v_pk_fma_f32 v[228:229], v[228:229], v[252:253], v[250:251] op_sel:[0,1,1] op_sel_hi:[1,1,1]
v_pk_fma_f32 v[230:231], v[230:231], v[252:253], v[250:251] op_sel:[0,1,1] op_sel_hi:[1,1,1]
v_pk_mul_f32 v[68:69], v[68:69], v[216:217]
v_pk_mul_f32 v[70:71], v[70:71], v[218:219]
v_pk_mul_f32 v[72:73], v[72:73], v[220:221]
v_pk_mul_f32 v[74:75], v[74:75], v[222:223]
v_pk_mul_f32 v[224:225], v[224:225], v[76:77]
v_pk_mul_f32 v[226:227], v[226:227], v[78:79]
v_pk_mul_f32 v[228:229], v[228:229], v[80:81]
v_pk_mul_f32 v[230:231], v[230:231], v[82:83]
v_mfma_f32_16x16x32_bf16 v[88:91], a[160:163], a[140:143], v[88:91]
buffer_load_dwordx4 v1, s[4:7], s39 offen offset:0 sc1 lds
s_lshl_b32 s38, s24, 8
v_exp_f32 v224, v224
v_mfma_f32_16x16x32_bf16 v[92:95], a[164:167], a[136:139], v[92:95]
s_add_u32 m0, s38, 74752
v_exp_f32 v225, v225
v_mfma_f32_16x16x32_bf16 v[96:99], a[164:167], a[140:143], v[96:99]
s_waitcnt lgkmcnt(4)
v_exp_f32 v226, v226
v_mfma_f32_16x16x16_bf16 v[84:87], a[168:169], v[212:213], v[84:87]
ds_read_b128 a[160:163], v208 offset:2048
ds_read_b128 a[164:167], v208 offset:20480
v_mfma_f32_16x16x16_bf16 v[88:91], a[168:169], v[214:215], v[88:91]
s_add_u32 s39, s38, s82
v_fma_f32 v224, v224, v254, v254
v_fma_f32 v225, v225, v254, v254
v_mfma_f32_16x16x16_bf16 v[92:95], a[172:173], v[212:213], v[92:95]
s_add_u32 s39, s39, 264192
v_exp_f32 v227, v227
v_mfma_f32_16x16x16_bf16 v[96:99], a[172:173], v[214:215], v[96:99]
s_waitcnt lgkmcnt(4)
v_exp_f32 v228, v228
s_waitcnt vmcnt(15)
s_barrier
v_mfma_f32_16x16x32_bf16 v[100:103], a[144:147], a[0:3], 0
ds_read_b128 a[168:171], v208 offset:3072
ds_read_b128 a[172:175], v208 offset:21504
v_mfma_f32_16x16x32_bf16 v[104:107], a[144:147], a[4:7], 0
buffer_load_dwordx4 a[216:219], v1, s[4:7], s52 offen offset:1024 sc1
buffer_load_dwordx4 a[220:223], v9, s[4:7], s52 offen offset:1024 sc1
v_fma_f32 v226, v226, v254, v254
v_fma_f32 v227, v227, v254, v254
v_mfma_f32_16x16x32_bf16 v[108:111], a[148:151], a[0:3], 0
v_exp_f32 v229, v229
v_mfma_f32_16x16x32_bf16 v[112:115], a[148:151], a[4:7], 0
s_waitcnt lgkmcnt(4)
v_exp_f32 v230, v230
v_mfma_f32_16x16x32_bf16 v[100:103], a[152:155], a[8:11], v[100:103]
ds_read_b128 a[144:147], v208 offset:4096
ds_read_b128 a[148:151], v208 offset:22528
v_mfma_f32_16x16x32_bf16 v[104:107], a[152:155], a[12:15], v[104:107]
s_mov_b64 exec, 0xffff
buffer_load_dwordx4 v1, s[4:7], s39 offen sc1 lds
s_mov_b64 exec, -1
v_fma_f32 v228, v228, v255, v255
v_fma_f32 v229, v229, v255, v255
v_mfma_f32_16x16x32_bf16 v[108:111], a[156:159], a[8:11], v[108:111]
v_exp_f32 v231, v231
v_mfma_f32_16x16x32_bf16 v[112:115], a[156:159], a[12:15], v[112:115]
s_waitcnt lgkmcnt(4)
v_rcp_f32 v224, v224
v_mfma_f32_16x16x32_bf16 v[100:103], a[160:163], a[16:19], v[100:103]
ds_read_b128 a[152:155], v208 offset:5120
ds_read_b128 a[156:159], v208 offset:23552
v_mfma_f32_16x16x32_bf16 v[104:107], a[160:163], a[20:23], v[104:107]
buffer_load_dwordx4 a[224:227], v1, s[4:7], s52 offen offset:2048 sc1
buffer_load_dwordx4 a[228:231], v9, s[4:7], s52 offen offset:2048 sc1
v_fma_f32 v230, v230, v255, v255
v_fma_f32 v231, v231, v255, v255
v_mfma_f32_16x16x32_bf16 v[108:111], a[164:167], a[16:19], v[108:111]
v_rcp_f32 v225, v225
v_mfma_f32_16x16x32_bf16 v[112:115], a[164:167], a[20:23], v[112:115]
s_waitcnt lgkmcnt(4)
v_rcp_f32 v226, v226
v_mfma_f32_16x16x32_bf16 v[100:103], a[168:171], a[24:27], v[100:103]
ds_read_b128 a[160:163], v208 offset:6144
ds_read_b128 a[164:167], v208 offset:24576
v_mfma_f32_16x16x32_bf16 v[104:107], a[168:171], a[28:31], v[104:107]
s_mul_i32 s38, s24, 9216
v_rcp_f32 v227, v227
v_mfma_f32_16x16x32_bf16 v[108:111], a[172:175], a[24:27], v[108:111]
s_add_u32 m0, s38, 75776
v_rcp_f32 v228, v228
v_mfma_f32_16x16x32_bf16 v[112:115], a[172:175], a[28:31], v[112:115]
s_waitcnt lgkmcnt(4)
v_rcp_f32 v229, v229
v_mfma_f32_16x16x32_bf16 v[100:103], a[144:147], a[32:35], v[100:103]
ds_read_b128 a[168:171], v208 offset:7168
ds_read_b128 a[172:175], v208 offset:25600
v_mfma_f32_16x16x32_bf16 v[104:107], a[144:147], a[36:39], v[104:107]
s_add_u32 s39, s38, s82
v_rcp_f32 v230, v230
v_mfma_f32_16x16x32_bf16 v[108:111], a[148:151], a[32:35], v[108:111]
s_add_u32 s39, s39, 265216
v_rcp_f32 v231, v231
v_mfma_f32_16x16x32_bf16 v[112:115], a[148:151], a[36:39], v[112:115]
s_waitcnt lgkmcnt(4)
v_pk_mul_f32 v[216:217], v[84:85], v[84:85]
v_pk_mul_f32 v[218:219], v[86:87], v[86:87]
v_pk_mul_f32 v[220:221], v[88:89], v[88:89]
v_pk_mul_f32 v[222:223], v[90:91], v[90:91]
v_pk_fma_f32 v[216:217], v[216:217], v[252:253], v[250:251] op_sel:[0,0,0] op_sel_hi:[1,0,0]
v_pk_fma_f32 v[218:219], v[218:219], v[252:253], v[250:251] op_sel:[0,0,0] op_sel_hi:[1,0,0]
v_pk_fma_f32 v[220:221], v[220:221], v[252:253], v[250:251] op_sel:[0,1,1] op_sel_hi:[1,1,1]
v_pk_fma_f32 v[222:223], v[222:223], v[252:253], v[250:251] op_sel:[0,1,1] op_sel_hi:[1,1,1]
v_pk_mul_f32 v[76:77], v[76:77], v[224:225]
v_pk_mul_f32 v[78:79], v[78:79], v[226:227]
v_pk_mul_f32 v[80:81], v[80:81], v[228:229]
v_pk_mul_f32 v[82:83], v[82:83], v[230:231]
v_pk_mul_f32 v[216:217], v[216:217], v[84:85]
v_pk_mul_f32 v[218:219], v[218:219], v[86:87]
v_pk_mul_f32 v[220:221], v[220:221], v[88:89]
v_pk_mul_f32 v[222:223], v[222:223], v[90:91]
v_mfma_f32_16x16x32_bf16 v[100:103], a[152:155], a[40:43], v[100:103]
ds_read_b128 a[144:147], v208 offset:8192
ds_read_b128 a[148:151], v208 offset:26624
v_exp_f32 v216, v216
v_mfma_f32_16x16x32_bf16 v[104:107], a[152:155], a[44:47], v[104:107]
buffer_load_dwordx4 a[232:235], v1, s[4:7], s52 offen offset:3072 sc1
buffer_load_dwordx4 a[236:239], v9, s[4:7], s52 offen offset:3072 sc1
v_exp_f32 v217, v217
v_mfma_f32_16x16x32_bf16 v[108:111], a[156:159], a[40:43], v[108:111]
buffer_load_dwordx4 v1, s[4:7], s39 offen offset:0 sc1 lds
buffer_load_dwordx4 v1, s[4:7], s39 offen offset:1024 sc1 lds
v_exp_f32 v218, v218
v_mfma_f32_16x16x32_bf16 v[112:115], a[156:159], a[44:47], v[112:115]
s_waitcnt lgkmcnt(4)
v_fma_f32 v216, v216, v254, v254
v_fma_f32 v217, v217, v254, v254
v_mfma_f32_16x16x32_bf16 v[100:103], a[160:163], a[48:51], v[100:103]
ds_read_b128 a[152:155], v208 offset:9216
ds_read_b128 a[156:159], v208 offset:27648
v_mfma_f32_16x16x32_bf16 v[104:107], a[160:163], a[52:55], v[104:107]
s_cmp_eq_u32 s25, 1
s_cselect_b32 s98, 4096, 0
v_exp_f32 v219, v219
v_mfma_f32_16x16x32_bf16 v[108:111], a[164:167], a[48:51], v[108:111]
s_add_u32 s52, s52, s98
v_exp_f32 v220, v220
v_mfma_f32_16x16x32_bf16 v[112:115], a[164:167], a[52:55], v[112:115]
s_waitcnt lgkmcnt(4)
v_fma_f32 v218, v218, v254, v254
v_fma_f32 v219, v219, v254, v254
v_mfma_f32_16x16x32_bf16 v[100:103], a[168:171], a[56:59], v[100:103]
ds_read_b128 a[160:163], v208 offset:10240
ds_read_b128 a[164:167], v208 offset:28672
v_mfma_f32_16x16x32_bf16 v[104:107], a[168:171], a[60:63], v[104:107]
buffer_load_dwordx4 v1, s[4:7], s39 offen offset:2048 sc1 lds
buffer_load_dwordx4 v1, s[4:7], s39 offen offset:3072 sc1 lds
v_exp_f32 v221, v221
v_mfma_f32_16x16x32_bf16 v[108:111], a[172:175], a[56:59], v[108:111]
s_add_u32 m0, m0, 4096
v_exp_f32 v222, v222
v_mfma_f32_16x16x32_bf16 v[112:115], a[172:175], a[60:63], v[112:115]
s_waitcnt lgkmcnt(4)
v_fma_f32 v220, v220, v255, v255
v_fma_f32 v221, v221, v255, v255
v_mfma_f32_16x16x32_bf16 v[100:103], a[144:147], a[64:67], v[100:103]
ds_read_b128 a[168:171], v208 offset:11264
ds_read_b128 a[172:175], v208 offset:29696
v_mfma_f32_16x16x32_bf16 v[104:107], a[144:147], a[68:71], v[104:107]
s_add_u32 s39, s39, 4096
v_exp_f32 v223, v223
v_mfma_f32_16x16x32_bf16 v[108:111], a[148:151], a[64:67], v[108:111]
s_add_u32 s52, s52, 4096
v_rcp_f32 v216, v216
v_mfma_f32_16x16x32_bf16 v[112:115], a[148:151], a[68:71], v[112:115]
s_waitcnt lgkmcnt(4)
v_fma_f32 v222, v222, v255, v255
v_fma_f32 v223, v223, v255, v255
v_mfma_f32_16x16x32_bf16 v[100:103], a[152:155], a[72:75], v[100:103]
ds_read_b128 a[144:147], v208 offset:12288
ds_read_b128 a[148:151], v208 offset:30720
v_mfma_f32_16x16x32_bf16 v[104:107], a[152:155], a[76:79], v[104:107]
buffer_load_dwordx4 v1, s[4:7], s39 offen offset:0 sc1 lds
buffer_load_dwordx4 v1, s[4:7], s39 offen offset:1024 sc1 lds
v_rcp_f32 v217, v217
v_mfma_f32_16x16x32_bf16 v[108:111], a[156:159], a[72:75], v[108:111]
v_rcp_f32 v218, v218
v_mfma_f32_16x16x32_bf16 v[112:115], a[156:159], a[76:79], v[112:115]
s_waitcnt lgkmcnt(4)
v_rcp_f32 v219, v219
v_mfma_f32_16x16x32_bf16 v[100:103], a[160:163], a[80:83], v[100:103]
ds_read_b128 a[152:155], v208 offset:13312
ds_read_b128 a[156:159], v208 offset:31744
v_mfma_f32_16x16x32_bf16 v[104:107], a[160:163], a[84:87], v[104:107]
v_rcp_f32 v220, v220
v_mfma_f32_16x16x32_bf16 v[108:111], a[164:167], a[80:83], v[108:111]
v_rcp_f32 v221, v221
v_mfma_f32_16x16x32_bf16 v[112:115], a[164:167], a[84:87], v[112:115]
s_waitcnt lgkmcnt(4)
v_rcp_f32 v222, v222
v_mfma_f32_16x16x32_bf16 v[100:103], a[168:171], a[88:91], v[100:103]
ds_read_b128 a[160:163], v208 offset:14336
ds_read_b128 a[164:167], v208 offset:32768
v_mfma_f32_16x16x32_bf16 v[104:107], a[168:171], a[92:95], v[104:107]
buffer_load_dwordx4 v1, s[4:7], s39 offen offset:2048 sc1 lds
buffer_load_dwordx4 v1, s[4:7], s39 offen offset:3072 sc1 lds
v_rcp_f32 v223, v223
v_mfma_f32_16x16x32_bf16 v[108:111], a[172:175], a[88:91], v[108:111]
s_add_u32 m0, m0, 4096
v_pk_mul_f32 v[224:225], v[92:93], v[92:93]
v_pk_mul_f32 v[226:227], v[94:95], v[94:95]
v_pk_mul_f32 v[228:229], v[96:97], v[96:97]
v_pk_mul_f32 v[230:231], v[98:99], v[98:99]
v_pk_fma_f32 v[224:225], v[224:225], v[252:253], v[250:251] op_sel:[0,0,0] op_sel_hi:[1,0,0]
v_pk_fma_f32 v[226:227], v[226:227], v[252:253], v[250:251] op_sel:[0,0,0] op_sel_hi:[1,0,0]
v_pk_fma_f32 v[228:229], v[228:229], v[252:253], v[250:251] op_sel:[0,1,1] op_sel_hi:[1,1,1]
v_pk_fma_f32 v[230:231], v[230:231], v[252:253], v[250:251] op_sel:[0,1,1] op_sel_hi:[1,1,1]
v_pk_mul_f32 v[84:85], v[84:85], v[216:217]
v_pk_mul_f32 v[86:87], v[86:87], v[218:219]
v_pk_mul_f32 v[88:89], v[88:89], v[220:221]
v_pk_mul_f32 v[90:91], v[90:91], v[222:223]
v_pk_mul_f32 v[224:225], v[224:225], v[92:93]
v_pk_mul_f32 v[226:227], v[226:227], v[94:95]
v_pk_mul_f32 v[228:229], v[228:229], v[96:97]
v_pk_mul_f32 v[230:231], v[230:231], v[98:99]
v_mfma_f32_16x16x32_bf16 v[112:115], a[172:175], a[92:95], v[112:115]
s_waitcnt lgkmcnt(4)
v_exp_f32 v224, v224
v_mfma_f32_16x16x32_bf16 v[100:103], a[144:147], a[96:99], v[100:103]
ds_read_b128 a[168:171], v208 offset:15360
ds_read_b128 a[172:175], v208 offset:33792
v_exp_f32 v225, v225
v_mfma_f32_16x16x32_bf16 v[104:107], a[144:147], a[100:103], v[104:107]
s_add_u32 s39, s39, 4096
v_exp_f32 v226, v226
v_mfma_f32_16x16x32_bf16 v[108:111], a[148:151], a[96:99], v[108:111]
v_fma_f32 v224, v224, v254, v254
v_fma_f32 v225, v225, v254, v254
v_mfma_f32_16x16x32_bf16 v[112:115], a[148:151], a[100:103], v[112:115]
s_waitcnt lgkmcnt(4)
v_exp_f32 v227, v227
v_mfma_f32_16x16x32_bf16 v[100:103], a[152:155], a[104:107], v[100:103]
ds_read_b128 a[144:147], v208 offset:16384
ds_read_b128 a[148:151], v208 offset:34816
v_mfma_f32_16x16x32_bf16 v[104:107], a[152:155], a[108:111], v[104:107]
buffer_load_dwordx4 v1, s[4:7], s39 offen offset:0 sc1 lds
v_exp_f32 v228, v228
v_mfma_f32_16x16x32_bf16 v[108:111], a[156:159], a[104:107], v[108:111]
buffer_load_dwordx4 a[240:243], v1, s[4:7], s52 offen offset:0 sc1
buffer_load_dwordx4 a[244:247], v9, s[4:7], s52 offen offset:0 sc1
v_mfma_f32_16x16x32_bf16 v[112:115], a[156:159], a[108:111], v[112:115]
s_waitcnt lgkmcnt(4)
s_lshl_b32 s38, s24, 8
v_fma_f32 v226, v226, v254, v254
v_fma_f32 v227, v227, v254, v254
v_mfma_f32_16x16x32_bf16 v[100:103], a[160:163], a[112:115], v[100:103]
ds_read_b128 a[152:155], v208 offset:17408
ds_read_b128 a[156:159], v208 offset:35840
v_exp_f32 v229, v229
v_mfma_f32_16x16x32_bf16 v[104:107], a[160:163], a[116:119], v[104:107]
s_add_u32 m0, s38, 112640
v_exp_f32 v230, v230
v_mfma_f32_16x16x32_bf16 v[108:111], a[164:167], a[112:115], v[108:111]
s_add_u32 s39, s38, s82
v_fma_f32 v228, v228, v255, v255
v_fma_f32 v229, v229, v255, v255
v_mfma_f32_16x16x32_bf16 v[112:115], a[164:167], a[116:119], v[112:115]
s_waitcnt lgkmcnt(4)
v_add_u32 v181, 160768, v239
v_mfma_f32_16x16x32_bf16 v[100:103], a[168:171], a[120:123], v[100:103]
ds_read_b64 a[160:161], v181 offset:0
ds_read_b64 a[164:165], v181 offset:512
v_exp_f32 v231, v231
v_mfma_f32_16x16x32_bf16 v[104:107], a[168:171], a[124:127], v[104:107]
s_add_u32 s39, s39, 302080
v_rcp_f32 v224, v224
v_mfma_f32_16x16x32_bf16 v[108:111], a[172:175], a[120:123], v[108:111]
v_fma_f32 v230, v230, v255, v255
v_fma_f32 v231, v231, v255, v255
v_mfma_f32_16x16x32_bf16 v[112:115], a[172:175], a[124:127], v[112:115]
s_waitcnt lgkmcnt(4)
v_rcp_f32 v225, v225
v_mfma_f32_16x16x32_bf16 v[100:103], a[144:147], a[128:131], v[100:103]
ds_read_b128 a[168:171], v209 offset:0
ds_read_b128 a[172:175], v209 offset:18432
v_mfma_f32_16x16x32_bf16 v[104:107], a[144:147], a[132:135], v[104:107]
buffer_load_dwordx4 a[248:251], v1, s[4:7], s52 offen offset:1024 sc1
buffer_load_dwordx4 a[252:255], v9, s[4:7], s52 offen offset:1024 sc1
v_rcp_f32 v226, v226
v_mfma_f32_16x16x32_bf16 v[108:111], a[148:151], a[128:131], v[108:111]
s_mov_b64 exec, 0xffff
buffer_load_dwordx4 v1, s[4:7], s39 offen sc1 lds
s_mov_b64 exec, -1
v_mfma_f32_16x16x32_bf16 v[112:115], a[148:151], a[132:135], v[112:115]
s_waitcnt lgkmcnt(4)
v_rcp_f32 v227, v227
v_mfma_f32_16x16x32_bf16 v[100:103], a[152:155], a[136:139], v[100:103]
ds_read_b128 a[144:147], v209 offset:1024
ds_read_b128 a[148:151], v209 offset:19456
v_rcp_f32 v228, v228
v_mfma_f32_16x16x32_bf16 v[104:107], a[152:155], a[140:143], v[104:107]
s_mov_b32 s37, L_c4-L_pc
v_rcp_f32 v229, v229
v_mfma_f32_16x16x32_bf16 v[108:111], a[156:159], a[136:139], v[108:111]
v_rcp_f32 v230, v230
v_mfma_f32_16x16x32_bf16 v[112:115], a[156:159], a[140:143], v[112:115]
s_waitcnt lgkmcnt(4)
v_rcp_f32 v231, v231
v_mfma_f32_16x16x16_bf16 v[100:103], a[160:161], v[212:213], v[100:103]
ds_read_b128 a[152:155], v209 offset:2048
ds_read_b128 a[156:159], v209 offset:20480
v_mfma_f32_16x16x16_bf16 v[104:107], a[160:161], v[214:215], v[104:107]
v_mfma_f32_16x16x16_bf16 v[108:111], a[164:165], v[212:213], v[108:111]
v_mfma_f32_16x16x16_bf16 v[112:115], a[164:165], v[214:215], v[112:115]
s_waitcnt vmcnt(18) lgkmcnt(4)
s_barrier
v_mfma_f32_16x16x32_bf16 v[116:119], a[168:171], a[0:3], 0
ds_read_b128 a[160:163], v209 offset:3072
ds_read_b128 a[164:167], v209 offset:21504
v_mfma_f32_16x16x32_bf16 v[120:123], a[168:171], a[4:7], 0
s_mul_i32 s38, s24, 9216
s_add_u32 m0, s38, 123904
v_mfma_f32_16x16x32_bf16 v[124:127], a[172:175], a[0:3], 0
s_add_u32 s39, s38, s82
v_mfma_f32_16x16x32_bf16 v[128:131], a[172:175], a[4:7], 0
s_waitcnt lgkmcnt(4)
s_add_u32 s39, s39, 303104
v_mfma_f32_16x16x32_bf16 v[116:119], a[144:147], a[8:11], v[116:119]
ds_read_b128 a[168:171], v209 offset:4096
ds_read_b128 a[172:175], v209 offset:22528
v_mfma_f32_16x16x32_bf16 v[120:123], a[144:147], a[12:15], v[120:123]
buffer_load_dwordx4 v1, s[4:7], s39 offen offset:0 sc1 lds
buffer_load_dwordx4 v1, s[4:7], s39 offen offset:1024 sc1 lds
v_mfma_f32_16x16x32_bf16 v[124:127], a[148:151], a[8:11], v[124:127]
buffer_load_dword v15, v14, s[88:91], s37 offen
v_pk_mul_f32 v[216:217], v[100:101], v[100:101]
v_pk_mul_f32 v[218:219], v[102:103], v[102:103]
v_pk_mul_f32 v[220:221], v[104:105], v[104:105]
v_pk_mul_f32 v[222:223], v[106:107], v[106:107]
v_pk_fma_f32 v[216:217], v[216:217], v[252:253], v[250:251] op_sel:[0,0,0] op_sel_hi:[1,0,0]
v_pk_fma_f32 v[218:219], v[218:219], v[252:253], v[250:251] op_sel:[0,0,0] op_sel_hi:[1,0,0]
v_pk_fma_f32 v[220:221], v[220:221], v[252:253], v[250:251] op_sel:[0,1,1] op_sel_hi:[1,1,1]
v_pk_fma_f32 v[222:223], v[222:223], v[252:253], v[250:251] op_sel:[0,1,1] op_sel_hi:[1,1,1]
v_pk_mul_f32 v[92:93], v[92:93], v[224:225]
v_pk_mul_f32 v[94:95], v[94:95], v[226:227]
v_pk_mul_f32 v[96:97], v[96:97], v[228:229]
v_pk_mul_f32 v[98:99], v[98:99], v[230:231]
v_pk_mul_f32 v[216:217], v[216:217], v[100:101]
v_pk_mul_f32 v[218:219], v[218:219], v[102:103]
v_pk_mul_f32 v[220:221], v[220:221], v[104:105]
v_pk_mul_f32 v[222:223], v[222:223], v[106:107]
v_mfma_f32_16x16x32_bf16 v[128:131], a[148:151], a[12:15], v[128:131]
s_waitcnt lgkmcnt(4)
v_exp_f32 v216, v216
v_exp_f32 v217, v217
v_exp_f32 v218, v218
v_fma_f32 v216, v216, v254, v254
v_fma_f32 v217, v217, v254, v254
v_exp_f32 v219, v219
v_exp_f32 v220, v220
v_fma_f32 v218, v218, v254, v254
v_fma_f32 v219, v219, v254, v254
v_exp_f32 v221, v221
v_mfma_f32_16x16x32_bf16 v[116:119], a[152:155], a[16:19], v[116:119]
ds_read_b128 a[144:147], v209 offset:5120
ds_read_b128 a[148:151], v209 offset:23552
v_exp_f32 v222, v222
v_mfma_f32_16x16x32_bf16 v[120:123], a[152:155], a[20:23], v[120:123]
buffer_load_dwordx4 v1, s[4:7], s39 offen offset:2048 sc1 lds
buffer_load_dwordx4 v1, s[4:7], s39 offen offset:3072 sc1 lds
v_mfma_f32_16x16x32_bf16 v[124:127], a[156:159], a[16:19], v[124:127]
s_add_u32 m0, m0, 4096
v_fma_f32 v220, v220, v255, v255
v_fma_f32 v221, v221, v255, v255
v_mfma_f32_16x16x32_bf16 v[128:131], a[156:159], a[20:23], v[128:131]
s_waitcnt lgkmcnt(4)
s_add_u32 s39, s39, 4096
v_exp_f32 v223, v223
v_mfma_f32_16x16x32_bf16 v[116:119], a[160:163], a[24:27], v[116:119]
ds_read_b128 a[152:155], v209 offset:6144
ds_read_b128 a[156:159], v209 offset:24576
v_rcp_f32 v216, v216
v_mfma_f32_16x16x32_bf16 v[120:123], a[160:163], a[28:31], v[120:123]
buffer_load_dwordx4 v1, s[4:7], s39 offen offset:0 sc1 lds
buffer_load_dwordx4 v1, s[4:7], s39 offen offset:1024 sc1 lds
v_mfma_f32_16x16x32_bf16 v[124:127], a[164:167], a[24:27], v[124:127]
v_fma_f32 v222, v222, v255, v255
v_fma_f32 v223, v223, v255, v255
v_mfma_f32_16x16x32_bf16 v[128:131], a[164:167], a[28:31], v[128:131]
s_waitcnt lgkmcnt(4)
v_rcp_f32 v217, v217
v_mfma_f32_16x16x32_bf16 v[116:119], a[168:171], a[32:35], v[116:119]
ds_read_b128 a[160:163], v209 offset:7168
ds_read_b128 a[164:167], v209 offset:25600
v_rcp_f32 v218, v218
v_mfma_f32_16x16x32_bf16 v[120:123], a[168:171], a[36:39], v[120:123]
buffer_load_dwordx4 v1, s[4:7], s39 offen offset:2048 sc1 lds
buffer_load_dwordx4 v1, s[4:7], s39 offen offset:3072 sc1 lds
v_mfma_f32_16x16x32_bf16 v[124:127], a[172:175], a[32:35], v[124:127]
s_add_u32 m0, m0, 4096
s_add_u32 s39, s39, 4096
v_rcp_f32 v219, v219
v_mfma_f32_16x16x32_bf16 v[128:131], a[172:175], a[36:39], v[128:131]
s_waitcnt lgkmcnt(4)
v_rcp_f32 v220, v220
v_mfma_f32_16x16x32_bf16 v[116:119], a[144:147], a[40:43], v[116:119]
ds_read_b128 a[168:171], v209 offset:8192
ds_read_b128 a[172:175], v209 offset:26624
v_rcp_f32 v221, v221
v_rcp_f32 v222, v222
v_rcp_f32 v223, v223
v_mfma_f32_16x16x32_bf16 v[120:123], a[144:147], a[44:47], v[120:123]
buffer_load_dwordx4 v1, s[4:7], s39 offen offset:0 sc1 lds
s_lshl_b32 s38, s24, 8
s_nop 0
v_pk_mul_f32 v[100:101], v[100:101], v[216:217]
v_pk_mul_f32 v[102:103], v[102:103], v[218:219]
v_pk_mul_f32 v[104:105], v[104:105], v[220:221]
v_pk_mul_f32 v[106:107], v[106:107], v[222:223]
v_pk_add_f32 v[198:199], v[36:37], v[38:39]
v_pk_mul_f32 v[200:201], v[36:37], v[36:37]
v_pk_fma_f32 v[200:201], v[38:39], v[38:39], v[200:201]
v_pk_add_f32 v[202:203], v[40:41], v[42:43]
v_pk_mul_f32 v[204:205], v[40:41], v[40:41]
v_pk_fma_f32 v[204:205], v[42:43], v[42:43], v[204:205]
v_pk_add_f32 v[198:199], v[198:199], v[44:45]
v_pk_fma_f32 v[200:201], v[44:45], v[44:45], v[200:201]
v_pk_add_f32 v[198:199], v[198:199], v[46:47]
v_pk_fma_f32 v[200:201], v[46:47], v[46:47], v[200:201]
v_pk_add_f32 v[202:203], v[202:203], v[48:49]
v_pk_fma_f32 v[204:205], v[48:49], v[48:49], v[204:205]
v_pk_add_f32 v[202:203], v[202:203], v[50:51]
v_pk_fma_f32 v[204:205], v[50:51], v[50:51], v[204:205]
v_pk_add_f32 v[198:199], v[198:199], v[52:53]
v_pk_fma_f32 v[200:201], v[52:53], v[52:53], v[200:201]
v_pk_add_f32 v[198:199], v[198:199], v[54:55]
v_pk_fma_f32 v[200:201], v[54:55], v[54:55], v[200:201]
v_pk_add_f32 v[202:203], v[202:203], v[56:57]
v_pk_fma_f32 v[204:205], v[56:57], v[56:57], v[204:205]
v_pk_add_f32 v[202:203], v[202:203], v[58:59]
v_pk_fma_f32 v[204:205], v[58:59], v[58:59], v[204:205]
v_pk_add_f32 v[198:199], v[198:199], v[60:61]
v_pk_fma_f32 v[200:201], v[60:61], v[60:61], v[200:201]
v_pk_add_f32 v[198:199], v[198:199], v[62:63]
v_pk_fma_f32 v[200:201], v[62:63], v[62:63], v[200:201]
v_pk_add_f32 v[202:203], v[202:203], v[64:65]
v_pk_fma_f32 v[204:205], v[64:65], v[64:65], v[204:205]
v_pk_add_f32 v[202:203], v[202:203], v[66:67]
v_pk_fma_f32 v[204:205], v[66:67], v[66:67], v[204:205]
v_pk_add_f32 v[198:199], v[198:199], v[68:69]
v_pk_fma_f32 v[200:201], v[68:69], v[68:69], v[200:201]
v_pk_add_f32 v[198:199], v[198:199], v[70:71]
v_pk_fma_f32 v[200:201], v[70:71], v[70:71], v[200:201]
v_pk_add_f32 v[202:203], v[202:203], v[72:73]
v_pk_fma_f32 v[204:205], v[72:73], v[72:73], v[204:205]
v_pk_add_f32 v[202:203], v[202:203], v[74:75]
v_pk_fma_f32 v[204:205], v[74:75], v[74:75], v[204:205]
v_pk_add_f32 v[198:199], v[198:199], v[76:77]
v_pk_fma_f32 v[200:201], v[76:77], v[76:77], v[200:201]
v_pk_add_f32 v[198:199], v[198:199], v[78:79]
v_pk_fma_f32 v[200:201], v[78:79], v[78:79], v[200:201]
v_pk_add_f32 v[202:203], v[202:203], v[80:81]
v_pk_fma_f32 v[204:205], v[80:81], v[80:81], v[204:205]
v_pk_add_f32 v[202:203], v[202:203], v[82:83]
v_pk_fma_f32 v[204:205], v[82:83], v[82:83], v[204:205]
v_pk_add_f32 v[198:199], v[198:199], v[84:85]
v_pk_fma_f32 v[200:201], v[84:85], v[84:85], v[200:201]
v_pk_add_f32 v[198:199], v[198:199], v[86:87]
v_pk_fma_f32 v[200:201], v[86:87], v[86:87], v[200:201]
v_pk_add_f32 v[202:203], v[202:203], v[88:89]
v_pk_fma_f32 v[204:205], v[88:89], v[88:89], v[204:205]
v_pk_add_f32 v[202:203], v[202:203], v[90:91]
v_pk_fma_f32 v[204:205], v[90:91], v[90:91], v[204:205]
v_pk_add_f32 v[198:199], v[198:199], v[92:93]
v_pk_fma_f32 v[200:201], v[92:93], v[92:93], v[200:201]
v_pk_add_f32 v[198:199], v[198:199], v[94:95]
v_pk_fma_f32 v[200:201], v[94:95], v[94:95], v[200:201]
v_pk_add_f32 v[202:203], v[202:203], v[96:97]
v_pk_fma_f32 v[204:205], v[96:97], v[96:97], v[204:205]
v_pk_add_f32 v[202:203], v[202:203], v[98:99]
v_pk_fma_f32 v[204:205], v[98:99], v[98:99], v[204:205]
v_pk_add_f32 v[198:199], v[198:199], v[100:101]
v_pk_fma_f32 v[200:201], v[100:101], v[100:101], v[200:201]
v_pk_add_f32 v[198:199], v[198:199], v[102:103]
v_pk_fma_f32 v[200:201], v[102:103], v[102:103], v[200:201]
v_pk_add_f32 v[202:203], v[202:203], v[104:105]
v_pk_fma_f32 v[204:205], v[104:105], v[104:105], v[204:205]
v_pk_add_f32 v[202:203], v[202:203], v[106:107]
v_pk_fma_f32 v[204:205], v[106:107], v[106:107], v[204:205]
v_mfma_f32_16x16x32_bf16 v[124:127], a[148:151], a[40:43], v[124:127]
s_add_u32 m0, s38, 160768
v_add_f32 v198, v198, v199
v_add_f32 v202, v202, v203
v_mfma_f32_16x16x32_bf16 v[128:131], a[148:151], a[44:47], v[128:131]
s_waitcnt lgkmcnt(4)
s_add_u32 s39, s38, s82
v_add_f32 v200, v200, v201
v_add_f32 v204, v204, v205
v_permlane16_swap_b32 v198, v202
v_mfma_f32_16x16x32_bf16 v[116:119], a[152:155], a[48:51], v[116:119]
ds_read_b128 a[144:147], v209 offset:9216
ds_read_b128 a[148:151], v209 offset:27648
s_nop 0
v_mfma_f32_16x16x32_bf16 v[120:123], a[152:155], a[52:55], v[120:123]
s_add_u32 s39, s39, 339968
v_permlane16_swap_b32 v200, v204
v_mfma_f32_16x16x32_bf16 v[124:127], a[156:159], a[48:51], v[124:127]
s_mov_b64 exec, 0xffff
buffer_load_dwordx4 v1, s[4:7], s39 offen sc1 lds
s_mov_b64 exec, -1
v_add_f32 v198, v198, v202
v_add_f32 v199, v200, v204
v_mov_b32 v200, v198
v_mfma_f32_16x16x32_bf16 v[128:131], a[156:159], a[52:55], v[128:131]
s_waitcnt lgkmcnt(4)
v_mov_b32 v201, v199
s_nop 0
v_mfma_f32_16x16x32_bf16 v[116:119], a[160:163], a[56:59], v[116:119]
ds_read_b128 a[152:155], v209 offset:10240
ds_read_b128 a[156:159], v209 offset:28672
v_permlane32_swap_b32 v198, v200
v_permlane32_swap_b32 v199, v201
v_mfma_f32_16x16x32_bf16 v[120:123], a[160:163], a[60:63], v[120:123]
v_add_f32 v198, v198, v200
v_add_f32 v199, v199, v201
v_mfma_f32_16x16x32_bf16 v[124:127], a[164:167], a[56:59], v[124:127]
s_mov_b32 exec_hi, 0
buffer_store_dwordx2 v[198:199], v239, s[8:11], s30 offen sc1
s_mov_b64 exec, -1
v_mfma_f32_16x16x32_bf16 v[128:131], a[164:167], a[60:63], v[128:131]
s_waitcnt lgkmcnt(4)
v_mfma_f32_16x16x32_bf16 v[116:119], a[168:171], a[64:67], v[116:119]
ds_read_b128 a[160:163], v209 offset:11264
ds_read_b128 a[164:167], v209 offset:29696
v_mfma_f32_16x16x32_bf16 v[120:123], a[168:171], a[68:71], v[120:123]
v_mfma_f32_16x16x32_bf16 v[124:127], a[172:175], a[64:67], v[124:127]
v_mfma_f32_16x16x32_bf16 v[128:131], a[172:175], a[68:71], v[128:131]
s_waitcnt lgkmcnt(4)
v_mfma_f32_16x16x32_bf16 v[116:119], a[144:147], a[72:75], v[116:119]
ds_read_b128 a[168:171], v209 offset:12288
ds_read_b128 a[172:175], v209 offset:30720
v_mfma_f32_16x16x32_bf16 v[120:123], a[144:147], a[76:79], v[120:123]
v_mfma_f32_16x16x32_bf16 v[124:127], a[148:151], a[72:75], v[124:127]
v_mfma_f32_16x16x32_bf16 v[128:131], a[148:151], a[76:79], v[128:131]
s_waitcnt lgkmcnt(4)
v_mfma_f32_16x16x32_bf16 v[116:119], a[152:155], a[80:83], v[116:119]
ds_read_b128 a[144:147], v209 offset:13312
ds_read_b128 a[148:151], v209 offset:31744
v_mfma_f32_16x16x32_bf16 v[120:123], a[152:155], a[84:87], v[120:123]
v_mfma_f32_16x16x32_bf16 v[124:127], a[156:159], a[80:83], v[124:127]
v_mfma_f32_16x16x32_bf16 v[128:131], a[156:159], a[84:87], v[128:131]
s_waitcnt lgkmcnt(4)
v_mfma_f32_16x16x32_bf16 v[116:119], a[160:163], a[88:91], v[116:119]
ds_read_b128 a[152:155], v209 offset:14336
ds_read_b128 a[156:159], v209 offset:32768
v_mfma_f32_16x16x32_bf16 v[120:123], a[160:163], a[92:95], v[120:123]
v_mfma_f32_16x16x32_bf16 v[124:127], a[164:167], a[88:91], v[124:127]
v_mfma_f32_16x16x32_bf16 v[128:131], a[164:167], a[92:95], v[128:131]
s_waitcnt lgkmcnt(4)
v_mfma_f32_16x16x32_bf16 v[116:119], a[168:171], a[96:99], v[116:119]
ds_read_b128 a[160:163], v209 offset:15360
ds_read_b128 a[164:167], v209 offset:33792
v_mfma_f32_16x16x32_bf16 v[120:123], a[168:171], a[100:103], v[120:123]
v_mfma_f32_16x16x32_bf16 v[124:127], a[172:175], a[96:99], v[124:127]
v_mfma_f32_16x16x32_bf16 v[128:131], a[172:175], a[100:103], v[128:131]
s_waitcnt lgkmcnt(4)
v_mfma_f32_16x16x32_bf16 v[116:119], a[144:147], a[104:107], v[116:119]
ds_read_b128 a[168:171], v209 offset:16384
ds_read_b128 a[172:175], v209 offset:34816
v_mfma_f32_16x16x32_bf16 v[120:123], a[144:147], a[108:111], v[120:123]
v_mfma_f32_16x16x32_bf16 v[124:127], a[148:151], a[104:107], v[124:127]
v_mfma_f32_16x16x32_bf16 v[128:131], a[148:151], a[108:111], v[128:131]
s_waitcnt lgkmcnt(4)
v_mfma_f32_16x16x32_bf16 v[116:119], a[152:155], a[112:115], v[116:119]
ds_read_b128 a[144:147], v209 offset:17408
ds_read_b128 a[148:151], v209 offset:35840
v_mfma_f32_16x16x32_bf16 v[120:123], a[152:155], a[116:119], v[120:123]
v_mfma_f32_16x16x32_bf16 v[124:127], a[156:159], a[112:115], v[124:127]
v_mfma_f32_16x16x32_bf16 v[128:131], a[156:159], a[116:119], v[128:131]
s_waitcnt lgkmcnt(4)
v_add_u32 v181, 36864, v239
v_mfma_f32_16x16x32_bf16 v[116:119], a[160:163], a[120:123], v[116:119]
ds_read_b64 a[152:153], v181 offset:0
ds_read_b64 a[156:157], v181 offset:512
v_mfma_f32_16x16x32_bf16 v[120:123], a[160:163], a[124:127], v[120:123]
v_mfma_f32_16x16x32_bf16 v[124:127], a[164:167], a[120:123], v[124:127]
v_mfma_f32_16x16x32_bf16 v[128:131], a[164:167], a[124:127], v[128:131]
s_waitcnt lgkmcnt(4)
v_mfma_f32_16x16x32_bf16 v[116:119], a[168:171], a[128:131], v[116:119]
ds_read_b128 a[160:163], v210 offset:0
ds_read_b128 a[164:167], v210 offset:18432
v_mfma_f32_16x16x32_bf16 v[120:123], a[168:171], a[132:135], v[120:123]
buffer_load_dwordx2 v[182:183], v234, s[8:11], s61 offen offset:0 sc1
v_mfma_f32_16x16x32_bf16 v[124:127], a[172:175], a[128:131], v[124:127]
buffer_load_dwordx2 v[184:185], v234, s[8:11], s61 offen offset:1024 sc1
v_mfma_f32_16x16x32_bf16 v[128:131], a[172:175], a[132:135], v[128:131]
s_waitcnt lgkmcnt(4)
v_mfma_f32_16x16x32_bf16 v[116:119], a[144:147], a[136:139], v[116:119]
ds_read_b128 a[168:171], v210 offset:1024
ds_read_b128 a[172:175], v210 offset:19456
v_mfma_f32_16x16x32_bf16 v[120:123], a[144:147], a[140:143], v[120:123]
buffer_load_dwordx2 v[186:187], v234, s[8:11], s61 offen offset:2048 sc1
v_mfma_f32_16x16x32_bf16 v[124:127], a[148:151], a[136:139], v[124:127]
buffer_load_dwordx2 v[188:189], v234, s[8:11], s61 offen offset:3072 sc1
v_mfma_f32_16x16x32_bf16 v[128:131], a[148:151], a[140:143], v[128:131]
s_waitcnt lgkmcnt(4)
v_mfma_f32_16x16x16_bf16 v[116:119], a[152:153], v[212:213], v[116:119]
ds_read_b128 a[144:147], v210 offset:2048
ds_read_b128 a[148:151], v210 offset:20480
v_mfma_f32_16x16x16_bf16 v[120:123], a[152:153], v[214:215], v[120:123]
buffer_load_dwordx2 v[190:191], v235, s[8:11], s61 offen offset:0 sc1
v_mfma_f32_16x16x16_bf16 v[124:127], a[156:157], v[212:213], v[124:127]
buffer_load_dwordx2 v[192:193], v235, s[8:11], s61 offen offset:1024 sc1
v_mfma_f32_16x16x16_bf16 v[128:131], a[156:157], v[214:215], v[128:131]
s_waitcnt vmcnt(18) lgkmcnt(4)
s_barrier
v_mfma_f32_16x16x32_bf16 v[132:135], a[160:163], a[0:3], 0
ds_read_b128 a[152:155], v210 offset:3072
ds_read_b128 a[156:159], v210 offset:21504
v_mfma_f32_16x16x32_bf16 v[136:139], a[160:163], a[4:7], 0
buffer_load_dwordx2 v[194:195], v235, s[8:11], s61 offen offset:2048 sc1
v_mfma_f32_16x16x32_bf16 v[140:143], a[164:167], a[0:3], 0
buffer_load_dwordx2 v[196:197], v235, s[8:11], s61 offen offset:3072 sc1
v_mfma_f32_16x16x32_bf16 v[144:147], a[164:167], a[4:7], 0
s_waitcnt lgkmcnt(4)
v_mfma_f32_16x16x32_bf16 v[132:135], a[168:171], a[8:11], v[132:135]
ds_read_b128 a[160:163], v210 offset:4096
ds_read_b128 a[164:167], v210 offset:22528
v_mfma_f32_16x16x32_bf16 v[136:139], a[168:171], a[12:15], v[136:139]
v_mfma_f32_16x16x32_bf16 v[140:143], a[172:175], a[8:11], v[140:143]
v_mfma_f32_16x16x32_bf16 v[144:147], a[172:175], a[12:15], v[144:147]
s_waitcnt lgkmcnt(4)
v_mfma_f32_16x16x32_bf16 v[132:135], a[144:147], a[16:19], v[132:135]
ds_read_b128 a[168:171], v210 offset:5120
ds_read_b128 a[172:175], v210 offset:23552
v_mfma_f32_16x16x32_bf16 v[136:139], a[144:147], a[20:23], v[136:139]
v_mfma_f32_16x16x32_bf16 v[140:143], a[148:151], a[16:19], v[140:143]
v_mfma_f32_16x16x32_bf16 v[144:147], a[148:151], a[20:23], v[144:147]
s_waitcnt lgkmcnt(4)
v_mfma_f32_16x16x32_bf16 v[132:135], a[152:155], a[24:27], v[132:135]
ds_read_b128 a[144:147], v210 offset:6144
ds_read_b128 a[148:151], v210 offset:24576
v_mfma_f32_16x16x32_bf16 v[136:139], a[152:155], a[28:31], v[136:139]
v_mfma_f32_16x16x32_bf16 v[140:143], a[156:159], a[24:27], v[140:143]
v_mfma_f32_16x16x32_bf16 v[144:147], a[156:159], a[28:31], v[144:147]
s_waitcnt lgkmcnt(4)
v_mfma_f32_16x16x32_bf16 v[132:135], a[160:163], a[32:35], v[132:135]
ds_read_b128 a[152:155], v210 offset:7168
ds_read_b128 a[156:159], v210 offset:25600
v_mfma_f32_16x16x32_bf16 v[136:139], a[160:163], a[36:39], v[136:139]
v_mfma_f32_16x16x32_bf16 v[140:143], a[164:167], a[32:35], v[140:143]
v_mfma_f32_16x16x32_bf16 v[144:147], a[164:167], a[36:39], v[144:147]
s_waitcnt lgkmcnt(4)
v_mfma_f32_16x16x32_bf16 v[132:135], a[168:171], a[40:43], v[132:135]
ds_read_b128 a[160:163], v210 offset:8192
ds_read_b128 a[164:167], v210 offset:26624
v_mfma_f32_16x16x32_bf16 v[136:139], a[168:171], a[44:47], v[136:139]
v_mfma_f32_16x16x32_bf16 v[140:143], a[172:175], a[40:43], v[140:143]
v_mfma_f32_16x16x32_bf16 v[144:147], a[172:175], a[44:47], v[144:147]
s_waitcnt lgkmcnt(4)
v_mfma_f32_16x16x32_bf16 v[132:135], a[144:147], a[48:51], v[132:135]
ds_read_b128 a[168:171], v210 offset:9216
ds_read_b128 a[172:175], v210 offset:27648
v_mfma_f32_16x16x32_bf16 v[136:139], a[144:147], a[52:55], v[136:139]
v_mfma_f32_16x16x32_bf16 v[140:143], a[148:151], a[48:51], v[140:143]
v_mfma_f32_16x16x32_bf16 v[144:147], a[148:151], a[52:55], v[144:147]
s_waitcnt lgkmcnt(4)
v_mfma_f32_16x16x32_bf16 v[132:135], a[152:155], a[56:59], v[132:135]
ds_read_b128 a[144:147], v210 offset:10240
ds_read_b128 a[148:151], v210 offset:28672
v_mfma_f32_16x16x32_bf16 v[136:139], a[152:155], a[60:63], v[136:139]
v_mfma_f32_16x16x32_bf16 v[140:143], a[156:159], a[56:59], v[140:143]
v_mfma_f32_16x16x32_bf16 v[144:147], a[156:159], a[60:63], v[144:147]
s_waitcnt lgkmcnt(4)
v_mfma_f32_16x16x32_bf16 v[132:135], a[160:163], a[64:67], v[132:135]
ds_read_b128 a[152:155], v210 offset:11264
ds_read_b128 a[156:159], v210 offset:29696
v_mfma_f32_16x16x32_bf16 v[136:139], a[160:163], a[68:71], v[136:139]
v_mfma_f32_16x16x32_bf16 v[140:143], a[164:167], a[64:67], v[140:143]
v_mfma_f32_16x16x32_bf16 v[144:147], a[164:167], a[68:71], v[144:147]
s_waitcnt lgkmcnt(4)
v_mfma_f32_16x16x32_bf16 v[132:135], a[168:171], a[72:75], v[132:135]
ds_read_b128 a[160:163], v210 offset:12288
ds_read_b128 a[164:167], v210 offset:30720
v_mfma_f32_16x16x32_bf16 v[136:139], a[168:171], a[76:79], v[136:139]
v_mfma_f32_16x16x32_bf16 v[140:143], a[172:175], a[72:75], v[140:143]
s_waitcnt vmcnt(0)
v_min3_f32 v200, v183, v185, v187
v_mfma_f32_16x16x32_bf16 v[144:147], a[172:175], a[76:79], v[144:147]
s_waitcnt lgkmcnt(4)
v_min3_f32 v201, v189, v191, v193
v_min3_f32 v200, v200, v195, v197
v_mfma_f32_16x16x32_bf16 v[132:135], a[144:147], a[80:83], v[132:135]
ds_read_b128 a[168:171], v210 offset:13312
ds_read_b128 a[172:175], v210 offset:31744
v_mfma_f32_16x16x32_bf16 v[136:139], a[144:147], a[84:87], v[136:139]
v_min_f32 v200, v200, v201
v_cmp_gt_f32 vcc, 0, v200
v_mfma_f32_16x16x32_bf16 v[140:143], a[148:151], a[80:83], v[140:143]
s_nop 0
s_cbranch_vccnz L_stzslow_23
L_stzback_24:
v_mfma_f32_16x16x32_bf16 v[144:147], a[148:151], a[84:87], v[144:147]
s_waitcnt lgkmcnt(4)
v_add_f32 v198, v182, v184
v_add_f32 v199, v183, v185
v_mfma_f32_16x16x32_bf16 v[132:135], a[152:155], a[88:91], v[132:135]
ds_read_b128 a[144:147], v210 offset:14336
ds_read_b128 a[148:151], v210 offset:32768
v_mfma_f32_16x16x32_bf16 v[136:139], a[152:155], a[92:95], v[136:139]
v_add_f32 v198, v198, v186
v_add_f32 v199, v199, v187
v_mfma_f32_16x16x32_bf16 v[140:143], a[156:159], a[88:91], v[140:143]
v_add_f32 v198, v198, v188
v_add_f32 v199, v199, v189
v_mfma_f32_16x16x32_bf16 v[144:147], a[156:159], a[92:95], v[144:147]
s_waitcnt lgkmcnt(4)
v_add_f32 v198, v198, v190
v_add_f32 v199, v199, v191
v_mfma_f32_16x16x32_bf16 v[132:135], a[160:163], a[96:99], v[132:135]
ds_read_b128 a[152:155], v210 offset:15360
ds_read_b128 a[156:159], v210 offset:33792
v_add_f32 v198, v198, v192
v_mfma_f32_16x16x32_bf16 v[136:139], a[160:163], a[100:103], v[136:139]
v_add_f32 v199, v199, v193
v_add_f32 v198, v198, v194
v_mfma_f32_16x16x32_bf16 v[140:143], a[164:167], a[96:99], v[140:143]
v_add_f32 v199, v199, v195
v_add_f32 v198, v198, v196
v_mfma_f32_16x16x32_bf16 v[144:147], a[164:167], a[100:103], v[144:147]
s_waitcnt lgkmcnt(4)
v_add_f32 v199, v199, v197
v_mov_b32 v200, v198
v_mfma_f32_16x16x32_bf16 v[132:135], a[168:171], a[104:107], v[132:135]
ds_read_b128 a[160:163], v210 offset:16384
ds_read_b128 a[164:167], v210 offset:34816
v_mov_b32 v201, v199
v_mfma_f32_16x16x32_bf16 v[136:139], a[168:171], a[108:111], v[136:139]
s_nop 0
v_permlane32_swap_b32 v198, v200
v_mfma_f32_16x16x32_bf16 v[140:143], a[172:175], a[104:107], v[140:143]
v_permlane32_swap_b32 v199, v201
v_mfma_f32_16x16x32_bf16 v[144:147], a[172:175], a[108:111], v[144:147]
s_waitcnt lgkmcnt(4)
v_add_f32 v198, v198, v200
v_add_f32 v199, v199, v201
v_mfma_f32_16x16x32_bf16 v[132:135], a[144:147], a[112:115], v[132:135]
ds_read_b128 a[168:171], v210 offset:17408
ds_read_b128 a[172:175], v210 offset:35840
v_mfma_f32_16x16x32_bf16 v[136:139], a[144:147], a[116:119], v[136:139]
v_mul_f32 v198, 0x39e38e39, v198
v_mul_f32 v200, v198, v198
v_mfma_f32_16x16x32_bf16 v[140:143], a[148:151], a[112:115], v[140:143]
v_mul_f32 v199, 0x39e38e39, v199
v_sub_f32 v199, v199, v200
v_mfma_f32_16x16x32_bf16 v[144:147], a[148:151], a[116:119], v[144:147]
s_waitcnt lgkmcnt(4)
v_max_f32 v199, 0, v199
v_add_u32 v181, 74752, v239
v_mfma_f32_16x16x32_bf16 v[132:135], a[152:155], a[120:123], v[132:135]
ds_read_b64 a[144:145], v181 offset:0
ds_read_b64 a[148:149], v181 offset:512
v_add_f32 v199, 0x3727c5ac, v199
v_rsq_f32 v202, v199
v_mfma_f32_16x16x32_bf16 v[136:139], a[152:155], a[124:127], v[136:139]
s_nop 0
v_mul_f32 v204, v198, v202
v_mov_b32 v203, v202
v_mfma_f32_16x16x32_bf16 v[140:143], a[156:159], a[120:123], v[140:143]
v_mov_b32 v205, v204
v_mfma_f32_16x16x32_bf16 v[144:147], a[156:159], a[124:127], v[144:147]
s_waitcnt lgkmcnt(4)
s_nop 0
v_mfma_f32_16x16x32_bf16 v[132:135], a[160:163], a[128:131], v[132:135]
ds_read_b128 a[152:155], v211 offset:0
ds_read_b128 a[156:159], v211 offset:18432
v_permlane16_swap_b32 v202, v203
v_mfma_f32_16x16x32_bf16 v[136:139], a[160:163], a[132:135], v[136:139]
v_permlane16_swap_b32 v204, v205
v_mfma_f32_16x16x32_bf16 v[140:143], a[164:167], a[128:131], v[140:143]
v_fma_f32 v36, v36, v202, -v204
v_fma_f32 v37, v37, v202, -v204
v_mfma_f32_16x16x32_bf16 v[144:147], a[164:167], a[132:135], v[144:147]
s_waitcnt lgkmcnt(4)
v_fma_f32 v38, v38, v202, -v204
v_fma_f32 v39, v39, v202, -v204
v_mfma_f32_16x16x32_bf16 v[132:135], a[168:171], a[136:139], v[132:135]
ds_read_b128 a[160:163], v211 offset:1024
ds_read_b128 a[164:167], v211 offset:19456
v_mfma_f32_16x16x32_bf16 v[136:139], a[168:171], a[140:143], v[136:139]
v_fma_f32 v44, v44, v202, -v204
v_fma_f32 v45, v45, v202, -v204
v_mfma_f32_16x16x32_bf16 v[140:143], a[172:175], a[136:139], v[140:143]
v_fma_f32 v46, v46, v202, -v204
v_fma_f32 v47, v47, v202, -v204
v_mfma_f32_16x16x32_bf16 v[144:147], a[172:175], a[140:143], v[144:147]
s_waitcnt lgkmcnt(4)
v_cvt_pk_bf16_f32 v216, v36, v37
v_cvt_pk_bf16_f32 v217, v38, v39
v_mfma_f32_16x16x16_bf16 v[132:135], a[144:145], v[212:213], v[132:135]
ds_read_b128 a[168:171], v211 offset:2048
ds_read_b128 a[172:175], v211 offset:20480
v_cvt_pk_bf16_f32 v218, v44, v45
v_mfma_f32_16x16x16_bf16 v[136:139], a[144:145], v[214:215], v[136:139]
v_cvt_pk_bf16_f32 v219, v46, v47
v_mfma_f32_16x16x16_bf16 v[140:143], a[148:149], v[212:213], v[140:143]
ds_write_b128 v236, v[216:219] offset:0
v_fma_f32 v40, v40, v203, -v205
v_mfma_f32_16x16x16_bf16 v[144:147], a[148:149], v[214:215], v[144:147]
s_waitcnt lgkmcnt(5)
v_fma_f32 v41, v41, v203, -v205
v_fma_f32 v42, v42, v203, -v205
s_barrier
v_mfma_f32_16x16x32_bf16 v[148:151], a[152:155], a[0:3], 0
ds_read_b128 a[144:147], v211 offset:3072
ds_read_b128 a[148:151], v211 offset:21504
v_fma_f32 v43, v43, v203, -v205
v_fma_f32 v48, v48, v203, -v205
v_mfma_f32_16x16x32_bf16 v[152:155], a[152:155], a[4:7], 0
v_fma_f32 v49, v49, v203, -v205
v_fma_f32 v50, v50, v203, -v205
v_mfma_f32_16x16x32_bf16 v[156:159], a[156:159], a[0:3], 0
v_fma_f32 v51, v51, v203, -v205
v_cvt_pk_bf16_f32 v220, v40, v41
v_mfma_f32_16x16x32_bf16 v[160:163], a[156:159], a[4:7], 0
s_waitcnt lgkmcnt(5)
v_cvt_pk_bf16_f32 v221, v42, v43
v_cvt_pk_bf16_f32 v222, v48, v49
v_mfma_f32_16x16x32_bf16 v[148:151], a[160:163], a[8:11], v[148:151]
ds_read_b128 a[152:155], v211 offset:4096
ds_read_b128 a[156:159], v211 offset:22528
v_cvt_pk_bf16_f32 v223, v50, v51
v_mfma_f32_16x16x32_bf16 v[152:155], a[160:163], a[12:15], v[152:155]
ds_write_b128 v236, v[220:223] offset:4608
v_mfma_f32_16x16x32_bf16 v[156:159], a[164:167], a[8:11], v[156:159]
ds_read_b64_tr_b16 v[36:37], v237 offset:0
ds_read_b64_tr_b16 v[38:39], v237 offset:1152
ds_read_b64_tr_b16 v[40:41], v237 offset:8
ds_read_b64_tr_b16 v[42:43], v237 offset:1160
v_mfma_f32_16x16x32_bf16 v[160:163], a[164:167], a[12:15], v[160:163]
s_waitcnt lgkmcnt(10)
v_fma_f32 v52, v52, v202, -v204
v_fma_f32 v53, v53, v202, -v204
v_mfma_f32_16x16x32_bf16 v[148:151], a[168:171], a[16:19], v[148:151]
ds_read_b128 a[160:163], v211 offset:5120
ds_read_b128 a[164:167], v211 offset:23552
v_mfma_f32_16x16x32_bf16 v[152:155], a[168:171], a[20:23], v[152:155]
v_fma_f32 v54, v54, v202, -v204
v_fma_f32 v55, v55, v202, -v204
v_mfma_f32_16x16x32_bf16 v[156:159], a[172:175], a[16:19], v[156:159]
v_fma_f32 v60, v60, v202, -v204
v_mfma_f32_16x16x32_bf16 v[160:163], a[172:175], a[20:23], v[160:163]
s_waitcnt lgkmcnt(9)
v_fma_f32 v61, v61, v202, -v204
v_mfma_f32_16x16x32_bf16 v[148:151], a[144:147], a[24:27], v[148:151]
ds_read_b128 a[168:171], v211 offset:6144
ds_read_b128 a[172:175], v211 offset:24576
v_mfma_f32_16x16x32_bf16 v[152:155], a[144:147], a[28:31], v[152:155]
v_fma_f32 v62, v62, v202, -v204
v_fma_f32 v63, v63, v202, -v204
v_mfma_f32_16x16x32_bf16 v[156:159], a[148:151], a[24:27], v[156:159]
v_cvt_pk_bf16_f32 v224, v52, v53
v_cvt_pk_bf16_f32 v225, v54, v55
v_mfma_f32_16x16x32_bf16 v[160:163], a[148:151], a[28:31], v[160:163]
s_waitcnt lgkmcnt(9)
v_cvt_pk_bf16_f32 v226, v60, v61
v_mfma_f32_16x16x32_bf16 v[148:151], a[152:155], a[32:35], v[148:151]
ds_read_b128 a[144:147], v211 offset:7168
ds_read_b128 a[148:151], v211 offset:25600
v_mfma_f32_16x16x32_bf16 v[152:155], a[152:155], a[36:39], v[152:155]
v_cvt_pk_bf16_f32 v227, v62, v63
v_mfma_f32_16x16x32_bf16 v[156:159], a[156:159], a[32:35], v[156:159]
ds_write_b128 v236, v[224:227] offset:64
v_mfma_f32_16x16x32_bf16 v[160:163], a[156:159], a[36:39], v[160:163]
s_waitcnt lgkmcnt(5)
buffer_store_dwordx4 v[36:39], v1, s[8:11], s66 offen offset:0 sc1
v_mfma_f32_16x16x32_bf16 v[148:151], a[160:163], a[40:43], v[148:151]
ds_read_b128 a[152:155], v211 offset:8192
ds_read_b128 a[156:159], v211 offset:26624
v_mfma_f32_16x16x32_bf16 v[152:155], a[160:163], a[44:47], v[152:155]
v_fma_f32 v56, v56, v203, -v205
v_fma_f32 v57, v57, v203, -v205
v_mfma_f32_16x16x32_bf16 v[156:159], a[164:167], a[40:43], v[156:159]
v_fma_f32 v58, v58, v203, -v205
v_fma_f32 v59, v59, v203, -v205
v_mfma_f32_16x16x32_bf16 v[160:163], a[164:167], a[44:47], v[160:163]
s_waitcnt lgkmcnt(5)
v_fma_f32 v64, v64, v203, -v205
v_fma_f32 v65, v65, v203, -v205
v_mfma_f32_16x16x32_bf16 v[148:151], a[168:171], a[48:51], v[148:151]
ds_read_b128 a[160:163], v211 offset:9216
ds_read_b128 a[164:167], v211 offset:27648
v_mfma_f32_16x16x32_bf16 v[152:155], a[168:171], a[52:55], v[152:155]
v_fma_f32 v66, v66, v203, -v205
v_fma_f32 v67, v67, v203, -v205
v_mfma_f32_16x16x32_bf16 v[156:159], a[172:175], a[48:51], v[156:159]
v_cvt_pk_bf16_f32 v228, v56, v57
v_cvt_pk_bf16_f32 v229, v58, v59
v_mfma_f32_16x16x32_bf16 v[160:163], a[172:175], a[52:55], v[160:163]
s_waitcnt lgkmcnt(5)
v_cvt_pk_bf16_f32 v230, v64, v65
v_cvt_pk_bf16_f32 v231, v66, v67
v_mfma_f32_16x16x32_bf16 v[148:151], a[144:147], a[56:59], v[148:151]
ds_read_b128 a[168:171], v211 offset:10240
ds_read_b128 a[172:175], v211 offset:28672
v_mfma_f32_16x16x32_bf16 v[152:155], a[144:147], a[60:63], v[152:155]
ds_write_b128 v236, v[228:231] offset:4672
v_mfma_f32_16x16x32_bf16 v[156:159], a[148:151], a[56:59], v[156:159]
ds_read_b64_tr_b16 v[52:53], v237 offset:64
ds_read_b64_tr_b16 v[54:55], v237 offset:1216
v_mfma_f32_16x16x32_bf16 v[160:163], a[148:151], a[60:63], v[160:163]
s_waitcnt lgkmcnt(7)
v_mfma_f32_16x16x32_bf16 v[148:151], a[152:155], a[64:67], v[148:151]
ds_read_b128 a[144:147], v211 offset:11264
ds_read_b128 a[148:151], v211 offset:29696
ds_read_b64_tr_b16 v[56:57], v237 offset:72
ds_read_b64_tr_b16 v[58:59], v237 offset:1224
buffer_store_dwordx4 v[40:43], v1, s[8:11], s66 offen offset:1024 sc1
v_mfma_f32_16x16x32_bf16 v[152:155], a[152:155], a[68:71], v[152:155]
v_fma_f32 v68, v68, v202, -v204
v_fma_f32 v69, v69, v202, -v204
v_mfma_f32_16x16x32_bf16 v[156:159], a[156:159], a[64:67], v[156:159]
v_fma_f32 v70, v70, v202, -v204
v_mfma_f32_16x16x32_bf16 v[160:163], a[156:159], a[68:71], v[160:163]
s_waitcnt lgkmcnt(9)
v_fma_f32 v71, v71, v202, -v204
v_mfma_f32_16x16x32_bf16 v[148:151], a[160:163], a[72:75], v[148:151]
ds_read_b128 a[152:155], v211 offset:12288
ds_read_b128 a[156:159], v211 offset:30720
v_mfma_f32_16x16x32_bf16 v[152:155], a[160:163], a[76:79], v[152:155]
v_fma_f32 v76, v76, v202, -v204
v_fma_f32 v77, v77, v202, -v204
v_mfma_f32_16x16x32_bf16 v[156:159], a[164:167], a[72:75], v[156:159]
v_fma_f32 v78, v78, v202, -v204
v_mfma_f32_16x16x32_bf16 v[160:163], a[164:167], a[76:79], v[160:163]
s_waitcnt lgkmcnt(9)
v_fma_f32 v79, v79, v202, -v204
v_cvt_pk_bf16_f32 v216, v68, v69
v_mfma_f32_16x16x32_bf16 v[148:151], a[168:171], a[80:83], v[148:151]
ds_read_b128 a[160:163], v211 offset:13312
ds_read_b128 a[164:167], v211 offset:31744
v_mfma_f32_16x16x32_bf16 v[152:155], a[168:171], a[84:87], v[152:155]
v_cvt_pk_bf16_f32 v217, v70, v71
v_cvt_pk_bf16_f32 v218, v76, v77
v_mfma_f32_16x16x32_bf16 v[156:159], a[172:175], a[80:83], v[156:159]
v_cvt_pk_bf16_f32 v219, v78, v79
v_mfma_f32_16x16x32_bf16 v[160:163], a[172:175], a[84:87], v[160:163]
s_waitcnt lgkmcnt(6)
v_mfma_f32_16x16x32_bf16 v[148:151], a[144:147], a[88:91], v[148:151]
ds_read_b128 a[168:171], v211 offset:14336
ds_read_b128 a[172:175], v211 offset:32768
v_mfma_f32_16x16x32_bf16 v[152:155], a[144:147], a[92:95], v[152:155]
ds_write_b128 v236, v[216:219] offset:128
buffer_store_dwordx4 v[52:55], v1, s[8:11], s66 offen offset:2048 sc1
v_mfma_f32_16x16x32_bf16 v[156:159], a[148:151], a[88:91], v[156:159]
v_fma_f32 v72, v72, v203, -v205
v_fma_f32 v73, v73, v203, -v205
v_mfma_f32_16x16x32_bf16 v[160:163], a[148:151], a[92:95], v[160:163]
s_waitcnt lgkmcnt(5)
v_fma_f32 v74, v74, v203, -v205
v_mfma_f32_16x16x32_bf16 v[148:151], a[152:155], a[96:99], v[148:151]
ds_read_b128 a[144:147], v211 offset:15360
ds_read_b128 a[148:151], v211 offset:33792
v_mfma_f32_16x16x32_bf16 v[152:155], a[152:155], a[100:103], v[152:155]
v_fma_f32 v75, v75, v203, -v205
v_fma_f32 v80, v80, v203, -v205
v_mfma_f32_16x16x32_bf16 v[156:159], a[156:159], a[96:99], v[156:159]
v_fma_f32 v81, v81, v203, -v205
v_fma_f32 v82, v82, v203, -v205
v_mfma_f32_16x16x32_bf16 v[160:163], a[156:159], a[100:103], v[160:163]
s_waitcnt lgkmcnt(5)
v_fma_f32 v83, v83, v203, -v205
v_cvt_pk_bf16_f32 v220, v72, v73
v_mfma_f32_16x16x32_bf16 v[148:151], a[160:163], a[104:107], v[148:151]
ds_read_b128 a[152:155], v211 offset:16384
ds_read_b128 a[156:159], v211 offset:34816
v_mfma_f32_16x16x32_bf16 v[152:155], a[160:163], a[108:111], v[152:155]
v_cvt_pk_bf16_f32 v221, v74, v75
v_cvt_pk_bf16_f32 v222, v80, v81
v_mfma_f32_16x16x32_bf16 v[156:159], a[164:167], a[104:107], v[156:159]
v_cvt_pk_bf16_f32 v223, v82, v83
v_mfma_f32_16x16x32_bf16 v[160:163], a[164:167], a[108:111], v[160:163]
s_waitcnt lgkmcnt(5)
v_mfma_f32_16x16x32_bf16 v[148:151], a[168:171], a[112:115], v[148:151]
ds_read_b128 a[160:163], v211 offset:17408
ds_read_b128 a[164:167], v211 offset:35840
v_mfma_f32_16x16x32_bf16 v[152:155], a[168:171], a[116:119], v[152:155]
ds_write_b128 v236, v[220:223] offset:4736
v_mfma_f32_16x16x32_bf16 v[156:159], a[172:175], a[112:115], v[156:159]
ds_read_b64_tr_b16 v[68:69], v237 offset:128
ds_read_b64_tr_b16 v[70:71], v237 offset:1280
ds_read_b64_tr_b16 v[72:73], v237 offset:136
ds_read_b64_tr_b16 v[74:75], v237 offset:1288
buffer_store_dwordx4 v[56:59], v1, s[8:11], s66 offen offset:3072 sc1
v_mfma_f32_16x16x32_bf16 v[160:163], a[172:175], a[116:119], v[160:163]
s_waitcnt lgkmcnt(9)
v_fma_f32 v84, v84, v202, -v204
v_add_u32 v181, 112640, v239
v_mfma_f32_16x16x32_bf16 v[148:151], a[144:147], a[120:123], v[148:151]
ds_read_b64 a[168:169], v181 offset:0
ds_read_b64 a[172:173], v181 offset:512
v_mfma_f32_16x16x32_bf16 v[152:155], a[144:147], a[124:127], v[152:155]
v_fma_f32 v85, v85, v202, -v204
v_fma_f32 v86, v86, v202, -v204
v_mfma_f32_16x16x32_bf16 v[156:159], a[148:151], a[120:123], v[156:159]
v_fma_f32 v87, v87, v202, -v204
v_fma_f32 v92, v92, v202, -v204
v_mfma_f32_16x16x32_bf16 v[160:163], a[148:151], a[124:127], v[160:163]
s_waitcnt lgkmcnt(9)
v_fma_f32 v93, v93, v202, -v204
v_fma_f32 v94, v94, v202, -v204
v_mfma_f32_16x16x32_bf16 v[148:151], a[152:155], a[128:131], v[148:151]
ds_read_b128 a[144:147], v208 offset:0
ds_read_b128 a[148:151], v208 offset:18432
v_mfma_f32_16x16x32_bf16 v[152:155], a[152:155], a[132:135], v[152:155]
v_fma_f32 v95, v95, v202, -v204
v_cvt_pk_bf16_f32 v224, v84, v85
v_mfma_f32_16x16x32_bf16 v[156:159], a[156:159], a[128:131], v[156:159]
v_cvt_pk_bf16_f32 v225, v86, v87
v_mfma_f32_16x16x32_bf16 v[160:163], a[156:159], a[132:135], v[160:163]
s_waitcnt lgkmcnt(9)
v_cvt_pk_bf16_f32 v226, v92, v93
v_cvt_pk_bf16_f32 v227, v94, v95
v_mfma_f32_16x16x32_bf16 v[148:151], a[160:163], a[136:139], v[148:151]
ds_read_b128 a[152:155], v208 offset:1024
ds_read_b128 a[156:159], v208 offset:19456
v_mfma_f32_16x16x32_bf16 v[152:155], a[160:163], a[140:143], v[152:155]
ds_write_b128 v236, v[224:227] offset:192
v_mfma_f32_16x16x32_bf16 v[156:159], a[164:167], a[136:139], v[156:159]
s_add_u32 s66, s66, 4096
s_waitcnt lgkmcnt(9)
v_mfma_f32_16x16x32_bf16 v[160:163], a[164:167], a[140:143], v[160:163]
s_waitcnt lgkmcnt(5)
buffer_store_dwordx4 v[68:71], v1, s[8:11], s66 offen offset:0 sc1
v_mfma_f32_16x16x16_bf16 v[148:151], a[168:169], v[212:213], v[148:151]
ds_read_b128 a[160:163], v208 offset:2048
ds_read_b128 a[164:167], v208 offset:20480
v_mfma_f32_16x16x16_bf16 v[152:155], a[168:169], v[214:215], v[152:155]
v_fma_f32 v88, v88, v203, -v205
v_fma_f32 v89, v89, v203, -v205
v_mfma_f32_16x16x16_bf16 v[156:159], a[172:173], v[212:213], v[156:159]
v_fma_f32 v90, v90, v203, -v205
v_fma_f32 v91, v91, v203, -v205
v_mfma_f32_16x16x16_bf16 v[160:163], a[172:173], v[214:215], v[160:163]
s_waitcnt lgkmcnt(5)
v_fma_f32 v96, v96, v203, -v205
v_fma_f32 v97, v97, v203, -v205
v_mfma_f32_16x16x32_bf16 v[164:167], a[144:147], a[0:3], 0
ds_read_b128 a[168:171], v208 offset:3072
ds_read_b128 a[172:175], v208 offset:21504
v_mfma_f32_16x16x32_bf16 v[168:171], a[144:147], a[4:7], 0
v_fma_f32 v98, v98, v203, -v205
v_fma_f32 v99, v99, v203, -v205
v_mfma_f32_16x16x32_bf16 v[172:175], a[148:151], a[0:3], 0
v_cvt_pk_bf16_f32 v228, v88, v89
v_cvt_pk_bf16_f32 v229, v90, v91
v_mfma_f32_16x16x32_bf16 v[176:179], a[148:151], a[4:7], 0
s_waitcnt lgkmcnt(5)
v_cvt_pk_bf16_f32 v230, v96, v97
v_cvt_pk_bf16_f32 v231, v98, v99
v_mfma_f32_16x16x32_bf16 v[164:167], a[152:155], a[8:11], v[164:167]
ds_read_b128 a[144:147], v208 offset:4096
ds_read_b128 a[148:151], v208 offset:22528
v_mfma_f32_16x16x32_bf16 v[168:171], a[152:155], a[12:15], v[168:171]
ds_write_b128 v236, v[228:231] offset:4800
v_mfma_f32_16x16x32_bf16 v[172:175], a[156:159], a[8:11], v[172:175]
ds_read_b64_tr_b16 v[84:85], v237 offset:192
ds_read_b64_tr_b16 v[86:87], v237 offset:1344
v_mfma_f32_16x16x32_bf16 v[176:179], a[156:159], a[12:15], v[176:179]
s_waitcnt lgkmcnt(7)
v_mfma_f32_16x16x32_bf16 v[164:167], a[160:163], a[16:19], v[164:167]
ds_read_b128 a[152:155], v208 offset:5120
ds_read_b128 a[156:159], v208 offset:23552
ds_read_b64_tr_b16 v[88:89], v237 offset:200
ds_read_b64_tr_b16 v[90:91], v237 offset:1352
buffer_store_dwordx4 v[72:75], v1, s[8:11], s66 offen offset:1024 sc1
v_mfma_f32_16x16x32_bf16 v[168:171], a[160:163], a[20:23], v[168:171]
v_fma_f32 v100, v100, v202, -v204
v_fma_f32 v101, v101, v202, -v204
v_mfma_f32_16x16x32_bf16 v[172:175], a[164:167], a[16:19], v[172:175]
v_fma_f32 v102, v102, v202, -v204
v_mfma_f32_16x16x32_bf16 v[176:179], a[164:167], a[20:23], v[176:179]
s_waitcnt lgkmcnt(9)
v_fma_f32 v103, v103, v202, -v204
v_fma_f32 v104, v104, v203, -v205
v_mfma_f32_16x16x32_bf16 v[164:167], a[168:171], a[24:27], v[164:167]
ds_read_b128 a[160:163], v208 offset:6144
ds_read_b128 a[164:167], v208 offset:24576
v_mfma_f32_16x16x32_bf16 v[168:171], a[168:171], a[28:31], v[168:171]
v_fma_f32 v105, v105, v203, -v205
v_fma_f32 v106, v106, v203, -v205
v_mfma_f32_16x16x32_bf16 v[172:175], a[172:175], a[24:27], v[172:175]
v_fma_f32 v107, v107, v203, -v205
v_cvt_pk_bf16_f32 v216, v100, v101
v_mfma_f32_16x16x32_bf16 v[176:179], a[172:175], a[28:31], v[176:179]
s_waitcnt lgkmcnt(9)
v_cvt_pk_bf16_f32 v217, v102, v103
v_mfma_f32_16x16x32_bf16 v[164:167], a[144:147], a[32:35], v[164:167]
ds_read_b128 a[168:171], v208 offset:7168
ds_read_b128 a[172:175], v208 offset:25600
v_mfma_f32_16x16x32_bf16 v[168:171], a[144:147], a[36:39], v[168:171]
v_cvt_pk_bf16_f32 v218, v104, v105
v_cvt_pk_bf16_f32 v219, v106, v107
v_mfma_f32_16x16x32_bf16 v[172:175], a[148:151], a[32:35], v[172:175]
ds_write_b64 v7, v[216:217] offset:256
v_mfma_f32_16x16x32_bf16 v[176:179], a[148:151], a[36:39], v[176:179]
s_waitcnt lgkmcnt(7)
v_mfma_f32_16x16x32_bf16 v[164:167], a[152:155], a[40:43], v[164:167]
ds_read_b128 a[144:147], v208 offset:8192
ds_read_b128 a[148:151], v208 offset:26624
v_mfma_f32_16x16x32_bf16 v[168:171], a[152:155], a[44:47], v[168:171]
ds_write_b64 v7, v[218:219] offset:4864
ds_read_b64_tr_b16 v[100:101], v238 offset:256
ds_read_b64_tr_b16 v[102:103], v238 offset:1408
buffer_store_dwordx4 v[84:87], v1, s[8:11], s66 offen offset:2048 sc1
v_mfma_f32_16x16x32_bf16 v[172:175], a[156:159], a[40:43], v[172:175]
v_mfma_f32_16x16x32_bf16 v[176:179], a[156:159], a[44:47], v[176:179]
s_waitcnt lgkmcnt(8)
v_mfma_f32_16x16x32_bf16 v[164:167], a[160:163], a[48:51], v[164:167]
ds_read_b128 a[152:155], v208 offset:9216
ds_read_b128 a[156:159], v208 offset:27648
v_mfma_f32_16x16x32_bf16 v[168:171], a[160:163], a[52:55], v[168:171]
v_mfma_f32_16x16x32_bf16 v[172:175], a[164:167], a[48:51], v[172:175]
v_mfma_f32_16x16x32_bf16 v[176:179], a[164:167], a[52:55], v[176:179]
s_waitcnt lgkmcnt(8)
v_mfma_f32_16x16x32_bf16 v[164:167], a[168:171], a[56:59], v[164:167]
ds_read_b128 a[160:163], v208 offset:10240
ds_read_b128 a[164:167], v208 offset:28672
v_mfma_f32_16x16x32_bf16 v[168:171], a[168:171], a[60:63], v[168:171]
v_mfma_f32_16x16x32_bf16 v[172:175], a[172:175], a[56:59], v[172:175]
v_mfma_f32_16x16x32_bf16 v[176:179], a[172:175], a[60:63], v[176:179]
s_waitcnt lgkmcnt(7)
v_mfma_f32_16x16x32_bf16 v[164:167], a[144:147], a[64:67], v[164:167]
ds_read_b128 a[168:171], v208 offset:11264
ds_read_b128 a[172:175], v208 offset:29696
v_mfma_f32_16x16x32_bf16 v[168:171], a[144:147], a[68:71], v[168:171]
v_mfma_f32_16x16x32_bf16 v[172:175], a[148:151], a[64:67], v[172:175]
buffer_store_dwordx4 v[88:91], v1, s[8:11], s66 offen offset:3072 sc1
v_mfma_f32_16x16x32_bf16 v[176:179], a[148:151], a[68:71], v[176:179]
s_waitcnt lgkmcnt(4)
v_mfma_f32_16x16x32_bf16 v[164:167], a[152:155], a[72:75], v[164:167]
ds_read_b128 a[144:147], v208 offset:12288
ds_read_b128 a[148:151], v208 offset:30720
v_mfma_f32_16x16x32_bf16 v[168:171], a[152:155], a[76:79], v[168:171]
v_mfma_f32_16x16x32_bf16 v[172:175], a[156:159], a[72:75], v[172:175]
v_mfma_f32_16x16x32_bf16 v[176:179], a[156:159], a[76:79], v[176:179]
s_waitcnt lgkmcnt(4)
v_mfma_f32_16x16x32_bf16 v[164:167], a[160:163], a[80:83], v[164:167]
ds_read_b128 a[152:155], v208 offset:13312
ds_read_b128 a[156:159], v208 offset:31744
v_mfma_f32_16x16x32_bf16 v[168:171], a[160:163], a[84:87], v[168:171]
v_mfma_f32_16x16x32_bf16 v[172:175], a[164:167], a[80:83], v[172:175]
v_mfma_f32_16x16x32_bf16 v[176:179], a[164:167], a[84:87], v[176:179]
s_waitcnt lgkmcnt(4)
v_mfma_f32_16x16x32_bf16 v[164:167], a[168:171], a[88:91], v[164:167]
ds_read_b128 a[160:163], v208 offset:14336
ds_read_b128 a[164:167], v208 offset:32768
v_mfma_f32_16x16x32_bf16 v[168:171], a[168:171], a[92:95], v[168:171]
v_mfma_f32_16x16x32_bf16 v[172:175], a[172:175], a[88:91], v[172:175]
s_add_u32 s66, s66, 4096
v_mfma_f32_16x16x32_bf16 v[176:179], a[172:175], a[92:95], v[176:179]
s_waitcnt lgkmcnt(4)
buffer_store_dwordx4 v[100:103], v1, s[8:11], s66 offen offset:0 sc1
v_mfma_f32_16x16x32_bf16 v[164:167], a[144:147], a[96:99], v[164:167]
ds_read_b128 a[168:171], v208 offset:15360
ds_read_b128 a[172:175], v208 offset:33792
v_mfma_f32_16x16x32_bf16 v[168:171], a[144:147], a[100:103], v[168:171]
v_mfma_f32_16x16x32_bf16 v[172:175], a[148:151], a[96:99], v[172:175]
v_mfma_f32_16x16x32_bf16 v[176:179], a[148:151], a[100:103], v[176:179]
s_waitcnt lgkmcnt(4)
v_mfma_f32_16x16x32_bf16 v[164:167], a[152:155], a[104:107], v[164:167]
ds_read_b128 a[144:147], v208 offset:16384
ds_read_b128 a[148:151], v208 offset:34816
v_mfma_f32_16x16x32_bf16 v[168:171], a[152:155], a[108:111], v[168:171]
v_mfma_f32_16x16x32_bf16 v[172:175], a[156:159], a[104:107], v[172:175]
v_mfma_f32_16x16x32_bf16 v[176:179], a[156:159], a[108:111], v[176:179]
s_waitcnt lgkmcnt(4)
v_mfma_f32_16x16x32_bf16 v[164:167], a[160:163], a[112:115], v[164:167]
ds_read_b128 a[152:155], v208 offset:17408
ds_read_b128 a[156:159], v208 offset:35840
v_mfma_f32_16x16x32_bf16 v[168:171], a[160:163], a[116:119], v[168:171]
v_mfma_f32_16x16x32_bf16 v[172:175], a[164:167], a[112:115], v[172:175]
v_mfma_f32_16x16x32_bf16 v[176:179], a[164:167], a[116:119], v[176:179]
s_waitcnt lgkmcnt(4)
v_add_u32 v181, 160768, v239
v_mfma_f32_16x16x32_bf16 v[164:167], a[168:171], a[120:123], v[164:167]
ds_read_b64 a[160:161], v181 offset:0
ds_read_b64 a[164:165], v181 offset:512
v_mfma_f32_16x16x32_bf16 v[168:171], a[168:171], a[124:127], v[168:171]
v_mfma_f32_16x16x32_bf16 v[172:175], a[172:175], a[120:123], v[172:175]
v_mfma_f32_16x16x32_bf16 v[176:179], a[172:175], a[124:127], v[176:179]
s_waitcnt lgkmcnt(4)
v_mfma_f32_16x16x32_bf16 v[164:167], a[144:147], a[128:131], v[164:167]
v_mfma_f32_16x16x32_bf16 v[168:171], a[144:147], a[132:135], v[168:171]
v_mfma_f32_16x16x32_bf16 v[172:175], a[148:151], a[128:131], v[172:175]
v_mfma_f32_16x16x32_bf16 v[176:179], a[148:151], a[132:135], v[176:179]
s_waitcnt lgkmcnt(2)
v_mfma_f32_16x16x32_bf16 v[164:167], a[152:155], a[136:139], v[164:167]
v_mfma_f32_16x16x32_bf16 v[168:171], a[152:155], a[140:143], v[168:171]
v_mfma_f32_16x16x32_bf16 v[172:175], a[156:159], a[136:139], v[172:175]
v_mfma_f32_16x16x32_bf16 v[176:179], a[156:159], a[140:143], v[176:179]
s_waitcnt lgkmcnt(0)
v_mfma_f32_16x16x16_bf16 v[164:167], a[160:161], v[212:213], v[164:167]
v_mfma_f32_16x16x16_bf16 v[168:171], a[160:161], v[214:215], v[168:171]
v_mfma_f32_16x16x16_bf16 v[172:175], a[164:165], v[212:213], v[172:175]
v_mfma_f32_16x16x16_bf16 v[176:179], a[164:165], v[214:215], v[176:179]
L_c4:
v_add_u32 v180, 0, v1
v_lshlrev_b32 v184, 16, v0
v_lshlrev_b32 v185, 16, v0
v_lshlrev_b32 v186, 16, v0
v_lshlrev_b32 v187, 16, v0
v_lshlrev_b32 v188, 16, v249
v_lshlrev_b32 v189, 16, v249
v_lshlrev_b32 v190, 16, v249
v_lshlrev_b32 v191, 16, v249
s_waitcnt lgkmcnt(0)
ds_write_b128 v240, v[36:39] offset:0
ds_write_b128 v240, v[40:43] offset:1024
ds_write_b128 v240, v[52:55] offset:2048
ds_write_b128 v240, v[56:59] offset:3072
s_cmp_eq_u32 s24, 0
s_cselect_b32 s67, 0, 1073741824
s_add_u32 s67, s67, 26542080
s_waitcnt vmcnt(0)
s_barrier
s_mov_b64 exec, 0xffff
buffer_atomic_add v4, v233, s[8:11], s67 offen sc1
s_mov_b64 exec, -1
v_add_u32 v200, 53248, v1
v_add_u32 v201, 90112, v1
v_add_u32 v202, 126976, v1
s_lshl_b32 s35, s80, 7
s_add_u32 s35, s35, 26542080
s_cmp_eq_u32 s24, 1
s_cselect_b32 s35, s35, 1073741824
v_mov_b32 v6, 0
v_mov_b32 v244, 0
v_mov_b32 v245, 0
v_mov_b32 v246, 0
buffer_load_dwordx4 a[80:83], v1, s[4:7], s52 offen offset:2048 sc1
buffer_load_dwordx4 a[84:87], v9, s[4:7], s52 offen offset:2048 sc1
ds_write_b128 v240, v[68:71] offset:4096
ds_write_b128 v240, v[72:75] offset:5120
ds_write_b128 v240, v[84:87] offset:6144
ds_write_b128 v240, v[88:91] offset:7168
ds_write_b128 v240, v[100:103] offset:8192
v_pk_mul_f32 v[192:193], v[108:109], v[108:109]
v_pk_mul_f32 v[194:195], v[110:111], v[110:111]
v_pk_mul_f32 v[196:197], v[112:113], v[112:113]
v_pk_mul_f32 v[198:199], v[114:115], v[114:115]
v_pk_fma_f32 v[192:193], v[192:193], v[252:253], v[250:251] op_sel:[0,0,0] op_sel_hi:[1,0,0]
v_pk_fma_f32 v[194:195], v[194:195], v[252:253], v[250:251] op_sel:[0,0,0] op_sel_hi:[1,0,0]
v_pk_fma_f32 v[196:197], v[196:197], v[252:253], v[250:251] op_sel:[0,1,1] op_sel_hi:[1,1,1]
v_pk_fma_f32 v[198:199], v[198:199], v[252:253], v[250:251] op_sel:[0,1,1] op_sel_hi:[1,1,1]
v_pk_mul_f32 v[192:193], v[192:193], v[108:109]
buffer_load_dwordx4 a[88:91], v1, s[4:7], s52 offen offset:3072 sc1
buffer_load_dwordx4 a[92:95], v9, s[4:7], s52 offen offset:3072 sc1
v_pk_mul_f32 v[194:195], v[194:195], v[110:111]
v_pk_mul_f32 v[196:197], v[196:197], v[112:113]
v_pk_mul_f32 v[198:199], v[198:199], v[114:115]
v_exp_f32 v192, v192
v_exp_f32 v193, v193
v_exp_f32 v194, v194
v_exp_f32 v195, v195
v_exp_f32 v196, v196
v_exp_f32 v197, v197
v_exp_f32 v198, v198
v_exp_f32 v199, v199
v_pk_fma_f32 v[192:193], v[192:193], v[254:255], v[254:255] op_sel:[0,0,0] op_sel_hi:[1,0,0]
v_pk_fma_f32 v[194:195], v[194:195], v[254:255], v[254:255] op_sel:[0,0,0] op_sel_hi:[1,0,0]
v_pk_fma_f32 v[196:197], v[196:197], v[254:255], v[254:255] op_sel:[0,1,1] op_sel_hi:[1,1,1]
s_cmp_eq_u32 s25, 2
s_cselect_b32 s98, 4096, 0
s_add_u32 s52, s52, s98
s_add_u32 s52, s52, 4096
buffer_load_dwordx4 a[96:99], v1, s[4:7], s52 offen offset:0 sc1
s_mov_b64 exec, 1
buffer_atomic_add v244, v6, s[8:11], s35 offen sc0 sc1
s_mov_b64 exec, -1
buffer_load_dwordx4 a[100:103], v9, s[4:7], s52 offen offset:0 sc1
v_pk_fma_f32 v[198:199], v[198:199], v[254:255], v[254:255] op_sel:[0,1,1] op_sel_hi:[1,1,1]
v_rcp_f32 v192, v192
v_rcp_f32 v193, v193
v_rcp_f32 v194, v194
v_rcp_f32 v195, v195
v_rcp_f32 v196, v196
v_rcp_f32 v197, v197
v_rcp_f32 v198, v198
v_rcp_f32 v199, v199
v_pk_mul_f32 v[108:109], v[108:109], v[192:193]
v_pk_mul_f32 v[110:111], v[110:111], v[194:195]
v_pk_mul_f32 v[112:113], v[112:113], v[196:197]
v_pk_mul_f32 v[114:115], v[114:115], v[198:199]
v_pk_mul_f32 v[192:193], v[116:117], v[116:117]
buffer_load_dwordx4 a[104:107], v1, s[4:7], s52 offen offset:1024 sc1
buffer_load_dwordx4 a[108:111], v9, s[4:7], s52 offen offset:1024 sc1
v_pk_mul_f32 v[194:195], v[118:119], v[118:119]
v_pk_mul_f32 v[196:197], v[120:121], v[120:121]
v_pk_mul_f32 v[198:199], v[122:123], v[122:123]
v_pk_fma_f32 v[192:193], v[192:193], v[252:253], v[250:251] op_sel:[0,0,0] op_sel_hi:[1,0,0]
v_pk_fma_f32 v[194:195], v[194:195], v[252:253], v[250:251] op_sel:[0,0,0] op_sel_hi:[1,0,0]
v_pk_fma_f32 v[196:197], v[196:197], v[252:253], v[250:251] op_sel:[0,1,1] op_sel_hi:[1,1,1]
v_pk_fma_f32 v[198:199], v[198:199], v[252:253], v[250:251] op_sel:[0,1,1] op_sel_hi:[1,1,1]
v_pk_mul_f32 v[192:193], v[192:193], v[116:117]
v_pk_mul_f32 v[194:195], v[194:195], v[118:119]
v_pk_mul_f32 v[196:197], v[196:197], v[120:121]
v_pk_mul_f32 v[198:199], v[198:199], v[122:123]
v_exp_f32 v192, v192
v_exp_f32 v193, v193
v_exp_f32 v194, v194
buffer_load_dwordx4 a[112:115], v1, s[4:7], s52 offen offset:2048 sc1
s_mov_b64 exec, 1
buffer_atomic_add v245, v6, s[8:11], s35 offen sc0 sc1
s_mov_b64 exec, -1
buffer_load_dwordx4 a[116:119], v9, s[4:7], s52 offen offset:2048 sc1
v_exp_f32 v195, v195
v_exp_f32 v196, v196
v_exp_f32 v197, v197
v_exp_f32 v198, v198
v_exp_f32 v199, v199
v_pk_fma_f32 v[192:193], v[192:193], v[254:255], v[254:255] op_sel:[0,0,0] op_sel_hi:[1,0,0]
v_pk_fma_f32 v[194:195], v[194:195], v[254:255], v[254:255] op_sel:[0,0,0] op_sel_hi:[1,0,0]
v_pk_fma_f32 v[196:197], v[196:197], v[254:255], v[254:255] op_sel:[0,1,1] op_sel_hi:[1,1,1]
v_pk_fma_f32 v[198:199], v[198:199], v[254:255], v[254:255] op_sel:[0,1,1] op_sel_hi:[1,1,1]
v_rcp_f32 v192, v192
v_rcp_f32 v193, v193
v_rcp_f32 v194, v194
v_rcp_f32 v195, v195
v_rcp_f32 v196, v196
buffer_load_dwordx4 a[120:123], v1, s[4:7], s52 offen offset:3072 sc1
buffer_load_dwordx4 a[124:127], v9, s[4:7], s52 offen offset:3072 sc1
v_rcp_f32 v197, v197
v_rcp_f32 v198, v198
v_rcp_f32 v199, v199
v_pk_mul_f32 v[116:117], v[116:117], v[192:193]
v_pk_mul_f32 v[118:119], v[118:119], v[194:195]
v_pk_mul_f32 v[120:121], v[120:121], v[196:197]
v_pk_mul_f32 v[122:123], v[122:123], v[198:199]
v_pk_mul_f32 v[192:193], v[124:125], v[124:125]
v_pk_mul_f32 v[194:195], v[126:127], v[126:127]
v_pk_mul_f32 v[196:197], v[128:129], v[128:129]
v_pk_mul_f32 v[198:199], v[130:131], v[130:131]
v_pk_fma_f32 v[192:193], v[192:193], v[252:253], v[250:251] op_sel:[0,0,0] op_sel_hi:[1,0,0]
v_pk_fma_f32 v[194:195], v[194:195], v[252:253], v[250:251] op_sel:[0,0,0] op_sel_hi:[1,0,0]
v_pk_fma_f32 v[196:197], v[196:197], v[252:253], v[250:251] op_sel:[0,1,1] op_sel_hi:[1,1,1]
s_cmp_eq_u32 s25, 3
s_cselect_b32 s98, 4096, 0
s_add_u32 s52, s52, s98
s_add_u32 s52, s52, 4096
buffer_load_dwordx4 a[128:131], v1, s[4:7], s52 offen offset:0 sc1
s_mov_b64 exec, 1
buffer_atomic_add v246, v6, s[8:11], s35 offen sc0 sc1
s_mov_b64 exec, -1
buffer_load_dwordx4 a[132:135], v9, s[4:7], s52 offen offset:0 sc1
v_pk_fma_f32 v[198:199], v[198:199], v[252:253], v[250:251] op_sel:[0,1,1] op_sel_hi:[1,1,1]
v_pk_mul_f32 v[192:193], v[192:193], v[124:125]
v_pk_mul_f32 v[194:195], v[194:195], v[126:127]
v_pk_mul_f32 v[196:197], v[196:197], v[128:129]
v_pk_mul_f32 v[198:199], v[198:199], v[130:131]
v_exp_f32 v192, v192
v_exp_f32 v193, v193
v_exp_f32 v194, v194
v_exp_f32 v195, v195
v_exp_f32 v196, v196
v_exp_f32 v197, v197
v_exp_f32 v198, v198
v_exp_f32 v199, v199
v_pk_fma_f32 v[192:193], v[192:193], v[254:255], v[254:255] op_sel:[0,0,0] op_sel_hi:[1,0,0]
buffer_load_dwordx4 a[136:139], v1, s[4:7], s52 offen offset:1024 sc1
buffer_load_dwordx4 a[140:143], v9, s[4:7], s52 offen offset:1024 sc1
v_pk_fma_f32 v[194:195], v[194:195], v[254:255], v[254:255] op_sel:[0,0,0] op_sel_hi:[1,0,0]
v_pk_fma_f32 v[196:197], v[196:197], v[254:255], v[254:255] op_sel:[0,1,1] op_sel_hi:[1,1,1]
v_pk_fma_f32 v[198:199], v[198:199], v[254:255], v[254:255] op_sel:[0,1,1] op_sel_hi:[1,1,1]
v_rcp_f32 v192, v192
v_rcp_f32 v193, v193
v_rcp_f32 v194, v194
v_rcp_f32 v195, v195
v_rcp_f32 v196, v196
v_rcp_f32 v197, v197
v_rcp_f32 v198, v198
v_rcp_f32 v199, v199
v_pk_mul_f32 v[124:125], v[124:125], v[192:193]
v_pk_mul_f32 v[126:127], v[126:127], v[194:195]
v_pk_mul_f32 v[128:129], v[128:129], v[196:197]
v_pk_mul_f32 v[130:131], v[130:131], v[198:199]
s_mul_i32 s30, s26, 589824
s_add_u32 s30, s30, 7340032
s_lshl_b32 s62, s24, 12
s_lshl_b32 s63, s24, 10
s_add_u32 s60, s30, s62
s_add_u32 s61, s30, s63
s_add_u32 s61, s61, 16384
s_cmp_eq_u32 s25, 0
s_cselect_b32 s99, 36864, 0
s_add_u32 s60, s60, s99
s_add_u32 s61, s61, s99
s_add_u32 m0, s62, 53248
s_add_u32 s60, s60, 0
s_waitcnt lgkmcnt(0)
s_cmp_eq_u32 s24, 1
s_cbranch_scc0 L_other_28
s_mov_b32 s31, 0
s_mov_b64 exec, 1
v_mov_b32 v247, 0
buffer_atomic_add v247, v6, s[8:11], s35 offen sc0 sc1
s_waitcnt vmcnt(14)
v_cmp_gt_u32 vcc, 16, v244
s_nop 0
s_cbranch_vccz L_polled_27
s_waitcnt vmcnt(9)
v_cmp_gt_u32 vcc, 16, v245
s_nop 0
s_cbranch_vccz L_polled_27
v_mov_b32 v244, 0
buffer_atomic_add v244, v6, s[8:11], s35 offen sc0 sc1
s_waitcnt vmcnt(5)
v_cmp_gt_u32 vcc, 16, v246
s_nop 0
s_cbranch_vccz L_polled_27
v_mov_b32 v245, 0
buffer_atomic_add v245, v6, s[8:11], s35 offen sc0 sc1
L_poll_26:
s_add_u32 s31, s31, 1
s_cmp_gt_u32 s31, 100000
s_cbranch_scc1 L_polled_27
v_mov_b32 v246, 0
buffer_atomic_add v246, v6, s[8:11], s35 offen sc0 sc1
s_waitcnt vmcnt(3)
v_cmp_gt_u32 vcc, 16, v247
s_nop 0
s_cbranch_vccz L_polled_27
v_mov_b32 v247, 0
buffer_atomic_add v247, v6, s[8:11], s35 offen sc0 sc1
s_waitcnt vmcnt(3)
v_cmp_gt_u32 vcc, 16, v244
s_nop 0
s_cbranch_vccz L_polled_27
v_mov_b32 v244, 0
buffer_atomic_add v244, v6, s[8:11], s35 offen sc0 sc1
s_waitcnt vmcnt(3)
v_cmp_gt_u32 vcc, 16, v245
s_nop 0
s_cbranch_vccz L_polled_27
v_mov_b32 v245, 0
buffer_atomic_add v245, v6, s[8:11], s35 offen sc0 sc1
s_waitcnt vmcnt(3)
v_cmp_gt_u32 vcc, 16, v246
s_nop 0
s_cbranch_vccz L_polled_27
s_branch L_poll_26
L_polled_27:
s_mov_b64 exec, -1
L_other_28:
s_barrier
buffer_load_dwordx4 v1, s[8:11], s60 offen offset:0 sc1 lds
buffer_load_dwordx4 v1, s[8:11], s60 offen offset:1024 sc1 lds
ds_read_b128 a[0:3], v180 offset:0
ds_read_b128 a[4:7], v180 offset:1024
ds_read_b128 a[8:11], v180 offset:2048
ds_read_b128 a[12:15], v180 offset:3072
ds_read_b128 a[16:19], v180 offset:4096
ds_read_b128 a[20:23], v180 offset:5120
ds_read_b128 a[24:27], v180 offset:6144
ds_read_b128 a[28:31], v180 offset:7168
ds_read_b128 a[32:35], v180 offset:8192
buffer_load_dwordx4 v1, s[8:11], s60 offen offset:2048 sc1 lds
buffer_load_dwordx4 v1, s[8:11], s60 offen offset:3072 sc1 lds
s_add_u32 m0, s63, 69632
s_add_u32 s61, s61, 0
buffer_load_dwordx4 v1, s[8:11], s61 offen offset:0 sc1 lds
s_waitcnt lgkmcnt(0)
v_mfma_f32_16x16x32_bf16 v[36:39], a[0:3], a[176:179], v[184:187]
ds_read_b128 a[36:39], v180 offset:9216
s_add_u32 m0, s62, 73728
v_mfma_f32_16x16x32_bf16 v[40:43], a[0:3], a[180:183], v[188:191]
ds_read_b128 a[40:43], v180 offset:10240
v_mul_f32 v192, v132, v132
v_mfma_f32_16x16x32_bf16 v[44:47], a[4:7], a[176:179], v[184:187]
ds_read_b128 a[44:47], v180 offset:11264
s_add_u32 s60, s60, 20480
v_mfma_f32_16x16x32_bf16 v[48:51], a[4:7], a[180:183], v[188:191]
ds_read_b128 a[48:51], v180 offset:12288
v_mul_f32 v193, v133, v133
v_mfma_f32_16x16x32_bf16 v[52:55], a[8:11], a[176:179], v[184:187]
ds_read_b128 a[52:55], v180 offset:13312
v_mul_f32 v194, v134, v134
v_mfma_f32_16x16x32_bf16 v[56:59], a[8:11], a[180:183], v[188:191]
ds_read_b128 a[56:59], v180 offset:14336
buffer_load_dwordx4 v1, s[8:11], s60 offen offset:0 sc1 lds
v_mfma_f32_16x16x32_bf16 v[60:63], a[12:15], a[176:179], v[184:187]
ds_read_b128 a[60:63], v180 offset:15360
v_mfma_f32_16x16x32_bf16 v[64:67], a[12:15], a[180:183], v[188:191]
ds_read_b128 a[64:67], v180 offset:16384
v_mul_f32 v195, v135, v135
v_mfma_f32_16x16x32_bf16 v[68:71], a[16:19], a[176:179], v[184:187]
ds_read_b128 a[68:71], v180 offset:17408
buffer_load_dwordx4 v1, s[8:11], s60 offen offset:1024 sc1 lds
v_mfma_f32_16x16x32_bf16 v[72:75], a[16:19], a[180:183], v[188:191]
v_fma_f32 v192, v192, v252, v250
v_mfma_f32_16x16x32_bf16 v[76:79], a[20:23], a[176:179], v[184:187]
v_mfma_f32_16x16x32_bf16 v[80:83], a[20:23], a[180:183], v[188:191]
buffer_load_dwordx4 v1, s[8:11], s60 offen offset:2048 sc1 lds
v_fma_f32 v193, v193, v252, v250
v_mfma_f32_16x16x32_bf16 v[84:87], a[24:27], a[176:179], v[184:187]
v_mfma_f32_16x16x32_bf16 v[88:91], a[24:27], a[180:183], v[188:191]
v_mfma_f32_16x16x32_bf16 v[92:95], a[28:31], a[176:179], v[184:187]
buffer_load_dwordx4 v1, s[8:11], s60 offen offset:3072 sc1 lds
v_fma_f32 v194, v194, v252, v250
v_mfma_f32_16x16x32_bf16 v[96:99], a[28:31], a[180:183], v[188:191]
v_mfma_f32_16x16x32_bf16 v[100:103], a[32:35], a[176:179], v[184:187]
v_fma_f32 v195, v195, v252, v250
v_mfma_f32_16x16x32_bf16 v[104:107], a[32:35], a[180:183], v[188:191]
s_waitcnt lgkmcnt(0)
v_mfma_f32_16x16x32_bf16 v[36:39], a[36:39], a[184:187], v[36:39]
ds_read_b128 a[0:3], v180 offset:18432
v_mul_f32 v192, v192, v132
v_mfma_f32_16x16x32_bf16 v[40:43], a[36:39], a[188:191], v[40:43]
ds_read_b128 a[4:7], v180 offset:19456
v_mfma_f32_16x16x32_bf16 v[44:47], a[40:43], a[184:187], v[44:47]
ds_read_b128 a[8:11], v180 offset:20480
v_mfma_f32_16x16x32_bf16 v[48:51], a[40:43], a[188:191], v[48:51]
ds_read_b128 a[12:15], v180 offset:21504
v_mul_f32 v193, v193, v133
v_mfma_f32_16x16x32_bf16 v[52:55], a[44:47], a[184:187], v[52:55]
ds_read_b128 a[16:19], v180 offset:22528
v_mfma_f32_16x16x32_bf16 v[56:59], a[44:47], a[188:191], v[56:59]
ds_read_b128 a[20:23], v180 offset:23552
v_mul_f32 v194, v194, v134
v_mfma_f32_16x16x32_bf16 v[60:63], a[48:51], a[184:187], v[60:63]
ds_read_b128 a[24:27], v180 offset:24576
v_mfma_f32_16x16x32_bf16 v[64:67], a[48:51], a[188:191], v[64:67]
ds_read_b128 a[28:31], v180 offset:25600
v_mul_f32 v195, v195, v135
v_mfma_f32_16x16x32_bf16 v[68:71], a[52:55], a[184:187], v[68:71]
ds_read_b128 a[32:35], v180 offset:26624
v_mfma_f32_16x16x32_bf16 v[72:75], a[52:55], a[188:191], v[72:75]
s_cmp_eq_u32 s25, 1
s_cselect_b32 s99, 36864, 0
s_add_u32 s60, s60, s99
v_mfma_f32_16x16x32_bf16 v[76:79], a[56:59], a[184:187], v[76:79]
s_add_u32 s61, s61, s99
s_add_u32 m0, s62, 90112
s_add_u32 s60, s60, 16384
v_mfma_f32_16x16x32_bf16 v[80:83], a[56:59], a[188:191], v[80:83]
buffer_load_dwordx4 v1, s[8:11], s60 offen offset:0 sc1 lds
v_mfma_f32_16x16x32_bf16 v[84:87], a[60:63], a[184:187], v[84:87]
buffer_load_dwordx4 v1, s[8:11], s60 offen offset:1024 sc1 lds
v_mfma_f32_16x16x32_bf16 v[88:91], a[60:63], a[188:191], v[88:91]
buffer_load_dwordx4 v1, s[8:11], s60 offen offset:2048 sc1 lds
v_mfma_f32_16x16x32_bf16 v[92:95], a[64:67], a[184:187], v[92:95]
v_exp_f32 v192, v192
v_mfma_f32_16x16x32_bf16 v[96:99], a[64:67], a[188:191], v[96:99]
buffer_load_dwordx4 v1, s[8:11], s60 offen offset:3072 sc1 lds
v_mfma_f32_16x16x32_bf16 v[100:103], a[68:71], a[184:187], v[100:103]
v_exp_f32 v193, v193
v_mfma_f32_16x16x32_bf16 v[104:107], a[68:71], a[188:191], v[104:107]
s_waitcnt lgkmcnt(0)
v_mfma_f32_16x16x32_bf16 v[36:39], a[0:3], a[192:195], v[36:39]
ds_read_b128 a[36:39], v180 offset:27648
s_add_u32 m0, s63, 106496
v_mfma_f32_16x16x32_bf16 v[40:43], a[0:3], a[196:199], v[40:43]
ds_read_b128 a[40:43], v180 offset:28672
v_mfma_f32_16x16x32_bf16 v[44:47], a[4:7], a[192:195], v[44:47]
ds_read_b128 a[44:47], v180 offset:29696
s_add_u32 s61, s61, 36864
v_mfma_f32_16x16x32_bf16 v[48:51], a[4:7], a[196:199], v[48:51]
ds_read_b128 a[48:51], v180 offset:30720
v_mfma_f32_16x16x32_bf16 v[52:55], a[8:11], a[192:195], v[52:55]
ds_read_b128 a[52:55], v180 offset:31744
buffer_load_dwordx4 v1, s[8:11], s61 offen offset:0 sc1 lds
v_mfma_f32_16x16x32_bf16 v[56:59], a[8:11], a[196:199], v[56:59]
ds_read_b128 a[56:59], v180 offset:32768
v_mfma_f32_16x16x32_bf16 v[60:63], a[12:15], a[192:195], v[60:63]
ds_read_b128 a[60:63], v180 offset:33792
s_add_u32 m0, s62, 110592
v_mfma_f32_16x16x32_bf16 v[64:67], a[12:15], a[196:199], v[64:67]
ds_read_b128 a[64:67], v180 offset:34816
v_mfma_f32_16x16x32_bf16 v[68:71], a[16:19], a[192:195], v[68:71]
ds_read_b128 a[68:71], v180 offset:35840
s_add_u32 s60, s60, 20480
v_mfma_f32_16x16x32_bf16 v[72:75], a[16:19], a[196:199], v[72:75]
v_exp_f32 v194, v194
v_mfma_f32_16x16x32_bf16 v[76:79], a[20:23], a[192:195], v[76:79]
buffer_load_dwordx4 v1, s[8:11], s60 offen offset:0 sc1 lds
v_mfma_f32_16x16x32_bf16 v[80:83], a[20:23], a[196:199], v[80:83]
v_exp_f32 v195, v195
v_mfma_f32_16x16x32_bf16 v[84:87], a[24:27], a[192:195], v[84:87]
buffer_load_dwordx4 v1, s[8:11], s60 offen offset:1024 sc1 lds
v_fma_f32 v192, v192, v254, v254
v_mfma_f32_16x16x32_bf16 v[88:91], a[24:27], a[196:199], v[88:91]
v_fma_f32 v193, v193, v254, v254
v_mfma_f32_16x16x32_bf16 v[92:95], a[28:31], a[192:195], v[92:95]
buffer_load_dwordx4 v1, s[8:11], s60 offen offset:2048 sc1 lds
v_mfma_f32_16x16x32_bf16 v[96:99], a[28:31], a[196:199], v[96:99]
v_fma_f32 v194, v194, v254, v254
v_mfma_f32_16x16x32_bf16 v[100:103], a[32:35], a[192:195], v[100:103]
v_mfma_f32_16x16x32_bf16 v[104:107], a[32:35], a[196:199], v[104:107]
s_waitcnt vmcnt(12) lgkmcnt(0)
s_barrier
v_mfma_f32_16x16x32_bf16 v[36:39], a[36:39], a[200:203], v[36:39]
ds_read_b128 a[0:3], v200 offset:0
buffer_load_dwordx4 v1, s[8:11], s60 offen offset:3072 sc1 lds
v_mfma_f32_16x16x32_bf16 v[40:43], a[36:39], a[204:207], v[40:43]
ds_read_b128 a[4:7], v200 offset:1024
v_fma_f32 v195, v195, v254, v254
v_mfma_f32_16x16x32_bf16 v[44:47], a[40:43], a[200:203], v[44:47]
ds_read_b128 a[8:11], v200 offset:2048
v_mfma_f32_16x16x32_bf16 v[48:51], a[40:43], a[204:207], v[48:51]
ds_read_b128 a[12:15], v200 offset:3072
v_mfma_f32_16x16x32_bf16 v[52:55], a[44:47], a[200:203], v[52:55]
ds_read_b128 a[16:19], v200 offset:4096
v_mfma_f32_16x16x32_bf16 v[56:59], a[44:47], a[204:207], v[56:59]
ds_read_b128 a[20:23], v200 offset:5120
v_mfma_f32_16x16x32_bf16 v[60:63], a[48:51], a[200:203], v[60:63]
ds_read_b128 a[24:27], v200 offset:6144
v_mfma_f32_16x16x32_bf16 v[64:67], a[48:51], a[204:207], v[64:67]
ds_read_b128 a[28:31], v200 offset:7168
v_mfma_f32_16x16x32_bf16 v[68:71], a[52:55], a[200:203], v[68:71]
ds_read_b128 a[32:35], v200 offset:8192
v_mfma_f32_16x16x32_bf16 v[72:75], a[52:55], a[204:207], v[72:75]
s_cmp_eq_u32 s25, 2
s_cselect_b32 s99, 36864, 0
s_add_u32 s60, s60, s99
v_mfma_f32_16x16x32_bf16 v[76:79], a[56:59], a[200:203], v[76:79]
s_add_u32 s61, s61, s99
s_add_u32 m0, s62, 126976
s_add_u32 s60, s60, 16384
v_mfma_f32_16x16x32_bf16 v[80:83], a[56:59], a[204:207], v[80:83]
buffer_load_dwordx4 v1, s[8:11], s60 offen offset:0 sc1 lds
v_mfma_f32_16x16x32_bf16 v[84:87], a[60:63], a[200:203], v[84:87]
v_rcp_f32 v192, v192
v_mfma_f32_16x16x32_bf16 v[88:91], a[60:63], a[204:207], v[88:91]
buffer_load_dwordx4 v1, s[8:11], s60 offen offset:1024 sc1 lds
v_mfma_f32_16x16x32_bf16 v[92:95], a[64:67], a[200:203], v[92:95]
v_rcp_f32 v193, v193
v_mfma_f32_16x16x32_bf16 v[96:99], a[64:67], a[204:207], v[96:99]
buffer_load_dwordx4 v1, s[8:11], s60 offen offset:2048 sc1 lds
v_mfma_f32_16x16x32_bf16 v[100:103], a[68:71], a[200:203], v[100:103]
v_rcp_f32 v194, v194
v_mfma_f32_16x16x32_bf16 v[104:107], a[68:71], a[204:207], v[104:107]
s_waitcnt lgkmcnt(0)
v_mfma_f32_16x16x32_bf16 v[36:39], a[0:3], a[208:211], v[36:39]
ds_read_b128 a[36:39], v200 offset:9216
buffer_load_dwordx4 v1, s[8:11], s60 offen offset:3072 sc1 lds
v_mfma_f32_16x16x32_bf16 v[40:43], a[0:3], a[212:215], v[40:43]
ds_read_b128 a[40:43], v200 offset:10240
v_mfma_f32_16x16x32_bf16 v[44:47], a[4:7], a[208:211], v[44:47]
ds_read_b128 a[44:47], v200 offset:11264
s_add_u32 m0, s63, 143360
v_mfma_f32_16x16x32_bf16 v[48:51], a[4:7], a[212:215], v[48:51]
ds_read_b128 a[48:51], v200 offset:12288
v_mfma_f32_16x16x32_bf16 v[52:55], a[8:11], a[208:211], v[52:55]
ds_read_b128 a[52:55], v200 offset:13312
s_add_u32 s61, s61, 36864
v_mfma_f32_16x16x32_bf16 v[56:59], a[8:11], a[212:215], v[56:59]
ds_read_b128 a[56:59], v200 offset:14336
v_mfma_f32_16x16x32_bf16 v[60:63], a[12:15], a[208:211], v[60:63]
ds_read_b128 a[60:63], v200 offset:15360
buffer_load_dwordx4 v1, s[8:11], s61 offen offset:0 sc1 lds
v_mfma_f32_16x16x32_bf16 v[64:67], a[12:15], a[212:215], v[64:67]
ds_read_b128 a[64:67], v200 offset:16384
v_mfma_f32_16x16x32_bf16 v[68:71], a[16:19], a[208:211], v[68:71]
ds_read_b128 a[68:71], v200 offset:17408
s_add_u32 m0, s62, 147456
v_mfma_f32_16x16x32_bf16 v[72:75], a[16:19], a[212:215], v[72:75]
s_add_u32 s60, s60, 20480
v_rcp_f32 v195, v195
v_mfma_f32_16x16x32_bf16 v[76:79], a[20:23], a[208:211], v[76:79]
v_mul_f32 v132, v132, v192
v_mul_f32 v133, v133, v193
v_mfma_f32_16x16x32_bf16 v[80:83], a[20:23], a[212:215], v[80:83]
v_mul_f32 v134, v134, v194
v_mul_f32 v135, v135, v195
v_mfma_f32_16x16x32_bf16 v[84:87], a[24:27], a[208:211], v[84:87]
buffer_load_dwordx4 v1, s[8:11], s60 offen offset:0 sc1 lds
v_mul_f32 v196, v136, v136
v_mfma_f32_16x16x32_bf16 v[88:91], a[24:27], a[212:215], v[88:91]
v_mfma_f32_16x16x32_bf16 v[92:95], a[28:31], a[208:211], v[92:95]
buffer_load_dwordx4 v1, s[8:11], s60 offen offset:1024 sc1 lds
v_mfma_f32_16x16x32_bf16 v[96:99], a[28:31], a[212:215], v[96:99]
v_mul_f32 v197, v137, v137
v_mfma_f32_16x16x32_bf16 v[100:103], a[32:35], a[208:211], v[100:103]
v_mfma_f32_16x16x32_bf16 v[104:107], a[32:35], a[212:215], v[104:107]
s_waitcnt vmcnt(16) lgkmcnt(0)
s_barrier
v_mfma_f32_16x16x32_bf16 v[36:39], a[36:39], a[216:219], v[36:39]
ds_read_b128 a[0:3], v200 offset:18432
buffer_load_dwordx4 v1, s[8:11], s60 offen offset:2048 sc1 lds
v_mfma_f32_16x16x32_bf16 v[40:43], a[36:39], a[220:223], v[40:43]
ds_read_b128 a[4:7], v200 offset:19456
v_mul_f32 v198, v138, v138
v_mfma_f32_16x16x32_bf16 v[44:47], a[40:43], a[216:219], v[44:47]
ds_read_b128 a[8:11], v200 offset:20480
v_mul_f32 v199, v139, v139
v_mfma_f32_16x16x32_bf16 v[48:51], a[40:43], a[220:223], v[48:51]
ds_read_b128 a[12:15], v200 offset:21504
v_mfma_f32_16x16x32_bf16 v[52:55], a[44:47], a[216:219], v[52:55]
ds_read_b128 a[16:19], v200 offset:22528
buffer_load_dwordx4 v1, s[8:11], s60 offen offset:3072 sc1 lds
v_mfma_f32_16x16x32_bf16 v[56:59], a[44:47], a[220:223], v[56:59]
ds_read_b128 a[20:23], v200 offset:23552
v_fma_f32 v196, v196, v253, v251
v_mfma_f32_16x16x32_bf16 v[60:63], a[48:51], a[216:219], v[60:63]
ds_read_b128 a[24:27], v200 offset:24576
v_fma_f32 v197, v197, v253, v251
v_mfma_f32_16x16x32_bf16 v[64:67], a[48:51], a[220:223], v[64:67]
ds_read_b128 a[28:31], v200 offset:25600
v_mfma_f32_16x16x32_bf16 v[68:71], a[52:55], a[216:219], v[68:71]
ds_read_b128 a[32:35], v200 offset:26624
buffer_load_dwordx4 a[144:147], v1, s[4:7], s52 offen offset:2048 sc1
v_mfma_f32_16x16x32_bf16 v[72:75], a[52:55], a[220:223], v[72:75]
v_fma_f32 v198, v198, v253, v251
v_mfma_f32_16x16x32_bf16 v[76:79], a[56:59], a[216:219], v[76:79]
v_mfma_f32_16x16x32_bf16 v[80:83], a[56:59], a[220:223], v[80:83]
v_fma_f32 v199, v199, v253, v251
v_mfma_f32_16x16x32_bf16 v[84:87], a[60:63], a[216:219], v[84:87]
buffer_load_dwordx4 a[148:151], v9, s[4:7], s52 offen offset:2048 sc1
v_mfma_f32_16x16x32_bf16 v[88:91], a[60:63], a[220:223], v[88:91]
v_mul_f32 v196, v196, v136
v_mfma_f32_16x16x32_bf16 v[92:95], a[64:67], a[216:219], v[92:95]
v_mfma_f32_16x16x32_bf16 v[96:99], a[64:67], a[220:223], v[96:99]
v_mfma_f32_16x16x32_bf16 v[100:103], a[68:71], a[216:219], v[100:103]
v_mul_f32 v197, v197, v137
v_mfma_f32_16x16x32_bf16 v[104:107], a[68:71], a[220:223], v[104:107]
s_waitcnt lgkmcnt(0)
v_mfma_f32_16x16x32_bf16 v[36:39], a[0:3], a[224:227], v[36:39]
ds_read_b128 a[36:39], v200 offset:27648
buffer_load_dwordx4 a[152:155], v1, s[4:7], s52 offen offset:3072 sc1
v_mfma_f32_16x16x32_bf16 v[40:43], a[0:3], a[228:231], v[40:43]
ds_read_b128 a[40:43], v200 offset:28672
v_mul_f32 v198, v198, v138
v_mfma_f32_16x16x32_bf16 v[44:47], a[4:7], a[224:227], v[44:47]
ds_read_b128 a[44:47], v200 offset:29696
buffer_load_dwordx4 a[156:159], v9, s[4:7], s52 offen offset:3072 sc1
v_mfma_f32_16x16x32_bf16 v[48:51], a[4:7], a[228:231], v[48:51]
ds_read_b128 a[48:51], v200 offset:30720
v_mul_f32 v199, v199, v139
v_mfma_f32_16x16x32_bf16 v[52:55], a[8:11], a[224:227], v[52:55]
ds_read_b128 a[52:55], v200 offset:31744
v_mfma_f32_16x16x32_bf16 v[56:59], a[8:11], a[228:231], v[56:59]
ds_read_b128 a[56:59], v200 offset:32768
v_mfma_f32_16x16x32_bf16 v[60:63], a[12:15], a[224:227], v[60:63]
ds_read_b128 a[60:63], v200 offset:33792
v_mfma_f32_16x16x32_bf16 v[64:67], a[12:15], a[228:231], v[64:67]
ds_read_b128 a[64:67], v200 offset:34816
v_mfma_f32_16x16x32_bf16 v[68:71], a[16:19], a[224:227], v[68:71]
ds_read_b128 a[68:71], v200 offset:35840
v_mfma_f32_16x16x32_bf16 v[72:75], a[16:19], a[228:231], v[72:75]
s_cmp_eq_u32 s25, 4
s_cselect_b32 s98, 4096, 0
s_add_u32 s52, s52, s98
v_mfma_f32_16x16x32_bf16 v[76:79], a[20:23], a[224:227], v[76:79]
s_add_u32 s52, s52, 4096
v_exp_f32 v196, v196
v_mfma_f32_16x16x32_bf16 v[80:83], a[20:23], a[228:231], v[80:83]
v_exp_f32 v197, v197
v_mfma_f32_16x16x32_bf16 v[84:87], a[24:27], a[224:227], v[84:87]
buffer_load_dwordx4 a[160:163], v1, s[4:7], s52 offen offset:0 sc1
v_mfma_f32_16x16x32_bf16 v[88:91], a[24:27], a[228:231], v[88:91]
v_mfma_f32_16x16x32_bf16 v[92:95], a[28:31], a[224:227], v[92:95]
buffer_load_dwordx4 a[164:167], v9, s[4:7], s52 offen offset:0 sc1
v_mfma_f32_16x16x32_bf16 v[96:99], a[28:31], a[228:231], v[96:99]
v_exp_f32 v198, v198
v_mfma_f32_16x16x32_bf16 v[100:103], a[32:35], a[224:227], v[100:103]
v_mfma_f32_16x16x32_bf16 v[104:107], a[32:35], a[228:231], v[104:107]
s_waitcnt vmcnt(19) lgkmcnt(0)
s_barrier
v_mfma_f32_16x16x32_bf16 v[36:39], a[36:39], a[232:235], v[36:39]
ds_read_b128 a[0:3], v201 offset:0
buffer_load_dwordx4 a[168:171], v1, s[4:7], s52 offen offset:1024 sc1
v_mfma_f32_16x16x32_bf16 v[40:43], a[36:39], a[236:239], v[40:43]
ds_read_b128 a[4:7], v201 offset:1024
buffer_load_dwordx4 a[172:175], v9, s[4:7], s52 offen offset:1024 sc1
v_mfma_f32_16x16x32_bf16 v[44:47], a[40:43], a[232:235], v[44:47]
ds_read_b128 a[8:11], v201 offset:2048
v_mfma_f32_16x16x32_bf16 v[48:51], a[40:43], a[236:239], v[48:51]
ds_read_b128 a[12:15], v201 offset:3072
v_mfma_f32_16x16x32_bf16 v[52:55], a[44:47], a[232:235], v[52:55]
ds_read_b128 a[16:19], v201 offset:4096
v_mfma_f32_16x16x32_bf16 v[56:59], a[44:47], a[236:239], v[56:59]
ds_read_b128 a[20:23], v201 offset:5120
v_mfma_f32_16x16x32_bf16 v[60:63], a[48:51], a[232:235], v[60:63]
ds_read_b128 a[24:27], v201 offset:6144
v_mfma_f32_16x16x32_bf16 v[64:67], a[48:51], a[236:239], v[64:67]
ds_read_b128 a[28:31], v201 offset:7168
v_mfma_f32_16x16x32_bf16 v[68:71], a[52:55], a[232:235], v[68:71]
ds_read_b128 a[32:35], v201 offset:8192
v_mfma_f32_16x16x32_bf16 v[72:75], a[52:55], a[236:239], v[72:75]
s_cmp_eq_u32 s25, 3
s_cselect_b32 s99, 36864, 0
s_add_u32 s60, s60, s99
v_mfma_f32_16x16x32_bf16 v[76:79], a[56:59], a[232:235], v[76:79]
s_add_u32 s61, s61, s99
s_add_u32 m0, s62, 53248
v_mfma_f32_16x16x32_bf16 v[80:83], a[56:59], a[236:239], v[80:83]
s_add_u32 s60, s60, 16384
v_exp_f32 v199, v199
v_mfma_f32_16x16x32_bf16 v[84:87], a[60:63], a[232:235], v[84:87]
v_fma_f32 v196, v196, v255, v255
v_fma_f32 v197, v197, v255, v255
v_mfma_f32_16x16x32_bf16 v[88:91], a[60:63], a[236:239], v[88:91]
buffer_load_dwordx4 v1, s[8:11], s60 offen offset:0 sc1 lds
v_fma_f32 v198, v198, v255, v255
v_mfma_f32_16x16x32_bf16 v[92:95], a[64:67], a[232:235], v[92:95]
v_fma_f32 v199, v199, v255, v255
v_mfma_f32_16x16x32_bf16 v[96:99], a[64:67], a[236:239], v[96:99]
buffer_load_dwordx4 v1, s[8:11], s60 offen offset:1024 sc1 lds
v_mfma_f32_16x16x32_bf16 v[100:103], a[68:71], a[232:235], v[100:103]
v_rcp_f32 v196, v196
v_mfma_f32_16x16x32_bf16 v[104:107], a[68:71], a[236:239], v[104:107]
s_waitcnt lgkmcnt(0)
v_mfma_f32_16x16x32_bf16 v[36:39], a[0:3], a[240:243], v[36:39]
ds_read_b128 a[36:39], v201 offset:9216
buffer_load_dwordx4 v1, s[8:11], s60 offen offset:2048 sc1 lds
v_mfma_f32_16x16x32_bf16 v[40:43], a[0:3], a[244:247], v[40:43]
ds_read_b128 a[40:43], v201 offset:10240
v_mfma_f32_16x16x32_bf16 v[44:47], a[4:7], a[240:243], v[44:47]
ds_read_b128 a[44:47], v201 offset:11264
buffer_load_dwordx4 v1, s[8:11], s60 offen offset:3072 sc1 lds
v_mfma_f32_16x16x32_bf16 v[48:51], a[4:7], a[244:247], v[48:51]
ds_read_b128 a[48:51], v201 offset:12288
v_mfma_f32_16x16x32_bf16 v[52:55], a[8:11], a[240:243], v[52:55]
ds_read_b128 a[52:55], v201 offset:13312
s_add_u32 m0, s63, 69632
v_mfma_f32_16x16x32_bf16 v[56:59], a[8:11], a[244:247], v[56:59]
ds_read_b128 a[56:59], v201 offset:14336
v_mfma_f32_16x16x32_bf16 v[60:63], a[12:15], a[240:243], v[60:63]
ds_read_b128 a[60:63], v201 offset:15360
s_add_u32 s61, s61, 36864
v_mfma_f32_16x16x32_bf16 v[64:67], a[12:15], a[244:247], v[64:67]
ds_read_b128 a[64:67], v201 offset:16384
v_mfma_f32_16x16x32_bf16 v[68:71], a[16:19], a[240:243], v[68:71]
ds_read_b128 a[68:71], v201 offset:17408
buffer_load_dwordx4 v1, s[8:11], s61 offen offset:0 sc1 lds
v_mfma_f32_16x16x32_bf16 v[72:75], a[16:19], a[244:247], v[72:75]
s_add_u32 m0, s62, 73728
v_rcp_f32 v197, v197
v_mfma_f32_16x16x32_bf16 v[76:79], a[20:23], a[240:243], v[76:79]
s_add_u32 s60, s60, 20480
v_rcp_f32 v198, v198
v_mfma_f32_16x16x32_bf16 v[80:83], a[20:23], a[244:247], v[80:83]
v_rcp_f32 v199, v199
v_mfma_f32_16x16x32_bf16 v[84:87], a[24:27], a[240:243], v[84:87]
v_mfma_f32_16x16x32_bf16 v[88:91], a[24:27], a[244:247], v[88:91]
v_mfma_f32_16x16x32_bf16 v[92:95], a[28:31], a[240:243], v[92:95]
buffer_load_dwordx4 v1, s[8:11], s60 offen offset:0 sc1 lds
v_mfma_f32_16x16x32_bf16 v[96:99], a[28:31], a[244:247], v[96:99]
v_mfma_f32_16x16x32_bf16 v[100:103], a[32:35], a[240:243], v[100:103]
v_mul_f32 v136, v136, v196
v_mfma_f32_16x16x32_bf16 v[104:107], a[32:35], a[244:247], v[104:107]
s_waitcnt vmcnt(23) lgkmcnt(0)
s_barrier
v_mfma_f32_16x16x32_bf16 v[36:39], a[36:39], a[248:251], v[36:39]
ds_read_b128 a[0:3], v201 offset:18432
buffer_load_dwordx4 v1, s[8:11], s60 offen offset:1024 sc1 lds
v_mfma_f32_16x16x32_bf16 v[40:43], a[36:39], a[252:255], v[40:43]
ds_read_b128 a[4:7], v201 offset:19456
v_mul_f32 v137, v137, v197
v_mfma_f32_16x16x32_bf16 v[44:47], a[40:43], a[248:251], v[44:47]
ds_read_b128 a[8:11], v201 offset:20480
v_mul_f32 v138, v138, v198
v_mfma_f32_16x16x32_bf16 v[48:51], a[40:43], a[252:255], v[48:51]
ds_read_b128 a[12:15], v201 offset:21504
v_mfma_f32_16x16x32_bf16 v[52:55], a[44:47], a[248:251], v[52:55]
ds_read_b128 a[16:19], v201 offset:22528
buffer_load_dwordx4 v1, s[8:11], s60 offen offset:2048 sc1 lds
v_mfma_f32_16x16x32_bf16 v[56:59], a[44:47], a[252:255], v[56:59]
ds_read_b128 a[20:23], v201 offset:23552
v_mul_f32 v139, v139, v199
v_mfma_f32_16x16x32_bf16 v[60:63], a[48:51], a[248:251], v[60:63]
ds_read_b128 a[24:27], v201 offset:24576
v_mfma_f32_16x16x32_bf16 v[64:67], a[48:51], a[252:255], v[64:67]
ds_read_b128 a[28:31], v201 offset:25600
v_mul_f32 v192, v140, v140
v_mfma_f32_16x16x32_bf16 v[68:71], a[52:55], a[248:251], v[68:71]
ds_read_b128 a[32:35], v201 offset:26624
buffer_load_dwordx4 v1, s[8:11], s60 offen offset:3072 sc1 lds
v_mfma_f32_16x16x32_bf16 v[72:75], a[52:55], a[252:255], v[72:75]
v_mfma_f32_16x16x32_bf16 v[76:79], a[56:59], a[248:251], v[76:79]
v_mul_f32 v193, v141, v141
v_mfma_f32_16x16x32_bf16 v[80:83], a[56:59], a[252:255], v[80:83]
v_mfma_f32_16x16x32_bf16 v[84:87], a[60:63], a[248:251], v[84:87]
buffer_load_dwordx4 a[176:179], v1, s[4:7], s52 offen offset:2048 sc1
v_mul_f32 v194, v142, v142
v_mfma_f32_16x16x32_bf16 v[88:91], a[60:63], a[252:255], v[88:91]
v_mfma_f32_16x16x32_bf16 v[92:95], a[64:67], a[248:251], v[92:95]
v_mul_f32 v195, v143, v143
v_mfma_f32_16x16x32_bf16 v[96:99], a[64:67], a[252:255], v[96:99]
v_mfma_f32_16x16x32_bf16 v[100:103], a[68:71], a[248:251], v[100:103]
v_mfma_f32_16x16x32_bf16 v[104:107], a[68:71], a[252:255], v[104:107]
v_fma_f32 v192, v192, v252, v250
s_waitcnt lgkmcnt(0)
v_mfma_f32_16x16x32_bf16 v[36:39], a[0:3], a[80:83], v[36:39]
ds_read_b128 a[36:39], v201 offset:27648
buffer_load_dwordx4 a[180:183], v9, s[4:7], s52 offen offset:2048 sc1
v_mfma_f32_16x16x32_bf16 v[40:43], a[0:3], a[84:87], v[40:43]
ds_read_b128 a[40:43], v201 offset:28672
v_fma_f32 v193, v193, v252, v250
v_mfma_f32_16x16x32_bf16 v[44:47], a[4:7], a[80:83], v[44:47]
ds_read_b128 a[44:47], v201 offset:29696
buffer_load_dwordx4 a[184:187], v1, s[4:7], s52 offen offset:3072 sc1
v_mfma_f32_16x16x32_bf16 v[48:51], a[4:7], a[84:87], v[48:51]
ds_read_b128 a[48:51], v201 offset:30720
v_fma_f32 v194, v194, v252, v250
v_mfma_f32_16x16x32_bf16 v[52:55], a[8:11], a[80:83], v[52:55]
ds_read_b128 a[52:55], v201 offset:31744
buffer_load_dwordx4 a[188:191], v9, s[4:7], s52 offen offset:3072 sc1
v_mfma_f32_16x16x32_bf16 v[56:59], a[8:11], a[84:87], v[56:59]
ds_read_b128 a[56:59], v201 offset:32768
v_mfma_f32_16x16x32_bf16 v[60:63], a[12:15], a[80:83], v[60:63]
ds_read_b128 a[60:63], v201 offset:33792
v_fma_f32 v195, v195, v252, v250
v_mfma_f32_16x16x32_bf16 v[64:67], a[12:15], a[84:87], v[64:67]
ds_read_b128 a[64:67], v201 offset:34816
v_mfma_f32_16x16x32_bf16 v[68:71], a[16:19], a[80:83], v[68:71]
ds_read_b128 a[68:71], v201 offset:35840
v_mul_f32 v192, v192, v140
v_mfma_f32_16x16x32_bf16 v[72:75], a[16:19], a[84:87], v[72:75]
s_cmp_eq_u32 s25, 5
s_cselect_b32 s98, 4096, 0
v_mfma_f32_16x16x32_bf16 v[76:79], a[20:23], a[80:83], v[76:79]
s_add_u32 s52, s52, s98
v_mul_f32 v193, v193, v141
v_mfma_f32_16x16x32_bf16 v[80:83], a[20:23], a[84:87], v[80:83]
s_add_u32 s52, s52, 4096
v_mfma_f32_16x16x32_bf16 v[84:87], a[24:27], a[80:83], v[84:87]
v_mfma_f32_16x16x32_bf16 v[88:91], a[24:27], a[84:87], v[88:91]
v_mul_f32 v194, v194, v142
v_mfma_f32_16x16x32_bf16 v[92:95], a[28:31], a[80:83], v[92:95]
buffer_load_dwordx4 a[192:195], v1, s[4:7], s52 offen offset:0 sc1
v_mfma_f32_16x16x32_bf16 v[96:99], a[28:31], a[84:87], v[96:99]
v_mul_f32 v195, v195, v143
v_mfma_f32_16x16x32_bf16 v[100:103], a[32:35], a[80:83], v[100:103]
v_mfma_f32_16x16x32_bf16 v[104:107], a[32:35], a[84:87], v[104:107]
s_waitcnt vmcnt(22) lgkmcnt(0)
s_barrier
v_mfma_f32_16x16x32_bf16 v[36:39], a[36:39], a[88:91], v[36:39]
ds_read_b128 a[0:3], v202 offset:0
buffer_load_dwordx4 a[196:199], v9, s[4:7], s52 offen offset:0 sc1
v_mfma_f32_16x16x32_bf16 v[40:43], a[36:39], a[92:95], v[40:43]
ds_read_b128 a[4:7], v202 offset:1024
buffer_load_dwordx4 a[200:203], v1, s[4:7], s52 offen offset:1024 sc1
v_mfma_f32_16x16x32_bf16 v[44:47], a[40:43], a[88:91], v[44:47]
ds_read_b128 a[8:11], v202 offset:2048
v_mfma_f32_16x16x32_bf16 v[48:51], a[40:43], a[92:95], v[48:51]
ds_read_b128 a[12:15], v202 offset:3072
buffer_load_dwordx4 a[204:207], v9, s[4:7], s52 offen offset:1024 sc1
v_mfma_f32_16x16x32_bf16 v[52:55], a[44:47], a[88:91], v[52:55]
ds_read_b128 a[16:19], v202 offset:4096
v_mfma_f32_16x16x32_bf16 v[56:59], a[44:47], a[92:95], v[56:59]
ds_read_b128 a[20:23], v202 offset:5120
v_mfma_f32_16x16x32_bf16 v[60:63], a[48:51], a[88:91], v[60:63]
ds_read_b128 a[24:27], v202 offset:6144
v_mfma_f32_16x16x32_bf16 v[64:67], a[48:51], a[92:95], v[64:67]
ds_read_b128 a[28:31], v202 offset:7168
v_mfma_f32_16x16x32_bf16 v[68:71], a[52:55], a[88:91], v[68:71]
ds_read_b128 a[32:35], v202 offset:8192
v_mfma_f32_16x16x32_bf16 v[72:75], a[52:55], a[92:95], v[72:75]
s_cmp_eq_u32 s25, 4
s_cselect_b32 s99, 36864, 0
s_add_u32 s60, s60, s99
v_mfma_f32_16x16x32_bf16 v[76:79], a[56:59], a[88:91], v[76:79]
s_add_u32 s61, s61, s99
v_exp_f32 v192, v192
v_mfma_f32_16x16x32_bf16 v[80:83], a[56:59], a[92:95], v[80:83]
s_add_u32 m0, s62, 90112
v_exp_f32 v193, v193
v_mfma_f32_16x16x32_bf16 v[84:87], a[60:63], a[88:91], v[84:87]
s_add_u32 s60, s60, 16384
v_exp_f32 v194, v194
v_mfma_f32_16x16x32_bf16 v[88:91], a[60:63], a[92:95], v[88:91]
v_mfma_f32_16x16x32_bf16 v[92:95], a[64:67], a[88:91], v[92:95]
v_exp_f32 v195, v195
v_mfma_f32_16x16x32_bf16 v[96:99], a[64:67], a[92:95], v[96:99]
buffer_load_dwordx4 v1, s[8:11], s60 offen offset:0 sc1 lds
v_mfma_f32_16x16x32_bf16 v[100:103], a[68:71], a[88:91], v[100:103]
v_mfma_f32_16x16x32_bf16 v[104:107], a[68:71], a[92:95], v[104:107]
s_waitcnt lgkmcnt(0)
v_mfma_f32_16x16x32_bf16 v[36:39], a[0:3], a[96:99], v[36:39]
ds_read_b128 a[36:39], v202 offset:9216
buffer_load_dwordx4 v1, s[8:11], s60 offen offset:1024 sc1 lds
v_mfma_f32_16x16x32_bf16 v[40:43], a[0:3], a[100:103], v[40:43]
ds_read_b128 a[40:43], v202 offset:10240
v_fma_f32 v192, v192, v254, v254
v_mfma_f32_16x16x32_bf16 v[44:47], a[4:7], a[96:99], v[44:47]
ds_read_b128 a[44:47], v202 offset:11264
buffer_load_dwordx4 v1, s[8:11], s60 offen offset:2048 sc1 lds
v_mfma_f32_16x16x32_bf16 v[48:51], a[4:7], a[100:103], v[48:51]
ds_read_b128 a[48:51], v202 offset:12288
v_fma_f32 v193, v193, v254, v254
v_mfma_f32_16x16x32_bf16 v[52:55], a[8:11], a[96:99], v[52:55]
ds_read_b128 a[52:55], v202 offset:13312
v_mfma_f32_16x16x32_bf16 v[56:59], a[8:11], a[100:103], v[56:59]
ds_read_b128 a[56:59], v202 offset:14336
buffer_load_dwordx4 v1, s[8:11], s60 offen offset:3072 sc1 lds
v_mfma_f32_16x16x32_bf16 v[60:63], a[12:15], a[96:99], v[60:63]
ds_read_b128 a[60:63], v202 offset:15360
v_fma_f32 v194, v194, v254, v254
v_mfma_f32_16x16x32_bf16 v[64:67], a[12:15], a[100:103], v[64:67]
ds_read_b128 a[64:67], v202 offset:16384
v_fma_f32 v195, v195, v254, v254
v_mfma_f32_16x16x32_bf16 v[68:71], a[16:19], a[96:99], v[68:71]
ds_read_b128 a[68:71], v202 offset:17408
s_add_u32 m0, s63, 106496
v_mfma_f32_16x16x32_bf16 v[72:75], a[16:19], a[100:103], v[72:75]
s_add_u32 s61, s61, 36864
v_mfma_f32_16x16x32_bf16 v[76:79], a[20:23], a[96:99], v[76:79]
v_rcp_f32 v192, v192
v_mfma_f32_16x16x32_bf16 v[80:83], a[20:23], a[100:103], v[80:83]
v_mfma_f32_16x16x32_bf16 v[84:87], a[24:27], a[96:99], v[84:87]
v_mfma_f32_16x16x32_bf16 v[88:91], a[24:27], a[100:103], v[88:91]
v_mfma_f32_16x16x32_bf16 v[92:95], a[28:31], a[96:99], v[92:95]
buffer_load_dwordx4 v1, s[8:11], s61 offen offset:0 sc1 lds
v_mfma_f32_16x16x32_bf16 v[96:99], a[28:31], a[100:103], v[96:99]
v_rcp_f32 v193, v193
v_mfma_f32_16x16x32_bf16 v[100:103], a[32:35], a[96:99], v[100:103]
v_mfma_f32_16x16x32_bf16 v[104:107], a[32:35], a[100:103], v[104:107]
s_waitcnt lgkmcnt(0)
v_mfma_f32_16x16x32_bf16 v[36:39], a[36:39], a[104:107], v[36:39]
ds_read_b128 a[0:3], v202 offset:18432
s_add_u32 m0, s62, 110592
v_mfma_f32_16x16x32_bf16 v[40:43], a[36:39], a[108:111], v[40:43]
ds_read_b128 a[4:7], v202 offset:19456
v_mfma_f32_16x16x32_bf16 v[44:47], a[40:43], a[104:107], v[44:47]
ds_read_b128 a[8:11], v202 offset:20480
s_add_u32 s60, s60, 20480
v_mfma_f32_16x16x32_bf16 v[48:51], a[40:43], a[108:111], v[48:51]
ds_read_b128 a[12:15], v202 offset:21504
v_mfma_f32_16x16x32_bf16 v[52:55], a[44:47], a[104:107], v[52:55]
ds_read_b128 a[16:19], v202 offset:22528
v_mfma_f32_16x16x32_bf16 v[56:59], a[44:47], a[108:111], v[56:59]
ds_read_b128 a[20:23], v202 offset:23552
buffer_load_dwordx4 v1, s[8:11], s60 offen offset:0 sc1 lds
v_mfma_f32_16x16x32_bf16 v[60:63], a[48:51], a[104:107], v[60:63]
ds_read_b128 a[24:27], v202 offset:24576
v_mfma_f32_16x16x32_bf16 v[64:67], a[48:51], a[108:111], v[64:67]
ds_read_b128 a[28:31], v202 offset:25600
v_mfma_f32_16x16x32_bf16 v[68:71], a[52:55], a[104:107], v[68:71]
ds_read_b128 a[32:35], v202 offset:26624
buffer_load_dwordx4 v1, s[8:11], s60 offen offset:1024 sc1 lds
v_mfma_f32_16x16x32_bf16 v[72:75], a[52:55], a[108:111], v[72:75]
v_rcp_f32 v194, v194
v_mfma_f32_16x16x32_bf16 v[76:79], a[56:59], a[104:107], v[76:79]
v_rcp_f32 v195, v195
v_mfma_f32_16x16x32_bf16 v[80:83], a[56:59], a[108:111], v[80:83]
buffer_load_dwordx4 v1, s[8:11], s60 offen offset:2048 sc1 lds
v_mul_f32 v140, v140, v192
v_mfma_f32_16x16x32_bf16 v[84:87], a[60:63], a[104:107], v[84:87]
v_mfma_f32_16x16x32_bf16 v[88:91], a[60:63], a[108:111], v[88:91]
v_mul_f32 v141, v141, v193
v_mfma_f32_16x16x32_bf16 v[92:95], a[64:67], a[104:107], v[92:95]
buffer_load_dwordx4 v1, s[8:11], s60 offen offset:3072 sc1 lds
v_mfma_f32_16x16x32_bf16 v[96:99], a[64:67], a[108:111], v[96:99]
v_mul_f32 v142, v142, v194
v_mfma_f32_16x16x32_bf16 v[100:103], a[68:71], a[104:107], v[100:103]
v_mfma_f32_16x16x32_bf16 v[104:107], a[68:71], a[108:111], v[104:107]
s_waitcnt lgkmcnt(0)
v_mfma_f32_16x16x32_bf16 v[36:39], a[0:3], a[112:115], v[36:39]
ds_read_b128 a[36:39], v202 offset:27648
buffer_load_dwordx4 a[208:211], v1, s[4:7], s52 offen offset:2048 sc1
v_mfma_f32_16x16x32_bf16 v[40:43], a[0:3], a[116:119], v[40:43]
ds_read_b128 a[40:43], v202 offset:28672
v_mul_f32 v143, v143, v195
v_mfma_f32_16x16x32_bf16 v[44:47], a[4:7], a[112:115], v[44:47]
ds_read_b128 a[44:47], v202 offset:29696
v_mul_f32 v196, v144, v144
v_mfma_f32_16x16x32_bf16 v[48:51], a[4:7], a[116:119], v[48:51]
ds_read_b128 a[48:51], v202 offset:30720
v_mfma_f32_16x16x32_bf16 v[52:55], a[8:11], a[112:115], v[52:55]
ds_read_b128 a[52:55], v202 offset:31744
buffer_load_dwordx4 a[212:215], v9, s[4:7], s52 offen offset:2048 sc1
v_mfma_f32_16x16x32_bf16 v[56:59], a[8:11], a[116:119], v[56:59]
ds_read_b128 a[56:59], v202 offset:32768
v_mul_f32 v197, v145, v145
v_mfma_f32_16x16x32_bf16 v[60:63], a[12:15], a[112:115], v[60:63]
ds_read_b128 a[60:63], v202 offset:33792
v_mfma_f32_16x16x32_bf16 v[64:67], a[12:15], a[116:119], v[64:67]
ds_read_b128 a[64:67], v202 offset:34816
v_mul_f32 v198, v146, v146
v_mfma_f32_16x16x32_bf16 v[68:71], a[16:19], a[112:115], v[68:71]
ds_read_b128 a[68:71], v202 offset:35840
buffer_load_dwordx4 a[216:219], v1, s[4:7], s52 offen offset:3072 sc1
v_mfma_f32_16x16x32_bf16 v[72:75], a[16:19], a[116:119], v[72:75]
v_mul_f32 v199, v147, v147
v_mfma_f32_16x16x32_bf16 v[76:79], a[20:23], a[112:115], v[76:79]
v_mfma_f32_16x16x32_bf16 v[80:83], a[20:23], a[116:119], v[80:83]
v_fma_f32 v196, v196, v253, v251
v_mfma_f32_16x16x32_bf16 v[84:87], a[24:27], a[112:115], v[84:87]
buffer_load_dwordx4 a[220:223], v9, s[4:7], s52 offen offset:3072 sc1
v_mfma_f32_16x16x32_bf16 v[88:91], a[24:27], a[116:119], v[88:91]
v_mfma_f32_16x16x32_bf16 v[92:95], a[28:31], a[112:115], v[92:95]
v_fma_f32 v197, v197, v253, v251
v_mfma_f32_16x16x32_bf16 v[96:99], a[28:31], a[116:119], v[96:99]
v_mfma_f32_16x16x32_bf16 v[100:103], a[32:35], a[112:115], v[100:103]
v_fma_f32 v198, v198, v253, v251
v_mfma_f32_16x16x32_bf16 v[104:107], a[32:35], a[116:119], v[104:107]
s_waitcnt vmcnt(21) lgkmcnt(0)
s_barrier
v_mfma_f32_16x16x32_bf16 v[36:39], a[36:39], a[120:123], v[36:39]
ds_read_b128 a[0:3], v200 offset:0
v_mfma_f32_16x16x32_bf16 v[40:43], a[36:39], a[124:127], v[40:43]
ds_read_b128 a[4:7], v200 offset:1024
v_fma_f32 v199, v199, v253, v251
v_mfma_f32_16x16x32_bf16 v[44:47], a[40:43], a[120:123], v[44:47]
ds_read_b128 a[8:11], v200 offset:2048
v_mfma_f32_16x16x32_bf16 v[48:51], a[40:43], a[124:127], v[48:51]
ds_read_b128 a[12:15], v200 offset:3072
v_mul_f32 v196, v196, v144
v_mfma_f32_16x16x32_bf16 v[52:55], a[44:47], a[120:123], v[52:55]
ds_read_b128 a[16:19], v200 offset:4096
v_mfma_f32_16x16x32_bf16 v[56:59], a[44:47], a[124:127], v[56:59]
ds_read_b128 a[20:23], v200 offset:5120
v_mul_f32 v197, v197, v145
v_mfma_f32_16x16x32_bf16 v[60:63], a[48:51], a[120:123], v[60:63]
ds_read_b128 a[24:27], v200 offset:6144
v_mfma_f32_16x16x32_bf16 v[64:67], a[48:51], a[124:127], v[64:67]
ds_read_b128 a[28:31], v200 offset:7168
v_mfma_f32_16x16x32_bf16 v[68:71], a[52:55], a[120:123], v[68:71]
ds_read_b128 a[32:35], v200 offset:8192
v_mul_f32 v198, v198, v146
v_mfma_f32_16x16x32_bf16 v[72:75], a[52:55], a[124:127], v[72:75]
s_cmp_eq_u32 s25, 5
s_cselect_b32 s99, 36864, 0
s_add_u32 s60, s60, s99
v_mfma_f32_16x16x32_bf16 v[76:79], a[56:59], a[120:123], v[76:79]
s_add_u32 s61, s61, s99
s_add_u32 m0, s62, 126976
s_add_u32 s60, s60, 16384
v_mfma_f32_16x16x32_bf16 v[80:83], a[56:59], a[124:127], v[80:83]
buffer_load_dwordx4 v1, s[8:11], s60 offen offset:0 sc1 lds
v_mul_f32 v199, v199, v147
v_mfma_f32_16x16x32_bf16 v[84:87], a[60:63], a[120:123], v[84:87]
buffer_load_dwordx4 v1, s[8:11], s60 offen offset:1024 sc1 lds
v_mfma_f32_16x16x32_bf16 v[88:91], a[60:63], a[124:127], v[88:91]
buffer_load_dwordx4 v1, s[8:11], s60 offen offset:2048 sc1 lds
v_mfma_f32_16x16x32_bf16 v[92:95], a[64:67], a[120:123], v[92:95]
v_exp_f32 v196, v196
v_mfma_f32_16x16x32_bf16 v[96:99], a[64:67], a[124:127], v[96:99]
buffer_load_dwordx4 v1, s[8:11], s60 offen offset:3072 sc1 lds
v_mfma_f32_16x16x32_bf16 v[100:103], a[68:71], a[120:123], v[100:103]
v_mfma_f32_16x16x32_bf16 v[104:107], a[68:71], a[124:127], v[104:107]
s_waitcnt lgkmcnt(0)
v_mfma_f32_16x16x32_bf16 v[36:39], a[0:3], a[128:131], v[36:39]
ds_read_b128 a[36:39], v200 offset:9216
s_add_u32 m0, s63, 143360
v_mfma_f32_16x16x32_bf16 v[40:43], a[0:3], a[132:135], v[40:43]
ds_read_b128 a[40:43], v200 offset:10240
v_mfma_f32_16x16x32_bf16 v[44:47], a[4:7], a[128:131], v[44:47]
ds_read_b128 a[44:47], v200 offset:11264
s_add_u32 s61, s61, 36864
v_mfma_f32_16x16x32_bf16 v[48:51], a[4:7], a[132:135], v[48:51]
ds_read_b128 a[48:51], v200 offset:12288
v_mfma_f32_16x16x32_bf16 v[52:55], a[8:11], a[128:131], v[52:55]
ds_read_b128 a[52:55], v200 offset:13312
buffer_load_dwordx4 v1, s[8:11], s61 offen offset:0 sc1 lds
v_mfma_f32_16x16x32_bf16 v[56:59], a[8:11], a[132:135], v[56:59]
ds_read_b128 a[56:59], v200 offset:14336
v_mfma_f32_16x16x32_bf16 v[60:63], a[12:15], a[128:131], v[60:63]
ds_read_b128 a[60:63], v200 offset:15360
s_add_u32 m0, s62, 147456
v_mfma_f32_16x16x32_bf16 v[64:67], a[12:15], a[132:135], v[64:67]
ds_read_b128 a[64:67], v200 offset:16384
v_mfma_f32_16x16x32_bf16 v[68:71], a[16:19], a[128:131], v[68:71]
ds_read_b128 a[68:71], v200 offset:17408
s_add_u32 s60, s60, 20480
v_mfma_f32_16x16x32_bf16 v[72:75], a[16:19], a[132:135], v[72:75]
v_exp_f32 v197, v197
v_mfma_f32_16x16x32_bf16 v[76:79], a[20:23], a[128:131], v[76:79]
buffer_load_dwordx4 v1, s[8:11], s60 offen offset:0 sc1 lds
v_mfma_f32_16x16x32_bf16 v[80:83], a[20:23], a[132:135], v[80:83]
v_exp_f32 v198, v198
v_mfma_f32_16x16x32_bf16 v[84:87], a[24:27], a[128:131], v[84:87]
buffer_load_dwordx4 v1, s[8:11], s60 offen offset:1024 sc1 lds
v_mfma_f32_16x16x32_bf16 v[88:91], a[24:27], a[132:135], v[88:91]
v_exp_f32 v199, v199
v_mfma_f32_16x16x32_bf16 v[92:95], a[28:31], a[128:131], v[92:95]
buffer_load_dwordx4 v1, s[8:11], s60 offen offset:2048 sc1 lds
v_fma_f32 v196, v196, v255, v255
v_mfma_f32_16x16x32_bf16 v[96:99], a[28:31], a[132:135], v[96:99]
v_mfma_f32_16x16x32_bf16 v[100:103], a[32:35], a[128:131], v[100:103]
v_fma_f32 v197, v197, v255, v255
v_mfma_f32_16x16x32_bf16 v[104:107], a[32:35], a[132:135], v[104:107]
s_waitcnt lgkmcnt(0)
v_mfma_f32_16x16x32_bf16 v[36:39], a[36:39], a[136:139], v[36:39]
ds_read_b128 a[0:3], v200 offset:18432
buffer_load_dwordx4 v1, s[8:11], s60 offen offset:3072 sc1 lds
v_mfma_f32_16x16x32_bf16 v[40:43], a[36:39], a[140:143], v[40:43]
ds_read_b128 a[4:7], v200 offset:19456
v_fma_f32 v198, v198, v255, v255
v_mfma_f32_16x16x32_bf16 v[44:47], a[40:43], a[136:139], v[44:47]
ds_read_b128 a[8:11], v200 offset:20480
v_fma_f32 v199, v199, v255, v255
v_mfma_f32_16x16x32_bf16 v[48:51], a[40:43], a[140:143], v[48:51]
ds_read_b128 a[12:15], v200 offset:21504
v_mfma_f32_16x16x32_bf16 v[52:55], a[44:47], a[136:139], v[52:55]
ds_read_b128 a[16:19], v200 offset:22528
v_mfma_f32_16x16x32_bf16 v[56:59], a[44:47], a[140:143], v[56:59]
ds_read_b128 a[20:23], v200 offset:23552
v_mfma_f32_16x16x32_bf16 v[60:63], a[48:51], a[136:139], v[60:63]
ds_read_b128 a[24:27], v200 offset:24576
v_mfma_f32_16x16x32_bf16 v[64:67], a[48:51], a[140:143], v[64:67]
ds_read_b128 a[28:31], v200 offset:25600
v_mfma_f32_16x16x32_bf16 v[68:71], a[52:55], a[136:139], v[68:71]
ds_read_b128 a[32:35], v200 offset:26624
v_mfma_f32_16x16x32_bf16 v[72:75], a[52:55], a[140:143], v[72:75]
s_cmp_eq_u32 s25, 6
s_cselect_b32 s98, 4096, 0
s_add_u32 s52, s52, s98
v_mfma_f32_16x16x32_bf16 v[76:79], a[56:59], a[136:139], v[76:79]
s_add_u32 s52, s52, 4096
v_rcp_f32 v196, v196
v_mfma_f32_16x16x32_bf16 v[80:83], a[56:59], a[140:143], v[80:83]
buffer_load_dwordx4 a[224:227], v1, s[4:7], s52 offen offset:0 sc1
v_mfma_f32_16x16x32_bf16 v[84:87], a[60:63], a[136:139], v[84:87]
buffer_load_dwordx4 a[228:231], v9, s[4:7], s52 offen offset:0 sc1
v_mfma_f32_16x16x32_bf16 v[88:91], a[60:63], a[140:143], v[88:91]
v_rcp_f32 v197, v197
v_mfma_f32_16x16x32_bf16 v[92:95], a[64:67], a[136:139], v[92:95]
buffer_load_dwordx4 a[232:235], v1, s[4:7], s52 offen offset:1024 sc1
v_mfma_f32_16x16x32_bf16 v[96:99], a[64:67], a[140:143], v[96:99]
v_rcp_f32 v198, v198
v_mfma_f32_16x16x32_bf16 v[100:103], a[68:71], a[136:139], v[100:103]
v_mfma_f32_16x16x32_bf16 v[104:107], a[68:71], a[140:143], v[104:107]
s_waitcnt lgkmcnt(0)
v_mfma_f32_16x16x32_bf16 v[36:39], a[0:3], a[144:147], v[36:39]
ds_read_b128 a[36:39], v200 offset:27648
buffer_load_dwordx4 a[236:239], v9, s[4:7], s52 offen offset:1024 sc1
v_mfma_f32_16x16x32_bf16 v[40:43], a[0:3], a[148:151], v[40:43]
ds_read_b128 a[40:43], v200 offset:28672
v_mfma_f32_16x16x32_bf16 v[44:47], a[4:7], a[144:147], v[44:47]
ds_read_b128 a[44:47], v200 offset:29696
v_mfma_f32_16x16x32_bf16 v[48:51], a[4:7], a[148:151], v[48:51]
ds_read_b128 a[48:51], v200 offset:30720
v_mfma_f32_16x16x32_bf16 v[52:55], a[8:11], a[144:147], v[52:55]
ds_read_b128 a[52:55], v200 offset:31744
buffer_load_dwordx4 a[240:243], v1, s[4:7], s52 offen offset:2048 sc1
v_mfma_f32_16x16x32_bf16 v[56:59], a[8:11], a[148:151], v[56:59]
ds_read_b128 a[56:59], v200 offset:32768
v_mfma_f32_16x16x32_bf16 v[60:63], a[12:15], a[144:147], v[60:63]
ds_read_b128 a[60:63], v200 offset:33792
v_mfma_f32_16x16x32_bf16 v[64:67], a[12:15], a[148:151], v[64:67]
ds_read_b128 a[64:67], v200 offset:34816
v_mfma_f32_16x16x32_bf16 v[68:71], a[16:19], a[144:147], v[68:71]
ds_read_b128 a[68:71], v200 offset:35840
buffer_load_dwordx4 a[244:247], v9, s[4:7], s52 offen offset:2048 sc1
v_mfma_f32_16x16x32_bf16 v[72:75], a[16:19], a[148:151], v[72:75]
v_rcp_f32 v199, v199
v_mfma_f32_16x16x32_bf16 v[76:79], a[20:23], a[144:147], v[76:79]
v_mul_f32 v144, v144, v196
v_mul_f32 v145, v145, v197
v_mfma_f32_16x16x32_bf16 v[80:83], a[20:23], a[148:151], v[80:83]
v_mul_f32 v146, v146, v198
v_mfma_f32_16x16x32_bf16 v[84:87], a[24:27], a[144:147], v[84:87]
buffer_load_dwordx4 a[248:251], v1, s[4:7], s52 offen offset:3072 sc1
v_mfma_f32_16x16x32_bf16 v[88:91], a[24:27], a[148:151], v[88:91]
v_mul_f32 v147, v147, v199
v_mfma_f32_16x16x32_bf16 v[92:95], a[28:31], a[144:147], v[92:95]
v_mfma_f32_16x16x32_bf16 v[96:99], a[28:31], a[148:151], v[96:99]
v_mul_f32 v192, v148, v148
v_mfma_f32_16x16x32_bf16 v[100:103], a[32:35], a[144:147], v[100:103]
v_mfma_f32_16x16x32_bf16 v[104:107], a[32:35], a[148:151], v[104:107]
s_waitcnt vmcnt(20) lgkmcnt(0)
s_barrier
v_mfma_f32_16x16x32_bf16 v[36:39], a[36:39], a[152:155], v[36:39]
ds_read_b128 a[0:3], v201 offset:0
buffer_load_dwordx4 a[252:255], v9, s[4:7], s52 offen offset:3072 sc1
v_mfma_f32_16x16x32_bf16 v[40:43], a[36:39], a[156:159], v[40:43]
ds_read_b128 a[4:7], v201 offset:1024
v_mul_f32 v193, v149, v149
v_mfma_f32_16x16x32_bf16 v[44:47], a[40:43], a[152:155], v[44:47]
ds_read_b128 a[8:11], v201 offset:2048
v_mul_f32 v194, v150, v150
v_mfma_f32_16x16x32_bf16 v[48:51], a[40:43], a[156:159], v[48:51]
ds_read_b128 a[12:15], v201 offset:3072
v_mfma_f32_16x16x32_bf16 v[52:55], a[44:47], a[152:155], v[52:55]
ds_read_b128 a[16:19], v201 offset:4096
v_mul_f32 v195, v151, v151
v_mfma_f32_16x16x32_bf16 v[56:59], a[44:47], a[156:159], v[56:59]
ds_read_b128 a[20:23], v201 offset:5120
v_mfma_f32_16x16x32_bf16 v[60:63], a[48:51], a[152:155], v[60:63]
ds_read_b128 a[24:27], v201 offset:6144
v_fma_f32 v192, v192, v252, v250
v_mfma_f32_16x16x32_bf16 v[64:67], a[48:51], a[156:159], v[64:67]
ds_read_b128 a[28:31], v201 offset:7168
v_mfma_f32_16x16x32_bf16 v[68:71], a[52:55], a[152:155], v[68:71]
ds_read_b128 a[32:35], v201 offset:8192
v_mfma_f32_16x16x32_bf16 v[72:75], a[52:55], a[156:159], v[72:75]
s_cmp_eq_u32 s25, 6
s_cselect_b32 s99, 36864, 0
s_add_u32 s60, s60, s99
v_mfma_f32_16x16x32_bf16 v[76:79], a[56:59], a[152:155], v[76:79]
s_add_u32 s61, s61, s99
s_add_u32 m0, s62, 53248
s_add_u32 s60, s60, 16384
v_mfma_f32_16x16x32_bf16 v[80:83], a[56:59], a[156:159], v[80:83]
buffer_load_dwordx4 v1, s[8:11], s60 offen offset:0 sc1 lds
v_fma_f32 v193, v193, v252, v250
v_mfma_f32_16x16x32_bf16 v[84:87], a[60:63], a[152:155], v[84:87]
v_fma_f32 v194, v194, v252, v250
v_mfma_f32_16x16x32_bf16 v[88:91], a[60:63], a[156:159], v[88:91]
buffer_load_dwordx4 v1, s[8:11], s60 offen offset:1024 sc1 lds
v_fma_f32 v195, v195, v252, v250
v_mfma_f32_16x16x32_bf16 v[92:95], a[64:67], a[152:155], v[92:95]
v_mfma_f32_16x16x32_bf16 v[96:99], a[64:67], a[156:159], v[96:99]
buffer_load_dwordx4 v1, s[8:11], s60 offen offset:2048 sc1 lds
v_mfma_f32_16x16x32_bf16 v[100:103], a[68:71], a[152:155], v[100:103]
v_mul_f32 v192, v192, v148
v_mfma_f32_16x16x32_bf16 v[104:107], a[68:71], a[156:159], v[104:107]
s_waitcnt lgkmcnt(0)
v_mfma_f32_16x16x32_bf16 v[36:39], a[0:3], a[160:163], v[36:39]
ds_read_b128 a[36:39], v201 offset:9216
buffer_load_dwordx4 v1, s[8:11], s60 offen offset:3072 sc1 lds
v_mfma_f32_16x16x32_bf16 v[40:43], a[0:3], a[164:167], v[40:43]
ds_read_b128 a[40:43], v201 offset:10240
v_mul_f32 v193, v193, v149
v_mfma_f32_16x16x32_bf16 v[44:47], a[4:7], a[160:163], v[44:47]
ds_read_b128 a[44:47], v201 offset:11264
s_add_u32 m0, s63, 69632
v_mfma_f32_16x16x32_bf16 v[48:51], a[4:7], a[164:167], v[48:51]
ds_read_b128 a[48:51], v201 offset:12288
v_mul_f32 v194, v194, v150
v_mfma_f32_16x16x32_bf16 v[52:55], a[8:11], a[160:163], v[52:55]
ds_read_b128 a[52:55], v201 offset:13312
s_add_u32 s61, s61, 36864
v_mfma_f32_16x16x32_bf16 v[56:59], a[8:11], a[164:167], v[56:59]
ds_read_b128 a[56:59], v201 offset:14336
v_mul_f32 v195, v195, v151
v_mfma_f32_16x16x32_bf16 v[60:63], a[12:15], a[160:163], v[60:63]
ds_read_b128 a[60:63], v201 offset:15360
buffer_load_dwordx4 v1, s[8:11], s61 offen offset:0 sc1 lds
v_mfma_f32_16x16x32_bf16 v[64:67], a[12:15], a[164:167], v[64:67]
ds_read_b128 a[64:67], v201 offset:16384
v_mfma_f32_16x16x32_bf16 v[68:71], a[16:19], a[160:163], v[68:71]
ds_read_b128 a[68:71], v201 offset:17408
s_add_u32 m0, s62, 73728
v_mfma_f32_16x16x32_bf16 v[72:75], a[16:19], a[164:167], v[72:75]
s_add_u32 s60, s60, 20480
v_exp_f32 v192, v192
v_mfma_f32_16x16x32_bf16 v[76:79], a[20:23], a[160:163], v[76:79]
v_mfma_f32_16x16x32_bf16 v[80:83], a[20:23], a[164:167], v[80:83]
v_mfma_f32_16x16x32_bf16 v[84:87], a[24:27], a[160:163], v[84:87]
buffer_load_dwordx4 v1, s[8:11], s60 offen offset:0 sc1 lds
v_mfma_f32_16x16x32_bf16 v[88:91], a[24:27], a[164:167], v[88:91]
v_exp_f32 v193, v193
v_mfma_f32_16x16x32_bf16 v[92:95], a[28:31], a[160:163], v[92:95]
buffer_load_dwordx4 v1, s[8:11], s60 offen offset:1024 sc1 lds
v_mfma_f32_16x16x32_bf16 v[96:99], a[28:31], a[164:167], v[96:99]
v_mfma_f32_16x16x32_bf16 v[100:103], a[32:35], a[160:163], v[100:103]
v_mfma_f32_16x16x32_bf16 v[104:107], a[32:35], a[164:167], v[104:107]
s_waitcnt lgkmcnt(0)
v_mfma_f32_16x16x32_bf16 v[36:39], a[36:39], a[168:171], v[36:39]
ds_read_b128 a[0:3], v201 offset:18432
buffer_load_dwordx4 v1, s[8:11], s60 offen offset:2048 sc1 lds
v_mfma_f32_16x16x32_bf16 v[40:43], a[36:39], a[172:175], v[40:43]
ds_read_b128 a[4:7], v201 offset:19456
v_mfma_f32_16x16x32_bf16 v[44:47], a[40:43], a[168:171], v[44:47]
ds_read_b128 a[8:11], v201 offset:20480
buffer_load_dwordx4 v1, s[8:11], s60 offen offset:3072 sc1 lds
v_mfma_f32_16x16x32_bf16 v[48:51], a[40:43], a[172:175], v[48:51]
ds_read_b128 a[12:15], v201 offset:21504
v_mfma_f32_16x16x32_bf16 v[52:55], a[44:47], a[168:171], v[52:55]
ds_read_b128 a[16:19], v201 offset:22528
v_mfma_f32_16x16x32_bf16 v[56:59], a[44:47], a[172:175], v[56:59]
ds_read_b128 a[20:23], v201 offset:23552
v_mfma_f32_16x16x32_bf16 v[60:63], a[48:51], a[168:171], v[60:63]
ds_read_b128 a[24:27], v201 offset:24576
v_mfma_f32_16x16x32_bf16 v[64:67], a[48:51], a[172:175], v[64:67]
ds_read_b128 a[28:31], v201 offset:25600
v_mfma_f32_16x16x32_bf16 v[68:71], a[52:55], a[168:171], v[68:71]
ds_read_b128 a[32:35], v201 offset:26624
v_mfma_f32_16x16x32_bf16 v[72:75], a[52:55], a[172:175], v[72:75]
s_cmp_eq_u32 s25, 7
s_cselect_b32 s98, 4096, 0
s_add_u32 s52, s52, s98
v_mfma_f32_16x16x32_bf16 v[76:79], a[56:59], a[168:171], v[76:79]
s_add_u32 s52, s52, 4096
v_exp_f32 v194, v194
v_mfma_f32_16x16x32_bf16 v[80:83], a[56:59], a[172:175], v[80:83]
v_exp_f32 v195, v195
v_mfma_f32_16x16x32_bf16 v[84:87], a[60:63], a[168:171], v[84:87]
buffer_load_dwordx4 a[80:83], v1, s[4:7], s52 offen offset:0 sc1
v_fma_f32 v192, v192, v254, v254
v_mfma_f32_16x16x32_bf16 v[88:91], a[60:63], a[172:175], v[88:91]
v_fma_f32 v193, v193, v254, v254
v_fma_f32 v194, v194, v254, v254
v_mfma_f32_16x16x32_bf16 v[92:95], a[64:67], a[168:171], v[92:95]
buffer_load_dwordx4 a[84:87], v9, s[4:7], s52 offen offset:0 sc1
v_mfma_f32_16x16x32_bf16 v[96:99], a[64:67], a[172:175], v[96:99]
v_fma_f32 v195, v195, v254, v254
v_mfma_f32_16x16x32_bf16 v[100:103], a[68:71], a[168:171], v[100:103]
v_mfma_f32_16x16x32_bf16 v[104:107], a[68:71], a[172:175], v[104:107]
s_waitcnt lgkmcnt(0)
v_mfma_f32_16x16x32_bf16 v[36:39], a[0:3], a[176:179], v[36:39]
ds_read_b128 a[36:39], v201 offset:27648
buffer_load_dwordx4 a[88:91], v1, s[4:7], s52 offen offset:1024 sc1
v_mfma_f32_16x16x32_bf16 v[40:43], a[0:3], a[180:183], v[40:43]
ds_read_b128 a[40:43], v201 offset:28672
v_mfma_f32_16x16x32_bf16 v[44:47], a[4:7], a[176:179], v[44:47]
ds_read_b128 a[44:47], v201 offset:29696
v_mfma_f32_16x16x32_bf16 v[48:51], a[4:7], a[180:183], v[48:51]
ds_read_b128 a[48:51], v201 offset:30720
v_mfma_f32_16x16x32_bf16 v[52:55], a[8:11], a[176:179], v[52:55]
ds_read_b128 a[52:55], v201 offset:31744
buffer_load_dwordx4 a[92:95], v9, s[4:7], s52 offen offset:1024 sc1
v_mfma_f32_16x16x32_bf16 v[56:59], a[8:11], a[180:183], v[56:59]
ds_read_b128 a[56:59], v201 offset:32768
v_mfma_f32_16x16x32_bf16 v[60:63], a[12:15], a[176:179], v[60:63]
ds_read_b128 a[60:63], v201 offset:33792
v_mfma_f32_16x16x32_bf16 v[64:67], a[12:15], a[180:183], v[64:67]
ds_read_b128 a[64:67], v201 offset:34816
v_mfma_f32_16x16x32_bf16 v[68:71], a[16:19], a[176:179], v[68:71]
ds_read_b128 a[68:71], v201 offset:35840
buffer_load_dwordx4 a[96:99], v1, s[4:7], s52 offen offset:2048 sc1
v_mfma_f32_16x16x32_bf16 v[72:75], a[16:19], a[180:183], v[72:75]
v_rcp_f32 v192, v192
v_mfma_f32_16x16x32_bf16 v[76:79], a[20:23], a[176:179], v[76:79]
v_rcp_f32 v193, v193
v_mfma_f32_16x16x32_bf16 v[80:83], a[20:23], a[180:183], v[80:83]
v_rcp_f32 v194, v194
v_mfma_f32_16x16x32_bf16 v[84:87], a[24:27], a[176:179], v[84:87]
buffer_load_dwordx4 a[100:103], v9, s[4:7], s52 offen offset:2048 sc1
v_mfma_f32_16x16x32_bf16 v[88:91], a[24:27], a[180:183], v[88:91]
v_mfma_f32_16x16x32_bf16 v[92:95], a[28:31], a[176:179], v[92:95]
v_rcp_f32 v195, v195
v_mfma_f32_16x16x32_bf16 v[96:99], a[28:31], a[180:183], v[96:99]
v_mfma_f32_16x16x32_bf16 v[100:103], a[32:35], a[176:179], v[100:103]
v_mfma_f32_16x16x32_bf16 v[104:107], a[32:35], a[180:183], v[104:107]
s_waitcnt vmcnt(23) lgkmcnt(0)
s_barrier
v_mfma_f32_16x16x32_bf16 v[36:39], a[36:39], a[184:187], v[36:39]
ds_read_b128 a[0:3], v202 offset:0
buffer_load_dwordx4 a[104:107], v1, s[4:7], s52 offen offset:3072 sc1
v_mfma_f32_16x16x32_bf16 v[40:43], a[36:39], a[188:191], v[40:43]
ds_read_b128 a[4:7], v202 offset:1024
buffer_load_dwordx4 a[108:111], v9, s[4:7], s52 offen offset:3072 sc1
v_mfma_f32_16x16x32_bf16 v[44:47], a[40:43], a[184:187], v[44:47]
ds_read_b128 a[8:11], v202 offset:2048
v_mul_f32 v148, v148, v192
v_mfma_f32_16x16x32_bf16 v[48:51], a[40:43], a[188:191], v[48:51]
ds_read_b128 a[12:15], v202 offset:3072
v_mul_f32 v149, v149, v193
v_mfma_f32_16x16x32_bf16 v[52:55], a[44:47], a[184:187], v[52:55]
ds_read_b128 a[16:19], v202 offset:4096
v_mfma_f32_16x16x32_bf16 v[56:59], a[44:47], a[188:191], v[56:59]
ds_read_b128 a[20:23], v202 offset:5120
v_mul_f32 v150, v150, v194
v_mfma_f32_16x16x32_bf16 v[60:63], a[48:51], a[184:187], v[60:63]
ds_read_b128 a[24:27], v202 offset:6144
v_mfma_f32_16x16x32_bf16 v[64:67], a[48:51], a[188:191], v[64:67]
ds_read_b128 a[28:31], v202 offset:7168
v_mul_f32 v151, v151, v195
v_mfma_f32_16x16x32_bf16 v[68:71], a[52:55], a[184:187], v[68:71]
ds_read_b128 a[32:35], v202 offset:8192
v_mfma_f32_16x16x32_bf16 v[72:75], a[52:55], a[188:191], v[72:75]
s_cmp_eq_u32 s25, 7
s_cselect_b32 s99, 36864, 0
s_add_u32 s60, s60, s99
v_mfma_f32_16x16x32_bf16 v[76:79], a[56:59], a[184:187], v[76:79]
s_add_u32 s61, s61, s99
s_add_u32 m0, s62, 90112
v_mul_f32 v196, v152, v152
v_mfma_f32_16x16x32_bf16 v[80:83], a[56:59], a[188:191], v[80:83]
s_add_u32 s60, s60, 16384
v_mfma_f32_16x16x32_bf16 v[84:87], a[60:63], a[184:187], v[84:87]
v_mul_f32 v197, v153, v153
v_mfma_f32_16x16x32_bf16 v[88:91], a[60:63], a[188:191], v[88:91]
buffer_load_dwordx4 v1, s[8:11], s60 offen offset:0 sc1 lds
v_mfma_f32_16x16x32_bf16 v[92:95], a[64:67], a[184:187], v[92:95]
v_mul_f32 v198, v154, v154
v_mfma_f32_16x16x32_bf16 v[96:99], a[64:67], a[188:191], v[96:99]
buffer_load_dwordx4 v1, s[8:11], s60 offen offset:1024 sc1 lds
v_mfma_f32_16x16x32_bf16 v[100:103], a[68:71], a[184:187], v[100:103]
v_mfma_f32_16x16x32_bf16 v[104:107], a[68:71], a[188:191], v[104:107]
v_mul_f32 v199, v155, v155
s_waitcnt lgkmcnt(0)
v_mfma_f32_16x16x32_bf16 v[36:39], a[0:3], a[192:195], v[36:39]
ds_read_b128 a[36:39], v202 offset:9216
buffer_load_dwordx4 v1, s[8:11], s60 offen offset:2048 sc1 lds
v_mfma_f32_16x16x32_bf16 v[40:43], a[0:3], a[196:199], v[40:43]
ds_read_b128 a[40:43], v202 offset:10240
v_fma_f32 v196, v196, v253, v251
v_mfma_f32_16x16x32_bf16 v[44:47], a[4:7], a[192:195], v[44:47]
ds_read_b128 a[44:47], v202 offset:11264
buffer_load_dwordx4 v1, s[8:11], s60 offen offset:3072 sc1 lds
v_mfma_f32_16x16x32_bf16 v[48:51], a[4:7], a[196:199], v[48:51]
ds_read_b128 a[48:51], v202 offset:12288
v_mfma_f32_16x16x32_bf16 v[52:55], a[8:11], a[192:195], v[52:55]
ds_read_b128 a[52:55], v202 offset:13312
s_add_u32 m0, s63, 106496
v_mfma_f32_16x16x32_bf16 v[56:59], a[8:11], a[196:199], v[56:59]
ds_read_b128 a[56:59], v202 offset:14336
v_fma_f32 v197, v197, v253, v251
v_mfma_f32_16x16x32_bf16 v[60:63], a[12:15], a[192:195], v[60:63]
ds_read_b128 a[60:63], v202 offset:15360
s_add_u32 s61, s61, 36864
v_mfma_f32_16x16x32_bf16 v[64:67], a[12:15], a[196:199], v[64:67]
ds_read_b128 a[64:67], v202 offset:16384
v_fma_f32 v198, v198, v253, v251
v_mfma_f32_16x16x32_bf16 v[68:71], a[16:19], a[192:195], v[68:71]
ds_read_b128 a[68:71], v202 offset:17408
buffer_load_dwordx4 v1, s[8:11], s61 offen offset:0 sc1 lds
v_mfma_f32_16x16x32_bf16 v[72:75], a[16:19], a[196:199], v[72:75]
s_add_u32 m0, s62, 110592
v_fma_f32 v199, v199, v253, v251
v_mfma_f32_16x16x32_bf16 v[76:79], a[20:23], a[192:195], v[76:79]
s_add_u32 s60, s60, 20480
v_mfma_f32_16x16x32_bf16 v[80:83], a[20:23], a[196:199], v[80:83]
v_mul_f32 v196, v196, v152
v_mfma_f32_16x16x32_bf16 v[84:87], a[24:27], a[192:195], v[84:87]
v_mfma_f32_16x16x32_bf16 v[88:91], a[24:27], a[196:199], v[88:91]
v_mul_f32 v197, v197, v153
v_mfma_f32_16x16x32_bf16 v[92:95], a[28:31], a[192:195], v[92:95]
buffer_load_dwordx4 v1, s[8:11], s60 offen offset:0 sc1 lds
v_mfma_f32_16x16x32_bf16 v[96:99], a[28:31], a[196:199], v[96:99]
v_mul_f32 v198, v198, v154
v_mfma_f32_16x16x32_bf16 v[100:103], a[32:35], a[192:195], v[100:103]
v_mfma_f32_16x16x32_bf16 v[104:107], a[32:35], a[196:199], v[104:107]
s_waitcnt lgkmcnt(0)
v_mfma_f32_16x16x32_bf16 v[36:39], a[36:39], a[200:203], v[36:39]
ds_read_b128 a[0:3], v202 offset:18432
buffer_load_dwordx4 v1, s[8:11], s60 offen offset:1024 sc1 lds
v_mfma_f32_16x16x32_bf16 v[40:43], a[36:39], a[204:207], v[40:43]
ds_read_b128 a[4:7], v202 offset:19456
v_mul_f32 v199, v199, v155
v_mfma_f32_16x16x32_bf16 v[44:47], a[40:43], a[200:203], v[44:47]
ds_read_b128 a[8:11], v202 offset:20480
buffer_load_dwordx4 v1, s[8:11], s60 offen offset:2048 sc1 lds
v_mfma_f32_16x16x32_bf16 v[48:51], a[40:43], a[204:207], v[48:51]
ds_read_b128 a[12:15], v202 offset:21504
v_mfma_f32_16x16x32_bf16 v[52:55], a[44:47], a[200:203], v[52:55]
ds_read_b128 a[16:19], v202 offset:22528
buffer_load_dwordx4 v1, s[8:11], s60 offen offset:3072 sc1 lds
v_mfma_f32_16x16x32_bf16 v[56:59], a[44:47], a[204:207], v[56:59]
ds_read_b128 a[20:23], v202 offset:23552
v_mfma_f32_16x16x32_bf16 v[60:63], a[48:51], a[200:203], v[60:63]
ds_read_b128 a[24:27], v202 offset:24576
v_mfma_f32_16x16x32_bf16 v[64:67], a[48:51], a[204:207], v[64:67]
ds_read_b128 a[28:31], v202 offset:25600
v_mfma_f32_16x16x32_bf16 v[68:71], a[52:55], a[200:203], v[68:71]
ds_read_b128 a[32:35], v202 offset:26624
v_mfma_f32_16x16x32_bf16 v[72:75], a[52:55], a[204:207], v[72:75]
s_cmp_eq_u32 s25, 8
s_cselect_b32 s98, 4096, 0
v_mfma_f32_16x16x32_bf16 v[76:79], a[56:59], a[200:203], v[76:79]
s_add_u32 s52, s52, s98
v_exp_f32 v196, v196
v_mfma_f32_16x16x32_bf16 v[80:83], a[56:59], a[204:207], v[80:83]
s_add_u32 s52, s52, 4096
v_exp_f32 v197, v197
v_mfma_f32_16x16x32_bf16 v[84:87], a[60:63], a[200:203], v[84:87]
v_exp_f32 v198, v198
v_mfma_f32_16x16x32_bf16 v[88:91], a[60:63], a[204:207], v[88:91]
v_mfma_f32_16x16x32_bf16 v[92:95], a[64:67], a[200:203], v[92:95]
buffer_load_dwordx4 a[112:115], v1, s[4:7], s52 offen offset:0 sc1
v_mfma_f32_16x16x32_bf16 v[96:99], a[64:67], a[204:207], v[96:99]
v_mfma_f32_16x16x32_bf16 v[100:103], a[68:71], a[200:203], v[100:103]
v_exp_f32 v199, v199
v_mfma_f32_16x16x32_bf16 v[104:107], a[68:71], a[204:207], v[104:107]
s_waitcnt lgkmcnt(0)
v_mfma_f32_16x16x32_bf16 v[36:39], a[0:3], a[208:211], v[36:39]
ds_read_b128 a[36:39], v202 offset:27648
buffer_load_dwordx4 a[116:119], v9, s[4:7], s52 offen offset:0 sc1
v_mfma_f32_16x16x32_bf16 v[40:43], a[0:3], a[212:215], v[40:43]
ds_read_b128 a[40:43], v202 offset:28672
v_mfma_f32_16x16x32_bf16 v[44:47], a[4:7], a[208:211], v[44:47]
ds_read_b128 a[44:47], v202 offset:29696
v_mfma_f32_16x16x32_bf16 v[48:51], a[4:7], a[212:215], v[48:51]
ds_read_b128 a[48:51], v202 offset:30720
v_fma_f32 v196, v196, v255, v255
v_mfma_f32_16x16x32_bf16 v[52:55], a[8:11], a[208:211], v[52:55]
ds_read_b128 a[52:55], v202 offset:31744
buffer_load_dwordx4 a[120:123], v1, s[4:7], s52 offen offset:1024 sc1
v_mfma_f32_16x16x32_bf16 v[56:59], a[8:11], a[212:215], v[56:59]
ds_read_b128 a[56:59], v202 offset:32768
v_fma_f32 v197, v197, v255, v255
v_mfma_f32_16x16x32_bf16 v[60:63], a[12:15], a[208:211], v[60:63]
ds_read_b128 a[60:63], v202 offset:33792
v_mfma_f32_16x16x32_bf16 v[64:67], a[12:15], a[212:215], v[64:67]
ds_read_b128 a[64:67], v202 offset:34816
v_mfma_f32_16x16x32_bf16 v[68:71], a[16:19], a[208:211], v[68:71]
ds_read_b128 a[68:71], v202 offset:35840
buffer_load_dwordx4 a[124:127], v9, s[4:7], s52 offen offset:1024 sc1
v_mfma_f32_16x16x32_bf16 v[72:75], a[16:19], a[212:215], v[72:75]
v_fma_f32 v198, v198, v255, v255
v_mfma_f32_16x16x32_bf16 v[76:79], a[20:23], a[208:211], v[76:79]
v_fma_f32 v199, v199, v255, v255
v_mfma_f32_16x16x32_bf16 v[80:83], a[20:23], a[212:215], v[80:83]
v_mfma_f32_16x16x32_bf16 v[84:87], a[24:27], a[208:211], v[84:87]
buffer_load_dwordx4 a[128:131], v1, s[4:7], s52 offen offset:2048 sc1
v_mfma_f32_16x16x32_bf16 v[88:91], a[24:27], a[212:215], v[88:91]
v_rcp_f32 v196, v196
v_mfma_f32_16x16x32_bf16 v[92:95], a[28:31], a[208:211], v[92:95]
v_mfma_f32_16x16x32_bf16 v[96:99], a[28:31], a[212:215], v[96:99]
v_mfma_f32_16x16x32_bf16 v[100:103], a[32:35], a[208:211], v[100:103]
v_mfma_f32_16x16x32_bf16 v[104:107], a[32:35], a[212:215], v[104:107]
s_waitcnt vmcnt(22) lgkmcnt(0)
s_barrier
v_mfma_f32_16x16x32_bf16 v[36:39], a[36:39], a[216:219], v[36:39]
ds_read_b128 a[0:3], v200 offset:0
buffer_load_dwordx4 a[132:135], v9, s[4:7], s52 offen offset:2048 sc1
v_mfma_f32_16x16x32_bf16 v[40:43], a[36:39], a[220:223], v[40:43]
ds_read_b128 a[4:7], v200 offset:1024
buffer_load_dwordx4 a[136:139], v1, s[4:7], s52 offen offset:3072 sc1
v_mfma_f32_16x16x32_bf16 v[44:47], a[40:43], a[216:219], v[44:47]
ds_read_b128 a[8:11], v200 offset:2048
v_mfma_f32_16x16x32_bf16 v[48:51], a[40:43], a[220:223], v[48:51]
ds_read_b128 a[12:15], v200 offset:3072
buffer_load_dwordx4 a[140:143], v9, s[4:7], s52 offen offset:3072 sc1
v_mfma_f32_16x16x32_bf16 v[52:55], a[44:47], a[216:219], v[52:55]
ds_read_b128 a[16:19], v200 offset:4096
v_mfma_f32_16x16x32_bf16 v[56:59], a[44:47], a[220:223], v[56:59]
ds_read_b128 a[20:23], v200 offset:5120
v_mfma_f32_16x16x32_bf16 v[60:63], a[48:51], a[216:219], v[60:63]
ds_read_b128 a[24:27], v200 offset:6144
v_mfma_f32_16x16x32_bf16 v[64:67], a[48:51], a[220:223], v[64:67]
ds_read_b128 a[28:31], v200 offset:7168
v_mfma_f32_16x16x32_bf16 v[68:71], a[52:55], a[216:219], v[68:71]
ds_read_b128 a[32:35], v200 offset:8192
v_mfma_f32_16x16x32_bf16 v[72:75], a[52:55], a[220:223], v[72:75]
s_cmp_eq_u32 s25, 8
s_cselect_b32 s99, 36864, 0
s_add_u32 s60, s60, s99
v_mfma_f32_16x16x32_bf16 v[76:79], a[56:59], a[216:219], v[76:79]
s_add_u32 s61, s61, s99
v_rcp_f32 v197, v197
v_mfma_f32_16x16x32_bf16 v[80:83], a[56:59], a[220:223], v[80:83]
s_add_u32 m0, s62, 126976
v_rcp_f32 v198, v198
v_mfma_f32_16x16x32_bf16 v[84:87], a[60:63], a[216:219], v[84:87]
s_add_u32 s60, s60, 16384
v_rcp_f32 v199, v199
v_mfma_f32_16x16x32_bf16 v[88:91], a[60:63], a[220:223], v[88:91]
v_mul_f32 v152, v152, v196
v_mfma_f32_16x16x32_bf16 v[92:95], a[64:67], a[216:219], v[92:95]
v_mfma_f32_16x16x32_bf16 v[96:99], a[64:67], a[220:223], v[96:99]
buffer_load_dwordx4 v1, s[8:11], s60 offen offset:0 sc1 lds
v_mfma_f32_16x16x32_bf16 v[100:103], a[68:71], a[216:219], v[100:103]
v_mul_f32 v153, v153, v197
v_mfma_f32_16x16x32_bf16 v[104:107], a[68:71], a[220:223], v[104:107]
s_waitcnt lgkmcnt(0)
v_mfma_f32_16x16x32_bf16 v[36:39], a[0:3], a[224:227], v[36:39]
ds_read_b128 a[36:39], v200 offset:9216
buffer_load_dwordx4 v1, s[8:11], s60 offen offset:1024 sc1 lds
v_mfma_f32_16x16x32_bf16 v[40:43], a[0:3], a[228:231], v[40:43]
ds_read_b128 a[40:43], v200 offset:10240
v_mul_f32 v154, v154, v198
v_mfma_f32_16x16x32_bf16 v[44:47], a[4:7], a[224:227], v[44:47]
ds_read_b128 a[44:47], v200 offset:11264
buffer_load_dwordx4 v1, s[8:11], s60 offen offset:2048 sc1 lds
v_mfma_f32_16x16x32_bf16 v[48:51], a[4:7], a[228:231], v[48:51]
ds_read_b128 a[48:51], v200 offset:12288
v_mul_f32 v155, v155, v199
v_mfma_f32_16x16x32_bf16 v[52:55], a[8:11], a[224:227], v[52:55]
ds_read_b128 a[52:55], v200 offset:13312
v_mfma_f32_16x16x32_bf16 v[56:59], a[8:11], a[228:231], v[56:59]
ds_read_b128 a[56:59], v200 offset:14336
buffer_load_dwordx4 v1, s[8:11], s60 offen offset:3072 sc1 lds
v_mfma_f32_16x16x32_bf16 v[60:63], a[12:15], a[224:227], v[60:63]
ds_read_b128 a[60:63], v200 offset:15360
v_mul_f32 v192, v156, v156
v_mfma_f32_16x16x32_bf16 v[64:67], a[12:15], a[228:231], v[64:67]
ds_read_b128 a[64:67], v200 offset:16384
v_mul_f32 v193, v157, v157
v_mfma_f32_16x16x32_bf16 v[68:71], a[16:19], a[224:227], v[68:71]
ds_read_b128 a[68:71], v200 offset:17408
s_add_u32 m0, s63, 143360
v_mfma_f32_16x16x32_bf16 v[72:75], a[16:19], a[228:231], v[72:75]
s_add_u32 s61, s61, 36864
v_mul_f32 v194, v158, v158
v_mfma_f32_16x16x32_bf16 v[76:79], a[20:23], a[224:227], v[76:79]
v_mfma_f32_16x16x32_bf16 v[80:83], a[20:23], a[228:231], v[80:83]
v_mfma_f32_16x16x32_bf16 v[84:87], a[24:27], a[224:227], v[84:87]
v_mul_f32 v195, v159, v159
v_mfma_f32_16x16x32_bf16 v[88:91], a[24:27], a[228:231], v[88:91]
v_mfma_f32_16x16x32_bf16 v[92:95], a[28:31], a[224:227], v[92:95]
buffer_load_dwordx4 v1, s[8:11], s61 offen offset:0 sc1 lds
v_fma_f32 v192, v192, v252, v250
v_mfma_f32_16x16x32_bf16 v[96:99], a[28:31], a[228:231], v[96:99]
v_mfma_f32_16x16x32_bf16 v[100:103], a[32:35], a[224:227], v[100:103]
v_fma_f32 v193, v193, v252, v250
v_mfma_f32_16x16x32_bf16 v[104:107], a[32:35], a[228:231], v[104:107]
s_waitcnt lgkmcnt(0)
v_mfma_f32_16x16x32_bf16 v[36:39], a[36:39], a[232:235], v[36:39]
ds_read_b128 a[0:3], v200 offset:18432
s_add_u32 m0, s62, 147456
v_mfma_f32_16x16x32_bf16 v[40:43], a[36:39], a[236:239], v[40:43]
ds_read_b128 a[4:7], v200 offset:19456
v_fma_f32 v194, v194, v252, v250
v_mfma_f32_16x16x32_bf16 v[44:47], a[40:43], a[232:235], v[44:47]
ds_read_b128 a[8:11], v200 offset:20480
s_add_u32 s60, s60, 20480
v_mfma_f32_16x16x32_bf16 v[48:51], a[40:43], a[236:239], v[48:51]
ds_read_b128 a[12:15], v200 offset:21504
v_fma_f32 v195, v195, v252, v250
v_mfma_f32_16x16x32_bf16 v[52:55], a[44:47], a[232:235], v[52:55]
ds_read_b128 a[16:19], v200 offset:22528
v_mfma_f32_16x16x32_bf16 v[56:59], a[44:47], a[236:239], v[56:59]
ds_read_b128 a[20:23], v200 offset:23552
buffer_load_dwordx4 v1, s[8:11], s60 offen offset:0 sc1 lds
v_mfma_f32_16x16x32_bf16 v[60:63], a[48:51], a[232:235], v[60:63]
ds_read_b128 a[24:27], v200 offset:24576
v_mul_f32 v192, v192, v156
v_mfma_f32_16x16x32_bf16 v[64:67], a[48:51], a[236:239], v[64:67]
ds_read_b128 a[28:31], v200 offset:25600
v_mfma_f32_16x16x32_bf16 v[68:71], a[52:55], a[232:235], v[68:71]
ds_read_b128 a[32:35], v200 offset:26624
buffer_load_dwordx4 v1, s[8:11], s60 offen offset:1024 sc1 lds
v_mfma_f32_16x16x32_bf16 v[72:75], a[52:55], a[236:239], v[72:75]
v_mul_f32 v193, v193, v157
v_mfma_f32_16x16x32_bf16 v[76:79], a[56:59], a[232:235], v[76:79]
v_mul_f32 v194, v194, v158
v_mfma_f32_16x16x32_bf16 v[80:83], a[56:59], a[236:239], v[80:83]
buffer_load_dwordx4 v1, s[8:11], s60 offen offset:2048 sc1 lds
v_mfma_f32_16x16x32_bf16 v[84:87], a[60:63], a[232:235], v[84:87]
v_mfma_f32_16x16x32_bf16 v[88:91], a[60:63], a[236:239], v[88:91]
v_mul_f32 v195, v195, v159
v_mfma_f32_16x16x32_bf16 v[92:95], a[64:67], a[232:235], v[92:95]
buffer_load_dwordx4 v1, s[8:11], s60 offen offset:3072 sc1 lds
v_mfma_f32_16x16x32_bf16 v[96:99], a[64:67], a[236:239], v[96:99]
v_exp_f32 v192, v192
v_mfma_f32_16x16x32_bf16 v[100:103], a[68:71], a[232:235], v[100:103]
v_mfma_f32_16x16x32_bf16 v[104:107], a[68:71], a[236:239], v[104:107]
s_waitcnt lgkmcnt(0)
v_mfma_f32_16x16x32_bf16 v[36:39], a[0:3], a[240:243], v[36:39]
ds_read_b128 a[36:39], v200 offset:27648
v_mfma_f32_16x16x32_bf16 v[40:43], a[0:3], a[244:247], v[40:43]
ds_read_b128 a[40:43], v200 offset:28672
v_mfma_f32_16x16x32_bf16 v[44:47], a[4:7], a[240:243], v[44:47]
ds_read_b128 a[44:47], v200 offset:29696
v_mfma_f32_16x16x32_bf16 v[48:51], a[4:7], a[244:247], v[48:51]
ds_read_b128 a[48:51], v200 offset:30720
v_mfma_f32_16x16x32_bf16 v[52:55], a[8:11], a[240:243], v[52:55]
ds_read_b128 a[52:55], v200 offset:31744
v_mfma_f32_16x16x32_bf16 v[56:59], a[8:11], a[244:247], v[56:59]
ds_read_b128 a[56:59], v200 offset:32768
v_mfma_f32_16x16x32_bf16 v[60:63], a[12:15], a[240:243], v[60:63]
ds_read_b128 a[60:63], v200 offset:33792
v_mfma_f32_16x16x32_bf16 v[64:67], a[12:15], a[244:247], v[64:67]
ds_read_b128 a[64:67], v200 offset:34816
v_mfma_f32_16x16x32_bf16 v[68:71], a[16:19], a[240:243], v[68:71]
ds_read_b128 a[68:71], v200 offset:35840
v_mfma_f32_16x16x32_bf16 v[72:75], a[16:19], a[244:247], v[72:75]
s_cmp_eq_u32 s25, 9
s_cselect_b32 s98, 4096, 0
s_add_u32 s52, s52, s98
v_mfma_f32_16x16x32_bf16 v[76:79], a[20:23], a[240:243], v[76:79]
s_add_u32 s52, s52, 4096
v_exp_f32 v193, v193
v_mfma_f32_16x16x32_bf16 v[80:83], a[20:23], a[244:247], v[80:83]
buffer_load_dwordx4 a[144:147], v1, s[4:7], s52 offen offset:0 sc1
v_mfma_f32_16x16x32_bf16 v[84:87], a[24:27], a[240:243], v[84:87]
buffer_load_dwordx4 a[148:151], v9, s[4:7], s52 offen offset:0 sc1
v_mfma_f32_16x16x32_bf16 v[88:91], a[24:27], a[244:247], v[88:91]
buffer_load_dwordx4 a[152:155], v1, s[4:7], s52 offen offset:1024 sc1
v_mfma_f32_16x16x32_bf16 v[92:95], a[28:31], a[240:243], v[92:95]
buffer_load_dwordx4 a[156:159], v9, s[4:7], s52 offen offset:1024 sc1
v_mfma_f32_16x16x32_bf16 v[96:99], a[28:31], a[244:247], v[96:99]
v_exp_f32 v194, v194
v_mfma_f32_16x16x32_bf16 v[100:103], a[32:35], a[240:243], v[100:103]
v_exp_f32 v195, v195
v_mfma_f32_16x16x32_bf16 v[104:107], a[32:35], a[244:247], v[104:107]
s_waitcnt vmcnt(21) lgkmcnt(0)
s_barrier
v_mfma_f32_16x16x32_bf16 v[36:39], a[36:39], a[248:251], v[36:39]
ds_read_b128 a[0:3], v201 offset:0
v_fma_f32 v192, v192, v254, v254
v_mfma_f32_16x16x32_bf16 v[40:43], a[36:39], a[252:255], v[40:43]
ds_read_b128 a[4:7], v201 offset:1024
v_fma_f32 v193, v193, v254, v254
v_mfma_f32_16x16x32_bf16 v[44:47], a[40:43], a[248:251], v[44:47]
ds_read_b128 a[8:11], v201 offset:2048
v_fma_f32 v194, v194, v254, v254
v_mfma_f32_16x16x32_bf16 v[48:51], a[40:43], a[252:255], v[48:51]
ds_read_b128 a[12:15], v201 offset:3072
v_mfma_f32_16x16x32_bf16 v[52:55], a[44:47], a[248:251], v[52:55]
ds_read_b128 a[16:19], v201 offset:4096
v_mfma_f32_16x16x32_bf16 v[56:59], a[44:47], a[252:255], v[56:59]
ds_read_b128 a[20:23], v201 offset:5120
v_fma_f32 v195, v195, v254, v254
v_mfma_f32_16x16x32_bf16 v[60:63], a[48:51], a[248:251], v[60:63]
ds_read_b128 a[24:27], v201 offset:6144
v_mfma_f32_16x16x32_bf16 v[64:67], a[48:51], a[252:255], v[64:67]
ds_read_b128 a[28:31], v201 offset:7168
v_mfma_f32_16x16x32_bf16 v[68:71], a[52:55], a[248:251], v[68:71]
ds_read_b128 a[32:35], v201 offset:8192
v_mfma_f32_16x16x32_bf16 v[72:75], a[52:55], a[252:255], v[72:75]
s_cmp_eq_u32 s25, 9
s_cselect_b32 s99, 36864, 0
s_add_u32 s60, s60, s99
v_mfma_f32_16x16x32_bf16 v[76:79], a[56:59], a[248:251], v[76:79]
s_add_u32 s61, s61, s99
s_add_u32 m0, s62, 53248
s_add_u32 s60, s60, 16384
v_mfma_f32_16x16x32_bf16 v[80:83], a[56:59], a[252:255], v[80:83]
buffer_load_dwordx4 v1, s[8:11], s60 offen offset:0 sc1 lds
v_mfma_f32_16x16x32_bf16 v[84:87], a[60:63], a[248:251], v[84:87]
buffer_load_dwordx4 v1, s[8:11], s60 offen offset:1024 sc1 lds
v_mfma_f32_16x16x32_bf16 v[88:91], a[60:63], a[252:255], v[88:91]
buffer_load_dwordx4 v1, s[8:11], s60 offen offset:2048 sc1 lds
v_mfma_f32_16x16x32_bf16 v[92:95], a[64:67], a[248:251], v[92:95]
v_rcp_f32 v192, v192
v_mfma_f32_16x16x32_bf16 v[96:99], a[64:67], a[252:255], v[96:99]
buffer_load_dwordx4 v1, s[8:11], s60 offen offset:3072 sc1 lds
v_mfma_f32_16x16x32_bf16 v[100:103], a[68:71], a[248:251], v[100:103]
v_rcp_f32 v193, v193
v_mfma_f32_16x16x32_bf16 v[104:107], a[68:71], a[252:255], v[104:107]
s_waitcnt lgkmcnt(0)
v_mfma_f32_16x16x32_bf16 v[36:39], a[0:3], a[80:83], v[36:39]
ds_read_b128 a[36:39], v201 offset:9216
s_add_u32 m0, s63, 69632
v_mfma_f32_16x16x32_bf16 v[40:43], a[0:3], a[84:87], v[40:43]
ds_read_b128 a[40:43], v201 offset:10240
v_mfma_f32_16x16x32_bf16 v[44:47], a[4:7], a[80:83], v[44:47]
ds_read_b128 a[44:47], v201 offset:11264
s_add_u32 s61, s61, 36864
v_mfma_f32_16x16x32_bf16 v[48:51], a[4:7], a[84:87], v[48:51]
ds_read_b128 a[48:51], v201 offset:12288
v_mfma_f32_16x16x32_bf16 v[52:55], a[8:11], a[80:83], v[52:55]
ds_read_b128 a[52:55], v201 offset:13312
buffer_load_dwordx4 v1, s[8:11], s61 offen offset:0 sc1 lds
v_mfma_f32_16x16x32_bf16 v[56:59], a[8:11], a[84:87], v[56:59]
ds_read_b128 a[56:59], v201 offset:14336
v_mfma_f32_16x16x32_bf16 v[60:63], a[12:15], a[80:83], v[60:63]
ds_read_b128 a[60:63], v201 offset:15360
s_add_u32 m0, s62, 73728
v_mfma_f32_16x16x32_bf16 v[64:67], a[12:15], a[84:87], v[64:67]
ds_read_b128 a[64:67], v201 offset:16384
v_mfma_f32_16x16x32_bf16 v[68:71], a[16:19], a[80:83], v[68:71]
ds_read_b128 a[68:71], v201 offset:17408
s_add_u32 s60, s60, 20480
v_mfma_f32_16x16x32_bf16 v[72:75], a[16:19], a[84:87], v[72:75]
v_rcp_f32 v194, v194
v_mfma_f32_16x16x32_bf16 v[76:79], a[20:23], a[80:83], v[76:79]
buffer_load_dwordx4 v1, s[8:11], s60 offen offset:0 sc1 lds
v_mfma_f32_16x16x32_bf16 v[80:83], a[20:23], a[84:87], v[80:83]
v_rcp_f32 v195, v195
v_mfma_f32_16x16x32_bf16 v[84:87], a[24:27], a[80:83], v[84:87]
buffer_load_dwordx4 v1, s[8:11], s60 offen offset:1024 sc1 lds
v_mul_f32 v156, v156, v192
v_mfma_f32_16x16x32_bf16 v[88:91], a[24:27], a[84:87], v[88:91]
v_mul_f32 v157, v157, v193
v_mul_f32 v158, v158, v194
v_mfma_f32_16x16x32_bf16 v[92:95], a[28:31], a[80:83], v[92:95]
buffer_load_dwordx4 v1, s[8:11], s60 offen offset:2048 sc1 lds
v_mfma_f32_16x16x32_bf16 v[96:99], a[28:31], a[84:87], v[96:99]
v_mul_f32 v159, v159, v195
v_mfma_f32_16x16x32_bf16 v[100:103], a[32:35], a[80:83], v[100:103]
v_mfma_f32_16x16x32_bf16 v[104:107], a[32:35], a[84:87], v[104:107]
v_mul_f32 v196, v160, v160
s_waitcnt lgkmcnt(0)
v_mfma_f32_16x16x32_bf16 v[36:39], a[36:39], a[88:91], v[36:39]
ds_read_b128 a[0:3], v201 offset:18432
buffer_load_dwordx4 v1, s[8:11], s60 offen offset:3072 sc1 lds
v_mfma_f32_16x16x32_bf16 v[40:43], a[36:39], a[92:95], v[40:43]
ds_read_b128 a[4:7], v201 offset:19456
v_mfma_f32_16x16x32_bf16 v[44:47], a[40:43], a[88:91], v[44:47]
ds_read_b128 a[8:11], v201 offset:20480
v_mul_f32 v197, v161, v161
v_mfma_f32_16x16x32_bf16 v[48:51], a[40:43], a[92:95], v[48:51]
ds_read_b128 a[12:15], v201 offset:21504
v_mfma_f32_16x16x32_bf16 v[52:55], a[44:47], a[88:91], v[52:55]
ds_read_b128 a[16:19], v201 offset:22528
buffer_load_dwordx4 a[160:163], v1, s[4:7], s52 offen offset:2048 sc1
v_mfma_f32_16x16x32_bf16 v[56:59], a[44:47], a[92:95], v[56:59]
ds_read_b128 a[20:23], v201 offset:23552
v_mul_f32 v198, v162, v162
v_mfma_f32_16x16x32_bf16 v[60:63], a[48:51], a[88:91], v[60:63]
ds_read_b128 a[24:27], v201 offset:24576
v_mfma_f32_16x16x32_bf16 v[64:67], a[48:51], a[92:95], v[64:67]
ds_read_b128 a[28:31], v201 offset:25600
v_mul_f32 v199, v163, v163
v_mfma_f32_16x16x32_bf16 v[68:71], a[52:55], a[88:91], v[68:71]
ds_read_b128 a[32:35], v201 offset:26624
buffer_load_dwordx4 a[164:167], v9, s[4:7], s52 offen offset:2048 sc1
v_mfma_f32_16x16x32_bf16 v[72:75], a[52:55], a[92:95], v[72:75]
v_fma_f32 v196, v196, v253, v251
v_mfma_f32_16x16x32_bf16 v[76:79], a[56:59], a[88:91], v[76:79]
v_mfma_f32_16x16x32_bf16 v[80:83], a[56:59], a[92:95], v[80:83]
v_fma_f32 v197, v197, v253, v251
v_mfma_f32_16x16x32_bf16 v[84:87], a[60:63], a[88:91], v[84:87]
buffer_load_dwordx4 a[168:171], v1, s[4:7], s52 offen offset:3072 sc1
v_mfma_f32_16x16x32_bf16 v[88:91], a[60:63], a[92:95], v[88:91]
v_mfma_f32_16x16x32_bf16 v[92:95], a[64:67], a[88:91], v[92:95]
v_fma_f32 v198, v198, v253, v251
v_mfma_f32_16x16x32_bf16 v[96:99], a[64:67], a[92:95], v[96:99]
v_mfma_f32_16x16x32_bf16 v[100:103], a[68:71], a[88:91], v[100:103]
v_fma_f32 v199, v199, v253, v251
v_mfma_f32_16x16x32_bf16 v[104:107], a[68:71], a[92:95], v[104:107]
s_waitcnt lgkmcnt(0)
v_mfma_f32_16x16x32_bf16 v[36:39], a[0:3], a[96:99], v[36:39]
ds_read_b128 a[36:39], v201 offset:27648
buffer_load_dwordx4 a[172:175], v9, s[4:7], s52 offen offset:3072 sc1
v_mfma_f32_16x16x32_bf16 v[40:43], a[0:3], a[100:103], v[40:43]
ds_read_b128 a[40:43], v201 offset:28672
v_mul_f32 v196, v196, v160
v_mfma_f32_16x16x32_bf16 v[44:47], a[4:7], a[96:99], v[44:47]
ds_read_b128 a[44:47], v201 offset:29696
v_mfma_f32_16x16x32_bf16 v[48:51], a[4:7], a[100:103], v[48:51]
ds_read_b128 a[48:51], v201 offset:30720
v_mul_f32 v197, v197, v161
v_mfma_f32_16x16x32_bf16 v[52:55], a[8:11], a[96:99], v[52:55]
ds_read_b128 a[52:55], v201 offset:31744
v_mfma_f32_16x16x32_bf16 v[56:59], a[8:11], a[100:103], v[56:59]
ds_read_b128 a[56:59], v201 offset:32768
v_mul_f32 v198, v198, v162
v_mfma_f32_16x16x32_bf16 v[60:63], a[12:15], a[96:99], v[60:63]
ds_read_b128 a[60:63], v201 offset:33792
v_mfma_f32_16x16x32_bf16 v[64:67], a[12:15], a[100:103], v[64:67]
ds_read_b128 a[64:67], v201 offset:34816
v_mul_f32 v199, v199, v163
v_mfma_f32_16x16x32_bf16 v[68:71], a[16:19], a[96:99], v[68:71]
ds_read_b128 a[68:71], v201 offset:35840
v_mfma_f32_16x16x32_bf16 v[72:75], a[16:19], a[100:103], v[72:75]
s_cmp_eq_u32 s25, 10
s_cselect_b32 s98, 4096, 0
s_add_u32 s52, s52, s98
v_mfma_f32_16x16x32_bf16 v[76:79], a[20:23], a[96:99], v[76:79]
s_add_u32 s52, s52, 4096
v_exp_f32 v196, v196
v_mfma_f32_16x16x32_bf16 v[80:83], a[20:23], a[100:103], v[80:83]
buffer_load_dwordx4 a[176:179], v1, s[4:7], s52 offen offset:0 sc1
v_mfma_f32_16x16x32_bf16 v[84:87], a[24:27], a[96:99], v[84:87]
buffer_load_dwordx4 a[180:183], v9, s[4:7], s52 offen offset:0 sc1
v_mfma_f32_16x16x32_bf16 v[88:91], a[24:27], a[100:103], v[88:91]
v_mfma_f32_16x16x32_bf16 v[92:95], a[28:31], a[96:99], v[92:95]
buffer_load_dwordx4 a[184:187], v1, s[4:7], s52 offen offset:1024 sc1
v_mfma_f32_16x16x32_bf16 v[96:99], a[28:31], a[100:103], v[96:99]
v_exp_f32 v197, v197
v_mfma_f32_16x16x32_bf16 v[100:103], a[32:35], a[96:99], v[100:103]
v_mfma_f32_16x16x32_bf16 v[104:107], a[32:35], a[100:103], v[104:107]
s_waitcnt vmcnt(20) lgkmcnt(0)
s_barrier
v_mfma_f32_16x16x32_bf16 v[36:39], a[36:39], a[104:107], v[36:39]
ds_read_b128 a[0:3], v202 offset:0
buffer_load_dwordx4 a[188:191], v9, s[4:7], s52 offen offset:1024 sc1
v_mfma_f32_16x16x32_bf16 v[40:43], a[36:39], a[108:111], v[40:43]
ds_read_b128 a[4:7], v202 offset:1024
v_mfma_f32_16x16x32_bf16 v[44:47], a[40:43], a[104:107], v[44:47]
ds_read_b128 a[8:11], v202 offset:2048
v_mfma_f32_16x16x32_bf16 v[48:51], a[40:43], a[108:111], v[48:51]
ds_read_b128 a[12:15], v202 offset:3072
v_mfma_f32_16x16x32_bf16 v[52:55], a[44:47], a[104:107], v[52:55]
ds_read_b128 a[16:19], v202 offset:4096
v_mfma_f32_16x16x32_bf16 v[56:59], a[44:47], a[108:111], v[56:59]
ds_read_b128 a[20:23], v202 offset:5120
v_mfma_f32_16x16x32_bf16 v[60:63], a[48:51], a[104:107], v[60:63]
ds_read_b128 a[24:27], v202 offset:6144
v_mfma_f32_16x16x32_bf16 v[64:67], a[48:51], a[108:111], v[64:67]
ds_read_b128 a[28:31], v202 offset:7168
v_mfma_f32_16x16x32_bf16 v[68:71], a[52:55], a[104:107], v[68:71]
ds_read_b128 a[32:35], v202 offset:8192
v_mfma_f32_16x16x32_bf16 v[72:75], a[52:55], a[108:111], v[72:75]
s_cmp_eq_u32 s25, 10
s_cselect_b32 s99, 36864, 0
s_add_u32 s60, s60, s99
v_mfma_f32_16x16x32_bf16 v[76:79], a[56:59], a[104:107], v[76:79]
s_add_u32 s61, s61, s99
s_add_u32 m0, s62, 90112
s_add_u32 s60, s60, 16384
v_mfma_f32_16x16x32_bf16 v[80:83], a[56:59], a[108:111], v[80:83]
buffer_load_dwordx4 v1, s[8:11], s60 offen offset:0 sc1 lds
v_mfma_f32_16x16x32_bf16 v[84:87], a[60:63], a[104:107], v[84:87]
v_exp_f32 v198, v198
v_mfma_f32_16x16x32_bf16 v[88:91], a[60:63], a[108:111], v[88:91]
buffer_load_dwordx4 v1, s[8:11], s60 offen offset:1024 sc1 lds
v_mfma_f32_16x16x32_bf16 v[92:95], a[64:67], a[104:107], v[92:95]
v_exp_f32 v199, v199
v_mfma_f32_16x16x32_bf16 v[96:99], a[64:67], a[108:111], v[96:99]
buffer_load_dwordx4 v1, s[8:11], s60 offen offset:2048 sc1 lds
v_fma_f32 v196, v196, v255, v255
v_mfma_f32_16x16x32_bf16 v[100:103], a[68:71], a[104:107], v[100:103]
v_fma_f32 v197, v197, v255, v255
v_fma_f32 v198, v198, v255, v255
v_mfma_f32_16x16x32_bf16 v[104:107], a[68:71], a[108:111], v[104:107]
s_waitcnt lgkmcnt(0)
v_mfma_f32_16x16x32_bf16 v[36:39], a[0:3], a[112:115], v[36:39]
ds_read_b128 a[36:39], v202 offset:9216
buffer_load_dwordx4 v1, s[8:11], s60 offen offset:3072 sc1 lds
v_mfma_f32_16x16x32_bf16 v[40:43], a[0:3], a[116:119], v[40:43]
ds_read_b128 a[40:43], v202 offset:10240
v_fma_f32 v199, v199, v255, v255
v_mfma_f32_16x16x32_bf16 v[44:47], a[4:7], a[112:115], v[44:47]
ds_read_b128 a[44:47], v202 offset:11264
s_add_u32 m0, s63, 106496
v_mfma_f32_16x16x32_bf16 v[48:51], a[4:7], a[116:119], v[48:51]
ds_read_b128 a[48:51], v202 offset:12288
v_mfma_f32_16x16x32_bf16 v[52:55], a[8:11], a[112:115], v[52:55]
ds_read_b128 a[52:55], v202 offset:13312
s_add_u32 s61, s61, 36864
v_mfma_f32_16x16x32_bf16 v[56:59], a[8:11], a[116:119], v[56:59]
ds_read_b128 a[56:59], v202 offset:14336
v_mfma_f32_16x16x32_bf16 v[60:63], a[12:15], a[112:115], v[60:63]
ds_read_b128 a[60:63], v202 offset:15360
buffer_load_dwordx4 v1, s[8:11], s61 offen offset:0 sc1 lds
v_mfma_f32_16x16x32_bf16 v[64:67], a[12:15], a[116:119], v[64:67]
ds_read_b128 a[64:67], v202 offset:16384
v_mfma_f32_16x16x32_bf16 v[68:71], a[16:19], a[112:115], v[68:71]
ds_read_b128 a[68:71], v202 offset:17408
s_add_u32 m0, s62, 110592
v_mfma_f32_16x16x32_bf16 v[72:75], a[16:19], a[116:119], v[72:75]
s_add_u32 s60, s60, 20480
v_rcp_f32 v196, v196
v_mfma_f32_16x16x32_bf16 v[76:79], a[20:23], a[112:115], v[76:79]
v_rcp_f32 v197, v197
v_mfma_f32_16x16x32_bf16 v[80:83], a[20:23], a[116:119], v[80:83]
v_rcp_f32 v198, v198
v_mfma_f32_16x16x32_bf16 v[84:87], a[24:27], a[112:115], v[84:87]
buffer_load_dwordx4 v1, s[8:11], s60 offen offset:0 sc1 lds
v_mfma_f32_16x16x32_bf16 v[88:91], a[24:27], a[116:119], v[88:91]
v_mfma_f32_16x16x32_bf16 v[92:95], a[28:31], a[112:115], v[92:95]
buffer_load_dwordx4 v1, s[8:11], s60 offen offset:1024 sc1 lds
v_mfma_f32_16x16x32_bf16 v[96:99], a[28:31], a[116:119], v[96:99]
v_mfma_f32_16x16x32_bf16 v[100:103], a[32:35], a[112:115], v[100:103]
v_rcp_f32 v199, v199
v_mfma_f32_16x16x32_bf16 v[104:107], a[32:35], a[116:119], v[104:107]
s_waitcnt lgkmcnt(0)
v_mfma_f32_16x16x32_bf16 v[36:39], a[36:39], a[120:123], v[36:39]
ds_read_b128 a[0:3], v202 offset:18432
buffer_load_dwordx4 v1, s[8:11], s60 offen offset:2048 sc1 lds
v_mfma_f32_16x16x32_bf16 v[40:43], a[36:39], a[124:127], v[40:43]
ds_read_b128 a[4:7], v202 offset:19456
v_mfma_f32_16x16x32_bf16 v[44:47], a[40:43], a[120:123], v[44:47]
ds_read_b128 a[8:11], v202 offset:20480
v_mfma_f32_16x16x32_bf16 v[48:51], a[40:43], a[124:127], v[48:51]
ds_read_b128 a[12:15], v202 offset:21504
v_mul_f32 v160, v160, v196
v_mfma_f32_16x16x32_bf16 v[52:55], a[44:47], a[120:123], v[52:55]
ds_read_b128 a[16:19], v202 offset:22528
buffer_load_dwordx4 v1, s[8:11], s60 offen offset:3072 sc1 lds
v_mfma_f32_16x16x32_bf16 v[56:59], a[44:47], a[124:127], v[56:59]
ds_read_b128 a[20:23], v202 offset:23552
v_mul_f32 v161, v161, v197
v_mfma_f32_16x16x32_bf16 v[60:63], a[48:51], a[120:123], v[60:63]
ds_read_b128 a[24:27], v202 offset:24576
v_mfma_f32_16x16x32_bf16 v[64:67], a[48:51], a[124:127], v[64:67]
ds_read_b128 a[28:31], v202 offset:25600
v_mfma_f32_16x16x32_bf16 v[68:71], a[52:55], a[120:123], v[68:71]
ds_read_b128 a[32:35], v202 offset:26624
buffer_load_dwordx4 a[192:195], v1, s[4:7], s52 offen offset:2048 sc1
v_mfma_f32_16x16x32_bf16 v[72:75], a[52:55], a[124:127], v[72:75]
v_mul_f32 v162, v162, v198
v_mfma_f32_16x16x32_bf16 v[76:79], a[56:59], a[120:123], v[76:79]
v_mul_f32 v163, v163, v199
v_mfma_f32_16x16x32_bf16 v[80:83], a[56:59], a[124:127], v[80:83]
v_mfma_f32_16x16x32_bf16 v[84:87], a[60:63], a[120:123], v[84:87]
buffer_load_dwordx4 a[196:199], v9, s[4:7], s52 offen offset:2048 sc1
v_mul_f32 v192, v164, v164
v_mfma_f32_16x16x32_bf16 v[88:91], a[60:63], a[124:127], v[88:91]
v_mfma_f32_16x16x32_bf16 v[92:95], a[64:67], a[120:123], v[92:95]
v_mfma_f32_16x16x32_bf16 v[96:99], a[64:67], a[124:127], v[96:99]
v_mul_f32 v193, v165, v165
v_mfma_f32_16x16x32_bf16 v[100:103], a[68:71], a[120:123], v[100:103]
v_mfma_f32_16x16x32_bf16 v[104:107], a[68:71], a[124:127], v[104:107]
v_mul_f32 v194, v166, v166
s_waitcnt lgkmcnt(0)
v_mfma_f32_16x16x32_bf16 v[36:39], a[0:3], a[128:131], v[36:39]
ds_read_b128 a[36:39], v202 offset:27648
buffer_load_dwordx4 a[200:203], v1, s[4:7], s52 offen offset:3072 sc1
v_mfma_f32_16x16x32_bf16 v[40:43], a[0:3], a[132:135], v[40:43]
ds_read_b128 a[40:43], v202 offset:28672
v_mul_f32 v195, v167, v167
v_mfma_f32_16x16x32_bf16 v[44:47], a[4:7], a[128:131], v[44:47]
ds_read_b128 a[44:47], v202 offset:29696
buffer_load_dwordx4 a[204:207], v9, s[4:7], s52 offen offset:3072 sc1
v_mfma_f32_16x16x32_bf16 v[48:51], a[4:7], a[132:135], v[48:51]
ds_read_b128 a[48:51], v202 offset:30720
v_mfma_f32_16x16x32_bf16 v[52:55], a[8:11], a[128:131], v[52:55]
ds_read_b128 a[52:55], v202 offset:31744
v_fma_f32 v192, v192, v252, v250
v_mfma_f32_16x16x32_bf16 v[56:59], a[8:11], a[132:135], v[56:59]
ds_read_b128 a[56:59], v202 offset:32768
v_mfma_f32_16x16x32_bf16 v[60:63], a[12:15], a[128:131], v[60:63]
ds_read_b128 a[60:63], v202 offset:33792
v_fma_f32 v193, v193, v252, v250
v_mfma_f32_16x16x32_bf16 v[64:67], a[12:15], a[132:135], v[64:67]
ds_read_b128 a[64:67], v202 offset:34816
v_mfma_f32_16x16x32_bf16 v[68:71], a[16:19], a[128:131], v[68:71]
ds_read_b128 a[68:71], v202 offset:35840
v_fma_f32 v194, v194, v252, v250
v_mfma_f32_16x16x32_bf16 v[72:75], a[16:19], a[132:135], v[72:75]
s_cmp_eq_u32 s25, 11
s_cselect_b32 s98, 4096, 0
s_add_u32 s52, s52, s98
v_mfma_f32_16x16x32_bf16 v[76:79], a[20:23], a[128:131], v[76:79]
s_add_u32 s52, s52, 4096
v_mfma_f32_16x16x32_bf16 v[80:83], a[20:23], a[132:135], v[80:83]
v_fma_f32 v195, v195, v252, v250
v_mfma_f32_16x16x32_bf16 v[84:87], a[24:27], a[128:131], v[84:87]
buffer_load_dwordx4 a[208:211], v1, s[4:7], s52 offen offset:0 sc1
v_mfma_f32_16x16x32_bf16 v[88:91], a[24:27], a[132:135], v[88:91]
v_mul_f32 v192, v192, v164
v_mfma_f32_16x16x32_bf16 v[92:95], a[28:31], a[128:131], v[92:95]
buffer_load_dwordx4 a[212:215], v9, s[4:7], s52 offen offset:0 sc1
v_mfma_f32_16x16x32_bf16 v[96:99], a[28:31], a[132:135], v[96:99]
v_mfma_f32_16x16x32_bf16 v[100:103], a[32:35], a[128:131], v[100:103]
v_mul_f32 v193, v193, v165
v_mfma_f32_16x16x32_bf16 v[104:107], a[32:35], a[132:135], v[104:107]
s_waitcnt vmcnt(23) lgkmcnt(0)
s_barrier
v_mfma_f32_16x16x32_bf16 v[36:39], a[36:39], a[136:139], v[36:39]
ds_read_b128 a[0:3], v200 offset:0
buffer_load_dwordx4 a[216:219], v1, s[4:7], s52 offen offset:1024 sc1
v_mfma_f32_16x16x32_bf16 v[40:43], a[36:39], a[140:143], v[40:43]
ds_read_b128 a[4:7], v200 offset:1024
buffer_load_dwordx4 a[220:223], v9, s[4:7], s52 offen offset:1024 sc1
v_mfma_f32_16x16x32_bf16 v[44:47], a[40:43], a[136:139], v[44:47]
ds_read_b128 a[8:11], v200 offset:2048
v_mul_f32 v194, v194, v166
v_mfma_f32_16x16x32_bf16 v[48:51], a[40:43], a[140:143], v[48:51]
ds_read_b128 a[12:15], v200 offset:3072
v_mul_f32 v195, v195, v167
v_mfma_f32_16x16x32_bf16 v[52:55], a[44:47], a[136:139], v[52:55]
ds_read_b128 a[16:19], v200 offset:4096
v_mfma_f32_16x16x32_bf16 v[56:59], a[44:47], a[140:143], v[56:59]
ds_read_b128 a[20:23], v200 offset:5120
v_mfma_f32_16x16x32_bf16 v[60:63], a[48:51], a[136:139], v[60:63]
ds_read_b128 a[24:27], v200 offset:6144
v_mfma_f32_16x16x32_bf16 v[64:67], a[48:51], a[140:143], v[64:67]
ds_read_b128 a[28:31], v200 offset:7168
v_mfma_f32_16x16x32_bf16 v[68:71], a[52:55], a[136:139], v[68:71]
ds_read_b128 a[32:35], v200 offset:8192
v_mfma_f32_16x16x32_bf16 v[72:75], a[52:55], a[140:143], v[72:75]
s_cmp_eq_u32 s25, 11
s_cselect_b32 s99, 36864, 0
s_add_u32 s60, s60, s99
v_mfma_f32_16x16x32_bf16 v[76:79], a[56:59], a[136:139], v[76:79]
s_add_u32 s61, s61, s99
s_add_u32 m0, s62, 126976
v_mfma_f32_16x16x32_bf16 v[80:83], a[56:59], a[140:143], v[80:83]
s_add_u32 s60, s60, 16384
v_exp_f32 v192, v192
v_mfma_f32_16x16x32_bf16 v[84:87], a[60:63], a[136:139], v[84:87]
v_exp_f32 v193, v193
v_mfma_f32_16x16x32_bf16 v[88:91], a[60:63], a[140:143], v[88:91]
buffer_load_dwordx4 v1, s[8:11], s60 offen offset:0 sc1 lds
v_mfma_f32_16x16x32_bf16 v[92:95], a[64:67], a[136:139], v[92:95]
v_exp_f32 v194, v194
v_mfma_f32_16x16x32_bf16 v[96:99], a[64:67], a[140:143], v[96:99]
buffer_load_dwordx4 v1, s[8:11], s60 offen offset:1024 sc1 lds
v_mfma_f32_16x16x32_bf16 v[100:103], a[68:71], a[136:139], v[100:103]
v_mfma_f32_16x16x32_bf16 v[104:107], a[68:71], a[140:143], v[104:107]
s_waitcnt lgkmcnt(0)
v_mfma_f32_16x16x32_bf16 v[36:39], a[0:3], a[144:147], v[36:39]
ds_read_b128 a[36:39], v200 offset:9216
buffer_load_dwordx4 v1, s[8:11], s60 offen offset:2048 sc1 lds
v_mfma_f32_16x16x32_bf16 v[40:43], a[0:3], a[148:151], v[40:43]
ds_read_b128 a[40:43], v200 offset:10240
v_mfma_f32_16x16x32_bf16 v[44:47], a[4:7], a[144:147], v[44:47]
ds_read_b128 a[44:47], v200 offset:11264
buffer_load_dwordx4 v1, s[8:11], s60 offen offset:3072 sc1 lds
v_mfma_f32_16x16x32_bf16 v[48:51], a[4:7], a[148:151], v[48:51]
ds_read_b128 a[48:51], v200 offset:12288
v_mfma_f32_16x16x32_bf16 v[52:55], a[8:11], a[144:147], v[52:55]
ds_read_b128 a[52:55], v200 offset:13312
s_add_u32 m0, s63, 143360
v_mfma_f32_16x16x32_bf16 v[56:59], a[8:11], a[148:151], v[56:59]
ds_read_b128 a[56:59], v200 offset:14336
v_mfma_f32_16x16x32_bf16 v[60:63], a[12:15], a[144:147], v[60:63]
ds_read_b128 a[60:63], v200 offset:15360
s_add_u32 s61, s61, 36864
v_mfma_f32_16x16x32_bf16 v[64:67], a[12:15], a[148:151], v[64:67]
ds_read_b128 a[64:67], v200 offset:16384
v_mfma_f32_16x16x32_bf16 v[68:71], a[16:19], a[144:147], v[68:71]
ds_read_b128 a[68:71], v200 offset:17408
buffer_load_dwordx4 v1, s[8:11], s61 offen offset:0 sc1 lds
v_mfma_f32_16x16x32_bf16 v[72:75], a[16:19], a[148:151], v[72:75]
s_add_u32 m0, s62, 147456
v_exp_f32 v195, v195
v_mfma_f32_16x16x32_bf16 v[76:79], a[20:23], a[144:147], v[76:79]
s_add_u32 s60, s60, 20480
v_fma_f32 v192, v192, v254, v254
v_fma_f32 v193, v193, v254, v254
v_mfma_f32_16x16x32_bf16 v[80:83], a[20:23], a[148:151], v[80:83]
v_fma_f32 v194, v194, v254, v254
v_mfma_f32_16x16x32_bf16 v[84:87], a[24:27], a[144:147], v[84:87]
v_mfma_f32_16x16x32_bf16 v[88:91], a[24:27], a[148:151], v[88:91]
v_fma_f32 v195, v195, v254, v254
v_mfma_f32_16x16x32_bf16 v[92:95], a[28:31], a[144:147], v[92:95]
buffer_load_dwordx4 v1, s[8:11], s60 offen offset:0 sc1 lds
v_mfma_f32_16x16x32_bf16 v[96:99], a[28:31], a[148:151], v[96:99]
v_rcp_f32 v192, v192
v_mfma_f32_16x16x32_bf16 v[100:103], a[32:35], a[144:147], v[100:103]
v_mfma_f32_16x16x32_bf16 v[104:107], a[32:35], a[148:151], v[104:107]
s_waitcnt vmcnt(27) lgkmcnt(0)
v_mfma_f32_16x16x32_bf16 v[36:39], a[36:39], a[152:155], v[36:39]
ds_read_b128 a[0:3], v200 offset:18432
buffer_load_dwordx4 v1, s[8:11], s60 offen offset:1024 sc1 lds
v_mfma_f32_16x16x32_bf16 v[40:43], a[36:39], a[156:159], v[40:43]
ds_read_b128 a[4:7], v200 offset:19456
v_mfma_f32_16x16x32_bf16 v[44:47], a[40:43], a[152:155], v[44:47]
ds_read_b128 a[8:11], v200 offset:20480
v_mfma_f32_16x16x32_bf16 v[48:51], a[40:43], a[156:159], v[48:51]
ds_read_b128 a[12:15], v200 offset:21504
v_mfma_f32_16x16x32_bf16 v[52:55], a[44:47], a[152:155], v[52:55]
ds_read_b128 a[16:19], v200 offset:22528
buffer_load_dwordx4 v1, s[8:11], s60 offen offset:2048 sc1 lds
v_mfma_f32_16x16x32_bf16 v[56:59], a[44:47], a[156:159], v[56:59]
ds_read_b128 a[20:23], v200 offset:23552
v_mfma_f32_16x16x32_bf16 v[60:63], a[48:51], a[152:155], v[60:63]
ds_read_b128 a[24:27], v200 offset:24576
v_mfma_f32_16x16x32_bf16 v[64:67], a[48:51], a[156:159], v[64:67]
ds_read_b128 a[28:31], v200 offset:25600
v_mfma_f32_16x16x32_bf16 v[68:71], a[52:55], a[152:155], v[68:71]
ds_read_b128 a[32:35], v200 offset:26624
buffer_load_dwordx4 v1, s[8:11], s60 offen offset:3072 sc1 lds
v_mfma_f32_16x16x32_bf16 v[72:75], a[52:55], a[156:159], v[72:75]
v_rcp_f32 v193, v193
v_mfma_f32_16x16x32_bf16 v[76:79], a[56:59], a[152:155], v[76:79]
v_rcp_f32 v194, v194
v_mfma_f32_16x16x32_bf16 v[80:83], a[56:59], a[156:159], v[80:83]
v_rcp_f32 v195, v195
v_mfma_f32_16x16x32_bf16 v[84:87], a[60:63], a[152:155], v[84:87]
buffer_load_dwordx4 a[224:227], v1, s[4:7], s52 offen offset:2048 sc1
v_mfma_f32_16x16x32_bf16 v[88:91], a[60:63], a[156:159], v[88:91]
v_mfma_f32_16x16x32_bf16 v[92:95], a[64:67], a[152:155], v[92:95]
v_mfma_f32_16x16x32_bf16 v[96:99], a[64:67], a[156:159], v[96:99]
v_mfma_f32_16x16x32_bf16 v[100:103], a[68:71], a[152:155], v[100:103]
v_mul_f32 v164, v164, v192
v_mfma_f32_16x16x32_bf16 v[104:107], a[68:71], a[156:159], v[104:107]
s_waitcnt lgkmcnt(0)
v_mfma_f32_16x16x32_bf16 v[36:39], a[0:3], a[160:163], v[36:39]
ds_read_b128 a[36:39], v200 offset:27648
buffer_load_dwordx4 a[228:231], v9, s[4:7], s52 offen offset:2048 sc1
v_mfma_f32_16x16x32_bf16 v[40:43], a[0:3], a[164:167], v[40:43]
ds_read_b128 a[40:43], v200 offset:28672
v_mul_f32 v165, v165, v193
v_mfma_f32_16x16x32_bf16 v[44:47], a[4:7], a[160:163], v[44:47]
ds_read_b128 a[44:47], v200 offset:29696
buffer_load_dwordx4 a[232:235], v1, s[4:7], s52 offen offset:3072 sc1
v_mfma_f32_16x16x32_bf16 v[48:51], a[4:7], a[164:167], v[48:51]
ds_read_b128 a[48:51], v200 offset:30720
v_mul_f32 v166, v166, v194
v_mfma_f32_16x16x32_bf16 v[52:55], a[8:11], a[160:163], v[52:55]
ds_read_b128 a[52:55], v200 offset:31744
buffer_load_dwordx4 a[236:239], v9, s[4:7], s52 offen offset:3072 sc1
v_mfma_f32_16x16x32_bf16 v[56:59], a[8:11], a[164:167], v[56:59]
ds_read_b128 a[56:59], v200 offset:32768
v_mul_f32 v167, v167, v195
v_mfma_f32_16x16x32_bf16 v[60:63], a[12:15], a[160:163], v[60:63]
ds_read_b128 a[60:63], v200 offset:33792
v_mfma_f32_16x16x32_bf16 v[64:67], a[12:15], a[164:167], v[64:67]
ds_read_b128 a[64:67], v200 offset:34816
v_mul_f32 v196, v168, v168
v_mfma_f32_16x16x32_bf16 v[68:71], a[16:19], a[160:163], v[68:71]
ds_read_b128 a[68:71], v200 offset:35840
v_mfma_f32_16x16x32_bf16 v[72:75], a[16:19], a[164:167], v[72:75]
s_cmp_eq_u32 s25, 12
s_cselect_b32 s98, 4096, 0
v_mfma_f32_16x16x32_bf16 v[76:79], a[20:23], a[160:163], v[76:79]
s_add_u32 s52, s52, s98
v_mul_f32 v197, v169, v169
v_mfma_f32_16x16x32_bf16 v[80:83], a[20:23], a[164:167], v[80:83]
s_add_u32 s52, s52, 4096
v_mfma_f32_16x16x32_bf16 v[84:87], a[24:27], a[160:163], v[84:87]
v_mul_f32 v198, v170, v170
v_mfma_f32_16x16x32_bf16 v[88:91], a[24:27], a[164:167], v[88:91]
v_mfma_f32_16x16x32_bf16 v[92:95], a[28:31], a[160:163], v[92:95]
buffer_load_dwordx4 a[240:243], v1, s[4:7], s52 offen offset:0 sc1
v_mul_f32 v199, v171, v171
v_mfma_f32_16x16x32_bf16 v[96:99], a[28:31], a[164:167], v[96:99]
v_mfma_f32_16x16x32_bf16 v[100:103], a[32:35], a[160:163], v[100:103]
v_mfma_f32_16x16x32_bf16 v[104:107], a[32:35], a[164:167], v[104:107]
s_waitcnt vmcnt(22) lgkmcnt(0)
s_barrier
v_mfma_f32_16x16x32_bf16 v[36:39], a[36:39], a[168:171], v[36:39]
ds_read_b128 a[0:3], v201 offset:0
buffer_load_dwordx4 a[244:247], v9, s[4:7], s52 offen offset:0 sc1
v_mfma_f32_16x16x32_bf16 v[40:43], a[36:39], a[172:175], v[40:43]
ds_read_b128 a[4:7], v201 offset:1024
buffer_load_dwordx4 a[248:251], v1, s[4:7], s52 offen offset:1024 sc1
v_mfma_f32_16x16x32_bf16 v[44:47], a[40:43], a[168:171], v[44:47]
ds_read_b128 a[8:11], v201 offset:2048
v_fma_f32 v196, v196, v253, v251
v_mfma_f32_16x16x32_bf16 v[48:51], a[40:43], a[172:175], v[48:51]
ds_read_b128 a[12:15], v201 offset:3072
buffer_load_dwordx4 a[252:255], v9, s[4:7], s52 offen offset:1024 sc1
v_mfma_f32_16x16x32_bf16 v[52:55], a[44:47], a[168:171], v[52:55]
ds_read_b128 a[16:19], v201 offset:4096
v_fma_f32 v197, v197, v253, v251
v_mfma_f32_16x16x32_bf16 v[56:59], a[44:47], a[172:175], v[56:59]
ds_read_b128 a[20:23], v201 offset:5120
v_fma_f32 v198, v198, v253, v251
v_mfma_f32_16x16x32_bf16 v[60:63], a[48:51], a[168:171], v[60:63]
ds_read_b128 a[24:27], v201 offset:6144
v_fma_f32 v199, v199, v253, v251
v_mfma_f32_16x16x32_bf16 v[64:67], a[48:51], a[172:175], v[64:67]
ds_read_b128 a[28:31], v201 offset:7168
v_mfma_f32_16x16x32_bf16 v[68:71], a[52:55], a[168:171], v[68:71]
ds_read_b128 a[32:35], v201 offset:8192
v_mul_f32 v196, v196, v168
v_mfma_f32_16x16x32_bf16 v[72:75], a[52:55], a[172:175], v[72:75]
s_cmp_eq_u32 s25, 12
s_cselect_b32 s99, 36864, 0
s_add_u32 s60, s60, s99
v_mfma_f32_16x16x32_bf16 v[76:79], a[56:59], a[168:171], v[76:79]
s_add_u32 s61, s61, s99
v_mul_f32 v197, v197, v169
v_mfma_f32_16x16x32_bf16 v[80:83], a[56:59], a[172:175], v[80:83]
s_add_u32 m0, s62, 53248
v_mfma_f32_16x16x32_bf16 v[84:87], a[60:63], a[168:171], v[84:87]
s_add_u32 s60, s60, 16384
v_mfma_f32_16x16x32_bf16 v[88:91], a[60:63], a[172:175], v[88:91]
v_mul_f32 v198, v198, v170
v_mfma_f32_16x16x32_bf16 v[92:95], a[64:67], a[168:171], v[92:95]
v_mfma_f32_16x16x32_bf16 v[96:99], a[64:67], a[172:175], v[96:99]
buffer_load_dwordx4 v1, s[8:11], s60 offen offset:0 sc1 lds
v_mul_f32 v199, v199, v171
v_mfma_f32_16x16x32_bf16 v[100:103], a[68:71], a[168:171], v[100:103]
v_mfma_f32_16x16x32_bf16 v[104:107], a[68:71], a[172:175], v[104:107]
s_waitcnt lgkmcnt(0)
v_mfma_f32_16x16x32_bf16 v[36:39], a[0:3], a[176:179], v[36:39]
ds_read_b128 a[36:39], v201 offset:9216
buffer_load_dwordx4 v1, s[8:11], s60 offen offset:1024 sc1 lds
v_mfma_f32_16x16x32_bf16 v[40:43], a[0:3], a[180:183], v[40:43]
ds_read_b128 a[40:43], v201 offset:10240
v_mfma_f32_16x16x32_bf16 v[44:47], a[4:7], a[176:179], v[44:47]
ds_read_b128 a[44:47], v201 offset:11264
buffer_load_dwordx4 v1, s[8:11], s60 offen offset:2048 sc1 lds
v_mfma_f32_16x16x32_bf16 v[48:51], a[4:7], a[180:183], v[48:51]
ds_read_b128 a[48:51], v201 offset:12288
v_mfma_f32_16x16x32_bf16 v[52:55], a[8:11], a[176:179], v[52:55]
ds_read_b128 a[52:55], v201 offset:13312
v_mfma_f32_16x16x32_bf16 v[56:59], a[8:11], a[180:183], v[56:59]
ds_read_b128 a[56:59], v201 offset:14336
buffer_load_dwordx4 v1, s[8:11], s60 offen offset:3072 sc1 lds
v_mfma_f32_16x16x32_bf16 v[60:63], a[12:15], a[176:179], v[60:63]
ds_read_b128 a[60:63], v201 offset:15360
v_mfma_f32_16x16x32_bf16 v[64:67], a[12:15], a[180:183], v[64:67]
ds_read_b128 a[64:67], v201 offset:16384
v_mfma_f32_16x16x32_bf16 v[68:71], a[16:19], a[176:179], v[68:71]
ds_read_b128 a[68:71], v201 offset:17408
s_add_u32 m0, s63, 69632
v_mfma_f32_16x16x32_bf16 v[72:75], a[16:19], a[180:183], v[72:75]
s_add_u32 s61, s61, 36864
v_exp_f32 v196, v196
v_mfma_f32_16x16x32_bf16 v[76:79], a[20:23], a[176:179], v[76:79]
v_exp_f32 v197, v197
v_mfma_f32_16x16x32_bf16 v[80:83], a[20:23], a[180:183], v[80:83]
v_exp_f32 v198, v198
v_mfma_f32_16x16x32_bf16 v[84:87], a[24:27], a[176:179], v[84:87]
v_mfma_f32_16x16x32_bf16 v[88:91], a[24:27], a[180:183], v[88:91]
v_mfma_f32_16x16x32_bf16 v[92:95], a[28:31], a[176:179], v[92:95]
buffer_load_dwordx4 v1, s[8:11], s61 offen offset:0 sc1 lds
v_mfma_f32_16x16x32_bf16 v[96:99], a[28:31], a[180:183], v[96:99]
v_exp_f32 v199, v199
v_mfma_f32_16x16x32_bf16 v[100:103], a[32:35], a[176:179], v[100:103]
v_mfma_f32_16x16x32_bf16 v[104:107], a[32:35], a[180:183], v[104:107]
s_waitcnt vmcnt(26) lgkmcnt(0)
v_mfma_f32_16x16x32_bf16 v[36:39], a[36:39], a[184:187], v[36:39]
ds_read_b128 a[0:3], v201 offset:18432
s_add_u32 m0, s62, 73728
v_mfma_f32_16x16x32_bf16 v[40:43], a[36:39], a[188:191], v[40:43]
ds_read_b128 a[4:7], v201 offset:19456
v_fma_f32 v196, v196, v255, v255
v_mfma_f32_16x16x32_bf16 v[44:47], a[40:43], a[184:187], v[44:47]
ds_read_b128 a[8:11], v201 offset:20480
s_add_u32 s60, s60, 20480
v_mfma_f32_16x16x32_bf16 v[48:51], a[40:43], a[188:191], v[48:51]
ds_read_b128 a[12:15], v201 offset:21504
v_fma_f32 v197, v197, v255, v255
v_mfma_f32_16x16x32_bf16 v[52:55], a[44:47], a[184:187], v[52:55]
ds_read_b128 a[16:19], v201 offset:22528
v_mfma_f32_16x16x32_bf16 v[56:59], a[44:47], a[188:191], v[56:59]
ds_read_b128 a[20:23], v201 offset:23552
buffer_load_dwordx4 v1, s[8:11], s60 offen offset:0 sc1 lds
v_mfma_f32_16x16x32_bf16 v[60:63], a[48:51], a[184:187], v[60:63]
ds_read_b128 a[24:27], v201 offset:24576
v_fma_f32 v198, v198, v255, v255
v_mfma_f32_16x16x32_bf16 v[64:67], a[48:51], a[188:191], v[64:67]
ds_read_b128 a[28:31], v201 offset:25600
v_fma_f32 v199, v199, v255, v255
v_mfma_f32_16x16x32_bf16 v[68:71], a[52:55], a[184:187], v[68:71]
ds_read_b128 a[32:35], v201 offset:26624
buffer_load_dwordx4 v1, s[8:11], s60 offen offset:1024 sc1 lds
v_mfma_f32_16x16x32_bf16 v[72:75], a[52:55], a[188:191], v[72:75]
v_mfma_f32_16x16x32_bf16 v[76:79], a[56:59], a[184:187], v[76:79]
v_rcp_f32 v196, v196
v_mfma_f32_16x16x32_bf16 v[80:83], a[56:59], a[188:191], v[80:83]
buffer_load_dwordx4 v1, s[8:11], s60 offen offset:2048 sc1 lds
v_mfma_f32_16x16x32_bf16 v[84:87], a[60:63], a[184:187], v[84:87]
v_mfma_f32_16x16x32_bf16 v[88:91], a[60:63], a[188:191], v[88:91]
v_mfma_f32_16x16x32_bf16 v[92:95], a[64:67], a[184:187], v[92:95]
buffer_load_dwordx4 v1, s[8:11], s60 offen offset:3072 sc1 lds
v_mfma_f32_16x16x32_bf16 v[96:99], a[64:67], a[188:191], v[96:99]
v_rcp_f32 v197, v197
v_mfma_f32_16x16x32_bf16 v[100:103], a[68:71], a[184:187], v[100:103]
v_mfma_f32_16x16x32_bf16 v[104:107], a[68:71], a[188:191], v[104:107]
s_waitcnt lgkmcnt(0)
v_mfma_f32_16x16x32_bf16 v[36:39], a[0:3], a[192:195], v[36:39]
ds_read_b128 a[36:39], v201 offset:27648
buffer_load_dwordx4 a[80:83], v1, s[4:7], s52 offen offset:2048 sc1
v_mfma_f32_16x16x32_bf16 v[40:43], a[0:3], a[196:199], v[40:43]
ds_read_b128 a[40:43], v201 offset:28672
s_mov_b32 s37, L_c5-L_pc
v_mfma_f32_16x16x32_bf16 v[44:47], a[4:7], a[192:195], v[44:47]
ds_read_b128 a[44:47], v201 offset:29696
v_mfma_f32_16x16x32_bf16 v[48:51], a[4:7], a[196:199], v[48:51]
ds_read_b128 a[48:51], v201 offset:30720
v_mfma_f32_16x16x32_bf16 v[52:55], a[8:11], a[192:195], v[52:55]
ds_read_b128 a[52:55], v201 offset:31744
buffer_load_dwordx4 a[84:87], v9, s[4:7], s52 offen offset:2048 sc1
v_mfma_f32_16x16x32_bf16 v[56:59], a[8:11], a[196:199], v[56:59]
ds_read_b128 a[56:59], v201 offset:32768
buffer_load_dword v15, v14, s[88:91], s37 offen
v_mfma_f32_16x16x32_bf16 v[60:63], a[12:15], a[192:195], v[60:63]
ds_read_b128 a[60:63], v201 offset:33792
v_mfma_f32_16x16x32_bf16 v[64:67], a[12:15], a[196:199], v[64:67]
ds_read_b128 a[64:67], v201 offset:34816
v_mfma_f32_16x16x32_bf16 v[68:71], a[16:19], a[192:195], v[68:71]
ds_read_b128 a[68:71], v201 offset:35840
buffer_load_dwordx4 a[88:91], v1, s[4:7], s52 offen offset:3072 sc1
v_mfma_f32_16x16x32_bf16 v[72:75], a[16:19], a[196:199], v[72:75]
v_rcp_f32 v198, v198
v_mfma_f32_16x16x32_bf16 v[76:79], a[20:23], a[192:195], v[76:79]
v_rcp_f32 v199, v199
v_mfma_f32_16x16x32_bf16 v[80:83], a[20:23], a[196:199], v[80:83]
v_mul_f32 v168, v168, v196
v_mfma_f32_16x16x32_bf16 v[84:87], a[24:27], a[192:195], v[84:87]
buffer_load_dwordx4 a[92:95], v9, s[4:7], s52 offen offset:3072 sc1
v_mfma_f32_16x16x32_bf16 v[88:91], a[24:27], a[196:199], v[88:91]
v_mul_f32 v169, v169, v197
v_mfma_f32_16x16x32_bf16 v[92:95], a[28:31], a[192:195], v[92:95]
v_mfma_f32_16x16x32_bf16 v[96:99], a[28:31], a[196:199], v[96:99]
v_mul_f32 v170, v170, v198
v_mfma_f32_16x16x32_bf16 v[100:103], a[32:35], a[192:195], v[100:103]
v_mfma_f32_16x16x32_bf16 v[104:107], a[32:35], a[196:199], v[104:107]
s_waitcnt vmcnt(22) lgkmcnt(0)
s_barrier
v_mfma_f32_16x16x32_bf16 v[36:39], a[36:39], a[200:203], v[36:39]
ds_read_b128 a[0:3], v202 offset:0
v_mul_f32 v171, v171, v199
v_mfma_f32_16x16x32_bf16 v[40:43], a[36:39], a[204:207], v[40:43]
ds_read_b128 a[4:7], v202 offset:1024
v_mfma_f32_16x16x32_bf16 v[44:47], a[40:43], a[200:203], v[44:47]
ds_read_b128 a[8:11], v202 offset:2048
v_mul_f32 v192, v172, v172
v_mfma_f32_16x16x32_bf16 v[48:51], a[40:43], a[204:207], v[48:51]
ds_read_b128 a[12:15], v202 offset:3072
v_mfma_f32_16x16x32_bf16 v[52:55], a[44:47], a[200:203], v[52:55]
ds_read_b128 a[16:19], v202 offset:4096
v_mul_f32 v193, v173, v173
v_mfma_f32_16x16x32_bf16 v[56:59], a[44:47], a[204:207], v[56:59]
ds_read_b128 a[20:23], v202 offset:5120
v_mfma_f32_16x16x32_bf16 v[60:63], a[48:51], a[200:203], v[60:63]
ds_read_b128 a[24:27], v202 offset:6144
v_mfma_f32_16x16x32_bf16 v[64:67], a[48:51], a[204:207], v[64:67]
ds_read_b128 a[28:31], v202 offset:7168
v_mul_f32 v194, v174, v174
v_mfma_f32_16x16x32_bf16 v[68:71], a[52:55], a[200:203], v[68:71]
ds_read_b128 a[32:35], v202 offset:8192
v_mfma_f32_16x16x32_bf16 v[72:75], a[52:55], a[204:207], v[72:75]
s_cmp_eq_u32 s25, 13
s_cselect_b32 s99, 36864, 0
s_add_u32 s60, s60, s99
v_mfma_f32_16x16x32_bf16 v[76:79], a[56:59], a[200:203], v[76:79]
s_add_u32 s61, s61, s99
s_add_u32 m0, s62, 90112
s_add_u32 s60, s60, 16384
v_mfma_f32_16x16x32_bf16 v[80:83], a[56:59], a[204:207], v[80:83]
buffer_load_dwordx4 v1, s[8:11], s60 offen offset:0 sc1 lds
v_mul_f32 v195, v175, v175
v_mfma_f32_16x16x32_bf16 v[84:87], a[60:63], a[200:203], v[84:87]
buffer_load_dwordx4 v1, s[8:11], s60 offen offset:1024 sc1 lds
v_fma_f32 v192, v192, v252, v250
v_mfma_f32_16x16x32_bf16 v[88:91], a[60:63], a[204:207], v[88:91]
buffer_load_dwordx4 v1, s[8:11], s60 offen offset:2048 sc1 lds
v_mfma_f32_16x16x32_bf16 v[92:95], a[64:67], a[200:203], v[92:95]
v_fma_f32 v193, v193, v252, v250
v_mfma_f32_16x16x32_bf16 v[96:99], a[64:67], a[204:207], v[96:99]
buffer_load_dwordx4 v1, s[8:11], s60 offen offset:3072 sc1 lds
v_mfma_f32_16x16x32_bf16 v[100:103], a[68:71], a[200:203], v[100:103]
v_fma_f32 v194, v194, v252, v250
v_mfma_f32_16x16x32_bf16 v[104:107], a[68:71], a[204:207], v[104:107]
s_waitcnt lgkmcnt(0)
v_mfma_f32_16x16x32_bf16 v[36:39], a[0:3], a[208:211], v[36:39]
ds_read_b128 a[36:39], v202 offset:9216
s_add_u32 m0, s63, 106496
v_mfma_f32_16x16x32_bf16 v[40:43], a[0:3], a[212:215], v[40:43]
ds_read_b128 a[40:43], v202 offset:10240
v_fma_f32 v195, v195, v252, v250
v_mfma_f32_16x16x32_bf16 v[44:47], a[4:7], a[208:211], v[44:47]
ds_read_b128 a[44:47], v202 offset:11264
s_add_u32 s61, s61, 36864
v_mfma_f32_16x16x32_bf16 v[48:51], a[4:7], a[212:215], v[48:51]
ds_read_b128 a[48:51], v202 offset:12288
v_mul_f32 v192, v192, v172
v_mfma_f32_16x16x32_bf16 v[52:55], a[8:11], a[208:211], v[52:55]
ds_read_b128 a[52:55], v202 offset:13312
buffer_load_dwordx4 v1, s[8:11], s61 offen offset:0 sc1 lds
v_mfma_f32_16x16x32_bf16 v[56:59], a[8:11], a[212:215], v[56:59]
ds_read_b128 a[56:59], v202 offset:14336
v_mul_f32 v193, v193, v173
v_mfma_f32_16x16x32_bf16 v[60:63], a[12:15], a[208:211], v[60:63]
ds_read_b128 a[60:63], v202 offset:15360
s_add_u32 m0, s62, 110592
v_mfma_f32_16x16x32_bf16 v[64:67], a[12:15], a[212:215], v[64:67]
ds_read_b128 a[64:67], v202 offset:16384
v_mfma_f32_16x16x32_bf16 v[68:71], a[16:19], a[208:211], v[68:71]
ds_read_b128 a[68:71], v202 offset:17408
s_add_u32 s60, s60, 20480
v_mfma_f32_16x16x32_bf16 v[72:75], a[16:19], a[212:215], v[72:75]
v_mul_f32 v194, v194, v174
v_mfma_f32_16x16x32_bf16 v[76:79], a[20:23], a[208:211], v[76:79]
buffer_load_dwordx4 v1, s[8:11], s60 offen offset:0 sc1 lds
v_mul_f32 v195, v195, v175
v_mfma_f32_16x16x32_bf16 v[80:83], a[20:23], a[212:215], v[80:83]
v_mfma_f32_16x16x32_bf16 v[84:87], a[24:27], a[208:211], v[84:87]
buffer_load_dwordx4 v1, s[8:11], s60 offen offset:1024 sc1 lds
v_mfma_f32_16x16x32_bf16 v[88:91], a[24:27], a[212:215], v[88:91]
v_exp_f32 v192, v192
v_mfma_f32_16x16x32_bf16 v[92:95], a[28:31], a[208:211], v[92:95]
buffer_load_dwordx4 v1, s[8:11], s60 offen offset:2048 sc1 lds
v_mfma_f32_16x16x32_bf16 v[96:99], a[28:31], a[212:215], v[96:99]
v_mfma_f32_16x16x32_bf16 v[100:103], a[32:35], a[208:211], v[100:103]
v_mfma_f32_16x16x32_bf16 v[104:107], a[32:35], a[212:215], v[104:107]
s_waitcnt vmcnt(26) lgkmcnt(0)
v_mfma_f32_16x16x32_bf16 v[36:39], a[36:39], a[216:219], v[36:39]
ds_read_b128 a[0:3], v202 offset:18432
buffer_load_dwordx4 v1, s[8:11], s60 offen offset:3072 sc1 lds
v_mfma_f32_16x16x32_bf16 v[40:43], a[36:39], a[220:223], v[40:43]
ds_read_b128 a[4:7], v202 offset:19456
v_mfma_f32_16x16x32_bf16 v[44:47], a[40:43], a[216:219], v[44:47]
ds_read_b128 a[8:11], v202 offset:20480
v_mfma_f32_16x16x32_bf16 v[48:51], a[40:43], a[220:223], v[48:51]
ds_read_b128 a[12:15], v202 offset:21504
v_mfma_f32_16x16x32_bf16 v[52:55], a[44:47], a[216:219], v[52:55]
ds_read_b128 a[16:19], v202 offset:22528
v_mfma_f32_16x16x32_bf16 v[56:59], a[44:47], a[220:223], v[56:59]
ds_read_b128 a[20:23], v202 offset:23552
v_mfma_f32_16x16x32_bf16 v[60:63], a[48:51], a[216:219], v[60:63]
ds_read_b128 a[24:27], v202 offset:24576
v_mfma_f32_16x16x32_bf16 v[64:67], a[48:51], a[220:223], v[64:67]
ds_read_b128 a[28:31], v202 offset:25600
v_mfma_f32_16x16x32_bf16 v[68:71], a[52:55], a[216:219], v[68:71]
ds_read_b128 a[32:35], v202 offset:26624
v_mfma_f32_16x16x32_bf16 v[72:75], a[52:55], a[220:223], v[72:75]
s_cmp_eq_u32 s25, 13
s_cselect_b32 s98, 4096, 0
s_add_u32 s52, s52, s98
v_mfma_f32_16x16x32_bf16 v[76:79], a[56:59], a[216:219], v[76:79]
s_add_u32 s52, s52, 4096
v_exp_f32 v193, v193
v_mfma_f32_16x16x32_bf16 v[80:83], a[56:59], a[220:223], v[80:83]
buffer_load_dwordx4 a[96:99], v1, s[4:7], s52 offen offset:0 sc1
v_mfma_f32_16x16x32_bf16 v[84:87], a[60:63], a[216:219], v[84:87]
buffer_load_dwordx4 a[100:103], v9, s[4:7], s52 offen offset:0 sc1
v_mfma_f32_16x16x32_bf16 v[88:91], a[60:63], a[220:223], v[88:91]
v_exp_f32 v194, v194
v_mfma_f32_16x16x32_bf16 v[92:95], a[64:67], a[216:219], v[92:95]
buffer_load_dwordx4 a[104:107], v1, s[4:7], s52 offen offset:1024 sc1
v_mfma_f32_16x16x32_bf16 v[96:99], a[64:67], a[220:223], v[96:99]
v_exp_f32 v195, v195
v_mfma_f32_16x16x32_bf16 v[100:103], a[68:71], a[216:219], v[100:103]
v_fma_f32 v192, v192, v254, v254
v_fma_f32 v193, v193, v254, v254
v_mfma_f32_16x16x32_bf16 v[104:107], a[68:71], a[220:223], v[104:107]
s_waitcnt lgkmcnt(0)
v_mfma_f32_16x16x32_bf16 v[36:39], a[0:3], a[224:227], v[36:39]
ds_read_b128 a[36:39], v202 offset:27648
buffer_load_dwordx4 a[108:111], v9, s[4:7], s52 offen offset:1024 sc1
v_mfma_f32_16x16x32_bf16 v[40:43], a[0:3], a[228:231], v[40:43]
ds_read_b128 a[40:43], v202 offset:28672
v_fma_f32 v194, v194, v254, v254
v_mfma_f32_16x16x32_bf16 v[44:47], a[4:7], a[224:227], v[44:47]
ds_read_b128 a[44:47], v202 offset:29696
v_fma_f32 v195, v195, v254, v254
v_mfma_f32_16x16x32_bf16 v[48:51], a[4:7], a[228:231], v[48:51]
ds_read_b128 a[48:51], v202 offset:30720
v_mfma_f32_16x16x32_bf16 v[52:55], a[8:11], a[224:227], v[52:55]
ds_read_b128 a[52:55], v202 offset:31744
buffer_load_dwordx4 a[112:115], v1, s[4:7], s52 offen offset:2048 sc1
v_mfma_f32_16x16x32_bf16 v[56:59], a[8:11], a[228:231], v[56:59]
ds_read_b128 a[56:59], v202 offset:32768
v_mfma_f32_16x16x32_bf16 v[60:63], a[12:15], a[224:227], v[60:63]
ds_read_b128 a[60:63], v202 offset:33792
v_mfma_f32_16x16x32_bf16 v[64:67], a[12:15], a[228:231], v[64:67]
ds_read_b128 a[64:67], v202 offset:34816
v_mfma_f32_16x16x32_bf16 v[68:71], a[16:19], a[224:227], v[68:71]
ds_read_b128 a[68:71], v202 offset:35840
buffer_load_dwordx4 a[116:119], v9, s[4:7], s52 offen offset:2048 sc1
v_mfma_f32_16x16x32_bf16 v[72:75], a[16:19], a[228:231], v[72:75]
v_rcp_f32 v192, v192
v_mfma_f32_16x16x32_bf16 v[76:79], a[20:23], a[224:227], v[76:79]
v_rcp_f32 v193, v193
v_mfma_f32_16x16x32_bf16 v[80:83], a[20:23], a[228:231], v[80:83]
v_mfma_f32_16x16x32_bf16 v[84:87], a[24:27], a[224:227], v[84:87]
buffer_load_dwordx4 a[120:123], v1, s[4:7], s52 offen offset:3072 sc1
v_mfma_f32_16x16x32_bf16 v[88:91], a[24:27], a[228:231], v[88:91]
v_mfma_f32_16x16x32_bf16 v[92:95], a[28:31], a[224:227], v[92:95]
v_rcp_f32 v194, v194
v_mfma_f32_16x16x32_bf16 v[96:99], a[28:31], a[228:231], v[96:99]
v_mfma_f32_16x16x32_bf16 v[100:103], a[32:35], a[224:227], v[100:103]
v_mfma_f32_16x16x32_bf16 v[104:107], a[32:35], a[228:231], v[104:107]
s_waitcnt vmcnt(21) lgkmcnt(0)
s_barrier
v_mfma_f32_16x16x32_bf16 v[36:39], a[36:39], a[232:235], v[36:39]
ds_read_b128 a[0:3], v200 offset:0
buffer_load_dwordx4 a[124:127], v9, s[4:7], s52 offen offset:3072 sc1
v_mfma_f32_16x16x32_bf16 v[40:43], a[36:39], a[236:239], v[40:43]
ds_read_b128 a[4:7], v200 offset:1024
v_mfma_f32_16x16x32_bf16 v[44:47], a[40:43], a[232:235], v[44:47]
ds_read_b128 a[8:11], v200 offset:2048
v_mfma_f32_16x16x32_bf16 v[48:51], a[40:43], a[236:239], v[48:51]
ds_read_b128 a[12:15], v200 offset:3072
v_mfma_f32_16x16x32_bf16 v[52:55], a[44:47], a[232:235], v[52:55]
ds_read_b128 a[16:19], v200 offset:4096
v_mfma_f32_16x16x32_bf16 v[56:59], a[44:47], a[236:239], v[56:59]
ds_read_b128 a[20:23], v200 offset:5120
v_mfma_f32_16x16x32_bf16 v[60:63], a[48:51], a[232:235], v[60:63]
ds_read_b128 a[24:27], v200 offset:6144
v_mfma_f32_16x16x32_bf16 v[64:67], a[48:51], a[236:239], v[64:67]
ds_read_b128 a[28:31], v200 offset:7168
v_mfma_f32_16x16x32_bf16 v[68:71], a[52:55], a[232:235], v[68:71]
ds_read_b128 a[32:35], v200 offset:8192
v_mfma_f32_16x16x32_bf16 v[72:75], a[52:55], a[236:239], v[72:75]
s_cmp_eq_u32 s25, 14
s_cselect_b32 s99, 36864, 0
s_add_u32 s60, s60, s99
v_mfma_f32_16x16x32_bf16 v[76:79], a[56:59], a[232:235], v[76:79]
s_add_u32 s61, s61, s99
s_add_u32 m0, s62, 126976
s_add_u32 s60, s60, 16384
v_mfma_f32_16x16x32_bf16 v[80:83], a[56:59], a[236:239], v[80:83]
buffer_load_dwordx4 v1, s[8:11], s60 offen offset:0 sc1 lds
v_mfma_f32_16x16x32_bf16 v[84:87], a[60:63], a[232:235], v[84:87]
v_rcp_f32 v195, v195
v_mfma_f32_16x16x32_bf16 v[88:91], a[60:63], a[236:239], v[88:91]
buffer_load_dwordx4 v1, s[8:11], s60 offen offset:1024 sc1 lds
v_mul_f32 v172, v172, v192
v_mfma_f32_16x16x32_bf16 v[92:95], a[64:67], a[232:235], v[92:95]
v_mul_f32 v173, v173, v193
v_mul_f32 v174, v174, v194
v_mfma_f32_16x16x32_bf16 v[96:99], a[64:67], a[236:239], v[96:99]
buffer_load_dwordx4 v1, s[8:11], s60 offen offset:2048 sc1 lds
v_mul_f32 v175, v175, v195
v_mfma_f32_16x16x32_bf16 v[100:103], a[68:71], a[232:235], v[100:103]
v_mul_f32 v196, v176, v176
v_mfma_f32_16x16x32_bf16 v[104:107], a[68:71], a[236:239], v[104:107]
v_mul_f32 v197, v177, v177
s_waitcnt lgkmcnt(0)
v_mfma_f32_16x16x32_bf16 v[36:39], a[0:3], a[240:243], v[36:39]
ds_read_b128 a[36:39], v200 offset:9216
buffer_load_dwordx4 v1, s[8:11], s60 offen offset:3072 sc1 lds
v_mfma_f32_16x16x32_bf16 v[40:43], a[0:3], a[244:247], v[40:43]
ds_read_b128 a[40:43], v200 offset:10240
v_mfma_f32_16x16x32_bf16 v[44:47], a[4:7], a[240:243], v[44:47]
ds_read_b128 a[44:47], v200 offset:11264
s_add_u32 m0, s63, 143360
v_mfma_f32_16x16x32_bf16 v[48:51], a[4:7], a[244:247], v[48:51]
ds_read_b128 a[48:51], v200 offset:12288
v_mul_f32 v198, v178, v178
v_mfma_f32_16x16x32_bf16 v[52:55], a[8:11], a[240:243], v[52:55]
ds_read_b128 a[52:55], v200 offset:13312
s_add_u32 s61, s61, 36864
v_mfma_f32_16x16x32_bf16 v[56:59], a[8:11], a[244:247], v[56:59]
ds_read_b128 a[56:59], v200 offset:14336
v_mul_f32 v199, v179, v179
v_mfma_f32_16x16x32_bf16 v[60:63], a[12:15], a[240:243], v[60:63]
ds_read_b128 a[60:63], v200 offset:15360
buffer_load_dwordx4 v1, s[8:11], s61 offen offset:0 sc1 lds
v_mfma_f32_16x16x32_bf16 v[64:67], a[12:15], a[244:247], v[64:67]
ds_read_b128 a[64:67], v200 offset:16384
v_fma_f32 v196, v196, v253, v251
v_mfma_f32_16x16x32_bf16 v[68:71], a[16:19], a[240:243], v[68:71]
ds_read_b128 a[68:71], v200 offset:17408
s_add_u32 m0, s62, 147456
v_mfma_f32_16x16x32_bf16 v[72:75], a[16:19], a[244:247], v[72:75]
s_add_u32 s60, s60, 20480
v_fma_f32 v197, v197, v253, v251
v_mfma_f32_16x16x32_bf16 v[76:79], a[20:23], a[240:243], v[76:79]
v_mfma_f32_16x16x32_bf16 v[80:83], a[20:23], a[244:247], v[80:83]
v_fma_f32 v198, v198, v253, v251
v_mfma_f32_16x16x32_bf16 v[84:87], a[24:27], a[240:243], v[84:87]
buffer_load_dwordx4 v1, s[8:11], s60 offen offset:0 sc1 lds
v_mfma_f32_16x16x32_bf16 v[88:91], a[24:27], a[244:247], v[88:91]
v_fma_f32 v199, v199, v253, v251
v_mfma_f32_16x16x32_bf16 v[92:95], a[28:31], a[240:243], v[92:95]
buffer_load_dwordx4 v1, s[8:11], s60 offen offset:1024 sc1 lds
v_mfma_f32_16x16x32_bf16 v[96:99], a[28:31], a[244:247], v[96:99]
v_mfma_f32_16x16x32_bf16 v[100:103], a[32:35], a[240:243], v[100:103]
v_mul_f32 v196, v196, v176
v_mfma_f32_16x16x32_bf16 v[104:107], a[32:35], a[244:247], v[104:107]
s_waitcnt vmcnt(24) lgkmcnt(0)
v_mfma_f32_16x16x32_bf16 v[36:39], a[36:39], a[248:251], v[36:39]
ds_read_b128 a[0:3], v200 offset:18432
buffer_load_dwordx4 v1, s[8:11], s60 offen offset:2048 sc1 lds
v_mfma_f32_16x16x32_bf16 v[40:43], a[36:39], a[252:255], v[40:43]
ds_read_b128 a[4:7], v200 offset:19456
v_mul_f32 v197, v197, v177
v_mfma_f32_16x16x32_bf16 v[44:47], a[40:43], a[248:251], v[44:47]
ds_read_b128 a[8:11], v200 offset:20480
buffer_load_dwordx4 v1, s[8:11], s60 offen offset:3072 sc1 lds
v_mfma_f32_16x16x32_bf16 v[48:51], a[40:43], a[252:255], v[48:51]
ds_read_b128 a[12:15], v200 offset:21504
v_mul_f32 v198, v198, v178
v_mfma_f32_16x16x32_bf16 v[52:55], a[44:47], a[248:251], v[52:55]
ds_read_b128 a[16:19], v200 offset:22528
v_mfma_f32_16x16x32_bf16 v[56:59], a[44:47], a[252:255], v[56:59]
ds_read_b128 a[20:23], v200 offset:23552
v_mul_f32 v199, v199, v179
v_mfma_f32_16x16x32_bf16 v[60:63], a[48:51], a[248:251], v[60:63]
ds_read_b128 a[24:27], v200 offset:24576
v_mfma_f32_16x16x32_bf16 v[64:67], a[48:51], a[252:255], v[64:67]
ds_read_b128 a[28:31], v200 offset:25600
v_mfma_f32_16x16x32_bf16 v[68:71], a[52:55], a[248:251], v[68:71]
ds_read_b128 a[32:35], v200 offset:26624
v_mfma_f32_16x16x32_bf16 v[72:75], a[52:55], a[252:255], v[72:75]
s_cmp_eq_u32 s25, 14
s_cselect_b32 s98, 4096, 0
s_add_u32 s52, s52, s98
v_mfma_f32_16x16x32_bf16 v[76:79], a[56:59], a[248:251], v[76:79]
s_add_u32 s52, s52, 4096
v_exp_f32 v196, v196
v_mfma_f32_16x16x32_bf16 v[80:83], a[56:59], a[252:255], v[80:83]
v_mfma_f32_16x16x32_bf16 v[84:87], a[60:63], a[248:251], v[84:87]
buffer_load_dwordx4 a[128:131], v1, s[4:7], s52 offen offset:0 sc1
v_mfma_f32_16x16x32_bf16 v[88:91], a[60:63], a[252:255], v[88:91]
v_exp_f32 v197, v197
v_mfma_f32_16x16x32_bf16 v[92:95], a[64:67], a[248:251], v[92:95]
buffer_load_dwordx4 a[132:135], v9, s[4:7], s52 offen offset:0 sc1
v_mfma_f32_16x16x32_bf16 v[96:99], a[64:67], a[252:255], v[96:99]
v_mfma_f32_16x16x32_bf16 v[100:103], a[68:71], a[248:251], v[100:103]
v_mfma_f32_16x16x32_bf16 v[104:107], a[68:71], a[252:255], v[104:107]
s_waitcnt lgkmcnt(0)
v_mfma_f32_16x16x32_bf16 v[36:39], a[0:3], a[80:83], v[36:39]
ds_read_b128 a[36:39], v200 offset:27648
buffer_load_dwordx4 a[136:139], v1, s[4:7], s52 offen offset:1024 sc1
v_mfma_f32_16x16x32_bf16 v[40:43], a[0:3], a[84:87], v[40:43]
ds_read_b128 a[40:43], v200 offset:28672
v_mfma_f32_16x16x32_bf16 v[44:47], a[4:7], a[80:83], v[44:47]
ds_read_b128 a[44:47], v200 offset:29696
v_mfma_f32_16x16x32_bf16 v[48:51], a[4:7], a[84:87], v[48:51]
ds_read_b128 a[48:51], v200 offset:30720
v_mfma_f32_16x16x32_bf16 v[52:55], a[8:11], a[80:83], v[52:55]
ds_read_b128 a[52:55], v200 offset:31744
buffer_load_dwordx4 a[140:143], v9, s[4:7], s52 offen offset:1024 sc1
v_mfma_f32_16x16x32_bf16 v[56:59], a[8:11], a[84:87], v[56:59]
ds_read_b128 a[56:59], v200 offset:32768
v_mfma_f32_16x16x32_bf16 v[60:63], a[12:15], a[80:83], v[60:63]
ds_read_b128 a[60:63], v200 offset:33792
v_mfma_f32_16x16x32_bf16 v[64:67], a[12:15], a[84:87], v[64:67]
ds_read_b128 a[64:67], v200 offset:34816
v_mfma_f32_16x16x32_bf16 v[68:71], a[16:19], a[80:83], v[68:71]
ds_read_b128 a[68:71], v200 offset:35840
buffer_load_dwordx4 a[144:147], v1, s[4:7], s52 offen offset:2048 sc1
v_mfma_f32_16x16x32_bf16 v[72:75], a[16:19], a[84:87], v[72:75]
v_exp_f32 v198, v198
v_mfma_f32_16x16x32_bf16 v[76:79], a[20:23], a[80:83], v[76:79]
v_exp_f32 v199, v199
v_mfma_f32_16x16x32_bf16 v[80:83], a[20:23], a[84:87], v[80:83]
v_fma_f32 v196, v196, v255, v255
v_fma_f32 v197, v197, v255, v255
v_mfma_f32_16x16x32_bf16 v[84:87], a[24:27], a[80:83], v[84:87]
buffer_load_dwordx4 a[148:151], v9, s[4:7], s52 offen offset:2048 sc1
v_mfma_f32_16x16x32_bf16 v[88:91], a[24:27], a[84:87], v[88:91]
v_fma_f32 v198, v198, v255, v255
v_mfma_f32_16x16x32_bf16 v[92:95], a[28:31], a[80:83], v[92:95]
v_mfma_f32_16x16x32_bf16 v[96:99], a[28:31], a[84:87], v[96:99]
v_fma_f32 v199, v199, v255, v255
v_mfma_f32_16x16x32_bf16 v[100:103], a[32:35], a[80:83], v[100:103]
v_mfma_f32_16x16x32_bf16 v[104:107], a[32:35], a[84:87], v[104:107]
s_waitcnt vmcnt(19) lgkmcnt(0)
s_barrier
v_mfma_f32_16x16x32_bf16 v[36:39], a[36:39], a[88:91], v[36:39]
ds_read_b128 a[0:3], v201 offset:0
buffer_load_dwordx4 a[152:155], v1, s[4:7], s52 offen offset:3072 sc1
v_mfma_f32_16x16x32_bf16 v[40:43], a[36:39], a[92:95], v[40:43]
ds_read_b128 a[4:7], v201 offset:1024
v_mfma_f32_16x16x32_bf16 v[44:47], a[40:43], a[88:91], v[44:47]
ds_read_b128 a[8:11], v201 offset:2048
buffer_load_dwordx4 a[156:159], v9, s[4:7], s52 offen offset:3072 sc1
v_mfma_f32_16x16x32_bf16 v[48:51], a[40:43], a[92:95], v[48:51]
ds_read_b128 a[12:15], v201 offset:3072
v_mfma_f32_16x16x32_bf16 v[52:55], a[44:47], a[88:91], v[52:55]
ds_read_b128 a[16:19], v201 offset:4096
s_mul_i32 s38, s24, 13312
v_mfma_f32_16x16x32_bf16 v[56:59], a[44:47], a[92:95], v[56:59]
ds_read_b128 a[20:23], v201 offset:5120
v_mfma_f32_16x16x32_bf16 v[60:63], a[48:51], a[88:91], v[60:63]
ds_read_b128 a[24:27], v201 offset:6144
v_mfma_f32_16x16x32_bf16 v[64:67], a[48:51], a[92:95], v[64:67]
ds_read_b128 a[28:31], v201 offset:7168
s_add_u32 m0, s38, 0
v_mfma_f32_16x16x32_bf16 v[68:71], a[52:55], a[88:91], v[68:71]
ds_read_b128 a[32:35], v201 offset:8192
v_mfma_f32_16x16x32_bf16 v[72:75], a[52:55], a[92:95], v[72:75]
s_add_u32 s39, s38, s83
v_rcp_f32 v196, v196
v_mfma_f32_16x16x32_bf16 v[76:79], a[56:59], a[88:91], v[76:79]
v_rcp_f32 v197, v197
v_mfma_f32_16x16x32_bf16 v[80:83], a[56:59], a[92:95], v[80:83]
v_rcp_f32 v198, v198
v_mfma_f32_16x16x32_bf16 v[84:87], a[60:63], a[88:91], v[84:87]
buffer_load_dwordx4 v1, s[4:7], s39 offen offset:0 sc1 lds
v_mfma_f32_16x16x32_bf16 v[88:91], a[60:63], a[92:95], v[88:91]
v_mfma_f32_16x16x32_bf16 v[92:95], a[64:67], a[88:91], v[92:95]
buffer_load_dwordx4 v1, s[4:7], s39 offen offset:1024 sc1 lds
v_mfma_f32_16x16x32_bf16 v[96:99], a[64:67], a[92:95], v[96:99]
v_rcp_f32 v199, v199
v_mfma_f32_16x16x32_bf16 v[100:103], a[68:71], a[88:91], v[100:103]
v_mfma_f32_16x16x32_bf16 v[104:107], a[68:71], a[92:95], v[104:107]
s_waitcnt lgkmcnt(0)
v_mfma_f32_16x16x32_bf16 v[36:39], a[0:3], a[96:99], v[36:39]
ds_read_b128 a[36:39], v201 offset:9216
buffer_load_dwordx4 v1, s[4:7], s39 offen offset:2048 sc1 lds
v_mfma_f32_16x16x32_bf16 v[40:43], a[0:3], a[100:103], v[40:43]
ds_read_b128 a[40:43], v201 offset:10240
v_mul_f32 v176, v176, v196
v_mfma_f32_16x16x32_bf16 v[44:47], a[4:7], a[96:99], v[44:47]
ds_read_b128 a[44:47], v201 offset:11264
buffer_load_dwordx4 v1, s[4:7], s39 offen offset:3072 sc1 lds
v_mfma_f32_16x16x32_bf16 v[48:51], a[4:7], a[100:103], v[48:51]
ds_read_b128 a[48:51], v201 offset:12288
v_mul_f32 v177, v177, v197
v_mfma_f32_16x16x32_bf16 v[52:55], a[8:11], a[96:99], v[52:55]
ds_read_b128 a[52:55], v201 offset:13312
v_mfma_f32_16x16x32_bf16 v[56:59], a[8:11], a[100:103], v[56:59]
ds_read_b128 a[56:59], v201 offset:14336
s_add_u32 m0, m0, 4096
v_mfma_f32_16x16x32_bf16 v[60:63], a[12:15], a[96:99], v[60:63]
ds_read_b128 a[60:63], v201 offset:15360
v_mul_f32 v178, v178, v198
v_mfma_f32_16x16x32_bf16 v[64:67], a[12:15], a[100:103], v[64:67]
ds_read_b128 a[64:67], v201 offset:16384
v_mul_f32 v179, v179, v199
v_mfma_f32_16x16x32_bf16 v[68:71], a[16:19], a[96:99], v[68:71]
ds_read_b128 a[68:71], v201 offset:17408
s_add_u32 s39, s39, 4096
v_mfma_f32_16x16x32_bf16 v[72:75], a[16:19], a[100:103], v[72:75]
s_lshl_b32 s30, s25, 3
v_mfma_f32_16x16x32_bf16 v[76:79], a[20:23], a[96:99], v[76:79]
s_lshl_b32 s31, s24, 1
v_mfma_f32_16x16x32_bf16 v[80:83], a[20:23], a[100:103], v[80:83]
buffer_load_dwordx4 v1, s[4:7], s39 offen offset:0 sc1 lds
v_mfma_f32_16x16x32_bf16 v[84:87], a[24:27], a[96:99], v[84:87]
s_add_u32 s30, s30, s31
v_mfma_f32_16x16x32_bf16 v[88:91], a[24:27], a[100:103], v[88:91]
s_mul_i32 s30, s30, 73728
v_mfma_f32_16x16x32_bf16 v[92:95], a[28:31], a[96:99], v[92:95]
buffer_load_dwordx4 v1, s[4:7], s39 offen offset:1024 sc1 lds
v_mfma_f32_16x16x32_bf16 v[96:99], a[28:31], a[100:103], v[96:99]
s_add_u32 s30, s30, 16777216
v_mfma_f32_16x16x32_bf16 v[100:103], a[32:35], a[96:99], v[100:103]
s_mul_i32 s31, s26, 4608
v_mfma_f32_16x16x32_bf16 v[104:107], a[32:35], a[100:103], v[104:107]
s_add_u32 s30, s30, s31
s_waitcnt vmcnt(23) lgkmcnt(0)
v_mfma_f32_16x16x32_bf16 v[36:39], a[36:39], a[104:107], v[36:39]
ds_read_b128 a[0:3], v201 offset:18432
buffer_load_dwordx4 v1, s[4:7], s39 offen offset:2048 sc1 lds
v_mfma_f32_16x16x32_bf16 v[40:43], a[36:39], a[108:111], v[40:43]
ds_read_b128 a[4:7], v201 offset:19456
v_mfma_f32_16x16x32_bf16 v[44:47], a[40:43], a[104:107], v[44:47]
ds_read_b128 a[8:11], v201 offset:20480
buffer_load_dwordx4 v1, s[4:7], s39 offen offset:3072 sc1 lds
v_mfma_f32_16x16x32_bf16 v[48:51], a[40:43], a[108:111], v[48:51]
ds_read_b128 a[12:15], v201 offset:21504
v_mfma_f32_16x16x32_bf16 v[52:55], a[44:47], a[104:107], v[52:55]
ds_read_b128 a[16:19], v201 offset:22528
v_mfma_f32_16x16x32_bf16 v[56:59], a[44:47], a[108:111], v[56:59]
ds_read_b128 a[20:23], v201 offset:23552
s_add_u32 m0, m0, 4096
v_mfma_f32_16x16x32_bf16 v[60:63], a[48:51], a[104:107], v[60:63]
ds_read_b128 a[24:27], v201 offset:24576
v_mfma_f32_16x16x32_bf16 v[64:67], a[48:51], a[108:111], v[64:67]
ds_read_b128 a[28:31], v201 offset:25600
v_mfma_f32_16x16x32_bf16 v[68:71], a[52:55], a[104:107], v[68:71]
ds_read_b128 a[32:35], v201 offset:26624
s_add_u32 s39, s39, 4096
v_mfma_f32_16x16x32_bf16 v[72:75], a[52:55], a[108:111], v[72:75]
s_and_b32 s65, s26, 1
v_mfma_f32_16x16x32_bf16 v[76:79], a[56:59], a[104:107], v[76:79]
s_lshl_b32 s64, s65, 9
v_mfma_f32_16x16x32_bf16 v[80:83], a[56:59], a[108:111], v[80:83]
buffer_load_dwordx4 v1, s[4:7], s39 offen offset:0 sc1 lds
v_mfma_f32_16x16x32_bf16 v[84:87], a[60:63], a[104:107], v[84:87]
s_add_u32 s64, s64, s30
v_mfma_f32_16x16x32_bf16 v[88:91], a[60:63], a[108:111], v[88:91]
s_xor_b32 s65, s65, 1
v_mfma_f32_16x16x32_bf16 v[92:95], a[64:67], a[104:107], v[92:95]
buffer_load_dwordx4 v1, s[4:7], s39 offen offset:1024 sc1 lds
v_mfma_f32_16x16x32_bf16 v[96:99], a[64:67], a[108:111], v[96:99]
s_lshl_b32 s65, s65, 12
v_mfma_f32_16x16x32_bf16 v[100:103], a[68:71], a[104:107], v[100:103]
s_add_u32 s65, s65, s30
v_mfma_f32_16x16x32_bf16 v[104:107], a[68:71], a[108:111], v[104:107]
s_waitcnt lgkmcnt(0)
v_mfma_f32_16x16x32_bf16 v[36:39], a[0:3], a[112:115], v[36:39]
ds_read_b128 a[36:39], v201 offset:27648
buffer_load_dwordx4 v1, s[4:7], s39 offen offset:2048 sc1 lds
v_mfma_f32_16x16x32_bf16 v[40:43], a[0:3], a[116:119], v[40:43]
ds_read_b128 a[40:43], v201 offset:28672
buffer_load_dwordx4 v1, s[4:7], s39 offen offset:3072 sc1 lds
v_mfma_f32_16x16x32_bf16 v[44:47], a[4:7], a[112:115], v[44:47]
ds_read_b128 a[44:47], v201 offset:29696
v_mfma_f32_16x16x32_bf16 v[48:51], a[4:7], a[116:119], v[48:51]
ds_read_b128 a[48:51], v201 offset:30720
s_add_u32 m0, m0, 4096
v_mfma_f32_16x16x32_bf16 v[52:55], a[8:11], a[112:115], v[52:55]
ds_read_b128 a[52:55], v201 offset:31744
v_add_u32 v204, 73728, v1
v_mfma_f32_16x16x32_bf16 v[56:59], a[8:11], a[116:119], v[56:59]
ds_read_b128 a[56:59], v201 offset:32768
s_add_u32 s39, s39, 4096
v_mfma_f32_16x16x32_bf16 v[60:63], a[12:15], a[112:115], v[60:63]
ds_read_b128 a[60:63], v201 offset:33792
buffer_load_dwordx4 v1, s[4:7], s39 offen offset:0 sc1 lds
v_mfma_f32_16x16x32_bf16 v[64:67], a[12:15], a[116:119], v[64:67]
ds_read_b128 a[64:67], v201 offset:34816
v_and_b32 v203, 1, v3
v_mfma_f32_16x16x32_bf16 v[68:71], a[16:19], a[112:115], v[68:71]
ds_read_b128 a[68:71], v201 offset:35840
s_mul_i32 s38, s24, 9216
v_mfma_f32_16x16x32_bf16 v[72:75], a[16:19], a[116:119], v[72:75]
s_add_u32 m0, s38, 53248
v_mul_u32_u24 v203, 73728, v203
v_mfma_f32_16x16x32_bf16 v[76:79], a[20:23], a[112:115], v[76:79]
s_add_u32 s39, s38, s83
v_mfma_f32_16x16x32_bf16 v[80:83], a[20:23], a[116:119], v[80:83]
s_add_u32 s39, s39, 53248
v_lshrrev_b32 v8, 1, v3
v_mfma_f32_16x16x32_bf16 v[84:87], a[24:27], a[112:115], v[84:87]
v_mfma_f32_16x16x32_bf16 v[88:91], a[24:27], a[116:119], v[88:91]
v_mfma_f32_16x16x32_bf16 v[92:95], a[28:31], a[112:115], v[92:95]
v_lshl_add_u32 v203, v8, 8, v203
v_mfma_f32_16x16x32_bf16 v[96:99], a[28:31], a[116:119], v[96:99]
buffer_load_dwordx4 v1, s[4:7], s39 offen offset:0 sc1 lds
v_mfma_f32_16x16x32_bf16 v[100:103], a[32:35], a[112:115], v[100:103]
v_lshl_add_u32 v203, v2, 4, v203
v_mfma_f32_16x16x32_bf16 v[104:107], a[32:35], a[116:119], v[104:107]
s_waitcnt vmcnt(14) lgkmcnt(0)
s_barrier
v_mfma_f32_16x16x32_bf16 v[36:39], a[36:39], a[120:123], v[36:39]
ds_read_b128 a[0:3], v202 offset:8192
buffer_load_dwordx4 v1, s[4:7], s39 offen offset:1024 sc1 lds
v_mfma_f32_16x16x32_bf16 v[40:43], a[36:39], a[124:127], v[40:43]
ds_read_b128 a[4:7], v202 offset:17408
v_mfma_f32_16x16x32_bf16 v[44:47], a[40:43], a[120:123], v[44:47]
ds_read_b128 a[8:11], v202 offset:26624
buffer_load_dwordx4 v1, s[4:7], s39 offen offset:2048 sc1 lds
v_mfma_f32_16x16x32_bf16 v[48:51], a[40:43], a[124:127], v[48:51]
ds_read_b128 a[12:15], v202 offset:35840
v_mfma_f32_16x16x32_bf16 v[52:55], a[44:47], a[120:123], v[52:55]
ds_read_b128 a[16:19], v202 offset:0
v_mfma_f32_16x16x32_bf16 v[56:59], a[44:47], a[124:127], v[56:59]
ds_read_b128 a[20:23], v202 offset:1024
buffer_load_dwordx4 v1, s[4:7], s39 offen offset:3072 sc1 lds
v_mfma_f32_16x16x32_bf16 v[60:63], a[48:51], a[120:123], v[60:63]
ds_read_b128 a[24:27], v202 offset:9216
v_mfma_f32_16x16x32_bf16 v[64:67], a[48:51], a[124:127], v[64:67]
ds_read_b128 a[28:31], v202 offset:10240
v_mfma_f32_16x16x32_bf16 v[68:71], a[52:55], a[120:123], v[68:71]
ds_read_b128 a[32:35], v202 offset:18432
s_add_u32 m0, m0, 4096
v_mfma_f32_16x16x32_bf16 v[72:75], a[52:55], a[124:127], v[72:75]
s_add_u32 s39, s39, 4096
v_mfma_f32_16x16x32_bf16 v[76:79], a[56:59], a[120:123], v[76:79]
v_mfma_f32_16x16x32_bf16 v[80:83], a[56:59], a[124:127], v[80:83]
v_mfma_f32_16x16x32_bf16 v[84:87], a[60:63], a[120:123], v[84:87]
v_mfma_f32_16x16x32_bf16 v[88:91], a[60:63], a[124:127], v[88:91]
v_mfma_f32_16x16x32_bf16 v[92:95], a[64:67], a[120:123], v[92:95]
buffer_load_dwordx4 v1, s[4:7], s39 offen offset:0 sc1 lds
v_mfma_f32_16x16x32_bf16 v[96:99], a[64:67], a[124:127], v[96:99]
v_mfma_f32_16x16x32_bf16 v[100:103], a[68:71], a[120:123], v[100:103]
v_mfma_f32_16x16x32_bf16 v[104:107], a[68:71], a[124:127], v[104:107]
s_waitcnt lgkmcnt(7)
v_mfma_f32_16x16x32_bf16 v[100:103], a[0:3], a[128:131], v[100:103]
ds_read_b128 a[36:39], v202 offset:19456
v_mfma_f32_16x16x32_bf16 v[104:107], a[0:3], a[132:135], v[104:107]
v_mfma_f32_16x16x32_bf16 v[100:103], a[4:7], a[136:139], v[100:103]
ds_read_b128 a[40:43], v202 offset:27648
v_mfma_f32_16x16x32_bf16 v[104:107], a[4:7], a[140:143], v[104:107]
s_waitcnt lgkmcnt(7)
v_mfma_f32_16x16x32_bf16 v[100:103], a[8:11], a[144:147], v[100:103]
ds_read_b128 a[44:47], v202 offset:28672
v_mfma_f32_16x16x32_bf16 v[104:107], a[8:11], a[148:151], v[104:107]
v_mfma_f32_16x16x32_bf16 v[100:103], a[12:15], a[152:155], v[100:103]
ds_read_b128 a[48:51], v202 offset:2048
v_mfma_f32_16x16x32_bf16 v[104:107], a[12:15], a[156:159], v[104:107]
s_waitcnt lgkmcnt(7)
v_mfma_f32_16x16x32_bf16 v[36:39], a[16:19], a[128:131], v[36:39]
ds_read_b128 a[52:55], v202 offset:3072
v_mfma_f32_16x16x32_bf16 v[40:43], a[16:19], a[132:135], v[40:43]
v_mfma_f32_16x16x32_bf16 v[44:47], a[20:23], a[128:131], v[44:47]
ds_read_b128 a[56:59], v202 offset:11264
v_mfma_f32_16x16x32_bf16 v[48:51], a[20:23], a[132:135], v[48:51]
v_mul_f32 v100, v100, v108
s_waitcnt lgkmcnt(7)
v_mfma_f32_16x16x32_bf16 v[36:39], a[24:27], a[136:139], v[36:39]
ds_read_b128 a[60:63], v202 offset:12288
v_mul_f32 v101, v101, v109
v_mfma_f32_16x16x32_bf16 v[40:43], a[24:27], a[140:143], v[40:43]
v_mul_f32 v102, v102, v110
v_mul_f32 v103, v103, v111
v_mfma_f32_16x16x32_bf16 v[44:47], a[28:31], a[136:139], v[44:47]
ds_read_b128 a[64:67], v202 offset:20480
v_cvt_pk_bf16_f32 v238, v100, v101
v_mfma_f32_16x16x32_bf16 v[48:51], a[28:31], a[140:143], v[48:51]
v_cvt_pk_bf16_f32 v239, v102, v103
s_waitcnt lgkmcnt(7)
v_mfma_f32_16x16x32_bf16 v[36:39], a[32:35], a[144:147], v[36:39]
ds_read_b128 a[68:71], v202 offset:21504
v_mul_f32 v104, v104, v112
v_mfma_f32_16x16x32_bf16 v[40:43], a[32:35], a[148:151], v[40:43]
v_mul_f32 v105, v105, v113
v_mfma_f32_16x16x32_bf16 v[44:47], a[36:39], a[144:147], v[44:47]
ds_read_b128 a[0:3], v202 offset:29696
v_mul_f32 v106, v106, v114
v_mfma_f32_16x16x32_bf16 v[48:51], a[36:39], a[148:151], v[48:51]
v_mul_f32 v107, v107, v115
s_waitcnt lgkmcnt(7)
v_mfma_f32_16x16x32_bf16 v[36:39], a[40:43], a[152:155], v[36:39]
ds_read_b128 a[4:7], v202 offset:30720
v_cvt_pk_bf16_f32 v240, v104, v105
v_mfma_f32_16x16x32_bf16 v[40:43], a[40:43], a[156:159], v[40:43]
v_cvt_pk_bf16_f32 v241, v106, v107
s_nop 0
v_mfma_f32_16x16x32_bf16 v[44:47], a[44:47], a[152:155], v[44:47]
ds_read_b128 a[8:11], v202 offset:4096
v_mfma_f32_16x16x32_bf16 v[48:51], a[44:47], a[156:159], v[48:51]
s_waitcnt lgkmcnt(7)
v_mfma_f32_16x16x32_bf16 v[52:55], a[48:51], a[128:131], v[52:55]
ds_read_b128 a[12:15], v202 offset:5120
v_permlane16_swap_b32 v238, v240
v_mfma_f32_16x16x32_bf16 v[56:59], a[48:51], a[132:135], v[56:59]
v_permlane16_swap_b32 v239, v241
v_mfma_f32_16x16x32_bf16 v[60:63], a[52:55], a[128:131], v[60:63]
ds_read_b128 a[16:19], v202 offset:13312
buffer_store_dwordx4 v[238:241], v203, s[8:11], s65 offen sc1
v_mfma_f32_16x16x32_bf16 v[64:67], a[52:55], a[132:135], v[64:67]
v_mul_f32 v36, v36, v116
s_waitcnt lgkmcnt(7)
v_mfma_f32_16x16x32_bf16 v[52:55], a[56:59], a[136:139], v[52:55]
ds_read_b128 a[20:23], v202 offset:14336
v_mul_f32 v37, v37, v117
v_mfma_f32_16x16x32_bf16 v[56:59], a[56:59], a[140:143], v[56:59]
v_mul_f32 v38, v38, v118
v_mul_f32 v39, v39, v119
v_mfma_f32_16x16x32_bf16 v[60:63], a[60:63], a[136:139], v[60:63]
ds_read_b128 a[24:27], v202 offset:22528
v_cvt_pk_bf16_f32 v206, v36, v37
v_mfma_f32_16x16x32_bf16 v[64:67], a[60:63], a[140:143], v[64:67]
v_cvt_pk_bf16_f32 v207, v38, v39
v_mul_f32 v44, v44, v124
s_waitcnt lgkmcnt(7)
v_mfma_f32_16x16x32_bf16 v[52:55], a[64:67], a[144:147], v[52:55]
ds_read_b128 a[28:31], v202 offset:23552
v_mul_f32 v45, v45, v125
v_mfma_f32_16x16x32_bf16 v[56:59], a[64:67], a[148:151], v[56:59]
v_mul_f32 v46, v46, v126
v_mul_f32 v47, v47, v127
v_mfma_f32_16x16x32_bf16 v[60:63], a[68:71], a[144:147], v[60:63]
ds_read_b128 a[32:35], v202 offset:31744
v_cvt_pk_bf16_f32 v208, v44, v45
v_mfma_f32_16x16x32_bf16 v[64:67], a[68:71], a[148:151], v[64:67]
v_cvt_pk_bf16_f32 v209, v46, v47
s_waitcnt lgkmcnt(7)
v_mfma_f32_16x16x32_bf16 v[52:55], a[0:3], a[152:155], v[52:55]
ds_read_b128 a[36:39], v202 offset:32768
buffer_store_dwordx4 v[206:209], v1, s[8:11], s64 offen offset:0 sc1
v_mul_f32 v40, v40, v120
v_mul_f32 v41, v41, v121
v_mfma_f32_16x16x32_bf16 v[56:59], a[0:3], a[156:159], v[56:59]
v_mul_f32 v42, v42, v122
v_mul_f32 v43, v43, v123
v_mfma_f32_16x16x32_bf16 v[60:63], a[4:7], a[152:155], v[60:63]
ds_read_b128 a[40:43], v202 offset:6144
v_cvt_pk_bf16_f32 v210, v40, v41
v_mfma_f32_16x16x32_bf16 v[64:67], a[4:7], a[156:159], v[64:67]
v_cvt_pk_bf16_f32 v211, v42, v43
v_mul_f32 v48, v48, v128
s_waitcnt lgkmcnt(7)
v_mfma_f32_16x16x32_bf16 v[68:71], a[8:11], a[128:131], v[68:71]
ds_read_b128 a[44:47], v202 offset:7168
v_mul_f32 v49, v49, v129
v_mfma_f32_16x16x32_bf16 v[72:75], a[8:11], a[132:135], v[72:75]
v_mul_f32 v50, v50, v130
v_mul_f32 v51, v51, v131
v_mfma_f32_16x16x32_bf16 v[76:79], a[12:15], a[128:131], v[76:79]
ds_read_b128 a[48:51], v202 offset:15360
v_cvt_pk_bf16_f32 v212, v48, v49
v_cvt_pk_bf16_f32 v213, v50, v51
buffer_store_dwordx4 v[210:213], v204, s[8:11], s64 offen offset:0 sc1
v_mfma_f32_16x16x32_bf16 v[80:83], a[12:15], a[132:135], v[80:83]
v_mul_f32 v52, v52, v132
s_waitcnt lgkmcnt(7)
v_mfma_f32_16x16x32_bf16 v[68:71], a[16:19], a[136:139], v[68:71]
ds_read_b128 a[52:55], v202 offset:16384
v_mul_f32 v53, v53, v133
v_mfma_f32_16x16x32_bf16 v[72:75], a[16:19], a[140:143], v[72:75]
v_mul_f32 v54, v54, v134
v_mul_f32 v55, v55, v135
v_mfma_f32_16x16x32_bf16 v[76:79], a[20:23], a[136:139], v[76:79]
ds_read_b128 a[56:59], v202 offset:24576
v_cvt_pk_bf16_f32 v214, v52, v53
v_mfma_f32_16x16x32_bf16 v[80:83], a[20:23], a[140:143], v[80:83]
v_cvt_pk_bf16_f32 v215, v54, v55
v_mul_f32 v60, v60, v140
s_waitcnt lgkmcnt(7)
v_mfma_f32_16x16x32_bf16 v[68:71], a[24:27], a[144:147], v[68:71]
ds_read_b128 a[60:63], v202 offset:25600
v_mul_f32 v61, v61, v141
v_mfma_f32_16x16x32_bf16 v[72:75], a[24:27], a[148:151], v[72:75]
v_mul_f32 v62, v62, v142
v_mul_f32 v63, v63, v143
v_mfma_f32_16x16x32_bf16 v[76:79], a[28:31], a[144:147], v[76:79]
ds_read_b128 a[64:67], v202 offset:33792
v_cvt_pk_bf16_f32 v216, v60, v61
v_mfma_f32_16x16x32_bf16 v[80:83], a[28:31], a[148:151], v[80:83]
v_cvt_pk_bf16_f32 v217, v62, v63
s_waitcnt lgkmcnt(7)
v_mfma_f32_16x16x32_bf16 v[68:71], a[32:35], a[152:155], v[68:71]
ds_read_b128 a[68:71], v202 offset:34816
buffer_store_dwordx4 v[214:217], v1, s[8:11], s64 offen offset:1024 sc1
v_mul_f32 v56, v56, v136
v_mul_f32 v57, v57, v137
v_mfma_f32_16x16x32_bf16 v[72:75], a[32:35], a[156:159], v[72:75]
v_mul_f32 v58, v58, v138
v_mul_f32 v59, v59, v139
v_mfma_f32_16x16x32_bf16 v[76:79], a[36:39], a[152:155], v[76:79]
v_cvt_pk_bf16_f32 v218, v56, v57
v_cvt_pk_bf16_f32 v219, v58, v59
v_mfma_f32_16x16x32_bf16 v[80:83], a[36:39], a[156:159], v[80:83]
v_mul_f32 v64, v64, v144
s_waitcnt lgkmcnt(6)
v_mfma_f32_16x16x32_bf16 v[84:87], a[40:43], a[128:131], v[84:87]
v_mul_f32 v65, v65, v145
v_mul_f32 v66, v66, v146
v_mfma_f32_16x16x32_bf16 v[88:91], a[40:43], a[132:135], v[88:91]
v_mul_f32 v67, v67, v147
v_cvt_pk_bf16_f32 v220, v64, v65
v_mfma_f32_16x16x32_bf16 v[92:95], a[44:47], a[128:131], v[92:95]
v_cvt_pk_bf16_f32 v221, v66, v67
buffer_store_dwordx4 v[218:221], v204, s[8:11], s64 offen offset:1024 sc1
v_mfma_f32_16x16x32_bf16 v[96:99], a[44:47], a[132:135], v[96:99]
v_mul_f32 v68, v68, v148
s_waitcnt lgkmcnt(4)
v_mfma_f32_16x16x32_bf16 v[84:87], a[48:51], a[136:139], v[84:87]
v_mul_f32 v69, v69, v149
v_mul_f32 v70, v70, v150
v_mfma_f32_16x16x32_bf16 v[88:91], a[48:51], a[140:143], v[88:91]
v_mul_f32 v71, v71, v151
v_cvt_pk_bf16_f32 v222, v68, v69
v_mfma_f32_16x16x32_bf16 v[92:95], a[52:55], a[136:139], v[92:95]
v_cvt_pk_bf16_f32 v223, v70, v71
v_mul_f32 v76, v76, v156
v_mfma_f32_16x16x32_bf16 v[96:99], a[52:55], a[140:143], v[96:99]
v_mul_f32 v77, v77, v157
s_waitcnt lgkmcnt(2)
v_mfma_f32_16x16x32_bf16 v[84:87], a[56:59], a[144:147], v[84:87]
v_mul_f32 v78, v78, v158
v_mul_f32 v79, v79, v159
v_mfma_f32_16x16x32_bf16 v[88:91], a[56:59], a[148:151], v[88:91]
v_cvt_pk_bf16_f32 v224, v76, v77
v_cvt_pk_bf16_f32 v225, v78, v79
v_mfma_f32_16x16x32_bf16 v[92:95], a[60:63], a[144:147], v[92:95]
buffer_store_dwordx4 v[222:225], v1, s[8:11], s64 offen offset:2048 sc1
v_mul_f32 v72, v72, v152
v_mfma_f32_16x16x32_bf16 v[96:99], a[60:63], a[148:151], v[96:99]
v_mul_f32 v73, v73, v153
v_mul_f32 v74, v74, v154
s_waitcnt lgkmcnt(0)
v_mfma_f32_16x16x32_bf16 v[84:87], a[64:67], a[152:155], v[84:87]
v_mul_f32 v75, v75, v155
v_cvt_pk_bf16_f32 v226, v72, v73
v_mfma_f32_16x16x32_bf16 v[88:91], a[64:67], a[156:159], v[88:91]
v_cvt_pk_bf16_f32 v227, v74, v75
v_mul_f32 v80, v80, v160
v_mfma_f32_16x16x32_bf16 v[92:95], a[68:71], a[152:155], v[92:95]
v_mul_f32 v81, v81, v161
v_mul_f32 v82, v82, v162
v_mfma_f32_16x16x32_bf16 v[96:99], a[68:71], a[156:159], v[96:99]
v_mul_f32 v83, v83, v163
v_cvt_pk_bf16_f32 v228, v80, v81
v_cvt_pk_bf16_f32 v229, v82, v83
buffer_store_dwordx4 v[226:229], v204, s[8:11], s64 offen offset:2048 sc1
s_nop 1
v_pk_mul_f32 v[84:85], v[84:85], v[164:165]
v_pk_mul_f32 v[86:87], v[86:87], v[166:167]
v_cvt_pk_bf16_f32 v230, v84, v85
v_cvt_pk_bf16_f32 v231, v86, v87
v_pk_mul_f32 v[92:93], v[92:93], v[172:173]
v_pk_mul_f32 v[94:95], v[94:95], v[174:175]
v_cvt_pk_bf16_f32 v232, v92, v93
v_cvt_pk_bf16_f32 v233, v94, v95
buffer_store_dwordx4 v[230:233], v1, s[8:11], s64 offen offset:3072 sc1
v_pk_mul_f32 v[88:89], v[88:89], v[168:169]
v_pk_mul_f32 v[90:91], v[90:91], v[170:171]
v_cvt_pk_bf16_f32 v234, v88, v89
v_cvt_pk_bf16_f32 v235, v90, v91
v_pk_mul_f32 v[96:97], v[96:97], v[176:177]
v_pk_mul_f32 v[98:99], v[98:99], v[178:179]
v_cvt_pk_bf16_f32 v236, v96, v97
v_cvt_pk_bf16_f32 v237, v98, v99
buffer_store_dwordx4 v[234:237], v204, s[8:11], s64 offen offset:3072 sc1
L_c5:
buffer_load_dwordx4 v1, s[4:7], s39 offen offset:1024 sc1 lds
buffer_load_dwordx4 v1, s[4:7], s39 offen offset:2048 sc1 lds
buffer_load_dwordx4 v1, s[4:7], s39 offen offset:3072 sc1 lds
s_add_u32 m0, m0, 4096
s_add_u32 s39, s39, 4096
buffer_load_dwordx4 v1, s[4:7], s39 offen offset:0 sc1 lds
s_mul_i32 s38, s24, 9216
s_add_u32 m0, s38, 90112
s_add_u32 s39, s38, s83
s_add_u32 s39, s39, 90112
buffer_load_dwordx4 v1, s[4:7], s39 offen offset:0 sc1 lds
buffer_load_dwordx4 v1, s[4:7], s39 offen offset:1024 sc1 lds
buffer_load_dwordx4 v1, s[4:7], s39 offen offset:2048 sc1 lds
v_lshlrev_b32 v7, 3, v1
s_lshl_b32 s31, s25, 11
v_add_u32 v7, s31, v7
s_cmp_eq_u32 s24, 0
s_cselect_b32 s30, 0, 1073741824
s_add_u32 s30, s30, 26574848
s_waitcnt vmcnt(7)
s_barrier
s_mov_b64 exec, 0xffff
buffer_atomic_add v4, v7, s[8:11], s30 offen sc1
s_mov_b64 exec, -1
s_lshl_b32 s35, s81, 7
s_add_u32 s35, s35, 26574848
s_cmp_eq_u32 s24, 1
s_cselect_b32 s35, s35, 1073741824
v_mov_b32 v6, 0
v_mov_b32 v244, 0
v_mov_b32 v245, 0
v_mov_b32 v246, 0
buffer_load_dwordx4 v1, s[4:7], s39 offen offset:3072 sc1 lds
s_add_u32 m0, m0, 4096
s_add_u32 s39, s39, 4096
buffer_load_dwordx4 v1, s[4:7], s39 offen offset:0 sc1 lds
buffer_load_dwordx4 v1, s[4:7], s39 offen offset:1024 sc1 lds
buffer_load_dwordx4 v1, s[4:7], s39 offen offset:2048 sc1 lds
s_mov_b64 exec, 1
buffer_atomic_add v244, v6, s[8:11], s35 offen sc0 sc1
s_mov_b64 exec, -1
buffer_load_dwordx4 v1, s[4:7], s39 offen offset:3072 sc1 lds
s_add_u32 m0, m0, 4096
s_add_u32 s39, s39, 4096
buffer_load_dwordx4 v1, s[4:7], s39 offen offset:0 sc1 lds
s_mul_i32 s38, s24, 9216
s_add_u32 m0, s38, 126976
s_add_u32 s39, s38, s83
s_add_u32 s39, s39, 126976
buffer_load_dwordx4 v1, s[4:7], s39 offen offset:0 sc1 lds
buffer_load_dwordx4 v1, s[4:7], s39 offen offset:1024 sc1 lds
s_mov_b64 exec, 1
buffer_atomic_add v245, v6, s[8:11], s35 offen sc0 sc1
s_mov_b64 exec, -1
buffer_load_dwordx4 v1, s[4:7], s39 offen offset:2048 sc1 lds
buffer_load_dwordx4 v1, s[4:7], s39 offen offset:3072 sc1 lds
s_add_u32 m0, m0, 4096
s_add_u32 s39, s39, 4096
buffer_load_dwordx4 v1, s[4:7], s39 offen offset:0 sc1 lds
buffer_load_dwordx4 v1, s[4:7], s39 offen offset:1024 sc1 lds
s_mov_b64 exec, 1
buffer_atomic_add v246, v6, s[8:11], s35 offen sc0 sc1
s_mov_b64 exec, -1
buffer_load_dwordx4 v1, s[4:7], s39 offen offset:2048 sc1 lds
buffer_load_dwordx4 v1, s[4:7], s39 offen offset:3072 sc1 lds
s_add_u32 m0, m0, 4096
s_add_u32 s39, s39, 4096
buffer_load_dwordx4 v1, s[4:7], s39 offen offset:0 sc1 lds
s_xor_b32 s30, s27, 1
s_lshl_b32 s60, s30, 2
s_add_u32 s60, s60, s24
s_mul_i32 s60, s60, 73728
s_and_b32 s32, s27, 1
s_mul_i32 s32, s32, 36864
s_add_u32 s32, s32, 16777216
s_add_u32 s60, s60, s32
s_lshl_b32 s61, s27, 2
s_add_u32 s61, s61, s24
s_mul_i32 s61, s61, 73728
s_add_u32 s61, s61, s32
s_cmp_eq_u32 s24, 1
s_cbranch_scc0 L_other_33
s_mov_b32 s31, 0
s_mov_b64 exec, 1
v_mov_b32 v247, 0
buffer_atomic_add v247, v6, s[8:11], s35 offen sc0 sc1
s_waitcnt vmcnt(14)
v_cmp_gt_u32 vcc, 16, v244
s_nop 0
s_cbranch_vccz L_polled_32
s_waitcnt vmcnt(9)
v_cmp_gt_u32 vcc, 16, v245
s_nop 0
s_cbranch_vccz L_polled_32
v_mov_b32 v244, 0
buffer_atomic_add v244, v6, s[8:11], s35 offen sc0 sc1
s_waitcnt vmcnt(5)
v_cmp_gt_u32 vcc, 16, v246
s_nop 0
s_cbranch_vccz L_polled_32
v_mov_b32 v245, 0
buffer_atomic_add v245, v6, s[8:11], s35 offen sc0 sc1
L_poll_31:
s_add_u32 s31, s31, 1
s_cmp_gt_u32 s31, 100000
s_cbranch_scc1 L_polled_32
v_mov_b32 v246, 0
buffer_atomic_add v246, v6, s[8:11], s35 offen sc0 sc1
s_waitcnt vmcnt(3)
v_cmp_gt_u32 vcc, 16, v247
s_nop 0
s_cbranch_vccz L_polled_32
v_mov_b32 v247, 0
buffer_atomic_add v247, v6, s[8:11], s35 offen sc0 sc1
s_waitcnt vmcnt(3)
v_cmp_gt_u32 vcc, 16, v244
s_nop 0
s_cbranch_vccz L_polled_32
v_mov_b32 v244, 0
buffer_atomic_add v244, v6, s[8:11], s35 offen sc0 sc1
s_waitcnt vmcnt(3)
v_cmp_gt_u32 vcc, 16, v245
s_nop 0
s_cbranch_vccz L_polled_32
v_mov_b32 v245, 0
buffer_atomic_add v245, v6, s[8:11], s35 offen sc0 sc1
s_waitcnt vmcnt(3)
v_cmp_gt_u32 vcc, 16, v246
s_nop 0
s_cbranch_vccz L_polled_32
s_branch L_poll_31
L_polled_32:
s_mov_b64 exec, -1
L_other_33:
s_barrier
buffer_load_dwordx4 a[0:3], v1, s[8:11], s60 offen offset:0 sc1
buffer_load_dwordx4 a[4:7], v1, s[8:11], s60 offen offset:1024 sc1
s_barrier
buffer_load_dwordx4 a[8:11], v1, s[8:11], s60 offen offset:2048 sc1
buffer_load_dwordx4 a[12:15], v1, s[8:11], s60 offen offset:3072 sc1
s_barrier
s_add_u32 s60, s60, 4096
buffer_load_dwordx4 a[16:19], v1, s[8:11], s60 offen offset:0 sc1
buffer_load_dwordx4 a[20:23], v1, s[8:11], s60 offen offset:1024 sc1
s_barrier
buffer_load_dwordx4 a[24:27], v1, s[8:11], s60 offen offset:2048 sc1
buffer_load_dwordx4 a[28:31], v1, s[8:11], s60 offen offset:3072 sc1
s_barrier
s_add_u32 s60, s60, 4096
buffer_load_dwordx4 a[32:35], v1, s[8:11], s60 offen offset:0 sc1
buffer_load_dwordx4 a[36:39], v1, s[8:11], s60 offen offset:1024 sc1
v_and_b32 v40, 7, v2
v_lshlrev_b32 v40, 4, v40
v_lshl_add_u32 v40, v3, 7, v40
v_add_u32 v40, 4096, v40
s_lshl_b32 s63, s81, 14
s_lshl_b32 s30, s24, 12
s_add_u32 s63, s63, s30
s_xor_b32 s62, s63, 131072
s_add_u32 s63, s63, 26640384
s_add_u32 s62, s62, 26640384
s_add_u32 s64, s83, 161280
v_mov_b32 v116, v40
v_add_u32 v36, 0, v1
v_add_u32 v37, 55296, v1
v_add_u32 v41, 55296, v40
v_add_u32 v38, 110592, v1
v_add_u32 v42, 110592, v40
ds_read_b128 a[160:163], v36 offset:0
ds_read_b128 a[164:167], v36 offset:1024
ds_read_b128 a[168:171], v36 offset:2048
ds_read_b128 a[172:175], v36 offset:3072
ds_read_b128 a[176:179], v40 offset:0
ds_read_b128 a[180:183], v36 offset:4608
ds_read_b128 a[184:187], v36 offset:5632
ds_read_b128 a[188:191], v36 offset:6656
ds_read_b128 a[192:195], v36 offset:7680
ds_read_b128 a[196:199], v40 offset:4608
s_lshl_b32 s30, s27, 2
s_add_u32 s30, s30, s24
v_mov_b32 v138, 1073741824
s_mul_i32 s66, s30, 18432
s_mul_i32 s32, s28, 2304
s_add_u32 s66, s66, s32
s_add_u32 s66, s66, 30834688
v_mov_b32 v140, v1
v_add_u32 v141, 2048, v140
v_cndmask_b32 v141, v138, v141, s[46:47]
s_lshl_b32 s67, s30, 7
s_lshl_b32 s32, s28, 14
s_add_u32 s67, s67, s32
s_add_u32 s67, s67, 33193984
v_lshlrev_b32 v139, 3, v2
v_cndmask_b32 v138, v138, v139, s[46:47]
s_lshl_b32 s30, s27, 2
s_add_u32 s30, s30, s24
v_mov_b32 v162, 1073741824
s_mul_i32 s68, s30, 18432
s_mul_i32 s32, s28, 144
s_add_u32 s68, s68, s32
v_mul_u32_u24 v164, 1152, v2
v_lshl_add_u32 v164, v3, 4, v164
v_add_u32 v165, 128, v164
v_cndmask_b32 v165, v162, v165, s[46:47]
s_waitcnt vmcnt(9) lgkmcnt(5)
v_mfma_f32_16x16x32_bf16 v[44:47], a[160:163], a[0:3], 0
ds_read_b128 a[200:203], v36 offset:9216
buffer_load_dwordx4 a[40:43], v1, s[8:11], s60 offen offset:2048 sc1
v_mfma_f32_16x16x32_bf16 v[48:51], a[164:167], a[0:3], 0
ds_read_b128 a[204:207], v36 offset:10240
v_mfma_f32_16x16x32_bf16 v[52:55], a[168:171], a[0:3], 0
ds_read_b128 a[208:211], v36 offset:11264
v_mfma_f32_16x16x32_bf16 v[56:59], a[172:175], a[0:3], 0
ds_read_b128 a[212:215], v36 offset:12288
v_mfma_f32_16x16x32_bf16 v[60:63], a[176:179], a[0:3], 0
ds_read_b128 a[216:219], v40 offset:9216
s_waitcnt vmcnt(9) lgkmcnt(5)
v_mfma_f32_16x16x32_bf16 v[44:47], a[180:183], a[4:7], v[44:47]
ds_read_b128 a[160:163], v36 offset:13824
buffer_load_dwordx4 a[0:3], v1, s[8:11], s60 offen offset:3072 sc1
v_mfma_f32_16x16x32_bf16 v[48:51], a[184:187], a[4:7], v[48:51]
ds_read_b128 a[164:167], v36 offset:14848
v_mfma_f32_16x16x32_bf16 v[52:55], a[188:191], a[4:7], v[52:55]
ds_read_b128 a[168:171], v36 offset:15872
v_mfma_f32_16x16x32_bf16 v[56:59], a[192:195], a[4:7], v[56:59]
ds_read_b128 a[172:175], v36 offset:16896
v_mfma_f32_16x16x32_bf16 v[60:63], a[196:199], a[4:7], v[60:63]
ds_read_b128 a[176:179], v40 offset:13824
s_waitcnt vmcnt(9) lgkmcnt(5)
v_mfma_f32_16x16x32_bf16 v[44:47], a[200:203], a[8:11], v[44:47]
ds_read_b128 a[180:183], v36 offset:18432
s_add_u32 s60, s60, 4096
buffer_load_dwordx4 a[4:7], v1, s[8:11], s60 offen offset:0 sc1
v_mfma_f32_16x16x32_bf16 v[48:51], a[204:207], a[8:11], v[48:51]
ds_read_b128 a[184:187], v36 offset:19456
v_mov_b32 v67, v248
v_mfma_f32_16x16x32_bf16 v[52:55], a[208:211], a[8:11], v[52:55]
ds_read_b128 a[188:191], v36 offset:20480
v_mfma_f32_16x16x32_bf16 v[56:59], a[212:215], a[8:11], v[56:59]
ds_read_b128 a[192:195], v36 offset:21504
v_mfma_f32_16x16x32_bf16 v[60:63], a[216:219], a[8:11], v[60:63]
ds_read_b128 a[196:199], v40 offset:18432
s_waitcnt vmcnt(9) lgkmcnt(5)
v_mfma_f32_16x16x32_bf16 v[44:47], a[160:163], a[12:15], v[44:47]
ds_read_b128 a[200:203], v36 offset:23040
buffer_load_dwordx4 a[8:11], v1, s[8:11], s60 offen offset:1024 sc1
v_mfma_f32_16x16x32_bf16 v[48:51], a[164:167], a[12:15], v[48:51]
ds_read_b128 a[204:207], v36 offset:24064
v_mfma_f32_16x16x32_bf16 v[52:55], a[168:171], a[12:15], v[52:55]
ds_read_b128 a[208:211], v36 offset:25088
v_mov_b32 v71, v248
v_mfma_f32_16x16x32_bf16 v[56:59], a[172:175], a[12:15], v[56:59]
ds_read_b128 a[212:215], v36 offset:26112
v_mfma_f32_16x16x32_bf16 v[60:63], a[176:179], a[12:15], v[60:63]
ds_read_b128 a[216:219], v40 offset:23040
s_waitcnt vmcnt(9) lgkmcnt(5)
v_mfma_f32_16x16x32_bf16 v[44:47], a[180:183], a[16:19], v[44:47]
ds_read_b128 a[160:163], v36 offset:27648
buffer_load_dwordx4 a[12:15], v1, s[8:11], s60 offen offset:2048 sc1
v_mfma_f32_16x16x32_bf16 v[48:51], a[184:187], a[16:19], v[48:51]
ds_read_b128 a[164:167], v36 offset:28672
v_mfma_f32_16x16x32_bf16 v[52:55], a[188:191], a[16:19], v[52:55]
ds_read_b128 a[168:171], v36 offset:29696
v_mfma_f32_16x16x32_bf16 v[56:59], a[192:195], a[16:19], v[56:59]
ds_read_b128 a[172:175], v36 offset:30720
v_mfma_f32_16x16x32_bf16 v[60:63], a[196:199], a[16:19], v[60:63]
ds_read_b128 a[176:179], v40 offset:27648
s_waitcnt vmcnt(9) lgkmcnt(5)
v_mfma_f32_16x16x32_bf16 v[44:47], a[200:203], a[20:23], v[44:47]
ds_read_b128 a[180:183], v36 offset:32256
buffer_load_dwordx4 a[16:19], v1, s[8:11], s60 offen offset:3072 sc1
v_mfma_f32_16x16x32_bf16 v[48:51], a[204:207], a[20:23], v[48:51]
ds_read_b128 a[184:187], v36 offset:33280
v_mov_b32 v75, v248
v_mfma_f32_16x16x32_bf16 v[52:55], a[208:211], a[20:23], v[52:55]
ds_read_b128 a[188:191], v36 offset:34304
v_mfma_f32_16x16x32_bf16 v[56:59], a[212:215], a[20:23], v[56:59]
ds_read_b128 a[192:195], v36 offset:35328
v_mfma_f32_16x16x32_bf16 v[60:63], a[216:219], a[20:23], v[60:63]
ds_read_b128 a[196:199], v40 offset:32256
s_waitcnt vmcnt(9) lgkmcnt(5)
v_mfma_f32_16x16x32_bf16 v[44:47], a[160:163], a[24:27], v[44:47]
ds_read_b128 a[200:203], v36 offset:36864
s_add_u32 s60, s60, 4096
buffer_load_dwordx4 a[20:23], v1, s[8:11], s60 offen offset:0 sc1
v_mfma_f32_16x16x32_bf16 v[48:51], a[164:167], a[24:27], v[48:51]
ds_read_b128 a[204:207], v36 offset:37888
v_mfma_f32_16x16x32_bf16 v[52:55], a[168:171], a[24:27], v[52:55]
ds_read_b128 a[208:211], v36 offset:38912
v_mfma_f32_16x16x32_bf16 v[56:59], a[172:175], a[24:27], v[56:59]
ds_read_b128 a[212:215], v36 offset:39936
v_mov_b32 v79, v248
v_mfma_f32_16x16x32_bf16 v[60:63], a[176:179], a[24:27], v[60:63]
ds_read_b128 a[216:219], v40 offset:36864
s_waitcnt vmcnt(9) lgkmcnt(5)
v_mfma_f32_16x16x32_bf16 v[44:47], a[180:183], a[28:31], v[44:47]
ds_read_b128 a[160:163], v36 offset:41472
buffer_load_dwordx4 a[24:27], v1, s[8:11], s60 offen offset:1024 sc1
v_mfma_f32_16x16x32_bf16 v[48:51], a[184:187], a[28:31], v[48:51]
ds_read_b128 a[164:167], v36 offset:42496
v_mfma_f32_16x16x32_bf16 v[52:55], a[188:191], a[28:31], v[52:55]
ds_read_b128 a[168:171], v36 offset:43520
v_mfma_f32_16x16x32_bf16 v[56:59], a[192:195], a[28:31], v[56:59]
ds_read_b128 a[172:175], v36 offset:44544
v_mfma_f32_16x16x32_bf16 v[60:63], a[196:199], a[28:31], v[60:63]
ds_read_b128 a[176:179], v40 offset:41472
s_waitcnt vmcnt(9) lgkmcnt(5)
v_mfma_f32_16x16x32_bf16 v[44:47], a[200:203], a[32:35], v[44:47]
ds_read_b128 a[180:183], v36 offset:46080
buffer_load_dwordx4 a[28:31], v1, s[8:11], s60 offen offset:2048 sc1
v_mfma_f32_16x16x32_bf16 v[48:51], a[204:207], a[32:35], v[48:51]
ds_read_b128 a[184:187], v36 offset:47104
v_mfma_f32_16x16x32_bf16 v[52:55], a[208:211], a[32:35], v[52:55]
ds_read_b128 a[188:191], v36 offset:48128
v_mfma_f32_16x16x32_bf16 v[56:59], a[212:215], a[32:35], v[56:59]
ds_read_b128 a[192:195], v36 offset:49152
v_mfma_f32_16x16x32_bf16 v[60:63], a[216:219], a[32:35], v[60:63]
ds_read_b128 a[196:199], v40 offset:46080
s_barrier
s_waitcnt vmcnt(9) lgkmcnt(5)
v_mfma_f32_16x16x32_bf16 v[44:47], a[160:163], a[36:39], v[44:47]
ds_read_b128 a[200:203], v36 offset:50688
buffer_load_dwordx4 a[32:35], v1, s[8:11], s60 offen offset:3072 sc1
v_mfma_f32_16x16x32_bf16 v[48:51], a[164:167], a[36:39], v[48:51]
ds_read_b128 a[204:207], v36 offset:51712
v_mfma_f32_16x16x32_bf16 v[52:55], a[168:171], a[36:39], v[52:55]
ds_read_b128 a[208:211], v36 offset:52736
v_mfma_f32_16x16x32_bf16 v[56:59], a[172:175], a[36:39], v[56:59]
ds_read_b128 a[212:215], v36 offset:53760
v_mfma_f32_16x16x32_bf16 v[60:63], a[176:179], a[36:39], v[60:63]
ds_read_b128 a[216:219], v40 offset:50688
s_waitcnt vmcnt(9) lgkmcnt(5)
v_mfma_f32_16x16x32_bf16 v[44:47], a[180:183], a[40:43], v[44:47]
ds_read_b128 a[160:163], v37 offset:0
s_add_u32 s60, s60, 4096
buffer_load_dwordx4 a[36:39], v1, s[8:11], s60 offen offset:0 sc1
v_mfma_f32_16x16x32_bf16 v[48:51], a[184:187], a[40:43], v[48:51]
ds_read_b128 a[164:167], v37 offset:1024
v_mfma_f32_16x16x32_bf16 v[52:55], a[188:191], a[40:43], v[52:55]
ds_read_b128 a[168:171], v37 offset:2048
v_mfma_f32_16x16x32_bf16 v[56:59], a[192:195], a[40:43], v[56:59]
ds_read_b128 a[172:175], v37 offset:3072
v_mfma_f32_16x16x32_bf16 v[60:63], a[196:199], a[40:43], v[60:63]
ds_read_b128 a[176:179], v41 offset:0
s_waitcnt vmcnt(9) lgkmcnt(5)
v_mfma_f32_16x16x32_bf16 v[44:47], a[200:203], a[0:3], v[44:47]
ds_read_b128 a[180:183], v37 offset:4608
buffer_load_dwordx4 a[40:43], v1, s[8:11], s60 offen offset:1024 sc1
v_mfma_f32_16x16x32_bf16 v[48:51], a[204:207], a[0:3], v[48:51]
ds_read_b128 a[184:187], v37 offset:5632
v_mfma_f32_16x16x32_bf16 v[52:55], a[208:211], a[0:3], v[52:55]
ds_read_b128 a[188:191], v37 offset:6656
v_mfma_f32_16x16x32_bf16 v[56:59], a[212:215], a[0:3], v[56:59]
ds_read_b128 a[192:195], v37 offset:7680
v_mfma_f32_16x16x32_bf16 v[60:63], a[216:219], a[0:3], v[60:63]
ds_read_b128 a[196:199], v41 offset:4608
s_waitcnt vmcnt(9) lgkmcnt(5)
v_mfma_f32_16x16x32_bf16 v[44:47], a[160:163], a[4:7], v[44:47]
ds_read_b128 a[200:203], v37 offset:9216
buffer_load_dwordx4 a[0:3], v1, s[8:11], s60 offen offset:2048 sc1
v_mfma_f32_16x16x32_bf16 v[48:51], a[164:167], a[4:7], v[48:51]
ds_read_b128 a[204:207], v37 offset:10240
v_mfma_f32_16x16x32_bf16 v[52:55], a[168:171], a[4:7], v[52:55]
ds_read_b128 a[208:211], v37 offset:11264
v_mfma_f32_16x16x32_bf16 v[56:59], a[172:175], a[4:7], v[56:59]
ds_read_b128 a[212:215], v37 offset:12288
v_mfma_f32_16x16x32_bf16 v[60:63], a[176:179], a[4:7], v[60:63]
ds_read_b128 a[216:219], v41 offset:9216
s_waitcnt vmcnt(9) lgkmcnt(5)
v_mfma_f32_16x16x32_bf16 v[44:47], a[180:183], a[8:11], v[44:47]
ds_read_b128 a[160:163], v37 offset:13824
buffer_load_dwordx4 a[4:7], v1, s[8:11], s60 offen offset:3072 sc1
v_mfma_f32_16x16x32_bf16 v[48:51], a[184:187], a[8:11], v[48:51]
ds_read_b128 a[164:167], v37 offset:14848
v_mfma_f32_16x16x32_bf16 v[52:55], a[188:191], a[8:11], v[52:55]
ds_read_b128 a[168:171], v37 offset:15872
v_mfma_f32_16x16x32_bf16 v[56:59], a[192:195], a[8:11], v[56:59]
ds_read_b128 a[172:175], v37 offset:16896
v_mfma_f32_16x16x32_bf16 v[60:63], a[196:199], a[8:11], v[60:63]
ds_read_b128 a[176:179], v41 offset:13824
s_waitcnt vmcnt(9) lgkmcnt(5)
v_mfma_f32_16x16x32_bf16 v[44:47], a[200:203], a[12:15], v[44:47]
ds_read_b128 a[180:183], v37 offset:18432
s_add_u32 s60, s60, 4096
buffer_load_dwordx4 a[8:11], v1, s[8:11], s60 offen offset:0 sc1
v_mfma_f32_16x16x32_bf16 v[48:51], a[204:207], a[12:15], v[48:51]
ds_read_b128 a[184:187], v37 offset:19456
v_mfma_f32_16x16x32_bf16 v[52:55], a[208:211], a[12:15], v[52:55]
ds_read_b128 a[188:191], v37 offset:20480
v_mfma_f32_16x16x32_bf16 v[56:59], a[212:215], a[12:15], v[56:59]
ds_read_b128 a[192:195], v37 offset:21504
v_mfma_f32_16x16x32_bf16 v[60:63], a[216:219], a[12:15], v[60:63]
ds_read_b128 a[196:199], v41 offset:18432
s_waitcnt vmcnt(9) lgkmcnt(5)
v_mfma_f32_16x16x32_bf16 v[44:47], a[160:163], a[16:19], v[44:47]
ds_read_b128 a[200:203], v37 offset:23040
buffer_load_dwordx4 a[12:15], v1, s[8:11], s60 offen offset:1024 sc1
v_mfma_f32_16x16x32_bf16 v[48:51], a[164:167], a[16:19], v[48:51]
ds_read_b128 a[204:207], v37 offset:24064
v_mfma_f32_16x16x32_bf16 v[52:55], a[168:171], a[16:19], v[52:55]
ds_read_b128 a[208:211], v37 offset:25088
v_mfma_f32_16x16x32_bf16 v[56:59], a[172:175], a[16:19], v[56:59]
ds_read_b128 a[212:215], v37 offset:26112
v_mfma_f32_16x16x32_bf16 v[60:63], a[176:179], a[16:19], v[60:63]
ds_read_b128 a[216:219], v41 offset:23040
s_waitcnt vmcnt(9) lgkmcnt(5)
v_mfma_f32_16x16x32_bf16 v[44:47], a[180:183], a[20:23], v[44:47]
ds_read_b128 a[160:163], v37 offset:27648
buffer_load_dwordx4 a[16:19], v1, s[8:11], s60 offen offset:2048 sc1
v_mfma_f32_16x16x32_bf16 v[48:51], a[184:187], a[20:23], v[48:51]
ds_read_b128 a[164:167], v37 offset:28672
buffer_load_dwordx4 a[228:231], v1, s[4:7], s64 offen offset:2048 sc1
v_mfma_f32_16x16x32_bf16 v[52:55], a[188:191], a[20:23], v[52:55]
ds_read_b128 a[168:171], v37 offset:29696
v_mfma_f32_16x16x32_bf16 v[56:59], a[192:195], a[20:23], v[56:59]
ds_read_b128 a[172:175], v37 offset:30720
v_mfma_f32_16x16x32_bf16 v[60:63], a[196:199], a[20:23], v[60:63]
ds_read_b128 a[176:179], v41 offset:27648
s_waitcnt vmcnt(10) lgkmcnt(5)
v_mfma_f32_16x16x32_bf16 v[44:47], a[200:203], a[24:27], v[44:47]
ds_read_b128 a[180:183], v37 offset:32256
buffer_load_dwordx4 a[20:23], v1, s[8:11], s60 offen offset:3072 sc1
v_mfma_f32_16x16x32_bf16 v[48:51], a[204:207], a[24:27], v[48:51]
ds_read_b128 a[184:187], v37 offset:33280
v_mfma_f32_16x16x32_bf16 v[52:55], a[208:211], a[24:27], v[52:55]
ds_read_b128 a[188:191], v37 offset:34304
v_mfma_f32_16x16x32_bf16 v[56:59], a[212:215], a[24:27], v[56:59]
ds_read_b128 a[192:195], v37 offset:35328
v_mfma_f32_16x16x32_bf16 v[60:63], a[216:219], a[24:27], v[60:63]
ds_read_b128 a[196:199], v41 offset:32256
s_waitcnt vmcnt(10) lgkmcnt(5)
v_mfma_f32_16x16x32_bf16 v[44:47], a[160:163], a[28:31], v[44:47]
ds_read_b128 a[200:203], v37 offset:36864
s_add_u32 s60, s60, 4096
buffer_load_dwordx4 a[24:27], v1, s[8:11], s60 offen offset:0 sc1
v_mfma_f32_16x16x32_bf16 v[48:51], a[164:167], a[28:31], v[48:51]
ds_read_b128 a[204:207], v37 offset:37888
v_mfma_f32_16x16x32_bf16 v[52:55], a[168:171], a[28:31], v[52:55]
ds_read_b128 a[208:211], v37 offset:38912
v_mfma_f32_16x16x32_bf16 v[56:59], a[172:175], a[28:31], v[56:59]
ds_read_b128 a[212:215], v37 offset:39936
buffer_load_dwordx4 a[232:235], v1, s[4:7], s64 offen offset:3072 sc1
v_mfma_f32_16x16x32_bf16 v[60:63], a[176:179], a[28:31], v[60:63]
ds_read_b128 a[216:219], v41 offset:36864
s_waitcnt vmcnt(11) lgkmcnt(5)
v_mfma_f32_16x16x32_bf16 v[44:47], a[180:183], a[32:35], v[44:47]
ds_read_b128 a[160:163], v37 offset:41472
buffer_load_dwordx4 a[28:31], v1, s[8:11], s60 offen offset:1024 sc1
v_mfma_f32_16x16x32_bf16 v[48:51], a[184:187], a[32:35], v[48:51]
ds_read_b128 a[164:167], v37 offset:42496
v_mfma_f32_16x16x32_bf16 v[52:55], a[188:191], a[32:35], v[52:55]
ds_read_b128 a[168:171], v37 offset:43520
v_mfma_f32_16x16x32_bf16 v[56:59], a[192:195], a[32:35], v[56:59]
ds_read_b128 a[172:175], v37 offset:44544
v_mfma_f32_16x16x32_bf16 v[60:63], a[196:199], a[32:35], v[60:63]
ds_read_b128 a[176:179], v41 offset:41472
s_waitcnt vmcnt(11) lgkmcnt(5)
v_mfma_f32_16x16x32_bf16 v[44:47], a[200:203], a[36:39], v[44:47]
ds_read_b128 a[180:183], v37 offset:46080
buffer_load_dwordx4 a[32:35], v1, s[8:11], s60 offen offset:2048 sc1
v_mfma_f32_16x16x32_bf16 v[48:51], a[204:207], a[36:39], v[48:51]
ds_read_b128 a[184:187], v37 offset:47104
v_mfma_f32_16x16x32_bf16 v[52:55], a[208:211], a[36:39], v[52:55]
ds_read_b128 a[188:191], v37 offset:48128
v_mfma_f32_16x16x32_bf16 v[56:59], a[212:215], a[36:39], v[56:59]
ds_read_b128 a[192:195], v37 offset:49152
v_mfma_f32_16x16x32_bf16 v[60:63], a[216:219], a[36:39], v[60:63]
ds_read_b128 a[196:199], v41 offset:46080
s_waitcnt vmcnt(11) lgkmcnt(5)
v_mfma_f32_16x16x32_bf16 v[44:47], a[160:163], a[40:43], v[44:47]
ds_read_b128 a[200:203], v37 offset:50688
buffer_load_dwordx4 a[36:39], v1, s[8:11], s60 offen offset:3072 sc1
v_mfma_f32_16x16x32_bf16 v[48:51], a[164:167], a[40:43], v[48:51]
ds_read_b128 a[204:207], v37 offset:51712
v_mfma_f32_16x16x32_bf16 v[52:55], a[168:171], a[40:43], v[52:55]
ds_read_b128 a[208:211], v37 offset:52736
buffer_load_dwordx4 a[236:239], v116, s[4:7], s64 offen sc1
v_mfma_f32_16x16x32_bf16 v[56:59], a[172:175], a[40:43], v[56:59]
ds_read_b128 a[212:215], v37 offset:53760
v_mfma_f32_16x16x32_bf16 v[60:63], a[176:179], a[40:43], v[60:63]
ds_read_b128 a[216:219], v41 offset:50688
s_waitcnt vmcnt(12) lgkmcnt(5)
v_mfma_f32_16x16x32_bf16 v[44:47], a[180:183], a[0:3], v[44:47]
ds_read_b128 a[160:163], v38 offset:0
s_add_u32 s60, s60, 4096
buffer_load_dwordx4 a[40:43], v1, s[8:11], s60 offen offset:0 sc1
v_mfma_f32_16x16x32_bf16 v[48:51], a[184:187], a[0:3], v[48:51]
ds_read_b128 a[164:167], v38 offset:1024
v_mfma_f32_16x16x32_bf16 v[52:55], a[188:191], a[0:3], v[52:55]
ds_read_b128 a[168:171], v38 offset:2048
v_mfma_f32_16x16x32_bf16 v[56:59], a[192:195], a[0:3], v[56:59]
ds_read_b128 a[172:175], v38 offset:3072
v_mfma_f32_16x16x32_bf16 v[60:63], a[196:199], a[0:3], v[60:63]
ds_read_b128 a[176:179], v42 offset:0
s_waitcnt vmcnt(12) lgkmcnt(5)
v_mfma_f32_16x16x32_bf16 v[44:47], a[200:203], a[4:7], v[44:47]
ds_read_b128 a[180:183], v38 offset:4608
buffer_load_dwordx4 a[0:3], v1, s[8:11], s60 offen offset:1024 sc1
v_mfma_f32_16x16x32_bf16 v[48:51], a[204:207], a[4:7], v[48:51]
ds_read_b128 a[184:187], v38 offset:5632
v_mfma_f32_16x16x32_bf16 v[52:55], a[208:211], a[4:7], v[52:55]
ds_read_b128 a[188:191], v38 offset:6656
v_mfma_f32_16x16x32_bf16 v[56:59], a[212:215], a[4:7], v[56:59]
ds_read_b128 a[192:195], v38 offset:7680
v_mfma_f32_16x16x32_bf16 v[60:63], a[216:219], a[4:7], v[60:63]
ds_read_b128 a[196:199], v42 offset:4608
s_waitcnt vmcnt(12) lgkmcnt(5)
v_mfma_f32_16x16x32_bf16 v[44:47], a[160:163], a[8:11], v[44:47]
ds_read_b128 a[200:203], v38 offset:9216
buffer_load_dwordx4 a[4:7], v1, s[8:11], s60 offen offset:2048 sc1
v_mfma_f32_16x16x32_bf16 v[48:51], a[164:167], a[8:11], v[48:51]
ds_read_b128 a[204:207], v38 offset:10240
v_mfma_f32_16x16x32_bf16 v[52:55], a[168:171], a[8:11], v[52:55]
ds_read_b128 a[208:211], v38 offset:11264
v_mfma_f32_16x16x32_bf16 v[56:59], a[172:175], a[8:11], v[56:59]
ds_read_b128 a[212:215], v38 offset:12288
v_mfma_f32_16x16x32_bf16 v[60:63], a[176:179], a[8:11], v[60:63]
ds_read_b128 a[216:219], v42 offset:9216
s_waitcnt vmcnt(12) lgkmcnt(5)
v_mfma_f32_16x16x32_bf16 v[44:47], a[180:183], a[12:15], v[44:47]
ds_read_b128 a[160:163], v38 offset:13824
buffer_load_dwordx4 a[8:11], v1, s[8:11], s60 offen offset:3072 sc1
v_mfma_f32_16x16x32_bf16 v[48:51], a[184:187], a[12:15], v[48:51]
ds_read_b128 a[164:167], v38 offset:14848
v_mfma_f32_16x16x32_bf16 v[52:55], a[188:191], a[12:15], v[52:55]
ds_read_b128 a[168:171], v38 offset:15872
v_mfma_f32_16x16x32_bf16 v[56:59], a[192:195], a[12:15], v[56:59]
ds_read_b128 a[172:175], v38 offset:16896
v_mfma_f32_16x16x32_bf16 v[60:63], a[196:199], a[12:15], v[60:63]
ds_read_b128 a[176:179], v42 offset:13824
s_waitcnt vmcnt(12) lgkmcnt(5)
v_mfma_f32_16x16x32_bf16 v[44:47], a[200:203], a[16:19], v[44:47]
ds_read_b128 a[180:183], v38 offset:18432
s_mov_b32 s60, s61
buffer_load_dwordx4 a[12:15], v1, s[8:11], s60 offen offset:0 sc1
v_mfma_f32_16x16x32_bf16 v[48:51], a[204:207], a[16:19], v[48:51]
ds_read_b128 a[184:187], v38 offset:19456
v_mfma_f32_16x16x32_bf16 v[52:55], a[208:211], a[16:19], v[52:55]
ds_read_b128 a[188:191], v38 offset:20480
v_mfma_f32_16x16x32_bf16 v[56:59], a[212:215], a[16:19], v[56:59]
ds_read_b128 a[192:195], v38 offset:21504
v_mfma_f32_16x16x32_bf16 v[60:63], a[216:219], a[16:19], v[60:63]
ds_read_b128 a[196:199], v42 offset:18432
s_waitcnt vmcnt(11) lgkmcnt(5)
v_mfma_f32_16x16x32_bf16 v[44:47], a[160:163], a[20:23], v[44:47]
ds_read_b128 a[200:203], v38 offset:23040
buffer_load_dwordx4 a[16:19], v1, s[8:11], s60 offen offset:1024 sc1
v_mfma_f32_16x16x32_bf16 v[48:51], a[164:167], a[20:23], v[48:51]
ds_read_b128 a[204:207], v38 offset:24064
v_mfma_f32_16x16x32_bf16 v[52:55], a[168:171], a[20:23], v[52:55]
ds_read_b128 a[208:211], v38 offset:25088
v_mfma_f32_16x16x32_bf16 v[56:59], a[172:175], a[20:23], v[56:59]
ds_read_b128 a[212:215], v38 offset:26112
v_mfma_f32_16x16x32_bf16 v[60:63], a[176:179], a[20:23], v[60:63]
ds_read_b128 a[216:219], v42 offset:23040
s_waitcnt vmcnt(11) lgkmcnt(5)
v_mfma_f32_16x16x32_bf16 v[44:47], a[180:183], a[24:27], v[44:47]
ds_read_b128 a[160:163], v38 offset:27648
buffer_load_dwordx4 a[20:23], v1, s[8:11], s60 offen offset:2048 sc1
v_mfma_f32_16x16x32_bf16 v[48:51], a[184:187], a[24:27], v[48:51]
ds_read_b128 a[164:167], v38 offset:28672
v_mfma_f32_16x16x32_bf16 v[52:55], a[188:191], a[24:27], v[52:55]
ds_read_b128 a[168:171], v38 offset:29696
v_mfma_f32_16x16x32_bf16 v[56:59], a[192:195], a[24:27], v[56:59]
ds_read_b128 a[172:175], v38 offset:30720
v_mfma_f32_16x16x32_bf16 v[60:63], a[196:199], a[24:27], v[60:63]
ds_read_b128 a[176:179], v42 offset:27648
s_waitcnt vmcnt(10) lgkmcnt(5)
v_mfma_f32_16x16x32_bf16 v[44:47], a[200:203], a[28:31], v[44:47]
ds_read_b128 a[180:183], v38 offset:32256
buffer_load_dwordx4 a[24:27], v1, s[8:11], s60 offen offset:3072 sc1
v_mfma_f32_16x16x32_bf16 v[48:51], a[204:207], a[28:31], v[48:51]
ds_read_b128 a[184:187], v38 offset:33280
v_mfma_f32_16x16x32_bf16 v[52:55], a[208:211], a[28:31], v[52:55]
ds_read_b128 a[188:191], v38 offset:34304
v_mfma_f32_16x16x32_bf16 v[56:59], a[212:215], a[28:31], v[56:59]
ds_read_b128 a[192:195], v38 offset:35328
v_mfma_f32_16x16x32_bf16 v[60:63], a[216:219], a[28:31], v[60:63]
ds_read_b128 a[196:199], v42 offset:32256
s_waitcnt vmcnt(10) lgkmcnt(5)
v_mfma_f32_16x16x32_bf16 v[44:47], a[160:163], a[32:35], v[44:47]
ds_read_b128 a[200:203], v38 offset:36864
s_add_u32 s60, s60, 4096
buffer_load_dwordx4 a[28:31], v1, s[8:11], s60 offen offset:0 sc1
v_mfma_f32_16x16x32_bf16 v[48:51], a[164:167], a[32:35], v[48:51]
ds_read_b128 a[204:207], v38 offset:37888
v_mfma_f32_16x16x32_bf16 v[52:55], a[168:171], a[32:35], v[52:55]
ds_read_b128 a[208:211], v38 offset:38912
v_mfma_f32_16x16x32_bf16 v[56:59], a[172:175], a[32:35], v[56:59]
ds_read_b128 a[212:215], v38 offset:39936
v_mfma_f32_16x16x32_bf16 v[60:63], a[176:179], a[32:35], v[60:63]
ds_read_b128 a[216:219], v42 offset:36864
s_waitcnt vmcnt(10) lgkmcnt(5)
v_mfma_f32_16x16x32_bf16 v[44:47], a[180:183], a[36:39], v[44:47]
ds_read_b128 a[160:163], v38 offset:41472
buffer_load_dwordx4 a[32:35], v1, s[8:11], s60 offen offset:1024 sc1
v_mfma_f32_16x16x32_bf16 v[48:51], a[184:187], a[36:39], v[48:51]
ds_read_b128 a[164:167], v38 offset:42496
v_mfma_f32_16x16x32_bf16 v[52:55], a[188:191], a[36:39], v[52:55]
ds_read_b128 a[168:171], v38 offset:43520
v_mfma_f32_16x16x32_bf16 v[56:59], a[192:195], a[36:39], v[56:59]
ds_read_b128 a[172:175], v38 offset:44544
v_mfma_f32_16x16x32_bf16 v[60:63], a[196:199], a[36:39], v[60:63]
ds_read_b128 a[176:179], v42 offset:41472
s_waitcnt vmcnt(9) lgkmcnt(5)
v_mfma_f32_16x16x32_bf16 v[44:47], a[200:203], a[40:43], v[44:47]
ds_read_b128 a[180:183], v38 offset:46080
buffer_load_dwordx4 a[36:39], v1, s[8:11], s60 offen offset:2048 sc1
v_mfma_f32_16x16x32_bf16 v[48:51], a[204:207], a[40:43], v[48:51]
ds_read_b128 a[184:187], v38 offset:47104
v_mfma_f32_16x16x32_bf16 v[52:55], a[208:211], a[40:43], v[52:55]
ds_read_b128 a[188:191], v38 offset:48128
v_mfma_f32_16x16x32_bf16 v[56:59], a[212:215], a[40:43], v[56:59]
ds_read_b128 a[192:195], v38 offset:49152
v_mfma_f32_16x16x32_bf16 v[60:63], a[216:219], a[40:43], v[60:63]
ds_read_b128 a[196:199], v42 offset:46080
s_waitcnt vmcnt(9) lgkmcnt(5)
v_mfma_f32_16x16x32_bf16 v[44:47], a[160:163], a[0:3], v[44:47]
ds_read_b128 a[200:203], v38 offset:50688
buffer_load_dwordx4 a[40:43], v1, s[8:11], s60 offen offset:3072 sc1
v_mfma_f32_16x16x32_bf16 v[48:51], a[164:167], a[0:3], v[48:51]
ds_read_b128 a[204:207], v38 offset:51712
v_mfma_f32_16x16x32_bf16 v[52:55], a[168:171], a[0:3], v[52:55]
v_mfma_f32_16x16x32_bf16 v[56:59], a[172:175], a[0:3], v[56:59]
v_mfma_f32_16x16x32_bf16 v[60:63], a[176:179], a[0:3], v[60:63]
s_waitcnt vmcnt(9) lgkmcnt(2)
v_mfma_f32_16x16x32_bf16 v[44:47], a[180:183], a[4:7], v[44:47]
ds_read_b128 a[160:163], v36 offset:0
s_add_u32 s60, s60, 4096
buffer_load_dwordx4 a[0:3], v1, s[8:11], s60 offen offset:0 sc1
v_mfma_f32_16x16x32_bf16 v[48:51], a[184:187], a[4:7], v[48:51]
ds_read_b128 a[164:167], v36 offset:1024
v_mfma_f32_16x16x32_bf16 v[52:55], a[188:191], a[4:7], v[52:55]
ds_read_b128 a[168:171], v36 offset:2048
v_mfma_f32_16x16x32_bf16 v[56:59], a[192:195], a[4:7], v[56:59]
ds_read_b128 a[172:175], v36 offset:3072
v_mfma_f32_16x16x32_bf16 v[60:63], a[196:199], a[4:7], v[60:63]
ds_read_b128 a[176:179], v40 offset:0
s_waitcnt vmcnt(9) lgkmcnt(5)
v_mfma_f32_16x16x32_bf16 v[44:47], a[200:203], a[8:11], v[44:47]
ds_read_b128 a[180:183], v36 offset:4608
buffer_load_dwordx4 a[4:7], v1, s[8:11], s60 offen offset:1024 sc1
v_mfma_f32_16x16x32_bf16 v[48:51], a[204:207], a[8:11], v[48:51]
ds_read_b128 a[184:187], v36 offset:5632
v_mfma_f32_16x16x32_bf16 v[52:55], a[228:231], a[8:11], v[52:55]
ds_read_b128 a[188:191], v36 offset:6656
v_mfma_f32_16x16x32_bf16 v[56:59], a[232:235], a[8:11], v[56:59]
ds_read_b128 a[192:195], v36 offset:7680
v_mfma_f32_16x16x32_bf16 v[60:63], a[236:239], a[8:11], v[60:63]
ds_read_b128 a[196:199], v40 offset:4608
s_waitcnt vmcnt(9) lgkmcnt(5)
v_mfma_f32_16x16x32_bf16 v[16:19], a[160:163], a[12:15], v[16:19]
ds_read_b128 a[200:203], v36 offset:9216
buffer_load_dwordx4 a[8:11], v1, s[8:11], s60 offen offset:2048 sc1
v_mfma_f32_16x16x32_bf16 v[20:23], a[164:167], a[12:15], v[20:23]
ds_read_b128 a[204:207], v36 offset:10240
v_mfma_f32_16x16x32_bf16 v[24:27], a[168:171], a[12:15], v[24:27]
ds_read_b128 a[208:211], v36 offset:11264
v_mfma_f32_16x16x32_bf16 v[28:31], a[172:175], a[12:15], v[28:31]
ds_read_b128 a[212:215], v36 offset:12288
v_mfma_f32_16x16x32_bf16 v[32:35], a[176:179], a[12:15], v[32:35]
ds_read_b128 a[216:219], v40 offset:9216
s_waitcnt vmcnt(9) lgkmcnt(5)
v_mfma_f32_16x16x32_bf16 v[16:19], a[180:183], a[16:19], v[16:19]
ds_read_b128 a[160:163], v36 offset:13824
buffer_load_dwordx4 a[12:15], v1, s[8:11], s60 offen offset:3072 sc1
v_mfma_f32_16x16x32_bf16 v[20:23], a[184:187], a[16:19], v[20:23]
ds_read_b128 a[164:167], v36 offset:14848
v_mfma_f32_16x16x32_bf16 v[24:27], a[188:191], a[16:19], v[24:27]
ds_read_b128 a[168:171], v36 offset:15872
v_mfma_f32_16x16x32_bf16 v[28:31], a[192:195], a[16:19], v[28:31]
ds_read_b128 a[172:175], v36 offset:16896
v_cvt_pk_bf16_f32 v64, v44, v45
v_mfma_f32_16x16x32_bf16 v[32:35], a[196:199], a[16:19], v[32:35]
ds_read_b128 a[176:179], v40 offset:13824
s_waitcnt vmcnt(9) lgkmcnt(5)
v_mfma_f32_16x16x32_bf16 v[16:19], a[200:203], a[20:23], v[16:19]
ds_read_b128 a[180:183], v36 offset:18432
s_add_u32 s60, s60, 4096
buffer_load_dwordx4 a[16:19], v1, s[8:11], s60 offen offset:0 sc1
v_mfma_f32_16x16x32_bf16 v[20:23], a[204:207], a[20:23], v[20:23]
ds_read_b128 a[184:187], v36 offset:19456
v_cvt_pk_bf16_f32 v65, v46, v47
v_mfma_f32_16x16x32_bf16 v[24:27], a[208:211], a[20:23], v[24:27]
ds_read_b128 a[188:191], v36 offset:20480
v_mfma_f32_16x16x32_bf16 v[28:31], a[212:215], a[20:23], v[28:31]
ds_read_b128 a[192:195], v36 offset:21504
v_mfma_f32_16x16x32_bf16 v[32:35], a[216:219], a[20:23], v[32:35]
ds_read_b128 a[196:199], v40 offset:18432
s_waitcnt vmcnt(9) lgkmcnt(5)
v_mfma_f32_16x16x32_bf16 v[16:19], a[160:163], a[24:27], v[16:19]
ds_read_b128 a[200:203], v36 offset:23040
buffer_load_dwordx4 a[20:23], v1, s[8:11], s60 offen offset:1024 sc1
v_mfma_f32_16x16x32_bf16 v[20:23], a[164:167], a[24:27], v[20:23]
ds_read_b128 a[204:207], v36 offset:24064
v_cvt_pk_bf16_f32 v66, v48, v49
v_mfma_f32_16x16x32_bf16 v[24:27], a[168:171], a[24:27], v[24:27]
ds_read_b128 a[208:211], v36 offset:25088
buffer_store_dwordx4 v[64:67], v1, s[8:11], s62 offen offset:0 sc1
v_mfma_f32_16x16x32_bf16 v[28:31], a[172:175], a[24:27], v[28:31]
ds_read_b128 a[212:215], v36 offset:26112
v_mfma_f32_16x16x32_bf16 v[32:35], a[176:179], a[24:27], v[32:35]
ds_read_b128 a[216:219], v40 offset:23040
s_waitcnt vmcnt(10) lgkmcnt(5)
v_mfma_f32_16x16x32_bf16 v[16:19], a[180:183], a[28:31], v[16:19]
ds_read_b128 a[160:163], v36 offset:27648
buffer_load_dwordx4 a[24:27], v1, s[8:11], s60 offen offset:2048 sc1
v_mfma_f32_16x16x32_bf16 v[20:23], a[184:187], a[28:31], v[20:23]
ds_read_b128 a[164:167], v36 offset:28672
v_cvt_pk_bf16_f32 v68, v50, v51
v_mfma_f32_16x16x32_bf16 v[24:27], a[188:191], a[28:31], v[24:27]
ds_read_b128 a[168:171], v36 offset:29696
v_mfma_f32_16x16x32_bf16 v[28:31], a[192:195], a[28:31], v[28:31]
ds_read_b128 a[172:175], v36 offset:30720
v_cvt_pk_bf16_f32 v69, v52, v53
v_mfma_f32_16x16x32_bf16 v[32:35], a[196:199], a[28:31], v[32:35]
ds_read_b128 a[176:179], v40 offset:27648
s_waitcnt vmcnt(10) lgkmcnt(5)
v_mfma_f32_16x16x32_bf16 v[16:19], a[200:203], a[32:35], v[16:19]
ds_read_b128 a[180:183], v36 offset:32256
buffer_load_dwordx4 a[28:31], v1, s[8:11], s60 offen offset:3072 sc1
v_mfma_f32_16x16x32_bf16 v[20:23], a[204:207], a[32:35], v[20:23]
ds_read_b128 a[184:187], v36 offset:33280
v_cvt_pk_bf16_f32 v70, v54, v55
v_mfma_f32_16x16x32_bf16 v[24:27], a[208:211], a[32:35], v[24:27]
ds_read_b128 a[188:191], v36 offset:34304
v_mfma_f32_16x16x32_bf16 v[28:31], a[212:215], a[32:35], v[28:31]
ds_read_b128 a[192:195], v36 offset:35328
v_mfma_f32_16x16x32_bf16 v[32:35], a[216:219], a[32:35], v[32:35]
ds_read_b128 a[196:199], v40 offset:32256
s_waitcnt vmcnt(10) lgkmcnt(5)
v_mfma_f32_16x16x32_bf16 v[16:19], a[160:163], a[36:39], v[16:19]
ds_read_b128 a[200:203], v36 offset:36864
s_add_u32 s60, s60, 4096
buffer_load_dwordx4 a[32:35], v1, s[8:11], s60 offen offset:0 sc1
v_mfma_f32_16x16x32_bf16 v[20:23], a[164:167], a[36:39], v[20:23]
ds_read_b128 a[204:207], v36 offset:37888
buffer_store_dwordx4 v[68:71], v1, s[8:11], s62 offen offset:1024 sc1
v_mfma_f32_16x16x32_bf16 v[24:27], a[168:171], a[36:39], v[24:27]
ds_read_b128 a[208:211], v36 offset:38912
v_cvt_pk_bf16_f32 v72, v56, v57
v_mfma_f32_16x16x32_bf16 v[28:31], a[172:175], a[36:39], v[28:31]
ds_read_b128 a[212:215], v36 offset:39936
v_mfma_f32_16x16x32_bf16 v[32:35], a[176:179], a[36:39], v[32:35]
ds_read_b128 a[216:219], v40 offset:36864
s_waitcnt vmcnt(11) lgkmcnt(5)
v_mfma_f32_16x16x32_bf16 v[16:19], a[180:183], a[40:43], v[16:19]
ds_read_b128 a[160:163], v36 offset:41472
buffer_load_dwordx4 a[36:39], v1, s[8:11], s60 offen offset:1024 sc1
v_mfma_f32_16x16x32_bf16 v[20:23], a[184:187], a[40:43], v[20:23]
ds_read_b128 a[164:167], v36 offset:42496
v_cvt_pk_bf16_f32 v73, v58, v59
v_mfma_f32_16x16x32_bf16 v[24:27], a[188:191], a[40:43], v[24:27]
ds_read_b128 a[168:171], v36 offset:43520
v_mfma_f32_16x16x32_bf16 v[28:31], a[192:195], a[40:43], v[28:31]
ds_read_b128 a[172:175], v36 offset:44544
v_cvt_pk_bf16_f32 v74, v60, v61
v_mfma_f32_16x16x32_bf16 v[32:35], a[196:199], a[40:43], v[32:35]
ds_read_b128 a[176:179], v40 offset:41472
s_waitcnt vmcnt(11) lgkmcnt(5)
v_mfma_f32_16x16x32_bf16 v[16:19], a[200:203], a[0:3], v[16:19]
ds_read_b128 a[180:183], v36 offset:46080
buffer_load_dwordx4 a[40:43], v1, s[8:11], s60 offen offset:2048 sc1
v_mfma_f32_16x16x32_bf16 v[20:23], a[204:207], a[0:3], v[20:23]
ds_read_b128 a[184:187], v36 offset:47104
buffer_store_dwordx4 v[72:75], v1, s[8:11], s62 offen offset:2048 sc1
v_mfma_f32_16x16x32_bf16 v[24:27], a[208:211], a[0:3], v[24:27]
ds_read_b128 a[188:191], v36 offset:48128
v_mfma_f32_16x16x32_bf16 v[28:31], a[212:215], a[0:3], v[28:31]
ds_read_b128 a[192:195], v36 offset:49152
v_mfma_f32_16x16x32_bf16 v[32:35], a[216:219], a[0:3], v[32:35]
ds_read_b128 a[196:199], v40 offset:46080
s_waitcnt vmcnt(12) lgkmcnt(5)
v_mfma_f32_16x16x32_bf16 v[16:19], a[160:163], a[4:7], v[16:19]
ds_read_b128 a[200:203], v36 offset:50688
buffer_load_dwordx4 a[0:3], v1, s[8:11], s60 offen offset:3072 sc1
v_mfma_f32_16x16x32_bf16 v[20:23], a[164:167], a[4:7], v[20:23]
ds_read_b128 a[204:207], v36 offset:51712
v_cvt_pk_bf16_f32 v76, v62, v63
v_mfma_f32_16x16x32_bf16 v[24:27], a[168:171], a[4:7], v[24:27]
ds_read_b128 a[208:211], v36 offset:52736
buffer_store_dwordx4 v[76:79], v1, s[8:11], s62 offen offset:3072 sc1
v_mfma_f32_16x16x32_bf16 v[28:31], a[172:175], a[4:7], v[28:31]
ds_read_b128 a[212:215], v36 offset:53760
v_mfma_f32_16x16x32_bf16 v[32:35], a[176:179], a[4:7], v[32:35]
ds_read_b128 a[216:219], v40 offset:50688
s_waitcnt vmcnt(13) lgkmcnt(5)
v_mfma_f32_16x16x32_bf16 v[16:19], a[180:183], a[8:11], v[16:19]
ds_read_b128 a[160:163], v37 offset:0
s_add_u32 s60, s60, 4096
buffer_load_dwordx4 a[4:7], v1, s[8:11], s60 offen offset:0 sc1
v_mfma_f32_16x16x32_bf16 v[20:23], a[184:187], a[8:11], v[20:23]
ds_read_b128 a[164:167], v37 offset:1024
v_mfma_f32_16x16x32_bf16 v[24:27], a[188:191], a[8:11], v[24:27]
ds_read_b128 a[168:171], v37 offset:2048
v_mfma_f32_16x16x32_bf16 v[28:31], a[192:195], a[8:11], v[28:31]
ds_read_b128 a[172:175], v37 offset:3072
v_mfma_f32_16x16x32_bf16 v[32:35], a[196:199], a[8:11], v[32:35]
ds_read_b128 a[176:179], v41 offset:0
s_waitcnt vmcnt(13) lgkmcnt(5)
v_mfma_f32_16x16x32_bf16 v[16:19], a[200:203], a[12:15], v[16:19]
ds_read_b128 a[180:183], v37 offset:4608
buffer_load_dwordx4 a[8:11], v1, s[8:11], s60 offen offset:1024 sc1
v_mfma_f32_16x16x32_bf16 v[20:23], a[204:207], a[12:15], v[20:23]
ds_read_b128 a[184:187], v37 offset:5632
v_mfma_f32_16x16x32_bf16 v[24:27], a[208:211], a[12:15], v[24:27]
ds_read_b128 a[188:191], v37 offset:6656
v_mfma_f32_16x16x32_bf16 v[28:31], a[212:215], a[12:15], v[28:31]
ds_read_b128 a[192:195], v37 offset:7680
v_mfma_f32_16x16x32_bf16 v[32:35], a[216:219], a[12:15], v[32:35]
ds_read_b128 a[196:199], v41 offset:4608
s_waitcnt vmcnt(13) lgkmcnt(5)
v_mfma_f32_16x16x32_bf16 v[16:19], a[160:163], a[16:19], v[16:19]
ds_read_b128 a[200:203], v37 offset:9216
buffer_load_dwordx4 a[12:15], v1, s[8:11], s60 offen offset:2048 sc1
v_mfma_f32_16x16x32_bf16 v[20:23], a[164:167], a[16:19], v[20:23]
ds_read_b128 a[204:207], v37 offset:10240
v_mfma_f32_16x16x32_bf16 v[24:27], a[168:171], a[16:19], v[24:27]
ds_read_b128 a[208:211], v37 offset:11264
v_mfma_f32_16x16x32_bf16 v[28:31], a[172:175], a[16:19], v[28:31]
ds_read_b128 a[212:215], v37 offset:12288
v_mfma_f32_16x16x32_bf16 v[32:35], a[176:179], a[16:19], v[32:35]
ds_read_b128 a[216:219], v41 offset:9216
s_waitcnt vmcnt(13) lgkmcnt(5)
v_mfma_f32_16x16x32_bf16 v[16:19], a[180:183], a[20:23], v[16:19]
ds_read_b128 a[160:163], v37 offset:13824
buffer_load_dwordx4 a[16:19], v1, s[8:11], s60 offen offset:3072 sc1
v_mfma_f32_16x16x32_bf16 v[20:23], a[184:187], a[20:23], v[20:23]
ds_read_b128 a[164:167], v37 offset:14848
v_mfma_f32_16x16x32_bf16 v[24:27], a[188:191], a[20:23], v[24:27]
ds_read_b128 a[168:171], v37 offset:15872
v_mfma_f32_16x16x32_bf16 v[28:31], a[192:195], a[20:23], v[28:31]
ds_read_b128 a[172:175], v37 offset:16896
v_mfma_f32_16x16x32_bf16 v[32:35], a[196:199], a[20:23], v[32:35]
ds_read_b128 a[176:179], v41 offset:13824
s_waitcnt vmcnt(12) lgkmcnt(5)
v_mfma_f32_16x16x32_bf16 v[16:19], a[200:203], a[24:27], v[16:19]
ds_read_b128 a[180:183], v37 offset:18432
s_add_u32 s60, s60, 4096
buffer_load_dwordx4 a[20:23], v1, s[8:11], s60 offen offset:0 sc1
v_mfma_f32_16x16x32_bf16 v[20:23], a[204:207], a[24:27], v[20:23]
ds_read_b128 a[184:187], v37 offset:19456
v_mfma_f32_16x16x32_bf16 v[24:27], a[208:211], a[24:27], v[24:27]
ds_read_b128 a[188:191], v37 offset:20480
v_mfma_f32_16x16x32_bf16 v[28:31], a[212:215], a[24:27], v[28:31]
ds_read_b128 a[192:195], v37 offset:21504
v_mfma_f32_16x16x32_bf16 v[32:35], a[216:219], a[24:27], v[32:35]
ds_read_b128 a[196:199], v41 offset:18432
s_waitcnt vmcnt(12) lgkmcnt(5)
v_mfma_f32_16x16x32_bf16 v[16:19], a[160:163], a[28:31], v[16:19]
ds_read_b128 a[200:203], v37 offset:23040
buffer_load_dwordx4 a[24:27], v1, s[8:11], s60 offen offset:1024 sc1
v_mfma_f32_16x16x32_bf16 v[20:23], a[164:167], a[28:31], v[20:23]
ds_read_b128 a[204:207], v37 offset:24064
v_mfma_f32_16x16x32_bf16 v[24:27], a[168:171], a[28:31], v[24:27]
ds_read_b128 a[208:211], v37 offset:25088
v_mfma_f32_16x16x32_bf16 v[28:31], a[172:175], a[28:31], v[28:31]
ds_read_b128 a[212:215], v37 offset:26112
v_mfma_f32_16x16x32_bf16 v[32:35], a[176:179], a[28:31], v[32:35]
ds_read_b128 a[216:219], v41 offset:23040
s_waitcnt vmcnt(12) lgkmcnt(5)
v_mfma_f32_16x16x32_bf16 v[16:19], a[180:183], a[32:35], v[16:19]
ds_read_b128 a[160:163], v37 offset:27648
buffer_load_dwordx4 a[28:31], v1, s[8:11], s60 offen offset:2048 sc1
v_mfma_f32_16x16x32_bf16 v[20:23], a[184:187], a[32:35], v[20:23]
ds_read_b128 a[164:167], v37 offset:28672
v_mfma_f32_16x16x32_bf16 v[24:27], a[188:191], a[32:35], v[24:27]
ds_read_b128 a[168:171], v37 offset:29696
v_mfma_f32_16x16x32_bf16 v[28:31], a[192:195], a[32:35], v[28:31]
ds_read_b128 a[172:175], v37 offset:30720
v_mfma_f32_16x16x32_bf16 v[32:35], a[196:199], a[32:35], v[32:35]
ds_read_b128 a[176:179], v41 offset:27648
s_waitcnt vmcnt(11) lgkmcnt(5)
v_mfma_f32_16x16x32_bf16 v[16:19], a[200:203], a[36:39], v[16:19]
ds_read_b128 a[180:183], v37 offset:32256
buffer_load_dwordx4 a[32:35], v1, s[8:11], s60 offen offset:3072 sc1
v_mfma_f32_16x16x32_bf16 v[20:23], a[204:207], a[36:39], v[20:23]
ds_read_b128 a[184:187], v37 offset:33280
v_mfma_f32_16x16x32_bf16 v[24:27], a[208:211], a[36:39], v[24:27]
ds_read_b128 a[188:191], v37 offset:34304
v_mfma_f32_16x16x32_bf16 v[28:31], a[212:215], a[36:39], v[28:31]
ds_read_b128 a[192:195], v37 offset:35328
v_mfma_f32_16x16x32_bf16 v[32:35], a[216:219], a[36:39], v[32:35]
ds_read_b128 a[196:199], v41 offset:32256
s_waitcnt vmcnt(11) lgkmcnt(5)
v_mfma_f32_16x16x32_bf16 v[16:19], a[160:163], a[40:43], v[16:19]
ds_read_b128 a[200:203], v37 offset:36864
s_add_u32 s60, s60, 4096
buffer_load_dwordx4 a[36:39], v1, s[8:11], s60 offen offset:0 sc1
v_mfma_f32_16x16x32_bf16 v[20:23], a[164:167], a[40:43], v[20:23]
ds_read_b128 a[204:207], v37 offset:37888
v_mfma_f32_16x16x32_bf16 v[24:27], a[168:171], a[40:43], v[24:27]
ds_read_b128 a[208:211], v37 offset:38912
v_mfma_f32_16x16x32_bf16 v[28:31], a[172:175], a[40:43], v[28:31]
ds_read_b128 a[212:215], v37 offset:39936
v_mfma_f32_16x16x32_bf16 v[32:35], a[176:179], a[40:43], v[32:35]
ds_read_b128 a[216:219], v41 offset:36864
s_waitcnt vmcnt(10) lgkmcnt(5)
v_mfma_f32_16x16x32_bf16 v[16:19], a[180:183], a[0:3], v[16:19]
ds_read_b128 a[160:163], v37 offset:41472
buffer_load_dwordx4 a[40:43], v1, s[8:11], s60 offen offset:1024 sc1
v_mfma_f32_16x16x32_bf16 v[20:23], a[184:187], a[0:3], v[20:23]
ds_read_b128 a[164:167], v37 offset:42496
v_mfma_f32_16x16x32_bf16 v[24:27], a[188:191], a[0:3], v[24:27]
ds_read_b128 a[168:171], v37 offset:43520
v_mfma_f32_16x16x32_bf16 v[28:31], a[192:195], a[0:3], v[28:31]
ds_read_b128 a[172:175], v37 offset:44544
v_mfma_f32_16x16x32_bf16 v[32:35], a[196:199], a[0:3], v[32:35]
ds_read_b128 a[176:179], v41 offset:41472
s_waitcnt vmcnt(9) lgkmcnt(5)
v_mfma_f32_16x16x32_bf16 v[16:19], a[200:203], a[4:7], v[16:19]
ds_read_b128 a[180:183], v37 offset:46080
buffer_load_dwordx4 a[0:3], v1, s[8:11], s60 offen offset:2048 sc1
v_mfma_f32_16x16x32_bf16 v[20:23], a[204:207], a[4:7], v[20:23]
ds_read_b128 a[184:187], v37 offset:47104
v_mfma_f32_16x16x32_bf16 v[24:27], a[208:211], a[4:7], v[24:27]
ds_read_b128 a[188:191], v37 offset:48128
v_mfma_f32_16x16x32_bf16 v[28:31], a[212:215], a[4:7], v[28:31]
ds_read_b128 a[192:195], v37 offset:49152
v_mfma_f32_16x16x32_bf16 v[32:35], a[216:219], a[4:7], v[32:35]
ds_read_b128 a[196:199], v41 offset:46080
s_waitcnt vmcnt(9) lgkmcnt(5)
v_mfma_f32_16x16x32_bf16 v[16:19], a[160:163], a[8:11], v[16:19]
ds_read_b128 a[200:203], v37 offset:50688
buffer_load_dwordx4 a[4:7], v1, s[8:11], s60 offen offset:3072 sc1
v_mfma_f32_16x16x32_bf16 v[20:23], a[164:167], a[8:11], v[20:23]
ds_read_b128 a[204:207], v37 offset:51712
v_mfma_f32_16x16x32_bf16 v[24:27], a[168:171], a[8:11], v[24:27]
ds_read_b128 a[208:211], v37 offset:52736
v_mfma_f32_16x16x32_bf16 v[28:31], a[172:175], a[8:11], v[28:31]
ds_read_b128 a[212:215], v37 offset:53760
v_mfma_f32_16x16x32_bf16 v[32:35], a[176:179], a[8:11], v[32:35]
ds_read_b128 a[216:219], v41 offset:50688
s_waitcnt vmcnt(9) lgkmcnt(5)
v_mfma_f32_16x16x32_bf16 v[16:19], a[180:183], a[12:15], v[16:19]
ds_read_b128 a[160:163], v38 offset:0
s_add_u32 s60, s60, 4096
buffer_load_dwordx4 a[8:11], v1, s[8:11], s60 offen offset:0 sc1
v_mfma_f32_16x16x32_bf16 v[20:23], a[184:187], a[12:15], v[20:23]
ds_read_b128 a[164:167], v38 offset:1024
v_mfma_f32_16x16x32_bf16 v[24:27], a[188:191], a[12:15], v[24:27]
ds_read_b128 a[168:171], v38 offset:2048
v_mfma_f32_16x16x32_bf16 v[28:31], a[192:195], a[12:15], v[28:31]
ds_read_b128 a[172:175], v38 offset:3072
v_mfma_f32_16x16x32_bf16 v[32:35], a[196:199], a[12:15], v[32:35]
ds_read_b128 a[176:179], v42 offset:0
s_waitcnt vmcnt(9) lgkmcnt(5)
v_mfma_f32_16x16x32_bf16 v[16:19], a[200:203], a[16:19], v[16:19]
ds_read_b128 a[180:183], v38 offset:4608
buffer_load_dwordx4 a[12:15], v1, s[8:11], s60 offen offset:1024 sc1
v_mfma_f32_16x16x32_bf16 v[20:23], a[204:207], a[16:19], v[20:23]
ds_read_b128 a[184:187], v38 offset:5632
v_mfma_f32_16x16x32_bf16 v[24:27], a[208:211], a[16:19], v[24:27]
ds_read_b128 a[188:191], v38 offset:6656
v_mfma_f32_16x16x32_bf16 v[28:31], a[212:215], a[16:19], v[28:31]
ds_read_b128 a[192:195], v38 offset:7680
v_mfma_f32_16x16x32_bf16 v[32:35], a[216:219], a[16:19], v[32:35]
ds_read_b128 a[196:199], v42 offset:4608
s_waitcnt vmcnt(9) lgkmcnt(5)
v_mfma_f32_16x16x32_bf16 v[16:19], a[160:163], a[20:23], v[16:19]
ds_read_b128 a[200:203], v38 offset:9216
buffer_load_dwordx4 a[16:19], v1, s[8:11], s60 offen offset:2048 sc1
v_mfma_f32_16x16x32_bf16 v[20:23], a[164:167], a[20:23], v[20:23]
ds_read_b128 a[204:207], v38 offset:10240
v_mfma_f32_16x16x32_bf16 v[24:27], a[168:171], a[20:23], v[24:27]
ds_read_b128 a[208:211], v38 offset:11264
v_mfma_f32_16x16x32_bf16 v[28:31], a[172:175], a[20:23], v[28:31]
ds_read_b128 a[212:215], v38 offset:12288
v_mfma_f32_16x16x32_bf16 v[32:35], a[176:179], a[20:23], v[32:35]
ds_read_b128 a[216:219], v42 offset:9216
s_waitcnt vmcnt(9) lgkmcnt(5)
v_mfma_f32_16x16x32_bf16 v[16:19], a[180:183], a[24:27], v[16:19]
ds_read_b128 a[160:163], v38 offset:13824
buffer_load_dwordx4 a[20:23], v1, s[8:11], s60 offen offset:3072 sc1
v_mfma_f32_16x16x32_bf16 v[20:23], a[184:187], a[24:27], v[20:23]
ds_read_b128 a[164:167], v38 offset:14848
v_mfma_f32_16x16x32_bf16 v[24:27], a[188:191], a[24:27], v[24:27]
ds_read_b128 a[168:171], v38 offset:15872
v_mfma_f32_16x16x32_bf16 v[28:31], a[192:195], a[24:27], v[28:31]
ds_read_b128 a[172:175], v38 offset:16896
v_mfma_f32_16x16x32_bf16 v[32:35], a[196:199], a[24:27], v[32:35]
ds_read_b128 a[176:179], v42 offset:13824
s_waitcnt vmcnt(9) lgkmcnt(5)
v_mfma_f32_16x16x32_bf16 v[16:19], a[200:203], a[28:31], v[16:19]
ds_read_b128 a[180:183], v38 offset:18432
buffer_load_dwordx4 v[80:83], v1, s[8:11], s63 offen offset:0 sc1
v_mfma_f32_16x16x32_bf16 v[20:23], a[204:207], a[28:31], v[20:23]
ds_read_b128 a[184:187], v38 offset:19456
v_mfma_f32_16x16x32_bf16 v[24:27], a[208:211], a[28:31], v[24:27]
ds_read_b128 a[188:191], v38 offset:20480
v_mfma_f32_16x16x32_bf16 v[28:31], a[212:215], a[28:31], v[28:31]
ds_read_b128 a[192:195], v38 offset:21504
v_mfma_f32_16x16x32_bf16 v[32:35], a[216:219], a[28:31], v[32:35]
ds_read_b128 a[196:199], v42 offset:18432
s_waitcnt vmcnt(9) lgkmcnt(5)
v_mfma_f32_16x16x32_bf16 v[16:19], a[160:163], a[32:35], v[16:19]
ds_read_b128 a[200:203], v38 offset:23040
buffer_load_dwordx4 v[84:87], v1, s[8:11], s63 offen offset:1024 sc1
v_mfma_f32_16x16x32_bf16 v[20:23], a[164:167], a[32:35], v[20:23]
ds_read_b128 a[204:207], v38 offset:24064
v_mfma_f32_16x16x32_bf16 v[24:27], a[168:171], a[32:35], v[24:27]
ds_read_b128 a[208:211], v38 offset:25088
v_mfma_f32_16x16x32_bf16 v[28:31], a[172:175], a[32:35], v[28:31]
ds_read_b128 a[212:215], v38 offset:26112
v_mfma_f32_16x16x32_bf16 v[32:35], a[176:179], a[32:35], v[32:35]
ds_read_b128 a[216:219], v42 offset:23040
s_waitcnt vmcnt(9) lgkmcnt(5)
v_mfma_f32_16x16x32_bf16 v[16:19], a[180:183], a[36:39], v[16:19]
ds_read_b128 a[160:163], v38 offset:27648
buffer_load_dwordx4 v[88:91], v1, s[8:11], s63 offen offset:2048 sc1
v_mfma_f32_16x16x32_bf16 v[20:23], a[184:187], a[36:39], v[20:23]
ds_read_b128 a[164:167], v38 offset:28672
v_mfma_f32_16x16x32_bf16 v[24:27], a[188:191], a[36:39], v[24:27]
ds_read_b128 a[168:171], v38 offset:29696
v_mfma_f32_16x16x32_bf16 v[28:31], a[192:195], a[36:39], v[28:31]
ds_read_b128 a[172:175], v38 offset:30720
v_mfma_f32_16x16x32_bf16 v[32:35], a[196:199], a[36:39], v[32:35]
ds_read_b128 a[176:179], v42 offset:27648
s_waitcnt vmcnt(9) lgkmcnt(5)
v_mfma_f32_16x16x32_bf16 v[16:19], a[200:203], a[40:43], v[16:19]
ds_read_b128 a[180:183], v38 offset:32256
buffer_load_dwordx4 v[92:95], v1, s[8:11], s63 offen offset:3072 sc1
v_mfma_f32_16x16x32_bf16 v[20:23], a[204:207], a[40:43], v[20:23]
ds_read_b128 a[184:187], v38 offset:33280
v_mfma_f32_16x16x32_bf16 v[24:27], a[208:211], a[40:43], v[24:27]
ds_read_b128 a[188:191], v38 offset:34304
v_mfma_f32_16x16x32_bf16 v[28:31], a[212:215], a[40:43], v[28:31]
ds_read_b128 a[192:195], v38 offset:35328
v_mfma_f32_16x16x32_bf16 v[32:35], a[216:219], a[40:43], v[32:35]
ds_read_b128 a[196:199], v42 offset:32256
s_waitcnt vmcnt(9) lgkmcnt(5)
v_mfma_f32_16x16x32_bf16 v[16:19], a[160:163], a[0:3], v[16:19]
ds_read_b128 a[200:203], v38 offset:36864
v_mfma_f32_16x16x32_bf16 v[20:23], a[164:167], a[0:3], v[20:23]
ds_read_b128 a[204:207], v38 offset:37888
v_mfma_f32_16x16x32_bf16 v[24:27], a[168:171], a[0:3], v[24:27]
ds_read_b128 a[208:211], v38 offset:38912
v_mfma_f32_16x16x32_bf16 v[28:31], a[172:175], a[0:3], v[28:31]
ds_read_b128 a[212:215], v38 offset:39936
v_mfma_f32_16x16x32_bf16 v[32:35], a[176:179], a[0:3], v[32:35]
ds_read_b128 a[216:219], v42 offset:36864
s_waitcnt vmcnt(8) lgkmcnt(5)
v_mfma_f32_16x16x32_bf16 v[16:19], a[180:183], a[4:7], v[16:19]
ds_read_b128 a[160:163], v38 offset:41472
v_mfma_f32_16x16x32_bf16 v[20:23], a[184:187], a[4:7], v[20:23]
ds_read_b128 a[164:167], v38 offset:42496
v_mfma_f32_16x16x32_bf16 v[24:27], a[188:191], a[4:7], v[24:27]
ds_read_b128 a[168:171], v38 offset:43520
v_mfma_f32_16x16x32_bf16 v[28:31], a[192:195], a[4:7], v[28:31]
ds_read_b128 a[172:175], v38 offset:44544
v_mfma_f32_16x16x32_bf16 v[32:35], a[196:199], a[4:7], v[32:35]
ds_read_b128 a[176:179], v42 offset:41472
s_waitcnt vmcnt(7) lgkmcnt(5)
v_mfma_f32_16x16x32_bf16 v[16:19], a[200:203], a[8:11], v[16:19]
ds_read_b128 a[180:183], v38 offset:46080
v_mfma_f32_16x16x32_bf16 v[20:23], a[204:207], a[8:11], v[20:23]
ds_read_b128 a[184:187], v38 offset:47104
v_mfma_f32_16x16x32_bf16 v[24:27], a[208:211], a[8:11], v[24:27]
ds_read_b128 a[188:191], v38 offset:48128
v_mfma_f32_16x16x32_bf16 v[28:31], a[212:215], a[8:11], v[28:31]
ds_read_b128 a[192:195], v38 offset:49152
v_mfma_f32_16x16x32_bf16 v[32:35], a[216:219], a[8:11], v[32:35]
ds_read_b128 a[196:199], v42 offset:46080
s_waitcnt vmcnt(6) lgkmcnt(5)
v_mfma_f32_16x16x32_bf16 v[16:19], a[160:163], a[12:15], v[16:19]
ds_read_b128 a[200:203], v38 offset:50688
v_mfma_f32_16x16x32_bf16 v[20:23], a[164:167], a[12:15], v[20:23]
ds_read_b128 a[204:207], v38 offset:51712
v_mfma_f32_16x16x32_bf16 v[24:27], a[168:171], a[12:15], v[24:27]
v_mfma_f32_16x16x32_bf16 v[28:31], a[172:175], a[12:15], v[28:31]
v_mfma_f32_16x16x32_bf16 v[32:35], a[176:179], a[12:15], v[32:35]
s_waitcnt vmcnt(5) lgkmcnt(2)
v_mfma_f32_16x16x32_bf16 v[16:19], a[180:183], a[16:19], v[16:19]
v_mfma_f32_16x16x32_bf16 v[20:23], a[184:187], a[16:19], v[20:23]
v_mfma_f32_16x16x32_bf16 v[24:27], a[188:191], a[16:19], v[24:27]
v_mfma_f32_16x16x32_bf16 v[28:31], a[192:195], a[16:19], v[28:31]
v_mfma_f32_16x16x32_bf16 v[32:35], a[196:199], a[16:19], v[32:35]
s_waitcnt vmcnt(4) lgkmcnt(0)
v_mfma_f32_16x16x32_bf16 v[16:19], a[200:203], a[20:23], v[16:19]
s_waitcnt vmcnt(0)
v_xor_b32 v118, v248, v83
v_xor_b32 v119, v248, v87
v_xor_b32 v120, v248, v91
v_xor_b32 v121, v248, v95
v_mfma_f32_16x16x32_bf16 v[20:23], a[204:207], a[20:23], v[20:23]
v_or3_b32 v118, v118, v119, v120
v_or_b32 v118, v118, v121
v_cmp_ne_u32 vcc, 0, v118
s_nop 0
s_cbranch_vccnz L_xslow_36
L_xback_37:
v_mfma_f32_16x16x32_bf16 v[24:27], a[228:231], a[20:23], v[24:27]
v_lshlrev_b32 v96, 16, v80
v_and_b32 v97, 0xffff0000, v80
v_lshlrev_b32 v98, 16, v81
v_and_b32 v99, 0xffff0000, v81
v_lshlrev_b32 v100, 16, v82
v_and_b32 v101, 0xffff0000, v82
v_mfma_f32_16x16x32_bf16 v[28:31], a[232:235], a[20:23], v[28:31]
v_lshlrev_b32 v102, 16, v84
v_and_b32 v103, 0xffff0000, v84
v_lshlrev_b32 v104, 16, v85
v_and_b32 v105, 0xffff0000, v85
v_lshlrev_b32 v106, 16, v86
v_and_b32 v107, 0xffff0000, v86
v_mfma_f32_16x16x32_bf16 v[32:35], a[236:239], a[20:23], v[32:35]
v_lshlrev_b32 v108, 16, v88
v_and_b32 v109, 0xffff0000, v88
v_lshlrev_b32 v110, 16, v89
v_and_b32 v111, 0xffff0000, v89
v_lshlrev_b32 v112, 16, v90
v_and_b32 v113, 0xffff0000, v90
v_lshlrev_b32 v114, 16, v92
v_and_b32 v115, 0xffff0000, v92
s_nop 3
v_pk_add_f32 v[16:17], v[16:17], v[96:97]
v_pk_add_f32 v[18:19], v[18:19], v[98:99]
v_pk_add_f32 v[20:21], v[20:21], v[100:101]
v_pk_add_f32 v[22:23], v[22:23], v[102:103]
v_pk_add_f32 v[24:25], v[24:25], v[104:105]
v_pk_add_f32 v[26:27], v[26:27], v[106:107]
v_pk_add_f32 v[28:29], v[28:29], v[108:109]
v_pk_add_f32 v[30:31], v[30:31], v[110:111]
v_pk_add_f32 v[32:33], v[32:33], v[112:113]
v_pk_add_f32 v[34:35], v[34:35], v[114:115]
s_cmp_eq_u32 s29, 1
s_cbranch_scc1 L_last
v_pk_add_f32 v[142:143], v[16:17], v[18:19]
v_pk_mul_f32 v[144:145], v[16:17], v[16:17]
v_pk_fma_f32 v[144:145], v[18:19], v[18:19], v[144:145]
v_pk_add_f32 v[142:143], v[142:143], v[20:21]
v_pk_fma_f32 v[144:145], v[20:21], v[20:21], v[144:145]
v_pk_add_f32 v[142:143], v[142:143], v[22:23]
v_pk_fma_f32 v[144:145], v[22:23], v[22:23], v[144:145]
v_pk_add_f32 v[142:143], v[142:143], v[24:25]
v_pk_fma_f32 v[144:145], v[24:25], v[24:25], v[144:145]
v_pk_add_f32 v[142:143], v[142:143], v[26:27]
v_pk_fma_f32 v[144:145], v[26:27], v[26:27], v[144:145]
v_pk_add_f32 v[142:143], v[142:143], v[28:29]
v_pk_fma_f32 v[144:145], v[28:29], v[28:29], v[144:145]
v_pk_add_f32 v[142:143], v[142:143], v[30:31]
v_pk_fma_f32 v[144:145], v[30:31], v[30:31], v[144:145]
s_mov_b32 exec_hi, 0
v_pk_add_f32 v[142:143], v[142:143], v[32:33]
v_pk_fma_f32 v[144:145], v[32:33], v[32:33], v[144:145]
v_pk_add_f32 v[142:143], v[142:143], v[34:35]
v_pk_fma_f32 v[144:145], v[34:35], v[34:35], v[144:145]
s_mov_b64 exec, -1
v_add_f32 v136, v142, v143
v_add_f32 v137, v144, v145
v_cvt_pk_bf16_f32 v132, v32, v33
v_cvt_pk_bf16_f32 v133, v34, v35
v_permlane32_swap_b32 v136, v137
v_add_f32 v136, v136, v137
v_mov_b32 v137, v136
v_cvt_pk_bf16_f32 v124, v16, v17
v_cvt_pk_bf16_f32 v125, v18, v19
v_permlane16_swap_b32 v136, v137
v_add_f32 v136, v136, v137
v_mov_b32 v137, v136
v_cvt_pk_bf16_f32 v126, v20, v21
v_cvt_pk_bf16_f32 v127, v22, v23
v_permlane32_swap_b32 v136, v137
buffer_store_dwordx4 v[124:127], v140, s[8:11], s66 offen sc1
buffer_store_dwordx2 v[136:137], v138, s[8:11], s67 offen sc1
v_cvt_pk_bf16_f32 v128, v24, v25
v_cvt_pk_bf16_f32 v129, v26, v27
v_cvt_pk_bf16_f32 v130, v28, v29
v_cvt_pk_bf16_f32 v131, v30, v31
v_permlane16_swap_b32 v132, v134
v_permlane16_swap_b32 v133, v135
buffer_store_dwordx4 v[128:131], v140, s[8:11], s66 offen offset:1024 sc1
buffer_store_dwordx4 v[132:135], v141, s[8:11], s66 offen sc1
s_barrier
s_mul_i32 s36, s26, 132608
s_mul_i32 s38, s24, 12288
s_add_u32 m0, s38, 0
s_add_u32 s39, s38, s36
buffer_load_dwordx4 v1, s[4:7], s39 offen offset:0 sc1 lds
buffer_load_dwordx4 v1, s[4:7], s39 offen offset:1024 sc1 lds
buffer_load_dwordx4 v1, s[4:7], s39 offen offset:2048 sc1 lds
buffer_load_dwordx4 v1, s[4:7], s39 offen offset:3072 sc1 lds
s_add_u32 m0, m0, 4096
s_add_u32 s39, s39, 4096
buffer_load_dwordx4 v1, s[4:7], s39 offen offset:0 sc1 lds
buffer_load_dwordx4 v1, s[4:7], s39 offen offset:1024 sc1 lds
buffer_load_dwordx4 v1, s[4:7], s39 offen offset:2048 sc1 lds
buffer_load_dwordx4 v1, s[4:7], s39 offen offset:3072 sc1 lds
s_and_b32 s33, s27, 1
s_cmp_lt_u32 s27, 31
s_cselect_b32 s33, s33, 0
s_cmp_eq_u32 s33, 1
s_cselect_b32 s34, -1, 0xffff
s_mov_b32 s35, 0
v_lshlrev_b32 v7, 3, v1
s_lshr_b32 s31, s81, 4
s_lshl_b32 s31, s31, 11
v_add_u32 v7, s31, v7
s_cmp_eq_u32 s24, 0
s_cselect_b32 s30, 0, 1073741824
s_add_u32 s30, s30, 26607616
s_waitcnt vmcnt(8)
s_barrier
s_mov_b64 exec, s[34:35]
buffer_atomic_add v4, v7, s[8:11], s30 offen sc1
s_mov_b64 exec, -1
s_cmp_eq_u32 s29, 1
s_cbranch_scc1 L_main_fin
s_cmp_eq_u32 s25, 0
s_cselect_b32 s34, 16, 24
s_lshl_b32 s35, s80, 7
s_add_u32 s35, s35, 26607616
s_cmp_eq_u32 s24, 1
s_cselect_b32 s35, s35, 1073741824
v_mov_b32 v6, 0
v_mov_b32 v244, 0
v_mov_b32 v245, 0
v_mov_b32 v246, 0
s_add_u32 m0, m0, 4096
s_add_u32 s39, s39, 4096
buffer_load_dwordx4 v1, s[4:7], s39 offen offset:0 sc1 lds
buffer_load_dwordx4 v1, s[4:7], s39 offen offset:1024 sc1 lds
buffer_load_dwordx4 v1, s[4:7], s39 offen offset:2048 sc1 lds
buffer_load_dwordx4 v1, s[4:7], s39 offen offset:3072 sc1 lds
s_mul_i32 s36, s26, 132608
s_mul_i32 s38, s24, 9216
s_add_u32 m0, s38, 49152
s_add_u32 s39, s38, s36
s_add_u32 s39, s39, 49152
s_mov_b64 exec, 1
buffer_atomic_add v244, v6, s[8:11], s35 offen sc0 sc1
s_mov_b64 exec, -1
buffer_load_dwordx4 v1, s[4:7], s39 offen offset:0 sc1 lds
buffer_load_dwordx4 v1, s[4:7], s39 offen offset:1024 sc1 lds
buffer_load_dwordx4 v1, s[4:7], s39 offen offset:2048 sc1 lds
s_mov_b64 exec, 1
buffer_atomic_add v245, v6, s[8:11], s35 offen sc0 sc1
s_mov_b64 exec, -1
buffer_load_dwordx4 v1, s[4:7], s39 offen offset:3072 sc1 lds
s_add_u32 m0, m0, 4096
s_add_u32 s39, s39, 4096
buffer_load_dwordx4 v1, s[4:7], s39 offen offset:0 sc1 lds
buffer_load_dwordx4 v1, s[4:7], s39 offen offset:1024 sc1 lds
s_mov_b64 exec, 1
buffer_atomic_add v246, v6, s[8:11], s35 offen sc0 sc1
s_mov_b64 exec, -1
buffer_load_dwordx4 v1, s[4:7], s39 offen offset:2048 sc1 lds
buffer_load_dwordx4 v1, s[4:7], s39 offen offset:3072 sc1 lds
s_add_u32 m0, m0, 4096
s_add_u32 s39, s39, 4096
buffer_load_dwordx4 v1, s[4:7], s39 offen offset:0 sc1 lds
s_lshl_b32 s60, s25, 3
s_sub_u32 s61, s60, 1
s_max_i32 s61, s61, 0
s_lshl_b32 s30, s24, 1
s_add_u32 s60, s60, s30
s_mul_i32 s30, s61, 18432
s_mul_i32 s62, s60, 18432
v_add_u32 v237, 18432, v1
s_mul_i32 s38, s24, 5120
s_add_u32 m0, s38, 135168
s_add_u32 s39, s38, s30
s_cmp_eq_u32 s24, 1
s_cbranch_scc0 L_other_41
s_mov_b32 s31, 0
s_mov_b64 exec, 1
v_mov_b32 v247, 0
buffer_atomic_add v247, v6, s[8:11], s35 offen sc0 sc1
s_waitcnt vmcnt(12)
v_cmp_gt_u32 vcc, s34, v244
s_nop 0
s_cbranch_vccz L_polled_40
s_waitcnt vmcnt(8)
v_cmp_gt_u32 vcc, s34, v245
s_nop 0
s_cbranch_vccz L_polled_40
v_mov_b32 v244, 0
buffer_atomic_add v244, v6, s[8:11], s35 offen sc0 sc1
s_waitcnt vmcnt(5)
v_cmp_gt_u32 vcc, s34, v246
s_nop 0
s_cbranch_vccz L_polled_40
v_mov_b32 v245, 0
buffer_atomic_add v245, v6, s[8:11], s35 offen sc0 sc1
L_poll_39:
s_add_u32 s31, s31, 1
s_cmp_gt_u32 s31, 100000
s_cbranch_scc1 L_polled_40
v_mov_b32 v246, 0
buffer_atomic_add v246, v6, s[8:11], s35 offen sc0 sc1
s_waitcnt vmcnt(3)
v_cmp_gt_u32 vcc, s34, v247
s_nop 0
s_cbranch_vccz L_polled_40
v_mov_b32 v247, 0
buffer_atomic_add v247, v6, s[8:11], s35 offen sc0 sc1
s_waitcnt vmcnt(3)
v_cmp_gt_u32 vcc, s34, v244
s_nop 0
s_cbranch_vccz L_polled_40
v_mov_b32 v244, 0
buffer_atomic_add v244, v6, s[8:11], s35 offen sc0 sc1
s_waitcnt vmcnt(3)
v_cmp_gt_u32 vcc, s34, v245
s_nop 0
s_cbranch_vccz L_polled_40
v_mov_b32 v245, 0
buffer_atomic_add v245, v6, s[8:11], s35 offen sc0 sc1
s_waitcnt vmcnt(3)
v_cmp_gt_u32 vcc, s34, v246
s_nop 0
s_cbranch_vccz L_polled_40
s_branch L_poll_39
L_polled_40:
s_mov_b64 exec, -1
L_other_41:
s_barrier
s_mov_b32 s29, 1
s_add_u32 s8, s8, 30834688
s_addc_u32 s9, s9, 0
s_mov_b32 s10, 30834688
s_branch L_layer
L_last:
v_cvt_pk_bf16_f32 v148, v16, v17
v_cvt_pk_bf16_f32 v149, v18, v19
v_cvt_pk_bf16_f32 v150, v20, v21
v_cvt_pk_bf16_f32 v151, v22, v23
v_cvt_pk_bf16_f32 v152, v24, v25
v_cvt_pk_bf16_f32 v153, v26, v27
v_cvt_pk_bf16_f32 v154, v28, v29
v_cvt_pk_bf16_f32 v155, v30, v31
v_cvt_pk_bf16_f32 v156, v32, v33
v_cvt_pk_bf16_f32 v157, v34, v35
buffer_store_dwordx4 v[148:151], v164, s[16:19], s68 offen
buffer_store_dwordx4 v[152:155], v164, s[16:19], s68 offen offset:64
v_permlane16_swap_b32 v156, v158
v_permlane16_swap_b32 v157, v159
buffer_store_dwordx4 v[156:159], v165, s[16:19], s68 offen
L_main_fin:
L_main_end:
s_endpgm
L_tagslow_1:
buffer_load_dwordx2 v[238:239], v48, s[84:87], 0 offen sc1
s_add_u32 s31, s31, 1
s_waitcnt vmcnt(0)
v_cmp_eq_u32 vcc, 0, v238
s_cmp_gt_u32 s31, 200000
s_cbranch_scc1 L_tagback_2
s_cbranch_vccnz L_tagslow_1
s_branch L_tagback_2
L_dbslow_11:
s_mov_b32 s67, 0
L_dbslow_11x:
buffer_load_dwordx2 v[148:149], v146, s[4:7], s66 offen sc1
s_add_u32 s67, s67, 1
s_waitcnt vmcnt(0)
v_cmp_ne_u64 vcc, v[148:149], v[238:239]
s_cmp_gt_u32 s67, 200000
s_cbranch_scc1 L_dbback_12
s_cbranch_vccnz L_dbslow_11x
s_branch L_dbback_12
L_stzslow_23:
s_mov_b32 s31, 0
L_stzloop_25:
buffer_load_dwordx2 v[182:183], v234, s[8:11], s61 offen offset:0 sc1
buffer_load_dwordx2 v[184:185], v234, s[8:11], s61 offen offset:1024 sc1
buffer_load_dwordx2 v[186:187], v234, s[8:11], s61 offen offset:2048 sc1
buffer_load_dwordx2 v[188:189], v234, s[8:11], s61 offen offset:3072 sc1
buffer_load_dwordx2 v[190:191], v235, s[8:11], s61 offen offset:0 sc1
buffer_load_dwordx2 v[192:193], v235, s[8:11], s61 offen offset:1024 sc1
buffer_load_dwordx2 v[194:195], v235, s[8:11], s61 offen offset:2048 sc1
buffer_load_dwordx2 v[196:197], v235, s[8:11], s61 offen offset:3072 sc1
s_add_u32 s31, s31, 1
s_waitcnt vmcnt(0)
v_min3_f32 v200, v183, v185, v187
v_min3_f32 v201, v189, v191, v193
v_min3_f32 v200, v200, v195, v197
v_min_f32 v200, v200, v201
v_cmp_gt_f32 vcc, 0, v200
s_cmp_gt_u32 s31, 200000
s_cbranch_scc1 L_stzback_24
s_cbranch_vccnz L_stzloop_25
s_branch L_stzback_24
L_xslow_36:
s_mov_b32 s31, 0
L_xloop_38:
buffer_load_dwordx4 v[80:83], v1, s[8:11], s63 offen offset:0 sc1
buffer_load_dwordx4 v[84:87], v1, s[8:11], s63 offen offset:1024 sc1
buffer_load_dwordx4 v[88:91], v1, s[8:11], s63 offen offset:2048 sc1
buffer_load_dwordx4 v[92:95], v1, s[8:11], s63 offen offset:3072 sc1
s_add_u32 s31, s31, 1
s_waitcnt vmcnt(0)
v_xor_b32 v118, v248, v83
v_xor_b32 v119, v248, v87
v_xor_b32 v120, v248, v91
v_xor_b32 v121, v248, v95
v_or3_b32 v118, v118, v119, v120
v_or_b32 v118, v118, v121
v_cmp_ne_u32 vcc, 0, v118
s_cmp_gt_u32 s31, 200000
s_cbranch_scc1 L_xback_37
s_cbranch_vccnz L_xloop_38
s_branch L_xback_37
L_code_end:
.section .rodata,"a"
.p2align 6
.amdhsa_kernel main_kernel
  .amdhsa_next_free_vgpr 512
  .amdhsa_next_free_sgpr 102
  .amdhsa_accum_offset 256
  .amdhsa_group_segment_fixed_size 0
  .amdhsa_kernarg_size 88
  .amdhsa_user_sgpr_count 2
  .amdhsa_user_sgpr_kernarg_segment_ptr 1
  .amdhsa_system_sgpr_workgroup_id_x 1
  .amdhsa_float_denorm_mode_32 3
.end_amdhsa_kernel
```

```asm
; @launch kernel=main_kernel grid=(256,1,1) block=(256,1,1) lds=163840
.amdgcn_target "amdgcn-amd-amdhsa--gfx950"
.text
.globl main_kernel
.p2align 8
.type main_kernel,@function
main_kernel:
s_cmp_ge_u32 s2, 256
s_cbranch_scc1 L_main_end
s_load_dwordx16 s[64:79], s[0:1], 0
s_memrealtime s[96:97]
s_load_dwordx2 s[4:5], s[0:1], 80
s_load_dwordx2 s[16:17], s[0:1], 64
s_load_dwordx2 s[84:85], s[0:1], 72
s_getpc_b64 s[88:89]
L_pc:
s_mov_b32 s90, L_code_end-L_pc
s_mov_b32 s91, 0x20000
s_lshr_b32 s31, s2, 3
s_lshl_b32 s31, s31, 10
v_lshl_add_u32 v14, v0, 2, s31
s_mov_b32 s37, L_pc-L_pc
buffer_load_dword v15, v14, s[88:91], s37 offen
v_lshrrev_b32 v6, 6, v0
v_and_b32 v0, 63, v0
v_readfirstlane_b32 s24, v6
v_lshlrev_b32 v1, 4, v0
v_and_b32 v2, 15, v0
v_lshrrev_b32 v3, 4, v0
v_cmp_gt_u32 s[50:51], 2, v3
s_nop 0
s_cmp_lt_u32 s2, 128
s_cbranch_scc1 L_p0_x1
s_sub_u32 s30, s2, 128
s_cmp_lt_u32 s30, 108
s_cselect_b32 s62, 0, 1073741824
s_cselect_b32 s30, s30, 0
s_and_b32 s60, s30, 3
s_lshr_b32 s61, s30, 2
s_mov_b32 s14, 1990656
s_mov_b32 s15, 0x20000
s_mul_i32 s30, s60, 497664
s_lshl_b32 s31, s61, 7
s_add_u32 s30, s30, s31
s_mul_i32 s31, s24, 27648
s_add_u32 s30, s30, s31
s_add_u32 s30, s30, s62
v_lshrrev_b32 v36, 7, v1
v_mul_u32_u24 v42, 3456, v36
v_and_b32 v36, 0x70, v1
v_add_u32 v42, v36, v42
s_lshl_b32 s32, s24, 10
s_waitcnt lgkmcnt(0)
s_mov_b32 s12, s66
s_mov_b32 s13, s67
s_add_u32 m0, s32, 0
s_add_u32 s31, s30, 0
buffer_load_dwordx4 v42, s[12:15], s31 offen nt lds
s_add_u32 m0, s32, 4096
s_add_u32 s31, s30, 110592
buffer_load_dwordx4 v42, s[12:15], s31 offen nt lds
s_add_u32 m0, s32, 8192
s_add_u32 s31, s30, 221184
buffer_load_dwordx4 v42, s[12:15], s31 offen nt lds
s_add_u32 m0, s32, 12288
s_add_u32 s31, s30, 331776
buffer_load_dwordx4 v42, s[12:15], s31 offen nt lds
s_add_u32 m0, s32, 16384
s_add_u32 s31, s30, 442368
s_cmp_lt_u32 s24, 2
s_cselect_b32 s31, s31, 1073741824
buffer_load_dwordx4 v42, s[12:15], s31 offen nt lds
s_branch L_p0_j1
L_p0_x1:
s_mov_b32 s14, 2359296
s_mov_b32 s15, 0x20000
s_mul_i32 s30, s24, 18
v_add_u32 v36, s30, v3
v_mul_u32_u24 v42, 1152, v2
v_lshl_add_u32 v42, v36, 4, v42
s_mul_i32 s30, s2, 18432
v_mov_b32 v37, 1073741824
v_cndmask_b32 v37, v37, v42, s[50:51]
s_waitcnt lgkmcnt(0)
s_mov_b32 s12, s64
s_mov_b32 s13, s65
buffer_load_dwordx4 v[64:67], v42, s[12:15], s30 offen offset:0
buffer_load_dwordx4 v[68:71], v42, s[12:15], s30 offen offset:64
buffer_load_dwordx4 v[72:75], v42, s[12:15], s30 offen offset:128
buffer_load_dwordx4 v[76:79], v42, s[12:15], s30 offen offset:192
buffer_load_dwordx4 v[80:83], v37, s[12:15], s30 offen offset:256
L_p0_j1:
s_mov_b32 s86, 256
s_mov_b32 s87, 0x20000
s_xor_b32 s30, s2, 248
s_or_b32 s30, s30, s24
s_cmp_eq_u32 s30, 0
s_cselect_b32 s30, 0, 1073741824
v_mov_b32 v48, 0
s_or_b32 s96, s96, 1
v_mov_b32 v238, s96
v_mov_b32 v239, s97
s_mov_b64 exec, 1
buffer_store_dwordx2 v[238:239], v48, s[84:87], s30 offen sc1
s_mov_b64 exec, -1
v_mov_b32 v4, 1
v_mov_b32 v5, 0
s_mov_b32 s56, 0
s_mov_b32 s29, 0
v_add_u32 v9, 66560, v1
v_cmp_eq_u32 s[46:47], 0, v3
v_cmp_eq_u32 s[48:49], 2, v3
s_mov_b32 s6, 19451904
s_mov_b32 s7, 0x20000
s_mov_b32 s10, 61669376
s_mov_b32 s11, 0x20000
s_mov_b32 s18, 2359296
s_mov_b32 s19, 0x20000
s_mov_b32 s22, 4096
s_mov_b32 s23, 0x20000
s_and_b32 s30, s2, 7
s_lshr_b32 s31, s2, 3
s_lshr_b32 s32, s31, 2
s_and_b32 s33, s31, 3
s_lshr_b32 s25, s30, 2
s_lshl_b32 s25, s25, 3
s_add_u32 s25, s25, s32
s_and_b32 s26, s30, 3
s_lshl_b32 s26, s26, 2
s_add_u32 s26, s26, s33
s_lshr_b32 s27, s30, 1
s_lshl_b32 s27, s27, 3
s_add_u32 s27, s27, s32
s_and_b32 s28, s30, 1
s_lshl_b32 s28, s28, 2
s_add_u32 s28, s28, s33
s_lshr_b32 s27, s30, 1
s_lshl_b32 s27, s27, 2
s_lshr_b32 s32, s31, 3
s_add_u32 s27, s27, s32
s_lshl_b32 s27, s27, 1
s_and_b32 s32, s30, 1
s_add_u32 s27, s27, s32
s_and_b32 s28, s31, 7
s_lshl_b32 s80, s25, 4
s_add_u32 s80, s80, s26
s_lshl_b32 s81, s27, 3
s_add_u32 s81, s81, s28
s_add_u32 s8, s4, 19451904
s_addc_u32 s9, s5, 0
s_mov_b32 s20, s76
s_mov_b32 s21, s77
v_lshrrev_b32 v36, 2, v2
v_lshl_add_u32 v36, v3, 3, v36
v_lshlrev_b32 v45, 7, v36
v_and_b32 v36, 3, v2
v_lshl_add_u32 v45, v36, 3, v45
s_lshl_b32 s31, s24, 5
v_add_u32 v45, s31, v45
v_mov_b32 v164, 3212836864
v_mov_b32 v165, 3212836864
v_mov_b32 v166, 3212836864
v_mov_b32 v167, 3212836864
s_lshl_b32 s30, s80, 10
s_lshl_b32 s31, s24, 8
s_add_u32 s30, s30, s31
s_add_u32 s30, s30, 26214400
s_mov_b32 s31, 30834688
v_mul_lo_u32 v36, v3, s31
v_lshl_add_u32 v37, v2, 4, v36
s_mov_b32 exec_hi, 0
buffer_store_dwordx4 v[164:167], v37, s[8:11], s30 offen sc1
s_mov_b64 exec, -1
v_lshl_add_u32 v37, v2, 15, v36
s_lshl_b32 s30, s2, 7
s_add_u32 s30, s30, 26476544
s_cmp_eq_u32 s24, 0
s_cselect_b32 s30, s30, 1073741824
s_mov_b64 exec, 0x001f001f
buffer_store_dword v48, v37, s[8:11], s30 offen sc1
s_mov_b64 exec, -1
s_cmp_lt_u32 s2, 128
s_cbranch_scc1 L_p0_x2
s_mul_i32 s92, s61, 29
s_lshr_b32 s92, s92, 8
s_mul_i32 s33, s92, 9
s_sub_u32 s33, s61, s33
s_lshl_b32 s33, s33, 6
s_lshl_b32 s31, s24, 4
s_add_u32 s33, s33, s31
v_add_u32 v36, s33, v2
v_mul_u32_u24 v37, 911, v36
v_lshrrev_b32 v37, 14, v37
v_mul_u32_u24 v38, 18, v37
v_sub_u32 v36, v36, v38
v_and_b32 v38, 1, v37
v_lshrrev_b32 v37, 1, v37
s_mov_b32 s31, 132608
v_mul_lo_u32 v37, v37, s31
s_cmp_eq_u32 s92, 0
s_cselect_b32 s93, 5, 0
s_cselect_b32 s94, 8, 4
s_cmp_eq_u32 s92, 2
s_cselect_b32 s93, 2, s93
s_cselect_b32 s94, 0, s94
s_sub_u32 s94, s94, 16
v_add_u32 v39, s93, v38
v_lshl_add_u32 v40, v38, 1, v36
v_add_u32 v40, s94, v40
v_cmp_gt_u32 vcc, 16, v36
s_nop 1
v_cndmask_b32 v39, 4, v39, vcc
v_cndmask_b32 v40, v40, v36, vcc
v_lshl_add_u32 v43, v39, 10, v37
v_lshl_add_u32 v43, v40, 4, v43
v_lshl_add_u32 v44, v39, 9, v37
v_lshl_add_u32 v44, v40, 3, v44
s_lshl_b32 s31, s60, 7
s_add_u32 s31, s31, 129024
v_add_u32 v44, s31, v44
s_mul_i32 s31, s60, 18
v_add_u32 v37, s31, v3
v_and_b32 v38, 3, v37
v_lshrrev_b32 v37, 2, v37
v_mul_u32_u24 v37, 7168, v37
v_add_u32 v43, v43, v37
v_lshl_add_u32 v43, v38, 8, v43
s_waitcnt vmcnt(3)
s_barrier
ds_read_b64_tr_b16 v[64:65], v45 offset:0
ds_read_b64_tr_b16 v[66:67], v45 offset:512
ds_read_b64_tr_b16 v[68:69], v45 offset:4096
ds_read_b64_tr_b16 v[70:71], v45 offset:4608
ds_read_b64_tr_b16 v[72:73], v45 offset:8192
ds_read_b64_tr_b16 v[74:75], v45 offset:8704
ds_read_b64_tr_b16 v[76:77], v45 offset:12288
ds_read_b64_tr_b16 v[78:79], v45 offset:12800
ds_read_b64_tr_b16 v[80:81], v45 offset:16384
ds_read_b64_tr_b16 v[82:83], v45 offset:16896
v_mov_b32 v36, 1073741824
v_mov_b32 v46, 0
v_cndmask_b32 v37, v36, v43, s[50:51]
s_add_u32 s31, s62, 0
s_waitcnt lgkmcnt(8)
buffer_store_dwordx4 v[64:67], v43, s[4:7], s31 offen sc1
s_add_u32 s31, s62, 7168
s_waitcnt lgkmcnt(6)
buffer_store_dwordx4 v[68:71], v43, s[4:7], s31 offen sc1
s_add_u32 s31, s62, 14336
s_waitcnt lgkmcnt(4)
buffer_store_dwordx4 v[72:75], v43, s[4:7], s31 offen sc1
s_add_u32 s31, s62, 21504
s_waitcnt lgkmcnt(2)
buffer_store_dwordx4 v[76:79], v43, s[4:7], s31 offen sc1
s_add_u32 s31, s62, 28672
s_waitcnt lgkmcnt(0)
buffer_store_dwordx4 v[80:83], v37, s[4:7], s31 offen sc1
v_mov_b32 v37, 0x3f803f80
v_dot2c_f32_bf16 v46, v64, v37
v_dot2c_f32_bf16 v46, v65, v37
v_dot2c_f32_bf16 v46, v66, v37
v_dot2c_f32_bf16 v46, v67, v37
v_dot2c_f32_bf16 v46, v68, v37
v_dot2c_f32_bf16 v46, v69, v37
v_dot2c_f32_bf16 v46, v70, v37
v_dot2c_f32_bf16 v46, v71, v37
v_dot2c_f32_bf16 v46, v72, v37
v_dot2c_f32_bf16 v46, v73, v37
v_dot2c_f32_bf16 v46, v74, v37
v_dot2c_f32_bf16 v46, v75, v37
v_dot2c_f32_bf16 v46, v76, v37
v_dot2c_f32_bf16 v46, v77, v37
v_dot2c_f32_bf16 v46, v78, v37
v_dot2c_f32_bf16 v46, v79, v37
v_dot2c_f32_bf16 v46, v80, v37
v_dot2c_f32_bf16 v46, v81, v37
v_dot2c_f32_bf16 v46, v82, v37
v_dot2c_f32_bf16 v46, v83, v37
s_nop 2
v_mov_b32 v37, v46
s_nop 1
v_permlane32_swap_b32 v46, v37
v_add_f32 v46, v46, v37
v_mov_b32 v37, v46
s_nop 1
v_permlane16_swap_b32 v46, v37
v_add_f32 v46, v46, v37
v_cvt_pk_bf16_f32 v50, v46, v46
v_and_b32 v37, 0xffff0000, v50
v_sub_f32 v37, v46, v37
v_cvt_pk_bf16_f32 v51, v37, v37
v_cndmask_b32 v36, v36, v44, s[46:47]
buffer_store_dwordx2 v[50:51], v36, s[4:7], s62 offen sc1
s_branch L_p0_j2
L_p0_x2:
s_mul_i32 s30, s24, 4608
s_mul_i32 s31, s2, 18432
s_add_u32 s31, s31, s30
s_add_u32 s31, s31, 0
v_mov_b32 v36, 1073741824
v_add_u32 v38, 4096, v1
v_cndmask_b32 v38, v36, v38, s[50:51]
v_mov_b32 v46, 0
v_mov_b32 v47, 0
v_mov_b32 v39, 0x3f803f80
s_waitcnt vmcnt(3)
buffer_store_dwordx4 v[64:67], v1, s[8:11], s31 offen offset:0 sc1
buffer_store_dwordx4 v[68:71], v1, s[8:11], s31 offen offset:1024 sc1
buffer_store_dwordx4 v[72:75], v1, s[8:11], s31 offen offset:2048 sc1
buffer_store_dwordx4 v[76:79], v1, s[8:11], s31 offen offset:3072 sc1
buffer_store_dwordx4 v[80:83], v38, s[8:11], s31 offen offset:0 sc1
v_dot2c_f32_bf16 v46, v64, v39
v_dot2c_f32_bf16 v46, v65, v39
v_dot2c_f32_bf16 v46, v66, v39
v_dot2c_f32_bf16 v46, v67, v39
v_dot2c_f32_bf16 v46, v68, v39
v_dot2c_f32_bf16 v46, v69, v39
v_dot2c_f32_bf16 v46, v70, v39
v_dot2c_f32_bf16 v46, v71, v39
v_dot2c_f32_bf16 v46, v72, v39
v_dot2c_f32_bf16 v46, v73, v39
v_dot2c_f32_bf16 v46, v74, v39
v_dot2c_f32_bf16 v46, v75, v39
v_dot2c_f32_bf16 v46, v76, v39
v_dot2c_f32_bf16 v46, v77, v39
v_dot2c_f32_bf16 v46, v78, v39
v_dot2c_f32_bf16 v46, v79, v39
v_dot2c_f32_bf16 v46, v80, v39
v_dot2c_f32_bf16 v46, v81, v39
v_dot2c_f32_bf16 v46, v82, v39
v_dot2c_f32_bf16 v46, v83, v39
v_dot2c_f32_bf16 v47, v64, v64
v_dot2c_f32_bf16 v47, v65, v65
v_dot2c_f32_bf16 v47, v66, v66
v_dot2c_f32_bf16 v47, v67, v67
v_dot2c_f32_bf16 v47, v68, v68
v_dot2c_f32_bf16 v47, v69, v69
v_dot2c_f32_bf16 v47, v70, v70
v_dot2c_f32_bf16 v47, v71, v71
v_dot2c_f32_bf16 v47, v72, v72
v_dot2c_f32_bf16 v47, v73, v73
v_dot2c_f32_bf16 v47, v74, v74
v_dot2c_f32_bf16 v47, v75, v75
v_dot2c_f32_bf16 v47, v76, v76
v_dot2c_f32_bf16 v47, v77, v77
v_dot2c_f32_bf16 v47, v78, v78
v_dot2c_f32_bf16 v47, v79, v79
v_dot2c_f32_bf16 v47, v80, v80
v_dot2c_f32_bf16 v47, v81, v81
v_dot2c_f32_bf16 v47, v82, v82
v_dot2c_f32_bf16 v47, v83, v83
v_mov_b32 v37, v46
s_nop 1
v_permlane32_swap_b32 v46, v37
v_add_f32 v46, v46, v37
v_mov_b32 v37, v46
s_nop 1
v_permlane16_swap_b32 v46, v37
v_add_f32 v46, v46, v37
v_mov_b32 v37, v47
s_nop 1
v_permlane32_swap_b32 v47, v37
v_add_f32 v47, v47, v37
v_mov_b32 v37, v47
s_nop 1
v_permlane16_swap_b32 v47, v37
v_add_f32 v47, v47, v37
s_lshl_b32 s30, s2, 7
s_lshl_b32 s31, s24, 14
s_add_u32 s30, s30, s31
s_add_u32 s30, s30, 2359296
v_cndmask_b32 v50, 0, v46, s[46:47]
v_cndmask_b32 v51, 0, v47, s[46:47]
v_lshlrev_b32 v37, 3, v2
v_lshl_add_u32 v37, v3, 16, v37
v_cndmask_b32 v37, v36, v37, s[50:51]
buffer_store_dwordx2 v[50:51], v37, s[8:11], s30 offen sc1
L_p0_j2:
buffer_load_dwordx2 v[238:239], v48, s[84:87], 0 offen sc1
s_sub_u32 s30, s2, 0
s_cmp_lt_u32 s30, 256
s_cselect_b32 s36, 0, 1073741824
s_cselect_b32 s30, s30, 0
s_and_b32 s34, s30, 3
s_lshr_b32 s35, s30, 2
s_mov_b32 s14, 5308416
s_mov_b32 s15, 0x20000
s_mul_i32 s30, s34, 1327104
s_lshl_b32 s31, s35, 7
s_add_u32 s30, s30, s31
s_mul_i32 s31, s24, 73728
s_add_u32 s30, s30, s31
s_add_u32 s30, s30, s36
v_lshrrev_b32 v36, 7, v1
v_mul_u32_u24 v42, 9216, v36
v_and_b32 v36, 0x70, v1
v_add_u32 v42, v36, v42
s_lshl_b32 s32, s24, 10
s_mov_b32 s12, s72
s_mov_b32 s13, s73
s_add_u32 m0, s32, 20480
s_add_u32 s31, s30, 0
buffer_load_dwordx4 v42, s[12:15], s31 offen nt lds
s_add_u32 m0, s32, 24576
s_add_u32 s31, s30, 294912
buffer_load_dwordx4 v42, s[12:15], s31 offen nt lds
s_add_u32 m0, s32, 28672
s_add_u32 s31, s30, 589824
buffer_load_dwordx4 v42, s[12:15], s31 offen nt lds
s_add_u32 m0, s32, 32768
s_add_u32 s31, s30, 884736
buffer_load_dwordx4 v42, s[12:15], s31 offen nt lds
s_add_u32 m0, s32, 36864
s_add_u32 s31, s30, 1179648
s_cmp_lt_u32 s24, 2
s_cselect_b32 s31, s31, 1073741824
buffer_load_dwordx4 v42, s[12:15], s31 offen nt lds
s_sub_u32 s30, s2, 0
s_cmp_lt_u32 s30, 256
s_cselect_b32 s36, 0, 1073741824
s_cselect_b32 s30, s30, 0
s_and_b32 s34, s30, 3
s_lshr_b32 s35, s30, 2
s_lshl_b32 s92, s35, 6
s_lshl_b32 s33, s24, 4
s_add_u32 s92, s92, s33
s_cmp_ge_u32 s92, 2304
s_cselect_b32 s93, 1, 0
s_cselect_b32 s33, 2304, 0
s_sub_u32 s92, s92, s33
s_mul_i32 s94, s92, 1821
s_lshr_b32 s94, s94, 19
s_mul_i32 s33, s94, 288
s_sub_u32 s92, s92, s33
s_lshr_b32 s95, s92, 5
s_bfe_u32 s96, s92, 0x10004
s_lshl_b32 s94, s94, 1
s_cmp_ge_u32 s92, 144
s_addc_u32 s94, s94, 0
s_cmp_gt_u32 s95, 4
s_cselect_b32 s33, 5, 0
s_sub_u32 s97, s95, s33
s_cmp_eq_u32 s93, 0
s_cselect_b32 s33, 5, 0
s_add_u32 s97, s97, s33
s_cmp_eq_u32 s95, 4
s_cselect_b32 s97, 4, s97
s_mul_i32 s94, s94, 9
s_add_u32 s94, s94, s97
s_mul_i32 s94, s94, 37888
s_add_u32 s94, s94, 2785280
v_and_b32 v36, 3, v2
v_bfe_u32 v37, v2, 2, 1
v_bfe_u32 v38, v2, 3, 1
v_lshl_add_u32 v36, v38, 2, v36
s_lshl_b32 s33, s96, 3
v_add_u32 v36, s33, v36
s_cmp_eq_u32 s95, 4
s_cbranch_scc0 L_w3j_3
s_xor_b32 s33, s93, 1
v_mov_b32 v36, v2
v_mov_b32 v37, s33
L_w3j_3:
v_mul_u32_u24 v170, 18432, v37
v_lshl_add_u32 v170, v36, 4, v170
v_lshl_add_u32 v170, v3, 8, v170
s_mul_i32 s31, s34, 4608
s_add_u32 s31, s31, s94
v_add_u32 v170, s31, v170
v_lshlrev_b32 v171, 9, v37
v_lshl_add_u32 v171, v36, 3, v171
s_lshl_b32 s31, s34, 7
s_add_u32 s31, s31, s94
s_add_u32 s31, s31, 36864
v_add_u32 v171, s31, v171
s_cmp_lt_u32 s2, 32
s_cbranch_scc1 L_p0_a5
s_cmp_lt_u32 s2, 176
s_cbranch_scc1 L_p0_b5
s_sub_u32 s30, s2, 176
s_cmp_lt_u32 s30, 36
s_cselect_b32 s53, 0, 1073741824
s_cselect_b32 s30, s30, 0
s_and_b32 s38, s30, 3
s_lshr_b32 s52, s30, 2
v_lshrrev_b32 v39, 2, v2
v_and_b32 v40, 3, v2
v_lshlrev_b32 v40, 3, v40
s_lshl_b32 s31, s24, 5
v_add_u32 v40, s31, v40
v_lshl_add_u32 v36, v3, 2, v39
v_lshl_add_u32 v52, v36, 7, v40
v_lshrrev_b32 v36, 1, v39
v_mul_u32_u24 v36, 18, v36
v_and_b32 v41, 1, v39
v_add3_u32 v36, v36, v41, 16
v_and_b32 v41, 1, v3
v_mul_u32_u24 v41, 72, v41
v_add_u32 v36, v36, v41
v_lshl_add_u32 v53, v36, 7, v40
s_lshl_b32 s31, s52, 6
s_lshl_b32 s33, s24, 4
s_add_u32 s31, s31, s33
v_add_u32 v36, s31, v2
v_mul_u32_u24 v37, 911, v36
v_lshrrev_b32 v37, 16, v37
v_mul_u32_u24 v38, 72, v37
v_sub_u32 v36, v36, v38
s_mov_b32 s31, 82944
v_mul_lo_u32 v41, v37, s31
v_add_u32 v41, 2121728, v41
v_lshrrev_b32 v39, 5, v36
v_lshlrev_b32 v39, 11, v39
v_bfe_u32 v40, v36, 2, 1
v_lshl_add_u32 v39, v40, 10, v39
v_bfe_u32 v40, v36, 3, 2
v_lshl_add_u32 v39, v40, 6, v39
v_and_b32 v40, 3, v36
v_lshl_add_u32 v39, v40, 4, v39
v_lshlrev_b32 v40, 4, v36
v_add_u32 v40, 3072, v40
v_cmp_gt_u32 vcc, 64, v36
v_mov_b32 v47, 7
s_nop 0
v_cndmask_b32 v39, v40, v39, vcc
v_cndmask_b32 v47, v47, 8, vcc
v_add_u32 v41, v41, v39
s_mul_i32 s31, s38, 16
s_add_u32 s31, s31, 0
v_add_u32 v37, s31, v3
v_and_b32 v38, 3, v37
v_lshrrev_b32 v37, 2, v37
v_mul_u32_u24 v37, 4608, v37
v_lshlrev_b32 v38, v47, v38
v_add3_u32 v172, v41, v37, v38
s_mul_i32 s31, s38, 2
s_add_u32 s31, s31, 64
v_add_u32 v37, s31, v3
v_and_b32 v38, 3, v37
v_lshrrev_b32 v37, 2, v37
v_mul_u32_u24 v37, 4608, v37
v_lshlrev_b32 v38, v47, v38
v_add3_u32 v173, v41, v37, v38
s_branch L_p0_j5
L_p0_b5:
s_sub_u32 s30, s2, 32
s_cmp_lt_u32 s30, 144
s_cselect_b32 s53, 0, 1073741824
s_cselect_b32 s30, s30, 0
s_and_b32 s38, s30, 15
s_lshr_b32 s52, s30, 4
s_lshl_b32 s31, s52, 6
s_lshl_b32 s33, s24, 4
s_add_u32 s31, s31, s33
v_add_u32 v36, s31, v2
v_mul_u32_u24 v37, 911, v36
v_lshrrev_b32 v37, 16, v37
v_mul_u32_u24 v38, 72, v37
v_sub_u32 v36, v36, v38
s_mov_b32 s31, 331776
v_mul_lo_u32 v41, v37, s31
v_add_u32 v41, 8241152, v41
v_lshrrev_b32 v39, 5, v36
v_lshlrev_b32 v39, 11, v39
v_bfe_u32 v40, v36, 2, 1
v_lshl_add_u32 v39, v40, 10, v39
v_bfe_u32 v40, v36, 3, 2
v_lshl_add_u32 v39, v40, 6, v39
v_and_b32 v40, 3, v36
v_lshl_add_u32 v39, v40, 4, v39
v_lshlrev_b32 v40, 4, v36
v_add_u32 v40, 3072, v40
v_cmp_gt_u32 vcc, 64, v36
v_mov_b32 v47, 7
s_nop 0
v_cndmask_b32 v39, v40, v39, vcc
v_cndmask_b32 v47, v47, 8, vcc
v_add_u32 v41, v41, v39
s_mul_i32 s31, s38, 18
s_add_u32 s31, s31, 0
v_add_u32 v37, s31, v3
v_and_b32 v38, 3, v37
v_lshrrev_b32 v37, 2, v37
v_mul_u32_u24 v37, 4608, v37
v_lshlrev_b32 v38, v47, v38
v_add3_u32 v172, v41, v37, v38
s_branch L_p0_j5
L_p0_a5:
s_add_u32 s30, s2, 256
s_cmp_lt_u32 s30, 288
s_cselect_b32 s53, 0, 1073741824
s_cselect_b32 s30, s30, 0
s_and_b32 s38, s30, 3
s_lshr_b32 s52, s30, 2
s_lshl_b32 s92, s52, 6
s_lshl_b32 s33, s24, 4
s_add_u32 s92, s92, s33
s_cmp_ge_u32 s92, 2304
s_cselect_b32 s93, 1, 0
s_cselect_b32 s33, 2304, 0
s_sub_u32 s92, s92, s33
s_mul_i32 s94, s92, 1821
s_lshr_b32 s94, s94, 19
s_mul_i32 s33, s94, 288
s_sub_u32 s92, s92, s33
s_lshr_b32 s95, s92, 5
s_bfe_u32 s96, s92, 0x10004
s_lshl_b32 s94, s94, 1
s_cmp_ge_u32 s92, 144
s_addc_u32 s94, s94, 0
s_cmp_gt_u32 s95, 4
s_cselect_b32 s33, 5, 0
s_sub_u32 s97, s95, s33
s_cmp_eq_u32 s93, 0
s_cselect_b32 s33, 5, 0
s_add_u32 s97, s97, s33
s_cmp_eq_u32 s95, 4
s_cselect_b32 s97, 4, s97
s_mul_i32 s94, s94, 9
s_add_u32 s94, s94, s97
s_mul_i32 s94, s94, 37888
s_add_u32 s94, s94, 2785280
v_and_b32 v36, 3, v2
v_bfe_u32 v37, v2, 2, 1
v_bfe_u32 v38, v2, 3, 1
v_lshl_add_u32 v36, v38, 2, v36
s_lshl_b32 s33, s96, 3
v_add_u32 v36, s33, v36
s_cmp_eq_u32 s95, 4
s_cbranch_scc0 L_w3j_6
s_xor_b32 s33, s93, 1
v_mov_b32 v36, v2
v_mov_b32 v37, s33
L_w3j_6:
v_mul_u32_u24 v172, 18432, v37
v_lshl_add_u32 v172, v36, 4, v172
v_lshl_add_u32 v172, v3, 8, v172
s_mul_i32 s31, s38, 4608
s_add_u32 s31, s31, s94
v_add_u32 v172, s31, v172
v_lshlrev_b32 v173, 9, v37
v_lshl_add_u32 v173, v36, 3, v173
s_lshl_b32 s31, s38, 7
s_add_u32 s31, s31, s94
s_add_u32 s31, s31, 36864
v_add_u32 v173, s31, v173
L_p0_j5:
s_lshl_b32 s30, s25, 2
s_add_u32 s30, s30, s24
s_mul_i32 s31, s30, 133120
s_lshl_b32 s30, s30, 17
s_lshl_b32 s98, s26, 8
s_add_u32 s98, s98, s30
s_lshl_b32 s101, s26, 12
s_add_u32 s101, s101, s31
s_add_u32 s101, s101, 10895360
s_lshl_b32 s63, s24, 13
s_add_u32 s63, s63, 61440
v_add_u32 v36, 0, v3
v_xor_b32 v37, v36, v2
v_lshlrev_b32 v36, 12, v36
v_lshl_add_u32 v156, v37, 4, v36
v_lshlrev_b32 v37, 4, v37
v_lshl_add_u32 v37, v2, 8, v37
v_add_u32 v160, s63, v37
v_add_u32 v36, 4, v3
v_xor_b32 v37, v36, v2
v_lshlrev_b32 v36, 12, v36
v_lshl_add_u32 v157, v37, 4, v36
v_lshlrev_b32 v37, 4, v37
v_lshl_add_u32 v37, v2, 8, v37
v_add_u32 v161, s63, v37
v_subrev_u32 v157, 1024, v157
v_add_u32 v36, 8, v3
v_xor_b32 v37, v36, v2
v_lshlrev_b32 v36, 12, v36
v_lshl_add_u32 v158, v37, 4, v36
v_lshlrev_b32 v37, 4, v37
v_lshl_add_u32 v37, v2, 8, v37
v_add_u32 v162, s63, v37
v_subrev_u32 v158, 2048, v158
v_add_u32 v36, 12, v3
v_xor_b32 v37, v36, v2
v_lshlrev_b32 v36, 12, v36
v_lshl_add_u32 v159, v37, 4, v36
v_lshlrev_b32 v37, 4, v37
v_lshl_add_u32 v37, v2, 8, v37
v_add_u32 v163, s63, v37
v_subrev_u32 v159, 3072, v159
v_lshrrev_b32 v41, 4, v1
s_lshl_b32 s30, s25, 3
s_sub_u32 s30, s30, 1
v_add_u32 v36, s30, v41
v_max_i32 v36, 0, v36
s_lshl_b32 s30, s27, 2
v_add_u32 v37, s30, v2
v_cndmask_b32 v36, v37, v36, s[46:47]
v_bfe_u32 v37, v41, 2, 1
v_mul_u32_u24 v37, 35, v37
s_mul_i32 s30, s26, 36
v_add_u32 v37, s30, v37
v_lshrrev_b32 v37, 6, v37
v_bfe_u32 v38, v41, 3, 2
v_mad_u32_u24 v37, v38, 9, v37
v_and_b32 v38, 3, v41
v_lshl_add_u32 v37, v37, 2, v38
v_add_u32 v37, 128, v37
v_cndmask_b32 v36, v37, v36, s[50:51]
v_lshlrev_b32 v174, 7, v36
s_lshl_b32 s30, s2, 7
s_add_u32 s30, s30, 19415040
s_lshl_b32 s32, s2, 3
s_add_u32 s32, s32, 19447808
s_cmp_eq_u32 s24, 0
s_cselect_b32 s30, s30, 1073741824
s_cselect_b32 s100, s32, 1073741824
s_waitcnt vmcnt(5)
v_cmp_eq_u32 vcc, 0, v238
s_mov_b32 s31, 0
s_cbranch_vccnz L_tagslow_7
L_tagback_8:
s_barrier
s_mov_b64 exec, 1
buffer_store_dwordx2 v[238:239], v48, s[4:7], s30 offen sc1
s_mov_b64 exec, -1
s_cmp_lt_u32 s2, 32
s_cbranch_scc1 L_p0_a3
s_cmp_lt_u32 s2, 176
s_cbranch_scc1 L_p0_b3
s_mov_b32 s14, 663552
s_mov_b32 s15, 0x20000
s_mul_i32 s30, s38, 165888
s_lshl_b32 s31, s52, 7
s_add_u32 s30, s30, s31
s_mul_i32 s31, s24, 9216
s_add_u32 s30, s30, s31
s_add_u32 s30, s30, s53
v_lshrrev_b32 v36, 7, v1
v_mul_u32_u24 v42, 1152, v36
v_and_b32 v36, 0x70, v1
v_add_u32 v42, v36, v42
s_lshl_b32 s32, s24, 10
s_mov_b32 s12, s68
s_mov_b32 s13, s69
s_add_u32 m0, s32, 40960
s_add_u32 s31, s30, 0
buffer_load_dwordx4 v42, s[12:15], s31 offen nt lds
s_add_u32 m0, s32, 45056
s_add_u32 s31, s30, 36864
buffer_load_dwordx4 v42, s[12:15], s31 offen nt lds
s_add_u32 m0, s32, 49152
s_add_u32 s31, s30, 73728
buffer_load_dwordx4 v42, s[12:15], s31 offen nt lds
s_add_u32 m0, s32, 53248
s_add_u32 s31, s30, 110592
buffer_load_dwordx4 v42, s[12:15], s31 offen nt lds
s_add_u32 m0, s32, 57344
s_add_u32 s31, s30, 147456
s_cmp_lt_u32 s24, 2
s_cselect_b32 s31, s31, 1073741824
buffer_load_dwordx4 v42, s[12:15], s31 offen nt lds
s_branch L_p0_j3
L_p0_b3:
s_mov_b32 s14, 2654208
s_mov_b32 s15, 0x20000
s_mul_i32 s30, s38, 165888
s_lshl_b32 s31, s52, 7
s_add_u32 s30, s30, s31
s_mul_i32 s31, s24, 9216
s_add_u32 s30, s30, s31
s_add_u32 s30, s30, s53
v_lshrrev_b32 v36, 7, v1
v_mul_u32_u24 v42, 1152, v36
v_and_b32 v36, 0x70, v1
v_add_u32 v42, v36, v42
s_lshl_b32 s32, s24, 10
s_mov_b32 s12, s78
s_mov_b32 s13, s79
s_add_u32 m0, s32, 40960
s_add_u32 s31, s30, 0
buffer_load_dwordx4 v42, s[12:15], s31 offen nt lds
s_add_u32 m0, s32, 45056
s_add_u32 s31, s30, 36864
buffer_load_dwordx4 v42, s[12:15], s31 offen nt lds
s_add_u32 m0, s32, 49152
s_add_u32 s31, s30, 73728
buffer_load_dwordx4 v42, s[12:15], s31 offen nt lds
s_add_u32 m0, s32, 53248
s_add_u32 s31, s30, 110592
buffer_load_dwordx4 v42, s[12:15], s31 offen nt lds
s_add_u32 m0, s32, 57344
s_add_u32 s31, s30, 147456
s_cmp_lt_u32 s24, 2
s_cselect_b32 s31, s31, 1073741824
buffer_load_dwordx4 v42, s[12:15], s31 offen nt lds
s_branch L_p0_j3
L_p0_a3:
s_mov_b32 s14, 5308416
s_mov_b32 s15, 0x20000
s_mul_i32 s30, s38, 1327104
s_lshl_b32 s31, s52, 7
s_add_u32 s30, s30, s31
s_mul_i32 s31, s24, 73728
s_add_u32 s30, s30, s31
s_add_u32 s30, s30, s53
v_lshrrev_b32 v36, 7, v1
v_mul_u32_u24 v42, 9216, v36
v_and_b32 v36, 0x70, v1
v_add_u32 v42, v36, v42
s_lshl_b32 s32, s24, 10
s_mov_b32 s12, s72
s_mov_b32 s13, s73
s_add_u32 m0, s32, 40960
s_add_u32 s31, s30, 0
buffer_load_dwordx4 v42, s[12:15], s31 offen nt lds
s_add_u32 m0, s32, 45056
s_add_u32 s31, s30, 294912
buffer_load_dwordx4 v42, s[12:15], s31 offen nt lds
s_add_u32 m0, s32, 49152
s_add_u32 s31, s30, 589824
buffer_load_dwordx4 v42, s[12:15], s31 offen nt lds
s_add_u32 m0, s32, 53248
s_add_u32 s31, s30, 884736
buffer_load_dwordx4 v42, s[12:15], s31 offen nt lds
s_add_u32 m0, s32, 57344
s_add_u32 s31, s30, 1179648
s_cmp_lt_u32 s24, 2
s_cselect_b32 s31, s31, 1073741824
buffer_load_dwordx4 v42, s[12:15], s31 offen nt lds
L_p0_j3:
s_waitcnt vmcnt(6)
s_barrier
ds_read_b64_tr_b16 v[84:85], v45 offset:20480
ds_read_b64_tr_b16 v[86:87], v45 offset:20992
ds_read_b64_tr_b16 v[88:89], v45 offset:24576
ds_read_b64_tr_b16 v[90:91], v45 offset:25088
ds_read_b64_tr_b16 v[92:93], v45 offset:28672
ds_read_b64_tr_b16 v[94:95], v45 offset:29184
ds_read_b64_tr_b16 v[96:97], v45 offset:32768
ds_read_b64_tr_b16 v[98:99], v45 offset:33280
ds_read_b64_tr_b16 v[100:101], v45 offset:36864
ds_read_b64_tr_b16 v[102:103], v45 offset:37376
v_mov_b32 v36, 1073741824
v_mov_b32 v46, 0
v_cndmask_b32 v37, v36, v170, s[50:51]
s_add_u32 s31, s36, 0
s_waitcnt lgkmcnt(8)
buffer_store_dwordx4 v[84:87], v170, s[4:7], s31 offen sc1
s_add_u32 s31, s36, 1024
s_waitcnt lgkmcnt(6)
buffer_store_dwordx4 v[88:91], v170, s[4:7], s31 offen sc1
s_add_u32 s31, s36, 2048
s_waitcnt lgkmcnt(4)
buffer_store_dwordx4 v[92:95], v170, s[4:7], s31 offen sc1
s_add_u32 s31, s36, 3072
s_waitcnt lgkmcnt(2)
buffer_store_dwordx4 v[96:99], v170, s[4:7], s31 offen sc1
s_add_u32 s31, s36, 4096
s_waitcnt lgkmcnt(0)
buffer_store_dwordx4 v[100:103], v37, s[4:7], s31 offen sc1
v_mov_b32 v37, 0x3f803f80
v_dot2c_f32_bf16 v46, v84, v37
v_dot2c_f32_bf16 v46, v85, v37
v_dot2c_f32_bf16 v46, v86, v37
v_dot2c_f32_bf16 v46, v87, v37
v_dot2c_f32_bf16 v46, v88, v37
v_dot2c_f32_bf16 v46, v89, v37
v_dot2c_f32_bf16 v46, v90, v37
v_dot2c_f32_bf16 v46, v91, v37
v_dot2c_f32_bf16 v46, v92, v37
v_dot2c_f32_bf16 v46, v93, v37
v_dot2c_f32_bf16 v46, v94, v37
v_dot2c_f32_bf16 v46, v95, v37
v_dot2c_f32_bf16 v46, v96, v37
v_dot2c_f32_bf16 v46, v97, v37
v_dot2c_f32_bf16 v46, v98, v37
v_dot2c_f32_bf16 v46, v99, v37
v_dot2c_f32_bf16 v46, v100, v37
v_dot2c_f32_bf16 v46, v101, v37
v_dot2c_f32_bf16 v46, v102, v37
v_dot2c_f32_bf16 v46, v103, v37
s_nop 2
v_mov_b32 v37, v46
s_nop 1
v_permlane32_swap_b32 v46, v37
v_add_f32 v46, v46, v37
v_mov_b32 v37, v46
s_nop 1
v_permlane16_swap_b32 v46, v37
v_add_f32 v46, v46, v37
v_cvt_pk_bf16_f32 v50, v46, v46
v_and_b32 v37, 0xffff0000, v50
v_sub_f32 v37, v46, v37
v_cvt_pk_bf16_f32 v51, v37, v37
v_cndmask_b32 v36, v36, v171, s[46:47]
buffer_store_dwordx2 v[50:51], v36, s[4:7], s36 offen sc1
s_waitcnt vmcnt(6)
s_barrier
s_cmp_lt_u32 s2, 32
s_cbranch_scc1 L_p0_a4
s_cmp_lt_u32 s2, 176
s_cbranch_scc1 L_p0_b4
ds_read_b64_tr_b16 v[104:105], v52 offset:40960
ds_read_b64_tr_b16 v[106:107], v52 offset:43264
ds_read_b64_tr_b16 v[108:109], v52 offset:45568
ds_read_b64_tr_b16 v[110:111], v52 offset:47872
ds_read_b64_tr_b16 v[112:113], v52 offset:50176
ds_read_b64_tr_b16 v[114:115], v52 offset:52480
ds_read_b64_tr_b16 v[116:117], v52 offset:54784
ds_read_b64_tr_b16 v[118:119], v52 offset:57088
ds_read_b64_tr_b16 v[120:121], v53 offset:40960
ds_read_b64_tr_b16 v[122:123], v53 offset:45568
v_mov_b32 v36, 1073741824
v_mov_b32 v46, 0
v_cndmask_b32 v37, v36, v173, s[50:51]
s_add_u32 s31, s53, 0
s_waitcnt lgkmcnt(8)
buffer_store_dwordx4 v[104:107], v172, s[4:7], s31 offen sc1
s_add_u32 s31, s53, 4608
s_waitcnt lgkmcnt(6)
buffer_store_dwordx4 v[108:111], v172, s[4:7], s31 offen sc1
s_add_u32 s31, s53, 9216
s_waitcnt lgkmcnt(4)
buffer_store_dwordx4 v[112:115], v172, s[4:7], s31 offen sc1
s_add_u32 s31, s53, 13824
s_waitcnt lgkmcnt(2)
buffer_store_dwordx4 v[116:119], v172, s[4:7], s31 offen sc1
s_add_u32 s31, s53, 0
s_waitcnt lgkmcnt(0)
buffer_store_dwordx4 v[120:123], v37, s[4:7], s31 offen sc1
buffer_store_dwordx2 v[50:51], v36, s[4:7], s53 offen sc1
s_branch L_p0_j4
L_p0_b4:
ds_read_b64_tr_b16 v[104:105], v45 offset:40960
ds_read_b64_tr_b16 v[106:107], v45 offset:41472
ds_read_b64_tr_b16 v[108:109], v45 offset:45056
ds_read_b64_tr_b16 v[110:111], v45 offset:45568
ds_read_b64_tr_b16 v[112:113], v45 offset:49152
ds_read_b64_tr_b16 v[114:115], v45 offset:49664
ds_read_b64_tr_b16 v[116:117], v45 offset:53248
ds_read_b64_tr_b16 v[118:119], v45 offset:53760
ds_read_b64_tr_b16 v[120:121], v45 offset:57344
ds_read_b64_tr_b16 v[122:123], v45 offset:57856
v_mov_b32 v36, 1073741824
v_mov_b32 v46, 0
v_cndmask_b32 v37, v36, v172, s[50:51]
s_add_u32 s31, s53, 0
s_waitcnt lgkmcnt(8)
buffer_store_dwordx4 v[104:107], v172, s[4:7], s31 offen sc1
s_add_u32 s31, s53, 4608
s_waitcnt lgkmcnt(6)
buffer_store_dwordx4 v[108:111], v172, s[4:7], s31 offen sc1
s_add_u32 s31, s53, 9216
s_waitcnt lgkmcnt(4)
buffer_store_dwordx4 v[112:115], v172, s[4:7], s31 offen sc1
s_add_u32 s31, s53, 13824
s_waitcnt lgkmcnt(2)
buffer_store_dwordx4 v[116:119], v172, s[4:7], s31 offen sc1
s_add_u32 s31, s53, 18432
s_waitcnt lgkmcnt(0)
buffer_store_dwordx4 v[120:123], v37, s[4:7], s31 offen sc1
buffer_store_dwordx2 v[50:51], v36, s[4:7], s53 offen sc1
s_branch L_p0_j4
L_p0_a4:
ds_read_b64_tr_b16 v[104:105], v45 offset:40960
ds_read_b64_tr_b16 v[106:107], v45 offset:41472
ds_read_b64_tr_b16 v[108:109], v45 offset:45056
ds_read_b64_tr_b16 v[110:111], v45 offset:45568
ds_read_b64_tr_b16 v[112:113], v45 offset:49152
ds_read_b64_tr_b16 v[114:115], v45 offset:49664
ds_read_b64_tr_b16 v[116:117], v45 offset:53248
ds_read_b64_tr_b16 v[118:119], v45 offset:53760
ds_read_b64_tr_b16 v[120:121], v45 offset:57344
ds_read_b64_tr_b16 v[122:123], v45 offset:57856
v_mov_b32 v36, 1073741824
v_mov_b32 v46, 0
v_cndmask_b32 v37, v36, v172, s[50:51]
s_add_u32 s31, s53, 0
s_waitcnt lgkmcnt(8)
buffer_store_dwordx4 v[104:107], v172, s[4:7], s31 offen sc1
s_add_u32 s31, s53, 1024
s_waitcnt lgkmcnt(6)
buffer_store_dwordx4 v[108:111], v172, s[4:7], s31 offen sc1
s_add_u32 s31, s53, 2048
s_waitcnt lgkmcnt(4)
buffer_store_dwordx4 v[112:115], v172, s[4:7], s31 offen sc1
s_add_u32 s31, s53, 3072
s_waitcnt lgkmcnt(2)
buffer_store_dwordx4 v[116:119], v172, s[4:7], s31 offen sc1
s_add_u32 s31, s53, 4096
s_waitcnt lgkmcnt(0)
buffer_store_dwordx4 v[120:123], v37, s[4:7], s31 offen sc1
v_mov_b32 v37, 0x3f803f80
v_dot2c_f32_bf16 v46, v104, v37
v_dot2c_f32_bf16 v46, v105, v37
v_dot2c_f32_bf16 v46, v106, v37
v_dot2c_f32_bf16 v46, v107, v37
v_dot2c_f32_bf16 v46, v108, v37
v_dot2c_f32_bf16 v46, v109, v37
v_dot2c_f32_bf16 v46, v110, v37
v_dot2c_f32_bf16 v46, v111, v37
v_dot2c_f32_bf16 v46, v112, v37
v_dot2c_f32_bf16 v46, v113, v37
v_dot2c_f32_bf16 v46, v114, v37
v_dot2c_f32_bf16 v46, v115, v37
v_dot2c_f32_bf16 v46, v116, v37
v_dot2c_f32_bf16 v46, v117, v37
v_dot2c_f32_bf16 v46, v118, v37
v_dot2c_f32_bf16 v46, v119, v37
v_dot2c_f32_bf16 v46, v120, v37
v_dot2c_f32_bf16 v46, v121, v37
v_dot2c_f32_bf16 v46, v122, v37
v_dot2c_f32_bf16 v46, v123, v37
s_nop 2
v_mov_b32 v37, v46
s_nop 1
v_permlane32_swap_b32 v46, v37
v_add_f32 v46, v46, v37
v_mov_b32 v37, v46
s_nop 1
v_permlane16_swap_b32 v46, v37
v_add_f32 v46, v46, v37
v_cvt_pk_bf16_f32 v50, v46, v46
v_and_b32 v37, 0xffff0000, v50
v_sub_f32 v37, v46, v37
v_cvt_pk_bf16_f32 v51, v37, v37
v_cndmask_b32 v36, v36, v173, s[46:47]
buffer_store_dwordx2 v[50:51], v36, s[4:7], s53 offen sc1
L_p0_j4:
s_mov_b32 m0, s63
s_mov_b32 s12, s74
s_mov_b32 s13, s75
s_mov_b32 s14, 8388608
s_mov_b32 s15, 0x20000
buffer_load_dwordx4 v156, s[12:15], s98 offen offset:0 nt lds
buffer_load_dwordx4 v157, s[12:15], s98 offen offset:1024 nt lds
buffer_load_dwordx4 v158, s[12:15], s98 offen offset:2048 nt lds
buffer_load_dwordx4 v159, s[12:15], s98 offen offset:3072 nt lds
s_add_u32 m0, s63, 4096
s_add_u32 s98, s98, 65536
buffer_load_dwordx4 v156, s[12:15], s98 offen offset:0 nt lds
buffer_load_dwordx4 v157, s[12:15], s98 offen offset:1024 nt lds
buffer_load_dwordx4 v158, s[12:15], s98 offen offset:2048 nt lds
buffer_load_dwordx4 v159, s[12:15], s98 offen offset:3072 nt lds
s_cmp_eq_u32 s24, 1
s_cbranch_scc0 L_p0done_10
s_mov_b32 s30, 19415040
s_mov_b32 s31, 0
s_mov_b32 exec_lo, 0x000f01ff
s_mov_b32 exec_hi, 0x00ffffff
L_p0poll_9:
buffer_load_dwordx2 v[50:51], v174, s[4:7], s30 offen sc1
s_add_u32 s31, s31, 1
s_waitcnt vmcnt(0)
v_cmp_ne_u64 vcc, v[50:51], v[238:239]
s_cmp_gt_u32 s31, 200000
s_cbranch_scc1 L_p0done_10
s_cbranch_vccnz L_p0poll_9
L_p0done_10:
s_mov_b64 exec, -1
s_barrier
s_lshl_b32 s33, s25, 8
s_lshl_b32 s32, s24, 6
s_add_u32 s33, s33, s32
v_lshlrev_b32 v8, 1, v2
buffer_load_ushort v0, v8, s[20:23], s33 offen
buffer_load_ushort v249, v8, s[20:23], s33 offen offset:32
s_lshl_b32 s30, s27, 2
s_add_u32 s30, s30, s24
s_mul_i32 s30, s30, 18432
s_mul_i32 s31, s28, 2304
s_add_u32 s30, s30, s31
s_add_u32 s30, s30, 0
v_and_b32 v6, 1, v3
v_lshlrev_b32 v6, 3, v6
v_lshl_add_u32 v6, v2, 4, v6
buffer_load_dwordx4 v[36:39], v1, s[8:11], s30 offen sc1
buffer_load_dwordx4 v[40:43], v1, s[8:11], s30 offen offset:1024 sc1
buffer_load_dwordx2 v[44:45], v6, s[8:11], s30 offen offset:2048 sc1
s_mul_i32 s36, s26, 132608
s_mul_i32 s38, s24, 12288
s_add_u32 m0, s38, 0
s_add_u32 s39, s38, s36
buffer_load_dwordx4 v1, s[4:7], s39 offen offset:0 sc1 lds
buffer_load_dwordx4 v1, s[4:7], s39 offen offset:1024 sc1 lds
buffer_load_dwordx4 v1, s[4:7], s39 offen offset:2048 sc1 lds
buffer_load_dwordx4 v1, s[4:7], s39 offen offset:3072 sc1 lds
s_add_u32 m0, m0, 4096
s_add_u32 s39, s39, 4096
buffer_load_dwordx4 v1, s[4:7], s39 offen offset:0 sc1 lds
buffer_load_dwordx4 v1, s[4:7], s39 offen offset:1024 sc1 lds
buffer_load_dwordx4 v1, s[4:7], s39 offen offset:2048 sc1 lds
buffer_load_dwordx4 v1, s[4:7], s39 offen offset:3072 sc1 lds
s_add_u32 m0, m0, 4096
s_add_u32 s39, s39, 4096
buffer_load_dwordx4 v1, s[4:7], s39 offen offset:0 sc1 lds
buffer_load_dwordx4 v1, s[4:7], s39 offen offset:1024 sc1 lds
buffer_load_dwordx4 v1, s[4:7], s39 offen offset:2048 sc1 lds
buffer_load_dwordx4 v1, s[4:7], s39 offen offset:3072 sc1 lds
v_and_b32 v6, 1, v2
v_cmp_eq_u32 s[40:41], 1, v6
v_lshl_add_u32 v6, v3, 2, v6
v_cmp_le_u32 s[42:43], v6, v2
v_add_u32 v6, 2, v6
v_cmp_le_u32 s[44:45], v6, v2
v_mov_b32 v6, 0x0c0c0100
v_mov_b32 v7, 0x01000c0c
v_cndmask_b32 v6, v6, v7, s[40:41]
v_mov_b32 v8, 0x0c0c0c0c
v_cndmask_b32 v10, v6, v8, s[42:43]
v_cndmask_b32 v12, v8, v6, s[42:43]
v_mov_b32 v6, 0x0c0c0302
v_mov_b32 v7, 0x03020c0c
v_cndmask_b32 v6, v6, v7, s[40:41]
v_cndmask_b32 v11, v6, v8, s[44:45]
v_cndmask_b32 v13, v8, v6, s[44:45]
s_mul_i32 s82, s26, 340992
s_add_u32 s82, s82, 2785280
s_mul_i32 s83, s28, 331776
s_add_u32 s83, s83, 8241152
s_and_b32 s30, s27, 1
s_mul_i32 s30, s30, 165888
s_add_u32 s83, s83, s30
s_waitcnt vmcnt(12)
v_lshlrev_b32 v16, 16, v36
v_and_b32 v17, 0xffff0000, v36
v_lshlrev_b32 v18, 16, v37
v_and_b32 v19, 0xffff0000, v37
v_lshlrev_b32 v20, 16, v38
v_and_b32 v21, 0xffff0000, v38
v_lshlrev_b32 v22, 16, v39
v_and_b32 v23, 0xffff0000, v39
v_lshlrev_b32 v24, 16, v40
v_and_b32 v25, 0xffff0000, v40
v_lshlrev_b32 v26, 16, v41
v_and_b32 v27, 0xffff0000, v41
v_lshlrev_b32 v28, 16, v42
v_and_b32 v29, 0xffff0000, v42
v_lshlrev_b32 v30, 16, v43
v_and_b32 v31, 0xffff0000, v43
v_lshlrev_b32 v32, 16, v44
v_and_b32 v33, 0xffff0000, v44
v_lshlrev_b32 v34, 16, v45
v_and_b32 v35, 0xffff0000, v45
ds_read_b128 a[232:235], v160 offset:0
ds_read_b128 a[236:239], v161 offset:0
ds_read_b128 a[240:243], v162 offset:0
ds_read_b128 a[244:247], v163 offset:0
ds_read_b128 a[248:251], v160 offset:4096
ds_read_b128 a[252:255], v161 offset:4096
ds_read_b128 v[240:243], v162 offset:4096
ds_read_b128 v[244:247], v163 offset:4096
s_waitcnt lgkmcnt(0)
v_mov_b32 v6, 0
s_barrier
v_mov_b32 v248, v238
s_mov_b64 exec, 1
buffer_store_dwordx2 v[238:239], v6, s[4:7], s100 offen sc1
s_mov_b64 exec, -1
s_mul_i32 s36, s26, 132608
s_mul_i32 s38, s24, 9216
s_add_u32 m0, s38, 49152
s_add_u32 s39, s38, s36
s_add_u32 s39, s39, 49152
buffer_load_dwordx4 v1, s[4:7], s39 offen offset:0 sc1 lds
buffer_load_dwordx4 v1, s[4:7], s39 offen offset:1024 sc1 lds
buffer_load_dwordx4 v1, s[4:7], s39 offen offset:2048 sc1 lds
buffer_load_dwordx4 v1, s[4:7], s39 offen offset:3072 sc1 lds
s_add_u32 m0, m0, 4096
s_add_u32 s39, s39, 4096
buffer_load_dwordx4 v1, s[4:7], s39 offen offset:0 sc1 lds
buffer_load_dwordx4 v1, s[4:7], s39 offen offset:1024 sc1 lds
buffer_load_dwordx4 v1, s[4:7], s39 offen offset:2048 sc1 lds
buffer_load_dwordx4 v1, s[4:7], s39 offen offset:3072 sc1 lds
s_add_u32 m0, m0, 4096
s_add_u32 s39, s39, 4096
buffer_load_dwordx4 v1, s[4:7], s39 offen offset:0 sc1 lds
s_lshl_b32 s60, s25, 3
s_sub_u32 s61, s60, 1
s_max_i32 s61, s61, 0
s_lshl_b32 s30, s24, 1
s_add_u32 s60, s60, s30
s_mul_i32 s30, s61, 18432
s_mul_i32 s62, s60, 18432
v_add_u32 v237, 18432, v1
s_mul_i32 s38, s24, 5120
s_add_u32 m0, s38, 135168
s_add_u32 s39, s38, s30
L_layer:
buffer_load_dwordx4 v1, s[8:11], s39 offen offset:0 sc1 lds
buffer_load_dwordx4 v1, s[8:11], s39 offen offset:1024 sc1 lds
buffer_load_dwordx4 v1, s[8:11], s39 offen offset:2048 sc1 lds
buffer_load_dwordx4 v1, s[8:11], s39 offen offset:3072 sc1 lds
s_add_u32 m0, m0, 4096
s_add_u32 s39, s39, 4096
buffer_load_dwordx4 v1, s[8:11], s39 offen offset:0 sc1 lds
s_barrier
buffer_load_dwordx4 a[0:3], v1, s[8:11], s62 offen offset:0 sc1
buffer_load_dwordx4 a[4:7], v237, s[8:11], s62 offen offset:0 sc1
s_barrier
buffer_load_dwordx4 a[8:11], v1, s[8:11], s62 offen offset:1024 sc1
buffer_load_dwordx4 a[12:15], v237, s[8:11], s62 offen offset:1024 sc1
s_barrier
buffer_load_dwordx4 a[16:19], v1, s[8:11], s62 offen offset:2048 sc1
buffer_load_dwordx4 a[20:23], v237, s[8:11], s62 offen offset:2048 sc1
s_barrier
buffer_load_dwordx4 a[24:27], v1, s[8:11], s62 offen offset:3072 sc1
buffer_load_dwordx4 a[28:31], v237, s[8:11], s62 offen offset:3072 sc1
s_barrier
s_add_u32 s62, s62, 4096
buffer_load_dwordx4 a[32:35], v1, s[8:11], s62 offen offset:0 sc1
buffer_load_dwordx4 a[36:39], v237, s[8:11], s62 offen offset:0 sc1
s_barrier
buffer_load_dwordx4 a[40:43], v1, s[8:11], s62 offen offset:1024 sc1
buffer_load_dwordx4 a[44:47], v237, s[8:11], s62 offen offset:1024 sc1
s_sub_u32 s30, s60, 2
v_add_u32 v6, s30, v3
v_max_i32 v6, 0, v6
v_mov_b32 v7, s61
v_cndmask_b32 v6, v6, v7, s[46:47]
v_lshl_add_u32 v6, v6, 4, v2
v_lshlrev_b32 v129, 3, v6
s_lshl_b32 s30, s24, 10
v_add_u32 v125, s30, v1
v_add_u32 v126, 135168, v1
v_lshrrev_b32 v127, 1, v1
v_add_u32 v127, 129024, v127
s_lshl_b32 s30, s24, 9
v_add_u32 v128, s30, v127
v_add_u32 v8, 64512, v1
s_waitcnt vmcnt(12)
s_barrier
ds_read_b128 a[144:147], v1 offset:0
ds_read_b128 a[148:151], v1 offset:1024
ds_read_b128 a[152:155], v1 offset:2048
ds_read_b128 a[156:159], v1 offset:3072
ds_read_b128 a[160:163], v1 offset:4096
ds_read_b128 a[164:167], v1 offset:5120
ds_read_b128 a[168:171], v1 offset:6144
ds_read_b128 a[172:175], v125 offset:0
ds_read_b128 a[176:179], v126 offset:0
v_lshrrev_b32 v146, 1, v1
s_lshl_b32 s66, s24, 9
s_add_u32 s66, s66, 19447808
s_waitcnt vmcnt(10) lgkmcnt(0)
v_mfma_f32_16x16x32_bf16 v[36:39], a[144:147], a[0:3], 0
ds_read_b128 a[180:183], v1 offset:7168
buffer_load_dwordx4 a[48:51], v1, s[8:11], s62 offen offset:2048 sc1
v_mfma_f32_16x16x32_bf16 v[64:67], a[144:147], a[4:7], 0
ds_read_b128 a[184:187], v1 offset:8192
v_mfma_f32_16x16x32_bf16 v[40:43], a[148:151], a[0:3], 0
ds_read_b128 a[188:191], v1 offset:9216
v_mfma_f32_16x16x32_bf16 v[68:71], a[148:151], a[4:7], 0
ds_read_b128 a[192:195], v1 offset:10240
v_mfma_f32_16x16x32_bf16 v[44:47], a[152:155], a[0:3], 0
ds_read_b128 a[196:199], v1 offset:11264
buffer_load_dwordx4 a[52:55], v237, s[8:11], s62 offen offset:2048 sc1
v_mfma_f32_16x16x32_bf16 v[72:75], a[152:155], a[4:7], 0
ds_read_b128 a[200:203], v1 offset:12288
v_mfma_f32_16x16x32_bf16 v[48:51], a[156:159], a[0:3], 0
ds_read_b128 a[204:207], v1 offset:13312
v_mfma_f32_16x16x32_bf16 v[76:79], a[156:159], a[4:7], 0
ds_read_b128 a[208:211], v125 offset:7168
v_mfma_f32_16x16x32_bf16 v[52:55], a[160:163], a[0:3], 0
ds_read_b128 a[212:215], v126 offset:1024
buffer_load_dwordx4 a[56:59], v1, s[8:11], s62 offen offset:3072 sc1
v_mfma_f32_16x16x32_bf16 v[80:83], a[160:163], a[4:7], 0
v_mfma_f32_16x16x32_bf16 v[92:95], a[172:175], a[176:179], 0
v_mfma_f32_16x16x32_bf16 v[96:99], a[160:163], a[176:179], 0
v_mfma_f32_16x16x32_bf16 v[56:59], a[164:167], a[0:3], 0
buffer_load_dwordx4 a[60:63], v237, s[8:11], s62 offen offset:3072 sc1
v_mfma_f32_16x16x32_bf16 v[84:87], a[164:167], a[4:7], 0
s_add_u32 s62, s62, 4096
v_mfma_f32_16x16x32_bf16 v[60:63], a[168:171], a[0:3], 0
v_mfma_f32_16x16x32_bf16 v[88:91], a[168:171], a[4:7], 0
s_waitcnt vmcnt(12) lgkmcnt(0)
v_mfma_f32_16x16x32_bf16 v[36:39], a[180:183], a[8:11], v[36:39]
ds_read_b128 a[144:147], v1 offset:14336
v_lshlrev_b32 v124, 2, v2
v_mfma_f32_16x16x32_bf16 v[64:67], a[180:183], a[12:15], v[64:67]
ds_read_b128 a[148:151], v1 offset:15360
v_mfma_f32_16x16x32_bf16 v[40:43], a[184:187], a[8:11], v[40:43]
ds_read_b128 a[152:155], v1 offset:16384
v_and_b32 v6, 1, v2
v_mfma_f32_16x16x32_bf16 v[68:71], a[184:187], a[12:15], v[68:71]
ds_read_b128 a[156:159], v1 offset:17408
v_mfma_f32_16x16x32_bf16 v[44:47], a[188:191], a[8:11], v[44:47]
ds_read_b128 a[160:163], v1 offset:18432
v_mfma_f32_16x16x32_bf16 v[72:75], a[188:191], a[12:15], v[72:75]
ds_read_b128 a[164:167], v1 offset:19456
buffer_load_dwordx4 a[64:67], v1, s[8:11], s62 offen offset:0 sc1
v_mfma_f32_16x16x32_bf16 v[48:51], a[192:195], a[8:11], v[48:51]
ds_read_b128 a[168:171], v1 offset:20480
v_lshl_add_u32 v6, v3, 2, v6
v_mfma_f32_16x16x32_bf16 v[76:79], a[192:195], a[12:15], v[76:79]
ds_read_b128 a[172:175], v125 offset:14336
v_lshlrev_b32 v6, 2, v6
v_mfma_f32_16x16x32_bf16 v[52:55], a[196:199], a[8:11], v[52:55]
ds_read_b128 a[176:179], v126 offset:2048
v_mfma_f32_16x16x32_bf16 v[80:83], a[196:199], a[12:15], v[80:83]
buffer_load_dwordx4 a[68:71], v237, s[8:11], s62 offen offset:0 sc1
v_mfma_f32_16x16x32_bf16 v[92:95], a[208:211], a[212:215], v[92:95]
v_add_u32 v122, 64, v6
v_mfma_f32_16x16x32_bf16 v[96:99], a[196:199], a[212:215], v[96:99]
v_mfma_f32_16x16x32_bf16 v[56:59], a[200:203], a[8:11], v[56:59]
v_add_u32 v7, 128, v6
v_mfma_f32_16x16x32_bf16 v[84:87], a[200:203], a[12:15], v[84:87]
v_mfma_f32_16x16x32_bf16 v[60:63], a[204:207], a[8:11], v[60:63]
buffer_load_dwordx4 a[72:75], v1, s[8:11], s62 offen offset:1024 sc1
v_mfma_f32_16x16x32_bf16 v[88:91], a[204:207], a[12:15], v[88:91]
s_mov_b32 s63, 2359296
v_cndmask_b32 v122, v122, v7, s[42:43]
s_waitcnt vmcnt(13) lgkmcnt(0)
v_mfma_f32_16x16x32_bf16 v[36:39], a[144:147], a[16:19], v[36:39]
ds_read_b128 a[180:183], v1 offset:21504
v_mfma_f32_16x16x32_bf16 v[64:67], a[144:147], a[20:23], v[64:67]
ds_read_b128 a[184:187], v1 offset:22528
v_add_u32 v123, 72, v6
v_mfma_f32_16x16x32_bf16 v[40:43], a[148:151], a[16:19], v[40:43]
ds_read_b128 a[188:191], v1 offset:23552
v_mfma_f32_16x16x32_bf16 v[68:71], a[148:151], a[20:23], v[68:71]
ds_read_b128 a[192:195], v1 offset:24576
v_mfma_f32_16x16x32_bf16 v[44:47], a[152:155], a[16:19], v[44:47]
ds_read_b128 a[196:199], v1 offset:25600
v_add_u32 v7, 136, v6
v_mfma_f32_16x16x32_bf16 v[72:75], a[152:155], a[20:23], v[72:75]
ds_read_b128 a[200:203], v1 offset:26624
v_mfma_f32_16x16x32_bf16 v[48:51], a[156:159], a[16:19], v[48:51]
ds_read_b128 a[204:207], v1 offset:27648
buffer_load_dwordx2 v[100:101], v129, s[8:11], s63 offen sc1
v_mfma_f32_16x16x32_bf16 v[76:79], a[156:159], a[20:23], v[76:79]
ds_read_b128 a[208:211], v125 offset:21504
v_cndmask_b32 v123, v123, v7, s[44:45]
v_mfma_f32_16x16x32_bf16 v[52:55], a[160:163], a[16:19], v[52:55]
ds_read_b128 a[212:215], v126 offset:3072
s_mul_i32 s36, s26, 132608
v_mfma_f32_16x16x32_bf16 v[80:83], a[160:163], a[20:23], v[80:83]
s_mov_b32 s63, 2375680
s_lshl_b32 s31, s24, 5
v_mfma_f32_16x16x32_bf16 v[92:95], a[172:175], a[176:179], v[92:95]
s_mul_i32 s38, s24, 12288
v_mfma_f32_16x16x32_bf16 v[96:99], a[160:163], a[176:179], v[96:99]
s_add_u32 m0, s38, 86016
v_add_u32 v6, s31, v2
v_mfma_f32_16x16x32_bf16 v[56:59], a[164:167], a[16:19], v[56:59]
s_add_u32 s39, s38, s36
v_mfma_f32_16x16x32_bf16 v[84:87], a[164:167], a[20:23], v[84:87]
s_add_u32 s39, s39, 86016
v_mfma_f32_16x16x32_bf16 v[60:63], a[168:171], a[16:19], v[60:63]
v_mul_u32_u24 v220, 176, v6
v_mfma_f32_16x16x32_bf16 v[88:91], a[168:171], a[20:23], v[88:91]
buffer_load_dwordx2 v[102:103], v129, s[8:11], s63 offen sc1
s_waitcnt vmcnt(13) lgkmcnt(0)
v_mfma_f32_16x16x32_bf16 v[36:39], a[180:183], a[24:27], v[36:39]
ds_read_b128 a[144:147], v1 offset:28672
v_add_u32 v220, 0, v220
v_mfma_f32_16x16x32_bf16 v[64:67], a[180:183], a[28:31], v[64:67]
ds_read_b128 a[148:151], v1 offset:29696
v_mfma_f32_16x16x32_bf16 v[40:43], a[184:187], a[24:27], v[40:43]
ds_read_b128 a[152:155], v1 offset:30720
v_mfma_f32_16x16x32_bf16 v[68:71], a[184:187], a[28:31], v[68:71]
ds_read_b128 a[156:159], v1 offset:31744
s_mov_b32 s63, 2392064
v_mfma_f32_16x16x32_bf16 v[44:47], a[188:191], a[24:27], v[44:47]
ds_read_b128 a[160:163], v1 offset:32768
v_lshl_add_u32 v218, v3, 3, v220
v_mfma_f32_16x16x32_bf16 v[72:75], a[188:191], a[28:31], v[72:75]
ds_read_b128 a[164:167], v1 offset:33792
v_mul_u32_u24 v219, 176, v2
v_mfma_f32_16x16x32_bf16 v[48:51], a[192:195], a[24:27], v[48:51]
ds_read_b128 a[168:171], v1 offset:34816
v_mfma_f32_16x16x32_bf16 v[76:79], a[192:195], a[28:31], v[76:79]
ds_read_b128 a[172:175], v125 offset:28672
buffer_load_dwordx2 v[104:105], v129, s[8:11], s63 offen sc1
v_mfma_f32_16x16x32_bf16 v[52:55], a[196:199], a[24:27], v[52:55]
ds_read_b128 a[176:179], v126 offset:4096
v_lshl_add_u32 v219, v3, 3, v219
v_mfma_f32_16x16x32_bf16 v[80:83], a[196:199], a[28:31], v[80:83]
s_mov_b32 s63, 2408448
v_mfma_f32_16x16x32_bf16 v[92:95], a[208:211], a[212:215], v[92:95]
v_add_u32 v219, 0, v219
v_mfma_f32_16x16x32_bf16 v[96:99], a[196:199], a[212:215], v[96:99]
v_mfma_f32_16x16x32_bf16 v[56:59], a[200:203], a[24:27], v[56:59]
buffer_load_dwordx4 v1, s[4:7], s39 offen offset:0 sc1 lds
v_mfma_f32_16x16x32_bf16 v[84:87], a[200:203], a[28:31], v[84:87]
v_add_u32 v222, s31, v219
v_mfma_f32_16x16x32_bf16 v[60:63], a[204:207], a[24:27], v[60:63]
v_mfma_f32_16x16x32_bf16 v[88:91], a[204:207], a[28:31], v[88:91]
v_lshrrev_b32 v6, 2, v2
s_waitcnt vmcnt(13) lgkmcnt(0)
v_mfma_f32_16x16x32_bf16 v[36:39], a[144:147], a[32:35], v[36:39]
ds_read_b128 a[180:183], v1 offset:35840
buffer_load_dwordx2 v[106:107], v129, s[8:11], s63 offen sc1
v_mfma_f32_16x16x32_bf16 v[64:67], a[144:147], a[36:39], v[64:67]
ds_read_b128 a[184:187], v1 offset:36864
buffer_load_dwordx4 v1, s[4:7], s39 offen offset:1024 sc1 lds
v_mfma_f32_16x16x32_bf16 v[40:43], a[148:151], a[32:35], v[40:43]
ds_read_b128 a[188:191], v1 offset:37888
v_lshl_add_u32 v6, v3, 2, v6
v_mfma_f32_16x16x32_bf16 v[68:71], a[148:151], a[36:39], v[68:71]
ds_read_b128 a[192:195], v1 offset:38912
v_mfma_f32_16x16x32_bf16 v[44:47], a[152:155], a[32:35], v[44:47]
ds_read_b128 a[196:199], v1 offset:39936
buffer_load_dwordx4 v1, s[4:7], s39 offen offset:2048 sc1 lds
v_mfma_f32_16x16x32_bf16 v[72:75], a[152:155], a[36:39], v[72:75]
ds_read_b128 a[200:203], v1 offset:40960
s_mov_b32 s63, 2424832
v_mfma_f32_16x16x32_bf16 v[48:51], a[156:159], a[32:35], v[48:51]
ds_read_b128 a[204:207], v1 offset:41984
v_add_u32 v6, s31, v6
v_mfma_f32_16x16x32_bf16 v[76:79], a[156:159], a[36:39], v[76:79]
ds_read_b128 a[208:211], v125 offset:35840
v_mul_u32_u24 v221, 176, v6
v_mfma_f32_16x16x32_bf16 v[52:55], a[160:163], a[32:35], v[52:55]
ds_read_b128 a[212:215], v126 offset:5120
buffer_load_dwordx2 v[108:109], v129, s[8:11], s63 offen sc1
v_mfma_f32_16x16x32_bf16 v[80:83], a[160:163], a[36:39], v[80:83]
buffer_load_dwordx4 v1, s[4:7], s39 offen offset:3072 sc1 lds
v_and_b32 v6, 3, v2
v_mfma_f32_16x16x32_bf16 v[92:95], a[172:175], a[176:179], v[92:95]
s_mov_b32 s63, 2441216
v_mfma_f32_16x16x32_bf16 v[96:99], a[160:163], a[176:179], v[96:99]
s_add_u32 m0, m0, 4096
v_mfma_f32_16x16x32_bf16 v[56:59], a[164:167], a[32:35], v[56:59]
s_add_u32 s39, s39, 4096
v_lshl_add_u32 v221, v6, 3, v221
v_mfma_f32_16x16x32_bf16 v[84:87], a[164:167], a[36:39], v[84:87]
v_mfma_f32_16x16x32_bf16 v[60:63], a[168:171], a[32:35], v[60:63]
v_add_u32 v221, 0, v221
v_mfma_f32_16x16x32_bf16 v[88:91], a[168:171], a[36:39], v[88:91]
s_waitcnt vmcnt(16) lgkmcnt(0)
v_mfma_f32_16x16x32_bf16 v[36:39], a[180:183], a[40:43], v[36:39]
ds_read_b128 a[144:147], v1 offset:43008
v_mfma_f32_16x16x32_bf16 v[64:67], a[180:183], a[44:47], v[64:67]
ds_read_b128 a[148:151], v1 offset:44032
buffer_load_dwordx2 v[110:111], v129, s[8:11], s63 offen sc1
v_mfma_f32_16x16x32_bf16 v[40:43], a[184:187], a[40:43], v[40:43]
ds_read_b128 a[152:155], v1 offset:45056
v_mov_b32 v171, 0
v_mfma_f32_16x16x32_bf16 v[68:71], a[184:187], a[44:47], v[68:71]
ds_read_b128 a[156:159], v1 offset:46080
v_mov_b32 v172, 0
v_mfma_f32_16x16x32_bf16 v[44:47], a[188:191], a[40:43], v[44:47]
ds_read_b128 a[160:163], v1 offset:47104
buffer_load_dwordx4 v1, s[4:7], s39 offen offset:0 sc1 lds
v_mfma_f32_16x16x32_bf16 v[72:75], a[188:191], a[44:47], v[72:75]
ds_read_b128 a[164:167], v1 offset:48128
s_mov_b32 s63, 2457600
v_mfma_f32_16x16x32_bf16 v[48:51], a[192:195], a[40:43], v[48:51]
ds_read_b128 a[168:171], v1 offset:49152
v_mov_b32 v179, 0
v_mfma_f32_16x16x32_bf16 v[76:79], a[192:195], a[44:47], v[76:79]
ds_read_b128 a[172:175], v125 offset:43008
v_mfma_f32_16x16x32_bf16 v[52:55], a[196:199], a[40:43], v[52:55]
ds_read_b128 a[176:179], v126 offset:6144
buffer_load_dwordx4 v1, s[4:7], s39 offen offset:1024 sc1 lds
v_mfma_f32_16x16x32_bf16 v[80:83], a[196:199], a[44:47], v[80:83]
v_mov_b32 v180, 0
v_mfma_f32_16x16x32_bf16 v[92:95], a[208:211], a[212:215], v[92:95]
buffer_load_dwordx2 v[112:113], v129, s[8:11], s63 offen sc1
v_mfma_f32_16x16x32_bf16 v[96:99], a[196:199], a[212:215], v[96:99]
s_mov_b32 s63, 2473984
s_mul_i32 s30, s60, 18432
v_mfma_f32_16x16x32_bf16 v[56:59], a[200:203], a[40:43], v[56:59]
buffer_load_dwordx4 v1, s[4:7], s39 offen offset:2048 sc1 lds
v_mfma_f32_16x16x32_bf16 v[84:87], a[200:203], a[44:47], v[84:87]
s_add_u32 s30, s30, 2490368
v_mfma_f32_16x16x32_bf16 v[60:63], a[204:207], a[40:43], v[60:63]
s_lshl_b32 s64, s26, 10
v_mfma_f32_16x16x32_bf16 v[88:91], a[204:207], a[44:47], v[88:91]
s_add_u32 s64, s64, s30
s_waitcnt vmcnt(19) lgkmcnt(0)
v_mfma_f32_16x16x32_bf16 v[36:39], a[144:147], a[48:51], v[36:39]
ds_read_b128 a[180:183], v1 offset:50176
buffer_load_dwordx4 v1, s[4:7], s39 offen offset:3072 sc1 lds
v_mfma_f32_16x16x32_bf16 v[64:67], a[144:147], a[52:55], v[64:67]
ds_read_b128 a[184:187], v1 offset:51200
v_mfma_f32_16x16x32_bf16 v[40:43], a[148:151], a[48:51], v[40:43]
ds_read_b128 a[188:191], v1 offset:52224
buffer_load_dwordx2 v[114:115], v129, s[8:11], s63 offen sc1
v_mfma_f32_16x16x32_bf16 v[68:71], a[148:151], a[52:55], v[68:71]
ds_read_b128 a[192:195], v1 offset:53248
v_mfma_f32_16x16x32_bf16 v[44:47], a[152:155], a[48:51], v[44:47]
ds_read_b128 a[196:199], v1 offset:54272
s_add_u32 m0, m0, 4096
v_mfma_f32_16x16x32_bf16 v[72:75], a[152:155], a[52:55], v[72:75]
ds_read_b128 a[200:203], v1 offset:55296
s_and_b32 s65, s26, 1
v_mfma_f32_16x16x32_bf16 v[48:51], a[156:159], a[48:51], v[48:51]
ds_read_b128 a[204:207], v1 offset:56320
buffer_load_dwordx4 a[76:79], v237, s[8:11], s62 offen offset:1024 sc1
v_mfma_f32_16x16x32_bf16 v[76:79], a[156:159], a[52:55], v[76:79]
ds_read_b128 a[208:211], v125 offset:50176
s_lshl_b32 s65, s65, 10
v_mfma_f32_16x16x32_bf16 v[52:55], a[160:163], a[48:51], v[52:55]
ds_read_b128 a[212:215], v126 offset:7168
s_add_u32 s39, s39, 4096
v_mfma_f32_16x16x32_bf16 v[80:83], a[160:163], a[52:55], v[80:83]
s_add_u32 s30, s30, s65
v_mfma_f32_16x16x32_bf16 v[92:95], a[172:175], a[176:179], v[92:95]
s_lshr_b32 s65, s26, 1
v_mfma_f32_16x16x32_bf16 v[96:99], a[160:163], a[176:179], v[96:99]
buffer_load_dwordx4 a[80:83], v1, s[8:11], s62 offen offset:2048 sc1
v_mfma_f32_16x16x32_bf16 v[56:59], a[164:167], a[48:51], v[56:59]
buffer_load_dwordx4 v1, s[4:7], s39 offen offset:0 sc1 lds
v_mfma_f32_16x16x32_bf16 v[84:87], a[164:167], a[52:55], v[84:87]
s_lshl_b32 s65, s65, 7
v_mfma_f32_16x16x32_bf16 v[60:63], a[168:171], a[48:51], v[60:63]
s_add_u32 s65, s65, s30
v_mfma_f32_16x16x32_bf16 v[88:91], a[168:171], a[52:55], v[88:91]
buffer_load_dwordx4 a[84:87], v237, s[8:11], s62 offen offset:2048 sc1
s_waitcnt vmcnt(23) lgkmcnt(0)
v_mfma_f32_16x16x32_bf16 v[36:39], a[180:183], a[56:59], v[36:39]
ds_read_b128 a[144:147], v1 offset:57344
buffer_load_dwordx4 v1, s[4:7], s39 offen offset:1024 sc1 lds
v_mfma_f32_16x16x32_bf16 v[64:67], a[180:183], a[60:63], v[64:67]
ds_read_b128 a[148:151], v1 offset:58368
v_mfma_f32_16x16x32_bf16 v[40:43], a[184:187], a[56:59], v[40:43]
ds_read_b128 a[152:155], v1 offset:59392
v_mfma_f32_16x16x32_bf16 v[68:71], a[184:187], a[60:63], v[68:71]
ds_read_b128 a[156:159], v1 offset:60416
buffer_load_dwordx4 a[88:91], v1, s[8:11], s62 offen offset:3072 sc1
v_mfma_f32_16x16x32_bf16 v[44:47], a[188:191], a[56:59], v[44:47]
ds_read_b128 a[160:163], v1 offset:61440
buffer_load_dwordx4 v1, s[4:7], s39 offen offset:2048 sc1 lds
v_mfma_f32_16x16x32_bf16 v[72:75], a[188:191], a[60:63], v[72:75]
ds_read_b128 a[164:167], v1 offset:62464
s_add_u32 s65, s65, 16384
v_mfma_f32_16x16x32_bf16 v[48:51], a[192:195], a[56:59], v[48:51]
ds_read_b128 a[168:171], v1 offset:63488
v_mov_b32 v224, 1073741824
v_mfma_f32_16x16x32_bf16 v[76:79], a[192:195], a[60:63], v[76:79]
ds_read_b128 a[172:175], v125 offset:57344
v_mfma_f32_16x16x32_bf16 v[52:55], a[196:199], a[56:59], v[52:55]
ds_read_b128 a[176:179], v126 offset:8192
buffer_load_dwordx4 a[92:95], v237, s[8:11], s62 offen offset:3072 sc1
v_mfma_f32_16x16x32_bf16 v[80:83], a[196:199], a[60:63], v[80:83]
buffer_load_dwordx4 v1, s[4:7], s39 offen offset:3072 sc1 lds
v_lshlrev_b32 v225, 3, v2
v_mfma_f32_16x16x32_bf16 v[92:95], a[208:211], a[212:215], v[92:95]
s_add_u32 s62, s62, 4096
v_mfma_f32_16x16x32_bf16 v[96:99], a[196:199], a[212:215], v[96:99]
v_cndmask_b32 v224, v224, v225, s[46:47]
v_mfma_f32_16x16x32_bf16 v[56:59], a[200:203], a[56:59], v[56:59]
buffer_load_dwordx2 v[148:149], v146, s[4:7], s66 offen sc1
v_mfma_f32_16x16x32_bf16 v[84:87], a[200:203], a[60:63], v[84:87]
v_mfma_f32_16x16x32_bf16 v[60:63], a[204:207], a[56:59], v[60:63]
v_add_u32 v225, 18432, v224
v_mfma_f32_16x16x32_bf16 v[88:91], a[204:207], a[60:63], v[88:91]
s_waitcnt vmcnt(27) lgkmcnt(0)
v_add_u32 v125, 64512, v125
v_mfma_f32_16x16x32_bf16 v[36:39], a[144:147], a[64:67], v[36:39]
ds_read_b128 a[180:183], v8 offset:0
buffer_load_dwordx4 a[96:99], v1, s[8:11], s62 offen offset:0 sc1
v_mfma_f32_16x16x32_bf16 v[64:67], a[144:147], a[68:71], v[64:67]
ds_read_b128 a[184:187], v8 offset:1024
v_mfma_f32_16x16x32_bf16 v[40:43], a[148:151], a[64:67], v[40:43]
ds_read_b128 a[188:191], v8 offset:2048
v_mfma_f32_16x16x32_bf16 v[68:71], a[148:151], a[68:71], v[68:71]
ds_read_b128 a[192:195], v8 offset:3072
v_mfma_f32_16x16x32_bf16 v[44:47], a[152:155], a[64:67], v[44:47]
ds_read_b128 a[196:199], v8 offset:4096
buffer_load_dwordx4 a[100:103], v237, s[8:11], s62 offen offset:0 sc1
v_mfma_f32_16x16x32_bf16 v[72:75], a[152:155], a[68:71], v[72:75]
ds_read_b128 a[200:203], v8 offset:5120
v_mfma_f32_16x16x32_bf16 v[48:51], a[156:159], a[64:67], v[48:51]
ds_read_b128 a[204:207], v8 offset:6144
v_mfma_f32_16x16x32_bf16 v[76:79], a[156:159], a[68:71], v[76:79]
ds_read_b128 a[208:211], v125 offset:0
v_mfma_f32_16x16x32_bf16 v[52:55], a[160:163], a[64:67], v[52:55]
ds_read_b128 a[212:215], v126 offset:9216
v_mfma_f32_16x16x32_bf16 v[80:83], a[160:163], a[68:71], v[80:83]
buffer_load_dwordx4 a[104:107], v1, s[8:11], s62 offen offset:1024 sc1
v_mfma_f32_16x16x32_bf16 v[92:95], a[172:175], a[176:179], v[92:95]
v_mfma_f32_16x16x32_bf16 v[96:99], a[160:163], a[176:179], v[96:99]
v_mfma_f32_16x16x32_bf16 v[56:59], a[164:167], a[64:67], v[56:59]
v_mfma_f32_16x16x32_bf16 v[84:87], a[164:167], a[68:71], v[84:87]
buffer_load_dwordx4 a[108:111], v237, s[8:11], s62 offen offset:1024 sc1
v_mfma_f32_16x16x32_bf16 v[60:63], a[168:171], a[64:67], v[60:63]
v_mfma_f32_16x16x32_bf16 v[88:91], a[168:171], a[68:71], v[88:91]
s_waitcnt vmcnt(13) lgkmcnt(0)
v_mfma_f32_16x16x32_bf16 v[36:39], a[180:183], a[72:75], v[36:39]
ds_read_b128 a[144:147], v8 offset:7168
v_mfma_f32_16x16x32_bf16 v[64:67], a[180:183], a[76:79], v[64:67]
ds_read_b128 a[148:151], v8 offset:8192
buffer_load_dwordx4 a[112:115], v1, s[8:11], s62 offen offset:2048 sc1
v_mfma_f32_16x16x32_bf16 v[40:43], a[184:187], a[72:75], v[40:43]
ds_read_b128 a[152:155], v8 offset:9216
v_add_f32 v130, v100, v102
v_mfma_f32_16x16x32_bf16 v[68:71], a[184:187], a[76:79], v[68:71]
ds_read_b128 a[156:159], v8 offset:10240
v_add_f32 v131, v101, v103
v_mfma_f32_16x16x32_bf16 v[44:47], a[188:191], a[72:75], v[44:47]
ds_read_b128 a[160:163], v8 offset:11264
v_add_f32 v130, v130, v104
v_mfma_f32_16x16x32_bf16 v[72:75], a[188:191], a[76:79], v[72:75]
ds_read_b128 a[164:167], v8 offset:12288
v_add_f32 v131, v131, v105
v_mfma_f32_16x16x32_bf16 v[48:51], a[192:195], a[72:75], v[48:51]
ds_read_b128 a[168:171], v8 offset:13312
buffer_load_dwordx4 a[116:119], v237, s[8:11], s62 offen offset:2048 sc1
v_mfma_f32_16x16x32_bf16 v[76:79], a[192:195], a[76:79], v[76:79]
ds_read_b128 a[172:175], v125 offset:7168
v_add_f32 v130, v130, v106
v_mfma_f32_16x16x32_bf16 v[52:55], a[196:199], a[72:75], v[52:55]
ds_read_b128 a[176:179], v126 offset:10240
v_add_f32 v131, v131, v107
v_mfma_f32_16x16x32_bf16 v[80:83], a[196:199], a[76:79], v[80:83]
v_add_f32 v130, v130, v108
v_add_f32 v131, v131, v109
v_mfma_f32_16x16x32_bf16 v[92:95], a[208:211], a[212:215], v[92:95]
buffer_load_dwordx4 a[120:123], v1, s[8:11], s62 offen offset:3072 sc1
v_add_f32 v130, v130, v110
v_mfma_f32_16x16x32_bf16 v[96:99], a[196:199], a[212:215], v[96:99]
v_add_f32 v131, v131, v111
v_mfma_f32_16x16x32_bf16 v[56:59], a[200:203], a[72:75], v[56:59]
v_add_f32 v130, v130, v112
v_mfma_f32_16x16x32_bf16 v[84:87], a[200:203], a[76:79], v[84:87]
v_add_f32 v131, v131, v113
v_mfma_f32_16x16x32_bf16 v[60:63], a[204:207], a[72:75], v[60:63]
buffer_load_dwordx4 a[124:127], v237, s[8:11], s62 offen offset:3072 sc1
v_add_f32 v130, v130, v114
v_mfma_f32_16x16x32_bf16 v[88:91], a[204:207], a[76:79], v[88:91]
s_add_u32 s62, s62, 4096
v_add_f32 v131, v131, v115
s_waitcnt vmcnt(14) lgkmcnt(0)
v_mfma_f32_16x16x32_bf16 v[36:39], a[144:147], a[80:83], v[36:39]
ds_read_b128 a[180:183], v8 offset:14336
v_mul_f32 v130, 0x3ae38e39, v130
v_mfma_f32_16x16x32_bf16 v[64:67], a[144:147], a[84:87], v[64:67]
ds_read_b128 a[184:187], v8 offset:15360
v_mul_f32 v6, v130, v130
v_mfma_f32_16x16x32_bf16 v[40:43], a[148:151], a[80:83], v[40:43]
ds_read_b128 a[188:191], v8 offset:16384
v_mul_f32 v131, 0x3ae38e39, v131
v_mfma_f32_16x16x32_bf16 v[68:71], a[148:151], a[84:87], v[68:71]
ds_read_b128 a[192:195], v8 offset:17408
v_mfma_f32_16x16x32_bf16 v[44:47], a[152:155], a[80:83], v[44:47]
ds_read_b128 a[196:199], v8 offset:18432
v_sub_f32 v131, v131, v6
v_mfma_f32_16x16x32_bf16 v[72:75], a[152:155], a[84:87], v[72:75]
ds_read_b128 a[200:203], v8 offset:19456
v_max_f32 v131, 0, v131
v_mfma_f32_16x16x32_bf16 v[48:51], a[156:159], a[80:83], v[48:51]
ds_read_b128 a[204:207], v8 offset:20480
v_add_f32 v131, 0x3727c5ac, v131
v_mfma_f32_16x16x32_bf16 v[76:79], a[156:159], a[84:87], v[76:79]
ds_read_b128 a[208:211], v125 offset:14336
buffer_load_dwordx4 a[128:131], v1, s[8:11], s62 offen offset:0 sc1
v_mfma_f32_16x16x32_bf16 v[52:55], a[160:163], a[80:83], v[52:55]
ds_read_b128 a[212:215], v126 offset:11264
v_mfma_f32_16x16x32_bf16 v[80:83], a[160:163], a[84:87], v[80:83]
v_rsq_f32 v132, v131
v_mfma_f32_16x16x32_bf16 v[92:95], a[172:175], a[176:179], v[92:95]
v_cvt_pk_bf16_f32 v6, -v130, -v130
v_and_b32 v6, 0xffff0000, v6
v_mfma_f32_16x16x32_bf16 v[96:99], a[160:163], a[176:179], v[96:99]
buffer_load_dwordx4 a[132:135], v237, s[8:11], s62 offen offset:0 sc1
v_add_f32 v6, v130, v6
v_mfma_f32_16x16x32_bf16 v[56:59], a[164:167], a[80:83], v[56:59]
v_cvt_pk_bf16_f32 v133, -v130, -v6
v_mfma_f32_16x16x32_bf16 v[84:87], a[164:167], a[84:87], v[84:87]
v_mfma_f32_16x16x32_bf16 v[60:63], a[168:171], a[80:83], v[60:63]
v_mfma_f32_16x16x32_bf16 v[88:91], a[168:171], a[84:87], v[88:91]
s_waitcnt vmcnt(10) lgkmcnt(0)
v_cmp_ne_u64 vcc, v[148:149], v[238:239]
s_cmp_eq_u32 s29, 0
s_cselect_b64 vcc, vcc, 0
s_cbranch_vccnz L_dbslow_11
L_dbback_12:
s_barrier
v_mfma_f32_16x16x32_bf16 v[36:39], a[180:183], a[88:91], v[36:39]
ds_read_b128 a[144:147], v8 offset:21504
buffer_load_dwordx4 a[136:139], v1, s[8:11], s62 offen offset:1024 sc1
v_mfma_f32_16x16x32_bf16 v[64:67], a[180:183], a[92:95], v[64:67]
ds_read_b128 a[148:151], v8 offset:22528
v_mfma_f32_16x16x32_bf16 v[40:43], a[184:187], a[88:91], v[40:43]
ds_read_b128 a[152:155], v8 offset:23552
v_mfma_f32_16x16x32_bf16 v[68:71], a[184:187], a[92:95], v[68:71]
ds_read_b128 a[156:159], v8 offset:24576
v_mfma_f32_16x16x32_bf16 v[44:47], a[188:191], a[88:91], v[44:47]
ds_read_b128 a[160:163], v8 offset:25600
buffer_load_dwordx4 a[140:143], v237, s[8:11], s62 offen offset:1024 sc1
v_mfma_f32_16x16x32_bf16 v[72:75], a[188:191], a[92:95], v[72:75]
ds_read_b128 a[164:167], v8 offset:26624
v_mfma_f32_16x16x32_bf16 v[48:51], a[192:195], a[88:91], v[48:51]
ds_read_b128 a[168:171], v8 offset:27648
v_mfma_f32_16x16x32_bf16 v[76:79], a[192:195], a[92:95], v[76:79]
ds_read_b128 a[172:175], v125 offset:21504
v_mfma_f32_16x16x32_bf16 v[52:55], a[196:199], a[88:91], v[52:55]
ds_read_b128 a[176:179], v126 offset:12288
s_mov_b32 s37, L_c2-L_pc
v_mfma_f32_16x16x32_bf16 v[80:83], a[196:199], a[92:95], v[80:83]
ds_bpermute_b32 v116, v124, v133 offset:128
v_mfma_f32_16x16x32_bf16 v[92:95], a[208:211], a[212:215], v[92:95]
ds_bpermute_b32 v118, v124, v133 offset:192
v_mfma_f32_16x16x32_bf16 v[96:99], a[196:199], a[212:215], v[96:99]
ds_bpermute_b32 v120, v124, v133
v_mfma_f32_16x16x32_bf16 v[56:59], a[200:203], a[88:91], v[56:59]
buffer_load_dword v15, v14, s[88:91], s37 offen
ds_bpermute_b32 v134, v124, v132 offset:128
v_mfma_f32_16x16x32_bf16 v[84:87], a[200:203], a[92:95], v[84:87]
ds_bpermute_b32 v135, v124, v132 offset:192
v_mfma_f32_16x16x32_bf16 v[60:63], a[204:207], a[88:91], v[60:63]
v_mfma_f32_16x16x32_bf16 v[88:91], a[204:207], a[92:95], v[88:91]
s_waitcnt vmcnt(11) lgkmcnt(0)
v_mfma_f32_16x16x32_bf16 v[36:39], a[144:147], a[96:99], v[36:39]
ds_read_b128 a[180:183], v8 offset:28672
v_mfma_f32_16x16x32_bf16 v[64:67], a[144:147], a[100:103], v[64:67]
ds_read_b128 a[184:187], v8 offset:29696
v_mfma_f32_16x16x32_bf16 v[40:43], a[148:151], a[96:99], v[40:43]
ds_read_b128 a[188:191], v8 offset:30720
v_mfma_f32_16x16x32_bf16 v[68:71], a[148:151], a[100:103], v[68:71]
ds_read_b128 a[192:195], v8 offset:31744
v_mfma_f32_16x16x32_bf16 v[44:47], a[152:155], a[96:99], v[44:47]
ds_read_b128 a[196:199], v8 offset:32768
s_mul_i32 s36, s28, 82944
v_mfma_f32_16x16x32_bf16 v[72:75], a[152:155], a[100:103], v[72:75]
ds_read_b128 a[200:203], v8 offset:33792
v_mfma_f32_16x16x32_bf16 v[48:51], a[156:159], a[96:99], v[48:51]
ds_read_b128 a[204:207], v8 offset:34816
buffer_store_dwordx4 a[232:235], v1, s[4:7], s101 offen offset:0 sc1
v_mfma_f32_16x16x32_bf16 v[76:79], a[156:159], a[100:103], v[76:79]
ds_read_b128 a[208:211], v125 offset:28672
s_mul_i32 s38, s24, 10240
v_mfma_f32_16x16x32_bf16 v[52:55], a[160:163], a[96:99], v[52:55]
ds_read_b128 a[212:215], v126 offset:13312
v_mfma_f32_16x16x32_bf16 v[80:83], a[160:163], a[100:103], v[80:83]
ds_bpermute_b32 v136, v122, v132 offset:0
v_mfma_f32_16x16x32_bf16 v[92:95], a[172:175], a[176:179], v[92:95]
ds_bpermute_b32 v137, v123, v132 offset:0
v_mfma_f32_16x16x32_bf16 v[96:99], a[160:163], a[176:179], v[96:99]
ds_bpermute_b32 v138, v122, v132 offset:64
s_add_u32 m0, s38, 37888
v_mfma_f32_16x16x32_bf16 v[56:59], a[164:167], a[96:99], v[56:59]
ds_bpermute_b32 v139, v123, v132 offset:64
v_mfma_f32_16x16x32_bf16 v[84:87], a[164:167], a[100:103], v[84:87]
s_add_u32 s39, s38, s36
v_mfma_f32_16x16x32_bf16 v[60:63], a[168:171], a[96:99], v[60:63]
buffer_store_dwordx4 a[236:239], v1, s[4:7], s101 offen offset:1024 sc1
v_mfma_f32_16x16x32_bf16 v[88:91], a[168:171], a[100:103], v[88:91]
s_add_u32 s39, s39, 2121728
s_waitcnt vmcnt(11) lgkmcnt(0)
v_mfma_f32_16x16x32_bf16 v[36:39], a[180:183], a[104:107], v[36:39]
ds_read_b128 a[144:147], v8 offset:35840
v_mov_b32 v117, v116
v_mfma_f32_16x16x32_bf16 v[64:67], a[180:183], a[108:111], v[64:67]
ds_read_b128 a[148:151], v8 offset:36864
v_mfma_f32_16x16x32_bf16 v[40:43], a[184:187], a[104:107], v[40:43]
ds_read_b128 a[152:155], v8 offset:37888
v_mov_b32 v119, v118
v_mfma_f32_16x16x32_bf16 v[68:71], a[184:187], a[108:111], v[68:71]
ds_read_b128 a[156:159], v8 offset:38912
v_mfma_f32_16x16x32_bf16 v[44:47], a[188:191], a[104:107], v[44:47]
ds_read_b128 a[160:163], v8 offset:39936
v_mov_b32 v121, v120
v_mfma_f32_16x16x32_bf16 v[72:75], a[188:191], a[108:111], v[72:75]
ds_read_b128 a[164:167], v8 offset:40960
v_mfma_f32_16x16x32_bf16 v[48:51], a[192:195], a[104:107], v[48:51]
ds_read_b128 a[168:171], v8 offset:41984
v_mfma_f32_16x16x32_bf16 v[76:79], a[192:195], a[108:111], v[76:79]
ds_read_b128 a[172:175], v125 offset:35840
buffer_load_dwordx4 v1, s[4:7], s39 offen offset:0 sc1 lds
v_mfma_f32_16x16x32_bf16 v[52:55], a[196:199], a[104:107], v[52:55]
ds_read_b128 a[176:179], v126 offset:14336
buffer_store_dwordx4 a[240:243], v1, s[4:7], s101 offen offset:2048 sc1
v_mfma_f32_16x16x32_bf16 v[80:83], a[196:199], a[108:111], v[80:83]
v_mul_f32 v134, 0x3eae1a93, v134
v_mul_f32 v135, 0x3eae1a93, v135
v_mfma_f32_16x16x32_bf16 v[92:95], a[208:211], a[212:215], v[92:95]
v_mfma_f32_16x16x32_bf16 v[96:99], a[196:199], a[212:215], v[96:99]
buffer_load_dwordx4 v1, s[4:7], s39 offen offset:1024 sc1 lds
v_mul_f32 v140, v134, v136
v_mfma_f32_16x16x32_bf16 v[56:59], a[200:203], a[104:107], v[56:59]
v_mfma_f32_16x16x32_bf16 v[84:87], a[200:203], a[108:111], v[84:87]
v_mfma_f32_16x16x32_bf16 v[60:63], a[204:207], a[104:107], v[60:63]
v_mul_f32 v141, v134, v137
v_mfma_f32_16x16x32_bf16 v[88:91], a[204:207], a[108:111], v[88:91]
buffer_load_dwordx4 v1, s[4:7], s39 offen offset:2048 sc1 lds
s_waitcnt vmcnt(13) lgkmcnt(0)
v_mfma_f32_16x16x32_bf16 v[36:39], a[144:147], a[112:115], v[36:39]
ds_read_b128 a[180:183], v8 offset:43008
buffer_store_dwordx4 a[244:247], v1, s[4:7], s101 offen offset:3072 sc1
v_mfma_f32_16x16x32_bf16 v[64:67], a[144:147], a[116:119], v[64:67]
ds_read_b128 a[184:187], v8 offset:44032
v_mul_f32 v142, v135, v138
v_mfma_f32_16x16x32_bf16 v[40:43], a[148:151], a[112:115], v[40:43]
ds_read_b128 a[188:191], v8 offset:45056
v_mul_f32 v143, v135, v139
v_mfma_f32_16x16x32_bf16 v[68:71], a[148:151], a[116:119], v[68:71]
ds_read_b128 a[192:195], v8 offset:46080
buffer_load_dwordx4 v1, s[4:7], s39 offen offset:3072 sc1 lds
v_mfma_f32_16x16x32_bf16 v[44:47], a[152:155], a[112:115], v[44:47]
ds_read_b128 a[196:199], v8 offset:47104
v_mfma_f32_16x16x32_bf16 v[72:75], a[152:155], a[116:119], v[72:75]
ds_read_b128 a[200:203], v8 offset:48128
v_mfma_f32_16x16x32_bf16 v[48:51], a[156:159], a[112:115], v[48:51]
ds_read_b128 a[204:207], v8 offset:49152
v_mfma_f32_16x16x32_bf16 v[76:79], a[156:159], a[116:119], v[76:79]
ds_read_b128 a[208:211], v125 offset:43008
s_add_u32 m0, m0, 4096
v_mfma_f32_16x16x32_bf16 v[52:55], a[160:163], a[112:115], v[52:55]
ds_read_b128 a[212:215], v126 offset:15360
v_mfma_f32_16x16x32_bf16 v[80:83], a[160:163], a[116:119], v[80:83]
ds_read_b64 a[216:217], v127 offset:0
buffer_store_dwordx4 a[248:251], v9, s[4:7], s101 offen offset:0 sc1
v_mfma_f32_16x16x32_bf16 v[92:95], a[172:175], a[176:179], v[92:95]
ds_read_b64 a[218:219], v127 offset:512
v_mfma_f32_16x16x32_bf16 v[96:99], a[160:163], a[176:179], v[96:99]
s_cmp_eq_u32 s60, 0
s_cselect_b32 s30, 0xf149f2ca, 0
s_add_u32 s39, s39, 4096
v_mfma_f32_16x16x32_bf16 v[56:59], a[164:167], a[112:115], v[56:59]
ds_read_b64 a[220:221], v127 offset:1024
v_mov_b32 v6, s30
v_mfma_f32_16x16x32_bf16 v[84:87], a[164:167], a[116:119], v[84:87]
ds_read_b64 a[222:223], v127 offset:1536
v_cndmask_b32 v144, v6, 0, s[42:43]
v_mfma_f32_16x16x32_bf16 v[60:63], a[168:171], a[112:115], v[60:63]
v_cndmask_b32 v145, v6, 0, s[44:45]
v_mfma_f32_16x16x32_bf16 v[88:91], a[168:171], a[116:119], v[88:91]
buffer_load_dwordx4 v1, s[4:7], s39 offen offset:0 sc1 lds
s_waitcnt vmcnt(15) lgkmcnt(0)
v_mfma_f32_16x16x32_bf16 v[36:39], a[180:183], a[120:123], v[36:39]
ds_read_b128 a[144:147], v8 offset:50176
v_mfma_f32_16x16x32_bf16 v[64:67], a[180:183], a[124:127], v[64:67]
ds_read_b128 a[148:151], v8 offset:51200
buffer_store_dwordx4 a[252:255], v9, s[4:7], s101 offen offset:1024 sc1
v_mfma_f32_16x16x32_bf16 v[40:43], a[184:187], a[120:123], v[40:43]
ds_read_b128 a[152:155], v8 offset:52224
v_mfma_f32_16x16x32_bf16 v[68:71], a[184:187], a[124:127], v[68:71]
ds_read_b128 a[156:159], v8 offset:53248
buffer_load_dwordx4 v1, s[4:7], s39 offen offset:1024 sc1 lds
v_mfma_f32_16x16x32_bf16 v[44:47], a[188:191], a[120:123], v[44:47]
ds_read_b128 a[160:163], v8 offset:54272
v_mfma_f32_16x16x32_bf16 v[72:75], a[188:191], a[124:127], v[72:75]
ds_read_b128 a[164:167], v8 offset:55296
v_mfma_f32_16x16x32_bf16 v[48:51], a[192:195], a[120:123], v[48:51]
ds_read_b128 a[168:171], v8 offset:56320
v_mfma_f32_16x16x32_bf16 v[76:79], a[192:195], a[124:127], v[76:79]
ds_read_b128 a[172:175], v125 offset:50176
buffer_load_dwordx4 v1, s[4:7], s39 offen offset:2048 sc1 lds
v_mfma_f32_16x16x32_bf16 v[52:55], a[196:199], a[120:123], v[52:55]
ds_read_b128 a[176:179], v126 offset:16384
v_mfma_f32_16x16x32_bf16 v[80:83], a[196:199], a[124:127], v[80:83]
ds_read_b64 a[224:225], v127 offset:2048
v_mfma_f32_16x16x32_bf16 v[92:95], a[208:211], a[212:215], v[92:95]
ds_read_b64 a[226:227], v127 offset:2560
buffer_store_dwordx4 v[240:243], v9, s[4:7], s101 offen offset:2048 sc1
v_mfma_f32_16x16x32_bf16 v[96:99], a[196:199], a[212:215], v[96:99]
buffer_load_dwordx4 v1, s[4:7], s39 offen offset:3072 sc1 lds
v_mfma_f32_16x16x32_bf16 v[56:59], a[200:203], a[120:123], v[56:59]
ds_read_b64 a[228:229], v127 offset:3072
v_mfma_f32_16x16x32_bf16 v[84:87], a[200:203], a[124:127], v[84:87]
ds_read_b64 a[230:231], v128
v_mfma_f32_16x16x32_bf16 v[60:63], a[204:207], a[120:123], v[60:63]
s_add_u32 m0, m0, 4096
v_mfma_f32_16x16x32_bf16 v[88:91], a[204:207], a[124:127], v[88:91]
s_add_u32 s39, s39, 4096
s_waitcnt vmcnt(18) lgkmcnt(0)
v_mfma_f32_16x16x32_bf16 v[36:39], a[144:147], a[128:131], v[36:39]
ds_read_b128 a[180:183], v8 offset:57344
v_mfma_f32_16x16x32_bf16 v[64:67], a[144:147], a[132:135], v[64:67]
ds_read_b128 a[184:187], v8 offset:58368
v_mfma_f32_16x16x32_bf16 v[40:43], a[148:151], a[128:131], v[40:43]
ds_read_b128 a[188:191], v8 offset:59392
v_mfma_f32_16x16x32_bf16 v[68:71], a[148:151], a[132:135], v[68:71]
ds_read_b128 a[192:195], v8 offset:60416
buffer_store_dwordx4 v[244:247], v9, s[4:7], s101 offen offset:3072 sc1
v_mfma_f32_16x16x32_bf16 v[44:47], a[152:155], a[128:131], v[44:47]
ds_read_b128 a[196:199], v8 offset:61440
v_mfma_f32_16x16x32_bf16 v[72:75], a[152:155], a[132:135], v[72:75]
ds_read_b128 a[200:203], v8 offset:62464
v_mfma_f32_16x16x32_bf16 v[48:51], a[156:159], a[128:131], v[48:51]
ds_read_b128 a[204:207], v8 offset:63488
v_mfma_f32_16x16x32_bf16 v[76:79], a[156:159], a[132:135], v[76:79]
ds_read_b128 a[208:211], v125 offset:57344
buffer_load_dwordx4 v1, s[4:7], s39 offen offset:0 sc1 lds
v_mfma_f32_16x16x32_bf16 v[52:55], a[160:163], a[128:131], v[52:55]
ds_read_b128 a[212:215], v126 offset:17408
v_mfma_f32_16x16x32_bf16 v[80:83], a[160:163], a[132:135], v[80:83]
s_mov_b32 s101, 1073741824
v_mfma_f32_16x16x32_bf16 v[92:95], a[172:175], a[176:179], v[92:95]
v_mfma_f32_16x16x32_bf16 v[96:99], a[160:163], a[176:179], v[96:99]
buffer_load_dwordx4 v1, s[4:7], s39 offen offset:1024 sc1 lds
v_mfma_f32_16x16x32_bf16 v[56:59], a[164:167], a[128:131], v[56:59]
v_mfma_f32_16x16x32_bf16 v[84:87], a[164:167], a[132:135], v[84:87]
v_mfma_f32_16x16x32_bf16 v[60:63], a[168:171], a[128:131], v[60:63]
v_mfma_f32_16x16x32_bf16 v[88:91], a[168:171], a[132:135], v[88:91]
s_waitcnt vmcnt(19) lgkmcnt(0)
v_mfma_f32_16x16x32_bf16 v[36:39], a[180:183], a[136:139], v[36:39]
v_mfma_f32_16x16x32_bf16 v[64:67], a[180:183], a[140:143], v[64:67]
v_mfma_f32_16x16x16_bf16 v[36:39], a[216:217], v[116:117], v[36:39]
v_mfma_f32_16x16x16_bf16 v[64:67], a[216:217], v[118:119], v[64:67]
v_mfma_f32_16x16x32_bf16 v[40:43], a[184:187], a[136:139], v[40:43]
v_mfma_f32_16x16x32_bf16 v[68:71], a[184:187], a[140:143], v[68:71]
s_nop 1
v_mfma_f32_16x16x16_bf16 v[40:43], a[218:219], v[116:117], v[40:43]
s_nop 1
v_mfma_f32_16x16x16_bf16 v[68:71], a[218:219], v[118:119], v[68:71]
v_cvt_pk_bf16_f32 v156, v36, v37
v_cvt_pk_bf16_f32 v157, v38, v39
v_mfma_f32_16x16x32_bf16 v[44:47], a[188:191], a[136:139], v[44:47]
ds_write_b64 v218, v[156:157] offset:2816
v_mfma_f32_16x16x32_bf16 v[72:75], a[188:191], a[140:143], v[72:75]
v_cvt_pk_bf16_f32 v162, v64, v65
v_cvt_pk_bf16_f32 v163, v66, v67
v_mfma_f32_16x16x16_bf16 v[44:47], a[220:221], v[116:117], v[44:47]
ds_write_b64 v218, v[162:163] offset:5632
v_mfma_f32_16x16x16_bf16 v[72:75], a[220:221], v[118:119], v[72:75]
v_cvt_pk_bf16_f32 v160, v40, v41
v_cvt_pk_bf16_f32 v161, v42, v43
v_mfma_f32_16x16x32_bf16 v[48:51], a[192:195], a[136:139], v[48:51]
ds_write_b64 v218, v[160:161] offset:2848
v_mfma_f32_16x16x32_bf16 v[76:79], a[192:195], a[140:143], v[76:79]
v_cvt_pk_bf16_f32 v166, v68, v69
v_cvt_pk_bf16_f32 v167, v70, v71
v_mfma_f32_16x16x16_bf16 v[48:51], a[222:223], v[116:117], v[48:51]
ds_write_b64 v218, v[166:167] offset:5664
v_mfma_f32_16x16x16_bf16 v[76:79], a[222:223], v[118:119], v[76:79]
v_cvt_pk_bf16_f32 v202, v44, v45
v_cvt_pk_bf16_f32 v203, v46, v47
v_mfma_f32_16x16x32_bf16 v[52:55], a[196:199], a[136:139], v[52:55]
ds_write_b64 v218, v[202:203] offset:2880
v_mfma_f32_16x16x32_bf16 v[80:83], a[196:199], a[140:143], v[80:83]
v_cvt_pk_bf16_f32 v204, v72, v73
v_cvt_pk_bf16_f32 v205, v74, v75
v_mfma_f32_16x16x16_bf16 v[52:55], a[224:225], v[116:117], v[52:55]
ds_write_b64 v218, v[204:205] offset:5696
v_mfma_f32_16x16x16_bf16 v[80:83], a[224:225], v[118:119], v[80:83]
v_cvt_pk_bf16_f32 v206, v48, v49
v_cvt_pk_bf16_f32 v207, v50, v51
v_mfma_f32_16x16x32_bf16 v[92:95], a[208:211], a[212:215], v[92:95]
ds_write_b64 v218, v[206:207] offset:2912
v_mfma_f32_16x16x32_bf16 v[96:99], a[196:199], a[212:215], v[96:99]
v_cvt_pk_bf16_f32 v208, v76, v77
v_cvt_pk_bf16_f32 v209, v78, v79
v_mfma_f32_16x16x16_bf16 v[92:95], a[230:231], v[120:121], v[92:95]
ds_write_b64 v218, v[208:209] offset:5728
v_mfma_f32_16x16x16_bf16 v[96:99], a[224:225], v[120:121], v[96:99]
v_cvt_pk_bf16_f32 v210, v52, v53
v_cvt_pk_bf16_f32 v211, v54, v55
v_mfma_f32_16x16x32_bf16 v[56:59], a[200:203], a[136:139], v[56:59]
ds_write_b64 v218, v[210:211] offset:2944
v_mfma_f32_16x16x32_bf16 v[84:87], a[200:203], a[140:143], v[84:87]
v_cvt_pk_bf16_f32 v212, v80, v81
v_cvt_pk_bf16_f32 v213, v82, v83
v_mfma_f32_16x16x16_bf16 v[56:59], a[226:227], v[116:117], v[56:59]
ds_write_b64 v218, v[212:213] offset:5760
v_mfma_f32_16x16x16_bf16 v[84:87], a[226:227], v[118:119], v[84:87]
v_cvt_pk_bf16_f32 v214, v92, v93
v_cvt_pk_bf16_f32 v215, v94, v95
v_mfma_f32_16x16x32_bf16 v[60:63], a[204:207], a[136:139], v[60:63]
ds_write_b64 v222, v[214:215]
v_mfma_f32_16x16x32_bf16 v[88:91], a[204:207], a[140:143], v[88:91]
v_cvt_pk_bf16_f32 v216, v96, v97
v_cvt_pk_bf16_f32 v217, v98, v99
v_mfma_f32_16x16x16_bf16 v[60:63], a[228:229], v[116:117], v[60:63]
ds_write_b64 v219, v[216:217] offset:128
v_mfma_f32_16x16x16_bf16 v[88:91], a[228:229], v[118:119], v[88:91]
s_waitcnt lgkmcnt(0)
s_barrier
ds_read_b64 v[150:151], v218
ds_read_b64 v[154:155], v218 offset:32
ds_read_b64 v[152:153], v220 offset:136
ds_read_b64 v[158:159], v220 offset:2952
ds_read_b64 v[164:165], v220 offset:5768
s_mul_i32 s36, s28, 82944
s_mul_i32 s38, s24, 11264
s_add_u32 m0, s38, 78848
s_add_u32 s39, s38, s36
s_add_u32 s39, s39, 2162688
buffer_load_dwordx4 v1, s[4:7], s39 offen offset:0 sc1 lds
buffer_load_dwordx4 v1, s[4:7], s39 offen offset:1024 sc1 lds
v_cndmask_b32 v170, 0, v210, s[48:49]
v_cndmask_b32 v173, 0, v211, s[48:49]
v_cndmask_b32 v178, 0, v212, s[48:49]
v_cndmask_b32 v181, 0, v213, s[48:49]
v_cvt_pk_bf16_f32 v168, v56, v57
v_cvt_pk_bf16_f32 v169, v58, v59
v_cvt_pk_bf16_f32 v176, v84, v85
v_cvt_pk_bf16_f32 v177, v86, v87
v_cvt_pk_bf16_f32 v174, v60, v61
v_cvt_pk_bf16_f32 v175, v62, v63
v_cvt_pk_bf16_f32 v182, v88, v89
v_cvt_pk_bf16_f32 v183, v90, v91
s_waitcnt lgkmcnt(0)
ds_read_b64_tr_b16 v[184:185], v221 offset:64
v_mfma_f32_16x16x32_bf16 v[36:39], v[150:153], v[168:171], 0
ds_read_b64_tr_b16 v[186:187], v221 offset:2880
v_mfma_f32_16x16x32_bf16 v[40:43], v[156:159], v[168:171], 0
ds_read_b64_tr_b16 v[188:189], v221 offset:5696
buffer_load_dwordx4 v1, s[4:7], s39 offen offset:2048 sc1 lds
v_mfma_f32_16x16x32_bf16 v[44:47], v[152:155], v[172:175], 0
ds_read_b64_tr_b16 v[190:191], v221 offset:96
v_mfma_f32_16x16x32_bf16 v[48:51], v[158:161], v[172:175], 0
ds_read_b64_tr_b16 v[192:193], v221 offset:2912
buffer_load_dwordx4 v1, s[4:7], s39 offen offset:3072 sc1 lds
v_mfma_f32_16x16x32_bf16 v[52:55], v[156:159], v[176:179], 0
ds_read_b64_tr_b16 v[194:195], v221 offset:5728
v_mfma_f32_16x16x32_bf16 v[56:59], v[162:165], v[176:179], 0
ds_read_b64_tr_b16 v[196:197], v221 offset:128
s_add_u32 m0, m0, 4096
s_add_u32 s39, s39, 4096
buffer_load_dwordx4 v1, s[4:7], s39 offen offset:0 sc1 lds
v_mfma_f32_16x16x32_bf16 v[60:63], v[158:161], v[180:183], 0
ds_read_b64_tr_b16 v[198:199], v221 offset:2944
v_mfma_f32_16x16x32_bf16 v[64:67], v[164:167], v[180:183], 0
ds_read_b64_tr_b16 v[200:201], v221 offset:5760
buffer_load_dwordx4 v1, s[4:7], s39 offen offset:1024 sc1 lds
v_cndmask_b32 v36, v36, v37, s[40:41]
v_cndmask_b32 v40, v40, v41, s[40:41]
v_cndmask_b32 v36, v36, v40, s[42:43]
v_fma_f32 v68, v36, v140, v144
v_cndmask_b32 v38, v38, v39, s[40:41]
v_cndmask_b32 v42, v42, v43, s[40:41]
v_cndmask_b32 v38, v38, v42, s[44:45]
v_fma_f32 v69, v38, v141, v145
v_max_f32 v76, v68, v69
v_cndmask_b32 v44, v44, v45, s[40:41]
buffer_load_dwordx4 v1, s[4:7], s39 offen offset:2048 sc1 lds
v_cndmask_b32 v48, v48, v49, s[40:41]
v_cndmask_b32 v44, v44, v48, s[42:43]
v_fma_f32 v70, v44, v140, v144
v_cndmask_b32 v46, v46, v47, s[40:41]
v_cndmask_b32 v50, v50, v51, s[40:41]
v_cndmask_b32 v46, v46, v50, s[44:45]
v_fma_f32 v71, v46, v141, v145
v_max_f32 v77, v70, v71
v_cndmask_b32 v52, v52, v53, s[40:41]
v_cndmask_b32 v56, v56, v57, s[40:41]
buffer_load_dwordx4 v1, s[4:7], s39 offen offset:3072 sc1 lds
v_cndmask_b32 v52, v52, v56, s[42:43]
v_mul_f32 v72, v52, v142
v_cndmask_b32 v54, v54, v55, s[40:41]
v_cndmask_b32 v58, v58, v59, s[40:41]
v_cndmask_b32 v54, v54, v58, s[44:45]
v_mul_f32 v73, v54, v143
v_max_f32 v78, v72, v73
v_cndmask_b32 v60, v60, v61, s[40:41]
v_cndmask_b32 v64, v64, v65, s[40:41]
v_cndmask_b32 v60, v60, v64, s[42:43]
s_add_u32 m0, m0, 4096
v_mul_f32 v74, v60, v142
v_cndmask_b32 v62, v62, v63, s[40:41]
v_cndmask_b32 v66, v66, v67, s[40:41]
v_cndmask_b32 v62, v62, v66, s[44:45]
v_mul_f32 v75, v62, v143
v_max_f32 v79, v74, v75
s_nop 1
v_permlane32_swap_b32 v76, v77
v_permlane32_swap_b32 v78, v79
s_add_u32 s39, s39, 4096
v_max_f32 v76, v76, v77
v_max_f32 v78, v78, v79
s_nop 1
v_permlane16_swap_b32 v76, v78
v_max_f32 v76, v76, v78
v_mov_b32 v78, v76
s_nop 1
v_permlane16_swap_b32 v76, v78
v_mov_b32 v77, v76
v_mov_b32 v79, v78
buffer_load_dwordx4 v1, s[4:7], s39 offen offset:0 sc1 lds
s_nop 0
v_permlane32_swap_b32 v76, v77
v_permlane32_swap_b32 v78, v79
v_sub_f32 v68, v68, v76
v_sub_f32 v69, v69, v76
v_sub_f32 v70, v70, v77
v_sub_f32 v71, v71, v77
v_sub_f32 v72, v72, v78
v_sub_f32 v73, v73, v78
v_sub_f32 v74, v74, v79
buffer_load_dwordx4 v1, s[4:7], s39 offen offset:1024 sc1 lds
v_sub_f32 v75, v75, v79
v_exp_f32 v68, v68
v_exp_f32 v69, v69
v_exp_f32 v70, v70
v_exp_f32 v71, v71
v_exp_f32 v72, v72
v_exp_f32 v73, v73
v_exp_f32 v74, v74
v_exp_f32 v75, v75
buffer_load_dwordx4 v1, s[4:7], s39 offen offset:2048 sc1 lds
v_add_f32 v76, v68, v69
v_add_f32 v77, v70, v71
v_add_f32 v78, v72, v73
v_add_f32 v79, v74, v75
v_mul_f32 v68, v68, v136
v_mul_f32 v69, v69, v137
v_mul_f32 v70, v70, v136
v_mul_f32 v71, v71, v137
v_mul_f32 v72, v72, v138
v_mul_f32 v73, v73, v139
v_mul_f32 v74, v74, v138
v_mul_f32 v75, v75, v139
s_nop 1
v_permlane32_swap_b32 v76, v77
v_permlane32_swap_b32 v78, v79
v_add_f32 v76, v76, v77
v_add_f32 v78, v78, v79
s_nop 1
v_permlane16_swap_b32 v76, v78
v_add_f32 v76, v76, v78
v_rcp_f32 v76, v76
s_nop 0
v_mov_b32 v78, v76
s_nop 1
v_permlane16_swap_b32 v76, v78
v_mov_b32 v77, v76
v_mov_b32 v79, v78
s_nop 0
v_permlane32_swap_b32 v76, v77
v_permlane32_swap_b32 v78, v79
s_waitcnt lgkmcnt(0)
v_mul_f32 v68, v68, v76
v_mul_f32 v69, v69, v76
v_cvt_pk_bf16_f32 v68, v68, v69
v_perm_b32 v84, v68, v68, v10
v_perm_b32 v85, v68, v68, v11
v_perm_b32 v86, v68, v68, v12
v_perm_b32 v87, v68, v68, v13
v_mul_f32 v70, v70, v77
v_mul_f32 v71, v71, v77
v_mfma_f32_16x16x32_bf16 v[36:39], v[184:187], v[84:87], 0
v_cvt_pk_bf16_f32 v70, v70, v71
v_perm_b32 v88, v70, v70, v10
v_mfma_f32_16x16x32_bf16 v[40:43], v[196:199], v[84:87], 0
v_perm_b32 v89, v70, v70, v11
v_perm_b32 v90, v70, v70, v12
v_perm_b32 v91, v70, v70, v13
v_mul_f32 v72, v72, v78
v_mul_f32 v73, v73, v78
v_mfma_f32_16x16x32_bf16 v[44:47], v[190:193], v[88:91], 0
v_cvt_pk_bf16_f32 v72, v72, v73
v_perm_b32 v92, v72, v72, v10
v_mfma_f32_16x16x32_bf16 v[48:51], v[196:199], v[88:91], 0
v_perm_b32 v93, v72, v72, v11
v_perm_b32 v94, v72, v72, v12
v_perm_b32 v95, v72, v72, v13
v_mul_f32 v74, v74, v79
v_mul_f32 v75, v75, v79
v_mfma_f32_16x16x32_bf16 v[52:55], v[186:189], v[92:95], 0
v_cvt_pk_bf16_f32 v74, v74, v75
v_perm_b32 v96, v74, v74, v10
v_mfma_f32_16x16x32_bf16 v[56:59], v[198:201], v[92:95], 0
v_perm_b32 v97, v74, v74, v11
v_perm_b32 v98, v74, v74, v12
v_perm_b32 v99, v74, v74, v13
v_cvt_pk_bf16_f32 v168, v36, v37
v_cvt_pk_bf16_f32 v169, v38, v39
v_mfma_f32_16x16x32_bf16 v[60:63], v[192:195], v[96:99], 0
v_mfma_f32_16x16x32_bf16 v[64:67], v[198:201], v[96:99], 0
v_cvt_pk_bf16_f32 v172, v40, v41
v_cvt_pk_bf16_f32 v170, v44, v45
v_cvt_pk_bf16_f32 v171, v46, v47
v_cvt_pk_bf16_f32 v173, v50, v51
buffer_store_dwordx4 v[168:171], v1, s[8:11], s64 offen sc1
buffer_store_dwordx2 v[172:173], v224, s[8:11], s65 offen sc1
v_cvt_pk_bf16_f32 v176, v52, v53
v_cvt_pk_bf16_f32 v177, v54, v55
v_cvt_pk_bf16_f32 v180, v56, v57
v_cvt_pk_bf16_f32 v178, v60, v61
v_cvt_pk_bf16_f32 v179, v62, v63
v_cvt_pk_bf16_f32 v181, v66, v67
buffer_store_dwordx4 v[176:179], v237, s[8:11], s64 offen sc1
buffer_store_dwordx2 v[180:181], v225, s[8:11], s65 offen sc1
L_c2:
s_mul_i32 s38, s24, 9216
s_add_u32 m0, s38, 123904
s_add_u32 s39, s38, s82
buffer_load_dwordx4 v1, s[4:7], s39 offen offset:0 sc1 lds
buffer_load_dwordx4 v1, s[4:7], s39 offen offset:1024 sc1 lds
buffer_load_dwordx4 v1, s[4:7], s39 offen offset:2048 sc1 lds
buffer_load_dwordx4 v1, s[4:7], s39 offen offset:3072 sc1 lds
s_add_u32 m0, m0, 4096
s_add_u32 s39, s39, 4096
buffer_load_dwordx4 v1, s[4:7], s39 offen offset:0 sc1 lds
buffer_load_dwordx4 v1, s[4:7], s39 offen offset:1024 sc1 lds
buffer_load_dwordx4 v1, s[4:7], s39 offen offset:2048 sc1 lds
v_lshlrev_b32 v7, 3, v1
s_lshl_b32 s31, s25, 11
v_add_u32 v7, s31, v7
s_cmp_eq_u32 s24, 0
s_cselect_b32 s30, 0, 1073741824
s_add_u32 s30, s30, 26476544
s_waitcnt vmcnt(7)
s_barrier
s_mov_b64 exec, 0xffff
buffer_atomic_add v4, v7, s[8:11], s30 offen sc1
s_mov_b64 exec, -1
s_lshl_b32 s35, s81, 7
s_add_u32 s35, s35, 26476544
s_cmp_eq_u32 s24, 1
s_cselect_b32 s35, s35, 1073741824
v_mov_b32 v6, 0
v_mov_b32 v244, 0
v_mov_b32 v245, 0
v_mov_b32 v246, 0
buffer_load_dwordx4 v1, s[4:7], s39 offen offset:3072 sc1 lds
s_add_u32 m0, m0, 4096
s_add_u32 s39, s39, 4096
buffer_load_dwordx4 v1, s[4:7], s39 offen offset:0 sc1 lds
s_lshl_b32 s38, s24, 8
s_add_u32 m0, s38, 160768
s_add_u32 s39, s38, s82
s_add_u32 s39, s39, 36864
s_mov_b64 exec, 0xffff
buffer_load_dwordx4 v1, s[4:7], s39 offen sc1 lds
s_mov_b64 exec, -1
s_mul_i32 s38, s24, 9216
s_add_u32 m0, s38, 0
s_add_u32 s39, s38, s82
s_add_u32 s39, s39, 37888
buffer_load_dwordx4 v1, s[4:7], s39 offen offset:0 sc1 lds
s_mov_b64 exec, 1
buffer_atomic_add v244, v6, s[8:11], s35 offen sc0 sc1
s_mov_b64 exec, -1
buffer_load_dwordx4 v1, s[4:7], s39 offen offset:1024 sc1 lds
buffer_load_dwordx4 v1, s[4:7], s39 offen offset:2048 sc1 lds
buffer_load_dwordx4 v1, s[4:7], s39 offen offset:3072 sc1 lds
s_add_u32 m0, m0, 4096
s_add_u32 s39, s39, 4096
s_mov_b64 exec, 1
buffer_atomic_add v245, v6, s[8:11], s35 offen sc0 sc1
s_mov_b64 exec, -1
buffer_load_dwordx4 v1, s[4:7], s39 offen offset:0 sc1 lds
buffer_load_dwordx4 v1, s[4:7], s39 offen offset:1024 sc1 lds
buffer_load_dwordx4 v1, s[4:7], s39 offen offset:2048 sc1 lds
s_mov_b64 exec, 1
buffer_atomic_add v246, v6, s[8:11], s35 offen sc0 sc1
s_mov_b64 exec, -1
buffer_load_dwordx4 v1, s[4:7], s39 offen offset:3072 sc1 lds
s_add_u32 m0, m0, 4096
s_add_u32 s39, s39, 4096
buffer_load_dwordx4 v1, s[4:7], s39 offen offset:0 sc1 lds
s_lshl_b32 s38, s24, 8
s_add_u32 m0, s38, 36864
s_add_u32 s39, s38, s82
s_add_u32 s39, s39, 74752
s_mov_b64 exec, 0xffff
buffer_load_dwordx4 v1, s[4:7], s39 offen sc1 lds
s_mov_b64 exec, -1
s_lshl_b32 s60, s27, 2
s_add_u32 s60, s60, s24
s_mul_i32 s60, s60, 18432
s_add_u32 s60, s60, 2490368
s_cmp_eq_u32 s24, 1
s_cbranch_scc0 L_other_15
s_mov_b32 s31, 0
s_mov_b64 exec, 1
v_mov_b32 v247, 0
buffer_atomic_add v247, v6, s[8:11], s35 offen sc0 sc1
s_waitcnt vmcnt(12)
v_cmp_gt_u32 vcc, 16, v244
s_nop 0
s_cbranch_vccz L_polled_14
s_waitcnt vmcnt(8)
v_cmp_gt_u32 vcc, 16, v245
s_nop 0
s_cbranch_vccz L_polled_14
v_mov_b32 v244, 0
buffer_atomic_add v244, v6, s[8:11], s35 offen sc0 sc1
s_waitcnt vmcnt(5)
v_cmp_gt_u32 vcc, 16, v246
s_nop 0
s_cbranch_vccz L_polled_14
v_mov_b32 v245, 0
buffer_atomic_add v245, v6, s[8:11], s35 offen sc0 sc1
L_poll_13:
s_add_u32 s31, s31, 1
s_cmp_gt_u32 s31, 100000
s_cbranch_scc1 L_polled_14
v_mov_b32 v246, 0
buffer_atomic_add v246, v6, s[8:11], s35 offen sc0 sc1
s_waitcnt vmcnt(3)
v_cmp_gt_u32 vcc, 16, v247
s_nop 0
s_cbranch_vccz L_polled_14
v_mov_b32 v247, 0
buffer_atomic_add v247, v6, s[8:11], s35 offen sc0 sc1
s_waitcnt vmcnt(3)
v_cmp_gt_u32 vcc, 16, v244
s_nop 0
s_cbranch_vccz L_polled_14
v_mov_b32 v244, 0
buffer_atomic_add v244, v6, s[8:11], s35 offen sc0 sc1
s_waitcnt vmcnt(3)
v_cmp_gt_u32 vcc, 16, v245
s_nop 0
s_cbranch_vccz L_polled_14
v_mov_b32 v245, 0
buffer_atomic_add v245, v6, s[8:11], s35 offen sc0 sc1
s_waitcnt vmcnt(3)
v_cmp_gt_u32 vcc, 16, v246
s_nop 0
s_cbranch_vccz L_polled_14
s_branch L_poll_13
L_polled_14:
s_mov_b64 exec, -1
L_other_15:
s_barrier
buffer_load_dwordx4 a[0:3], v1, s[8:11], s60 offen offset:0 sc1
buffer_load_dwordx4 a[4:7], v1, s[8:11], s60 offen offset:1024 sc1
s_barrier
buffer_load_dwordx4 a[8:11], v1, s[8:11], s60 offen offset:2048 sc1
buffer_load_dwordx4 a[12:15], v1, s[8:11], s60 offen offset:3072 sc1
s_barrier
s_add_u32 s60, s60, 4096
buffer_load_dwordx4 a[16:19], v1, s[8:11], s60 offen offset:0 sc1
buffer_load_dwordx4 a[20:23], v1, s[8:11], s60 offen offset:1024 sc1
s_barrier
buffer_load_dwordx4 a[24:27], v1, s[8:11], s60 offen offset:2048 sc1
buffer_load_dwordx4 a[28:31], v1, s[8:11], s60 offen offset:3072 sc1
s_barrier
s_add_u32 s60, s60, 4096
buffer_load_dwordx4 a[32:35], v1, s[8:11], s60 offen offset:0 sc1
v_lshrrev_b32 v40, 1, v1
v_and_b32 v36, 7, v2
v_lshlrev_b32 v36, 4, v36
v_lshl_add_u32 v36, v3, 7, v36
v_add_u32 v36, 4096, v36
v_add_u32 v36, 37888, v36
v_add_u32 v39, 37888, v1
v_add_u32 v37, 79360, v1
v_add_u32 v38, 41472, v36
ds_read_b128 a[72:75], v39 offset:0
ds_read_b128 a[76:79], v39 offset:1024
ds_read_b128 a[80:83], v39 offset:2048
ds_read_b128 a[84:87], v39 offset:3072
ds_read_b128 a[88:91], v36 offset:0
ds_read_b128 a[92:95], v39 offset:4608
ds_read_b128 a[96:99], v39 offset:5632
ds_read_b128 a[100:103], v39 offset:6656
ds_read_b128 a[104:107], v39 offset:7680
ds_read_b128 a[108:111], v36 offset:4608
s_lshl_b32 s30, s27, 2
s_add_u32 s30, s30, s24
v_mov_b32 v58, 1073741824
s_mul_i32 s62, s30, 18432
s_mul_i32 s32, s28, 2304
s_add_u32 s62, s62, s32
s_add_u32 s62, s62, 4849664
v_mov_b32 v60, v1
v_add_u32 v61, 2048, v60
v_cndmask_b32 v61, v58, v61, s[46:47]
s_lshl_b32 s63, s30, 7
s_lshl_b32 s32, s28, 14
s_add_u32 s63, s63, s32
s_add_u32 s63, s63, 7208960
v_lshlrev_b32 v59, 3, v2
v_cndmask_b32 v58, v58, v59, s[46:47]
s_waitcnt vmcnt(8) lgkmcnt(5)
v_mfma_f32_16x16x32_bf16 v[16:19], a[72:75], a[0:3], v[16:19]
ds_read_b128 a[112:115], v39 offset:9216
buffer_load_dwordx4 a[36:39], v1, s[8:11], s60 offen offset:1024 sc1
v_mfma_f32_16x16x32_bf16 v[20:23], a[76:79], a[0:3], v[20:23]
ds_read_b128 a[116:119], v39 offset:10240
v_mfma_f32_16x16x32_bf16 v[24:27], a[80:83], a[0:3], v[24:27]
ds_read_b128 a[120:123], v39 offset:11264
v_mfma_f32_16x16x32_bf16 v[28:31], a[84:87], a[0:3], v[28:31]
ds_read_b128 a[124:127], v39 offset:12288
v_mfma_f32_16x16x32_bf16 v[32:35], a[88:91], a[0:3], v[32:35]
ds_read_b128 a[128:131], v36 offset:9216
s_waitcnt vmcnt(8) lgkmcnt(5)
v_mfma_f32_16x16x32_bf16 v[16:19], a[92:95], a[4:7], v[16:19]
ds_read_b128 a[72:75], v39 offset:13824
buffer_load_dwordx4 a[40:43], v1, s[8:11], s60 offen offset:2048 sc1
v_mfma_f32_16x16x32_bf16 v[20:23], a[96:99], a[4:7], v[20:23]
ds_read_b128 a[76:79], v39 offset:14848
v_mfma_f32_16x16x32_bf16 v[24:27], a[100:103], a[4:7], v[24:27]
ds_read_b128 a[80:83], v39 offset:15872
v_mfma_f32_16x16x32_bf16 v[28:31], a[104:107], a[4:7], v[28:31]
ds_read_b128 a[84:87], v39 offset:16896
v_mfma_f32_16x16x32_bf16 v[32:35], a[108:111], a[4:7], v[32:35]
ds_read_b128 a[88:91], v36 offset:13824
s_waitcnt vmcnt(8) lgkmcnt(5)
v_mfma_f32_16x16x32_bf16 v[16:19], a[112:115], a[8:11], v[16:19]
ds_read_b128 a[92:95], v39 offset:18432
buffer_load_dwordx4 a[44:47], v1, s[8:11], s60 offen offset:3072 sc1
v_mfma_f32_16x16x32_bf16 v[20:23], a[116:119], a[8:11], v[20:23]
ds_read_b128 a[96:99], v39 offset:19456
v_mfma_f32_16x16x32_bf16 v[24:27], a[120:123], a[8:11], v[24:27]
ds_read_b128 a[100:103], v39 offset:20480
v_mfma_f32_16x16x32_bf16 v[28:31], a[124:127], a[8:11], v[28:31]
ds_read_b128 a[104:107], v39 offset:21504
v_mfma_f32_16x16x32_bf16 v[32:35], a[128:131], a[8:11], v[32:35]
ds_read_b128 a[108:111], v36 offset:18432
s_waitcnt vmcnt(8) lgkmcnt(5)
v_mfma_f32_16x16x32_bf16 v[16:19], a[72:75], a[12:15], v[16:19]
ds_read_b128 a[112:115], v39 offset:23040
s_add_u32 s60, s60, 4096
buffer_load_dwordx4 a[48:51], v1, s[8:11], s60 offen offset:0 sc1
v_mfma_f32_16x16x32_bf16 v[20:23], a[76:79], a[12:15], v[20:23]
ds_read_b128 a[116:119], v39 offset:24064
v_mfma_f32_16x16x32_bf16 v[24:27], a[80:83], a[12:15], v[24:27]
ds_read_b128 a[120:123], v39 offset:25088
v_mfma_f32_16x16x32_bf16 v[28:31], a[84:87], a[12:15], v[28:31]
ds_read_b128 a[124:127], v39 offset:26112
v_mfma_f32_16x16x32_bf16 v[32:35], a[88:91], a[12:15], v[32:35]
ds_read_b128 a[128:131], v36 offset:23040
s_waitcnt vmcnt(8) lgkmcnt(5)
v_mfma_f32_16x16x32_bf16 v[16:19], a[92:95], a[16:19], v[16:19]
ds_read_b128 a[72:75], v39 offset:27648
buffer_load_dwordx4 a[52:55], v1, s[8:11], s60 offen offset:1024 sc1
v_mfma_f32_16x16x32_bf16 v[20:23], a[96:99], a[16:19], v[20:23]
ds_read_b128 a[76:79], v39 offset:28672
v_mfma_f32_16x16x32_bf16 v[24:27], a[100:103], a[16:19], v[24:27]
ds_read_b128 a[80:83], v39 offset:29696
v_mfma_f32_16x16x32_bf16 v[28:31], a[104:107], a[16:19], v[28:31]
ds_read_b128 a[84:87], v39 offset:30720
v_mfma_f32_16x16x32_bf16 v[32:35], a[108:111], a[16:19], v[32:35]
ds_read_b128 a[88:91], v36 offset:27648
s_waitcnt vmcnt(8) lgkmcnt(5)
v_mfma_f32_16x16x32_bf16 v[16:19], a[112:115], a[20:23], v[16:19]
ds_read_b128 a[92:95], v39 offset:32256
buffer_load_dwordx4 a[56:59], v1, s[8:11], s60 offen offset:2048 sc1
v_mfma_f32_16x16x32_bf16 v[20:23], a[116:119], a[20:23], v[20:23]
ds_read_b128 a[96:99], v39 offset:33280
v_mfma_f32_16x16x32_bf16 v[24:27], a[120:123], a[20:23], v[24:27]
ds_read_b128 a[100:103], v39 offset:34304
v_mfma_f32_16x16x32_bf16 v[28:31], a[124:127], a[20:23], v[28:31]
ds_read_b128 a[104:107], v39 offset:35328
v_mfma_f32_16x16x32_bf16 v[32:35], a[128:131], a[20:23], v[32:35]
ds_read_b128 a[108:111], v36 offset:32256
s_waitcnt vmcnt(8) lgkmcnt(5)
v_mfma_f32_16x16x32_bf16 v[16:19], a[72:75], a[24:27], v[16:19]
ds_read_b128 a[112:115], v39 offset:36864
buffer_load_dwordx4 a[60:63], v1, s[8:11], s60 offen offset:3072 sc1
v_mfma_f32_16x16x32_bf16 v[20:23], a[76:79], a[24:27], v[20:23]
ds_read_b128 a[116:119], v39 offset:37888
v_mfma_f32_16x16x32_bf16 v[24:27], a[80:83], a[24:27], v[24:27]
ds_read_b128 a[120:123], v39 offset:38912
v_mfma_f32_16x16x32_bf16 v[28:31], a[84:87], a[24:27], v[28:31]
ds_read_b128 a[124:127], v39 offset:39936
v_mfma_f32_16x16x32_bf16 v[32:35], a[88:91], a[24:27], v[32:35]
ds_read_b128 a[128:131], v36 offset:36864
s_waitcnt vmcnt(8) lgkmcnt(5)
v_mfma_f32_16x16x32_bf16 v[16:19], a[92:95], a[28:31], v[16:19]
ds_read_b128 a[72:75], v37 offset:0
s_add_u32 s60, s60, 4096
buffer_load_dwordx2 a[64:65], v40, s[8:11], s60 offen offset:0 sc1
buffer_load_dwordx2 a[66:67], v40, s[8:11], s60 offen offset:1024 sc1
v_mfma_f32_16x16x32_bf16 v[20:23], a[96:99], a[28:31], v[20:23]
ds_read_b128 a[76:79], v37 offset:1024
v_mfma_f32_16x16x32_bf16 v[24:27], a[100:103], a[28:31], v[24:27]
ds_read_b128 a[80:83], v37 offset:2048
v_mfma_f32_16x16x32_bf16 v[28:31], a[104:107], a[28:31], v[28:31]
ds_read_b128 a[84:87], v37 offset:3072
v_mfma_f32_16x16x32_bf16 v[32:35], a[108:111], a[28:31], v[32:35]
ds_read_b128 a[88:91], v38 offset:0
s_waitcnt vmcnt(9) lgkmcnt(5)
v_mfma_f32_16x16x32_bf16 v[16:19], a[112:115], a[32:35], v[16:19]
ds_read_b128 a[92:95], v37 offset:4608
buffer_load_dwordx2 a[68:69], v40, s[8:11], s60 offen offset:512 sc1
buffer_load_dwordx2 a[70:71], v40, s[8:11], s60 offen offset:1536 sc1
v_mfma_f32_16x16x32_bf16 v[20:23], a[116:119], a[32:35], v[20:23]
ds_read_b128 a[96:99], v37 offset:5632
v_mfma_f32_16x16x32_bf16 v[24:27], a[120:123], a[32:35], v[24:27]
ds_read_b128 a[100:103], v37 offset:6656
v_mfma_f32_16x16x32_bf16 v[28:31], a[124:127], a[32:35], v[28:31]
ds_read_b128 a[104:107], v37 offset:7680
v_mfma_f32_16x16x32_bf16 v[32:35], a[128:131], a[32:35], v[32:35]
ds_read_b128 a[108:111], v38 offset:4608
s_waitcnt vmcnt(10) lgkmcnt(5)
v_mfma_f32_16x16x32_bf16 v[16:19], a[72:75], a[36:39], v[16:19]
ds_read_b128 a[112:115], v37 offset:9216
v_mfma_f32_16x16x32_bf16 v[20:23], a[76:79], a[36:39], v[20:23]
ds_read_b128 a[116:119], v37 offset:10240
v_mfma_f32_16x16x32_bf16 v[24:27], a[80:83], a[36:39], v[24:27]
ds_read_b128 a[120:123], v37 offset:11264
v_mfma_f32_16x16x32_bf16 v[28:31], a[84:87], a[36:39], v[28:31]
ds_read_b128 a[124:127], v37 offset:12288
v_mfma_f32_16x16x32_bf16 v[32:35], a[88:91], a[36:39], v[32:35]
ds_read_b128 a[128:131], v38 offset:9216
s_waitcnt vmcnt(9) lgkmcnt(5)
v_mfma_f32_16x16x32_bf16 v[16:19], a[92:95], a[40:43], v[16:19]
ds_read_b128 a[72:75], v37 offset:13824
v_mfma_f32_16x16x32_bf16 v[20:23], a[96:99], a[40:43], v[20:23]
ds_read_b128 a[76:79], v37 offset:14848
v_mfma_f32_16x16x32_bf16 v[24:27], a[100:103], a[40:43], v[24:27]
ds_read_b128 a[80:83], v37 offset:15872
v_mfma_f32_16x16x32_bf16 v[28:31], a[104:107], a[40:43], v[28:31]
ds_read_b128 a[84:87], v37 offset:16896
v_mfma_f32_16x16x32_bf16 v[32:35], a[108:111], a[40:43], v[32:35]
ds_read_b128 a[88:91], v38 offset:13824
s_waitcnt vmcnt(8) lgkmcnt(5)
v_mfma_f32_16x16x32_bf16 v[16:19], a[112:115], a[44:47], v[16:19]
ds_read_b128 a[92:95], v37 offset:18432
v_mfma_f32_16x16x32_bf16 v[20:23], a[116:119], a[44:47], v[20:23]
ds_read_b128 a[96:99], v37 offset:19456
v_mfma_f32_16x16x32_bf16 v[24:27], a[120:123], a[44:47], v[24:27]
ds_read_b128 a[100:103], v37 offset:20480
v_mfma_f32_16x16x32_bf16 v[28:31], a[124:127], a[44:47], v[28:31]
ds_read_b128 a[104:107], v37 offset:21504
v_mfma_f32_16x16x32_bf16 v[32:35], a[128:131], a[44:47], v[32:35]
ds_read_b128 a[108:111], v38 offset:18432
s_waitcnt vmcnt(7) lgkmcnt(5)
v_mfma_f32_16x16x32_bf16 v[16:19], a[72:75], a[48:51], v[16:19]
ds_read_b128 a[112:115], v37 offset:23040
v_mfma_f32_16x16x32_bf16 v[20:23], a[76:79], a[48:51], v[20:23]
ds_read_b128 a[116:119], v37 offset:24064
v_mfma_f32_16x16x32_bf16 v[24:27], a[80:83], a[48:51], v[24:27]
ds_read_b128 a[120:123], v37 offset:25088
v_mfma_f32_16x16x32_bf16 v[28:31], a[84:87], a[48:51], v[28:31]
ds_read_b128 a[124:127], v37 offset:26112
v_mfma_f32_16x16x32_bf16 v[32:35], a[88:91], a[48:51], v[32:35]
ds_read_b128 a[128:131], v38 offset:23040
s_waitcnt vmcnt(6) lgkmcnt(5)
v_mfma_f32_16x16x32_bf16 v[16:19], a[92:95], a[52:55], v[16:19]
ds_read_b128 a[72:75], v37 offset:27648
v_mfma_f32_16x16x32_bf16 v[20:23], a[96:99], a[52:55], v[20:23]
ds_read_b128 a[76:79], v37 offset:28672
v_mfma_f32_16x16x32_bf16 v[24:27], a[100:103], a[52:55], v[24:27]
ds_read_b128 a[80:83], v37 offset:29696
v_mfma_f32_16x16x32_bf16 v[28:31], a[104:107], a[52:55], v[28:31]
ds_read_b128 a[84:87], v37 offset:30720
v_mfma_f32_16x16x32_bf16 v[32:35], a[108:111], a[52:55], v[32:35]
ds_read_b128 a[88:91], v38 offset:27648
s_waitcnt vmcnt(5) lgkmcnt(5)
v_mfma_f32_16x16x32_bf16 v[16:19], a[112:115], a[56:59], v[16:19]
ds_read_b128 a[92:95], v37 offset:32256
v_mfma_f32_16x16x32_bf16 v[20:23], a[116:119], a[56:59], v[20:23]
ds_read_b128 a[96:99], v37 offset:33280
v_mfma_f32_16x16x32_bf16 v[24:27], a[120:123], a[56:59], v[24:27]
ds_read_b128 a[100:103], v37 offset:34304
v_mfma_f32_16x16x32_bf16 v[28:31], a[124:127], a[56:59], v[28:31]
ds_read_b128 a[104:107], v37 offset:35328
v_mfma_f32_16x16x32_bf16 v[32:35], a[128:131], a[56:59], v[32:35]
ds_read_b128 a[108:111], v38 offset:32256
s_waitcnt vmcnt(4) lgkmcnt(5)
v_mfma_f32_16x16x32_bf16 v[16:19], a[72:75], a[60:63], v[16:19]
ds_read_b128 a[112:115], v37 offset:36864
v_mfma_f32_16x16x32_bf16 v[20:23], a[76:79], a[60:63], v[20:23]
ds_read_b128 a[116:119], v37 offset:37888
v_mfma_f32_16x16x32_bf16 v[24:27], a[80:83], a[60:63], v[24:27]
ds_read_b128 a[120:123], v37 offset:38912
v_mfma_f32_16x16x32_bf16 v[28:31], a[84:87], a[60:63], v[28:31]
ds_read_b128 a[124:127], v37 offset:39936
v_mfma_f32_16x16x32_bf16 v[32:35], a[88:91], a[60:63], v[32:35]
ds_read_b128 a[128:131], v38 offset:36864
s_waitcnt vmcnt(2) lgkmcnt(5)
v_mfma_f32_16x16x32_bf16 v[16:19], a[92:95], a[64:67], v[16:19]
v_mfma_f32_16x16x32_bf16 v[20:23], a[96:99], a[64:67], v[20:23]
v_mfma_f32_16x16x32_bf16 v[24:27], a[100:103], a[64:67], v[24:27]
v_mfma_f32_16x16x32_bf16 v[28:31], a[104:107], a[64:67], v[28:31]
v_mfma_f32_16x16x32_bf16 v[32:35], a[108:111], a[64:67], v[32:35]
s_waitcnt vmcnt(0) lgkmcnt(0)
v_mfma_f32_16x16x32_bf16 v[16:19], a[112:115], a[68:71], v[16:19]
v_mfma_f32_16x16x32_bf16 v[20:23], a[116:119], a[68:71], v[20:23]
v_mfma_f32_16x16x32_bf16 v[24:27], a[120:123], a[68:71], v[24:27]
v_mfma_f32_16x16x32_bf16 v[28:31], a[124:127], a[68:71], v[28:31]
v_mfma_f32_16x16x32_bf16 v[32:35], a[128:131], a[68:71], v[32:35]
s_nop 3
v_pk_add_f32 v[62:63], v[16:17], v[18:19]
v_pk_mul_f32 v[64:65], v[16:17], v[16:17]
v_pk_fma_f32 v[64:65], v[18:19], v[18:19], v[64:65]
v_pk_add_f32 v[62:63], v[62:63], v[20:21]
v_pk_fma_f32 v[64:65], v[20:21], v[20:21], v[64:65]
v_pk_add_f32 v[62:63], v[62:63], v[22:23]
v_pk_fma_f32 v[64:65], v[22:23], v[22:23], v[64:65]
v_pk_add_f32 v[62:63], v[62:63], v[24:25]
v_pk_fma_f32 v[64:65], v[24:25], v[24:25], v[64:65]
v_pk_add_f32 v[62:63], v[62:63], v[26:27]
v_pk_fma_f32 v[64:65], v[26:27], v[26:27], v[64:65]
v_pk_add_f32 v[62:63], v[62:63], v[28:29]
v_pk_fma_f32 v[64:65], v[28:29], v[28:29], v[64:65]
v_pk_add_f32 v[62:63], v[62:63], v[30:31]
v_pk_fma_f32 v[64:65], v[30:31], v[30:31], v[64:65]
s_mov_b32 exec_hi, 0
v_pk_add_f32 v[62:63], v[62:63], v[32:33]
v_pk_fma_f32 v[64:65], v[32:33], v[32:33], v[64:65]
v_pk_add_f32 v[62:63], v[62:63], v[34:35]
v_pk_fma_f32 v[64:65], v[34:35], v[34:35], v[64:65]
s_mov_b64 exec, -1
v_add_f32 v56, v62, v63
v_add_f32 v57, v64, v65
v_cvt_pk_bf16_f32 v52, v32, v33
v_cvt_pk_bf16_f32 v53, v34, v35
v_permlane32_swap_b32 v56, v57
v_add_f32 v56, v56, v57
v_mov_b32 v57, v56
v_cvt_pk_bf16_f32 v44, v16, v17
v_cvt_pk_bf16_f32 v45, v18, v19
v_permlane16_swap_b32 v56, v57
v_add_f32 v56, v56, v57
v_mov_b32 v57, v56
v_cvt_pk_bf16_f32 v46, v20, v21
v_cvt_pk_bf16_f32 v47, v22, v23
v_permlane32_swap_b32 v56, v57
buffer_store_dwordx4 v[44:47], v60, s[8:11], s62 offen sc1
buffer_store_dwordx2 v[56:57], v58, s[8:11], s63 offen sc1
v_cvt_pk_bf16_f32 v48, v24, v25
v_cvt_pk_bf16_f32 v49, v26, v27
v_cvt_pk_bf16_f32 v50, v28, v29
v_cvt_pk_bf16_f32 v51, v30, v31
v_permlane16_swap_b32 v52, v54
v_permlane16_swap_b32 v53, v55
buffer_store_dwordx4 v[48:51], v60, s[8:11], s62 offen offset:1024 sc1
buffer_store_dwordx4 v[52:55], v61, s[8:11], s62 offen sc1
s_barrier
s_mul_i32 s38, s24, 9216
s_add_u32 m0, s38, 37888
s_add_u32 s39, s38, s82
s_add_u32 s39, s39, 75776
buffer_load_dwordx4 v1, s[4:7], s39 offen offset:0 sc1 lds
buffer_load_dwordx4 v1, s[4:7], s39 offen offset:1024 sc1 lds
buffer_load_dwordx4 v1, s[4:7], s39 offen offset:2048 sc1 lds
buffer_load_dwordx4 v1, s[4:7], s39 offen offset:3072 sc1 lds
s_add_u32 m0, m0, 4096
s_add_u32 s39, s39, 4096
buffer_load_dwordx4 v1, s[4:7], s39 offen offset:0 sc1 lds
buffer_load_dwordx4 v1, s[4:7], s39 offen offset:1024 sc1 lds
buffer_load_dwordx4 v1, s[4:7], s39 offen offset:2048 sc1 lds
v_lshlrev_b32 v7, 3, v1
s_lshr_b32 s31, s81, 4
s_lshl_b32 s31, s31, 11
v_add_u32 v7, s31, v7
s_cmp_eq_u32 s24, 0
s_cselect_b32 s30, 0, 1073741824
s_add_u32 s30, s30, 26509312
s_waitcnt vmcnt(7)
s_barrier
s_mov_b64 exec, 0xffff
buffer_atomic_add v4, v7, s[8:11], s30 offen sc1
s_mov_b64 exec, -1
s_lshl_b32 s35, s80, 7
s_add_u32 s35, s35, 26509312
s_cmp_eq_u32 s24, 1
s_cselect_b32 s35, s35, 1073741824
v_mov_b32 v6, 0
v_mov_b32 v244, 0
v_mov_b32 v245, 0
v_mov_b32 v246, 0
buffer_load_dwordx4 v1, s[4:7], s39 offen offset:3072 sc1 lds
s_add_u32 m0, m0, 4096
s_add_u32 s39, s39, 4096
buffer_load_dwordx4 v1, s[4:7], s39 offen offset:0 sc1 lds
s_lshl_b32 s38, s24, 8
s_add_u32 m0, s38, 74752
s_add_u32 s39, s38, s82
s_add_u32 s39, s39, 112640
s_mov_b64 exec, 0xffff
buffer_load_dwordx4 v1, s[4:7], s39 offen sc1 lds
s_mov_b64 exec, -1
s_mul_i32 s38, s24, 9216
s_add_u32 m0, s38, 75776
s_add_u32 s39, s38, s82
s_add_u32 s39, s39, 113664
buffer_load_dwordx4 v1, s[4:7], s39 offen offset:0 sc1 lds
s_mov_b64 exec, 1
buffer_atomic_add v244, v6, s[8:11], s35 offen sc0 sc1
s_mov_b64 exec, -1
buffer_load_dwordx4 v1, s[4:7], s39 offen offset:1024 sc1 lds
buffer_load_dwordx4 v1, s[4:7], s39 offen offset:2048 sc1 lds
buffer_load_dwordx4 v1, s[4:7], s39 offen offset:3072 sc1 lds
s_add_u32 m0, m0, 4096
s_add_u32 s39, s39, 4096
s_mov_b64 exec, 1
buffer_atomic_add v245, v6, s[8:11], s35 offen sc0 sc1
s_mov_b64 exec, -1
buffer_load_dwordx4 v1, s[4:7], s39 offen offset:0 sc1 lds
buffer_load_dwordx4 v1, s[4:7], s39 offen offset:1024 sc1 lds
buffer_load_dwordx4 v1, s[4:7], s39 offen offset:2048 sc1 lds
s_mov_b64 exec, 1
buffer_atomic_add v246, v6, s[8:11], s35 offen sc0 sc1
s_mov_b64 exec, -1
buffer_load_dwordx4 v1, s[4:7], s39 offen offset:3072 sc1 lds
s_add_u32 m0, m0, 4096
s_add_u32 s39, s39, 4096
buffer_load_dwordx4 v1, s[4:7], s39 offen offset:0 sc1 lds
s_lshl_b32 s38, s24, 8
s_add_u32 m0, s38, 112640
s_add_u32 s39, s38, s82
s_add_u32 s39, s39, 150528
s_mov_b64 exec, 0xffff
buffer_load_dwordx4 v1, s[4:7], s39 offen sc1 lds
s_mov_b64 exec, -1
s_lshl_b32 s60, s25, 2
s_add_u32 s60, s60, s24
s_mul_i32 s62, s60, 36864
s_add_u32 s62, s62, 4849664
v_add_u32 v180, 18432, v1
s_cmp_eq_u32 s24, 1
s_cbranch_scc0 L_other_20
s_mov_b32 s31, 0
s_mov_b64 exec, 1
v_mov_b32 v247, 0
buffer_atomic_add v247, v6, s[8:11], s35 offen sc0 sc1
s_waitcnt vmcnt(12)
v_cmp_gt_u32 vcc, 16, v244
s_nop 0
s_cbranch_vccz L_polled_19
s_waitcnt vmcnt(8)
v_cmp_gt_u32 vcc, 16, v245
s_nop 0
s_cbranch_vccz L_polled_19
v_mov_b32 v244, 0
buffer_atomic_add v244, v6, s[8:11], s35 offen sc0 sc1
s_waitcnt vmcnt(5)
v_cmp_gt_u32 vcc, 16, v246
s_nop 0
s_cbranch_vccz L_polled_19
v_mov_b32 v245, 0
buffer_atomic_add v245, v6, s[8:11], s35 offen sc0 sc1
L_poll_18:
s_add_u32 s31, s31, 1
s_cmp_gt_u32 s31, 100000
s_cbranch_scc1 L_polled_19
v_mov_b32 v246, 0
buffer_atomic_add v246, v6, s[8:11], s35 offen sc0 sc1
s_waitcnt vmcnt(3)
v_cmp_gt_u32 vcc, 16, v247
s_nop 0
s_cbranch_vccz L_polled_19
v_mov_b32 v247, 0
buffer_atomic_add v247, v6, s[8:11], s35 offen sc0 sc1
s_waitcnt vmcnt(3)
v_cmp_gt_u32 vcc, 16, v244
s_nop 0
s_cbranch_vccz L_polled_19
v_mov_b32 v244, 0
buffer_atomic_add v244, v6, s[8:11], s35 offen sc0 sc1
s_waitcnt vmcnt(3)
v_cmp_gt_u32 vcc, 16, v245
s_nop 0
s_cbranch_vccz L_polled_19
v_mov_b32 v245, 0
buffer_atomic_add v245, v6, s[8:11], s35 offen sc0 sc1
s_waitcnt vmcnt(3)
v_cmp_gt_u32 vcc, 16, v246
s_nop 0
s_cbranch_vccz L_polled_19
s_branch L_poll_18
L_polled_19:
s_mov_b64 exec, -1
L_other_20:
s_barrier
buffer_load_dwordx4 a[0:3], v1, s[8:11], s62 offen offset:0 sc1
buffer_load_dwordx4 a[4:7], v180, s[8:11], s62 offen offset:0 sc1
s_barrier
buffer_load_dwordx4 a[8:11], v1, s[8:11], s62 offen offset:1024 sc1
buffer_load_dwordx4 a[12:15], v180, s[8:11], s62 offen offset:1024 sc1
s_barrier
buffer_load_dwordx4 a[16:19], v1, s[8:11], s62 offen offset:2048 sc1
buffer_load_dwordx4 a[20:23], v180, s[8:11], s62 offen offset:2048 sc1
s_barrier
buffer_load_dwordx4 a[24:27], v1, s[8:11], s62 offen offset:3072 sc1
buffer_load_dwordx4 a[28:31], v180, s[8:11], s62 offen offset:3072 sc1
s_barrier
s_add_u32 s62, s62, 4096
buffer_load_dwordx4 a[32:35], v1, s[8:11], s62 offen offset:0 sc1
buffer_load_dwordx4 a[36:39], v180, s[8:11], s62 offen offset:0 sc1
s_barrier
buffer_load_dwordx4 a[40:43], v1, s[8:11], s62 offen offset:1024 sc1
buffer_load_dwordx4 a[44:47], v180, s[8:11], s62 offen offset:1024 sc1
s_lshl_b32 s53, s25, 2
s_add_u32 s53, s53, s24
s_mul_i32 s53, s53, 133120
s_add_u32 s53, s53, 10895360
s_lshl_b32 s52, s25, 12
s_add_u32 s52, s52, s53
v_lshrrev_b32 v239, 1, v1
v_and_b32 v6, 0xf8, v239
v_lshrrev_b32 v7, 1, v3
v_lshl_add_u32 v232, v7, 16, v6
s_lshl_b32 s63, s60, 8
s_add_u32 s63, s63, 7208960
v_add_u32 v208, 123904, v1
v_add_u32 v209, 0, v1
v_add_u32 v210, 37888, v1
v_add_u32 v211, 75776, v1
ds_read_b128 a[144:147], v208 offset:0
ds_read_b128 a[148:151], v208 offset:18432
ds_read_b128 a[152:155], v209 offset:0
ds_read_b128 a[156:159], v209 offset:18432
ds_read_b128 a[160:163], v208 offset:1024
ds_read_b128 a[164:167], v208 offset:19456
s_waitcnt vmcnt(10) lgkmcnt(4)
v_mfma_f32_16x16x32_bf16 v[36:39], a[144:147], a[0:3], 0
ds_read_b128 a[168:171], v209 offset:1024
ds_read_b128 a[172:175], v209 offset:19456
v_mfma_f32_16x16x32_bf16 v[40:43], a[144:147], a[4:7], 0
buffer_load_dwordx4 a[48:51], v1, s[8:11], s62 offen offset:2048 sc1
v_mfma_f32_16x16x32_bf16 v[44:47], a[148:151], a[0:3], 0
buffer_load_dwordx4 a[52:55], v180, s[8:11], s62 offen offset:2048 sc1
v_mfma_f32_16x16x32_bf16 v[48:51], a[148:151], a[4:7], 0
s_waitcnt lgkmcnt(4)
v_mfma_f32_16x16x32_bf16 v[52:55], a[152:155], a[0:3], 0
ds_read_b128 a[144:147], v208 offset:2048
ds_read_b128 a[148:151], v208 offset:20480
v_mfma_f32_16x16x32_bf16 v[56:59], a[152:155], a[4:7], 0
buffer_load_dwordx4 a[56:59], v1, s[8:11], s62 offen offset:3072 sc1
v_lshl_add_u32 v234, v7, 13, v6
v_mfma_f32_16x16x32_bf16 v[60:63], a[156:159], a[0:3], 0
v_add_u32 v235, 4096, v234
v_mfma_f32_16x16x32_bf16 v[64:67], a[156:159], a[4:7], 0
s_waitcnt vmcnt(11) lgkmcnt(4)
s_barrier
v_mfma_f32_16x16x32_bf16 v[36:39], a[160:163], a[8:11], v[36:39]
ds_read_b128 a[152:155], v209 offset:2048
ds_read_b128 a[156:159], v209 offset:20480
v_mfma_f32_16x16x32_bf16 v[40:43], a[160:163], a[12:15], v[40:43]
buffer_load_dwordx4 a[60:63], v180, s[8:11], s62 offen offset:3072 sc1
s_mul_i32 s30, s24, 9216
v_mfma_f32_16x16x32_bf16 v[44:47], a[164:167], a[8:11], v[44:47]
s_add_u32 s62, s62, 4096
v_mfma_f32_16x16x32_bf16 v[48:51], a[164:167], a[12:15], v[48:51]
s_waitcnt lgkmcnt(4)
s_add_u32 s30, s30, 0
v_mfma_f32_16x16x32_bf16 v[52:55], a[168:171], a[8:11], v[52:55]
ds_read_b128 a[160:163], v208 offset:3072
ds_read_b128 a[164:167], v208 offset:21504
v_mfma_f32_16x16x32_bf16 v[56:59], a[168:171], a[12:15], v[56:59]
buffer_load_dwordx4 a[64:67], v1, s[8:11], s62 offen offset:0 sc1
v_mul_u32_u24 v236, 288, v2
v_mfma_f32_16x16x32_bf16 v[60:63], a[172:175], a[8:11], v[60:63]
v_mfma_f32_16x16x32_bf16 v[64:67], a[172:175], a[12:15], v[64:67]
s_waitcnt lgkmcnt(4)
v_add_u32 v236, s30, v236
s_waitcnt vmcnt(11)
v_mfma_f32_16x16x32_bf16 v[36:39], a[144:147], a[16:19], v[36:39]
ds_read_b128 a[168:171], v209 offset:3072
ds_read_b128 a[172:175], v209 offset:21504
v_mfma_f32_16x16x32_bf16 v[40:43], a[144:147], a[20:23], v[40:43]
buffer_load_dwordx2 v[182:183], v232, s[8:11], s63 offen sc1
v_mfma_f32_16x16x32_bf16 v[44:47], a[148:151], a[16:19], v[44:47]
s_add_u32 s63, s63, 16384
v_lshl_add_u32 v7, v3, 3, v236
v_mfma_f32_16x16x32_bf16 v[48:51], a[148:151], a[20:23], v[48:51]
s_waitcnt lgkmcnt(4)
v_mfma_f32_16x16x32_bf16 v[52:55], a[152:155], a[16:19], v[52:55]
ds_read_b128 a[144:147], v208 offset:4096
ds_read_b128 a[148:151], v208 offset:22528
v_mfma_f32_16x16x32_bf16 v[56:59], a[152:155], a[20:23], v[56:59]
v_lshl_add_u32 v236, v3, 4, v236
v_mfma_f32_16x16x32_bf16 v[60:63], a[156:159], a[16:19], v[60:63]
buffer_load_dwordx2 v[184:185], v232, s[8:11], s63 offen sc1
v_lshrrev_b32 v8, 2, v2
v_mfma_f32_16x16x32_bf16 v[64:67], a[156:159], a[20:23], v[64:67]
s_waitcnt vmcnt(11) lgkmcnt(4)
v_mfma_f32_16x16x32_bf16 v[36:39], a[160:163], a[24:27], v[36:39]
ds_read_b128 a[152:155], v209 offset:4096
ds_read_b128 a[156:159], v209 offset:22528
v_mfma_f32_16x16x32_bf16 v[40:43], a[160:163], a[28:31], v[40:43]
s_add_u32 s63, s63, 16384
v_lshl_add_u32 v8, v3, 3, v8
v_mfma_f32_16x16x32_bf16 v[44:47], a[164:167], a[24:27], v[44:47]
v_mfma_f32_16x16x32_bf16 v[48:51], a[164:167], a[28:31], v[48:51]
s_waitcnt lgkmcnt(4)
v_mul_u32_u24 v237, 288, v8
v_mfma_f32_16x16x32_bf16 v[52:55], a[168:171], a[24:27], v[52:55]
ds_read_b128 a[160:163], v208 offset:5120
ds_read_b128 a[164:167], v208 offset:23552
v_mfma_f32_16x16x32_bf16 v[56:59], a[168:171], a[28:31], v[56:59]
buffer_load_dwordx2 v[186:187], v232, s[8:11], s63 offen sc1
v_add_u32 v237, s30, v237
v_mfma_f32_16x16x32_bf16 v[60:63], a[172:175], a[24:27], v[60:63]
s_add_u32 s63, s63, 16384
v_mfma_f32_16x16x32_bf16 v[64:67], a[172:175], a[28:31], v[64:67]
s_waitcnt vmcnt(10) lgkmcnt(4)
v_mfma_f32_16x16x32_bf16 v[36:39], a[144:147], a[32:35], v[36:39]
ds_read_b128 a[168:171], v209 offset:5120
ds_read_b128 a[172:175], v209 offset:23552
v_mfma_f32_16x16x32_bf16 v[40:43], a[144:147], a[36:39], v[40:43]
buffer_load_dwordx2 v[188:189], v232, s[8:11], s63 offen sc1
v_and_b32 v8, 3, v2
v_mfma_f32_16x16x32_bf16 v[44:47], a[148:151], a[32:35], v[44:47]
s_add_u32 s63, s63, 16384
v_lshl_add_u32 v238, v8, 3, v237
v_mfma_f32_16x16x32_bf16 v[48:51], a[148:151], a[36:39], v[48:51]
s_waitcnt lgkmcnt(4)
v_mfma_f32_16x16x32_bf16 v[52:55], a[152:155], a[32:35], v[52:55]
ds_read_b128 a[144:147], v208 offset:6144
ds_read_b128 a[148:151], v208 offset:24576
v_mfma_f32_16x16x32_bf16 v[56:59], a[152:155], a[36:39], v[56:59]
v_lshl_add_u32 v237, v8, 4, v237
v_mfma_f32_16x16x32_bf16 v[60:63], a[156:159], a[32:35], v[60:63]
buffer_load_dwordx4 a[68:71], v180, s[8:11], s62 offen offset:0 sc1
v_mfma_f32_16x16x32_bf16 v[64:67], a[156:159], a[36:39], v[64:67]
s_waitcnt lgkmcnt(4)
s_mul_i32 s66, s26, 589824
s_waitcnt vmcnt(10)
v_mfma_f32_16x16x32_bf16 v[36:39], a[160:163], a[40:43], v[36:39]
ds_read_b128 a[152:155], v209 offset:6144
ds_read_b128 a[156:159], v209 offset:24576
v_mfma_f32_16x16x32_bf16 v[40:43], a[160:163], a[44:47], v[40:43]
buffer_load_dwordx4 a[72:75], v1, s[8:11], s62 offen offset:1024 sc1
s_mul_i32 s31, s60, 9216
v_mfma_f32_16x16x32_bf16 v[44:47], a[164:167], a[40:43], v[44:47]
s_add_u32 s66, s66, s31
v_mfma_f32_16x16x32_bf16 v[48:51], a[164:167], a[44:47], v[48:51]
s_waitcnt lgkmcnt(4)
v_mfma_f32_16x16x32_bf16 v[52:55], a[168:171], a[40:43], v[52:55]
ds_read_b128 a[160:163], v208 offset:7168
ds_read_b128 a[164:167], v208 offset:25600
v_mfma_f32_16x16x32_bf16 v[56:59], a[168:171], a[44:47], v[56:59]
buffer_load_dwordx4 a[76:79], v180, s[8:11], s62 offen offset:1024 sc1
v_mfma_f32_16x16x32_bf16 v[60:63], a[172:175], a[40:43], v[60:63]
s_add_u32 s66, s66, 7340032
v_mfma_f32_16x16x32_bf16 v[64:67], a[172:175], a[44:47], v[64:67]
s_waitcnt vmcnt(10) lgkmcnt(4)
v_mfma_f32_16x16x32_bf16 v[36:39], a[144:147], a[48:51], v[36:39]
ds_read_b128 a[168:171], v209 offset:7168
ds_read_b128 a[172:175], v209 offset:25600
v_mfma_f32_16x16x32_bf16 v[40:43], a[144:147], a[52:55], v[40:43]
buffer_load_dwordx4 a[80:83], v1, s[8:11], s62 offen offset:2048 sc1
v_lshlrev_b32 v233, 7, v1
v_mfma_f32_16x16x32_bf16 v[44:47], a[148:151], a[48:51], v[44:47]
buffer_load_dwordx4 a[84:87], v180, s[8:11], s62 offen offset:2048 sc1
v_mfma_f32_16x16x32_bf16 v[48:51], a[148:151], a[52:55], v[48:51]
s_waitcnt lgkmcnt(4)
s_lshl_b32 s31, s26, 7
v_mfma_f32_16x16x32_bf16 v[52:55], a[152:155], a[48:51], v[52:55]
ds_read_b128 a[144:147], v208 offset:8192
ds_read_b128 a[148:151], v208 offset:26624
v_mfma_f32_16x16x32_bf16 v[56:59], a[152:155], a[52:55], v[56:59]
buffer_load_dwordx4 a[88:91], v1, s[8:11], s62 offen offset:3072 sc1
v_add_u32 v233, s31, v233
v_mfma_f32_16x16x32_bf16 v[60:63], a[156:159], a[48:51], v[60:63]
s_lshl_b32 s61, s25, 14
v_mfma_f32_16x16x32_bf16 v[64:67], a[156:159], a[52:55], v[64:67]
s_waitcnt vmcnt(11) lgkmcnt(4)
v_mfma_f32_16x16x32_bf16 v[36:39], a[160:163], a[56:59], v[36:39]
ds_read_b128 a[152:155], v209 offset:8192
ds_read_b128 a[156:159], v209 offset:26624
v_mfma_f32_16x16x32_bf16 v[40:43], a[160:163], a[60:63], v[40:43]
buffer_load_dwordx4 a[92:95], v180, s[8:11], s62 offen offset:3072 sc1
v_mfma_f32_16x16x32_bf16 v[44:47], a[164:167], a[56:59], v[44:47]
s_add_u32 s62, s62, 4096
s_lshl_b32 s30, s24, 8
v_mfma_f32_16x16x32_bf16 v[48:51], a[164:167], a[60:63], v[48:51]
s_waitcnt lgkmcnt(4)
v_mfma_f32_16x16x32_bf16 v[52:55], a[168:171], a[56:59], v[52:55]
ds_read_b128 a[160:163], v208 offset:9216
ds_read_b128 a[164:167], v208 offset:27648
v_mfma_f32_16x16x32_bf16 v[56:59], a[168:171], a[60:63], v[56:59]
buffer_load_dwordx4 a[96:99], v1, s[8:11], s62 offen offset:0 sc1
s_add_u32 s61, s61, s30
v_mfma_f32_16x16x32_bf16 v[60:63], a[172:175], a[56:59], v[60:63]
s_add_u32 s61, s61, 26214400
v_mfma_f32_16x16x32_bf16 v[64:67], a[172:175], a[60:63], v[64:67]
s_waitcnt vmcnt(7) lgkmcnt(4)
v_mfma_f32_16x16x32_bf16 v[36:39], a[144:147], a[64:67], v[36:39]
ds_read_b128 a[168:171], v209 offset:9216
ds_read_b128 a[172:175], v209 offset:27648
v_mfma_f32_16x16x32_bf16 v[40:43], a[144:147], a[68:71], v[40:43]
buffer_load_dwordx4 a[100:103], v180, s[8:11], s62 offen offset:0 sc1
s_mul_i32 s30, s24, 9216
v_mfma_f32_16x16x32_bf16 v[44:47], a[148:151], a[64:67], v[44:47]
buffer_load_dwordx4 a[104:107], v1, s[8:11], s62 offen offset:1024 sc1
v_mfma_f32_16x16x32_bf16 v[48:51], a[148:151], a[68:71], v[48:51]
s_waitcnt lgkmcnt(4)
s_add_u32 s30, s30, 0
v_mfma_f32_16x16x32_bf16 v[52:55], a[152:155], a[64:67], v[52:55]
ds_read_b128 a[144:147], v208 offset:10240
ds_read_b128 a[148:151], v208 offset:28672
v_mfma_f32_16x16x32_bf16 v[56:59], a[152:155], a[68:71], v[56:59]
buffer_load_dwordx4 a[108:111], v180, s[8:11], s62 offen offset:1024 sc1
v_add_u32 v240, s30, v1
v_mfma_f32_16x16x32_bf16 v[60:63], a[156:159], a[64:67], v[60:63]
s_lshl_b32 s30, s26, 10
v_mfma_f32_16x16x32_bf16 v[64:67], a[156:159], a[68:71], v[64:67]
s_waitcnt vmcnt(8) lgkmcnt(4)
v_mfma_f32_16x16x32_bf16 v[36:39], a[160:163], a[72:75], v[36:39]
ds_read_b128 a[152:155], v209 offset:10240
ds_read_b128 a[156:159], v209 offset:28672
v_mfma_f32_16x16x32_bf16 v[40:43], a[160:163], a[76:79], v[40:43]
buffer_load_dwordx4 a[112:115], v1, s[8:11], s62 offen offset:2048 sc1
v_mfma_f32_16x16x32_bf16 v[44:47], a[164:167], a[72:75], v[44:47]
buffer_load_dwordx4 a[116:119], v180, s[8:11], s62 offen offset:2048 sc1
s_add_u32 s30, s30, s61
v_mfma_f32_16x16x32_bf16 v[48:51], a[164:167], a[76:79], v[48:51]
s_waitcnt lgkmcnt(4)
v_mfma_f32_16x16x32_bf16 v[52:55], a[168:171], a[72:75], v[52:55]
ds_read_b128 a[160:163], v208 offset:11264
ds_read_b128 a[164:167], v208 offset:29696
v_mfma_f32_16x16x32_bf16 v[56:59], a[168:171], a[76:79], v[56:59]
buffer_load_dwordx4 a[120:123], v1, s[8:11], s62 offen offset:3072 sc1
v_mfma_f32_16x16x32_bf16 v[60:63], a[172:175], a[72:75], v[60:63]
v_mfma_f32_16x16x32_bf16 v[64:67], a[172:175], a[76:79], v[64:67]
s_waitcnt vmcnt(9) lgkmcnt(4)
v_mfma_f32_16x16x32_bf16 v[36:39], a[144:147], a[80:83], v[36:39]
ds_read_b128 a[168:171], v209 offset:11264
ds_read_b128 a[172:175], v209 offset:29696
v_mfma_f32_16x16x32_bf16 v[40:43], a[144:147], a[84:87], v[40:43]
buffer_load_dwordx4 a[124:127], v180, s[8:11], s62 offen offset:3072 sc1
v_mfma_f32_16x16x32_bf16 v[44:47], a[148:151], a[80:83], v[44:47]
s_add_u32 s62, s62, 4096
v_add_f32 v198, v182, v184
v_add_f32 v199, v183, v185
v_mfma_f32_16x16x32_bf16 v[48:51], a[148:151], a[84:87], v[48:51]
s_waitcnt lgkmcnt(4)
v_add_f32 v198, v198, v186
v_mfma_f32_16x16x32_bf16 v[52:55], a[152:155], a[80:83], v[52:55]
ds_read_b128 a[144:147], v208 offset:12288
ds_read_b128 a[148:151], v208 offset:30720
v_mfma_f32_16x16x32_bf16 v[56:59], a[152:155], a[84:87], v[56:59]
buffer_load_dwordx4 a[128:131], v1, s[8:11], s62 offen offset:0 sc1
v_add_f32 v199, v199, v187
v_mfma_f32_16x16x32_bf16 v[60:63], a[156:159], a[80:83], v[60:63]
v_add_f32 v198, v198, v188
v_mfma_f32_16x16x32_bf16 v[64:67], a[156:159], a[84:87], v[64:67]
s_waitcnt lgkmcnt(4)
v_add_f32 v199, v199, v189
s_waitcnt vmcnt(9)
v_mfma_f32_16x16x32_bf16 v[36:39], a[160:163], a[88:91], v[36:39]
ds_read_b128 a[152:155], v209 offset:12288
ds_read_b128 a[156:159], v209 offset:30720
v_mfma_f32_16x16x32_bf16 v[40:43], a[160:163], a[92:95], v[40:43]
buffer_load_dwordx4 a[132:135], v180, s[8:11], s62 offen offset:0 sc1
v_mov_b32 v200, v198
v_mfma_f32_16x16x32_bf16 v[44:47], a[164:167], a[88:91], v[44:47]
v_mov_b32 v201, v199
v_mfma_f32_16x16x32_bf16 v[48:51], a[164:167], a[92:95], v[48:51]
s_waitcnt lgkmcnt(4)
s_nop 0
v_mfma_f32_16x16x32_bf16 v[52:55], a[168:171], a[88:91], v[52:55]
ds_read_b128 a[160:163], v208 offset:13312
ds_read_b128 a[164:167], v208 offset:31744
v_mfma_f32_16x16x32_bf16 v[56:59], a[168:171], a[92:95], v[56:59]
buffer_load_dwordx4 a[136:139], v1, s[8:11], s62 offen offset:1024 sc1
v_mfma_f32_16x16x32_bf16 v[60:63], a[172:175], a[88:91], v[60:63]
buffer_load_dwordx4 a[140:143], v180, s[8:11], s62 offen offset:1024 sc1
v_mfma_f32_16x16x32_bf16 v[64:67], a[172:175], a[92:95], v[64:67]
s_waitcnt vmcnt(10) lgkmcnt(4)
v_mfma_f32_16x16x32_bf16 v[36:39], a[144:147], a[96:99], v[36:39]
ds_read_b128 a[168:171], v209 offset:13312
ds_read_b128 a[172:175], v209 offset:31744
v_mfma_f32_16x16x32_bf16 v[40:43], a[144:147], a[100:103], v[40:43]
v_permlane32_swap_b32 v198, v200
v_mfma_f32_16x16x32_bf16 v[44:47], a[148:151], a[96:99], v[44:47]
v_permlane32_swap_b32 v199, v201
v_mfma_f32_16x16x32_bf16 v[48:51], a[148:151], a[100:103], v[48:51]
s_waitcnt lgkmcnt(4)
v_add_f32 v198, v198, v200
v_add_f32 v199, v199, v201
v_mfma_f32_16x16x32_bf16 v[52:55], a[152:155], a[96:99], v[52:55]
ds_read_b128 a[144:147], v208 offset:14336
ds_read_b128 a[148:151], v208 offset:32768
v_mfma_f32_16x16x32_bf16 v[56:59], a[152:155], a[100:103], v[56:59]
v_mul_f32 v198, 0x3ae38e39, v198
v_mul_f32 v200, v198, v198
v_mfma_f32_16x16x32_bf16 v[60:63], a[156:159], a[96:99], v[60:63]
v_mul_f32 v199, 0x3ae38e39, v199
v_mfma_f32_16x16x32_bf16 v[64:67], a[156:159], a[100:103], v[64:67]
s_waitcnt vmcnt(8) lgkmcnt(4)
v_mfma_f32_16x16x32_bf16 v[36:39], a[160:163], a[104:107], v[36:39]
ds_read_b128 a[152:155], v209 offset:14336
ds_read_b128 a[156:159], v209 offset:32768
v_mfma_f32_16x16x32_bf16 v[40:43], a[160:163], a[108:111], v[40:43]
v_sub_f32 v199, v199, v200
v_max_f32 v199, 0, v199
v_mfma_f32_16x16x32_bf16 v[44:47], a[164:167], a[104:107], v[44:47]
v_add_f32 v199, 0x3727c5ac, v199
v_mfma_f32_16x16x32_bf16 v[48:51], a[164:167], a[108:111], v[48:51]
s_waitcnt lgkmcnt(4)
v_rsq_f32 v250, v199
v_mfma_f32_16x16x32_bf16 v[52:55], a[168:171], a[104:107], v[52:55]
ds_read_b128 a[160:163], v208 offset:15360
ds_read_b128 a[164:167], v208 offset:33792
v_mfma_f32_16x16x32_bf16 v[56:59], a[168:171], a[108:111], v[56:59]
v_mfma_f32_16x16x32_bf16 v[60:63], a[172:175], a[104:107], v[60:63]
v_sqrt_f32 v254, v199
v_mfma_f32_16x16x32_bf16 v[64:67], a[172:175], a[108:111], v[64:67]
s_waitcnt vmcnt(6) lgkmcnt(4)
v_mfma_f32_16x16x32_bf16 v[36:39], a[144:147], a[112:115], v[36:39]
ds_read_b128 a[168:171], v209 offset:15360
ds_read_b128 a[172:175], v209 offset:33792
v_mfma_f32_16x16x32_bf16 v[40:43], a[144:147], a[116:119], v[40:43]
v_cvt_pk_bf16_f32 v200, -v198, -v198
v_mfma_f32_16x16x32_bf16 v[44:47], a[148:151], a[112:115], v[44:47]
v_and_b32 v200, 0xffff0000, v200
v_mfma_f32_16x16x32_bf16 v[48:51], a[148:151], a[116:119], v[48:51]
s_waitcnt lgkmcnt(4)
v_add_f32 v200, v198, v200
v_mfma_f32_16x16x32_bf16 v[52:55], a[152:155], a[112:115], v[52:55]
ds_read_b128 a[144:147], v208 offset:16384
ds_read_b128 a[148:151], v208 offset:34816
v_mfma_f32_16x16x32_bf16 v[56:59], a[152:155], a[116:119], v[56:59]
v_cvt_pk_bf16_f32 v212, -v198, -v200
v_mfma_f32_16x16x32_bf16 v[60:63], a[156:159], a[112:115], v[60:63]
v_mul_f32 v252, v250, v250
v_mfma_f32_16x16x32_bf16 v[64:67], a[156:159], a[116:119], v[64:67]
s_waitcnt lgkmcnt(4)
v_mul_f32 v252, v252, v250
s_waitcnt vmcnt(4)
v_mfma_f32_16x16x32_bf16 v[36:39], a[160:163], a[120:123], v[36:39]
ds_read_b128 a[152:155], v209 offset:16384
ds_read_b128 a[156:159], v209 offset:34816
v_mfma_f32_16x16x32_bf16 v[40:43], a[160:163], a[124:127], v[40:43]
v_mul_f32 v252, 0xbdd2d3e8, v252
v_mul_f32 v250, 0xc0135761, v250
v_mfma_f32_16x16x32_bf16 v[44:47], a[164:167], a[120:123], v[44:47]
v_mfma_f32_16x16x32_bf16 v[48:51], a[164:167], a[124:127], v[48:51]
s_waitcnt lgkmcnt(4)
v_mov_b32 v214, v212
v_mfma_f32_16x16x32_bf16 v[52:55], a[168:171], a[120:123], v[52:55]
ds_read_b128 a[160:163], v208 offset:17408
ds_read_b128 a[164:167], v208 offset:35840
v_mfma_f32_16x16x32_bf16 v[56:59], a[168:171], a[124:127], v[56:59]
v_mov_b32 v255, v254
v_mov_b32 v253, v252
v_mfma_f32_16x16x32_bf16 v[60:63], a[172:175], a[120:123], v[60:63]
v_mfma_f32_16x16x32_bf16 v[64:67], a[172:175], a[124:127], v[64:67]
s_waitcnt lgkmcnt(4)
v_mov_b32 v251, v250
s_waitcnt vmcnt(2)
v_mfma_f32_16x16x32_bf16 v[36:39], a[144:147], a[128:131], v[36:39]
ds_read_b128 a[168:171], v209 offset:17408
ds_read_b128 a[172:175], v209 offset:35840
v_mfma_f32_16x16x32_bf16 v[40:43], a[144:147], a[132:135], v[40:43]
v_permlane16_swap_b32 v212, v214
v_mfma_f32_16x16x32_bf16 v[44:47], a[148:151], a[128:131], v[44:47]
v_permlane16_swap_b32 v254, v255
v_mfma_f32_16x16x32_bf16 v[48:51], a[148:151], a[132:135], v[48:51]
s_waitcnt lgkmcnt(4)
v_add_u32 v181, 160768, v239
v_mfma_f32_16x16x32_bf16 v[52:55], a[152:155], a[128:131], v[52:55]
ds_read_b64 a[144:145], v181 offset:0
ds_read_b64 a[148:149], v181 offset:512
v_mfma_f32_16x16x32_bf16 v[56:59], a[152:155], a[132:135], v[56:59]
v_permlane16_swap_b32 v252, v253
v_mfma_f32_16x16x32_bf16 v[60:63], a[156:159], a[128:131], v[60:63]
v_mfma_f32_16x16x32_bf16 v[64:67], a[156:159], a[132:135], v[64:67]
s_waitcnt vmcnt(0) lgkmcnt(4)
v_add_u32 v181, 36864, v239
v_mfma_f32_16x16x32_bf16 v[36:39], a[160:163], a[136:139], v[36:39]
ds_read_b64 a[152:153], v181 offset:0
ds_read_b64 a[156:157], v181 offset:512
v_mfma_f32_16x16x32_bf16 v[40:43], a[160:163], a[140:143], v[40:43]
v_permlane16_swap_b32 v250, v251
v_mfma_f32_16x16x32_bf16 v[44:47], a[164:167], a[136:139], v[44:47]
v_mov_b32 v213, v212
v_mfma_f32_16x16x32_bf16 v[48:51], a[164:167], a[140:143], v[48:51]
s_waitcnt lgkmcnt(4)
v_mov_b32 v215, v214
v_mfma_f32_16x16x32_bf16 v[52:55], a[168:171], a[136:139], v[52:55]
ds_read_b128 a[160:163], v210 offset:0
ds_read_b128 a[164:167], v210 offset:18432
v_mfma_f32_16x16x32_bf16 v[56:59], a[168:171], a[140:143], v[56:59]
v_mfma_f32_16x16x32_bf16 v[60:63], a[172:175], a[136:139], v[60:63]
v_mfma_f32_16x16x32_bf16 v[64:67], a[172:175], a[140:143], v[64:67]
s_waitcnt lgkmcnt(4)
v_mfma_f32_16x16x16_bf16 v[36:39], a[144:145], v[212:213], v[36:39]
ds_read_b128 a[168:171], v210 offset:1024
ds_read_b128 a[172:175], v210 offset:19456
v_mfma_f32_16x16x16_bf16 v[40:43], a[144:145], v[214:215], v[40:43]
v_mfma_f32_16x16x16_bf16 v[44:47], a[148:149], v[212:213], v[44:47]
v_mfma_f32_16x16x16_bf16 v[48:51], a[148:149], v[214:215], v[48:51]
s_waitcnt lgkmcnt(4)
v_mfma_f32_16x16x16_bf16 v[52:55], a[152:153], v[212:213], v[52:55]
ds_read_b128 a[144:147], v210 offset:2048
ds_read_b128 a[148:151], v210 offset:20480
v_mfma_f32_16x16x16_bf16 v[56:59], a[152:153], v[214:215], v[56:59]
v_mfma_f32_16x16x16_bf16 v[60:63], a[156:157], v[212:213], v[60:63]
v_mfma_f32_16x16x16_bf16 v[64:67], a[156:157], v[214:215], v[64:67]
s_waitcnt lgkmcnt(4)
s_barrier
v_mfma_f32_16x16x32_bf16 v[68:71], a[160:163], a[0:3], 0
ds_read_b128 a[152:155], v210 offset:3072
ds_read_b128 a[156:159], v210 offset:21504
v_mfma_f32_16x16x32_bf16 v[72:75], a[160:163], a[4:7], 0
s_mul_i32 s38, s24, 9216
s_add_u32 m0, s38, 123904
v_mfma_f32_16x16x32_bf16 v[76:79], a[164:167], a[0:3], 0
s_add_u32 s39, s38, s82
v_mfma_f32_16x16x32_bf16 v[80:83], a[164:167], a[4:7], 0
s_waitcnt lgkmcnt(4)
v_mfma_f32_16x16x32_bf16 v[68:71], a[168:171], a[8:11], v[68:71]
ds_read_b128 a[160:163], v210 offset:4096
ds_read_b128 a[164:167], v210 offset:22528
v_mfma_f32_16x16x32_bf16 v[72:75], a[168:171], a[12:15], v[72:75]
s_add_u32 s39, s39, 151552
v_mfma_f32_16x16x32_bf16 v[76:79], a[172:175], a[8:11], v[76:79]
buffer_load_dwordx4 v1, s[4:7], s39 offen offset:0 sc1 lds
buffer_load_dwordx4 v1, s[4:7], s39 offen offset:1024 sc1 lds
v_pk_mul_f32 v[216:217], v[36:37], v[36:37]
v_pk_mul_f32 v[218:219], v[38:39], v[38:39]
v_pk_mul_f32 v[220:221], v[40:41], v[40:41]
v_pk_mul_f32 v[222:223], v[42:43], v[42:43]
v_pk_fma_f32 v[216:217], v[216:217], v[252:253], v[250:251] op_sel:[0,0,0] op_sel_hi:[1,0,0]
v_pk_fma_f32 v[218:219], v[218:219], v[252:253], v[250:251] op_sel:[0,0,0] op_sel_hi:[1,0,0]
v_pk_fma_f32 v[220:221], v[220:221], v[252:253], v[250:251] op_sel:[0,1,1] op_sel_hi:[1,1,1]
v_pk_fma_f32 v[222:223], v[222:223], v[252:253], v[250:251] op_sel:[0,1,1] op_sel_hi:[1,1,1]
v_pk_mul_f32 v[216:217], v[216:217], v[36:37]
v_pk_mul_f32 v[218:219], v[218:219], v[38:39]
v_pk_mul_f32 v[220:221], v[220:221], v[40:41]
v_pk_mul_f32 v[222:223], v[222:223], v[42:43]
v_mfma_f32_16x16x32_bf16 v[80:83], a[172:175], a[12:15], v[80:83]
s_waitcnt lgkmcnt(4)
v_exp_f32 v216, v216
v_mfma_f32_16x16x32_bf16 v[68:71], a[144:147], a[16:19], v[68:71]
ds_read_b128 a[168:171], v210 offset:5120
ds_read_b128 a[172:175], v210 offset:23552
v_mfma_f32_16x16x32_bf16 v[72:75], a[144:147], a[20:23], v[72:75]
v_exp_f32 v217, v217
v_mfma_f32_16x16x32_bf16 v[76:79], a[148:151], a[16:19], v[76:79]
buffer_load_dwordx4 v1, s[4:7], s39 offen offset:2048 sc1 lds
buffer_load_dwordx4 v1, s[4:7], s39 offen offset:3072 sc1 lds
v_mfma_f32_16x16x32_bf16 v[80:83], a[148:151], a[20:23], v[80:83]
s_waitcnt lgkmcnt(4)
v_exp_f32 v218, v218
v_mfma_f32_16x16x32_bf16 v[68:71], a[152:155], a[24:27], v[68:71]
ds_read_b128 a[144:147], v210 offset:6144
ds_read_b128 a[148:151], v210 offset:24576
v_mfma_f32_16x16x32_bf16 v[72:75], a[152:155], a[28:31], v[72:75]
s_add_u32 m0, m0, 4096
v_fma_f32 v216, v216, v254, v254
v_fma_f32 v217, v217, v254, v254
v_mfma_f32_16x16x32_bf16 v[76:79], a[156:159], a[24:27], v[76:79]
s_add_u32 s39, s39, 4096
v_exp_f32 v219, v219
v_mfma_f32_16x16x32_bf16 v[80:83], a[156:159], a[28:31], v[80:83]
s_waitcnt lgkmcnt(4)
v_exp_f32 v220, v220
v_mfma_f32_16x16x32_bf16 v[68:71], a[160:163], a[32:35], v[68:71]
ds_read_b128 a[152:155], v210 offset:7168
ds_read_b128 a[156:159], v210 offset:25600
v_mfma_f32_16x16x32_bf16 v[72:75], a[160:163], a[36:39], v[72:75]
buffer_load_dwordx4 v1, s[4:7], s39 offen offset:0 sc1 lds
buffer_load_dwordx4 v1, s[4:7], s39 offen offset:1024 sc1 lds
v_mfma_f32_16x16x32_bf16 v[76:79], a[164:167], a[32:35], v[76:79]
v_fma_f32 v218, v218, v254, v254
v_fma_f32 v219, v219, v254, v254
v_mfma_f32_16x16x32_bf16 v[80:83], a[164:167], a[36:39], v[80:83]
s_waitcnt lgkmcnt(4)
v_exp_f32 v221, v221
v_mfma_f32_16x16x32_bf16 v[68:71], a[168:171], a[40:43], v[68:71]
ds_read_b128 a[160:163], v210 offset:8192
ds_read_b128 a[164:167], v210 offset:26624
v_exp_f32 v222, v222
v_mfma_f32_16x16x32_bf16 v[72:75], a[168:171], a[44:47], v[72:75]
buffer_load_dwordx4 v1, s[4:7], s39 offen offset:2048 sc1 lds
buffer_load_dwordx4 v1, s[4:7], s39 offen offset:3072 sc1 lds
v_mfma_f32_16x16x32_bf16 v[76:79], a[172:175], a[40:43], v[76:79]
s_add_u32 m0, m0, 4096
v_fma_f32 v220, v220, v255, v255
v_fma_f32 v221, v221, v255, v255
v_mfma_f32_16x16x32_bf16 v[80:83], a[172:175], a[44:47], v[80:83]
s_waitcnt lgkmcnt(4)
v_exp_f32 v223, v223
v_mfma_f32_16x16x32_bf16 v[68:71], a[144:147], a[48:51], v[68:71]
ds_read_b128 a[168:171], v210 offset:9216
ds_read_b128 a[172:175], v210 offset:27648
v_rcp_f32 v216, v216
v_mfma_f32_16x16x32_bf16 v[72:75], a[144:147], a[52:55], v[72:75]
s_add_u32 s39, s39, 4096
v_fma_f32 v222, v222, v255, v255
v_fma_f32 v223, v223, v255, v255
v_mfma_f32_16x16x32_bf16 v[76:79], a[148:151], a[48:51], v[76:79]
buffer_load_dwordx4 v1, s[4:7], s39 offen offset:0 sc1 lds
v_mfma_f32_16x16x32_bf16 v[80:83], a[148:151], a[52:55], v[80:83]
s_waitcnt lgkmcnt(4)
v_rcp_f32 v217, v217
v_mfma_f32_16x16x32_bf16 v[68:71], a[152:155], a[56:59], v[68:71]
ds_read_b128 a[144:147], v210 offset:10240
ds_read_b128 a[148:151], v210 offset:28672
v_rcp_f32 v218, v218
v_mfma_f32_16x16x32_bf16 v[72:75], a[152:155], a[60:63], v[72:75]
s_lshl_b32 s38, s24, 8
v_rcp_f32 v219, v219
v_mfma_f32_16x16x32_bf16 v[76:79], a[156:159], a[56:59], v[76:79]
s_add_u32 m0, s38, 160768
v_rcp_f32 v220, v220
v_mfma_f32_16x16x32_bf16 v[80:83], a[156:159], a[60:63], v[80:83]
s_waitcnt lgkmcnt(4)
s_add_u32 s39, s38, s82
v_mfma_f32_16x16x32_bf16 v[68:71], a[160:163], a[64:67], v[68:71]
ds_read_b128 a[152:155], v210 offset:11264
ds_read_b128 a[156:159], v210 offset:29696
v_mfma_f32_16x16x32_bf16 v[72:75], a[160:163], a[68:71], v[72:75]
s_add_u32 s39, s39, 188416
v_rcp_f32 v221, v221
v_mfma_f32_16x16x32_bf16 v[76:79], a[164:167], a[64:67], v[76:79]
v_rcp_f32 v222, v222
v_mfma_f32_16x16x32_bf16 v[80:83], a[164:167], a[68:71], v[80:83]
s_waitcnt lgkmcnt(4)
v_rcp_f32 v223, v223
v_mfma_f32_16x16x32_bf16 v[68:71], a[168:171], a[72:75], v[68:71]
ds_read_b128 a[160:163], v210 offset:12288
ds_read_b128 a[164:167], v210 offset:30720
v_pk_mul_f32 v[224:225], v[44:45], v[44:45]
v_pk_mul_f32 v[226:227], v[46:47], v[46:47]
v_pk_mul_f32 v[228:229], v[48:49], v[48:49]
v_pk_mul_f32 v[230:231], v[50:51], v[50:51]
v_pk_fma_f32 v[224:225], v[224:225], v[252:253], v[250:251] op_sel:[0,0,0] op_sel_hi:[1,0,0]
v_pk_fma_f32 v[226:227], v[226:227], v[252:253], v[250:251] op_sel:[0,0,0] op_sel_hi:[1,0,0]
v_pk_fma_f32 v[228:229], v[228:229], v[252:253], v[250:251] op_sel:[0,1,1] op_sel_hi:[1,1,1]
v_pk_fma_f32 v[230:231], v[230:231], v[252:253], v[250:251] op_sel:[0,1,1] op_sel_hi:[1,1,1]
v_pk_mul_f32 v[36:37], v[36:37], v[216:217]
v_pk_mul_f32 v[38:39], v[38:39], v[218:219]
v_pk_mul_f32 v[40:41], v[40:41], v[220:221]
v_pk_mul_f32 v[42:43], v[42:43], v[222:223]
v_pk_mul_f32 v[224:225], v[224:225], v[44:45]
v_pk_mul_f32 v[226:227], v[226:227], v[46:47]
v_pk_mul_f32 v[228:229], v[228:229], v[48:49]
v_pk_mul_f32 v[230:231], v[230:231], v[50:51]
v_mfma_f32_16x16x32_bf16 v[72:75], a[168:171], a[76:79], v[72:75]
s_mov_b64 exec, 0xffff
buffer_load_dwordx4 v1, s[4:7], s39 offen sc1 lds
s_mov_b64 exec, -1
v_exp_f32 v224, v224
v_mfma_f32_16x16x32_bf16 v[76:79], a[172:175], a[72:75], v[76:79]
v_exp_f32 v225, v225
v_mfma_f32_16x16x32_bf16 v[80:83], a[172:175], a[76:79], v[80:83]
s_waitcnt lgkmcnt(4)
v_exp_f32 v226, v226
v_mfma_f32_16x16x32_bf16 v[68:71], a[144:147], a[80:83], v[68:71]
ds_read_b128 a[168:171], v210 offset:13312
ds_read_b128 a[172:175], v210 offset:31744
v_mfma_f32_16x16x32_bf16 v[72:75], a[144:147], a[84:87], v[72:75]
s_mul_i32 s38, s24, 9216
v_fma_f32 v224, v224, v254, v254
v_fma_f32 v225, v225, v254, v254
v_mfma_f32_16x16x32_bf16 v[76:79], a[148:151], a[80:83], v[76:79]
s_add_u32 m0, s38, 0
v_exp_f32 v227, v227
v_mfma_f32_16x16x32_bf16 v[80:83], a[148:151], a[84:87], v[80:83]
s_waitcnt lgkmcnt(4)
v_exp_f32 v228, v228
v_mfma_f32_16x16x32_bf16 v[68:71], a[152:155], a[88:91], v[68:71]
ds_read_b128 a[144:147], v210 offset:14336
ds_read_b128 a[148:151], v210 offset:32768
v_mfma_f32_16x16x32_bf16 v[72:75], a[152:155], a[92:95], v[72:75]
s_add_u32 s39, s38, s82
v_fma_f32 v226, v226, v254, v254
v_fma_f32 v227, v227, v254, v254
v_mfma_f32_16x16x32_bf16 v[76:79], a[156:159], a[88:91], v[76:79]
s_add_u32 s39, s39, 189440
v_exp_f32 v229, v229
v_mfma_f32_16x16x32_bf16 v[80:83], a[156:159], a[92:95], v[80:83]
s_waitcnt lgkmcnt(4)
v_exp_f32 v230, v230
v_mfma_f32_16x16x32_bf16 v[68:71], a[160:163], a[96:99], v[68:71]
ds_read_b128 a[152:155], v210 offset:15360
ds_read_b128 a[156:159], v210 offset:33792
v_mfma_f32_16x16x32_bf16 v[72:75], a[160:163], a[100:103], v[72:75]
v_fma_f32 v228, v228, v255, v255
v_fma_f32 v229, v229, v255, v255
v_mfma_f32_16x16x32_bf16 v[76:79], a[164:167], a[96:99], v[76:79]
buffer_load_dwordx4 v1, s[4:7], s39 offen offset:0 sc1 lds
buffer_load_dwordx4 v1, s[4:7], s39 offen offset:1024 sc1 lds
v_exp_f32 v231, v231
v_mfma_f32_16x16x32_bf16 v[80:83], a[164:167], a[100:103], v[80:83]
s_waitcnt lgkmcnt(4)
v_rcp_f32 v224, v224
v_mfma_f32_16x16x32_bf16 v[68:71], a[168:171], a[104:107], v[68:71]
ds_read_b128 a[160:163], v210 offset:16384
ds_read_b128 a[164:167], v210 offset:34816
v_mfma_f32_16x16x32_bf16 v[72:75], a[168:171], a[108:111], v[72:75]
v_fma_f32 v230, v230, v255, v255
v_fma_f32 v231, v231, v255, v255
v_mfma_f32_16x16x32_bf16 v[76:79], a[172:175], a[104:107], v[76:79]
v_rcp_f32 v225, v225
v_mfma_f32_16x16x32_bf16 v[80:83], a[172:175], a[108:111], v[80:83]
s_waitcnt lgkmcnt(4)
v_rcp_f32 v226, v226
v_mfma_f32_16x16x32_bf16 v[68:71], a[144:147], a[112:115], v[68:71]
ds_read_b128 a[168:171], v210 offset:17408
ds_read_b128 a[172:175], v210 offset:35840
v_mfma_f32_16x16x32_bf16 v[72:75], a[144:147], a[116:119], v[72:75]
buffer_load_dwordx4 v1, s[4:7], s39 offen offset:2048 sc1 lds
buffer_load_dwordx4 v1, s[4:7], s39 offen offset:3072 sc1 lds
v_rcp_f32 v227, v227
v_mfma_f32_16x16x32_bf16 v[76:79], a[148:151], a[112:115], v[76:79]
s_add_u32 m0, m0, 4096
v_rcp_f32 v228, v228
v_mfma_f32_16x16x32_bf16 v[80:83], a[148:151], a[116:119], v[80:83]
s_waitcnt lgkmcnt(4)
v_add_u32 v181, 74752, v239
v_mfma_f32_16x16x32_bf16 v[68:71], a[152:155], a[120:123], v[68:71]
ds_read_b64 a[144:145], v181 offset:0
ds_read_b64 a[148:149], v181 offset:512
v_rcp_f32 v229, v229
v_mfma_f32_16x16x32_bf16 v[72:75], a[152:155], a[124:127], v[72:75]
s_add_u32 s39, s39, 4096
v_rcp_f32 v230, v230
v_mfma_f32_16x16x32_bf16 v[76:79], a[156:159], a[120:123], v[76:79]
v_rcp_f32 v231, v231
v_mfma_f32_16x16x32_bf16 v[80:83], a[156:159], a[124:127], v[80:83]
s_waitcnt lgkmcnt(4)
v_pk_mul_f32 v[216:217], v[52:53], v[52:53]
v_pk_mul_f32 v[218:219], v[54:55], v[54:55]
v_pk_mul_f32 v[220:221], v[56:57], v[56:57]
v_pk_mul_f32 v[222:223], v[58:59], v[58:59]
v_pk_fma_f32 v[216:217], v[216:217], v[252:253], v[250:251] op_sel:[0,0,0] op_sel_hi:[1,0,0]
v_pk_fma_f32 v[218:219], v[218:219], v[252:253], v[250:251] op_sel:[0,0,0] op_sel_hi:[1,0,0]
v_pk_fma_f32 v[220:221], v[220:221], v[252:253], v[250:251] op_sel:[0,1,1] op_sel_hi:[1,1,1]
v_pk_fma_f32 v[222:223], v[222:223], v[252:253], v[250:251] op_sel:[0,1,1] op_sel_hi:[1,1,1]
v_pk_mul_f32 v[44:45], v[44:45], v[224:225]
v_pk_mul_f32 v[46:47], v[46:47], v[226:227]
v_pk_mul_f32 v[48:49], v[48:49], v[228:229]
v_pk_mul_f32 v[50:51], v[50:51], v[230:231]
v_pk_mul_f32 v[216:217], v[216:217], v[52:53]
v_pk_mul_f32 v[218:219], v[218:219], v[54:55]
v_pk_mul_f32 v[220:221], v[220:221], v[56:57]
v_pk_mul_f32 v[222:223], v[222:223], v[58:59]
v_mfma_f32_16x16x32_bf16 v[68:71], a[160:163], a[128:131], v[68:71]
ds_read_b128 a[152:155], v211 offset:0
ds_read_b128 a[156:159], v211 offset:18432
v_exp_f32 v216, v216
v_mfma_f32_16x16x32_bf16 v[72:75], a[160:163], a[132:135], v[72:75]
buffer_load_dwordx4 v1, s[4:7], s39 offen offset:0 sc1 lds
buffer_load_dwordx4 v1, s[4:7], s39 offen offset:1024 sc1 lds
v_exp_f32 v217, v217
v_mfma_f32_16x16x32_bf16 v[76:79], a[164:167], a[128:131], v[76:79]
v_exp_f32 v218, v218
v_mfma_f32_16x16x32_bf16 v[80:83], a[164:167], a[132:135], v[80:83]
s_waitcnt lgkmcnt(4)
v_fma_f32 v216, v216, v254, v254
v_fma_f32 v217, v217, v254, v254
v_mfma_f32_16x16x32_bf16 v[68:71], a[168:171], a[136:139], v[68:71]
ds_read_b128 a[160:163], v211 offset:1024
ds_read_b128 a[164:167], v211 offset:19456
v_mfma_f32_16x16x32_bf16 v[72:75], a[168:171], a[140:143], v[72:75]
v_exp_f32 v219, v219
v_mfma_f32_16x16x32_bf16 v[76:79], a[172:175], a[136:139], v[76:79]
v_exp_f32 v220, v220
v_mfma_f32_16x16x32_bf16 v[80:83], a[172:175], a[140:143], v[80:83]
s_waitcnt lgkmcnt(4)
v_fma_f32 v218, v218, v254, v254
v_fma_f32 v219, v219, v254, v254
v_mfma_f32_16x16x16_bf16 v[68:71], a[144:145], v[212:213], v[68:71]
ds_read_b128 a[168:171], v211 offset:2048
ds_read_b128 a[172:175], v211 offset:20480
v_mfma_f32_16x16x16_bf16 v[72:75], a[144:145], v[214:215], v[72:75]
buffer_load_dwordx4 v1, s[4:7], s39 offen offset:2048 sc1 lds
buffer_load_dwordx4 v1, s[4:7], s39 offen offset:3072 sc1 lds
v_exp_f32 v221, v221
v_mfma_f32_16x16x16_bf16 v[76:79], a[148:149], v[212:213], v[76:79]
s_add_u32 m0, m0, 4096
v_exp_f32 v222, v222
v_mfma_f32_16x16x16_bf16 v[80:83], a[148:149], v[214:215], v[80:83]
s_waitcnt vmcnt(8) lgkmcnt(4)
s_barrier
v_mfma_f32_16x16x32_bf16 v[84:87], a[152:155], a[0:3], 0
ds_read_b128 a[144:147], v211 offset:3072
ds_read_b128 a[148:151], v211 offset:21504
v_fma_f32 v220, v220, v255, v255
v_fma_f32 v221, v221, v255, v255
v_mfma_f32_16x16x32_bf16 v[88:91], a[152:155], a[4:7], 0
buffer_load_dwordx4 a[176:179], v1, s[4:7], s52 offen offset:0 sc1
buffer_load_dwordx4 a[180:183], v9, s[4:7], s52 offen offset:0 sc1
v_exp_f32 v223, v223
v_mfma_f32_16x16x32_bf16 v[92:95], a[156:159], a[0:3], 0
s_add_u32 s39, s39, 4096
v_rcp_f32 v216, v216
v_mfma_f32_16x16x32_bf16 v[96:99], a[156:159], a[4:7], 0
s_waitcnt lgkmcnt(4)
v_fma_f32 v222, v222, v255, v255
v_fma_f32 v223, v223, v255, v255
v_mfma_f32_16x16x32_bf16 v[84:87], a[160:163], a[8:11], v[84:87]
ds_read_b128 a[152:155], v211 offset:4096
ds_read_b128 a[156:159], v211 offset:22528
v_mfma_f32_16x16x32_bf16 v[88:91], a[160:163], a[12:15], v[88:91]
buffer_load_dwordx4 v1, s[4:7], s39 offen offset:0 sc1 lds
v_rcp_f32 v217, v217
v_mfma_f32_16x16x32_bf16 v[92:95], a[164:167], a[8:11], v[92:95]
s_lshl_b32 s38, s24, 8
v_rcp_f32 v218, v218
v_mfma_f32_16x16x32_bf16 v[96:99], a[164:167], a[12:15], v[96:99]
s_waitcnt lgkmcnt(4)
v_rcp_f32 v219, v219
v_mfma_f32_16x16x32_bf16 v[84:87], a[168:171], a[16:19], v[84:87]
ds_read_b128 a[160:163], v211 offset:5120
ds_read_b128 a[164:167], v211 offset:23552
v_mfma_f32_16x16x32_bf16 v[88:91], a[168:171], a[20:23], v[88:91]
s_add_u32 m0, s38, 36864
v_rcp_f32 v220, v220
v_mfma_f32_16x16x32_bf16 v[92:95], a[172:175], a[16:19], v[92:95]
buffer_load_dwordx4 a[184:187], v1, s[4:7], s52 offen offset:1024 sc1
buffer_load_dwordx4 a[188:191], v9, s[4:7], s52 offen offset:1024 sc1
v_mfma_f32_16x16x32_bf16 v[96:99], a[172:175], a[20:23], v[96:99]
s_waitcnt lgkmcnt(4)
v_rcp_f32 v221, v221
v_mfma_f32_16x16x32_bf16 v[84:87], a[144:147], a[24:27], v[84:87]
ds_read_b128 a[168:171], v211 offset:6144
ds_read_b128 a[172:175], v211 offset:24576
v_rcp_f32 v222, v222
v_mfma_f32_16x16x32_bf16 v[88:91], a[144:147], a[28:31], v[88:91]
s_add_u32 s39, s38, s82
v_rcp_f32 v223, v223
v_mfma_f32_16x16x32_bf16 v[92:95], a[148:151], a[24:27], v[92:95]
s_add_u32 s39, s39, 226304
v_pk_mul_f32 v[224:225], v[60:61], v[60:61]
v_pk_mul_f32 v[226:227], v[62:63], v[62:63]
v_pk_mul_f32 v[228:229], v[64:65], v[64:65]
v_pk_mul_f32 v[230:231], v[66:67], v[66:67]
v_pk_fma_f32 v[224:225], v[224:225], v[252:253], v[250:251] op_sel:[0,0,0] op_sel_hi:[1,0,0]
v_pk_fma_f32 v[226:227], v[226:227], v[252:253], v[250:251] op_sel:[0,0,0] op_sel_hi:[1,0,0]
v_pk_fma_f32 v[228:229], v[228:229], v[252:253], v[250:251] op_sel:[0,1,1] op_sel_hi:[1,1,1]
v_pk_fma_f32 v[230:231], v[230:231], v[252:253], v[250:251] op_sel:[0,1,1] op_sel_hi:[1,1,1]
v_pk_mul_f32 v[52:53], v[52:53], v[216:217]
v_pk_mul_f32 v[54:55], v[54:55], v[218:219]
v_pk_mul_f32 v[56:57], v[56:57], v[220:221]
v_pk_mul_f32 v[58:59], v[58:59], v[222:223]
v_pk_mul_f32 v[224:225], v[224:225], v[60:61]
v_pk_mul_f32 v[226:227], v[226:227], v[62:63]
v_pk_mul_f32 v[228:229], v[228:229], v[64:65]
v_pk_mul_f32 v[230:231], v[230:231], v[66:67]
v_mfma_f32_16x16x32_bf16 v[96:99], a[148:151], a[28:31], v[96:99]
s_waitcnt lgkmcnt(4)
v_exp_f32 v224, v224
v_mfma_f32_16x16x32_bf16 v[84:87], a[152:155], a[32:35], v[84:87]
ds_read_b128 a[144:147], v211 offset:7168
ds_read_b128 a[148:151], v211 offset:25600
v_exp_f32 v225, v225
v_mfma_f32_16x16x32_bf16 v[88:91], a[152:155], a[36:39], v[88:91]
v_exp_f32 v226, v226
v_mfma_f32_16x16x32_bf16 v[92:95], a[156:159], a[32:35], v[92:95]
s_mov_b64 exec, 0xffff
buffer_load_dwordx4 v1, s[4:7], s39 offen sc1 lds
s_mov_b64 exec, -1
v_mfma_f32_16x16x32_bf16 v[96:99], a[156:159], a[36:39], v[96:99]
s_waitcnt lgkmcnt(4)
v_fma_f32 v224, v224, v254, v254
v_fma_f32 v225, v225, v254, v254
v_mfma_f32_16x16x32_bf16 v[84:87], a[160:163], a[40:43], v[84:87]
ds_read_b128 a[152:155], v211 offset:8192
ds_read_b128 a[156:159], v211 offset:26624
v_exp_f32 v227, v227
v_mfma_f32_16x16x32_bf16 v[88:91], a[160:163], a[44:47], v[88:91]
buffer_load_dwordx4 a[192:195], v1, s[4:7], s52 offen offset:2048 sc1
buffer_load_dwordx4 a[196:199], v9, s[4:7], s52 offen offset:2048 sc1
v_exp_f32 v228, v228
v_mfma_f32_16x16x32_bf16 v[92:95], a[164:167], a[40:43], v[92:95]
v_fma_f32 v226, v226, v254, v254
v_fma_f32 v227, v227, v254, v254
v_mfma_f32_16x16x32_bf16 v[96:99], a[164:167], a[44:47], v[96:99]
s_waitcnt lgkmcnt(4)
v_exp_f32 v229, v229
v_mfma_f32_16x16x32_bf16 v[84:87], a[168:171], a[48:51], v[84:87]
ds_read_b128 a[160:163], v211 offset:9216
ds_read_b128 a[164:167], v211 offset:27648
v_mfma_f32_16x16x32_bf16 v[88:91], a[168:171], a[52:55], v[88:91]
v_exp_f32 v230, v230
v_mfma_f32_16x16x32_bf16 v[92:95], a[172:175], a[48:51], v[92:95]
s_mul_i32 s38, s24, 9216
v_fma_f32 v228, v228, v255, v255
v_fma_f32 v229, v229, v255, v255
v_mfma_f32_16x16x32_bf16 v[96:99], a[172:175], a[52:55], v[96:99]
s_waitcnt lgkmcnt(4)
v_exp_f32 v231, v231
v_mfma_f32_16x16x32_bf16 v[84:87], a[144:147], a[56:59], v[84:87]
ds_read_b128 a[168:171], v211 offset:10240
ds_read_b128 a[172:175], v211 offset:28672
v_mfma_f32_16x16x32_bf16 v[88:91], a[144:147], a[60:63], v[88:91]
s_add_u32 m0, s38, 37888
v_rcp_f32 v224, v224
v_mfma_f32_16x16x32_bf16 v[92:95], a[148:151], a[56:59], v[92:95]
s_add_u32 s39, s38, s82
v_fma_f32 v230, v230, v255, v255
v_fma_f32 v231, v231, v255, v255
v_mfma_f32_16x16x32_bf16 v[96:99], a[148:151], a[60:63], v[96:99]
s_waitcnt lgkmcnt(4)
v_rcp_f32 v225, v225
v_mfma_f32_16x16x32_bf16 v[84:87], a[152:155], a[64:67], v[84:87]
ds_read_b128 a[144:147], v211 offset:11264
ds_read_b128 a[148:151], v211 offset:29696
v_mfma_f32_16x16x32_bf16 v[88:91], a[152:155], a[68:71], v[88:91]
buffer_load_dwordx4 a[200:203], v1, s[4:7], s52 offen offset:3072 sc1
buffer_load_dwordx4 a[204:207], v9, s[4:7], s52 offen offset:3072 sc1
v_rcp_f32 v226, v226
v_mfma_f32_16x16x32_bf16 v[92:95], a[156:159], a[64:67], v[92:95]
s_add_u32 s39, s39, 227328
v_rcp_f32 v227, v227
v_mfma_f32_16x16x32_bf16 v[96:99], a[156:159], a[68:71], v[96:99]
s_waitcnt lgkmcnt(4)
v_rcp_f32 v228, v228
v_mfma_f32_16x16x32_bf16 v[84:87], a[160:163], a[72:75], v[84:87]
ds_read_b128 a[152:155], v211 offset:12288
ds_read_b128 a[156:159], v211 offset:30720
v_mfma_f32_16x16x32_bf16 v[88:91], a[160:163], a[76:79], v[88:91]
buffer_load_dwordx4 v1, s[4:7], s39 offen offset:0 sc1 lds
buffer_load_dwordx4 v1, s[4:7], s39 offen offset:1024 sc1 lds
v_mfma_f32_16x16x32_bf16 v[92:95], a[164:167], a[72:75], v[92:95]
s_mov_b32 s52, s53
v_rcp_f32 v229, v229
v_mfma_f32_16x16x32_bf16 v[96:99], a[164:167], a[76:79], v[96:99]
s_waitcnt lgkmcnt(4)
v_rcp_f32 v230, v230
v_mfma_f32_16x16x32_bf16 v[84:87], a[168:171], a[80:83], v[84:87]
ds_read_b128 a[160:163], v211 offset:13312
ds_read_b128 a[164:167], v211 offset:31744
v_rcp_f32 v231, v231
v_mfma_f32_16x16x32_bf16 v[88:91], a[168:171], a[84:87], v[88:91]
buffer_load_dwordx4 v1, s[4:7], s39 offen offset:2048 sc1 lds
buffer_load_dwordx4 v1, s[4:7], s39 offen offset:3072 sc1 lds
v_pk_mul_f32 v[216:217], v[68:69], v[68:69]
v_pk_mul_f32 v[218:219], v[70:71], v[70:71]
v_pk_mul_f32 v[220:221], v[72:73], v[72:73]
v_pk_mul_f32 v[222:223], v[74:75], v[74:75]
v_pk_fma_f32 v[216:217], v[216:217], v[252:253], v[250:251] op_sel:[0,0,0] op_sel_hi:[1,0,0]
v_pk_fma_f32 v[218:219], v[218:219], v[252:253], v[250:251] op_sel:[0,0,0] op_sel_hi:[1,0,0]
v_pk_fma_f32 v[220:221], v[220:221], v[252:253], v[250:251] op_sel:[0,1,1] op_sel_hi:[1,1,1]
v_pk_fma_f32 v[222:223], v[222:223], v[252:253], v[250:251] op_sel:[0,1,1] op_sel_hi:[1,1,1]
v_pk_mul_f32 v[60:61], v[60:61], v[224:225]
v_pk_mul_f32 v[62:63], v[62:63], v[226:227]
v_pk_mul_f32 v[64:65], v[64:65], v[228:229]
v_pk_mul_f32 v[66:67], v[66:67], v[230:231]
v_pk_mul_f32 v[216:217], v[216:217], v[68:69]
v_pk_mul_f32 v[218:219], v[218:219], v[70:71]
v_pk_mul_f32 v[220:221], v[220:221], v[72:73]
v_pk_mul_f32 v[222:223], v[222:223], v[74:75]
v_mfma_f32_16x16x32_bf16 v[92:95], a[172:175], a[80:83], v[92:95]
s_add_u32 m0, m0, 4096
v_exp_f32 v216, v216
v_mfma_f32_16x16x32_bf16 v[96:99], a[172:175], a[84:87], v[96:99]
s_waitcnt lgkmcnt(4)
v_exp_f32 v217, v217
v_mfma_f32_16x16x32_bf16 v[84:87], a[144:147], a[88:91], v[84:87]
ds_read_b128 a[168:171], v211 offset:14336
ds_read_b128 a[172:175], v211 offset:32768
v_exp_f32 v218, v218
v_mfma_f32_16x16x32_bf16 v[88:91], a[144:147], a[92:95], v[88:91]
s_add_u32 s39, s39, 4096
v_fma_f32 v216, v216, v254, v254
v_fma_f32 v217, v217, v254, v254
v_mfma_f32_16x16x32_bf16 v[92:95], a[148:151], a[88:91], v[92:95]
s_cmp_eq_u32 s25, 0
s_cselect_b32 s98, 4096, 0
v_mfma_f32_16x16x32_bf16 v[96:99], a[148:151], a[92:95], v[96:99]
s_waitcnt lgkmcnt(4)
v_exp_f32 v219, v219
v_mfma_f32_16x16x32_bf16 v[84:87], a[152:155], a[96:99], v[84:87]
ds_read_b128 a[144:147], v211 offset:15360
ds_read_b128 a[148:151], v211 offset:33792
v_exp_f32 v220, v220
v_mfma_f32_16x16x32_bf16 v[88:91], a[152:155], a[100:103], v[88:91]
s_add_u32 s52, s52, s98
v_fma_f32 v218, v218, v254, v254
v_fma_f32 v219, v219, v254, v254
v_mfma_f32_16x16x32_bf16 v[92:95], a[156:159], a[96:99], v[92:95]
v_exp_f32 v221, v221
v_mfma_f32_16x16x32_bf16 v[96:99], a[156:159], a[100:103], v[96:99]
s_waitcnt lgkmcnt(4)
v_exp_f32 v222, v222
v_mfma_f32_16x16x32_bf16 v[84:87], a[160:163], a[104:107], v[84:87]
ds_read_b128 a[152:155], v211 offset:16384
ds_read_b128 a[156:159], v211 offset:34816
v_mfma_f32_16x16x32_bf16 v[88:91], a[160:163], a[108:111], v[88:91]
buffer_load_dwordx4 v1, s[4:7], s39 offen offset:0 sc1 lds
buffer_load_dwordx4 v1, s[4:7], s39 offen offset:1024 sc1 lds
v_mfma_f32_16x16x32_bf16 v[92:95], a[164:167], a[104:107], v[92:95]
v_fma_f32 v220, v220, v255, v255
v_fma_f32 v221, v221, v255, v255
v_mfma_f32_16x16x32_bf16 v[96:99], a[164:167], a[108:111], v[96:99]
s_waitcnt lgkmcnt(4)
v_exp_f32 v223, v223
v_mfma_f32_16x16x32_bf16 v[84:87], a[168:171], a[112:115], v[84:87]
ds_read_b128 a[160:163], v211 offset:17408
ds_read_b128 a[164:167], v211 offset:35840
v_rcp_f32 v216, v216
v_mfma_f32_16x16x32_bf16 v[88:91], a[168:171], a[116:119], v[88:91]
buffer_load_dwordx4 v1, s[4:7], s39 offen offset:2048 sc1 lds
buffer_load_dwordx4 v1, s[4:7], s39 offen offset:3072 sc1 lds
v_mfma_f32_16x16x32_bf16 v[92:95], a[172:175], a[112:115], v[92:95]
s_add_u32 m0, m0, 4096
v_fma_f32 v222, v222, v255, v255
v_fma_f32 v223, v223, v255, v255
v_mfma_f32_16x16x32_bf16 v[96:99], a[172:175], a[116:119], v[96:99]
s_waitcnt lgkmcnt(4)
v_rcp_f32 v217, v217
v_add_u32 v181, 112640, v239
v_mfma_f32_16x16x32_bf16 v[84:87], a[144:147], a[120:123], v[84:87]
ds_read_b64 a[168:169], v181 offset:0
ds_read_b64 a[172:173], v181 offset:512
v_rcp_f32 v218, v218
v_mfma_f32_16x16x32_bf16 v[88:91], a[144:147], a[124:127], v[88:91]
s_add_u32 s39, s39, 4096
v_rcp_f32 v219, v219
v_mfma_f32_16x16x32_bf16 v[92:95], a[148:151], a[120:123], v[92:95]
v_rcp_f32 v220, v220
v_mfma_f32_16x16x32_bf16 v[96:99], a[148:151], a[124:127], v[96:99]
s_waitcnt lgkmcnt(4)
v_rcp_f32 v221, v221
v_mfma_f32_16x16x32_bf16 v[84:87], a[152:155], a[128:131], v[84:87]
ds_read_b128 a[144:147], v208 offset:0
ds_read_b128 a[148:151], v208 offset:18432
v_mfma_f32_16x16x32_bf16 v[88:91], a[152:155], a[132:135], v[88:91]
buffer_load_dwordx4 a[208:211], v1, s[4:7], s52 offen offset:0 sc1
buffer_load_dwordx4 a[212:215], v9, s[4:7], s52 offen offset:0 sc1
v_mfma_f32_16x16x32_bf16 v[92:95], a[156:159], a[128:131], v[92:95]
v_rcp_f32 v222, v222
v_mfma_f32_16x16x32_bf16 v[96:99], a[156:159], a[132:135], v[96:99]
s_waitcnt lgkmcnt(4)
v_rcp_f32 v223, v223
v_mfma_f32_16x16x32_bf16 v[84:87], a[160:163], a[136:139], v[84:87]
ds_read_b128 a[152:155], v208 offset:1024
ds_read_b128 a[156:159], v208 offset:19456
v_pk_mul_f32 v[224:225], v[76:77], v[76:77]
v_pk_mul_f32 v[226:227], v[78:79], v[78:79]
v_pk_mul_f32 v[228:229], v[80:81], v[80:81]
v_pk_mul_f32 v[230:231], v[82:83], v[82:83]
v_pk_fma_f32 v[224:225], v[224:225], v[252:253], v[250:251] op_sel:[0,0,0] op_sel_hi:[1,0,0]
v_pk_fma_f32 v[226:227], v[226:227], v[252:253], v[250:251] op_sel:[0,0,0] op_sel_hi:[1,0,0]
v_pk_fma_f32 v[228:229], v[228:229], v[252:253], v[250:251] op_sel:[0,1,1] op_sel_hi:[1,1,1]
v_pk_fma_f32 v[230:231], v[230:231], v[252:253], v[250:251] op_sel:[0,1,1] op_sel_hi:[1,1,1]
v_pk_mul_f32 v[68:69], v[68:69], v[216:217]
v_pk_mul_f32 v[70:71], v[70:71], v[218:219]
v_pk_mul_f32 v[72:73], v[72:73], v[220:221]
v_pk_mul_f32 v[74:75], v[74:75], v[222:223]
v_pk_mul_f32 v[224:225], v[224:225], v[76:77]
v_pk_mul_f32 v[226:227], v[226:227], v[78:79]
v_pk_mul_f32 v[228:229], v[228:229], v[80:81]
v_pk_mul_f32 v[230:231], v[230:231], v[82:83]
v_mfma_f32_16x16x32_bf16 v[88:91], a[160:163], a[140:143], v[88:91]
buffer_load_dwordx4 v1, s[4:7], s39 offen offset:0 sc1 lds
s_lshl_b32 s38, s24, 8
v_exp_f32 v224, v224
v_mfma_f32_16x16x32_bf16 v[92:95], a[164:167], a[136:139], v[92:95]
s_add_u32 m0, s38, 74752
v_exp_f32 v225, v225
v_mfma_f32_16x16x32_bf16 v[96:99], a[164:167], a[140:143], v[96:99]
s_waitcnt lgkmcnt(4)
v_exp_f32 v226, v226
v_mfma_f32_16x16x16_bf16 v[84:87], a[168:169], v[212:213], v[84:87]
ds_read_b128 a[160:163], v208 offset:2048
ds_read_b128 a[164:167], v208 offset:20480
v_mfma_f32_16x16x16_bf16 v[88:91], a[168:169], v[214:215], v[88:91]
s_add_u32 s39, s38, s82
v_fma_f32 v224, v224, v254, v254
v_fma_f32 v225, v225, v254, v254
v_mfma_f32_16x16x16_bf16 v[92:95], a[172:173], v[212:213], v[92:95]
s_add_u32 s39, s39, 264192
v_exp_f32 v227, v227
v_mfma_f32_16x16x16_bf16 v[96:99], a[172:173], v[214:215], v[96:99]
s_waitcnt lgkmcnt(4)
v_exp_f32 v228, v228
s_waitcnt vmcnt(15)
s_barrier
v_mfma_f32_16x16x32_bf16 v[100:103], a[144:147], a[0:3], 0
ds_read_b128 a[168:171], v208 offset:3072
ds_read_b128 a[172:175], v208 offset:21504
v_mfma_f32_16x16x32_bf16 v[104:107], a[144:147], a[4:7], 0
buffer_load_dwordx4 a[216:219], v1, s[4:7], s52 offen offset:1024 sc1
buffer_load_dwordx4 a[220:223], v9, s[4:7], s52 offen offset:1024 sc1
v_fma_f32 v226, v226, v254, v254
v_fma_f32 v227, v227, v254, v254
v_mfma_f32_16x16x32_bf16 v[108:111], a[148:151], a[0:3], 0
v_exp_f32 v229, v229
v_mfma_f32_16x16x32_bf16 v[112:115], a[148:151], a[4:7], 0
s_waitcnt lgkmcnt(4)
v_exp_f32 v230, v230
v_mfma_f32_16x16x32_bf16 v[100:103], a[152:155], a[8:11], v[100:103]
ds_read_b128 a[144:147], v208 offset:4096
ds_read_b128 a[148:151], v208 offset:22528
v_mfma_f32_16x16x32_bf16 v[104:107], a[152:155], a[12:15], v[104:107]
s_mov_b64 exec, 0xffff
buffer_load_dwordx4 v1, s[4:7], s39 offen sc1 lds
s_mov_b64 exec, -1
v_fma_f32 v228, v228, v255, v255
v_fma_f32 v229, v229, v255, v255
v_mfma_f32_16x16x32_bf16 v[108:111], a[156:159], a[8:11], v[108:111]
v_exp_f32 v231, v231
v_mfma_f32_16x16x32_bf16 v[112:115], a[156:159], a[12:15], v[112:115]
s_waitcnt lgkmcnt(4)
v_rcp_f32 v224, v224
v_mfma_f32_16x16x32_bf16 v[100:103], a[160:163], a[16:19], v[100:103]
ds_read_b128 a[152:155], v208 offset:5120
ds_read_b128 a[156:159], v208 offset:23552
v_mfma_f32_16x16x32_bf16 v[104:107], a[160:163], a[20:23], v[104:107]
buffer_load_dwordx4 a[224:227], v1, s[4:7], s52 offen offset:2048 sc1
buffer_load_dwordx4 a[228:231], v9, s[4:7], s52 offen offset:2048 sc1
v_fma_f32 v230, v230, v255, v255
v_fma_f32 v231, v231, v255, v255
v_mfma_f32_16x16x32_bf16 v[108:111], a[164:167], a[16:19], v[108:111]
v_rcp_f32 v225, v225
v_mfma_f32_16x16x32_bf16 v[112:115], a[164:167], a[20:23], v[112:115]
s_waitcnt lgkmcnt(4)
v_rcp_f32 v226, v226
v_mfma_f32_16x16x32_bf16 v[100:103], a[168:171], a[24:27], v[100:103]
ds_read_b128 a[160:163], v208 offset:6144
ds_read_b128 a[164:167], v208 offset:24576
v_mfma_f32_16x16x32_bf16 v[104:107], a[168:171], a[28:31], v[104:107]
s_mul_i32 s38, s24, 9216
v_rcp_f32 v227, v227
v_mfma_f32_16x16x32_bf16 v[108:111], a[172:175], a[24:27], v[108:111]
s_add_u32 m0, s38, 75776
v_rcp_f32 v228, v228
v_mfma_f32_16x16x32_bf16 v[112:115], a[172:175], a[28:31], v[112:115]
s_waitcnt lgkmcnt(4)
v_rcp_f32 v229, v229
v_mfma_f32_16x16x32_bf16 v[100:103], a[144:147], a[32:35], v[100:103]
ds_read_b128 a[168:171], v208 offset:7168
ds_read_b128 a[172:175], v208 offset:25600
v_mfma_f32_16x16x32_bf16 v[104:107], a[144:147], a[36:39], v[104:107]
s_add_u32 s39, s38, s82
v_rcp_f32 v230, v230
v_mfma_f32_16x16x32_bf16 v[108:111], a[148:151], a[32:35], v[108:111]
s_add_u32 s39, s39, 265216
v_rcp_f32 v231, v231
v_mfma_f32_16x16x32_bf16 v[112:115], a[148:151], a[36:39], v[112:115]
s_waitcnt lgkmcnt(4)
v_pk_mul_f32 v[216:217], v[84:85], v[84:85]
v_pk_mul_f32 v[218:219], v[86:87], v[86:87]
v_pk_mul_f32 v[220:221], v[88:89], v[88:89]
v_pk_mul_f32 v[222:223], v[90:91], v[90:91]
v_pk_fma_f32 v[216:217], v[216:217], v[252:253], v[250:251] op_sel:[0,0,0] op_sel_hi:[1,0,0]
v_pk_fma_f32 v[218:219], v[218:219], v[252:253], v[250:251] op_sel:[0,0,0] op_sel_hi:[1,0,0]
v_pk_fma_f32 v[220:221], v[220:221], v[252:253], v[250:251] op_sel:[0,1,1] op_sel_hi:[1,1,1]
v_pk_fma_f32 v[222:223], v[222:223], v[252:253], v[250:251] op_sel:[0,1,1] op_sel_hi:[1,1,1]
v_pk_mul_f32 v[76:77], v[76:77], v[224:225]
v_pk_mul_f32 v[78:79], v[78:79], v[226:227]
v_pk_mul_f32 v[80:81], v[80:81], v[228:229]
v_pk_mul_f32 v[82:83], v[82:83], v[230:231]
v_pk_mul_f32 v[216:217], v[216:217], v[84:85]
v_pk_mul_f32 v[218:219], v[218:219], v[86:87]
v_pk_mul_f32 v[220:221], v[220:221], v[88:89]
v_pk_mul_f32 v[222:223], v[222:223], v[90:91]
v_mfma_f32_16x16x32_bf16 v[100:103], a[152:155], a[40:43], v[100:103]
ds_read_b128 a[144:147], v208 offset:8192
ds_read_b128 a[148:151], v208 offset:26624
v_exp_f32 v216, v216
v_mfma_f32_16x16x32_bf16 v[104:107], a[152:155], a[44:47], v[104:107]
buffer_load_dwordx4 a[232:235], v1, s[4:7], s52 offen offset:3072 sc1
buffer_load_dwordx4 a[236:239], v9, s[4:7], s52 offen offset:3072 sc1
v_exp_f32 v217, v217
v_mfma_f32_16x16x32_bf16 v[108:111], a[156:159], a[40:43], v[108:111]
buffer_load_dwordx4 v1, s[4:7], s39 offen offset:0 sc1 lds
buffer_load_dwordx4 v1, s[4:7], s39 offen offset:1024 sc1 lds
v_exp_f32 v218, v218
v_mfma_f32_16x16x32_bf16 v[112:115], a[156:159], a[44:47], v[112:115]
s_waitcnt lgkmcnt(4)
v_fma_f32 v216, v216, v254, v254
v_fma_f32 v217, v217, v254, v254
v_mfma_f32_16x16x32_bf16 v[100:103], a[160:163], a[48:51], v[100:103]
ds_read_b128 a[152:155], v208 offset:9216
ds_read_b128 a[156:159], v208 offset:27648
v_mfma_f32_16x16x32_bf16 v[104:107], a[160:163], a[52:55], v[104:107]
s_cmp_eq_u32 s25, 1
s_cselect_b32 s98, 4096, 0
v_exp_f32 v219, v219
v_mfma_f32_16x16x32_bf16 v[108:111], a[164:167], a[48:51], v[108:111]
s_add_u32 s52, s52, s98
v_exp_f32 v220, v220
v_mfma_f32_16x16x32_bf16 v[112:115], a[164:167], a[52:55], v[112:115]
s_waitcnt lgkmcnt(4)
v_fma_f32 v218, v218, v254, v254
v_fma_f32 v219, v219, v254, v254
v_mfma_f32_16x16x32_bf16 v[100:103], a[168:171], a[56:59], v[100:103]
ds_read_b128 a[160:163], v208 offset:10240
ds_read_b128 a[164:167], v208 offset:28672
v_mfma_f32_16x16x32_bf16 v[104:107], a[168:171], a[60:63], v[104:107]
buffer_load_dwordx4 v1, s[4:7], s39 offen offset:2048 sc1 lds
buffer_load_dwordx4 v1, s[4:7], s39 offen offset:3072 sc1 lds
v_exp_f32 v221, v221
v_mfma_f32_16x16x32_bf16 v[108:111], a[172:175], a[56:59], v[108:111]
s_add_u32 m0, m0, 4096
v_exp_f32 v222, v222
v_mfma_f32_16x16x32_bf16 v[112:115], a[172:175], a[60:63], v[112:115]
s_waitcnt lgkmcnt(4)
v_fma_f32 v220, v220, v255, v255
v_fma_f32 v221, v221, v255, v255
v_mfma_f32_16x16x32_bf16 v[100:103], a[144:147], a[64:67], v[100:103]
ds_read_b128 a[168:171], v208 offset:11264
ds_read_b128 a[172:175], v208 offset:29696
v_mfma_f32_16x16x32_bf16 v[104:107], a[144:147], a[68:71], v[104:107]
s_add_u32 s39, s39, 4096
v_exp_f32 v223, v223
v_mfma_f32_16x16x32_bf16 v[108:111], a[148:151], a[64:67], v[108:111]
s_add_u32 s52, s52, 4096
v_rcp_f32 v216, v216
v_mfma_f32_16x16x32_bf16 v[112:115], a[148:151], a[68:71], v[112:115]
s_waitcnt lgkmcnt(4)
v_fma_f32 v222, v222, v255, v255
v_fma_f32 v223, v223, v255, v255
v_mfma_f32_16x16x32_bf16 v[100:103], a[152:155], a[72:75], v[100:103]
ds_read_b128 a[144:147], v208 offset:12288
ds_read_b128 a[148:151], v208 offset:30720
v_mfma_f32_16x16x32_bf16 v[104:107], a[152:155], a[76:79], v[104:107]
buffer_load_dwordx4 v1, s[4:7], s39 offen offset:0 sc1 lds
buffer_load_dwordx4 v1, s[4:7], s39 offen offset:1024 sc1 lds
v_rcp_f32 v217, v217
v_mfma_f32_16x16x32_bf16 v[108:111], a[156:159], a[72:75], v[108:111]
v_rcp_f32 v218, v218
v_mfma_f32_16x16x32_bf16 v[112:115], a[156:159], a[76:79], v[112:115]
s_waitcnt lgkmcnt(4)
v_rcp_f32 v219, v219
v_mfma_f32_16x16x32_bf16 v[100:103], a[160:163], a[80:83], v[100:103]
ds_read_b128 a[152:155], v208 offset:13312
ds_read_b128 a[156:159], v208 offset:31744
v_mfma_f32_16x16x32_bf16 v[104:107], a[160:163], a[84:87], v[104:107]
v_rcp_f32 v220, v220
v_mfma_f32_16x16x32_bf16 v[108:111], a[164:167], a[80:83], v[108:111]
v_rcp_f32 v221, v221
v_mfma_f32_16x16x32_bf16 v[112:115], a[164:167], a[84:87], v[112:115]
s_waitcnt lgkmcnt(4)
v_rcp_f32 v222, v222
v_mfma_f32_16x16x32_bf16 v[100:103], a[168:171], a[88:91], v[100:103]
ds_read_b128 a[160:163], v208 offset:14336
ds_read_b128 a[164:167], v208 offset:32768
v_mfma_f32_16x16x32_bf16 v[104:107], a[168:171], a[92:95], v[104:107]
buffer_load_dwordx4 v1, s[4:7], s39 offen offset:2048 sc1 lds
buffer_load_dwordx4 v1, s[4:7], s39 offen offset:3072 sc1 lds
v_rcp_f32 v223, v223
v_mfma_f32_16x16x32_bf16 v[108:111], a[172:175], a[88:91], v[108:111]
s_add_u32 m0, m0, 4096
v_pk_mul_f32 v[224:225], v[92:93], v[92:93]
v_pk_mul_f32 v[226:227], v[94:95], v[94:95]
v_pk_mul_f32 v[228:229], v[96:97], v[96:97]
v_pk_mul_f32 v[230:231], v[98:99], v[98:99]
v_pk_fma_f32 v[224:225], v[224:225], v[252:253], v[250:251] op_sel:[0,0,0] op_sel_hi:[1,0,0]
v_pk_fma_f32 v[226:227], v[226:227], v[252:253], v[250:251] op_sel:[0,0,0] op_sel_hi:[1,0,0]
v_pk_fma_f32 v[228:229], v[228:229], v[252:253], v[250:251] op_sel:[0,1,1] op_sel_hi:[1,1,1]
v_pk_fma_f32 v[230:231], v[230:231], v[252:253], v[250:251] op_sel:[0,1,1] op_sel_hi:[1,1,1]
v_pk_mul_f32 v[84:85], v[84:85], v[216:217]
v_pk_mul_f32 v[86:87], v[86:87], v[218:219]
v_pk_mul_f32 v[88:89], v[88:89], v[220:221]
v_pk_mul_f32 v[90:91], v[90:91], v[222:223]
v_pk_mul_f32 v[224:225], v[224:225], v[92:93]
v_pk_mul_f32 v[226:227], v[226:227], v[94:95]
v_pk_mul_f32 v[228:229], v[228:229], v[96:97]
v_pk_mul_f32 v[230:231], v[230:231], v[98:99]
v_mfma_f32_16x16x32_bf16 v[112:115], a[172:175], a[92:95], v[112:115]
s_waitcnt lgkmcnt(4)
v_exp_f32 v224, v224
v_mfma_f32_16x16x32_bf16 v[100:103], a[144:147], a[96:99], v[100:103]
ds_read_b128 a[168:171], v208 offset:15360
ds_read_b128 a[172:175], v208 offset:33792
v_exp_f32 v225, v225
v_mfma_f32_16x16x32_bf16 v[104:107], a[144:147], a[100:103], v[104:107]
s_add_u32 s39, s39, 4096
v_exp_f32 v226, v226
v_mfma_f32_16x16x32_bf16 v[108:111], a[148:151], a[96:99], v[108:111]
v_fma_f32 v224, v224, v254, v254
v_fma_f32 v225, v225, v254, v254
v_mfma_f32_16x16x32_bf16 v[112:115], a[148:151], a[100:103], v[112:115]
s_waitcnt lgkmcnt(4)
v_exp_f32 v227, v227
v_mfma_f32_16x16x32_bf16 v[100:103], a[152:155], a[104:107], v[100:103]
ds_read_b128 a[144:147], v208 offset:16384
ds_read_b128 a[148:151], v208 offset:34816
v_mfma_f32_16x16x32_bf16 v[104:107], a[152:155], a[108:111], v[104:107]
buffer_load_dwordx4 v1, s[4:7], s39 offen offset:0 sc1 lds
v_exp_f32 v228, v228
v_mfma_f32_16x16x32_bf16 v[108:111], a[156:159], a[104:107], v[108:111]
buffer_load_dwordx4 a[240:243], v1, s[4:7], s52 offen offset:0 sc1
buffer_load_dwordx4 a[244:247], v9, s[4:7], s52 offen offset:0 sc1
v_mfma_f32_16x16x32_bf16 v[112:115], a[156:159], a[108:111], v[112:115]
s_waitcnt lgkmcnt(4)
s_lshl_b32 s38, s24, 8
v_fma_f32 v226, v226, v254, v254
v_fma_f32 v227, v227, v254, v254
v_mfma_f32_16x16x32_bf16 v[100:103], a[160:163], a[112:115], v[100:103]
ds_read_b128 a[152:155], v208 offset:17408
ds_read_b128 a[156:159], v208 offset:35840
v_exp_f32 v229, v229
v_mfma_f32_16x16x32_bf16 v[104:107], a[160:163], a[116:119], v[104:107]
s_add_u32 m0, s38, 112640
v_exp_f32 v230, v230
v_mfma_f32_16x16x32_bf16 v[108:111], a[164:167], a[112:115], v[108:111]
s_add_u32 s39, s38, s82
v_fma_f32 v228, v228, v255, v255
v_fma_f32 v229, v229, v255, v255
v_mfma_f32_16x16x32_bf16 v[112:115], a[164:167], a[116:119], v[112:115]
s_waitcnt lgkmcnt(4)
v_add_u32 v181, 160768, v239
v_mfma_f32_16x16x32_bf16 v[100:103], a[168:171], a[120:123], v[100:103]
ds_read_b64 a[160:161], v181 offset:0
ds_read_b64 a[164:165], v181 offset:512
v_exp_f32 v231, v231
v_mfma_f32_16x16x32_bf16 v[104:107], a[168:171], a[124:127], v[104:107]
s_add_u32 s39, s39, 302080
v_rcp_f32 v224, v224
v_mfma_f32_16x16x32_bf16 v[108:111], a[172:175], a[120:123], v[108:111]
v_fma_f32 v230, v230, v255, v255
v_fma_f32 v231, v231, v255, v255
v_mfma_f32_16x16x32_bf16 v[112:115], a[172:175], a[124:127], v[112:115]
s_waitcnt lgkmcnt(4)
v_rcp_f32 v225, v225
v_mfma_f32_16x16x32_bf16 v[100:103], a[144:147], a[128:131], v[100:103]
ds_read_b128 a[168:171], v209 offset:0
ds_read_b128 a[172:175], v209 offset:18432
v_mfma_f32_16x16x32_bf16 v[104:107], a[144:147], a[132:135], v[104:107]
buffer_load_dwordx4 a[248:251], v1, s[4:7], s52 offen offset:1024 sc1
buffer_load_dwordx4 a[252:255], v9, s[4:7], s52 offen offset:1024 sc1
v_rcp_f32 v226, v226
v_mfma_f32_16x16x32_bf16 v[108:111], a[148:151], a[128:131], v[108:111]
s_mov_b64 exec, 0xffff
buffer_load_dwordx4 v1, s[4:7], s39 offen sc1 lds
s_mov_b64 exec, -1
v_mfma_f32_16x16x32_bf16 v[112:115], a[148:151], a[132:135], v[112:115]
s_waitcnt lgkmcnt(4)
v_rcp_f32 v227, v227
v_mfma_f32_16x16x32_bf16 v[100:103], a[152:155], a[136:139], v[100:103]
ds_read_b128 a[144:147], v209 offset:1024
ds_read_b128 a[148:151], v209 offset:19456
v_rcp_f32 v228, v228
v_mfma_f32_16x16x32_bf16 v[104:107], a[152:155], a[140:143], v[104:107]
s_mov_b32 s37, L_c4-L_pc
v_rcp_f32 v229, v229
v_mfma_f32_16x16x32_bf16 v[108:111], a[156:159], a[136:139], v[108:111]
v_rcp_f32 v230, v230
v_mfma_f32_16x16x32_bf16 v[112:115], a[156:159], a[140:143], v[112:115]
s_waitcnt lgkmcnt(4)
v_rcp_f32 v231, v231
v_mfma_f32_16x16x16_bf16 v[100:103], a[160:161], v[212:213], v[100:103]
ds_read_b128 a[152:155], v209 offset:2048
ds_read_b128 a[156:159], v209 offset:20480
v_mfma_f32_16x16x16_bf16 v[104:107], a[160:161], v[214:215], v[104:107]
v_mfma_f32_16x16x16_bf16 v[108:111], a[164:165], v[212:213], v[108:111]
v_mfma_f32_16x16x16_bf16 v[112:115], a[164:165], v[214:215], v[112:115]
s_waitcnt vmcnt(18) lgkmcnt(4)
s_barrier
v_mfma_f32_16x16x32_bf16 v[116:119], a[168:171], a[0:3], 0
ds_read_b128 a[160:163], v209 offset:3072
ds_read_b128 a[164:167], v209 offset:21504
v_mfma_f32_16x16x32_bf16 v[120:123], a[168:171], a[4:7], 0
s_mul_i32 s38, s24, 9216
s_add_u32 m0, s38, 123904
v_mfma_f32_16x16x32_bf16 v[124:127], a[172:175], a[0:3], 0
s_add_u32 s39, s38, s82
v_mfma_f32_16x16x32_bf16 v[128:131], a[172:175], a[4:7], 0
s_waitcnt lgkmcnt(4)
s_add_u32 s39, s39, 303104
v_mfma_f32_16x16x32_bf16 v[116:119], a[144:147], a[8:11], v[116:119]
ds_read_b128 a[168:171], v209 offset:4096
ds_read_b128 a[172:175], v209 offset:22528
v_mfma_f32_16x16x32_bf16 v[120:123], a[144:147], a[12:15], v[120:123]
buffer_load_dwordx4 v1, s[4:7], s39 offen offset:0 sc1 lds
buffer_load_dwordx4 v1, s[4:7], s39 offen offset:1024 sc1 lds
v_mfma_f32_16x16x32_bf16 v[124:127], a[148:151], a[8:11], v[124:127]
buffer_load_dword v15, v14, s[88:91], s37 offen
v_pk_mul_f32 v[216:217], v[100:101], v[100:101]
v_pk_mul_f32 v[218:219], v[102:103], v[102:103]
v_pk_mul_f32 v[220:221], v[104:105], v[104:105]
v_pk_mul_f32 v[222:223], v[106:107], v[106:107]
v_pk_fma_f32 v[216:217], v[216:217], v[252:253], v[250:251] op_sel:[0,0,0] op_sel_hi:[1,0,0]
v_pk_fma_f32 v[218:219], v[218:219], v[252:253], v[250:251] op_sel:[0,0,0] op_sel_hi:[1,0,0]
v_pk_fma_f32 v[220:221], v[220:221], v[252:253], v[250:251] op_sel:[0,1,1] op_sel_hi:[1,1,1]
v_pk_fma_f32 v[222:223], v[222:223], v[252:253], v[250:251] op_sel:[0,1,1] op_sel_hi:[1,1,1]
v_pk_mul_f32 v[92:93], v[92:93], v[224:225]
v_pk_mul_f32 v[94:95], v[94:95], v[226:227]
v_pk_mul_f32 v[96:97], v[96:97], v[228:229]
v_pk_mul_f32 v[98:99], v[98:99], v[230:231]
v_pk_mul_f32 v[216:217], v[216:217], v[100:101]
v_pk_mul_f32 v[218:219], v[218:219], v[102:103]
v_pk_mul_f32 v[220:221], v[220:221], v[104:105]
v_pk_mul_f32 v[222:223], v[222:223], v[106:107]
v_mfma_f32_16x16x32_bf16 v[128:131], a[148:151], a[12:15], v[128:131]
s_waitcnt lgkmcnt(4)
v_exp_f32 v216, v216
v_exp_f32 v217, v217
v_exp_f32 v218, v218
v_fma_f32 v216, v216, v254, v254
v_fma_f32 v217, v217, v254, v254
v_exp_f32 v219, v219
v_exp_f32 v220, v220
v_fma_f32 v218, v218, v254, v254
v_fma_f32 v219, v219, v254, v254
v_exp_f32 v221, v221
v_mfma_f32_16x16x32_bf16 v[116:119], a[152:155], a[16:19], v[116:119]
ds_read_b128 a[144:147], v209 offset:5120
ds_read_b128 a[148:151], v209 offset:23552
v_exp_f32 v222, v222
v_mfma_f32_16x16x32_bf16 v[120:123], a[152:155], a[20:23], v[120:123]
buffer_load_dwordx4 v1, s[4:7], s39 offen offset:2048 sc1 lds
buffer_load_dwordx4 v1, s[4:7], s39 offen offset:3072 sc1 lds
v_mfma_f32_16x16x32_bf16 v[124:127], a[156:159], a[16:19], v[124:127]
s_add_u32 m0, m0, 4096
v_fma_f32 v220, v220, v255, v255
v_fma_f32 v221, v221, v255, v255
v_mfma_f32_16x16x32_bf16 v[128:131], a[156:159], a[20:23], v[128:131]
s_waitcnt lgkmcnt(4)
s_add_u32 s39, s39, 4096
v_exp_f32 v223, v223
v_mfma_f32_16x16x32_bf16 v[116:119], a[160:163], a[24:27], v[116:119]
ds_read_b128 a[152:155], v209 offset:6144
ds_read_b128 a[156:159], v209 offset:24576
v_rcp_f32 v216, v216
v_mfma_f32_16x16x32_bf16 v[120:123], a[160:163], a[28:31], v[120:123]
buffer_load_dwordx4 v1, s[4:7], s39 offen offset:0 sc1 lds
buffer_load_dwordx4 v1, s[4:7], s39 offen offset:1024 sc1 lds
v_mfma_f32_16x16x32_bf16 v[124:127], a[164:167], a[24:27], v[124:127]
v_fma_f32 v222, v222, v255, v255
v_fma_f32 v223, v223, v255, v255
v_mfma_f32_16x16x32_bf16 v[128:131], a[164:167], a[28:31], v[128:131]
s_waitcnt lgkmcnt(4)
v_rcp_f32 v217, v217
v_mfma_f32_16x16x32_bf16 v[116:119], a[168:171], a[32:35], v[116:119]
ds_read_b128 a[160:163], v209 offset:7168
ds_read_b128 a[164:167], v209 offset:25600
v_rcp_f32 v218, v218
v_mfma_f32_16x16x32_bf16 v[120:123], a[168:171], a[36:39], v[120:123]
buffer_load_dwordx4 v1, s[4:7], s39 offen offset:2048 sc1 lds
buffer_load_dwordx4 v1, s[4:7], s39 offen offset:3072 sc1 lds
v_mfma_f32_16x16x32_bf16 v[124:127], a[172:175], a[32:35], v[124:127]
s_add_u32 m0, m0, 4096
s_add_u32 s39, s39, 4096
v_rcp_f32 v219, v219
v_mfma_f32_16x16x32_bf16 v[128:131], a[172:175], a[36:39], v[128:131]
s_waitcnt lgkmcnt(4)
v_rcp_f32 v220, v220
v_mfma_f32_16x16x32_bf16 v[116:119], a[144:147], a[40:43], v[116:119]
ds_read_b128 a[168:171], v209 offset:8192
ds_read_b128 a[172:175], v209 offset:26624
v_rcp_f32 v221, v221
v_rcp_f32 v222, v222
v_rcp_f32 v223, v223
v_mfma_f32_16x16x32_bf16 v[120:123], a[144:147], a[44:47], v[120:123]
buffer_load_dwordx4 v1, s[4:7], s39 offen offset:0 sc1 lds
s_lshl_b32 s38, s24, 8
s_nop 0
v_pk_mul_f32 v[100:101], v[100:101], v[216:217]
v_pk_mul_f32 v[102:103], v[102:103], v[218:219]
v_pk_mul_f32 v[104:105], v[104:105], v[220:221]
v_pk_mul_f32 v[106:107], v[106:107], v[222:223]
v_pk_add_f32 v[198:199], v[36:37], v[38:39]
v_pk_mul_f32 v[200:201], v[36:37], v[36:37]
v_pk_fma_f32 v[200:201], v[38:39], v[38:39], v[200:201]
v_pk_add_f32 v[202:203], v[40:41], v[42:43]
v_pk_mul_f32 v[204:205], v[40:41], v[40:41]
v_pk_fma_f32 v[204:205], v[42:43], v[42:43], v[204:205]
v_pk_add_f32 v[198:199], v[198:199], v[44:45]
v_pk_fma_f32 v[200:201], v[44:45], v[44:45], v[200:201]
v_pk_add_f32 v[198:199], v[198:199], v[46:47]
v_pk_fma_f32 v[200:201], v[46:47], v[46:47], v[200:201]
v_pk_add_f32 v[202:203], v[202:203], v[48:49]
v_pk_fma_f32 v[204:205], v[48:49], v[48:49], v[204:205]
v_pk_add_f32 v[202:203], v[202:203], v[50:51]
v_pk_fma_f32 v[204:205], v[50:51], v[50:51], v[204:205]
v_pk_add_f32 v[198:199], v[198:199], v[52:53]
v_pk_fma_f32 v[200:201], v[52:53], v[52:53], v[200:201]
v_pk_add_f32 v[198:199], v[198:199], v[54:55]
v_pk_fma_f32 v[200:201], v[54:55], v[54:55], v[200:201]
v_pk_add_f32 v[202:203], v[202:203], v[56:57]
v_pk_fma_f32 v[204:205], v[56:57], v[56:57], v[204:205]
v_pk_add_f32 v[202:203], v[202:203], v[58:59]
v_pk_fma_f32 v[204:205], v[58:59], v[58:59], v[204:205]
v_pk_add_f32 v[198:199], v[198:199], v[60:61]
v_pk_fma_f32 v[200:201], v[60:61], v[60:61], v[200:201]
v_pk_add_f32 v[198:199], v[198:199], v[62:63]
v_pk_fma_f32 v[200:201], v[62:63], v[62:63], v[200:201]
v_pk_add_f32 v[202:203], v[202:203], v[64:65]
v_pk_fma_f32 v[204:205], v[64:65], v[64:65], v[204:205]
v_pk_add_f32 v[202:203], v[202:203], v[66:67]
v_pk_fma_f32 v[204:205], v[66:67], v[66:67], v[204:205]
v_pk_add_f32 v[198:199], v[198:199], v[68:69]
v_pk_fma_f32 v[200:201], v[68:69], v[68:69], v[200:201]
v_pk_add_f32 v[198:199], v[198:199], v[70:71]
v_pk_fma_f32 v[200:201], v[70:71], v[70:71], v[200:201]
v_pk_add_f32 v[202:203], v[202:203], v[72:73]
v_pk_fma_f32 v[204:205], v[72:73], v[72:73], v[204:205]
v_pk_add_f32 v[202:203], v[202:203], v[74:75]
v_pk_fma_f32 v[204:205], v[74:75], v[74:75], v[204:205]
v_pk_add_f32 v[198:199], v[198:199], v[76:77]
v_pk_fma_f32 v[200:201], v[76:77], v[76:77], v[200:201]
v_pk_add_f32 v[198:199], v[198:199], v[78:79]
v_pk_fma_f32 v[200:201], v[78:79], v[78:79], v[200:201]
v_pk_add_f32 v[202:203], v[202:203], v[80:81]
v_pk_fma_f32 v[204:205], v[80:81], v[80:81], v[204:205]
v_pk_add_f32 v[202:203], v[202:203], v[82:83]
v_pk_fma_f32 v[204:205], v[82:83], v[82:83], v[204:205]
v_pk_add_f32 v[198:199], v[198:199], v[84:85]
v_pk_fma_f32 v[200:201], v[84:85], v[84:85], v[200:201]
v_pk_add_f32 v[198:199], v[198:199], v[86:87]
v_pk_fma_f32 v[200:201], v[86:87], v[86:87], v[200:201]
v_pk_add_f32 v[202:203], v[202:203], v[88:89]
v_pk_fma_f32 v[204:205], v[88:89], v[88:89], v[204:205]
v_pk_add_f32 v[202:203], v[202:203], v[90:91]
v_pk_fma_f32 v[204:205], v[90:91], v[90:91], v[204:205]
v_pk_add_f32 v[198:199], v[198:199], v[92:93]
v_pk_fma_f32 v[200:201], v[92:93], v[92:93], v[200:201]
v_pk_add_f32 v[198:199], v[198:199], v[94:95]
v_pk_fma_f32 v[200:201], v[94:95], v[94:95], v[200:201]
v_pk_add_f32 v[202:203], v[202:203], v[96:97]
v_pk_fma_f32 v[204:205], v[96:97], v[96:97], v[204:205]
v_pk_add_f32 v[202:203], v[202:203], v[98:99]
v_pk_fma_f32 v[204:205], v[98:99], v[98:99], v[204:205]
v_pk_add_f32 v[198:199], v[198:199], v[100:101]
v_pk_fma_f32 v[200:201], v[100:101], v[100:101], v[200:201]
v_pk_add_f32 v[198:199], v[198:199], v[102:103]
v_pk_fma_f32 v[200:201], v[102:103], v[102:103], v[200:201]
v_pk_add_f32 v[202:203], v[202:203], v[104:105]
v_pk_fma_f32 v[204:205], v[104:105], v[104:105], v[204:205]
v_pk_add_f32 v[202:203], v[202:203], v[106:107]
v_pk_fma_f32 v[204:205], v[106:107], v[106:107], v[204:205]
v_mfma_f32_16x16x32_bf16 v[124:127], a[148:151], a[40:43], v[124:127]
s_add_u32 m0, s38, 160768
v_add_f32 v198, v198, v199
v_add_f32 v202, v202, v203
v_mfma_f32_16x16x32_bf16 v[128:131], a[148:151], a[44:47], v[128:131]
s_waitcnt lgkmcnt(4)
s_add_u32 s39, s38, s82
v_add_f32 v200, v200, v201
v_add_f32 v204, v204, v205
v_permlane16_swap_b32 v198, v202
v_mfma_f32_16x16x32_bf16 v[116:119], a[152:155], a[48:51], v[116:119]
ds_read_b128 a[144:147], v209 offset:9216
ds_read_b128 a[148:151], v209 offset:27648
s_nop 0
v_mfma_f32_16x16x32_bf16 v[120:123], a[152:155], a[52:55], v[120:123]
s_add_u32 s39, s39, 339968
v_permlane16_swap_b32 v200, v204
v_mfma_f32_16x16x32_bf16 v[124:127], a[156:159], a[48:51], v[124:127]
s_mov_b64 exec, 0xffff
buffer_load_dwordx4 v1, s[4:7], s39 offen sc1 lds
s_mov_b64 exec, -1
v_add_f32 v198, v198, v202
v_add_f32 v199, v200, v204
v_mov_b32 v200, v198
v_mfma_f32_16x16x32_bf16 v[128:131], a[156:159], a[52:55], v[128:131]
s_waitcnt lgkmcnt(4)
v_mov_b32 v201, v199
s_nop 0
v_mfma_f32_16x16x32_bf16 v[116:119], a[160:163], a[56:59], v[116:119]
ds_read_b128 a[152:155], v209 offset:10240
ds_read_b128 a[156:159], v209 offset:28672
v_permlane32_swap_b32 v198, v200
v_permlane32_swap_b32 v199, v201
v_mfma_f32_16x16x32_bf16 v[120:123], a[160:163], a[60:63], v[120:123]
v_add_f32 v198, v198, v200
v_add_f32 v199, v199, v201
v_mfma_f32_16x16x32_bf16 v[124:127], a[164:167], a[56:59], v[124:127]
s_mov_b32 exec_hi, 0
buffer_store_dwordx2 v[198:199], v239, s[8:11], s30 offen sc1
s_mov_b64 exec, -1
v_mfma_f32_16x16x32_bf16 v[128:131], a[164:167], a[60:63], v[128:131]
s_waitcnt lgkmcnt(4)
v_mfma_f32_16x16x32_bf16 v[116:119], a[168:171], a[64:67], v[116:119]
ds_read_b128 a[160:163], v209 offset:11264
ds_read_b128 a[164:167], v209 offset:29696
v_mfma_f32_16x16x32_bf16 v[120:123], a[168:171], a[68:71], v[120:123]
v_mfma_f32_16x16x32_bf16 v[124:127], a[172:175], a[64:67], v[124:127]
v_mfma_f32_16x16x32_bf16 v[128:131], a[172:175], a[68:71], v[128:131]
s_waitcnt lgkmcnt(4)
v_mfma_f32_16x16x32_bf16 v[116:119], a[144:147], a[72:75], v[116:119]
ds_read_b128 a[168:171], v209 offset:12288
ds_read_b128 a[172:175], v209 offset:30720
v_mfma_f32_16x16x32_bf16 v[120:123], a[144:147], a[76:79], v[120:123]
v_mfma_f32_16x16x32_bf16 v[124:127], a[148:151], a[72:75], v[124:127]
v_mfma_f32_16x16x32_bf16 v[128:131], a[148:151], a[76:79], v[128:131]
s_waitcnt lgkmcnt(4)
v_mfma_f32_16x16x32_bf16 v[116:119], a[152:155], a[80:83], v[116:119]
ds_read_b128 a[144:147], v209 offset:13312
ds_read_b128 a[148:151], v209 offset:31744
v_mfma_f32_16x16x32_bf16 v[120:123], a[152:155], a[84:87], v[120:123]
v_mfma_f32_16x16x32_bf16 v[124:127], a[156:159], a[80:83], v[124:127]
v_mfma_f32_16x16x32_bf16 v[128:131], a[156:159], a[84:87], v[128:131]
s_waitcnt lgkmcnt(4)
v_mfma_f32_16x16x32_bf16 v[116:119], a[160:163], a[88:91], v[116:119]
ds_read_b128 a[152:155], v209 offset:14336
ds_read_b128 a[156:159], v209 offset:32768
v_mfma_f32_16x16x32_bf16 v[120:123], a[160:163], a[92:95], v[120:123]
v_mfma_f32_16x16x32_bf16 v[124:127], a[164:167], a[88:91], v[124:127]
v_mfma_f32_16x16x32_bf16 v[128:131], a[164:167], a[92:95], v[128:131]
s_waitcnt lgkmcnt(4)
v_mfma_f32_16x16x32_bf16 v[116:119], a[168:171], a[96:99], v[116:119]
ds_read_b128 a[160:163], v209 offset:15360
ds_read_b128 a[164:167], v209 offset:33792
v_mfma_f32_16x16x32_bf16 v[120:123], a[168:171], a[100:103], v[120:123]
v_mfma_f32_16x16x32_bf16 v[124:127], a[172:175], a[96:99], v[124:127]
v_mfma_f32_16x16x32_bf16 v[128:131], a[172:175], a[100:103], v[128:131]
s_waitcnt lgkmcnt(4)
v_mfma_f32_16x16x32_bf16 v[116:119], a[144:147], a[104:107], v[116:119]
ds_read_b128 a[168:171], v209 offset:16384
ds_read_b128 a[172:175], v209 offset:34816
v_mfma_f32_16x16x32_bf16 v[120:123], a[144:147], a[108:111], v[120:123]
v_mfma_f32_16x16x32_bf16 v[124:127], a[148:151], a[104:107], v[124:127]
v_mfma_f32_16x16x32_bf16 v[128:131], a[148:151], a[108:111], v[128:131]
s_waitcnt lgkmcnt(4)
v_mfma_f32_16x16x32_bf16 v[116:119], a[152:155], a[112:115], v[116:119]
ds_read_b128 a[144:147], v209 offset:17408
ds_read_b128 a[148:151], v209 offset:35840
v_mfma_f32_16x16x32_bf16 v[120:123], a[152:155], a[116:119], v[120:123]
v_mfma_f32_16x16x32_bf16 v[124:127], a[156:159], a[112:115], v[124:127]
v_mfma_f32_16x16x32_bf16 v[128:131], a[156:159], a[116:119], v[128:131]
s_waitcnt lgkmcnt(4)
v_add_u32 v181, 36864, v239
v_mfma_f32_16x16x32_bf16 v[116:119], a[160:163], a[120:123], v[116:119]
ds_read_b64 a[152:153], v181 offset:0
ds_read_b64 a[156:157], v181 offset:512
v_mfma_f32_16x16x32_bf16 v[120:123], a[160:163], a[124:127], v[120:123]
v_mfma_f32_16x16x32_bf16 v[124:127], a[164:167], a[120:123], v[124:127]
v_mfma_f32_16x16x32_bf16 v[128:131], a[164:167], a[124:127], v[128:131]
s_waitcnt lgkmcnt(4)
v_mfma_f32_16x16x32_bf16 v[116:119], a[168:171], a[128:131], v[116:119]
ds_read_b128 a[160:163], v210 offset:0
ds_read_b128 a[164:167], v210 offset:18432
v_mfma_f32_16x16x32_bf16 v[120:123], a[168:171], a[132:135], v[120:123]
buffer_load_dwordx2 v[182:183], v234, s[8:11], s61 offen offset:0 sc1
v_mfma_f32_16x16x32_bf16 v[124:127], a[172:175], a[128:131], v[124:127]
buffer_load_dwordx2 v[184:185], v234, s[8:11], s61 offen offset:1024 sc1
v_mfma_f32_16x16x32_bf16 v[128:131], a[172:175], a[132:135], v[128:131]
s_waitcnt lgkmcnt(4)
v_mfma_f32_16x16x32_bf16 v[116:119], a[144:147], a[136:139], v[116:119]
ds_read_b128 a[168:171], v210 offset:1024
ds_read_b128 a[172:175], v210 offset:19456
v_mfma_f32_16x16x32_bf16 v[120:123], a[144:147], a[140:143], v[120:123]
buffer_load_dwordx2 v[186:187], v234, s[8:11], s61 offen offset:2048 sc1
v_mfma_f32_16x16x32_bf16 v[124:127], a[148:151], a[136:139], v[124:127]
buffer_load_dwordx2 v[188:189], v234, s[8:11], s61 offen offset:3072 sc1
v_mfma_f32_16x16x32_bf16 v[128:131], a[148:151], a[140:143], v[128:131]
s_waitcnt lgkmcnt(4)
v_mfma_f32_16x16x16_bf16 v[116:119], a[152:153], v[212:213], v[116:119]
ds_read_b128 a[144:147], v210 offset:2048
ds_read_b128 a[148:151], v210 offset:20480
v_mfma_f32_16x16x16_bf16 v[120:123], a[152:153], v[214:215], v[120:123]
buffer_load_dwordx2 v[190:191], v235, s[8:11], s61 offen offset:0 sc1
v_mfma_f32_16x16x16_bf16 v[124:127], a[156:157], v[212:213], v[124:127]
buffer_load_dwordx2 v[192:193], v235, s[8:11], s61 offen offset:1024 sc1
v_mfma_f32_16x16x16_bf16 v[128:131], a[156:157], v[214:215], v[128:131]
s_waitcnt vmcnt(18) lgkmcnt(4)
s_barrier
v_mfma_f32_16x16x32_bf16 v[132:135], a[160:163], a[0:3], 0
ds_read_b128 a[152:155], v210 offset:3072
ds_read_b128 a[156:159], v210 offset:21504
v_mfma_f32_16x16x32_bf16 v[136:139], a[160:163], a[4:7], 0
buffer_load_dwordx2 v[194:195], v235, s[8:11], s61 offen offset:2048 sc1
v_mfma_f32_16x16x32_bf16 v[140:143], a[164:167], a[0:3], 0
buffer_load_dwordx2 v[196:197], v235, s[8:11], s61 offen offset:3072 sc1
v_mfma_f32_16x16x32_bf16 v[144:147], a[164:167], a[4:7], 0
s_waitcnt lgkmcnt(4)
v_mfma_f32_16x16x32_bf16 v[132:135], a[168:171], a[8:11], v[132:135]
ds_read_b128 a[160:163], v210 offset:4096
ds_read_b128 a[164:167], v210 offset:22528
v_mfma_f32_16x16x32_bf16 v[136:139], a[168:171], a[12:15], v[136:139]
v_mfma_f32_16x16x32_bf16 v[140:143], a[172:175], a[8:11], v[140:143]
v_mfma_f32_16x16x32_bf16 v[144:147], a[172:175], a[12:15], v[144:147]
s_waitcnt lgkmcnt(4)
v_mfma_f32_16x16x32_bf16 v[132:135], a[144:147], a[16:19], v[132:135]
ds_read_b128 a[168:171], v210 offset:5120
ds_read_b128 a[172:175], v210 offset:23552
v_mfma_f32_16x16x32_bf16 v[136:139], a[144:147], a[20:23], v[136:139]
v_mfma_f32_16x16x32_bf16 v[140:143], a[148:151], a[16:19], v[140:143]
v_mfma_f32_16x16x32_bf16 v[144:147], a[148:151], a[20:23], v[144:147]
s_waitcnt lgkmcnt(4)
v_mfma_f32_16x16x32_bf16 v[132:135], a[152:155], a[24:27], v[132:135]
ds_read_b128 a[144:147], v210 offset:6144
ds_read_b128 a[148:151], v210 offset:24576
v_mfma_f32_16x16x32_bf16 v[136:139], a[152:155], a[28:31], v[136:139]
v_mfma_f32_16x16x32_bf16 v[140:143], a[156:159], a[24:27], v[140:143]
v_mfma_f32_16x16x32_bf16 v[144:147], a[156:159], a[28:31], v[144:147]
s_waitcnt lgkmcnt(4)
v_mfma_f32_16x16x32_bf16 v[132:135], a[160:163], a[32:35], v[132:135]
ds_read_b128 a[152:155], v210 offset:7168
ds_read_b128 a[156:159], v210 offset:25600
v_mfma_f32_16x16x32_bf16 v[136:139], a[160:163], a[36:39], v[136:139]
v_mfma_f32_16x16x32_bf16 v[140:143], a[164:167], a[32:35], v[140:143]
v_mfma_f32_16x16x32_bf16 v[144:147], a[164:167], a[36:39], v[144:147]
s_waitcnt lgkmcnt(4)
v_mfma_f32_16x16x32_bf16 v[132:135], a[168:171], a[40:43], v[132:135]
ds_read_b128 a[160:163], v210 offset:8192
ds_read_b128 a[164:167], v210 offset:26624
v_mfma_f32_16x16x32_bf16 v[136:139], a[168:171], a[44:47], v[136:139]
v_mfma_f32_16x16x32_bf16 v[140:143], a[172:175], a[40:43], v[140:143]
v_mfma_f32_16x16x32_bf16 v[144:147], a[172:175], a[44:47], v[144:147]
s_waitcnt lgkmcnt(4)
v_mfma_f32_16x16x32_bf16 v[132:135], a[144:147], a[48:51], v[132:135]
ds_read_b128 a[168:171], v210 offset:9216
ds_read_b128 a[172:175], v210 offset:27648
v_mfma_f32_16x16x32_bf16 v[136:139], a[144:147], a[52:55], v[136:139]
v_mfma_f32_16x16x32_bf16 v[140:143], a[148:151], a[48:51], v[140:143]
v_mfma_f32_16x16x32_bf16 v[144:147], a[148:151], a[52:55], v[144:147]
s_waitcnt lgkmcnt(4)
v_mfma_f32_16x16x32_bf16 v[132:135], a[152:155], a[56:59], v[132:135]
ds_read_b128 a[144:147], v210 offset:10240
ds_read_b128 a[148:151], v210 offset:28672
v_mfma_f32_16x16x32_bf16 v[136:139], a[152:155], a[60:63], v[136:139]
v_mfma_f32_16x16x32_bf16 v[140:143], a[156:159], a[56:59], v[140:143]
v_mfma_f32_16x16x32_bf16 v[144:147], a[156:159], a[60:63], v[144:147]
s_waitcnt lgkmcnt(4)
v_mfma_f32_16x16x32_bf16 v[132:135], a[160:163], a[64:67], v[132:135]
ds_read_b128 a[152:155], v210 offset:11264
ds_read_b128 a[156:159], v210 offset:29696
v_mfma_f32_16x16x32_bf16 v[136:139], a[160:163], a[68:71], v[136:139]
v_mfma_f32_16x16x32_bf16 v[140:143], a[164:167], a[64:67], v[140:143]
v_mfma_f32_16x16x32_bf16 v[144:147], a[164:167], a[68:71], v[144:147]
s_waitcnt lgkmcnt(4)
v_mfma_f32_16x16x32_bf16 v[132:135], a[168:171], a[72:75], v[132:135]
ds_read_b128 a[160:163], v210 offset:12288
ds_read_b128 a[164:167], v210 offset:30720
v_mfma_f32_16x16x32_bf16 v[136:139], a[168:171], a[76:79], v[136:139]
v_mfma_f32_16x16x32_bf16 v[140:143], a[172:175], a[72:75], v[140:143]
s_waitcnt vmcnt(0)
v_min3_f32 v200, v183, v185, v187
v_mfma_f32_16x16x32_bf16 v[144:147], a[172:175], a[76:79], v[144:147]
s_waitcnt lgkmcnt(4)
v_min3_f32 v201, v189, v191, v193
v_min3_f32 v200, v200, v195, v197
v_mfma_f32_16x16x32_bf16 v[132:135], a[144:147], a[80:83], v[132:135]
ds_read_b128 a[168:171], v210 offset:13312
ds_read_b128 a[172:175], v210 offset:31744
v_mfma_f32_16x16x32_bf16 v[136:139], a[144:147], a[84:87], v[136:139]
v_min_f32 v200, v200, v201
v_cmp_gt_f32 vcc, 0, v200
v_mfma_f32_16x16x32_bf16 v[140:143], a[148:151], a[80:83], v[140:143]
s_nop 0
s_cbranch_vccnz L_stzslow_23
L_stzback_24:
v_mfma_f32_16x16x32_bf16 v[144:147], a[148:151], a[84:87], v[144:147]
s_waitcnt lgkmcnt(4)
v_add_f32 v198, v182, v184
v_add_f32 v199, v183, v185
v_mfma_f32_16x16x32_bf16 v[132:135], a[152:155], a[88:91], v[132:135]
ds_read_b128 a[144:147], v210 offset:14336
ds_read_b128 a[148:151], v210 offset:32768
v_mfma_f32_16x16x32_bf16 v[136:139], a[152:155], a[92:95], v[136:139]
v_add_f32 v198, v198, v186
v_add_f32 v199, v199, v187
v_mfma_f32_16x16x32_bf16 v[140:143], a[156:159], a[88:91], v[140:143]
v_add_f32 v198, v198, v188
v_add_f32 v199, v199, v189
v_mfma_f32_16x16x32_bf16 v[144:147], a[156:159], a[92:95], v[144:147]
s_waitcnt lgkmcnt(4)
v_add_f32 v198, v198, v190
v_add_f32 v199, v199, v191
v_mfma_f32_16x16x32_bf16 v[132:135], a[160:163], a[96:99], v[132:135]
ds_read_b128 a[152:155], v210 offset:15360
ds_read_b128 a[156:159], v210 offset:33792
v_add_f32 v198, v198, v192
v_mfma_f32_16x16x32_bf16 v[136:139], a[160:163], a[100:103], v[136:139]
v_add_f32 v199, v199, v193
v_add_f32 v198, v198, v194
v_mfma_f32_16x16x32_bf16 v[140:143], a[164:167], a[96:99], v[140:143]
v_add_f32 v199, v199, v195
v_add_f32 v198, v198, v196
v_mfma_f32_16x16x32_bf16 v[144:147], a[164:167], a[100:103], v[144:147]
s_waitcnt lgkmcnt(4)
v_add_f32 v199, v199, v197
v_mov_b32 v200, v198
v_mfma_f32_16x16x32_bf16 v[132:135], a[168:171], a[104:107], v[132:135]
ds_read_b128 a[160:163], v210 offset:16384
ds_read_b128 a[164:167], v210 offset:34816
v_mov_b32 v201, v199
v_mfma_f32_16x16x32_bf16 v[136:139], a[168:171], a[108:111], v[136:139]
s_nop 0
v_permlane32_swap_b32 v198, v200
v_mfma_f32_16x16x32_bf16 v[140:143], a[172:175], a[104:107], v[140:143]
v_permlane32_swap_b32 v199, v201
v_mfma_f32_16x16x32_bf16 v[144:147], a[172:175], a[108:111], v[144:147]
s_waitcnt lgkmcnt(4)
v_add_f32 v198, v198, v200
v_add_f32 v199, v199, v201
v_mfma_f32_16x16x32_bf16 v[132:135], a[144:147], a[112:115], v[132:135]
ds_read_b128 a[168:171], v210 offset:17408
ds_read_b128 a[172:175], v210 offset:35840
v_mfma_f32_16x16x32_bf16 v[136:139], a[144:147], a[116:119], v[136:139]
v_mul_f32 v198, 0x39e38e39, v198
v_mul_f32 v200, v198, v198
v_mfma_f32_16x16x32_bf16 v[140:143], a[148:151], a[112:115], v[140:143]
v_mul_f32 v199, 0x39e38e39, v199
v_sub_f32 v199, v199, v200
v_mfma_f32_16x16x32_bf16 v[144:147], a[148:151], a[116:119], v[144:147]
s_waitcnt lgkmcnt(4)
v_max_f32 v199, 0, v199
v_add_u32 v181, 74752, v239
v_mfma_f32_16x16x32_bf16 v[132:135], a[152:155], a[120:123], v[132:135]
ds_read_b64 a[144:145], v181 offset:0
ds_read_b64 a[148:149], v181 offset:512
v_add_f32 v199, 0x3727c5ac, v199
v_rsq_f32 v202, v199
v_mfma_f32_16x16x32_bf16 v[136:139], a[152:155], a[124:127], v[136:139]
s_nop 0
v_mul_f32 v204, v198, v202
v_mov_b32 v203, v202
v_mfma_f32_16x16x32_bf16 v[140:143], a[156:159], a[120:123], v[140:143]
v_mov_b32 v205, v204
v_mfma_f32_16x16x32_bf16 v[144:147], a[156:159], a[124:127], v[144:147]
s_waitcnt lgkmcnt(4)
s_nop 0
v_mfma_f32_16x16x32_bf16 v[132:135], a[160:163], a[128:131], v[132:135]
ds_read_b128 a[152:155], v211 offset:0
ds_read_b128 a[156:159], v211 offset:18432
v_permlane16_swap_b32 v202, v203
v_mfma_f32_16x16x32_bf16 v[136:139], a[160:163], a[132:135], v[136:139]
v_permlane16_swap_b32 v204, v205
v_mfma_f32_16x16x32_bf16 v[140:143], a[164:167], a[128:131], v[140:143]
v_fma_f32 v36, v36, v202, -v204
v_fma_f32 v37, v37, v202, -v204
v_mfma_f32_16x16x32_bf16 v[144:147], a[164:167], a[132:135], v[144:147]
s_waitcnt lgkmcnt(4)
v_fma_f32 v38, v38, v202, -v204
v_fma_f32 v39, v39, v202, -v204
v_mfma_f32_16x16x32_bf16 v[132:135], a[168:171], a[136:139], v[132:135]
ds_read_b128 a[160:163], v211 offset:1024
ds_read_b128 a[164:167], v211 offset:19456
v_mfma_f32_16x16x32_bf16 v[136:139], a[168:171], a[140:143], v[136:139]
v_fma_f32 v44, v44, v202, -v204
v_fma_f32 v45, v45, v202, -v204
v_mfma_f32_16x16x32_bf16 v[140:143], a[172:175], a[136:139], v[140:143]
v_fma_f32 v46, v46, v202, -v204
v_fma_f32 v47, v47, v202, -v204
v_mfma_f32_16x16x32_bf16 v[144:147], a[172:175], a[140:143], v[144:147]
s_waitcnt lgkmcnt(4)
v_cvt_pk_bf16_f32 v216, v36, v37
v_cvt_pk_bf16_f32 v217, v38, v39
v_mfma_f32_16x16x16_bf16 v[132:135], a[144:145], v[212:213], v[132:135]
ds_read_b128 a[168:171], v211 offset:2048
ds_read_b128 a[172:175], v211 offset:20480
v_cvt_pk_bf16_f32 v218, v44, v45
v_mfma_f32_16x16x16_bf16 v[136:139], a[144:145], v[214:215], v[136:139]
v_cvt_pk_bf16_f32 v219, v46, v47
v_mfma_f32_16x16x16_bf16 v[140:143], a[148:149], v[212:213], v[140:143]
ds_write_b128 v236, v[216:219] offset:0
v_fma_f32 v40, v40, v203, -v205
v_mfma_f32_16x16x16_bf16 v[144:147], a[148:149], v[214:215], v[144:147]
s_waitcnt lgkmcnt(5)
v_fma_f32 v41, v41, v203, -v205
v_fma_f32 v42, v42, v203, -v205
s_barrier
v_mfma_f32_16x16x32_bf16 v[148:151], a[152:155], a[0:3], 0
ds_read_b128 a[144:147], v211 offset:3072
ds_read_b128 a[148:151], v211 offset:21504
v_fma_f32 v43, v43, v203, -v205
v_fma_f32 v48, v48, v203, -v205
v_mfma_f32_16x16x32_bf16 v[152:155], a[152:155], a[4:7], 0
v_fma_f32 v49, v49, v203, -v205
v_fma_f32 v50, v50, v203, -v205
v_mfma_f32_16x16x32_bf16 v[156:159], a[156:159], a[0:3], 0
v_fma_f32 v51, v51, v203, -v205
v_cvt_pk_bf16_f32 v220, v40, v41
v_mfma_f32_16x16x32_bf16 v[160:163], a[156:159], a[4:7], 0
s_waitcnt lgkmcnt(5)
v_cvt_pk_bf16_f32 v221, v42, v43
v_cvt_pk_bf16_f32 v222, v48, v49
v_mfma_f32_16x16x32_bf16 v[148:151], a[160:163], a[8:11], v[148:151]
ds_read_b128 a[152:155], v211 offset:4096
ds_read_b128 a[156:159], v211 offset:22528
v_cvt_pk_bf16_f32 v223, v50, v51
v_mfma_f32_16x16x32_bf16 v[152:155], a[160:163], a[12:15], v[152:155]
ds_write_b128 v236, v[220:223] offset:4608
v_mfma_f32_16x16x32_bf16 v[156:159], a[164:167], a[8:11], v[156:159]
ds_read_b64_tr_b16 v[36:37], v237 offset:0
ds_read_b64_tr_b16 v[38:39], v237 offset:1152
ds_read_b64_tr_b16 v[40:41], v237 offset:8
ds_read_b64_tr_b16 v[42:43], v237 offset:1160
v_mfma_f32_16x16x32_bf16 v[160:163], a[164:167], a[12:15], v[160:163]
s_waitcnt lgkmcnt(10)
v_fma_f32 v52, v52, v202, -v204
v_fma_f32 v53, v53, v202, -v204
v_mfma_f32_16x16x32_bf16 v[148:151], a[168:171], a[16:19], v[148:151]
ds_read_b128 a[160:163], v211 offset:5120
ds_read_b128 a[164:167], v211 offset:23552
v_mfma_f32_16x16x32_bf16 v[152:155], a[168:171], a[20:23], v[152:155]
v_fma_f32 v54, v54, v202, -v204
v_fma_f32 v55, v55, v202, -v204
v_mfma_f32_16x16x32_bf16 v[156:159], a[172:175], a[16:19], v[156:159]
v_fma_f32 v60, v60, v202, -v204
v_mfma_f32_16x16x32_bf16 v[160:163], a[172:175], a[20:23], v[160:163]
s_waitcnt lgkmcnt(9)
v_fma_f32 v61, v61, v202, -v204
v_mfma_f32_16x16x32_bf16 v[148:151], a[144:147], a[24:27], v[148:151]
ds_read_b128 a[168:171], v211 offset:6144
ds_read_b128 a[172:175], v211 offset:24576
v_mfma_f32_16x16x32_bf16 v[152:155], a[144:147], a[28:31], v[152:155]
v_fma_f32 v62, v62, v202, -v204
v_fma_f32 v63, v63, v202, -v204
v_mfma_f32_16x16x32_bf16 v[156:159], a[148:151], a[24:27], v[156:159]
v_cvt_pk_bf16_f32 v224, v52, v53
v_cvt_pk_bf16_f32 v225, v54, v55
v_mfma_f32_16x16x32_bf16 v[160:163], a[148:151], a[28:31], v[160:163]
s_waitcnt lgkmcnt(9)
v_cvt_pk_bf16_f32 v226, v60, v61
v_mfma_f32_16x16x32_bf16 v[148:151], a[152:155], a[32:35], v[148:151]
ds_read_b128 a[144:147], v211 offset:7168
ds_read_b128 a[148:151], v211 offset:25600
v_mfma_f32_16x16x32_bf16 v[152:155], a[152:155], a[36:39], v[152:155]
v_cvt_pk_bf16_f32 v227, v62, v63
v_mfma_f32_16x16x32_bf16 v[156:159], a[156:159], a[32:35], v[156:159]
ds_write_b128 v236, v[224:227] offset:64
v_mfma_f32_16x16x32_bf16 v[160:163], a[156:159], a[36:39], v[160:163]
s_waitcnt lgkmcnt(5)
buffer_store_dwordx4 v[36:39], v1, s[8:11], s66 offen offset:0 sc1
v_mfma_f32_16x16x32_bf16 v[148:151], a[160:163], a[40:43], v[148:151]
ds_read_b128 a[152:155], v211 offset:8192
ds_read_b128 a[156:159], v211 offset:26624
v_mfma_f32_16x16x32_bf16 v[152:155], a[160:163], a[44:47], v[152:155]
v_fma_f32 v56, v56, v203, -v205
v_fma_f32 v57, v57, v203, -v205
v_mfma_f32_16x16x32_bf16 v[156:159], a[164:167], a[40:43], v[156:159]
v_fma_f32 v58, v58, v203, -v205
v_fma_f32 v59, v59, v203, -v205
v_mfma_f32_16x16x32_bf16 v[160:163], a[164:167], a[44:47], v[160:163]
s_waitcnt lgkmcnt(5)
v_fma_f32 v64, v64, v203, -v205
v_fma_f32 v65, v65, v203, -v205
v_mfma_f32_16x16x32_bf16 v[148:151], a[168:171], a[48:51], v[148:151]
ds_read_b128 a[160:163], v211 offset:9216
ds_read_b128 a[164:167], v211 offset:27648
v_mfma_f32_16x16x32_bf16 v[152:155], a[168:171], a[52:55], v[152:155]
v_fma_f32 v66, v66, v203, -v205
v_fma_f32 v67, v67, v203, -v205
v_mfma_f32_16x16x32_bf16 v[156:159], a[172:175], a[48:51], v[156:159]
v_cvt_pk_bf16_f32 v228, v56, v57
v_cvt_pk_bf16_f32 v229, v58, v59
v_mfma_f32_16x16x32_bf16 v[160:163], a[172:175], a[52:55], v[160:163]
s_waitcnt lgkmcnt(5)
v_cvt_pk_bf16_f32 v230, v64, v65
v_cvt_pk_bf16_f32 v231, v66, v67
v_mfma_f32_16x16x32_bf16 v[148:151], a[144:147], a[56:59], v[148:151]
ds_read_b128 a[168:171], v211 offset:10240
ds_read_b128 a[172:175], v211 offset:28672
v_mfma_f32_16x16x32_bf16 v[152:155], a[144:147], a[60:63], v[152:155]
ds_write_b128 v236, v[228:231] offset:4672
v_mfma_f32_16x16x32_bf16 v[156:159], a[148:151], a[56:59], v[156:159]
ds_read_b64_tr_b16 v[52:53], v237 offset:64
ds_read_b64_tr_b16 v[54:55], v237 offset:1216
v_mfma_f32_16x16x32_bf16 v[160:163], a[148:151], a[60:63], v[160:163]
s_waitcnt lgkmcnt(7)
v_mfma_f32_16x16x32_bf16 v[148:151], a[152:155], a[64:67], v[148:151]
ds_read_b128 a[144:147], v211 offset:11264
ds_read_b128 a[148:151], v211 offset:29696
ds_read_b64_tr_b16 v[56:57], v237 offset:72
ds_read_b64_tr_b16 v[58:59], v237 offset:1224
buffer_store_dwordx4 v[40:43], v1, s[8:11], s66 offen offset:1024 sc1
v_mfma_f32_16x16x32_bf16 v[152:155], a[152:155], a[68:71], v[152:155]
v_fma_f32 v68, v68, v202, -v204
v_fma_f32 v69, v69, v202, -v204
v_mfma_f32_16x16x32_bf16 v[156:159], a[156:159], a[64:67], v[156:159]
v_fma_f32 v70, v70, v202, -v204
v_mfma_f32_16x16x32_bf16 v[160:163], a[156:159], a[68:71], v[160:163]
s_waitcnt lgkmcnt(9)
v_fma_f32 v71, v71, v202, -v204
v_mfma_f32_16x16x32_bf16 v[148:151], a[160:163], a[72:75], v[148:151]
ds_read_b128 a[152:155], v211 offset:12288
ds_read_b128 a[156:159], v211 offset:30720
v_mfma_f32_16x16x32_bf16 v[152:155], a[160:163], a[76:79], v[152:155]
v_fma_f32 v76, v76, v202, -v204
v_fma_f32 v77, v77, v202, -v204
v_mfma_f32_16x16x32_bf16 v[156:159], a[164:167], a[72:75], v[156:159]
v_fma_f32 v78, v78, v202, -v204
v_mfma_f32_16x16x32_bf16 v[160:163], a[164:167], a[76:79], v[160:163]
s_waitcnt lgkmcnt(9)
v_fma_f32 v79, v79, v202, -v204
v_cvt_pk_bf16_f32 v216, v68, v69
v_mfma_f32_16x16x32_bf16 v[148:151], a[168:171], a[80:83], v[148:151]
ds_read_b128 a[160:163], v211 offset:13312
ds_read_b128 a[164:167], v211 offset:31744
v_mfma_f32_16x16x32_bf16 v[152:155], a[168:171], a[84:87], v[152:155]
v_cvt_pk_bf16_f32 v217, v70, v71
v_cvt_pk_bf16_f32 v218, v76, v77
v_mfma_f32_16x16x32_bf16 v[156:159], a[172:175], a[80:83], v[156:159]
v_cvt_pk_bf16_f32 v219, v78, v79
v_mfma_f32_16x16x32_bf16 v[160:163], a[172:175], a[84:87], v[160:163]
s_waitcnt lgkmcnt(6)
v_mfma_f32_16x16x32_bf16 v[148:151], a[144:147], a[88:91], v[148:151]
ds_read_b128 a[168:171], v211 offset:14336
ds_read_b128 a[172:175], v211 offset:32768
v_mfma_f32_16x16x32_bf16 v[152:155], a[144:147], a[92:95], v[152:155]
ds_write_b128 v236, v[216:219] offset:128
buffer_store_dwordx4 v[52:55], v1, s[8:11], s66 offen offset:2048 sc1
v_mfma_f32_16x16x32_bf16 v[156:159], a[148:151], a[88:91], v[156:159]
v_fma_f32 v72, v72, v203, -v205
v_fma_f32 v73, v73, v203, -v205
v_mfma_f32_16x16x32_bf16 v[160:163], a[148:151], a[92:95], v[160:163]
s_waitcnt lgkmcnt(5)
v_fma_f32 v74, v74, v203, -v205
v_mfma_f32_16x16x32_bf16 v[148:151], a[152:155], a[96:99], v[148:151]
ds_read_b128 a[144:147], v211 offset:15360
ds_read_b128 a[148:151], v211 offset:33792
v_mfma_f32_16x16x32_bf16 v[152:155], a[152:155], a[100:103], v[152:155]
v_fma_f32 v75, v75, v203, -v205
v_fma_f32 v80, v80, v203, -v205
v_mfma_f32_16x16x32_bf16 v[156:159], a[156:159], a[96:99], v[156:159]
v_fma_f32 v81, v81, v203, -v205
v_fma_f32 v82, v82, v203, -v205
v_mfma_f32_16x16x32_bf16 v[160:163], a[156:159], a[100:103], v[160:163]
s_waitcnt lgkmcnt(5)
v_fma_f32 v83, v83, v203, -v205
v_cvt_pk_bf16_f32 v220, v72, v73
v_mfma_f32_16x16x32_bf16 v[148:151], a[160:163], a[104:107], v[148:151]
ds_read_b128 a[152:155], v211 offset:16384
ds_read_b128 a[156:159], v211 offset:34816
v_mfma_f32_16x16x32_bf16 v[152:155], a[160:163], a[108:111], v[152:155]
v_cvt_pk_bf16_f32 v221, v74, v75
v_cvt_pk_bf16_f32 v222, v80, v81
v_mfma_f32_16x16x32_bf16 v[156:159], a[164:167], a[104:107], v[156:159]
v_cvt_pk_bf16_f32 v223, v82, v83
v_mfma_f32_16x16x32_bf16 v[160:163], a[164:167], a[108:111], v[160:163]
s_waitcnt lgkmcnt(5)
v_mfma_f32_16x16x32_bf16 v[148:151], a[168:171], a[112:115], v[148:151]
ds_read_b128 a[160:163], v211 offset:17408
ds_read_b128 a[164:167], v211 offset:35840
v_mfma_f32_16x16x32_bf16 v[152:155], a[168:171], a[116:119], v[152:155]
ds_write_b128 v236, v[220:223] offset:4736
v_mfma_f32_16x16x32_bf16 v[156:159], a[172:175], a[112:115], v[156:159]
ds_read_b64_tr_b16 v[68:69], v237 offset:128
ds_read_b64_tr_b16 v[70:71], v237 offset:1280
ds_read_b64_tr_b16 v[72:73], v237 offset:136
ds_read_b64_tr_b16 v[74:75], v237 offset:1288
buffer_store_dwordx4 v[56:59], v1, s[8:11], s66 offen offset:3072 sc1
v_mfma_f32_16x16x32_bf16 v[160:163], a[172:175], a[116:119], v[160:163]
s_waitcnt lgkmcnt(9)
v_fma_f32 v84, v84, v202, -v204
v_add_u32 v181, 112640, v239
v_mfma_f32_16x16x32_bf16 v[148:151], a[144:147], a[120:123], v[148:151]
ds_read_b64 a[168:169], v181 offset:0
ds_read_b64 a[172:173], v181 offset:512
v_mfma_f32_16x16x32_bf16 v[152:155], a[144:147], a[124:127], v[152:155]
v_fma_f32 v85, v85, v202, -v204
v_fma_f32 v86, v86, v202, -v204
v_mfma_f32_16x16x32_bf16 v[156:159], a[148:151], a[120:123], v[156:159]
v_fma_f32 v87, v87, v202, -v204
v_fma_f32 v92, v92, v202, -v204
v_mfma_f32_16x16x32_bf16 v[160:163], a[148:151], a[124:127], v[160:163]
s_waitcnt lgkmcnt(9)
v_fma_f32 v93, v93, v202, -v204
v_fma_f32 v94, v94, v202, -v204
v_mfma_f32_16x16x32_bf16 v[148:151], a[152:155], a[128:131], v[148:151]
ds_read_b128 a[144:147], v208 offset:0
ds_read_b128 a[148:151], v208 offset:18432
v_mfma_f32_16x16x32_bf16 v[152:155], a[152:155], a[132:135], v[152:155]
v_fma_f32 v95, v95, v202, -v204
v_cvt_pk_bf16_f32 v224, v84, v85
v_mfma_f32_16x16x32_bf16 v[156:159], a[156:159], a[128:131], v[156:159]
v_cvt_pk_bf16_f32 v225, v86, v87
v_mfma_f32_16x16x32_bf16 v[160:163], a[156:159], a[132:135], v[160:163]
s_waitcnt lgkmcnt(9)
v_cvt_pk_bf16_f32 v226, v92, v93
v_cvt_pk_bf16_f32 v227, v94, v95
v_mfma_f32_16x16x32_bf16 v[148:151], a[160:163], a[136:139], v[148:151]
ds_read_b128 a[152:155], v208 offset:1024
ds_read_b128 a[156:159], v208 offset:19456
v_mfma_f32_16x16x32_bf16 v[152:155], a[160:163], a[140:143], v[152:155]
ds_write_b128 v236, v[224:227] offset:192
v_mfma_f32_16x16x32_bf16 v[156:159], a[164:167], a[136:139], v[156:159]
s_add_u32 s66, s66, 4096
s_waitcnt lgkmcnt(9)
v_mfma_f32_16x16x32_bf16 v[160:163], a[164:167], a[140:143], v[160:163]
s_waitcnt lgkmcnt(5)
buffer_store_dwordx4 v[68:71], v1, s[8:11], s66 offen offset:0 sc1
v_mfma_f32_16x16x16_bf16 v[148:151], a[168:169], v[212:213], v[148:151]
ds_read_b128 a[160:163], v208 offset:2048
ds_read_b128 a[164:167], v208 offset:20480
v_mfma_f32_16x16x16_bf16 v[152:155], a[168:169], v[214:215], v[152:155]
v_fma_f32 v88, v88, v203, -v205
v_fma_f32 v89, v89, v203, -v205
v_mfma_f32_16x16x16_bf16 v[156:159], a[172:173], v[212:213], v[156:159]
v_fma_f32 v90, v90, v203, -v205
v_fma_f32 v91, v91, v203, -v205
v_mfma_f32_16x16x16_bf16 v[160:163], a[172:173], v[214:215], v[160:163]
s_waitcnt lgkmcnt(5)
v_fma_f32 v96, v96, v203, -v205
v_fma_f32 v97, v97, v203, -v205
v_mfma_f32_16x16x32_bf16 v[164:167], a[144:147], a[0:3], 0
ds_read_b128 a[168:171], v208 offset:3072
ds_read_b128 a[172:175], v208 offset:21504
v_mfma_f32_16x16x32_bf16 v[168:171], a[144:147], a[4:7], 0
v_fma_f32 v98, v98, v203, -v205
v_fma_f32 v99, v99, v203, -v205
v_mfma_f32_16x16x32_bf16 v[172:175], a[148:151], a[0:3], 0
v_cvt_pk_bf16_f32 v228, v88, v89
v_cvt_pk_bf16_f32 v229, v90, v91
v_mfma_f32_16x16x32_bf16 v[176:179], a[148:151], a[4:7], 0
s_waitcnt lgkmcnt(5)
v_cvt_pk_bf16_f32 v230, v96, v97
v_cvt_pk_bf16_f32 v231, v98, v99
v_mfma_f32_16x16x32_bf16 v[164:167], a[152:155], a[8:11], v[164:167]
ds_read_b128 a[144:147], v208 offset:4096
ds_read_b128 a[148:151], v208 offset:22528
v_mfma_f32_16x16x32_bf16 v[168:171], a[152:155], a[12:15], v[168:171]
ds_write_b128 v236, v[228:231] offset:4800
v_mfma_f32_16x16x32_bf16 v[172:175], a[156:159], a[8:11], v[172:175]
ds_read_b64_tr_b16 v[84:85], v237 offset:192
ds_read_b64_tr_b16 v[86:87], v237 offset:1344
v_mfma_f32_16x16x32_bf16 v[176:179], a[156:159], a[12:15], v[176:179]
s_waitcnt lgkmcnt(7)
v_mfma_f32_16x16x32_bf16 v[164:167], a[160:163], a[16:19], v[164:167]
ds_read_b128 a[152:155], v208 offset:5120
ds_read_b128 a[156:159], v208 offset:23552
ds_read_b64_tr_b16 v[88:89], v237 offset:200
ds_read_b64_tr_b16 v[90:91], v237 offset:1352
buffer_store_dwordx4 v[72:75], v1, s[8:11], s66 offen offset:1024 sc1
v_mfma_f32_16x16x32_bf16 v[168:171], a[160:163], a[20:23], v[168:171]
v_fma_f32 v100, v100, v202, -v204
v_fma_f32 v101, v101, v202, -v204
v_mfma_f32_16x16x32_bf16 v[172:175], a[164:167], a[16:19], v[172:175]
v_fma_f32 v102, v102, v202, -v204
v_mfma_f32_16x16x32_bf16 v[176:179], a[164:167], a[20:23], v[176:179]
s_waitcnt lgkmcnt(9)
v_fma_f32 v103, v103, v202, -v204
v_fma_f32 v104, v104, v203, -v205
v_mfma_f32_16x16x32_bf16 v[164:167], a[168:171], a[24:27], v[164:167]
ds_read_b128 a[160:163], v208 offset:6144
ds_read_b128 a[164:167], v208 offset:24576
v_mfma_f32_16x16x32_bf16 v[168:171], a[168:171], a[28:31], v[168:171]
v_fma_f32 v105, v105, v203, -v205
v_fma_f32 v106, v106, v203, -v205
v_mfma_f32_16x16x32_bf16 v[172:175], a[172:175], a[24:27], v[172:175]
v_fma_f32 v107, v107, v203, -v205
v_cvt_pk_bf16_f32 v216, v100, v101
v_mfma_f32_16x16x32_bf16 v[176:179], a[172:175], a[28:31], v[176:179]
s_waitcnt lgkmcnt(9)
v_cvt_pk_bf16_f32 v217, v102, v103
v_mfma_f32_16x16x32_bf16 v[164:167], a[144:147], a[32:35], v[164:167]
ds_read_b128 a[168:171], v208 offset:7168
ds_read_b128 a[172:175], v208 offset:25600
v_mfma_f32_16x16x32_bf16 v[168:171], a[144:147], a[36:39], v[168:171]
v_cvt_pk_bf16_f32 v218, v104, v105
v_cvt_pk_bf16_f32 v219, v106, v107
v_mfma_f32_16x16x32_bf16 v[172:175], a[148:151], a[32:35], v[172:175]
ds_write_b64 v7, v[216:217] offset:256
v_mfma_f32_16x16x32_bf16 v[176:179], a[148:151], a[36:39], v[176:179]
s_waitcnt lgkmcnt(7)
v_mfma_f32_16x16x32_bf16 v[164:167], a[152:155], a[40:43], v[164:167]
ds_read_b128 a[144:147], v208 offset:8192
ds_read_b128 a[148:151], v208 offset:26624
v_mfma_f32_16x16x32_bf16 v[168:171], a[152:155], a[44:47], v[168:171]
ds_write_b64 v7, v[218:219] offset:4864
ds_read_b64_tr_b16 v[100:101], v238 offset:256
ds_read_b64_tr_b16 v[102:103], v238 offset:1408
buffer_store_dwordx4 v[84:87], v1, s[8:11], s66 offen offset:2048 sc1
v_mfma_f32_16x16x32_bf16 v[172:175], a[156:159], a[40:43], v[172:175]
v_mfma_f32_16x16x32_bf16 v[176:179], a[156:159], a[44:47], v[176:179]
s_waitcnt lgkmcnt(8)
v_mfma_f32_16x16x32_bf16 v[164:167], a[160:163], a[48:51], v[164:167]
ds_read_b128 a[152:155], v208 offset:9216
ds_read_b128 a[156:159], v208 offset:27648
v_mfma_f32_16x16x32_bf16 v[168:171], a[160:163], a[52:55], v[168:171]
v_mfma_f32_16x16x32_bf16 v[172:175], a[164:167], a[48:51], v[172:175]
v_mfma_f32_16x16x32_bf16 v[176:179], a[164:167], a[52:55], v[176:179]
s_waitcnt lgkmcnt(8)
v_mfma_f32_16x16x32_bf16 v[164:167], a[168:171], a[56:59], v[164:167]
ds_read_b128 a[160:163], v208 offset:10240
ds_read_b128 a[164:167], v208 offset:28672
v_mfma_f32_16x16x32_bf16 v[168:171], a[168:171], a[60:63], v[168:171]
v_mfma_f32_16x16x32_bf16 v[172:175], a[172:175], a[56:59], v[172:175]
v_mfma_f32_16x16x32_bf16 v[176:179], a[172:175], a[60:63], v[176:179]
s_waitcnt lgkmcnt(7)
v_mfma_f32_16x16x32_bf16 v[164:167], a[144:147], a[64:67], v[164:167]
ds_read_b128 a[168:171], v208 offset:11264
ds_read_b128 a[172:175], v208 offset:29696
v_mfma_f32_16x16x32_bf16 v[168:171], a[144:147], a[68:71], v[168:171]
v_mfma_f32_16x16x32_bf16 v[172:175], a[148:151], a[64:67], v[172:175]
buffer_store_dwordx4 v[88:91], v1, s[8:11], s66 offen offset:3072 sc1
v_mfma_f32_16x16x32_bf16 v[176:179], a[148:151], a[68:71], v[176:179]
s_waitcnt lgkmcnt(4)
v_mfma_f32_16x16x32_bf16 v[164:167], a[152:155], a[72:75], v[164:167]
ds_read_b128 a[144:147], v208 offset:12288
ds_read_b128 a[148:151], v208 offset:30720
v_mfma_f32_16x16x32_bf16 v[168:171], a[152:155], a[76:79], v[168:171]
v_mfma_f32_16x16x32_bf16 v[172:175], a[156:159], a[72:75], v[172:175]
v_mfma_f32_16x16x32_bf16 v[176:179], a[156:159], a[76:79], v[176:179]
s_waitcnt lgkmcnt(4)
v_mfma_f32_16x16x32_bf16 v[164:167], a[160:163], a[80:83], v[164:167]
ds_read_b128 a[152:155], v208 offset:13312
ds_read_b128 a[156:159], v208 offset:31744
v_mfma_f32_16x16x32_bf16 v[168:171], a[160:163], a[84:87], v[168:171]
v_mfma_f32_16x16x32_bf16 v[172:175], a[164:167], a[80:83], v[172:175]
v_mfma_f32_16x16x32_bf16 v[176:179], a[164:167], a[84:87], v[176:179]
s_waitcnt lgkmcnt(4)
v_mfma_f32_16x16x32_bf16 v[164:167], a[168:171], a[88:91], v[164:167]
ds_read_b128 a[160:163], v208 offset:14336
ds_read_b128 a[164:167], v208 offset:32768
v_mfma_f32_16x16x32_bf16 v[168:171], a[168:171], a[92:95], v[168:171]
v_mfma_f32_16x16x32_bf16 v[172:175], a[172:175], a[88:91], v[172:175]
s_add_u32 s66, s66, 4096
v_mfma_f32_16x16x32_bf16 v[176:179], a[172:175], a[92:95], v[176:179]
s_waitcnt lgkmcnt(4)
buffer_store_dwordx4 v[100:103], v1, s[8:11], s66 offen offset:0 sc1
v_mfma_f32_16x16x32_bf16 v[164:167], a[144:147], a[96:99], v[164:167]
ds_read_b128 a[168:171], v208 offset:15360
ds_read_b128 a[172:175], v208 offset:33792
v_mfma_f32_16x16x32_bf16 v[168:171], a[144:147], a[100:103], v[168:171]
v_mfma_f32_16x16x32_bf16 v[172:175], a[148:151], a[96:99], v[172:175]
v_mfma_f32_16x16x32_bf16 v[176:179], a[148:151], a[100:103], v[176:179]
s_waitcnt lgkmcnt(4)
v_mfma_f32_16x16x32_bf16 v[164:167], a[152:155], a[104:107], v[164:167]
ds_read_b128 a[144:147], v208 offset:16384
ds_read_b128 a[148:151], v208 offset:34816
v_mfma_f32_16x16x32_bf16 v[168:171], a[152:155], a[108:111], v[168:171]
v_mfma_f32_16x16x32_bf16 v[172:175], a[156:159], a[104:107], v[172:175]
v_mfma_f32_16x16x32_bf16 v[176:179], a[156:159], a[108:111], v[176:179]
s_waitcnt lgkmcnt(4)
v_mfma_f32_16x16x32_bf16 v[164:167], a[160:163], a[112:115], v[164:167]
ds_read_b128 a[152:155], v208 offset:17408
ds_read_b128 a[156:159], v208 offset:35840
v_mfma_f32_16x16x32_bf16 v[168:171], a[160:163], a[116:119], v[168:171]
v_mfma_f32_16x16x32_bf16 v[172:175], a[164:167], a[112:115], v[172:175]
v_mfma_f32_16x16x32_bf16 v[176:179], a[164:167], a[116:119], v[176:179]
s_waitcnt lgkmcnt(4)
v_add_u32 v181, 160768, v239
v_mfma_f32_16x16x32_bf16 v[164:167], a[168:171], a[120:123], v[164:167]
ds_read_b64 a[160:161], v181 offset:0
ds_read_b64 a[164:165], v181 offset:512
v_mfma_f32_16x16x32_bf16 v[168:171], a[168:171], a[124:127], v[168:171]
v_mfma_f32_16x16x32_bf16 v[172:175], a[172:175], a[120:123], v[172:175]
v_mfma_f32_16x16x32_bf16 v[176:179], a[172:175], a[124:127], v[176:179]
s_waitcnt lgkmcnt(4)
v_mfma_f32_16x16x32_bf16 v[164:167], a[144:147], a[128:131], v[164:167]
v_mfma_f32_16x16x32_bf16 v[168:171], a[144:147], a[132:135], v[168:171]
v_mfma_f32_16x16x32_bf16 v[172:175], a[148:151], a[128:131], v[172:175]
v_mfma_f32_16x16x32_bf16 v[176:179], a[148:151], a[132:135], v[176:179]
s_waitcnt lgkmcnt(2)
v_mfma_f32_16x16x32_bf16 v[164:167], a[152:155], a[136:139], v[164:167]
v_mfma_f32_16x16x32_bf16 v[168:171], a[152:155], a[140:143], v[168:171]
v_mfma_f32_16x16x32_bf16 v[172:175], a[156:159], a[136:139], v[172:175]
v_mfma_f32_16x16x32_bf16 v[176:179], a[156:159], a[140:143], v[176:179]
s_waitcnt lgkmcnt(0)
v_mfma_f32_16x16x16_bf16 v[164:167], a[160:161], v[212:213], v[164:167]
v_mfma_f32_16x16x16_bf16 v[168:171], a[160:161], v[214:215], v[168:171]
v_mfma_f32_16x16x16_bf16 v[172:175], a[164:165], v[212:213], v[172:175]
v_mfma_f32_16x16x16_bf16 v[176:179], a[164:165], v[214:215], v[176:179]
L_c4:
v_add_u32 v180, 0, v1
v_lshlrev_b32 v184, 16, v0
v_lshlrev_b32 v185, 16, v0
v_lshlrev_b32 v186, 16, v0
v_lshlrev_b32 v187, 16, v0
v_lshlrev_b32 v188, 16, v249
v_lshlrev_b32 v189, 16, v249
v_lshlrev_b32 v190, 16, v249
v_lshlrev_b32 v191, 16, v249
s_waitcnt lgkmcnt(0)
ds_write_b128 v240, v[36:39] offset:0
ds_write_b128 v240, v[40:43] offset:1024
ds_write_b128 v240, v[52:55] offset:2048
ds_write_b128 v240, v[56:59] offset:3072
s_cmp_eq_u32 s24, 0
s_cselect_b32 s67, 0, 1073741824
s_add_u32 s67, s67, 26542080
s_waitcnt vmcnt(0)
s_barrier
s_mov_b64 exec, 0xffff
buffer_atomic_add v4, v233, s[8:11], s67 offen sc1
s_mov_b64 exec, -1
v_add_u32 v200, 53248, v1
v_add_u32 v201, 90112, v1
v_add_u32 v202, 126976, v1
s_lshl_b32 s35, s80, 7
s_add_u32 s35, s35, 26542080
s_cmp_eq_u32 s24, 1
s_cselect_b32 s35, s35, 1073741824
v_mov_b32 v6, 0
v_mov_b32 v244, 0
v_mov_b32 v245, 0
v_mov_b32 v246, 0
buffer_load_dwordx4 a[80:83], v1, s[4:7], s52 offen offset:2048 sc1
buffer_load_dwordx4 a[84:87], v9, s[4:7], s52 offen offset:2048 sc1
ds_write_b128 v240, v[68:71] offset:4096
ds_write_b128 v240, v[72:75] offset:5120
ds_write_b128 v240, v[84:87] offset:6144
ds_write_b128 v240, v[88:91] offset:7168
ds_write_b128 v240, v[100:103] offset:8192
v_pk_mul_f32 v[192:193], v[108:109], v[108:109]
v_pk_mul_f32 v[194:195], v[110:111], v[110:111]
v_pk_mul_f32 v[196:197], v[112:113], v[112:113]
v_pk_mul_f32 v[198:199], v[114:115], v[114:115]
v_pk_fma_f32 v[192:193], v[192:193], v[252:253], v[250:251] op_sel:[0,0,0] op_sel_hi:[1,0,0]
v_pk_fma_f32 v[194:195], v[194:195], v[252:253], v[250:251] op_sel:[0,0,0] op_sel_hi:[1,0,0]
v_pk_fma_f32 v[196:197], v[196:197], v[252:253], v[250:251] op_sel:[0,1,1] op_sel_hi:[1,1,1]
v_pk_fma_f32 v[198:199], v[198:199], v[252:253], v[250:251] op_sel:[0,1,1] op_sel_hi:[1,1,1]
v_pk_mul_f32 v[192:193], v[192:193], v[108:109]
buffer_load_dwordx4 a[88:91], v1, s[4:7], s52 offen offset:3072 sc1
buffer_load_dwordx4 a[92:95], v9, s[4:7], s52 offen offset:3072 sc1
v_pk_mul_f32 v[194:195], v[194:195], v[110:111]
v_pk_mul_f32 v[196:197], v[196:197], v[112:113]
v_pk_mul_f32 v[198:199], v[198:199], v[114:115]
v_exp_f32 v192, v192
v_exp_f32 v193, v193
v_exp_f32 v194, v194
v_exp_f32 v195, v195
v_exp_f32 v196, v196
v_exp_f32 v197, v197
v_exp_f32 v198, v198
v_exp_f32 v199, v199
v_pk_fma_f32 v[192:193], v[192:193], v[254:255], v[254:255] op_sel:[0,0,0] op_sel_hi:[1,0,0]
v_pk_fma_f32 v[194:195], v[194:195], v[254:255], v[254:255] op_sel:[0,0,0] op_sel_hi:[1,0,0]
v_pk_fma_f32 v[196:197], v[196:197], v[254:255], v[254:255] op_sel:[0,1,1] op_sel_hi:[1,1,1]
s_cmp_eq_u32 s25, 2
s_cselect_b32 s98, 4096, 0
s_add_u32 s52, s52, s98
s_add_u32 s52, s52, 4096
buffer_load_dwordx4 a[96:99], v1, s[4:7], s52 offen offset:0 sc1
s_mov_b64 exec, 1
buffer_atomic_add v244, v6, s[8:11], s35 offen sc0 sc1
s_mov_b64 exec, -1
buffer_load_dwordx4 a[100:103], v9, s[4:7], s52 offen offset:0 sc1
v_pk_fma_f32 v[198:199], v[198:199], v[254:255], v[254:255] op_sel:[0,1,1] op_sel_hi:[1,1,1]
v_rcp_f32 v192, v192
v_rcp_f32 v193, v193
v_rcp_f32 v194, v194
v_rcp_f32 v195, v195
v_rcp_f32 v196, v196
v_rcp_f32 v197, v197
v_rcp_f32 v198, v198
v_rcp_f32 v199, v199
v_pk_mul_f32 v[108:109], v[108:109], v[192:193]
v_pk_mul_f32 v[110:111], v[110:111], v[194:195]
v_pk_mul_f32 v[112:113], v[112:113], v[196:197]
v_pk_mul_f32 v[114:115], v[114:115], v[198:199]
v_pk_mul_f32 v[192:193], v[116:117], v[116:117]
buffer_load_dwordx4 a[104:107], v1, s[4:7], s52 offen offset:1024 sc1
buffer_load_dwordx4 a[108:111], v9, s[4:7], s52 offen offset:1024 sc1
v_pk_mul_f32 v[194:195], v[118:119], v[118:119]
v_pk_mul_f32 v[196:197], v[120:121], v[120:121]
v_pk_mul_f32 v[198:199], v[122:123], v[122:123]
v_pk_fma_f32 v[192:193], v[192:193], v[252:253], v[250:251] op_sel:[0,0,0] op_sel_hi:[1,0,0]
v_pk_fma_f32 v[194:195], v[194:195], v[252:253], v[250:251] op_sel:[0,0,0] op_sel_hi:[1,0,0]
v_pk_fma_f32 v[196:197], v[196:197], v[252:253], v[250:251] op_sel:[0,1,1] op_sel_hi:[1,1,1]
v_pk_fma_f32 v[198:199], v[198:199], v[252:253], v[250:251] op_sel:[0,1,1] op_sel_hi:[1,1,1]
v_pk_mul_f32 v[192:193], v[192:193], v[116:117]
v_pk_mul_f32 v[194:195], v[194:195], v[118:119]
v_pk_mul_f32 v[196:197], v[196:197], v[120:121]
v_pk_mul_f32 v[198:199], v[198:199], v[122:123]
v_exp_f32 v192, v192
v_exp_f32 v193, v193
v_exp_f32 v194, v194
buffer_load_dwordx4 a[112:115], v1, s[4:7], s52 offen offset:2048 sc1
s_mov_b64 exec, 1
buffer_atomic_add v245, v6, s[8:11], s35 offen sc0 sc1
s_mov_b64 exec, -1
buffer_load_dwordx4 a[116:119], v9, s[4:7], s52 offen offset:2048 sc1
v_exp_f32 v195, v195
v_exp_f32 v196, v196
v_exp_f32 v197, v197
v_exp_f32 v198, v198
v_exp_f32 v199, v199
v_pk_fma_f32 v[192:193], v[192:193], v[254:255], v[254:255] op_sel:[0,0,0] op_sel_hi:[1,0,0]
v_pk_fma_f32 v[194:195], v[194:195], v[254:255], v[254:255] op_sel:[0,0,0] op_sel_hi:[1,0,0]
v_pk_fma_f32 v[196:197], v[196:197], v[254:255], v[254:255] op_sel:[0,1,1] op_sel_hi:[1,1,1]
v_pk_fma_f32 v[198:199], v[198:199], v[254:255], v[254:255] op_sel:[0,1,1] op_sel_hi:[1,1,1]
v_rcp_f32 v192, v192
v_rcp_f32 v193, v193
v_rcp_f32 v194, v194
v_rcp_f32 v195, v195
v_rcp_f32 v196, v196
buffer_load_dwordx4 a[120:123], v1, s[4:7], s52 offen offset:3072 sc1
buffer_load_dwordx4 a[124:127], v9, s[4:7], s52 offen offset:3072 sc1
v_rcp_f32 v197, v197
v_rcp_f32 v198, v198
v_rcp_f32 v199, v199
v_pk_mul_f32 v[116:117], v[116:117], v[192:193]
v_pk_mul_f32 v[118:119], v[118:119], v[194:195]
v_pk_mul_f32 v[120:121], v[120:121], v[196:197]
v_pk_mul_f32 v[122:123], v[122:123], v[198:199]
v_pk_mul_f32 v[192:193], v[124:125], v[124:125]
v_pk_mul_f32 v[194:195], v[126:127], v[126:127]
v_pk_mul_f32 v[196:197], v[128:129], v[128:129]
v_pk_mul_f32 v[198:199], v[130:131], v[130:131]
v_pk_fma_f32 v[192:193], v[192:193], v[252:253], v[250:251] op_sel:[0,0,0] op_sel_hi:[1,0,0]
v_pk_fma_f32 v[194:195], v[194:195], v[252:253], v[250:251] op_sel:[0,0,0] op_sel_hi:[1,0,0]
v_pk_fma_f32 v[196:197], v[196:197], v[252:253], v[250:251] op_sel:[0,1,1] op_sel_hi:[1,1,1]
s_cmp_eq_u32 s25, 3
s_cselect_b32 s98, 4096, 0
s_add_u32 s52, s52, s98
s_add_u32 s52, s52, 4096
buffer_load_dwordx4 a[128:131], v1, s[4:7], s52 offen offset:0 sc1
s_mov_b64 exec, 1
buffer_atomic_add v246, v6, s[8:11], s35 offen sc0 sc1
s_mov_b64 exec, -1
buffer_load_dwordx4 a[132:135], v9, s[4:7], s52 offen offset:0 sc1
v_pk_fma_f32 v[198:199], v[198:199], v[252:253], v[250:251] op_sel:[0,1,1] op_sel_hi:[1,1,1]
v_pk_mul_f32 v[192:193], v[192:193], v[124:125]
v_pk_mul_f32 v[194:195], v[194:195], v[126:127]
v_pk_mul_f32 v[196:197], v[196:197], v[128:129]
v_pk_mul_f32 v[198:199], v[198:199], v[130:131]
v_exp_f32 v192, v192
v_exp_f32 v193, v193
v_exp_f32 v194, v194
v_exp_f32 v195, v195
v_exp_f32 v196, v196
v_exp_f32 v197, v197
v_exp_f32 v198, v198
v_exp_f32 v199, v199
v_pk_fma_f32 v[192:193], v[192:193], v[254:255], v[254:255] op_sel:[0,0,0] op_sel_hi:[1,0,0]
buffer_load_dwordx4 a[136:139], v1, s[4:7], s52 offen offset:1024 sc1
buffer_load_dwordx4 a[140:143], v9, s[4:7], s52 offen offset:1024 sc1
v_pk_fma_f32 v[194:195], v[194:195], v[254:255], v[254:255] op_sel:[0,0,0] op_sel_hi:[1,0,0]
v_pk_fma_f32 v[196:197], v[196:197], v[254:255], v[254:255] op_sel:[0,1,1] op_sel_hi:[1,1,1]
v_pk_fma_f32 v[198:199], v[198:199], v[254:255], v[254:255] op_sel:[0,1,1] op_sel_hi:[1,1,1]
v_rcp_f32 v192, v192
v_rcp_f32 v193, v193
v_rcp_f32 v194, v194
v_rcp_f32 v195, v195
v_rcp_f32 v196, v196
v_rcp_f32 v197, v197
v_rcp_f32 v198, v198
v_rcp_f32 v199, v199
v_pk_mul_f32 v[124:125], v[124:125], v[192:193]
v_pk_mul_f32 v[126:127], v[126:127], v[194:195]
v_pk_mul_f32 v[128:129], v[128:129], v[196:197]
v_pk_mul_f32 v[130:131], v[130:131], v[198:199]
s_mul_i32 s30, s26, 589824
s_add_u32 s30, s30, 7340032
s_lshl_b32 s62, s24, 12
s_lshl_b32 s63, s24, 10
s_add_u32 s60, s30, s62
s_add_u32 s61, s30, s63
s_add_u32 s61, s61, 16384
s_cmp_eq_u32 s25, 0
s_cselect_b32 s99, 36864, 0
s_add_u32 s60, s60, s99
s_add_u32 s61, s61, s99
s_add_u32 m0, s62, 53248
s_add_u32 s60, s60, 0
s_waitcnt lgkmcnt(0)
s_cmp_eq_u32 s24, 1
s_cbranch_scc0 L_other_28
s_mov_b32 s31, 0
s_mov_b64 exec, 1
v_mov_b32 v247, 0
buffer_atomic_add v247, v6, s[8:11], s35 offen sc0 sc1
s_waitcnt vmcnt(14)
v_cmp_gt_u32 vcc, 16, v244
s_nop 0
s_cbranch_vccz L_polled_27
s_waitcnt vmcnt(9)
v_cmp_gt_u32 vcc, 16, v245
s_nop 0
s_cbranch_vccz L_polled_27
v_mov_b32 v244, 0
buffer_atomic_add v244, v6, s[8:11], s35 offen sc0 sc1
s_waitcnt vmcnt(5)
v_cmp_gt_u32 vcc, 16, v246
s_nop 0
s_cbranch_vccz L_polled_27
v_mov_b32 v245, 0
buffer_atomic_add v245, v6, s[8:11], s35 offen sc0 sc1
L_poll_26:
s_add_u32 s31, s31, 1
s_cmp_gt_u32 s31, 100000
s_cbranch_scc1 L_polled_27
v_mov_b32 v246, 0
buffer_atomic_add v246, v6, s[8:11], s35 offen sc0 sc1
s_waitcnt vmcnt(3)
v_cmp_gt_u32 vcc, 16, v247
s_nop 0
s_cbranch_vccz L_polled_27
v_mov_b32 v247, 0
buffer_atomic_add v247, v6, s[8:11], s35 offen sc0 sc1
s_waitcnt vmcnt(3)
v_cmp_gt_u32 vcc, 16, v244
s_nop 0
s_cbranch_vccz L_polled_27
v_mov_b32 v244, 0
buffer_atomic_add v244, v6, s[8:11], s35 offen sc0 sc1
s_waitcnt vmcnt(3)
v_cmp_gt_u32 vcc, 16, v245
s_nop 0
s_cbranch_vccz L_polled_27
v_mov_b32 v245, 0
buffer_atomic_add v245, v6, s[8:11], s35 offen sc0 sc1
s_waitcnt vmcnt(3)
v_cmp_gt_u32 vcc, 16, v246
s_nop 0
s_cbranch_vccz L_polled_27
s_branch L_poll_26
L_polled_27:
s_mov_b64 exec, -1
L_other_28:
s_barrier
buffer_load_dwordx4 v1, s[8:11], s60 offen offset:0 sc1 lds
buffer_load_dwordx4 v1, s[8:11], s60 offen offset:1024 sc1 lds
ds_read_b128 a[0:3], v180 offset:0
ds_read_b128 a[4:7], v180 offset:1024
ds_read_b128 a[8:11], v180 offset:2048
ds_read_b128 a[12:15], v180 offset:3072
ds_read_b128 a[16:19], v180 offset:4096
ds_read_b128 a[20:23], v180 offset:5120
ds_read_b128 a[24:27], v180 offset:6144
ds_read_b128 a[28:31], v180 offset:7168
ds_read_b128 a[32:35], v180 offset:8192
buffer_load_dwordx4 v1, s[8:11], s60 offen offset:2048 sc1 lds
buffer_load_dwordx4 v1, s[8:11], s60 offen offset:3072 sc1 lds
s_add_u32 m0, s63, 69632
s_add_u32 s61, s61, 0
buffer_load_dwordx4 v1, s[8:11], s61 offen offset:0 sc1 lds
s_waitcnt lgkmcnt(0)
v_mfma_f32_16x16x32_bf16 v[36:39], a[0:3], a[176:179], v[184:187]
ds_read_b128 a[36:39], v180 offset:9216
s_add_u32 m0, s62, 73728
v_mfma_f32_16x16x32_bf16 v[40:43], a[0:3], a[180:183], v[188:191]
ds_read_b128 a[40:43], v180 offset:10240
v_mul_f32 v192, v132, v132
v_mfma_f32_16x16x32_bf16 v[44:47], a[4:7], a[176:179], v[184:187]
ds_read_b128 a[44:47], v180 offset:11264
s_add_u32 s60, s60, 20480
v_mfma_f32_16x16x32_bf16 v[48:51], a[4:7], a[180:183], v[188:191]
ds_read_b128 a[48:51], v180 offset:12288
v_mul_f32 v193, v133, v133
v_mfma_f32_16x16x32_bf16 v[52:55], a[8:11], a[176:179], v[184:187]
ds_read_b128 a[52:55], v180 offset:13312
v_mul_f32 v194, v134, v134
v_mfma_f32_16x16x32_bf16 v[56:59], a[8:11], a[180:183], v[188:191]
ds_read_b128 a[56:59], v180 offset:14336
buffer_load_dwordx4 v1, s[8:11], s60 offen offset:0 sc1 lds
v_mfma_f32_16x16x32_bf16 v[60:63], a[12:15], a[176:179], v[184:187]
ds_read_b128 a[60:63], v180 offset:15360
v_mfma_f32_16x16x32_bf16 v[64:67], a[12:15], a[180:183], v[188:191]
ds_read_b128 a[64:67], v180 offset:16384
v_mul_f32 v195, v135, v135
v_mfma_f32_16x16x32_bf16 v[68:71], a[16:19], a[176:179], v[184:187]
ds_read_b128 a[68:71], v180 offset:17408
buffer_load_dwordx4 v1, s[8:11], s60 offen offset:1024 sc1 lds
v_mfma_f32_16x16x32_bf16 v[72:75], a[16:19], a[180:183], v[188:191]
v_fma_f32 v192, v192, v252, v250
v_mfma_f32_16x16x32_bf16 v[76:79], a[20:23], a[176:179], v[184:187]
v_mfma_f32_16x16x32_bf16 v[80:83], a[20:23], a[180:183], v[188:191]
buffer_load_dwordx4 v1, s[8:11], s60 offen offset:2048 sc1 lds
v_fma_f32 v193, v193, v252, v250
v_mfma_f32_16x16x32_bf16 v[84:87], a[24:27], a[176:179], v[184:187]
v_mfma_f32_16x16x32_bf16 v[88:91], a[24:27], a[180:183], v[188:191]
v_mfma_f32_16x16x32_bf16 v[92:95], a[28:31], a[176:179], v[184:187]
buffer_load_dwordx4 v1, s[8:11], s60 offen offset:3072 sc1 lds
v_fma_f32 v194, v194, v252, v250
v_mfma_f32_16x16x32_bf16 v[96:99], a[28:31], a[180:183], v[188:191]
v_mfma_f32_16x16x32_bf16 v[100:103], a[32:35], a[176:179], v[184:187]
v_fma_f32 v195, v195, v252, v250
v_mfma_f32_16x16x32_bf16 v[104:107], a[32:35], a[180:183], v[188:191]
s_waitcnt lgkmcnt(0)
v_mfma_f32_16x16x32_bf16 v[36:39], a[36:39], a[184:187], v[36:39]
ds_read_b128 a[0:3], v180 offset:18432
v_mul_f32 v192, v192, v132
v_mfma_f32_16x16x32_bf16 v[40:43], a[36:39], a[188:191], v[40:43]
ds_read_b128 a[4:7], v180 offset:19456
v_mfma_f32_16x16x32_bf16 v[44:47], a[40:43], a[184:187], v[44:47]
ds_read_b128 a[8:11], v180 offset:20480
v_mfma_f32_16x16x32_bf16 v[48:51], a[40:43], a[188:191], v[48:51]
ds_read_b128 a[12:15], v180 offset:21504
v_mul_f32 v193, v193, v133
v_mfma_f32_16x16x32_bf16 v[52:55], a[44:47], a[184:187], v[52:55]
ds_read_b128 a[16:19], v180 offset:22528
v_mfma_f32_16x16x32_bf16 v[56:59], a[44:47], a[188:191], v[56:59]
ds_read_b128 a[20:23], v180 offset:23552
v_mul_f32 v194, v194, v134
v_mfma_f32_16x16x32_bf16 v[60:63], a[48:51], a[184:187], v[60:63]
ds_read_b128 a[24:27], v180 offset:24576
v_mfma_f32_16x16x32_bf16 v[64:67], a[48:51], a[188:191], v[64:67]
ds_read_b128 a[28:31], v180 offset:25600
v_mul_f32 v195, v195, v135
v_mfma_f32_16x16x32_bf16 v[68:71], a[52:55], a[184:187], v[68:71]
ds_read_b128 a[32:35], v180 offset:26624
v_mfma_f32_16x16x32_bf16 v[72:75], a[52:55], a[188:191], v[72:75]
s_cmp_eq_u32 s25, 1
s_cselect_b32 s99, 36864, 0
s_add_u32 s60, s60, s99
v_mfma_f32_16x16x32_bf16 v[76:79], a[56:59], a[184:187], v[76:79]
s_add_u32 s61, s61, s99
s_add_u32 m0, s62, 90112
s_add_u32 s60, s60, 16384
v_mfma_f32_16x16x32_bf16 v[80:83], a[56:59], a[188:191], v[80:83]
buffer_load_dwordx4 v1, s[8:11], s60 offen offset:0 sc1 lds
v_mfma_f32_16x16x32_bf16 v[84:87], a[60:63], a[184:187], v[84:87]
buffer_load_dwordx4 v1, s[8:11], s60 offen offset:1024 sc1 lds
v_mfma_f32_16x16x32_bf16 v[88:91], a[60:63], a[188:191], v[88:91]
buffer_load_dwordx4 v1, s[8:11], s60 offen offset:2048 sc1 lds
v_mfma_f32_16x16x32_bf16 v[92:95], a[64:67], a[184:187], v[92:95]
v_exp_f32 v192, v192
v_mfma_f32_16x16x32_bf16 v[96:99], a[64:67], a[188:191], v[96:99]
buffer_load_dwordx4 v1, s[8:11], s60 offen offset:3072 sc1 lds
v_mfma_f32_16x16x32_bf16 v[100:103], a[68:71], a[184:187], v[100:103]
v_exp_f32 v193, v193
v_mfma_f32_16x16x32_bf16 v[104:107], a[68:71], a[188:191], v[104:107]
s_waitcnt lgkmcnt(0)
v_mfma_f32_16x16x32_bf16 v[36:39], a[0:3], a[192:195], v[36:39]
ds_read_b128 a[36:39], v180 offset:27648
s_add_u32 m0, s63, 106496
v_mfma_f32_16x16x32_bf16 v[40:43], a[0:3], a[196:199], v[40:43]
ds_read_b128 a[40:43], v180 offset:28672
v_mfma_f32_16x16x32_bf16 v[44:47], a[4:7], a[192:195], v[44:47]
ds_read_b128 a[44:47], v180 offset:29696
s_add_u32 s61, s61, 36864
v_mfma_f32_16x16x32_bf16 v[48:51], a[4:7], a[196:199], v[48:51]
ds_read_b128 a[48:51], v180 offset:30720
v_mfma_f32_16x16x32_bf16 v[52:55], a[8:11], a[192:195], v[52:55]
ds_read_b128 a[52:55], v180 offset:31744
buffer_load_dwordx4 v1, s[8:11], s61 offen offset:0 sc1 lds
v_mfma_f32_16x16x32_bf16 v[56:59], a[8:11], a[196:199], v[56:59]
ds_read_b128 a[56:59], v180 offset:32768
v_mfma_f32_16x16x32_bf16 v[60:63], a[12:15], a[192:195], v[60:63]
ds_read_b128 a[60:63], v180 offset:33792
s_add_u32 m0, s62, 110592
v_mfma_f32_16x16x32_bf16 v[64:67], a[12:15], a[196:199], v[64:67]
ds_read_b128 a[64:67], v180 offset:34816
v_mfma_f32_16x16x32_bf16 v[68:71], a[16:19], a[192:195], v[68:71]
ds_read_b128 a[68:71], v180 offset:35840
s_add_u32 s60, s60, 20480
v_mfma_f32_16x16x32_bf16 v[72:75], a[16:19], a[196:199], v[72:75]
v_exp_f32 v194, v194
v_mfma_f32_16x16x32_bf16 v[76:79], a[20:23], a[192:195], v[76:79]
buffer_load_dwordx4 v1, s[8:11], s60 offen offset:0 sc1 lds
v_mfma_f32_16x16x32_bf16 v[80:83], a[20:23], a[196:199], v[80:83]
v_exp_f32 v195, v195
v_mfma_f32_16x16x32_bf16 v[84:87], a[24:27], a[192:195], v[84:87]
buffer_load_dwordx4 v1, s[8:11], s60 offen offset:1024 sc1 lds
v_fma_f32 v192, v192, v254, v254
v_mfma_f32_16x16x32_bf16 v[88:91], a[24:27], a[196:199], v[88:91]
v_fma_f32 v193, v193, v254, v254
v_mfma_f32_16x16x32_bf16 v[92:95], a[28:31], a[192:195], v[92:95]
buffer_load_dwordx4 v1, s[8:11], s60 offen offset:2048 sc1 lds
v_mfma_f32_16x16x32_bf16 v[96:99], a[28:31], a[196:199], v[96:99]
v_fma_f32 v194, v194, v254, v254
v_mfma_f32_16x16x32_bf16 v[100:103], a[32:35], a[192:195], v[100:103]
v_mfma_f32_16x16x32_bf16 v[104:107], a[32:35], a[196:199], v[104:107]
s_waitcnt vmcnt(12) lgkmcnt(0)
s_barrier
v_mfma_f32_16x16x32_bf16 v[36:39], a[36:39], a[200:203], v[36:39]
ds_read_b128 a[0:3], v200 offset:0
buffer_load_dwordx4 v1, s[8:11], s60 offen offset:3072 sc1 lds
v_mfma_f32_16x16x32_bf16 v[40:43], a[36:39], a[204:207], v[40:43]
ds_read_b128 a[4:7], v200 offset:1024
v_fma_f32 v195, v195, v254, v254
v_mfma_f32_16x16x32_bf16 v[44:47], a[40:43], a[200:203], v[44:47]
ds_read_b128 a[8:11], v200 offset:2048
v_mfma_f32_16x16x32_bf16 v[48:51], a[40:43], a[204:207], v[48:51]
ds_read_b128 a[12:15], v200 offset:3072
v_mfma_f32_16x16x32_bf16 v[52:55], a[44:47], a[200:203], v[52:55]
ds_read_b128 a[16:19], v200 offset:4096
v_mfma_f32_16x16x32_bf16 v[56:59], a[44:47], a[204:207], v[56:59]
ds_read_b128 a[20:23], v200 offset:5120
v_mfma_f32_16x16x32_bf16 v[60:63], a[48:51], a[200:203], v[60:63]
ds_read_b128 a[24:27], v200 offset:6144
v_mfma_f32_16x16x32_bf16 v[64:67], a[48:51], a[204:207], v[64:67]
ds_read_b128 a[28:31], v200 offset:7168
v_mfma_f32_16x16x32_bf16 v[68:71], a[52:55], a[200:203], v[68:71]
ds_read_b128 a[32:35], v200 offset:8192
v_mfma_f32_16x16x32_bf16 v[72:75], a[52:55], a[204:207], v[72:75]
s_cmp_eq_u32 s25, 2
s_cselect_b32 s99, 36864, 0
s_add_u32 s60, s60, s99
v_mfma_f32_16x16x32_bf16 v[76:79], a[56:59], a[200:203], v[76:79]
s_add_u32 s61, s61, s99
s_add_u32 m0, s62, 126976
s_add_u32 s60, s60, 16384
v_mfma_f32_16x16x32_bf16 v[80:83], a[56:59], a[204:207], v[80:83]
buffer_load_dwordx4 v1, s[8:11], s60 offen offset:0 sc1 lds
v_mfma_f32_16x16x32_bf16 v[84:87], a[60:63], a[200:203], v[84:87]
v_rcp_f32 v192, v192
v_mfma_f32_16x16x32_bf16 v[88:91], a[60:63], a[204:207], v[88:91]
buffer_load_dwordx4 v1, s[8:11], s60 offen offset:1024 sc1 lds
v_mfma_f32_16x16x32_bf16 v[92:95], a[64:67], a[200:203], v[92:95]
v_rcp_f32 v193, v193
v_mfma_f32_16x16x32_bf16 v[96:99], a[64:67], a[204:207], v[96:99]
buffer_load_dwordx4 v1, s[8:11], s60 offen offset:2048 sc1 lds
v_mfma_f32_16x16x32_bf16 v[100:103], a[68:71], a[200:203], v[100:103]
v_rcp_f32 v194, v194
v_mfma_f32_16x16x32_bf16 v[104:107], a[68:71], a[204:207], v[104:107]
s_waitcnt lgkmcnt(0)
v_mfma_f32_16x16x32_bf16 v[36:39], a[0:3], a[208:211], v[36:39]
ds_read_b128 a[36:39], v200 offset:9216
buffer_load_dwordx4 v1, s[8:11], s60 offen offset:3072 sc1 lds
v_mfma_f32_16x16x32_bf16 v[40:43], a[0:3], a[212:215], v[40:43]
ds_read_b128 a[40:43], v200 offset:10240
v_mfma_f32_16x16x32_bf16 v[44:47], a[4:7], a[208:211], v[44:47]
ds_read_b128 a[44:47], v200 offset:11264
s_add_u32 m0, s63, 143360
v_mfma_f32_16x16x32_bf16 v[48:51], a[4:7], a[212:215], v[48:51]
ds_read_b128 a[48:51], v200 offset:12288
v_mfma_f32_16x16x32_bf16 v[52:55], a[8:11], a[208:211], v[52:55]
ds_read_b128 a[52:55], v200 offset:13312
s_add_u32 s61, s61, 36864
v_mfma_f32_16x16x32_bf16 v[56:59], a[8:11], a[212:215], v[56:59]
ds_read_b128 a[56:59], v200 offset:14336
v_mfma_f32_16x16x32_bf16 v[60:63], a[12:15], a[208:211], v[60:63]
ds_read_b128 a[60:63], v200 offset:15360
buffer_load_dwordx4 v1, s[8:11], s61 offen offset:0 sc1 lds
v_mfma_f32_16x16x32_bf16 v[64:67], a[12:15], a[212:215], v[64:67]
ds_read_b128 a[64:67], v200 offset:16384
v_mfma_f32_16x16x32_bf16 v[68:71], a[16:19], a[208:211], v[68:71]
ds_read_b128 a[68:71], v200 offset:17408
s_add_u32 m0, s62, 147456
v_mfma_f32_16x16x32_bf16 v[72:75], a[16:19], a[212:215], v[72:75]
s_add_u32 s60, s60, 20480
v_rcp_f32 v195, v195
v_mfma_f32_16x16x32_bf16 v[76:79], a[20:23], a[208:211], v[76:79]
v_mul_f32 v132, v132, v192
v_mul_f32 v133, v133, v193
v_mfma_f32_16x16x32_bf16 v[80:83], a[20:23], a[212:215], v[80:83]
v_mul_f32 v134, v134, v194
v_mul_f32 v135, v135, v195
v_mfma_f32_16x16x32_bf16 v[84:87], a[24:27], a[208:211], v[84:87]
buffer_load_dwordx4 v1, s[8:11], s60 offen offset:0 sc1 lds
v_mul_f32 v196, v136, v136
v_mfma_f32_16x16x32_bf16 v[88:91], a[24:27], a[212:215], v[88:91]
v_mfma_f32_16x16x32_bf16 v[92:95], a[28:31], a[208:211], v[92:95]
buffer_load_dwordx4 v1, s[8:11], s60 offen offset:1024 sc1 lds
v_mfma_f32_16x16x32_bf16 v[96:99], a[28:31], a[212:215], v[96:99]
v_mul_f32 v197, v137, v137
v_mfma_f32_16x16x32_bf16 v[100:103], a[32:35], a[208:211], v[100:103]
v_mfma_f32_16x16x32_bf16 v[104:107], a[32:35], a[212:215], v[104:107]
s_waitcnt vmcnt(16) lgkmcnt(0)
s_barrier
v_mfma_f32_16x16x32_bf16 v[36:39], a[36:39], a[216:219], v[36:39]
ds_read_b128 a[0:3], v200 offset:18432
buffer_load_dwordx4 v1, s[8:11], s60 offen offset:2048 sc1 lds
v_mfma_f32_16x16x32_bf16 v[40:43], a[36:39], a[220:223], v[40:43]
ds_read_b128 a[4:7], v200 offset:19456
v_mul_f32 v198, v138, v138
v_mfma_f32_16x16x32_bf16 v[44:47], a[40:43], a[216:219], v[44:47]
ds_read_b128 a[8:11], v200 offset:20480
v_mul_f32 v199, v139, v139
v_mfma_f32_16x16x32_bf16 v[48:51], a[40:43], a[220:223], v[48:51]
ds_read_b128 a[12:15], v200 offset:21504
v_mfma_f32_16x16x32_bf16 v[52:55], a[44:47], a[216:219], v[52:55]
ds_read_b128 a[16:19], v200 offset:22528
buffer_load_dwordx4 v1, s[8:11], s60 offen offset:3072 sc1 lds
v_mfma_f32_16x16x32_bf16 v[56:59], a[44:47], a[220:223], v[56:59]
ds_read_b128 a[20:23], v200 offset:23552
v_fma_f32 v196, v196, v253, v251
v_mfma_f32_16x16x32_bf16 v[60:63], a[48:51], a[216:219], v[60:63]
ds_read_b128 a[24:27], v200 offset:24576
v_fma_f32 v197, v197, v253, v251
v_mfma_f32_16x16x32_bf16 v[64:67], a[48:51], a[220:223], v[64:67]
ds_read_b128 a[28:31], v200 offset:25600
v_mfma_f32_16x16x32_bf16 v[68:71], a[52:55], a[216:219], v[68:71]
ds_read_b128 a[32:35], v200 offset:26624
buffer_load_dwordx4 a[144:147], v1, s[4:7], s52 offen offset:2048 sc1
v_mfma_f32_16x16x32_bf16 v[72:75], a[52:55], a[220:223], v[72:75]
v_fma_f32 v198, v198, v253, v251
v_mfma_f32_16x16x32_bf16 v[76:79], a[56:59], a[216:219], v[76:79]
v_mfma_f32_16x16x32_bf16 v[80:83], a[56:59], a[220:223], v[80:83]
v_fma_f32 v199, v199, v253, v251
v_mfma_f32_16x16x32_bf16 v[84:87], a[60:63], a[216:219], v[84:87]
buffer_load_dwordx4 a[148:151], v9, s[4:7], s52 offen offset:2048 sc1
v_mfma_f32_16x16x32_bf16 v[88:91], a[60:63], a[220:223], v[88:91]
v_mul_f32 v196, v196, v136
v_mfma_f32_16x16x32_bf16 v[92:95], a[64:67], a[216:219], v[92:95]
v_mfma_f32_16x16x32_bf16 v[96:99], a[64:67], a[220:223], v[96:99]
v_mfma_f32_16x16x32_bf16 v[100:103], a[68:71], a[216:219], v[100:103]
v_mul_f32 v197, v197, v137
v_mfma_f32_16x16x32_bf16 v[104:107], a[68:71], a[220:223], v[104:107]
s_waitcnt lgkmcnt(0)
v_mfma_f32_16x16x32_bf16 v[36:39], a[0:3], a[224:227], v[36:39]
ds_read_b128 a[36:39], v200 offset:27648
buffer_load_dwordx4 a[152:155], v1, s[4:7], s52 offen offset:3072 sc1
v_mfma_f32_16x16x32_bf16 v[40:43], a[0:3], a[228:231], v[40:43]
ds_read_b128 a[40:43], v200 offset:28672
v_mul_f32 v198, v198, v138
v_mfma_f32_16x16x32_bf16 v[44:47], a[4:7], a[224:227], v[44:47]
ds_read_b128 a[44:47], v200 offset:29696
buffer_load_dwordx4 a[156:159], v9, s[4:7], s52 offen offset:3072 sc1
v_mfma_f32_16x16x32_bf16 v[48:51], a[4:7], a[228:231], v[48:51]
ds_read_b128 a[48:51], v200 offset:30720
v_mul_f32 v199, v199, v139
v_mfma_f32_16x16x32_bf16 v[52:55], a[8:11], a[224:227], v[52:55]
ds_read_b128 a[52:55], v200 offset:31744
v_mfma_f32_16x16x32_bf16 v[56:59], a[8:11], a[228:231], v[56:59]
ds_read_b128 a[56:59], v200 offset:32768
v_mfma_f32_16x16x32_bf16 v[60:63], a[12:15], a[224:227], v[60:63]
ds_read_b128 a[60:63], v200 offset:33792
v_mfma_f32_16x16x32_bf16 v[64:67], a[12:15], a[228:231], v[64:67]
ds_read_b128 a[64:67], v200 offset:34816
v_mfma_f32_16x16x32_bf16 v[68:71], a[16:19], a[224:227], v[68:71]
ds_read_b128 a[68:71], v200 offset:35840
v_mfma_f32_16x16x32_bf16 v[72:75], a[16:19], a[228:231], v[72:75]
s_cmp_eq_u32 s25, 4
s_cselect_b32 s98, 4096, 0
s_add_u32 s52, s52, s98
v_mfma_f32_16x16x32_bf16 v[76:79], a[20:23], a[224:227], v[76:79]
s_add_u32 s52, s52, 4096
v_exp_f32 v196, v196
v_mfma_f32_16x16x32_bf16 v[80:83], a[20:23], a[228:231], v[80:83]
v_exp_f32 v197, v197
v_mfma_f32_16x16x32_bf16 v[84:87], a[24:27], a[224:227], v[84:87]
buffer_load_dwordx4 a[160:163], v1, s[4:7], s52 offen offset:0 sc1
v_mfma_f32_16x16x32_bf16 v[88:91], a[24:27], a[228:231], v[88:91]
v_mfma_f32_16x16x32_bf16 v[92:95], a[28:31], a[224:227], v[92:95]
buffer_load_dwordx4 a[164:167], v9, s[4:7], s52 offen offset:0 sc1
v_mfma_f32_16x16x32_bf16 v[96:99], a[28:31], a[228:231], v[96:99]
v_exp_f32 v198, v198
v_mfma_f32_16x16x32_bf16 v[100:103], a[32:35], a[224:227], v[100:103]
v_mfma_f32_16x16x32_bf16 v[104:107], a[32:35], a[228:231], v[104:107]
s_waitcnt vmcnt(19) lgkmcnt(0)
s_barrier
v_mfma_f32_16x16x32_bf16 v[36:39], a[36:39], a[232:235], v[36:39]
ds_read_b128 a[0:3], v201 offset:0
buffer_load_dwordx4 a[168:171], v1, s[4:7], s52 offen offset:1024 sc1
v_mfma_f32_16x16x32_bf16 v[40:43], a[36:39], a[236:239], v[40:43]
ds_read_b128 a[4:7], v201 offset:1024
buffer_load_dwordx4 a[172:175], v9, s[4:7], s52 offen offset:1024 sc1
v_mfma_f32_16x16x32_bf16 v[44:47], a[40:43], a[232:235], v[44:47]
ds_read_b128 a[8:11], v201 offset:2048
v_mfma_f32_16x16x32_bf16 v[48:51], a[40:43], a[236:239], v[48:51]
ds_read_b128 a[12:15], v201 offset:3072
v_mfma_f32_16x16x32_bf16 v[52:55], a[44:47], a[232:235], v[52:55]
ds_read_b128 a[16:19], v201 offset:4096
v_mfma_f32_16x16x32_bf16 v[56:59], a[44:47], a[236:239], v[56:59]
ds_read_b128 a[20:23], v201 offset:5120
v_mfma_f32_16x16x32_bf16 v[60:63], a[48:51], a[232:235], v[60:63]
ds_read_b128 a[24:27], v201 offset:6144
v_mfma_f32_16x16x32_bf16 v[64:67], a[48:51], a[236:239], v[64:67]
ds_read_b128 a[28:31], v201 offset:7168
v_mfma_f32_16x16x32_bf16 v[68:71], a[52:55], a[232:235], v[68:71]
ds_read_b128 a[32:35], v201 offset:8192
v_mfma_f32_16x16x32_bf16 v[72:75], a[52:55], a[236:239], v[72:75]
s_cmp_eq_u32 s25, 3
s_cselect_b32 s99, 36864, 0
s_add_u32 s60, s60, s99
v_mfma_f32_16x16x32_bf16 v[76:79], a[56:59], a[232:235], v[76:79]
s_add_u32 s61, s61, s99
s_add_u32 m0, s62, 53248
v_mfma_f32_16x16x32_bf16 v[80:83], a[56:59], a[236:239], v[80:83]
s_add_u32 s60, s60, 16384
v_exp_f32 v199, v199
v_mfma_f32_16x16x32_bf16 v[84:87], a[60:63], a[232:235], v[84:87]
v_fma_f32 v196, v196, v255, v255
v_fma_f32 v197, v197, v255, v255
v_mfma_f32_16x16x32_bf16 v[88:91], a[60:63], a[236:239], v[88:91]
buffer_load_dwordx4 v1, s[8:11], s60 offen offset:0 sc1 lds
v_fma_f32 v198, v198, v255, v255
v_mfma_f32_16x16x32_bf16 v[92:95], a[64:67], a[232:235], v[92:95]
v_fma_f32 v199, v199, v255, v255
v_mfma_f32_16x16x32_bf16 v[96:99], a[64:67], a[236:239], v[96:99]
buffer_load_dwordx4 v1, s[8:11], s60 offen offset:1024 sc1 lds
v_mfma_f32_16x16x32_bf16 v[100:103], a[68:71], a[232:235], v[100:103]
v_rcp_f32 v196, v196
v_mfma_f32_16x16x32_bf16 v[104:107], a[68:71], a[236:239], v[104:107]
s_waitcnt lgkmcnt(0)
v_mfma_f32_16x16x32_bf16 v[36:39], a[0:3], a[240:243], v[36:39]
ds_read_b128 a[36:39], v201 offset:9216
buffer_load_dwordx4 v1, s[8:11], s60 offen offset:2048 sc1 lds
v_mfma_f32_16x16x32_bf16 v[40:43], a[0:3], a[244:247], v[40:43]
ds_read_b128 a[40:43], v201 offset:10240
v_mfma_f32_16x16x32_bf16 v[44:47], a[4:7], a[240:243], v[44:47]
ds_read_b128 a[44:47], v201 offset:11264
buffer_load_dwordx4 v1, s[8:11], s60 offen offset:3072 sc1 lds
v_mfma_f32_16x16x32_bf16 v[48:51], a[4:7], a[244:247], v[48:51]
ds_read_b128 a[48:51], v201 offset:12288
v_mfma_f32_16x16x32_bf16 v[52:55], a[8:11], a[240:243], v[52:55]
ds_read_b128 a[52:55], v201 offset:13312
s_add_u32 m0, s63, 69632
v_mfma_f32_16x16x32_bf16 v[56:59], a[8:11], a[244:247], v[56:59]
ds_read_b128 a[56:59], v201 offset:14336
v_mfma_f32_16x16x32_bf16 v[60:63], a[12:15], a[240:243], v[60:63]
ds_read_b128 a[60:63], v201 offset:15360
s_add_u32 s61, s61, 36864
v_mfma_f32_16x16x32_bf16 v[64:67], a[12:15], a[244:247], v[64:67]
ds_read_b128 a[64:67], v201 offset:16384
v_mfma_f32_16x16x32_bf16 v[68:71], a[16:19], a[240:243], v[68:71]
ds_read_b128 a[68:71], v201 offset:17408
buffer_load_dwordx4 v1, s[8:11], s61 offen offset:0 sc1 lds
v_mfma_f32_16x16x32_bf16 v[72:75], a[16:19], a[244:247], v[72:75]
s_add_u32 m0, s62, 73728
v_rcp_f32 v197, v197
v_mfma_f32_16x16x32_bf16 v[76:79], a[20:23], a[240:243], v[76:79]
s_add_u32 s60, s60, 20480
v_rcp_f32 v198, v198
v_mfma_f32_16x16x32_bf16 v[80:83], a[20:23], a[244:247], v[80:83]
v_rcp_f32 v199, v199
v_mfma_f32_16x16x32_bf16 v[84:87], a[24:27], a[240:243], v[84:87]
v_mfma_f32_16x16x32_bf16 v[88:91], a[24:27], a[244:247], v[88:91]
v_mfma_f32_16x16x32_bf16 v[92:95], a[28:31], a[240:243], v[92:95]
buffer_load_dwordx4 v1, s[8:11], s60 offen offset:0 sc1 lds
v_mfma_f32_16x16x32_bf16 v[96:99], a[28:31], a[244:247], v[96:99]
v_mfma_f32_16x16x32_bf16 v[100:103], a[32:35], a[240:243], v[100:103]
v_mul_f32 v136, v136, v196
v_mfma_f32_16x16x32_bf16 v[104:107], a[32:35], a[244:247], v[104:107]
s_waitcnt vmcnt(23) lgkmcnt(0)
s_barrier
v_mfma_f32_16x16x32_bf16 v[36:39], a[36:39], a[248:251], v[36:39]
ds_read_b128 a[0:3], v201 offset:18432
buffer_load_dwordx4 v1, s[8:11], s60 offen offset:1024 sc1 lds
v_mfma_f32_16x16x32_bf16 v[40:43], a[36:39], a[252:255], v[40:43]
ds_read_b128 a[4:7], v201 offset:19456
v_mul_f32 v137, v137, v197
v_mfma_f32_16x16x32_bf16 v[44:47], a[40:43], a[248:251], v[44:47]
ds_read_b128 a[8:11], v201 offset:20480
v_mul_f32 v138, v138, v198
v_mfma_f32_16x16x32_bf16 v[48:51], a[40:43], a[252:255], v[48:51]
ds_read_b128 a[12:15], v201 offset:21504
v_mfma_f32_16x16x32_bf16 v[52:55], a[44:47], a[248:251], v[52:55]
ds_read_b128 a[16:19], v201 offset:22528
buffer_load_dwordx4 v1, s[8:11], s60 offen offset:2048 sc1 lds
v_mfma_f32_16x16x32_bf16 v[56:59], a[44:47], a[252:255], v[56:59]
ds_read_b128 a[20:23], v201 offset:23552
v_mul_f32 v139, v139, v199
v_mfma_f32_16x16x32_bf16 v[60:63], a[48:51], a[248:251], v[60:63]
ds_read_b128 a[24:27], v201 offset:24576
v_mfma_f32_16x16x32_bf16 v[64:67], a[48:51], a[252:255], v[64:67]
ds_read_b128 a[28:31], v201 offset:25600
v_mul_f32 v192, v140, v140
v_mfma_f32_16x16x32_bf16 v[68:71], a[52:55], a[248:251], v[68:71]
ds_read_b128 a[32:35], v201 offset:26624
buffer_load_dwordx4 v1, s[8:11], s60 offen offset:3072 sc1 lds
v_mfma_f32_16x16x32_bf16 v[72:75], a[52:55], a[252:255], v[72:75]
v_mfma_f32_16x16x32_bf16 v[76:79], a[56:59], a[248:251], v[76:79]
v_mul_f32 v193, v141, v141
v_mfma_f32_16x16x32_bf16 v[80:83], a[56:59], a[252:255], v[80:83]
v_mfma_f32_16x16x32_bf16 v[84:87], a[60:63], a[248:251], v[84:87]
buffer_load_dwordx4 a[176:179], v1, s[4:7], s52 offen offset:2048 sc1
v_mul_f32 v194, v142, v142
v_mfma_f32_16x16x32_bf16 v[88:91], a[60:63], a[252:255], v[88:91]
v_mfma_f32_16x16x32_bf16 v[92:95], a[64:67], a[248:251], v[92:95]
v_mul_f32 v195, v143, v143
v_mfma_f32_16x16x32_bf16 v[96:99], a[64:67], a[252:255], v[96:99]
v_mfma_f32_16x16x32_bf16 v[100:103], a[68:71], a[248:251], v[100:103]
v_mfma_f32_16x16x32_bf16 v[104:107], a[68:71], a[252:255], v[104:107]
v_fma_f32 v192, v192, v252, v250
s_waitcnt lgkmcnt(0)
v_mfma_f32_16x16x32_bf16 v[36:39], a[0:3], a[80:83], v[36:39]
ds_read_b128 a[36:39], v201 offset:27648
buffer_load_dwordx4 a[180:183], v9, s[4:7], s52 offen offset:2048 sc1
v_mfma_f32_16x16x32_bf16 v[40:43], a[0:3], a[84:87], v[40:43]
ds_read_b128 a[40:43], v201 offset:28672
v_fma_f32 v193, v193, v252, v250
v_mfma_f32_16x16x32_bf16 v[44:47], a[4:7], a[80:83], v[44:47]
ds_read_b128 a[44:47], v201 offset:29696
buffer_load_dwordx4 a[184:187], v1, s[4:7], s52 offen offset:3072 sc1
v_mfma_f32_16x16x32_bf16 v[48:51], a[4:7], a[84:87], v[48:51]
ds_read_b128 a[48:51], v201 offset:30720
v_fma_f32 v194, v194, v252, v250
v_mfma_f32_16x16x32_bf16 v[52:55], a[8:11], a[80:83], v[52:55]
ds_read_b128 a[52:55], v201 offset:31744
buffer_load_dwordx4 a[188:191], v9, s[4:7], s52 offen offset:3072 sc1
v_mfma_f32_16x16x32_bf16 v[56:59], a[8:11], a[84:87], v[56:59]
ds_read_b128 a[56:59], v201 offset:32768
v_mfma_f32_16x16x32_bf16 v[60:63], a[12:15], a[80:83], v[60:63]
ds_read_b128 a[60:63], v201 offset:33792
v_fma_f32 v195, v195, v252, v250
v_mfma_f32_16x16x32_bf16 v[64:67], a[12:15], a[84:87], v[64:67]
ds_read_b128 a[64:67], v201 offset:34816
v_mfma_f32_16x16x32_bf16 v[68:71], a[16:19], a[80:83], v[68:71]
ds_read_b128 a[68:71], v201 offset:35840
v_mul_f32 v192, v192, v140
v_mfma_f32_16x16x32_bf16 v[72:75], a[16:19], a[84:87], v[72:75]
s_cmp_eq_u32 s25, 5
s_cselect_b32 s98, 4096, 0
v_mfma_f32_16x16x32_bf16 v[76:79], a[20:23], a[80:83], v[76:79]
s_add_u32 s52, s52, s98
v_mul_f32 v193, v193, v141
v_mfma_f32_16x16x32_bf16 v[80:83], a[20:23], a[84:87], v[80:83]
s_add_u32 s52, s52, 4096
v_mfma_f32_16x16x32_bf16 v[84:87], a[24:27], a[80:83], v[84:87]
v_mfma_f32_16x16x32_bf16 v[88:91], a[24:27], a[84:87], v[88:91]
v_mul_f32 v194, v194, v142
v_mfma_f32_16x16x32_bf16 v[92:95], a[28:31], a[80:83], v[92:95]
buffer_load_dwordx4 a[192:195], v1, s[4:7], s52 offen offset:0 sc1
v_mfma_f32_16x16x32_bf16 v[96:99], a[28:31], a[84:87], v[96:99]
v_mul_f32 v195, v195, v143
v_mfma_f32_16x16x32_bf16 v[100:103], a[32:35], a[80:83], v[100:103]
v_mfma_f32_16x16x32_bf16 v[104:107], a[32:35], a[84:87], v[104:107]
s_waitcnt vmcnt(22) lgkmcnt(0)
s_barrier
v_mfma_f32_16x16x32_bf16 v[36:39], a[36:39], a[88:91], v[36:39]
ds_read_b128 a[0:3], v202 offset:0
buffer_load_dwordx4 a[196:199], v9, s[4:7], s52 offen offset:0 sc1
v_mfma_f32_16x16x32_bf16 v[40:43], a[36:39], a[92:95], v[40:43]
ds_read_b128 a[4:7], v202 offset:1024
buffer_load_dwordx4 a[200:203], v1, s[4:7], s52 offen offset:1024 sc1
v_mfma_f32_16x16x32_bf16 v[44:47], a[40:43], a[88:91], v[44:47]
ds_read_b128 a[8:11], v202 offset:2048
v_mfma_f32_16x16x32_bf16 v[48:51], a[40:43], a[92:95], v[48:51]
ds_read_b128 a[12:15], v202 offset:3072
buffer_load_dwordx4 a[204:207], v9, s[4:7], s52 offen offset:1024 sc1
v_mfma_f32_16x16x32_bf16 v[52:55], a[44:47], a[88:91], v[52:55]
ds_read_b128 a[16:19], v202 offset:4096
v_mfma_f32_16x16x32_bf16 v[56:59], a[44:47], a[92:95], v[56:59]
ds_read_b128 a[20:23], v202 offset:5120
v_mfma_f32_16x16x32_bf16 v[60:63], a[48:51], a[88:91], v[60:63]
ds_read_b128 a[24:27], v202 offset:6144
v_mfma_f32_16x16x32_bf16 v[64:67], a[48:51], a[92:95], v[64:67]
ds_read_b128 a[28:31], v202 offset:7168
v_mfma_f32_16x16x32_bf16 v[68:71], a[52:55], a[88:91], v[68:71]
ds_read_b128 a[32:35], v202 offset:8192
v_mfma_f32_16x16x32_bf16 v[72:75], a[52:55], a[92:95], v[72:75]
s_cmp_eq_u32 s25, 4
s_cselect_b32 s99, 36864, 0
s_add_u32 s60, s60, s99
v_mfma_f32_16x16x32_bf16 v[76:79], a[56:59], a[88:91], v[76:79]
s_add_u32 s61, s61, s99
v_exp_f32 v192, v192
v_mfma_f32_16x16x32_bf16 v[80:83], a[56:59], a[92:95], v[80:83]
s_add_u32 m0, s62, 90112
v_exp_f32 v193, v193
v_mfma_f32_16x16x32_bf16 v[84:87], a[60:63], a[88:91], v[84:87]
s_add_u32 s60, s60, 16384
v_exp_f32 v194, v194
v_mfma_f32_16x16x32_bf16 v[88:91], a[60:63], a[92:95], v[88:91]
v_mfma_f32_16x16x32_bf16 v[92:95], a[64:67], a[88:91], v[92:95]
v_exp_f32 v195, v195
v_mfma_f32_16x16x32_bf16 v[96:99], a[64:67], a[92:95], v[96:99]
buffer_load_dwordx4 v1, s[8:11], s60 offen offset:0 sc1 lds
v_mfma_f32_16x16x32_bf16 v[100:103], a[68:71], a[88:91], v[100:103]
v_mfma_f32_16x16x32_bf16 v[104:107], a[68:71], a[92:95], v[104:107]
s_waitcnt lgkmcnt(0)
v_mfma_f32_16x16x32_bf16 v[36:39], a[0:3], a[96:99], v[36:39]
ds_read_b128 a[36:39], v202 offset:9216
buffer_load_dwordx4 v1, s[8:11], s60 offen offset:1024 sc1 lds
v_mfma_f32_16x16x32_bf16 v[40:43], a[0:3], a[100:103], v[40:43]
ds_read_b128 a[40:43], v202 offset:10240
v_fma_f32 v192, v192, v254, v254
v_mfma_f32_16x16x32_bf16 v[44:47], a[4:7], a[96:99], v[44:47]
ds_read_b128 a[44:47], v202 offset:11264
buffer_load_dwordx4 v1, s[8:11], s60 offen offset:2048 sc1 lds
v_mfma_f32_16x16x32_bf16 v[48:51], a[4:7], a[100:103], v[48:51]
ds_read_b128 a[48:51], v202 offset:12288
v_fma_f32 v193, v193, v254, v254
v_mfma_f32_16x16x32_bf16 v[52:55], a[8:11], a[96:99], v[52:55]
ds_read_b128 a[52:55], v202 offset:13312
v_mfma_f32_16x16x32_bf16 v[56:59], a[8:11], a[100:103], v[56:59]
ds_read_b128 a[56:59], v202 offset:14336
buffer_load_dwordx4 v1, s[8:11], s60 offen offset:3072 sc1 lds
v_mfma_f32_16x16x32_bf16 v[60:63], a[12:15], a[96:99], v[60:63]
ds_read_b128 a[60:63], v202 offset:15360
v_fma_f32 v194, v194, v254, v254
v_mfma_f32_16x16x32_bf16 v[64:67], a[12:15], a[100:103], v[64:67]
ds_read_b128 a[64:67], v202 offset:16384
v_fma_f32 v195, v195, v254, v254
v_mfma_f32_16x16x32_bf16 v[68:71], a[16:19], a[96:99], v[68:71]
ds_read_b128 a[68:71], v202 offset:17408
s_add_u32 m0, s63, 106496
v_mfma_f32_16x16x32_bf16 v[72:75], a[16:19], a[100:103], v[72:75]
s_add_u32 s61, s61, 36864
v_mfma_f32_16x16x32_bf16 v[76:79], a[20:23], a[96:99], v[76:79]
v_rcp_f32 v192, v192
v_mfma_f32_16x16x32_bf16 v[80:83], a[20:23], a[100:103], v[80:83]
v_mfma_f32_16x16x32_bf16 v[84:87], a[24:27], a[96:99], v[84:87]
v_mfma_f32_16x16x32_bf16 v[88:91], a[24:27], a[100:103], v[88:91]
v_mfma_f32_16x16x32_bf16 v[92:95], a[28:31], a[96:99], v[92:95]
buffer_load_dwordx4 v1, s[8:11], s61 offen offset:0 sc1 lds
v_mfma_f32_16x16x32_bf16 v[96:99], a[28:31], a[100:103], v[96:99]
v_rcp_f32 v193, v193
v_mfma_f32_16x16x32_bf16 v[100:103], a[32:35], a[96:99], v[100:103]
v_mfma_f32_16x16x32_bf16 v[104:107], a[32:35], a[100:103], v[104:107]
s_waitcnt lgkmcnt(0)
v_mfma_f32_16x16x32_bf16 v[36:39], a[36:39], a[104:107], v[36:39]
ds_read_b128 a[0:3], v202 offset:18432
s_add_u32 m0, s62, 110592
v_mfma_f32_16x16x32_bf16 v[40:43], a[36:39], a[108:111], v[40:43]
ds_read_b128 a[4:7], v202 offset:19456
v_mfma_f32_16x16x32_bf16 v[44:47], a[40:43], a[104:107], v[44:47]
ds_read_b128 a[8:11], v202 offset:20480
s_add_u32 s60, s60, 20480
v_mfma_f32_16x16x32_bf16 v[48:51], a[40:43], a[108:111], v[48:51]
ds_read_b128 a[12:15], v202 offset:21504
v_mfma_f32_16x16x32_bf16 v[52:55], a[44:47], a[104:107], v[52:55]
ds_read_b128 a[16:19], v202 offset:22528
v_mfma_f32_16x16x32_bf16 v[56:59], a[44:47], a[108:111], v[56:59]
ds_read_b128 a[20:23], v202 offset:23552
buffer_load_dwordx4 v1, s[8:11], s60 offen offset:0 sc1 lds
v_mfma_f32_16x16x32_bf16 v[60:63], a[48:51], a[104:107], v[60:63]
ds_read_b128 a[24:27], v202 offset:24576
v_mfma_f32_16x16x32_bf16 v[64:67], a[48:51], a[108:111], v[64:67]
ds_read_b128 a[28:31], v202 offset:25600
v_mfma_f32_16x16x32_bf16 v[68:71], a[52:55], a[104:107], v[68:71]
ds_read_b128 a[32:35], v202 offset:26624
buffer_load_dwordx4 v1, s[8:11], s60 offen offset:1024 sc1 lds
v_mfma_f32_16x16x32_bf16 v[72:75], a[52:55], a[108:111], v[72:75]
v_rcp_f32 v194, v194
v_mfma_f32_16x16x32_bf16 v[76:79], a[56:59], a[104:107], v[76:79]
v_rcp_f32 v195, v195
v_mfma_f32_16x16x32_bf16 v[80:83], a[56:59], a[108:111], v[80:83]
buffer_load_dwordx4 v1, s[8:11], s60 offen offset:2048 sc1 lds
v_mul_f32 v140, v140, v192
v_mfma_f32_16x16x32_bf16 v[84:87], a[60:63], a[104:107], v[84:87]
v_mfma_f32_16x16x32_bf16 v[88:91], a[60:63], a[108:111], v[88:91]
v_mul_f32 v141, v141, v193
v_mfma_f32_16x16x32_bf16 v[92:95], a[64:67], a[104:107], v[92:95]
buffer_load_dwordx4 v1, s[8:11], s60 offen offset:3072 sc1 lds
v_mfma_f32_16x16x32_bf16 v[96:99], a[64:67], a[108:111], v[96:99]
v_mul_f32 v142, v142, v194
v_mfma_f32_16x16x32_bf16 v[100:103], a[68:71], a[104:107], v[100:103]
v_mfma_f32_16x16x32_bf16 v[104:107], a[68:71], a[108:111], v[104:107]
s_waitcnt lgkmcnt(0)
v_mfma_f32_16x16x32_bf16 v[36:39], a[0:3], a[112:115], v[36:39]
ds_read_b128 a[36:39], v202 offset:27648
buffer_load_dwordx4 a[208:211], v1, s[4:7], s52 offen offset:2048 sc1
v_mfma_f32_16x16x32_bf16 v[40:43], a[0:3], a[116:119], v[40:43]
ds_read_b128 a[40:43], v202 offset:28672
v_mul_f32 v143, v143, v195
v_mfma_f32_16x16x32_bf16 v[44:47], a[4:7], a[112:115], v[44:47]
ds_read_b128 a[44:47], v202 offset:29696
v_mul_f32 v196, v144, v144
v_mfma_f32_16x16x32_bf16 v[48:51], a[4:7], a[116:119], v[48:51]
ds_read_b128 a[48:51], v202 offset:30720
v_mfma_f32_16x16x32_bf16 v[52:55], a[8:11], a[112:115], v[52:55]
ds_read_b128 a[52:55], v202 offset:31744
buffer_load_dwordx4 a[212:215], v9, s[4:7], s52 offen offset:2048 sc1
v_mfma_f32_16x16x32_bf16 v[56:59], a[8:11], a[116:119], v[56:59]
ds_read_b128 a[56:59], v202 offset:32768
v_mul_f32 v197, v145, v145
v_mfma_f32_16x16x32_bf16 v[60:63], a[12:15], a[112:115], v[60:63]
ds_read_b128 a[60:63], v202 offset:33792
v_mfma_f32_16x16x32_bf16 v[64:67], a[12:15], a[116:119], v[64:67]
ds_read_b128 a[64:67], v202 offset:34816
v_mul_f32 v198, v146, v146
v_mfma_f32_16x16x32_bf16 v[68:71], a[16:19], a[112:115], v[68:71]
ds_read_b128 a[68:71], v202 offset:35840
buffer_load_dwordx4 a[216:219], v1, s[4:7], s52 offen offset:3072 sc1
v_mfma_f32_16x16x32_bf16 v[72:75], a[16:19], a[116:119], v[72:75]
v_mul_f32 v199, v147, v147
v_mfma_f32_16x16x32_bf16 v[76:79], a[20:23], a[112:115], v[76:79]
v_mfma_f32_16x16x32_bf16 v[80:83], a[20:23], a[116:119], v[80:83]
v_fma_f32 v196, v196, v253, v251
v_mfma_f32_16x16x32_bf16 v[84:87], a[24:27], a[112:115], v[84:87]
buffer_load_dwordx4 a[220:223], v9, s[4:7], s52 offen offset:3072 sc1
v_mfma_f32_16x16x32_bf16 v[88:91], a[24:27], a[116:119], v[88:91]
v_mfma_f32_16x16x32_bf16 v[92:95], a[28:31], a[112:115], v[92:95]
v_fma_f32 v197, v197, v253, v251
v_mfma_f32_16x16x32_bf16 v[96:99], a[28:31], a[116:119], v[96:99]
v_mfma_f32_16x16x32_bf16 v[100:103], a[32:35], a[112:115], v[100:103]
v_fma_f32 v198, v198, v253, v251
v_mfma_f32_16x16x32_bf16 v[104:107], a[32:35], a[116:119], v[104:107]
s_waitcnt vmcnt(21) lgkmcnt(0)
s_barrier
v_mfma_f32_16x16x32_bf16 v[36:39], a[36:39], a[120:123], v[36:39]
ds_read_b128 a[0:3], v200 offset:0
v_mfma_f32_16x16x32_bf16 v[40:43], a[36:39], a[124:127], v[40:43]
ds_read_b128 a[4:7], v200 offset:1024
v_fma_f32 v199, v199, v253, v251
v_mfma_f32_16x16x32_bf16 v[44:47], a[40:43], a[120:123], v[44:47]
ds_read_b128 a[8:11], v200 offset:2048
v_mfma_f32_16x16x32_bf16 v[48:51], a[40:43], a[124:127], v[48:51]
ds_read_b128 a[12:15], v200 offset:3072
v_mul_f32 v196, v196, v144
v_mfma_f32_16x16x32_bf16 v[52:55], a[44:47], a[120:123], v[52:55]
ds_read_b128 a[16:19], v200 offset:4096
v_mfma_f32_16x16x32_bf16 v[56:59], a[44:47], a[124:127], v[56:59]
ds_read_b128 a[20:23], v200 offset:5120
v_mul_f32 v197, v197, v145
v_mfma_f32_16x16x32_bf16 v[60:63], a[48:51], a[120:123], v[60:63]
ds_read_b128 a[24:27], v200 offset:6144
v_mfma_f32_16x16x32_bf16 v[64:67], a[48:51], a[124:127], v[64:67]
ds_read_b128 a[28:31], v200 offset:7168
v_mfma_f32_16x16x32_bf16 v[68:71], a[52:55], a[120:123], v[68:71]
ds_read_b128 a[32:35], v200 offset:8192
v_mul_f32 v198, v198, v146
v_mfma_f32_16x16x32_bf16 v[72:75], a[52:55], a[124:127], v[72:75]
s_cmp_eq_u32 s25, 5
s_cselect_b32 s99, 36864, 0
s_add_u32 s60, s60, s99
v_mfma_f32_16x16x32_bf16 v[76:79], a[56:59], a[120:123], v[76:79]
s_add_u32 s61, s61, s99
s_add_u32 m0, s62, 126976
s_add_u32 s60, s60, 16384
v_mfma_f32_16x16x32_bf16 v[80:83], a[56:59], a[124:127], v[80:83]
buffer_load_dwordx4 v1, s[8:11], s60 offen offset:0 sc1 lds
v_mul_f32 v199, v199, v147
v_mfma_f32_16x16x32_bf16 v[84:87], a[60:63], a[120:123], v[84:87]
buffer_load_dwordx4 v1, s[8:11], s60 offen offset:1024 sc1 lds
v_mfma_f32_16x16x32_bf16 v[88:91], a[60:63], a[124:127], v[88:91]
buffer_load_dwordx4 v1, s[8:11], s60 offen offset:2048 sc1 lds
v_mfma_f32_16x16x32_bf16 v[92:95], a[64:67], a[120:123], v[92:95]
v_exp_f32 v196, v196
v_mfma_f32_16x16x32_bf16 v[96:99], a[64:67], a[124:127], v[96:99]
buffer_load_dwordx4 v1, s[8:11], s60 offen offset:3072 sc1 lds
v_mfma_f32_16x16x32_bf16 v[100:103], a[68:71], a[120:123], v[100:103]
v_mfma_f32_16x16x32_bf16 v[104:107], a[68:71], a[124:127], v[104:107]
s_waitcnt lgkmcnt(0)
v_mfma_f32_16x16x32_bf16 v[36:39], a[0:3], a[128:131], v[36:39]
ds_read_b128 a[36:39], v200 offset:9216
s_add_u32 m0, s63, 143360
v_mfma_f32_16x16x32_bf16 v[40:43], a[0:3], a[132:135], v[40:43]
ds_read_b128 a[40:43], v200 offset:10240
v_mfma_f32_16x16x32_bf16 v[44:47], a[4:7], a[128:131], v[44:47]
ds_read_b128 a[44:47], v200 offset:11264
s_add_u32 s61, s61, 36864
v_mfma_f32_16x16x32_bf16 v[48:51], a[4:7], a[132:135], v[48:51]
ds_read_b128 a[48:51], v200 offset:12288
v_mfma_f32_16x16x32_bf16 v[52:55], a[8:11], a[128:131], v[52:55]
ds_read_b128 a[52:55], v200 offset:13312
buffer_load_dwordx4 v1, s[8:11], s61 offen offset:0 sc1 lds
v_mfma_f32_16x16x32_bf16 v[56:59], a[8:11], a[132:135], v[56:59]
ds_read_b128 a[56:59], v200 offset:14336
v_mfma_f32_16x16x32_bf16 v[60:63], a[12:15], a[128:131], v[60:63]
ds_read_b128 a[60:63], v200 offset:15360
s_add_u32 m0, s62, 147456
v_mfma_f32_16x16x32_bf16 v[64:67], a[12:15], a[132:135], v[64:67]
ds_read_b128 a[64:67], v200 offset:16384
v_mfma_f32_16x16x32_bf16 v[68:71], a[16:19], a[128:131], v[68:71]
ds_read_b128 a[68:71], v200 offset:17408
s_add_u32 s60, s60, 20480
v_mfma_f32_16x16x32_bf16 v[72:75], a[16:19], a[132:135], v[72:75]
v_exp_f32 v197, v197
v_mfma_f32_16x16x32_bf16 v[76:79], a[20:23], a[128:131], v[76:79]
buffer_load_dwordx4 v1, s[8:11], s60 offen offset:0 sc1 lds
v_mfma_f32_16x16x32_bf16 v[80:83], a[20:23], a[132:135], v[80:83]
v_exp_f32 v198, v198
v_mfma_f32_16x16x32_bf16 v[84:87], a[24:27], a[128:131], v[84:87]
buffer_load_dwordx4 v1, s[8:11], s60 offen offset:1024 sc1 lds
v_mfma_f32_16x16x32_bf16 v[88:91], a[24:27], a[132:135], v[88:91]
v_exp_f32 v199, v199
v_mfma_f32_16x16x32_bf16 v[92:95], a[28:31], a[128:131], v[92:95]
buffer_load_dwordx4 v1, s[8:11], s60 offen offset:2048 sc1 lds
v_fma_f32 v196, v196, v255, v255
v_mfma_f32_16x16x32_bf16 v[96:99], a[28:31], a[132:135], v[96:99]
v_mfma_f32_16x16x32_bf16 v[100:103], a[32:35], a[128:131], v[100:103]
v_fma_f32 v197, v197, v255, v255
v_mfma_f32_16x16x32_bf16 v[104:107], a[32:35], a[132:135], v[104:107]
s_waitcnt lgkmcnt(0)
v_mfma_f32_16x16x32_bf16 v[36:39], a[36:39], a[136:139], v[36:39]
ds_read_b128 a[0:3], v200 offset:18432
buffer_load_dwordx4 v1, s[8:11], s60 offen offset:3072 sc1 lds
v_mfma_f32_16x16x32_bf16 v[40:43], a[36:39], a[140:143], v[40:43]
ds_read_b128 a[4:7], v200 offset:19456
v_fma_f32 v198, v198, v255, v255
v_mfma_f32_16x16x32_bf16 v[44:47], a[40:43], a[136:139], v[44:47]
ds_read_b128 a[8:11], v200 offset:20480
v_fma_f32 v199, v199, v255, v255
v_mfma_f32_16x16x32_bf16 v[48:51], a[40:43], a[140:143], v[48:51]
ds_read_b128 a[12:15], v200 offset:21504
v_mfma_f32_16x16x32_bf16 v[52:55], a[44:47], a[136:139], v[52:55]
ds_read_b128 a[16:19], v200 offset:22528
v_mfma_f32_16x16x32_bf16 v[56:59], a[44:47], a[140:143], v[56:59]
ds_read_b128 a[20:23], v200 offset:23552
v_mfma_f32_16x16x32_bf16 v[60:63], a[48:51], a[136:139], v[60:63]
ds_read_b128 a[24:27], v200 offset:24576
v_mfma_f32_16x16x32_bf16 v[64:67], a[48:51], a[140:143], v[64:67]
ds_read_b128 a[28:31], v200 offset:25600
v_mfma_f32_16x16x32_bf16 v[68:71], a[52:55], a[136:139], v[68:71]
ds_read_b128 a[32:35], v200 offset:26624
v_mfma_f32_16x16x32_bf16 v[72:75], a[52:55], a[140:143], v[72:75]
s_cmp_eq_u32 s25, 6
s_cselect_b32 s98, 4096, 0
s_add_u32 s52, s52, s98
v_mfma_f32_16x16x32_bf16 v[76:79], a[56:59], a[136:139], v[76:79]
s_add_u32 s52, s52, 4096
v_rcp_f32 v196, v196
v_mfma_f32_16x16x32_bf16 v[80:83], a[56:59], a[140:143], v[80:83]
buffer_load_dwordx4 a[224:227], v1, s[4:7], s52 offen offset:0 sc1
v_mfma_f32_16x16x32_bf16 v[84:87], a[60:63], a[136:139], v[84:87]
buffer_load_dwordx4 a[228:231], v9, s[4:7], s52 offen offset:0 sc1
v_mfma_f32_16x16x32_bf16 v[88:91], a[60:63], a[140:143], v[88:91]
v_rcp_f32 v197, v197
v_mfma_f32_16x16x32_bf16 v[92:95], a[64:67], a[136:139], v[92:95]
buffer_load_dwordx4 a[232:235], v1, s[4:7], s52 offen offset:1024 sc1
v_mfma_f32_16x16x32_bf16 v[96:99], a[64:67], a[140:143], v[96:99]
v_rcp_f32 v198, v198
v_mfma_f32_16x16x32_bf16 v[100:103], a[68:71], a[136:139], v[100:103]
v_mfma_f32_16x16x32_bf16 v[104:107], a[68:71], a[140:143], v[104:107]
s_waitcnt lgkmcnt(0)
v_mfma_f32_16x16x32_bf16 v[36:39], a[0:3], a[144:147], v[36:39]
ds_read_b128 a[36:39], v200 offset:27648
buffer_load_dwordx4 a[236:239], v9, s[4:7], s52 offen offset:1024 sc1
v_mfma_f32_16x16x32_bf16 v[40:43], a[0:3], a[148:151], v[40:43]
ds_read_b128 a[40:43], v200 offset:28672
v_mfma_f32_16x16x32_bf16 v[44:47], a[4:7], a[144:147], v[44:47]
ds_read_b128 a[44:47], v200 offset:29696
v_mfma_f32_16x16x32_bf16 v[48:51], a[4:7], a[148:151], v[48:51]
ds_read_b128 a[48:51], v200 offset:30720
v_mfma_f32_16x16x32_bf16 v[52:55], a[8:11], a[144:147], v[52:55]
ds_read_b128 a[52:55], v200 offset:31744
buffer_load_dwordx4 a[240:243], v1, s[4:7], s52 offen offset:2048 sc1
v_mfma_f32_16x16x32_bf16 v[56:59], a[8:11], a[148:151], v[56:59]
ds_read_b128 a[56:59], v200 offset:32768
v_mfma_f32_16x16x32_bf16 v[60:63], a[12:15], a[144:147], v[60:63]
ds_read_b128 a[60:63], v200 offset:33792
v_mfma_f32_16x16x32_bf16 v[64:67], a[12:15], a[148:151], v[64:67]
ds_read_b128 a[64:67], v200 offset:34816
v_mfma_f32_16x16x32_bf16 v[68:71], a[16:19], a[144:147], v[68:71]
ds_read_b128 a[68:71], v200 offset:35840
buffer_load_dwordx4 a[244:247], v9, s[4:7], s52 offen offset:2048 sc1
v_mfma_f32_16x16x32_bf16 v[72:75], a[16:19], a[148:151], v[72:75]
v_rcp_f32 v199, v199
v_mfma_f32_16x16x32_bf16 v[76:79], a[20:23], a[144:147], v[76:79]
v_mul_f32 v144, v144, v196
v_mul_f32 v145, v145, v197
v_mfma_f32_16x16x32_bf16 v[80:83], a[20:23], a[148:151], v[80:83]
v_mul_f32 v146, v146, v198
v_mfma_f32_16x16x32_bf16 v[84:87], a[24:27], a[144:147], v[84:87]
buffer_load_dwordx4 a[248:251], v1, s[4:7], s52 offen offset:3072 sc1
v_mfma_f32_16x16x32_bf16 v[88:91], a[24:27], a[148:151], v[88:91]
v_mul_f32 v147, v147, v199
v_mfma_f32_16x16x32_bf16 v[92:95], a[28:31], a[144:147], v[92:95]
v_mfma_f32_16x16x32_bf16 v[96:99], a[28:31], a[148:151], v[96:99]
v_mul_f32 v192, v148, v148
v_mfma_f32_16x16x32_bf16 v[100:103], a[32:35], a[144:147], v[100:103]
v_mfma_f32_16x16x32_bf16 v[104:107], a[32:35], a[148:151], v[104:107]
s_waitcnt vmcnt(20) lgkmcnt(0)
s_barrier
v_mfma_f32_16x16x32_bf16 v[36:39], a[36:39], a[152:155], v[36:39]
ds_read_b128 a[0:3], v201 offset:0
buffer_load_dwordx4 a[252:255], v9, s[4:7], s52 offen offset:3072 sc1
v_mfma_f32_16x16x32_bf16 v[40:43], a[36:39], a[156:159], v[40:43]
ds_read_b128 a[4:7], v201 offset:1024
v_mul_f32 v193, v149, v149
v_mfma_f32_16x16x32_bf16 v[44:47], a[40:43], a[152:155], v[44:47]
ds_read_b128 a[8:11], v201 offset:2048
v_mul_f32 v194, v150, v150
v_mfma_f32_16x16x32_bf16 v[48:51], a[40:43], a[156:159], v[48:51]
ds_read_b128 a[12:15], v201 offset:3072
v_mfma_f32_16x16x32_bf16 v[52:55], a[44:47], a[152:155], v[52:55]
ds_read_b128 a[16:19], v201 offset:4096
v_mul_f32 v195, v151, v151
v_mfma_f32_16x16x32_bf16 v[56:59], a[44:47], a[156:159], v[56:59]
ds_read_b128 a[20:23], v201 offset:5120
v_mfma_f32_16x16x32_bf16 v[60:63], a[48:51], a[152:155], v[60:63]
ds_read_b128 a[24:27], v201 offset:6144
v_fma_f32 v192, v192, v252, v250
v_mfma_f32_16x16x32_bf16 v[64:67], a[48:51], a[156:159], v[64:67]
ds_read_b128 a[28:31], v201 offset:7168
v_mfma_f32_16x16x32_bf16 v[68:71], a[52:55], a[152:155], v[68:71]
ds_read_b128 a[32:35], v201 offset:8192
v_mfma_f32_16x16x32_bf16 v[72:75], a[52:55], a[156:159], v[72:75]
s_cmp_eq_u32 s25, 6
s_cselect_b32 s99, 36864, 0
s_add_u32 s60, s60, s99
v_mfma_f32_16x16x32_bf16 v[76:79], a[56:59], a[152:155], v[76:79]
s_add_u32 s61, s61, s99
s_add_u32 m0, s62, 53248
s_add_u32 s60, s60, 16384
v_mfma_f32_16x16x32_bf16 v[80:83], a[56:59], a[156:159], v[80:83]
buffer_load_dwordx4 v1, s[8:11], s60 offen offset:0 sc1 lds
v_fma_f32 v193, v193, v252, v250
v_mfma_f32_16x16x32_bf16 v[84:87], a[60:63], a[152:155], v[84:87]
v_fma_f32 v194, v194, v252, v250
v_mfma_f32_16x16x32_bf16 v[88:91], a[60:63], a[156:159], v[88:91]
buffer_load_dwordx4 v1, s[8:11], s60 offen offset:1024 sc1 lds
v_fma_f32 v195, v195, v252, v250
v_mfma_f32_16x16x32_bf16 v[92:95], a[64:67], a[152:155], v[92:95]
v_mfma_f32_16x16x32_bf16 v[96:99], a[64:67], a[156:159], v[96:99]
buffer_load_dwordx4 v1, s[8:11], s60 offen offset:2048 sc1 lds
v_mfma_f32_16x16x32_bf16 v[100:103], a[68:71], a[152:155], v[100:103]
v_mul_f32 v192, v192, v148
v_mfma_f32_16x16x32_bf16 v[104:107], a[68:71], a[156:159], v[104:107]
s_waitcnt lgkmcnt(0)
v_mfma_f32_16x16x32_bf16 v[36:39], a[0:3], a[160:163], v[36:39]
ds_read_b128 a[36:39], v201 offset:9216
buffer_load_dwordx4 v1, s[8:11], s60 offen offset:3072 sc1 lds
v_mfma_f32_16x16x32_bf16 v[40:43], a[0:3], a[164:167], v[40:43]
ds_read_b128 a[40:43], v201 offset:10240
v_mul_f32 v193, v193, v149
v_mfma_f32_16x16x32_bf16 v[44:47], a[4:7], a[160:163], v[44:47]
ds_read_b128 a[44:47], v201 offset:11264
s_add_u32 m0, s63, 69632
v_mfma_f32_16x16x32_bf16 v[48:51], a[4:7], a[164:167], v[48:51]
ds_read_b128 a[48:51], v201 offset:12288
v_mul_f32 v194, v194, v150
v_mfma_f32_16x16x32_bf16 v[52:55], a[8:11], a[160:163], v[52:55]
ds_read_b128 a[52:55], v201 offset:13312
s_add_u32 s61, s61, 36864
v_mfma_f32_16x16x32_bf16 v[56:59], a[8:11], a[164:167], v[56:59]
ds_read_b128 a[56:59], v201 offset:14336
v_mul_f32 v195, v195, v151
v_mfma_f32_16x16x32_bf16 v[60:63], a[12:15], a[160:163], v[60:63]
ds_read_b128 a[60:63], v201 offset:15360
buffer_load_dwordx4 v1, s[8:11], s61 offen offset:0 sc1 lds
v_mfma_f32_16x16x32_bf16 v[64:67], a[12:15], a[164:167], v[64:67]
ds_read_b128 a[64:67], v201 offset:16384
v_mfma_f32_16x16x32_bf16 v[68:71], a[16:19], a[160:163], v[68:71]
ds_read_b128 a[68:71], v201 offset:17408
s_add_u32 m0, s62, 73728
v_mfma_f32_16x16x32_bf16 v[72:75], a[16:19], a[164:167], v[72:75]
s_add_u32 s60, s60, 20480
v_exp_f32 v192, v192
v_mfma_f32_16x16x32_bf16 v[76:79], a[20:23], a[160:163], v[76:79]
v_mfma_f32_16x16x32_bf16 v[80:83], a[20:23], a[164:167], v[80:83]
v_mfma_f32_16x16x32_bf16 v[84:87], a[24:27], a[160:163], v[84:87]
buffer_load_dwordx4 v1, s[8:11], s60 offen offset:0 sc1 lds
v_mfma_f32_16x16x32_bf16 v[88:91], a[24:27], a[164:167], v[88:91]
v_exp_f32 v193, v193
v_mfma_f32_16x16x32_bf16 v[92:95], a[28:31], a[160:163], v[92:95]
buffer_load_dwordx4 v1, s[8:11], s60 offen offset:1024 sc1 lds
v_mfma_f32_16x16x32_bf16 v[96:99], a[28:31], a[164:167], v[96:99]
v_mfma_f32_16x16x32_bf16 v[100:103], a[32:35], a[160:163], v[100:103]
v_mfma_f32_16x16x32_bf16 v[104:107], a[32:35], a[164:167], v[104:107]
s_waitcnt lgkmcnt(0)
v_mfma_f32_16x16x32_bf16 v[36:39], a[36:39], a[168:171], v[36:39]
ds_read_b128 a[0:3], v201 offset:18432
buffer_load_dwordx4 v1, s[8:11], s60 offen offset:2048 sc1 lds
v_mfma_f32_16x16x32_bf16 v[40:43], a[36:39], a[172:175], v[40:43]
ds_read_b128 a[4:7], v201 offset:19456
v_mfma_f32_16x16x32_bf16 v[44:47], a[40:43], a[168:171], v[44:47]
ds_read_b128 a[8:11], v201 offset:20480
buffer_load_dwordx4 v1, s[8:11], s60 offen offset:3072 sc1 lds
v_mfma_f32_16x16x32_bf16 v[48:51], a[40:43], a[172:175], v[48:51]
ds_read_b128 a[12:15], v201 offset:21504
v_mfma_f32_16x16x32_bf16 v[52:55], a[44:47], a[168:171], v[52:55]
ds_read_b128 a[16:19], v201 offset:22528
v_mfma_f32_16x16x32_bf16 v[56:59], a[44:47], a[172:175], v[56:59]
ds_read_b128 a[20:23], v201 offset:23552
v_mfma_f32_16x16x32_bf16 v[60:63], a[48:51], a[168:171], v[60:63]
ds_read_b128 a[24:27], v201 offset:24576
v_mfma_f32_16x16x32_bf16 v[64:67], a[48:51], a[172:175], v[64:67]
ds_read_b128 a[28:31], v201 offset:25600
v_mfma_f32_16x16x32_bf16 v[68:71], a[52:55], a[168:171], v[68:71]
ds_read_b128 a[32:35], v201 offset:26624
v_mfma_f32_16x16x32_bf16 v[72:75], a[52:55], a[172:175], v[72:75]
s_cmp_eq_u32 s25, 7
s_cselect_b32 s98, 4096, 0
s_add_u32 s52, s52, s98
v_mfma_f32_16x16x32_bf16 v[76:79], a[56:59], a[168:171], v[76:79]
s_add_u32 s52, s52, 4096
v_exp_f32 v194, v194
v_mfma_f32_16x16x32_bf16 v[80:83], a[56:59], a[172:175], v[80:83]
v_exp_f32 v195, v195
v_mfma_f32_16x16x32_bf16 v[84:87], a[60:63], a[168:171], v[84:87]
buffer_load_dwordx4 a[80:83], v1, s[4:7], s52 offen offset:0 sc1
v_fma_f32 v192, v192, v254, v254
v_mfma_f32_16x16x32_bf16 v[88:91], a[60:63], a[172:175], v[88:91]
v_fma_f32 v193, v193, v254, v254
v_fma_f32 v194, v194, v254, v254
v_mfma_f32_16x16x32_bf16 v[92:95], a[64:67], a[168:171], v[92:95]
buffer_load_dwordx4 a[84:87], v9, s[4:7], s52 offen offset:0 sc1
v_mfma_f32_16x16x32_bf16 v[96:99], a[64:67], a[172:175], v[96:99]
v_fma_f32 v195, v195, v254, v254
v_mfma_f32_16x16x32_bf16 v[100:103], a[68:71], a[168:171], v[100:103]
v_mfma_f32_16x16x32_bf16 v[104:107], a[68:71], a[172:175], v[104:107]
s_waitcnt lgkmcnt(0)
v_mfma_f32_16x16x32_bf16 v[36:39], a[0:3], a[176:179], v[36:39]
ds_read_b128 a[36:39], v201 offset:27648
buffer_load_dwordx4 a[88:91], v1, s[4:7], s52 offen offset:1024 sc1
v_mfma_f32_16x16x32_bf16 v[40:43], a[0:3], a[180:183], v[40:43]
ds_read_b128 a[40:43], v201 offset:28672
v_mfma_f32_16x16x32_bf16 v[44:47], a[4:7], a[176:179], v[44:47]
ds_read_b128 a[44:47], v201 offset:29696
v_mfma_f32_16x16x32_bf16 v[48:51], a[4:7], a[180:183], v[48:51]
ds_read_b128 a[48:51], v201 offset:30720
v_mfma_f32_16x16x32_bf16 v[52:55], a[8:11], a[176:179], v[52:55]
ds_read_b128 a[52:55], v201 offset:31744
buffer_load_dwordx4 a[92:95], v9, s[4:7], s52 offen offset:1024 sc1
v_mfma_f32_16x16x32_bf16 v[56:59], a[8:11], a[180:183], v[56:59]
ds_read_b128 a[56:59], v201 offset:32768
v_mfma_f32_16x16x32_bf16 v[60:63], a[12:15], a[176:179], v[60:63]
ds_read_b128 a[60:63], v201 offset:33792
v_mfma_f32_16x16x32_bf16 v[64:67], a[12:15], a[180:183], v[64:67]
ds_read_b128 a[64:67], v201 offset:34816
v_mfma_f32_16x16x32_bf16 v[68:71], a[16:19], a[176:179], v[68:71]
ds_read_b128 a[68:71], v201 offset:35840
buffer_load_dwordx4 a[96:99], v1, s[4:7], s52 offen offset:2048 sc1
v_mfma_f32_16x16x32_bf16 v[72:75], a[16:19], a[180:183], v[72:75]
v_rcp_f32 v192, v192
v_mfma_f32_16x16x32_bf16 v[76:79], a[20:23], a[176:179], v[76:79]
v_rcp_f32 v193, v193
v_mfma_f32_16x16x32_bf16 v[80:83], a[20:23], a[180:183], v[80:83]
v_rcp_f32 v194, v194
v_mfma_f32_16x16x32_bf16 v[84:87], a[24:27], a[176:179], v[84:87]
buffer_load_dwordx4 a[100:103], v9, s[4:7], s52 offen offset:2048 sc1
v_mfma_f32_16x16x32_bf16 v[88:91], a[24:27], a[180:183], v[88:91]
v_mfma_f32_16x16x32_bf16 v[92:95], a[28:31], a[176:179], v[92:95]
v_rcp_f32 v195, v195
v_mfma_f32_16x16x32_bf16 v[96:99], a[28:31], a[180:183], v[96:99]
v_mfma_f32_16x16x32_bf16 v[100:103], a[32:35], a[176:179], v[100:103]
v_mfma_f32_16x16x32_bf16 v[104:107], a[32:35], a[180:183], v[104:107]
s_waitcnt vmcnt(23) lgkmcnt(0)
s_barrier
v_mfma_f32_16x16x32_bf16 v[36:39], a[36:39], a[184:187], v[36:39]
ds_read_b128 a[0:3], v202 offset:0
buffer_load_dwordx4 a[104:107], v1, s[4:7], s52 offen offset:3072 sc1
v_mfma_f32_16x16x32_bf16 v[40:43], a[36:39], a[188:191], v[40:43]
ds_read_b128 a[4:7], v202 offset:1024
buffer_load_dwordx4 a[108:111], v9, s[4:7], s52 offen offset:3072 sc1
v_mfma_f32_16x16x32_bf16 v[44:47], a[40:43], a[184:187], v[44:47]
ds_read_b128 a[8:11], v202 offset:2048
v_mul_f32 v148, v148, v192
v_mfma_f32_16x16x32_bf16 v[48:51], a[40:43], a[188:191], v[48:51]
ds_read_b128 a[12:15], v202 offset:3072
v_mul_f32 v149, v149, v193
v_mfma_f32_16x16x32_bf16 v[52:55], a[44:47], a[184:187], v[52:55]
ds_read_b128 a[16:19], v202 offset:4096
v_mfma_f32_16x16x32_bf16 v[56:59], a[44:47], a[188:191], v[56:59]
ds_read_b128 a[20:23], v202 offset:5120
v_mul_f32 v150, v150, v194
v_mfma_f32_16x16x32_bf16 v[60:63], a[48:51], a[184:187], v[60:63]
ds_read_b128 a[24:27], v202 offset:6144
v_mfma_f32_16x16x32_bf16 v[64:67], a[48:51], a[188:191], v[64:67]
ds_read_b128 a[28:31], v202 offset:7168
v_mul_f32 v151, v151, v195
v_mfma_f32_16x16x32_bf16 v[68:71], a[52:55], a[184:187], v[68:71]
ds_read_b128 a[32:35], v202 offset:8192
v_mfma_f32_16x16x32_bf16 v[72:75], a[52:55], a[188:191], v[72:75]
s_cmp_eq_u32 s25, 7
s_cselect_b32 s99, 36864, 0
s_add_u32 s60, s60, s99
v_mfma_f32_16x16x32_bf16 v[76:79], a[56:59], a[184:187], v[76:79]
s_add_u32 s61, s61, s99
s_add_u32 m0, s62, 90112
v_mul_f32 v196, v152, v152
v_mfma_f32_16x16x32_bf16 v[80:83], a[56:59], a[188:191], v[80:83]
s_add_u32 s60, s60, 16384
v_mfma_f32_16x16x32_bf16 v[84:87], a[60:63], a[184:187], v[84:87]
v_mul_f32 v197, v153, v153
v_mfma_f32_16x16x32_bf16 v[88:91], a[60:63], a[188:191], v[88:91]
buffer_load_dwordx4 v1, s[8:11], s60 offen offset:0 sc1 lds
v_mfma_f32_16x16x32_bf16 v[92:95], a[64:67], a[184:187], v[92:95]
v_mul_f32 v198, v154, v154
v_mfma_f32_16x16x32_bf16 v[96:99], a[64:67], a[188:191], v[96:99]
buffer_load_dwordx4 v1, s[8:11], s60 offen offset:1024 sc1 lds
v_mfma_f32_16x16x32_bf16 v[100:103], a[68:71], a[184:187], v[100:103]
v_mfma_f32_16x16x32_bf16 v[104:107], a[68:71], a[188:191], v[104:107]
v_mul_f32 v199, v155, v155
s_waitcnt lgkmcnt(0)
v_mfma_f32_16x16x32_bf16 v[36:39], a[0:3], a[192:195], v[36:39]
ds_read_b128 a[36:39], v202 offset:9216
buffer_load_dwordx4 v1, s[8:11], s60 offen offset:2048 sc1 lds
v_mfma_f32_16x16x32_bf16 v[40:43], a[0:3], a[196:199], v[40:43]
ds_read_b128 a[40:43], v202 offset:10240
v_fma_f32 v196, v196, v253, v251
v_mfma_f32_16x16x32_bf16 v[44:47], a[4:7], a[192:195], v[44:47]
ds_read_b128 a[44:47], v202 offset:11264
buffer_load_dwordx4 v1, s[8:11], s60 offen offset:3072 sc1 lds
v_mfma_f32_16x16x32_bf16 v[48:51], a[4:7], a[196:199], v[48:51]
ds_read_b128 a[48:51], v202 offset:12288
v_mfma_f32_16x16x32_bf16 v[52:55], a[8:11], a[192:195], v[52:55]
ds_read_b128 a[52:55], v202 offset:13312
s_add_u32 m0, s63, 106496
v_mfma_f32_16x16x32_bf16 v[56:59], a[8:11], a[196:199], v[56:59]
ds_read_b128 a[56:59], v202 offset:14336
v_fma_f32 v197, v197, v253, v251
v_mfma_f32_16x16x32_bf16 v[60:63], a[12:15], a[192:195], v[60:63]
ds_read_b128 a[60:63], v202 offset:15360
s_add_u32 s61, s61, 36864
v_mfma_f32_16x16x32_bf16 v[64:67], a[12:15], a[196:199], v[64:67]
ds_read_b128 a[64:67], v202 offset:16384
v_fma_f32 v198, v198, v253, v251
v_mfma_f32_16x16x32_bf16 v[68:71], a[16:19], a[192:195], v[68:71]
ds_read_b128 a[68:71], v202 offset:17408
buffer_load_dwordx4 v1, s[8:11], s61 offen offset:0 sc1 lds
v_mfma_f32_16x16x32_bf16 v[72:75], a[16:19], a[196:199], v[72:75]
s_add_u32 m0, s62, 110592
v_fma_f32 v199, v199, v253, v251
v_mfma_f32_16x16x32_bf16 v[76:79], a[20:23], a[192:195], v[76:79]
s_add_u32 s60, s60, 20480
v_mfma_f32_16x16x32_bf16 v[80:83], a[20:23], a[196:199], v[80:83]
v_mul_f32 v196, v196, v152
v_mfma_f32_16x16x32_bf16 v[84:87], a[24:27], a[192:195], v[84:87]
v_mfma_f32_16x16x32_bf16 v[88:91], a[24:27], a[196:199], v[88:91]
v_mul_f32 v197, v197, v153
v_mfma_f32_16x16x32_bf16 v[92:95], a[28:31], a[192:195], v[92:95]
buffer_load_dwordx4 v1, s[8:11], s60 offen offset:0 sc1 lds
v_mfma_f32_16x16x32_bf16 v[96:99], a[28:31], a[196:199], v[96:99]
v_mul_f32 v198, v198, v154
v_mfma_f32_16x16x32_bf16 v[100:103], a[32:35], a[192:195], v[100:103]
v_mfma_f32_16x16x32_bf16 v[104:107], a[32:35], a[196:199], v[104:107]
s_waitcnt lgkmcnt(0)
v_mfma_f32_16x16x32_bf16 v[36:39], a[36:39], a[200:203], v[36:39]
ds_read_b128 a[0:3], v202 offset:18432
buffer_load_dwordx4 v1, s[8:11], s60 offen offset:1024 sc1 lds
v_mfma_f32_16x16x32_bf16 v[40:43], a[36:39], a[204:207], v[40:43]
ds_read_b128 a[4:7], v202 offset:19456
v_mul_f32 v199, v199, v155
v_mfma_f32_16x16x32_bf16 v[44:47], a[40:43], a[200:203], v[44:47]
ds_read_b128 a[8:11], v202 offset:20480
buffer_load_dwordx4 v1, s[8:11], s60 offen offset:2048 sc1 lds
v_mfma_f32_16x16x32_bf16 v[48:51], a[40:43], a[204:207], v[48:51]
ds_read_b128 a[12:15], v202 offset:21504
v_mfma_f32_16x16x32_bf16 v[52:55], a[44:47], a[200:203], v[52:55]
ds_read_b128 a[16:19], v202 offset:22528
buffer_load_dwordx4 v1, s[8:11], s60 offen offset:3072 sc1 lds
v_mfma_f32_16x16x32_bf16 v[56:59], a[44:47], a[204:207], v[56:59]
ds_read_b128 a[20:23], v202 offset:23552
v_mfma_f32_16x16x32_bf16 v[60:63], a[48:51], a[200:203], v[60:63]
ds_read_b128 a[24:27], v202 offset:24576
v_mfma_f32_16x16x32_bf16 v[64:67], a[48:51], a[204:207], v[64:67]
ds_read_b128 a[28:31], v202 offset:25600
v_mfma_f32_16x16x32_bf16 v[68:71], a[52:55], a[200:203], v[68:71]
ds_read_b128 a[32:35], v202 offset:26624
v_mfma_f32_16x16x32_bf16 v[72:75], a[52:55], a[204:207], v[72:75]
s_cmp_eq_u32 s25, 8
s_cselect_b32 s98, 4096, 0
v_mfma_f32_16x16x32_bf16 v[76:79], a[56:59], a[200:203], v[76:79]
s_add_u32 s52, s52, s98
v_exp_f32 v196, v196
v_mfma_f32_16x16x32_bf16 v[80:83], a[56:59], a[204:207], v[80:83]
s_add_u32 s52, s52, 4096
v_exp_f32 v197, v197
v_mfma_f32_16x16x32_bf16 v[84:87], a[60:63], a[200:203], v[84:87]
v_exp_f32 v198, v198
v_mfma_f32_16x16x32_bf16 v[88:91], a[60:63], a[204:207], v[88:91]
v_mfma_f32_16x16x32_bf16 v[92:95], a[64:67], a[200:203], v[92:95]
buffer_load_dwordx4 a[112:115], v1, s[4:7], s52 offen offset:0 sc1
v_mfma_f32_16x16x32_bf16 v[96:99], a[64:67], a[204:207], v[96:99]
v_mfma_f32_16x16x32_bf16 v[100:103], a[68:71], a[200:203], v[100:103]
v_exp_f32 v199, v199
v_mfma_f32_16x16x32_bf16 v[104:107], a[68:71], a[204:207], v[104:107]
s_waitcnt lgkmcnt(0)
v_mfma_f32_16x16x32_bf16 v[36:39], a[0:3], a[208:211], v[36:39]
ds_read_b128 a[36:39], v202 offset:27648
buffer_load_dwordx4 a[116:119], v9, s[4:7], s52 offen offset:0 sc1
v_mfma_f32_16x16x32_bf16 v[40:43], a[0:3], a[212:215], v[40:43]
ds_read_b128 a[40:43], v202 offset:28672
v_mfma_f32_16x16x32_bf16 v[44:47], a[4:7], a[208:211], v[44:47]
ds_read_b128 a[44:47], v202 offset:29696
v_mfma_f32_16x16x32_bf16 v[48:51], a[4:7], a[212:215], v[48:51]
ds_read_b128 a[48:51], v202 offset:30720
v_fma_f32 v196, v196, v255, v255
v_mfma_f32_16x16x32_bf16 v[52:55], a[8:11], a[208:211], v[52:55]
ds_read_b128 a[52:55], v202 offset:31744
buffer_load_dwordx4 a[120:123], v1, s[4:7], s52 offen offset:1024 sc1
v_mfma_f32_16x16x32_bf16 v[56:59], a[8:11], a[212:215], v[56:59]
ds_read_b128 a[56:59], v202 offset:32768
v_fma_f32 v197, v197, v255, v255
v_mfma_f32_16x16x32_bf16 v[60:63], a[12:15], a[208:211], v[60:63]
ds_read_b128 a[60:63], v202 offset:33792
v_mfma_f32_16x16x32_bf16 v[64:67], a[12:15], a[212:215], v[64:67]
ds_read_b128 a[64:67], v202 offset:34816
v_mfma_f32_16x16x32_bf16 v[68:71], a[16:19], a[208:211], v[68:71]
ds_read_b128 a[68:71], v202 offset:35840
buffer_load_dwordx4 a[124:127], v9, s[4:7], s52 offen offset:1024 sc1
v_mfma_f32_16x16x32_bf16 v[72:75], a[16:19], a[212:215], v[72:75]
v_fma_f32 v198, v198, v255, v255
v_mfma_f32_16x16x32_bf16 v[76:79], a[20:23], a[208:211], v[76:79]
v_fma_f32 v199, v199, v255, v255
v_mfma_f32_16x16x32_bf16 v[80:83], a[20:23], a[212:215], v[80:83]
v_mfma_f32_16x16x32_bf16 v[84:87], a[24:27], a[208:211], v[84:87]
buffer_load_dwordx4 a[128:131], v1, s[4:7], s52 offen offset:2048 sc1
v_mfma_f32_16x16x32_bf16 v[88:91], a[24:27], a[212:215], v[88:91]
v_rcp_f32 v196, v196
v_mfma_f32_16x16x32_bf16 v[92:95], a[28:31], a[208:211], v[92:95]
v_mfma_f32_16x16x32_bf16 v[96:99], a[28:31], a[212:215], v[96:99]
v_mfma_f32_16x16x32_bf16 v[100:103], a[32:35], a[208:211], v[100:103]
v_mfma_f32_16x16x32_bf16 v[104:107], a[32:35], a[212:215], v[104:107]
s_waitcnt vmcnt(22) lgkmcnt(0)
s_barrier
v_mfma_f32_16x16x32_bf16 v[36:39], a[36:39], a[216:219], v[36:39]
ds_read_b128 a[0:3], v200 offset:0
buffer_load_dwordx4 a[132:135], v9, s[4:7], s52 offen offset:2048 sc1
v_mfma_f32_16x16x32_bf16 v[40:43], a[36:39], a[220:223], v[40:43]
ds_read_b128 a[4:7], v200 offset:1024
buffer_load_dwordx4 a[136:139], v1, s[4:7], s52 offen offset:3072 sc1
v_mfma_f32_16x16x32_bf16 v[44:47], a[40:43], a[216:219], v[44:47]
ds_read_b128 a[8:11], v200 offset:2048
v_mfma_f32_16x16x32_bf16 v[48:51], a[40:43], a[220:223], v[48:51]
ds_read_b128 a[12:15], v200 offset:3072
buffer_load_dwordx4 a[140:143], v9, s[4:7], s52 offen offset:3072 sc1
v_mfma_f32_16x16x32_bf16 v[52:55], a[44:47], a[216:219], v[52:55]
ds_read_b128 a[16:19], v200 offset:4096
v_mfma_f32_16x16x32_bf16 v[56:59], a[44:47], a[220:223], v[56:59]
ds_read_b128 a[20:23], v200 offset:5120
v_mfma_f32_16x16x32_bf16 v[60:63], a[48:51], a[216:219], v[60:63]
ds_read_b128 a[24:27], v200 offset:6144
v_mfma_f32_16x16x32_bf16 v[64:67], a[48:51], a[220:223], v[64:67]
ds_read_b128 a[28:31], v200 offset:7168
v_mfma_f32_16x16x32_bf16 v[68:71], a[52:55], a[216:219], v[68:71]
ds_read_b128 a[32:35], v200 offset:8192
v_mfma_f32_16x16x32_bf16 v[72:75], a[52:55], a[220:223], v[72:75]
s_cmp_eq_u32 s25, 8
s_cselect_b32 s99, 36864, 0
s_add_u32 s60, s60, s99
v_mfma_f32_16x16x32_bf16 v[76:79], a[56:59], a[216:219], v[76:79]
s_add_u32 s61, s61, s99
v_rcp_f32 v197, v197
v_mfma_f32_16x16x32_bf16 v[80:83], a[56:59], a[220:223], v[80:83]
s_add_u32 m0, s62, 126976
v_rcp_f32 v198, v198
v_mfma_f32_16x16x32_bf16 v[84:87], a[60:63], a[216:219], v[84:87]
s_add_u32 s60, s60, 16384
v_rcp_f32 v199, v199
v_mfma_f32_16x16x32_bf16 v[88:91], a[60:63], a[220:223], v[88:91]
v_mul_f32 v152, v152, v196
v_mfma_f32_16x16x32_bf16 v[92:95], a[64:67], a[216:219], v[92:95]
v_mfma_f32_16x16x32_bf16 v[96:99], a[64:67], a[220:223], v[96:99]
buffer_load_dwordx4 v1, s[8:11], s60 offen offset:0 sc1 lds
v_mfma_f32_16x16x32_bf16 v[100:103], a[68:71], a[216:219], v[100:103]
v_mul_f32 v153, v153, v197
v_mfma_f32_16x16x32_bf16 v[104:107], a[68:71], a[220:223], v[104:107]
s_waitcnt lgkmcnt(0)
v_mfma_f32_16x16x32_bf16 v[36:39], a[0:3], a[224:227], v[36:39]
ds_read_b128 a[36:39], v200 offset:9216
buffer_load_dwordx4 v1, s[8:11], s60 offen offset:1024 sc1 lds
v_mfma_f32_16x16x32_bf16 v[40:43], a[0:3], a[228:231], v[40:43]
ds_read_b128 a[40:43], v200 offset:10240
v_mul_f32 v154, v154, v198
v_mfma_f32_16x16x32_bf16 v[44:47], a[4:7], a[224:227], v[44:47]
ds_read_b128 a[44:47], v200 offset:11264
buffer_load_dwordx4 v1, s[8:11], s60 offen offset:2048 sc1 lds
v_mfma_f32_16x16x32_bf16 v[48:51], a[4:7], a[228:231], v[48:51]
ds_read_b128 a[48:51], v200 offset:12288
v_mul_f32 v155, v155, v199
v_mfma_f32_16x16x32_bf16 v[52:55], a[8:11], a[224:227], v[52:55]
ds_read_b128 a[52:55], v200 offset:13312
v_mfma_f32_16x16x32_bf16 v[56:59], a[8:11], a[228:231], v[56:59]
ds_read_b128 a[56:59], v200 offset:14336
buffer_load_dwordx4 v1, s[8:11], s60 offen offset:3072 sc1 lds
v_mfma_f32_16x16x32_bf16 v[60:63], a[12:15], a[224:227], v[60:63]
ds_read_b128 a[60:63], v200 offset:15360
v_mul_f32 v192, v156, v156
v_mfma_f32_16x16x32_bf16 v[64:67], a[12:15], a[228:231], v[64:67]
ds_read_b128 a[64:67], v200 offset:16384
v_mul_f32 v193, v157, v157
v_mfma_f32_16x16x32_bf16 v[68:71], a[16:19], a[224:227], v[68:71]
ds_read_b128 a[68:71], v200 offset:17408
s_add_u32 m0, s63, 143360
v_mfma_f32_16x16x32_bf16 v[72:75], a[16:19], a[228:231], v[72:75]
s_add_u32 s61, s61, 36864
v_mul_f32 v194, v158, v158
v_mfma_f32_16x16x32_bf16 v[76:79], a[20:23], a[224:227], v[76:79]
v_mfma_f32_16x16x32_bf16 v[80:83], a[20:23], a[228:231], v[80:83]
v_mfma_f32_16x16x32_bf16 v[84:87], a[24:27], a[224:227], v[84:87]
v_mul_f32 v195, v159, v159
v_mfma_f32_16x16x32_bf16 v[88:91], a[24:27], a[228:231], v[88:91]
v_mfma_f32_16x16x32_bf16 v[92:95], a[28:31], a[224:227], v[92:95]
buffer_load_dwordx4 v1, s[8:11], s61 offen offset:0 sc1 lds
v_fma_f32 v192, v192, v252, v250
v_mfma_f32_16x16x32_bf16 v[96:99], a[28:31], a[228:231], v[96:99]
v_mfma_f32_16x16x32_bf16 v[100:103], a[32:35], a[224:227], v[100:103]
v_fma_f32 v193, v193, v252, v250
v_mfma_f32_16x16x32_bf16 v[104:107], a[32:35], a[228:231], v[104:107]
s_waitcnt lgkmcnt(0)
v_mfma_f32_16x16x32_bf16 v[36:39], a[36:39], a[232:235], v[36:39]
ds_read_b128 a[0:3], v200 offset:18432
s_add_u32 m0, s62, 147456
v_mfma_f32_16x16x32_bf16 v[40:43], a[36:39], a[236:239], v[40:43]
ds_read_b128 a[4:7], v200 offset:19456
v_fma_f32 v194, v194, v252, v250
v_mfma_f32_16x16x32_bf16 v[44:47], a[40:43], a[232:235], v[44:47]
ds_read_b128 a[8:11], v200 offset:20480
s_add_u32 s60, s60, 20480
v_mfma_f32_16x16x32_bf16 v[48:51], a[40:43], a[236:239], v[48:51]
ds_read_b128 a[12:15], v200 offset:21504
v_fma_f32 v195, v195, v252, v250
v_mfma_f32_16x16x32_bf16 v[52:55], a[44:47], a[232:235], v[52:55]
ds_read_b128 a[16:19], v200 offset:22528
v_mfma_f32_16x16x32_bf16 v[56:59], a[44:47], a[236:239], v[56:59]
ds_read_b128 a[20:23], v200 offset:23552
buffer_load_dwordx4 v1, s[8:11], s60 offen offset:0 sc1 lds
v_mfma_f32_16x16x32_bf16 v[60:63], a[48:51], a[232:235], v[60:63]
ds_read_b128 a[24:27], v200 offset:24576
v_mul_f32 v192, v192, v156
v_mfma_f32_16x16x32_bf16 v[64:67], a[48:51], a[236:239], v[64:67]
ds_read_b128 a[28:31], v200 offset:25600
v_mfma_f32_16x16x32_bf16 v[68:71], a[52:55], a[232:235], v[68:71]
ds_read_b128 a[32:35], v200 offset:26624
buffer_load_dwordx4 v1, s[8:11], s60 offen offset:1024 sc1 lds
v_mfma_f32_16x16x32_bf16 v[72:75], a[52:55], a[236:239], v[72:75]
v_mul_f32 v193, v193, v157
v_mfma_f32_16x16x32_bf16 v[76:79], a[56:59], a[232:235], v[76:79]
v_mul_f32 v194, v194, v158
v_mfma_f32_16x16x32_bf16 v[80:83], a[56:59], a[236:239], v[80:83]
buffer_load_dwordx4 v1, s[8:11], s60 offen offset:2048 sc1 lds
v_mfma_f32_16x16x32_bf16 v[84:87], a[60:63], a[232:235], v[84:87]
v_mfma_f32_16x16x32_bf16 v[88:91], a[60:63], a[236:239], v[88:91]
v_mul_f32 v195, v195, v159
v_mfma_f32_16x16x32_bf16 v[92:95], a[64:67], a[232:235], v[92:95]
buffer_load_dwordx4 v1, s[8:11], s60 offen offset:3072 sc1 lds
v_mfma_f32_16x16x32_bf16 v[96:99], a[64:67], a[236:239], v[96:99]
v_exp_f32 v192, v192
v_mfma_f32_16x16x32_bf16 v[100:103], a[68:71], a[232:235], v[100:103]
v_mfma_f32_16x16x32_bf16 v[104:107], a[68:71], a[236:239], v[104:107]
s_waitcnt lgkmcnt(0)
v_mfma_f32_16x16x32_bf16 v[36:39], a[0:3], a[240:243], v[36:39]
ds_read_b128 a[36:39], v200 offset:27648
v_mfma_f32_16x16x32_bf16 v[40:43], a[0:3], a[244:247], v[40:43]
ds_read_b128 a[40:43], v200 offset:28672
v_mfma_f32_16x16x32_bf16 v[44:47], a[4:7], a[240:243], v[44:47]
ds_read_b128 a[44:47], v200 offset:29696
v_mfma_f32_16x16x32_bf16 v[48:51], a[4:7], a[244:247], v[48:51]
ds_read_b128 a[48:51], v200 offset:30720
v_mfma_f32_16x16x32_bf16 v[52:55], a[8:11], a[240:243], v[52:55]
ds_read_b128 a[52:55], v200 offset:31744
v_mfma_f32_16x16x32_bf16 v[56:59], a[8:11], a[244:247], v[56:59]
ds_read_b128 a[56:59], v200 offset:32768
v_mfma_f32_16x16x32_bf16 v[60:63], a[12:15], a[240:243], v[60:63]
ds_read_b128 a[60:63], v200 offset:33792
v_mfma_f32_16x16x32_bf16 v[64:67], a[12:15], a[244:247], v[64:67]
ds_read_b128 a[64:67], v200 offset:34816
v_mfma_f32_16x16x32_bf16 v[68:71], a[16:19], a[240:243], v[68:71]
ds_read_b128 a[68:71], v200 offset:35840
v_mfma_f32_16x16x32_bf16 v[72:75], a[16:19], a[244:247], v[72:75]
s_cmp_eq_u32 s25, 9
s_cselect_b32 s98, 4096, 0
s_add_u32 s52, s52, s98
v_mfma_f32_16x16x32_bf16 v[76:79], a[20:23], a[240:243], v[76:79]
s_add_u32 s52, s52, 4096
v_exp_f32 v193, v193
v_mfma_f32_16x16x32_bf16 v[80:83], a[20:23], a[244:247], v[80:83]
buffer_load_dwordx4 a[144:147], v1, s[4:7], s52 offen offset:0 sc1
v_mfma_f32_16x16x32_bf16 v[84:87], a[24:27], a[240:243], v[84:87]
buffer_load_dwordx4 a[148:151], v9, s[4:7], s52 offen offset:0 sc1
v_mfma_f32_16x16x32_bf16 v[88:91], a[24:27], a[244:247], v[88:91]
buffer_load_dwordx4 a[152:155], v1, s[4:7], s52 offen offset:1024 sc1
v_mfma_f32_16x16x32_bf16 v[92:95], a[28:31], a[240:243], v[92:95]
buffer_load_dwordx4 a[156:159], v9, s[4:7], s52 offen offset:1024 sc1
v_mfma_f32_16x16x32_bf16 v[96:99], a[28:31], a[244:247], v[96:99]
v_exp_f32 v194, v194
v_mfma_f32_16x16x32_bf16 v[100:103], a[32:35], a[240:243], v[100:103]
v_exp_f32 v195, v195
v_mfma_f32_16x16x32_bf16 v[104:107], a[32:35], a[244:247], v[104:107]
s_waitcnt vmcnt(21) lgkmcnt(0)
s_barrier
v_mfma_f32_16x16x32_bf16 v[36:39], a[36:39], a[248:251], v[36:39]
ds_read_b128 a[0:3], v201 offset:0
v_fma_f32 v192, v192, v254, v254
v_mfma_f32_16x16x32_bf16 v[40:43], a[36:39], a[252:255], v[40:43]
ds_read_b128 a[4:7], v201 offset:1024
v_fma_f32 v193, v193, v254, v254
v_mfma_f32_16x16x32_bf16 v[44:47], a[40:43], a[248:251], v[44:47]
ds_read_b128 a[8:11], v201 offset:2048
v_fma_f32 v194, v194, v254, v254
v_mfma_f32_16x16x32_bf16 v[48:51], a[40:43], a[252:255], v[48:51]
ds_read_b128 a[12:15], v201 offset:3072
v_mfma_f32_16x16x32_bf16 v[52:55], a[44:47], a[248:251], v[52:55]
ds_read_b128 a[16:19], v201 offset:4096
v_mfma_f32_16x16x32_bf16 v[56:59], a[44:47], a[252:255], v[56:59]
ds_read_b128 a[20:23], v201 offset:5120
v_fma_f32 v195, v195, v254, v254
v_mfma_f32_16x16x32_bf16 v[60:63], a[48:51], a[248:251], v[60:63]
ds_read_b128 a[24:27], v201 offset:6144
v_mfma_f32_16x16x32_bf16 v[64:67], a[48:51], a[252:255], v[64:67]
ds_read_b128 a[28:31], v201 offset:7168
v_mfma_f32_16x16x32_bf16 v[68:71], a[52:55], a[248:251], v[68:71]
ds_read_b128 a[32:35], v201 offset:8192
v_mfma_f32_16x16x32_bf16 v[72:75], a[52:55], a[252:255], v[72:75]
s_cmp_eq_u32 s25, 9
s_cselect_b32 s99, 36864, 0
s_add_u32 s60, s60, s99
v_mfma_f32_16x16x32_bf16 v[76:79], a[56:59], a[248:251], v[76:79]
s_add_u32 s61, s61, s99
s_add_u32 m0, s62, 53248
s_add_u32 s60, s60, 16384
v_mfma_f32_16x16x32_bf16 v[80:83], a[56:59], a[252:255], v[80:83]
buffer_load_dwordx4 v1, s[8:11], s60 offen offset:0 sc1 lds
v_mfma_f32_16x16x32_bf16 v[84:87], a[60:63], a[248:251], v[84:87]
buffer_load_dwordx4 v1, s[8:11], s60 offen offset:1024 sc1 lds
v_mfma_f32_16x16x32_bf16 v[88:91], a[60:63], a[252:255], v[88:91]
buffer_load_dwordx4 v1, s[8:11], s60 offen offset:2048 sc1 lds
v_mfma_f32_16x16x32_bf16 v[92:95], a[64:67], a[248:251], v[92:95]
v_rcp_f32 v192, v192
v_mfma_f32_16x16x32_bf16 v[96:99], a[64:67], a[252:255], v[96:99]
buffer_load_dwordx4 v1, s[8:11], s60 offen offset:3072 sc1 lds
v_mfma_f32_16x16x32_bf16 v[100:103], a[68:71], a[248:251], v[100:103]
v_rcp_f32 v193, v193
v_mfma_f32_16x16x32_bf16 v[104:107], a[68:71], a[252:255], v[104:107]
s_waitcnt lgkmcnt(0)
v_mfma_f32_16x16x32_bf16 v[36:39], a[0:3], a[80:83], v[36:39]
ds_read_b128 a[36:39], v201 offset:9216
s_add_u32 m0, s63, 69632
v_mfma_f32_16x16x32_bf16 v[40:43], a[0:3], a[84:87], v[40:43]
ds_read_b128 a[40:43], v201 offset:10240
v_mfma_f32_16x16x32_bf16 v[44:47], a[4:7], a[80:83], v[44:47]
ds_read_b128 a[44:47], v201 offset:11264
s_add_u32 s61, s61, 36864
v_mfma_f32_16x16x32_bf16 v[48:51], a[4:7], a[84:87], v[48:51]
ds_read_b128 a[48:51], v201 offset:12288
v_mfma_f32_16x16x32_bf16 v[52:55], a[8:11], a[80:83], v[52:55]
ds_read_b128 a[52:55], v201 offset:13312
buffer_load_dwordx4 v1, s[8:11], s61 offen offset:0 sc1 lds
v_mfma_f32_16x16x32_bf16 v[56:59], a[8:11], a[84:87], v[56:59]
ds_read_b128 a[56:59], v201 offset:14336
v_mfma_f32_16x16x32_bf16 v[60:63], a[12:15], a[80:83], v[60:63]
ds_read_b128 a[60:63], v201 offset:15360
s_add_u32 m0, s62, 73728
v_mfma_f32_16x16x32_bf16 v[64:67], a[12:15], a[84:87], v[64:67]
ds_read_b128 a[64:67], v201 offset:16384
v_mfma_f32_16x16x32_bf16 v[68:71], a[16:19], a[80:83], v[68:71]
ds_read_b128 a[68:71], v201 offset:17408
s_add_u32 s60, s60, 20480
v_mfma_f32_16x16x32_bf16 v[72:75], a[16:19], a[84:87], v[72:75]
v_rcp_f32 v194, v194
v_mfma_f32_16x16x32_bf16 v[76:79], a[20:23], a[80:83], v[76:79]
buffer_load_dwordx4 v1, s[8:11], s60 offen offset:0 sc1 lds
v_mfma_f32_16x16x32_bf16 v[80:83], a[20:23], a[84:87], v[80:83]
v_rcp_f32 v195, v195
v_mfma_f32_16x16x32_bf16 v[84:87], a[24:27], a[80:83], v[84:87]
buffer_load_dwordx4 v1, s[8:11], s60 offen offset:1024 sc1 lds
v_mul_f32 v156, v156, v192
v_mfma_f32_16x16x32_bf16 v[88:91], a[24:27], a[84:87], v[88:91]
v_mul_f32 v157, v157, v193
v_mul_f32 v158, v158, v194
v_mfma_f32_16x16x32_bf16 v[92:95], a[28:31], a[80:83], v[92:95]
buffer_load_dwordx4 v1, s[8:11], s60 offen offset:2048 sc1 lds
v_mfma_f32_16x16x32_bf16 v[96:99], a[28:31], a[84:87], v[96:99]
v_mul_f32 v159, v159, v195
v_mfma_f32_16x16x32_bf16 v[100:103], a[32:35], a[80:83], v[100:103]
v_mfma_f32_16x16x32_bf16 v[104:107], a[32:35], a[84:87], v[104:107]
v_mul_f32 v196, v160, v160
s_waitcnt lgkmcnt(0)
v_mfma_f32_16x16x32_bf16 v[36:39], a[36:39], a[88:91], v[36:39]
ds_read_b128 a[0:3], v201 offset:18432
buffer_load_dwordx4 v1, s[8:11], s60 offen offset:3072 sc1 lds
v_mfma_f32_16x16x32_bf16 v[40:43], a[36:39], a[92:95], v[40:43]
ds_read_b128 a[4:7], v201 offset:19456
v_mfma_f32_16x16x32_bf16 v[44:47], a[40:43], a[88:91], v[44:47]
ds_read_b128 a[8:11], v201 offset:20480
v_mul_f32 v197, v161, v161
v_mfma_f32_16x16x32_bf16 v[48:51], a[40:43], a[92:95], v[48:51]
ds_read_b128 a[12:15], v201 offset:21504
v_mfma_f32_16x16x32_bf16 v[52:55], a[44:47], a[88:91], v[52:55]
ds_read_b128 a[16:19], v201 offset:22528
buffer_load_dwordx4 a[160:163], v1, s[4:7], s52 offen offset:2048 sc1
v_mfma_f32_16x16x32_bf16 v[56:59], a[44:47], a[92:95], v[56:59]
ds_read_b128 a[20:23], v201 offset:23552
v_mul_f32 v198, v162, v162
v_mfma_f32_16x16x32_bf16 v[60:63], a[48:51], a[88:91], v[60:63]
ds_read_b128 a[24:27], v201 offset:24576
v_mfma_f32_16x16x32_bf16 v[64:67], a[48:51], a[92:95], v[64:67]
ds_read_b128 a[28:31], v201 offset:25600
v_mul_f32 v199, v163, v163
v_mfma_f32_16x16x32_bf16 v[68:71], a[52:55], a[88:91], v[68:71]
ds_read_b128 a[32:35], v201 offset:26624
buffer_load_dwordx4 a[164:167], v9, s[4:7], s52 offen offset:2048 sc1
v_mfma_f32_16x16x32_bf16 v[72:75], a[52:55], a[92:95], v[72:75]
v_fma_f32 v196, v196, v253, v251
v_mfma_f32_16x16x32_bf16 v[76:79], a[56:59], a[88:91], v[76:79]
v_mfma_f32_16x16x32_bf16 v[80:83], a[56:59], a[92:95], v[80:83]
v_fma_f32 v197, v197, v253, v251
v_mfma_f32_16x16x32_bf16 v[84:87], a[60:63], a[88:91], v[84:87]
buffer_load_dwordx4 a[168:171], v1, s[4:7], s52 offen offset:3072 sc1
v_mfma_f32_16x16x32_bf16 v[88:91], a[60:63], a[92:95], v[88:91]
v_mfma_f32_16x16x32_bf16 v[92:95], a[64:67], a[88:91], v[92:95]
v_fma_f32 v198, v198, v253, v251
v_mfma_f32_16x16x32_bf16 v[96:99], a[64:67], a[92:95], v[96:99]
v_mfma_f32_16x16x32_bf16 v[100:103], a[68:71], a[88:91], v[100:103]
v_fma_f32 v199, v199, v253, v251
v_mfma_f32_16x16x32_bf16 v[104:107], a[68:71], a[92:95], v[104:107]
s_waitcnt lgkmcnt(0)
v_mfma_f32_16x16x32_bf16 v[36:39], a[0:3], a[96:99], v[36:39]
ds_read_b128 a[36:39], v201 offset:27648
buffer_load_dwordx4 a[172:175], v9, s[4:7], s52 offen offset:3072 sc1
v_mfma_f32_16x16x32_bf16 v[40:43], a[0:3], a[100:103], v[40:43]
ds_read_b128 a[40:43], v201 offset:28672
v_mul_f32 v196, v196, v160
v_mfma_f32_16x16x32_bf16 v[44:47], a[4:7], a[96:99], v[44:47]
ds_read_b128 a[44:47], v201 offset:29696
v_mfma_f32_16x16x32_bf16 v[48:51], a[4:7], a[100:103], v[48:51]
ds_read_b128 a[48:51], v201 offset:30720
v_mul_f32 v197, v197, v161
v_mfma_f32_16x16x32_bf16 v[52:55], a[8:11], a[96:99], v[52:55]
ds_read_b128 a[52:55], v201 offset:31744
v_mfma_f32_16x16x32_bf16 v[56:59], a[8:11], a[100:103], v[56:59]
ds_read_b128 a[56:59], v201 offset:32768
v_mul_f32 v198, v198, v162
v_mfma_f32_16x16x32_bf16 v[60:63], a[12:15], a[96:99], v[60:63]
ds_read_b128 a[60:63], v201 offset:33792
v_mfma_f32_16x16x32_bf16 v[64:67], a[12:15], a[100:103], v[64:67]
ds_read_b128 a[64:67], v201 offset:34816
v_mul_f32 v199, v199, v163
v_mfma_f32_16x16x32_bf16 v[68:71], a[16:19], a[96:99], v[68:71]
ds_read_b128 a[68:71], v201 offset:35840
v_mfma_f32_16x16x32_bf16 v[72:75], a[16:19], a[100:103], v[72:75]
s_cmp_eq_u32 s25, 10
s_cselect_b32 s98, 4096, 0
s_add_u32 s52, s52, s98
v_mfma_f32_16x16x32_bf16 v[76:79], a[20:23], a[96:99], v[76:79]
s_add_u32 s52, s52, 4096
v_exp_f32 v196, v196
v_mfma_f32_16x16x32_bf16 v[80:83], a[20:23], a[100:103], v[80:83]
buffer_load_dwordx4 a[176:179], v1, s[4:7], s52 offen offset:0 sc1
v_mfma_f32_16x16x32_bf16 v[84:87], a[24:27], a[96:99], v[84:87]
buffer_load_dwordx4 a[180:183], v9, s[4:7], s52 offen offset:0 sc1
v_mfma_f32_16x16x32_bf16 v[88:91], a[24:27], a[100:103], v[88:91]
v_mfma_f32_16x16x32_bf16 v[92:95], a[28:31], a[96:99], v[92:95]
buffer_load_dwordx4 a[184:187], v1, s[4:7], s52 offen offset:1024 sc1
v_mfma_f32_16x16x32_bf16 v[96:99], a[28:31], a[100:103], v[96:99]
v_exp_f32 v197, v197
v_mfma_f32_16x16x32_bf16 v[100:103], a[32:35], a[96:99], v[100:103]
v_mfma_f32_16x16x32_bf16 v[104:107], a[32:35], a[100:103], v[104:107]
s_waitcnt vmcnt(20) lgkmcnt(0)
s_barrier
v_mfma_f32_16x16x32_bf16 v[36:39], a[36:39], a[104:107], v[36:39]
ds_read_b128 a[0:3], v202 offset:0
buffer_load_dwordx4 a[188:191], v9, s[4:7], s52 offen offset:1024 sc1
v_mfma_f32_16x16x32_bf16 v[40:43], a[36:39], a[108:111], v[40:43]
ds_read_b128 a[4:7], v202 offset:1024
s_bfe_u32 s97, s27, 0x20001
v_mfma_f32_16x16x32_bf16 v[44:47], a[40:43], a[104:107], v[44:47]
ds_read_b128 a[8:11], v202 offset:2048
s_lshl_b32 s97, s97, 2
v_mfma_f32_16x16x32_bf16 v[48:51], a[40:43], a[108:111], v[48:51]
ds_read_b128 a[12:15], v202 offset:3072
v_mfma_f32_16x16x32_bf16 v[52:55], a[44:47], a[104:107], v[52:55]
ds_read_b128 a[16:19], v202 offset:4096
s_add_u32 s97, s97, s24
v_mfma_f32_16x16x32_bf16 v[56:59], a[44:47], a[108:111], v[56:59]
ds_read_b128 a[20:23], v202 offset:5120
s_mul_i32 s97, s97, 6144
v_mfma_f32_16x16x32_bf16 v[60:63], a[48:51], a[104:107], v[60:63]
ds_read_b128 a[24:27], v202 offset:6144
v_mfma_f32_16x16x32_bf16 v[64:67], a[48:51], a[108:111], v[64:67]
ds_read_b128 a[28:31], v202 offset:7168
s_add_u32 s97, s97, s83
v_mfma_f32_16x16x32_bf16 v[68:71], a[52:55], a[104:107], v[68:71]
ds_read_b128 a[32:35], v202 offset:8192
s_add_u32 s97, s97, 67584
v_mfma_f32_16x16x32_bf16 v[72:75], a[52:55], a[108:111], v[72:75]
s_cmp_eq_u32 s25, 10
s_cselect_b32 s99, 36864, 0
s_add_u32 s60, s60, s99
v_mfma_f32_16x16x32_bf16 v[76:79], a[56:59], a[104:107], v[76:79]
s_add_u32 s61, s61, s99
s_add_u32 m0, s62, 90112
s_add_u32 s60, s60, 16384
v_mfma_f32_16x16x32_bf16 v[80:83], a[56:59], a[108:111], v[80:83]
buffer_load_dwordx4 v1, s[8:11], s60 offen offset:0 sc1 lds
v_lshlrev_b32 v8, 3, v1
v_mfma_f32_16x16x32_bf16 v[84:87], a[60:63], a[104:107], v[84:87]
v_cmp_gt_u32 vcc, 1024, v8
v_mfma_f32_16x16x32_bf16 v[88:91], a[60:63], a[108:111], v[88:91]
buffer_load_dwordx4 v1, s[8:11], s60 offen offset:1024 sc1 lds
v_mov_b32 v6, 1073741824
v_mfma_f32_16x16x32_bf16 v[92:95], a[64:67], a[104:107], v[92:95]
s_nop 0
v_exp_f32 v198, v198
v_mfma_f32_16x16x32_bf16 v[96:99], a[64:67], a[108:111], v[96:99]
buffer_load_dwordx4 v1, s[8:11], s60 offen offset:2048 sc1 lds
v_mfma_f32_16x16x32_bf16 v[100:103], a[68:71], a[104:107], v[100:103]
v_cndmask_b32 v8, v6, v8, vcc
v_mfma_f32_16x16x32_bf16 v[104:107], a[68:71], a[108:111], v[104:107]
s_waitcnt lgkmcnt(0)
v_mfma_f32_16x16x32_bf16 v[36:39], a[0:3], a[112:115], v[36:39]
ds_read_b128 a[36:39], v202 offset:9216
buffer_load_dwordx4 v1, s[8:11], s60 offen offset:3072 sc1 lds
v_mfma_f32_16x16x32_bf16 v[40:43], a[0:3], a[116:119], v[40:43]
ds_read_b128 a[40:43], v202 offset:10240
buffer_load_dwordx4 a[72:75], v1, s[4:7], s97 offen offset:0 sc1
v_mfma_f32_16x16x32_bf16 v[44:47], a[4:7], a[112:115], v[44:47]
ds_read_b128 a[44:47], v202 offset:11264
s_add_u32 m0, s63, 106496
v_mfma_f32_16x16x32_bf16 v[48:51], a[4:7], a[116:119], v[48:51]
ds_read_b128 a[48:51], v202 offset:12288
s_mov_b32 s37, L_c5-L_pc
v_mfma_f32_16x16x32_bf16 v[52:55], a[8:11], a[112:115], v[52:55]
ds_read_b128 a[52:55], v202 offset:13312
buffer_load_dword v15, v14, s[88:91], s37 offen
v_mfma_f32_16x16x32_bf16 v[56:59], a[8:11], a[116:119], v[56:59]
ds_read_b128 a[56:59], v202 offset:14336
s_add_u32 s61, s61, 36864
v_mfma_f32_16x16x32_bf16 v[60:63], a[12:15], a[112:115], v[60:63]
ds_read_b128 a[60:63], v202 offset:15360
buffer_load_dwordx4 v1, s[8:11], s61 offen offset:0 sc1 lds
v_mfma_f32_16x16x32_bf16 v[64:67], a[12:15], a[116:119], v[64:67]
ds_read_b128 a[64:67], v202 offset:16384
v_mfma_f32_16x16x32_bf16 v[68:71], a[16:19], a[112:115], v[68:71]
ds_read_b128 a[68:71], v202 offset:17408
s_add_u32 m0, s62, 110592
v_mfma_f32_16x16x32_bf16 v[72:75], a[16:19], a[116:119], v[72:75]
s_add_u32 s60, s60, 20480
v_exp_f32 v199, v199
v_mfma_f32_16x16x32_bf16 v[76:79], a[20:23], a[112:115], v[76:79]
v_fma_f32 v196, v196, v255, v255
v_fma_f32 v197, v197, v255, v255
v_mfma_f32_16x16x32_bf16 v[80:83], a[20:23], a[116:119], v[80:83]
v_fma_f32 v198, v198, v255, v255
v_fma_f32 v199, v199, v255, v255
v_mfma_f32_16x16x32_bf16 v[84:87], a[24:27], a[112:115], v[84:87]
buffer_load_dwordx4 v1, s[8:11], s60 offen offset:0 sc1 lds
v_mfma_f32_16x16x32_bf16 v[88:91], a[24:27], a[116:119], v[88:91]
v_rcp_f32 v196, v196
v_mfma_f32_16x16x32_bf16 v[92:95], a[28:31], a[112:115], v[92:95]
buffer_load_dwordx4 v1, s[8:11], s60 offen offset:1024 sc1 lds
v_mfma_f32_16x16x32_bf16 v[96:99], a[28:31], a[116:119], v[96:99]
v_rcp_f32 v197, v197
v_mfma_f32_16x16x32_bf16 v[100:103], a[32:35], a[112:115], v[100:103]
v_rcp_f32 v198, v198
v_mfma_f32_16x16x32_bf16 v[104:107], a[32:35], a[116:119], v[104:107]
s_waitcnt lgkmcnt(0)
v_mfma_f32_16x16x32_bf16 v[36:39], a[36:39], a[120:123], v[36:39]
ds_read_b128 a[0:3], v202 offset:18432
buffer_load_dwordx4 v1, s[8:11], s60 offen offset:2048 sc1 lds
v_mfma_f32_16x16x32_bf16 v[40:43], a[36:39], a[124:127], v[40:43]
ds_read_b128 a[4:7], v202 offset:19456
v_mfma_f32_16x16x32_bf16 v[44:47], a[40:43], a[120:123], v[44:47]
ds_read_b128 a[8:11], v202 offset:20480
v_mfma_f32_16x16x32_bf16 v[48:51], a[40:43], a[124:127], v[48:51]
ds_read_b128 a[12:15], v202 offset:21504
v_mfma_f32_16x16x32_bf16 v[52:55], a[44:47], a[120:123], v[52:55]
ds_read_b128 a[16:19], v202 offset:22528
buffer_load_dwordx4 v1, s[8:11], s60 offen offset:3072 sc1 lds
v_mfma_f32_16x16x32_bf16 v[56:59], a[44:47], a[124:127], v[56:59]
ds_read_b128 a[20:23], v202 offset:23552
v_mfma_f32_16x16x32_bf16 v[60:63], a[48:51], a[120:123], v[60:63]
ds_read_b128 a[24:27], v202 offset:24576
v_mfma_f32_16x16x32_bf16 v[64:67], a[48:51], a[124:127], v[64:67]
ds_read_b128 a[28:31], v202 offset:25600
v_mfma_f32_16x16x32_bf16 v[68:71], a[52:55], a[120:123], v[68:71]
ds_read_b128 a[32:35], v202 offset:26624
buffer_load_dwordx4 a[192:195], v1, s[4:7], s52 offen offset:2048 sc1
v_mfma_f32_16x16x32_bf16 v[72:75], a[52:55], a[124:127], v[72:75]
v_rcp_f32 v199, v199
v_mfma_f32_16x16x32_bf16 v[76:79], a[56:59], a[120:123], v[76:79]
v_mul_f32 v160, v160, v196
v_mul_f32 v161, v161, v197
v_mfma_f32_16x16x32_bf16 v[80:83], a[56:59], a[124:127], v[80:83]
v_mul_f32 v162, v162, v198
v_mul_f32 v163, v163, v199
v_mfma_f32_16x16x32_bf16 v[84:87], a[60:63], a[120:123], v[84:87]
buffer_load_dwordx4 a[196:199], v9, s[4:7], s52 offen offset:2048 sc1
v_mul_f32 v192, v164, v164
v_mfma_f32_16x16x32_bf16 v[88:91], a[60:63], a[124:127], v[88:91]
v_mfma_f32_16x16x32_bf16 v[92:95], a[64:67], a[120:123], v[92:95]
v_mfma_f32_16x16x32_bf16 v[96:99], a[64:67], a[124:127], v[96:99]
v_mul_f32 v193, v165, v165
v_mfma_f32_16x16x32_bf16 v[100:103], a[68:71], a[120:123], v[100:103]
v_mfma_f32_16x16x32_bf16 v[104:107], a[68:71], a[124:127], v[104:107]
v_mul_f32 v194, v166, v166
s_waitcnt lgkmcnt(0)
v_mfma_f32_16x16x32_bf16 v[36:39], a[0:3], a[128:131], v[36:39]
ds_read_b128 a[36:39], v202 offset:27648
buffer_load_dwordx4 a[200:203], v1, s[4:7], s52 offen offset:3072 sc1
v_mfma_f32_16x16x32_bf16 v[40:43], a[0:3], a[132:135], v[40:43]
ds_read_b128 a[40:43], v202 offset:28672
v_mul_f32 v195, v167, v167
v_mfma_f32_16x16x32_bf16 v[44:47], a[4:7], a[128:131], v[44:47]
ds_read_b128 a[44:47], v202 offset:29696
buffer_load_dwordx4 a[204:207], v9, s[4:7], s52 offen offset:3072 sc1
v_mfma_f32_16x16x32_bf16 v[48:51], a[4:7], a[132:135], v[48:51]
ds_read_b128 a[48:51], v202 offset:30720
v_mfma_f32_16x16x32_bf16 v[52:55], a[8:11], a[128:131], v[52:55]
ds_read_b128 a[52:55], v202 offset:31744
v_fma_f32 v192, v192, v252, v250
v_mfma_f32_16x16x32_bf16 v[56:59], a[8:11], a[132:135], v[56:59]
ds_read_b128 a[56:59], v202 offset:32768
v_mfma_f32_16x16x32_bf16 v[60:63], a[12:15], a[128:131], v[60:63]
ds_read_b128 a[60:63], v202 offset:33792
v_fma_f32 v193, v193, v252, v250
v_mfma_f32_16x16x32_bf16 v[64:67], a[12:15], a[132:135], v[64:67]
ds_read_b128 a[64:67], v202 offset:34816
v_mfma_f32_16x16x32_bf16 v[68:71], a[16:19], a[128:131], v[68:71]
ds_read_b128 a[68:71], v202 offset:35840
v_fma_f32 v194, v194, v252, v250
v_mfma_f32_16x16x32_bf16 v[72:75], a[16:19], a[132:135], v[72:75]
s_cmp_eq_u32 s25, 11
s_cselect_b32 s98, 4096, 0
s_add_u32 s52, s52, s98
v_mfma_f32_16x16x32_bf16 v[76:79], a[20:23], a[128:131], v[76:79]
buffer_load_dwordx4 a[72:75], v1, s[4:7], s97 offen offset:1024 sc1
s_add_u32 s52, s52, 4096
v_mfma_f32_16x16x32_bf16 v[80:83], a[20:23], a[132:135], v[80:83]
v_fma_f32 v195, v195, v252, v250
v_mfma_f32_16x16x32_bf16 v[84:87], a[24:27], a[128:131], v[84:87]
buffer_load_dwordx4 a[208:211], v1, s[4:7], s52 offen offset:0 sc1
v_mfma_f32_16x16x32_bf16 v[88:91], a[24:27], a[132:135], v[88:91]
v_mul_f32 v192, v192, v164
v_mfma_f32_16x16x32_bf16 v[92:95], a[28:31], a[128:131], v[92:95]
buffer_load_dwordx4 a[212:215], v9, s[4:7], s52 offen offset:0 sc1
v_mfma_f32_16x16x32_bf16 v[96:99], a[28:31], a[132:135], v[96:99]
v_mfma_f32_16x16x32_bf16 v[100:103], a[32:35], a[128:131], v[100:103]
v_mul_f32 v193, v193, v165
v_mfma_f32_16x16x32_bf16 v[104:107], a[32:35], a[132:135], v[104:107]
s_waitcnt vmcnt(26) lgkmcnt(0)
s_barrier
v_mfma_f32_16x16x32_bf16 v[36:39], a[36:39], a[136:139], v[36:39]
ds_read_b128 a[0:3], v200 offset:0
buffer_load_dwordx4 a[216:219], v1, s[4:7], s52 offen offset:1024 sc1
v_mfma_f32_16x16x32_bf16 v[40:43], a[36:39], a[140:143], v[40:43]
ds_read_b128 a[4:7], v200 offset:1024
buffer_load_dwordx4 a[220:223], v9, s[4:7], s52 offen offset:1024 sc1
v_mfma_f32_16x16x32_bf16 v[44:47], a[40:43], a[136:139], v[44:47]
ds_read_b128 a[8:11], v200 offset:2048
v_mul_f32 v194, v194, v166
v_mfma_f32_16x16x32_bf16 v[48:51], a[40:43], a[140:143], v[48:51]
ds_read_b128 a[12:15], v200 offset:3072
v_mul_f32 v195, v195, v167
v_mfma_f32_16x16x32_bf16 v[52:55], a[44:47], a[136:139], v[52:55]
ds_read_b128 a[16:19], v200 offset:4096
v_mfma_f32_16x16x32_bf16 v[56:59], a[44:47], a[140:143], v[56:59]
ds_read_b128 a[20:23], v200 offset:5120
v_mfma_f32_16x16x32_bf16 v[60:63], a[48:51], a[136:139], v[60:63]
ds_read_b128 a[24:27], v200 offset:6144
v_mfma_f32_16x16x32_bf16 v[64:67], a[48:51], a[140:143], v[64:67]
ds_read_b128 a[28:31], v200 offset:7168
v_mfma_f32_16x16x32_bf16 v[68:71], a[52:55], a[136:139], v[68:71]
ds_read_b128 a[32:35], v200 offset:8192
v_mfma_f32_16x16x32_bf16 v[72:75], a[52:55], a[140:143], v[72:75]
s_cmp_eq_u32 s25, 11
s_cselect_b32 s99, 36864, 0
s_add_u32 s60, s60, s99
v_mfma_f32_16x16x32_bf16 v[76:79], a[56:59], a[136:139], v[76:79]
s_add_u32 s61, s61, s99
s_add_u32 m0, s62, 126976
v_mfma_f32_16x16x32_bf16 v[80:83], a[56:59], a[140:143], v[80:83]
s_add_u32 s60, s60, 16384
v_exp_f32 v192, v192
v_mfma_f32_16x16x32_bf16 v[84:87], a[60:63], a[136:139], v[84:87]
v_exp_f32 v193, v193
v_mfma_f32_16x16x32_bf16 v[88:91], a[60:63], a[140:143], v[88:91]
buffer_load_dwordx4 v1, s[8:11], s60 offen offset:0 sc1 lds
v_mfma_f32_16x16x32_bf16 v[92:95], a[64:67], a[136:139], v[92:95]
v_exp_f32 v194, v194
v_mfma_f32_16x16x32_bf16 v[96:99], a[64:67], a[140:143], v[96:99]
buffer_load_dwordx4 v1, s[8:11], s60 offen offset:1024 sc1 lds
v_mfma_f32_16x16x32_bf16 v[100:103], a[68:71], a[136:139], v[100:103]
v_mfma_f32_16x16x32_bf16 v[104:107], a[68:71], a[140:143], v[104:107]
s_waitcnt lgkmcnt(0)
v_mfma_f32_16x16x32_bf16 v[36:39], a[0:3], a[144:147], v[36:39]
ds_read_b128 a[36:39], v200 offset:9216
buffer_load_dwordx4 v1, s[8:11], s60 offen offset:2048 sc1 lds
v_mfma_f32_16x16x32_bf16 v[40:43], a[0:3], a[148:151], v[40:43]
ds_read_b128 a[40:43], v200 offset:10240
v_mfma_f32_16x16x32_bf16 v[44:47], a[4:7], a[144:147], v[44:47]
ds_read_b128 a[44:47], v200 offset:11264
buffer_load_dwordx4 v1, s[8:11], s60 offen offset:3072 sc1 lds
v_mfma_f32_16x16x32_bf16 v[48:51], a[4:7], a[148:151], v[48:51]
ds_read_b128 a[48:51], v200 offset:12288
v_mfma_f32_16x16x32_bf16 v[52:55], a[8:11], a[144:147], v[52:55]
ds_read_b128 a[52:55], v200 offset:13312
s_add_u32 m0, s63, 143360
v_mfma_f32_16x16x32_bf16 v[56:59], a[8:11], a[148:151], v[56:59]
ds_read_b128 a[56:59], v200 offset:14336
v_mfma_f32_16x16x32_bf16 v[60:63], a[12:15], a[144:147], v[60:63]
ds_read_b128 a[60:63], v200 offset:15360
s_add_u32 s61, s61, 36864
v_mfma_f32_16x16x32_bf16 v[64:67], a[12:15], a[148:151], v[64:67]
ds_read_b128 a[64:67], v200 offset:16384
v_mfma_f32_16x16x32_bf16 v[68:71], a[16:19], a[144:147], v[68:71]
ds_read_b128 a[68:71], v200 offset:17408
buffer_load_dwordx4 v1, s[8:11], s61 offen offset:0 sc1 lds
v_mfma_f32_16x16x32_bf16 v[72:75], a[16:19], a[148:151], v[72:75]
s_add_u32 m0, s62, 147456
v_exp_f32 v195, v195
v_mfma_f32_16x16x32_bf16 v[76:79], a[20:23], a[144:147], v[76:79]
s_add_u32 s60, s60, 20480
v_fma_f32 v192, v192, v254, v254
v_fma_f32 v193, v193, v254, v254
v_mfma_f32_16x16x32_bf16 v[80:83], a[20:23], a[148:151], v[80:83]
v_fma_f32 v194, v194, v254, v254
v_mfma_f32_16x16x32_bf16 v[84:87], a[24:27], a[144:147], v[84:87]
v_mfma_f32_16x16x32_bf16 v[88:91], a[24:27], a[148:151], v[88:91]
v_fma_f32 v195, v195, v254, v254
v_mfma_f32_16x16x32_bf16 v[92:95], a[28:31], a[144:147], v[92:95]
buffer_load_dwordx4 v1, s[8:11], s60 offen offset:0 sc1 lds
v_mfma_f32_16x16x32_bf16 v[96:99], a[28:31], a[148:151], v[96:99]
v_rcp_f32 v192, v192
v_mfma_f32_16x16x32_bf16 v[100:103], a[32:35], a[144:147], v[100:103]
v_mfma_f32_16x16x32_bf16 v[104:107], a[32:35], a[148:151], v[104:107]
s_waitcnt vmcnt(30) lgkmcnt(0)
v_mfma_f32_16x16x32_bf16 v[36:39], a[36:39], a[152:155], v[36:39]
ds_read_b128 a[0:3], v200 offset:18432
buffer_load_dwordx4 v1, s[8:11], s60 offen offset:1024 sc1 lds
v_mfma_f32_16x16x32_bf16 v[40:43], a[36:39], a[156:159], v[40:43]
ds_read_b128 a[4:7], v200 offset:19456
v_mfma_f32_16x16x32_bf16 v[44:47], a[40:43], a[152:155], v[44:47]
ds_read_b128 a[8:11], v200 offset:20480
buffer_load_dwordx4 a[72:75], v1, s[4:7], s97 offen offset:2048 sc1
v_mfma_f32_16x16x32_bf16 v[48:51], a[40:43], a[156:159], v[48:51]
ds_read_b128 a[12:15], v200 offset:21504
v_mfma_f32_16x16x32_bf16 v[52:55], a[44:47], a[152:155], v[52:55]
ds_read_b128 a[16:19], v200 offset:22528
buffer_load_dwordx4 v1, s[8:11], s60 offen offset:2048 sc1 lds
v_mfma_f32_16x16x32_bf16 v[56:59], a[44:47], a[156:159], v[56:59]
ds_read_b128 a[20:23], v200 offset:23552
v_mfma_f32_16x16x32_bf16 v[60:63], a[48:51], a[152:155], v[60:63]
ds_read_b128 a[24:27], v200 offset:24576
v_mfma_f32_16x16x32_bf16 v[64:67], a[48:51], a[156:159], v[64:67]
ds_read_b128 a[28:31], v200 offset:25600
v_mfma_f32_16x16x32_bf16 v[68:71], a[52:55], a[152:155], v[68:71]
ds_read_b128 a[32:35], v200 offset:26624
buffer_load_dwordx4 v1, s[8:11], s60 offen offset:3072 sc1 lds
v_mfma_f32_16x16x32_bf16 v[72:75], a[52:55], a[156:159], v[72:75]
v_rcp_f32 v193, v193
v_mfma_f32_16x16x32_bf16 v[76:79], a[56:59], a[152:155], v[76:79]
v_rcp_f32 v194, v194
v_mfma_f32_16x16x32_bf16 v[80:83], a[56:59], a[156:159], v[80:83]
v_rcp_f32 v195, v195
v_mfma_f32_16x16x32_bf16 v[84:87], a[60:63], a[152:155], v[84:87]
buffer_load_dwordx4 a[224:227], v1, s[4:7], s52 offen offset:2048 sc1
v_mfma_f32_16x16x32_bf16 v[88:91], a[60:63], a[156:159], v[88:91]
v_mfma_f32_16x16x32_bf16 v[92:95], a[64:67], a[152:155], v[92:95]
v_mfma_f32_16x16x32_bf16 v[96:99], a[64:67], a[156:159], v[96:99]
v_mfma_f32_16x16x32_bf16 v[100:103], a[68:71], a[152:155], v[100:103]
v_mul_f32 v164, v164, v192
v_mfma_f32_16x16x32_bf16 v[104:107], a[68:71], a[156:159], v[104:107]
s_waitcnt lgkmcnt(0)
v_mfma_f32_16x16x32_bf16 v[36:39], a[0:3], a[160:163], v[36:39]
ds_read_b128 a[36:39], v200 offset:27648
buffer_load_dwordx4 a[228:231], v9, s[4:7], s52 offen offset:2048 sc1
v_mfma_f32_16x16x32_bf16 v[40:43], a[0:3], a[164:167], v[40:43]
ds_read_b128 a[40:43], v200 offset:28672
v_mul_f32 v165, v165, v193
v_mfma_f32_16x16x32_bf16 v[44:47], a[4:7], a[160:163], v[44:47]
ds_read_b128 a[44:47], v200 offset:29696
buffer_load_dwordx4 a[232:235], v1, s[4:7], s52 offen offset:3072 sc1
v_mfma_f32_16x16x32_bf16 v[48:51], a[4:7], a[164:167], v[48:51]
ds_read_b128 a[48:51], v200 offset:30720
v_mul_f32 v166, v166, v194
v_mfma_f32_16x16x32_bf16 v[52:55], a[8:11], a[160:163], v[52:55]
ds_read_b128 a[52:55], v200 offset:31744
buffer_load_dwordx4 a[236:239], v9, s[4:7], s52 offen offset:3072 sc1
v_mfma_f32_16x16x32_bf16 v[56:59], a[8:11], a[164:167], v[56:59]
ds_read_b128 a[56:59], v200 offset:32768
v_mul_f32 v167, v167, v195
v_mfma_f32_16x16x32_bf16 v[60:63], a[12:15], a[160:163], v[60:63]
ds_read_b128 a[60:63], v200 offset:33792
v_mfma_f32_16x16x32_bf16 v[64:67], a[12:15], a[164:167], v[64:67]
ds_read_b128 a[64:67], v200 offset:34816
v_mul_f32 v196, v168, v168
v_mfma_f32_16x16x32_bf16 v[68:71], a[16:19], a[160:163], v[68:71]
ds_read_b128 a[68:71], v200 offset:35840
v_mfma_f32_16x16x32_bf16 v[72:75], a[16:19], a[164:167], v[72:75]
s_cmp_eq_u32 s25, 12
s_cselect_b32 s98, 4096, 0
v_mfma_f32_16x16x32_bf16 v[76:79], a[20:23], a[160:163], v[76:79]
s_add_u32 s52, s52, s98
v_mul_f32 v197, v169, v169
v_mfma_f32_16x16x32_bf16 v[80:83], a[20:23], a[164:167], v[80:83]
s_add_u32 s52, s52, 4096
v_mfma_f32_16x16x32_bf16 v[84:87], a[24:27], a[160:163], v[84:87]
v_mul_f32 v198, v170, v170
v_mfma_f32_16x16x32_bf16 v[88:91], a[24:27], a[164:167], v[88:91]
v_mfma_f32_16x16x32_bf16 v[92:95], a[28:31], a[160:163], v[92:95]
buffer_load_dwordx4 a[240:243], v1, s[4:7], s52 offen offset:0 sc1
v_mul_f32 v199, v171, v171
v_mfma_f32_16x16x32_bf16 v[96:99], a[28:31], a[164:167], v[96:99]
v_mfma_f32_16x16x32_bf16 v[100:103], a[32:35], a[160:163], v[100:103]
v_mfma_f32_16x16x32_bf16 v[104:107], a[32:35], a[164:167], v[104:107]
s_waitcnt vmcnt(24) lgkmcnt(0)
s_barrier
v_mfma_f32_16x16x32_bf16 v[36:39], a[36:39], a[168:171], v[36:39]
ds_read_b128 a[0:3], v201 offset:0
buffer_load_dwordx4 a[244:247], v9, s[4:7], s52 offen offset:0 sc1
v_mfma_f32_16x16x32_bf16 v[40:43], a[36:39], a[172:175], v[40:43]
ds_read_b128 a[4:7], v201 offset:1024
buffer_load_dwordx4 a[248:251], v1, s[4:7], s52 offen offset:1024 sc1
v_mfma_f32_16x16x32_bf16 v[44:47], a[40:43], a[168:171], v[44:47]
ds_read_b128 a[8:11], v201 offset:2048
v_fma_f32 v196, v196, v253, v251
v_mfma_f32_16x16x32_bf16 v[48:51], a[40:43], a[172:175], v[48:51]
ds_read_b128 a[12:15], v201 offset:3072
buffer_load_dwordx4 a[252:255], v9, s[4:7], s52 offen offset:1024 sc1
v_mfma_f32_16x16x32_bf16 v[52:55], a[44:47], a[168:171], v[52:55]
ds_read_b128 a[16:19], v201 offset:4096
v_fma_f32 v197, v197, v253, v251
v_mfma_f32_16x16x32_bf16 v[56:59], a[44:47], a[172:175], v[56:59]
ds_read_b128 a[20:23], v201 offset:5120
v_fma_f32 v198, v198, v253, v251
v_mfma_f32_16x16x32_bf16 v[60:63], a[48:51], a[168:171], v[60:63]
ds_read_b128 a[24:27], v201 offset:6144
v_fma_f32 v199, v199, v253, v251
v_mfma_f32_16x16x32_bf16 v[64:67], a[48:51], a[172:175], v[64:67]
ds_read_b128 a[28:31], v201 offset:7168
v_mfma_f32_16x16x32_bf16 v[68:71], a[52:55], a[168:171], v[68:71]
ds_read_b128 a[32:35], v201 offset:8192
v_mul_f32 v196, v196, v168
v_mfma_f32_16x16x32_bf16 v[72:75], a[52:55], a[172:175], v[72:75]
s_cmp_eq_u32 s25, 12
s_cselect_b32 s99, 36864, 0
s_add_u32 s60, s60, s99
v_mfma_f32_16x16x32_bf16 v[76:79], a[56:59], a[168:171], v[76:79]
s_add_u32 s61, s61, s99
v_mul_f32 v197, v197, v169
v_mfma_f32_16x16x32_bf16 v[80:83], a[56:59], a[172:175], v[80:83]
s_add_u32 m0, s62, 53248
v_mfma_f32_16x16x32_bf16 v[84:87], a[60:63], a[168:171], v[84:87]
s_add_u32 s60, s60, 16384
v_mfma_f32_16x16x32_bf16 v[88:91], a[60:63], a[172:175], v[88:91]
buffer_load_dwordx4 a[72:75], v1, s[4:7], s97 offen offset:3072 sc1
v_mul_f32 v198, v198, v170
v_mfma_f32_16x16x32_bf16 v[92:95], a[64:67], a[168:171], v[92:95]
s_add_u32 s97, s97, 4096
v_mfma_f32_16x16x32_bf16 v[96:99], a[64:67], a[172:175], v[96:99]
buffer_load_dwordx4 v1, s[8:11], s60 offen offset:0 sc1 lds
v_mul_f32 v199, v199, v171
v_mfma_f32_16x16x32_bf16 v[100:103], a[68:71], a[168:171], v[100:103]
v_mfma_f32_16x16x32_bf16 v[104:107], a[68:71], a[172:175], v[104:107]
s_waitcnt lgkmcnt(0)
v_mfma_f32_16x16x32_bf16 v[36:39], a[0:3], a[176:179], v[36:39]
ds_read_b128 a[36:39], v201 offset:9216
buffer_load_dwordx4 v1, s[8:11], s60 offen offset:1024 sc1 lds
v_mfma_f32_16x16x32_bf16 v[40:43], a[0:3], a[180:183], v[40:43]
ds_read_b128 a[40:43], v201 offset:10240
v_mfma_f32_16x16x32_bf16 v[44:47], a[4:7], a[176:179], v[44:47]
ds_read_b128 a[44:47], v201 offset:11264
buffer_load_dwordx4 v1, s[8:11], s60 offen offset:2048 sc1 lds
v_mfma_f32_16x16x32_bf16 v[48:51], a[4:7], a[180:183], v[48:51]
ds_read_b128 a[48:51], v201 offset:12288
v_mfma_f32_16x16x32_bf16 v[52:55], a[8:11], a[176:179], v[52:55]
ds_read_b128 a[52:55], v201 offset:13312
v_mfma_f32_16x16x32_bf16 v[56:59], a[8:11], a[180:183], v[56:59]
ds_read_b128 a[56:59], v201 offset:14336
buffer_load_dwordx4 v1, s[8:11], s60 offen offset:3072 sc1 lds
v_mfma_f32_16x16x32_bf16 v[60:63], a[12:15], a[176:179], v[60:63]
ds_read_b128 a[60:63], v201 offset:15360
v_mfma_f32_16x16x32_bf16 v[64:67], a[12:15], a[180:183], v[64:67]
ds_read_b128 a[64:67], v201 offset:16384
v_mfma_f32_16x16x32_bf16 v[68:71], a[16:19], a[176:179], v[68:71]
ds_read_b128 a[68:71], v201 offset:17408
s_add_u32 m0, s63, 69632
v_mfma_f32_16x16x32_bf16 v[72:75], a[16:19], a[180:183], v[72:75]
s_add_u32 s61, s61, 36864
v_exp_f32 v196, v196
v_mfma_f32_16x16x32_bf16 v[76:79], a[20:23], a[176:179], v[76:79]
v_exp_f32 v197, v197
v_mfma_f32_16x16x32_bf16 v[80:83], a[20:23], a[180:183], v[80:83]
v_exp_f32 v198, v198
v_mfma_f32_16x16x32_bf16 v[84:87], a[24:27], a[176:179], v[84:87]
v_mfma_f32_16x16x32_bf16 v[88:91], a[24:27], a[180:183], v[88:91]
v_mfma_f32_16x16x32_bf16 v[92:95], a[28:31], a[176:179], v[92:95]
buffer_load_dwordx4 v1, s[8:11], s61 offen offset:0 sc1 lds
v_mfma_f32_16x16x32_bf16 v[96:99], a[28:31], a[180:183], v[96:99]
v_exp_f32 v199, v199
v_mfma_f32_16x16x32_bf16 v[100:103], a[32:35], a[176:179], v[100:103]
v_mfma_f32_16x16x32_bf16 v[104:107], a[32:35], a[180:183], v[104:107]
s_waitcnt vmcnt(29) lgkmcnt(0)
v_mfma_f32_16x16x32_bf16 v[36:39], a[36:39], a[184:187], v[36:39]
ds_read_b128 a[0:3], v201 offset:18432
s_add_u32 m0, s62, 73728
v_mfma_f32_16x16x32_bf16 v[40:43], a[36:39], a[188:191], v[40:43]
ds_read_b128 a[4:7], v201 offset:19456
v_fma_f32 v196, v196, v255, v255
v_mfma_f32_16x16x32_bf16 v[44:47], a[40:43], a[184:187], v[44:47]
ds_read_b128 a[8:11], v201 offset:20480
s_add_u32 s60, s60, 20480
v_mfma_f32_16x16x32_bf16 v[48:51], a[40:43], a[188:191], v[48:51]
ds_read_b128 a[12:15], v201 offset:21504
v_fma_f32 v197, v197, v255, v255
v_mfma_f32_16x16x32_bf16 v[52:55], a[44:47], a[184:187], v[52:55]
ds_read_b128 a[16:19], v201 offset:22528
v_mfma_f32_16x16x32_bf16 v[56:59], a[44:47], a[188:191], v[56:59]
ds_read_b128 a[20:23], v201 offset:23552
buffer_load_dwordx4 v1, s[8:11], s60 offen offset:0 sc1 lds
v_mfma_f32_16x16x32_bf16 v[60:63], a[48:51], a[184:187], v[60:63]
ds_read_b128 a[24:27], v201 offset:24576
v_fma_f32 v198, v198, v255, v255
v_mfma_f32_16x16x32_bf16 v[64:67], a[48:51], a[188:191], v[64:67]
ds_read_b128 a[28:31], v201 offset:25600
v_fma_f32 v199, v199, v255, v255
v_mfma_f32_16x16x32_bf16 v[68:71], a[52:55], a[184:187], v[68:71]
ds_read_b128 a[32:35], v201 offset:26624
buffer_load_dwordx4 v1, s[8:11], s60 offen offset:1024 sc1 lds
v_mfma_f32_16x16x32_bf16 v[72:75], a[52:55], a[188:191], v[72:75]
v_mfma_f32_16x16x32_bf16 v[76:79], a[56:59], a[184:187], v[76:79]
v_rcp_f32 v196, v196
v_mfma_f32_16x16x32_bf16 v[80:83], a[56:59], a[188:191], v[80:83]
buffer_load_dwordx4 v1, s[8:11], s60 offen offset:2048 sc1 lds
v_mfma_f32_16x16x32_bf16 v[84:87], a[60:63], a[184:187], v[84:87]
v_mfma_f32_16x16x32_bf16 v[88:91], a[60:63], a[188:191], v[88:91]
v_mfma_f32_16x16x32_bf16 v[92:95], a[64:67], a[184:187], v[92:95]
buffer_load_dwordx4 v1, s[8:11], s60 offen offset:3072 sc1 lds
v_mfma_f32_16x16x32_bf16 v[96:99], a[64:67], a[188:191], v[96:99]
v_rcp_f32 v197, v197
v_mfma_f32_16x16x32_bf16 v[100:103], a[68:71], a[184:187], v[100:103]
v_mfma_f32_16x16x32_bf16 v[104:107], a[68:71], a[188:191], v[104:107]
s_waitcnt lgkmcnt(0)
v_mfma_f32_16x16x32_bf16 v[36:39], a[0:3], a[192:195], v[36:39]
ds_read_b128 a[36:39], v201 offset:27648
buffer_load_dwordx4 a[80:83], v1, s[4:7], s52 offen offset:2048 sc1
v_mfma_f32_16x16x32_bf16 v[40:43], a[0:3], a[196:199], v[40:43]
ds_read_b128 a[40:43], v201 offset:28672
v_mfma_f32_16x16x32_bf16 v[44:47], a[4:7], a[192:195], v[44:47]
ds_read_b128 a[44:47], v201 offset:29696
v_mfma_f32_16x16x32_bf16 v[48:51], a[4:7], a[196:199], v[48:51]
ds_read_b128 a[48:51], v201 offset:30720
v_mfma_f32_16x16x32_bf16 v[52:55], a[8:11], a[192:195], v[52:55]
ds_read_b128 a[52:55], v201 offset:31744
buffer_load_dwordx4 a[84:87], v9, s[4:7], s52 offen offset:2048 sc1
v_mfma_f32_16x16x32_bf16 v[56:59], a[8:11], a[196:199], v[56:59]
ds_read_b128 a[56:59], v201 offset:32768
v_mfma_f32_16x16x32_bf16 v[60:63], a[12:15], a[192:195], v[60:63]
ds_read_b128 a[60:63], v201 offset:33792
v_mfma_f32_16x16x32_bf16 v[64:67], a[12:15], a[196:199], v[64:67]
ds_read_b128 a[64:67], v201 offset:34816
v_mfma_f32_16x16x32_bf16 v[68:71], a[16:19], a[192:195], v[68:71]
ds_read_b128 a[68:71], v201 offset:35840
buffer_load_dwordx4 a[88:91], v1, s[4:7], s52 offen offset:3072 sc1
v_mfma_f32_16x16x32_bf16 v[72:75], a[16:19], a[196:199], v[72:75]
v_rcp_f32 v198, v198
v_mfma_f32_16x16x32_bf16 v[76:79], a[20:23], a[192:195], v[76:79]
v_rcp_f32 v199, v199
v_mfma_f32_16x16x32_bf16 v[80:83], a[20:23], a[196:199], v[80:83]
v_mul_f32 v168, v168, v196
v_mfma_f32_16x16x32_bf16 v[84:87], a[24:27], a[192:195], v[84:87]
buffer_load_dwordx4 a[92:95], v9, s[4:7], s52 offen offset:3072 sc1
v_mfma_f32_16x16x32_bf16 v[88:91], a[24:27], a[196:199], v[88:91]
v_mul_f32 v169, v169, v197
v_mfma_f32_16x16x32_bf16 v[92:95], a[28:31], a[192:195], v[92:95]
v_mfma_f32_16x16x32_bf16 v[96:99], a[28:31], a[196:199], v[96:99]
v_mul_f32 v170, v170, v198
v_mfma_f32_16x16x32_bf16 v[100:103], a[32:35], a[192:195], v[100:103]
v_mfma_f32_16x16x32_bf16 v[104:107], a[32:35], a[196:199], v[104:107]
s_waitcnt vmcnt(22) lgkmcnt(0)
s_barrier
v_mfma_f32_16x16x32_bf16 v[36:39], a[36:39], a[200:203], v[36:39]
ds_read_b128 a[0:3], v202 offset:0
v_mul_f32 v171, v171, v199
v_mfma_f32_16x16x32_bf16 v[40:43], a[36:39], a[204:207], v[40:43]
ds_read_b128 a[4:7], v202 offset:1024
v_mfma_f32_16x16x32_bf16 v[44:47], a[40:43], a[200:203], v[44:47]
ds_read_b128 a[8:11], v202 offset:2048
v_mul_f32 v192, v172, v172
v_mfma_f32_16x16x32_bf16 v[48:51], a[40:43], a[204:207], v[48:51]
ds_read_b128 a[12:15], v202 offset:3072
v_mfma_f32_16x16x32_bf16 v[52:55], a[44:47], a[200:203], v[52:55]
ds_read_b128 a[16:19], v202 offset:4096
v_mul_f32 v193, v173, v173
v_mfma_f32_16x16x32_bf16 v[56:59], a[44:47], a[204:207], v[56:59]
ds_read_b128 a[20:23], v202 offset:5120
v_mfma_f32_16x16x32_bf16 v[60:63], a[48:51], a[200:203], v[60:63]
ds_read_b128 a[24:27], v202 offset:6144
v_mfma_f32_16x16x32_bf16 v[64:67], a[48:51], a[204:207], v[64:67]
ds_read_b128 a[28:31], v202 offset:7168
v_mul_f32 v194, v174, v174
v_mfma_f32_16x16x32_bf16 v[68:71], a[52:55], a[200:203], v[68:71]
ds_read_b128 a[32:35], v202 offset:8192
v_mfma_f32_16x16x32_bf16 v[72:75], a[52:55], a[204:207], v[72:75]
s_cmp_eq_u32 s25, 13
s_cselect_b32 s99, 36864, 0
s_add_u32 s60, s60, s99
v_mfma_f32_16x16x32_bf16 v[76:79], a[56:59], a[200:203], v[76:79]
s_add_u32 s61, s61, s99
s_add_u32 m0, s62, 90112
s_add_u32 s60, s60, 16384
v_mfma_f32_16x16x32_bf16 v[80:83], a[56:59], a[204:207], v[80:83]
buffer_load_dwordx4 v1, s[8:11], s60 offen offset:0 sc1 lds
v_mul_f32 v195, v175, v175
v_mfma_f32_16x16x32_bf16 v[84:87], a[60:63], a[200:203], v[84:87]
buffer_load_dwordx4 v1, s[8:11], s60 offen offset:1024 sc1 lds
v_fma_f32 v192, v192, v252, v250
v_mfma_f32_16x16x32_bf16 v[88:91], a[60:63], a[204:207], v[88:91]
buffer_load_dwordx4 v1, s[8:11], s60 offen offset:2048 sc1 lds
v_mfma_f32_16x16x32_bf16 v[92:95], a[64:67], a[200:203], v[92:95]
v_fma_f32 v193, v193, v252, v250
v_mfma_f32_16x16x32_bf16 v[96:99], a[64:67], a[204:207], v[96:99]
buffer_load_dwordx4 v1, s[8:11], s60 offen offset:3072 sc1 lds
v_mfma_f32_16x16x32_bf16 v[100:103], a[68:71], a[200:203], v[100:103]
v_fma_f32 v194, v194, v252, v250
v_mfma_f32_16x16x32_bf16 v[104:107], a[68:71], a[204:207], v[104:107]
s_waitcnt lgkmcnt(0)
v_mfma_f32_16x16x32_bf16 v[36:39], a[0:3], a[208:211], v[36:39]
ds_read_b128 a[36:39], v202 offset:9216
s_add_u32 m0, s63, 106496
v_mfma_f32_16x16x32_bf16 v[40:43], a[0:3], a[212:215], v[40:43]
ds_read_b128 a[40:43], v202 offset:10240
v_fma_f32 v195, v195, v252, v250
v_mfma_f32_16x16x32_bf16 v[44:47], a[4:7], a[208:211], v[44:47]
ds_read_b128 a[44:47], v202 offset:11264
s_add_u32 s61, s61, 36864
v_mfma_f32_16x16x32_bf16 v[48:51], a[4:7], a[212:215], v[48:51]
ds_read_b128 a[48:51], v202 offset:12288
v_mul_f32 v192, v192, v172
v_mfma_f32_16x16x32_bf16 v[52:55], a[8:11], a[208:211], v[52:55]
ds_read_b128 a[52:55], v202 offset:13312
buffer_load_dwordx4 v1, s[8:11], s61 offen offset:0 sc1 lds
v_mfma_f32_16x16x32_bf16 v[56:59], a[8:11], a[212:215], v[56:59]
ds_read_b128 a[56:59], v202 offset:14336
v_mul_f32 v193, v193, v173
v_mfma_f32_16x16x32_bf16 v[60:63], a[12:15], a[208:211], v[60:63]
ds_read_b128 a[60:63], v202 offset:15360
s_add_u32 m0, s62, 110592
v_mfma_f32_16x16x32_bf16 v[64:67], a[12:15], a[212:215], v[64:67]
ds_read_b128 a[64:67], v202 offset:16384
v_mfma_f32_16x16x32_bf16 v[68:71], a[16:19], a[208:211], v[68:71]
ds_read_b128 a[68:71], v202 offset:17408
s_add_u32 s60, s60, 20480
v_mfma_f32_16x16x32_bf16 v[72:75], a[16:19], a[212:215], v[72:75]
v_mul_f32 v194, v194, v174
v_mfma_f32_16x16x32_bf16 v[76:79], a[20:23], a[208:211], v[76:79]
buffer_load_dwordx4 v1, s[8:11], s60 offen offset:0 sc1 lds
v_mul_f32 v195, v195, v175
v_mfma_f32_16x16x32_bf16 v[80:83], a[20:23], a[212:215], v[80:83]
v_mfma_f32_16x16x32_bf16 v[84:87], a[24:27], a[208:211], v[84:87]
buffer_load_dwordx4 v1, s[8:11], s60 offen offset:1024 sc1 lds
v_mfma_f32_16x16x32_bf16 v[88:91], a[24:27], a[212:215], v[88:91]
v_exp_f32 v192, v192
v_mfma_f32_16x16x32_bf16 v[92:95], a[28:31], a[208:211], v[92:95]
buffer_load_dwordx4 v1, s[8:11], s60 offen offset:2048 sc1 lds
v_mfma_f32_16x16x32_bf16 v[96:99], a[28:31], a[212:215], v[96:99]
v_mfma_f32_16x16x32_bf16 v[100:103], a[32:35], a[208:211], v[100:103]
buffer_load_dwordx4 a[72:75], v1, s[4:7], s97 offen offset:0 sc1
v_mfma_f32_16x16x32_bf16 v[104:107], a[32:35], a[212:215], v[104:107]
s_waitcnt vmcnt(27) lgkmcnt(0)
v_mfma_f32_16x16x32_bf16 v[36:39], a[36:39], a[216:219], v[36:39]
ds_read_b128 a[0:3], v202 offset:18432
buffer_load_dwordx4 v1, s[8:11], s60 offen offset:3072 sc1 lds
v_mfma_f32_16x16x32_bf16 v[40:43], a[36:39], a[220:223], v[40:43]
ds_read_b128 a[4:7], v202 offset:19456
v_mfma_f32_16x16x32_bf16 v[44:47], a[40:43], a[216:219], v[44:47]
ds_read_b128 a[8:11], v202 offset:20480
v_mfma_f32_16x16x32_bf16 v[48:51], a[40:43], a[220:223], v[48:51]
ds_read_b128 a[12:15], v202 offset:21504
v_mfma_f32_16x16x32_bf16 v[52:55], a[44:47], a[216:219], v[52:55]
ds_read_b128 a[16:19], v202 offset:22528
v_mfma_f32_16x16x32_bf16 v[56:59], a[44:47], a[220:223], v[56:59]
ds_read_b128 a[20:23], v202 offset:23552
v_mfma_f32_16x16x32_bf16 v[60:63], a[48:51], a[216:219], v[60:63]
ds_read_b128 a[24:27], v202 offset:24576
v_mfma_f32_16x16x32_bf16 v[64:67], a[48:51], a[220:223], v[64:67]
ds_read_b128 a[28:31], v202 offset:25600
v_mfma_f32_16x16x32_bf16 v[68:71], a[52:55], a[216:219], v[68:71]
ds_read_b128 a[32:35], v202 offset:26624
v_mfma_f32_16x16x32_bf16 v[72:75], a[52:55], a[220:223], v[72:75]
s_cmp_eq_u32 s25, 13
s_cselect_b32 s98, 4096, 0
s_add_u32 s52, s52, s98
v_mfma_f32_16x16x32_bf16 v[76:79], a[56:59], a[216:219], v[76:79]
s_add_u32 s52, s52, 4096
v_exp_f32 v193, v193
v_mfma_f32_16x16x32_bf16 v[80:83], a[56:59], a[220:223], v[80:83]
buffer_load_dwordx4 a[96:99], v1, s[4:7], s52 offen offset:0 sc1
v_mfma_f32_16x16x32_bf16 v[84:87], a[60:63], a[216:219], v[84:87]
buffer_load_dwordx4 a[100:103], v9, s[4:7], s52 offen offset:0 sc1
v_mfma_f32_16x16x32_bf16 v[88:91], a[60:63], a[220:223], v[88:91]
v_exp_f32 v194, v194
v_mfma_f32_16x16x32_bf16 v[92:95], a[64:67], a[216:219], v[92:95]
buffer_load_dwordx4 a[104:107], v1, s[4:7], s52 offen offset:1024 sc1
v_mfma_f32_16x16x32_bf16 v[96:99], a[64:67], a[220:223], v[96:99]
v_exp_f32 v195, v195
v_mfma_f32_16x16x32_bf16 v[100:103], a[68:71], a[216:219], v[100:103]
v_fma_f32 v192, v192, v254, v254
v_fma_f32 v193, v193, v254, v254
v_mfma_f32_16x16x32_bf16 v[104:107], a[68:71], a[220:223], v[104:107]
s_waitcnt lgkmcnt(0)
v_mfma_f32_16x16x32_bf16 v[36:39], a[0:3], a[224:227], v[36:39]
ds_read_b128 a[36:39], v202 offset:27648
buffer_load_dwordx4 a[108:111], v9, s[4:7], s52 offen offset:1024 sc1
v_mfma_f32_16x16x32_bf16 v[40:43], a[0:3], a[228:231], v[40:43]
ds_read_b128 a[40:43], v202 offset:28672
v_fma_f32 v194, v194, v254, v254
v_mfma_f32_16x16x32_bf16 v[44:47], a[4:7], a[224:227], v[44:47]
ds_read_b128 a[44:47], v202 offset:29696
v_fma_f32 v195, v195, v254, v254
v_mfma_f32_16x16x32_bf16 v[48:51], a[4:7], a[228:231], v[48:51]
ds_read_b128 a[48:51], v202 offset:30720
v_mfma_f32_16x16x32_bf16 v[52:55], a[8:11], a[224:227], v[52:55]
ds_read_b128 a[52:55], v202 offset:31744
buffer_load_dwordx4 a[112:115], v1, s[4:7], s52 offen offset:2048 sc1
v_mfma_f32_16x16x32_bf16 v[56:59], a[8:11], a[228:231], v[56:59]
ds_read_b128 a[56:59], v202 offset:32768
v_mfma_f32_16x16x32_bf16 v[60:63], a[12:15], a[224:227], v[60:63]
ds_read_b128 a[60:63], v202 offset:33792
v_mfma_f32_16x16x32_bf16 v[64:67], a[12:15], a[228:231], v[64:67]
ds_read_b128 a[64:67], v202 offset:34816
v_mfma_f32_16x16x32_bf16 v[68:71], a[16:19], a[224:227], v[68:71]
ds_read_b128 a[68:71], v202 offset:35840
buffer_load_dwordx4 a[116:119], v9, s[4:7], s52 offen offset:2048 sc1
v_mfma_f32_16x16x32_bf16 v[72:75], a[16:19], a[228:231], v[72:75]
v_rcp_f32 v192, v192
v_mfma_f32_16x16x32_bf16 v[76:79], a[20:23], a[224:227], v[76:79]
v_rcp_f32 v193, v193
v_mfma_f32_16x16x32_bf16 v[80:83], a[20:23], a[228:231], v[80:83]
v_mfma_f32_16x16x32_bf16 v[84:87], a[24:27], a[224:227], v[84:87]
buffer_load_dwordx4 a[120:123], v1, s[4:7], s52 offen offset:3072 sc1
v_mfma_f32_16x16x32_bf16 v[88:91], a[24:27], a[228:231], v[88:91]
v_mfma_f32_16x16x32_bf16 v[92:95], a[28:31], a[224:227], v[92:95]
v_rcp_f32 v194, v194
v_mfma_f32_16x16x32_bf16 v[96:99], a[28:31], a[228:231], v[96:99]
v_mfma_f32_16x16x32_bf16 v[100:103], a[32:35], a[224:227], v[100:103]
v_mfma_f32_16x16x32_bf16 v[104:107], a[32:35], a[228:231], v[104:107]
s_waitcnt vmcnt(21) lgkmcnt(0)
s_barrier
v_mfma_f32_16x16x32_bf16 v[36:39], a[36:39], a[232:235], v[36:39]
ds_read_b128 a[0:3], v200 offset:0
buffer_load_dwordx4 a[124:127], v9, s[4:7], s52 offen offset:3072 sc1
v_mfma_f32_16x16x32_bf16 v[40:43], a[36:39], a[236:239], v[40:43]
ds_read_b128 a[4:7], v200 offset:1024
v_mfma_f32_16x16x32_bf16 v[44:47], a[40:43], a[232:235], v[44:47]
ds_read_b128 a[8:11], v200 offset:2048
v_mfma_f32_16x16x32_bf16 v[48:51], a[40:43], a[236:239], v[48:51]
ds_read_b128 a[12:15], v200 offset:3072
v_mfma_f32_16x16x32_bf16 v[52:55], a[44:47], a[232:235], v[52:55]
ds_read_b128 a[16:19], v200 offset:4096
v_mfma_f32_16x16x32_bf16 v[56:59], a[44:47], a[236:239], v[56:59]
ds_read_b128 a[20:23], v200 offset:5120
v_mfma_f32_16x16x32_bf16 v[60:63], a[48:51], a[232:235], v[60:63]
ds_read_b128 a[24:27], v200 offset:6144
v_mfma_f32_16x16x32_bf16 v[64:67], a[48:51], a[236:239], v[64:67]
ds_read_b128 a[28:31], v200 offset:7168
v_mfma_f32_16x16x32_bf16 v[68:71], a[52:55], a[232:235], v[68:71]
ds_read_b128 a[32:35], v200 offset:8192
buffer_load_dwordx4 a[72:75], v1, s[4:7], s97 offen offset:1024 sc1
v_mfma_f32_16x16x32_bf16 v[72:75], a[52:55], a[236:239], v[72:75]
s_cmp_eq_u32 s25, 14
s_cselect_b32 s99, 36864, 0
s_add_u32 s60, s60, s99
v_mfma_f32_16x16x32_bf16 v[76:79], a[56:59], a[232:235], v[76:79]
s_add_u32 s61, s61, s99
s_add_u32 m0, s62, 126976
s_add_u32 s60, s60, 16384
v_mfma_f32_16x16x32_bf16 v[80:83], a[56:59], a[236:239], v[80:83]
buffer_load_dwordx4 v1, s[8:11], s60 offen offset:0 sc1 lds
v_mfma_f32_16x16x32_bf16 v[84:87], a[60:63], a[232:235], v[84:87]
v_rcp_f32 v195, v195
v_mfma_f32_16x16x32_bf16 v[88:91], a[60:63], a[236:239], v[88:91]
buffer_load_dwordx4 v1, s[8:11], s60 offen offset:1024 sc1 lds
v_mul_f32 v172, v172, v192
v_mfma_f32_16x16x32_bf16 v[92:95], a[64:67], a[232:235], v[92:95]
v_mul_f32 v173, v173, v193
v_mul_f32 v174, v174, v194
v_mfma_f32_16x16x32_bf16 v[96:99], a[64:67], a[236:239], v[96:99]
buffer_load_dwordx4 v1, s[8:11], s60 offen offset:2048 sc1 lds
v_mul_f32 v175, v175, v195
v_mfma_f32_16x16x32_bf16 v[100:103], a[68:71], a[232:235], v[100:103]
v_mul_f32 v196, v176, v176
v_mfma_f32_16x16x32_bf16 v[104:107], a[68:71], a[236:239], v[104:107]
v_mul_f32 v197, v177, v177
s_waitcnt lgkmcnt(0)
v_mfma_f32_16x16x32_bf16 v[36:39], a[0:3], a[240:243], v[36:39]
ds_read_b128 a[36:39], v200 offset:9216
buffer_load_dwordx4 v1, s[8:11], s60 offen offset:3072 sc1 lds
v_mfma_f32_16x16x32_bf16 v[40:43], a[0:3], a[244:247], v[40:43]
ds_read_b128 a[40:43], v200 offset:10240
v_mfma_f32_16x16x32_bf16 v[44:47], a[4:7], a[240:243], v[44:47]
ds_read_b128 a[44:47], v200 offset:11264
s_add_u32 m0, s63, 143360
v_mfma_f32_16x16x32_bf16 v[48:51], a[4:7], a[244:247], v[48:51]
ds_read_b128 a[48:51], v200 offset:12288
v_mul_f32 v198, v178, v178
v_mfma_f32_16x16x32_bf16 v[52:55], a[8:11], a[240:243], v[52:55]
ds_read_b128 a[52:55], v200 offset:13312
s_add_u32 s61, s61, 36864
v_mfma_f32_16x16x32_bf16 v[56:59], a[8:11], a[244:247], v[56:59]
ds_read_b128 a[56:59], v200 offset:14336
v_mul_f32 v199, v179, v179
v_mfma_f32_16x16x32_bf16 v[60:63], a[12:15], a[240:243], v[60:63]
ds_read_b128 a[60:63], v200 offset:15360
buffer_load_dwordx4 v1, s[8:11], s61 offen offset:0 sc1 lds
v_mfma_f32_16x16x32_bf16 v[64:67], a[12:15], a[244:247], v[64:67]
ds_read_b128 a[64:67], v200 offset:16384
v_fma_f32 v196, v196, v253, v251
v_mfma_f32_16x16x32_bf16 v[68:71], a[16:19], a[240:243], v[68:71]
ds_read_b128 a[68:71], v200 offset:17408
s_add_u32 m0, s62, 147456
v_mfma_f32_16x16x32_bf16 v[72:75], a[16:19], a[244:247], v[72:75]
s_add_u32 s60, s60, 20480
v_fma_f32 v197, v197, v253, v251
v_mfma_f32_16x16x32_bf16 v[76:79], a[20:23], a[240:243], v[76:79]
v_mfma_f32_16x16x32_bf16 v[80:83], a[20:23], a[244:247], v[80:83]
v_fma_f32 v198, v198, v253, v251
v_mfma_f32_16x16x32_bf16 v[84:87], a[24:27], a[240:243], v[84:87]
buffer_load_dwordx4 v1, s[8:11], s60 offen offset:0 sc1 lds
v_mfma_f32_16x16x32_bf16 v[88:91], a[24:27], a[244:247], v[88:91]
v_fma_f32 v199, v199, v253, v251
v_mfma_f32_16x16x32_bf16 v[92:95], a[28:31], a[240:243], v[92:95]
buffer_load_dwordx4 v1, s[8:11], s60 offen offset:1024 sc1 lds
v_mfma_f32_16x16x32_bf16 v[96:99], a[28:31], a[244:247], v[96:99]
v_mfma_f32_16x16x32_bf16 v[100:103], a[32:35], a[240:243], v[100:103]
v_mul_f32 v196, v196, v176
v_mfma_f32_16x16x32_bf16 v[104:107], a[32:35], a[244:247], v[104:107]
s_waitcnt vmcnt(26) lgkmcnt(0)
v_mfma_f32_16x16x32_bf16 v[36:39], a[36:39], a[248:251], v[36:39]
ds_read_b128 a[0:3], v200 offset:18432
buffer_load_dwordx4 v1, s[8:11], s60 offen offset:2048 sc1 lds
v_mfma_f32_16x16x32_bf16 v[40:43], a[36:39], a[252:255], v[40:43]
ds_read_b128 a[4:7], v200 offset:19456
v_mul_f32 v197, v197, v177
v_mfma_f32_16x16x32_bf16 v[44:47], a[40:43], a[248:251], v[44:47]
ds_read_b128 a[8:11], v200 offset:20480
buffer_load_dwordx4 v1, s[8:11], s60 offen offset:3072 sc1 lds
v_mfma_f32_16x16x32_bf16 v[48:51], a[40:43], a[252:255], v[48:51]
ds_read_b128 a[12:15], v200 offset:21504
v_mul_f32 v198, v198, v178
v_mfma_f32_16x16x32_bf16 v[52:55], a[44:47], a[248:251], v[52:55]
ds_read_b128 a[16:19], v200 offset:22528
v_mfma_f32_16x16x32_bf16 v[56:59], a[44:47], a[252:255], v[56:59]
ds_read_b128 a[20:23], v200 offset:23552
v_mul_f32 v199, v199, v179
v_mfma_f32_16x16x32_bf16 v[60:63], a[48:51], a[248:251], v[60:63]
ds_read_b128 a[24:27], v200 offset:24576
v_mfma_f32_16x16x32_bf16 v[64:67], a[48:51], a[252:255], v[64:67]
ds_read_b128 a[28:31], v200 offset:25600
v_mfma_f32_16x16x32_bf16 v[68:71], a[52:55], a[248:251], v[68:71]
ds_read_b128 a[32:35], v200 offset:26624
v_mfma_f32_16x16x32_bf16 v[72:75], a[52:55], a[252:255], v[72:75]
s_cmp_eq_u32 s25, 14
s_cselect_b32 s98, 4096, 0
s_add_u32 s52, s52, s98
v_mfma_f32_16x16x32_bf16 v[76:79], a[56:59], a[248:251], v[76:79]
s_add_u32 s52, s52, 4096
v_exp_f32 v196, v196
v_mfma_f32_16x16x32_bf16 v[80:83], a[56:59], a[252:255], v[80:83]
v_mfma_f32_16x16x32_bf16 v[84:87], a[60:63], a[248:251], v[84:87]
buffer_load_dwordx4 a[128:131], v1, s[4:7], s52 offen offset:0 sc1
v_mfma_f32_16x16x32_bf16 v[88:91], a[60:63], a[252:255], v[88:91]
v_exp_f32 v197, v197
v_mfma_f32_16x16x32_bf16 v[92:95], a[64:67], a[248:251], v[92:95]
buffer_load_dwordx4 a[132:135], v9, s[4:7], s52 offen offset:0 sc1
v_mfma_f32_16x16x32_bf16 v[96:99], a[64:67], a[252:255], v[96:99]
v_mfma_f32_16x16x32_bf16 v[100:103], a[68:71], a[248:251], v[100:103]
v_mfma_f32_16x16x32_bf16 v[104:107], a[68:71], a[252:255], v[104:107]
s_waitcnt lgkmcnt(0)
v_mfma_f32_16x16x32_bf16 v[36:39], a[0:3], a[80:83], v[36:39]
ds_read_b128 a[36:39], v200 offset:27648
buffer_load_dwordx4 a[136:139], v1, s[4:7], s52 offen offset:1024 sc1
v_mfma_f32_16x16x32_bf16 v[40:43], a[0:3], a[84:87], v[40:43]
ds_read_b128 a[40:43], v200 offset:28672
v_mfma_f32_16x16x32_bf16 v[44:47], a[4:7], a[80:83], v[44:47]
ds_read_b128 a[44:47], v200 offset:29696
v_mfma_f32_16x16x32_bf16 v[48:51], a[4:7], a[84:87], v[48:51]
ds_read_b128 a[48:51], v200 offset:30720
v_mfma_f32_16x16x32_bf16 v[52:55], a[8:11], a[80:83], v[52:55]
ds_read_b128 a[52:55], v200 offset:31744
buffer_load_dwordx4 a[140:143], v9, s[4:7], s52 offen offset:1024 sc1
v_mfma_f32_16x16x32_bf16 v[56:59], a[8:11], a[84:87], v[56:59]
ds_read_b128 a[56:59], v200 offset:32768
v_mfma_f32_16x16x32_bf16 v[60:63], a[12:15], a[80:83], v[60:63]
ds_read_b128 a[60:63], v200 offset:33792
v_mfma_f32_16x16x32_bf16 v[64:67], a[12:15], a[84:87], v[64:67]
ds_read_b128 a[64:67], v200 offset:34816
v_mfma_f32_16x16x32_bf16 v[68:71], a[16:19], a[80:83], v[68:71]
ds_read_b128 a[68:71], v200 offset:35840
buffer_load_dwordx4 a[144:147], v1, s[4:7], s52 offen offset:2048 sc1
v_mfma_f32_16x16x32_bf16 v[72:75], a[16:19], a[84:87], v[72:75]
v_exp_f32 v198, v198
v_mfma_f32_16x16x32_bf16 v[76:79], a[20:23], a[80:83], v[76:79]
v_exp_f32 v199, v199
v_mfma_f32_16x16x32_bf16 v[80:83], a[20:23], a[84:87], v[80:83]
v_fma_f32 v196, v196, v255, v255
v_fma_f32 v197, v197, v255, v255
v_mfma_f32_16x16x32_bf16 v[84:87], a[24:27], a[80:83], v[84:87]
buffer_load_dwordx4 a[148:151], v9, s[4:7], s52 offen offset:2048 sc1
v_mfma_f32_16x16x32_bf16 v[88:91], a[24:27], a[84:87], v[88:91]
v_fma_f32 v198, v198, v255, v255
v_mfma_f32_16x16x32_bf16 v[92:95], a[28:31], a[80:83], v[92:95]
v_mfma_f32_16x16x32_bf16 v[96:99], a[28:31], a[84:87], v[96:99]
v_fma_f32 v199, v199, v255, v255
v_mfma_f32_16x16x32_bf16 v[100:103], a[32:35], a[80:83], v[100:103]
v_mfma_f32_16x16x32_bf16 v[104:107], a[32:35], a[84:87], v[104:107]
s_waitcnt vmcnt(20) lgkmcnt(0)
s_barrier
v_mfma_f32_16x16x32_bf16 v[36:39], a[36:39], a[88:91], v[36:39]
ds_read_b128 a[0:3], v201 offset:0
buffer_load_dwordx4 a[152:155], v1, s[4:7], s52 offen offset:3072 sc1
v_mfma_f32_16x16x32_bf16 v[40:43], a[36:39], a[92:95], v[40:43]
ds_read_b128 a[4:7], v201 offset:1024
v_mfma_f32_16x16x32_bf16 v[44:47], a[40:43], a[88:91], v[44:47]
ds_read_b128 a[8:11], v201 offset:2048
buffer_load_dwordx4 a[156:159], v9, s[4:7], s52 offen offset:3072 sc1
v_mfma_f32_16x16x32_bf16 v[48:51], a[40:43], a[92:95], v[48:51]
ds_read_b128 a[12:15], v201 offset:3072
v_mfma_f32_16x16x32_bf16 v[52:55], a[44:47], a[88:91], v[52:55]
ds_read_b128 a[16:19], v201 offset:4096
s_mul_i32 s38, s24, 13312
v_mfma_f32_16x16x32_bf16 v[56:59], a[44:47], a[92:95], v[56:59]
ds_read_b128 a[20:23], v201 offset:5120
v_mfma_f32_16x16x32_bf16 v[60:63], a[48:51], a[88:91], v[60:63]
ds_read_b128 a[24:27], v201 offset:6144
v_mfma_f32_16x16x32_bf16 v[64:67], a[48:51], a[92:95], v[64:67]
ds_read_b128 a[28:31], v201 offset:7168
s_add_u32 m0, s38, 0
v_mfma_f32_16x16x32_bf16 v[68:71], a[52:55], a[88:91], v[68:71]
ds_read_b128 a[32:35], v201 offset:8192
v_mfma_f32_16x16x32_bf16 v[72:75], a[52:55], a[92:95], v[72:75]
s_add_u32 s39, s38, s83
v_rcp_f32 v196, v196
v_mfma_f32_16x16x32_bf16 v[76:79], a[56:59], a[88:91], v[76:79]
v_rcp_f32 v197, v197
v_mfma_f32_16x16x32_bf16 v[80:83], a[56:59], a[92:95], v[80:83]
v_rcp_f32 v198, v198
v_mfma_f32_16x16x32_bf16 v[84:87], a[60:63], a[88:91], v[84:87]
buffer_load_dwordx4 v1, s[4:7], s39 offen offset:0 sc1 lds
v_mfma_f32_16x16x32_bf16 v[88:91], a[60:63], a[92:95], v[88:91]
v_mfma_f32_16x16x32_bf16 v[92:95], a[64:67], a[88:91], v[92:95]
buffer_load_dwordx4 v1, s[4:7], s39 offen offset:1024 sc1 lds
v_mfma_f32_16x16x32_bf16 v[96:99], a[64:67], a[92:95], v[96:99]
v_rcp_f32 v199, v199
v_mfma_f32_16x16x32_bf16 v[100:103], a[68:71], a[88:91], v[100:103]
v_mfma_f32_16x16x32_bf16 v[104:107], a[68:71], a[92:95], v[104:107]
s_waitcnt lgkmcnt(0)
v_mfma_f32_16x16x32_bf16 v[36:39], a[0:3], a[96:99], v[36:39]
ds_read_b128 a[36:39], v201 offset:9216
buffer_load_dwordx4 v1, s[4:7], s39 offen offset:2048 sc1 lds
v_mfma_f32_16x16x32_bf16 v[40:43], a[0:3], a[100:103], v[40:43]
ds_read_b128 a[40:43], v201 offset:10240
v_mul_f32 v176, v176, v196
v_mfma_f32_16x16x32_bf16 v[44:47], a[4:7], a[96:99], v[44:47]
ds_read_b128 a[44:47], v201 offset:11264
buffer_load_dwordx4 v1, s[4:7], s39 offen offset:3072 sc1 lds
v_mfma_f32_16x16x32_bf16 v[48:51], a[4:7], a[100:103], v[48:51]
ds_read_b128 a[48:51], v201 offset:12288
v_mul_f32 v177, v177, v197
v_mfma_f32_16x16x32_bf16 v[52:55], a[8:11], a[96:99], v[52:55]
ds_read_b128 a[52:55], v201 offset:13312
v_mfma_f32_16x16x32_bf16 v[56:59], a[8:11], a[100:103], v[56:59]
ds_read_b128 a[56:59], v201 offset:14336
s_add_u32 m0, m0, 4096
v_mfma_f32_16x16x32_bf16 v[60:63], a[12:15], a[96:99], v[60:63]
ds_read_b128 a[60:63], v201 offset:15360
v_mul_f32 v178, v178, v198
v_mfma_f32_16x16x32_bf16 v[64:67], a[12:15], a[100:103], v[64:67]
ds_read_b128 a[64:67], v201 offset:16384
v_mul_f32 v179, v179, v199
v_mfma_f32_16x16x32_bf16 v[68:71], a[16:19], a[96:99], v[68:71]
ds_read_b128 a[68:71], v201 offset:17408
s_add_u32 s39, s39, 4096
v_mfma_f32_16x16x32_bf16 v[72:75], a[16:19], a[100:103], v[72:75]
s_lshl_b32 s30, s25, 3
v_mfma_f32_16x16x32_bf16 v[76:79], a[20:23], a[96:99], v[76:79]
s_lshl_b32 s31, s24, 1
v_mfma_f32_16x16x32_bf16 v[80:83], a[20:23], a[100:103], v[80:83]
buffer_load_dwordx4 v1, s[4:7], s39 offen offset:0 sc1 lds
v_mfma_f32_16x16x32_bf16 v[84:87], a[24:27], a[96:99], v[84:87]
s_add_u32 s30, s30, s31
v_mfma_f32_16x16x32_bf16 v[88:91], a[24:27], a[100:103], v[88:91]
s_mul_i32 s30, s30, 73728
v_mfma_f32_16x16x32_bf16 v[92:95], a[28:31], a[96:99], v[92:95]
buffer_load_dwordx4 v1, s[4:7], s39 offen offset:1024 sc1 lds
v_mfma_f32_16x16x32_bf16 v[96:99], a[28:31], a[100:103], v[96:99]
s_add_u32 s30, s30, 16777216
v_mfma_f32_16x16x32_bf16 v[100:103], a[32:35], a[96:99], v[100:103]
s_mul_i32 s31, s26, 4608
v_mfma_f32_16x16x32_bf16 v[104:107], a[32:35], a[100:103], v[104:107]
s_add_u32 s30, s30, s31
s_waitcnt vmcnt(24) lgkmcnt(0)
v_mfma_f32_16x16x32_bf16 v[36:39], a[36:39], a[104:107], v[36:39]
ds_read_b128 a[0:3], v201 offset:18432
buffer_load_dwordx4 v1, s[4:7], s39 offen offset:2048 sc1 lds
v_mfma_f32_16x16x32_bf16 v[40:43], a[36:39], a[108:111], v[40:43]
ds_read_b128 a[4:7], v201 offset:19456
v_mfma_f32_16x16x32_bf16 v[44:47], a[40:43], a[104:107], v[44:47]
ds_read_b128 a[8:11], v201 offset:20480
buffer_load_dwordx4 v1, s[4:7], s39 offen offset:3072 sc1 lds
v_mfma_f32_16x16x32_bf16 v[48:51], a[40:43], a[108:111], v[48:51]
ds_read_b128 a[12:15], v201 offset:21504
v_mfma_f32_16x16x32_bf16 v[52:55], a[44:47], a[104:107], v[52:55]
ds_read_b128 a[16:19], v201 offset:22528
v_mfma_f32_16x16x32_bf16 v[56:59], a[44:47], a[108:111], v[56:59]
ds_read_b128 a[20:23], v201 offset:23552
s_add_u32 m0, m0, 4096
v_mfma_f32_16x16x32_bf16 v[60:63], a[48:51], a[104:107], v[60:63]
ds_read_b128 a[24:27], v201 offset:24576
v_mfma_f32_16x16x32_bf16 v[64:67], a[48:51], a[108:111], v[64:67]
ds_read_b128 a[28:31], v201 offset:25600
v_mfma_f32_16x16x32_bf16 v[68:71], a[52:55], a[104:107], v[68:71]
ds_read_b128 a[32:35], v201 offset:26624
s_add_u32 s39, s39, 4096
v_mfma_f32_16x16x32_bf16 v[72:75], a[52:55], a[108:111], v[72:75]
s_and_b32 s65, s26, 1
v_mfma_f32_16x16x32_bf16 v[76:79], a[56:59], a[104:107], v[76:79]
s_lshl_b32 s64, s65, 9
v_mfma_f32_16x16x32_bf16 v[80:83], a[56:59], a[108:111], v[80:83]
buffer_load_dwordx4 v1, s[4:7], s39 offen offset:0 sc1 lds
v_mfma_f32_16x16x32_bf16 v[84:87], a[60:63], a[104:107], v[84:87]
s_add_u32 s64, s64, s30
v_mfma_f32_16x16x32_bf16 v[88:91], a[60:63], a[108:111], v[88:91]
s_xor_b32 s65, s65, 1
v_mfma_f32_16x16x32_bf16 v[92:95], a[64:67], a[104:107], v[92:95]
buffer_load_dwordx4 v1, s[4:7], s39 offen offset:1024 sc1 lds
v_mfma_f32_16x16x32_bf16 v[96:99], a[64:67], a[108:111], v[96:99]
s_lshl_b32 s65, s65, 12
v_mfma_f32_16x16x32_bf16 v[100:103], a[68:71], a[104:107], v[100:103]
s_add_u32 s65, s65, s30
v_mfma_f32_16x16x32_bf16 v[104:107], a[68:71], a[108:111], v[104:107]
s_waitcnt lgkmcnt(0)
v_mfma_f32_16x16x32_bf16 v[36:39], a[0:3], a[112:115], v[36:39]
ds_read_b128 a[36:39], v201 offset:27648
buffer_load_dwordx4 v1, s[4:7], s39 offen offset:2048 sc1 lds
v_mfma_f32_16x16x32_bf16 v[40:43], a[0:3], a[116:119], v[40:43]
ds_read_b128 a[40:43], v201 offset:28672
buffer_load_dwordx4 v1, s[4:7], s39 offen offset:3072 sc1 lds
v_mfma_f32_16x16x32_bf16 v[44:47], a[4:7], a[112:115], v[44:47]
ds_read_b128 a[44:47], v201 offset:29696
v_mfma_f32_16x16x32_bf16 v[48:51], a[4:7], a[116:119], v[48:51]
ds_read_b128 a[48:51], v201 offset:30720
s_add_u32 m0, m0, 4096
v_mfma_f32_16x16x32_bf16 v[52:55], a[8:11], a[112:115], v[52:55]
ds_read_b128 a[52:55], v201 offset:31744
v_add_u32 v204, 73728, v1
v_mfma_f32_16x16x32_bf16 v[56:59], a[8:11], a[116:119], v[56:59]
ds_read_b128 a[56:59], v201 offset:32768
s_add_u32 s39, s39, 4096
v_mfma_f32_16x16x32_bf16 v[60:63], a[12:15], a[112:115], v[60:63]
ds_read_b128 a[60:63], v201 offset:33792
buffer_load_dwordx4 v1, s[4:7], s39 offen offset:0 sc1 lds
v_mfma_f32_16x16x32_bf16 v[64:67], a[12:15], a[116:119], v[64:67]
ds_read_b128 a[64:67], v201 offset:34816
v_and_b32 v203, 1, v3
v_mfma_f32_16x16x32_bf16 v[68:71], a[16:19], a[112:115], v[68:71]
ds_read_b128 a[68:71], v201 offset:35840
s_mul_i32 s38, s24, 9216
v_mfma_f32_16x16x32_bf16 v[72:75], a[16:19], a[116:119], v[72:75]
s_add_u32 m0, s38, 53248
v_mul_u32_u24 v203, 73728, v203
v_mfma_f32_16x16x32_bf16 v[76:79], a[20:23], a[112:115], v[76:79]
s_add_u32 s39, s38, s83
v_mfma_f32_16x16x32_bf16 v[80:83], a[20:23], a[116:119], v[80:83]
s_add_u32 s39, s39, 53248
v_lshrrev_b32 v7, 1, v3
v_mfma_f32_16x16x32_bf16 v[84:87], a[24:27], a[112:115], v[84:87]
v_mfma_f32_16x16x32_bf16 v[88:91], a[24:27], a[116:119], v[88:91]
v_mfma_f32_16x16x32_bf16 v[92:95], a[28:31], a[112:115], v[92:95]
v_lshl_add_u32 v203, v7, 8, v203
v_mfma_f32_16x16x32_bf16 v[96:99], a[28:31], a[116:119], v[96:99]
buffer_load_dwordx4 v1, s[4:7], s39 offen offset:0 sc1 lds
v_mfma_f32_16x16x32_bf16 v[100:103], a[32:35], a[112:115], v[100:103]
v_lshl_add_u32 v203, v2, 4, v203
v_mfma_f32_16x16x32_bf16 v[104:107], a[32:35], a[116:119], v[104:107]
s_waitcnt vmcnt(14) lgkmcnt(0)
s_barrier
v_mfma_f32_16x16x32_bf16 v[36:39], a[36:39], a[120:123], v[36:39]
ds_read_b128 a[0:3], v202 offset:8192
buffer_load_dwordx4 v1, s[4:7], s39 offen offset:1024 sc1 lds
v_mfma_f32_16x16x32_bf16 v[40:43], a[36:39], a[124:127], v[40:43]
ds_read_b128 a[4:7], v202 offset:17408
v_mfma_f32_16x16x32_bf16 v[44:47], a[40:43], a[120:123], v[44:47]
ds_read_b128 a[8:11], v202 offset:26624
buffer_load_dwordx4 v1, s[4:7], s39 offen offset:2048 sc1 lds
v_mfma_f32_16x16x32_bf16 v[48:51], a[40:43], a[124:127], v[48:51]
ds_read_b128 a[12:15], v202 offset:35840
v_mfma_f32_16x16x32_bf16 v[52:55], a[44:47], a[120:123], v[52:55]
ds_read_b128 a[16:19], v202 offset:0
v_mfma_f32_16x16x32_bf16 v[56:59], a[44:47], a[124:127], v[56:59]
ds_read_b128 a[20:23], v202 offset:1024
buffer_load_dwordx4 v1, s[4:7], s39 offen offset:3072 sc1 lds
v_mfma_f32_16x16x32_bf16 v[60:63], a[48:51], a[120:123], v[60:63]
ds_read_b128 a[24:27], v202 offset:9216
v_mfma_f32_16x16x32_bf16 v[64:67], a[48:51], a[124:127], v[64:67]
ds_read_b128 a[28:31], v202 offset:10240
v_mfma_f32_16x16x32_bf16 v[68:71], a[52:55], a[120:123], v[68:71]
ds_read_b128 a[32:35], v202 offset:18432
s_add_u32 m0, m0, 4096
v_mfma_f32_16x16x32_bf16 v[72:75], a[52:55], a[124:127], v[72:75]
s_add_u32 s39, s39, 4096
v_mfma_f32_16x16x32_bf16 v[76:79], a[56:59], a[120:123], v[76:79]
v_mfma_f32_16x16x32_bf16 v[80:83], a[56:59], a[124:127], v[80:83]
v_mfma_f32_16x16x32_bf16 v[84:87], a[60:63], a[120:123], v[84:87]
v_mfma_f32_16x16x32_bf16 v[88:91], a[60:63], a[124:127], v[88:91]
v_mfma_f32_16x16x32_bf16 v[92:95], a[64:67], a[120:123], v[92:95]
buffer_load_dwordx4 v1, s[4:7], s39 offen offset:0 sc1 lds
v_mfma_f32_16x16x32_bf16 v[96:99], a[64:67], a[124:127], v[96:99]
v_mfma_f32_16x16x32_bf16 v[100:103], a[68:71], a[120:123], v[100:103]
v_mfma_f32_16x16x32_bf16 v[104:107], a[68:71], a[124:127], v[104:107]
s_waitcnt lgkmcnt(7)
v_mfma_f32_16x16x32_bf16 v[100:103], a[0:3], a[128:131], v[100:103]
ds_read_b128 a[36:39], v202 offset:19456
v_mfma_f32_16x16x32_bf16 v[104:107], a[0:3], a[132:135], v[104:107]
v_mfma_f32_16x16x32_bf16 v[100:103], a[4:7], a[136:139], v[100:103]
ds_read_b128 a[40:43], v202 offset:27648
v_mfma_f32_16x16x32_bf16 v[104:107], a[4:7], a[140:143], v[104:107]
s_waitcnt lgkmcnt(7)
v_mfma_f32_16x16x32_bf16 v[100:103], a[8:11], a[144:147], v[100:103]
ds_read_b128 a[44:47], v202 offset:28672
v_mfma_f32_16x16x32_bf16 v[104:107], a[8:11], a[148:151], v[104:107]
v_mfma_f32_16x16x32_bf16 v[100:103], a[12:15], a[152:155], v[100:103]
ds_read_b128 a[48:51], v202 offset:2048
v_mfma_f32_16x16x32_bf16 v[104:107], a[12:15], a[156:159], v[104:107]
s_waitcnt lgkmcnt(7)
v_mfma_f32_16x16x32_bf16 v[36:39], a[16:19], a[128:131], v[36:39]
ds_read_b128 a[52:55], v202 offset:3072
v_mfma_f32_16x16x32_bf16 v[40:43], a[16:19], a[132:135], v[40:43]
v_mfma_f32_16x16x32_bf16 v[44:47], a[20:23], a[128:131], v[44:47]
ds_read_b128 a[56:59], v202 offset:11264
v_mfma_f32_16x16x32_bf16 v[48:51], a[20:23], a[132:135], v[48:51]
v_mul_f32 v100, v100, v108
s_waitcnt lgkmcnt(7)
v_mfma_f32_16x16x32_bf16 v[36:39], a[24:27], a[136:139], v[36:39]
ds_read_b128 a[60:63], v202 offset:12288
v_mul_f32 v101, v101, v109
v_mfma_f32_16x16x32_bf16 v[40:43], a[24:27], a[140:143], v[40:43]
v_mul_f32 v102, v102, v110
v_mul_f32 v103, v103, v111
v_mfma_f32_16x16x32_bf16 v[44:47], a[28:31], a[136:139], v[44:47]
ds_read_b128 a[64:67], v202 offset:20480
v_cvt_pk_bf16_f32 v238, v100, v101
v_mfma_f32_16x16x32_bf16 v[48:51], a[28:31], a[140:143], v[48:51]
v_cvt_pk_bf16_f32 v239, v102, v103
s_waitcnt lgkmcnt(7)
v_mfma_f32_16x16x32_bf16 v[36:39], a[32:35], a[144:147], v[36:39]
ds_read_b128 a[68:71], v202 offset:21504
v_mul_f32 v104, v104, v112
v_mfma_f32_16x16x32_bf16 v[40:43], a[32:35], a[148:151], v[40:43]
v_mul_f32 v105, v105, v113
v_mfma_f32_16x16x32_bf16 v[44:47], a[36:39], a[144:147], v[44:47]
ds_read_b128 a[0:3], v202 offset:29696
v_mul_f32 v106, v106, v114
v_mfma_f32_16x16x32_bf16 v[48:51], a[36:39], a[148:151], v[48:51]
v_mul_f32 v107, v107, v115
s_waitcnt lgkmcnt(7)
v_mfma_f32_16x16x32_bf16 v[36:39], a[40:43], a[152:155], v[36:39]
ds_read_b128 a[4:7], v202 offset:30720
v_cvt_pk_bf16_f32 v240, v104, v105
v_mfma_f32_16x16x32_bf16 v[40:43], a[40:43], a[156:159], v[40:43]
v_cvt_pk_bf16_f32 v241, v106, v107
s_nop 0
v_mfma_f32_16x16x32_bf16 v[44:47], a[44:47], a[152:155], v[44:47]
ds_read_b128 a[8:11], v202 offset:4096
v_mfma_f32_16x16x32_bf16 v[48:51], a[44:47], a[156:159], v[48:51]
s_waitcnt lgkmcnt(7)
v_mfma_f32_16x16x32_bf16 v[52:55], a[48:51], a[128:131], v[52:55]
ds_read_b128 a[12:15], v202 offset:5120
v_permlane16_swap_b32 v238, v240
v_mfma_f32_16x16x32_bf16 v[56:59], a[48:51], a[132:135], v[56:59]
v_permlane16_swap_b32 v239, v241
v_mfma_f32_16x16x32_bf16 v[60:63], a[52:55], a[128:131], v[60:63]
ds_read_b128 a[16:19], v202 offset:13312
buffer_store_dwordx4 v[238:241], v203, s[8:11], s65 offen sc1
v_mfma_f32_16x16x32_bf16 v[64:67], a[52:55], a[132:135], v[64:67]
v_mul_f32 v36, v36, v116
s_waitcnt lgkmcnt(7)
v_mfma_f32_16x16x32_bf16 v[52:55], a[56:59], a[136:139], v[52:55]
ds_read_b128 a[20:23], v202 offset:14336
v_mul_f32 v37, v37, v117
v_mfma_f32_16x16x32_bf16 v[56:59], a[56:59], a[140:143], v[56:59]
v_mul_f32 v38, v38, v118
v_mul_f32 v39, v39, v119
v_mfma_f32_16x16x32_bf16 v[60:63], a[60:63], a[136:139], v[60:63]
ds_read_b128 a[24:27], v202 offset:22528
v_cvt_pk_bf16_f32 v206, v36, v37
v_mfma_f32_16x16x32_bf16 v[64:67], a[60:63], a[140:143], v[64:67]
v_cvt_pk_bf16_f32 v207, v38, v39
v_mul_f32 v44, v44, v124
s_waitcnt lgkmcnt(7)
v_mfma_f32_16x16x32_bf16 v[52:55], a[64:67], a[144:147], v[52:55]
ds_read_b128 a[28:31], v202 offset:23552
v_mul_f32 v45, v45, v125
v_mfma_f32_16x16x32_bf16 v[56:59], a[64:67], a[148:151], v[56:59]
v_mul_f32 v46, v46, v126
v_mul_f32 v47, v47, v127
v_mfma_f32_16x16x32_bf16 v[60:63], a[68:71], a[144:147], v[60:63]
ds_read_b128 a[32:35], v202 offset:31744
v_cvt_pk_bf16_f32 v208, v44, v45
v_mfma_f32_16x16x32_bf16 v[64:67], a[68:71], a[148:151], v[64:67]
v_cvt_pk_bf16_f32 v209, v46, v47
s_waitcnt lgkmcnt(7)
v_mfma_f32_16x16x32_bf16 v[52:55], a[0:3], a[152:155], v[52:55]
ds_read_b128 a[36:39], v202 offset:32768
buffer_store_dwordx4 v[206:209], v1, s[8:11], s64 offen offset:0 sc1
v_mul_f32 v40, v40, v120
v_mul_f32 v41, v41, v121
v_mfma_f32_16x16x32_bf16 v[56:59], a[0:3], a[156:159], v[56:59]
v_mul_f32 v42, v42, v122
v_mul_f32 v43, v43, v123
v_mfma_f32_16x16x32_bf16 v[60:63], a[4:7], a[152:155], v[60:63]
ds_read_b128 a[40:43], v202 offset:6144
v_cvt_pk_bf16_f32 v210, v40, v41
v_mfma_f32_16x16x32_bf16 v[64:67], a[4:7], a[156:159], v[64:67]
v_cvt_pk_bf16_f32 v211, v42, v43
v_mul_f32 v48, v48, v128
s_waitcnt lgkmcnt(7)
v_mfma_f32_16x16x32_bf16 v[68:71], a[8:11], a[128:131], v[68:71]
ds_read_b128 a[44:47], v202 offset:7168
v_mul_f32 v49, v49, v129
v_mfma_f32_16x16x32_bf16 v[72:75], a[8:11], a[132:135], v[72:75]
v_mul_f32 v50, v50, v130
v_mul_f32 v51, v51, v131
v_mfma_f32_16x16x32_bf16 v[76:79], a[12:15], a[128:131], v[76:79]
ds_read_b128 a[48:51], v202 offset:15360
v_cvt_pk_bf16_f32 v212, v48, v49
v_cvt_pk_bf16_f32 v213, v50, v51
buffer_store_dwordx4 v[210:213], v204, s[8:11], s64 offen offset:0 sc1
v_mfma_f32_16x16x32_bf16 v[80:83], a[12:15], a[132:135], v[80:83]
v_mul_f32 v52, v52, v132
s_waitcnt lgkmcnt(7)
v_mfma_f32_16x16x32_bf16 v[68:71], a[16:19], a[136:139], v[68:71]
ds_read_b128 a[52:55], v202 offset:16384
v_mul_f32 v53, v53, v133
v_mfma_f32_16x16x32_bf16 v[72:75], a[16:19], a[140:143], v[72:75]
v_mul_f32 v54, v54, v134
v_mul_f32 v55, v55, v135
v_mfma_f32_16x16x32_bf16 v[76:79], a[20:23], a[136:139], v[76:79]
ds_read_b128 a[56:59], v202 offset:24576
v_cvt_pk_bf16_f32 v214, v52, v53
v_mfma_f32_16x16x32_bf16 v[80:83], a[20:23], a[140:143], v[80:83]
v_cvt_pk_bf16_f32 v215, v54, v55
v_mul_f32 v60, v60, v140
s_waitcnt lgkmcnt(7)
v_mfma_f32_16x16x32_bf16 v[68:71], a[24:27], a[144:147], v[68:71]
ds_read_b128 a[60:63], v202 offset:25600
v_mul_f32 v61, v61, v141
v_mfma_f32_16x16x32_bf16 v[72:75], a[24:27], a[148:151], v[72:75]
v_mul_f32 v62, v62, v142
v_mul_f32 v63, v63, v143
v_mfma_f32_16x16x32_bf16 v[76:79], a[28:31], a[144:147], v[76:79]
ds_read_b128 a[64:67], v202 offset:33792
v_cvt_pk_bf16_f32 v216, v60, v61
v_mfma_f32_16x16x32_bf16 v[80:83], a[28:31], a[148:151], v[80:83]
v_cvt_pk_bf16_f32 v217, v62, v63
s_waitcnt lgkmcnt(7)
v_mfma_f32_16x16x32_bf16 v[68:71], a[32:35], a[152:155], v[68:71]
ds_read_b128 a[68:71], v202 offset:34816
buffer_store_dwordx4 v[214:217], v1, s[8:11], s64 offen offset:1024 sc1
v_mul_f32 v56, v56, v136
v_mul_f32 v57, v57, v137
v_mfma_f32_16x16x32_bf16 v[72:75], a[32:35], a[156:159], v[72:75]
v_mul_f32 v58, v58, v138
v_mul_f32 v59, v59, v139
v_mfma_f32_16x16x32_bf16 v[76:79], a[36:39], a[152:155], v[76:79]
v_cvt_pk_bf16_f32 v218, v56, v57
v_cvt_pk_bf16_f32 v219, v58, v59
v_mfma_f32_16x16x32_bf16 v[80:83], a[36:39], a[156:159], v[80:83]
v_mul_f32 v64, v64, v144
s_waitcnt lgkmcnt(6)
v_mfma_f32_16x16x32_bf16 v[84:87], a[40:43], a[128:131], v[84:87]
v_mul_f32 v65, v65, v145
v_mul_f32 v66, v66, v146
v_mfma_f32_16x16x32_bf16 v[88:91], a[40:43], a[132:135], v[88:91]
v_mul_f32 v67, v67, v147
v_cvt_pk_bf16_f32 v220, v64, v65
v_mfma_f32_16x16x32_bf16 v[92:95], a[44:47], a[128:131], v[92:95]
v_cvt_pk_bf16_f32 v221, v66, v67
buffer_store_dwordx4 v[218:221], v204, s[8:11], s64 offen offset:1024 sc1
v_mfma_f32_16x16x32_bf16 v[96:99], a[44:47], a[132:135], v[96:99]
v_mul_f32 v68, v68, v148
s_waitcnt lgkmcnt(4)
v_mfma_f32_16x16x32_bf16 v[84:87], a[48:51], a[136:139], v[84:87]
v_mul_f32 v69, v69, v149
v_mul_f32 v70, v70, v150
v_mfma_f32_16x16x32_bf16 v[88:91], a[48:51], a[140:143], v[88:91]
v_mul_f32 v71, v71, v151
v_cvt_pk_bf16_f32 v222, v68, v69
v_mfma_f32_16x16x32_bf16 v[92:95], a[52:55], a[136:139], v[92:95]
v_cvt_pk_bf16_f32 v223, v70, v71
v_mul_f32 v76, v76, v156
v_mfma_f32_16x16x32_bf16 v[96:99], a[52:55], a[140:143], v[96:99]
v_mul_f32 v77, v77, v157
s_waitcnt lgkmcnt(2)
v_mfma_f32_16x16x32_bf16 v[84:87], a[56:59], a[144:147], v[84:87]
v_mul_f32 v78, v78, v158
v_mul_f32 v79, v79, v159
v_mfma_f32_16x16x32_bf16 v[88:91], a[56:59], a[148:151], v[88:91]
v_cvt_pk_bf16_f32 v224, v76, v77
v_cvt_pk_bf16_f32 v225, v78, v79
v_mfma_f32_16x16x32_bf16 v[92:95], a[60:63], a[144:147], v[92:95]
buffer_store_dwordx4 v[222:225], v1, s[8:11], s64 offen offset:2048 sc1
v_mul_f32 v72, v72, v152
v_mfma_f32_16x16x32_bf16 v[96:99], a[60:63], a[148:151], v[96:99]
v_mul_f32 v73, v73, v153
v_mul_f32 v74, v74, v154
s_waitcnt lgkmcnt(0)
v_mfma_f32_16x16x32_bf16 v[84:87], a[64:67], a[152:155], v[84:87]
v_mul_f32 v75, v75, v155
v_cvt_pk_bf16_f32 v226, v72, v73
v_mfma_f32_16x16x32_bf16 v[88:91], a[64:67], a[156:159], v[88:91]
v_cvt_pk_bf16_f32 v227, v74, v75
v_mul_f32 v80, v80, v160
v_mfma_f32_16x16x32_bf16 v[92:95], a[68:71], a[152:155], v[92:95]
v_mul_f32 v81, v81, v161
v_mul_f32 v82, v82, v162
v_mfma_f32_16x16x32_bf16 v[96:99], a[68:71], a[156:159], v[96:99]
v_mul_f32 v83, v83, v163
v_cvt_pk_bf16_f32 v228, v80, v81
v_cvt_pk_bf16_f32 v229, v82, v83
buffer_store_dwordx4 v[226:229], v204, s[8:11], s64 offen offset:2048 sc1
s_nop 1
v_pk_mul_f32 v[84:85], v[84:85], v[164:165]
v_pk_mul_f32 v[86:87], v[86:87], v[166:167]
v_cvt_pk_bf16_f32 v230, v84, v85
v_cvt_pk_bf16_f32 v231, v86, v87
v_pk_mul_f32 v[92:93], v[92:93], v[172:173]
v_pk_mul_f32 v[94:95], v[94:95], v[174:175]
v_cvt_pk_bf16_f32 v232, v92, v93
v_cvt_pk_bf16_f32 v233, v94, v95
buffer_store_dwordx4 v[230:233], v1, s[8:11], s64 offen offset:3072 sc1
v_pk_mul_f32 v[88:89], v[88:89], v[168:169]
v_pk_mul_f32 v[90:91], v[90:91], v[170:171]
v_cvt_pk_bf16_f32 v234, v88, v89
v_cvt_pk_bf16_f32 v235, v90, v91
v_pk_mul_f32 v[96:97], v[96:97], v[176:177]
v_pk_mul_f32 v[98:99], v[98:99], v[178:179]
v_cvt_pk_bf16_f32 v236, v96, v97
v_cvt_pk_bf16_f32 v237, v98, v99
buffer_store_dwordx4 v[234:237], v204, s[8:11], s64 offen offset:3072 sc1
L_c5:
buffer_load_dwordx4 v1, s[4:7], s39 offen offset:1024 sc1 lds
buffer_load_dwordx4 v1, s[4:7], s39 offen offset:2048 sc1 lds
buffer_load_dwordx4 v1, s[4:7], s39 offen offset:3072 sc1 lds
s_add_u32 m0, m0, 4096
s_add_u32 s39, s39, 4096
buffer_load_dwordx4 v1, s[4:7], s39 offen offset:0 sc1 lds
s_mul_i32 s38, s24, 9216
s_add_u32 m0, s38, 90112
s_add_u32 s39, s38, s83
s_add_u32 s39, s39, 90112
buffer_load_dwordx4 v1, s[4:7], s39 offen offset:0 sc1 lds
buffer_load_dwordx4 v1, s[4:7], s39 offen offset:1024 sc1 lds
buffer_load_dwordx4 v1, s[4:7], s39 offen offset:2048 sc1 lds
v_lshlrev_b32 v7, 3, v1
s_lshl_b32 s31, s25, 11
v_add_u32 v7, s31, v7
s_cmp_eq_u32 s24, 0
s_cselect_b32 s30, 0, 1073741824
s_add_u32 s30, s30, 26574848
s_waitcnt vmcnt(7)
s_barrier
s_mov_b64 exec, 0xffff
buffer_atomic_add v4, v7, s[8:11], s30 offen sc1
s_mov_b64 exec, -1
s_lshl_b32 s35, s81, 7
s_add_u32 s35, s35, 26574848
s_cmp_eq_u32 s24, 1
s_cselect_b32 s35, s35, 1073741824
v_mov_b32 v6, 0
v_mov_b32 v244, 0
v_mov_b32 v245, 0
v_mov_b32 v246, 0
buffer_load_dwordx4 v1, s[4:7], s39 offen offset:3072 sc1 lds
s_add_u32 m0, m0, 4096
s_add_u32 s39, s39, 4096
buffer_load_dwordx4 v1, s[4:7], s39 offen offset:0 sc1 lds
buffer_load_dwordx4 v1, s[4:7], s39 offen offset:1024 sc1 lds
buffer_load_dwordx4 v1, s[4:7], s39 offen offset:2048 sc1 lds
s_mov_b64 exec, 1
buffer_atomic_add v244, v6, s[8:11], s35 offen sc0 sc1
s_mov_b64 exec, -1
buffer_load_dwordx4 v1, s[4:7], s39 offen offset:3072 sc1 lds
s_add_u32 m0, m0, 4096
s_add_u32 s39, s39, 4096
buffer_load_dwordx4 v1, s[4:7], s39 offen offset:0 sc1 lds
s_mul_i32 s38, s24, 9216
s_add_u32 m0, s38, 126976
s_add_u32 s39, s38, s83
s_add_u32 s39, s39, 126976
buffer_load_dwordx4 v1, s[4:7], s39 offen offset:0 sc1 lds
buffer_load_dwordx4 v1, s[4:7], s39 offen offset:1024 sc1 lds
s_mov_b64 exec, 1
buffer_atomic_add v245, v6, s[8:11], s35 offen sc0 sc1
s_mov_b64 exec, -1
buffer_load_dwordx4 v1, s[4:7], s39 offen offset:2048 sc1 lds
buffer_load_dwordx4 v1, s[4:7], s39 offen offset:3072 sc1 lds
s_add_u32 m0, m0, 4096
s_add_u32 s39, s39, 4096
buffer_load_dwordx4 v1, s[4:7], s39 offen offset:0 sc1 lds
buffer_load_dwordx4 v1, s[4:7], s39 offen offset:1024 sc1 lds
s_mov_b64 exec, 1
buffer_atomic_add v246, v6, s[8:11], s35 offen sc0 sc1
s_mov_b64 exec, -1
buffer_load_dwordx4 v1, s[4:7], s39 offen offset:2048 sc1 lds
buffer_load_dwordx4 v1, s[4:7], s39 offen offset:3072 sc1 lds
s_add_u32 m0, m0, 4096
s_add_u32 s39, s39, 4096
buffer_load_dwordx4 v1, s[4:7], s39 offen offset:0 sc1 lds
s_xor_b32 s30, s27, 1
s_lshl_b32 s60, s30, 2
s_add_u32 s60, s60, s24
s_mul_i32 s60, s60, 73728
s_and_b32 s32, s27, 1
s_mul_i32 s32, s32, 36864
s_add_u32 s32, s32, 16777216
s_add_u32 s60, s60, s32
s_lshl_b32 s61, s27, 2
s_add_u32 s61, s61, s24
s_mul_i32 s61, s61, 73728
s_add_u32 s61, s61, s32
s_cmp_eq_u32 s24, 1
s_cbranch_scc0 L_other_33
s_mov_b32 s31, 0
s_mov_b64 exec, 1
v_mov_b32 v247, 0
buffer_atomic_add v247, v6, s[8:11], s35 offen sc0 sc1
s_waitcnt vmcnt(14)
v_cmp_gt_u32 vcc, 16, v244
s_nop 0
s_cbranch_vccz L_polled_32
s_waitcnt vmcnt(9)
v_cmp_gt_u32 vcc, 16, v245
s_nop 0
s_cbranch_vccz L_polled_32
v_mov_b32 v244, 0
buffer_atomic_add v244, v6, s[8:11], s35 offen sc0 sc1
s_waitcnt vmcnt(5)
v_cmp_gt_u32 vcc, 16, v246
s_nop 0
s_cbranch_vccz L_polled_32
v_mov_b32 v245, 0
buffer_atomic_add v245, v6, s[8:11], s35 offen sc0 sc1
L_poll_31:
s_add_u32 s31, s31, 1
s_cmp_gt_u32 s31, 100000
s_cbranch_scc1 L_polled_32
v_mov_b32 v246, 0
buffer_atomic_add v246, v6, s[8:11], s35 offen sc0 sc1
s_waitcnt vmcnt(3)
v_cmp_gt_u32 vcc, 16, v247
s_nop 0
s_cbranch_vccz L_polled_32
v_mov_b32 v247, 0
buffer_atomic_add v247, v6, s[8:11], s35 offen sc0 sc1
s_waitcnt vmcnt(3)
v_cmp_gt_u32 vcc, 16, v244
s_nop 0
s_cbranch_vccz L_polled_32
v_mov_b32 v244, 0
buffer_atomic_add v244, v6, s[8:11], s35 offen sc0 sc1
s_waitcnt vmcnt(3)
v_cmp_gt_u32 vcc, 16, v245
s_nop 0
s_cbranch_vccz L_polled_32
v_mov_b32 v245, 0
buffer_atomic_add v245, v6, s[8:11], s35 offen sc0 sc1
s_waitcnt vmcnt(3)
v_cmp_gt_u32 vcc, 16, v246
s_nop 0
s_cbranch_vccz L_polled_32
s_branch L_poll_31
L_polled_32:
s_mov_b64 exec, -1
L_other_33:
s_barrier
buffer_load_dwordx4 a[0:3], v1, s[8:11], s60 offen offset:0 sc1
buffer_load_dwordx4 a[4:7], v1, s[8:11], s60 offen offset:1024 sc1
s_barrier
buffer_load_dwordx4 a[8:11], v1, s[8:11], s60 offen offset:2048 sc1
buffer_load_dwordx4 a[12:15], v1, s[8:11], s60 offen offset:3072 sc1
s_barrier
s_add_u32 s60, s60, 4096
buffer_load_dwordx4 a[16:19], v1, s[8:11], s60 offen offset:0 sc1
buffer_load_dwordx4 a[20:23], v1, s[8:11], s60 offen offset:1024 sc1
s_barrier
buffer_load_dwordx4 a[24:27], v1, s[8:11], s60 offen offset:2048 sc1
buffer_load_dwordx4 a[28:31], v1, s[8:11], s60 offen offset:3072 sc1
s_barrier
s_add_u32 s60, s60, 4096
buffer_load_dwordx4 a[32:35], v1, s[8:11], s60 offen offset:0 sc1
buffer_load_dwordx4 a[36:39], v1, s[8:11], s60 offen offset:1024 sc1
v_and_b32 v40, 7, v2
v_lshlrev_b32 v40, 4, v40
v_lshl_add_u32 v40, v3, 7, v40
v_add_u32 v40, 4096, v40
s_lshl_b32 s63, s81, 14
s_lshl_b32 s30, s24, 12
s_add_u32 s63, s63, s30
s_xor_b32 s62, s63, 131072
s_add_u32 s63, s63, 26640384
s_add_u32 s62, s62, 26640384
s_add_u32 s64, s83, 161280
v_mov_b32 v116, v40
v_add_u32 v36, 0, v1
v_add_u32 v37, 55296, v1
v_add_u32 v41, 55296, v40
v_add_u32 v38, 110592, v1
v_add_u32 v42, 110592, v40
ds_read_b128 a[160:163], v36 offset:0
ds_read_b128 a[164:167], v36 offset:1024
ds_read_b128 a[168:171], v36 offset:2048
ds_read_b128 a[172:175], v36 offset:3072
ds_read_b128 a[176:179], v40 offset:0
ds_read_b128 a[180:183], v36 offset:4608
ds_read_b128 a[184:187], v36 offset:5632
ds_read_b128 a[188:191], v36 offset:6656
ds_read_b128 a[192:195], v36 offset:7680
ds_read_b128 a[196:199], v40 offset:4608
s_lshl_b32 s30, s27, 2
s_add_u32 s30, s30, s24
v_mov_b32 v138, 1073741824
s_mul_i32 s66, s30, 18432
s_mul_i32 s32, s28, 2304
s_add_u32 s66, s66, s32
s_add_u32 s66, s66, 30834688
v_mov_b32 v140, v1
v_add_u32 v141, 2048, v140
v_cndmask_b32 v141, v138, v141, s[46:47]
s_lshl_b32 s67, s30, 7
s_lshl_b32 s32, s28, 14
s_add_u32 s67, s67, s32
s_add_u32 s67, s67, 33193984
v_lshlrev_b32 v139, 3, v2
v_cndmask_b32 v138, v138, v139, s[46:47]
s_lshl_b32 s30, s27, 2
s_add_u32 s30, s30, s24
v_mov_b32 v162, 1073741824
s_mul_i32 s68, s30, 18432
s_mul_i32 s32, s28, 144
s_add_u32 s68, s68, s32
v_mul_u32_u24 v164, 1152, v2
v_lshl_add_u32 v164, v3, 4, v164
v_add_u32 v165, 128, v164
v_cndmask_b32 v165, v162, v165, s[46:47]
s_waitcnt vmcnt(9) lgkmcnt(5)
v_mfma_f32_16x16x32_bf16 v[44:47], a[160:163], a[0:3], 0
ds_read_b128 a[200:203], v36 offset:9216
buffer_load_dwordx4 a[40:43], v1, s[8:11], s60 offen offset:2048 sc1
v_mfma_f32_16x16x32_bf16 v[48:51], a[164:167], a[0:3], 0
ds_read_b128 a[204:207], v36 offset:10240
v_mfma_f32_16x16x32_bf16 v[52:55], a[168:171], a[0:3], 0
ds_read_b128 a[208:211], v36 offset:11264
v_mfma_f32_16x16x32_bf16 v[56:59], a[172:175], a[0:3], 0
ds_read_b128 a[212:215], v36 offset:12288
v_mfma_f32_16x16x32_bf16 v[60:63], a[176:179], a[0:3], 0
ds_read_b128 a[216:219], v40 offset:9216
s_waitcnt vmcnt(9) lgkmcnt(5)
v_mfma_f32_16x16x32_bf16 v[44:47], a[180:183], a[4:7], v[44:47]
ds_read_b128 a[160:163], v36 offset:13824
buffer_load_dwordx4 a[0:3], v1, s[8:11], s60 offen offset:3072 sc1
v_mfma_f32_16x16x32_bf16 v[48:51], a[184:187], a[4:7], v[48:51]
ds_read_b128 a[164:167], v36 offset:14848
v_mfma_f32_16x16x32_bf16 v[52:55], a[188:191], a[4:7], v[52:55]
ds_read_b128 a[168:171], v36 offset:15872
v_mfma_f32_16x16x32_bf16 v[56:59], a[192:195], a[4:7], v[56:59]
ds_read_b128 a[172:175], v36 offset:16896
v_mfma_f32_16x16x32_bf16 v[60:63], a[196:199], a[4:7], v[60:63]
ds_read_b128 a[176:179], v40 offset:13824
s_waitcnt vmcnt(9) lgkmcnt(5)
v_mfma_f32_16x16x32_bf16 v[44:47], a[200:203], a[8:11], v[44:47]
ds_read_b128 a[180:183], v36 offset:18432
s_add_u32 s60, s60, 4096
buffer_load_dwordx4 a[4:7], v1, s[8:11], s60 offen offset:0 sc1
v_mfma_f32_16x16x32_bf16 v[48:51], a[204:207], a[8:11], v[48:51]
ds_read_b128 a[184:187], v36 offset:19456
v_mov_b32 v67, v248
v_mfma_f32_16x16x32_bf16 v[52:55], a[208:211], a[8:11], v[52:55]
ds_read_b128 a[188:191], v36 offset:20480
v_mfma_f32_16x16x32_bf16 v[56:59], a[212:215], a[8:11], v[56:59]
ds_read_b128 a[192:195], v36 offset:21504
v_mfma_f32_16x16x32_bf16 v[60:63], a[216:219], a[8:11], v[60:63]
ds_read_b128 a[196:199], v40 offset:18432
s_waitcnt vmcnt(9) lgkmcnt(5)
v_mfma_f32_16x16x32_bf16 v[44:47], a[160:163], a[12:15], v[44:47]
ds_read_b128 a[200:203], v36 offset:23040
buffer_load_dwordx4 a[8:11], v1, s[8:11], s60 offen offset:1024 sc1
v_mfma_f32_16x16x32_bf16 v[48:51], a[164:167], a[12:15], v[48:51]
ds_read_b128 a[204:207], v36 offset:24064
v_mfma_f32_16x16x32_bf16 v[52:55], a[168:171], a[12:15], v[52:55]
ds_read_b128 a[208:211], v36 offset:25088
v_mov_b32 v71, v248
v_mfma_f32_16x16x32_bf16 v[56:59], a[172:175], a[12:15], v[56:59]
ds_read_b128 a[212:215], v36 offset:26112
v_mfma_f32_16x16x32_bf16 v[60:63], a[176:179], a[12:15], v[60:63]
ds_read_b128 a[216:219], v40 offset:23040
s_waitcnt vmcnt(9) lgkmcnt(5)
v_mfma_f32_16x16x32_bf16 v[44:47], a[180:183], a[16:19], v[44:47]
ds_read_b128 a[160:163], v36 offset:27648
buffer_load_dwordx4 a[12:15], v1, s[8:11], s60 offen offset:2048 sc1
v_mfma_f32_16x16x32_bf16 v[48:51], a[184:187], a[16:19], v[48:51]
ds_read_b128 a[164:167], v36 offset:28672
v_mfma_f32_16x16x32_bf16 v[52:55], a[188:191], a[16:19], v[52:55]
ds_read_b128 a[168:171], v36 offset:29696
v_mfma_f32_16x16x32_bf16 v[56:59], a[192:195], a[16:19], v[56:59]
ds_read_b128 a[172:175], v36 offset:30720
v_mfma_f32_16x16x32_bf16 v[60:63], a[196:199], a[16:19], v[60:63]
ds_read_b128 a[176:179], v40 offset:27648
s_waitcnt vmcnt(9) lgkmcnt(5)
v_mfma_f32_16x16x32_bf16 v[44:47], a[200:203], a[20:23], v[44:47]
ds_read_b128 a[180:183], v36 offset:32256
buffer_load_dwordx4 a[16:19], v1, s[8:11], s60 offen offset:3072 sc1
v_mfma_f32_16x16x32_bf16 v[48:51], a[204:207], a[20:23], v[48:51]
ds_read_b128 a[184:187], v36 offset:33280
v_mov_b32 v75, v248
v_mfma_f32_16x16x32_bf16 v[52:55], a[208:211], a[20:23], v[52:55]
ds_read_b128 a[188:191], v36 offset:34304
v_mfma_f32_16x16x32_bf16 v[56:59], a[212:215], a[20:23], v[56:59]
ds_read_b128 a[192:195], v36 offset:35328
v_mfma_f32_16x16x32_bf16 v[60:63], a[216:219], a[20:23], v[60:63]
ds_read_b128 a[196:199], v40 offset:32256
s_waitcnt vmcnt(9) lgkmcnt(5)
v_mfma_f32_16x16x32_bf16 v[44:47], a[160:163], a[24:27], v[44:47]
ds_read_b128 a[200:203], v36 offset:36864
s_add_u32 s60, s60, 4096
buffer_load_dwordx4 a[20:23], v1, s[8:11], s60 offen offset:0 sc1
v_mfma_f32_16x16x32_bf16 v[48:51], a[164:167], a[24:27], v[48:51]
ds_read_b128 a[204:207], v36 offset:37888
v_mfma_f32_16x16x32_bf16 v[52:55], a[168:171], a[24:27], v[52:55]
ds_read_b128 a[208:211], v36 offset:38912
v_mfma_f32_16x16x32_bf16 v[56:59], a[172:175], a[24:27], v[56:59]
ds_read_b128 a[212:215], v36 offset:39936
v_mov_b32 v79, v248
v_mfma_f32_16x16x32_bf16 v[60:63], a[176:179], a[24:27], v[60:63]
ds_read_b128 a[216:219], v40 offset:36864
s_waitcnt vmcnt(9) lgkmcnt(5)
v_mfma_f32_16x16x32_bf16 v[44:47], a[180:183], a[28:31], v[44:47]
ds_read_b128 a[160:163], v36 offset:41472
buffer_load_dwordx4 a[24:27], v1, s[8:11], s60 offen offset:1024 sc1
v_mfma_f32_16x16x32_bf16 v[48:51], a[184:187], a[28:31], v[48:51]
ds_read_b128 a[164:167], v36 offset:42496
v_mfma_f32_16x16x32_bf16 v[52:55], a[188:191], a[28:31], v[52:55]
ds_read_b128 a[168:171], v36 offset:43520
v_mfma_f32_16x16x32_bf16 v[56:59], a[192:195], a[28:31], v[56:59]
ds_read_b128 a[172:175], v36 offset:44544
v_mfma_f32_16x16x32_bf16 v[60:63], a[196:199], a[28:31], v[60:63]
ds_read_b128 a[176:179], v40 offset:41472
s_waitcnt vmcnt(9) lgkmcnt(5)
v_mfma_f32_16x16x32_bf16 v[44:47], a[200:203], a[32:35], v[44:47]
ds_read_b128 a[180:183], v36 offset:46080
buffer_load_dwordx4 a[28:31], v1, s[8:11], s60 offen offset:2048 sc1
v_mfma_f32_16x16x32_bf16 v[48:51], a[204:207], a[32:35], v[48:51]
ds_read_b128 a[184:187], v36 offset:47104
v_mfma_f32_16x16x32_bf16 v[52:55], a[208:211], a[32:35], v[52:55]
ds_read_b128 a[188:191], v36 offset:48128
v_mfma_f32_16x16x32_bf16 v[56:59], a[212:215], a[32:35], v[56:59]
ds_read_b128 a[192:195], v36 offset:49152
v_mfma_f32_16x16x32_bf16 v[60:63], a[216:219], a[32:35], v[60:63]
ds_read_b128 a[196:199], v40 offset:46080
s_barrier
s_waitcnt vmcnt(9) lgkmcnt(5)
v_mfma_f32_16x16x32_bf16 v[44:47], a[160:163], a[36:39], v[44:47]
ds_read_b128 a[200:203], v36 offset:50688
buffer_load_dwordx4 a[32:35], v1, s[8:11], s60 offen offset:3072 sc1
v_mfma_f32_16x16x32_bf16 v[48:51], a[164:167], a[36:39], v[48:51]
ds_read_b128 a[204:207], v36 offset:51712
v_mfma_f32_16x16x32_bf16 v[52:55], a[168:171], a[36:39], v[52:55]
ds_read_b128 a[208:211], v36 offset:52736
v_mfma_f32_16x16x32_bf16 v[56:59], a[172:175], a[36:39], v[56:59]
ds_read_b128 a[212:215], v36 offset:53760
v_mfma_f32_16x16x32_bf16 v[60:63], a[176:179], a[36:39], v[60:63]
ds_read_b128 a[216:219], v40 offset:50688
s_waitcnt vmcnt(9) lgkmcnt(5)
v_mfma_f32_16x16x32_bf16 v[44:47], a[180:183], a[40:43], v[44:47]
ds_read_b128 a[160:163], v37 offset:0
s_add_u32 s60, s60, 4096
buffer_load_dwordx4 a[36:39], v1, s[8:11], s60 offen offset:0 sc1
v_mfma_f32_16x16x32_bf16 v[48:51], a[184:187], a[40:43], v[48:51]
ds_read_b128 a[164:167], v37 offset:1024
v_mfma_f32_16x16x32_bf16 v[52:55], a[188:191], a[40:43], v[52:55]
ds_read_b128 a[168:171], v37 offset:2048
v_mfma_f32_16x16x32_bf16 v[56:59], a[192:195], a[40:43], v[56:59]
ds_read_b128 a[172:175], v37 offset:3072
v_mfma_f32_16x16x32_bf16 v[60:63], a[196:199], a[40:43], v[60:63]
ds_read_b128 a[176:179], v41 offset:0
s_waitcnt vmcnt(9) lgkmcnt(5)
v_mfma_f32_16x16x32_bf16 v[44:47], a[200:203], a[0:3], v[44:47]
ds_read_b128 a[180:183], v37 offset:4608
buffer_load_dwordx4 a[40:43], v1, s[8:11], s60 offen offset:1024 sc1
v_mfma_f32_16x16x32_bf16 v[48:51], a[204:207], a[0:3], v[48:51]
ds_read_b128 a[184:187], v37 offset:5632
v_mfma_f32_16x16x32_bf16 v[52:55], a[208:211], a[0:3], v[52:55]
ds_read_b128 a[188:191], v37 offset:6656
v_mfma_f32_16x16x32_bf16 v[56:59], a[212:215], a[0:3], v[56:59]
ds_read_b128 a[192:195], v37 offset:7680
v_mfma_f32_16x16x32_bf16 v[60:63], a[216:219], a[0:3], v[60:63]
ds_read_b128 a[196:199], v41 offset:4608
s_waitcnt vmcnt(9) lgkmcnt(5)
v_mfma_f32_16x16x32_bf16 v[44:47], a[160:163], a[4:7], v[44:47]
ds_read_b128 a[200:203], v37 offset:9216
buffer_load_dwordx4 a[0:3], v1, s[8:11], s60 offen offset:2048 sc1
v_mfma_f32_16x16x32_bf16 v[48:51], a[164:167], a[4:7], v[48:51]
ds_read_b128 a[204:207], v37 offset:10240
v_mfma_f32_16x16x32_bf16 v[52:55], a[168:171], a[4:7], v[52:55]
ds_read_b128 a[208:211], v37 offset:11264
v_mfma_f32_16x16x32_bf16 v[56:59], a[172:175], a[4:7], v[56:59]
ds_read_b128 a[212:215], v37 offset:12288
v_mfma_f32_16x16x32_bf16 v[60:63], a[176:179], a[4:7], v[60:63]
ds_read_b128 a[216:219], v41 offset:9216
s_waitcnt vmcnt(9) lgkmcnt(5)
v_mfma_f32_16x16x32_bf16 v[44:47], a[180:183], a[8:11], v[44:47]
ds_read_b128 a[160:163], v37 offset:13824
buffer_load_dwordx4 a[4:7], v1, s[8:11], s60 offen offset:3072 sc1
v_mfma_f32_16x16x32_bf16 v[48:51], a[184:187], a[8:11], v[48:51]
ds_read_b128 a[164:167], v37 offset:14848
v_mfma_f32_16x16x32_bf16 v[52:55], a[188:191], a[8:11], v[52:55]
ds_read_b128 a[168:171], v37 offset:15872
v_mfma_f32_16x16x32_bf16 v[56:59], a[192:195], a[8:11], v[56:59]
ds_read_b128 a[172:175], v37 offset:16896
v_mfma_f32_16x16x32_bf16 v[60:63], a[196:199], a[8:11], v[60:63]
ds_read_b128 a[176:179], v41 offset:13824
s_waitcnt vmcnt(9) lgkmcnt(5)
v_mfma_f32_16x16x32_bf16 v[44:47], a[200:203], a[12:15], v[44:47]
ds_read_b128 a[180:183], v37 offset:18432
s_add_u32 s60, s60, 4096
buffer_load_dwordx4 a[8:11], v1, s[8:11], s60 offen offset:0 sc1
v_mfma_f32_16x16x32_bf16 v[48:51], a[204:207], a[12:15], v[48:51]
ds_read_b128 a[184:187], v37 offset:19456
v_mfma_f32_16x16x32_bf16 v[52:55], a[208:211], a[12:15], v[52:55]
ds_read_b128 a[188:191], v37 offset:20480
v_mfma_f32_16x16x32_bf16 v[56:59], a[212:215], a[12:15], v[56:59]
ds_read_b128 a[192:195], v37 offset:21504
v_mfma_f32_16x16x32_bf16 v[60:63], a[216:219], a[12:15], v[60:63]
ds_read_b128 a[196:199], v41 offset:18432
s_waitcnt vmcnt(9) lgkmcnt(5)
v_mfma_f32_16x16x32_bf16 v[44:47], a[160:163], a[16:19], v[44:47]
ds_read_b128 a[200:203], v37 offset:23040
buffer_load_dwordx4 a[12:15], v1, s[8:11], s60 offen offset:1024 sc1
v_mfma_f32_16x16x32_bf16 v[48:51], a[164:167], a[16:19], v[48:51]
ds_read_b128 a[204:207], v37 offset:24064
v_mfma_f32_16x16x32_bf16 v[52:55], a[168:171], a[16:19], v[52:55]
ds_read_b128 a[208:211], v37 offset:25088
v_mfma_f32_16x16x32_bf16 v[56:59], a[172:175], a[16:19], v[56:59]
ds_read_b128 a[212:215], v37 offset:26112
v_mfma_f32_16x16x32_bf16 v[60:63], a[176:179], a[16:19], v[60:63]
ds_read_b128 a[216:219], v41 offset:23040
s_waitcnt vmcnt(9) lgkmcnt(5)
v_mfma_f32_16x16x32_bf16 v[44:47], a[180:183], a[20:23], v[44:47]
ds_read_b128 a[160:163], v37 offset:27648
buffer_load_dwordx4 a[16:19], v1, s[8:11], s60 offen offset:2048 sc1
v_mfma_f32_16x16x32_bf16 v[48:51], a[184:187], a[20:23], v[48:51]
ds_read_b128 a[164:167], v37 offset:28672
buffer_load_dwordx4 a[228:231], v1, s[4:7], s64 offen offset:2048 sc1
v_mfma_f32_16x16x32_bf16 v[52:55], a[188:191], a[20:23], v[52:55]
ds_read_b128 a[168:171], v37 offset:29696
v_mfma_f32_16x16x32_bf16 v[56:59], a[192:195], a[20:23], v[56:59]
ds_read_b128 a[172:175], v37 offset:30720
v_mfma_f32_16x16x32_bf16 v[60:63], a[196:199], a[20:23], v[60:63]
ds_read_b128 a[176:179], v41 offset:27648
s_waitcnt vmcnt(10) lgkmcnt(5)
v_mfma_f32_16x16x32_bf16 v[44:47], a[200:203], a[24:27], v[44:47]
ds_read_b128 a[180:183], v37 offset:32256
buffer_load_dwordx4 a[20:23], v1, s[8:11], s60 offen offset:3072 sc1
v_mfma_f32_16x16x32_bf16 v[48:51], a[204:207], a[24:27], v[48:51]
ds_read_b128 a[184:187], v37 offset:33280
v_mfma_f32_16x16x32_bf16 v[52:55], a[208:211], a[24:27], v[52:55]
ds_read_b128 a[188:191], v37 offset:34304
v_mfma_f32_16x16x32_bf16 v[56:59], a[212:215], a[24:27], v[56:59]
ds_read_b128 a[192:195], v37 offset:35328
v_mfma_f32_16x16x32_bf16 v[60:63], a[216:219], a[24:27], v[60:63]
ds_read_b128 a[196:199], v41 offset:32256
s_waitcnt vmcnt(10) lgkmcnt(5)
v_mfma_f32_16x16x32_bf16 v[44:47], a[160:163], a[28:31], v[44:47]
ds_read_b128 a[200:203], v37 offset:36864
s_add_u32 s60, s60, 4096
buffer_load_dwordx4 a[24:27], v1, s[8:11], s60 offen offset:0 sc1
v_mfma_f32_16x16x32_bf16 v[48:51], a[164:167], a[28:31], v[48:51]
ds_read_b128 a[204:207], v37 offset:37888
v_mfma_f32_16x16x32_bf16 v[52:55], a[168:171], a[28:31], v[52:55]
ds_read_b128 a[208:211], v37 offset:38912
v_mfma_f32_16x16x32_bf16 v[56:59], a[172:175], a[28:31], v[56:59]
ds_read_b128 a[212:215], v37 offset:39936
buffer_load_dwordx4 a[232:235], v1, s[4:7], s64 offen offset:3072 sc1
v_mfma_f32_16x16x32_bf16 v[60:63], a[176:179], a[28:31], v[60:63]
ds_read_b128 a[216:219], v41 offset:36864
s_waitcnt vmcnt(11) lgkmcnt(5)
v_mfma_f32_16x16x32_bf16 v[44:47], a[180:183], a[32:35], v[44:47]
ds_read_b128 a[160:163], v37 offset:41472
buffer_load_dwordx4 a[28:31], v1, s[8:11], s60 offen offset:1024 sc1
v_mfma_f32_16x16x32_bf16 v[48:51], a[184:187], a[32:35], v[48:51]
ds_read_b128 a[164:167], v37 offset:42496
v_mfma_f32_16x16x32_bf16 v[52:55], a[188:191], a[32:35], v[52:55]
ds_read_b128 a[168:171], v37 offset:43520
v_mfma_f32_16x16x32_bf16 v[56:59], a[192:195], a[32:35], v[56:59]
ds_read_b128 a[172:175], v37 offset:44544
v_mfma_f32_16x16x32_bf16 v[60:63], a[196:199], a[32:35], v[60:63]
ds_read_b128 a[176:179], v41 offset:41472
s_waitcnt vmcnt(11) lgkmcnt(5)
v_mfma_f32_16x16x32_bf16 v[44:47], a[200:203], a[36:39], v[44:47]
ds_read_b128 a[180:183], v37 offset:46080
buffer_load_dwordx4 a[32:35], v1, s[8:11], s60 offen offset:2048 sc1
v_mfma_f32_16x16x32_bf16 v[48:51], a[204:207], a[36:39], v[48:51]
ds_read_b128 a[184:187], v37 offset:47104
v_mfma_f32_16x16x32_bf16 v[52:55], a[208:211], a[36:39], v[52:55]
ds_read_b128 a[188:191], v37 offset:48128
v_mfma_f32_16x16x32_bf16 v[56:59], a[212:215], a[36:39], v[56:59]
ds_read_b128 a[192:195], v37 offset:49152
v_mfma_f32_16x16x32_bf16 v[60:63], a[216:219], a[36:39], v[60:63]
ds_read_b128 a[196:199], v41 offset:46080
s_waitcnt vmcnt(11) lgkmcnt(5)
v_mfma_f32_16x16x32_bf16 v[44:47], a[160:163], a[40:43], v[44:47]
ds_read_b128 a[200:203], v37 offset:50688
buffer_load_dwordx4 a[36:39], v1, s[8:11], s60 offen offset:3072 sc1
v_mfma_f32_16x16x32_bf16 v[48:51], a[164:167], a[40:43], v[48:51]
ds_read_b128 a[204:207], v37 offset:51712
v_mfma_f32_16x16x32_bf16 v[52:55], a[168:171], a[40:43], v[52:55]
ds_read_b128 a[208:211], v37 offset:52736
buffer_load_dwordx4 a[236:239], v116, s[4:7], s64 offen sc1
v_mfma_f32_16x16x32_bf16 v[56:59], a[172:175], a[40:43], v[56:59]
ds_read_b128 a[212:215], v37 offset:53760
v_mfma_f32_16x16x32_bf16 v[60:63], a[176:179], a[40:43], v[60:63]
ds_read_b128 a[216:219], v41 offset:50688
s_waitcnt vmcnt(12) lgkmcnt(5)
v_mfma_f32_16x16x32_bf16 v[44:47], a[180:183], a[0:3], v[44:47]
ds_read_b128 a[160:163], v38 offset:0
s_add_u32 s60, s60, 4096
buffer_load_dwordx4 a[40:43], v1, s[8:11], s60 offen offset:0 sc1
v_mfma_f32_16x16x32_bf16 v[48:51], a[184:187], a[0:3], v[48:51]
ds_read_b128 a[164:167], v38 offset:1024
v_mfma_f32_16x16x32_bf16 v[52:55], a[188:191], a[0:3], v[52:55]
ds_read_b128 a[168:171], v38 offset:2048
v_mfma_f32_16x16x32_bf16 v[56:59], a[192:195], a[0:3], v[56:59]
ds_read_b128 a[172:175], v38 offset:3072
v_mfma_f32_16x16x32_bf16 v[60:63], a[196:199], a[0:3], v[60:63]
ds_read_b128 a[176:179], v42 offset:0
s_waitcnt vmcnt(12) lgkmcnt(5)
v_mfma_f32_16x16x32_bf16 v[44:47], a[200:203], a[4:7], v[44:47]
ds_read_b128 a[180:183], v38 offset:4608
buffer_load_dwordx4 a[0:3], v1, s[8:11], s60 offen offset:1024 sc1
v_mfma_f32_16x16x32_bf16 v[48:51], a[204:207], a[4:7], v[48:51]
ds_read_b128 a[184:187], v38 offset:5632
v_mfma_f32_16x16x32_bf16 v[52:55], a[208:211], a[4:7], v[52:55]
ds_read_b128 a[188:191], v38 offset:6656
v_mfma_f32_16x16x32_bf16 v[56:59], a[212:215], a[4:7], v[56:59]
ds_read_b128 a[192:195], v38 offset:7680
v_mfma_f32_16x16x32_bf16 v[60:63], a[216:219], a[4:7], v[60:63]
ds_read_b128 a[196:199], v42 offset:4608
s_waitcnt vmcnt(12) lgkmcnt(5)
v_mfma_f32_16x16x32_bf16 v[44:47], a[160:163], a[8:11], v[44:47]
ds_read_b128 a[200:203], v38 offset:9216
buffer_load_dwordx4 a[4:7], v1, s[8:11], s60 offen offset:2048 sc1
v_mfma_f32_16x16x32_bf16 v[48:51], a[164:167], a[8:11], v[48:51]
ds_read_b128 a[204:207], v38 offset:10240
v_mfma_f32_16x16x32_bf16 v[52:55], a[168:171], a[8:11], v[52:55]
ds_read_b128 a[208:211], v38 offset:11264
v_mfma_f32_16x16x32_bf16 v[56:59], a[172:175], a[8:11], v[56:59]
ds_read_b128 a[212:215], v38 offset:12288
v_mfma_f32_16x16x32_bf16 v[60:63], a[176:179], a[8:11], v[60:63]
ds_read_b128 a[216:219], v42 offset:9216
s_waitcnt vmcnt(12) lgkmcnt(5)
v_mfma_f32_16x16x32_bf16 v[44:47], a[180:183], a[12:15], v[44:47]
ds_read_b128 a[160:163], v38 offset:13824
buffer_load_dwordx4 a[8:11], v1, s[8:11], s60 offen offset:3072 sc1
v_mfma_f32_16x16x32_bf16 v[48:51], a[184:187], a[12:15], v[48:51]
ds_read_b128 a[164:167], v38 offset:14848
v_mfma_f32_16x16x32_bf16 v[52:55], a[188:191], a[12:15], v[52:55]
ds_read_b128 a[168:171], v38 offset:15872
v_mfma_f32_16x16x32_bf16 v[56:59], a[192:195], a[12:15], v[56:59]
ds_read_b128 a[172:175], v38 offset:16896
v_mfma_f32_16x16x32_bf16 v[60:63], a[196:199], a[12:15], v[60:63]
ds_read_b128 a[176:179], v42 offset:13824
s_waitcnt vmcnt(12) lgkmcnt(5)
v_mfma_f32_16x16x32_bf16 v[44:47], a[200:203], a[16:19], v[44:47]
ds_read_b128 a[180:183], v38 offset:18432
s_mov_b32 s60, s61
buffer_load_dwordx4 a[12:15], v1, s[8:11], s60 offen offset:0 sc1
v_mfma_f32_16x16x32_bf16 v[48:51], a[204:207], a[16:19], v[48:51]
ds_read_b128 a[184:187], v38 offset:19456
v_mfma_f32_16x16x32_bf16 v[52:55], a[208:211], a[16:19], v[52:55]
ds_read_b128 a[188:191], v38 offset:20480
v_mfma_f32_16x16x32_bf16 v[56:59], a[212:215], a[16:19], v[56:59]
ds_read_b128 a[192:195], v38 offset:21504
v_mfma_f32_16x16x32_bf16 v[60:63], a[216:219], a[16:19], v[60:63]
ds_read_b128 a[196:199], v42 offset:18432
s_waitcnt vmcnt(11) lgkmcnt(5)
v_mfma_f32_16x16x32_bf16 v[44:47], a[160:163], a[20:23], v[44:47]
ds_read_b128 a[200:203], v38 offset:23040
buffer_load_dwordx4 a[16:19], v1, s[8:11], s60 offen offset:1024 sc1
v_mfma_f32_16x16x32_bf16 v[48:51], a[164:167], a[20:23], v[48:51]
ds_read_b128 a[204:207], v38 offset:24064
v_mfma_f32_16x16x32_bf16 v[52:55], a[168:171], a[20:23], v[52:55]
ds_read_b128 a[208:211], v38 offset:25088
v_mfma_f32_16x16x32_bf16 v[56:59], a[172:175], a[20:23], v[56:59]
ds_read_b128 a[212:215], v38 offset:26112
v_mfma_f32_16x16x32_bf16 v[60:63], a[176:179], a[20:23], v[60:63]
ds_read_b128 a[216:219], v42 offset:23040
s_waitcnt vmcnt(11) lgkmcnt(5)
v_mfma_f32_16x16x32_bf16 v[44:47], a[180:183], a[24:27], v[44:47]
ds_read_b128 a[160:163], v38 offset:27648
buffer_load_dwordx4 a[20:23], v1, s[8:11], s60 offen offset:2048 sc1
v_mfma_f32_16x16x32_bf16 v[48:51], a[184:187], a[24:27], v[48:51]
ds_read_b128 a[164:167], v38 offset:28672
v_mfma_f32_16x16x32_bf16 v[52:55], a[188:191], a[24:27], v[52:55]
ds_read_b128 a[168:171], v38 offset:29696
v_mfma_f32_16x16x32_bf16 v[56:59], a[192:195], a[24:27], v[56:59]
ds_read_b128 a[172:175], v38 offset:30720
v_mfma_f32_16x16x32_bf16 v[60:63], a[196:199], a[24:27], v[60:63]
ds_read_b128 a[176:179], v42 offset:27648
s_waitcnt vmcnt(10) lgkmcnt(5)
v_mfma_f32_16x16x32_bf16 v[44:47], a[200:203], a[28:31], v[44:47]
ds_read_b128 a[180:183], v38 offset:32256
buffer_load_dwordx4 a[24:27], v1, s[8:11], s60 offen offset:3072 sc1
v_mfma_f32_16x16x32_bf16 v[48:51], a[204:207], a[28:31], v[48:51]
ds_read_b128 a[184:187], v38 offset:33280
v_mfma_f32_16x16x32_bf16 v[52:55], a[208:211], a[28:31], v[52:55]
ds_read_b128 a[188:191], v38 offset:34304
v_mfma_f32_16x16x32_bf16 v[56:59], a[212:215], a[28:31], v[56:59]
ds_read_b128 a[192:195], v38 offset:35328
v_mfma_f32_16x16x32_bf16 v[60:63], a[216:219], a[28:31], v[60:63]
ds_read_b128 a[196:199], v42 offset:32256
s_waitcnt vmcnt(10) lgkmcnt(5)
v_mfma_f32_16x16x32_bf16 v[44:47], a[160:163], a[32:35], v[44:47]
ds_read_b128 a[200:203], v38 offset:36864
s_add_u32 s60, s60, 4096
buffer_load_dwordx4 a[28:31], v1, s[8:11], s60 offen offset:0 sc1
v_mfma_f32_16x16x32_bf16 v[48:51], a[164:167], a[32:35], v[48:51]
ds_read_b128 a[204:207], v38 offset:37888
v_mfma_f32_16x16x32_bf16 v[52:55], a[168:171], a[32:35], v[52:55]
ds_read_b128 a[208:211], v38 offset:38912
v_mfma_f32_16x16x32_bf16 v[56:59], a[172:175], a[32:35], v[56:59]
ds_read_b128 a[212:215], v38 offset:39936
v_mfma_f32_16x16x32_bf16 v[60:63], a[176:179], a[32:35], v[60:63]
ds_read_b128 a[216:219], v42 offset:36864
s_waitcnt vmcnt(10) lgkmcnt(5)
v_mfma_f32_16x16x32_bf16 v[44:47], a[180:183], a[36:39], v[44:47]
ds_read_b128 a[160:163], v38 offset:41472
buffer_load_dwordx4 a[32:35], v1, s[8:11], s60 offen offset:1024 sc1
v_mfma_f32_16x16x32_bf16 v[48:51], a[184:187], a[36:39], v[48:51]
ds_read_b128 a[164:167], v38 offset:42496
v_mfma_f32_16x16x32_bf16 v[52:55], a[188:191], a[36:39], v[52:55]
ds_read_b128 a[168:171], v38 offset:43520
v_mfma_f32_16x16x32_bf16 v[56:59], a[192:195], a[36:39], v[56:59]
ds_read_b128 a[172:175], v38 offset:44544
v_mfma_f32_16x16x32_bf16 v[60:63], a[196:199], a[36:39], v[60:63]
ds_read_b128 a[176:179], v42 offset:41472
s_waitcnt vmcnt(9) lgkmcnt(5)
v_mfma_f32_16x16x32_bf16 v[44:47], a[200:203], a[40:43], v[44:47]
ds_read_b128 a[180:183], v38 offset:46080
buffer_load_dwordx4 a[36:39], v1, s[8:11], s60 offen offset:2048 sc1
v_mfma_f32_16x16x32_bf16 v[48:51], a[204:207], a[40:43], v[48:51]
ds_read_b128 a[184:187], v38 offset:47104
v_mfma_f32_16x16x32_bf16 v[52:55], a[208:211], a[40:43], v[52:55]
ds_read_b128 a[188:191], v38 offset:48128
v_mfma_f32_16x16x32_bf16 v[56:59], a[212:215], a[40:43], v[56:59]
ds_read_b128 a[192:195], v38 offset:49152
v_mfma_f32_16x16x32_bf16 v[60:63], a[216:219], a[40:43], v[60:63]
ds_read_b128 a[196:199], v42 offset:46080
s_waitcnt vmcnt(9) lgkmcnt(5)
v_mfma_f32_16x16x32_bf16 v[44:47], a[160:163], a[0:3], v[44:47]
ds_read_b128 a[200:203], v38 offset:50688
buffer_load_dwordx4 a[40:43], v1, s[8:11], s60 offen offset:3072 sc1
v_mfma_f32_16x16x32_bf16 v[48:51], a[164:167], a[0:3], v[48:51]
ds_read_b128 a[204:207], v38 offset:51712
v_mfma_f32_16x16x32_bf16 v[52:55], a[168:171], a[0:3], v[52:55]
v_mfma_f32_16x16x32_bf16 v[56:59], a[172:175], a[0:3], v[56:59]
v_mfma_f32_16x16x32_bf16 v[60:63], a[176:179], a[0:3], v[60:63]
s_waitcnt vmcnt(9) lgkmcnt(2)
v_mfma_f32_16x16x32_bf16 v[44:47], a[180:183], a[4:7], v[44:47]
ds_read_b128 a[160:163], v36 offset:0
s_add_u32 s60, s60, 4096
buffer_load_dwordx4 a[0:3], v1, s[8:11], s60 offen offset:0 sc1
v_mfma_f32_16x16x32_bf16 v[48:51], a[184:187], a[4:7], v[48:51]
ds_read_b128 a[164:167], v36 offset:1024
v_mfma_f32_16x16x32_bf16 v[52:55], a[188:191], a[4:7], v[52:55]
ds_read_b128 a[168:171], v36 offset:2048
v_mfma_f32_16x16x32_bf16 v[56:59], a[192:195], a[4:7], v[56:59]
ds_read_b128 a[172:175], v36 offset:3072
v_mfma_f32_16x16x32_bf16 v[60:63], a[196:199], a[4:7], v[60:63]
ds_read_b128 a[176:179], v40 offset:0
s_waitcnt vmcnt(9) lgkmcnt(5)
v_mfma_f32_16x16x32_bf16 v[44:47], a[200:203], a[8:11], v[44:47]
ds_read_b128 a[180:183], v36 offset:4608
buffer_load_dwordx4 a[4:7], v1, s[8:11], s60 offen offset:1024 sc1
v_mfma_f32_16x16x32_bf16 v[48:51], a[204:207], a[8:11], v[48:51]
ds_read_b128 a[184:187], v36 offset:5632
v_mfma_f32_16x16x32_bf16 v[52:55], a[228:231], a[8:11], v[52:55]
ds_read_b128 a[188:191], v36 offset:6656
v_mfma_f32_16x16x32_bf16 v[56:59], a[232:235], a[8:11], v[56:59]
ds_read_b128 a[192:195], v36 offset:7680
v_mfma_f32_16x16x32_bf16 v[60:63], a[236:239], a[8:11], v[60:63]
ds_read_b128 a[196:199], v40 offset:4608
s_waitcnt vmcnt(9) lgkmcnt(5)
v_mfma_f32_16x16x32_bf16 v[16:19], a[160:163], a[12:15], v[16:19]
ds_read_b128 a[200:203], v36 offset:9216
buffer_load_dwordx4 a[8:11], v1, s[8:11], s60 offen offset:2048 sc1
v_mfma_f32_16x16x32_bf16 v[20:23], a[164:167], a[12:15], v[20:23]
ds_read_b128 a[204:207], v36 offset:10240
v_mfma_f32_16x16x32_bf16 v[24:27], a[168:171], a[12:15], v[24:27]
ds_read_b128 a[208:211], v36 offset:11264
v_mfma_f32_16x16x32_bf16 v[28:31], a[172:175], a[12:15], v[28:31]
ds_read_b128 a[212:215], v36 offset:12288
v_mfma_f32_16x16x32_bf16 v[32:35], a[176:179], a[12:15], v[32:35]
ds_read_b128 a[216:219], v40 offset:9216
s_waitcnt vmcnt(9) lgkmcnt(5)
v_mfma_f32_16x16x32_bf16 v[16:19], a[180:183], a[16:19], v[16:19]
ds_read_b128 a[160:163], v36 offset:13824
buffer_load_dwordx4 a[12:15], v1, s[8:11], s60 offen offset:3072 sc1
v_mfma_f32_16x16x32_bf16 v[20:23], a[184:187], a[16:19], v[20:23]
ds_read_b128 a[164:167], v36 offset:14848
v_mfma_f32_16x16x32_bf16 v[24:27], a[188:191], a[16:19], v[24:27]
ds_read_b128 a[168:171], v36 offset:15872
v_mfma_f32_16x16x32_bf16 v[28:31], a[192:195], a[16:19], v[28:31]
ds_read_b128 a[172:175], v36 offset:16896
v_cvt_pk_bf16_f32 v64, v44, v45
v_mfma_f32_16x16x32_bf16 v[32:35], a[196:199], a[16:19], v[32:35]
ds_read_b128 a[176:179], v40 offset:13824
s_waitcnt vmcnt(9) lgkmcnt(5)
v_mfma_f32_16x16x32_bf16 v[16:19], a[200:203], a[20:23], v[16:19]
ds_read_b128 a[180:183], v36 offset:18432
s_add_u32 s60, s60, 4096
buffer_load_dwordx4 a[16:19], v1, s[8:11], s60 offen offset:0 sc1
v_mfma_f32_16x16x32_bf16 v[20:23], a[204:207], a[20:23], v[20:23]
ds_read_b128 a[184:187], v36 offset:19456
v_cvt_pk_bf16_f32 v65, v46, v47
v_mfma_f32_16x16x32_bf16 v[24:27], a[208:211], a[20:23], v[24:27]
ds_read_b128 a[188:191], v36 offset:20480
v_mfma_f32_16x16x32_bf16 v[28:31], a[212:215], a[20:23], v[28:31]
ds_read_b128 a[192:195], v36 offset:21504
v_mfma_f32_16x16x32_bf16 v[32:35], a[216:219], a[20:23], v[32:35]
ds_read_b128 a[196:199], v40 offset:18432
s_waitcnt vmcnt(9) lgkmcnt(5)
v_mfma_f32_16x16x32_bf16 v[16:19], a[160:163], a[24:27], v[16:19]
ds_read_b128 a[200:203], v36 offset:23040
buffer_load_dwordx4 a[20:23], v1, s[8:11], s60 offen offset:1024 sc1
v_mfma_f32_16x16x32_bf16 v[20:23], a[164:167], a[24:27], v[20:23]
ds_read_b128 a[204:207], v36 offset:24064
v_cvt_pk_bf16_f32 v66, v48, v49
v_mfma_f32_16x16x32_bf16 v[24:27], a[168:171], a[24:27], v[24:27]
ds_read_b128 a[208:211], v36 offset:25088
buffer_store_dwordx4 v[64:67], v1, s[8:11], s62 offen offset:0 sc1
v_mfma_f32_16x16x32_bf16 v[28:31], a[172:175], a[24:27], v[28:31]
ds_read_b128 a[212:215], v36 offset:26112
v_mfma_f32_16x16x32_bf16 v[32:35], a[176:179], a[24:27], v[32:35]
ds_read_b128 a[216:219], v40 offset:23040
s_waitcnt vmcnt(10) lgkmcnt(5)
v_mfma_f32_16x16x32_bf16 v[16:19], a[180:183], a[28:31], v[16:19]
ds_read_b128 a[160:163], v36 offset:27648
buffer_load_dwordx4 a[24:27], v1, s[8:11], s60 offen offset:2048 sc1
v_mfma_f32_16x16x32_bf16 v[20:23], a[184:187], a[28:31], v[20:23]
ds_read_b128 a[164:167], v36 offset:28672
v_cvt_pk_bf16_f32 v68, v50, v51
v_mfma_f32_16x16x32_bf16 v[24:27], a[188:191], a[28:31], v[24:27]
ds_read_b128 a[168:171], v36 offset:29696
v_mfma_f32_16x16x32_bf16 v[28:31], a[192:195], a[28:31], v[28:31]
ds_read_b128 a[172:175], v36 offset:30720
v_cvt_pk_bf16_f32 v69, v52, v53
v_mfma_f32_16x16x32_bf16 v[32:35], a[196:199], a[28:31], v[32:35]
ds_read_b128 a[176:179], v40 offset:27648
s_waitcnt vmcnt(10) lgkmcnt(5)
v_mfma_f32_16x16x32_bf16 v[16:19], a[200:203], a[32:35], v[16:19]
ds_read_b128 a[180:183], v36 offset:32256
buffer_load_dwordx4 a[28:31], v1, s[8:11], s60 offen offset:3072 sc1
v_mfma_f32_16x16x32_bf16 v[20:23], a[204:207], a[32:35], v[20:23]
ds_read_b128 a[184:187], v36 offset:33280
v_cvt_pk_bf16_f32 v70, v54, v55
v_mfma_f32_16x16x32_bf16 v[24:27], a[208:211], a[32:35], v[24:27]
ds_read_b128 a[188:191], v36 offset:34304
v_mfma_f32_16x16x32_bf16 v[28:31], a[212:215], a[32:35], v[28:31]
ds_read_b128 a[192:195], v36 offset:35328
v_mfma_f32_16x16x32_bf16 v[32:35], a[216:219], a[32:35], v[32:35]
ds_read_b128 a[196:199], v40 offset:32256
s_waitcnt vmcnt(10) lgkmcnt(5)
v_mfma_f32_16x16x32_bf16 v[16:19], a[160:163], a[36:39], v[16:19]
ds_read_b128 a[200:203], v36 offset:36864
s_add_u32 s60, s60, 4096
buffer_load_dwordx4 a[32:35], v1, s[8:11], s60 offen offset:0 sc1
v_mfma_f32_16x16x32_bf16 v[20:23], a[164:167], a[36:39], v[20:23]
ds_read_b128 a[204:207], v36 offset:37888
buffer_store_dwordx4 v[68:71], v1, s[8:11], s62 offen offset:1024 sc1
v_mfma_f32_16x16x32_bf16 v[24:27], a[168:171], a[36:39], v[24:27]
ds_read_b128 a[208:211], v36 offset:38912
v_cvt_pk_bf16_f32 v72, v56, v57
v_mfma_f32_16x16x32_bf16 v[28:31], a[172:175], a[36:39], v[28:31]
ds_read_b128 a[212:215], v36 offset:39936
v_mfma_f32_16x16x32_bf16 v[32:35], a[176:179], a[36:39], v[32:35]
ds_read_b128 a[216:219], v40 offset:36864
s_waitcnt vmcnt(11) lgkmcnt(5)
v_mfma_f32_16x16x32_bf16 v[16:19], a[180:183], a[40:43], v[16:19]
ds_read_b128 a[160:163], v36 offset:41472
buffer_load_dwordx4 a[36:39], v1, s[8:11], s60 offen offset:1024 sc1
v_mfma_f32_16x16x32_bf16 v[20:23], a[184:187], a[40:43], v[20:23]
ds_read_b128 a[164:167], v36 offset:42496
v_cvt_pk_bf16_f32 v73, v58, v59
v_mfma_f32_16x16x32_bf16 v[24:27], a[188:191], a[40:43], v[24:27]
ds_read_b128 a[168:171], v36 offset:43520
v_mfma_f32_16x16x32_bf16 v[28:31], a[192:195], a[40:43], v[28:31]
ds_read_b128 a[172:175], v36 offset:44544
v_cvt_pk_bf16_f32 v74, v60, v61
v_mfma_f32_16x16x32_bf16 v[32:35], a[196:199], a[40:43], v[32:35]
ds_read_b128 a[176:179], v40 offset:41472
s_waitcnt vmcnt(11) lgkmcnt(5)
v_mfma_f32_16x16x32_bf16 v[16:19], a[200:203], a[0:3], v[16:19]
ds_read_b128 a[180:183], v36 offset:46080
buffer_load_dwordx4 a[40:43], v1, s[8:11], s60 offen offset:2048 sc1
v_mfma_f32_16x16x32_bf16 v[20:23], a[204:207], a[0:3], v[20:23]
ds_read_b128 a[184:187], v36 offset:47104
buffer_store_dwordx4 v[72:75], v1, s[8:11], s62 offen offset:2048 sc1
v_mfma_f32_16x16x32_bf16 v[24:27], a[208:211], a[0:3], v[24:27]
ds_read_b128 a[188:191], v36 offset:48128
v_mfma_f32_16x16x32_bf16 v[28:31], a[212:215], a[0:3], v[28:31]
ds_read_b128 a[192:195], v36 offset:49152
v_mfma_f32_16x16x32_bf16 v[32:35], a[216:219], a[0:3], v[32:35]
ds_read_b128 a[196:199], v40 offset:46080
s_waitcnt vmcnt(12) lgkmcnt(5)
v_mfma_f32_16x16x32_bf16 v[16:19], a[160:163], a[4:7], v[16:19]
ds_read_b128 a[200:203], v36 offset:50688
buffer_load_dwordx4 a[0:3], v1, s[8:11], s60 offen offset:3072 sc1
v_mfma_f32_16x16x32_bf16 v[20:23], a[164:167], a[4:7], v[20:23]
ds_read_b128 a[204:207], v36 offset:51712
v_cvt_pk_bf16_f32 v76, v62, v63
v_mfma_f32_16x16x32_bf16 v[24:27], a[168:171], a[4:7], v[24:27]
ds_read_b128 a[208:211], v36 offset:52736
buffer_store_dwordx4 v[76:79], v1, s[8:11], s62 offen offset:3072 sc1
v_mfma_f32_16x16x32_bf16 v[28:31], a[172:175], a[4:7], v[28:31]
ds_read_b128 a[212:215], v36 offset:53760
v_mfma_f32_16x16x32_bf16 v[32:35], a[176:179], a[4:7], v[32:35]
ds_read_b128 a[216:219], v40 offset:50688
s_waitcnt vmcnt(13) lgkmcnt(5)
v_mfma_f32_16x16x32_bf16 v[16:19], a[180:183], a[8:11], v[16:19]
ds_read_b128 a[160:163], v37 offset:0
s_add_u32 s60, s60, 4096
buffer_load_dwordx4 a[4:7], v1, s[8:11], s60 offen offset:0 sc1
v_mfma_f32_16x16x32_bf16 v[20:23], a[184:187], a[8:11], v[20:23]
ds_read_b128 a[164:167], v37 offset:1024
v_mfma_f32_16x16x32_bf16 v[24:27], a[188:191], a[8:11], v[24:27]
ds_read_b128 a[168:171], v37 offset:2048
v_mfma_f32_16x16x32_bf16 v[28:31], a[192:195], a[8:11], v[28:31]
ds_read_b128 a[172:175], v37 offset:3072
v_mfma_f32_16x16x32_bf16 v[32:35], a[196:199], a[8:11], v[32:35]
ds_read_b128 a[176:179], v41 offset:0
s_waitcnt vmcnt(13) lgkmcnt(5)
v_mfma_f32_16x16x32_bf16 v[16:19], a[200:203], a[12:15], v[16:19]
ds_read_b128 a[180:183], v37 offset:4608
buffer_load_dwordx4 a[8:11], v1, s[8:11], s60 offen offset:1024 sc1
v_mfma_f32_16x16x32_bf16 v[20:23], a[204:207], a[12:15], v[20:23]
ds_read_b128 a[184:187], v37 offset:5632
v_mfma_f32_16x16x32_bf16 v[24:27], a[208:211], a[12:15], v[24:27]
ds_read_b128 a[188:191], v37 offset:6656
v_mfma_f32_16x16x32_bf16 v[28:31], a[212:215], a[12:15], v[28:31]
ds_read_b128 a[192:195], v37 offset:7680
v_mfma_f32_16x16x32_bf16 v[32:35], a[216:219], a[12:15], v[32:35]
ds_read_b128 a[196:199], v41 offset:4608
s_waitcnt vmcnt(13) lgkmcnt(5)
v_mfma_f32_16x16x32_bf16 v[16:19], a[160:163], a[16:19], v[16:19]
ds_read_b128 a[200:203], v37 offset:9216
buffer_load_dwordx4 a[12:15], v1, s[8:11], s60 offen offset:2048 sc1
v_mfma_f32_16x16x32_bf16 v[20:23], a[164:167], a[16:19], v[20:23]
ds_read_b128 a[204:207], v37 offset:10240
v_mfma_f32_16x16x32_bf16 v[24:27], a[168:171], a[16:19], v[24:27]
ds_read_b128 a[208:211], v37 offset:11264
v_mfma_f32_16x16x32_bf16 v[28:31], a[172:175], a[16:19], v[28:31]
ds_read_b128 a[212:215], v37 offset:12288
v_mfma_f32_16x16x32_bf16 v[32:35], a[176:179], a[16:19], v[32:35]
ds_read_b128 a[216:219], v41 offset:9216
s_waitcnt vmcnt(13) lgkmcnt(5)
v_mfma_f32_16x16x32_bf16 v[16:19], a[180:183], a[20:23], v[16:19]
ds_read_b128 a[160:163], v37 offset:13824
buffer_load_dwordx4 a[16:19], v1, s[8:11], s60 offen offset:3072 sc1
v_mfma_f32_16x16x32_bf16 v[20:23], a[184:187], a[20:23], v[20:23]
ds_read_b128 a[164:167], v37 offset:14848
v_mfma_f32_16x16x32_bf16 v[24:27], a[188:191], a[20:23], v[24:27]
ds_read_b128 a[168:171], v37 offset:15872
v_mfma_f32_16x16x32_bf16 v[28:31], a[192:195], a[20:23], v[28:31]
ds_read_b128 a[172:175], v37 offset:16896
v_mfma_f32_16x16x32_bf16 v[32:35], a[196:199], a[20:23], v[32:35]
ds_read_b128 a[176:179], v41 offset:13824
s_waitcnt vmcnt(12) lgkmcnt(5)
v_mfma_f32_16x16x32_bf16 v[16:19], a[200:203], a[24:27], v[16:19]
ds_read_b128 a[180:183], v37 offset:18432
s_add_u32 s60, s60, 4096
buffer_load_dwordx4 a[20:23], v1, s[8:11], s60 offen offset:0 sc1
v_mfma_f32_16x16x32_bf16 v[20:23], a[204:207], a[24:27], v[20:23]
ds_read_b128 a[184:187], v37 offset:19456
v_mfma_f32_16x16x32_bf16 v[24:27], a[208:211], a[24:27], v[24:27]
ds_read_b128 a[188:191], v37 offset:20480
v_mfma_f32_16x16x32_bf16 v[28:31], a[212:215], a[24:27], v[28:31]
ds_read_b128 a[192:195], v37 offset:21504
v_mfma_f32_16x16x32_bf16 v[32:35], a[216:219], a[24:27], v[32:35]
ds_read_b128 a[196:199], v41 offset:18432
s_waitcnt vmcnt(12) lgkmcnt(5)
v_mfma_f32_16x16x32_bf16 v[16:19], a[160:163], a[28:31], v[16:19]
ds_read_b128 a[200:203], v37 offset:23040
buffer_load_dwordx4 a[24:27], v1, s[8:11], s60 offen offset:1024 sc1
v_mfma_f32_16x16x32_bf16 v[20:23], a[164:167], a[28:31], v[20:23]
ds_read_b128 a[204:207], v37 offset:24064
v_mfma_f32_16x16x32_bf16 v[24:27], a[168:171], a[28:31], v[24:27]
ds_read_b128 a[208:211], v37 offset:25088
v_mfma_f32_16x16x32_bf16 v[28:31], a[172:175], a[28:31], v[28:31]
ds_read_b128 a[212:215], v37 offset:26112
v_mfma_f32_16x16x32_bf16 v[32:35], a[176:179], a[28:31], v[32:35]
ds_read_b128 a[216:219], v41 offset:23040
s_waitcnt vmcnt(12) lgkmcnt(5)
v_mfma_f32_16x16x32_bf16 v[16:19], a[180:183], a[32:35], v[16:19]
ds_read_b128 a[160:163], v37 offset:27648
buffer_load_dwordx4 a[28:31], v1, s[8:11], s60 offen offset:2048 sc1
v_mfma_f32_16x16x32_bf16 v[20:23], a[184:187], a[32:35], v[20:23]
ds_read_b128 a[164:167], v37 offset:28672
v_mfma_f32_16x16x32_bf16 v[24:27], a[188:191], a[32:35], v[24:27]
ds_read_b128 a[168:171], v37 offset:29696
v_mfma_f32_16x16x32_bf16 v[28:31], a[192:195], a[32:35], v[28:31]
ds_read_b128 a[172:175], v37 offset:30720
v_mfma_f32_16x16x32_bf16 v[32:35], a[196:199], a[32:35], v[32:35]
ds_read_b128 a[176:179], v41 offset:27648
s_waitcnt vmcnt(11) lgkmcnt(5)
v_mfma_f32_16x16x32_bf16 v[16:19], a[200:203], a[36:39], v[16:19]
ds_read_b128 a[180:183], v37 offset:32256
buffer_load_dwordx4 a[32:35], v1, s[8:11], s60 offen offset:3072 sc1
v_mfma_f32_16x16x32_bf16 v[20:23], a[204:207], a[36:39], v[20:23]
ds_read_b128 a[184:187], v37 offset:33280
v_mfma_f32_16x16x32_bf16 v[24:27], a[208:211], a[36:39], v[24:27]
ds_read_b128 a[188:191], v37 offset:34304
v_mfma_f32_16x16x32_bf16 v[28:31], a[212:215], a[36:39], v[28:31]
ds_read_b128 a[192:195], v37 offset:35328
v_mfma_f32_16x16x32_bf16 v[32:35], a[216:219], a[36:39], v[32:35]
ds_read_b128 a[196:199], v41 offset:32256
s_waitcnt vmcnt(11) lgkmcnt(5)
v_mfma_f32_16x16x32_bf16 v[16:19], a[160:163], a[40:43], v[16:19]
ds_read_b128 a[200:203], v37 offset:36864
s_add_u32 s60, s60, 4096
buffer_load_dwordx4 a[36:39], v1, s[8:11], s60 offen offset:0 sc1
v_mfma_f32_16x16x32_bf16 v[20:23], a[164:167], a[40:43], v[20:23]
ds_read_b128 a[204:207], v37 offset:37888
v_mfma_f32_16x16x32_bf16 v[24:27], a[168:171], a[40:43], v[24:27]
ds_read_b128 a[208:211], v37 offset:38912
v_mfma_f32_16x16x32_bf16 v[28:31], a[172:175], a[40:43], v[28:31]
ds_read_b128 a[212:215], v37 offset:39936
v_mfma_f32_16x16x32_bf16 v[32:35], a[176:179], a[40:43], v[32:35]
ds_read_b128 a[216:219], v41 offset:36864
s_waitcnt vmcnt(10) lgkmcnt(5)
v_mfma_f32_16x16x32_bf16 v[16:19], a[180:183], a[0:3], v[16:19]
ds_read_b128 a[160:163], v37 offset:41472
buffer_load_dwordx4 a[40:43], v1, s[8:11], s60 offen offset:1024 sc1
v_mfma_f32_16x16x32_bf16 v[20:23], a[184:187], a[0:3], v[20:23]
ds_read_b128 a[164:167], v37 offset:42496
v_mfma_f32_16x16x32_bf16 v[24:27], a[188:191], a[0:3], v[24:27]
ds_read_b128 a[168:171], v37 offset:43520
v_mfma_f32_16x16x32_bf16 v[28:31], a[192:195], a[0:3], v[28:31]
ds_read_b128 a[172:175], v37 offset:44544
v_mfma_f32_16x16x32_bf16 v[32:35], a[196:199], a[0:3], v[32:35]
ds_read_b128 a[176:179], v41 offset:41472
s_waitcnt vmcnt(9) lgkmcnt(5)
v_mfma_f32_16x16x32_bf16 v[16:19], a[200:203], a[4:7], v[16:19]
ds_read_b128 a[180:183], v37 offset:46080
buffer_load_dwordx4 a[0:3], v1, s[8:11], s60 offen offset:2048 sc1
v_mfma_f32_16x16x32_bf16 v[20:23], a[204:207], a[4:7], v[20:23]
ds_read_b128 a[184:187], v37 offset:47104
v_mfma_f32_16x16x32_bf16 v[24:27], a[208:211], a[4:7], v[24:27]
ds_read_b128 a[188:191], v37 offset:48128
v_mfma_f32_16x16x32_bf16 v[28:31], a[212:215], a[4:7], v[28:31]
ds_read_b128 a[192:195], v37 offset:49152
v_mfma_f32_16x16x32_bf16 v[32:35], a[216:219], a[4:7], v[32:35]
ds_read_b128 a[196:199], v41 offset:46080
s_waitcnt vmcnt(9) lgkmcnt(5)
v_mfma_f32_16x16x32_bf16 v[16:19], a[160:163], a[8:11], v[16:19]
ds_read_b128 a[200:203], v37 offset:50688
buffer_load_dwordx4 a[4:7], v1, s[8:11], s60 offen offset:3072 sc1
v_mfma_f32_16x16x32_bf16 v[20:23], a[164:167], a[8:11], v[20:23]
ds_read_b128 a[204:207], v37 offset:51712
v_mfma_f32_16x16x32_bf16 v[24:27], a[168:171], a[8:11], v[24:27]
ds_read_b128 a[208:211], v37 offset:52736
v_mfma_f32_16x16x32_bf16 v[28:31], a[172:175], a[8:11], v[28:31]
ds_read_b128 a[212:215], v37 offset:53760
v_mfma_f32_16x16x32_bf16 v[32:35], a[176:179], a[8:11], v[32:35]
ds_read_b128 a[216:219], v41 offset:50688
s_waitcnt vmcnt(9) lgkmcnt(5)
v_mfma_f32_16x16x32_bf16 v[16:19], a[180:183], a[12:15], v[16:19]
ds_read_b128 a[160:163], v38 offset:0
s_add_u32 s60, s60, 4096
buffer_load_dwordx4 a[8:11], v1, s[8:11], s60 offen offset:0 sc1
v_mfma_f32_16x16x32_bf16 v[20:23], a[184:187], a[12:15], v[20:23]
ds_read_b128 a[164:167], v38 offset:1024
v_mfma_f32_16x16x32_bf16 v[24:27], a[188:191], a[12:15], v[24:27]
ds_read_b128 a[168:171], v38 offset:2048
v_mfma_f32_16x16x32_bf16 v[28:31], a[192:195], a[12:15], v[28:31]
ds_read_b128 a[172:175], v38 offset:3072
v_mfma_f32_16x16x32_bf16 v[32:35], a[196:199], a[12:15], v[32:35]
ds_read_b128 a[176:179], v42 offset:0
s_waitcnt vmcnt(9) lgkmcnt(5)
v_mfma_f32_16x16x32_bf16 v[16:19], a[200:203], a[16:19], v[16:19]
ds_read_b128 a[180:183], v38 offset:4608
buffer_load_dwordx4 a[12:15], v1, s[8:11], s60 offen offset:1024 sc1
v_mfma_f32_16x16x32_bf16 v[20:23], a[204:207], a[16:19], v[20:23]
ds_read_b128 a[184:187], v38 offset:5632
v_mfma_f32_16x16x32_bf16 v[24:27], a[208:211], a[16:19], v[24:27]
ds_read_b128 a[188:191], v38 offset:6656
v_mfma_f32_16x16x32_bf16 v[28:31], a[212:215], a[16:19], v[28:31]
ds_read_b128 a[192:195], v38 offset:7680
v_mfma_f32_16x16x32_bf16 v[32:35], a[216:219], a[16:19], v[32:35]
ds_read_b128 a[196:199], v42 offset:4608
s_waitcnt vmcnt(9) lgkmcnt(5)
v_mfma_f32_16x16x32_bf16 v[16:19], a[160:163], a[20:23], v[16:19]
ds_read_b128 a[200:203], v38 offset:9216
buffer_load_dwordx4 a[16:19], v1, s[8:11], s60 offen offset:2048 sc1
v_mfma_f32_16x16x32_bf16 v[20:23], a[164:167], a[20:23], v[20:23]
ds_read_b128 a[204:207], v38 offset:10240
v_mfma_f32_16x16x32_bf16 v[24:27], a[168:171], a[20:23], v[24:27]
ds_read_b128 a[208:211], v38 offset:11264
v_mfma_f32_16x16x32_bf16 v[28:31], a[172:175], a[20:23], v[28:31]
ds_read_b128 a[212:215], v38 offset:12288
v_mfma_f32_16x16x32_bf16 v[32:35], a[176:179], a[20:23], v[32:35]
ds_read_b128 a[216:219], v42 offset:9216
s_waitcnt vmcnt(9) lgkmcnt(5)
v_mfma_f32_16x16x32_bf16 v[16:19], a[180:183], a[24:27], v[16:19]
ds_read_b128 a[160:163], v38 offset:13824
buffer_load_dwordx4 a[20:23], v1, s[8:11], s60 offen offset:3072 sc1
v_mfma_f32_16x16x32_bf16 v[20:23], a[184:187], a[24:27], v[20:23]
ds_read_b128 a[164:167], v38 offset:14848
v_mfma_f32_16x16x32_bf16 v[24:27], a[188:191], a[24:27], v[24:27]
ds_read_b128 a[168:171], v38 offset:15872
v_mfma_f32_16x16x32_bf16 v[28:31], a[192:195], a[24:27], v[28:31]
ds_read_b128 a[172:175], v38 offset:16896
v_mfma_f32_16x16x32_bf16 v[32:35], a[196:199], a[24:27], v[32:35]
ds_read_b128 a[176:179], v42 offset:13824
s_waitcnt vmcnt(9) lgkmcnt(5)
v_mfma_f32_16x16x32_bf16 v[16:19], a[200:203], a[28:31], v[16:19]
ds_read_b128 a[180:183], v38 offset:18432
buffer_load_dwordx4 v[80:83], v1, s[8:11], s63 offen offset:0 sc1
v_mfma_f32_16x16x32_bf16 v[20:23], a[204:207], a[28:31], v[20:23]
ds_read_b128 a[184:187], v38 offset:19456
v_mfma_f32_16x16x32_bf16 v[24:27], a[208:211], a[28:31], v[24:27]
ds_read_b128 a[188:191], v38 offset:20480
v_mfma_f32_16x16x32_bf16 v[28:31], a[212:215], a[28:31], v[28:31]
ds_read_b128 a[192:195], v38 offset:21504
v_mfma_f32_16x16x32_bf16 v[32:35], a[216:219], a[28:31], v[32:35]
ds_read_b128 a[196:199], v42 offset:18432
s_waitcnt vmcnt(9) lgkmcnt(5)
v_mfma_f32_16x16x32_bf16 v[16:19], a[160:163], a[32:35], v[16:19]
ds_read_b128 a[200:203], v38 offset:23040
buffer_load_dwordx4 v[84:87], v1, s[8:11], s63 offen offset:1024 sc1
v_mfma_f32_16x16x32_bf16 v[20:23], a[164:167], a[32:35], v[20:23]
ds_read_b128 a[204:207], v38 offset:24064
v_mfma_f32_16x16x32_bf16 v[24:27], a[168:171], a[32:35], v[24:27]
ds_read_b128 a[208:211], v38 offset:25088
v_mfma_f32_16x16x32_bf16 v[28:31], a[172:175], a[32:35], v[28:31]
ds_read_b128 a[212:215], v38 offset:26112
v_mfma_f32_16x16x32_bf16 v[32:35], a[176:179], a[32:35], v[32:35]
ds_read_b128 a[216:219], v42 offset:23040
s_waitcnt vmcnt(9) lgkmcnt(5)
v_mfma_f32_16x16x32_bf16 v[16:19], a[180:183], a[36:39], v[16:19]
ds_read_b128 a[160:163], v38 offset:27648
buffer_load_dwordx4 v[88:91], v1, s[8:11], s63 offen offset:2048 sc1
v_mfma_f32_16x16x32_bf16 v[20:23], a[184:187], a[36:39], v[20:23]
ds_read_b128 a[164:167], v38 offset:28672
v_mfma_f32_16x16x32_bf16 v[24:27], a[188:191], a[36:39], v[24:27]
ds_read_b128 a[168:171], v38 offset:29696
v_mfma_f32_16x16x32_bf16 v[28:31], a[192:195], a[36:39], v[28:31]
ds_read_b128 a[172:175], v38 offset:30720
v_mfma_f32_16x16x32_bf16 v[32:35], a[196:199], a[36:39], v[32:35]
ds_read_b128 a[176:179], v42 offset:27648
s_waitcnt vmcnt(9) lgkmcnt(5)
v_mfma_f32_16x16x32_bf16 v[16:19], a[200:203], a[40:43], v[16:19]
ds_read_b128 a[180:183], v38 offset:32256
buffer_load_dwordx4 v[92:95], v1, s[8:11], s63 offen offset:3072 sc1
v_mfma_f32_16x16x32_bf16 v[20:23], a[204:207], a[40:43], v[20:23]
ds_read_b128 a[184:187], v38 offset:33280
v_mfma_f32_16x16x32_bf16 v[24:27], a[208:211], a[40:43], v[24:27]
ds_read_b128 a[188:191], v38 offset:34304
v_mfma_f32_16x16x32_bf16 v[28:31], a[212:215], a[40:43], v[28:31]
ds_read_b128 a[192:195], v38 offset:35328
v_mfma_f32_16x16x32_bf16 v[32:35], a[216:219], a[40:43], v[32:35]
ds_read_b128 a[196:199], v42 offset:32256
s_waitcnt vmcnt(9) lgkmcnt(5)
v_mfma_f32_16x16x32_bf16 v[16:19], a[160:163], a[0:3], v[16:19]
ds_read_b128 a[200:203], v38 offset:36864
v_mfma_f32_16x16x32_bf16 v[20:23], a[164:167], a[0:3], v[20:23]
ds_read_b128 a[204:207], v38 offset:37888
v_mfma_f32_16x16x32_bf16 v[24:27], a[168:171], a[0:3], v[24:27]
ds_read_b128 a[208:211], v38 offset:38912
v_mfma_f32_16x16x32_bf16 v[28:31], a[172:175], a[0:3], v[28:31]
ds_read_b128 a[212:215], v38 offset:39936
v_mfma_f32_16x16x32_bf16 v[32:35], a[176:179], a[0:3], v[32:35]
ds_read_b128 a[216:219], v42 offset:36864
s_waitcnt vmcnt(8) lgkmcnt(5)
v_mfma_f32_16x16x32_bf16 v[16:19], a[180:183], a[4:7], v[16:19]
ds_read_b128 a[160:163], v38 offset:41472
v_mfma_f32_16x16x32_bf16 v[20:23], a[184:187], a[4:7], v[20:23]
ds_read_b128 a[164:167], v38 offset:42496
v_mfma_f32_16x16x32_bf16 v[24:27], a[188:191], a[4:7], v[24:27]
ds_read_b128 a[168:171], v38 offset:43520
v_mfma_f32_16x16x32_bf16 v[28:31], a[192:195], a[4:7], v[28:31]
ds_read_b128 a[172:175], v38 offset:44544
v_mfma_f32_16x16x32_bf16 v[32:35], a[196:199], a[4:7], v[32:35]
ds_read_b128 a[176:179], v42 offset:41472
s_waitcnt vmcnt(7) lgkmcnt(5)
v_mfma_f32_16x16x32_bf16 v[16:19], a[200:203], a[8:11], v[16:19]
ds_read_b128 a[180:183], v38 offset:46080
v_mfma_f32_16x16x32_bf16 v[20:23], a[204:207], a[8:11], v[20:23]
ds_read_b128 a[184:187], v38 offset:47104
v_mfma_f32_16x16x32_bf16 v[24:27], a[208:211], a[8:11], v[24:27]
ds_read_b128 a[188:191], v38 offset:48128
v_mfma_f32_16x16x32_bf16 v[28:31], a[212:215], a[8:11], v[28:31]
ds_read_b128 a[192:195], v38 offset:49152
v_mfma_f32_16x16x32_bf16 v[32:35], a[216:219], a[8:11], v[32:35]
ds_read_b128 a[196:199], v42 offset:46080
s_waitcnt vmcnt(6) lgkmcnt(5)
v_mfma_f32_16x16x32_bf16 v[16:19], a[160:163], a[12:15], v[16:19]
ds_read_b128 a[200:203], v38 offset:50688
v_mfma_f32_16x16x32_bf16 v[20:23], a[164:167], a[12:15], v[20:23]
ds_read_b128 a[204:207], v38 offset:51712
v_mfma_f32_16x16x32_bf16 v[24:27], a[168:171], a[12:15], v[24:27]
v_mfma_f32_16x16x32_bf16 v[28:31], a[172:175], a[12:15], v[28:31]
v_mfma_f32_16x16x32_bf16 v[32:35], a[176:179], a[12:15], v[32:35]
s_waitcnt vmcnt(5) lgkmcnt(2)
v_mfma_f32_16x16x32_bf16 v[16:19], a[180:183], a[16:19], v[16:19]
v_mfma_f32_16x16x32_bf16 v[20:23], a[184:187], a[16:19], v[20:23]
v_mfma_f32_16x16x32_bf16 v[24:27], a[188:191], a[16:19], v[24:27]
v_mfma_f32_16x16x32_bf16 v[28:31], a[192:195], a[16:19], v[28:31]
v_mfma_f32_16x16x32_bf16 v[32:35], a[196:199], a[16:19], v[32:35]
s_waitcnt vmcnt(4) lgkmcnt(0)
v_mfma_f32_16x16x32_bf16 v[16:19], a[200:203], a[20:23], v[16:19]
s_waitcnt vmcnt(0)
v_xor_b32 v118, v248, v83
v_xor_b32 v119, v248, v87
v_xor_b32 v120, v248, v91
v_xor_b32 v121, v248, v95
v_mfma_f32_16x16x32_bf16 v[20:23], a[204:207], a[20:23], v[20:23]
v_or3_b32 v118, v118, v119, v120
v_or_b32 v118, v118, v121
v_cmp_ne_u32 vcc, 0, v118
s_nop 0
s_cbranch_vccnz L_xslow_36
L_xback_37:
v_mfma_f32_16x16x32_bf16 v[24:27], a[228:231], a[20:23], v[24:27]
v_lshlrev_b32 v96, 16, v80
v_and_b32 v97, 0xffff0000, v80
v_lshlrev_b32 v98, 16, v81
v_and_b32 v99, 0xffff0000, v81
v_lshlrev_b32 v100, 16, v82
v_and_b32 v101, 0xffff0000, v82
v_mfma_f32_16x16x32_bf16 v[28:31], a[232:235], a[20:23], v[28:31]
v_lshlrev_b32 v102, 16, v84
v_and_b32 v103, 0xffff0000, v84
v_lshlrev_b32 v104, 16, v85
v_and_b32 v105, 0xffff0000, v85
v_lshlrev_b32 v106, 16, v86
v_and_b32 v107, 0xffff0000, v86
v_mfma_f32_16x16x32_bf16 v[32:35], a[236:239], a[20:23], v[32:35]
v_lshlrev_b32 v108, 16, v88
v_and_b32 v109, 0xffff0000, v88
v_lshlrev_b32 v110, 16, v89
v_and_b32 v111, 0xffff0000, v89
v_lshlrev_b32 v112, 16, v90
v_and_b32 v113, 0xffff0000, v90
v_lshlrev_b32 v114, 16, v92
v_and_b32 v115, 0xffff0000, v92
s_nop 3
v_pk_add_f32 v[16:17], v[16:17], v[96:97]
v_pk_add_f32 v[18:19], v[18:19], v[98:99]
v_pk_add_f32 v[20:21], v[20:21], v[100:101]
v_pk_add_f32 v[22:23], v[22:23], v[102:103]
v_pk_add_f32 v[24:25], v[24:25], v[104:105]
v_pk_add_f32 v[26:27], v[26:27], v[106:107]
v_pk_add_f32 v[28:29], v[28:29], v[108:109]
v_pk_add_f32 v[30:31], v[30:31], v[110:111]
v_pk_add_f32 v[32:33], v[32:33], v[112:113]
v_pk_add_f32 v[34:35], v[34:35], v[114:115]
s_cmp_eq_u32 s29, 1
s_cbranch_scc1 L_last
v_pk_add_f32 v[142:143], v[16:17], v[18:19]
v_pk_mul_f32 v[144:145], v[16:17], v[16:17]
v_pk_fma_f32 v[144:145], v[18:19], v[18:19], v[144:145]
v_pk_add_f32 v[142:143], v[142:143], v[20:21]
v_pk_fma_f32 v[144:145], v[20:21], v[20:21], v[144:145]
v_pk_add_f32 v[142:143], v[142:143], v[22:23]
v_pk_fma_f32 v[144:145], v[22:23], v[22:23], v[144:145]
v_pk_add_f32 v[142:143], v[142:143], v[24:25]
v_pk_fma_f32 v[144:145], v[24:25], v[24:25], v[144:145]
v_pk_add_f32 v[142:143], v[142:143], v[26:27]
v_pk_fma_f32 v[144:145], v[26:27], v[26:27], v[144:145]
v_pk_add_f32 v[142:143], v[142:143], v[28:29]
v_pk_fma_f32 v[144:145], v[28:29], v[28:29], v[144:145]
v_pk_add_f32 v[142:143], v[142:143], v[30:31]
v_pk_fma_f32 v[144:145], v[30:31], v[30:31], v[144:145]
s_mov_b32 exec_hi, 0
v_pk_add_f32 v[142:143], v[142:143], v[32:33]
v_pk_fma_f32 v[144:145], v[32:33], v[32:33], v[144:145]
v_pk_add_f32 v[142:143], v[142:143], v[34:35]
v_pk_fma_f32 v[144:145], v[34:35], v[34:35], v[144:145]
s_mov_b64 exec, -1
v_add_f32 v136, v142, v143
v_add_f32 v137, v144, v145
v_cvt_pk_bf16_f32 v132, v32, v33
v_cvt_pk_bf16_f32 v133, v34, v35
v_permlane32_swap_b32 v136, v137
v_add_f32 v136, v136, v137
v_mov_b32 v137, v136
v_cvt_pk_bf16_f32 v124, v16, v17
v_cvt_pk_bf16_f32 v125, v18, v19
v_permlane16_swap_b32 v136, v137
v_add_f32 v136, v136, v137
v_mov_b32 v137, v136
v_cvt_pk_bf16_f32 v126, v20, v21
v_cvt_pk_bf16_f32 v127, v22, v23
v_permlane32_swap_b32 v136, v137
buffer_store_dwordx4 v[124:127], v140, s[8:11], s66 offen sc1
buffer_store_dwordx2 v[136:137], v138, s[8:11], s67 offen sc1
v_cvt_pk_bf16_f32 v128, v24, v25
v_cvt_pk_bf16_f32 v129, v26, v27
v_cvt_pk_bf16_f32 v130, v28, v29
v_cvt_pk_bf16_f32 v131, v30, v31
v_permlane16_swap_b32 v132, v134
v_permlane16_swap_b32 v133, v135
buffer_store_dwordx4 v[128:131], v140, s[8:11], s66 offen offset:1024 sc1
buffer_store_dwordx4 v[132:135], v141, s[8:11], s66 offen sc1
s_barrier
s_mul_i32 s36, s26, 132608
s_mul_i32 s38, s24, 12288
s_add_u32 m0, s38, 0
s_add_u32 s39, s38, s36
buffer_load_dwordx4 v1, s[4:7], s39 offen offset:0 sc1 lds
buffer_load_dwordx4 v1, s[4:7], s39 offen offset:1024 sc1 lds
buffer_load_dwordx4 v1, s[4:7], s39 offen offset:2048 sc1 lds
buffer_load_dwordx4 v1, s[4:7], s39 offen offset:3072 sc1 lds
s_add_u32 m0, m0, 4096
s_add_u32 s39, s39, 4096
buffer_load_dwordx4 v1, s[4:7], s39 offen offset:0 sc1 lds
buffer_load_dwordx4 v1, s[4:7], s39 offen offset:1024 sc1 lds
buffer_load_dwordx4 v1, s[4:7], s39 offen offset:2048 sc1 lds
buffer_load_dwordx4 v1, s[4:7], s39 offen offset:3072 sc1 lds
s_and_b32 s33, s27, 1
s_cmp_lt_u32 s27, 31
s_cselect_b32 s33, s33, 0
s_cmp_eq_u32 s33, 1
s_cselect_b32 s34, -1, 0xffff
s_mov_b32 s35, 0
v_lshlrev_b32 v7, 3, v1
s_lshr_b32 s31, s81, 4
s_lshl_b32 s31, s31, 11
v_add_u32 v7, s31, v7
s_cmp_eq_u32 s24, 0
s_cselect_b32 s30, 0, 1073741824
s_add_u32 s30, s30, 26607616
s_waitcnt vmcnt(8)
s_barrier
s_mov_b64 exec, s[34:35]
buffer_atomic_add v4, v7, s[8:11], s30 offen sc1
s_mov_b64 exec, -1
s_cmp_eq_u32 s29, 1
s_cbranch_scc1 L_main_fin
s_cmp_eq_u32 s25, 0
s_cselect_b32 s34, 16, 24
s_lshl_b32 s35, s80, 7
s_add_u32 s35, s35, 26607616
s_cmp_eq_u32 s24, 1
s_cselect_b32 s35, s35, 1073741824
v_mov_b32 v6, 0
v_mov_b32 v244, 0
v_mov_b32 v245, 0
v_mov_b32 v246, 0
s_add_u32 m0, m0, 4096
s_add_u32 s39, s39, 4096
buffer_load_dwordx4 v1, s[4:7], s39 offen offset:0 sc1 lds
buffer_load_dwordx4 v1, s[4:7], s39 offen offset:1024 sc1 lds
buffer_load_dwordx4 v1, s[4:7], s39 offen offset:2048 sc1 lds
buffer_load_dwordx4 v1, s[4:7], s39 offen offset:3072 sc1 lds
s_mul_i32 s36, s26, 132608
s_mul_i32 s38, s24, 9216
s_add_u32 m0, s38, 49152
s_add_u32 s39, s38, s36
s_add_u32 s39, s39, 49152
s_mov_b64 exec, 1
buffer_atomic_add v244, v6, s[8:11], s35 offen sc0 sc1
s_mov_b64 exec, -1
buffer_load_dwordx4 v1, s[4:7], s39 offen offset:0 sc1 lds
buffer_load_dwordx4 v1, s[4:7], s39 offen offset:1024 sc1 lds
buffer_load_dwordx4 v1, s[4:7], s39 offen offset:2048 sc1 lds
s_mov_b64 exec, 1
buffer_atomic_add v245, v6, s[8:11], s35 offen sc0 sc1
s_mov_b64 exec, -1
buffer_load_dwordx4 v1, s[4:7], s39 offen offset:3072 sc1 lds
s_add_u32 m0, m0, 4096
s_add_u32 s39, s39, 4096
buffer_load_dwordx4 v1, s[4:7], s39 offen offset:0 sc1 lds
buffer_load_dwordx4 v1, s[4:7], s39 offen offset:1024 sc1 lds
s_mov_b64 exec, 1
buffer_atomic_add v246, v6, s[8:11], s35 offen sc0 sc1
s_mov_b64 exec, -1
buffer_load_dwordx4 v1, s[4:7], s39 offen offset:2048 sc1 lds
buffer_load_dwordx4 v1, s[4:7], s39 offen offset:3072 sc1 lds
s_add_u32 m0, m0, 4096
s_add_u32 s39, s39, 4096
buffer_load_dwordx4 v1, s[4:7], s39 offen offset:0 sc1 lds
s_lshl_b32 s60, s25, 3
s_sub_u32 s61, s60, 1
s_max_i32 s61, s61, 0
s_lshl_b32 s30, s24, 1
s_add_u32 s60, s60, s30
s_mul_i32 s30, s61, 18432
s_mul_i32 s62, s60, 18432
v_add_u32 v237, 18432, v1
s_mul_i32 s38, s24, 5120
s_add_u32 m0, s38, 135168
s_add_u32 s39, s38, s30
s_cmp_eq_u32 s24, 1
s_cbranch_scc0 L_other_41
s_mov_b32 s31, 0
s_mov_b64 exec, 1
v_mov_b32 v247, 0
buffer_atomic_add v247, v6, s[8:11], s35 offen sc0 sc1
s_waitcnt vmcnt(12)
v_cmp_gt_u32 vcc, s34, v244
s_nop 0
s_cbranch_vccz L_polled_40
s_waitcnt vmcnt(8)
v_cmp_gt_u32 vcc, s34, v245
s_nop 0
s_cbranch_vccz L_polled_40
v_mov_b32 v244, 0
buffer_atomic_add v244, v6, s[8:11], s35 offen sc0 sc1
s_waitcnt vmcnt(5)
v_cmp_gt_u32 vcc, s34, v246
s_nop 0
s_cbranch_vccz L_polled_40
v_mov_b32 v245, 0
buffer_atomic_add v245, v6, s[8:11], s35 offen sc0 sc1
L_poll_39:
s_add_u32 s31, s31, 1
s_cmp_gt_u32 s31, 100000
s_cbranch_scc1 L_polled_40
v_mov_b32 v246, 0
buffer_atomic_add v246, v6, s[8:11], s35 offen sc0 sc1
s_waitcnt vmcnt(3)
v_cmp_gt_u32 vcc, s34, v247
s_nop 0
s_cbranch_vccz L_polled_40
v_mov_b32 v247, 0
buffer_atomic_add v247, v6, s[8:11], s35 offen sc0 sc1
s_waitcnt vmcnt(3)
v_cmp_gt_u32 vcc, s34, v244
s_nop 0
s_cbranch_vccz L_polled_40
v_mov_b32 v244, 0
buffer_atomic_add v244, v6, s[8:11], s35 offen sc0 sc1
s_waitcnt vmcnt(3)
v_cmp_gt_u32 vcc, s34, v245
s_nop 0
s_cbranch_vccz L_polled_40
v_mov_b32 v245, 0
buffer_atomic_add v245, v6, s[8:11], s35 offen sc0 sc1
s_waitcnt vmcnt(3)
v_cmp_gt_u32 vcc, s34, v246
s_nop 0
s_cbranch_vccz L_polled_40
s_branch L_poll_39
L_polled_40:
s_mov_b64 exec, -1
L_other_41:
s_barrier
s_mov_b32 s29, 1
s_add_u32 s8, s8, 30834688
s_addc_u32 s9, s9, 0
s_mov_b32 s10, 30834688
s_branch L_layer
L_last:
v_cvt_pk_bf16_f32 v148, v16, v17
v_cvt_pk_bf16_f32 v149, v18, v19
v_cvt_pk_bf16_f32 v150, v20, v21
v_cvt_pk_bf16_f32 v151, v22, v23
v_cvt_pk_bf16_f32 v152, v24, v25
v_cvt_pk_bf16_f32 v153, v26, v27
v_cvt_pk_bf16_f32 v154, v28, v29
v_cvt_pk_bf16_f32 v155, v30, v31
v_cvt_pk_bf16_f32 v156, v32, v33
v_cvt_pk_bf16_f32 v157, v34, v35
buffer_store_dwordx4 v[148:151], v164, s[16:19], s68 offen
buffer_store_dwordx4 v[152:155], v164, s[16:19], s68 offen offset:64
v_permlane16_swap_b32 v156, v158
v_permlane16_swap_b32 v157, v159
buffer_store_dwordx4 v[156:159], v165, s[16:19], s68 offen
L_main_fin:
L_main_end:
s_endpgm
L_tagslow_7:
buffer_load_dwordx2 v[238:239], v48, s[84:87], 0 offen sc1
s_add_u32 s31, s31, 1
s_waitcnt vmcnt(0)
v_cmp_eq_u32 vcc, 0, v238
s_cmp_gt_u32 s31, 200000
s_cbranch_scc1 L_tagback_8
s_cbranch_vccnz L_tagslow_7
s_branch L_tagback_8
L_dbslow_11:
s_mov_b32 s67, 0
L_dbslow_11x:
buffer_load_dwordx2 v[148:149], v146, s[4:7], s66 offen sc1
s_add_u32 s67, s67, 1
s_waitcnt vmcnt(0)
v_cmp_ne_u64 vcc, v[148:149], v[238:239]
s_cmp_gt_u32 s67, 200000
s_cbranch_scc1 L_dbback_12
s_cbranch_vccnz L_dbslow_11x
s_branch L_dbback_12
L_stzslow_23:
s_mov_b32 s31, 0
L_stzloop_25:
buffer_load_dwordx2 v[182:183], v234, s[8:11], s61 offen offset:0 sc1
buffer_load_dwordx2 v[184:185], v234, s[8:11], s61 offen offset:1024 sc1
buffer_load_dwordx2 v[186:187], v234, s[8:11], s61 offen offset:2048 sc1
buffer_load_dwordx2 v[188:189], v234, s[8:11], s61 offen offset:3072 sc1
buffer_load_dwordx2 v[190:191], v235, s[8:11], s61 offen offset:0 sc1
buffer_load_dwordx2 v[192:193], v235, s[8:11], s61 offen offset:1024 sc1
buffer_load_dwordx2 v[194:195], v235, s[8:11], s61 offen offset:2048 sc1
buffer_load_dwordx2 v[196:197], v235, s[8:11], s61 offen offset:3072 sc1
s_add_u32 s31, s31, 1
s_waitcnt vmcnt(0)
v_min3_f32 v200, v183, v185, v187
v_min3_f32 v201, v189, v191, v193
v_min3_f32 v200, v200, v195, v197
v_min_f32 v200, v200, v201
v_cmp_gt_f32 vcc, 0, v200
s_cmp_gt_u32 s31, 200000
s_cbranch_scc1 L_stzback_24
s_cbranch_vccnz L_stzloop_25
s_branch L_stzback_24
L_xslow_36:
s_mov_b32 s31, 0
L_xloop_38:
buffer_load_dwordx4 v[80:83], v1, s[8:11], s63 offen offset:0 sc1
buffer_load_dwordx4 v[84:87], v1, s[8:11], s63 offen offset:1024 sc1
buffer_load_dwordx4 v[88:91], v1, s[8:11], s63 offen offset:2048 sc1
buffer_load_dwordx4 v[92:95], v1, s[8:11], s63 offen offset:3072 sc1
s_add_u32 s31, s31, 1
s_waitcnt vmcnt(0)
v_xor_b32 v118, v248, v83
v_xor_b32 v119, v248, v87
v_xor_b32 v120, v248, v91
v_xor_b32 v121, v248, v95
v_or3_b32 v118, v118, v119, v120
v_or_b32 v118, v118, v121
v_cmp_ne_u32 vcc, 0, v118
s_cmp_gt_u32 s31, 200000
s_cbranch_scc1 L_xback_37
s_cbranch_vccnz L_xloop_38
s_branch L_xback_37
L_code_end:
.section .rodata,"a"
.p2align 6
.amdhsa_kernel main_kernel
  .amdhsa_next_free_vgpr 512
  .amdhsa_next_free_sgpr 102
  .amdhsa_accum_offset 256
  .amdhsa_group_segment_fixed_size 0
  .amdhsa_kernarg_size 88
  .amdhsa_user_sgpr_count 2
  .amdhsa_user_sgpr_kernarg_segment_ptr 1
  .amdhsa_system_sgpr_workgroup_id_x 1
  .amdhsa_float_denorm_mode_32 3
.end_amdhsa_kernel
```

```asm
; @launch kernel=main_kernel grid=(256,1,1) block=(256,1,1) lds=163840
.amdgcn_target "amdgcn-amd-amdhsa--gfx950"
.text
.globl main_kernel
.p2align 8
.type main_kernel,@function
main_kernel:
s_cmp_ge_u32 s2, 256
s_cbranch_scc1 L_main_end
s_load_dwordx16 s[64:79], s[0:1], 0
s_memrealtime s[96:97]
s_load_dwordx2 s[4:5], s[0:1], 80
s_load_dwordx2 s[16:17], s[0:1], 64
s_load_dwordx2 s[84:85], s[0:1], 72
s_getpc_b64 s[88:89]
L_pc:
s_mov_b32 s90, L_code_end-L_pc
s_mov_b32 s91, 0x20000
s_lshr_b32 s31, s2, 3
s_lshl_b32 s31, s31, 10
v_lshl_add_u32 v14, v0, 2, s31
s_mov_b32 s37, L_pc-L_pc
buffer_load_dword v15, v14, s[88:91], s37 offen
v_lshrrev_b32 v6, 6, v0
v_and_b32 v0, 63, v0
v_readfirstlane_b32 s24, v6
v_lshlrev_b32 v1, 4, v0
v_and_b32 v2, 15, v0
v_lshrrev_b32 v3, 4, v0
v_cmp_gt_u32 s[50:51], 2, v3
s_nop 0
s_cmp_lt_u32 s2, 128
s_cbranch_scc1 L_p0_x1
s_sub_u32 s30, s2, 128
s_cmp_lt_u32 s30, 108
s_cselect_b32 s62, 0, 1073741824
s_cselect_b32 s30, s30, 0
s_and_b32 s60, s30, 3
s_lshr_b32 s61, s30, 2
s_mov_b32 s14, 1990656
s_mov_b32 s15, 0x20000
s_mul_i32 s30, s60, 497664
s_lshl_b32 s31, s61, 7
s_add_u32 s30, s30, s31
s_mul_i32 s31, s24, 27648
s_add_u32 s30, s30, s31
s_add_u32 s30, s30, s62
v_lshrrev_b32 v36, 7, v1
v_mul_u32_u24 v42, 3456, v36
v_and_b32 v36, 0x70, v1
v_add_u32 v42, v36, v42
s_lshl_b32 s32, s24, 10
s_waitcnt lgkmcnt(0)
s_mov_b32 s12, s66
s_mov_b32 s13, s67
s_add_u32 m0, s32, 0
s_add_u32 s31, s30, 0
buffer_load_dwordx4 v42, s[12:15], s31 offen nt lds
s_add_u32 m0, s32, 4096
s_add_u32 s31, s30, 110592
buffer_load_dwordx4 v42, s[12:15], s31 offen nt lds
s_add_u32 m0, s32, 8192
s_add_u32 s31, s30, 221184
buffer_load_dwordx4 v42, s[12:15], s31 offen nt lds
s_add_u32 m0, s32, 12288
s_add_u32 s31, s30, 331776
buffer_load_dwordx4 v42, s[12:15], s31 offen nt lds
s_add_u32 m0, s32, 16384
s_add_u32 s31, s30, 442368
s_cmp_lt_u32 s24, 2
s_cselect_b32 s31, s31, 1073741824
buffer_load_dwordx4 v42, s[12:15], s31 offen nt lds
s_branch L_p0_j1
L_p0_x1:
s_mov_b32 s14, 2359296
s_mov_b32 s15, 0x20000
s_mul_i32 s30, s24, 18
v_add_u32 v36, s30, v3
v_mul_u32_u24 v42, 1152, v2
v_lshl_add_u32 v42, v36, 4, v42
s_mul_i32 s30, s2, 18432
v_mov_b32 v37, 1073741824
v_cndmask_b32 v37, v37, v42, s[50:51]
s_waitcnt lgkmcnt(0)
s_mov_b32 s12, s64
s_mov_b32 s13, s65
buffer_load_dwordx4 v[64:67], v42, s[12:15], s30 offen offset:0
buffer_load_dwordx4 v[68:71], v42, s[12:15], s30 offen offset:64
buffer_load_dwordx4 v[72:75], v42, s[12:15], s30 offen offset:128
buffer_load_dwordx4 v[76:79], v42, s[12:15], s30 offen offset:192
buffer_load_dwordx4 v[80:83], v37, s[12:15], s30 offen offset:256
L_p0_j1:
s_mov_b32 s86, 256
s_mov_b32 s87, 0x20000
s_xor_b32 s30, s2, 248
s_or_b32 s30, s30, s24
s_cmp_eq_u32 s30, 0
s_cselect_b32 s30, 0, 1073741824
v_mov_b32 v48, 0
s_or_b32 s96, s96, 1
v_mov_b32 v238, s96
v_mov_b32 v239, s97
s_mov_b64 exec, 1
buffer_store_dwordx2 v[238:239], v48, s[84:87], s30 offen sc1
s_mov_b64 exec, -1
v_mov_b32 v4, 1
v_mov_b32 v5, 0
s_mov_b32 s56, 0
s_mov_b32 s29, 0
v_add_u32 v9, 66560, v1
v_cmp_eq_u32 s[46:47], 0, v3
v_cmp_eq_u32 s[48:49], 2, v3
s_mov_b32 s6, 19451904
s_mov_b32 s7, 0x20000
s_mov_b32 s10, 61669376
s_mov_b32 s11, 0x20000
s_mov_b32 s18, 2359296
s_mov_b32 s19, 0x20000
s_mov_b32 s22, 4096
s_mov_b32 s23, 0x20000
s_and_b32 s30, s2, 7
s_lshr_b32 s31, s2, 3
s_lshr_b32 s32, s31, 2
s_and_b32 s33, s31, 3
s_lshr_b32 s25, s30, 2
s_lshl_b32 s25, s25, 3
s_add_u32 s25, s25, s32
s_and_b32 s26, s30, 3
s_lshl_b32 s26, s26, 2
s_add_u32 s26, s26, s33
s_lshr_b32 s27, s30, 1
s_lshl_b32 s27, s27, 3
s_add_u32 s27, s27, s32
s_and_b32 s28, s30, 1
s_lshl_b32 s28, s28, 2
s_add_u32 s28, s28, s33
s_lshr_b32 s27, s30, 1
s_lshl_b32 s27, s27, 2
s_lshr_b32 s32, s31, 3
s_add_u32 s27, s27, s32
s_lshl_b32 s27, s27, 1
s_and_b32 s32, s30, 1
s_add_u32 s27, s27, s32
s_and_b32 s28, s31, 7
s_lshl_b32 s80, s25, 4
s_add_u32 s80, s80, s26
s_lshl_b32 s81, s27, 3
s_add_u32 s81, s81, s28
s_add_u32 s8, s4, 19451904
s_addc_u32 s9, s5, 0
s_mov_b32 s20, s76
s_mov_b32 s21, s77
v_lshrrev_b32 v36, 2, v2
v_lshl_add_u32 v36, v3, 3, v36
v_lshlrev_b32 v45, 7, v36
v_and_b32 v36, 3, v2
v_lshl_add_u32 v45, v36, 3, v45
s_lshl_b32 s31, s24, 5
v_add_u32 v45, s31, v45
v_mov_b32 v164, 3212836864
v_mov_b32 v165, 3212836864
v_mov_b32 v166, 3212836864
v_mov_b32 v167, 3212836864
s_lshl_b32 s30, s80, 10
s_lshl_b32 s31, s24, 8
s_add_u32 s30, s30, s31
s_add_u32 s30, s30, 26214400
s_mov_b32 s31, 30834688
v_mul_lo_u32 v36, v3, s31
v_lshl_add_u32 v37, v2, 4, v36
s_mov_b32 exec_hi, 0
buffer_store_dwordx4 v[164:167], v37, s[8:11], s30 offen sc1
s_mov_b64 exec, -1
v_lshl_add_u32 v37, v2, 15, v36
s_lshl_b32 s30, s2, 7
s_add_u32 s30, s30, 26476544
s_cmp_eq_u32 s24, 0
s_cselect_b32 s30, s30, 1073741824
s_mov_b64 exec, 0x001f001f
buffer_store_dword v48, v37, s[8:11], s30 offen sc1
s_mov_b64 exec, -1
s_cmp_lt_u32 s2, 128
s_cbranch_scc1 L_p0_x2
s_mul_i32 s92, s61, 29
s_lshr_b32 s92, s92, 8
s_mul_i32 s33, s92, 9
s_sub_u32 s33, s61, s33
s_lshl_b32 s33, s33, 6
s_lshl_b32 s31, s24, 4
s_add_u32 s33, s33, s31
v_add_u32 v36, s33, v2
v_mul_u32_u24 v37, 911, v36
v_lshrrev_b32 v37, 14, v37
v_mul_u32_u24 v38, 18, v37
v_sub_u32 v36, v36, v38
v_and_b32 v38, 1, v37
v_lshrrev_b32 v37, 1, v37
s_mov_b32 s31, 132608
v_mul_lo_u32 v37, v37, s31
s_cmp_eq_u32 s92, 0
s_cselect_b32 s93, 5, 0
s_cselect_b32 s94, 8, 4
s_cmp_eq_u32 s92, 2
s_cselect_b32 s93, 2, s93
s_cselect_b32 s94, 0, s94
s_sub_u32 s94, s94, 16
v_add_u32 v39, s93, v38
v_lshl_add_u32 v40, v38, 1, v36
v_add_u32 v40, s94, v40
v_cmp_gt_u32 vcc, 16, v36
s_nop 1
v_cndmask_b32 v39, 4, v39, vcc
v_cndmask_b32 v40, v40, v36, vcc
v_lshl_add_u32 v43, v39, 10, v37
v_lshl_add_u32 v43, v40, 4, v43
v_lshl_add_u32 v44, v39, 9, v37
v_lshl_add_u32 v44, v40, 3, v44
s_lshl_b32 s31, s60, 7
s_add_u32 s31, s31, 129024
v_add_u32 v44, s31, v44
s_mul_i32 s31, s60, 18
v_add_u32 v37, s31, v3
v_and_b32 v38, 3, v37
v_lshrrev_b32 v37, 2, v37
v_mul_u32_u24 v37, 7168, v37
v_add_u32 v43, v43, v37
v_lshl_add_u32 v43, v38, 8, v43
s_waitcnt vmcnt(3)
s_barrier
ds_read_b64_tr_b16 v[64:65], v45 offset:0
ds_read_b64_tr_b16 v[66:67], v45 offset:512
ds_read_b64_tr_b16 v[68:69], v45 offset:4096
ds_read_b64_tr_b16 v[70:71], v45 offset:4608
ds_read_b64_tr_b16 v[72:73], v45 offset:8192
ds_read_b64_tr_b16 v[74:75], v45 offset:8704
ds_read_b64_tr_b16 v[76:77], v45 offset:12288
ds_read_b64_tr_b16 v[78:79], v45 offset:12800
ds_read_b64_tr_b16 v[80:81], v45 offset:16384
ds_read_b64_tr_b16 v[82:83], v45 offset:16896
v_mov_b32 v36, 1073741824
v_mov_b32 v46, 0
v_cndmask_b32 v37, v36, v43, s[50:51]
s_add_u32 s31, s62, 0
s_waitcnt lgkmcnt(8)
buffer_store_dwordx4 v[64:67], v43, s[4:7], s31 offen sc1
s_add_u32 s31, s62, 7168
s_waitcnt lgkmcnt(6)
buffer_store_dwordx4 v[68:71], v43, s[4:7], s31 offen sc1
s_add_u32 s31, s62, 14336
s_waitcnt lgkmcnt(4)
buffer_store_dwordx4 v[72:75], v43, s[4:7], s31 offen sc1
s_add_u32 s31, s62, 21504
s_waitcnt lgkmcnt(2)
buffer_store_dwordx4 v[76:79], v43, s[4:7], s31 offen sc1
s_add_u32 s31, s62, 28672
s_waitcnt lgkmcnt(0)
buffer_store_dwordx4 v[80:83], v37, s[4:7], s31 offen sc1
v_mov_b32 v37, 0x3f803f80
v_dot2c_f32_bf16 v46, v64, v37
v_dot2c_f32_bf16 v46, v65, v37
v_dot2c_f32_bf16 v46, v66, v37
v_dot2c_f32_bf16 v46, v67, v37
v_dot2c_f32_bf16 v46, v68, v37
v_dot2c_f32_bf16 v46, v69, v37
v_dot2c_f32_bf16 v46, v70, v37
v_dot2c_f32_bf16 v46, v71, v37
v_dot2c_f32_bf16 v46, v72, v37
v_dot2c_f32_bf16 v46, v73, v37
v_dot2c_f32_bf16 v46, v74, v37
v_dot2c_f32_bf16 v46, v75, v37
v_dot2c_f32_bf16 v46, v76, v37
v_dot2c_f32_bf16 v46, v77, v37
v_dot2c_f32_bf16 v46, v78, v37
v_dot2c_f32_bf16 v46, v79, v37
v_dot2c_f32_bf16 v46, v80, v37
v_dot2c_f32_bf16 v46, v81, v37
v_dot2c_f32_bf16 v46, v82, v37
v_dot2c_f32_bf16 v46, v83, v37
s_nop 2
v_mov_b32 v37, v46
s_nop 1
v_permlane32_swap_b32 v46, v37
v_add_f32 v46, v46, v37
v_mov_b32 v37, v46
s_nop 1
v_permlane16_swap_b32 v46, v37
v_add_f32 v46, v46, v37
v_cvt_pk_bf16_f32 v50, v46, v46
v_and_b32 v37, 0xffff0000, v50
v_sub_f32 v37, v46, v37
v_cvt_pk_bf16_f32 v51, v37, v37
v_cndmask_b32 v36, v36, v44, s[46:47]
buffer_store_dwordx2 v[50:51], v36, s[4:7], s62 offen sc1
s_branch L_p0_j2
L_p0_x2:
s_mul_i32 s30, s24, 4608
s_mul_i32 s31, s2, 18432
s_add_u32 s31, s31, s30
s_add_u32 s31, s31, 0
v_mov_b32 v36, 1073741824
v_add_u32 v38, 4096, v1
v_cndmask_b32 v38, v36, v38, s[50:51]
v_mov_b32 v46, 0
v_mov_b32 v47, 0
v_mov_b32 v39, 0x3f803f80
s_waitcnt vmcnt(3)
buffer_store_dwordx4 v[64:67], v1, s[8:11], s31 offen offset:0 sc1
buffer_store_dwordx4 v[68:71], v1, s[8:11], s31 offen offset:1024 sc1
buffer_store_dwordx4 v[72:75], v1, s[8:11], s31 offen offset:2048 sc1
buffer_store_dwordx4 v[76:79], v1, s[8:11], s31 offen offset:3072 sc1
buffer_store_dwordx4 v[80:83], v38, s[8:11], s31 offen offset:0 sc1
v_dot2c_f32_bf16 v46, v64, v39
v_dot2c_f32_bf16 v46, v65, v39
v_dot2c_f32_bf16 v46, v66, v39
v_dot2c_f32_bf16 v46, v67, v39
v_dot2c_f32_bf16 v46, v68, v39
v_dot2c_f32_bf16 v46, v69, v39
v_dot2c_f32_bf16 v46, v70, v39
v_dot2c_f32_bf16 v46, v71, v39
v_dot2c_f32_bf16 v46, v72, v39
v_dot2c_f32_bf16 v46, v73, v39
v_dot2c_f32_bf16 v46, v74, v39
v_dot2c_f32_bf16 v46, v75, v39
v_dot2c_f32_bf16 v46, v76, v39
v_dot2c_f32_bf16 v46, v77, v39
v_dot2c_f32_bf16 v46, v78, v39
v_dot2c_f32_bf16 v46, v79, v39
v_dot2c_f32_bf16 v46, v80, v39
v_dot2c_f32_bf16 v46, v81, v39
v_dot2c_f32_bf16 v46, v82, v39
v_dot2c_f32_bf16 v46, v83, v39
v_dot2c_f32_bf16 v47, v64, v64
v_dot2c_f32_bf16 v47, v65, v65
v_dot2c_f32_bf16 v47, v66, v66
v_dot2c_f32_bf16 v47, v67, v67
v_dot2c_f32_bf16 v47, v68, v68
v_dot2c_f32_bf16 v47, v69, v69
v_dot2c_f32_bf16 v47, v70, v70
v_dot2c_f32_bf16 v47, v71, v71
v_dot2c_f32_bf16 v47, v72, v72
v_dot2c_f32_bf16 v47, v73, v73
v_dot2c_f32_bf16 v47, v74, v74
v_dot2c_f32_bf16 v47, v75, v75
v_dot2c_f32_bf16 v47, v76, v76
v_dot2c_f32_bf16 v47, v77, v77
v_dot2c_f32_bf16 v47, v78, v78
v_dot2c_f32_bf16 v47, v79, v79
v_dot2c_f32_bf16 v47, v80, v80
v_dot2c_f32_bf16 v47, v81, v81
v_dot2c_f32_bf16 v47, v82, v82
v_dot2c_f32_bf16 v47, v83, v83
v_mov_b32 v37, v46
s_nop 1
v_permlane32_swap_b32 v46, v37
v_add_f32 v46, v46, v37
v_mov_b32 v37, v46
s_nop 1
v_permlane16_swap_b32 v46, v37
v_add_f32 v46, v46, v37
v_mov_b32 v37, v47
s_nop 1
v_permlane32_swap_b32 v47, v37
v_add_f32 v47, v47, v37
v_mov_b32 v37, v47
s_nop 1
v_permlane16_swap_b32 v47, v37
v_add_f32 v47, v47, v37
s_lshl_b32 s30, s2, 7
s_lshl_b32 s31, s24, 14
s_add_u32 s30, s30, s31
s_add_u32 s30, s30, 2359296
v_cndmask_b32 v50, 0, v46, s[46:47]
v_cndmask_b32 v51, 0, v47, s[46:47]
v_lshlrev_b32 v37, 3, v2
v_lshl_add_u32 v37, v3, 16, v37
v_cndmask_b32 v37, v36, v37, s[50:51]
buffer_store_dwordx2 v[50:51], v37, s[8:11], s30 offen sc1
L_p0_j2:
buffer_load_dwordx2 v[238:239], v48, s[84:87], 0 offen sc1
s_sub_u32 s30, s2, 0
s_cmp_lt_u32 s30, 256
s_cselect_b32 s36, 0, 1073741824
s_cselect_b32 s30, s30, 0
s_and_b32 s34, s30, 3
s_lshr_b32 s35, s30, 2
s_mov_b32 s14, 5308416
s_mov_b32 s15, 0x20000
s_mul_i32 s30, s34, 1327104
s_lshl_b32 s31, s35, 7
s_add_u32 s30, s30, s31
s_mul_i32 s31, s24, 73728
s_add_u32 s30, s30, s31
s_add_u32 s30, s30, s36
v_lshrrev_b32 v36, 7, v1
v_mul_u32_u24 v42, 9216, v36
v_and_b32 v36, 0x70, v1
v_add_u32 v42, v36, v42
s_lshl_b32 s32, s24, 10
s_mov_b32 s12, s72
s_mov_b32 s13, s73
s_add_u32 m0, s32, 20480
s_add_u32 s31, s30, 0
buffer_load_dwordx4 v42, s[12:15], s31 offen nt lds
s_add_u32 m0, s32, 24576
s_add_u32 s31, s30, 294912
buffer_load_dwordx4 v42, s[12:15], s31 offen nt lds
s_add_u32 m0, s32, 28672
s_add_u32 s31, s30, 589824
buffer_load_dwordx4 v42, s[12:15], s31 offen nt lds
s_add_u32 m0, s32, 32768
s_add_u32 s31, s30, 884736
buffer_load_dwordx4 v42, s[12:15], s31 offen nt lds
s_add_u32 m0, s32, 36864
s_add_u32 s31, s30, 1179648
s_cmp_lt_u32 s24, 2
s_cselect_b32 s31, s31, 1073741824
buffer_load_dwordx4 v42, s[12:15], s31 offen nt lds
s_sub_u32 s30, s2, 0
s_cmp_lt_u32 s30, 256
s_cselect_b32 s36, 0, 1073741824
s_cselect_b32 s30, s30, 0
s_and_b32 s34, s30, 3
s_lshr_b32 s35, s30, 2
s_lshl_b32 s92, s35, 6
s_lshl_b32 s33, s24, 4
s_add_u32 s92, s92, s33
s_cmp_ge_u32 s92, 2304
s_cselect_b32 s93, 1, 0
s_cselect_b32 s33, 2304, 0
s_sub_u32 s92, s92, s33
s_mul_i32 s94, s92, 1821
s_lshr_b32 s94, s94, 19
s_mul_i32 s33, s94, 288
s_sub_u32 s92, s92, s33
s_lshr_b32 s95, s92, 5
s_bfe_u32 s96, s92, 0x10004
s_lshl_b32 s94, s94, 1
s_cmp_ge_u32 s92, 144
s_addc_u32 s94, s94, 0
s_cmp_gt_u32 s95, 4
s_cselect_b32 s33, 5, 0
s_sub_u32 s97, s95, s33
s_cmp_eq_u32 s93, 0
s_cselect_b32 s33, 5, 0
s_add_u32 s97, s97, s33
s_cmp_eq_u32 s95, 4
s_cselect_b32 s97, 4, s97
s_mul_i32 s94, s94, 9
s_add_u32 s94, s94, s97
s_mul_i32 s94, s94, 37888
s_add_u32 s94, s94, 2785280
v_and_b32 v36, 3, v2
v_bfe_u32 v37, v2, 2, 1
v_bfe_u32 v38, v2, 3, 1
v_lshl_add_u32 v36, v38, 2, v36
s_lshl_b32 s33, s96, 3
v_add_u32 v36, s33, v36
s_cmp_eq_u32 s95, 4
s_cbranch_scc0 L_w3j_3
s_xor_b32 s33, s93, 1
v_mov_b32 v36, v2
v_mov_b32 v37, s33
L_w3j_3:
v_mul_u32_u24 v170, 18432, v37
v_lshl_add_u32 v170, v36, 4, v170
v_lshl_add_u32 v170, v3, 8, v170
s_mul_i32 s31, s34, 4608
s_add_u32 s31, s31, s94
v_add_u32 v170, s31, v170
v_lshlrev_b32 v171, 9, v37
v_lshl_add_u32 v171, v36, 3, v171
s_lshl_b32 s31, s34, 7
s_add_u32 s31, s31, s94
s_add_u32 s31, s31, 36864
v_add_u32 v171, s31, v171
s_cmp_lt_u32 s2, 32
s_cbranch_scc1 L_p0_a5
s_cmp_lt_u32 s2, 176
s_cbranch_scc1 L_p0_b5
s_sub_u32 s30, s2, 176
s_cmp_lt_u32 s30, 36
s_cselect_b32 s53, 0, 1073741824
s_cselect_b32 s30, s30, 0
s_and_b32 s38, s30, 3
s_lshr_b32 s52, s30, 2
v_lshrrev_b32 v39, 2, v2
v_and_b32 v40, 3, v2
v_lshlrev_b32 v40, 3, v40
s_lshl_b32 s31, s24, 5
v_add_u32 v40, s31, v40
v_lshl_add_u32 v36, v3, 2, v39
v_lshl_add_u32 v52, v36, 7, v40
v_lshrrev_b32 v36, 1, v39
v_mul_u32_u24 v36, 18, v36
v_and_b32 v41, 1, v39
v_add3_u32 v36, v36, v41, 16
v_and_b32 v41, 1, v3
v_mul_u32_u24 v41, 72, v41
v_add_u32 v36, v36, v41
v_lshl_add_u32 v53, v36, 7, v40
s_lshl_b32 s31, s52, 6
s_lshl_b32 s33, s24, 4
s_add_u32 s31, s31, s33
v_add_u32 v36, s31, v2
v_mul_u32_u24 v37, 911, v36
v_lshrrev_b32 v37, 16, v37
v_mul_u32_u24 v38, 72, v37
v_sub_u32 v36, v36, v38
s_mov_b32 s31, 82944
v_mul_lo_u32 v41, v37, s31
v_add_u32 v41, 2121728, v41
v_lshrrev_b32 v39, 5, v36
v_lshlrev_b32 v39, 11, v39
v_bfe_u32 v40, v36, 2, 1
v_lshl_add_u32 v39, v40, 10, v39
v_bfe_u32 v40, v36, 3, 2
v_lshl_add_u32 v39, v40, 6, v39
v_and_b32 v40, 3, v36
v_lshl_add_u32 v39, v40, 4, v39
v_lshlrev_b32 v40, 4, v36
v_add_u32 v40, 3072, v40
v_cmp_gt_u32 vcc, 64, v36
v_mov_b32 v47, 7
s_nop 0
v_cndmask_b32 v39, v40, v39, vcc
v_cndmask_b32 v47, v47, 8, vcc
v_add_u32 v41, v41, v39
s_mul_i32 s31, s38, 16
s_add_u32 s31, s31, 0
v_add_u32 v37, s31, v3
v_and_b32 v38, 3, v37
v_lshrrev_b32 v37, 2, v37
v_mul_u32_u24 v37, 4608, v37
v_lshlrev_b32 v38, v47, v38
v_add3_u32 v172, v41, v37, v38
s_mul_i32 s31, s38, 2
s_add_u32 s31, s31, 64
v_add_u32 v37, s31, v3
v_and_b32 v38, 3, v37
v_lshrrev_b32 v37, 2, v37
v_mul_u32_u24 v37, 4608, v37
v_lshlrev_b32 v38, v47, v38
v_add3_u32 v173, v41, v37, v38
s_branch L_p0_j5
L_p0_b5:
s_sub_u32 s30, s2, 32
s_cmp_lt_u32 s30, 144
s_cselect_b32 s53, 0, 1073741824
s_cselect_b32 s30, s30, 0
s_and_b32 s38, s30, 15
s_lshr_b32 s52, s30, 4
s_lshl_b32 s31, s52, 6
s_lshl_b32 s33, s24, 4
s_add_u32 s31, s31, s33
v_add_u32 v36, s31, v2
v_mul_u32_u24 v37, 911, v36
v_lshrrev_b32 v37, 16, v37
v_mul_u32_u24 v38, 72, v37
v_sub_u32 v36, v36, v38
s_mov_b32 s31, 331776
v_mul_lo_u32 v41, v37, s31
v_add_u32 v41, 8241152, v41
v_lshrrev_b32 v39, 5, v36
v_lshlrev_b32 v39, 11, v39
v_bfe_u32 v40, v36, 2, 1
v_lshl_add_u32 v39, v40, 10, v39
v_bfe_u32 v40, v36, 3, 2
v_lshl_add_u32 v39, v40, 6, v39
v_and_b32 v40, 3, v36
v_lshl_add_u32 v39, v40, 4, v39
v_lshlrev_b32 v40, 4, v36
v_add_u32 v40, 3072, v40
v_cmp_gt_u32 vcc, 64, v36
v_mov_b32 v47, 7
s_nop 0
v_cndmask_b32 v39, v40, v39, vcc
v_cndmask_b32 v47, v47, 8, vcc
v_add_u32 v41, v41, v39
s_mul_i32 s31, s38, 18
s_add_u32 s31, s31, 0
v_add_u32 v37, s31, v3
v_and_b32 v38, 3, v37
v_lshrrev_b32 v37, 2, v37
v_mul_u32_u24 v37, 4608, v37
v_lshlrev_b32 v38, v47, v38
v_add3_u32 v172, v41, v37, v38
s_branch L_p0_j5
L_p0_a5:
s_add_u32 s30, s2, 256
s_cmp_lt_u32 s30, 288
s_cselect_b32 s53, 0, 1073741824
s_cselect_b32 s30, s30, 0
s_and_b32 s38, s30, 3
s_lshr_b32 s52, s30, 2
s_lshl_b32 s92, s52, 6
s_lshl_b32 s33, s24, 4
s_add_u32 s92, s92, s33
s_cmp_ge_u32 s92, 2304
s_cselect_b32 s93, 1, 0
s_cselect_b32 s33, 2304, 0
s_sub_u32 s92, s92, s33
s_mul_i32 s94, s92, 1821
s_lshr_b32 s94, s94, 19
s_mul_i32 s33, s94, 288
s_sub_u32 s92, s92, s33
s_lshr_b32 s95, s92, 5
s_bfe_u32 s96, s92, 0x10004
s_lshl_b32 s94, s94, 1
s_cmp_ge_u32 s92, 144
s_addc_u32 s94, s94, 0
s_cmp_gt_u32 s95, 4
s_cselect_b32 s33, 5, 0
s_sub_u32 s97, s95, s33
s_cmp_eq_u32 s93, 0
s_cselect_b32 s33, 5, 0
s_add_u32 s97, s97, s33
s_cmp_eq_u32 s95, 4
s_cselect_b32 s97, 4, s97
s_mul_i32 s94, s94, 9
s_add_u32 s94, s94, s97
s_mul_i32 s94, s94, 37888
s_add_u32 s94, s94, 2785280
v_and_b32 v36, 3, v2
v_bfe_u32 v37, v2, 2, 1
v_bfe_u32 v38, v2, 3, 1
v_lshl_add_u32 v36, v38, 2, v36
s_lshl_b32 s33, s96, 3
v_add_u32 v36, s33, v36
s_cmp_eq_u32 s95, 4
s_cbranch_scc0 L_w3j_6
s_xor_b32 s33, s93, 1
v_mov_b32 v36, v2
v_mov_b32 v37, s33
L_w3j_6:
v_mul_u32_u24 v172, 18432, v37
v_lshl_add_u32 v172, v36, 4, v172
v_lshl_add_u32 v172, v3, 8, v172
s_mul_i32 s31, s38, 4608
s_add_u32 s31, s31, s94
v_add_u32 v172, s31, v172
v_lshlrev_b32 v173, 9, v37
v_lshl_add_u32 v173, v36, 3, v173
s_lshl_b32 s31, s38, 7
s_add_u32 s31, s31, s94
s_add_u32 s31, s31, 36864
v_add_u32 v173, s31, v173
L_p0_j5:
s_lshl_b32 s30, s25, 2
s_add_u32 s30, s30, s24
s_mul_i32 s31, s30, 133120
s_lshl_b32 s30, s30, 17
s_mul_i32 s32, s24, 0
s_add_u32 s32, s32, s26
s_and_b32 s32, s32, 15
s_lshl_b32 s3, s32, 8
s_add_u32 s3, s3, s30
s_lshl_b32 s101, s32, 12
s_add_u32 s101, s101, s31
s_add_u32 s101, s101, 10895360
v_lshrrev_b32 v41, 4, v1
s_lshl_b32 s30, s25, 3
s_sub_u32 s30, s30, 1
v_add_u32 v36, s30, v41
v_max_i32 v36, 0, v36
s_lshl_b32 s30, s27, 2
v_add_u32 v37, s30, v2
v_cndmask_b32 v36, v37, v36, s[46:47]
v_bfe_u32 v37, v41, 2, 1
v_mul_u32_u24 v37, 35, v37
s_mul_i32 s30, s26, 36
v_add_u32 v37, s30, v37
v_lshrrev_b32 v37, 6, v37
v_bfe_u32 v38, v41, 3, 2
v_mad_u32_u24 v37, v38, 9, v37
v_and_b32 v38, 3, v41
v_lshl_add_u32 v37, v37, 2, v38
v_add_u32 v37, 128, v37
v_cndmask_b32 v36, v37, v36, s[50:51]
v_lshlrev_b32 v174, 7, v36
s_lshl_b32 s30, s2, 7
s_add_u32 s30, s30, 19415040
s_lshl_b32 s32, s2, 3
s_add_u32 s32, s32, 19447808
s_cmp_eq_u32 s24, 0
s_cselect_b32 s30, s30, 1073741824
s_cselect_b32 s100, s32, 1073741824
s_waitcnt vmcnt(5)
v_cmp_eq_u32 vcc, 0, v238
s_mov_b32 s31, 0
s_cbranch_vccnz L_tagslow_7
L_tagback_8:
s_barrier
s_mov_b64 exec, 1
buffer_store_dwordx2 v[238:239], v48, s[4:7], s30 offen sc1
s_mov_b64 exec, -1
s_cmp_lt_u32 s2, 32
s_cbranch_scc1 L_p0_a3
s_cmp_lt_u32 s2, 176
s_cbranch_scc1 L_p0_b3
s_mov_b32 s14, 663552
s_mov_b32 s15, 0x20000
s_mul_i32 s30, s38, 165888
s_lshl_b32 s31, s52, 7
s_add_u32 s30, s30, s31
s_mul_i32 s31, s24, 9216
s_add_u32 s30, s30, s31
s_add_u32 s30, s30, s53
v_lshrrev_b32 v36, 7, v1
v_mul_u32_u24 v42, 1152, v36
v_and_b32 v36, 0x70, v1
v_add_u32 v42, v36, v42
s_lshl_b32 s32, s24, 10
s_mov_b32 s12, s68
s_mov_b32 s13, s69
s_add_u32 m0, s32, 40960
s_add_u32 s31, s30, 0
buffer_load_dwordx4 v42, s[12:15], s31 offen nt lds
s_add_u32 m0, s32, 45056
s_add_u32 s31, s30, 36864
buffer_load_dwordx4 v42, s[12:15], s31 offen nt lds
s_add_u32 m0, s32, 49152
s_add_u32 s31, s30, 73728
buffer_load_dwordx4 v42, s[12:15], s31 offen nt lds
s_add_u32 m0, s32, 53248
s_add_u32 s31, s30, 110592
buffer_load_dwordx4 v42, s[12:15], s31 offen nt lds
s_add_u32 m0, s32, 57344
s_add_u32 s31, s30, 147456
s_cmp_lt_u32 s24, 2
s_cselect_b32 s31, s31, 1073741824
buffer_load_dwordx4 v42, s[12:15], s31 offen nt lds
s_branch L_p0_j3
L_p0_b3:
s_mov_b32 s14, 2654208
s_mov_b32 s15, 0x20000
s_mul_i32 s30, s38, 165888
s_lshl_b32 s31, s52, 7
s_add_u32 s30, s30, s31
s_mul_i32 s31, s24, 9216
s_add_u32 s30, s30, s31
s_add_u32 s30, s30, s53
v_lshrrev_b32 v36, 7, v1
v_mul_u32_u24 v42, 1152, v36
v_and_b32 v36, 0x70, v1
v_add_u32 v42, v36, v42
s_lshl_b32 s32, s24, 10
s_mov_b32 s12, s78
s_mov_b32 s13, s79
s_add_u32 m0, s32, 40960
s_add_u32 s31, s30, 0
buffer_load_dwordx4 v42, s[12:15], s31 offen nt lds
s_add_u32 m0, s32, 45056
s_add_u32 s31, s30, 36864
buffer_load_dwordx4 v42, s[12:15], s31 offen nt lds
s_add_u32 m0, s32, 49152
s_add_u32 s31, s30, 73728
buffer_load_dwordx4 v42, s[12:15], s31 offen nt lds
s_add_u32 m0, s32, 53248
s_add_u32 s31, s30, 110592
buffer_load_dwordx4 v42, s[12:15], s31 offen nt lds
s_add_u32 m0, s32, 57344
s_add_u32 s31, s30, 147456
s_cmp_lt_u32 s24, 2
s_cselect_b32 s31, s31, 1073741824
buffer_load_dwordx4 v42, s[12:15], s31 offen nt lds
s_branch L_p0_j3
L_p0_a3:
s_mov_b32 s14, 5308416
s_mov_b32 s15, 0x20000
s_mul_i32 s30, s38, 1327104
s_lshl_b32 s31, s52, 7
s_add_u32 s30, s30, s31
s_mul_i32 s31, s24, 73728
s_add_u32 s30, s30, s31
s_add_u32 s30, s30, s53
v_lshrrev_b32 v36, 7, v1
v_mul_u32_u24 v42, 9216, v36
v_and_b32 v36, 0x70, v1
v_add_u32 v42, v36, v42
s_lshl_b32 s32, s24, 10
s_mov_b32 s12, s72
s_mov_b32 s13, s73
s_add_u32 m0, s32, 40960
s_add_u32 s31, s30, 0
buffer_load_dwordx4 v42, s[12:15], s31 offen nt lds
s_add_u32 m0, s32, 45056
s_add_u32 s31, s30, 294912
buffer_load_dwordx4 v42, s[12:15], s31 offen nt lds
s_add_u32 m0, s32, 49152
s_add_u32 s31, s30, 589824
buffer_load_dwordx4 v42, s[12:15], s31 offen nt lds
s_add_u32 m0, s32, 53248
s_add_u32 s31, s30, 884736
buffer_load_dwordx4 v42, s[12:15], s31 offen nt lds
s_add_u32 m0, s32, 57344
s_add_u32 s31, s30, 1179648
s_cmp_lt_u32 s24, 2
s_cselect_b32 s31, s31, 1073741824
buffer_load_dwordx4 v42, s[12:15], s31 offen nt lds
L_p0_j3:
s_waitcnt vmcnt(6)
s_barrier
ds_read_b64_tr_b16 v[84:85], v45 offset:20480
ds_read_b64_tr_b16 v[86:87], v45 offset:20992
ds_read_b64_tr_b16 v[88:89], v45 offset:24576
ds_read_b64_tr_b16 v[90:91], v45 offset:25088
ds_read_b64_tr_b16 v[92:93], v45 offset:28672
ds_read_b64_tr_b16 v[94:95], v45 offset:29184
ds_read_b64_tr_b16 v[96:97], v45 offset:32768
ds_read_b64_tr_b16 v[98:99], v45 offset:33280
ds_read_b64_tr_b16 v[100:101], v45 offset:36864
ds_read_b64_tr_b16 v[102:103], v45 offset:37376
v_mov_b32 v36, 1073741824
v_mov_b32 v46, 0
v_cndmask_b32 v37, v36, v170, s[50:51]
s_add_u32 s31, s36, 0
s_waitcnt lgkmcnt(8)
buffer_store_dwordx4 v[84:87], v170, s[4:7], s31 offen sc1
s_add_u32 s31, s36, 1024
s_waitcnt lgkmcnt(6)
buffer_store_dwordx4 v[88:91], v170, s[4:7], s31 offen sc1
s_add_u32 s31, s36, 2048
s_waitcnt lgkmcnt(4)
buffer_store_dwordx4 v[92:95], v170, s[4:7], s31 offen sc1
s_add_u32 s31, s36, 3072
s_waitcnt lgkmcnt(2)
buffer_store_dwordx4 v[96:99], v170, s[4:7], s31 offen sc1
s_add_u32 s31, s36, 4096
s_waitcnt lgkmcnt(0)
buffer_store_dwordx4 v[100:103], v37, s[4:7], s31 offen sc1
v_mov_b32 v37, 0x3f803f80
v_dot2c_f32_bf16 v46, v84, v37
v_dot2c_f32_bf16 v46, v85, v37
v_dot2c_f32_bf16 v46, v86, v37
v_dot2c_f32_bf16 v46, v87, v37
v_dot2c_f32_bf16 v46, v88, v37
v_dot2c_f32_bf16 v46, v89, v37
v_dot2c_f32_bf16 v46, v90, v37
v_dot2c_f32_bf16 v46, v91, v37
v_dot2c_f32_bf16 v46, v92, v37
v_dot2c_f32_bf16 v46, v93, v37
v_dot2c_f32_bf16 v46, v94, v37
v_dot2c_f32_bf16 v46, v95, v37
v_dot2c_f32_bf16 v46, v96, v37
v_dot2c_f32_bf16 v46, v97, v37
v_dot2c_f32_bf16 v46, v98, v37
v_dot2c_f32_bf16 v46, v99, v37
v_dot2c_f32_bf16 v46, v100, v37
v_dot2c_f32_bf16 v46, v101, v37
v_dot2c_f32_bf16 v46, v102, v37
v_dot2c_f32_bf16 v46, v103, v37
s_nop 2
v_mov_b32 v37, v46
s_nop 1
v_permlane32_swap_b32 v46, v37
v_add_f32 v46, v46, v37
v_mov_b32 v37, v46
s_nop 1
v_permlane16_swap_b32 v46, v37
v_add_f32 v46, v46, v37
v_cvt_pk_bf16_f32 v50, v46, v46
v_and_b32 v37, 0xffff0000, v50
v_sub_f32 v37, v46, v37
v_cvt_pk_bf16_f32 v51, v37, v37
v_cndmask_b32 v36, v36, v171, s[46:47]
buffer_store_dwordx2 v[50:51], v36, s[4:7], s36 offen sc1
s_waitcnt vmcnt(6)
s_barrier
s_cmp_lt_u32 s2, 32
s_cbranch_scc1 L_p0_a4
s_cmp_lt_u32 s2, 176
s_cbranch_scc1 L_p0_b4
ds_read_b64_tr_b16 v[104:105], v52 offset:40960
ds_read_b64_tr_b16 v[106:107], v52 offset:43264
ds_read_b64_tr_b16 v[108:109], v52 offset:45568
ds_read_b64_tr_b16 v[110:111], v52 offset:47872
ds_read_b64_tr_b16 v[112:113], v52 offset:50176
ds_read_b64_tr_b16 v[114:115], v52 offset:52480
ds_read_b64_tr_b16 v[116:117], v52 offset:54784
ds_read_b64_tr_b16 v[118:119], v52 offset:57088
ds_read_b64_tr_b16 v[120:121], v53 offset:40960
ds_read_b64_tr_b16 v[122:123], v53 offset:45568
v_mov_b32 v36, 1073741824
v_mov_b32 v46, 0
v_cndmask_b32 v37, v36, v173, s[50:51]
s_add_u32 s31, s53, 0
s_waitcnt lgkmcnt(8)
buffer_store_dwordx4 v[104:107], v172, s[4:7], s31 offen sc1
s_add_u32 s31, s53, 4608
s_waitcnt lgkmcnt(6)
buffer_store_dwordx4 v[108:111], v172, s[4:7], s31 offen sc1
s_add_u32 s31, s53, 9216
s_waitcnt lgkmcnt(4)
buffer_store_dwordx4 v[112:115], v172, s[4:7], s31 offen sc1
s_add_u32 s31, s53, 13824
s_waitcnt lgkmcnt(2)
buffer_store_dwordx4 v[116:119], v172, s[4:7], s31 offen sc1
s_add_u32 s31, s53, 0
s_waitcnt lgkmcnt(0)
buffer_store_dwordx4 v[120:123], v37, s[4:7], s31 offen sc1
buffer_store_dwordx2 v[50:51], v36, s[4:7], s53 offen sc1
s_branch L_p0_j4
L_p0_b4:
ds_read_b64_tr_b16 v[104:105], v45 offset:40960
ds_read_b64_tr_b16 v[106:107], v45 offset:41472
ds_read_b64_tr_b16 v[108:109], v45 offset:45056
ds_read_b64_tr_b16 v[110:111], v45 offset:45568
ds_read_b64_tr_b16 v[112:113], v45 offset:49152
ds_read_b64_tr_b16 v[114:115], v45 offset:49664
ds_read_b64_tr_b16 v[116:117], v45 offset:53248
ds_read_b64_tr_b16 v[118:119], v45 offset:53760
ds_read_b64_tr_b16 v[120:121], v45 offset:57344
ds_read_b64_tr_b16 v[122:123], v45 offset:57856
v_mov_b32 v36, 1073741824
v_mov_b32 v46, 0
v_cndmask_b32 v37, v36, v172, s[50:51]
s_add_u32 s31, s53, 0
s_waitcnt lgkmcnt(8)
buffer_store_dwordx4 v[104:107], v172, s[4:7], s31 offen sc1
s_add_u32 s31, s53, 4608
s_waitcnt lgkmcnt(6)
buffer_store_dwordx4 v[108:111], v172, s[4:7], s31 offen sc1
s_add_u32 s31, s53, 9216
s_waitcnt lgkmcnt(4)
buffer_store_dwordx4 v[112:115], v172, s[4:7], s31 offen sc1
s_add_u32 s31, s53, 13824
s_waitcnt lgkmcnt(2)
buffer_store_dwordx4 v[116:119], v172, s[4:7], s31 offen sc1
s_add_u32 s31, s53, 18432
s_waitcnt lgkmcnt(0)
buffer_store_dwordx4 v[120:123], v37, s[4:7], s31 offen sc1
buffer_store_dwordx2 v[50:51], v36, s[4:7], s53 offen sc1
s_branch L_p0_j4
L_p0_a4:
ds_read_b64_tr_b16 v[104:105], v45 offset:40960
ds_read_b64_tr_b16 v[106:107], v45 offset:41472
ds_read_b64_tr_b16 v[108:109], v45 offset:45056
ds_read_b64_tr_b16 v[110:111], v45 offset:45568
ds_read_b64_tr_b16 v[112:113], v45 offset:49152
ds_read_b64_tr_b16 v[114:115], v45 offset:49664
ds_read_b64_tr_b16 v[116:117], v45 offset:53248
ds_read_b64_tr_b16 v[118:119], v45 offset:53760
ds_read_b64_tr_b16 v[120:121], v45 offset:57344
ds_read_b64_tr_b16 v[122:123], v45 offset:57856
v_mov_b32 v36, 1073741824
v_mov_b32 v46, 0
v_cndmask_b32 v37, v36, v172, s[50:51]
s_add_u32 s31, s53, 0
s_waitcnt lgkmcnt(8)
buffer_store_dwordx4 v[104:107], v172, s[4:7], s31 offen sc1
s_add_u32 s31, s53, 1024
s_waitcnt lgkmcnt(6)
buffer_store_dwordx4 v[108:111], v172, s[4:7], s31 offen sc1
s_add_u32 s31, s53, 2048
s_waitcnt lgkmcnt(4)
buffer_store_dwordx4 v[112:115], v172, s[4:7], s31 offen sc1
s_add_u32 s31, s53, 3072
s_waitcnt lgkmcnt(2)
buffer_store_dwordx4 v[116:119], v172, s[4:7], s31 offen sc1
s_add_u32 s31, s53, 4096
s_waitcnt lgkmcnt(0)
buffer_store_dwordx4 v[120:123], v37, s[4:7], s31 offen sc1
v_mov_b32 v37, 0x3f803f80
v_dot2c_f32_bf16 v46, v104, v37
v_dot2c_f32_bf16 v46, v105, v37
v_dot2c_f32_bf16 v46, v106, v37
v_dot2c_f32_bf16 v46, v107, v37
v_dot2c_f32_bf16 v46, v108, v37
v_dot2c_f32_bf16 v46, v109, v37
v_dot2c_f32_bf16 v46, v110, v37
v_dot2c_f32_bf16 v46, v111, v37
v_dot2c_f32_bf16 v46, v112, v37
v_dot2c_f32_bf16 v46, v113, v37
v_dot2c_f32_bf16 v46, v114, v37
v_dot2c_f32_bf16 v46, v115, v37
v_dot2c_f32_bf16 v46, v116, v37
v_dot2c_f32_bf16 v46, v117, v37
v_dot2c_f32_bf16 v46, v118, v37
v_dot2c_f32_bf16 v46, v119, v37
v_dot2c_f32_bf16 v46, v120, v37
v_dot2c_f32_bf16 v46, v121, v37
v_dot2c_f32_bf16 v46, v122, v37
v_dot2c_f32_bf16 v46, v123, v37
s_nop 2
v_mov_b32 v37, v46
s_nop 1
v_permlane32_swap_b32 v46, v37
v_add_f32 v46, v46, v37
v_mov_b32 v37, v46
s_nop 1
v_permlane16_swap_b32 v46, v37
v_add_f32 v46, v46, v37
v_cvt_pk_bf16_f32 v50, v46, v46
v_and_b32 v37, 0xffff0000, v50
v_sub_f32 v37, v46, v37
v_cvt_pk_bf16_f32 v51, v37, v37
v_cndmask_b32 v36, v36, v173, s[46:47]
buffer_store_dwordx2 v[50:51], v36, s[4:7], s53 offen sc1
L_p0_j4:
s_mov_b32 s12, s74
s_mov_b32 s13, s75
s_mov_b32 s14, 8388608
s_mov_b32 s15, 0x20000
s_cmp_eq_u32 s24, 1
s_cselect_b32 s63, 0, 1073741824
s_add_u32 s63, s63, 19415040
s_mov_b32 exec_lo, 0x000f01ff
s_mov_b32 exec_hi, 0x00ffffff
buffer_load_dwordx2 v[176:177], v174, s[4:7], s63 offen sc1
s_mov_b64 exec, -1
s_cmp_eq_u32 s24, 1
s_cbranch_scc0 L_p0done_10
s_mov_b32 s31, 0
s_mov_b32 exec_lo, 0x000f01ff
s_mov_b32 exec_hi, 0x00ffffff
s_waitcnt vmcnt(0)
v_cmp_ne_u64 vcc, v[176:177], v[238:239]
s_nop 0
s_cbranch_vccz L_p0done_10
L_p0poll_9:
buffer_load_dwordx2 v[176:177], v174, s[4:7], s63 offen sc1
s_add_u32 s31, s31, 1
s_waitcnt vmcnt(0)
v_cmp_ne_u64 vcc, v[176:177], v[238:239]
s_cmp_gt_u32 s31, 200000
s_cbranch_scc1 L_p0done_10
s_cbranch_vccnz L_p0poll_9
L_p0done_10:
s_mov_b64 exec, -1
s_barrier
s_lshl_b32 s33, s25, 8
s_lshl_b32 s32, s24, 6
s_add_u32 s33, s33, s32
v_lshlrev_b32 v8, 1, v2
buffer_load_ushort v0, v8, s[20:23], s33 offen
buffer_load_ushort v249, v8, s[20:23], s33 offen offset:32
s_lshl_b32 s30, s27, 2
s_add_u32 s30, s30, s24
s_mul_i32 s30, s30, 18432
s_mul_i32 s31, s28, 2304
s_add_u32 s30, s30, s31
s_add_u32 s30, s30, 0
v_and_b32 v6, 1, v3
v_lshlrev_b32 v6, 3, v6
v_lshl_add_u32 v6, v2, 4, v6
buffer_load_dwordx4 v[36:39], v1, s[8:11], s30 offen sc1
buffer_load_dwordx4 v[40:43], v1, s[8:11], s30 offen offset:1024 sc1
buffer_load_dwordx2 v[44:45], v6, s[8:11], s30 offen offset:2048 sc1
s_mul_i32 s36, s26, 132608
s_mul_i32 s38, s24, 12288
s_add_u32 m0, s38, 0
s_add_u32 s39, s38, s36
buffer_load_dwordx4 v1, s[4:7], s39 offen offset:0 sc1 lds
buffer_load_dwordx4 v1, s[4:7], s39 offen offset:1024 sc1 lds
buffer_load_dwordx4 v1, s[4:7], s39 offen offset:2048 sc1 lds
buffer_load_dwordx4 v1, s[4:7], s39 offen offset:3072 sc1 lds
s_add_u32 m0, m0, 4096
s_add_u32 s39, s39, 4096
buffer_load_dwordx4 v1, s[4:7], s39 offen offset:0 sc1 lds
buffer_load_dwordx4 v1, s[4:7], s39 offen offset:1024 sc1 lds
buffer_load_dwordx4 v1, s[4:7], s39 offen offset:2048 sc1 lds
buffer_load_dwordx4 v1, s[4:7], s39 offen offset:3072 sc1 lds
s_add_u32 m0, m0, 4096
s_add_u32 s39, s39, 4096
buffer_load_dwordx4 v1, s[4:7], s39 offen offset:0 sc1 lds
buffer_load_dwordx4 v1, s[4:7], s39 offen offset:1024 sc1 lds
buffer_load_dwordx4 v1, s[4:7], s39 offen offset:2048 sc1 lds
buffer_load_dwordx4 v1, s[4:7], s39 offen offset:3072 sc1 lds
v_and_b32 v6, 1, v2
v_cmp_eq_u32 s[40:41], 1, v6
v_lshl_add_u32 v6, v3, 2, v6
v_cmp_le_u32 s[42:43], v6, v2
v_add_u32 v6, 2, v6
v_cmp_le_u32 s[44:45], v6, v2
v_mov_b32 v6, 0x0c0c0100
v_mov_b32 v7, 0x01000c0c
v_cndmask_b32 v6, v6, v7, s[40:41]
v_mov_b32 v8, 0x0c0c0c0c
v_cndmask_b32 v10, v6, v8, s[42:43]
v_cndmask_b32 v12, v8, v6, s[42:43]
v_mov_b32 v6, 0x0c0c0302
v_mov_b32 v7, 0x03020c0c
v_cndmask_b32 v6, v6, v7, s[40:41]
v_cndmask_b32 v11, v6, v8, s[44:45]
v_cndmask_b32 v13, v8, v6, s[44:45]
s_mul_i32 s82, s26, 340992
s_add_u32 s82, s82, 2785280
s_mul_i32 s83, s28, 331776
s_add_u32 s83, s83, 8241152
s_and_b32 s30, s27, 1
s_mul_i32 s30, s30, 165888
s_add_u32 s83, s83, s30
s_waitcnt vmcnt(12)
v_lshlrev_b32 v16, 16, v36
v_and_b32 v17, 0xffff0000, v36
v_lshlrev_b32 v18, 16, v37
v_and_b32 v19, 0xffff0000, v37
v_lshlrev_b32 v20, 16, v38
v_and_b32 v21, 0xffff0000, v38
v_lshlrev_b32 v22, 16, v39
v_and_b32 v23, 0xffff0000, v39
v_lshlrev_b32 v24, 16, v40
v_and_b32 v25, 0xffff0000, v40
v_lshlrev_b32 v26, 16, v41
v_and_b32 v27, 0xffff0000, v41
v_lshlrev_b32 v28, 16, v42
v_and_b32 v29, 0xffff0000, v42
v_lshlrev_b32 v30, 16, v43
v_and_b32 v31, 0xffff0000, v43
v_lshlrev_b32 v32, 16, v44
v_and_b32 v33, 0xffff0000, v44
v_lshlrev_b32 v34, 16, v45
v_and_b32 v35, 0xffff0000, v45
v_mov_b32 v6, 0
s_barrier
v_mov_b32 v248, v238
s_mov_b64 exec, 1
buffer_store_dwordx2 v[238:239], v6, s[4:7], s100 offen sc1
s_mov_b64 exec, -1
s_mul_i32 s36, s26, 132608
s_mul_i32 s38, s24, 9216
s_add_u32 m0, s38, 49152
s_add_u32 s39, s38, s36
s_add_u32 s39, s39, 49152
buffer_load_dwordx4 v1, s[4:7], s39 offen offset:0 sc1 lds
buffer_load_dwordx4 v1, s[4:7], s39 offen offset:1024 sc1 lds
buffer_load_dwordx4 v1, s[4:7], s39 offen offset:2048 sc1 lds
buffer_load_dwordx4 v1, s[4:7], s39 offen offset:3072 sc1 lds
s_add_u32 m0, m0, 4096
s_add_u32 s39, s39, 4096
buffer_load_dwordx4 v1, s[4:7], s39 offen offset:0 sc1 lds
buffer_load_dwordx4 v1, s[4:7], s39 offen offset:1024 sc1 lds
buffer_load_dwordx4 v1, s[4:7], s39 offen offset:2048 sc1 lds
buffer_load_dwordx4 v1, s[4:7], s39 offen offset:3072 sc1 lds
s_add_u32 m0, m0, 4096
s_add_u32 s39, s39, 4096
buffer_load_dwordx4 v1, s[4:7], s39 offen offset:0 sc1 lds
s_lshl_b32 s60, s25, 3
s_sub_u32 s61, s60, 1
s_max_i32 s61, s61, 0
s_lshl_b32 s30, s24, 1
s_add_u32 s60, s60, s30
s_mul_i32 s30, s61, 18432
s_mul_i32 s62, s60, 18432
v_add_u32 v237, 18432, v1
s_mul_i32 s38, s24, 5120
s_add_u32 m0, s38, 135168
s_add_u32 s39, s38, s30
L_layer:
buffer_load_dwordx4 v1, s[8:11], s39 offen offset:0 sc1 lds
buffer_load_dwordx4 v1, s[8:11], s39 offen offset:1024 sc1 lds
buffer_load_dwordx4 v1, s[8:11], s39 offen offset:2048 sc1 lds
buffer_load_dwordx4 v1, s[8:11], s39 offen offset:3072 sc1 lds
s_add_u32 m0, m0, 4096
s_add_u32 s39, s39, 4096
buffer_load_dwordx4 v1, s[8:11], s39 offen offset:0 sc1 lds
s_barrier
buffer_load_dwordx4 a[0:3], v1, s[8:11], s62 offen offset:0 sc1
buffer_load_dwordx4 a[4:7], v237, s[8:11], s62 offen offset:0 sc1
s_barrier
buffer_load_dwordx4 a[8:11], v1, s[8:11], s62 offen offset:1024 sc1
buffer_load_dwordx4 a[12:15], v237, s[8:11], s62 offen offset:1024 sc1
s_barrier
buffer_load_dwordx4 a[16:19], v1, s[8:11], s62 offen offset:2048 sc1
buffer_load_dwordx4 a[20:23], v237, s[8:11], s62 offen offset:2048 sc1
s_barrier
buffer_load_dwordx4 a[24:27], v1, s[8:11], s62 offen offset:3072 sc1
buffer_load_dwordx4 a[28:31], v237, s[8:11], s62 offen offset:3072 sc1
s_barrier
s_add_u32 s62, s62, 4096
buffer_load_dwordx4 a[32:35], v1, s[8:11], s62 offen offset:0 sc1
buffer_load_dwordx4 a[36:39], v237, s[8:11], s62 offen offset:0 sc1
s_barrier
buffer_load_dwordx4 a[40:43], v1, s[8:11], s62 offen offset:1024 sc1
buffer_load_dwordx4 a[44:47], v237, s[8:11], s62 offen offset:1024 sc1
s_sub_u32 s30, s60, 2
v_add_u32 v6, s30, v3
v_max_i32 v6, 0, v6
v_mov_b32 v7, s61
v_cndmask_b32 v6, v6, v7, s[46:47]
v_lshl_add_u32 v6, v6, 4, v2
v_lshlrev_b32 v129, 3, v6
s_lshl_b32 s30, s24, 10
v_add_u32 v125, s30, v1
v_add_u32 v126, 135168, v1
v_lshrrev_b32 v127, 1, v1
v_add_u32 v127, 129024, v127
s_lshl_b32 s30, s24, 9
v_add_u32 v128, s30, v127
v_add_u32 v8, 64512, v1
s_waitcnt vmcnt(12)
s_barrier
ds_read_b128 a[144:147], v1 offset:0
ds_read_b128 a[148:151], v1 offset:1024
ds_read_b128 a[152:155], v1 offset:2048
ds_read_b128 a[156:159], v1 offset:3072
ds_read_b128 a[160:163], v1 offset:4096
ds_read_b128 a[164:167], v1 offset:5120
ds_read_b128 a[168:171], v1 offset:6144
ds_read_b128 a[172:175], v125 offset:0
ds_read_b128 a[176:179], v126 offset:0
v_lshrrev_b32 v146, 1, v1
s_lshl_b32 s66, s24, 9
s_add_u32 s66, s66, 19447808
s_waitcnt vmcnt(10) lgkmcnt(0)
v_mfma_f32_16x16x32_bf16 v[36:39], a[144:147], a[0:3], 0
ds_read_b128 a[180:183], v1 offset:7168
buffer_load_dwordx4 a[48:51], v1, s[8:11], s62 offen offset:2048 sc1
v_mfma_f32_16x16x32_bf16 v[64:67], a[144:147], a[4:7], 0
ds_read_b128 a[184:187], v1 offset:8192
v_mfma_f32_16x16x32_bf16 v[40:43], a[148:151], a[0:3], 0
ds_read_b128 a[188:191], v1 offset:9216
v_mfma_f32_16x16x32_bf16 v[68:71], a[148:151], a[4:7], 0
ds_read_b128 a[192:195], v1 offset:10240
v_mfma_f32_16x16x32_bf16 v[44:47], a[152:155], a[0:3], 0
ds_read_b128 a[196:199], v1 offset:11264
buffer_load_dwordx4 a[52:55], v237, s[8:11], s62 offen offset:2048 sc1
v_mfma_f32_16x16x32_bf16 v[72:75], a[152:155], a[4:7], 0
ds_read_b128 a[200:203], v1 offset:12288
v_mfma_f32_16x16x32_bf16 v[48:51], a[156:159], a[0:3], 0
ds_read_b128 a[204:207], v1 offset:13312
v_mfma_f32_16x16x32_bf16 v[76:79], a[156:159], a[4:7], 0
ds_read_b128 a[208:211], v125 offset:7168
v_mfma_f32_16x16x32_bf16 v[52:55], a[160:163], a[0:3], 0
ds_read_b128 a[212:215], v126 offset:1024
buffer_load_dwordx4 a[56:59], v1, s[8:11], s62 offen offset:3072 sc1
v_mfma_f32_16x16x32_bf16 v[80:83], a[160:163], a[4:7], 0
v_mfma_f32_16x16x32_bf16 v[92:95], a[172:175], a[176:179], 0
v_mfma_f32_16x16x32_bf16 v[96:99], a[160:163], a[176:179], 0
v_mfma_f32_16x16x32_bf16 v[56:59], a[164:167], a[0:3], 0
buffer_load_dwordx4 a[60:63], v237, s[8:11], s62 offen offset:3072 sc1
v_mfma_f32_16x16x32_bf16 v[84:87], a[164:167], a[4:7], 0
s_add_u32 s62, s62, 4096
v_mfma_f32_16x16x32_bf16 v[60:63], a[168:171], a[0:3], 0
v_mfma_f32_16x16x32_bf16 v[88:91], a[168:171], a[4:7], 0
s_waitcnt vmcnt(12) lgkmcnt(0)
v_mfma_f32_16x16x32_bf16 v[36:39], a[180:183], a[8:11], v[36:39]
ds_read_b128 a[144:147], v1 offset:14336
v_lshlrev_b32 v124, 2, v2
v_mfma_f32_16x16x32_bf16 v[64:67], a[180:183], a[12:15], v[64:67]
ds_read_b128 a[148:151], v1 offset:15360
v_and_b32 v6, 1, v2
v_mfma_f32_16x16x32_bf16 v[40:43], a[184:187], a[8:11], v[40:43]
ds_read_b128 a[152:155], v1 offset:16384
v_mfma_f32_16x16x32_bf16 v[68:71], a[184:187], a[12:15], v[68:71]
ds_read_b128 a[156:159], v1 offset:17408
v_lshl_add_u32 v6, v3, 2, v6
v_mfma_f32_16x16x32_bf16 v[44:47], a[188:191], a[8:11], v[44:47]
ds_read_b128 a[160:163], v1 offset:18432
v_lshlrev_b32 v6, 2, v6
v_mfma_f32_16x16x32_bf16 v[72:75], a[188:191], a[12:15], v[72:75]
ds_read_b128 a[164:167], v1 offset:19456
buffer_load_dwordx4 a[64:67], v1, s[8:11], s62 offen offset:0 sc1
v_mfma_f32_16x16x32_bf16 v[48:51], a[192:195], a[8:11], v[48:51]
ds_read_b128 a[168:171], v1 offset:20480
v_add_u32 v122, 64, v6
v_mfma_f32_16x16x32_bf16 v[76:79], a[192:195], a[12:15], v[76:79]
ds_read_b128 a[172:175], v125 offset:14336
v_mfma_f32_16x16x32_bf16 v[52:55], a[196:199], a[8:11], v[52:55]
ds_read_b128 a[176:179], v126 offset:2048
v_add_u32 v7, 128, v6
v_mfma_f32_16x16x32_bf16 v[80:83], a[196:199], a[12:15], v[80:83]
buffer_load_dwordx4 a[68:71], v237, s[8:11], s62 offen offset:0 sc1
v_cndmask_b32 v122, v122, v7, s[42:43]
v_mfma_f32_16x16x32_bf16 v[92:95], a[208:211], a[212:215], v[92:95]
v_mfma_f32_16x16x32_bf16 v[96:99], a[196:199], a[212:215], v[96:99]
v_add_u32 v123, 72, v6
v_mfma_f32_16x16x32_bf16 v[56:59], a[200:203], a[8:11], v[56:59]
v_mfma_f32_16x16x32_bf16 v[84:87], a[200:203], a[12:15], v[84:87]
v_add_u32 v7, 136, v6
v_mfma_f32_16x16x32_bf16 v[60:63], a[204:207], a[8:11], v[60:63]
buffer_load_dwordx4 a[72:75], v1, s[8:11], s62 offen offset:1024 sc1
v_cndmask_b32 v123, v123, v7, s[44:45]
v_mfma_f32_16x16x32_bf16 v[88:91], a[204:207], a[12:15], v[88:91]
s_mov_b32 s63, 2359296
s_waitcnt vmcnt(13) lgkmcnt(0)
v_mfma_f32_16x16x32_bf16 v[36:39], a[144:147], a[16:19], v[36:39]
ds_read_b128 a[180:183], v1 offset:21504
s_lshl_b32 s31, s24, 5
v_mfma_f32_16x16x32_bf16 v[64:67], a[144:147], a[20:23], v[64:67]
ds_read_b128 a[184:187], v1 offset:22528
v_mfma_f32_16x16x32_bf16 v[40:43], a[148:151], a[16:19], v[40:43]
ds_read_b128 a[188:191], v1 offset:23552
v_add_u32 v6, s31, v2
v_mfma_f32_16x16x32_bf16 v[68:71], a[148:151], a[20:23], v[68:71]
ds_read_b128 a[192:195], v1 offset:24576
v_mul_u32_u24 v220, 176, v6
v_mfma_f32_16x16x32_bf16 v[44:47], a[152:155], a[16:19], v[44:47]
ds_read_b128 a[196:199], v1 offset:25600
v_mfma_f32_16x16x32_bf16 v[72:75], a[152:155], a[20:23], v[72:75]
ds_read_b128 a[200:203], v1 offset:26624
v_add_u32 v220, 0, v220
v_mfma_f32_16x16x32_bf16 v[48:51], a[156:159], a[16:19], v[48:51]
ds_read_b128 a[204:207], v1 offset:27648
buffer_load_dwordx2 v[100:101], v129, s[8:11], s63 offen sc1
v_mfma_f32_16x16x32_bf16 v[76:79], a[156:159], a[20:23], v[76:79]
ds_read_b128 a[208:211], v125 offset:21504
v_lshl_add_u32 v218, v3, 3, v220
v_mfma_f32_16x16x32_bf16 v[52:55], a[160:163], a[16:19], v[52:55]
ds_read_b128 a[212:215], v126 offset:3072
s_mul_i32 s36, s26, 132608
v_mfma_f32_16x16x32_bf16 v[80:83], a[160:163], a[20:23], v[80:83]
s_mov_b32 s63, 2375680
v_mul_u32_u24 v219, 176, v2
v_mfma_f32_16x16x32_bf16 v[92:95], a[172:175], a[176:179], v[92:95]
s_mul_i32 s38, s24, 12288
v_lshl_add_u32 v219, v3, 3, v219
v_mfma_f32_16x16x32_bf16 v[96:99], a[160:163], a[176:179], v[96:99]
s_add_u32 m0, s38, 86016
v_mfma_f32_16x16x32_bf16 v[56:59], a[164:167], a[16:19], v[56:59]
s_add_u32 s39, s38, s36
v_add_u32 v219, 0, v219
v_mfma_f32_16x16x32_bf16 v[84:87], a[164:167], a[20:23], v[84:87]
s_add_u32 s39, s39, 86016
v_add_u32 v222, s31, v219
v_mfma_f32_16x16x32_bf16 v[60:63], a[168:171], a[16:19], v[60:63]
v_mfma_f32_16x16x32_bf16 v[88:91], a[168:171], a[20:23], v[88:91]
buffer_load_dwordx2 v[102:103], v129, s[8:11], s63 offen sc1
s_waitcnt vmcnt(13) lgkmcnt(0)
v_mfma_f32_16x16x32_bf16 v[36:39], a[180:183], a[24:27], v[36:39]
ds_read_b128 a[144:147], v1 offset:28672
v_lshrrev_b32 v6, 2, v2
v_mfma_f32_16x16x32_bf16 v[64:67], a[180:183], a[28:31], v[64:67]
ds_read_b128 a[148:151], v1 offset:29696
v_lshl_add_u32 v6, v3, 2, v6
v_mfma_f32_16x16x32_bf16 v[40:43], a[184:187], a[24:27], v[40:43]
ds_read_b128 a[152:155], v1 offset:30720
v_add_u32 v6, s31, v6
v_mfma_f32_16x16x32_bf16 v[68:71], a[184:187], a[28:31], v[68:71]
ds_read_b128 a[156:159], v1 offset:31744
s_mov_b32 s63, 2392064
v_mfma_f32_16x16x32_bf16 v[44:47], a[188:191], a[24:27], v[44:47]
ds_read_b128 a[160:163], v1 offset:32768
v_mul_u32_u24 v221, 176, v6
v_mfma_f32_16x16x32_bf16 v[72:75], a[188:191], a[28:31], v[72:75]
ds_read_b128 a[164:167], v1 offset:33792
v_and_b32 v6, 3, v2
v_mfma_f32_16x16x32_bf16 v[48:51], a[192:195], a[24:27], v[48:51]
ds_read_b128 a[168:171], v1 offset:34816
v_mfma_f32_16x16x32_bf16 v[76:79], a[192:195], a[28:31], v[76:79]
ds_read_b128 a[172:175], v125 offset:28672
buffer_load_dwordx2 v[104:105], v129, s[8:11], s63 offen sc1
v_mfma_f32_16x16x32_bf16 v[52:55], a[196:199], a[24:27], v[52:55]
ds_read_b128 a[176:179], v126 offset:4096
v_lshl_add_u32 v221, v6, 3, v221
v_mfma_f32_16x16x32_bf16 v[80:83], a[196:199], a[28:31], v[80:83]
s_mov_b32 s63, 2408448
v_add_u32 v221, 0, v221
v_mfma_f32_16x16x32_bf16 v[92:95], a[208:211], a[212:215], v[92:95]
v_mov_b32 v171, 0
v_mfma_f32_16x16x32_bf16 v[96:99], a[196:199], a[212:215], v[96:99]
v_mfma_f32_16x16x32_bf16 v[56:59], a[200:203], a[24:27], v[56:59]
buffer_load_dwordx4 v1, s[4:7], s39 offen offset:0 sc1 lds
v_mov_b32 v172, 0
v_mfma_f32_16x16x32_bf16 v[84:87], a[200:203], a[28:31], v[84:87]
v_mfma_f32_16x16x32_bf16 v[60:63], a[204:207], a[24:27], v[60:63]
v_mov_b32 v179, 0
v_mfma_f32_16x16x32_bf16 v[88:91], a[204:207], a[28:31], v[88:91]
v_mov_b32 v180, 0
s_waitcnt vmcnt(13) lgkmcnt(0)
v_mfma_f32_16x16x32_bf16 v[36:39], a[144:147], a[32:35], v[36:39]
ds_read_b128 a[180:183], v1 offset:35840
buffer_load_dwordx2 v[106:107], v129, s[8:11], s63 offen sc1
v_mfma_f32_16x16x32_bf16 v[64:67], a[144:147], a[36:39], v[64:67]
ds_read_b128 a[184:187], v1 offset:36864
buffer_load_dwordx4 v1, s[4:7], s39 offen offset:1024 sc1 lds
v_mfma_f32_16x16x32_bf16 v[40:43], a[148:151], a[32:35], v[40:43]
ds_read_b128 a[188:191], v1 offset:37888
s_mul_i32 s30, s60, 18432
v_mfma_f32_16x16x32_bf16 v[68:71], a[148:151], a[36:39], v[68:71]
ds_read_b128 a[192:195], v1 offset:38912
s_add_u32 s30, s30, 2490368
v_mfma_f32_16x16x32_bf16 v[44:47], a[152:155], a[32:35], v[44:47]
ds_read_b128 a[196:199], v1 offset:39936
buffer_load_dwordx4 v1, s[4:7], s39 offen offset:2048 sc1 lds
v_mfma_f32_16x16x32_bf16 v[72:75], a[152:155], a[36:39], v[72:75]
ds_read_b128 a[200:203], v1 offset:40960
s_mov_b32 s63, 2424832
v_mfma_f32_16x16x32_bf16 v[48:51], a[156:159], a[32:35], v[48:51]
ds_read_b128 a[204:207], v1 offset:41984
s_lshl_b32 s64, s26, 10
v_mfma_f32_16x16x32_bf16 v[76:79], a[156:159], a[36:39], v[76:79]
ds_read_b128 a[208:211], v125 offset:35840
s_add_u32 s64, s64, s30
v_mfma_f32_16x16x32_bf16 v[52:55], a[160:163], a[32:35], v[52:55]
ds_read_b128 a[212:215], v126 offset:5120
buffer_load_dwordx2 v[108:109], v129, s[8:11], s63 offen sc1
v_mfma_f32_16x16x32_bf16 v[80:83], a[160:163], a[36:39], v[80:83]
buffer_load_dwordx4 v1, s[4:7], s39 offen offset:3072 sc1 lds
s_and_b32 s65, s26, 1
v_mfma_f32_16x16x32_bf16 v[92:95], a[172:175], a[176:179], v[92:95]
s_mov_b32 s63, 2441216
s_lshl_b32 s65, s65, 10
v_mfma_f32_16x16x32_bf16 v[96:99], a[160:163], a[176:179], v[96:99]
s_add_u32 m0, m0, 4096
s_add_u32 s30, s30, s65
v_mfma_f32_16x16x32_bf16 v[56:59], a[164:167], a[32:35], v[56:59]
s_add_u32 s39, s39, 4096
v_mfma_f32_16x16x32_bf16 v[84:87], a[164:167], a[36:39], v[84:87]
s_lshr_b32 s65, s26, 1
v_mfma_f32_16x16x32_bf16 v[60:63], a[168:171], a[32:35], v[60:63]
s_lshl_b32 s65, s65, 7
v_mfma_f32_16x16x32_bf16 v[88:91], a[168:171], a[36:39], v[88:91]
s_add_u32 s65, s65, s30
s_waitcnt vmcnt(16) lgkmcnt(0)
v_mfma_f32_16x16x32_bf16 v[36:39], a[180:183], a[40:43], v[36:39]
ds_read_b128 a[144:147], v1 offset:43008
v_mfma_f32_16x16x32_bf16 v[64:67], a[180:183], a[44:47], v[64:67]
ds_read_b128 a[148:151], v1 offset:44032
buffer_load_dwordx2 v[110:111], v129, s[8:11], s63 offen sc1
v_mfma_f32_16x16x32_bf16 v[40:43], a[184:187], a[40:43], v[40:43]
ds_read_b128 a[152:155], v1 offset:45056
s_add_u32 s65, s65, 16384
v_mfma_f32_16x16x32_bf16 v[68:71], a[184:187], a[44:47], v[68:71]
ds_read_b128 a[156:159], v1 offset:46080
v_mov_b32 v224, 1073741824
v_mfma_f32_16x16x32_bf16 v[44:47], a[188:191], a[40:43], v[44:47]
ds_read_b128 a[160:163], v1 offset:47104
buffer_load_dwordx4 v1, s[4:7], s39 offen offset:0 sc1 lds
v_mfma_f32_16x16x32_bf16 v[72:75], a[188:191], a[44:47], v[72:75]
ds_read_b128 a[164:167], v1 offset:48128
s_mov_b32 s63, 2457600
v_mfma_f32_16x16x32_bf16 v[48:51], a[192:195], a[40:43], v[48:51]
ds_read_b128 a[168:171], v1 offset:49152
v_lshlrev_b32 v225, 3, v2
v_mfma_f32_16x16x32_bf16 v[76:79], a[192:195], a[44:47], v[76:79]
ds_read_b128 a[172:175], v125 offset:43008
v_cndmask_b32 v224, v224, v225, s[46:47]
v_mfma_f32_16x16x32_bf16 v[52:55], a[196:199], a[40:43], v[52:55]
ds_read_b128 a[176:179], v126 offset:6144
buffer_load_dwordx4 v1, s[4:7], s39 offen offset:1024 sc1 lds
v_mfma_f32_16x16x32_bf16 v[80:83], a[196:199], a[44:47], v[80:83]
v_add_u32 v225, 18432, v224
v_mfma_f32_16x16x32_bf16 v[92:95], a[208:211], a[212:215], v[92:95]
buffer_load_dwordx2 v[112:113], v129, s[8:11], s63 offen sc1
s_lshl_b32 s68, s24, 13
v_mfma_f32_16x16x32_bf16 v[96:99], a[196:199], a[212:215], v[96:99]
s_mov_b32 s63, 2473984
v_add_u32 v6, 0, v3
v_mfma_f32_16x16x32_bf16 v[56:59], a[200:203], a[40:43], v[56:59]
buffer_load_dwordx4 v1, s[4:7], s39 offen offset:2048 sc1 lds
v_mfma_f32_16x16x32_bf16 v[84:87], a[200:203], a[44:47], v[84:87]
v_xor_b32 v7, v6, v2
v_mfma_f32_16x16x32_bf16 v[60:63], a[204:207], a[40:43], v[60:63]
v_mfma_f32_16x16x32_bf16 v[88:91], a[204:207], a[44:47], v[88:91]
v_lshlrev_b32 v6, 12, v6
s_waitcnt vmcnt(19) lgkmcnt(0)
v_mfma_f32_16x16x32_bf16 v[36:39], a[144:147], a[48:51], v[36:39]
ds_read_b128 a[180:183], v1 offset:50176
buffer_load_dwordx4 v1, s[4:7], s39 offen offset:3072 sc1 lds
v_mfma_f32_16x16x32_bf16 v[64:67], a[144:147], a[52:55], v[64:67]
ds_read_b128 a[184:187], v1 offset:51200
v_lshl_add_u32 v240, v7, 4, v6
v_mfma_f32_16x16x32_bf16 v[40:43], a[148:151], a[48:51], v[40:43]
ds_read_b128 a[188:191], v1 offset:52224
buffer_load_dwordx2 v[114:115], v129, s[8:11], s63 offen sc1
v_mfma_f32_16x16x32_bf16 v[68:71], a[148:151], a[52:55], v[68:71]
ds_read_b128 a[192:195], v1 offset:53248
v_lshlrev_b32 v7, 4, v7
v_mfma_f32_16x16x32_bf16 v[44:47], a[152:155], a[48:51], v[44:47]
ds_read_b128 a[196:199], v1 offset:54272
s_add_u32 m0, m0, 4096
v_mfma_f32_16x16x32_bf16 v[72:75], a[152:155], a[52:55], v[72:75]
ds_read_b128 a[200:203], v1 offset:55296
v_lshl_add_u32 v7, v2, 8, v7
v_mfma_f32_16x16x32_bf16 v[48:51], a[156:159], a[48:51], v[48:51]
ds_read_b128 a[204:207], v1 offset:56320
buffer_load_dwordx4 a[76:79], v237, s[8:11], s62 offen offset:1024 sc1
v_mfma_f32_16x16x32_bf16 v[76:79], a[156:159], a[52:55], v[76:79]
ds_read_b128 a[208:211], v125 offset:50176
v_add_u32 v244, s68, v7
v_mfma_f32_16x16x32_bf16 v[52:55], a[160:163], a[48:51], v[52:55]
ds_read_b128 a[212:215], v126 offset:7168
s_add_u32 s39, s39, 4096
v_mfma_f32_16x16x32_bf16 v[80:83], a[160:163], a[52:55], v[80:83]
v_add_u32 v6, 4, v3
v_xor_b32 v7, v6, v2
v_mfma_f32_16x16x32_bf16 v[92:95], a[172:175], a[176:179], v[92:95]
v_lshlrev_b32 v6, 12, v6
v_mfma_f32_16x16x32_bf16 v[96:99], a[160:163], a[176:179], v[96:99]
buffer_load_dwordx4 a[80:83], v1, s[8:11], s62 offen offset:2048 sc1
v_mfma_f32_16x16x32_bf16 v[56:59], a[164:167], a[48:51], v[56:59]
buffer_load_dwordx4 v1, s[4:7], s39 offen offset:0 sc1 lds
v_lshl_add_u32 v241, v7, 4, v6
v_mfma_f32_16x16x32_bf16 v[84:87], a[164:167], a[52:55], v[84:87]
v_mfma_f32_16x16x32_bf16 v[60:63], a[168:171], a[48:51], v[60:63]
v_lshlrev_b32 v7, 4, v7
v_mfma_f32_16x16x32_bf16 v[88:91], a[168:171], a[52:55], v[88:91]
buffer_load_dwordx4 a[84:87], v237, s[8:11], s62 offen offset:2048 sc1
s_waitcnt vmcnt(23) lgkmcnt(0)
v_mfma_f32_16x16x32_bf16 v[36:39], a[180:183], a[56:59], v[36:39]
ds_read_b128 a[144:147], v1 offset:57344
buffer_load_dwordx4 v1, s[4:7], s39 offen offset:1024 sc1 lds
v_mfma_f32_16x16x32_bf16 v[64:67], a[180:183], a[60:63], v[64:67]
ds_read_b128 a[148:151], v1 offset:58368
v_lshl_add_u32 v7, v2, 8, v7
v_mfma_f32_16x16x32_bf16 v[40:43], a[184:187], a[56:59], v[40:43]
ds_read_b128 a[152:155], v1 offset:59392
v_add_u32 v245, s68, v7
v_mfma_f32_16x16x32_bf16 v[68:71], a[184:187], a[60:63], v[68:71]
ds_read_b128 a[156:159], v1 offset:60416
buffer_load_dwordx4 a[88:91], v1, s[8:11], s62 offen offset:3072 sc1
v_mfma_f32_16x16x32_bf16 v[44:47], a[188:191], a[56:59], v[44:47]
ds_read_b128 a[160:163], v1 offset:61440
buffer_load_dwordx4 v1, s[4:7], s39 offen offset:2048 sc1 lds
v_mfma_f32_16x16x32_bf16 v[72:75], a[188:191], a[60:63], v[72:75]
ds_read_b128 a[164:167], v1 offset:62464
v_subrev_u32 v241, 1024, v241
v_mfma_f32_16x16x32_bf16 v[48:51], a[192:195], a[56:59], v[48:51]
ds_read_b128 a[168:171], v1 offset:63488
v_add_u32 v6, 8, v3
v_mfma_f32_16x16x32_bf16 v[76:79], a[192:195], a[60:63], v[76:79]
ds_read_b128 a[172:175], v125 offset:57344
v_xor_b32 v7, v6, v2
v_mfma_f32_16x16x32_bf16 v[52:55], a[196:199], a[56:59], v[52:55]
ds_read_b128 a[176:179], v126 offset:8192
buffer_load_dwordx4 a[92:95], v237, s[8:11], s62 offen offset:3072 sc1
v_mfma_f32_16x16x32_bf16 v[80:83], a[196:199], a[60:63], v[80:83]
buffer_load_dwordx4 v1, s[4:7], s39 offen offset:3072 sc1 lds
v_lshlrev_b32 v6, 12, v6
v_mfma_f32_16x16x32_bf16 v[92:95], a[208:211], a[212:215], v[92:95]
s_add_u32 s62, s62, 4096
v_lshl_add_u32 v242, v7, 4, v6
v_mfma_f32_16x16x32_bf16 v[96:99], a[196:199], a[212:215], v[96:99]
v_lshlrev_b32 v7, 4, v7
v_mfma_f32_16x16x32_bf16 v[56:59], a[200:203], a[56:59], v[56:59]
buffer_load_dwordx2 v[148:149], v146, s[4:7], s66 offen sc1
v_lshl_add_u32 v7, v2, 8, v7
v_mfma_f32_16x16x32_bf16 v[84:87], a[200:203], a[60:63], v[84:87]
v_mfma_f32_16x16x32_bf16 v[60:63], a[204:207], a[56:59], v[60:63]
v_add_u32 v246, s68, v7
v_mfma_f32_16x16x32_bf16 v[88:91], a[204:207], a[60:63], v[88:91]
s_waitcnt vmcnt(27) lgkmcnt(0)
v_add_u32 v125, 64512, v125
v_mfma_f32_16x16x32_bf16 v[36:39], a[144:147], a[64:67], v[36:39]
ds_read_b128 a[180:183], v8 offset:0
buffer_load_dwordx4 a[96:99], v1, s[8:11], s62 offen offset:0 sc1
v_mfma_f32_16x16x32_bf16 v[64:67], a[144:147], a[68:71], v[64:67]
ds_read_b128 a[184:187], v8 offset:1024
v_subrev_u32 v242, 2048, v242
v_mfma_f32_16x16x32_bf16 v[40:43], a[148:151], a[64:67], v[40:43]
ds_read_b128 a[188:191], v8 offset:2048
v_add_u32 v6, 12, v3
v_mfma_f32_16x16x32_bf16 v[68:71], a[148:151], a[68:71], v[68:71]
ds_read_b128 a[192:195], v8 offset:3072
v_xor_b32 v7, v6, v2
v_mfma_f32_16x16x32_bf16 v[44:47], a[152:155], a[64:67], v[44:47]
ds_read_b128 a[196:199], v8 offset:4096
buffer_load_dwordx4 a[100:103], v237, s[8:11], s62 offen offset:0 sc1
v_mfma_f32_16x16x32_bf16 v[72:75], a[152:155], a[68:71], v[72:75]
ds_read_b128 a[200:203], v8 offset:5120
v_lshlrev_b32 v6, 12, v6
v_mfma_f32_16x16x32_bf16 v[48:51], a[156:159], a[64:67], v[48:51]
ds_read_b128 a[204:207], v8 offset:6144
v_lshl_add_u32 v243, v7, 4, v6
v_mfma_f32_16x16x32_bf16 v[76:79], a[156:159], a[68:71], v[76:79]
ds_read_b128 a[208:211], v125 offset:0
v_mfma_f32_16x16x32_bf16 v[52:55], a[160:163], a[64:67], v[52:55]
ds_read_b128 a[212:215], v126 offset:9216
v_lshlrev_b32 v7, 4, v7
v_mfma_f32_16x16x32_bf16 v[80:83], a[160:163], a[68:71], v[80:83]
buffer_load_dwordx4 a[104:107], v1, s[8:11], s62 offen offset:1024 sc1
v_mfma_f32_16x16x32_bf16 v[92:95], a[172:175], a[176:179], v[92:95]
v_lshl_add_u32 v7, v2, 8, v7
v_mfma_f32_16x16x32_bf16 v[96:99], a[160:163], a[176:179], v[96:99]
v_add_u32 v247, s68, v7
v_mfma_f32_16x16x32_bf16 v[56:59], a[164:167], a[64:67], v[56:59]
v_mfma_f32_16x16x32_bf16 v[84:87], a[164:167], a[68:71], v[84:87]
buffer_load_dwordx4 a[108:111], v237, s[8:11], s62 offen offset:1024 sc1
v_subrev_u32 v243, 3072, v243
v_mfma_f32_16x16x32_bf16 v[60:63], a[168:171], a[64:67], v[60:63]
v_mfma_f32_16x16x32_bf16 v[88:91], a[168:171], a[68:71], v[88:91]
s_waitcnt vmcnt(13) lgkmcnt(0)
v_mfma_f32_16x16x32_bf16 v[36:39], a[180:183], a[72:75], v[36:39]
ds_read_b128 a[144:147], v8 offset:7168
v_mfma_f32_16x16x32_bf16 v[64:67], a[180:183], a[76:79], v[64:67]
ds_read_b128 a[148:151], v8 offset:8192
buffer_load_dwordx4 a[112:115], v1, s[8:11], s62 offen offset:2048 sc1
v_mfma_f32_16x16x32_bf16 v[40:43], a[184:187], a[72:75], v[40:43]
ds_read_b128 a[152:155], v8 offset:9216
v_add_f32 v130, v100, v102
v_mfma_f32_16x16x32_bf16 v[68:71], a[184:187], a[76:79], v[68:71]
ds_read_b128 a[156:159], v8 offset:10240
v_add_f32 v131, v101, v103
v_mfma_f32_16x16x32_bf16 v[44:47], a[188:191], a[72:75], v[44:47]
ds_read_b128 a[160:163], v8 offset:11264
v_add_f32 v130, v130, v104
v_mfma_f32_16x16x32_bf16 v[72:75], a[188:191], a[76:79], v[72:75]
ds_read_b128 a[164:167], v8 offset:12288
v_add_f32 v131, v131, v105
v_mfma_f32_16x16x32_bf16 v[48:51], a[192:195], a[72:75], v[48:51]
ds_read_b128 a[168:171], v8 offset:13312
buffer_load_dwordx4 a[116:119], v237, s[8:11], s62 offen offset:2048 sc1
v_mfma_f32_16x16x32_bf16 v[76:79], a[192:195], a[76:79], v[76:79]
ds_read_b128 a[172:175], v125 offset:7168
v_add_f32 v130, v130, v106
v_mfma_f32_16x16x32_bf16 v[52:55], a[196:199], a[72:75], v[52:55]
ds_read_b128 a[176:179], v126 offset:10240
v_add_f32 v131, v131, v107
v_mfma_f32_16x16x32_bf16 v[80:83], a[196:199], a[76:79], v[80:83]
v_add_f32 v130, v130, v108
v_add_f32 v131, v131, v109
v_mfma_f32_16x16x32_bf16 v[92:95], a[208:211], a[212:215], v[92:95]
buffer_load_dwordx4 a[120:123], v1, s[8:11], s62 offen offset:3072 sc1
v_add_f32 v130, v130, v110
v_mfma_f32_16x16x32_bf16 v[96:99], a[196:199], a[212:215], v[96:99]
v_add_f32 v131, v131, v111
v_mfma_f32_16x16x32_bf16 v[56:59], a[200:203], a[72:75], v[56:59]
v_add_f32 v130, v130, v112
v_mfma_f32_16x16x32_bf16 v[84:87], a[200:203], a[76:79], v[84:87]
v_add_f32 v131, v131, v113
v_mfma_f32_16x16x32_bf16 v[60:63], a[204:207], a[72:75], v[60:63]
buffer_load_dwordx4 a[124:127], v237, s[8:11], s62 offen offset:3072 sc1
v_add_f32 v130, v130, v114
v_mfma_f32_16x16x32_bf16 v[88:91], a[204:207], a[76:79], v[88:91]
s_add_u32 s62, s62, 4096
v_add_f32 v131, v131, v115
s_waitcnt vmcnt(14) lgkmcnt(0)
v_mfma_f32_16x16x32_bf16 v[36:39], a[144:147], a[80:83], v[36:39]
ds_read_b128 a[180:183], v8 offset:14336
v_mul_f32 v130, 0x3ae38e39, v130
v_mfma_f32_16x16x32_bf16 v[64:67], a[144:147], a[84:87], v[64:67]
ds_read_b128 a[184:187], v8 offset:15360
v_mul_f32 v6, v130, v130
v_mfma_f32_16x16x32_bf16 v[40:43], a[148:151], a[80:83], v[40:43]
ds_read_b128 a[188:191], v8 offset:16384
v_mul_f32 v131, 0x3ae38e39, v131
v_mfma_f32_16x16x32_bf16 v[68:71], a[148:151], a[84:87], v[68:71]
ds_read_b128 a[192:195], v8 offset:17408
v_mfma_f32_16x16x32_bf16 v[44:47], a[152:155], a[80:83], v[44:47]
ds_read_b128 a[196:199], v8 offset:18432
v_sub_f32 v131, v131, v6
v_mfma_f32_16x16x32_bf16 v[72:75], a[152:155], a[84:87], v[72:75]
ds_read_b128 a[200:203], v8 offset:19456
v_max_f32 v131, 0, v131
v_mfma_f32_16x16x32_bf16 v[48:51], a[156:159], a[80:83], v[48:51]
ds_read_b128 a[204:207], v8 offset:20480
v_add_f32 v131, 0x3727c5ac, v131
v_mfma_f32_16x16x32_bf16 v[76:79], a[156:159], a[84:87], v[76:79]
ds_read_b128 a[208:211], v125 offset:14336
buffer_load_dwordx4 a[128:131], v1, s[8:11], s62 offen offset:0 sc1
v_mfma_f32_16x16x32_bf16 v[52:55], a[160:163], a[80:83], v[52:55]
ds_read_b128 a[212:215], v126 offset:11264
v_mfma_f32_16x16x32_bf16 v[80:83], a[160:163], a[84:87], v[80:83]
v_rsq_f32 v132, v131
v_mfma_f32_16x16x32_bf16 v[92:95], a[172:175], a[176:179], v[92:95]
v_cvt_pk_bf16_f32 v6, -v130, -v130
v_and_b32 v6, 0xffff0000, v6
v_mfma_f32_16x16x32_bf16 v[96:99], a[160:163], a[176:179], v[96:99]
buffer_load_dwordx4 a[132:135], v237, s[8:11], s62 offen offset:0 sc1
v_add_f32 v6, v130, v6
v_mfma_f32_16x16x32_bf16 v[56:59], a[164:167], a[80:83], v[56:59]
v_cvt_pk_bf16_f32 v133, -v130, -v6
v_mfma_f32_16x16x32_bf16 v[84:87], a[164:167], a[84:87], v[84:87]
v_mfma_f32_16x16x32_bf16 v[60:63], a[168:171], a[80:83], v[60:63]
v_mfma_f32_16x16x32_bf16 v[88:91], a[168:171], a[84:87], v[88:91]
s_waitcnt vmcnt(10) lgkmcnt(0)
v_cmp_ne_u64 vcc, v[148:149], v[238:239]
s_cmp_eq_u32 s29, 0
s_cselect_b64 vcc, vcc, 0
s_cbranch_vccnz L_dbslow_11
L_dbback_12:
s_barrier
v_mfma_f32_16x16x32_bf16 v[36:39], a[180:183], a[88:91], v[36:39]
ds_read_b128 a[144:147], v8 offset:21504
buffer_load_dwordx4 a[136:139], v1, s[8:11], s62 offen offset:1024 sc1
v_mfma_f32_16x16x32_bf16 v[64:67], a[180:183], a[92:95], v[64:67]
ds_read_b128 a[148:151], v8 offset:22528
v_mfma_f32_16x16x32_bf16 v[40:43], a[184:187], a[88:91], v[40:43]
ds_read_b128 a[152:155], v8 offset:23552
s_add_u32 m0, s68, 0
v_mfma_f32_16x16x32_bf16 v[68:71], a[184:187], a[92:95], v[68:71]
ds_read_b128 a[156:159], v8 offset:24576
v_mfma_f32_16x16x32_bf16 v[44:47], a[188:191], a[88:91], v[44:47]
ds_read_b128 a[160:163], v8 offset:25600
buffer_load_dwordx4 a[140:143], v237, s[8:11], s62 offen offset:1024 sc1
v_mfma_f32_16x16x32_bf16 v[72:75], a[188:191], a[92:95], v[72:75]
ds_read_b128 a[164:167], v8 offset:26624
s_add_u32 s3, s3, 0
v_mfma_f32_16x16x32_bf16 v[48:51], a[192:195], a[88:91], v[48:51]
ds_read_b128 a[168:171], v8 offset:27648
v_mfma_f32_16x16x32_bf16 v[76:79], a[192:195], a[92:95], v[76:79]
ds_read_b128 a[172:175], v125 offset:21504
buffer_load_dwordx4 v240, s[12:15], s3 offen offset:0 nt lds
v_mfma_f32_16x16x32_bf16 v[52:55], a[196:199], a[88:91], v[52:55]
ds_read_b128 a[176:179], v126 offset:12288
s_mov_b32 s37, L_c2-L_pc
v_mfma_f32_16x16x32_bf16 v[80:83], a[196:199], a[92:95], v[80:83]
ds_bpermute_b32 v116, v124, v133 offset:128
v_mfma_f32_16x16x32_bf16 v[92:95], a[208:211], a[212:215], v[92:95]
ds_bpermute_b32 v118, v124, v133 offset:192
buffer_load_dwordx4 v241, s[12:15], s3 offen offset:1024 nt lds
v_mfma_f32_16x16x32_bf16 v[96:99], a[196:199], a[212:215], v[96:99]
ds_bpermute_b32 v120, v124, v133
v_mfma_f32_16x16x32_bf16 v[56:59], a[200:203], a[88:91], v[56:59]
buffer_load_dword v15, v14, s[88:91], s37 offen
ds_bpermute_b32 v134, v124, v132 offset:128
v_mfma_f32_16x16x32_bf16 v[84:87], a[200:203], a[92:95], v[84:87]
ds_bpermute_b32 v135, v124, v132 offset:192
buffer_load_dwordx4 v242, s[12:15], s3 offen offset:2048 nt lds
v_mfma_f32_16x16x32_bf16 v[60:63], a[204:207], a[88:91], v[60:63]
v_mfma_f32_16x16x32_bf16 v[88:91], a[204:207], a[92:95], v[88:91]
buffer_load_dwordx4 v243, s[12:15], s3 offen offset:3072 nt lds
s_waitcnt vmcnt(15) lgkmcnt(0)
v_mfma_f32_16x16x32_bf16 v[36:39], a[144:147], a[96:99], v[36:39]
ds_read_b128 a[180:183], v8 offset:28672
v_mfma_f32_16x16x32_bf16 v[64:67], a[144:147], a[100:103], v[64:67]
ds_read_b128 a[184:187], v8 offset:29696
v_mfma_f32_16x16x32_bf16 v[40:43], a[148:151], a[96:99], v[40:43]
ds_read_b128 a[188:191], v8 offset:30720
s_add_u32 m0, s68, 4096
v_mfma_f32_16x16x32_bf16 v[68:71], a[148:151], a[100:103], v[68:71]
ds_read_b128 a[192:195], v8 offset:31744
v_mfma_f32_16x16x32_bf16 v[44:47], a[152:155], a[96:99], v[44:47]
ds_read_b128 a[196:199], v8 offset:32768
s_add_u32 s3, s3, 65536
v_mfma_f32_16x16x32_bf16 v[72:75], a[152:155], a[100:103], v[72:75]
ds_read_b128 a[200:203], v8 offset:33792
v_mfma_f32_16x16x32_bf16 v[48:51], a[156:159], a[96:99], v[48:51]
ds_read_b128 a[204:207], v8 offset:34816
v_mfma_f32_16x16x32_bf16 v[76:79], a[156:159], a[100:103], v[76:79]
ds_read_b128 a[208:211], v125 offset:28672
buffer_load_dwordx4 v240, s[12:15], s3 offen offset:0 nt lds
v_mfma_f32_16x16x32_bf16 v[52:55], a[160:163], a[96:99], v[52:55]
ds_read_b128 a[212:215], v126 offset:13312
v_mfma_f32_16x16x32_bf16 v[80:83], a[160:163], a[100:103], v[80:83]
ds_bpermute_b32 v136, v122, v132 offset:0
v_mfma_f32_16x16x32_bf16 v[92:95], a[172:175], a[176:179], v[92:95]
ds_bpermute_b32 v137, v123, v132 offset:0
buffer_load_dwordx4 v241, s[12:15], s3 offen offset:1024 nt lds
v_mfma_f32_16x16x32_bf16 v[96:99], a[160:163], a[176:179], v[96:99]
ds_bpermute_b32 v138, v122, v132 offset:64
v_mfma_f32_16x16x32_bf16 v[56:59], a[164:167], a[96:99], v[56:59]
ds_bpermute_b32 v139, v123, v132 offset:64
buffer_load_dwordx4 v242, s[12:15], s3 offen offset:2048 nt lds
v_mfma_f32_16x16x32_bf16 v[84:87], a[164:167], a[100:103], v[84:87]
v_mfma_f32_16x16x32_bf16 v[60:63], a[168:171], a[96:99], v[60:63]
v_mfma_f32_16x16x32_bf16 v[88:91], a[168:171], a[100:103], v[88:91]
buffer_load_dwordx4 v243, s[12:15], s3 offen offset:3072 nt lds
s_waitcnt vmcnt(17) lgkmcnt(0)
v_mfma_f32_16x16x32_bf16 v[36:39], a[180:183], a[104:107], v[36:39]
ds_read_b128 a[144:147], v8 offset:35840
v_mov_b32 v117, v116
v_mfma_f32_16x16x32_bf16 v[64:67], a[180:183], a[108:111], v[64:67]
ds_read_b128 a[148:151], v8 offset:36864
v_mfma_f32_16x16x32_bf16 v[40:43], a[184:187], a[104:107], v[40:43]
ds_read_b128 a[152:155], v8 offset:37888
s_mov_b32 s3, 1073741824
v_mfma_f32_16x16x32_bf16 v[68:71], a[184:187], a[108:111], v[68:71]
ds_read_b128 a[156:159], v8 offset:38912
v_mov_b32 v119, v118
v_mfma_f32_16x16x32_bf16 v[44:47], a[188:191], a[104:107], v[44:47]
ds_read_b128 a[160:163], v8 offset:39936
v_mov_b32 v121, v120
v_mfma_f32_16x16x32_bf16 v[72:75], a[188:191], a[108:111], v[72:75]
ds_read_b128 a[164:167], v8 offset:40960
s_mul_i32 s36, s28, 82944
v_mfma_f32_16x16x32_bf16 v[48:51], a[192:195], a[104:107], v[48:51]
ds_read_b128 a[168:171], v8 offset:41984
v_mfma_f32_16x16x32_bf16 v[76:79], a[192:195], a[108:111], v[76:79]
ds_read_b128 a[172:175], v125 offset:35840
v_mul_f32 v134, 0x3eae1a93, v134
v_mfma_f32_16x16x32_bf16 v[52:55], a[196:199], a[104:107], v[52:55]
ds_read_b128 a[176:179], v126 offset:14336
s_mul_i32 s38, s24, 8192
v_mfma_f32_16x16x32_bf16 v[80:83], a[196:199], a[108:111], v[80:83]
ds_read_b64 a[0:1], v127 offset:0
v_mul_f32 v135, 0x3eae1a93, v135
v_mfma_f32_16x16x32_bf16 v[92:95], a[208:211], a[212:215], v[92:95]
ds_read_b64 a[2:3], v127 offset:512
v_mfma_f32_16x16x32_bf16 v[96:99], a[196:199], a[212:215], v[96:99]
s_add_u32 m0, s38, 37888
v_mul_f32 v140, v134, v136
v_mfma_f32_16x16x32_bf16 v[56:59], a[200:203], a[104:107], v[56:59]
ds_read_b64 a[4:5], v127 offset:1024
v_mfma_f32_16x16x32_bf16 v[84:87], a[200:203], a[108:111], v[84:87]
ds_read_b64 a[6:7], v127 offset:1536
v_mfma_f32_16x16x32_bf16 v[60:63], a[204:207], a[104:107], v[60:63]
s_add_u32 s39, s38, s36
v_mul_f32 v141, v134, v137
v_mfma_f32_16x16x32_bf16 v[88:91], a[204:207], a[108:111], v[88:91]
s_add_u32 s39, s39, 2121728
s_waitcnt vmcnt(15) lgkmcnt(0)
v_mfma_f32_16x16x32_bf16 v[36:39], a[144:147], a[112:115], v[36:39]
ds_read_b128 a[180:183], v8 offset:43008
v_mul_f32 v142, v135, v138
v_mfma_f32_16x16x32_bf16 v[64:67], a[144:147], a[116:119], v[64:67]
ds_read_b128 a[184:187], v8 offset:44032
v_mfma_f32_16x16x32_bf16 v[40:43], a[148:151], a[112:115], v[40:43]
ds_read_b128 a[188:191], v8 offset:45056
v_mul_f32 v143, v135, v139
v_mfma_f32_16x16x32_bf16 v[68:71], a[148:151], a[116:119], v[68:71]
ds_read_b128 a[192:195], v8 offset:46080
v_mfma_f32_16x16x32_bf16 v[44:47], a[152:155], a[112:115], v[44:47]
ds_read_b128 a[196:199], v8 offset:47104
v_mfma_f32_16x16x32_bf16 v[72:75], a[152:155], a[116:119], v[72:75]
ds_read_b128 a[200:203], v8 offset:48128
v_mfma_f32_16x16x32_bf16 v[48:51], a[156:159], a[112:115], v[48:51]
ds_read_b128 a[204:207], v8 offset:49152
v_mfma_f32_16x16x32_bf16 v[76:79], a[156:159], a[116:119], v[76:79]
ds_read_b128 a[208:211], v125 offset:43008
v_mfma_f32_16x16x32_bf16 v[52:55], a[160:163], a[112:115], v[52:55]
ds_read_b128 a[212:215], v126 offset:15360
buffer_load_dwordx4 v1, s[4:7], s39 offen offset:0 sc1 lds
v_mfma_f32_16x16x32_bf16 v[80:83], a[160:163], a[116:119], v[80:83]
ds_read_b64 a[8:9], v127 offset:2048
v_mfma_f32_16x16x32_bf16 v[92:95], a[172:175], a[176:179], v[92:95]
ds_read_b64 a[10:11], v127 offset:2560
v_mfma_f32_16x16x32_bf16 v[96:99], a[160:163], a[176:179], v[96:99]
s_cmp_eq_u32 s60, 0
s_cselect_b32 s30, 0xf149f2ca, 0
v_mov_b32 v6, s30
v_mfma_f32_16x16x32_bf16 v[56:59], a[164:167], a[112:115], v[56:59]
ds_read_b64 a[12:13], v127 offset:3072
buffer_load_dwordx4 v1, s[4:7], s39 offen offset:1024 sc1 lds
v_mfma_f32_16x16x32_bf16 v[84:87], a[164:167], a[116:119], v[84:87]
ds_read_b64 a[14:15], v128
v_cndmask_b32 v144, v6, 0, s[42:43]
v_mfma_f32_16x16x32_bf16 v[60:63], a[168:171], a[112:115], v[60:63]
v_cndmask_b32 v145, v6, 0, s[44:45]
v_mfma_f32_16x16x32_bf16 v[88:91], a[168:171], a[116:119], v[88:91]
s_waitcnt vmcnt(15) lgkmcnt(0)
v_mfma_f32_16x16x32_bf16 v[36:39], a[180:183], a[120:123], v[36:39]
ds_read_b128 a[144:147], v8 offset:50176
buffer_load_dwordx4 v1, s[4:7], s39 offen offset:2048 sc1 lds
v_mfma_f32_16x16x32_bf16 v[64:67], a[180:183], a[124:127], v[64:67]
ds_read_b128 a[148:151], v8 offset:51200
v_mfma_f32_16x16x32_bf16 v[40:43], a[184:187], a[120:123], v[40:43]
ds_read_b128 a[152:155], v8 offset:52224
v_mfma_f32_16x16x32_bf16 v[68:71], a[184:187], a[124:127], v[68:71]
ds_read_b128 a[156:159], v8 offset:53248
buffer_load_dwordx4 v1, s[4:7], s39 offen offset:3072 sc1 lds
v_mfma_f32_16x16x32_bf16 v[44:47], a[188:191], a[120:123], v[44:47]
ds_read_b128 a[160:163], v8 offset:54272
v_mfma_f32_16x16x32_bf16 v[72:75], a[188:191], a[124:127], v[72:75]
ds_read_b128 a[164:167], v8 offset:55296
v_mfma_f32_16x16x32_bf16 v[48:51], a[192:195], a[120:123], v[48:51]
ds_read_b128 a[168:171], v8 offset:56320
v_mfma_f32_16x16x32_bf16 v[76:79], a[192:195], a[124:127], v[76:79]
ds_read_b128 a[172:175], v125 offset:50176
s_add_u32 m0, m0, 4096
v_mfma_f32_16x16x32_bf16 v[52:55], a[196:199], a[120:123], v[52:55]
ds_read_b128 a[176:179], v126 offset:16384
s_waitcnt vmcnt(8)
v_mfma_f32_16x16x32_bf16 v[80:83], a[196:199], a[124:127], v[80:83]
ds_read_b128 a[224:227], v244 offset:0
v_mfma_f32_16x16x32_bf16 v[92:95], a[208:211], a[212:215], v[92:95]
ds_read_b128 a[228:231], v245 offset:0
v_mfma_f32_16x16x32_bf16 v[96:99], a[196:199], a[212:215], v[96:99]
s_add_u32 s39, s39, 4096
v_mfma_f32_16x16x32_bf16 v[56:59], a[200:203], a[120:123], v[56:59]
ds_read_b128 a[232:235], v246 offset:0
v_mfma_f32_16x16x32_bf16 v[84:87], a[200:203], a[124:127], v[84:87]
ds_read_b128 a[236:239], v247 offset:0
v_mfma_f32_16x16x32_bf16 v[60:63], a[204:207], a[120:123], v[60:63]
v_mfma_f32_16x16x32_bf16 v[88:91], a[204:207], a[124:127], v[88:91]
buffer_load_dwordx4 v1, s[4:7], s39 offen offset:0 sc1 lds
s_waitcnt lgkmcnt(0)
v_mfma_f32_16x16x32_bf16 v[36:39], a[144:147], a[128:131], v[36:39]
ds_read_b128 a[180:183], v8 offset:57344
v_mfma_f32_16x16x32_bf16 v[64:67], a[144:147], a[132:135], v[64:67]
ds_read_b128 a[184:187], v8 offset:58368
v_mfma_f32_16x16x32_bf16 v[40:43], a[148:151], a[128:131], v[40:43]
ds_read_b128 a[188:191], v8 offset:59392
v_mfma_f32_16x16x32_bf16 v[68:71], a[148:151], a[132:135], v[68:71]
ds_read_b128 a[192:195], v8 offset:60416
buffer_load_dwordx4 v1, s[4:7], s39 offen offset:1024 sc1 lds
v_mfma_f32_16x16x32_bf16 v[44:47], a[152:155], a[128:131], v[44:47]
ds_read_b128 a[196:199], v8 offset:61440
v_mfma_f32_16x16x32_bf16 v[72:75], a[152:155], a[132:135], v[72:75]
ds_read_b128 a[200:203], v8 offset:62464
v_mfma_f32_16x16x32_bf16 v[48:51], a[156:159], a[128:131], v[48:51]
ds_read_b128 a[204:207], v8 offset:63488
v_mfma_f32_16x16x32_bf16 v[76:79], a[156:159], a[132:135], v[76:79]
ds_read_b128 a[208:211], v125 offset:57344
buffer_load_dwordx4 v1, s[4:7], s39 offen offset:2048 sc1 lds
v_mfma_f32_16x16x32_bf16 v[52:55], a[160:163], a[128:131], v[52:55]
ds_read_b128 a[212:215], v126 offset:17408
s_waitcnt vmcnt(7)
v_mfma_f32_16x16x32_bf16 v[80:83], a[160:163], a[132:135], v[80:83]
ds_read_b128 a[240:243], v244 offset:4096
v_mfma_f32_16x16x32_bf16 v[92:95], a[172:175], a[176:179], v[92:95]
ds_read_b128 a[244:247], v245 offset:4096
v_mfma_f32_16x16x32_bf16 v[96:99], a[160:163], a[176:179], v[96:99]
ds_read_b128 a[248:251], v246 offset:4096
buffer_load_dwordx4 v1, s[4:7], s39 offen offset:3072 sc1 lds
v_mfma_f32_16x16x32_bf16 v[56:59], a[164:167], a[128:131], v[56:59]
ds_read_b128 a[252:255], v247 offset:4096
v_mfma_f32_16x16x32_bf16 v[84:87], a[164:167], a[132:135], v[84:87]
v_mfma_f32_16x16x32_bf16 v[60:63], a[168:171], a[128:131], v[60:63]
v_mfma_f32_16x16x32_bf16 v[88:91], a[168:171], a[132:135], v[88:91]
s_waitcnt lgkmcnt(0)
s_barrier
v_mfma_f32_16x16x32_bf16 v[36:39], a[180:183], a[136:139], v[36:39]
v_mfma_f32_16x16x32_bf16 v[64:67], a[180:183], a[140:143], v[64:67]
v_mfma_f32_16x16x16_bf16 v[36:39], a[0:1], v[116:117], v[36:39]
v_mfma_f32_16x16x16_bf16 v[64:67], a[0:1], v[118:119], v[64:67]
v_mfma_f32_16x16x32_bf16 v[40:43], a[184:187], a[136:139], v[40:43]
v_mfma_f32_16x16x32_bf16 v[68:71], a[184:187], a[140:143], v[68:71]
s_nop 1
v_mfma_f32_16x16x16_bf16 v[40:43], a[2:3], v[116:117], v[40:43]
s_nop 1
v_mfma_f32_16x16x16_bf16 v[68:71], a[2:3], v[118:119], v[68:71]
v_cvt_pk_bf16_f32 v156, v36, v37
v_cvt_pk_bf16_f32 v157, v38, v39
v_mfma_f32_16x16x32_bf16 v[44:47], a[188:191], a[136:139], v[44:47]
ds_write_b64 v218, v[156:157] offset:2816
v_mfma_f32_16x16x32_bf16 v[72:75], a[188:191], a[140:143], v[72:75]
v_cvt_pk_bf16_f32 v162, v64, v65
v_cvt_pk_bf16_f32 v163, v66, v67
v_mfma_f32_16x16x16_bf16 v[44:47], a[4:5], v[116:117], v[44:47]
ds_write_b64 v218, v[162:163] offset:5632
v_mfma_f32_16x16x16_bf16 v[72:75], a[4:5], v[118:119], v[72:75]
v_cvt_pk_bf16_f32 v160, v40, v41
v_cvt_pk_bf16_f32 v161, v42, v43
v_mfma_f32_16x16x32_bf16 v[48:51], a[192:195], a[136:139], v[48:51]
ds_write_b64 v218, v[160:161] offset:2848
v_mfma_f32_16x16x32_bf16 v[76:79], a[192:195], a[140:143], v[76:79]
v_cvt_pk_bf16_f32 v166, v68, v69
v_cvt_pk_bf16_f32 v167, v70, v71
v_mfma_f32_16x16x16_bf16 v[48:51], a[6:7], v[116:117], v[48:51]
ds_write_b64 v218, v[166:167] offset:5664
v_mfma_f32_16x16x16_bf16 v[76:79], a[6:7], v[118:119], v[76:79]
v_cvt_pk_bf16_f32 v202, v44, v45
v_cvt_pk_bf16_f32 v203, v46, v47
v_mfma_f32_16x16x32_bf16 v[52:55], a[196:199], a[136:139], v[52:55]
ds_write_b64 v218, v[202:203] offset:2880
v_mfma_f32_16x16x32_bf16 v[80:83], a[196:199], a[140:143], v[80:83]
v_cvt_pk_bf16_f32 v204, v72, v73
v_cvt_pk_bf16_f32 v205, v74, v75
v_mfma_f32_16x16x16_bf16 v[52:55], a[8:9], v[116:117], v[52:55]
ds_write_b64 v218, v[204:205] offset:5696
v_mfma_f32_16x16x16_bf16 v[80:83], a[8:9], v[118:119], v[80:83]
v_cvt_pk_bf16_f32 v206, v48, v49
v_cvt_pk_bf16_f32 v207, v50, v51
v_mfma_f32_16x16x32_bf16 v[92:95], a[208:211], a[212:215], v[92:95]
ds_write_b64 v218, v[206:207] offset:2912
v_mfma_f32_16x16x32_bf16 v[96:99], a[196:199], a[212:215], v[96:99]
v_cvt_pk_bf16_f32 v208, v76, v77
v_cvt_pk_bf16_f32 v209, v78, v79
v_mfma_f32_16x16x16_bf16 v[92:95], a[14:15], v[120:121], v[92:95]
ds_write_b64 v218, v[208:209] offset:5728
v_mfma_f32_16x16x16_bf16 v[96:99], a[8:9], v[120:121], v[96:99]
v_cvt_pk_bf16_f32 v210, v52, v53
v_cvt_pk_bf16_f32 v211, v54, v55
v_mfma_f32_16x16x32_bf16 v[56:59], a[200:203], a[136:139], v[56:59]
ds_write_b64 v218, v[210:211] offset:2944
v_mfma_f32_16x16x32_bf16 v[84:87], a[200:203], a[140:143], v[84:87]
v_cvt_pk_bf16_f32 v212, v80, v81
v_cvt_pk_bf16_f32 v213, v82, v83
v_mfma_f32_16x16x16_bf16 v[56:59], a[10:11], v[116:117], v[56:59]
ds_write_b64 v218, v[212:213] offset:5760
v_mfma_f32_16x16x16_bf16 v[84:87], a[10:11], v[118:119], v[84:87]
v_cvt_pk_bf16_f32 v214, v92, v93
v_cvt_pk_bf16_f32 v215, v94, v95
v_mfma_f32_16x16x32_bf16 v[60:63], a[204:207], a[136:139], v[60:63]
ds_write_b64 v222, v[214:215]
v_mfma_f32_16x16x32_bf16 v[88:91], a[204:207], a[140:143], v[88:91]
v_cvt_pk_bf16_f32 v216, v96, v97
v_cvt_pk_bf16_f32 v217, v98, v99
v_mfma_f32_16x16x16_bf16 v[60:63], a[12:13], v[116:117], v[60:63]
ds_write_b64 v219, v[216:217] offset:128
v_mfma_f32_16x16x16_bf16 v[88:91], a[12:13], v[118:119], v[88:91]
s_waitcnt lgkmcnt(0)
s_barrier
ds_read_b64 v[150:151], v218
ds_read_b64 v[154:155], v218 offset:32
ds_read_b64 v[152:153], v220 offset:136
ds_read_b64 v[158:159], v220 offset:2952
ds_read_b64 v[164:165], v220 offset:5768
s_mul_i32 s36, s28, 82944
s_mul_i32 s38, s24, 13312
s_add_u32 m0, s38, 70656
s_add_u32 s39, s38, s36
s_add_u32 s39, s39, 2154496
buffer_load_dwordx4 v1, s[4:7], s39 offen offset:0 sc1 lds
buffer_load_dwordx4 v1, s[4:7], s39 offen offset:1024 sc1 lds
v_cndmask_b32 v170, 0, v210, s[48:49]
v_cndmask_b32 v173, 0, v211, s[48:49]
v_cndmask_b32 v178, 0, v212, s[48:49]
v_cndmask_b32 v181, 0, v213, s[48:49]
v_cvt_pk_bf16_f32 v168, v56, v57
v_cvt_pk_bf16_f32 v169, v58, v59
v_cvt_pk_bf16_f32 v176, v84, v85
v_cvt_pk_bf16_f32 v177, v86, v87
v_cvt_pk_bf16_f32 v174, v60, v61
v_cvt_pk_bf16_f32 v175, v62, v63
v_cvt_pk_bf16_f32 v182, v88, v89
v_cvt_pk_bf16_f32 v183, v90, v91
s_waitcnt lgkmcnt(0)
ds_read_b64_tr_b16 v[184:185], v221 offset:64
v_mfma_f32_16x16x32_bf16 v[36:39], v[150:153], v[168:171], 0
ds_read_b64_tr_b16 v[186:187], v221 offset:2880
v_mfma_f32_16x16x32_bf16 v[40:43], v[156:159], v[168:171], 0
ds_read_b64_tr_b16 v[188:189], v221 offset:5696
buffer_load_dwordx4 v1, s[4:7], s39 offen offset:2048 sc1 lds
v_mfma_f32_16x16x32_bf16 v[44:47], v[152:155], v[172:175], 0
ds_read_b64_tr_b16 v[190:191], v221 offset:96
v_mfma_f32_16x16x32_bf16 v[48:51], v[158:161], v[172:175], 0
ds_read_b64_tr_b16 v[192:193], v221 offset:2912
buffer_load_dwordx4 v1, s[4:7], s39 offen offset:3072 sc1 lds
v_mfma_f32_16x16x32_bf16 v[52:55], v[156:159], v[176:179], 0
ds_read_b64_tr_b16 v[194:195], v221 offset:5728
v_mfma_f32_16x16x32_bf16 v[56:59], v[162:165], v[176:179], 0
ds_read_b64_tr_b16 v[196:197], v221 offset:128
s_add_u32 m0, m0, 4096
s_add_u32 s39, s39, 4096
buffer_load_dwordx4 v1, s[4:7], s39 offen offset:0 sc1 lds
v_mfma_f32_16x16x32_bf16 v[60:63], v[158:161], v[180:183], 0
ds_read_b64_tr_b16 v[198:199], v221 offset:2944
v_mfma_f32_16x16x32_bf16 v[64:67], v[164:167], v[180:183], 0
ds_read_b64_tr_b16 v[200:201], v221 offset:5760
buffer_load_dwordx4 v1, s[4:7], s39 offen offset:1024 sc1 lds
v_cndmask_b32 v36, v36, v37, s[40:41]
v_cndmask_b32 v40, v40, v41, s[40:41]
v_cndmask_b32 v36, v36, v40, s[42:43]
v_fma_f32 v68, v36, v140, v144
v_cndmask_b32 v38, v38, v39, s[40:41]
v_cndmask_b32 v42, v42, v43, s[40:41]
v_cndmask_b32 v38, v38, v42, s[44:45]
buffer_load_dwordx4 v1, s[4:7], s39 offen offset:2048 sc1 lds
v_fma_f32 v69, v38, v141, v145
v_max_f32 v76, v68, v69
v_cndmask_b32 v44, v44, v45, s[40:41]
v_cndmask_b32 v48, v48, v49, s[40:41]
v_cndmask_b32 v44, v44, v48, s[42:43]
v_fma_f32 v70, v44, v140, v144
buffer_load_dwordx4 v1, s[4:7], s39 offen offset:3072 sc1 lds
v_cndmask_b32 v46, v46, v47, s[40:41]
v_cndmask_b32 v50, v50, v51, s[40:41]
v_cndmask_b32 v46, v46, v50, s[44:45]
v_fma_f32 v71, v46, v141, v145
v_max_f32 v77, v70, v71
v_cndmask_b32 v52, v52, v53, s[40:41]
s_add_u32 m0, m0, 4096
v_cndmask_b32 v56, v56, v57, s[40:41]
v_cndmask_b32 v52, v52, v56, s[42:43]
v_mul_f32 v72, v52, v142
v_cndmask_b32 v54, v54, v55, s[40:41]
v_cndmask_b32 v58, v58, v59, s[40:41]
v_cndmask_b32 v54, v54, v58, s[44:45]
s_add_u32 s39, s39, 4096
v_mul_f32 v73, v54, v143
v_max_f32 v78, v72, v73
v_cndmask_b32 v60, v60, v61, s[40:41]
v_cndmask_b32 v64, v64, v65, s[40:41]
v_cndmask_b32 v60, v60, v64, s[42:43]
v_mul_f32 v74, v60, v142
buffer_load_dwordx4 v1, s[4:7], s39 offen offset:0 sc1 lds
v_cndmask_b32 v62, v62, v63, s[40:41]
v_cndmask_b32 v66, v66, v67, s[40:41]
v_cndmask_b32 v62, v62, v66, s[44:45]
v_mul_f32 v75, v62, v143
v_max_f32 v79, v74, v75
s_nop 1
v_permlane32_swap_b32 v76, v77
buffer_load_dwordx4 v1, s[4:7], s39 offen offset:1024 sc1 lds
v_permlane32_swap_b32 v78, v79
v_max_f32 v76, v76, v77
v_max_f32 v78, v78, v79
s_nop 1
v_permlane16_swap_b32 v76, v78
v_max_f32 v76, v76, v78
buffer_load_dwordx4 v1, s[4:7], s39 offen offset:2048 sc1 lds
v_mov_b32 v78, v76
s_nop 1
v_permlane16_swap_b32 v76, v78
v_mov_b32 v77, v76
v_mov_b32 v79, v78
s_nop 0
buffer_load_dwordx4 v1, s[4:7], s39 offen offset:3072 sc1 lds
v_permlane32_swap_b32 v76, v77
v_permlane32_swap_b32 v78, v79
v_sub_f32 v68, v68, v76
v_sub_f32 v69, v69, v76
v_sub_f32 v70, v70, v77
v_sub_f32 v71, v71, v77
s_add_u32 m0, m0, 4096
v_sub_f32 v72, v72, v78
v_sub_f32 v73, v73, v78
v_sub_f32 v74, v74, v79
v_sub_f32 v75, v75, v79
v_exp_f32 v68, v68
v_exp_f32 v69, v69
s_add_u32 s39, s39, 4096
v_exp_f32 v70, v70
v_exp_f32 v71, v71
v_exp_f32 v72, v72
v_exp_f32 v73, v73
v_exp_f32 v74, v74
v_exp_f32 v75, v75
buffer_load_dwordx4 v1, s[4:7], s39 offen offset:0 sc1 lds
v_add_f32 v76, v68, v69
v_add_f32 v77, v70, v71
v_add_f32 v78, v72, v73
v_add_f32 v79, v74, v75
v_mul_f32 v68, v68, v136
v_mul_f32 v69, v69, v137
v_mul_f32 v70, v70, v136
v_mul_f32 v71, v71, v137
v_mul_f32 v72, v72, v138
v_mul_f32 v73, v73, v139
v_mul_f32 v74, v74, v138
v_mul_f32 v75, v75, v139
s_nop 1
v_permlane32_swap_b32 v76, v77
v_permlane32_swap_b32 v78, v79
v_add_f32 v76, v76, v77
v_add_f32 v78, v78, v79
s_nop 1
v_permlane16_swap_b32 v76, v78
v_add_f32 v76, v76, v78
v_rcp_f32 v76, v76
s_nop 0
v_mov_b32 v78, v76
s_nop 1
v_permlane16_swap_b32 v76, v78
v_mov_b32 v77, v76
v_mov_b32 v79, v78
s_nop 0
v_permlane32_swap_b32 v76, v77
v_permlane32_swap_b32 v78, v79
s_waitcnt lgkmcnt(0)
v_mul_f32 v68, v68, v76
v_mul_f32 v69, v69, v76
v_cvt_pk_bf16_f32 v68, v68, v69
v_perm_b32 v84, v68, v68, v10
v_perm_b32 v85, v68, v68, v11
v_perm_b32 v86, v68, v68, v12
v_perm_b32 v87, v68, v68, v13
v_mul_f32 v70, v70, v77
v_mul_f32 v71, v71, v77
v_mfma_f32_16x16x32_bf16 v[36:39], v[184:187], v[84:87], 0
v_cvt_pk_bf16_f32 v70, v70, v71
v_perm_b32 v88, v70, v70, v10
v_mfma_f32_16x16x32_bf16 v[40:43], v[196:199], v[84:87], 0
v_perm_b32 v89, v70, v70, v11
v_perm_b32 v90, v70, v70, v12
v_perm_b32 v91, v70, v70, v13
v_mul_f32 v72, v72, v78
v_mul_f32 v73, v73, v78
v_mfma_f32_16x16x32_bf16 v[44:47], v[190:193], v[88:91], 0
v_cvt_pk_bf16_f32 v72, v72, v73
v_perm_b32 v92, v72, v72, v10
v_mfma_f32_16x16x32_bf16 v[48:51], v[196:199], v[88:91], 0
v_perm_b32 v93, v72, v72, v11
v_perm_b32 v94, v72, v72, v12
v_perm_b32 v95, v72, v72, v13
v_mul_f32 v74, v74, v79
v_mul_f32 v75, v75, v79
v_mfma_f32_16x16x32_bf16 v[52:55], v[186:189], v[92:95], 0
v_cvt_pk_bf16_f32 v74, v74, v75
v_perm_b32 v96, v74, v74, v10
v_mfma_f32_16x16x32_bf16 v[56:59], v[198:201], v[92:95], 0
v_perm_b32 v97, v74, v74, v11
v_perm_b32 v98, v74, v74, v12
v_perm_b32 v99, v74, v74, v13
v_cvt_pk_bf16_f32 v168, v36, v37
v_cvt_pk_bf16_f32 v169, v38, v39
v_mfma_f32_16x16x32_bf16 v[60:63], v[192:195], v[96:99], 0
v_mfma_f32_16x16x32_bf16 v[64:67], v[198:201], v[96:99], 0
v_cvt_pk_bf16_f32 v172, v40, v41
v_cvt_pk_bf16_f32 v170, v44, v45
v_cvt_pk_bf16_f32 v171, v46, v47
v_cvt_pk_bf16_f32 v173, v50, v51
buffer_store_dwordx4 v[168:171], v1, s[8:11], s64 offen sc1
buffer_store_dwordx2 v[172:173], v224, s[8:11], s65 offen sc1
v_cvt_pk_bf16_f32 v176, v52, v53
v_cvt_pk_bf16_f32 v177, v54, v55
v_cvt_pk_bf16_f32 v180, v56, v57
v_cvt_pk_bf16_f32 v178, v60, v61
v_cvt_pk_bf16_f32 v179, v62, v63
v_cvt_pk_bf16_f32 v181, v66, v67
buffer_store_dwordx4 v[176:179], v237, s[8:11], s64 offen sc1
buffer_store_dwordx2 v[180:181], v225, s[8:11], s65 offen sc1
L_c2:
s_mul_i32 s38, s24, 9216
s_add_u32 m0, s38, 123904
s_add_u32 s39, s38, s82
buffer_load_dwordx4 v1, s[4:7], s39 offen offset:0 sc1 lds
buffer_load_dwordx4 v1, s[4:7], s39 offen offset:1024 sc1 lds
buffer_load_dwordx4 v1, s[4:7], s39 offen offset:2048 sc1 lds
buffer_load_dwordx4 v1, s[4:7], s39 offen offset:3072 sc1 lds
s_add_u32 m0, m0, 4096
s_add_u32 s39, s39, 4096
buffer_load_dwordx4 v1, s[4:7], s39 offen offset:0 sc1 lds
buffer_load_dwordx4 v1, s[4:7], s39 offen offset:1024 sc1 lds
buffer_load_dwordx4 v1, s[4:7], s39 offen offset:2048 sc1 lds
v_lshlrev_b32 v7, 3, v1
s_lshl_b32 s31, s25, 11
v_add_u32 v7, s31, v7
s_cmp_eq_u32 s24, 0
s_cselect_b32 s30, 0, 1073741824
s_add_u32 s30, s30, 26476544
s_waitcnt vmcnt(7)
s_barrier
s_mov_b64 exec, 0xffff
buffer_atomic_add v4, v7, s[8:11], s30 offen sc1
s_mov_b64 exec, -1
s_lshl_b32 s35, s81, 7
s_add_u32 s35, s35, 26476544
s_cmp_eq_u32 s24, 1
s_cselect_b32 s35, s35, 1073741824
v_mov_b32 v6, 0
v_mov_b32 v244, 0
v_mov_b32 v245, 0
v_mov_b32 v246, 0
buffer_load_dwordx4 v1, s[4:7], s39 offen offset:3072 sc1 lds
s_add_u32 m0, m0, 4096
s_add_u32 s39, s39, 4096
buffer_load_dwordx4 v1, s[4:7], s39 offen offset:0 sc1 lds
s_lshl_b32 s38, s24, 8
s_add_u32 m0, s38, 160768
s_add_u32 s39, s38, s82
s_add_u32 s39, s39, 36864
s_mov_b64 exec, 0xffff
buffer_load_dwordx4 v1, s[4:7], s39 offen sc1 lds
s_mov_b64 exec, -1
s_mul_i32 s38, s24, 9216
s_add_u32 m0, s38, 0
s_add_u32 s39, s38, s82
s_add_u32 s39, s39, 37888
buffer_load_dwordx4 v1, s[4:7], s39 offen offset:0 sc1 lds
s_mov_b64 exec, 1
buffer_atomic_add v244, v6, s[8:11], s35 offen sc0 sc1
s_mov_b64 exec, -1
buffer_load_dwordx4 v1, s[4:7], s39 offen offset:1024 sc1 lds
buffer_load_dwordx4 v1, s[4:7], s39 offen offset:2048 sc1 lds
buffer_load_dwordx4 v1, s[4:7], s39 offen offset:3072 sc1 lds
s_add_u32 m0, m0, 4096
s_add_u32 s39, s39, 4096
s_mov_b64 exec, 1
buffer_atomic_add v245, v6, s[8:11], s35 offen sc0 sc1
s_mov_b64 exec, -1
buffer_load_dwordx4 v1, s[4:7], s39 offen offset:0 sc1 lds
buffer_load_dwordx4 v1, s[4:7], s39 offen offset:1024 sc1 lds
buffer_load_dwordx4 v1, s[4:7], s39 offen offset:2048 sc1 lds
s_mov_b64 exec, 1
buffer_atomic_add v246, v6, s[8:11], s35 offen sc0 sc1
s_mov_b64 exec, -1
buffer_load_dwordx4 v1, s[4:7], s39 offen offset:3072 sc1 lds
s_add_u32 m0, m0, 4096
s_add_u32 s39, s39, 4096
buffer_load_dwordx4 v1, s[4:7], s39 offen offset:0 sc1 lds
s_lshl_b32 s38, s24, 8
s_add_u32 m0, s38, 36864
s_add_u32 s39, s38, s82
s_add_u32 s39, s39, 74752
s_mov_b64 exec, 0xffff
buffer_load_dwordx4 v1, s[4:7], s39 offen sc1 lds
s_mov_b64 exec, -1
s_lshl_b32 s60, s27, 2
s_add_u32 s60, s60, s24
s_mul_i32 s60, s60, 18432
s_add_u32 s60, s60, 2490368
s_cmp_eq_u32 s24, 1
s_cbranch_scc0 L_other_15
s_mov_b32 s31, 0
s_mov_b64 exec, 1
v_mov_b32 v247, 0
buffer_atomic_add v247, v6, s[8:11], s35 offen sc0 sc1
s_waitcnt vmcnt(12)
v_cmp_gt_u32 vcc, 16, v244
s_nop 0
s_cbranch_vccz L_polled_14
s_waitcnt vmcnt(8)
v_cmp_gt_u32 vcc, 16, v245
s_nop 0
s_cbranch_vccz L_polled_14
v_mov_b32 v244, 0
buffer_atomic_add v244, v6, s[8:11], s35 offen sc0 sc1
s_waitcnt vmcnt(5)
v_cmp_gt_u32 vcc, 16, v246
s_nop 0
s_cbranch_vccz L_polled_14
v_mov_b32 v245, 0
buffer_atomic_add v245, v6, s[8:11], s35 offen sc0 sc1
L_poll_13:
s_add_u32 s31, s31, 1
s_cmp_gt_u32 s31, 100000
s_cbranch_scc1 L_polled_14
v_mov_b32 v246, 0
buffer_atomic_add v246, v6, s[8:11], s35 offen sc0 sc1
s_waitcnt vmcnt(3)
v_cmp_gt_u32 vcc, 16, v247
s_nop 0
s_cbranch_vccz L_polled_14
v_mov_b32 v247, 0
buffer_atomic_add v247, v6, s[8:11], s35 offen sc0 sc1
s_waitcnt vmcnt(3)
v_cmp_gt_u32 vcc, 16, v244
s_nop 0
s_cbranch_vccz L_polled_14
v_mov_b32 v244, 0
buffer_atomic_add v244, v6, s[8:11], s35 offen sc0 sc1
s_waitcnt vmcnt(3)
v_cmp_gt_u32 vcc, 16, v245
s_nop 0
s_cbranch_vccz L_polled_14
v_mov_b32 v245, 0
buffer_atomic_add v245, v6, s[8:11], s35 offen sc0 sc1
s_waitcnt vmcnt(3)
v_cmp_gt_u32 vcc, 16, v246
s_nop 0
s_cbranch_vccz L_polled_14
s_branch L_poll_13
L_polled_14:
s_mov_b64 exec, -1
L_other_15:
s_barrier
buffer_load_dwordx4 a[0:3], v1, s[8:11], s60 offen offset:0 sc1
buffer_load_dwordx4 a[4:7], v1, s[8:11], s60 offen offset:1024 sc1
s_barrier
buffer_load_dwordx4 a[8:11], v1, s[8:11], s60 offen offset:2048 sc1
buffer_load_dwordx4 a[12:15], v1, s[8:11], s60 offen offset:3072 sc1
s_barrier
s_add_u32 s60, s60, 4096
buffer_load_dwordx4 a[16:19], v1, s[8:11], s60 offen offset:0 sc1
buffer_load_dwordx4 a[20:23], v1, s[8:11], s60 offen offset:1024 sc1
s_barrier
buffer_load_dwordx4 a[24:27], v1, s[8:11], s60 offen offset:2048 sc1
buffer_load_dwordx4 a[28:31], v1, s[8:11], s60 offen offset:3072 sc1
v_lshrrev_b32 v40, 1, v1
v_and_b32 v36, 7, v2
v_lshlrev_b32 v36, 4, v36
v_lshl_add_u32 v36, v3, 7, v36
v_add_u32 v36, 4096, v36
v_add_u32 v36, 37888, v36
v_add_u32 v39, 37888, v1
v_add_u32 v37, 79360, v1
v_add_u32 v38, 41472, v36
ds_read_b128 a[72:75], v39 offset:0
ds_read_b128 a[76:79], v39 offset:1024
ds_read_b128 a[80:83], v39 offset:2048
ds_read_b128 a[84:87], v39 offset:3072
ds_read_b128 a[88:91], v36 offset:0
ds_read_b128 a[92:95], v39 offset:4608
ds_read_b128 a[96:99], v39 offset:5632
ds_read_b128 a[100:103], v39 offset:6656
ds_read_b128 a[104:107], v39 offset:7680
ds_read_b128 a[108:111], v36 offset:4608
s_lshl_b32 s30, s27, 2
s_add_u32 s30, s30, s24
v_mov_b32 v58, 1073741824
s_mul_i32 s62, s30, 18432
s_mul_i32 s32, s28, 2304
s_add_u32 s62, s62, s32
s_add_u32 s62, s62, 4849664
v_mov_b32 v60, v1
v_add_u32 v61, 2048, v60
v_cndmask_b32 v61, v58, v61, s[46:47]
s_lshl_b32 s63, s30, 7
s_lshl_b32 s32, s28, 14
s_add_u32 s63, s63, s32
s_add_u32 s63, s63, 7208960
v_lshlrev_b32 v59, 3, v2
v_cndmask_b32 v58, v58, v59, s[46:47]
s_waitcnt vmcnt(7) lgkmcnt(5)
v_mfma_f32_16x16x32_bf16 v[16:19], a[72:75], a[0:3], v[16:19]
ds_read_b128 a[112:115], v39 offset:9216
s_add_u32 s60, s60, 4096
buffer_load_dwordx4 a[32:35], v1, s[8:11], s60 offen offset:0 sc1
v_mfma_f32_16x16x32_bf16 v[20:23], a[76:79], a[0:3], v[20:23]
ds_read_b128 a[116:119], v39 offset:10240
v_mfma_f32_16x16x32_bf16 v[24:27], a[80:83], a[0:3], v[24:27]
ds_read_b128 a[120:123], v39 offset:11264
v_mfma_f32_16x16x32_bf16 v[28:31], a[84:87], a[0:3], v[28:31]
ds_read_b128 a[124:127], v39 offset:12288
v_mfma_f32_16x16x32_bf16 v[32:35], a[88:91], a[0:3], v[32:35]
ds_read_b128 a[128:131], v36 offset:9216
s_waitcnt vmcnt(7) lgkmcnt(5)
v_mfma_f32_16x16x32_bf16 v[16:19], a[92:95], a[4:7], v[16:19]
ds_read_b128 a[72:75], v39 offset:13824
buffer_load_dwordx4 a[36:39], v1, s[8:11], s60 offen offset:1024 sc1
v_mfma_f32_16x16x32_bf16 v[20:23], a[96:99], a[4:7], v[20:23]
ds_read_b128 a[76:79], v39 offset:14848
v_mfma_f32_16x16x32_bf16 v[24:27], a[100:103], a[4:7], v[24:27]
ds_read_b128 a[80:83], v39 offset:15872
v_mfma_f32_16x16x32_bf16 v[28:31], a[104:107], a[4:7], v[28:31]
ds_read_b128 a[84:87], v39 offset:16896
v_mfma_f32_16x16x32_bf16 v[32:35], a[108:111], a[4:7], v[32:35]
ds_read_b128 a[88:91], v36 offset:13824
s_waitcnt vmcnt(7) lgkmcnt(5)
v_mfma_f32_16x16x32_bf16 v[16:19], a[112:115], a[8:11], v[16:19]
ds_read_b128 a[92:95], v39 offset:18432
buffer_load_dwordx4 a[40:43], v1, s[8:11], s60 offen offset:2048 sc1
v_mfma_f32_16x16x32_bf16 v[20:23], a[116:119], a[8:11], v[20:23]
ds_read_b128 a[96:99], v39 offset:19456
v_mfma_f32_16x16x32_bf16 v[24:27], a[120:123], a[8:11], v[24:27]
ds_read_b128 a[100:103], v39 offset:20480
v_mfma_f32_16x16x32_bf16 v[28:31], a[124:127], a[8:11], v[28:31]
ds_read_b128 a[104:107], v39 offset:21504
v_mfma_f32_16x16x32_bf16 v[32:35], a[128:131], a[8:11], v[32:35]
ds_read_b128 a[108:111], v36 offset:18432
s_waitcnt vmcnt(7) lgkmcnt(5)
v_mfma_f32_16x16x32_bf16 v[16:19], a[72:75], a[12:15], v[16:19]
ds_read_b128 a[112:115], v39 offset:23040
buffer_load_dwordx4 a[44:47], v1, s[8:11], s60 offen offset:3072 sc1
v_mfma_f32_16x16x32_bf16 v[20:23], a[76:79], a[12:15], v[20:23]
ds_read_b128 a[116:119], v39 offset:24064
v_mfma_f32_16x16x32_bf16 v[24:27], a[80:83], a[12:15], v[24:27]
ds_read_b128 a[120:123], v39 offset:25088
v_mfma_f32_16x16x32_bf16 v[28:31], a[84:87], a[12:15], v[28:31]
ds_read_b128 a[124:127], v39 offset:26112
v_mfma_f32_16x16x32_bf16 v[32:35], a[88:91], a[12:15], v[32:35]
ds_read_b128 a[128:131], v36 offset:23040
s_waitcnt vmcnt(7) lgkmcnt(5)
v_mfma_f32_16x16x32_bf16 v[16:19], a[92:95], a[16:19], v[16:19]
ds_read_b128 a[72:75], v39 offset:27648
s_add_u32 s60, s60, 4096
buffer_load_dwordx4 a[48:51], v1, s[8:11], s60 offen offset:0 sc1
v_mfma_f32_16x16x32_bf16 v[20:23], a[96:99], a[16:19], v[20:23]
ds_read_b128 a[76:79], v39 offset:28672
v_mfma_f32_16x16x32_bf16 v[24:27], a[100:103], a[16:19], v[24:27]
ds_read_b128 a[80:83], v39 offset:29696
v_mfma_f32_16x16x32_bf16 v[28:31], a[104:107], a[16:19], v[28:31]
ds_read_b128 a[84:87], v39 offset:30720
v_mfma_f32_16x16x32_bf16 v[32:35], a[108:111], a[16:19], v[32:35]
ds_read_b128 a[88:91], v36 offset:27648
s_waitcnt vmcnt(7) lgkmcnt(5)
v_mfma_f32_16x16x32_bf16 v[16:19], a[112:115], a[20:23], v[16:19]
ds_read_b128 a[92:95], v39 offset:32256
buffer_load_dwordx4 a[52:55], v1, s[8:11], s60 offen offset:1024 sc1
v_mfma_f32_16x16x32_bf16 v[20:23], a[116:119], a[20:23], v[20:23]
ds_read_b128 a[96:99], v39 offset:33280
v_mfma_f32_16x16x32_bf16 v[24:27], a[120:123], a[20:23], v[24:27]
ds_read_b128 a[100:103], v39 offset:34304
v_mfma_f32_16x16x32_bf16 v[28:31], a[124:127], a[20:23], v[28:31]
ds_read_b128 a[104:107], v39 offset:35328
v_mfma_f32_16x16x32_bf16 v[32:35], a[128:131], a[20:23], v[32:35]
ds_read_b128 a[108:111], v36 offset:32256
s_waitcnt vmcnt(7) lgkmcnt(5)
v_mfma_f32_16x16x32_bf16 v[16:19], a[72:75], a[24:27], v[16:19]
ds_read_b128 a[112:115], v39 offset:36864
buffer_load_dwordx4 a[56:59], v1, s[8:11], s60 offen offset:2048 sc1
v_mfma_f32_16x16x32_bf16 v[20:23], a[76:79], a[24:27], v[20:23]
ds_read_b128 a[116:119], v39 offset:37888
v_mfma_f32_16x16x32_bf16 v[24:27], a[80:83], a[24:27], v[24:27]
ds_read_b128 a[120:123], v39 offset:38912
v_mfma_f32_16x16x32_bf16 v[28:31], a[84:87], a[24:27], v[28:31]
ds_read_b128 a[124:127], v39 offset:39936
v_mfma_f32_16x16x32_bf16 v[32:35], a[88:91], a[24:27], v[32:35]
ds_read_b128 a[128:131], v36 offset:36864
s_waitcnt vmcnt(7) lgkmcnt(5)
v_mfma_f32_16x16x32_bf16 v[16:19], a[92:95], a[28:31], v[16:19]
ds_read_b128 a[72:75], v37 offset:0
buffer_load_dwordx4 a[60:63], v1, s[8:11], s60 offen offset:3072 sc1
v_mfma_f32_16x16x32_bf16 v[20:23], a[96:99], a[28:31], v[20:23]
ds_read_b128 a[76:79], v37 offset:1024
v_mfma_f32_16x16x32_bf16 v[24:27], a[100:103], a[28:31], v[24:27]
ds_read_b128 a[80:83], v37 offset:2048
v_mfma_f32_16x16x32_bf16 v[28:31], a[104:107], a[28:31], v[28:31]
ds_read_b128 a[84:87], v37 offset:3072
v_mfma_f32_16x16x32_bf16 v[32:35], a[108:111], a[28:31], v[32:35]
ds_read_b128 a[88:91], v38 offset:0
s_waitcnt vmcnt(7) lgkmcnt(5)
v_mfma_f32_16x16x32_bf16 v[16:19], a[112:115], a[32:35], v[16:19]
ds_read_b128 a[92:95], v37 offset:4608
s_add_u32 s60, s60, 4096
buffer_load_dwordx2 a[64:65], v40, s[8:11], s60 offen offset:0 sc1
buffer_load_dwordx2 a[66:67], v40, s[8:11], s60 offen offset:1024 sc1
v_mfma_f32_16x16x32_bf16 v[20:23], a[116:119], a[32:35], v[20:23]
ds_read_b128 a[96:99], v37 offset:5632
v_mfma_f32_16x16x32_bf16 v[24:27], a[120:123], a[32:35], v[24:27]
ds_read_b128 a[100:103], v37 offset:6656
v_mfma_f32_16x16x32_bf16 v[28:31], a[124:127], a[32:35], v[28:31]
ds_read_b128 a[104:107], v37 offset:7680
v_mfma_f32_16x16x32_bf16 v[32:35], a[128:131], a[32:35], v[32:35]
ds_read_b128 a[108:111], v38 offset:4608
s_waitcnt vmcnt(8) lgkmcnt(5)
v_mfma_f32_16x16x32_bf16 v[16:19], a[72:75], a[36:39], v[16:19]
ds_read_b128 a[112:115], v37 offset:9216
buffer_load_dwordx2 a[68:69], v40, s[8:11], s60 offen offset:512 sc1
buffer_load_dwordx2 a[70:71], v40, s[8:11], s60 offen offset:1536 sc1
v_mfma_f32_16x16x32_bf16 v[20:23], a[76:79], a[36:39], v[20:23]
ds_read_b128 a[116:119], v37 offset:10240
v_mfma_f32_16x16x32_bf16 v[24:27], a[80:83], a[36:39], v[24:27]
ds_read_b128 a[120:123], v37 offset:11264
v_mfma_f32_16x16x32_bf16 v[28:31], a[84:87], a[36:39], v[28:31]
ds_read_b128 a[124:127], v37 offset:12288
v_mfma_f32_16x16x32_bf16 v[32:35], a[88:91], a[36:39], v[32:35]
ds_read_b128 a[128:131], v38 offset:9216
s_waitcnt vmcnt(9) lgkmcnt(5)
v_mfma_f32_16x16x32_bf16 v[16:19], a[92:95], a[40:43], v[16:19]
ds_read_b128 a[72:75], v37 offset:13824
v_mfma_f32_16x16x32_bf16 v[20:23], a[96:99], a[40:43], v[20:23]
ds_read_b128 a[76:79], v37 offset:14848
v_mfma_f32_16x16x32_bf16 v[24:27], a[100:103], a[40:43], v[24:27]
ds_read_b128 a[80:83], v37 offset:15872
v_mfma_f32_16x16x32_bf16 v[28:31], a[104:107], a[40:43], v[28:31]
ds_read_b128 a[84:87], v37 offset:16896
v_mfma_f32_16x16x32_bf16 v[32:35], a[108:111], a[40:43], v[32:35]
ds_read_b128 a[88:91], v38 offset:13824
s_waitcnt vmcnt(8) lgkmcnt(5)
v_mfma_f32_16x16x32_bf16 v[16:19], a[112:115], a[44:47], v[16:19]
ds_read_b128 a[92:95], v37 offset:18432
v_mfma_f32_16x16x32_bf16 v[20:23], a[116:119], a[44:47], v[20:23]
ds_read_b128 a[96:99], v37 offset:19456
v_mfma_f32_16x16x32_bf16 v[24:27], a[120:123], a[44:47], v[24:27]
ds_read_b128 a[100:103], v37 offset:20480
v_mfma_f32_16x16x32_bf16 v[28:31], a[124:127], a[44:47], v[28:31]
ds_read_b128 a[104:107], v37 offset:21504
v_mfma_f32_16x16x32_bf16 v[32:35], a[128:131], a[44:47], v[32:35]
ds_read_b128 a[108:111], v38 offset:18432
s_waitcnt vmcnt(7) lgkmcnt(5)
v_mfma_f32_16x16x32_bf16 v[16:19], a[72:75], a[48:51], v[16:19]
ds_read_b128 a[112:115], v37 offset:23040
v_mfma_f32_16x16x32_bf16 v[20:23], a[76:79], a[48:51], v[20:23]
ds_read_b128 a[116:119], v37 offset:24064
v_mfma_f32_16x16x32_bf16 v[24:27], a[80:83], a[48:51], v[24:27]
ds_read_b128 a[120:123], v37 offset:25088
v_mfma_f32_16x16x32_bf16 v[28:31], a[84:87], a[48:51], v[28:31]
ds_read_b128 a[124:127], v37 offset:26112
v_mfma_f32_16x16x32_bf16 v[32:35], a[88:91], a[48:51], v[32:35]
ds_read_b128 a[128:131], v38 offset:23040
s_waitcnt vmcnt(6) lgkmcnt(5)
v_mfma_f32_16x16x32_bf16 v[16:19], a[92:95], a[52:55], v[16:19]
ds_read_b128 a[72:75], v37 offset:27648
v_mfma_f32_16x16x32_bf16 v[20:23], a[96:99], a[52:55], v[20:23]
ds_read_b128 a[76:79], v37 offset:28672
v_mfma_f32_16x16x32_bf16 v[24:27], a[100:103], a[52:55], v[24:27]
ds_read_b128 a[80:83], v37 offset:29696
v_mfma_f32_16x16x32_bf16 v[28:31], a[104:107], a[52:55], v[28:31]
ds_read_b128 a[84:87], v37 offset:30720
v_mfma_f32_16x16x32_bf16 v[32:35], a[108:111], a[52:55], v[32:35]
ds_read_b128 a[88:91], v38 offset:27648
s_waitcnt vmcnt(5) lgkmcnt(5)
v_mfma_f32_16x16x32_bf16 v[16:19], a[112:115], a[56:59], v[16:19]
ds_read_b128 a[92:95], v37 offset:32256
v_mfma_f32_16x16x32_bf16 v[20:23], a[116:119], a[56:59], v[20:23]
ds_read_b128 a[96:99], v37 offset:33280
v_mfma_f32_16x16x32_bf16 v[24:27], a[120:123], a[56:59], v[24:27]
ds_read_b128 a[100:103], v37 offset:34304
v_mfma_f32_16x16x32_bf16 v[28:31], a[124:127], a[56:59], v[28:31]
ds_read_b128 a[104:107], v37 offset:35328
v_mfma_f32_16x16x32_bf16 v[32:35], a[128:131], a[56:59], v[32:35]
ds_read_b128 a[108:111], v38 offset:32256
s_waitcnt vmcnt(4) lgkmcnt(5)
v_mfma_f32_16x16x32_bf16 v[16:19], a[72:75], a[60:63], v[16:19]
ds_read_b128 a[112:115], v37 offset:36864
v_mfma_f32_16x16x32_bf16 v[20:23], a[76:79], a[60:63], v[20:23]
ds_read_b128 a[116:119], v37 offset:37888
v_mfma_f32_16x16x32_bf16 v[24:27], a[80:83], a[60:63], v[24:27]
ds_read_b128 a[120:123], v37 offset:38912
v_mfma_f32_16x16x32_bf16 v[28:31], a[84:87], a[60:63], v[28:31]
ds_read_b128 a[124:127], v37 offset:39936
v_mfma_f32_16x16x32_bf16 v[32:35], a[88:91], a[60:63], v[32:35]
ds_read_b128 a[128:131], v38 offset:36864
s_waitcnt vmcnt(2) lgkmcnt(5)
v_mfma_f32_16x16x32_bf16 v[16:19], a[92:95], a[64:67], v[16:19]
v_mfma_f32_16x16x32_bf16 v[20:23], a[96:99], a[64:67], v[20:23]
v_mfma_f32_16x16x32_bf16 v[24:27], a[100:103], a[64:67], v[24:27]
v_mfma_f32_16x16x32_bf16 v[28:31], a[104:107], a[64:67], v[28:31]
v_mfma_f32_16x16x32_bf16 v[32:35], a[108:111], a[64:67], v[32:35]
s_waitcnt vmcnt(0) lgkmcnt(0)
v_mfma_f32_16x16x32_bf16 v[16:19], a[112:115], a[68:71], v[16:19]
v_mfma_f32_16x16x32_bf16 v[20:23], a[116:119], a[68:71], v[20:23]
v_mfma_f32_16x16x32_bf16 v[24:27], a[120:123], a[68:71], v[24:27]
v_mfma_f32_16x16x32_bf16 v[28:31], a[124:127], a[68:71], v[28:31]
v_mfma_f32_16x16x32_bf16 v[32:35], a[128:131], a[68:71], v[32:35]
s_nop 3
v_pk_add_f32 v[62:63], v[16:17], v[18:19]
v_pk_mul_f32 v[64:65], v[16:17], v[16:17]
v_pk_fma_f32 v[64:65], v[18:19], v[18:19], v[64:65]
v_pk_add_f32 v[62:63], v[62:63], v[20:21]
v_pk_fma_f32 v[64:65], v[20:21], v[20:21], v[64:65]
v_pk_add_f32 v[62:63], v[62:63], v[22:23]
v_pk_fma_f32 v[64:65], v[22:23], v[22:23], v[64:65]
v_pk_add_f32 v[62:63], v[62:63], v[24:25]
v_pk_fma_f32 v[64:65], v[24:25], v[24:25], v[64:65]
v_pk_add_f32 v[62:63], v[62:63], v[26:27]
v_pk_fma_f32 v[64:65], v[26:27], v[26:27], v[64:65]
v_pk_add_f32 v[62:63], v[62:63], v[28:29]
v_pk_fma_f32 v[64:65], v[28:29], v[28:29], v[64:65]
v_pk_add_f32 v[62:63], v[62:63], v[30:31]
v_pk_fma_f32 v[64:65], v[30:31], v[30:31], v[64:65]
s_mov_b32 exec_hi, 0
v_pk_add_f32 v[62:63], v[62:63], v[32:33]
v_pk_fma_f32 v[64:65], v[32:33], v[32:33], v[64:65]
v_pk_add_f32 v[62:63], v[62:63], v[34:35]
v_pk_fma_f32 v[64:65], v[34:35], v[34:35], v[64:65]
s_mov_b64 exec, -1
v_add_f32 v56, v62, v63
v_add_f32 v57, v64, v65
v_cvt_pk_bf16_f32 v52, v32, v33
v_cvt_pk_bf16_f32 v53, v34, v35
v_permlane32_swap_b32 v56, v57
v_add_f32 v56, v56, v57
v_mov_b32 v57, v56
v_cvt_pk_bf16_f32 v44, v16, v17
v_cvt_pk_bf16_f32 v45, v18, v19
v_permlane16_swap_b32 v56, v57
v_add_f32 v56, v56, v57
v_mov_b32 v57, v56
v_cvt_pk_bf16_f32 v46, v20, v21
v_cvt_pk_bf16_f32 v47, v22, v23
v_permlane32_swap_b32 v56, v57
buffer_store_dwordx4 v[44:47], v60, s[8:11], s62 offen sc1
buffer_store_dwordx2 v[56:57], v58, s[8:11], s63 offen sc1
v_cvt_pk_bf16_f32 v48, v24, v25
v_cvt_pk_bf16_f32 v49, v26, v27
v_cvt_pk_bf16_f32 v50, v28, v29
v_cvt_pk_bf16_f32 v51, v30, v31
v_permlane16_swap_b32 v52, v54
v_permlane16_swap_b32 v53, v55
buffer_store_dwordx4 v[48:51], v60, s[8:11], s62 offen offset:1024 sc1
buffer_store_dwordx4 v[52:55], v61, s[8:11], s62 offen sc1
s_barrier
s_mul_i32 s38, s24, 9216
s_add_u32 m0, s38, 37888
s_add_u32 s39, s38, s82
s_add_u32 s39, s39, 75776
buffer_load_dwordx4 v1, s[4:7], s39 offen offset:0 sc1 lds
buffer_load_dwordx4 v1, s[4:7], s39 offen offset:1024 sc1 lds
buffer_load_dwordx4 v1, s[4:7], s39 offen offset:2048 sc1 lds
buffer_load_dwordx4 v1, s[4:7], s39 offen offset:3072 sc1 lds
s_add_u32 m0, m0, 4096
s_add_u32 s39, s39, 4096
buffer_load_dwordx4 v1, s[4:7], s39 offen offset:0 sc1 lds
buffer_load_dwordx4 v1, s[4:7], s39 offen offset:1024 sc1 lds
buffer_load_dwordx4 v1, s[4:7], s39 offen offset:2048 sc1 lds
v_lshlrev_b32 v7, 3, v1
s_lshr_b32 s31, s81, 4
s_lshl_b32 s31, s31, 11
v_add_u32 v7, s31, v7
s_cmp_eq_u32 s24, 0
s_cselect_b32 s30, 0, 1073741824
s_add_u32 s30, s30, 26509312
s_waitcnt vmcnt(7)
s_barrier
s_mov_b64 exec, 0xffff
buffer_atomic_add v4, v7, s[8:11], s30 offen sc1
s_mov_b64 exec, -1
s_lshl_b32 s35, s80, 7
s_add_u32 s35, s35, 26509312
s_cmp_eq_u32 s24, 1
s_cselect_b32 s35, s35, 1073741824
v_mov_b32 v6, 0
v_mov_b32 v244, 0
v_mov_b32 v245, 0
v_mov_b32 v246, 0
buffer_load_dwordx4 v1, s[4:7], s39 offen offset:3072 sc1 lds
s_add_u32 m0, m0, 4096
s_add_u32 s39, s39, 4096
buffer_load_dwordx4 v1, s[4:7], s39 offen offset:0 sc1 lds
s_lshl_b32 s38, s24, 8
s_add_u32 m0, s38, 74752
s_add_u32 s39, s38, s82
s_add_u32 s39, s39, 112640
s_mov_b64 exec, 0xffff
buffer_load_dwordx4 v1, s[4:7], s39 offen sc1 lds
s_mov_b64 exec, -1
s_mul_i32 s38, s24, 9216
s_add_u32 m0, s38, 75776
s_add_u32 s39, s38, s82
s_add_u32 s39, s39, 113664
buffer_load_dwordx4 v1, s[4:7], s39 offen offset:0 sc1 lds
s_mov_b64 exec, 1
buffer_atomic_add v244, v6, s[8:11], s35 offen sc0 sc1
s_mov_b64 exec, -1
buffer_load_dwordx4 v1, s[4:7], s39 offen offset:1024 sc1 lds
buffer_load_dwordx4 v1, s[4:7], s39 offen offset:2048 sc1 lds
buffer_load_dwordx4 v1, s[4:7], s39 offen offset:3072 sc1 lds
s_add_u32 m0, m0, 4096
s_add_u32 s39, s39, 4096
s_mov_b64 exec, 1
buffer_atomic_add v245, v6, s[8:11], s35 offen sc0 sc1
s_mov_b64 exec, -1
buffer_load_dwordx4 v1, s[4:7], s39 offen offset:0 sc1 lds
buffer_load_dwordx4 v1, s[4:7], s39 offen offset:1024 sc1 lds
buffer_load_dwordx4 v1, s[4:7], s39 offen offset:2048 sc1 lds
s_mov_b64 exec, 1
buffer_atomic_add v246, v6, s[8:11], s35 offen sc0 sc1
s_mov_b64 exec, -1
buffer_load_dwordx4 v1, s[4:7], s39 offen offset:3072 sc1 lds
s_add_u32 m0, m0, 4096
s_add_u32 s39, s39, 4096
buffer_load_dwordx4 v1, s[4:7], s39 offen offset:0 sc1 lds
s_lshl_b32 s38, s24, 8
s_add_u32 m0, s38, 112640
s_add_u32 s39, s38, s82
s_add_u32 s39, s39, 150528
s_mov_b64 exec, 0xffff
buffer_load_dwordx4 v1, s[4:7], s39 offen sc1 lds
s_mov_b64 exec, -1
s_lshl_b32 s60, s25, 2
s_add_u32 s60, s60, s24
s_mul_i32 s62, s60, 36864
s_add_u32 s62, s62, 4849664
v_add_u32 v180, 18432, v1
s_cmp_eq_u32 s24, 1
s_cbranch_scc0 L_other_20
s_mov_b32 s31, 0
s_mov_b64 exec, 1
v_mov_b32 v247, 0
buffer_atomic_add v247, v6, s[8:11], s35 offen sc0 sc1
s_waitcnt vmcnt(12)
v_cmp_gt_u32 vcc, 16, v244
s_nop 0
s_cbranch_vccz L_polled_19
s_waitcnt vmcnt(8)
v_cmp_gt_u32 vcc, 16, v245
s_nop 0
s_cbranch_vccz L_polled_19
v_mov_b32 v244, 0
buffer_atomic_add v244, v6, s[8:11], s35 offen sc0 sc1
s_waitcnt vmcnt(5)
v_cmp_gt_u32 vcc, 16, v246
s_nop 0
s_cbranch_vccz L_polled_19
v_mov_b32 v245, 0
buffer_atomic_add v245, v6, s[8:11], s35 offen sc0 sc1
L_poll_18:
s_add_u32 s31, s31, 1
s_cmp_gt_u32 s31, 100000
s_cbranch_scc1 L_polled_19
v_mov_b32 v246, 0
buffer_atomic_add v246, v6, s[8:11], s35 offen sc0 sc1
s_waitcnt vmcnt(3)
v_cmp_gt_u32 vcc, 16, v247
s_nop 0
s_cbranch_vccz L_polled_19
v_mov_b32 v247, 0
buffer_atomic_add v247, v6, s[8:11], s35 offen sc0 sc1
s_waitcnt vmcnt(3)
v_cmp_gt_u32 vcc, 16, v244
s_nop 0
s_cbranch_vccz L_polled_19
v_mov_b32 v244, 0
buffer_atomic_add v244, v6, s[8:11], s35 offen sc0 sc1
s_waitcnt vmcnt(3)
v_cmp_gt_u32 vcc, 16, v245
s_nop 0
s_cbranch_vccz L_polled_19
v_mov_b32 v245, 0
buffer_atomic_add v245, v6, s[8:11], s35 offen sc0 sc1
s_waitcnt vmcnt(3)
v_cmp_gt_u32 vcc, 16, v246
s_nop 0
s_cbranch_vccz L_polled_19
s_branch L_poll_18
L_polled_19:
s_mov_b64 exec, -1
L_other_20:
s_barrier
buffer_load_dwordx4 a[0:3], v1, s[8:11], s62 offen offset:0 sc1
buffer_load_dwordx4 a[4:7], v180, s[8:11], s62 offen offset:0 sc1
s_barrier
buffer_load_dwordx4 a[8:11], v1, s[8:11], s62 offen offset:1024 sc1
buffer_load_dwordx4 a[12:15], v180, s[8:11], s62 offen offset:1024 sc1
s_barrier
buffer_load_dwordx4 a[16:19], v1, s[8:11], s62 offen offset:2048 sc1
buffer_load_dwordx4 a[20:23], v180, s[8:11], s62 offen offset:2048 sc1
s_barrier
buffer_load_dwordx4 a[24:27], v1, s[8:11], s62 offen offset:3072 sc1
buffer_load_dwordx4 a[28:31], v180, s[8:11], s62 offen offset:3072 sc1
s_barrier
s_add_u32 s62, s62, 4096
buffer_load_dwordx4 a[32:35], v1, s[8:11], s62 offen offset:0 sc1
buffer_load_dwordx4 a[36:39], v180, s[8:11], s62 offen offset:0 sc1
s_barrier
buffer_load_dwordx4 a[40:43], v1, s[8:11], s62 offen offset:1024 sc1
buffer_load_dwordx4 a[44:47], v180, s[8:11], s62 offen offset:1024 sc1
s_lshl_b32 s53, s25, 2
s_add_u32 s53, s53, s24
s_mul_i32 s53, s53, 133120
s_add_u32 s53, s53, 10895360
s_lshl_b32 s52, s25, 12
s_add_u32 s52, s52, s53
v_lshrrev_b32 v239, 1, v1
v_and_b32 v6, 0xf8, v239
v_lshrrev_b32 v7, 1, v3
v_lshl_add_u32 v232, v7, 16, v6
s_lshl_b32 s63, s60, 8
s_add_u32 s63, s63, 7208960
v_add_u32 v208, 123904, v1
v_add_u32 v209, 0, v1
v_add_u32 v210, 37888, v1
v_add_u32 v211, 75776, v1
ds_read_b128 a[144:147], v208 offset:0
ds_read_b128 a[148:151], v208 offset:18432
ds_read_b128 a[152:155], v209 offset:0
ds_read_b128 a[156:159], v209 offset:18432
ds_read_b128 a[160:163], v208 offset:1024
ds_read_b128 a[164:167], v208 offset:19456
s_waitcnt vmcnt(10) lgkmcnt(4)
v_mfma_f32_16x16x32_bf16 v[36:39], a[144:147], a[0:3], 0
ds_read_b128 a[168:171], v209 offset:1024
ds_read_b128 a[172:175], v209 offset:19456
v_mfma_f32_16x16x32_bf16 v[40:43], a[144:147], a[4:7], 0
buffer_load_dwordx4 a[48:51], v1, s[8:11], s62 offen offset:2048 sc1
v_mfma_f32_16x16x32_bf16 v[44:47], a[148:151], a[0:3], 0
buffer_load_dwordx4 a[52:55], v180, s[8:11], s62 offen offset:2048 sc1
v_mfma_f32_16x16x32_bf16 v[48:51], a[148:151], a[4:7], 0
s_waitcnt lgkmcnt(4)
v_mfma_f32_16x16x32_bf16 v[52:55], a[152:155], a[0:3], 0
ds_read_b128 a[144:147], v208 offset:2048
ds_read_b128 a[148:151], v208 offset:20480
v_mfma_f32_16x16x32_bf16 v[56:59], a[152:155], a[4:7], 0
buffer_load_dwordx4 a[56:59], v1, s[8:11], s62 offen offset:3072 sc1
v_lshl_add_u32 v234, v7, 13, v6
v_mfma_f32_16x16x32_bf16 v[60:63], a[156:159], a[0:3], 0
v_add_u32 v235, 4096, v234
v_mfma_f32_16x16x32_bf16 v[64:67], a[156:159], a[4:7], 0
s_waitcnt vmcnt(11) lgkmcnt(4)
s_barrier
v_mfma_f32_16x16x32_bf16 v[36:39], a[160:163], a[8:11], v[36:39]
ds_read_b128 a[152:155], v209 offset:2048
ds_read_b128 a[156:159], v209 offset:20480
v_mfma_f32_16x16x32_bf16 v[40:43], a[160:163], a[12:15], v[40:43]
buffer_load_dwordx4 a[60:63], v180, s[8:11], s62 offen offset:3072 sc1
s_mul_i32 s30, s24, 9216
v_mfma_f32_16x16x32_bf16 v[44:47], a[164:167], a[8:11], v[44:47]
s_add_u32 s62, s62, 4096
v_mfma_f32_16x16x32_bf16 v[48:51], a[164:167], a[12:15], v[48:51]
s_waitcnt lgkmcnt(4)
s_add_u32 s30, s30, 0
v_mfma_f32_16x16x32_bf16 v[52:55], a[168:171], a[8:11], v[52:55]
ds_read_b128 a[160:163], v208 offset:3072
ds_read_b128 a[164:167], v208 offset:21504
v_mfma_f32_16x16x32_bf16 v[56:59], a[168:171], a[12:15], v[56:59]
buffer_load_dwordx4 a[64:67], v1, s[8:11], s62 offen offset:0 sc1
v_mul_u32_u24 v236, 288, v2
v_mfma_f32_16x16x32_bf16 v[60:63], a[172:175], a[8:11], v[60:63]
v_mfma_f32_16x16x32_bf16 v[64:67], a[172:175], a[12:15], v[64:67]
s_waitcnt lgkmcnt(4)
v_add_u32 v236, s30, v236
s_waitcnt vmcnt(11)
v_mfma_f32_16x16x32_bf16 v[36:39], a[144:147], a[16:19], v[36:39]
ds_read_b128 a[168:171], v209 offset:3072
ds_read_b128 a[172:175], v209 offset:21504
v_mfma_f32_16x16x32_bf16 v[40:43], a[144:147], a[20:23], v[40:43]
buffer_load_dwordx2 v[182:183], v232, s[8:11], s63 offen sc1
v_mfma_f32_16x16x32_bf16 v[44:47], a[148:151], a[16:19], v[44:47]
s_add_u32 s63, s63, 16384
v_lshl_add_u32 v7, v3, 3, v236
v_mfma_f32_16x16x32_bf16 v[48:51], a[148:151], a[20:23], v[48:51]
s_waitcnt lgkmcnt(4)
v_mfma_f32_16x16x32_bf16 v[52:55], a[152:155], a[16:19], v[52:55]
ds_read_b128 a[144:147], v208 offset:4096
ds_read_b128 a[148:151], v208 offset:22528
v_mfma_f32_16x16x32_bf16 v[56:59], a[152:155], a[20:23], v[56:59]
v_lshl_add_u32 v236, v3, 4, v236
v_mfma_f32_16x16x32_bf16 v[60:63], a[156:159], a[16:19], v[60:63]
buffer_load_dwordx2 v[184:185], v232, s[8:11], s63 offen sc1
v_lshrrev_b32 v8, 2, v2
v_mfma_f32_16x16x32_bf16 v[64:67], a[156:159], a[20:23], v[64:67]
s_waitcnt vmcnt(11) lgkmcnt(4)
v_mfma_f32_16x16x32_bf16 v[36:39], a[160:163], a[24:27], v[36:39]
ds_read_b128 a[152:155], v209 offset:4096
ds_read_b128 a[156:159], v209 offset:22528
v_mfma_f32_16x16x32_bf16 v[40:43], a[160:163], a[28:31], v[40:43]
s_add_u32 s63, s63, 16384
v_lshl_add_u32 v8, v3, 3, v8
v_mfma_f32_16x16x32_bf16 v[44:47], a[164:167], a[24:27], v[44:47]
v_mfma_f32_16x16x32_bf16 v[48:51], a[164:167], a[28:31], v[48:51]
s_waitcnt lgkmcnt(4)
v_mul_u32_u24 v237, 288, v8
v_mfma_f32_16x16x32_bf16 v[52:55], a[168:171], a[24:27], v[52:55]
ds_read_b128 a[160:163], v208 offset:5120
ds_read_b128 a[164:167], v208 offset:23552
v_mfma_f32_16x16x32_bf16 v[56:59], a[168:171], a[28:31], v[56:59]
buffer_load_dwordx2 v[186:187], v232, s[8:11], s63 offen sc1
v_add_u32 v237, s30, v237
v_mfma_f32_16x16x32_bf16 v[60:63], a[172:175], a[24:27], v[60:63]
s_add_u32 s63, s63, 16384
v_mfma_f32_16x16x32_bf16 v[64:67], a[172:175], a[28:31], v[64:67]
s_waitcnt vmcnt(10) lgkmcnt(4)
v_mfma_f32_16x16x32_bf16 v[36:39], a[144:147], a[32:35], v[36:39]
ds_read_b128 a[168:171], v209 offset:5120
ds_read_b128 a[172:175], v209 offset:23552
v_mfma_f32_16x16x32_bf16 v[40:43], a[144:147], a[36:39], v[40:43]
buffer_load_dwordx2 v[188:189], v232, s[8:11], s63 offen sc1
v_and_b32 v8, 3, v2
v_mfma_f32_16x16x32_bf16 v[44:47], a[148:151], a[32:35], v[44:47]
s_add_u32 s63, s63, 16384
v_lshl_add_u32 v238, v8, 3, v237
v_mfma_f32_16x16x32_bf16 v[48:51], a[148:151], a[36:39], v[48:51]
s_waitcnt lgkmcnt(4)
v_mfma_f32_16x16x32_bf16 v[52:55], a[152:155], a[32:35], v[52:55]
ds_read_b128 a[144:147], v208 offset:6144
ds_read_b128 a[148:151], v208 offset:24576
v_mfma_f32_16x16x32_bf16 v[56:59], a[152:155], a[36:39], v[56:59]
v_lshl_add_u32 v237, v8, 4, v237
v_mfma_f32_16x16x32_bf16 v[60:63], a[156:159], a[32:35], v[60:63]
buffer_load_dwordx4 a[68:71], v180, s[8:11], s62 offen offset:0 sc1
v_mfma_f32_16x16x32_bf16 v[64:67], a[156:159], a[36:39], v[64:67]
s_waitcnt lgkmcnt(4)
s_mul_i32 s66, s26, 589824
s_waitcnt vmcnt(10)
v_mfma_f32_16x16x32_bf16 v[36:39], a[160:163], a[40:43], v[36:39]
ds_read_b128 a[152:155], v209 offset:6144
ds_read_b128 a[156:159], v209 offset:24576
v_mfma_f32_16x16x32_bf16 v[40:43], a[160:163], a[44:47], v[40:43]
buffer_load_dwordx4 a[72:75], v1, s[8:11], s62 offen offset:1024 sc1
s_mul_i32 s31, s60, 9216
v_mfma_f32_16x16x32_bf16 v[44:47], a[164:167], a[40:43], v[44:47]
s_add_u32 s66, s66, s31
v_mfma_f32_16x16x32_bf16 v[48:51], a[164:167], a[44:47], v[48:51]
s_waitcnt lgkmcnt(4)
v_mfma_f32_16x16x32_bf16 v[52:55], a[168:171], a[40:43], v[52:55]
ds_read_b128 a[160:163], v208 offset:7168
ds_read_b128 a[164:167], v208 offset:25600
v_mfma_f32_16x16x32_bf16 v[56:59], a[168:171], a[44:47], v[56:59]
buffer_load_dwordx4 a[76:79], v180, s[8:11], s62 offen offset:1024 sc1
v_mfma_f32_16x16x32_bf16 v[60:63], a[172:175], a[40:43], v[60:63]
s_add_u32 s66, s66, 7340032
v_mfma_f32_16x16x32_bf16 v[64:67], a[172:175], a[44:47], v[64:67]
s_waitcnt vmcnt(10) lgkmcnt(4)
v_mfma_f32_16x16x32_bf16 v[36:39], a[144:147], a[48:51], v[36:39]
ds_read_b128 a[168:171], v209 offset:7168
ds_read_b128 a[172:175], v209 offset:25600
v_mfma_f32_16x16x32_bf16 v[40:43], a[144:147], a[52:55], v[40:43]
buffer_load_dwordx4 a[80:83], v1, s[8:11], s62 offen offset:2048 sc1
v_lshlrev_b32 v233, 7, v1
v_mfma_f32_16x16x32_bf16 v[44:47], a[148:151], a[48:51], v[44:47]
buffer_load_dwordx4 a[84:87], v180, s[8:11], s62 offen offset:2048 sc1
v_mfma_f32_16x16x32_bf16 v[48:51], a[148:151], a[52:55], v[48:51]
s_waitcnt lgkmcnt(4)
s_lshl_b32 s31, s26, 7
v_mfma_f32_16x16x32_bf16 v[52:55], a[152:155], a[48:51], v[52:55]
ds_read_b128 a[144:147], v208 offset:8192
ds_read_b128 a[148:151], v208 offset:26624
v_mfma_f32_16x16x32_bf16 v[56:59], a[152:155], a[52:55], v[56:59]
buffer_load_dwordx4 a[88:91], v1, s[8:11], s62 offen offset:3072 sc1
v_add_u32 v233, s31, v233
v_mfma_f32_16x16x32_bf16 v[60:63], a[156:159], a[48:51], v[60:63]
s_lshl_b32 s61, s25, 14
v_mfma_f32_16x16x32_bf16 v[64:67], a[156:159], a[52:55], v[64:67]
s_waitcnt vmcnt(11) lgkmcnt(4)
v_mfma_f32_16x16x32_bf16 v[36:39], a[160:163], a[56:59], v[36:39]
ds_read_b128 a[152:155], v209 offset:8192
ds_read_b128 a[156:159], v209 offset:26624
v_mfma_f32_16x16x32_bf16 v[40:43], a[160:163], a[60:63], v[40:43]
buffer_load_dwordx4 a[92:95], v180, s[8:11], s62 offen offset:3072 sc1
v_mfma_f32_16x16x32_bf16 v[44:47], a[164:167], a[56:59], v[44:47]
s_add_u32 s62, s62, 4096
s_lshl_b32 s30, s24, 8
v_mfma_f32_16x16x32_bf16 v[48:51], a[164:167], a[60:63], v[48:51]
s_waitcnt lgkmcnt(4)
v_mfma_f32_16x16x32_bf16 v[52:55], a[168:171], a[56:59], v[52:55]
ds_read_b128 a[160:163], v208 offset:9216
ds_read_b128 a[164:167], v208 offset:27648
v_mfma_f32_16x16x32_bf16 v[56:59], a[168:171], a[60:63], v[56:59]
buffer_load_dwordx4 a[96:99], v1, s[8:11], s62 offen offset:0 sc1
s_add_u32 s61, s61, s30
v_mfma_f32_16x16x32_bf16 v[60:63], a[172:175], a[56:59], v[60:63]
s_add_u32 s61, s61, 26214400
v_mfma_f32_16x16x32_bf16 v[64:67], a[172:175], a[60:63], v[64:67]
s_waitcnt vmcnt(7) lgkmcnt(4)
v_mfma_f32_16x16x32_bf16 v[36:39], a[144:147], a[64:67], v[36:39]
ds_read_b128 a[168:171], v209 offset:9216
ds_read_b128 a[172:175], v209 offset:27648
v_mfma_f32_16x16x32_bf16 v[40:43], a[144:147], a[68:71], v[40:43]
buffer_load_dwordx4 a[100:103], v180, s[8:11], s62 offen offset:0 sc1
s_mul_i32 s30, s24, 9216
v_mfma_f32_16x16x32_bf16 v[44:47], a[148:151], a[64:67], v[44:47]
buffer_load_dwordx4 a[104:107], v1, s[8:11], s62 offen offset:1024 sc1
v_mfma_f32_16x16x32_bf16 v[48:51], a[148:151], a[68:71], v[48:51]
s_waitcnt lgkmcnt(4)
s_add_u32 s30, s30, 0
v_mfma_f32_16x16x32_bf16 v[52:55], a[152:155], a[64:67], v[52:55]
ds_read_b128 a[144:147], v208 offset:10240
ds_read_b128 a[148:151], v208 offset:28672
v_mfma_f32_16x16x32_bf16 v[56:59], a[152:155], a[68:71], v[56:59]
buffer_load_dwordx4 a[108:111], v180, s[8:11], s62 offen offset:1024 sc1
v_add_u32 v240, s30, v1
v_mfma_f32_16x16x32_bf16 v[60:63], a[156:159], a[64:67], v[60:63]
s_lshl_b32 s30, s26, 10
v_mfma_f32_16x16x32_bf16 v[64:67], a[156:159], a[68:71], v[64:67]
s_waitcnt vmcnt(8) lgkmcnt(4)
v_mfma_f32_16x16x32_bf16 v[36:39], a[160:163], a[72:75], v[36:39]
ds_read_b128 a[152:155], v209 offset:10240
ds_read_b128 a[156:159], v209 offset:28672
v_mfma_f32_16x16x32_bf16 v[40:43], a[160:163], a[76:79], v[40:43]
buffer_load_dwordx4 a[112:115], v1, s[8:11], s62 offen offset:2048 sc1
v_mfma_f32_16x16x32_bf16 v[44:47], a[164:167], a[72:75], v[44:47]
buffer_load_dwordx4 a[116:119], v180, s[8:11], s62 offen offset:2048 sc1
s_add_u32 s30, s30, s61
v_mfma_f32_16x16x32_bf16 v[48:51], a[164:167], a[76:79], v[48:51]
s_waitcnt lgkmcnt(4)
v_mfma_f32_16x16x32_bf16 v[52:55], a[168:171], a[72:75], v[52:55]
ds_read_b128 a[160:163], v208 offset:11264
ds_read_b128 a[164:167], v208 offset:29696
v_mfma_f32_16x16x32_bf16 v[56:59], a[168:171], a[76:79], v[56:59]
buffer_load_dwordx4 a[120:123], v1, s[8:11], s62 offen offset:3072 sc1
v_mfma_f32_16x16x32_bf16 v[60:63], a[172:175], a[72:75], v[60:63]
v_mfma_f32_16x16x32_bf16 v[64:67], a[172:175], a[76:79], v[64:67]
s_waitcnt vmcnt(9) lgkmcnt(4)
v_mfma_f32_16x16x32_bf16 v[36:39], a[144:147], a[80:83], v[36:39]
ds_read_b128 a[168:171], v209 offset:11264
ds_read_b128 a[172:175], v209 offset:29696
v_mfma_f32_16x16x32_bf16 v[40:43], a[144:147], a[84:87], v[40:43]
buffer_load_dwordx4 a[124:127], v180, s[8:11], s62 offen offset:3072 sc1
v_mfma_f32_16x16x32_bf16 v[44:47], a[148:151], a[80:83], v[44:47]
s_add_u32 s62, s62, 4096
v_add_f32 v198, v182, v184
v_add_f32 v199, v183, v185
v_mfma_f32_16x16x32_bf16 v[48:51], a[148:151], a[84:87], v[48:51]
s_waitcnt lgkmcnt(4)
v_add_f32 v198, v198, v186
v_mfma_f32_16x16x32_bf16 v[52:55], a[152:155], a[80:83], v[52:55]
ds_read_b128 a[144:147], v208 offset:12288
ds_read_b128 a[148:151], v208 offset:30720
v_mfma_f32_16x16x32_bf16 v[56:59], a[152:155], a[84:87], v[56:59]
buffer_load_dwordx4 a[128:131], v1, s[8:11], s62 offen offset:0 sc1
v_add_f32 v199, v199, v187
v_mfma_f32_16x16x32_bf16 v[60:63], a[156:159], a[80:83], v[60:63]
v_add_f32 v198, v198, v188
v_mfma_f32_16x16x32_bf16 v[64:67], a[156:159], a[84:87], v[64:67]
s_waitcnt lgkmcnt(4)
v_add_f32 v199, v199, v189
s_waitcnt vmcnt(9)
v_mfma_f32_16x16x32_bf16 v[36:39], a[160:163], a[88:91], v[36:39]
ds_read_b128 a[152:155], v209 offset:12288
ds_read_b128 a[156:159], v209 offset:30720
v_mfma_f32_16x16x32_bf16 v[40:43], a[160:163], a[92:95], v[40:43]
buffer_load_dwordx4 a[132:135], v180, s[8:11], s62 offen offset:0 sc1
v_mov_b32 v200, v198
v_mfma_f32_16x16x32_bf16 v[44:47], a[164:167], a[88:91], v[44:47]
v_mov_b32 v201, v199
v_mfma_f32_16x16x32_bf16 v[48:51], a[164:167], a[92:95], v[48:51]
s_waitcnt lgkmcnt(4)
s_nop 0
v_mfma_f32_16x16x32_bf16 v[52:55], a[168:171], a[88:91], v[52:55]
ds_read_b128 a[160:163], v208 offset:13312
ds_read_b128 a[164:167], v208 offset:31744
v_mfma_f32_16x16x32_bf16 v[56:59], a[168:171], a[92:95], v[56:59]
buffer_load_dwordx4 a[136:139], v1, s[8:11], s62 offen offset:1024 sc1
v_mfma_f32_16x16x32_bf16 v[60:63], a[172:175], a[88:91], v[60:63]
buffer_load_dwordx4 a[140:143], v180, s[8:11], s62 offen offset:1024 sc1
v_mfma_f32_16x16x32_bf16 v[64:67], a[172:175], a[92:95], v[64:67]
s_waitcnt vmcnt(10) lgkmcnt(4)
v_mfma_f32_16x16x32_bf16 v[36:39], a[144:147], a[96:99], v[36:39]
ds_read_b128 a[168:171], v209 offset:13312
ds_read_b128 a[172:175], v209 offset:31744
v_mfma_f32_16x16x32_bf16 v[40:43], a[144:147], a[100:103], v[40:43]
v_permlane32_swap_b32 v198, v200
v_mfma_f32_16x16x32_bf16 v[44:47], a[148:151], a[96:99], v[44:47]
v_permlane32_swap_b32 v199, v201
v_mfma_f32_16x16x32_bf16 v[48:51], a[148:151], a[100:103], v[48:51]
s_waitcnt lgkmcnt(4)
v_add_f32 v198, v198, v200
v_add_f32 v199, v199, v201
v_mfma_f32_16x16x32_bf16 v[52:55], a[152:155], a[96:99], v[52:55]
ds_read_b128 a[144:147], v208 offset:14336
ds_read_b128 a[148:151], v208 offset:32768
v_mfma_f32_16x16x32_bf16 v[56:59], a[152:155], a[100:103], v[56:59]
v_mul_f32 v198, 0x3ae38e39, v198
v_mul_f32 v200, v198, v198
v_mfma_f32_16x16x32_bf16 v[60:63], a[156:159], a[96:99], v[60:63]
v_mul_f32 v199, 0x3ae38e39, v199
v_mfma_f32_16x16x32_bf16 v[64:67], a[156:159], a[100:103], v[64:67]
s_waitcnt vmcnt(8) lgkmcnt(4)
v_mfma_f32_16x16x32_bf16 v[36:39], a[160:163], a[104:107], v[36:39]
ds_read_b128 a[152:155], v209 offset:14336
ds_read_b128 a[156:159], v209 offset:32768
v_mfma_f32_16x16x32_bf16 v[40:43], a[160:163], a[108:111], v[40:43]
v_sub_f32 v199, v199, v200
v_max_f32 v199, 0, v199
v_mfma_f32_16x16x32_bf16 v[44:47], a[164:167], a[104:107], v[44:47]
v_add_f32 v199, 0x3727c5ac, v199
v_mfma_f32_16x16x32_bf16 v[48:51], a[164:167], a[108:111], v[48:51]
s_waitcnt lgkmcnt(4)
v_rsq_f32 v250, v199
v_mfma_f32_16x16x32_bf16 v[52:55], a[168:171], a[104:107], v[52:55]
ds_read_b128 a[160:163], v208 offset:15360
ds_read_b128 a[164:167], v208 offset:33792
v_mfma_f32_16x16x32_bf16 v[56:59], a[168:171], a[108:111], v[56:59]
v_mfma_f32_16x16x32_bf16 v[60:63], a[172:175], a[104:107], v[60:63]
v_sqrt_f32 v254, v199
v_mfma_f32_16x16x32_bf16 v[64:67], a[172:175], a[108:111], v[64:67]
s_waitcnt vmcnt(6) lgkmcnt(4)
v_mfma_f32_16x16x32_bf16 v[36:39], a[144:147], a[112:115], v[36:39]
ds_read_b128 a[168:171], v209 offset:15360
ds_read_b128 a[172:175], v209 offset:33792
v_mfma_f32_16x16x32_bf16 v[40:43], a[144:147], a[116:119], v[40:43]
v_cvt_pk_bf16_f32 v200, -v198, -v198
v_mfma_f32_16x16x32_bf16 v[44:47], a[148:151], a[112:115], v[44:47]
v_and_b32 v200, 0xffff0000, v200
v_mfma_f32_16x16x32_bf16 v[48:51], a[148:151], a[116:119], v[48:51]
s_waitcnt lgkmcnt(4)
v_add_f32 v200, v198, v200
v_mfma_f32_16x16x32_bf16 v[52:55], a[152:155], a[112:115], v[52:55]
ds_read_b128 a[144:147], v208 offset:16384
ds_read_b128 a[148:151], v208 offset:34816
v_mfma_f32_16x16x32_bf16 v[56:59], a[152:155], a[116:119], v[56:59]
v_cvt_pk_bf16_f32 v212, -v198, -v200
v_mfma_f32_16x16x32_bf16 v[60:63], a[156:159], a[112:115], v[60:63]
v_mul_f32 v252, v250, v250
v_mfma_f32_16x16x32_bf16 v[64:67], a[156:159], a[116:119], v[64:67]
s_waitcnt lgkmcnt(4)
v_mul_f32 v252, v252, v250
s_waitcnt vmcnt(4)
v_mfma_f32_16x16x32_bf16 v[36:39], a[160:163], a[120:123], v[36:39]
ds_read_b128 a[152:155], v209 offset:16384
ds_read_b128 a[156:159], v209 offset:34816
v_mfma_f32_16x16x32_bf16 v[40:43], a[160:163], a[124:127], v[40:43]
v_mul_f32 v252, 0xbdd2d3e8, v252
v_mul_f32 v250, 0xc0135761, v250
v_mfma_f32_16x16x32_bf16 v[44:47], a[164:167], a[120:123], v[44:47]
v_mfma_f32_16x16x32_bf16 v[48:51], a[164:167], a[124:127], v[48:51]
s_waitcnt lgkmcnt(4)
v_mov_b32 v214, v212
v_mfma_f32_16x16x32_bf16 v[52:55], a[168:171], a[120:123], v[52:55]
ds_read_b128 a[160:163], v208 offset:17408
ds_read_b128 a[164:167], v208 offset:35840
v_mfma_f32_16x16x32_bf16 v[56:59], a[168:171], a[124:127], v[56:59]
v_mov_b32 v255, v254
v_mov_b32 v253, v252
v_mfma_f32_16x16x32_bf16 v[60:63], a[172:175], a[120:123], v[60:63]
v_mfma_f32_16x16x32_bf16 v[64:67], a[172:175], a[124:127], v[64:67]
s_waitcnt lgkmcnt(4)
v_mov_b32 v251, v250
s_waitcnt vmcnt(2)
v_mfma_f32_16x16x32_bf16 v[36:39], a[144:147], a[128:131], v[36:39]
ds_read_b128 a[168:171], v209 offset:17408
ds_read_b128 a[172:175], v209 offset:35840
v_mfma_f32_16x16x32_bf16 v[40:43], a[144:147], a[132:135], v[40:43]
v_permlane16_swap_b32 v212, v214
v_mfma_f32_16x16x32_bf16 v[44:47], a[148:151], a[128:131], v[44:47]
v_permlane16_swap_b32 v254, v255
v_mfma_f32_16x16x32_bf16 v[48:51], a[148:151], a[132:135], v[48:51]
s_waitcnt lgkmcnt(4)
v_add_u32 v181, 160768, v239
v_mfma_f32_16x16x32_bf16 v[52:55], a[152:155], a[128:131], v[52:55]
ds_read_b64 a[144:145], v181 offset:0
ds_read_b64 a[148:149], v181 offset:512
v_mfma_f32_16x16x32_bf16 v[56:59], a[152:155], a[132:135], v[56:59]
v_permlane16_swap_b32 v252, v253
v_mfma_f32_16x16x32_bf16 v[60:63], a[156:159], a[128:131], v[60:63]
v_mfma_f32_16x16x32_bf16 v[64:67], a[156:159], a[132:135], v[64:67]
s_waitcnt vmcnt(0) lgkmcnt(4)
v_add_u32 v181, 36864, v239
v_mfma_f32_16x16x32_bf16 v[36:39], a[160:163], a[136:139], v[36:39]
ds_read_b64 a[152:153], v181 offset:0
ds_read_b64 a[156:157], v181 offset:512
v_mfma_f32_16x16x32_bf16 v[40:43], a[160:163], a[140:143], v[40:43]
v_permlane16_swap_b32 v250, v251
v_mfma_f32_16x16x32_bf16 v[44:47], a[164:167], a[136:139], v[44:47]
v_mov_b32 v213, v212
v_mfma_f32_16x16x32_bf16 v[48:51], a[164:167], a[140:143], v[48:51]
s_waitcnt lgkmcnt(4)
v_mov_b32 v215, v214
v_mfma_f32_16x16x32_bf16 v[52:55], a[168:171], a[136:139], v[52:55]
ds_read_b128 a[160:163], v210 offset:0
ds_read_b128 a[164:167], v210 offset:18432
v_mfma_f32_16x16x32_bf16 v[56:59], a[168:171], a[140:143], v[56:59]
v_mfma_f32_16x16x32_bf16 v[60:63], a[172:175], a[136:139], v[60:63]
v_mfma_f32_16x16x32_bf16 v[64:67], a[172:175], a[140:143], v[64:67]
s_waitcnt lgkmcnt(4)
v_mfma_f32_16x16x16_bf16 v[36:39], a[144:145], v[212:213], v[36:39]
ds_read_b128 a[168:171], v210 offset:1024
ds_read_b128 a[172:175], v210 offset:19456
v_mfma_f32_16x16x16_bf16 v[40:43], a[144:145], v[214:215], v[40:43]
v_mfma_f32_16x16x16_bf16 v[44:47], a[148:149], v[212:213], v[44:47]
v_mfma_f32_16x16x16_bf16 v[48:51], a[148:149], v[214:215], v[48:51]
s_waitcnt lgkmcnt(4)
v_mfma_f32_16x16x16_bf16 v[52:55], a[152:153], v[212:213], v[52:55]
ds_read_b128 a[144:147], v210 offset:2048
ds_read_b128 a[148:151], v210 offset:20480
v_mfma_f32_16x16x16_bf16 v[56:59], a[152:153], v[214:215], v[56:59]
v_mfma_f32_16x16x16_bf16 v[60:63], a[156:157], v[212:213], v[60:63]
v_mfma_f32_16x16x16_bf16 v[64:67], a[156:157], v[214:215], v[64:67]
s_waitcnt lgkmcnt(4)
s_barrier
v_mfma_f32_16x16x32_bf16 v[68:71], a[160:163], a[0:3], 0
ds_read_b128 a[152:155], v210 offset:3072
ds_read_b128 a[156:159], v210 offset:21504
v_mfma_f32_16x16x32_bf16 v[72:75], a[160:163], a[4:7], 0
s_mul_i32 s38, s24, 9216
s_add_u32 m0, s38, 123904
v_mfma_f32_16x16x32_bf16 v[76:79], a[164:167], a[0:3], 0
s_add_u32 s39, s38, s82
v_mfma_f32_16x16x32_bf16 v[80:83], a[164:167], a[4:7], 0
s_waitcnt lgkmcnt(4)
v_mfma_f32_16x16x32_bf16 v[68:71], a[168:171], a[8:11], v[68:71]
ds_read_b128 a[160:163], v210 offset:4096
ds_read_b128 a[164:167], v210 offset:22528
v_mfma_f32_16x16x32_bf16 v[72:75], a[168:171], a[12:15], v[72:75]
s_add_u32 s39, s39, 151552
v_mfma_f32_16x16x32_bf16 v[76:79], a[172:175], a[8:11], v[76:79]
buffer_load_dwordx4 v1, s[4:7], s39 offen offset:0 sc1 lds
buffer_load_dwordx4 v1, s[4:7], s39 offen offset:1024 sc1 lds
v_pk_mul_f32 v[216:217], v[36:37], v[36:37]
v_pk_mul_f32 v[218:219], v[38:39], v[38:39]
v_pk_mul_f32 v[220:221], v[40:41], v[40:41]
v_pk_mul_f32 v[222:223], v[42:43], v[42:43]
v_pk_fma_f32 v[216:217], v[216:217], v[252:253], v[250:251] op_sel:[0,0,0] op_sel_hi:[1,0,0]
v_pk_fma_f32 v[218:219], v[218:219], v[252:253], v[250:251] op_sel:[0,0,0] op_sel_hi:[1,0,0]
v_pk_fma_f32 v[220:221], v[220:221], v[252:253], v[250:251] op_sel:[0,1,1] op_sel_hi:[1,1,1]
v_pk_fma_f32 v[222:223], v[222:223], v[252:253], v[250:251] op_sel:[0,1,1] op_sel_hi:[1,1,1]
v_pk_mul_f32 v[216:217], v[216:217], v[36:37]
v_pk_mul_f32 v[218:219], v[218:219], v[38:39]
v_pk_mul_f32 v[220:221], v[220:221], v[40:41]
v_pk_mul_f32 v[222:223], v[222:223], v[42:43]
v_mfma_f32_16x16x32_bf16 v[80:83], a[172:175], a[12:15], v[80:83]
s_waitcnt lgkmcnt(4)
v_exp_f32 v216, v216
v_mfma_f32_16x16x32_bf16 v[68:71], a[144:147], a[16:19], v[68:71]
ds_read_b128 a[168:171], v210 offset:5120
ds_read_b128 a[172:175], v210 offset:23552
v_mfma_f32_16x16x32_bf16 v[72:75], a[144:147], a[20:23], v[72:75]
v_exp_f32 v217, v217
v_mfma_f32_16x16x32_bf16 v[76:79], a[148:151], a[16:19], v[76:79]
buffer_load_dwordx4 v1, s[4:7], s39 offen offset:2048 sc1 lds
buffer_load_dwordx4 v1, s[4:7], s39 offen offset:3072 sc1 lds
v_mfma_f32_16x16x32_bf16 v[80:83], a[148:151], a[20:23], v[80:83]
s_waitcnt lgkmcnt(4)
v_exp_f32 v218, v218
v_mfma_f32_16x16x32_bf16 v[68:71], a[152:155], a[24:27], v[68:71]
ds_read_b128 a[144:147], v210 offset:6144
ds_read_b128 a[148:151], v210 offset:24576
v_mfma_f32_16x16x32_bf16 v[72:75], a[152:155], a[28:31], v[72:75]
s_add_u32 m0, m0, 4096
v_fma_f32 v216, v216, v254, v254
v_fma_f32 v217, v217, v254, v254
v_mfma_f32_16x16x32_bf16 v[76:79], a[156:159], a[24:27], v[76:79]
s_add_u32 s39, s39, 4096
v_exp_f32 v219, v219
v_mfma_f32_16x16x32_bf16 v[80:83], a[156:159], a[28:31], v[80:83]
s_waitcnt lgkmcnt(4)
v_exp_f32 v220, v220
v_mfma_f32_16x16x32_bf16 v[68:71], a[160:163], a[32:35], v[68:71]
ds_read_b128 a[152:155], v210 offset:7168
ds_read_b128 a[156:159], v210 offset:25600
v_mfma_f32_16x16x32_bf16 v[72:75], a[160:163], a[36:39], v[72:75]
buffer_load_dwordx4 v1, s[4:7], s39 offen offset:0 sc1 lds
buffer_load_dwordx4 v1, s[4:7], s39 offen offset:1024 sc1 lds
v_mfma_f32_16x16x32_bf16 v[76:79], a[164:167], a[32:35], v[76:79]
v_fma_f32 v218, v218, v254, v254
v_fma_f32 v219, v219, v254, v254
v_mfma_f32_16x16x32_bf16 v[80:83], a[164:167], a[36:39], v[80:83]
s_waitcnt lgkmcnt(4)
v_exp_f32 v221, v221
v_mfma_f32_16x16x32_bf16 v[68:71], a[168:171], a[40:43], v[68:71]
ds_read_b128 a[160:163], v210 offset:8192
ds_read_b128 a[164:167], v210 offset:26624
v_exp_f32 v222, v222
v_mfma_f32_16x16x32_bf16 v[72:75], a[168:171], a[44:47], v[72:75]
buffer_load_dwordx4 v1, s[4:7], s39 offen offset:2048 sc1 lds
buffer_load_dwordx4 v1, s[4:7], s39 offen offset:3072 sc1 lds
v_mfma_f32_16x16x32_bf16 v[76:79], a[172:175], a[40:43], v[76:79]
s_add_u32 m0, m0, 4096
v_fma_f32 v220, v220, v255, v255
v_fma_f32 v221, v221, v255, v255
v_mfma_f32_16x16x32_bf16 v[80:83], a[172:175], a[44:47], v[80:83]
s_waitcnt lgkmcnt(4)
v_exp_f32 v223, v223
v_mfma_f32_16x16x32_bf16 v[68:71], a[144:147], a[48:51], v[68:71]
ds_read_b128 a[168:171], v210 offset:9216
ds_read_b128 a[172:175], v210 offset:27648
v_rcp_f32 v216, v216
v_mfma_f32_16x16x32_bf16 v[72:75], a[144:147], a[52:55], v[72:75]
s_add_u32 s39, s39, 4096
v_fma_f32 v222, v222, v255, v255
v_fma_f32 v223, v223, v255, v255
v_mfma_f32_16x16x32_bf16 v[76:79], a[148:151], a[48:51], v[76:79]
buffer_load_dwordx4 v1, s[4:7], s39 offen offset:0 sc1 lds
v_mfma_f32_16x16x32_bf16 v[80:83], a[148:151], a[52:55], v[80:83]
s_waitcnt lgkmcnt(4)
v_rcp_f32 v217, v217
v_mfma_f32_16x16x32_bf16 v[68:71], a[152:155], a[56:59], v[68:71]
ds_read_b128 a[144:147], v210 offset:10240
ds_read_b128 a[148:151], v210 offset:28672
v_rcp_f32 v218, v218
v_mfma_f32_16x16x32_bf16 v[72:75], a[152:155], a[60:63], v[72:75]
s_lshl_b32 s38, s24, 8
v_rcp_f32 v219, v219
v_mfma_f32_16x16x32_bf16 v[76:79], a[156:159], a[56:59], v[76:79]
buffer_store_dwordx4 a[224:227], v1, s[4:7], s101 offen offset:0 sc1
s_add_u32 m0, s38, 160768
v_mfma_f32_16x16x32_bf16 v[80:83], a[156:159], a[60:63], v[80:83]
s_waitcnt lgkmcnt(4)
s_add_u32 s39, s38, s82
v_rcp_f32 v220, v220
v_mfma_f32_16x16x32_bf16 v[68:71], a[160:163], a[64:67], v[68:71]
ds_read_b128 a[152:155], v210 offset:11264
ds_read_b128 a[156:159], v210 offset:29696
v_mfma_f32_16x16x32_bf16 v[72:75], a[160:163], a[68:71], v[72:75]
s_add_u32 s39, s39, 188416
v_rcp_f32 v221, v221
v_mfma_f32_16x16x32_bf16 v[76:79], a[164:167], a[64:67], v[76:79]
v_rcp_f32 v222, v222
v_mfma_f32_16x16x32_bf16 v[80:83], a[164:167], a[68:71], v[80:83]
s_waitcnt lgkmcnt(4)
v_rcp_f32 v223, v223
v_mfma_f32_16x16x32_bf16 v[68:71], a[168:171], a[72:75], v[68:71]
ds_read_b128 a[160:163], v210 offset:12288
ds_read_b128 a[164:167], v210 offset:30720
v_pk_mul_f32 v[224:225], v[44:45], v[44:45]
v_pk_mul_f32 v[226:227], v[46:47], v[46:47]
v_pk_mul_f32 v[228:229], v[48:49], v[48:49]
v_pk_mul_f32 v[230:231], v[50:51], v[50:51]
v_pk_fma_f32 v[224:225], v[224:225], v[252:253], v[250:251] op_sel:[0,0,0] op_sel_hi:[1,0,0]
v_pk_fma_f32 v[226:227], v[226:227], v[252:253], v[250:251] op_sel:[0,0,0] op_sel_hi:[1,0,0]
v_pk_fma_f32 v[228:229], v[228:229], v[252:253], v[250:251] op_sel:[0,1,1] op_sel_hi:[1,1,1]
v_pk_fma_f32 v[230:231], v[230:231], v[252:253], v[250:251] op_sel:[0,1,1] op_sel_hi:[1,1,1]
v_pk_mul_f32 v[36:37], v[36:37], v[216:217]
v_pk_mul_f32 v[38:39], v[38:39], v[218:219]
v_pk_mul_f32 v[40:41], v[40:41], v[220:221]
v_pk_mul_f32 v[42:43], v[42:43], v[222:223]
v_pk_mul_f32 v[224:225], v[224:225], v[44:45]
v_pk_mul_f32 v[226:227], v[226:227], v[46:47]
v_pk_mul_f32 v[228:229], v[228:229], v[48:49]
v_pk_mul_f32 v[230:231], v[230:231], v[50:51]
v_mfma_f32_16x16x32_bf16 v[72:75], a[168:171], a[76:79], v[72:75]
s_mov_b64 exec, 0xffff
buffer_load_dwordx4 v1, s[4:7], s39 offen sc1 lds
s_mov_b64 exec, -1
v_exp_f32 v224, v224
v_mfma_f32_16x16x32_bf16 v[76:79], a[172:175], a[72:75], v[76:79]
v_exp_f32 v225, v225
v_mfma_f32_16x16x32_bf16 v[80:83], a[172:175], a[76:79], v[80:83]
s_waitcnt lgkmcnt(4)
v_exp_f32 v226, v226
v_mfma_f32_16x16x32_bf16 v[68:71], a[144:147], a[80:83], v[68:71]
ds_read_b128 a[168:171], v210 offset:13312
ds_read_b128 a[172:175], v210 offset:31744
v_mfma_f32_16x16x32_bf16 v[72:75], a[144:147], a[84:87], v[72:75]
s_mul_i32 s38, s24, 9216
v_fma_f32 v224, v224, v254, v254
v_fma_f32 v225, v225, v254, v254
v_mfma_f32_16x16x32_bf16 v[76:79], a[148:151], a[80:83], v[76:79]
s_add_u32 m0, s38, 0
v_exp_f32 v227, v227
v_mfma_f32_16x16x32_bf16 v[80:83], a[148:151], a[84:87], v[80:83]
s_waitcnt lgkmcnt(4)
v_exp_f32 v228, v228
v_mfma_f32_16x16x32_bf16 v[68:71], a[152:155], a[88:91], v[68:71]
ds_read_b128 a[144:147], v210 offset:14336
ds_read_b128 a[148:151], v210 offset:32768
v_mfma_f32_16x16x32_bf16 v[72:75], a[152:155], a[92:95], v[72:75]
s_add_u32 s39, s38, s82
v_fma_f32 v226, v226, v254, v254
v_fma_f32 v227, v227, v254, v254
v_mfma_f32_16x16x32_bf16 v[76:79], a[156:159], a[88:91], v[76:79]
s_add_u32 s39, s39, 189440
v_exp_f32 v229, v229
v_mfma_f32_16x16x32_bf16 v[80:83], a[156:159], a[92:95], v[80:83]
s_waitcnt lgkmcnt(4)
v_exp_f32 v230, v230
v_mfma_f32_16x16x32_bf16 v[68:71], a[160:163], a[96:99], v[68:71]
ds_read_b128 a[152:155], v210 offset:15360
ds_read_b128 a[156:159], v210 offset:33792
v_mfma_f32_16x16x32_bf16 v[72:75], a[160:163], a[100:103], v[72:75]
buffer_store_dwordx4 a[228:231], v1, s[4:7], s101 offen offset:1024 sc1
v_fma_f32 v228, v228, v255, v255
v_fma_f32 v229, v229, v255, v255
v_mfma_f32_16x16x32_bf16 v[76:79], a[164:167], a[96:99], v[76:79]
buffer_load_dwordx4 v1, s[4:7], s39 offen offset:0 sc1 lds
buffer_load_dwordx4 v1, s[4:7], s39 offen offset:1024 sc1 lds
v_exp_f32 v231, v231
v_mfma_f32_16x16x32_bf16 v[80:83], a[164:167], a[100:103], v[80:83]
s_waitcnt lgkmcnt(4)
v_rcp_f32 v224, v224
v_mfma_f32_16x16x32_bf16 v[68:71], a[168:171], a[104:107], v[68:71]
ds_read_b128 a[160:163], v210 offset:16384
ds_read_b128 a[164:167], v210 offset:34816
v_mfma_f32_16x16x32_bf16 v[72:75], a[168:171], a[108:111], v[72:75]
v_fma_f32 v230, v230, v255, v255
v_fma_f32 v231, v231, v255, v255
v_mfma_f32_16x16x32_bf16 v[76:79], a[172:175], a[104:107], v[76:79]
v_rcp_f32 v225, v225
v_mfma_f32_16x16x32_bf16 v[80:83], a[172:175], a[108:111], v[80:83]
s_waitcnt lgkmcnt(4)
v_rcp_f32 v226, v226
v_mfma_f32_16x16x32_bf16 v[68:71], a[144:147], a[112:115], v[68:71]
ds_read_b128 a[168:171], v210 offset:17408
ds_read_b128 a[172:175], v210 offset:35840
v_mfma_f32_16x16x32_bf16 v[72:75], a[144:147], a[116:119], v[72:75]
buffer_load_dwordx4 v1, s[4:7], s39 offen offset:2048 sc1 lds
buffer_load_dwordx4 v1, s[4:7], s39 offen offset:3072 sc1 lds
v_rcp_f32 v227, v227
v_mfma_f32_16x16x32_bf16 v[76:79], a[148:151], a[112:115], v[76:79]
s_add_u32 m0, m0, 4096
v_rcp_f32 v228, v228
v_mfma_f32_16x16x32_bf16 v[80:83], a[148:151], a[116:119], v[80:83]
s_waitcnt lgkmcnt(4)
v_add_u32 v181, 74752, v239
v_mfma_f32_16x16x32_bf16 v[68:71], a[152:155], a[120:123], v[68:71]
ds_read_b64 a[144:145], v181 offset:0
ds_read_b64 a[148:149], v181 offset:512
v_rcp_f32 v229, v229
v_mfma_f32_16x16x32_bf16 v[72:75], a[152:155], a[124:127], v[72:75]
s_add_u32 s39, s39, 4096
v_rcp_f32 v230, v230
v_mfma_f32_16x16x32_bf16 v[76:79], a[156:159], a[120:123], v[76:79]
v_rcp_f32 v231, v231
v_mfma_f32_16x16x32_bf16 v[80:83], a[156:159], a[124:127], v[80:83]
s_waitcnt lgkmcnt(4)
v_pk_mul_f32 v[216:217], v[52:53], v[52:53]
v_pk_mul_f32 v[218:219], v[54:55], v[54:55]
v_pk_mul_f32 v[220:221], v[56:57], v[56:57]
v_pk_mul_f32 v[222:223], v[58:59], v[58:59]
v_pk_fma_f32 v[216:217], v[216:217], v[252:253], v[250:251] op_sel:[0,0,0] op_sel_hi:[1,0,0]
v_pk_fma_f32 v[218:219], v[218:219], v[252:253], v[250:251] op_sel:[0,0,0] op_sel_hi:[1,0,0]
v_pk_fma_f32 v[220:221], v[220:221], v[252:253], v[250:251] op_sel:[0,1,1] op_sel_hi:[1,1,1]
v_pk_fma_f32 v[222:223], v[222:223], v[252:253], v[250:251] op_sel:[0,1,1] op_sel_hi:[1,1,1]
v_pk_mul_f32 v[44:45], v[44:45], v[224:225]
v_pk_mul_f32 v[46:47], v[46:47], v[226:227]
v_pk_mul_f32 v[48:49], v[48:49], v[228:229]
v_pk_mul_f32 v[50:51], v[50:51], v[230:231]
v_pk_mul_f32 v[216:217], v[216:217], v[52:53]
v_pk_mul_f32 v[218:219], v[218:219], v[54:55]
v_pk_mul_f32 v[220:221], v[220:221], v[56:57]
v_pk_mul_f32 v[222:223], v[222:223], v[58:59]
v_mfma_f32_16x16x32_bf16 v[68:71], a[160:163], a[128:131], v[68:71]
ds_read_b128 a[152:155], v211 offset:0
ds_read_b128 a[156:159], v211 offset:18432
v_exp_f32 v216, v216
v_mfma_f32_16x16x32_bf16 v[72:75], a[160:163], a[132:135], v[72:75]
buffer_load_dwordx4 v1, s[4:7], s39 offen offset:0 sc1 lds
buffer_load_dwordx4 v1, s[4:7], s39 offen offset:1024 sc1 lds
v_exp_f32 v217, v217
v_mfma_f32_16x16x32_bf16 v[76:79], a[164:167], a[128:131], v[76:79]
buffer_store_dwordx4 a[232:235], v1, s[4:7], s101 offen offset:2048 sc1
v_exp_f32 v218, v218
v_mfma_f32_16x16x32_bf16 v[80:83], a[164:167], a[132:135], v[80:83]
s_waitcnt lgkmcnt(4)
v_fma_f32 v216, v216, v254, v254
v_fma_f32 v217, v217, v254, v254
v_mfma_f32_16x16x32_bf16 v[68:71], a[168:171], a[136:139], v[68:71]
ds_read_b128 a[160:163], v211 offset:1024
ds_read_b128 a[164:167], v211 offset:19456
v_mfma_f32_16x16x32_bf16 v[72:75], a[168:171], a[140:143], v[72:75]
v_exp_f32 v219, v219
v_mfma_f32_16x16x32_bf16 v[76:79], a[172:175], a[136:139], v[76:79]
v_exp_f32 v220, v220
v_mfma_f32_16x16x32_bf16 v[80:83], a[172:175], a[140:143], v[80:83]
s_waitcnt lgkmcnt(4)
v_fma_f32 v218, v218, v254, v254
v_fma_f32 v219, v219, v254, v254
v_mfma_f32_16x16x16_bf16 v[68:71], a[144:145], v[212:213], v[68:71]
ds_read_b128 a[168:171], v211 offset:2048
ds_read_b128 a[172:175], v211 offset:20480
v_mfma_f32_16x16x16_bf16 v[72:75], a[144:145], v[214:215], v[72:75]
buffer_load_dwordx4 v1, s[4:7], s39 offen offset:2048 sc1 lds
buffer_load_dwordx4 v1, s[4:7], s39 offen offset:3072 sc1 lds
v_exp_f32 v221, v221
v_mfma_f32_16x16x16_bf16 v[76:79], a[148:149], v[212:213], v[76:79]
s_add_u32 m0, m0, 4096
v_exp_f32 v222, v222
v_mfma_f32_16x16x16_bf16 v[80:83], a[148:149], v[214:215], v[80:83]
s_waitcnt vmcnt(10) lgkmcnt(4)
s_barrier
v_mfma_f32_16x16x32_bf16 v[84:87], a[152:155], a[0:3], 0
ds_read_b128 a[144:147], v211 offset:3072
ds_read_b128 a[148:151], v211 offset:21504
v_fma_f32 v220, v220, v255, v255
v_fma_f32 v221, v221, v255, v255
v_mfma_f32_16x16x32_bf16 v[88:91], a[152:155], a[4:7], 0
s_add_u32 s39, s39, 4096
v_exp_f32 v223, v223
v_mfma_f32_16x16x32_bf16 v[92:95], a[156:159], a[0:3], 0
v_rcp_f32 v216, v216
v_mfma_f32_16x16x32_bf16 v[96:99], a[156:159], a[4:7], 0
s_waitcnt lgkmcnt(4)
v_fma_f32 v222, v222, v255, v255
v_fma_f32 v223, v223, v255, v255
v_mfma_f32_16x16x32_bf16 v[84:87], a[160:163], a[8:11], v[84:87]
ds_read_b128 a[152:155], v211 offset:4096
ds_read_b128 a[156:159], v211 offset:22528
v_mfma_f32_16x16x32_bf16 v[88:91], a[160:163], a[12:15], v[88:91]
buffer_load_dwordx4 v1, s[4:7], s39 offen offset:0 sc1 lds
v_rcp_f32 v217, v217
v_mfma_f32_16x16x32_bf16 v[92:95], a[164:167], a[8:11], v[92:95]
s_lshl_b32 s38, s24, 8
v_rcp_f32 v218, v218
v_mfma_f32_16x16x32_bf16 v[96:99], a[164:167], a[12:15], v[96:99]
s_waitcnt lgkmcnt(4)
v_rcp_f32 v219, v219
v_mfma_f32_16x16x32_bf16 v[84:87], a[168:171], a[16:19], v[84:87]
ds_read_b128 a[160:163], v211 offset:5120
ds_read_b128 a[164:167], v211 offset:23552
v_mfma_f32_16x16x32_bf16 v[88:91], a[168:171], a[20:23], v[88:91]
buffer_store_dwordx4 a[236:239], v1, s[4:7], s101 offen offset:3072 sc1
v_rcp_f32 v220, v220
v_mfma_f32_16x16x32_bf16 v[92:95], a[172:175], a[16:19], v[92:95]
s_add_u32 m0, s38, 36864
v_rcp_f32 v221, v221
v_mfma_f32_16x16x32_bf16 v[96:99], a[172:175], a[20:23], v[96:99]
s_waitcnt lgkmcnt(4)
v_rcp_f32 v222, v222
v_mfma_f32_16x16x32_bf16 v[84:87], a[144:147], a[24:27], v[84:87]
ds_read_b128 a[168:171], v211 offset:6144
ds_read_b128 a[172:175], v211 offset:24576
v_mfma_f32_16x16x32_bf16 v[88:91], a[144:147], a[28:31], v[88:91]
s_add_u32 s39, s38, s82
v_rcp_f32 v223, v223
v_mfma_f32_16x16x32_bf16 v[92:95], a[148:151], a[24:27], v[92:95]
s_add_u32 s39, s39, 226304
v_pk_mul_f32 v[224:225], v[60:61], v[60:61]
v_pk_mul_f32 v[226:227], v[62:63], v[62:63]
v_pk_mul_f32 v[228:229], v[64:65], v[64:65]
v_pk_mul_f32 v[230:231], v[66:67], v[66:67]
v_pk_fma_f32 v[224:225], v[224:225], v[252:253], v[250:251] op_sel:[0,0,0] op_sel_hi:[1,0,0]
v_pk_fma_f32 v[226:227], v[226:227], v[252:253], v[250:251] op_sel:[0,0,0] op_sel_hi:[1,0,0]
v_pk_fma_f32 v[228:229], v[228:229], v[252:253], v[250:251] op_sel:[0,1,1] op_sel_hi:[1,1,1]
v_pk_fma_f32 v[230:231], v[230:231], v[252:253], v[250:251] op_sel:[0,1,1] op_sel_hi:[1,1,1]
v_pk_mul_f32 v[52:53], v[52:53], v[216:217]
v_pk_mul_f32 v[54:55], v[54:55], v[218:219]
v_pk_mul_f32 v[56:57], v[56:57], v[220:221]
v_pk_mul_f32 v[58:59], v[58:59], v[222:223]
v_pk_mul_f32 v[224:225], v[224:225], v[60:61]
v_pk_mul_f32 v[226:227], v[226:227], v[62:63]
v_pk_mul_f32 v[228:229], v[228:229], v[64:65]
v_pk_mul_f32 v[230:231], v[230:231], v[66:67]
v_mfma_f32_16x16x32_bf16 v[96:99], a[148:151], a[28:31], v[96:99]
s_waitcnt lgkmcnt(4)
v_exp_f32 v224, v224
v_mfma_f32_16x16x32_bf16 v[84:87], a[152:155], a[32:35], v[84:87]
ds_read_b128 a[144:147], v211 offset:7168
ds_read_b128 a[148:151], v211 offset:25600
v_exp_f32 v225, v225
v_mfma_f32_16x16x32_bf16 v[88:91], a[152:155], a[36:39], v[88:91]
v_exp_f32 v226, v226
v_mfma_f32_16x16x32_bf16 v[92:95], a[156:159], a[32:35], v[92:95]
s_mov_b64 exec, 0xffff
buffer_load_dwordx4 v1, s[4:7], s39 offen sc1 lds
s_mov_b64 exec, -1
v_mfma_f32_16x16x32_bf16 v[96:99], a[156:159], a[36:39], v[96:99]
s_waitcnt lgkmcnt(4)
v_fma_f32 v224, v224, v254, v254
v_fma_f32 v225, v225, v254, v254
v_mfma_f32_16x16x32_bf16 v[84:87], a[160:163], a[40:43], v[84:87]
ds_read_b128 a[152:155], v211 offset:8192
ds_read_b128 a[156:159], v211 offset:26624
v_exp_f32 v227, v227
v_mfma_f32_16x16x32_bf16 v[88:91], a[160:163], a[44:47], v[88:91]
v_exp_f32 v228, v228
v_mfma_f32_16x16x32_bf16 v[92:95], a[164:167], a[40:43], v[92:95]
v_fma_f32 v226, v226, v254, v254
v_fma_f32 v227, v227, v254, v254
v_mfma_f32_16x16x32_bf16 v[96:99], a[164:167], a[44:47], v[96:99]
s_waitcnt lgkmcnt(4)
v_exp_f32 v229, v229
v_mfma_f32_16x16x32_bf16 v[84:87], a[168:171], a[48:51], v[84:87]
ds_read_b128 a[160:163], v211 offset:9216
ds_read_b128 a[164:167], v211 offset:27648
v_mfma_f32_16x16x32_bf16 v[88:91], a[168:171], a[52:55], v[88:91]
v_exp_f32 v230, v230
v_mfma_f32_16x16x32_bf16 v[92:95], a[172:175], a[48:51], v[92:95]
buffer_store_dwordx4 a[240:243], v9, s[4:7], s101 offen offset:0 sc1
s_mul_i32 s38, s24, 9216
v_mfma_f32_16x16x32_bf16 v[96:99], a[172:175], a[52:55], v[96:99]
s_waitcnt lgkmcnt(4)
v_fma_f32 v228, v228, v255, v255
v_fma_f32 v229, v229, v255, v255
v_mfma_f32_16x16x32_bf16 v[84:87], a[144:147], a[56:59], v[84:87]
ds_read_b128 a[168:171], v211 offset:10240
ds_read_b128 a[172:175], v211 offset:28672
v_exp_f32 v231, v231
v_mfma_f32_16x16x32_bf16 v[88:91], a[144:147], a[60:63], v[88:91]
s_add_u32 m0, s38, 37888
v_rcp_f32 v224, v224
v_mfma_f32_16x16x32_bf16 v[92:95], a[148:151], a[56:59], v[92:95]
s_add_u32 s39, s38, s82
v_fma_f32 v230, v230, v255, v255
v_fma_f32 v231, v231, v255, v255
v_mfma_f32_16x16x32_bf16 v[96:99], a[148:151], a[60:63], v[96:99]
s_waitcnt lgkmcnt(4)
v_rcp_f32 v225, v225
v_mfma_f32_16x16x32_bf16 v[84:87], a[152:155], a[64:67], v[84:87]
ds_read_b128 a[144:147], v211 offset:11264
ds_read_b128 a[148:151], v211 offset:29696
v_mfma_f32_16x16x32_bf16 v[88:91], a[152:155], a[68:71], v[88:91]
s_add_u32 s39, s39, 227328
v_rcp_f32 v226, v226
v_mfma_f32_16x16x32_bf16 v[92:95], a[156:159], a[64:67], v[92:95]
v_rcp_f32 v227, v227
v_mfma_f32_16x16x32_bf16 v[96:99], a[156:159], a[68:71], v[96:99]
s_waitcnt lgkmcnt(4)
v_rcp_f32 v228, v228
v_mfma_f32_16x16x32_bf16 v[84:87], a[160:163], a[72:75], v[84:87]
ds_read_b128 a[152:155], v211 offset:12288
ds_read_b128 a[156:159], v211 offset:30720
v_mfma_f32_16x16x32_bf16 v[88:91], a[160:163], a[76:79], v[88:91]
buffer_load_dwordx4 v1, s[4:7], s39 offen offset:0 sc1 lds
buffer_load_dwordx4 v1, s[4:7], s39 offen offset:1024 sc1 lds
v_mfma_f32_16x16x32_bf16 v[92:95], a[164:167], a[72:75], v[92:95]
v_rcp_f32 v229, v229
v_mfma_f32_16x16x32_bf16 v[96:99], a[164:167], a[76:79], v[96:99]
s_waitcnt lgkmcnt(4)
v_rcp_f32 v230, v230
v_mfma_f32_16x16x32_bf16 v[84:87], a[168:171], a[80:83], v[84:87]
ds_read_b128 a[160:163], v211 offset:13312
ds_read_b128 a[164:167], v211 offset:31744
v_rcp_f32 v231, v231
v_mfma_f32_16x16x32_bf16 v[88:91], a[168:171], a[84:87], v[88:91]
buffer_load_dwordx4 v1, s[4:7], s39 offen offset:2048 sc1 lds
buffer_load_dwordx4 v1, s[4:7], s39 offen offset:3072 sc1 lds
v_pk_mul_f32 v[216:217], v[68:69], v[68:69]
v_pk_mul_f32 v[218:219], v[70:71], v[70:71]
v_pk_mul_f32 v[220:221], v[72:73], v[72:73]
v_pk_mul_f32 v[222:223], v[74:75], v[74:75]
v_pk_fma_f32 v[216:217], v[216:217], v[252:253], v[250:251] op_sel:[0,0,0] op_sel_hi:[1,0,0]
v_pk_fma_f32 v[218:219], v[218:219], v[252:253], v[250:251] op_sel:[0,0,0] op_sel_hi:[1,0,0]
v_pk_fma_f32 v[220:221], v[220:221], v[252:253], v[250:251] op_sel:[0,1,1] op_sel_hi:[1,1,1]
v_pk_fma_f32 v[222:223], v[222:223], v[252:253], v[250:251] op_sel:[0,1,1] op_sel_hi:[1,1,1]
v_pk_mul_f32 v[60:61], v[60:61], v[224:225]
v_pk_mul_f32 v[62:63], v[62:63], v[226:227]
v_pk_mul_f32 v[64:65], v[64:65], v[228:229]
v_pk_mul_f32 v[66:67], v[66:67], v[230:231]
v_pk_mul_f32 v[216:217], v[216:217], v[68:69]
v_pk_mul_f32 v[218:219], v[218:219], v[70:71]
v_pk_mul_f32 v[220:221], v[220:221], v[72:73]
v_pk_mul_f32 v[222:223], v[222:223], v[74:75]
v_mfma_f32_16x16x32_bf16 v[92:95], a[172:175], a[80:83], v[92:95]
s_add_u32 m0, m0, 4096
v_exp_f32 v216, v216
v_mfma_f32_16x16x32_bf16 v[96:99], a[172:175], a[84:87], v[96:99]
s_waitcnt lgkmcnt(4)
v_exp_f32 v217, v217
v_mfma_f32_16x16x32_bf16 v[84:87], a[144:147], a[88:91], v[84:87]
ds_read_b128 a[168:171], v211 offset:14336
ds_read_b128 a[172:175], v211 offset:32768
v_exp_f32 v218, v218
v_mfma_f32_16x16x32_bf16 v[88:91], a[144:147], a[92:95], v[88:91]
buffer_store_dwordx4 a[244:247], v9, s[4:7], s101 offen offset:1024 sc1
v_fma_f32 v216, v216, v254, v254
v_mfma_f32_16x16x32_bf16 v[92:95], a[148:151], a[88:91], v[92:95]
s_add_u32 s39, s39, 4096
v_fma_f32 v217, v217, v254, v254
v_mfma_f32_16x16x32_bf16 v[96:99], a[148:151], a[92:95], v[96:99]
s_waitcnt lgkmcnt(4)
v_exp_f32 v219, v219
v_mfma_f32_16x16x32_bf16 v[84:87], a[152:155], a[96:99], v[84:87]
ds_read_b128 a[144:147], v211 offset:15360
ds_read_b128 a[148:151], v211 offset:33792
v_exp_f32 v220, v220
v_mfma_f32_16x16x32_bf16 v[88:91], a[152:155], a[100:103], v[88:91]
v_fma_f32 v218, v218, v254, v254
v_fma_f32 v219, v219, v254, v254
v_mfma_f32_16x16x32_bf16 v[92:95], a[156:159], a[96:99], v[92:95]
v_exp_f32 v221, v221
v_mfma_f32_16x16x32_bf16 v[96:99], a[156:159], a[100:103], v[96:99]
s_waitcnt lgkmcnt(4)
v_exp_f32 v222, v222
v_mfma_f32_16x16x32_bf16 v[84:87], a[160:163], a[104:107], v[84:87]
ds_read_b128 a[152:155], v211 offset:16384
ds_read_b128 a[156:159], v211 offset:34816
v_mfma_f32_16x16x32_bf16 v[88:91], a[160:163], a[108:111], v[88:91]
buffer_load_dwordx4 v1, s[4:7], s39 offen offset:0 sc1 lds
buffer_load_dwordx4 v1, s[4:7], s39 offen offset:1024 sc1 lds
v_mfma_f32_16x16x32_bf16 v[92:95], a[164:167], a[104:107], v[92:95]
v_fma_f32 v220, v220, v255, v255
v_fma_f32 v221, v221, v255, v255
v_mfma_f32_16x16x32_bf16 v[96:99], a[164:167], a[108:111], v[96:99]
s_waitcnt lgkmcnt(4)
v_exp_f32 v223, v223
v_mfma_f32_16x16x32_bf16 v[84:87], a[168:171], a[112:115], v[84:87]
ds_read_b128 a[160:163], v211 offset:17408
ds_read_b128 a[164:167], v211 offset:35840
v_rcp_f32 v216, v216
v_mfma_f32_16x16x32_bf16 v[88:91], a[168:171], a[116:119], v[88:91]
buffer_load_dwordx4 v1, s[4:7], s39 offen offset:2048 sc1 lds
buffer_load_dwordx4 v1, s[4:7], s39 offen offset:3072 sc1 lds
v_mfma_f32_16x16x32_bf16 v[92:95], a[172:175], a[112:115], v[92:95]
s_add_u32 m0, m0, 4096
v_fma_f32 v222, v222, v255, v255
v_fma_f32 v223, v223, v255, v255
v_mfma_f32_16x16x32_bf16 v[96:99], a[172:175], a[116:119], v[96:99]
s_waitcnt lgkmcnt(4)
v_rcp_f32 v217, v217
v_add_u32 v181, 112640, v239
v_mfma_f32_16x16x32_bf16 v[84:87], a[144:147], a[120:123], v[84:87]
ds_read_b64 a[168:169], v181 offset:0
ds_read_b64 a[172:173], v181 offset:512
v_rcp_f32 v218, v218
v_mfma_f32_16x16x32_bf16 v[88:91], a[144:147], a[124:127], v[88:91]
s_add_u32 s39, s39, 4096
v_rcp_f32 v219, v219
v_mfma_f32_16x16x32_bf16 v[92:95], a[148:151], a[120:123], v[92:95]
buffer_store_dwordx4 a[248:251], v9, s[4:7], s101 offen offset:2048 sc1
v_mfma_f32_16x16x32_bf16 v[96:99], a[148:151], a[124:127], v[96:99]
s_waitcnt lgkmcnt(4)
v_rcp_f32 v220, v220
v_mfma_f32_16x16x32_bf16 v[84:87], a[152:155], a[128:131], v[84:87]
ds_read_b128 a[144:147], v208 offset:0
ds_read_b128 a[148:151], v208 offset:18432
v_mfma_f32_16x16x32_bf16 v[88:91], a[152:155], a[132:135], v[88:91]
v_rcp_f32 v221, v221
v_mfma_f32_16x16x32_bf16 v[92:95], a[156:159], a[128:131], v[92:95]
v_rcp_f32 v222, v222
v_mfma_f32_16x16x32_bf16 v[96:99], a[156:159], a[132:135], v[96:99]
s_waitcnt lgkmcnt(4)
v_rcp_f32 v223, v223
v_mfma_f32_16x16x32_bf16 v[84:87], a[160:163], a[136:139], v[84:87]
ds_read_b128 a[152:155], v208 offset:1024
ds_read_b128 a[156:159], v208 offset:19456
v_pk_mul_f32 v[224:225], v[76:77], v[76:77]
v_pk_mul_f32 v[226:227], v[78:79], v[78:79]
v_pk_mul_f32 v[228:229], v[80:81], v[80:81]
v_pk_mul_f32 v[230:231], v[82:83], v[82:83]
v_pk_fma_f32 v[224:225], v[224:225], v[252:253], v[250:251] op_sel:[0,0,0] op_sel_hi:[1,0,0]
v_pk_fma_f32 v[226:227], v[226:227], v[252:253], v[250:251] op_sel:[0,0,0] op_sel_hi:[1,0,0]
v_pk_fma_f32 v[228:229], v[228:229], v[252:253], v[250:251] op_sel:[0,1,1] op_sel_hi:[1,1,1]
v_pk_fma_f32 v[230:231], v[230:231], v[252:253], v[250:251] op_sel:[0,1,1] op_sel_hi:[1,1,1]
v_pk_mul_f32 v[68:69], v[68:69], v[216:217]
v_pk_mul_f32 v[70:71], v[70:71], v[218:219]
v_pk_mul_f32 v[72:73], v[72:73], v[220:221]
v_pk_mul_f32 v[74:75], v[74:75], v[222:223]
v_pk_mul_f32 v[224:225], v[224:225], v[76:77]
v_pk_mul_f32 v[226:227], v[226:227], v[78:79]
v_pk_mul_f32 v[228:229], v[228:229], v[80:81]
v_pk_mul_f32 v[230:231], v[230:231], v[82:83]
v_mfma_f32_16x16x32_bf16 v[88:91], a[160:163], a[140:143], v[88:91]
buffer_load_dwordx4 v1, s[4:7], s39 offen offset:0 sc1 lds
s_lshl_b32 s38, s24, 8
v_exp_f32 v224, v224
v_mfma_f32_16x16x32_bf16 v[92:95], a[164:167], a[136:139], v[92:95]
s_add_u32 m0, s38, 74752
v_exp_f32 v225, v225
v_mfma_f32_16x16x32_bf16 v[96:99], a[164:167], a[140:143], v[96:99]
s_waitcnt lgkmcnt(4)
v_exp_f32 v226, v226
v_mfma_f32_16x16x16_bf16 v[84:87], a[168:169], v[212:213], v[84:87]
ds_read_b128 a[160:163], v208 offset:2048
ds_read_b128 a[164:167], v208 offset:20480
v_mfma_f32_16x16x16_bf16 v[88:91], a[168:169], v[214:215], v[88:91]
s_add_u32 s39, s38, s82
v_fma_f32 v224, v224, v254, v254
v_fma_f32 v225, v225, v254, v254
v_mfma_f32_16x16x16_bf16 v[92:95], a[172:173], v[212:213], v[92:95]
s_add_u32 s39, s39, 264192
v_exp_f32 v227, v227
v_mfma_f32_16x16x16_bf16 v[96:99], a[172:173], v[214:215], v[96:99]
s_waitcnt lgkmcnt(4)
v_exp_f32 v228, v228
s_waitcnt vmcnt(12)
s_barrier
v_mfma_f32_16x16x32_bf16 v[100:103], a[144:147], a[0:3], 0
ds_read_b128 a[168:171], v208 offset:3072
ds_read_b128 a[172:175], v208 offset:21504
v_mfma_f32_16x16x32_bf16 v[104:107], a[144:147], a[4:7], 0
s_mov_b32 s37, L_c4-L_pc
v_fma_f32 v226, v226, v254, v254
v_fma_f32 v227, v227, v254, v254
v_mfma_f32_16x16x32_bf16 v[108:111], a[148:151], a[0:3], 0
v_exp_f32 v229, v229
v_mfma_f32_16x16x32_bf16 v[112:115], a[148:151], a[4:7], 0
s_waitcnt lgkmcnt(4)
v_exp_f32 v230, v230
v_mfma_f32_16x16x32_bf16 v[100:103], a[152:155], a[8:11], v[100:103]
ds_read_b128 a[144:147], v208 offset:4096
ds_read_b128 a[148:151], v208 offset:22528
v_mfma_f32_16x16x32_bf16 v[104:107], a[152:155], a[12:15], v[104:107]
s_mov_b64 exec, 0xffff
buffer_load_dwordx4 v1, s[4:7], s39 offen sc1 lds
s_mov_b64 exec, -1
v_fma_f32 v228, v228, v255, v255
v_fma_f32 v229, v229, v255, v255
v_mfma_f32_16x16x32_bf16 v[108:111], a[156:159], a[8:11], v[108:111]
buffer_store_dwordx4 a[252:255], v9, s[4:7], s101 offen offset:3072 sc1
buffer_load_dword v15, v14, s[88:91], s37 offen
v_exp_f32 v231, v231
v_mfma_f32_16x16x32_bf16 v[112:115], a[156:159], a[12:15], v[112:115]
s_waitcnt lgkmcnt(4)
v_rcp_f32 v224, v224
v_mfma_f32_16x16x32_bf16 v[100:103], a[160:163], a[16:19], v[100:103]
ds_read_b128 a[152:155], v208 offset:5120
ds_read_b128 a[156:159], v208 offset:23552
v_mfma_f32_16x16x32_bf16 v[104:107], a[160:163], a[20:23], v[104:107]
s_mov_b32 s101, 1073741824
v_fma_f32 v230, v230, v255, v255
v_fma_f32 v231, v231, v255, v255
v_mfma_f32_16x16x32_bf16 v[108:111], a[164:167], a[16:19], v[108:111]
v_rcp_f32 v225, v225
v_mfma_f32_16x16x32_bf16 v[112:115], a[164:167], a[20:23], v[112:115]
s_waitcnt lgkmcnt(4)
v_rcp_f32 v226, v226
v_mfma_f32_16x16x32_bf16 v[100:103], a[168:171], a[24:27], v[100:103]
ds_read_b128 a[160:163], v208 offset:6144
ds_read_b128 a[164:167], v208 offset:24576
v_mfma_f32_16x16x32_bf16 v[104:107], a[168:171], a[28:31], v[104:107]
s_mul_i32 s38, s24, 9216
v_rcp_f32 v227, v227
v_mfma_f32_16x16x32_bf16 v[108:111], a[172:175], a[24:27], v[108:111]
s_add_u32 m0, s38, 75776
v_rcp_f32 v228, v228
v_mfma_f32_16x16x32_bf16 v[112:115], a[172:175], a[28:31], v[112:115]
s_waitcnt lgkmcnt(4)
v_rcp_f32 v229, v229
v_mfma_f32_16x16x32_bf16 v[100:103], a[144:147], a[32:35], v[100:103]
ds_read_b128 a[168:171], v208 offset:7168
ds_read_b128 a[172:175], v208 offset:25600
v_mfma_f32_16x16x32_bf16 v[104:107], a[144:147], a[36:39], v[104:107]
s_add_u32 s39, s38, s82
v_rcp_f32 v230, v230
v_mfma_f32_16x16x32_bf16 v[108:111], a[148:151], a[32:35], v[108:111]
s_add_u32 s39, s39, 265216
v_rcp_f32 v231, v231
v_mfma_f32_16x16x32_bf16 v[112:115], a[148:151], a[36:39], v[112:115]
s_waitcnt lgkmcnt(4)
v_pk_mul_f32 v[216:217], v[84:85], v[84:85]
v_pk_mul_f32 v[218:219], v[86:87], v[86:87]
v_pk_mul_f32 v[220:221], v[88:89], v[88:89]
v_pk_mul_f32 v[222:223], v[90:91], v[90:91]
v_pk_fma_f32 v[216:217], v[216:217], v[252:253], v[250:251] op_sel:[0,0,0] op_sel_hi:[1,0,0]
v_pk_fma_f32 v[218:219], v[218:219], v[252:253], v[250:251] op_sel:[0,0,0] op_sel_hi:[1,0,0]
v_pk_fma_f32 v[220:221], v[220:221], v[252:253], v[250:251] op_sel:[0,1,1] op_sel_hi:[1,1,1]
v_pk_fma_f32 v[222:223], v[222:223], v[252:253], v[250:251] op_sel:[0,1,1] op_sel_hi:[1,1,1]
v_pk_mul_f32 v[76:77], v[76:77], v[224:225]
v_pk_mul_f32 v[78:79], v[78:79], v[226:227]
v_pk_mul_f32 v[80:81], v[80:81], v[228:229]
v_pk_mul_f32 v[82:83], v[82:83], v[230:231]
v_pk_mul_f32 v[216:217], v[216:217], v[84:85]
v_pk_mul_f32 v[218:219], v[218:219], v[86:87]
v_pk_mul_f32 v[220:221], v[220:221], v[88:89]
v_pk_mul_f32 v[222:223], v[222:223], v[90:91]
v_mfma_f32_16x16x32_bf16 v[100:103], a[152:155], a[40:43], v[100:103]
ds_read_b128 a[144:147], v208 offset:8192
ds_read_b128 a[148:151], v208 offset:26624
v_exp_f32 v216, v216
v_mfma_f32_16x16x32_bf16 v[104:107], a[152:155], a[44:47], v[104:107]
v_exp_f32 v217, v217
v_mfma_f32_16x16x32_bf16 v[108:111], a[156:159], a[40:43], v[108:111]
buffer_load_dwordx4 v1, s[4:7], s39 offen offset:0 sc1 lds
buffer_load_dwordx4 v1, s[4:7], s39 offen offset:1024 sc1 lds
v_exp_f32 v218, v218
v_mfma_f32_16x16x32_bf16 v[112:115], a[156:159], a[44:47], v[112:115]
s_waitcnt lgkmcnt(4)
v_fma_f32 v216, v216, v254, v254
v_fma_f32 v217, v217, v254, v254
v_mfma_f32_16x16x32_bf16 v[100:103], a[160:163], a[48:51], v[100:103]
ds_read_b128 a[152:155], v208 offset:9216
ds_read_b128 a[156:159], v208 offset:27648
v_mfma_f32_16x16x32_bf16 v[104:107], a[160:163], a[52:55], v[104:107]
v_exp_f32 v219, v219
v_mfma_f32_16x16x32_bf16 v[108:111], a[164:167], a[48:51], v[108:111]
v_exp_f32 v220, v220
v_mfma_f32_16x16x32_bf16 v[112:115], a[164:167], a[52:55], v[112:115]
s_waitcnt lgkmcnt(4)
v_fma_f32 v218, v218, v254, v254
v_fma_f32 v219, v219, v254, v254
v_mfma_f32_16x16x32_bf16 v[100:103], a[168:171], a[56:59], v[100:103]
ds_read_b128 a[160:163], v208 offset:10240
ds_read_b128 a[164:167], v208 offset:28672
v_mfma_f32_16x16x32_bf16 v[104:107], a[168:171], a[60:63], v[104:107]
buffer_load_dwordx4 v1, s[4:7], s39 offen offset:2048 sc1 lds
buffer_load_dwordx4 v1, s[4:7], s39 offen offset:3072 sc1 lds
v_exp_f32 v221, v221
v_mfma_f32_16x16x32_bf16 v[108:111], a[172:175], a[56:59], v[108:111]
s_add_u32 m0, m0, 4096
v_exp_f32 v222, v222
v_mfma_f32_16x16x32_bf16 v[112:115], a[172:175], a[60:63], v[112:115]
s_waitcnt lgkmcnt(4)
v_fma_f32 v220, v220, v255, v255
v_fma_f32 v221, v221, v255, v255
v_mfma_f32_16x16x32_bf16 v[100:103], a[144:147], a[64:67], v[100:103]
ds_read_b128 a[168:171], v208 offset:11264
ds_read_b128 a[172:175], v208 offset:29696
v_mfma_f32_16x16x32_bf16 v[104:107], a[144:147], a[68:71], v[104:107]
s_add_u32 s39, s39, 4096
v_exp_f32 v223, v223
v_mfma_f32_16x16x32_bf16 v[108:111], a[148:151], a[64:67], v[108:111]
v_rcp_f32 v216, v216
v_mfma_f32_16x16x32_bf16 v[112:115], a[148:151], a[68:71], v[112:115]
s_waitcnt lgkmcnt(4)
v_fma_f32 v222, v222, v255, v255
v_fma_f32 v223, v223, v255, v255
v_mfma_f32_16x16x32_bf16 v[100:103], a[152:155], a[72:75], v[100:103]
ds_read_b128 a[144:147], v208 offset:12288
ds_read_b128 a[148:151], v208 offset:30720
v_mfma_f32_16x16x32_bf16 v[104:107], a[152:155], a[76:79], v[104:107]
buffer_load_dwordx4 v1, s[4:7], s39 offen offset:0 sc1 lds
buffer_load_dwordx4 v1, s[4:7], s39 offen offset:1024 sc1 lds
v_rcp_f32 v217, v217
v_mfma_f32_16x16x32_bf16 v[108:111], a[156:159], a[72:75], v[108:111]
v_rcp_f32 v218, v218
v_mfma_f32_16x16x32_bf16 v[112:115], a[156:159], a[76:79], v[112:115]
s_waitcnt lgkmcnt(4)
v_rcp_f32 v219, v219
v_mfma_f32_16x16x32_bf16 v[100:103], a[160:163], a[80:83], v[100:103]
ds_read_b128 a[152:155], v208 offset:13312
ds_read_b128 a[156:159], v208 offset:31744
v_mfma_f32_16x16x32_bf16 v[104:107], a[160:163], a[84:87], v[104:107]
v_rcp_f32 v220, v220
v_mfma_f32_16x16x32_bf16 v[108:111], a[164:167], a[80:83], v[108:111]
v_rcp_f32 v221, v221
v_mfma_f32_16x16x32_bf16 v[112:115], a[164:167], a[84:87], v[112:115]
s_waitcnt lgkmcnt(4)
v_rcp_f32 v222, v222
v_mfma_f32_16x16x32_bf16 v[100:103], a[168:171], a[88:91], v[100:103]
ds_read_b128 a[160:163], v208 offset:14336
ds_read_b128 a[164:167], v208 offset:32768
v_mfma_f32_16x16x32_bf16 v[104:107], a[168:171], a[92:95], v[104:107]
buffer_load_dwordx4 v1, s[4:7], s39 offen offset:2048 sc1 lds
buffer_load_dwordx4 v1, s[4:7], s39 offen offset:3072 sc1 lds
v_rcp_f32 v223, v223
v_mfma_f32_16x16x32_bf16 v[108:111], a[172:175], a[88:91], v[108:111]
s_add_u32 m0, m0, 4096
v_pk_mul_f32 v[224:225], v[92:93], v[92:93]
v_pk_mul_f32 v[226:227], v[94:95], v[94:95]
v_pk_mul_f32 v[228:229], v[96:97], v[96:97]
v_pk_mul_f32 v[230:231], v[98:99], v[98:99]
v_pk_fma_f32 v[224:225], v[224:225], v[252:253], v[250:251] op_sel:[0,0,0] op_sel_hi:[1,0,0]
v_pk_fma_f32 v[226:227], v[226:227], v[252:253], v[250:251] op_sel:[0,0,0] op_sel_hi:[1,0,0]
v_pk_fma_f32 v[228:229], v[228:229], v[252:253], v[250:251] op_sel:[0,1,1] op_sel_hi:[1,1,1]
v_pk_fma_f32 v[230:231], v[230:231], v[252:253], v[250:251] op_sel:[0,1,1] op_sel_hi:[1,1,1]
v_pk_mul_f32 v[84:85], v[84:85], v[216:217]
v_pk_mul_f32 v[86:87], v[86:87], v[218:219]
v_pk_mul_f32 v[88:89], v[88:89], v[220:221]
v_pk_mul_f32 v[90:91], v[90:91], v[222:223]
v_pk_mul_f32 v[224:225], v[224:225], v[92:93]
v_pk_mul_f32 v[226:227], v[226:227], v[94:95]
v_pk_mul_f32 v[228:229], v[228:229], v[96:97]
v_pk_mul_f32 v[230:231], v[230:231], v[98:99]
v_mfma_f32_16x16x32_bf16 v[112:115], a[172:175], a[92:95], v[112:115]
s_waitcnt lgkmcnt(4)
v_exp_f32 v224, v224
v_mfma_f32_16x16x32_bf16 v[100:103], a[144:147], a[96:99], v[100:103]
ds_read_b128 a[168:171], v208 offset:15360
ds_read_b128 a[172:175], v208 offset:33792
v_exp_f32 v225, v225
v_mfma_f32_16x16x32_bf16 v[104:107], a[144:147], a[100:103], v[104:107]
s_add_u32 s39, s39, 4096
v_exp_f32 v226, v226
v_mfma_f32_16x16x32_bf16 v[108:111], a[148:151], a[96:99], v[108:111]
v_fma_f32 v224, v224, v254, v254
v_fma_f32 v225, v225, v254, v254
v_mfma_f32_16x16x32_bf16 v[112:115], a[148:151], a[100:103], v[112:115]
s_waitcnt lgkmcnt(4)
v_exp_f32 v227, v227
v_mfma_f32_16x16x32_bf16 v[100:103], a[152:155], a[104:107], v[100:103]
ds_read_b128 a[144:147], v208 offset:16384
ds_read_b128 a[148:151], v208 offset:34816
v_mfma_f32_16x16x32_bf16 v[104:107], a[152:155], a[108:111], v[104:107]
buffer_load_dwordx4 v1, s[4:7], s39 offen offset:0 sc1 lds
v_exp_f32 v228, v228
v_mfma_f32_16x16x32_bf16 v[108:111], a[156:159], a[104:107], v[108:111]
s_lshl_b32 s38, s24, 8
v_fma_f32 v226, v226, v254, v254
v_fma_f32 v227, v227, v254, v254
v_mfma_f32_16x16x32_bf16 v[112:115], a[156:159], a[108:111], v[112:115]
s_waitcnt lgkmcnt(4)
v_exp_f32 v229, v229
v_mfma_f32_16x16x32_bf16 v[100:103], a[160:163], a[112:115], v[100:103]
ds_read_b128 a[152:155], v208 offset:17408
ds_read_b128 a[156:159], v208 offset:35840
v_mfma_f32_16x16x32_bf16 v[104:107], a[160:163], a[116:119], v[104:107]
s_add_u32 m0, s38, 112640
v_exp_f32 v230, v230
v_mfma_f32_16x16x32_bf16 v[108:111], a[164:167], a[112:115], v[108:111]
s_add_u32 s39, s38, s82
v_fma_f32 v228, v228, v255, v255
v_fma_f32 v229, v229, v255, v255
v_mfma_f32_16x16x32_bf16 v[112:115], a[164:167], a[116:119], v[112:115]
s_waitcnt lgkmcnt(4)
v_add_u32 v181, 160768, v239
v_mfma_f32_16x16x32_bf16 v[100:103], a[168:171], a[120:123], v[100:103]
ds_read_b64 a[160:161], v181 offset:0
ds_read_b64 a[164:165], v181 offset:512
v_exp_f32 v231, v231
v_mfma_f32_16x16x32_bf16 v[104:107], a[168:171], a[124:127], v[104:107]
s_add_u32 s39, s39, 302080
v_rcp_f32 v224, v224
v_mfma_f32_16x16x32_bf16 v[108:111], a[172:175], a[120:123], v[108:111]
v_fma_f32 v230, v230, v255, v255
v_fma_f32 v231, v231, v255, v255
v_mfma_f32_16x16x32_bf16 v[112:115], a[172:175], a[124:127], v[112:115]
s_waitcnt lgkmcnt(4)
v_rcp_f32 v225, v225
v_mfma_f32_16x16x32_bf16 v[100:103], a[144:147], a[128:131], v[100:103]
ds_read_b128 a[168:171], v209 offset:0
ds_read_b128 a[172:175], v209 offset:18432
v_mfma_f32_16x16x32_bf16 v[104:107], a[144:147], a[132:135], v[104:107]
v_rcp_f32 v226, v226
v_mfma_f32_16x16x32_bf16 v[108:111], a[148:151], a[128:131], v[108:111]
s_mov_b64 exec, 0xffff
buffer_load_dwordx4 v1, s[4:7], s39 offen sc1 lds
s_mov_b64 exec, -1
v_mfma_f32_16x16x32_bf16 v[112:115], a[148:151], a[132:135], v[112:115]
s_waitcnt lgkmcnt(4)
v_rcp_f32 v227, v227
v_mfma_f32_16x16x32_bf16 v[100:103], a[152:155], a[136:139], v[100:103]
ds_read_b128 a[144:147], v209 offset:1024
ds_read_b128 a[148:151], v209 offset:19456
v_rcp_f32 v228, v228
v_mfma_f32_16x16x32_bf16 v[104:107], a[152:155], a[140:143], v[104:107]
v_rcp_f32 v229, v229
v_mfma_f32_16x16x32_bf16 v[108:111], a[156:159], a[136:139], v[108:111]
v_rcp_f32 v230, v230
v_mfma_f32_16x16x32_bf16 v[112:115], a[156:159], a[140:143], v[112:115]
s_waitcnt lgkmcnt(4)
v_rcp_f32 v231, v231
v_mfma_f32_16x16x16_bf16 v[100:103], a[160:161], v[212:213], v[100:103]
ds_read_b128 a[152:155], v209 offset:2048
ds_read_b128 a[156:159], v209 offset:20480
v_mfma_f32_16x16x16_bf16 v[104:107], a[160:161], v[214:215], v[104:107]
v_mfma_f32_16x16x16_bf16 v[108:111], a[164:165], v[212:213], v[108:111]
v_mfma_f32_16x16x16_bf16 v[112:115], a[164:165], v[214:215], v[112:115]
s_waitcnt vmcnt(12) lgkmcnt(4)
s_barrier
v_mfma_f32_16x16x32_bf16 v[116:119], a[168:171], a[0:3], 0
ds_read_b128 a[160:163], v209 offset:3072
ds_read_b128 a[164:167], v209 offset:21504
v_mfma_f32_16x16x32_bf16 v[120:123], a[168:171], a[4:7], 0
s_mul_i32 s38, s24, 9216
s_add_u32 m0, s38, 123904
v_mfma_f32_16x16x32_bf16 v[124:127], a[172:175], a[0:3], 0
s_add_u32 s39, s38, s82
v_mfma_f32_16x16x32_bf16 v[128:131], a[172:175], a[4:7], 0
s_waitcnt lgkmcnt(4)
s_add_u32 s39, s39, 303104
v_mfma_f32_16x16x32_bf16 v[116:119], a[144:147], a[8:11], v[116:119]
ds_read_b128 a[168:171], v209 offset:4096
ds_read_b128 a[172:175], v209 offset:22528
v_mfma_f32_16x16x32_bf16 v[120:123], a[144:147], a[12:15], v[120:123]
buffer_load_dwordx4 v1, s[4:7], s39 offen offset:0 sc1 lds
buffer_load_dwordx4 v1, s[4:7], s39 offen offset:1024 sc1 lds
v_mfma_f32_16x16x32_bf16 v[124:127], a[148:151], a[8:11], v[124:127]
v_pk_mul_f32 v[216:217], v[100:101], v[100:101]
v_pk_mul_f32 v[218:219], v[102:103], v[102:103]
v_pk_mul_f32 v[220:221], v[104:105], v[104:105]
v_pk_mul_f32 v[222:223], v[106:107], v[106:107]
v_pk_fma_f32 v[216:217], v[216:217], v[252:253], v[250:251] op_sel:[0,0,0] op_sel_hi:[1,0,0]
v_pk_fma_f32 v[218:219], v[218:219], v[252:253], v[250:251] op_sel:[0,0,0] op_sel_hi:[1,0,0]
v_pk_fma_f32 v[220:221], v[220:221], v[252:253], v[250:251] op_sel:[0,1,1] op_sel_hi:[1,1,1]
v_pk_fma_f32 v[222:223], v[222:223], v[252:253], v[250:251] op_sel:[0,1,1] op_sel_hi:[1,1,1]
v_pk_mul_f32 v[92:93], v[92:93], v[224:225]
v_pk_mul_f32 v[94:95], v[94:95], v[226:227]
v_pk_mul_f32 v[96:97], v[96:97], v[228:229]
v_pk_mul_f32 v[98:99], v[98:99], v[230:231]
v_pk_mul_f32 v[216:217], v[216:217], v[100:101]
v_pk_mul_f32 v[218:219], v[218:219], v[102:103]
v_pk_mul_f32 v[220:221], v[220:221], v[104:105]
v_pk_mul_f32 v[222:223], v[222:223], v[106:107]
v_mfma_f32_16x16x32_bf16 v[128:131], a[148:151], a[12:15], v[128:131]
s_waitcnt lgkmcnt(4)
v_exp_f32 v216, v216
v_exp_f32 v217, v217
v_exp_f32 v218, v218
v_fma_f32 v216, v216, v254, v254
v_fma_f32 v217, v217, v254, v254
v_exp_f32 v219, v219
v_exp_f32 v220, v220
v_fma_f32 v218, v218, v254, v254
v_fma_f32 v219, v219, v254, v254
v_exp_f32 v221, v221
v_mfma_f32_16x16x32_bf16 v[116:119], a[152:155], a[16:19], v[116:119]
ds_read_b128 a[144:147], v209 offset:5120
ds_read_b128 a[148:151], v209 offset:23552
v_exp_f32 v222, v222
v_mfma_f32_16x16x32_bf16 v[120:123], a[152:155], a[20:23], v[120:123]
buffer_load_dwordx4 v1, s[4:7], s39 offen offset:2048 sc1 lds
buffer_load_dwordx4 v1, s[4:7], s39 offen offset:3072 sc1 lds
v_mfma_f32_16x16x32_bf16 v[124:127], a[156:159], a[16:19], v[124:127]
s_add_u32 m0, m0, 4096
v_fma_f32 v220, v220, v255, v255
v_fma_f32 v221, v221, v255, v255
v_mfma_f32_16x16x32_bf16 v[128:131], a[156:159], a[20:23], v[128:131]
s_waitcnt lgkmcnt(4)
s_add_u32 s39, s39, 4096
v_exp_f32 v223, v223
v_mfma_f32_16x16x32_bf16 v[116:119], a[160:163], a[24:27], v[116:119]
ds_read_b128 a[152:155], v209 offset:6144
ds_read_b128 a[156:159], v209 offset:24576
v_rcp_f32 v216, v216
v_mfma_f32_16x16x32_bf16 v[120:123], a[160:163], a[28:31], v[120:123]
buffer_load_dwordx4 v1, s[4:7], s39 offen offset:0 sc1 lds
buffer_load_dwordx4 v1, s[4:7], s39 offen offset:1024 sc1 lds
v_mfma_f32_16x16x32_bf16 v[124:127], a[164:167], a[24:27], v[124:127]
v_fma_f32 v222, v222, v255, v255
v_fma_f32 v223, v223, v255, v255
v_mfma_f32_16x16x32_bf16 v[128:131], a[164:167], a[28:31], v[128:131]
s_waitcnt lgkmcnt(4)
v_rcp_f32 v217, v217
v_mfma_f32_16x16x32_bf16 v[116:119], a[168:171], a[32:35], v[116:119]
ds_read_b128 a[160:163], v209 offset:7168
ds_read_b128 a[164:167], v209 offset:25600
v_rcp_f32 v218, v218
v_mfma_f32_16x16x32_bf16 v[120:123], a[168:171], a[36:39], v[120:123]
buffer_load_dwordx4 v1, s[4:7], s39 offen offset:2048 sc1 lds
buffer_load_dwordx4 v1, s[4:7], s39 offen offset:3072 sc1 lds
v_mfma_f32_16x16x32_bf16 v[124:127], a[172:175], a[32:35], v[124:127]
s_add_u32 m0, m0, 4096
s_add_u32 s39, s39, 4096
v_rcp_f32 v219, v219
v_mfma_f32_16x16x32_bf16 v[128:131], a[172:175], a[36:39], v[128:131]
s_waitcnt lgkmcnt(4)
v_rcp_f32 v220, v220
v_mfma_f32_16x16x32_bf16 v[116:119], a[144:147], a[40:43], v[116:119]
ds_read_b128 a[168:171], v209 offset:8192
ds_read_b128 a[172:175], v209 offset:26624
v_rcp_f32 v221, v221
v_rcp_f32 v222, v222
v_rcp_f32 v223, v223
v_mfma_f32_16x16x32_bf16 v[120:123], a[144:147], a[44:47], v[120:123]
buffer_load_dwordx4 v1, s[4:7], s39 offen offset:0 sc1 lds
s_lshl_b32 s38, s24, 8
s_nop 0
v_pk_mul_f32 v[100:101], v[100:101], v[216:217]
v_pk_mul_f32 v[102:103], v[102:103], v[218:219]
v_pk_mul_f32 v[104:105], v[104:105], v[220:221]
v_pk_mul_f32 v[106:107], v[106:107], v[222:223]
v_pk_add_f32 v[198:199], v[36:37], v[38:39]
v_pk_mul_f32 v[200:201], v[36:37], v[36:37]
v_pk_fma_f32 v[200:201], v[38:39], v[38:39], v[200:201]
v_pk_add_f32 v[202:203], v[40:41], v[42:43]
v_pk_mul_f32 v[204:205], v[40:41], v[40:41]
v_pk_fma_f32 v[204:205], v[42:43], v[42:43], v[204:205]
v_pk_add_f32 v[198:199], v[198:199], v[44:45]
v_pk_fma_f32 v[200:201], v[44:45], v[44:45], v[200:201]
v_pk_add_f32 v[198:199], v[198:199], v[46:47]
v_pk_fma_f32 v[200:201], v[46:47], v[46:47], v[200:201]
v_pk_add_f32 v[202:203], v[202:203], v[48:49]
v_pk_fma_f32 v[204:205], v[48:49], v[48:49], v[204:205]
v_pk_add_f32 v[202:203], v[202:203], v[50:51]
v_pk_fma_f32 v[204:205], v[50:51], v[50:51], v[204:205]
v_pk_add_f32 v[198:199], v[198:199], v[52:53]
v_pk_fma_f32 v[200:201], v[52:53], v[52:53], v[200:201]
v_pk_add_f32 v[198:199], v[198:199], v[54:55]
v_pk_fma_f32 v[200:201], v[54:55], v[54:55], v[200:201]
v_pk_add_f32 v[202:203], v[202:203], v[56:57]
v_pk_fma_f32 v[204:205], v[56:57], v[56:57], v[204:205]
v_pk_add_f32 v[202:203], v[202:203], v[58:59]
v_pk_fma_f32 v[204:205], v[58:59], v[58:59], v[204:205]
v_pk_add_f32 v[198:199], v[198:199], v[60:61]
v_pk_fma_f32 v[200:201], v[60:61], v[60:61], v[200:201]
v_pk_add_f32 v[198:199], v[198:199], v[62:63]
v_pk_fma_f32 v[200:201], v[62:63], v[62:63], v[200:201]
v_pk_add_f32 v[202:203], v[202:203], v[64:65]
v_pk_fma_f32 v[204:205], v[64:65], v[64:65], v[204:205]
v_pk_add_f32 v[202:203], v[202:203], v[66:67]
v_pk_fma_f32 v[204:205], v[66:67], v[66:67], v[204:205]
v_pk_add_f32 v[198:199], v[198:199], v[68:69]
v_pk_fma_f32 v[200:201], v[68:69], v[68:69], v[200:201]
v_pk_add_f32 v[198:199], v[198:199], v[70:71]
v_pk_fma_f32 v[200:201], v[70:71], v[70:71], v[200:201]
v_pk_add_f32 v[202:203], v[202:203], v[72:73]
v_pk_fma_f32 v[204:205], v[72:73], v[72:73], v[204:205]
v_pk_add_f32 v[202:203], v[202:203], v[74:75]
v_pk_fma_f32 v[204:205], v[74:75], v[74:75], v[204:205]
v_pk_add_f32 v[198:199], v[198:199], v[76:77]
v_pk_fma_f32 v[200:201], v[76:77], v[76:77], v[200:201]
v_pk_add_f32 v[198:199], v[198:199], v[78:79]
v_pk_fma_f32 v[200:201], v[78:79], v[78:79], v[200:201]
v_pk_add_f32 v[202:203], v[202:203], v[80:81]
v_pk_fma_f32 v[204:205], v[80:81], v[80:81], v[204:205]
v_pk_add_f32 v[202:203], v[202:203], v[82:83]
v_pk_fma_f32 v[204:205], v[82:83], v[82:83], v[204:205]
v_pk_add_f32 v[198:199], v[198:199], v[84:85]
v_pk_fma_f32 v[200:201], v[84:85], v[84:85], v[200:201]
v_pk_add_f32 v[198:199], v[198:199], v[86:87]
v_pk_fma_f32 v[200:201], v[86:87], v[86:87], v[200:201]
v_pk_add_f32 v[202:203], v[202:203], v[88:89]
v_pk_fma_f32 v[204:205], v[88:89], v[88:89], v[204:205]
v_pk_add_f32 v[202:203], v[202:203], v[90:91]
v_pk_fma_f32 v[204:205], v[90:91], v[90:91], v[204:205]
v_pk_add_f32 v[198:199], v[198:199], v[92:93]
v_pk_fma_f32 v[200:201], v[92:93], v[92:93], v[200:201]
v_pk_add_f32 v[198:199], v[198:199], v[94:95]
v_pk_fma_f32 v[200:201], v[94:95], v[94:95], v[200:201]
v_pk_add_f32 v[202:203], v[202:203], v[96:97]
v_pk_fma_f32 v[204:205], v[96:97], v[96:97], v[204:205]
v_pk_add_f32 v[202:203], v[202:203], v[98:99]
v_pk_fma_f32 v[204:205], v[98:99], v[98:99], v[204:205]
v_pk_add_f32 v[198:199], v[198:199], v[100:101]
v_pk_fma_f32 v[200:201], v[100:101], v[100:101], v[200:201]
v_pk_add_f32 v[198:199], v[198:199], v[102:103]
v_pk_fma_f32 v[200:201], v[102:103], v[102:103], v[200:201]
v_pk_add_f32 v[202:203], v[202:203], v[104:105]
v_pk_fma_f32 v[204:205], v[104:105], v[104:105], v[204:205]
v_pk_add_f32 v[202:203], v[202:203], v[106:107]
v_pk_fma_f32 v[204:205], v[106:107], v[106:107], v[204:205]
v_mfma_f32_16x16x32_bf16 v[124:127], a[148:151], a[40:43], v[124:127]
s_add_u32 m0, s38, 160768
v_add_f32 v198, v198, v199
v_add_f32 v202, v202, v203
v_mfma_f32_16x16x32_bf16 v[128:131], a[148:151], a[44:47], v[128:131]
s_waitcnt lgkmcnt(4)
s_add_u32 s39, s38, s82
v_add_f32 v200, v200, v201
v_add_f32 v204, v204, v205
v_permlane16_swap_b32 v198, v202
v_mfma_f32_16x16x32_bf16 v[116:119], a[152:155], a[48:51], v[116:119]
ds_read_b128 a[144:147], v209 offset:9216
ds_read_b128 a[148:151], v209 offset:27648
s_nop 0
v_mfma_f32_16x16x32_bf16 v[120:123], a[152:155], a[52:55], v[120:123]
s_add_u32 s39, s39, 339968
v_permlane16_swap_b32 v200, v204
v_add_f32 v198, v198, v202
v_mfma_f32_16x16x32_bf16 v[124:127], a[156:159], a[48:51], v[124:127]
s_mov_b64 exec, 0xffff
buffer_load_dwordx4 v1, s[4:7], s39 offen sc1 lds
s_mov_b64 exec, -1
v_add_f32 v199, v200, v204
v_mov_b32 v200, v198
v_mfma_f32_16x16x32_bf16 v[128:131], a[156:159], a[52:55], v[128:131]
s_waitcnt lgkmcnt(4)
v_mov_b32 v201, v199
s_nop 0
v_permlane32_swap_b32 v198, v200
v_mfma_f32_16x16x32_bf16 v[116:119], a[160:163], a[56:59], v[116:119]
ds_read_b128 a[152:155], v209 offset:10240
ds_read_b128 a[156:159], v209 offset:28672
v_permlane32_swap_b32 v199, v201
v_mfma_f32_16x16x32_bf16 v[120:123], a[160:163], a[60:63], v[120:123]
v_add_f32 v198, v198, v200
v_add_f32 v199, v199, v201
v_mfma_f32_16x16x32_bf16 v[124:127], a[164:167], a[56:59], v[124:127]
s_waitcnt vmcnt(21)
s_mov_b32 exec_hi, 0
buffer_store_dwordx2 v[198:199], v239, s[8:11], s30 offen sc1
s_mov_b64 exec, -1
v_mfma_f32_16x16x32_bf16 v[128:131], a[164:167], a[60:63], v[128:131]
s_waitcnt lgkmcnt(4)
v_mfma_f32_16x16x32_bf16 v[116:119], a[168:171], a[64:67], v[116:119]
ds_read_b128 a[160:163], v209 offset:11264
ds_read_b128 a[164:167], v209 offset:29696
v_mfma_f32_16x16x32_bf16 v[120:123], a[168:171], a[68:71], v[120:123]
v_mfma_f32_16x16x32_bf16 v[124:127], a[172:175], a[64:67], v[124:127]
v_mfma_f32_16x16x32_bf16 v[128:131], a[172:175], a[68:71], v[128:131]
s_waitcnt lgkmcnt(4)
v_mfma_f32_16x16x32_bf16 v[116:119], a[144:147], a[72:75], v[116:119]
ds_read_b128 a[168:171], v209 offset:12288
ds_read_b128 a[172:175], v209 offset:30720
v_mfma_f32_16x16x32_bf16 v[120:123], a[144:147], a[76:79], v[120:123]
v_mfma_f32_16x16x32_bf16 v[124:127], a[148:151], a[72:75], v[124:127]
v_mfma_f32_16x16x32_bf16 v[128:131], a[148:151], a[76:79], v[128:131]
s_waitcnt lgkmcnt(4)
v_mfma_f32_16x16x32_bf16 v[116:119], a[152:155], a[80:83], v[116:119]
ds_read_b128 a[144:147], v209 offset:13312
ds_read_b128 a[148:151], v209 offset:31744
v_mfma_f32_16x16x32_bf16 v[120:123], a[152:155], a[84:87], v[120:123]
v_mfma_f32_16x16x32_bf16 v[124:127], a[156:159], a[80:83], v[124:127]
v_mfma_f32_16x16x32_bf16 v[128:131], a[156:159], a[84:87], v[128:131]
s_waitcnt lgkmcnt(4)
v_mfma_f32_16x16x32_bf16 v[116:119], a[160:163], a[88:91], v[116:119]
ds_read_b128 a[152:155], v209 offset:14336
ds_read_b128 a[156:159], v209 offset:32768
v_mfma_f32_16x16x32_bf16 v[120:123], a[160:163], a[92:95], v[120:123]
v_mfma_f32_16x16x32_bf16 v[124:127], a[164:167], a[88:91], v[124:127]
v_mfma_f32_16x16x32_bf16 v[128:131], a[164:167], a[92:95], v[128:131]
s_waitcnt lgkmcnt(4)
v_mfma_f32_16x16x32_bf16 v[116:119], a[168:171], a[96:99], v[116:119]
ds_read_b128 a[160:163], v209 offset:15360
ds_read_b128 a[164:167], v209 offset:33792
v_mfma_f32_16x16x32_bf16 v[120:123], a[168:171], a[100:103], v[120:123]
v_mfma_f32_16x16x32_bf16 v[124:127], a[172:175], a[96:99], v[124:127]
v_mfma_f32_16x16x32_bf16 v[128:131], a[172:175], a[100:103], v[128:131]
s_waitcnt lgkmcnt(4)
v_mfma_f32_16x16x32_bf16 v[116:119], a[144:147], a[104:107], v[116:119]
ds_read_b128 a[168:171], v209 offset:16384
ds_read_b128 a[172:175], v209 offset:34816
v_mfma_f32_16x16x32_bf16 v[120:123], a[144:147], a[108:111], v[120:123]
v_mfma_f32_16x16x32_bf16 v[124:127], a[148:151], a[104:107], v[124:127]
v_mfma_f32_16x16x32_bf16 v[128:131], a[148:151], a[108:111], v[128:131]
s_waitcnt lgkmcnt(4)
v_mfma_f32_16x16x32_bf16 v[116:119], a[152:155], a[112:115], v[116:119]
ds_read_b128 a[144:147], v209 offset:17408
ds_read_b128 a[148:151], v209 offset:35840
v_mfma_f32_16x16x32_bf16 v[120:123], a[152:155], a[116:119], v[120:123]
v_mfma_f32_16x16x32_bf16 v[124:127], a[156:159], a[112:115], v[124:127]
v_mfma_f32_16x16x32_bf16 v[128:131], a[156:159], a[116:119], v[128:131]
s_waitcnt lgkmcnt(4)
v_add_u32 v181, 36864, v239
v_mfma_f32_16x16x32_bf16 v[116:119], a[160:163], a[120:123], v[116:119]
ds_read_b64 a[152:153], v181 offset:0
ds_read_b64 a[156:157], v181 offset:512
v_mfma_f32_16x16x32_bf16 v[120:123], a[160:163], a[124:127], v[120:123]
v_mfma_f32_16x16x32_bf16 v[124:127], a[164:167], a[120:123], v[124:127]
v_mfma_f32_16x16x32_bf16 v[128:131], a[164:167], a[124:127], v[128:131]
s_waitcnt lgkmcnt(4)
v_mfma_f32_16x16x32_bf16 v[116:119], a[168:171], a[128:131], v[116:119]
ds_read_b128 a[160:163], v210 offset:0
ds_read_b128 a[164:167], v210 offset:18432
v_mfma_f32_16x16x32_bf16 v[120:123], a[168:171], a[132:135], v[120:123]
buffer_load_dwordx2 v[182:183], v234, s[8:11], s61 offen offset:0 sc1
v_mfma_f32_16x16x32_bf16 v[124:127], a[172:175], a[128:131], v[124:127]
buffer_load_dwordx2 v[184:185], v234, s[8:11], s61 offen offset:1024 sc1
v_mfma_f32_16x16x32_bf16 v[128:131], a[172:175], a[132:135], v[128:131]
s_waitcnt lgkmcnt(4)
v_mfma_f32_16x16x32_bf16 v[116:119], a[144:147], a[136:139], v[116:119]
ds_read_b128 a[168:171], v210 offset:1024
ds_read_b128 a[172:175], v210 offset:19456
v_mfma_f32_16x16x32_bf16 v[120:123], a[144:147], a[140:143], v[120:123]
buffer_load_dwordx2 v[186:187], v234, s[8:11], s61 offen offset:2048 sc1
v_mfma_f32_16x16x32_bf16 v[124:127], a[148:151], a[136:139], v[124:127]
buffer_load_dwordx2 v[188:189], v234, s[8:11], s61 offen offset:3072 sc1
v_mfma_f32_16x16x32_bf16 v[128:131], a[148:151], a[140:143], v[128:131]
s_waitcnt lgkmcnt(4)
v_mfma_f32_16x16x16_bf16 v[116:119], a[152:153], v[212:213], v[116:119]
ds_read_b128 a[144:147], v210 offset:2048
ds_read_b128 a[148:151], v210 offset:20480
v_mfma_f32_16x16x16_bf16 v[120:123], a[152:153], v[214:215], v[120:123]
buffer_load_dwordx2 v[190:191], v235, s[8:11], s61 offen offset:0 sc1
v_mfma_f32_16x16x16_bf16 v[124:127], a[156:157], v[212:213], v[124:127]
buffer_load_dwordx2 v[192:193], v235, s[8:11], s61 offen offset:1024 sc1
v_mfma_f32_16x16x16_bf16 v[128:131], a[156:157], v[214:215], v[128:131]
s_waitcnt vmcnt(17) lgkmcnt(4)
s_barrier
v_mfma_f32_16x16x32_bf16 v[132:135], a[160:163], a[0:3], 0
ds_read_b128 a[152:155], v210 offset:3072
ds_read_b128 a[156:159], v210 offset:21504
v_mfma_f32_16x16x32_bf16 v[136:139], a[160:163], a[4:7], 0
buffer_load_dwordx2 v[194:195], v235, s[8:11], s61 offen offset:2048 sc1
v_mfma_f32_16x16x32_bf16 v[140:143], a[164:167], a[0:3], 0
buffer_load_dwordx2 v[196:197], v235, s[8:11], s61 offen offset:3072 sc1
v_mfma_f32_16x16x32_bf16 v[144:147], a[164:167], a[4:7], 0
s_waitcnt lgkmcnt(4)
v_mfma_f32_16x16x32_bf16 v[132:135], a[168:171], a[8:11], v[132:135]
ds_read_b128 a[160:163], v210 offset:4096
ds_read_b128 a[164:167], v210 offset:22528
v_mfma_f32_16x16x32_bf16 v[136:139], a[168:171], a[12:15], v[136:139]
v_mfma_f32_16x16x32_bf16 v[140:143], a[172:175], a[8:11], v[140:143]
v_mfma_f32_16x16x32_bf16 v[144:147], a[172:175], a[12:15], v[144:147]
s_waitcnt lgkmcnt(4)
v_mfma_f32_16x16x32_bf16 v[132:135], a[144:147], a[16:19], v[132:135]
ds_read_b128 a[168:171], v210 offset:5120
ds_read_b128 a[172:175], v210 offset:23552
v_mfma_f32_16x16x32_bf16 v[136:139], a[144:147], a[20:23], v[136:139]
v_mfma_f32_16x16x32_bf16 v[140:143], a[148:151], a[16:19], v[140:143]
v_mfma_f32_16x16x32_bf16 v[144:147], a[148:151], a[20:23], v[144:147]
s_waitcnt lgkmcnt(4)
v_mfma_f32_16x16x32_bf16 v[132:135], a[152:155], a[24:27], v[132:135]
ds_read_b128 a[144:147], v210 offset:6144
ds_read_b128 a[148:151], v210 offset:24576
v_mfma_f32_16x16x32_bf16 v[136:139], a[152:155], a[28:31], v[136:139]
v_mfma_f32_16x16x32_bf16 v[140:143], a[156:159], a[24:27], v[140:143]
v_mfma_f32_16x16x32_bf16 v[144:147], a[156:159], a[28:31], v[144:147]
s_waitcnt lgkmcnt(4)
v_mfma_f32_16x16x32_bf16 v[132:135], a[160:163], a[32:35], v[132:135]
ds_read_b128 a[152:155], v210 offset:7168
ds_read_b128 a[156:159], v210 offset:25600
v_mfma_f32_16x16x32_bf16 v[136:139], a[160:163], a[36:39], v[136:139]
v_mfma_f32_16x16x32_bf16 v[140:143], a[164:167], a[32:35], v[140:143]
v_mfma_f32_16x16x32_bf16 v[144:147], a[164:167], a[36:39], v[144:147]
s_waitcnt lgkmcnt(4)
v_mfma_f32_16x16x32_bf16 v[132:135], a[168:171], a[40:43], v[132:135]
ds_read_b128 a[160:163], v210 offset:8192
ds_read_b128 a[164:167], v210 offset:26624
v_mfma_f32_16x16x32_bf16 v[136:139], a[168:171], a[44:47], v[136:139]
v_mfma_f32_16x16x32_bf16 v[140:143], a[172:175], a[40:43], v[140:143]
v_mfma_f32_16x16x32_bf16 v[144:147], a[172:175], a[44:47], v[144:147]
s_waitcnt lgkmcnt(4)
v_mfma_f32_16x16x32_bf16 v[132:135], a[144:147], a[48:51], v[132:135]
ds_read_b128 a[168:171], v210 offset:9216
ds_read_b128 a[172:175], v210 offset:27648
v_mfma_f32_16x16x32_bf16 v[136:139], a[144:147], a[52:55], v[136:139]
v_mfma_f32_16x16x32_bf16 v[140:143], a[148:151], a[48:51], v[140:143]
v_mfma_f32_16x16x32_bf16 v[144:147], a[148:151], a[52:55], v[144:147]
s_waitcnt lgkmcnt(4)
v_mfma_f32_16x16x32_bf16 v[132:135], a[152:155], a[56:59], v[132:135]
ds_read_b128 a[144:147], v210 offset:10240
ds_read_b128 a[148:151], v210 offset:28672
v_mfma_f32_16x16x32_bf16 v[136:139], a[152:155], a[60:63], v[136:139]
v_mfma_f32_16x16x32_bf16 v[140:143], a[156:159], a[56:59], v[140:143]
v_mfma_f32_16x16x32_bf16 v[144:147], a[156:159], a[60:63], v[144:147]
s_waitcnt lgkmcnt(4)
v_mfma_f32_16x16x32_bf16 v[132:135], a[160:163], a[64:67], v[132:135]
ds_read_b128 a[152:155], v210 offset:11264
ds_read_b128 a[156:159], v210 offset:29696
v_mfma_f32_16x16x32_bf16 v[136:139], a[160:163], a[68:71], v[136:139]
v_mfma_f32_16x16x32_bf16 v[140:143], a[164:167], a[64:67], v[140:143]
v_mfma_f32_16x16x32_bf16 v[144:147], a[164:167], a[68:71], v[144:147]
s_waitcnt lgkmcnt(4)
v_mfma_f32_16x16x32_bf16 v[132:135], a[168:171], a[72:75], v[132:135]
ds_read_b128 a[160:163], v210 offset:12288
ds_read_b128 a[164:167], v210 offset:30720
v_mfma_f32_16x16x32_bf16 v[136:139], a[168:171], a[76:79], v[136:139]
v_mfma_f32_16x16x32_bf16 v[140:143], a[172:175], a[72:75], v[140:143]
s_waitcnt vmcnt(0)
v_min3_f32 v200, v183, v185, v187
v_mfma_f32_16x16x32_bf16 v[144:147], a[172:175], a[76:79], v[144:147]
s_waitcnt lgkmcnt(4)
v_min3_f32 v201, v189, v191, v193
v_mfma_f32_16x16x32_bf16 v[132:135], a[144:147], a[80:83], v[132:135]
ds_read_b128 a[168:171], v210 offset:13312
ds_read_b128 a[172:175], v210 offset:31744
v_mfma_f32_16x16x32_bf16 v[136:139], a[144:147], a[84:87], v[136:139]
v_min3_f32 v200, v200, v195, v197
v_min_f32 v200, v200, v201
v_mfma_f32_16x16x32_bf16 v[140:143], a[148:151], a[80:83], v[140:143]
v_cmp_gt_f32 vcc, 0, v200
v_mfma_f32_16x16x32_bf16 v[144:147], a[148:151], a[84:87], v[144:147]
s_waitcnt lgkmcnt(4)
s_nop 0
s_cbranch_vccnz L_stzslow_23
L_stzback_24:
v_mfma_f32_16x16x32_bf16 v[132:135], a[152:155], a[88:91], v[132:135]
ds_read_b128 a[144:147], v210 offset:14336
ds_read_b128 a[148:151], v210 offset:32768
v_mfma_f32_16x16x32_bf16 v[136:139], a[152:155], a[92:95], v[136:139]
v_add_f32 v198, v182, v184
v_add_f32 v199, v183, v185
v_mfma_f32_16x16x32_bf16 v[140:143], a[156:159], a[88:91], v[140:143]
buffer_load_dwordx4 a[176:179], v1, s[4:7], s52 offen offset:0 sc1
buffer_load_dwordx4 a[180:183], v9, s[4:7], s52 offen offset:0 sc1
v_add_f32 v198, v198, v186
v_add_f32 v199, v199, v187
v_mfma_f32_16x16x32_bf16 v[144:147], a[156:159], a[92:95], v[144:147]
s_waitcnt lgkmcnt(4)
v_add_f32 v198, v198, v188
v_add_f32 v199, v199, v189
v_mfma_f32_16x16x32_bf16 v[132:135], a[160:163], a[96:99], v[132:135]
ds_read_b128 a[152:155], v210 offset:15360
ds_read_b128 a[156:159], v210 offset:33792
v_add_f32 v198, v198, v190
v_mfma_f32_16x16x32_bf16 v[136:139], a[160:163], a[100:103], v[136:139]
v_add_f32 v199, v199, v191
v_add_f32 v198, v198, v192
v_mfma_f32_16x16x32_bf16 v[140:143], a[164:167], a[96:99], v[140:143]
buffer_load_dwordx4 a[184:187], v1, s[4:7], s52 offen offset:1024 sc1
buffer_load_dwordx4 a[188:191], v9, s[4:7], s52 offen offset:1024 sc1
v_add_f32 v199, v199, v193
v_add_f32 v198, v198, v194
v_mfma_f32_16x16x32_bf16 v[144:147], a[164:167], a[100:103], v[144:147]
s_waitcnt lgkmcnt(4)
v_add_f32 v199, v199, v195
v_add_f32 v198, v198, v196
v_mfma_f32_16x16x32_bf16 v[132:135], a[168:171], a[104:107], v[132:135]
ds_read_b128 a[160:163], v210 offset:16384
ds_read_b128 a[164:167], v210 offset:34816
v_add_f32 v199, v199, v197
v_mov_b32 v200, v198
v_mfma_f32_16x16x32_bf16 v[136:139], a[168:171], a[108:111], v[136:139]
v_mov_b32 v201, v199
s_nop 0
v_mfma_f32_16x16x32_bf16 v[140:143], a[172:175], a[104:107], v[140:143]
v_permlane32_swap_b32 v198, v200
v_mfma_f32_16x16x32_bf16 v[144:147], a[172:175], a[108:111], v[144:147]
s_waitcnt lgkmcnt(4)
v_permlane32_swap_b32 v199, v201
v_mfma_f32_16x16x32_bf16 v[132:135], a[144:147], a[112:115], v[132:135]
ds_read_b128 a[168:171], v210 offset:17408
ds_read_b128 a[172:175], v210 offset:35840
v_add_f32 v198, v198, v200
v_mfma_f32_16x16x32_bf16 v[136:139], a[144:147], a[116:119], v[136:139]
buffer_load_dwordx4 a[192:195], v1, s[4:7], s52 offen offset:2048 sc1
buffer_load_dwordx4 a[196:199], v9, s[4:7], s52 offen offset:2048 sc1
v_add_f32 v199, v199, v201
v_mul_f32 v198, 0x39e38e39, v198
v_mfma_f32_16x16x32_bf16 v[140:143], a[148:151], a[112:115], v[140:143]
v_mul_f32 v200, v198, v198
v_mul_f32 v199, 0x39e38e39, v199
v_mfma_f32_16x16x32_bf16 v[144:147], a[148:151], a[116:119], v[144:147]
s_waitcnt lgkmcnt(4)
v_sub_f32 v199, v199, v200
v_add_u32 v181, 74752, v239
v_mfma_f32_16x16x32_bf16 v[132:135], a[152:155], a[120:123], v[132:135]
ds_read_b64 a[144:145], v181 offset:0
ds_read_b64 a[148:149], v181 offset:512
v_max_f32 v199, 0, v199
v_add_f32 v199, 0x3727c5ac, v199
v_mfma_f32_16x16x32_bf16 v[136:139], a[152:155], a[124:127], v[136:139]
buffer_load_dwordx4 a[200:203], v1, s[4:7], s52 offen offset:3072 sc1
buffer_load_dwordx4 a[204:207], v9, s[4:7], s52 offen offset:3072 sc1
v_rsq_f32 v202, v199
v_mfma_f32_16x16x32_bf16 v[140:143], a[156:159], a[120:123], v[140:143]
s_nop 0
v_mul_f32 v204, v198, v202
v_mov_b32 v203, v202
v_mfma_f32_16x16x32_bf16 v[144:147], a[156:159], a[124:127], v[144:147]
s_waitcnt lgkmcnt(4)
v_mov_b32 v205, v204
s_nop 0
v_mfma_f32_16x16x32_bf16 v[132:135], a[160:163], a[128:131], v[132:135]
ds_read_b128 a[152:155], v211 offset:0
ds_read_b128 a[156:159], v211 offset:18432
v_mfma_f32_16x16x32_bf16 v[136:139], a[160:163], a[132:135], v[136:139]
s_mov_b32 s52, s53
v_permlane16_swap_b32 v202, v203
v_mfma_f32_16x16x32_bf16 v[140:143], a[164:167], a[128:131], v[140:143]
s_cmp_eq_u32 s25, 0
s_cselect_b32 s98, 4096, 0
v_permlane16_swap_b32 v204, v205
v_mfma_f32_16x16x32_bf16 v[144:147], a[164:167], a[132:135], v[144:147]
s_waitcnt lgkmcnt(4)
v_fma_f32 v36, v36, v202, -v204
v_fma_f32 v37, v37, v202, -v204
v_mfma_f32_16x16x32_bf16 v[132:135], a[168:171], a[136:139], v[132:135]
ds_read_b128 a[160:163], v211 offset:1024
ds_read_b128 a[164:167], v211 offset:19456
v_fma_f32 v38, v38, v202, -v204
v_mfma_f32_16x16x32_bf16 v[136:139], a[168:171], a[140:143], v[136:139]
s_add_u32 s52, s52, s98
v_fma_f32 v39, v39, v202, -v204
v_fma_f32 v44, v44, v202, -v204
v_mfma_f32_16x16x32_bf16 v[140:143], a[172:175], a[136:139], v[140:143]
v_fma_f32 v45, v45, v202, -v204
v_fma_f32 v46, v46, v202, -v204
v_mfma_f32_16x16x32_bf16 v[144:147], a[172:175], a[140:143], v[144:147]
s_waitcnt lgkmcnt(4)
v_fma_f32 v47, v47, v202, -v204
v_cvt_pk_bf16_f32 v216, v36, v37
v_mfma_f32_16x16x16_bf16 v[132:135], a[144:145], v[212:213], v[132:135]
ds_read_b128 a[168:171], v211 offset:2048
ds_read_b128 a[172:175], v211 offset:20480
v_cvt_pk_bf16_f32 v217, v38, v39
v_cvt_pk_bf16_f32 v218, v44, v45
v_mfma_f32_16x16x16_bf16 v[136:139], a[144:145], v[214:215], v[136:139]
v_cvt_pk_bf16_f32 v219, v46, v47
v_mfma_f32_16x16x16_bf16 v[140:143], a[148:149], v[212:213], v[140:143]
ds_write_b128 v236, v[216:219] offset:0
v_fma_f32 v40, v40, v203, -v205
v_mfma_f32_16x16x16_bf16 v[144:147], a[148:149], v[214:215], v[144:147]
s_waitcnt lgkmcnt(5)
v_fma_f32 v41, v41, v203, -v205
v_fma_f32 v42, v42, v203, -v205
s_barrier
v_mfma_f32_16x16x32_bf16 v[148:151], a[152:155], a[0:3], 0
ds_read_b128 a[144:147], v211 offset:3072
ds_read_b128 a[148:151], v211 offset:21504
v_fma_f32 v43, v43, v203, -v205
v_fma_f32 v48, v48, v203, -v205
v_mfma_f32_16x16x32_bf16 v[152:155], a[152:155], a[4:7], 0
buffer_load_dwordx4 a[208:211], v1, s[4:7], s52 offen offset:0 sc1
buffer_load_dwordx4 a[212:215], v9, s[4:7], s52 offen offset:0 sc1
v_fma_f32 v49, v49, v203, -v205
v_fma_f32 v50, v50, v203, -v205
v_mfma_f32_16x16x32_bf16 v[156:159], a[156:159], a[0:3], 0
buffer_load_dwordx4 a[216:219], v1, s[4:7], s52 offen offset:1024 sc1
buffer_load_dwordx4 a[220:223], v9, s[4:7], s52 offen offset:1024 sc1
v_fma_f32 v51, v51, v203, -v205
v_mfma_f32_16x16x32_bf16 v[160:163], a[156:159], a[4:7], 0
s_waitcnt lgkmcnt(5)
v_cvt_pk_bf16_f32 v220, v40, v41
v_cvt_pk_bf16_f32 v221, v42, v43
v_mfma_f32_16x16x32_bf16 v[148:151], a[160:163], a[8:11], v[148:151]
ds_read_b128 a[152:155], v211 offset:4096
ds_read_b128 a[156:159], v211 offset:22528
v_cvt_pk_bf16_f32 v222, v48, v49
v_cvt_pk_bf16_f32 v223, v50, v51
v_mfma_f32_16x16x32_bf16 v[152:155], a[160:163], a[12:15], v[152:155]
ds_write_b128 v236, v[220:223] offset:4608
v_mfma_f32_16x16x32_bf16 v[156:159], a[164:167], a[8:11], v[156:159]
ds_read_b64_tr_b16 v[36:37], v237 offset:0
ds_read_b64_tr_b16 v[38:39], v237 offset:1152
ds_read_b64_tr_b16 v[40:41], v237 offset:8
ds_read_b64_tr_b16 v[42:43], v237 offset:1160
v_mfma_f32_16x16x32_bf16 v[160:163], a[164:167], a[12:15], v[160:163]
s_waitcnt lgkmcnt(10)
v_fma_f32 v52, v52, v202, -v204
v_fma_f32 v53, v53, v202, -v204
v_mfma_f32_16x16x32_bf16 v[148:151], a[168:171], a[16:19], v[148:151]
ds_read_b128 a[160:163], v211 offset:5120
ds_read_b128 a[164:167], v211 offset:23552
v_mfma_f32_16x16x32_bf16 v[152:155], a[168:171], a[20:23], v[152:155]
buffer_load_dwordx4 a[224:227], v1, s[4:7], s52 offen offset:2048 sc1
buffer_load_dwordx4 a[228:231], v9, s[4:7], s52 offen offset:2048 sc1
v_mfma_f32_16x16x32_bf16 v[156:159], a[172:175], a[16:19], v[156:159]
v_fma_f32 v54, v54, v202, -v204
v_fma_f32 v55, v55, v202, -v204
v_mfma_f32_16x16x32_bf16 v[160:163], a[172:175], a[20:23], v[160:163]
s_waitcnt lgkmcnt(9)
v_fma_f32 v60, v60, v202, -v204
v_fma_f32 v61, v61, v202, -v204
v_mfma_f32_16x16x32_bf16 v[148:151], a[144:147], a[24:27], v[148:151]
ds_read_b128 a[168:171], v211 offset:6144
ds_read_b128 a[172:175], v211 offset:24576
v_mfma_f32_16x16x32_bf16 v[152:155], a[144:147], a[28:31], v[152:155]
buffer_load_dwordx4 a[232:235], v1, s[4:7], s52 offen offset:3072 sc1
buffer_load_dwordx4 a[236:239], v9, s[4:7], s52 offen offset:3072 sc1
v_fma_f32 v62, v62, v202, -v204
v_mfma_f32_16x16x32_bf16 v[156:159], a[148:151], a[24:27], v[156:159]
v_fma_f32 v63, v63, v202, -v204
v_cvt_pk_bf16_f32 v224, v52, v53
v_mfma_f32_16x16x32_bf16 v[160:163], a[148:151], a[28:31], v[160:163]
s_waitcnt lgkmcnt(9)
v_cvt_pk_bf16_f32 v225, v54, v55
v_cvt_pk_bf16_f32 v226, v60, v61
v_mfma_f32_16x16x32_bf16 v[148:151], a[152:155], a[32:35], v[148:151]
ds_read_b128 a[144:147], v211 offset:7168
ds_read_b128 a[148:151], v211 offset:25600
v_mfma_f32_16x16x32_bf16 v[152:155], a[152:155], a[36:39], v[152:155]
v_cvt_pk_bf16_f32 v227, v62, v63
v_mfma_f32_16x16x32_bf16 v[156:159], a[156:159], a[32:35], v[156:159]
ds_write_b128 v236, v[224:227] offset:64
v_mfma_f32_16x16x32_bf16 v[160:163], a[156:159], a[36:39], v[160:163]
s_waitcnt lgkmcnt(5)
buffer_store_dwordx4 v[36:39], v1, s[8:11], s66 offen offset:0 sc1
v_mfma_f32_16x16x32_bf16 v[148:151], a[160:163], a[40:43], v[148:151]
ds_read_b128 a[152:155], v211 offset:8192
ds_read_b128 a[156:159], v211 offset:26624
v_mfma_f32_16x16x32_bf16 v[152:155], a[160:163], a[44:47], v[152:155]
v_fma_f32 v56, v56, v203, -v205
v_fma_f32 v57, v57, v203, -v205
v_mfma_f32_16x16x32_bf16 v[156:159], a[164:167], a[40:43], v[156:159]
v_fma_f32 v58, v58, v203, -v205
v_fma_f32 v59, v59, v203, -v205
v_mfma_f32_16x16x32_bf16 v[160:163], a[164:167], a[44:47], v[160:163]
s_waitcnt lgkmcnt(5)
v_fma_f32 v64, v64, v203, -v205
v_fma_f32 v65, v65, v203, -v205
v_mfma_f32_16x16x32_bf16 v[148:151], a[168:171], a[48:51], v[148:151]
ds_read_b128 a[160:163], v211 offset:9216
ds_read_b128 a[164:167], v211 offset:27648
v_mfma_f32_16x16x32_bf16 v[152:155], a[168:171], a[52:55], v[152:155]
v_fma_f32 v66, v66, v203, -v205
v_fma_f32 v67, v67, v203, -v205
v_mfma_f32_16x16x32_bf16 v[156:159], a[172:175], a[48:51], v[156:159]
v_cvt_pk_bf16_f32 v228, v56, v57
v_cvt_pk_bf16_f32 v229, v58, v59
v_mfma_f32_16x16x32_bf16 v[160:163], a[172:175], a[52:55], v[160:163]
s_waitcnt lgkmcnt(5)
v_cvt_pk_bf16_f32 v230, v64, v65
v_cvt_pk_bf16_f32 v231, v66, v67
v_mfma_f32_16x16x32_bf16 v[148:151], a[144:147], a[56:59], v[148:151]
ds_read_b128 a[168:171], v211 offset:10240
ds_read_b128 a[172:175], v211 offset:28672
v_mfma_f32_16x16x32_bf16 v[152:155], a[144:147], a[60:63], v[152:155]
ds_write_b128 v236, v[228:231] offset:4672
v_mfma_f32_16x16x32_bf16 v[156:159], a[148:151], a[56:59], v[156:159]
ds_read_b64_tr_b16 v[52:53], v237 offset:64
ds_read_b64_tr_b16 v[54:55], v237 offset:1216
v_mfma_f32_16x16x32_bf16 v[160:163], a[148:151], a[60:63], v[160:163]
s_waitcnt lgkmcnt(7)
v_mfma_f32_16x16x32_bf16 v[148:151], a[152:155], a[64:67], v[148:151]
ds_read_b128 a[144:147], v211 offset:11264
ds_read_b128 a[148:151], v211 offset:29696
ds_read_b64_tr_b16 v[56:57], v237 offset:72
ds_read_b64_tr_b16 v[58:59], v237 offset:1224
buffer_store_dwordx4 v[40:43], v1, s[8:11], s66 offen offset:1024 sc1
v_mfma_f32_16x16x32_bf16 v[152:155], a[152:155], a[68:71], v[152:155]
v_fma_f32 v68, v68, v202, -v204
v_fma_f32 v69, v69, v202, -v204
v_mfma_f32_16x16x32_bf16 v[156:159], a[156:159], a[64:67], v[156:159]
v_fma_f32 v70, v70, v202, -v204
v_mfma_f32_16x16x32_bf16 v[160:163], a[156:159], a[68:71], v[160:163]
s_waitcnt lgkmcnt(9)
v_fma_f32 v71, v71, v202, -v204
v_mfma_f32_16x16x32_bf16 v[148:151], a[160:163], a[72:75], v[148:151]
ds_read_b128 a[152:155], v211 offset:12288
ds_read_b128 a[156:159], v211 offset:30720
v_mfma_f32_16x16x32_bf16 v[152:155], a[160:163], a[76:79], v[152:155]
v_fma_f32 v76, v76, v202, -v204
v_fma_f32 v77, v77, v202, -v204
v_mfma_f32_16x16x32_bf16 v[156:159], a[164:167], a[72:75], v[156:159]
v_fma_f32 v78, v78, v202, -v204
v_mfma_f32_16x16x32_bf16 v[160:163], a[164:167], a[76:79], v[160:163]
s_waitcnt lgkmcnt(9)
v_fma_f32 v79, v79, v202, -v204
v_cvt_pk_bf16_f32 v216, v68, v69
v_mfma_f32_16x16x32_bf16 v[148:151], a[168:171], a[80:83], v[148:151]
ds_read_b128 a[160:163], v211 offset:13312
ds_read_b128 a[164:167], v211 offset:31744
v_mfma_f32_16x16x32_bf16 v[152:155], a[168:171], a[84:87], v[152:155]
v_cvt_pk_bf16_f32 v217, v70, v71
v_cvt_pk_bf16_f32 v218, v76, v77
v_mfma_f32_16x16x32_bf16 v[156:159], a[172:175], a[80:83], v[156:159]
v_cvt_pk_bf16_f32 v219, v78, v79
v_mfma_f32_16x16x32_bf16 v[160:163], a[172:175], a[84:87], v[160:163]
s_waitcnt lgkmcnt(6)
v_mfma_f32_16x16x32_bf16 v[148:151], a[144:147], a[88:91], v[148:151]
ds_read_b128 a[168:171], v211 offset:14336
ds_read_b128 a[172:175], v211 offset:32768
v_mfma_f32_16x16x32_bf16 v[152:155], a[144:147], a[92:95], v[152:155]
ds_write_b128 v236, v[216:219] offset:128
buffer_store_dwordx4 v[52:55], v1, s[8:11], s66 offen offset:2048 sc1
v_mfma_f32_16x16x32_bf16 v[156:159], a[148:151], a[88:91], v[156:159]
v_fma_f32 v72, v72, v203, -v205
v_fma_f32 v73, v73, v203, -v205
v_mfma_f32_16x16x32_bf16 v[160:163], a[148:151], a[92:95], v[160:163]
s_waitcnt lgkmcnt(5)
v_fma_f32 v74, v74, v203, -v205
v_mfma_f32_16x16x32_bf16 v[148:151], a[152:155], a[96:99], v[148:151]
ds_read_b128 a[144:147], v211 offset:15360
ds_read_b128 a[148:151], v211 offset:33792
v_mfma_f32_16x16x32_bf16 v[152:155], a[152:155], a[100:103], v[152:155]
v_fma_f32 v75, v75, v203, -v205
v_fma_f32 v80, v80, v203, -v205
v_mfma_f32_16x16x32_bf16 v[156:159], a[156:159], a[96:99], v[156:159]
v_fma_f32 v81, v81, v203, -v205
v_fma_f32 v82, v82, v203, -v205
v_mfma_f32_16x16x32_bf16 v[160:163], a[156:159], a[100:103], v[160:163]
s_waitcnt lgkmcnt(5)
v_fma_f32 v83, v83, v203, -v205
v_cvt_pk_bf16_f32 v220, v72, v73
v_mfma_f32_16x16x32_bf16 v[148:151], a[160:163], a[104:107], v[148:151]
ds_read_b128 a[152:155], v211 offset:16384
ds_read_b128 a[156:159], v211 offset:34816
v_mfma_f32_16x16x32_bf16 v[152:155], a[160:163], a[108:111], v[152:155]
v_cvt_pk_bf16_f32 v221, v74, v75
v_cvt_pk_bf16_f32 v222, v80, v81
v_mfma_f32_16x16x32_bf16 v[156:159], a[164:167], a[104:107], v[156:159]
v_cvt_pk_bf16_f32 v223, v82, v83
v_mfma_f32_16x16x32_bf16 v[160:163], a[164:167], a[108:111], v[160:163]
s_waitcnt lgkmcnt(5)
v_mfma_f32_16x16x32_bf16 v[148:151], a[168:171], a[112:115], v[148:151]
ds_read_b128 a[160:163], v211 offset:17408
ds_read_b128 a[164:167], v211 offset:35840
v_mfma_f32_16x16x32_bf16 v[152:155], a[168:171], a[116:119], v[152:155]
ds_write_b128 v236, v[220:223] offset:4736
v_mfma_f32_16x16x32_bf16 v[156:159], a[172:175], a[112:115], v[156:159]
ds_read_b64_tr_b16 v[68:69], v237 offset:128
ds_read_b64_tr_b16 v[70:71], v237 offset:1280
ds_read_b64_tr_b16 v[72:73], v237 offset:136
ds_read_b64_tr_b16 v[74:75], v237 offset:1288
buffer_store_dwordx4 v[56:59], v1, s[8:11], s66 offen offset:3072 sc1
v_mfma_f32_16x16x32_bf16 v[160:163], a[172:175], a[116:119], v[160:163]
s_waitcnt lgkmcnt(9)
v_fma_f32 v84, v84, v202, -v204
v_add_u32 v181, 112640, v239
v_mfma_f32_16x16x32_bf16 v[148:151], a[144:147], a[120:123], v[148:151]
ds_read_b64 a[168:169], v181 offset:0
ds_read_b64 a[172:173], v181 offset:512
v_mfma_f32_16x16x32_bf16 v[152:155], a[144:147], a[124:127], v[152:155]
v_fma_f32 v85, v85, v202, -v204
v_fma_f32 v86, v86, v202, -v204
v_mfma_f32_16x16x32_bf16 v[156:159], a[148:151], a[120:123], v[156:159]
v_fma_f32 v87, v87, v202, -v204
v_fma_f32 v92, v92, v202, -v204
v_mfma_f32_16x16x32_bf16 v[160:163], a[148:151], a[124:127], v[160:163]
s_waitcnt lgkmcnt(9)
v_fma_f32 v93, v93, v202, -v204
v_fma_f32 v94, v94, v202, -v204
v_mfma_f32_16x16x32_bf16 v[148:151], a[152:155], a[128:131], v[148:151]
ds_read_b128 a[144:147], v208 offset:0
ds_read_b128 a[148:151], v208 offset:18432
v_mfma_f32_16x16x32_bf16 v[152:155], a[152:155], a[132:135], v[152:155]
v_fma_f32 v95, v95, v202, -v204
v_cvt_pk_bf16_f32 v224, v84, v85
v_mfma_f32_16x16x32_bf16 v[156:159], a[156:159], a[128:131], v[156:159]
v_cvt_pk_bf16_f32 v225, v86, v87
v_mfma_f32_16x16x32_bf16 v[160:163], a[156:159], a[132:135], v[160:163]
s_waitcnt lgkmcnt(9)
v_cvt_pk_bf16_f32 v226, v92, v93
v_cvt_pk_bf16_f32 v227, v94, v95
v_mfma_f32_16x16x32_bf16 v[148:151], a[160:163], a[136:139], v[148:151]
ds_read_b128 a[152:155], v208 offset:1024
ds_read_b128 a[156:159], v208 offset:19456
v_mfma_f32_16x16x32_bf16 v[152:155], a[160:163], a[140:143], v[152:155]
ds_write_b128 v236, v[224:227] offset:192
v_mfma_f32_16x16x32_bf16 v[156:159], a[164:167], a[136:139], v[156:159]
s_add_u32 s66, s66, 4096
s_waitcnt lgkmcnt(9)
v_mfma_f32_16x16x32_bf16 v[160:163], a[164:167], a[140:143], v[160:163]
s_waitcnt lgkmcnt(5)
buffer_store_dwordx4 v[68:71], v1, s[8:11], s66 offen offset:0 sc1
v_mfma_f32_16x16x16_bf16 v[148:151], a[168:169], v[212:213], v[148:151]
ds_read_b128 a[160:163], v208 offset:2048
ds_read_b128 a[164:167], v208 offset:20480
v_mfma_f32_16x16x16_bf16 v[152:155], a[168:169], v[214:215], v[152:155]
v_fma_f32 v88, v88, v203, -v205
v_fma_f32 v89, v89, v203, -v205
v_mfma_f32_16x16x16_bf16 v[156:159], a[172:173], v[212:213], v[156:159]
v_fma_f32 v90, v90, v203, -v205
v_fma_f32 v91, v91, v203, -v205
v_mfma_f32_16x16x16_bf16 v[160:163], a[172:173], v[214:215], v[160:163]
s_waitcnt lgkmcnt(5)
v_fma_f32 v96, v96, v203, -v205
v_fma_f32 v97, v97, v203, -v205
v_mfma_f32_16x16x32_bf16 v[164:167], a[144:147], a[0:3], 0
ds_read_b128 a[168:171], v208 offset:3072
ds_read_b128 a[172:175], v208 offset:21504
v_mfma_f32_16x16x32_bf16 v[168:171], a[144:147], a[4:7], 0
v_fma_f32 v98, v98, v203, -v205
v_fma_f32 v99, v99, v203, -v205
v_mfma_f32_16x16x32_bf16 v[172:175], a[148:151], a[0:3], 0
v_cvt_pk_bf16_f32 v228, v88, v89
v_cvt_pk_bf16_f32 v229, v90, v91
v_mfma_f32_16x16x32_bf16 v[176:179], a[148:151], a[4:7], 0
s_waitcnt lgkmcnt(5)
v_cvt_pk_bf16_f32 v230, v96, v97
v_cvt_pk_bf16_f32 v231, v98, v99
v_mfma_f32_16x16x32_bf16 v[164:167], a[152:155], a[8:11], v[164:167]
ds_read_b128 a[144:147], v208 offset:4096
ds_read_b128 a[148:151], v208 offset:22528
v_mfma_f32_16x16x32_bf16 v[168:171], a[152:155], a[12:15], v[168:171]
ds_write_b128 v236, v[228:231] offset:4800
v_mfma_f32_16x16x32_bf16 v[172:175], a[156:159], a[8:11], v[172:175]
ds_read_b64_tr_b16 v[84:85], v237 offset:192
ds_read_b64_tr_b16 v[86:87], v237 offset:1344
v_mfma_f32_16x16x32_bf16 v[176:179], a[156:159], a[12:15], v[176:179]
s_waitcnt lgkmcnt(7)
v_mfma_f32_16x16x32_bf16 v[164:167], a[160:163], a[16:19], v[164:167]
ds_read_b128 a[152:155], v208 offset:5120
ds_read_b128 a[156:159], v208 offset:23552
ds_read_b64_tr_b16 v[88:89], v237 offset:200
ds_read_b64_tr_b16 v[90:91], v237 offset:1352
buffer_store_dwordx4 v[72:75], v1, s[8:11], s66 offen offset:1024 sc1
v_mfma_f32_16x16x32_bf16 v[168:171], a[160:163], a[20:23], v[168:171]
v_fma_f32 v100, v100, v202, -v204
v_fma_f32 v101, v101, v202, -v204
v_mfma_f32_16x16x32_bf16 v[172:175], a[164:167], a[16:19], v[172:175]
v_fma_f32 v102, v102, v202, -v204
v_mfma_f32_16x16x32_bf16 v[176:179], a[164:167], a[20:23], v[176:179]
s_waitcnt lgkmcnt(9)
v_fma_f32 v103, v103, v202, -v204
v_fma_f32 v104, v104, v203, -v205
v_mfma_f32_16x16x32_bf16 v[164:167], a[168:171], a[24:27], v[164:167]
ds_read_b128 a[160:163], v208 offset:6144
ds_read_b128 a[164:167], v208 offset:24576
v_mfma_f32_16x16x32_bf16 v[168:171], a[168:171], a[28:31], v[168:171]
v_fma_f32 v105, v105, v203, -v205
v_fma_f32 v106, v106, v203, -v205
v_mfma_f32_16x16x32_bf16 v[172:175], a[172:175], a[24:27], v[172:175]
v_fma_f32 v107, v107, v203, -v205
v_cvt_pk_bf16_f32 v216, v100, v101
v_mfma_f32_16x16x32_bf16 v[176:179], a[172:175], a[28:31], v[176:179]
s_waitcnt lgkmcnt(9)
v_cvt_pk_bf16_f32 v217, v102, v103
v_mfma_f32_16x16x32_bf16 v[164:167], a[144:147], a[32:35], v[164:167]
ds_read_b128 a[168:171], v208 offset:7168
ds_read_b128 a[172:175], v208 offset:25600
v_mfma_f32_16x16x32_bf16 v[168:171], a[144:147], a[36:39], v[168:171]
v_cvt_pk_bf16_f32 v218, v104, v105
v_cvt_pk_bf16_f32 v219, v106, v107
v_mfma_f32_16x16x32_bf16 v[172:175], a[148:151], a[32:35], v[172:175]
ds_write_b64 v7, v[216:217] offset:256
v_mfma_f32_16x16x32_bf16 v[176:179], a[148:151], a[36:39], v[176:179]
s_waitcnt lgkmcnt(7)
v_mfma_f32_16x16x32_bf16 v[164:167], a[152:155], a[40:43], v[164:167]
ds_read_b128 a[144:147], v208 offset:8192
ds_read_b128 a[148:151], v208 offset:26624
v_mfma_f32_16x16x32_bf16 v[168:171], a[152:155], a[44:47], v[168:171]
ds_write_b64 v7, v[218:219] offset:4864
ds_read_b64_tr_b16 v[100:101], v238 offset:256
ds_read_b64_tr_b16 v[102:103], v238 offset:1408
buffer_store_dwordx4 v[84:87], v1, s[8:11], s66 offen offset:2048 sc1
v_mfma_f32_16x16x32_bf16 v[172:175], a[156:159], a[40:43], v[172:175]
v_mfma_f32_16x16x32_bf16 v[176:179], a[156:159], a[44:47], v[176:179]
s_waitcnt lgkmcnt(8)
v_mfma_f32_16x16x32_bf16 v[164:167], a[160:163], a[48:51], v[164:167]
ds_read_b128 a[152:155], v208 offset:9216
ds_read_b128 a[156:159], v208 offset:27648
v_mfma_f32_16x16x32_bf16 v[168:171], a[160:163], a[52:55], v[168:171]
v_mfma_f32_16x16x32_bf16 v[172:175], a[164:167], a[48:51], v[172:175]
v_mfma_f32_16x16x32_bf16 v[176:179], a[164:167], a[52:55], v[176:179]
s_waitcnt lgkmcnt(8)
v_mfma_f32_16x16x32_bf16 v[164:167], a[168:171], a[56:59], v[164:167]
ds_read_b128 a[160:163], v208 offset:10240
ds_read_b128 a[164:167], v208 offset:28672
v_mfma_f32_16x16x32_bf16 v[168:171], a[168:171], a[60:63], v[168:171]
v_mfma_f32_16x16x32_bf16 v[172:175], a[172:175], a[56:59], v[172:175]
v_mfma_f32_16x16x32_bf16 v[176:179], a[172:175], a[60:63], v[176:179]
s_waitcnt lgkmcnt(7)
v_mfma_f32_16x16x32_bf16 v[164:167], a[144:147], a[64:67], v[164:167]
ds_read_b128 a[168:171], v208 offset:11264
ds_read_b128 a[172:175], v208 offset:29696
v_mfma_f32_16x16x32_bf16 v[168:171], a[144:147], a[68:71], v[168:171]
v_mfma_f32_16x16x32_bf16 v[172:175], a[148:151], a[64:67], v[172:175]
buffer_store_dwordx4 v[88:91], v1, s[8:11], s66 offen offset:3072 sc1
v_mfma_f32_16x16x32_bf16 v[176:179], a[148:151], a[68:71], v[176:179]
s_waitcnt lgkmcnt(4)
v_mfma_f32_16x16x32_bf16 v[164:167], a[152:155], a[72:75], v[164:167]
ds_read_b128 a[144:147], v208 offset:12288
ds_read_b128 a[148:151], v208 offset:30720
v_mfma_f32_16x16x32_bf16 v[168:171], a[152:155], a[76:79], v[168:171]
s_cmp_eq_u32 s25, 1
s_cselect_b32 s98, 4096, 0
v_mfma_f32_16x16x32_bf16 v[172:175], a[156:159], a[72:75], v[172:175]
s_add_u32 s52, s52, s98
v_mfma_f32_16x16x32_bf16 v[176:179], a[156:159], a[76:79], v[176:179]
s_waitcnt lgkmcnt(4)
v_mfma_f32_16x16x32_bf16 v[164:167], a[160:163], a[80:83], v[164:167]
ds_read_b128 a[152:155], v208 offset:13312
ds_read_b128 a[156:159], v208 offset:31744
v_mfma_f32_16x16x32_bf16 v[168:171], a[160:163], a[84:87], v[168:171]
s_add_u32 s52, s52, 4096
v_mfma_f32_16x16x32_bf16 v[172:175], a[164:167], a[80:83], v[172:175]
v_mfma_f32_16x16x32_bf16 v[176:179], a[164:167], a[84:87], v[176:179]
s_waitcnt lgkmcnt(4)
v_mfma_f32_16x16x32_bf16 v[164:167], a[168:171], a[88:91], v[164:167]
ds_read_b128 a[160:163], v208 offset:14336
ds_read_b128 a[164:167], v208 offset:32768
v_mfma_f32_16x16x32_bf16 v[168:171], a[168:171], a[92:95], v[168:171]
v_mfma_f32_16x16x32_bf16 v[172:175], a[172:175], a[88:91], v[172:175]
s_add_u32 s66, s66, 4096
v_mfma_f32_16x16x32_bf16 v[176:179], a[172:175], a[92:95], v[176:179]
s_waitcnt lgkmcnt(4)
buffer_store_dwordx4 v[100:103], v1, s[8:11], s66 offen offset:0 sc1
v_mfma_f32_16x16x32_bf16 v[164:167], a[144:147], a[96:99], v[164:167]
ds_read_b128 a[168:171], v208 offset:15360
ds_read_b128 a[172:175], v208 offset:33792
v_mfma_f32_16x16x32_bf16 v[168:171], a[144:147], a[100:103], v[168:171]
v_mfma_f32_16x16x32_bf16 v[172:175], a[148:151], a[96:99], v[172:175]
v_mfma_f32_16x16x32_bf16 v[176:179], a[148:151], a[100:103], v[176:179]
s_waitcnt lgkmcnt(4)
v_mfma_f32_16x16x32_bf16 v[164:167], a[152:155], a[104:107], v[164:167]
ds_read_b128 a[144:147], v208 offset:16384
ds_read_b128 a[148:151], v208 offset:34816
v_mfma_f32_16x16x32_bf16 v[168:171], a[152:155], a[108:111], v[168:171]
v_mfma_f32_16x16x32_bf16 v[172:175], a[156:159], a[104:107], v[172:175]
v_mfma_f32_16x16x32_bf16 v[176:179], a[156:159], a[108:111], v[176:179]
s_waitcnt lgkmcnt(4)
v_mfma_f32_16x16x32_bf16 v[164:167], a[160:163], a[112:115], v[164:167]
ds_read_b128 a[152:155], v208 offset:17408
ds_read_b128 a[156:159], v208 offset:35840
v_mfma_f32_16x16x32_bf16 v[168:171], a[160:163], a[116:119], v[168:171]
buffer_load_dwordx4 a[240:243], v1, s[4:7], s52 offen offset:0 sc1
buffer_load_dwordx4 a[244:247], v9, s[4:7], s52 offen offset:0 sc1
v_mfma_f32_16x16x32_bf16 v[172:175], a[164:167], a[112:115], v[172:175]
v_mfma_f32_16x16x32_bf16 v[176:179], a[164:167], a[116:119], v[176:179]
s_waitcnt lgkmcnt(4)
v_add_u32 v181, 160768, v239
v_mfma_f32_16x16x32_bf16 v[164:167], a[168:171], a[120:123], v[164:167]
ds_read_b64 a[160:161], v181 offset:0
ds_read_b64 a[164:165], v181 offset:512
v_mfma_f32_16x16x32_bf16 v[168:171], a[168:171], a[124:127], v[168:171]
v_mfma_f32_16x16x32_bf16 v[172:175], a[172:175], a[120:123], v[172:175]
v_mfma_f32_16x16x32_bf16 v[176:179], a[172:175], a[124:127], v[176:179]
s_waitcnt lgkmcnt(4)
v_mfma_f32_16x16x32_bf16 v[164:167], a[144:147], a[128:131], v[164:167]
v_mfma_f32_16x16x32_bf16 v[168:171], a[144:147], a[132:135], v[168:171]
v_mfma_f32_16x16x32_bf16 v[172:175], a[148:151], a[128:131], v[172:175]
buffer_load_dwordx4 a[248:251], v1, s[4:7], s52 offen offset:1024 sc1
buffer_load_dwordx4 a[252:255], v9, s[4:7], s52 offen offset:1024 sc1
v_mfma_f32_16x16x32_bf16 v[176:179], a[148:151], a[132:135], v[176:179]
s_waitcnt lgkmcnt(2)
v_mfma_f32_16x16x32_bf16 v[164:167], a[152:155], a[136:139], v[164:167]
v_mfma_f32_16x16x32_bf16 v[168:171], a[152:155], a[140:143], v[168:171]
v_mfma_f32_16x16x32_bf16 v[172:175], a[156:159], a[136:139], v[172:175]
v_mfma_f32_16x16x32_bf16 v[176:179], a[156:159], a[140:143], v[176:179]
s_waitcnt lgkmcnt(0)
v_mfma_f32_16x16x16_bf16 v[164:167], a[160:161], v[212:213], v[164:167]
v_mfma_f32_16x16x16_bf16 v[168:171], a[160:161], v[214:215], v[168:171]
v_mfma_f32_16x16x16_bf16 v[172:175], a[164:165], v[212:213], v[172:175]
v_mfma_f32_16x16x16_bf16 v[176:179], a[164:165], v[214:215], v[176:179]
L_c4:
v_add_u32 v180, 0, v1
v_lshlrev_b32 v184, 16, v0
v_lshlrev_b32 v185, 16, v0
v_lshlrev_b32 v186, 16, v0
v_lshlrev_b32 v187, 16, v0
v_lshlrev_b32 v188, 16, v249
v_lshlrev_b32 v189, 16, v249
v_lshlrev_b32 v190, 16, v249
v_lshlrev_b32 v191, 16, v249
s_waitcnt lgkmcnt(0)
ds_write_b128 v240, v[36:39] offset:0
ds_write_b128 v240, v[40:43] offset:1024
ds_write_b128 v240, v[52:55] offset:2048
ds_write_b128 v240, v[56:59] offset:3072
s_cmp_eq_u32 s24, 0
s_cselect_b32 s67, 0, 1073741824
s_add_u32 s67, s67, 26542080
s_waitcnt vmcnt(4)
s_barrier
s_mov_b64 exec, 0xffff
buffer_atomic_add v4, v233, s[8:11], s67 offen sc1
s_mov_b64 exec, -1
v_add_u32 v200, 53248, v1
v_add_u32 v201, 90112, v1
v_add_u32 v202, 126976, v1
s_lshl_b32 s35, s80, 7
s_add_u32 s35, s35, 26542080
s_cmp_eq_u32 s24, 1
s_cselect_b32 s35, s35, 1073741824
v_mov_b32 v6, 0
v_mov_b32 v244, 0
v_mov_b32 v245, 0
v_mov_b32 v246, 0
buffer_load_dwordx4 a[80:83], v1, s[4:7], s52 offen offset:2048 sc1
buffer_load_dwordx4 a[84:87], v9, s[4:7], s52 offen offset:2048 sc1
ds_write_b128 v240, v[68:71] offset:4096
ds_write_b128 v240, v[72:75] offset:5120
ds_write_b128 v240, v[84:87] offset:6144
ds_write_b128 v240, v[88:91] offset:7168
ds_write_b128 v240, v[100:103] offset:8192
v_pk_mul_f32 v[192:193], v[108:109], v[108:109]
v_pk_mul_f32 v[194:195], v[110:111], v[110:111]
v_pk_mul_f32 v[196:197], v[112:113], v[112:113]
v_pk_mul_f32 v[198:199], v[114:115], v[114:115]
v_pk_fma_f32 v[192:193], v[192:193], v[252:253], v[250:251] op_sel:[0,0,0] op_sel_hi:[1,0,0]
v_pk_fma_f32 v[194:195], v[194:195], v[252:253], v[250:251] op_sel:[0,0,0] op_sel_hi:[1,0,0]
v_pk_fma_f32 v[196:197], v[196:197], v[252:253], v[250:251] op_sel:[0,1,1] op_sel_hi:[1,1,1]
v_pk_fma_f32 v[198:199], v[198:199], v[252:253], v[250:251] op_sel:[0,1,1] op_sel_hi:[1,1,1]
v_pk_mul_f32 v[192:193], v[192:193], v[108:109]
buffer_load_dwordx4 a[88:91], v1, s[4:7], s52 offen offset:3072 sc1
buffer_load_dwordx4 a[92:95], v9, s[4:7], s52 offen offset:3072 sc1
v_pk_mul_f32 v[194:195], v[194:195], v[110:111]
v_pk_mul_f32 v[196:197], v[196:197], v[112:113]
v_pk_mul_f32 v[198:199], v[198:199], v[114:115]
v_exp_f32 v192, v192
v_exp_f32 v193, v193
v_exp_f32 v194, v194
v_exp_f32 v195, v195
v_exp_f32 v196, v196
v_exp_f32 v197, v197
v_exp_f32 v198, v198
v_exp_f32 v199, v199
v_pk_fma_f32 v[192:193], v[192:193], v[254:255], v[254:255] op_sel:[0,0,0] op_sel_hi:[1,0,0]
v_pk_fma_f32 v[194:195], v[194:195], v[254:255], v[254:255] op_sel:[0,0,0] op_sel_hi:[1,0,0]
v_pk_fma_f32 v[196:197], v[196:197], v[254:255], v[254:255] op_sel:[0,1,1] op_sel_hi:[1,1,1]
s_cmp_eq_u32 s25, 2
s_cselect_b32 s98, 4096, 0
s_add_u32 s52, s52, s98
s_add_u32 s52, s52, 4096
buffer_load_dwordx4 a[96:99], v1, s[4:7], s52 offen offset:0 sc1
s_mov_b64 exec, 1
buffer_atomic_add v244, v6, s[8:11], s35 offen sc0 sc1
s_mov_b64 exec, -1
buffer_load_dwordx4 a[100:103], v9, s[4:7], s52 offen offset:0 sc1
v_pk_fma_f32 v[198:199], v[198:199], v[254:255], v[254:255] op_sel:[0,1,1] op_sel_hi:[1,1,1]
v_rcp_f32 v192, v192
v_rcp_f32 v193, v193
v_rcp_f32 v194, v194
v_rcp_f32 v195, v195
v_rcp_f32 v196, v196
v_rcp_f32 v197, v197
v_rcp_f32 v198, v198
v_rcp_f32 v199, v199
v_pk_mul_f32 v[108:109], v[108:109], v[192:193]
v_pk_mul_f32 v[110:111], v[110:111], v[194:195]
v_pk_mul_f32 v[112:113], v[112:113], v[196:197]
v_pk_mul_f32 v[114:115], v[114:115], v[198:199]
v_pk_mul_f32 v[192:193], v[116:117], v[116:117]
buffer_load_dwordx4 a[104:107], v1, s[4:7], s52 offen offset:1024 sc1
buffer_load_dwordx4 a[108:111], v9, s[4:7], s52 offen offset:1024 sc1
v_pk_mul_f32 v[194:195], v[118:119], v[118:119]
v_pk_mul_f32 v[196:197], v[120:121], v[120:121]
v_pk_mul_f32 v[198:199], v[122:123], v[122:123]
v_pk_fma_f32 v[192:193], v[192:193], v[252:253], v[250:251] op_sel:[0,0,0] op_sel_hi:[1,0,0]
v_pk_fma_f32 v[194:195], v[194:195], v[252:253], v[250:251] op_sel:[0,0,0] op_sel_hi:[1,0,0]
v_pk_fma_f32 v[196:197], v[196:197], v[252:253], v[250:251] op_sel:[0,1,1] op_sel_hi:[1,1,1]
v_pk_fma_f32 v[198:199], v[198:199], v[252:253], v[250:251] op_sel:[0,1,1] op_sel_hi:[1,1,1]
v_pk_mul_f32 v[192:193], v[192:193], v[116:117]
v_pk_mul_f32 v[194:195], v[194:195], v[118:119]
v_pk_mul_f32 v[196:197], v[196:197], v[120:121]
v_pk_mul_f32 v[198:199], v[198:199], v[122:123]
v_exp_f32 v192, v192
v_exp_f32 v193, v193
v_exp_f32 v194, v194
buffer_load_dwordx4 a[112:115], v1, s[4:7], s52 offen offset:2048 sc1
s_mov_b64 exec, 1
buffer_atomic_add v245, v6, s[8:11], s35 offen sc0 sc1
s_mov_b64 exec, -1
buffer_load_dwordx4 a[116:119], v9, s[4:7], s52 offen offset:2048 sc1
v_exp_f32 v195, v195
v_exp_f32 v196, v196
v_exp_f32 v197, v197
v_exp_f32 v198, v198
v_exp_f32 v199, v199
v_pk_fma_f32 v[192:193], v[192:193], v[254:255], v[254:255] op_sel:[0,0,0] op_sel_hi:[1,0,0]
v_pk_fma_f32 v[194:195], v[194:195], v[254:255], v[254:255] op_sel:[0,0,0] op_sel_hi:[1,0,0]
v_pk_fma_f32 v[196:197], v[196:197], v[254:255], v[254:255] op_sel:[0,1,1] op_sel_hi:[1,1,1]
v_pk_fma_f32 v[198:199], v[198:199], v[254:255], v[254:255] op_sel:[0,1,1] op_sel_hi:[1,1,1]
v_rcp_f32 v192, v192
v_rcp_f32 v193, v193
v_rcp_f32 v194, v194
v_rcp_f32 v195, v195
v_rcp_f32 v196, v196
buffer_load_dwordx4 a[120:123], v1, s[4:7], s52 offen offset:3072 sc1
buffer_load_dwordx4 a[124:127], v9, s[4:7], s52 offen offset:3072 sc1
v_rcp_f32 v197, v197
v_rcp_f32 v198, v198
v_rcp_f32 v199, v199
v_pk_mul_f32 v[116:117], v[116:117], v[192:193]
v_pk_mul_f32 v[118:119], v[118:119], v[194:195]
v_pk_mul_f32 v[120:121], v[120:121], v[196:197]
v_pk_mul_f32 v[122:123], v[122:123], v[198:199]
v_pk_mul_f32 v[192:193], v[124:125], v[124:125]
v_pk_mul_f32 v[194:195], v[126:127], v[126:127]
v_pk_mul_f32 v[196:197], v[128:129], v[128:129]
v_pk_mul_f32 v[198:199], v[130:131], v[130:131]
v_pk_fma_f32 v[192:193], v[192:193], v[252:253], v[250:251] op_sel:[0,0,0] op_sel_hi:[1,0,0]
v_pk_fma_f32 v[194:195], v[194:195], v[252:253], v[250:251] op_sel:[0,0,0] op_sel_hi:[1,0,0]
v_pk_fma_f32 v[196:197], v[196:197], v[252:253], v[250:251] op_sel:[0,1,1] op_sel_hi:[1,1,1]
s_cmp_eq_u32 s25, 3
s_cselect_b32 s98, 4096, 0
s_add_u32 s52, s52, s98
s_add_u32 s52, s52, 4096
buffer_load_dwordx4 a[128:131], v1, s[4:7], s52 offen offset:0 sc1
s_mov_b64 exec, 1
buffer_atomic_add v246, v6, s[8:11], s35 offen sc0 sc1
s_mov_b64 exec, -1
buffer_load_dwordx4 a[132:135], v9, s[4:7], s52 offen offset:0 sc1
v_pk_fma_f32 v[198:199], v[198:199], v[252:253], v[250:251] op_sel:[0,1,1] op_sel_hi:[1,1,1]
v_pk_mul_f32 v[192:193], v[192:193], v[124:125]
v_pk_mul_f32 v[194:195], v[194:195], v[126:127]
v_pk_mul_f32 v[196:197], v[196:197], v[128:129]
v_pk_mul_f32 v[198:199], v[198:199], v[130:131]
v_exp_f32 v192, v192
v_exp_f32 v193, v193
v_exp_f32 v194, v194
v_exp_f32 v195, v195
v_exp_f32 v196, v196
v_exp_f32 v197, v197
v_exp_f32 v198, v198
v_exp_f32 v199, v199
v_pk_fma_f32 v[192:193], v[192:193], v[254:255], v[254:255] op_sel:[0,0,0] op_sel_hi:[1,0,0]
buffer_load_dwordx4 a[136:139], v1, s[4:7], s52 offen offset:1024 sc1
buffer_load_dwordx4 a[140:143], v9, s[4:7], s52 offen offset:1024 sc1
v_pk_fma_f32 v[194:195], v[194:195], v[254:255], v[254:255] op_sel:[0,0,0] op_sel_hi:[1,0,0]
v_pk_fma_f32 v[196:197], v[196:197], v[254:255], v[254:255] op_sel:[0,1,1] op_sel_hi:[1,1,1]
v_pk_fma_f32 v[198:199], v[198:199], v[254:255], v[254:255] op_sel:[0,1,1] op_sel_hi:[1,1,1]
v_rcp_f32 v192, v192
v_rcp_f32 v193, v193
v_rcp_f32 v194, v194
v_rcp_f32 v195, v195
v_rcp_f32 v196, v196
v_rcp_f32 v197, v197
v_rcp_f32 v198, v198
v_rcp_f32 v199, v199
v_pk_mul_f32 v[124:125], v[124:125], v[192:193]
v_pk_mul_f32 v[126:127], v[126:127], v[194:195]
v_pk_mul_f32 v[128:129], v[128:129], v[196:197]
v_pk_mul_f32 v[130:131], v[130:131], v[198:199]
s_mul_i32 s30, s26, 589824
s_add_u32 s30, s30, 7340032
s_lshl_b32 s62, s24, 12
s_lshl_b32 s63, s24, 10
s_add_u32 s60, s30, s62
s_add_u32 s61, s30, s63
s_add_u32 s61, s61, 16384
s_cmp_eq_u32 s25, 0
s_cselect_b32 s99, 36864, 0
s_add_u32 s60, s60, s99
s_add_u32 s61, s61, s99
s_add_u32 m0, s62, 53248
s_add_u32 s60, s60, 0
s_waitcnt lgkmcnt(0)
s_cmp_eq_u32 s24, 1
s_cbranch_scc0 L_other_28
s_mov_b32 s31, 0
s_mov_b64 exec, 1
v_mov_b32 v247, 0
buffer_atomic_add v247, v6, s[8:11], s35 offen sc0 sc1
s_waitcnt vmcnt(14)
v_cmp_gt_u32 vcc, 16, v244
s_nop 0
s_cbranch_vccz L_polled_27
s_waitcnt vmcnt(9)
v_cmp_gt_u32 vcc, 16, v245
s_nop 0
s_cbranch_vccz L_polled_27
v_mov_b32 v244, 0
buffer_atomic_add v244, v6, s[8:11], s35 offen sc0 sc1
s_waitcnt vmcnt(5)
v_cmp_gt_u32 vcc, 16, v246
s_nop 0
s_cbranch_vccz L_polled_27
v_mov_b32 v245, 0
buffer_atomic_add v245, v6, s[8:11], s35 offen sc0 sc1
L_poll_26:
s_add_u32 s31, s31, 1
s_cmp_gt_u32 s31, 100000
s_cbranch_scc1 L_polled_27
v_mov_b32 v246, 0
buffer_atomic_add v246, v6, s[8:11], s35 offen sc0 sc1
s_waitcnt vmcnt(3)
v_cmp_gt_u32 vcc, 16, v247
s_nop 0
s_cbranch_vccz L_polled_27
v_mov_b32 v247, 0
buffer_atomic_add v247, v6, s[8:11], s35 offen sc0 sc1
s_waitcnt vmcnt(3)
v_cmp_gt_u32 vcc, 16, v244
s_nop 0
s_cbranch_vccz L_polled_27
v_mov_b32 v244, 0
buffer_atomic_add v244, v6, s[8:11], s35 offen sc0 sc1
s_waitcnt vmcnt(3)
v_cmp_gt_u32 vcc, 16, v245
s_nop 0
s_cbranch_vccz L_polled_27
v_mov_b32 v245, 0
buffer_atomic_add v245, v6, s[8:11], s35 offen sc0 sc1
s_waitcnt vmcnt(3)
v_cmp_gt_u32 vcc, 16, v246
s_nop 0
s_cbranch_vccz L_polled_27
s_branch L_poll_26
L_polled_27:
s_mov_b64 exec, -1
L_other_28:
s_barrier
buffer_load_dwordx4 v1, s[8:11], s60 offen offset:0 sc1 lds
buffer_load_dwordx4 v1, s[8:11], s60 offen offset:1024 sc1 lds
ds_read_b128 a[0:3], v180 offset:0
ds_read_b128 a[4:7], v180 offset:1024
ds_read_b128 a[8:11], v180 offset:2048
ds_read_b128 a[12:15], v180 offset:3072
ds_read_b128 a[16:19], v180 offset:4096
ds_read_b128 a[20:23], v180 offset:5120
ds_read_b128 a[24:27], v180 offset:6144
ds_read_b128 a[28:31], v180 offset:7168
ds_read_b128 a[32:35], v180 offset:8192
buffer_load_dwordx4 v1, s[8:11], s60 offen offset:2048 sc1 lds
buffer_load_dwordx4 v1, s[8:11], s60 offen offset:3072 sc1 lds
s_add_u32 m0, s63, 69632
s_add_u32 s61, s61, 0
buffer_load_dwordx4 v1, s[8:11], s61 offen offset:0 sc1 lds
s_waitcnt lgkmcnt(0)
v_mfma_f32_16x16x32_bf16 v[36:39], a[0:3], a[176:179], v[184:187]
ds_read_b128 a[36:39], v180 offset:9216
s_add_u32 m0, s62, 73728
v_mfma_f32_16x16x32_bf16 v[40:43], a[0:3], a[180:183], v[188:191]
ds_read_b128 a[40:43], v180 offset:10240
v_mul_f32 v192, v132, v132
v_mfma_f32_16x16x32_bf16 v[44:47], a[4:7], a[176:179], v[184:187]
ds_read_b128 a[44:47], v180 offset:11264
s_add_u32 s60, s60, 20480
v_mfma_f32_16x16x32_bf16 v[48:51], a[4:7], a[180:183], v[188:191]
ds_read_b128 a[48:51], v180 offset:12288
v_mul_f32 v193, v133, v133
v_mfma_f32_16x16x32_bf16 v[52:55], a[8:11], a[176:179], v[184:187]
ds_read_b128 a[52:55], v180 offset:13312
v_mul_f32 v194, v134, v134
v_mfma_f32_16x16x32_bf16 v[56:59], a[8:11], a[180:183], v[188:191]
ds_read_b128 a[56:59], v180 offset:14336
buffer_load_dwordx4 v1, s[8:11], s60 offen offset:0 sc1 lds
v_mfma_f32_16x16x32_bf16 v[60:63], a[12:15], a[176:179], v[184:187]
ds_read_b128 a[60:63], v180 offset:15360
v_mfma_f32_16x16x32_bf16 v[64:67], a[12:15], a[180:183], v[188:191]
ds_read_b128 a[64:67], v180 offset:16384
v_mul_f32 v195, v135, v135
v_mfma_f32_16x16x32_bf16 v[68:71], a[16:19], a[176:179], v[184:187]
ds_read_b128 a[68:71], v180 offset:17408
buffer_load_dwordx4 v1, s[8:11], s60 offen offset:1024 sc1 lds
v_mfma_f32_16x16x32_bf16 v[72:75], a[16:19], a[180:183], v[188:191]
v_fma_f32 v192, v192, v252, v250
v_mfma_f32_16x16x32_bf16 v[76:79], a[20:23], a[176:179], v[184:187]
v_mfma_f32_16x16x32_bf16 v[80:83], a[20:23], a[180:183], v[188:191]
buffer_load_dwordx4 v1, s[8:11], s60 offen offset:2048 sc1 lds
v_fma_f32 v193, v193, v252, v250
v_mfma_f32_16x16x32_bf16 v[84:87], a[24:27], a[176:179], v[184:187]
v_mfma_f32_16x16x32_bf16 v[88:91], a[24:27], a[180:183], v[188:191]
v_mfma_f32_16x16x32_bf16 v[92:95], a[28:31], a[176:179], v[184:187]
buffer_load_dwordx4 v1, s[8:11], s60 offen offset:3072 sc1 lds
v_fma_f32 v194, v194, v252, v250
v_mfma_f32_16x16x32_bf16 v[96:99], a[28:31], a[180:183], v[188:191]
v_mfma_f32_16x16x32_bf16 v[100:103], a[32:35], a[176:179], v[184:187]
v_fma_f32 v195, v195, v252, v250
v_mfma_f32_16x16x32_bf16 v[104:107], a[32:35], a[180:183], v[188:191]
s_waitcnt lgkmcnt(0)
v_mfma_f32_16x16x32_bf16 v[36:39], a[36:39], a[184:187], v[36:39]
ds_read_b128 a[0:3], v180 offset:18432
v_mul_f32 v192, v192, v132
v_mfma_f32_16x16x32_bf16 v[40:43], a[36:39], a[188:191], v[40:43]
ds_read_b128 a[4:7], v180 offset:19456
v_mfma_f32_16x16x32_bf16 v[44:47], a[40:43], a[184:187], v[44:47]
ds_read_b128 a[8:11], v180 offset:20480
v_mfma_f32_16x16x32_bf16 v[48:51], a[40:43], a[188:191], v[48:51]
ds_read_b128 a[12:15], v180 offset:21504
v_mul_f32 v193, v193, v133
v_mfma_f32_16x16x32_bf16 v[52:55], a[44:47], a[184:187], v[52:55]
ds_read_b128 a[16:19], v180 offset:22528
v_mfma_f32_16x16x32_bf16 v[56:59], a[44:47], a[188:191], v[56:59]
ds_read_b128 a[20:23], v180 offset:23552
v_mul_f32 v194, v194, v134
v_mfma_f32_16x16x32_bf16 v[60:63], a[48:51], a[184:187], v[60:63]
ds_read_b128 a[24:27], v180 offset:24576
v_mfma_f32_16x16x32_bf16 v[64:67], a[48:51], a[188:191], v[64:67]
ds_read_b128 a[28:31], v180 offset:25600
v_mul_f32 v195, v195, v135
v_mfma_f32_16x16x32_bf16 v[68:71], a[52:55], a[184:187], v[68:71]
ds_read_b128 a[32:35], v180 offset:26624
v_mfma_f32_16x16x32_bf16 v[72:75], a[52:55], a[188:191], v[72:75]
s_cmp_eq_u32 s25, 1
s_cselect_b32 s99, 36864, 0
s_add_u32 s60, s60, s99
v_mfma_f32_16x16x32_bf16 v[76:79], a[56:59], a[184:187], v[76:79]
s_add_u32 s61, s61, s99
s_add_u32 m0, s62, 90112
s_add_u32 s60, s60, 16384
v_mfma_f32_16x16x32_bf16 v[80:83], a[56:59], a[188:191], v[80:83]
buffer_load_dwordx4 v1, s[8:11], s60 offen offset:0 sc1 lds
v_mfma_f32_16x16x32_bf16 v[84:87], a[60:63], a[184:187], v[84:87]
buffer_load_dwordx4 v1, s[8:11], s60 offen offset:1024 sc1 lds
v_mfma_f32_16x16x32_bf16 v[88:91], a[60:63], a[188:191], v[88:91]
buffer_load_dwordx4 v1, s[8:11], s60 offen offset:2048 sc1 lds
v_mfma_f32_16x16x32_bf16 v[92:95], a[64:67], a[184:187], v[92:95]
v_exp_f32 v192, v192
v_mfma_f32_16x16x32_bf16 v[96:99], a[64:67], a[188:191], v[96:99]
buffer_load_dwordx4 v1, s[8:11], s60 offen offset:3072 sc1 lds
v_mfma_f32_16x16x32_bf16 v[100:103], a[68:71], a[184:187], v[100:103]
v_exp_f32 v193, v193
v_mfma_f32_16x16x32_bf16 v[104:107], a[68:71], a[188:191], v[104:107]
s_waitcnt lgkmcnt(0)
v_mfma_f32_16x16x32_bf16 v[36:39], a[0:3], a[192:195], v[36:39]
ds_read_b128 a[36:39], v180 offset:27648
s_add_u32 m0, s63, 106496
v_mfma_f32_16x16x32_bf16 v[40:43], a[0:3], a[196:199], v[40:43]
ds_read_b128 a[40:43], v180 offset:28672
v_mfma_f32_16x16x32_bf16 v[44:47], a[4:7], a[192:195], v[44:47]
ds_read_b128 a[44:47], v180 offset:29696
s_add_u32 s61, s61, 36864
v_mfma_f32_16x16x32_bf16 v[48:51], a[4:7], a[196:199], v[48:51]
ds_read_b128 a[48:51], v180 offset:30720
v_mfma_f32_16x16x32_bf16 v[52:55], a[8:11], a[192:195], v[52:55]
ds_read_b128 a[52:55], v180 offset:31744
buffer_load_dwordx4 v1, s[8:11], s61 offen offset:0 sc1 lds
v_mfma_f32_16x16x32_bf16 v[56:59], a[8:11], a[196:199], v[56:59]
ds_read_b128 a[56:59], v180 offset:32768
v_mfma_f32_16x16x32_bf16 v[60:63], a[12:15], a[192:195], v[60:63]
ds_read_b128 a[60:63], v180 offset:33792
s_add_u32 m0, s62, 110592
v_mfma_f32_16x16x32_bf16 v[64:67], a[12:15], a[196:199], v[64:67]
ds_read_b128 a[64:67], v180 offset:34816
v_mfma_f32_16x16x32_bf16 v[68:71], a[16:19], a[192:195], v[68:71]
ds_read_b128 a[68:71], v180 offset:35840
s_add_u32 s60, s60, 20480
v_mfma_f32_16x16x32_bf16 v[72:75], a[16:19], a[196:199], v[72:75]
v_exp_f32 v194, v194
v_mfma_f32_16x16x32_bf16 v[76:79], a[20:23], a[192:195], v[76:79]
buffer_load_dwordx4 v1, s[8:11], s60 offen offset:0 sc1 lds
v_mfma_f32_16x16x32_bf16 v[80:83], a[20:23], a[196:199], v[80:83]
v_exp_f32 v195, v195
v_mfma_f32_16x16x32_bf16 v[84:87], a[24:27], a[192:195], v[84:87]
buffer_load_dwordx4 v1, s[8:11], s60 offen offset:1024 sc1 lds
v_fma_f32 v192, v192, v254, v254
v_mfma_f32_16x16x32_bf16 v[88:91], a[24:27], a[196:199], v[88:91]
v_fma_f32 v193, v193, v254, v254
v_mfma_f32_16x16x32_bf16 v[92:95], a[28:31], a[192:195], v[92:95]
buffer_load_dwordx4 v1, s[8:11], s60 offen offset:2048 sc1 lds
v_mfma_f32_16x16x32_bf16 v[96:99], a[28:31], a[196:199], v[96:99]
v_fma_f32 v194, v194, v254, v254
v_mfma_f32_16x16x32_bf16 v[100:103], a[32:35], a[192:195], v[100:103]
v_mfma_f32_16x16x32_bf16 v[104:107], a[32:35], a[196:199], v[104:107]
s_waitcnt vmcnt(12) lgkmcnt(0)
s_barrier
v_mfma_f32_16x16x32_bf16 v[36:39], a[36:39], a[200:203], v[36:39]
ds_read_b128 a[0:3], v200 offset:0
buffer_load_dwordx4 v1, s[8:11], s60 offen offset:3072 sc1 lds
v_mfma_f32_16x16x32_bf16 v[40:43], a[36:39], a[204:207], v[40:43]
ds_read_b128 a[4:7], v200 offset:1024
v_fma_f32 v195, v195, v254, v254
v_mfma_f32_16x16x32_bf16 v[44:47], a[40:43], a[200:203], v[44:47]
ds_read_b128 a[8:11], v200 offset:2048
v_mfma_f32_16x16x32_bf16 v[48:51], a[40:43], a[204:207], v[48:51]
ds_read_b128 a[12:15], v200 offset:3072
v_mfma_f32_16x16x32_bf16 v[52:55], a[44:47], a[200:203], v[52:55]
ds_read_b128 a[16:19], v200 offset:4096
v_mfma_f32_16x16x32_bf16 v[56:59], a[44:47], a[204:207], v[56:59]
ds_read_b128 a[20:23], v200 offset:5120
v_mfma_f32_16x16x32_bf16 v[60:63], a[48:51], a[200:203], v[60:63]
ds_read_b128 a[24:27], v200 offset:6144
v_mfma_f32_16x16x32_bf16 v[64:67], a[48:51], a[204:207], v[64:67]
ds_read_b128 a[28:31], v200 offset:7168
v_mfma_f32_16x16x32_bf16 v[68:71], a[52:55], a[200:203], v[68:71]
ds_read_b128 a[32:35], v200 offset:8192
v_mfma_f32_16x16x32_bf16 v[72:75], a[52:55], a[204:207], v[72:75]
s_cmp_eq_u32 s25, 2
s_cselect_b32 s99, 36864, 0
s_add_u32 s60, s60, s99
v_mfma_f32_16x16x32_bf16 v[76:79], a[56:59], a[200:203], v[76:79]
s_add_u32 s61, s61, s99
s_add_u32 m0, s62, 126976
s_add_u32 s60, s60, 16384
v_mfma_f32_16x16x32_bf16 v[80:83], a[56:59], a[204:207], v[80:83]
buffer_load_dwordx4 v1, s[8:11], s60 offen offset:0 sc1 lds
v_mfma_f32_16x16x32_bf16 v[84:87], a[60:63], a[200:203], v[84:87]
v_rcp_f32 v192, v192
v_mfma_f32_16x16x32_bf16 v[88:91], a[60:63], a[204:207], v[88:91]
buffer_load_dwordx4 v1, s[8:11], s60 offen offset:1024 sc1 lds
v_mfma_f32_16x16x32_bf16 v[92:95], a[64:67], a[200:203], v[92:95]
v_rcp_f32 v193, v193
v_mfma_f32_16x16x32_bf16 v[96:99], a[64:67], a[204:207], v[96:99]
buffer_load_dwordx4 v1, s[8:11], s60 offen offset:2048 sc1 lds
v_mfma_f32_16x16x32_bf16 v[100:103], a[68:71], a[200:203], v[100:103]
v_rcp_f32 v194, v194
v_mfma_f32_16x16x32_bf16 v[104:107], a[68:71], a[204:207], v[104:107]
s_waitcnt lgkmcnt(0)
v_mfma_f32_16x16x32_bf16 v[36:39], a[0:3], a[208:211], v[36:39]
ds_read_b128 a[36:39], v200 offset:9216
buffer_load_dwordx4 v1, s[8:11], s60 offen offset:3072 sc1 lds
v_mfma_f32_16x16x32_bf16 v[40:43], a[0:3], a[212:215], v[40:43]
ds_read_b128 a[40:43], v200 offset:10240
v_mfma_f32_16x16x32_bf16 v[44:47], a[4:7], a[208:211], v[44:47]
ds_read_b128 a[44:47], v200 offset:11264
s_add_u32 m0, s63, 143360
v_mfma_f32_16x16x32_bf16 v[48:51], a[4:7], a[212:215], v[48:51]
ds_read_b128 a[48:51], v200 offset:12288
v_mfma_f32_16x16x32_bf16 v[52:55], a[8:11], a[208:211], v[52:55]
ds_read_b128 a[52:55], v200 offset:13312
s_add_u32 s61, s61, 36864
v_mfma_f32_16x16x32_bf16 v[56:59], a[8:11], a[212:215], v[56:59]
ds_read_b128 a[56:59], v200 offset:14336
v_mfma_f32_16x16x32_bf16 v[60:63], a[12:15], a[208:211], v[60:63]
ds_read_b128 a[60:63], v200 offset:15360
buffer_load_dwordx4 v1, s[8:11], s61 offen offset:0 sc1 lds
v_mfma_f32_16x16x32_bf16 v[64:67], a[12:15], a[212:215], v[64:67]
ds_read_b128 a[64:67], v200 offset:16384
v_mfma_f32_16x16x32_bf16 v[68:71], a[16:19], a[208:211], v[68:71]
ds_read_b128 a[68:71], v200 offset:17408
s_add_u32 m0, s62, 147456
v_mfma_f32_16x16x32_bf16 v[72:75], a[16:19], a[212:215], v[72:75]
s_add_u32 s60, s60, 20480
v_rcp_f32 v195, v195
v_mfma_f32_16x16x32_bf16 v[76:79], a[20:23], a[208:211], v[76:79]
v_mul_f32 v132, v132, v192
v_mul_f32 v133, v133, v193
v_mfma_f32_16x16x32_bf16 v[80:83], a[20:23], a[212:215], v[80:83]
v_mul_f32 v134, v134, v194
v_mul_f32 v135, v135, v195
v_mfma_f32_16x16x32_bf16 v[84:87], a[24:27], a[208:211], v[84:87]
buffer_load_dwordx4 v1, s[8:11], s60 offen offset:0 sc1 lds
v_mul_f32 v196, v136, v136
v_mfma_f32_16x16x32_bf16 v[88:91], a[24:27], a[212:215], v[88:91]
v_mfma_f32_16x16x32_bf16 v[92:95], a[28:31], a[208:211], v[92:95]
buffer_load_dwordx4 v1, s[8:11], s60 offen offset:1024 sc1 lds
v_mfma_f32_16x16x32_bf16 v[96:99], a[28:31], a[212:215], v[96:99]
v_mul_f32 v197, v137, v137
v_mfma_f32_16x16x32_bf16 v[100:103], a[32:35], a[208:211], v[100:103]
v_mfma_f32_16x16x32_bf16 v[104:107], a[32:35], a[212:215], v[104:107]
s_waitcnt vmcnt(16) lgkmcnt(0)
s_barrier
v_mfma_f32_16x16x32_bf16 v[36:39], a[36:39], a[216:219], v[36:39]
ds_read_b128 a[0:3], v200 offset:18432
buffer_load_dwordx4 v1, s[8:11], s60 offen offset:2048 sc1 lds
v_mfma_f32_16x16x32_bf16 v[40:43], a[36:39], a[220:223], v[40:43]
ds_read_b128 a[4:7], v200 offset:19456
v_mul_f32 v198, v138, v138
v_mfma_f32_16x16x32_bf16 v[44:47], a[40:43], a[216:219], v[44:47]
ds_read_b128 a[8:11], v200 offset:20480
v_mul_f32 v199, v139, v139
v_mfma_f32_16x16x32_bf16 v[48:51], a[40:43], a[220:223], v[48:51]
ds_read_b128 a[12:15], v200 offset:21504
v_mfma_f32_16x16x32_bf16 v[52:55], a[44:47], a[216:219], v[52:55]
ds_read_b128 a[16:19], v200 offset:22528
buffer_load_dwordx4 v1, s[8:11], s60 offen offset:3072 sc1 lds
v_mfma_f32_16x16x32_bf16 v[56:59], a[44:47], a[220:223], v[56:59]
ds_read_b128 a[20:23], v200 offset:23552
v_fma_f32 v196, v196, v253, v251
v_mfma_f32_16x16x32_bf16 v[60:63], a[48:51], a[216:219], v[60:63]
ds_read_b128 a[24:27], v200 offset:24576
v_fma_f32 v197, v197, v253, v251
v_mfma_f32_16x16x32_bf16 v[64:67], a[48:51], a[220:223], v[64:67]
ds_read_b128 a[28:31], v200 offset:25600
v_mfma_f32_16x16x32_bf16 v[68:71], a[52:55], a[216:219], v[68:71]
ds_read_b128 a[32:35], v200 offset:26624
buffer_load_dwordx4 a[144:147], v1, s[4:7], s52 offen offset:2048 sc1
v_mfma_f32_16x16x32_bf16 v[72:75], a[52:55], a[220:223], v[72:75]
v_fma_f32 v198, v198, v253, v251
v_mfma_f32_16x16x32_bf16 v[76:79], a[56:59], a[216:219], v[76:79]
v_mfma_f32_16x16x32_bf16 v[80:83], a[56:59], a[220:223], v[80:83]
v_fma_f32 v199, v199, v253, v251
v_mfma_f32_16x16x32_bf16 v[84:87], a[60:63], a[216:219], v[84:87]
buffer_load_dwordx4 a[148:151], v9, s[4:7], s52 offen offset:2048 sc1
v_mfma_f32_16x16x32_bf16 v[88:91], a[60:63], a[220:223], v[88:91]
v_mul_f32 v196, v196, v136
v_mfma_f32_16x16x32_bf16 v[92:95], a[64:67], a[216:219], v[92:95]
v_mfma_f32_16x16x32_bf16 v[96:99], a[64:67], a[220:223], v[96:99]
v_mfma_f32_16x16x32_bf16 v[100:103], a[68:71], a[216:219], v[100:103]
v_mul_f32 v197, v197, v137
v_mfma_f32_16x16x32_bf16 v[104:107], a[68:71], a[220:223], v[104:107]
s_waitcnt lgkmcnt(0)
v_mfma_f32_16x16x32_bf16 v[36:39], a[0:3], a[224:227], v[36:39]
ds_read_b128 a[36:39], v200 offset:27648
buffer_load_dwordx4 a[152:155], v1, s[4:7], s52 offen offset:3072 sc1
v_mfma_f32_16x16x32_bf16 v[40:43], a[0:3], a[228:231], v[40:43]
ds_read_b128 a[40:43], v200 offset:28672
v_mul_f32 v198, v198, v138
v_mfma_f32_16x16x32_bf16 v[44:47], a[4:7], a[224:227], v[44:47]
ds_read_b128 a[44:47], v200 offset:29696
buffer_load_dwordx4 a[156:159], v9, s[4:7], s52 offen offset:3072 sc1
v_mfma_f32_16x16x32_bf16 v[48:51], a[4:7], a[228:231], v[48:51]
ds_read_b128 a[48:51], v200 offset:30720
v_mul_f32 v199, v199, v139
v_mfma_f32_16x16x32_bf16 v[52:55], a[8:11], a[224:227], v[52:55]
ds_read_b128 a[52:55], v200 offset:31744
v_mfma_f32_16x16x32_bf16 v[56:59], a[8:11], a[228:231], v[56:59]
ds_read_b128 a[56:59], v200 offset:32768
v_mfma_f32_16x16x32_bf16 v[60:63], a[12:15], a[224:227], v[60:63]
ds_read_b128 a[60:63], v200 offset:33792
v_mfma_f32_16x16x32_bf16 v[64:67], a[12:15], a[228:231], v[64:67]
ds_read_b128 a[64:67], v200 offset:34816
v_mfma_f32_16x16x32_bf16 v[68:71], a[16:19], a[224:227], v[68:71]
ds_read_b128 a[68:71], v200 offset:35840
v_mfma_f32_16x16x32_bf16 v[72:75], a[16:19], a[228:231], v[72:75]
s_cmp_eq_u32 s25, 4
s_cselect_b32 s98, 4096, 0
s_add_u32 s52, s52, s98
v_mfma_f32_16x16x32_bf16 v[76:79], a[20:23], a[224:227], v[76:79]
s_add_u32 s52, s52, 4096
v_exp_f32 v196, v196
v_mfma_f32_16x16x32_bf16 v[80:83], a[20:23], a[228:231], v[80:83]
v_exp_f32 v197, v197
v_mfma_f32_16x16x32_bf16 v[84:87], a[24:27], a[224:227], v[84:87]
buffer_load_dwordx4 a[160:163], v1, s[4:7], s52 offen offset:0 sc1
v_mfma_f32_16x16x32_bf16 v[88:91], a[24:27], a[228:231], v[88:91]
v_mfma_f32_16x16x32_bf16 v[92:95], a[28:31], a[224:227], v[92:95]
buffer_load_dwordx4 a[164:167], v9, s[4:7], s52 offen offset:0 sc1
v_mfma_f32_16x16x32_bf16 v[96:99], a[28:31], a[228:231], v[96:99]
v_exp_f32 v198, v198
v_mfma_f32_16x16x32_bf16 v[100:103], a[32:35], a[224:227], v[100:103]
v_mfma_f32_16x16x32_bf16 v[104:107], a[32:35], a[228:231], v[104:107]
s_waitcnt vmcnt(19) lgkmcnt(0)
s_barrier
v_mfma_f32_16x16x32_bf16 v[36:39], a[36:39], a[232:235], v[36:39]
ds_read_b128 a[0:3], v201 offset:0
buffer_load_dwordx4 a[168:171], v1, s[4:7], s52 offen offset:1024 sc1
v_mfma_f32_16x16x32_bf16 v[40:43], a[36:39], a[236:239], v[40:43]
ds_read_b128 a[4:7], v201 offset:1024
buffer_load_dwordx4 a[172:175], v9, s[4:7], s52 offen offset:1024 sc1
v_mfma_f32_16x16x32_bf16 v[44:47], a[40:43], a[232:235], v[44:47]
ds_read_b128 a[8:11], v201 offset:2048
v_mfma_f32_16x16x32_bf16 v[48:51], a[40:43], a[236:239], v[48:51]
ds_read_b128 a[12:15], v201 offset:3072
v_mfma_f32_16x16x32_bf16 v[52:55], a[44:47], a[232:235], v[52:55]
ds_read_b128 a[16:19], v201 offset:4096
v_mfma_f32_16x16x32_bf16 v[56:59], a[44:47], a[236:239], v[56:59]
ds_read_b128 a[20:23], v201 offset:5120
v_mfma_f32_16x16x32_bf16 v[60:63], a[48:51], a[232:235], v[60:63]
ds_read_b128 a[24:27], v201 offset:6144
v_mfma_f32_16x16x32_bf16 v[64:67], a[48:51], a[236:239], v[64:67]
ds_read_b128 a[28:31], v201 offset:7168
v_mfma_f32_16x16x32_bf16 v[68:71], a[52:55], a[232:235], v[68:71]
ds_read_b128 a[32:35], v201 offset:8192
v_mfma_f32_16x16x32_bf16 v[72:75], a[52:55], a[236:239], v[72:75]
s_cmp_eq_u32 s25, 3
s_cselect_b32 s99, 36864, 0
s_add_u32 s60, s60, s99
v_mfma_f32_16x16x32_bf16 v[76:79], a[56:59], a[232:235], v[76:79]
s_add_u32 s61, s61, s99
s_add_u32 m0, s62, 53248
v_mfma_f32_16x16x32_bf16 v[80:83], a[56:59], a[236:239], v[80:83]
s_add_u32 s60, s60, 16384
v_exp_f32 v199, v199
v_mfma_f32_16x16x32_bf16 v[84:87], a[60:63], a[232:235], v[84:87]
v_fma_f32 v196, v196, v255, v255
v_fma_f32 v197, v197, v255, v255
v_mfma_f32_16x16x32_bf16 v[88:91], a[60:63], a[236:239], v[88:91]
buffer_load_dwordx4 v1, s[8:11], s60 offen offset:0 sc1 lds
v_fma_f32 v198, v198, v255, v255
v_mfma_f32_16x16x32_bf16 v[92:95], a[64:67], a[232:235], v[92:95]
v_fma_f32 v199, v199, v255, v255
v_mfma_f32_16x16x32_bf16 v[96:99], a[64:67], a[236:239], v[96:99]
buffer_load_dwordx4 v1, s[8:11], s60 offen offset:1024 sc1 lds
v_mfma_f32_16x16x32_bf16 v[100:103], a[68:71], a[232:235], v[100:103]
v_rcp_f32 v196, v196
v_mfma_f32_16x16x32_bf16 v[104:107], a[68:71], a[236:239], v[104:107]
s_waitcnt lgkmcnt(0)
v_mfma_f32_16x16x32_bf16 v[36:39], a[0:3], a[240:243], v[36:39]
ds_read_b128 a[36:39], v201 offset:9216
buffer_load_dwordx4 v1, s[8:11], s60 offen offset:2048 sc1 lds
v_mfma_f32_16x16x32_bf16 v[40:43], a[0:3], a[244:247], v[40:43]
ds_read_b128 a[40:43], v201 offset:10240
v_mfma_f32_16x16x32_bf16 v[44:47], a[4:7], a[240:243], v[44:47]
ds_read_b128 a[44:47], v201 offset:11264
buffer_load_dwordx4 v1, s[8:11], s60 offen offset:3072 sc1 lds
v_mfma_f32_16x16x32_bf16 v[48:51], a[4:7], a[244:247], v[48:51]
ds_read_b128 a[48:51], v201 offset:12288
v_mfma_f32_16x16x32_bf16 v[52:55], a[8:11], a[240:243], v[52:55]
ds_read_b128 a[52:55], v201 offset:13312
s_add_u32 m0, s63, 69632
v_mfma_f32_16x16x32_bf16 v[56:59], a[8:11], a[244:247], v[56:59]
ds_read_b128 a[56:59], v201 offset:14336
v_mfma_f32_16x16x32_bf16 v[60:63], a[12:15], a[240:243], v[60:63]
ds_read_b128 a[60:63], v201 offset:15360
s_add_u32 s61, s61, 36864
v_mfma_f32_16x16x32_bf16 v[64:67], a[12:15], a[244:247], v[64:67]
ds_read_b128 a[64:67], v201 offset:16384
v_mfma_f32_16x16x32_bf16 v[68:71], a[16:19], a[240:243], v[68:71]
ds_read_b128 a[68:71], v201 offset:17408
buffer_load_dwordx4 v1, s[8:11], s61 offen offset:0 sc1 lds
v_mfma_f32_16x16x32_bf16 v[72:75], a[16:19], a[244:247], v[72:75]
s_add_u32 m0, s62, 73728
v_rcp_f32 v197, v197
v_mfma_f32_16x16x32_bf16 v[76:79], a[20:23], a[240:243], v[76:79]
s_add_u32 s60, s60, 20480
v_rcp_f32 v198, v198
v_mfma_f32_16x16x32_bf16 v[80:83], a[20:23], a[244:247], v[80:83]
v_rcp_f32 v199, v199
v_mfma_f32_16x16x32_bf16 v[84:87], a[24:27], a[240:243], v[84:87]
v_mfma_f32_16x16x32_bf16 v[88:91], a[24:27], a[244:247], v[88:91]
v_mfma_f32_16x16x32_bf16 v[92:95], a[28:31], a[240:243], v[92:95]
buffer_load_dwordx4 v1, s[8:11], s60 offen offset:0 sc1 lds
v_mfma_f32_16x16x32_bf16 v[96:99], a[28:31], a[244:247], v[96:99]
v_mfma_f32_16x16x32_bf16 v[100:103], a[32:35], a[240:243], v[100:103]
v_mul_f32 v136, v136, v196
v_mfma_f32_16x16x32_bf16 v[104:107], a[32:35], a[244:247], v[104:107]
s_waitcnt vmcnt(23) lgkmcnt(0)
s_barrier
v_mfma_f32_16x16x32_bf16 v[36:39], a[36:39], a[248:251], v[36:39]
ds_read_b128 a[0:3], v201 offset:18432
buffer_load_dwordx4 v1, s[8:11], s60 offen offset:1024 sc1 lds
v_mfma_f32_16x16x32_bf16 v[40:43], a[36:39], a[252:255], v[40:43]
ds_read_b128 a[4:7], v201 offset:19456
v_mul_f32 v137, v137, v197
v_mfma_f32_16x16x32_bf16 v[44:47], a[40:43], a[248:251], v[44:47]
ds_read_b128 a[8:11], v201 offset:20480
v_mul_f32 v138, v138, v198
v_mfma_f32_16x16x32_bf16 v[48:51], a[40:43], a[252:255], v[48:51]
ds_read_b128 a[12:15], v201 offset:21504
v_mfma_f32_16x16x32_bf16 v[52:55], a[44:47], a[248:251], v[52:55]
ds_read_b128 a[16:19], v201 offset:22528
buffer_load_dwordx4 v1, s[8:11], s60 offen offset:2048 sc1 lds
v_mfma_f32_16x16x32_bf16 v[56:59], a[44:47], a[252:255], v[56:59]
ds_read_b128 a[20:23], v201 offset:23552
v_mul_f32 v139, v139, v199
v_mfma_f32_16x16x32_bf16 v[60:63], a[48:51], a[248:251], v[60:63]
ds_read_b128 a[24:27], v201 offset:24576
v_mfma_f32_16x16x32_bf16 v[64:67], a[48:51], a[252:255], v[64:67]
ds_read_b128 a[28:31], v201 offset:25600
v_mul_f32 v192, v140, v140
v_mfma_f32_16x16x32_bf16 v[68:71], a[52:55], a[248:251], v[68:71]
ds_read_b128 a[32:35], v201 offset:26624
buffer_load_dwordx4 v1, s[8:11], s60 offen offset:3072 sc1 lds
v_mfma_f32_16x16x32_bf16 v[72:75], a[52:55], a[252:255], v[72:75]
v_mfma_f32_16x16x32_bf16 v[76:79], a[56:59], a[248:251], v[76:79]
v_mul_f32 v193, v141, v141
v_mfma_f32_16x16x32_bf16 v[80:83], a[56:59], a[252:255], v[80:83]
v_mfma_f32_16x16x32_bf16 v[84:87], a[60:63], a[248:251], v[84:87]
buffer_load_dwordx4 a[176:179], v1, s[4:7], s52 offen offset:2048 sc1
v_mul_f32 v194, v142, v142
v_mfma_f32_16x16x32_bf16 v[88:91], a[60:63], a[252:255], v[88:91]
v_mfma_f32_16x16x32_bf16 v[92:95], a[64:67], a[248:251], v[92:95]
v_mul_f32 v195, v143, v143
v_mfma_f32_16x16x32_bf16 v[96:99], a[64:67], a[252:255], v[96:99]
v_mfma_f32_16x16x32_bf16 v[100:103], a[68:71], a[248:251], v[100:103]
v_mfma_f32_16x16x32_bf16 v[104:107], a[68:71], a[252:255], v[104:107]
v_fma_f32 v192, v192, v252, v250
s_waitcnt lgkmcnt(0)
v_mfma_f32_16x16x32_bf16 v[36:39], a[0:3], a[80:83], v[36:39]
ds_read_b128 a[36:39], v201 offset:27648
buffer_load_dwordx4 a[180:183], v9, s[4:7], s52 offen offset:2048 sc1
v_mfma_f32_16x16x32_bf16 v[40:43], a[0:3], a[84:87], v[40:43]
ds_read_b128 a[40:43], v201 offset:28672
v_fma_f32 v193, v193, v252, v250
v_mfma_f32_16x16x32_bf16 v[44:47], a[4:7], a[80:83], v[44:47]
ds_read_b128 a[44:47], v201 offset:29696
buffer_load_dwordx4 a[184:187], v1, s[4:7], s52 offen offset:3072 sc1
v_mfma_f32_16x16x32_bf16 v[48:51], a[4:7], a[84:87], v[48:51]
ds_read_b128 a[48:51], v201 offset:30720
v_fma_f32 v194, v194, v252, v250
v_mfma_f32_16x16x32_bf16 v[52:55], a[8:11], a[80:83], v[52:55]
ds_read_b128 a[52:55], v201 offset:31744
buffer_load_dwordx4 a[188:191], v9, s[4:7], s52 offen offset:3072 sc1
v_mfma_f32_16x16x32_bf16 v[56:59], a[8:11], a[84:87], v[56:59]
ds_read_b128 a[56:59], v201 offset:32768
v_mfma_f32_16x16x32_bf16 v[60:63], a[12:15], a[80:83], v[60:63]
ds_read_b128 a[60:63], v201 offset:33792
v_fma_f32 v195, v195, v252, v250
v_mfma_f32_16x16x32_bf16 v[64:67], a[12:15], a[84:87], v[64:67]
ds_read_b128 a[64:67], v201 offset:34816
v_mfma_f32_16x16x32_bf16 v[68:71], a[16:19], a[80:83], v[68:71]
ds_read_b128 a[68:71], v201 offset:35840
v_mul_f32 v192, v192, v140
v_mfma_f32_16x16x32_bf16 v[72:75], a[16:19], a[84:87], v[72:75]
s_cmp_eq_u32 s25, 5
s_cselect_b32 s98, 4096, 0
v_mfma_f32_16x16x32_bf16 v[76:79], a[20:23], a[80:83], v[76:79]
s_add_u32 s52, s52, s98
v_mul_f32 v193, v193, v141
v_mfma_f32_16x16x32_bf16 v[80:83], a[20:23], a[84:87], v[80:83]
s_add_u32 s52, s52, 4096
v_mfma_f32_16x16x32_bf16 v[84:87], a[24:27], a[80:83], v[84:87]
v_mfma_f32_16x16x32_bf16 v[88:91], a[24:27], a[84:87], v[88:91]
v_mul_f32 v194, v194, v142
v_mfma_f32_16x16x32_bf16 v[92:95], a[28:31], a[80:83], v[92:95]
buffer_load_dwordx4 a[192:195], v1, s[4:7], s52 offen offset:0 sc1
v_mfma_f32_16x16x32_bf16 v[96:99], a[28:31], a[84:87], v[96:99]
v_mul_f32 v195, v195, v143
v_mfma_f32_16x16x32_bf16 v[100:103], a[32:35], a[80:83], v[100:103]
v_mfma_f32_16x16x32_bf16 v[104:107], a[32:35], a[84:87], v[104:107]
s_waitcnt vmcnt(22) lgkmcnt(0)
s_barrier
v_mfma_f32_16x16x32_bf16 v[36:39], a[36:39], a[88:91], v[36:39]
ds_read_b128 a[0:3], v202 offset:0
buffer_load_dwordx4 a[196:199], v9, s[4:7], s52 offen offset:0 sc1
v_mfma_f32_16x16x32_bf16 v[40:43], a[36:39], a[92:95], v[40:43]
ds_read_b128 a[4:7], v202 offset:1024
buffer_load_dwordx4 a[200:203], v1, s[4:7], s52 offen offset:1024 sc1
v_mfma_f32_16x16x32_bf16 v[44:47], a[40:43], a[88:91], v[44:47]
ds_read_b128 a[8:11], v202 offset:2048
v_mfma_f32_16x16x32_bf16 v[48:51], a[40:43], a[92:95], v[48:51]
ds_read_b128 a[12:15], v202 offset:3072
buffer_load_dwordx4 a[204:207], v9, s[4:7], s52 offen offset:1024 sc1
v_mfma_f32_16x16x32_bf16 v[52:55], a[44:47], a[88:91], v[52:55]
ds_read_b128 a[16:19], v202 offset:4096
v_mfma_f32_16x16x32_bf16 v[56:59], a[44:47], a[92:95], v[56:59]
ds_read_b128 a[20:23], v202 offset:5120
v_mfma_f32_16x16x32_bf16 v[60:63], a[48:51], a[88:91], v[60:63]
ds_read_b128 a[24:27], v202 offset:6144
v_mfma_f32_16x16x32_bf16 v[64:67], a[48:51], a[92:95], v[64:67]
ds_read_b128 a[28:31], v202 offset:7168
v_mfma_f32_16x16x32_bf16 v[68:71], a[52:55], a[88:91], v[68:71]
ds_read_b128 a[32:35], v202 offset:8192
v_mfma_f32_16x16x32_bf16 v[72:75], a[52:55], a[92:95], v[72:75]
s_cmp_eq_u32 s25, 4
s_cselect_b32 s99, 36864, 0
s_add_u32 s60, s60, s99
v_mfma_f32_16x16x32_bf16 v[76:79], a[56:59], a[88:91], v[76:79]
s_add_u32 s61, s61, s99
v_exp_f32 v192, v192
v_mfma_f32_16x16x32_bf16 v[80:83], a[56:59], a[92:95], v[80:83]
s_add_u32 m0, s62, 90112
v_exp_f32 v193, v193
v_mfma_f32_16x16x32_bf16 v[84:87], a[60:63], a[88:91], v[84:87]
s_add_u32 s60, s60, 16384
v_exp_f32 v194, v194
v_mfma_f32_16x16x32_bf16 v[88:91], a[60:63], a[92:95], v[88:91]
v_mfma_f32_16x16x32_bf16 v[92:95], a[64:67], a[88:91], v[92:95]
v_exp_f32 v195, v195
v_mfma_f32_16x16x32_bf16 v[96:99], a[64:67], a[92:95], v[96:99]
buffer_load_dwordx4 v1, s[8:11], s60 offen offset:0 sc1 lds
v_mfma_f32_16x16x32_bf16 v[100:103], a[68:71], a[88:91], v[100:103]
v_mfma_f32_16x16x32_bf16 v[104:107], a[68:71], a[92:95], v[104:107]
s_waitcnt lgkmcnt(0)
v_mfma_f32_16x16x32_bf16 v[36:39], a[0:3], a[96:99], v[36:39]
ds_read_b128 a[36:39], v202 offset:9216
buffer_load_dwordx4 v1, s[8:11], s60 offen offset:1024 sc1 lds
v_mfma_f32_16x16x32_bf16 v[40:43], a[0:3], a[100:103], v[40:43]
ds_read_b128 a[40:43], v202 offset:10240
v_fma_f32 v192, v192, v254, v254
v_mfma_f32_16x16x32_bf16 v[44:47], a[4:7], a[96:99], v[44:47]
ds_read_b128 a[44:47], v202 offset:11264
buffer_load_dwordx4 v1, s[8:11], s60 offen offset:2048 sc1 lds
v_mfma_f32_16x16x32_bf16 v[48:51], a[4:7], a[100:103], v[48:51]
ds_read_b128 a[48:51], v202 offset:12288
v_fma_f32 v193, v193, v254, v254
v_mfma_f32_16x16x32_bf16 v[52:55], a[8:11], a[96:99], v[52:55]
ds_read_b128 a[52:55], v202 offset:13312
v_mfma_f32_16x16x32_bf16 v[56:59], a[8:11], a[100:103], v[56:59]
ds_read_b128 a[56:59], v202 offset:14336
buffer_load_dwordx4 v1, s[8:11], s60 offen offset:3072 sc1 lds
v_mfma_f32_16x16x32_bf16 v[60:63], a[12:15], a[96:99], v[60:63]
ds_read_b128 a[60:63], v202 offset:15360
v_fma_f32 v194, v194, v254, v254
v_mfma_f32_16x16x32_bf16 v[64:67], a[12:15], a[100:103], v[64:67]
ds_read_b128 a[64:67], v202 offset:16384
v_fma_f32 v195, v195, v254, v254
v_mfma_f32_16x16x32_bf16 v[68:71], a[16:19], a[96:99], v[68:71]
ds_read_b128 a[68:71], v202 offset:17408
s_add_u32 m0, s63, 106496
v_mfma_f32_16x16x32_bf16 v[72:75], a[16:19], a[100:103], v[72:75]
s_add_u32 s61, s61, 36864
v_mfma_f32_16x16x32_bf16 v[76:79], a[20:23], a[96:99], v[76:79]
v_rcp_f32 v192, v192
v_mfma_f32_16x16x32_bf16 v[80:83], a[20:23], a[100:103], v[80:83]
v_mfma_f32_16x16x32_bf16 v[84:87], a[24:27], a[96:99], v[84:87]
v_mfma_f32_16x16x32_bf16 v[88:91], a[24:27], a[100:103], v[88:91]
v_mfma_f32_16x16x32_bf16 v[92:95], a[28:31], a[96:99], v[92:95]
buffer_load_dwordx4 v1, s[8:11], s61 offen offset:0 sc1 lds
v_mfma_f32_16x16x32_bf16 v[96:99], a[28:31], a[100:103], v[96:99]
v_rcp_f32 v193, v193
v_mfma_f32_16x16x32_bf16 v[100:103], a[32:35], a[96:99], v[100:103]
v_mfma_f32_16x16x32_bf16 v[104:107], a[32:35], a[100:103], v[104:107]
s_waitcnt lgkmcnt(0)
v_mfma_f32_16x16x32_bf16 v[36:39], a[36:39], a[104:107], v[36:39]
ds_read_b128 a[0:3], v202 offset:18432
s_add_u32 m0, s62, 110592
v_mfma_f32_16x16x32_bf16 v[40:43], a[36:39], a[108:111], v[40:43]
ds_read_b128 a[4:7], v202 offset:19456
v_mfma_f32_16x16x32_bf16 v[44:47], a[40:43], a[104:107], v[44:47]
ds_read_b128 a[8:11], v202 offset:20480
s_add_u32 s60, s60, 20480
v_mfma_f32_16x16x32_bf16 v[48:51], a[40:43], a[108:111], v[48:51]
ds_read_b128 a[12:15], v202 offset:21504
v_mfma_f32_16x16x32_bf16 v[52:55], a[44:47], a[104:107], v[52:55]
ds_read_b128 a[16:19], v202 offset:22528
v_mfma_f32_16x16x32_bf16 v[56:59], a[44:47], a[108:111], v[56:59]
ds_read_b128 a[20:23], v202 offset:23552
buffer_load_dwordx4 v1, s[8:11], s60 offen offset:0 sc1 lds
v_mfma_f32_16x16x32_bf16 v[60:63], a[48:51], a[104:107], v[60:63]
ds_read_b128 a[24:27], v202 offset:24576
v_mfma_f32_16x16x32_bf16 v[64:67], a[48:51], a[108:111], v[64:67]
ds_read_b128 a[28:31], v202 offset:25600
v_mfma_f32_16x16x32_bf16 v[68:71], a[52:55], a[104:107], v[68:71]
ds_read_b128 a[32:35], v202 offset:26624
buffer_load_dwordx4 v1, s[8:11], s60 offen offset:1024 sc1 lds
v_mfma_f32_16x16x32_bf16 v[72:75], a[52:55], a[108:111], v[72:75]
v_rcp_f32 v194, v194
v_mfma_f32_16x16x32_bf16 v[76:79], a[56:59], a[104:107], v[76:79]
v_rcp_f32 v195, v195
v_mfma_f32_16x16x32_bf16 v[80:83], a[56:59], a[108:111], v[80:83]
buffer_load_dwordx4 v1, s[8:11], s60 offen offset:2048 sc1 lds
v_mul_f32 v140, v140, v192
v_mfma_f32_16x16x32_bf16 v[84:87], a[60:63], a[104:107], v[84:87]
v_mfma_f32_16x16x32_bf16 v[88:91], a[60:63], a[108:111], v[88:91]
v_mul_f32 v141, v141, v193
v_mfma_f32_16x16x32_bf16 v[92:95], a[64:67], a[104:107], v[92:95]
buffer_load_dwordx4 v1, s[8:11], s60 offen offset:3072 sc1 lds
v_mfma_f32_16x16x32_bf16 v[96:99], a[64:67], a[108:111], v[96:99]
v_mul_f32 v142, v142, v194
v_mfma_f32_16x16x32_bf16 v[100:103], a[68:71], a[104:107], v[100:103]
v_mfma_f32_16x16x32_bf16 v[104:107], a[68:71], a[108:111], v[104:107]
s_waitcnt lgkmcnt(0)
v_mfma_f32_16x16x32_bf16 v[36:39], a[0:3], a[112:115], v[36:39]
ds_read_b128 a[36:39], v202 offset:27648
buffer_load_dwordx4 a[208:211], v1, s[4:7], s52 offen offset:2048 sc1
v_mfma_f32_16x16x32_bf16 v[40:43], a[0:3], a[116:119], v[40:43]
ds_read_b128 a[40:43], v202 offset:28672
v_mul_f32 v143, v143, v195
v_mfma_f32_16x16x32_bf16 v[44:47], a[4:7], a[112:115], v[44:47]
ds_read_b128 a[44:47], v202 offset:29696
v_mul_f32 v196, v144, v144
v_mfma_f32_16x16x32_bf16 v[48:51], a[4:7], a[116:119], v[48:51]
ds_read_b128 a[48:51], v202 offset:30720
v_mfma_f32_16x16x32_bf16 v[52:55], a[8:11], a[112:115], v[52:55]
ds_read_b128 a[52:55], v202 offset:31744
buffer_load_dwordx4 a[212:215], v9, s[4:7], s52 offen offset:2048 sc1
v_mfma_f32_16x16x32_bf16 v[56:59], a[8:11], a[116:119], v[56:59]
ds_read_b128 a[56:59], v202 offset:32768
v_mul_f32 v197, v145, v145
v_mfma_f32_16x16x32_bf16 v[60:63], a[12:15], a[112:115], v[60:63]
ds_read_b128 a[60:63], v202 offset:33792
v_mfma_f32_16x16x32_bf16 v[64:67], a[12:15], a[116:119], v[64:67]
ds_read_b128 a[64:67], v202 offset:34816
v_mul_f32 v198, v146, v146
v_mfma_f32_16x16x32_bf16 v[68:71], a[16:19], a[112:115], v[68:71]
ds_read_b128 a[68:71], v202 offset:35840
buffer_load_dwordx4 a[216:219], v1, s[4:7], s52 offen offset:3072 sc1
v_mfma_f32_16x16x32_bf16 v[72:75], a[16:19], a[116:119], v[72:75]
v_mul_f32 v199, v147, v147
v_mfma_f32_16x16x32_bf16 v[76:79], a[20:23], a[112:115], v[76:79]
v_mfma_f32_16x16x32_bf16 v[80:83], a[20:23], a[116:119], v[80:83]
v_fma_f32 v196, v196, v253, v251
v_mfma_f32_16x16x32_bf16 v[84:87], a[24:27], a[112:115], v[84:87]
buffer_load_dwordx4 a[220:223], v9, s[4:7], s52 offen offset:3072 sc1
v_mfma_f32_16x16x32_bf16 v[88:91], a[24:27], a[116:119], v[88:91]
v_mfma_f32_16x16x32_bf16 v[92:95], a[28:31], a[112:115], v[92:95]
v_fma_f32 v197, v197, v253, v251
v_mfma_f32_16x16x32_bf16 v[96:99], a[28:31], a[116:119], v[96:99]
v_mfma_f32_16x16x32_bf16 v[100:103], a[32:35], a[112:115], v[100:103]
v_fma_f32 v198, v198, v253, v251
v_mfma_f32_16x16x32_bf16 v[104:107], a[32:35], a[116:119], v[104:107]
s_waitcnt vmcnt(21) lgkmcnt(0)
s_barrier
v_mfma_f32_16x16x32_bf16 v[36:39], a[36:39], a[120:123], v[36:39]
ds_read_b128 a[0:3], v200 offset:0
v_mfma_f32_16x16x32_bf16 v[40:43], a[36:39], a[124:127], v[40:43]
ds_read_b128 a[4:7], v200 offset:1024
v_fma_f32 v199, v199, v253, v251
v_mfma_f32_16x16x32_bf16 v[44:47], a[40:43], a[120:123], v[44:47]
ds_read_b128 a[8:11], v200 offset:2048
v_mfma_f32_16x16x32_bf16 v[48:51], a[40:43], a[124:127], v[48:51]
ds_read_b128 a[12:15], v200 offset:3072
v_mul_f32 v196, v196, v144
v_mfma_f32_16x16x32_bf16 v[52:55], a[44:47], a[120:123], v[52:55]
ds_read_b128 a[16:19], v200 offset:4096
v_mfma_f32_16x16x32_bf16 v[56:59], a[44:47], a[124:127], v[56:59]
ds_read_b128 a[20:23], v200 offset:5120
v_mul_f32 v197, v197, v145
v_mfma_f32_16x16x32_bf16 v[60:63], a[48:51], a[120:123], v[60:63]
ds_read_b128 a[24:27], v200 offset:6144
v_mfma_f32_16x16x32_bf16 v[64:67], a[48:51], a[124:127], v[64:67]
ds_read_b128 a[28:31], v200 offset:7168
v_mfma_f32_16x16x32_bf16 v[68:71], a[52:55], a[120:123], v[68:71]
ds_read_b128 a[32:35], v200 offset:8192
v_mul_f32 v198, v198, v146
v_mfma_f32_16x16x32_bf16 v[72:75], a[52:55], a[124:127], v[72:75]
s_cmp_eq_u32 s25, 5
s_cselect_b32 s99, 36864, 0
s_add_u32 s60, s60, s99
v_mfma_f32_16x16x32_bf16 v[76:79], a[56:59], a[120:123], v[76:79]
s_add_u32 s61, s61, s99
s_add_u32 m0, s62, 126976
s_add_u32 s60, s60, 16384
v_mfma_f32_16x16x32_bf16 v[80:83], a[56:59], a[124:127], v[80:83]
buffer_load_dwordx4 v1, s[8:11], s60 offen offset:0 sc1 lds
v_mul_f32 v199, v199, v147
v_mfma_f32_16x16x32_bf16 v[84:87], a[60:63], a[120:123], v[84:87]
buffer_load_dwordx4 v1, s[8:11], s60 offen offset:1024 sc1 lds
v_mfma_f32_16x16x32_bf16 v[88:91], a[60:63], a[124:127], v[88:91]
buffer_load_dwordx4 v1, s[8:11], s60 offen offset:2048 sc1 lds
v_mfma_f32_16x16x32_bf16 v[92:95], a[64:67], a[120:123], v[92:95]
v_exp_f32 v196, v196
v_mfma_f32_16x16x32_bf16 v[96:99], a[64:67], a[124:127], v[96:99]
buffer_load_dwordx4 v1, s[8:11], s60 offen offset:3072 sc1 lds
v_mfma_f32_16x16x32_bf16 v[100:103], a[68:71], a[120:123], v[100:103]
v_mfma_f32_16x16x32_bf16 v[104:107], a[68:71], a[124:127], v[104:107]
s_waitcnt lgkmcnt(0)
v_mfma_f32_16x16x32_bf16 v[36:39], a[0:3], a[128:131], v[36:39]
ds_read_b128 a[36:39], v200 offset:9216
s_add_u32 m0, s63, 143360
v_mfma_f32_16x16x32_bf16 v[40:43], a[0:3], a[132:135], v[40:43]
ds_read_b128 a[40:43], v200 offset:10240
v_mfma_f32_16x16x32_bf16 v[44:47], a[4:7], a[128:131], v[44:47]
ds_read_b128 a[44:47], v200 offset:11264
s_add_u32 s61, s61, 36864
v_mfma_f32_16x16x32_bf16 v[48:51], a[4:7], a[132:135], v[48:51]
ds_read_b128 a[48:51], v200 offset:12288
v_mfma_f32_16x16x32_bf16 v[52:55], a[8:11], a[128:131], v[52:55]
ds_read_b128 a[52:55], v200 offset:13312
buffer_load_dwordx4 v1, s[8:11], s61 offen offset:0 sc1 lds
v_mfma_f32_16x16x32_bf16 v[56:59], a[8:11], a[132:135], v[56:59]
ds_read_b128 a[56:59], v200 offset:14336
v_mfma_f32_16x16x32_bf16 v[60:63], a[12:15], a[128:131], v[60:63]
ds_read_b128 a[60:63], v200 offset:15360
s_add_u32 m0, s62, 147456
v_mfma_f32_16x16x32_bf16 v[64:67], a[12:15], a[132:135], v[64:67]
ds_read_b128 a[64:67], v200 offset:16384
v_mfma_f32_16x16x32_bf16 v[68:71], a[16:19], a[128:131], v[68:71]
ds_read_b128 a[68:71], v200 offset:17408
s_add_u32 s60, s60, 20480
v_mfma_f32_16x16x32_bf16 v[72:75], a[16:19], a[132:135], v[72:75]
v_exp_f32 v197, v197
v_mfma_f32_16x16x32_bf16 v[76:79], a[20:23], a[128:131], v[76:79]
buffer_load_dwordx4 v1, s[8:11], s60 offen offset:0 sc1 lds
v_mfma_f32_16x16x32_bf16 v[80:83], a[20:23], a[132:135], v[80:83]
v_exp_f32 v198, v198
v_mfma_f32_16x16x32_bf16 v[84:87], a[24:27], a[128:131], v[84:87]
buffer_load_dwordx4 v1, s[8:11], s60 offen offset:1024 sc1 lds
v_mfma_f32_16x16x32_bf16 v[88:91], a[24:27], a[132:135], v[88:91]
v_exp_f32 v199, v199
v_mfma_f32_16x16x32_bf16 v[92:95], a[28:31], a[128:131], v[92:95]
buffer_load_dwordx4 v1, s[8:11], s60 offen offset:2048 sc1 lds
v_fma_f32 v196, v196, v255, v255
v_mfma_f32_16x16x32_bf16 v[96:99], a[28:31], a[132:135], v[96:99]
v_mfma_f32_16x16x32_bf16 v[100:103], a[32:35], a[128:131], v[100:103]
v_fma_f32 v197, v197, v255, v255
v_mfma_f32_16x16x32_bf16 v[104:107], a[32:35], a[132:135], v[104:107]
s_waitcnt lgkmcnt(0)
v_mfma_f32_16x16x32_bf16 v[36:39], a[36:39], a[136:139], v[36:39]
ds_read_b128 a[0:3], v200 offset:18432
buffer_load_dwordx4 v1, s[8:11], s60 offen offset:3072 sc1 lds
v_mfma_f32_16x16x32_bf16 v[40:43], a[36:39], a[140:143], v[40:43]
ds_read_b128 a[4:7], v200 offset:19456
v_fma_f32 v198, v198, v255, v255
v_mfma_f32_16x16x32_bf16 v[44:47], a[40:43], a[136:139], v[44:47]
ds_read_b128 a[8:11], v200 offset:20480
v_fma_f32 v199, v199, v255, v255
v_mfma_f32_16x16x32_bf16 v[48:51], a[40:43], a[140:143], v[48:51]
ds_read_b128 a[12:15], v200 offset:21504
v_mfma_f32_16x16x32_bf16 v[52:55], a[44:47], a[136:139], v[52:55]
ds_read_b128 a[16:19], v200 offset:22528
v_mfma_f32_16x16x32_bf16 v[56:59], a[44:47], a[140:143], v[56:59]
ds_read_b128 a[20:23], v200 offset:23552
v_mfma_f32_16x16x32_bf16 v[60:63], a[48:51], a[136:139], v[60:63]
ds_read_b128 a[24:27], v200 offset:24576
v_mfma_f32_16x16x32_bf16 v[64:67], a[48:51], a[140:143], v[64:67]
ds_read_b128 a[28:31], v200 offset:25600
v_mfma_f32_16x16x32_bf16 v[68:71], a[52:55], a[136:139], v[68:71]
ds_read_b128 a[32:35], v200 offset:26624
v_mfma_f32_16x16x32_bf16 v[72:75], a[52:55], a[140:143], v[72:75]
s_cmp_eq_u32 s25, 6
s_cselect_b32 s98, 4096, 0
s_add_u32 s52, s52, s98
v_mfma_f32_16x16x32_bf16 v[76:79], a[56:59], a[136:139], v[76:79]
s_add_u32 s52, s52, 4096
v_rcp_f32 v196, v196
v_mfma_f32_16x16x32_bf16 v[80:83], a[56:59], a[140:143], v[80:83]
buffer_load_dwordx4 a[224:227], v1, s[4:7], s52 offen offset:0 sc1
v_mfma_f32_16x16x32_bf16 v[84:87], a[60:63], a[136:139], v[84:87]
buffer_load_dwordx4 a[228:231], v9, s[4:7], s52 offen offset:0 sc1
v_mfma_f32_16x16x32_bf16 v[88:91], a[60:63], a[140:143], v[88:91]
v_rcp_f32 v197, v197
v_mfma_f32_16x16x32_bf16 v[92:95], a[64:67], a[136:139], v[92:95]
buffer_load_dwordx4 a[232:235], v1, s[4:7], s52 offen offset:1024 sc1
v_mfma_f32_16x16x32_bf16 v[96:99], a[64:67], a[140:143], v[96:99]
v_rcp_f32 v198, v198
v_mfma_f32_16x16x32_bf16 v[100:103], a[68:71], a[136:139], v[100:103]
v_mfma_f32_16x16x32_bf16 v[104:107], a[68:71], a[140:143], v[104:107]
s_waitcnt lgkmcnt(0)
v_mfma_f32_16x16x32_bf16 v[36:39], a[0:3], a[144:147], v[36:39]
ds_read_b128 a[36:39], v200 offset:27648
buffer_load_dwordx4 a[236:239], v9, s[4:7], s52 offen offset:1024 sc1
v_mfma_f32_16x16x32_bf16 v[40:43], a[0:3], a[148:151], v[40:43]
ds_read_b128 a[40:43], v200 offset:28672
v_mfma_f32_16x16x32_bf16 v[44:47], a[4:7], a[144:147], v[44:47]
ds_read_b128 a[44:47], v200 offset:29696
v_mfma_f32_16x16x32_bf16 v[48:51], a[4:7], a[148:151], v[48:51]
ds_read_b128 a[48:51], v200 offset:30720
v_mfma_f32_16x16x32_bf16 v[52:55], a[8:11], a[144:147], v[52:55]
ds_read_b128 a[52:55], v200 offset:31744
buffer_load_dwordx4 a[240:243], v1, s[4:7], s52 offen offset:2048 sc1
v_mfma_f32_16x16x32_bf16 v[56:59], a[8:11], a[148:151], v[56:59]
ds_read_b128 a[56:59], v200 offset:32768
v_mfma_f32_16x16x32_bf16 v[60:63], a[12:15], a[144:147], v[60:63]
ds_read_b128 a[60:63], v200 offset:33792
v_mfma_f32_16x16x32_bf16 v[64:67], a[12:15], a[148:151], v[64:67]
ds_read_b128 a[64:67], v200 offset:34816
v_mfma_f32_16x16x32_bf16 v[68:71], a[16:19], a[144:147], v[68:71]
ds_read_b128 a[68:71], v200 offset:35840
buffer_load_dwordx4 a[244:247], v9, s[4:7], s52 offen offset:2048 sc1
v_mfma_f32_16x16x32_bf16 v[72:75], a[16:19], a[148:151], v[72:75]
v_rcp_f32 v199, v199
v_mfma_f32_16x16x32_bf16 v[76:79], a[20:23], a[144:147], v[76:79]
v_mul_f32 v144, v144, v196
v_mul_f32 v145, v145, v197
v_mfma_f32_16x16x32_bf16 v[80:83], a[20:23], a[148:151], v[80:83]
v_mul_f32 v146, v146, v198
v_mfma_f32_16x16x32_bf16 v[84:87], a[24:27], a[144:147], v[84:87]
buffer_load_dwordx4 a[248:251], v1, s[4:7], s52 offen offset:3072 sc1
v_mfma_f32_16x16x32_bf16 v[88:91], a[24:27], a[148:151], v[88:91]
v_mul_f32 v147, v147, v199
v_mfma_f32_16x16x32_bf16 v[92:95], a[28:31], a[144:147], v[92:95]
v_mfma_f32_16x16x32_bf16 v[96:99], a[28:31], a[148:151], v[96:99]
v_mul_f32 v192, v148, v148
v_mfma_f32_16x16x32_bf16 v[100:103], a[32:35], a[144:147], v[100:103]
v_mfma_f32_16x16x32_bf16 v[104:107], a[32:35], a[148:151], v[104:107]
s_waitcnt vmcnt(20) lgkmcnt(0)
s_barrier
v_mfma_f32_16x16x32_bf16 v[36:39], a[36:39], a[152:155], v[36:39]
ds_read_b128 a[0:3], v201 offset:0
buffer_load_dwordx4 a[252:255], v9, s[4:7], s52 offen offset:3072 sc1
v_mfma_f32_16x16x32_bf16 v[40:43], a[36:39], a[156:159], v[40:43]
ds_read_b128 a[4:7], v201 offset:1024
v_mul_f32 v193, v149, v149
v_mfma_f32_16x16x32_bf16 v[44:47], a[40:43], a[152:155], v[44:47]
ds_read_b128 a[8:11], v201 offset:2048
v_mul_f32 v194, v150, v150
v_mfma_f32_16x16x32_bf16 v[48:51], a[40:43], a[156:159], v[48:51]
ds_read_b128 a[12:15], v201 offset:3072
v_mfma_f32_16x16x32_bf16 v[52:55], a[44:47], a[152:155], v[52:55]
ds_read_b128 a[16:19], v201 offset:4096
v_mul_f32 v195, v151, v151
v_mfma_f32_16x16x32_bf16 v[56:59], a[44:47], a[156:159], v[56:59]
ds_read_b128 a[20:23], v201 offset:5120
v_mfma_f32_16x16x32_bf16 v[60:63], a[48:51], a[152:155], v[60:63]
ds_read_b128 a[24:27], v201 offset:6144
v_fma_f32 v192, v192, v252, v250
v_mfma_f32_16x16x32_bf16 v[64:67], a[48:51], a[156:159], v[64:67]
ds_read_b128 a[28:31], v201 offset:7168
v_mfma_f32_16x16x32_bf16 v[68:71], a[52:55], a[152:155], v[68:71]
ds_read_b128 a[32:35], v201 offset:8192
v_mfma_f32_16x16x32_bf16 v[72:75], a[52:55], a[156:159], v[72:75]
s_cmp_eq_u32 s25, 6
s_cselect_b32 s99, 36864, 0
s_add_u32 s60, s60, s99
v_mfma_f32_16x16x32_bf16 v[76:79], a[56:59], a[152:155], v[76:79]
s_add_u32 s61, s61, s99
s_add_u32 m0, s62, 53248
s_add_u32 s60, s60, 16384
v_mfma_f32_16x16x32_bf16 v[80:83], a[56:59], a[156:159], v[80:83]
buffer_load_dwordx4 v1, s[8:11], s60 offen offset:0 sc1 lds
v_fma_f32 v193, v193, v252, v250
v_mfma_f32_16x16x32_bf16 v[84:87], a[60:63], a[152:155], v[84:87]
v_fma_f32 v194, v194, v252, v250
v_mfma_f32_16x16x32_bf16 v[88:91], a[60:63], a[156:159], v[88:91]
buffer_load_dwordx4 v1, s[8:11], s60 offen offset:1024 sc1 lds
v_fma_f32 v195, v195, v252, v250
v_mfma_f32_16x16x32_bf16 v[92:95], a[64:67], a[152:155], v[92:95]
v_mfma_f32_16x16x32_bf16 v[96:99], a[64:67], a[156:159], v[96:99]
buffer_load_dwordx4 v1, s[8:11], s60 offen offset:2048 sc1 lds
v_mfma_f32_16x16x32_bf16 v[100:103], a[68:71], a[152:155], v[100:103]
v_mul_f32 v192, v192, v148
v_mfma_f32_16x16x32_bf16 v[104:107], a[68:71], a[156:159], v[104:107]
s_waitcnt lgkmcnt(0)
v_mfma_f32_16x16x32_bf16 v[36:39], a[0:3], a[160:163], v[36:39]
ds_read_b128 a[36:39], v201 offset:9216
buffer_load_dwordx4 v1, s[8:11], s60 offen offset:3072 sc1 lds
v_mfma_f32_16x16x32_bf16 v[40:43], a[0:3], a[164:167], v[40:43]
ds_read_b128 a[40:43], v201 offset:10240
v_mul_f32 v193, v193, v149
v_mfma_f32_16x16x32_bf16 v[44:47], a[4:7], a[160:163], v[44:47]
ds_read_b128 a[44:47], v201 offset:11264
s_add_u32 m0, s63, 69632
v_mfma_f32_16x16x32_bf16 v[48:51], a[4:7], a[164:167], v[48:51]
ds_read_b128 a[48:51], v201 offset:12288
v_mul_f32 v194, v194, v150
v_mfma_f32_16x16x32_bf16 v[52:55], a[8:11], a[160:163], v[52:55]
ds_read_b128 a[52:55], v201 offset:13312
s_add_u32 s61, s61, 36864
v_mfma_f32_16x16x32_bf16 v[56:59], a[8:11], a[164:167], v[56:59]
ds_read_b128 a[56:59], v201 offset:14336
v_mul_f32 v195, v195, v151
v_mfma_f32_16x16x32_bf16 v[60:63], a[12:15], a[160:163], v[60:63]
ds_read_b128 a[60:63], v201 offset:15360
buffer_load_dwordx4 v1, s[8:11], s61 offen offset:0 sc1 lds
v_mfma_f32_16x16x32_bf16 v[64:67], a[12:15], a[164:167], v[64:67]
ds_read_b128 a[64:67], v201 offset:16384
v_mfma_f32_16x16x32_bf16 v[68:71], a[16:19], a[160:163], v[68:71]
ds_read_b128 a[68:71], v201 offset:17408
s_add_u32 m0, s62, 73728
v_mfma_f32_16x16x32_bf16 v[72:75], a[16:19], a[164:167], v[72:75]
s_add_u32 s60, s60, 20480
v_exp_f32 v192, v192
v_mfma_f32_16x16x32_bf16 v[76:79], a[20:23], a[160:163], v[76:79]
v_mfma_f32_16x16x32_bf16 v[80:83], a[20:23], a[164:167], v[80:83]
v_mfma_f32_16x16x32_bf16 v[84:87], a[24:27], a[160:163], v[84:87]
buffer_load_dwordx4 v1, s[8:11], s60 offen offset:0 sc1 lds
v_mfma_f32_16x16x32_bf16 v[88:91], a[24:27], a[164:167], v[88:91]
v_exp_f32 v193, v193
v_mfma_f32_16x16x32_bf16 v[92:95], a[28:31], a[160:163], v[92:95]
buffer_load_dwordx4 v1, s[8:11], s60 offen offset:1024 sc1 lds
v_mfma_f32_16x16x32_bf16 v[96:99], a[28:31], a[164:167], v[96:99]
v_mfma_f32_16x16x32_bf16 v[100:103], a[32:35], a[160:163], v[100:103]
v_mfma_f32_16x16x32_bf16 v[104:107], a[32:35], a[164:167], v[104:107]
s_waitcnt lgkmcnt(0)
v_mfma_f32_16x16x32_bf16 v[36:39], a[36:39], a[168:171], v[36:39]
ds_read_b128 a[0:3], v201 offset:18432
buffer_load_dwordx4 v1, s[8:11], s60 offen offset:2048 sc1 lds
v_mfma_f32_16x16x32_bf16 v[40:43], a[36:39], a[172:175], v[40:43]
ds_read_b128 a[4:7], v201 offset:19456
v_mfma_f32_16x16x32_bf16 v[44:47], a[40:43], a[168:171], v[44:47]
ds_read_b128 a[8:11], v201 offset:20480
buffer_load_dwordx4 v1, s[8:11], s60 offen offset:3072 sc1 lds
v_mfma_f32_16x16x32_bf16 v[48:51], a[40:43], a[172:175], v[48:51]
ds_read_b128 a[12:15], v201 offset:21504
v_mfma_f32_16x16x32_bf16 v[52:55], a[44:47], a[168:171], v[52:55]
ds_read_b128 a[16:19], v201 offset:22528
v_mfma_f32_16x16x32_bf16 v[56:59], a[44:47], a[172:175], v[56:59]
ds_read_b128 a[20:23], v201 offset:23552
v_mfma_f32_16x16x32_bf16 v[60:63], a[48:51], a[168:171], v[60:63]
ds_read_b128 a[24:27], v201 offset:24576
v_mfma_f32_16x16x32_bf16 v[64:67], a[48:51], a[172:175], v[64:67]
ds_read_b128 a[28:31], v201 offset:25600
v_mfma_f32_16x16x32_bf16 v[68:71], a[52:55], a[168:171], v[68:71]
ds_read_b128 a[32:35], v201 offset:26624
v_mfma_f32_16x16x32_bf16 v[72:75], a[52:55], a[172:175], v[72:75]
s_cmp_eq_u32 s25, 7
s_cselect_b32 s98, 4096, 0
s_add_u32 s52, s52, s98
v_mfma_f32_16x16x32_bf16 v[76:79], a[56:59], a[168:171], v[76:79]
s_add_u32 s52, s52, 4096
v_exp_f32 v194, v194
v_mfma_f32_16x16x32_bf16 v[80:83], a[56:59], a[172:175], v[80:83]
v_exp_f32 v195, v195
v_mfma_f32_16x16x32_bf16 v[84:87], a[60:63], a[168:171], v[84:87]
buffer_load_dwordx4 a[80:83], v1, s[4:7], s52 offen offset:0 sc1
v_fma_f32 v192, v192, v254, v254
v_mfma_f32_16x16x32_bf16 v[88:91], a[60:63], a[172:175], v[88:91]
v_fma_f32 v193, v193, v254, v254
v_fma_f32 v194, v194, v254, v254
v_mfma_f32_16x16x32_bf16 v[92:95], a[64:67], a[168:171], v[92:95]
buffer_load_dwordx4 a[84:87], v9, s[4:7], s52 offen offset:0 sc1
v_mfma_f32_16x16x32_bf16 v[96:99], a[64:67], a[172:175], v[96:99]
v_fma_f32 v195, v195, v254, v254
v_mfma_f32_16x16x32_bf16 v[100:103], a[68:71], a[168:171], v[100:103]
v_mfma_f32_16x16x32_bf16 v[104:107], a[68:71], a[172:175], v[104:107]
s_waitcnt lgkmcnt(0)
v_mfma_f32_16x16x32_bf16 v[36:39], a[0:3], a[176:179], v[36:39]
ds_read_b128 a[36:39], v201 offset:27648
buffer_load_dwordx4 a[88:91], v1, s[4:7], s52 offen offset:1024 sc1
v_mfma_f32_16x16x32_bf16 v[40:43], a[0:3], a[180:183], v[40:43]
ds_read_b128 a[40:43], v201 offset:28672
v_mfma_f32_16x16x32_bf16 v[44:47], a[4:7], a[176:179], v[44:47]
ds_read_b128 a[44:47], v201 offset:29696
v_mfma_f32_16x16x32_bf16 v[48:51], a[4:7], a[180:183], v[48:51]
ds_read_b128 a[48:51], v201 offset:30720
v_mfma_f32_16x16x32_bf16 v[52:55], a[8:11], a[176:179], v[52:55]
ds_read_b128 a[52:55], v201 offset:31744
buffer_load_dwordx4 a[92:95], v9, s[4:7], s52 offen offset:1024 sc1
v_mfma_f32_16x16x32_bf16 v[56:59], a[8:11], a[180:183], v[56:59]
ds_read_b128 a[56:59], v201 offset:32768
v_mfma_f32_16x16x32_bf16 v[60:63], a[12:15], a[176:179], v[60:63]
ds_read_b128 a[60:63], v201 offset:33792
v_mfma_f32_16x16x32_bf16 v[64:67], a[12:15], a[180:183], v[64:67]
ds_read_b128 a[64:67], v201 offset:34816
v_mfma_f32_16x16x32_bf16 v[68:71], a[16:19], a[176:179], v[68:71]
ds_read_b128 a[68:71], v201 offset:35840
buffer_load_dwordx4 a[96:99], v1, s[4:7], s52 offen offset:2048 sc1
v_mfma_f32_16x16x32_bf16 v[72:75], a[16:19], a[180:183], v[72:75]
v_rcp_f32 v192, v192
v_mfma_f32_16x16x32_bf16 v[76:79], a[20:23], a[176:179], v[76:79]
v_rcp_f32 v193, v193
v_mfma_f32_16x16x32_bf16 v[80:83], a[20:23], a[180:183], v[80:83]
v_rcp_f32 v194, v194
v_mfma_f32_16x16x32_bf16 v[84:87], a[24:27], a[176:179], v[84:87]
buffer_load_dwordx4 a[100:103], v9, s[4:7], s52 offen offset:2048 sc1
v_mfma_f32_16x16x32_bf16 v[88:91], a[24:27], a[180:183], v[88:91]
v_mfma_f32_16x16x32_bf16 v[92:95], a[28:31], a[176:179], v[92:95]
v_rcp_f32 v195, v195
v_mfma_f32_16x16x32_bf16 v[96:99], a[28:31], a[180:183], v[96:99]
v_mfma_f32_16x16x32_bf16 v[100:103], a[32:35], a[176:179], v[100:103]
v_mfma_f32_16x16x32_bf16 v[104:107], a[32:35], a[180:183], v[104:107]
s_waitcnt vmcnt(23) lgkmcnt(0)
s_barrier
v_mfma_f32_16x16x32_bf16 v[36:39], a[36:39], a[184:187], v[36:39]
ds_read_b128 a[0:3], v202 offset:0
buffer_load_dwordx4 a[104:107], v1, s[4:7], s52 offen offset:3072 sc1
v_mfma_f32_16x16x32_bf16 v[40:43], a[36:39], a[188:191], v[40:43]
ds_read_b128 a[4:7], v202 offset:1024
buffer_load_dwordx4 a[108:111], v9, s[4:7], s52 offen offset:3072 sc1
v_mfma_f32_16x16x32_bf16 v[44:47], a[40:43], a[184:187], v[44:47]
ds_read_b128 a[8:11], v202 offset:2048
v_mul_f32 v148, v148, v192
v_mfma_f32_16x16x32_bf16 v[48:51], a[40:43], a[188:191], v[48:51]
ds_read_b128 a[12:15], v202 offset:3072
v_mul_f32 v149, v149, v193
v_mfma_f32_16x16x32_bf16 v[52:55], a[44:47], a[184:187], v[52:55]
ds_read_b128 a[16:19], v202 offset:4096
v_mfma_f32_16x16x32_bf16 v[56:59], a[44:47], a[188:191], v[56:59]
ds_read_b128 a[20:23], v202 offset:5120
v_mul_f32 v150, v150, v194
v_mfma_f32_16x16x32_bf16 v[60:63], a[48:51], a[184:187], v[60:63]
ds_read_b128 a[24:27], v202 offset:6144
v_mfma_f32_16x16x32_bf16 v[64:67], a[48:51], a[188:191], v[64:67]
ds_read_b128 a[28:31], v202 offset:7168
v_mul_f32 v151, v151, v195
v_mfma_f32_16x16x32_bf16 v[68:71], a[52:55], a[184:187], v[68:71]
ds_read_b128 a[32:35], v202 offset:8192
v_mfma_f32_16x16x32_bf16 v[72:75], a[52:55], a[188:191], v[72:75]
s_cmp_eq_u32 s25, 7
s_cselect_b32 s99, 36864, 0
s_add_u32 s60, s60, s99
v_mfma_f32_16x16x32_bf16 v[76:79], a[56:59], a[184:187], v[76:79]
s_add_u32 s61, s61, s99
s_add_u32 m0, s62, 90112
v_mul_f32 v196, v152, v152
v_mfma_f32_16x16x32_bf16 v[80:83], a[56:59], a[188:191], v[80:83]
s_add_u32 s60, s60, 16384
v_mfma_f32_16x16x32_bf16 v[84:87], a[60:63], a[184:187], v[84:87]
v_mul_f32 v197, v153, v153
v_mfma_f32_16x16x32_bf16 v[88:91], a[60:63], a[188:191], v[88:91]
buffer_load_dwordx4 v1, s[8:11], s60 offen offset:0 sc1 lds
v_mfma_f32_16x16x32_bf16 v[92:95], a[64:67], a[184:187], v[92:95]
v_mul_f32 v198, v154, v154
v_mfma_f32_16x16x32_bf16 v[96:99], a[64:67], a[188:191], v[96:99]
buffer_load_dwordx4 v1, s[8:11], s60 offen offset:1024 sc1 lds
v_mfma_f32_16x16x32_bf16 v[100:103], a[68:71], a[184:187], v[100:103]
v_mfma_f32_16x16x32_bf16 v[104:107], a[68:71], a[188:191], v[104:107]
v_mul_f32 v199, v155, v155
s_waitcnt lgkmcnt(0)
v_mfma_f32_16x16x32_bf16 v[36:39], a[0:3], a[192:195], v[36:39]
ds_read_b128 a[36:39], v202 offset:9216
buffer_load_dwordx4 v1, s[8:11], s60 offen offset:2048 sc1 lds
v_mfma_f32_16x16x32_bf16 v[40:43], a[0:3], a[196:199], v[40:43]
ds_read_b128 a[40:43], v202 offset:10240
v_fma_f32 v196, v196, v253, v251
v_mfma_f32_16x16x32_bf16 v[44:47], a[4:7], a[192:195], v[44:47]
ds_read_b128 a[44:47], v202 offset:11264
buffer_load_dwordx4 v1, s[8:11], s60 offen offset:3072 sc1 lds
v_mfma_f32_16x16x32_bf16 v[48:51], a[4:7], a[196:199], v[48:51]
ds_read_b128 a[48:51], v202 offset:12288
v_mfma_f32_16x16x32_bf16 v[52:55], a[8:11], a[192:195], v[52:55]
ds_read_b128 a[52:55], v202 offset:13312
s_add_u32 m0, s63, 106496
v_mfma_f32_16x16x32_bf16 v[56:59], a[8:11], a[196:199], v[56:59]
ds_read_b128 a[56:59], v202 offset:14336
v_fma_f32 v197, v197, v253, v251
v_mfma_f32_16x16x32_bf16 v[60:63], a[12:15], a[192:195], v[60:63]
ds_read_b128 a[60:63], v202 offset:15360
s_add_u32 s61, s61, 36864
v_mfma_f32_16x16x32_bf16 v[64:67], a[12:15], a[196:199], v[64:67]
ds_read_b128 a[64:67], v202 offset:16384
v_fma_f32 v198, v198, v253, v251
v_mfma_f32_16x16x32_bf16 v[68:71], a[16:19], a[192:195], v[68:71]
ds_read_b128 a[68:71], v202 offset:17408
buffer_load_dwordx4 v1, s[8:11], s61 offen offset:0 sc1 lds
v_mfma_f32_16x16x32_bf16 v[72:75], a[16:19], a[196:199], v[72:75]
s_add_u32 m0, s62, 110592
v_fma_f32 v199, v199, v253, v251
v_mfma_f32_16x16x32_bf16 v[76:79], a[20:23], a[192:195], v[76:79]
s_add_u32 s60, s60, 20480
v_mfma_f32_16x16x32_bf16 v[80:83], a[20:23], a[196:199], v[80:83]
v_mul_f32 v196, v196, v152
v_mfma_f32_16x16x32_bf16 v[84:87], a[24:27], a[192:195], v[84:87]
v_mfma_f32_16x16x32_bf16 v[88:91], a[24:27], a[196:199], v[88:91]
v_mul_f32 v197, v197, v153
v_mfma_f32_16x16x32_bf16 v[92:95], a[28:31], a[192:195], v[92:95]
buffer_load_dwordx4 v1, s[8:11], s60 offen offset:0 sc1 lds
v_mfma_f32_16x16x32_bf16 v[96:99], a[28:31], a[196:199], v[96:99]
v_mul_f32 v198, v198, v154
v_mfma_f32_16x16x32_bf16 v[100:103], a[32:35], a[192:195], v[100:103]
v_mfma_f32_16x16x32_bf16 v[104:107], a[32:35], a[196:199], v[104:107]
s_waitcnt lgkmcnt(0)
v_mfma_f32_16x16x32_bf16 v[36:39], a[36:39], a[200:203], v[36:39]
ds_read_b128 a[0:3], v202 offset:18432
buffer_load_dwordx4 v1, s[8:11], s60 offen offset:1024 sc1 lds
v_mfma_f32_16x16x32_bf16 v[40:43], a[36:39], a[204:207], v[40:43]
ds_read_b128 a[4:7], v202 offset:19456
v_mul_f32 v199, v199, v155
v_mfma_f32_16x16x32_bf16 v[44:47], a[40:43], a[200:203], v[44:47]
ds_read_b128 a[8:11], v202 offset:20480
buffer_load_dwordx4 v1, s[8:11], s60 offen offset:2048 sc1 lds
v_mfma_f32_16x16x32_bf16 v[48:51], a[40:43], a[204:207], v[48:51]
ds_read_b128 a[12:15], v202 offset:21504
v_mfma_f32_16x16x32_bf16 v[52:55], a[44:47], a[200:203], v[52:55]
ds_read_b128 a[16:19], v202 offset:22528
buffer_load_dwordx4 v1, s[8:11], s60 offen offset:3072 sc1 lds
v_mfma_f32_16x16x32_bf16 v[56:59], a[44:47], a[204:207], v[56:59]
ds_read_b128 a[20:23], v202 offset:23552
v_mfma_f32_16x16x32_bf16 v[60:63], a[48:51], a[200:203], v[60:63]
ds_read_b128 a[24:27], v202 offset:24576
v_mfma_f32_16x16x32_bf16 v[64:67], a[48:51], a[204:207], v[64:67]
ds_read_b128 a[28:31], v202 offset:25600
v_mfma_f32_16x16x32_bf16 v[68:71], a[52:55], a[200:203], v[68:71]
ds_read_b128 a[32:35], v202 offset:26624
v_mfma_f32_16x16x32_bf16 v[72:75], a[52:55], a[204:207], v[72:75]
s_cmp_eq_u32 s25, 8
s_cselect_b32 s98, 4096, 0
v_mfma_f32_16x16x32_bf16 v[76:79], a[56:59], a[200:203], v[76:79]
s_add_u32 s52, s52, s98
v_exp_f32 v196, v196
v_mfma_f32_16x16x32_bf16 v[80:83], a[56:59], a[204:207], v[80:83]
s_add_u32 s52, s52, 4096
v_exp_f32 v197, v197
v_mfma_f32_16x16x32_bf16 v[84:87], a[60:63], a[200:203], v[84:87]
v_exp_f32 v198, v198
v_mfma_f32_16x16x32_bf16 v[88:91], a[60:63], a[204:207], v[88:91]
v_mfma_f32_16x16x32_bf16 v[92:95], a[64:67], a[200:203], v[92:95]
buffer_load_dwordx4 a[112:115], v1, s[4:7], s52 offen offset:0 sc1
v_mfma_f32_16x16x32_bf16 v[96:99], a[64:67], a[204:207], v[96:99]
v_mfma_f32_16x16x32_bf16 v[100:103], a[68:71], a[200:203], v[100:103]
v_exp_f32 v199, v199
v_mfma_f32_16x16x32_bf16 v[104:107], a[68:71], a[204:207], v[104:107]
s_waitcnt lgkmcnt(0)
v_mfma_f32_16x16x32_bf16 v[36:39], a[0:3], a[208:211], v[36:39]
ds_read_b128 a[36:39], v202 offset:27648
buffer_load_dwordx4 a[116:119], v9, s[4:7], s52 offen offset:0 sc1
v_mfma_f32_16x16x32_bf16 v[40:43], a[0:3], a[212:215], v[40:43]
ds_read_b128 a[40:43], v202 offset:28672
v_mfma_f32_16x16x32_bf16 v[44:47], a[4:7], a[208:211], v[44:47]
ds_read_b128 a[44:47], v202 offset:29696
v_mfma_f32_16x16x32_bf16 v[48:51], a[4:7], a[212:215], v[48:51]
ds_read_b128 a[48:51], v202 offset:30720
v_fma_f32 v196, v196, v255, v255
v_mfma_f32_16x16x32_bf16 v[52:55], a[8:11], a[208:211], v[52:55]
ds_read_b128 a[52:55], v202 offset:31744
buffer_load_dwordx4 a[120:123], v1, s[4:7], s52 offen offset:1024 sc1
v_mfma_f32_16x16x32_bf16 v[56:59], a[8:11], a[212:215], v[56:59]
ds_read_b128 a[56:59], v202 offset:32768
v_fma_f32 v197, v197, v255, v255
v_mfma_f32_16x16x32_bf16 v[60:63], a[12:15], a[208:211], v[60:63]
ds_read_b128 a[60:63], v202 offset:33792
v_mfma_f32_16x16x32_bf16 v[64:67], a[12:15], a[212:215], v[64:67]
ds_read_b128 a[64:67], v202 offset:34816
v_mfma_f32_16x16x32_bf16 v[68:71], a[16:19], a[208:211], v[68:71]
ds_read_b128 a[68:71], v202 offset:35840
buffer_load_dwordx4 a[124:127], v9, s[4:7], s52 offen offset:1024 sc1
v_mfma_f32_16x16x32_bf16 v[72:75], a[16:19], a[212:215], v[72:75]
v_fma_f32 v198, v198, v255, v255
v_mfma_f32_16x16x32_bf16 v[76:79], a[20:23], a[208:211], v[76:79]
v_fma_f32 v199, v199, v255, v255
v_mfma_f32_16x16x32_bf16 v[80:83], a[20:23], a[212:215], v[80:83]
v_mfma_f32_16x16x32_bf16 v[84:87], a[24:27], a[208:211], v[84:87]
buffer_load_dwordx4 a[128:131], v1, s[4:7], s52 offen offset:2048 sc1
v_mfma_f32_16x16x32_bf16 v[88:91], a[24:27], a[212:215], v[88:91]
v_rcp_f32 v196, v196
v_mfma_f32_16x16x32_bf16 v[92:95], a[28:31], a[208:211], v[92:95]
v_mfma_f32_16x16x32_bf16 v[96:99], a[28:31], a[212:215], v[96:99]
v_mfma_f32_16x16x32_bf16 v[100:103], a[32:35], a[208:211], v[100:103]
v_mfma_f32_16x16x32_bf16 v[104:107], a[32:35], a[212:215], v[104:107]
s_waitcnt vmcnt(22) lgkmcnt(0)
s_barrier
v_mfma_f32_16x16x32_bf16 v[36:39], a[36:39], a[216:219], v[36:39]
ds_read_b128 a[0:3], v200 offset:0
buffer_load_dwordx4 a[132:135], v9, s[4:7], s52 offen offset:2048 sc1
v_mfma_f32_16x16x32_bf16 v[40:43], a[36:39], a[220:223], v[40:43]
ds_read_b128 a[4:7], v200 offset:1024
buffer_load_dwordx4 a[136:139], v1, s[4:7], s52 offen offset:3072 sc1
v_mfma_f32_16x16x32_bf16 v[44:47], a[40:43], a[216:219], v[44:47]
ds_read_b128 a[8:11], v200 offset:2048
v_mfma_f32_16x16x32_bf16 v[48:51], a[40:43], a[220:223], v[48:51]
ds_read_b128 a[12:15], v200 offset:3072
buffer_load_dwordx4 a[140:143], v9, s[4:7], s52 offen offset:3072 sc1
v_mfma_f32_16x16x32_bf16 v[52:55], a[44:47], a[216:219], v[52:55]
ds_read_b128 a[16:19], v200 offset:4096
v_mfma_f32_16x16x32_bf16 v[56:59], a[44:47], a[220:223], v[56:59]
ds_read_b128 a[20:23], v200 offset:5120
v_mfma_f32_16x16x32_bf16 v[60:63], a[48:51], a[216:219], v[60:63]
ds_read_b128 a[24:27], v200 offset:6144
v_mfma_f32_16x16x32_bf16 v[64:67], a[48:51], a[220:223], v[64:67]
ds_read_b128 a[28:31], v200 offset:7168
v_mfma_f32_16x16x32_bf16 v[68:71], a[52:55], a[216:219], v[68:71]
ds_read_b128 a[32:35], v200 offset:8192
v_mfma_f32_16x16x32_bf16 v[72:75], a[52:55], a[220:223], v[72:75]
s_cmp_eq_u32 s25, 8
s_cselect_b32 s99, 36864, 0
s_add_u32 s60, s60, s99
v_mfma_f32_16x16x32_bf16 v[76:79], a[56:59], a[216:219], v[76:79]
s_add_u32 s61, s61, s99
v_rcp_f32 v197, v197
v_mfma_f32_16x16x32_bf16 v[80:83], a[56:59], a[220:223], v[80:83]
s_add_u32 m0, s62, 126976
v_rcp_f32 v198, v198
v_mfma_f32_16x16x32_bf16 v[84:87], a[60:63], a[216:219], v[84:87]
s_add_u32 s60, s60, 16384
v_rcp_f32 v199, v199
v_mfma_f32_16x16x32_bf16 v[88:91], a[60:63], a[220:223], v[88:91]
v_mul_f32 v152, v152, v196
v_mfma_f32_16x16x32_bf16 v[92:95], a[64:67], a[216:219], v[92:95]
v_mfma_f32_16x16x32_bf16 v[96:99], a[64:67], a[220:223], v[96:99]
buffer_load_dwordx4 v1, s[8:11], s60 offen offset:0 sc1 lds
v_mfma_f32_16x16x32_bf16 v[100:103], a[68:71], a[216:219], v[100:103]
v_mul_f32 v153, v153, v197
v_mfma_f32_16x16x32_bf16 v[104:107], a[68:71], a[220:223], v[104:107]
s_waitcnt lgkmcnt(0)
v_mfma_f32_16x16x32_bf16 v[36:39], a[0:3], a[224:227], v[36:39]
ds_read_b128 a[36:39], v200 offset:9216
buffer_load_dwordx4 v1, s[8:11], s60 offen offset:1024 sc1 lds
v_mfma_f32_16x16x32_bf16 v[40:43], a[0:3], a[228:231], v[40:43]
ds_read_b128 a[40:43], v200 offset:10240
v_mul_f32 v154, v154, v198
v_mfma_f32_16x16x32_bf16 v[44:47], a[4:7], a[224:227], v[44:47]
ds_read_b128 a[44:47], v200 offset:11264
buffer_load_dwordx4 v1, s[8:11], s60 offen offset:2048 sc1 lds
v_mfma_f32_16x16x32_bf16 v[48:51], a[4:7], a[228:231], v[48:51]
ds_read_b128 a[48:51], v200 offset:12288
v_mul_f32 v155, v155, v199
v_mfma_f32_16x16x32_bf16 v[52:55], a[8:11], a[224:227], v[52:55]
ds_read_b128 a[52:55], v200 offset:13312
v_mfma_f32_16x16x32_bf16 v[56:59], a[8:11], a[228:231], v[56:59]
ds_read_b128 a[56:59], v200 offset:14336
buffer_load_dwordx4 v1, s[8:11], s60 offen offset:3072 sc1 lds
v_mfma_f32_16x16x32_bf16 v[60:63], a[12:15], a[224:227], v[60:63]
ds_read_b128 a[60:63], v200 offset:15360
v_mul_f32 v192, v156, v156
v_mfma_f32_16x16x32_bf16 v[64:67], a[12:15], a[228:231], v[64:67]
ds_read_b128 a[64:67], v200 offset:16384
v_mul_f32 v193, v157, v157
v_mfma_f32_16x16x32_bf16 v[68:71], a[16:19], a[224:227], v[68:71]
ds_read_b128 a[68:71], v200 offset:17408
s_add_u32 m0, s63, 143360
v_mfma_f32_16x16x32_bf16 v[72:75], a[16:19], a[228:231], v[72:75]
s_add_u32 s61, s61, 36864
v_mul_f32 v194, v158, v158
v_mfma_f32_16x16x32_bf16 v[76:79], a[20:23], a[224:227], v[76:79]
v_mfma_f32_16x16x32_bf16 v[80:83], a[20:23], a[228:231], v[80:83]
v_mfma_f32_16x16x32_bf16 v[84:87], a[24:27], a[224:227], v[84:87]
v_mul_f32 v195, v159, v159
v_mfma_f32_16x16x32_bf16 v[88:91], a[24:27], a[228:231], v[88:91]
v_mfma_f32_16x16x32_bf16 v[92:95], a[28:31], a[224:227], v[92:95]
buffer_load_dwordx4 v1, s[8:11], s61 offen offset:0 sc1 lds
v_fma_f32 v192, v192, v252, v250
v_mfma_f32_16x16x32_bf16 v[96:99], a[28:31], a[228:231], v[96:99]
v_mfma_f32_16x16x32_bf16 v[100:103], a[32:35], a[224:227], v[100:103]
v_fma_f32 v193, v193, v252, v250
v_mfma_f32_16x16x32_bf16 v[104:107], a[32:35], a[228:231], v[104:107]
s_waitcnt lgkmcnt(0)
v_mfma_f32_16x16x32_bf16 v[36:39], a[36:39], a[232:235], v[36:39]
ds_read_b128 a[0:3], v200 offset:18432
s_add_u32 m0, s62, 147456
v_mfma_f32_16x16x32_bf16 v[40:43], a[36:39], a[236:239], v[40:43]
ds_read_b128 a[4:7], v200 offset:19456
v_fma_f32 v194, v194, v252, v250
v_mfma_f32_16x16x32_bf16 v[44:47], a[40:43], a[232:235], v[44:47]
ds_read_b128 a[8:11], v200 offset:20480
s_add_u32 s60, s60, 20480
v_mfma_f32_16x16x32_bf16 v[48:51], a[40:43], a[236:239], v[48:51]
ds_read_b128 a[12:15], v200 offset:21504
v_fma_f32 v195, v195, v252, v250
v_mfma_f32_16x16x32_bf16 v[52:55], a[44:47], a[232:235], v[52:55]
ds_read_b128 a[16:19], v200 offset:22528
v_mfma_f32_16x16x32_bf16 v[56:59], a[44:47], a[236:239], v[56:59]
ds_read_b128 a[20:23], v200 offset:23552
buffer_load_dwordx4 v1, s[8:11], s60 offen offset:0 sc1 lds
v_mfma_f32_16x16x32_bf16 v[60:63], a[48:51], a[232:235], v[60:63]
ds_read_b128 a[24:27], v200 offset:24576
v_mul_f32 v192, v192, v156
v_mfma_f32_16x16x32_bf16 v[64:67], a[48:51], a[236:239], v[64:67]
ds_read_b128 a[28:31], v200 offset:25600
v_mfma_f32_16x16x32_bf16 v[68:71], a[52:55], a[232:235], v[68:71]
ds_read_b128 a[32:35], v200 offset:26624
buffer_load_dwordx4 v1, s[8:11], s60 offen offset:1024 sc1 lds
v_mfma_f32_16x16x32_bf16 v[72:75], a[52:55], a[236:239], v[72:75]
v_mul_f32 v193, v193, v157
v_mfma_f32_16x16x32_bf16 v[76:79], a[56:59], a[232:235], v[76:79]
v_mul_f32 v194, v194, v158
v_mfma_f32_16x16x32_bf16 v[80:83], a[56:59], a[236:239], v[80:83]
buffer_load_dwordx4 v1, s[8:11], s60 offen offset:2048 sc1 lds
v_mfma_f32_16x16x32_bf16 v[84:87], a[60:63], a[232:235], v[84:87]
v_mfma_f32_16x16x32_bf16 v[88:91], a[60:63], a[236:239], v[88:91]
v_mul_f32 v195, v195, v159
v_mfma_f32_16x16x32_bf16 v[92:95], a[64:67], a[232:235], v[92:95]
buffer_load_dwordx4 v1, s[8:11], s60 offen offset:3072 sc1 lds
v_mfma_f32_16x16x32_bf16 v[96:99], a[64:67], a[236:239], v[96:99]
v_exp_f32 v192, v192
v_mfma_f32_16x16x32_bf16 v[100:103], a[68:71], a[232:235], v[100:103]
v_mfma_f32_16x16x32_bf16 v[104:107], a[68:71], a[236:239], v[104:107]
s_waitcnt lgkmcnt(0)
v_mfma_f32_16x16x32_bf16 v[36:39], a[0:3], a[240:243], v[36:39]
ds_read_b128 a[36:39], v200 offset:27648
v_mfma_f32_16x16x32_bf16 v[40:43], a[0:3], a[244:247], v[40:43]
ds_read_b128 a[40:43], v200 offset:28672
v_mfma_f32_16x16x32_bf16 v[44:47], a[4:7], a[240:243], v[44:47]
ds_read_b128 a[44:47], v200 offset:29696
v_mfma_f32_16x16x32_bf16 v[48:51], a[4:7], a[244:247], v[48:51]
ds_read_b128 a[48:51], v200 offset:30720
v_mfma_f32_16x16x32_bf16 v[52:55], a[8:11], a[240:243], v[52:55]
ds_read_b128 a[52:55], v200 offset:31744
v_mfma_f32_16x16x32_bf16 v[56:59], a[8:11], a[244:247], v[56:59]
ds_read_b128 a[56:59], v200 offset:32768
v_mfma_f32_16x16x32_bf16 v[60:63], a[12:15], a[240:243], v[60:63]
ds_read_b128 a[60:63], v200 offset:33792
v_mfma_f32_16x16x32_bf16 v[64:67], a[12:15], a[244:247], v[64:67]
ds_read_b128 a[64:67], v200 offset:34816
v_mfma_f32_16x16x32_bf16 v[68:71], a[16:19], a[240:243], v[68:71]
ds_read_b128 a[68:71], v200 offset:35840
v_mfma_f32_16x16x32_bf16 v[72:75], a[16:19], a[244:247], v[72:75]
s_cmp_eq_u32 s25, 9
s_cselect_b32 s98, 4096, 0
s_add_u32 s52, s52, s98
v_mfma_f32_16x16x32_bf16 v[76:79], a[20:23], a[240:243], v[76:79]
s_add_u32 s52, s52, 4096
v_exp_f32 v193, v193
v_mfma_f32_16x16x32_bf16 v[80:83], a[20:23], a[244:247], v[80:83]
buffer_load_dwordx4 a[144:147], v1, s[4:7], s52 offen offset:0 sc1
v_mfma_f32_16x16x32_bf16 v[84:87], a[24:27], a[240:243], v[84:87]
buffer_load_dwordx4 a[148:151], v9, s[4:7], s52 offen offset:0 sc1
v_mfma_f32_16x16x32_bf16 v[88:91], a[24:27], a[244:247], v[88:91]
buffer_load_dwordx4 a[152:155], v1, s[4:7], s52 offen offset:1024 sc1
v_mfma_f32_16x16x32_bf16 v[92:95], a[28:31], a[240:243], v[92:95]
buffer_load_dwordx4 a[156:159], v9, s[4:7], s52 offen offset:1024 sc1
v_mfma_f32_16x16x32_bf16 v[96:99], a[28:31], a[244:247], v[96:99]
v_exp_f32 v194, v194
v_mfma_f32_16x16x32_bf16 v[100:103], a[32:35], a[240:243], v[100:103]
v_exp_f32 v195, v195
v_mfma_f32_16x16x32_bf16 v[104:107], a[32:35], a[244:247], v[104:107]
s_waitcnt vmcnt(21) lgkmcnt(0)
s_barrier
v_mfma_f32_16x16x32_bf16 v[36:39], a[36:39], a[248:251], v[36:39]
ds_read_b128 a[0:3], v201 offset:0
v_fma_f32 v192, v192, v254, v254
v_mfma_f32_16x16x32_bf16 v[40:43], a[36:39], a[252:255], v[40:43]
ds_read_b128 a[4:7], v201 offset:1024
v_fma_f32 v193, v193, v254, v254
v_mfma_f32_16x16x32_bf16 v[44:47], a[40:43], a[248:251], v[44:47]
ds_read_b128 a[8:11], v201 offset:2048
v_fma_f32 v194, v194, v254, v254
v_mfma_f32_16x16x32_bf16 v[48:51], a[40:43], a[252:255], v[48:51]
ds_read_b128 a[12:15], v201 offset:3072
v_mfma_f32_16x16x32_bf16 v[52:55], a[44:47], a[248:251], v[52:55]
ds_read_b128 a[16:19], v201 offset:4096
v_mfma_f32_16x16x32_bf16 v[56:59], a[44:47], a[252:255], v[56:59]
ds_read_b128 a[20:23], v201 offset:5120
v_fma_f32 v195, v195, v254, v254
v_mfma_f32_16x16x32_bf16 v[60:63], a[48:51], a[248:251], v[60:63]
ds_read_b128 a[24:27], v201 offset:6144
v_mfma_f32_16x16x32_bf16 v[64:67], a[48:51], a[252:255], v[64:67]
ds_read_b128 a[28:31], v201 offset:7168
v_mfma_f32_16x16x32_bf16 v[68:71], a[52:55], a[248:251], v[68:71]
ds_read_b128 a[32:35], v201 offset:8192
v_mfma_f32_16x16x32_bf16 v[72:75], a[52:55], a[252:255], v[72:75]
s_cmp_eq_u32 s25, 9
s_cselect_b32 s99, 36864, 0
s_add_u32 s60, s60, s99
v_mfma_f32_16x16x32_bf16 v[76:79], a[56:59], a[248:251], v[76:79]
s_add_u32 s61, s61, s99
s_add_u32 m0, s62, 53248
s_add_u32 s60, s60, 16384
v_mfma_f32_16x16x32_bf16 v[80:83], a[56:59], a[252:255], v[80:83]
buffer_load_dwordx4 v1, s[8:11], s60 offen offset:0 sc1 lds
v_mfma_f32_16x16x32_bf16 v[84:87], a[60:63], a[248:251], v[84:87]
buffer_load_dwordx4 v1, s[8:11], s60 offen offset:1024 sc1 lds
v_mfma_f32_16x16x32_bf16 v[88:91], a[60:63], a[252:255], v[88:91]
buffer_load_dwordx4 v1, s[8:11], s60 offen offset:2048 sc1 lds
v_mfma_f32_16x16x32_bf16 v[92:95], a[64:67], a[248:251], v[92:95]
v_rcp_f32 v192, v192
v_mfma_f32_16x16x32_bf16 v[96:99], a[64:67], a[252:255], v[96:99]
buffer_load_dwordx4 v1, s[8:11], s60 offen offset:3072 sc1 lds
v_mfma_f32_16x16x32_bf16 v[100:103], a[68:71], a[248:251], v[100:103]
v_rcp_f32 v193, v193
v_mfma_f32_16x16x32_bf16 v[104:107], a[68:71], a[252:255], v[104:107]
s_waitcnt lgkmcnt(0)
v_mfma_f32_16x16x32_bf16 v[36:39], a[0:3], a[80:83], v[36:39]
ds_read_b128 a[36:39], v201 offset:9216
s_add_u32 m0, s63, 69632
v_mfma_f32_16x16x32_bf16 v[40:43], a[0:3], a[84:87], v[40:43]
ds_read_b128 a[40:43], v201 offset:10240
v_mfma_f32_16x16x32_bf16 v[44:47], a[4:7], a[80:83], v[44:47]
ds_read_b128 a[44:47], v201 offset:11264
s_add_u32 s61, s61, 36864
v_mfma_f32_16x16x32_bf16 v[48:51], a[4:7], a[84:87], v[48:51]
ds_read_b128 a[48:51], v201 offset:12288
v_mfma_f32_16x16x32_bf16 v[52:55], a[8:11], a[80:83], v[52:55]
ds_read_b128 a[52:55], v201 offset:13312
buffer_load_dwordx4 v1, s[8:11], s61 offen offset:0 sc1 lds
v_mfma_f32_16x16x32_bf16 v[56:59], a[8:11], a[84:87], v[56:59]
ds_read_b128 a[56:59], v201 offset:14336
v_mfma_f32_16x16x32_bf16 v[60:63], a[12:15], a[80:83], v[60:63]
ds_read_b128 a[60:63], v201 offset:15360
s_add_u32 m0, s62, 73728
v_mfma_f32_16x16x32_bf16 v[64:67], a[12:15], a[84:87], v[64:67]
ds_read_b128 a[64:67], v201 offset:16384
v_mfma_f32_16x16x32_bf16 v[68:71], a[16:19], a[80:83], v[68:71]
ds_read_b128 a[68:71], v201 offset:17408
s_add_u32 s60, s60, 20480
v_mfma_f32_16x16x32_bf16 v[72:75], a[16:19], a[84:87], v[72:75]
v_rcp_f32 v194, v194
v_mfma_f32_16x16x32_bf16 v[76:79], a[20:23], a[80:83], v[76:79]
buffer_load_dwordx4 v1, s[8:11], s60 offen offset:0 sc1 lds
v_mfma_f32_16x16x32_bf16 v[80:83], a[20:23], a[84:87], v[80:83]
v_rcp_f32 v195, v195
v_mfma_f32_16x16x32_bf16 v[84:87], a[24:27], a[80:83], v[84:87]
buffer_load_dwordx4 v1, s[8:11], s60 offen offset:1024 sc1 lds
v_mul_f32 v156, v156, v192
v_mfma_f32_16x16x32_bf16 v[88:91], a[24:27], a[84:87], v[88:91]
v_mul_f32 v157, v157, v193
v_mul_f32 v158, v158, v194
v_mfma_f32_16x16x32_bf16 v[92:95], a[28:31], a[80:83], v[92:95]
buffer_load_dwordx4 v1, s[8:11], s60 offen offset:2048 sc1 lds
v_mfma_f32_16x16x32_bf16 v[96:99], a[28:31], a[84:87], v[96:99]
v_mul_f32 v159, v159, v195
v_mfma_f32_16x16x32_bf16 v[100:103], a[32:35], a[80:83], v[100:103]
v_mfma_f32_16x16x32_bf16 v[104:107], a[32:35], a[84:87], v[104:107]
v_mul_f32 v196, v160, v160
s_waitcnt lgkmcnt(0)
v_mfma_f32_16x16x32_bf16 v[36:39], a[36:39], a[88:91], v[36:39]
ds_read_b128 a[0:3], v201 offset:18432
buffer_load_dwordx4 v1, s[8:11], s60 offen offset:3072 sc1 lds
v_mfma_f32_16x16x32_bf16 v[40:43], a[36:39], a[92:95], v[40:43]
ds_read_b128 a[4:7], v201 offset:19456
v_mfma_f32_16x16x32_bf16 v[44:47], a[40:43], a[88:91], v[44:47]
ds_read_b128 a[8:11], v201 offset:20480
v_mul_f32 v197, v161, v161
v_mfma_f32_16x16x32_bf16 v[48:51], a[40:43], a[92:95], v[48:51]
ds_read_b128 a[12:15], v201 offset:21504
v_mfma_f32_16x16x32_bf16 v[52:55], a[44:47], a[88:91], v[52:55]
ds_read_b128 a[16:19], v201 offset:22528
buffer_load_dwordx4 a[160:163], v1, s[4:7], s52 offen offset:2048 sc1
v_mfma_f32_16x16x32_bf16 v[56:59], a[44:47], a[92:95], v[56:59]
ds_read_b128 a[20:23], v201 offset:23552
v_mul_f32 v198, v162, v162
v_mfma_f32_16x16x32_bf16 v[60:63], a[48:51], a[88:91], v[60:63]
ds_read_b128 a[24:27], v201 offset:24576
v_mfma_f32_16x16x32_bf16 v[64:67], a[48:51], a[92:95], v[64:67]
ds_read_b128 a[28:31], v201 offset:25600
v_mul_f32 v199, v163, v163
v_mfma_f32_16x16x32_bf16 v[68:71], a[52:55], a[88:91], v[68:71]
ds_read_b128 a[32:35], v201 offset:26624
buffer_load_dwordx4 a[164:167], v9, s[4:7], s52 offen offset:2048 sc1
v_mfma_f32_16x16x32_bf16 v[72:75], a[52:55], a[92:95], v[72:75]
v_fma_f32 v196, v196, v253, v251
v_mfma_f32_16x16x32_bf16 v[76:79], a[56:59], a[88:91], v[76:79]
v_mfma_f32_16x16x32_bf16 v[80:83], a[56:59], a[92:95], v[80:83]
v_fma_f32 v197, v197, v253, v251
v_mfma_f32_16x16x32_bf16 v[84:87], a[60:63], a[88:91], v[84:87]
buffer_load_dwordx4 a[168:171], v1, s[4:7], s52 offen offset:3072 sc1
v_mfma_f32_16x16x32_bf16 v[88:91], a[60:63], a[92:95], v[88:91]
v_mfma_f32_16x16x32_bf16 v[92:95], a[64:67], a[88:91], v[92:95]
v_fma_f32 v198, v198, v253, v251
v_mfma_f32_16x16x32_bf16 v[96:99], a[64:67], a[92:95], v[96:99]
v_mfma_f32_16x16x32_bf16 v[100:103], a[68:71], a[88:91], v[100:103]
v_fma_f32 v199, v199, v253, v251
v_mfma_f32_16x16x32_bf16 v[104:107], a[68:71], a[92:95], v[104:107]
s_waitcnt lgkmcnt(0)
v_mfma_f32_16x16x32_bf16 v[36:39], a[0:3], a[96:99], v[36:39]
ds_read_b128 a[36:39], v201 offset:27648
buffer_load_dwordx4 a[172:175], v9, s[4:7], s52 offen offset:3072 sc1
v_mfma_f32_16x16x32_bf16 v[40:43], a[0:3], a[100:103], v[40:43]
ds_read_b128 a[40:43], v201 offset:28672
v_mul_f32 v196, v196, v160
v_mfma_f32_16x16x32_bf16 v[44:47], a[4:7], a[96:99], v[44:47]
ds_read_b128 a[44:47], v201 offset:29696
v_mfma_f32_16x16x32_bf16 v[48:51], a[4:7], a[100:103], v[48:51]
ds_read_b128 a[48:51], v201 offset:30720
v_mul_f32 v197, v197, v161
v_mfma_f32_16x16x32_bf16 v[52:55], a[8:11], a[96:99], v[52:55]
ds_read_b128 a[52:55], v201 offset:31744
v_mfma_f32_16x16x32_bf16 v[56:59], a[8:11], a[100:103], v[56:59]
ds_read_b128 a[56:59], v201 offset:32768
v_mul_f32 v198, v198, v162
v_mfma_f32_16x16x32_bf16 v[60:63], a[12:15], a[96:99], v[60:63]
ds_read_b128 a[60:63], v201 offset:33792
v_mfma_f32_16x16x32_bf16 v[64:67], a[12:15], a[100:103], v[64:67]
ds_read_b128 a[64:67], v201 offset:34816
v_mul_f32 v199, v199, v163
v_mfma_f32_16x16x32_bf16 v[68:71], a[16:19], a[96:99], v[68:71]
ds_read_b128 a[68:71], v201 offset:35840
v_mfma_f32_16x16x32_bf16 v[72:75], a[16:19], a[100:103], v[72:75]
s_cmp_eq_u32 s25, 10
s_cselect_b32 s98, 4096, 0
s_add_u32 s52, s52, s98
v_mfma_f32_16x16x32_bf16 v[76:79], a[20:23], a[96:99], v[76:79]
s_add_u32 s52, s52, 4096
v_exp_f32 v196, v196
v_mfma_f32_16x16x32_bf16 v[80:83], a[20:23], a[100:103], v[80:83]
buffer_load_dwordx4 a[176:179], v1, s[4:7], s52 offen offset:0 sc1
v_mfma_f32_16x16x32_bf16 v[84:87], a[24:27], a[96:99], v[84:87]
buffer_load_dwordx4 a[180:183], v9, s[4:7], s52 offen offset:0 sc1
v_mfma_f32_16x16x32_bf16 v[88:91], a[24:27], a[100:103], v[88:91]
v_mfma_f32_16x16x32_bf16 v[92:95], a[28:31], a[96:99], v[92:95]
buffer_load_dwordx4 a[184:187], v1, s[4:7], s52 offen offset:1024 sc1
v_mfma_f32_16x16x32_bf16 v[96:99], a[28:31], a[100:103], v[96:99]
v_exp_f32 v197, v197
v_mfma_f32_16x16x32_bf16 v[100:103], a[32:35], a[96:99], v[100:103]
v_mfma_f32_16x16x32_bf16 v[104:107], a[32:35], a[100:103], v[104:107]
s_waitcnt vmcnt(20) lgkmcnt(0)
s_barrier
v_mfma_f32_16x16x32_bf16 v[36:39], a[36:39], a[104:107], v[36:39]
ds_read_b128 a[0:3], v202 offset:0
buffer_load_dwordx4 a[188:191], v9, s[4:7], s52 offen offset:1024 sc1
v_mfma_f32_16x16x32_bf16 v[40:43], a[36:39], a[108:111], v[40:43]
ds_read_b128 a[4:7], v202 offset:1024
s_bfe_u32 s97, s27, 0x20001
v_mfma_f32_16x16x32_bf16 v[44:47], a[40:43], a[104:107], v[44:47]
ds_read_b128 a[8:11], v202 offset:2048
s_lshl_b32 s97, s97, 2
v_mfma_f32_16x16x32_bf16 v[48:51], a[40:43], a[108:111], v[48:51]
ds_read_b128 a[12:15], v202 offset:3072
v_mfma_f32_16x16x32_bf16 v[52:55], a[44:47], a[104:107], v[52:55]
ds_read_b128 a[16:19], v202 offset:4096
s_add_u32 s97, s97, s24
v_mfma_f32_16x16x32_bf16 v[56:59], a[44:47], a[108:111], v[56:59]
ds_read_b128 a[20:23], v202 offset:5120
s_mul_i32 s97, s97, 6144
v_mfma_f32_16x16x32_bf16 v[60:63], a[48:51], a[104:107], v[60:63]
ds_read_b128 a[24:27], v202 offset:6144
v_mfma_f32_16x16x32_bf16 v[64:67], a[48:51], a[108:111], v[64:67]
ds_read_b128 a[28:31], v202 offset:7168
s_add_u32 s97, s97, s83
v_mfma_f32_16x16x32_bf16 v[68:71], a[52:55], a[104:107], v[68:71]
ds_read_b128 a[32:35], v202 offset:8192
s_add_u32 s97, s97, 67584
v_mfma_f32_16x16x32_bf16 v[72:75], a[52:55], a[108:111], v[72:75]
s_cmp_eq_u32 s25, 10
s_cselect_b32 s99, 36864, 0
s_add_u32 s60, s60, s99
v_mfma_f32_16x16x32_bf16 v[76:79], a[56:59], a[104:107], v[76:79]
s_add_u32 s61, s61, s99
s_add_u32 m0, s62, 90112
s_add_u32 s60, s60, 16384
v_mfma_f32_16x16x32_bf16 v[80:83], a[56:59], a[108:111], v[80:83]
buffer_load_dwordx4 v1, s[8:11], s60 offen offset:0 sc1 lds
v_lshlrev_b32 v8, 3, v1
v_mfma_f32_16x16x32_bf16 v[84:87], a[60:63], a[104:107], v[84:87]
v_cmp_gt_u32 vcc, 1024, v8
v_mfma_f32_16x16x32_bf16 v[88:91], a[60:63], a[108:111], v[88:91]
buffer_load_dwordx4 v1, s[8:11], s60 offen offset:1024 sc1 lds
v_mov_b32 v6, 1073741824
v_mfma_f32_16x16x32_bf16 v[92:95], a[64:67], a[104:107], v[92:95]
s_nop 0
v_exp_f32 v198, v198
v_mfma_f32_16x16x32_bf16 v[96:99], a[64:67], a[108:111], v[96:99]
buffer_load_dwordx4 v1, s[8:11], s60 offen offset:2048 sc1 lds
v_mfma_f32_16x16x32_bf16 v[100:103], a[68:71], a[104:107], v[100:103]
v_cndmask_b32 v8, v6, v8, vcc
v_mfma_f32_16x16x32_bf16 v[104:107], a[68:71], a[108:111], v[104:107]
s_waitcnt lgkmcnt(0)
v_mfma_f32_16x16x32_bf16 v[36:39], a[0:3], a[112:115], v[36:39]
ds_read_b128 a[36:39], v202 offset:9216
buffer_load_dwordx4 v1, s[8:11], s60 offen offset:3072 sc1 lds
v_mfma_f32_16x16x32_bf16 v[40:43], a[0:3], a[116:119], v[40:43]
ds_read_b128 a[40:43], v202 offset:10240
buffer_load_dwordx4 a[72:75], v1, s[4:7], s97 offen offset:0 sc1
v_mfma_f32_16x16x32_bf16 v[44:47], a[4:7], a[112:115], v[44:47]
ds_read_b128 a[44:47], v202 offset:11264
s_add_u32 m0, s63, 106496
v_mfma_f32_16x16x32_bf16 v[48:51], a[4:7], a[116:119], v[48:51]
ds_read_b128 a[48:51], v202 offset:12288
s_mov_b32 s37, L_c5-L_pc
v_mfma_f32_16x16x32_bf16 v[52:55], a[8:11], a[112:115], v[52:55]
ds_read_b128 a[52:55], v202 offset:13312
buffer_load_dword v15, v14, s[88:91], s37 offen
v_mfma_f32_16x16x32_bf16 v[56:59], a[8:11], a[116:119], v[56:59]
ds_read_b128 a[56:59], v202 offset:14336
s_add_u32 s61, s61, 36864
v_mfma_f32_16x16x32_bf16 v[60:63], a[12:15], a[112:115], v[60:63]
ds_read_b128 a[60:63], v202 offset:15360
buffer_load_dwordx4 v1, s[8:11], s61 offen offset:0 sc1 lds
v_mfma_f32_16x16x32_bf16 v[64:67], a[12:15], a[116:119], v[64:67]
ds_read_b128 a[64:67], v202 offset:16384
v_mfma_f32_16x16x32_bf16 v[68:71], a[16:19], a[112:115], v[68:71]
ds_read_b128 a[68:71], v202 offset:17408
s_add_u32 m0, s62, 110592
v_mfma_f32_16x16x32_bf16 v[72:75], a[16:19], a[116:119], v[72:75]
s_add_u32 s60, s60, 20480
v_exp_f32 v199, v199
v_mfma_f32_16x16x32_bf16 v[76:79], a[20:23], a[112:115], v[76:79]
v_fma_f32 v196, v196, v255, v255
v_fma_f32 v197, v197, v255, v255
v_mfma_f32_16x16x32_bf16 v[80:83], a[20:23], a[116:119], v[80:83]
v_fma_f32 v198, v198, v255, v255
v_fma_f32 v199, v199, v255, v255
v_mfma_f32_16x16x32_bf16 v[84:87], a[24:27], a[112:115], v[84:87]
buffer_load_dwordx4 v1, s[8:11], s60 offen offset:0 sc1 lds
v_mfma_f32_16x16x32_bf16 v[88:91], a[24:27], a[116:119], v[88:91]
v_rcp_f32 v196, v196
v_mfma_f32_16x16x32_bf16 v[92:95], a[28:31], a[112:115], v[92:95]
buffer_load_dwordx4 v1, s[8:11], s60 offen offset:1024 sc1 lds
v_mfma_f32_16x16x32_bf16 v[96:99], a[28:31], a[116:119], v[96:99]
v_rcp_f32 v197, v197
v_mfma_f32_16x16x32_bf16 v[100:103], a[32:35], a[112:115], v[100:103]
v_rcp_f32 v198, v198
v_mfma_f32_16x16x32_bf16 v[104:107], a[32:35], a[116:119], v[104:107]
s_waitcnt lgkmcnt(0)
v_mfma_f32_16x16x32_bf16 v[36:39], a[36:39], a[120:123], v[36:39]
ds_read_b128 a[0:3], v202 offset:18432
buffer_load_dwordx4 v1, s[8:11], s60 offen offset:2048 sc1 lds
v_mfma_f32_16x16x32_bf16 v[40:43], a[36:39], a[124:127], v[40:43]
ds_read_b128 a[4:7], v202 offset:19456
v_mfma_f32_16x16x32_bf16 v[44:47], a[40:43], a[120:123], v[44:47]
ds_read_b128 a[8:11], v202 offset:20480
v_mfma_f32_16x16x32_bf16 v[48:51], a[40:43], a[124:127], v[48:51]
ds_read_b128 a[12:15], v202 offset:21504
v_mfma_f32_16x16x32_bf16 v[52:55], a[44:47], a[120:123], v[52:55]
ds_read_b128 a[16:19], v202 offset:22528
buffer_load_dwordx4 v1, s[8:11], s60 offen offset:3072 sc1 lds
v_mfma_f32_16x16x32_bf16 v[56:59], a[44:47], a[124:127], v[56:59]
ds_read_b128 a[20:23], v202 offset:23552
v_mfma_f32_16x16x32_bf16 v[60:63], a[48:51], a[120:123], v[60:63]
ds_read_b128 a[24:27], v202 offset:24576
v_mfma_f32_16x16x32_bf16 v[64:67], a[48:51], a[124:127], v[64:67]
ds_read_b128 a[28:31], v202 offset:25600
v_mfma_f32_16x16x32_bf16 v[68:71], a[52:55], a[120:123], v[68:71]
ds_read_b128 a[32:35], v202 offset:26624
buffer_load_dwordx4 a[192:195], v1, s[4:7], s52 offen offset:2048 sc1
v_mfma_f32_16x16x32_bf16 v[72:75], a[52:55], a[124:127], v[72:75]
v_rcp_f32 v199, v199
v_mfma_f32_16x16x32_bf16 v[76:79], a[56:59], a[120:123], v[76:79]
v_mul_f32 v160, v160, v196
v_mul_f32 v161, v161, v197
v_mfma_f32_16x16x32_bf16 v[80:83], a[56:59], a[124:127], v[80:83]
v_mul_f32 v162, v162, v198
v_mul_f32 v163, v163, v199
v_mfma_f32_16x16x32_bf16 v[84:87], a[60:63], a[120:123], v[84:87]
buffer_load_dwordx4 a[196:199], v9, s[4:7], s52 offen offset:2048 sc1
v_mul_f32 v192, v164, v164
v_mfma_f32_16x16x32_bf16 v[88:91], a[60:63], a[124:127], v[88:91]
v_mfma_f32_16x16x32_bf16 v[92:95], a[64:67], a[120:123], v[92:95]
v_mfma_f32_16x16x32_bf16 v[96:99], a[64:67], a[124:127], v[96:99]
v_mul_f32 v193, v165, v165
v_mfma_f32_16x16x32_bf16 v[100:103], a[68:71], a[120:123], v[100:103]
v_mfma_f32_16x16x32_bf16 v[104:107], a[68:71], a[124:127], v[104:107]
v_mul_f32 v194, v166, v166
s_waitcnt lgkmcnt(0)
v_mfma_f32_16x16x32_bf16 v[36:39], a[0:3], a[128:131], v[36:39]
ds_read_b128 a[36:39], v202 offset:27648
buffer_load_dwordx4 a[200:203], v1, s[4:7], s52 offen offset:3072 sc1
v_mfma_f32_16x16x32_bf16 v[40:43], a[0:3], a[132:135], v[40:43]
ds_read_b128 a[40:43], v202 offset:28672
v_mul_f32 v195, v167, v167
v_mfma_f32_16x16x32_bf16 v[44:47], a[4:7], a[128:131], v[44:47]
ds_read_b128 a[44:47], v202 offset:29696
buffer_load_dwordx4 a[204:207], v9, s[4:7], s52 offen offset:3072 sc1
v_mfma_f32_16x16x32_bf16 v[48:51], a[4:7], a[132:135], v[48:51]
ds_read_b128 a[48:51], v202 offset:30720
v_mfma_f32_16x16x32_bf16 v[52:55], a[8:11], a[128:131], v[52:55]
ds_read_b128 a[52:55], v202 offset:31744
v_fma_f32 v192, v192, v252, v250
v_mfma_f32_16x16x32_bf16 v[56:59], a[8:11], a[132:135], v[56:59]
ds_read_b128 a[56:59], v202 offset:32768
v_mfma_f32_16x16x32_bf16 v[60:63], a[12:15], a[128:131], v[60:63]
ds_read_b128 a[60:63], v202 offset:33792
v_fma_f32 v193, v193, v252, v250
v_mfma_f32_16x16x32_bf16 v[64:67], a[12:15], a[132:135], v[64:67]
ds_read_b128 a[64:67], v202 offset:34816
v_mfma_f32_16x16x32_bf16 v[68:71], a[16:19], a[128:131], v[68:71]
ds_read_b128 a[68:71], v202 offset:35840
v_fma_f32 v194, v194, v252, v250
v_mfma_f32_16x16x32_bf16 v[72:75], a[16:19], a[132:135], v[72:75]
s_cmp_eq_u32 s25, 11
s_cselect_b32 s98, 4096, 0
s_add_u32 s52, s52, s98
v_mfma_f32_16x16x32_bf16 v[76:79], a[20:23], a[128:131], v[76:79]
buffer_load_dwordx4 a[72:75], v1, s[4:7], s97 offen offset:1024 sc1
s_add_u32 s52, s52, 4096
v_mfma_f32_16x16x32_bf16 v[80:83], a[20:23], a[132:135], v[80:83]
v_fma_f32 v195, v195, v252, v250
v_mfma_f32_16x16x32_bf16 v[84:87], a[24:27], a[128:131], v[84:87]
buffer_load_dwordx4 a[208:211], v1, s[4:7], s52 offen offset:0 sc1
v_mfma_f32_16x16x32_bf16 v[88:91], a[24:27], a[132:135], v[88:91]
v_mul_f32 v192, v192, v164
v_mfma_f32_16x16x32_bf16 v[92:95], a[28:31], a[128:131], v[92:95]
buffer_load_dwordx4 a[212:215], v9, s[4:7], s52 offen offset:0 sc1
v_mfma_f32_16x16x32_bf16 v[96:99], a[28:31], a[132:135], v[96:99]
v_mfma_f32_16x16x32_bf16 v[100:103], a[32:35], a[128:131], v[100:103]
v_mul_f32 v193, v193, v165
v_mfma_f32_16x16x32_bf16 v[104:107], a[32:35], a[132:135], v[104:107]
s_waitcnt vmcnt(26) lgkmcnt(0)
s_barrier
v_mfma_f32_16x16x32_bf16 v[36:39], a[36:39], a[136:139], v[36:39]
ds_read_b128 a[0:3], v200 offset:0
buffer_load_dwordx4 a[216:219], v1, s[4:7], s52 offen offset:1024 sc1
v_mfma_f32_16x16x32_bf16 v[40:43], a[36:39], a[140:143], v[40:43]
ds_read_b128 a[4:7], v200 offset:1024
buffer_load_dwordx4 a[220:223], v9, s[4:7], s52 offen offset:1024 sc1
v_mfma_f32_16x16x32_bf16 v[44:47], a[40:43], a[136:139], v[44:47]
ds_read_b128 a[8:11], v200 offset:2048
v_mul_f32 v194, v194, v166
v_mfma_f32_16x16x32_bf16 v[48:51], a[40:43], a[140:143], v[48:51]
ds_read_b128 a[12:15], v200 offset:3072
v_mul_f32 v195, v195, v167
v_mfma_f32_16x16x32_bf16 v[52:55], a[44:47], a[136:139], v[52:55]
ds_read_b128 a[16:19], v200 offset:4096
v_mfma_f32_16x16x32_bf16 v[56:59], a[44:47], a[140:143], v[56:59]
ds_read_b128 a[20:23], v200 offset:5120
v_mfma_f32_16x16x32_bf16 v[60:63], a[48:51], a[136:139], v[60:63]
ds_read_b128 a[24:27], v200 offset:6144
v_mfma_f32_16x16x32_bf16 v[64:67], a[48:51], a[140:143], v[64:67]
ds_read_b128 a[28:31], v200 offset:7168
v_mfma_f32_16x16x32_bf16 v[68:71], a[52:55], a[136:139], v[68:71]
ds_read_b128 a[32:35], v200 offset:8192
v_mfma_f32_16x16x32_bf16 v[72:75], a[52:55], a[140:143], v[72:75]
s_cmp_eq_u32 s25, 11
s_cselect_b32 s99, 36864, 0
s_add_u32 s60, s60, s99
v_mfma_f32_16x16x32_bf16 v[76:79], a[56:59], a[136:139], v[76:79]
s_add_u32 s61, s61, s99
s_add_u32 m0, s62, 126976
v_mfma_f32_16x16x32_bf16 v[80:83], a[56:59], a[140:143], v[80:83]
s_add_u32 s60, s60, 16384
v_exp_f32 v192, v192
v_mfma_f32_16x16x32_bf16 v[84:87], a[60:63], a[136:139], v[84:87]
v_exp_f32 v193, v193
v_mfma_f32_16x16x32_bf16 v[88:91], a[60:63], a[140:143], v[88:91]
buffer_load_dwordx4 v1, s[8:11], s60 offen offset:0 sc1 lds
v_mfma_f32_16x16x32_bf16 v[92:95], a[64:67], a[136:139], v[92:95]
v_exp_f32 v194, v194
v_mfma_f32_16x16x32_bf16 v[96:99], a[64:67], a[140:143], v[96:99]
buffer_load_dwordx4 v1, s[8:11], s60 offen offset:1024 sc1 lds
v_mfma_f32_16x16x32_bf16 v[100:103], a[68:71], a[136:139], v[100:103]
v_mfma_f32_16x16x32_bf16 v[104:107], a[68:71], a[140:143], v[104:107]
s_waitcnt lgkmcnt(0)
v_mfma_f32_16x16x32_bf16 v[36:39], a[0:3], a[144:147], v[36:39]
ds_read_b128 a[36:39], v200 offset:9216
buffer_load_dwordx4 v1, s[8:11], s60 offen offset:2048 sc1 lds
v_mfma_f32_16x16x32_bf16 v[40:43], a[0:3], a[148:151], v[40:43]
ds_read_b128 a[40:43], v200 offset:10240
v_mfma_f32_16x16x32_bf16 v[44:47], a[4:7], a[144:147], v[44:47]
ds_read_b128 a[44:47], v200 offset:11264
buffer_load_dwordx4 v1, s[8:11], s60 offen offset:3072 sc1 lds
v_mfma_f32_16x16x32_bf16 v[48:51], a[4:7], a[148:151], v[48:51]
ds_read_b128 a[48:51], v200 offset:12288
v_mfma_f32_16x16x32_bf16 v[52:55], a[8:11], a[144:147], v[52:55]
ds_read_b128 a[52:55], v200 offset:13312
s_add_u32 m0, s63, 143360
v_mfma_f32_16x16x32_bf16 v[56:59], a[8:11], a[148:151], v[56:59]
ds_read_b128 a[56:59], v200 offset:14336
v_mfma_f32_16x16x32_bf16 v[60:63], a[12:15], a[144:147], v[60:63]
ds_read_b128 a[60:63], v200 offset:15360
s_add_u32 s61, s61, 36864
v_mfma_f32_16x16x32_bf16 v[64:67], a[12:15], a[148:151], v[64:67]
ds_read_b128 a[64:67], v200 offset:16384
v_mfma_f32_16x16x32_bf16 v[68:71], a[16:19], a[144:147], v[68:71]
ds_read_b128 a[68:71], v200 offset:17408
buffer_load_dwordx4 v1, s[8:11], s61 offen offset:0 sc1 lds
v_mfma_f32_16x16x32_bf16 v[72:75], a[16:19], a[148:151], v[72:75]
s_add_u32 m0, s62, 147456
v_exp_f32 v195, v195
v_mfma_f32_16x16x32_bf16 v[76:79], a[20:23], a[144:147], v[76:79]
s_add_u32 s60, s60, 20480
v_fma_f32 v192, v192, v254, v254
v_fma_f32 v193, v193, v254, v254
v_mfma_f32_16x16x32_bf16 v[80:83], a[20:23], a[148:151], v[80:83]
v_fma_f32 v194, v194, v254, v254
v_mfma_f32_16x16x32_bf16 v[84:87], a[24:27], a[144:147], v[84:87]
v_mfma_f32_16x16x32_bf16 v[88:91], a[24:27], a[148:151], v[88:91]
v_fma_f32 v195, v195, v254, v254
v_mfma_f32_16x16x32_bf16 v[92:95], a[28:31], a[144:147], v[92:95]
buffer_load_dwordx4 v1, s[8:11], s60 offen offset:0 sc1 lds
v_mfma_f32_16x16x32_bf16 v[96:99], a[28:31], a[148:151], v[96:99]
v_rcp_f32 v192, v192
v_mfma_f32_16x16x32_bf16 v[100:103], a[32:35], a[144:147], v[100:103]
v_mfma_f32_16x16x32_bf16 v[104:107], a[32:35], a[148:151], v[104:107]
s_waitcnt vmcnt(30) lgkmcnt(0)
v_mfma_f32_16x16x32_bf16 v[36:39], a[36:39], a[152:155], v[36:39]
ds_read_b128 a[0:3], v200 offset:18432
buffer_load_dwordx4 v1, s[8:11], s60 offen offset:1024 sc1 lds
v_mfma_f32_16x16x32_bf16 v[40:43], a[36:39], a[156:159], v[40:43]
ds_read_b128 a[4:7], v200 offset:19456
v_mfma_f32_16x16x32_bf16 v[44:47], a[40:43], a[152:155], v[44:47]
ds_read_b128 a[8:11], v200 offset:20480
buffer_load_dwordx4 a[72:75], v1, s[4:7], s97 offen offset:2048 sc1
v_mfma_f32_16x16x32_bf16 v[48:51], a[40:43], a[156:159], v[48:51]
ds_read_b128 a[12:15], v200 offset:21504
v_mfma_f32_16x16x32_bf16 v[52:55], a[44:47], a[152:155], v[52:55]
ds_read_b128 a[16:19], v200 offset:22528
buffer_load_dwordx4 v1, s[8:11], s60 offen offset:2048 sc1 lds
v_mfma_f32_16x16x32_bf16 v[56:59], a[44:47], a[156:159], v[56:59]
ds_read_b128 a[20:23], v200 offset:23552
v_mfma_f32_16x16x32_bf16 v[60:63], a[48:51], a[152:155], v[60:63]
ds_read_b128 a[24:27], v200 offset:24576
v_mfma_f32_16x16x32_bf16 v[64:67], a[48:51], a[156:159], v[64:67]
ds_read_b128 a[28:31], v200 offset:25600
v_mfma_f32_16x16x32_bf16 v[68:71], a[52:55], a[152:155], v[68:71]
ds_read_b128 a[32:35], v200 offset:26624
buffer_load_dwordx4 v1, s[8:11], s60 offen offset:3072 sc1 lds
v_mfma_f32_16x16x32_bf16 v[72:75], a[52:55], a[156:159], v[72:75]
v_rcp_f32 v193, v193
v_mfma_f32_16x16x32_bf16 v[76:79], a[56:59], a[152:155], v[76:79]
v_rcp_f32 v194, v194
v_mfma_f32_16x16x32_bf16 v[80:83], a[56:59], a[156:159], v[80:83]
v_rcp_f32 v195, v195
v_mfma_f32_16x16x32_bf16 v[84:87], a[60:63], a[152:155], v[84:87]
buffer_load_dwordx4 a[224:227], v1, s[4:7], s52 offen offset:2048 sc1
v_mfma_f32_16x16x32_bf16 v[88:91], a[60:63], a[156:159], v[88:91]
v_mfma_f32_16x16x32_bf16 v[92:95], a[64:67], a[152:155], v[92:95]
v_mfma_f32_16x16x32_bf16 v[96:99], a[64:67], a[156:159], v[96:99]
v_mfma_f32_16x16x32_bf16 v[100:103], a[68:71], a[152:155], v[100:103]
v_mul_f32 v164, v164, v192
v_mfma_f32_16x16x32_bf16 v[104:107], a[68:71], a[156:159], v[104:107]
s_waitcnt lgkmcnt(0)
v_mfma_f32_16x16x32_bf16 v[36:39], a[0:3], a[160:163], v[36:39]
ds_read_b128 a[36:39], v200 offset:27648
buffer_load_dwordx4 a[228:231], v9, s[4:7], s52 offen offset:2048 sc1
v_mfma_f32_16x16x32_bf16 v[40:43], a[0:3], a[164:167], v[40:43]
ds_read_b128 a[40:43], v200 offset:28672
v_mul_f32 v165, v165, v193
v_mfma_f32_16x16x32_bf16 v[44:47], a[4:7], a[160:163], v[44:47]
ds_read_b128 a[44:47], v200 offset:29696
buffer_load_dwordx4 a[232:235], v1, s[4:7], s52 offen offset:3072 sc1
v_mfma_f32_16x16x32_bf16 v[48:51], a[4:7], a[164:167], v[48:51]
ds_read_b128 a[48:51], v200 offset:30720
v_mul_f32 v166, v166, v194
v_mfma_f32_16x16x32_bf16 v[52:55], a[8:11], a[160:163], v[52:55]
ds_read_b128 a[52:55], v200 offset:31744
buffer_load_dwordx4 a[236:239], v9, s[4:7], s52 offen offset:3072 sc1
v_mfma_f32_16x16x32_bf16 v[56:59], a[8:11], a[164:167], v[56:59]
ds_read_b128 a[56:59], v200 offset:32768
v_mul_f32 v167, v167, v195
v_mfma_f32_16x16x32_bf16 v[60:63], a[12:15], a[160:163], v[60:63]
ds_read_b128 a[60:63], v200 offset:33792
v_mfma_f32_16x16x32_bf16 v[64:67], a[12:15], a[164:167], v[64:67]
ds_read_b128 a[64:67], v200 offset:34816
v_mul_f32 v196, v168, v168
v_mfma_f32_16x16x32_bf16 v[68:71], a[16:19], a[160:163], v[68:71]
ds_read_b128 a[68:71], v200 offset:35840
v_mfma_f32_16x16x32_bf16 v[72:75], a[16:19], a[164:167], v[72:75]
s_cmp_eq_u32 s25, 12
s_cselect_b32 s98, 4096, 0
v_mfma_f32_16x16x32_bf16 v[76:79], a[20:23], a[160:163], v[76:79]
s_add_u32 s52, s52, s98
v_mul_f32 v197, v169, v169
v_mfma_f32_16x16x32_bf16 v[80:83], a[20:23], a[164:167], v[80:83]
s_add_u32 s52, s52, 4096
v_mfma_f32_16x16x32_bf16 v[84:87], a[24:27], a[160:163], v[84:87]
v_mul_f32 v198, v170, v170
v_mfma_f32_16x16x32_bf16 v[88:91], a[24:27], a[164:167], v[88:91]
v_mfma_f32_16x16x32_bf16 v[92:95], a[28:31], a[160:163], v[92:95]
buffer_load_dwordx4 a[240:243], v1, s[4:7], s52 offen offset:0 sc1
v_mul_f32 v199, v171, v171
v_mfma_f32_16x16x32_bf16 v[96:99], a[28:31], a[164:167], v[96:99]
v_mfma_f32_16x16x32_bf16 v[100:103], a[32:35], a[160:163], v[100:103]
v_mfma_f32_16x16x32_bf16 v[104:107], a[32:35], a[164:167], v[104:107]
s_waitcnt vmcnt(24) lgkmcnt(0)
s_barrier
v_mfma_f32_16x16x32_bf16 v[36:39], a[36:39], a[168:171], v[36:39]
ds_read_b128 a[0:3], v201 offset:0
buffer_load_dwordx4 a[244:247], v9, s[4:7], s52 offen offset:0 sc1
v_mfma_f32_16x16x32_bf16 v[40:43], a[36:39], a[172:175], v[40:43]
ds_read_b128 a[4:7], v201 offset:1024
buffer_load_dwordx4 a[248:251], v1, s[4:7], s52 offen offset:1024 sc1
v_mfma_f32_16x16x32_bf16 v[44:47], a[40:43], a[168:171], v[44:47]
ds_read_b128 a[8:11], v201 offset:2048
v_fma_f32 v196, v196, v253, v251
v_mfma_f32_16x16x32_bf16 v[48:51], a[40:43], a[172:175], v[48:51]
ds_read_b128 a[12:15], v201 offset:3072
buffer_load_dwordx4 a[252:255], v9, s[4:7], s52 offen offset:1024 sc1
v_mfma_f32_16x16x32_bf16 v[52:55], a[44:47], a[168:171], v[52:55]
ds_read_b128 a[16:19], v201 offset:4096
v_fma_f32 v197, v197, v253, v251
v_mfma_f32_16x16x32_bf16 v[56:59], a[44:47], a[172:175], v[56:59]
ds_read_b128 a[20:23], v201 offset:5120
v_fma_f32 v198, v198, v253, v251
v_mfma_f32_16x16x32_bf16 v[60:63], a[48:51], a[168:171], v[60:63]
ds_read_b128 a[24:27], v201 offset:6144
v_fma_f32 v199, v199, v253, v251
v_mfma_f32_16x16x32_bf16 v[64:67], a[48:51], a[172:175], v[64:67]
ds_read_b128 a[28:31], v201 offset:7168
v_mfma_f32_16x16x32_bf16 v[68:71], a[52:55], a[168:171], v[68:71]
ds_read_b128 a[32:35], v201 offset:8192
v_mul_f32 v196, v196, v168
v_mfma_f32_16x16x32_bf16 v[72:75], a[52:55], a[172:175], v[72:75]
s_cmp_eq_u32 s25, 12
s_cselect_b32 s99, 36864, 0
s_add_u32 s60, s60, s99
v_mfma_f32_16x16x32_bf16 v[76:79], a[56:59], a[168:171], v[76:79]
s_add_u32 s61, s61, s99
v_mul_f32 v197, v197, v169
v_mfma_f32_16x16x32_bf16 v[80:83], a[56:59], a[172:175], v[80:83]
s_add_u32 m0, s62, 53248
v_mfma_f32_16x16x32_bf16 v[84:87], a[60:63], a[168:171], v[84:87]
s_add_u32 s60, s60, 16384
v_mfma_f32_16x16x32_bf16 v[88:91], a[60:63], a[172:175], v[88:91]
buffer_load_dwordx4 a[72:75], v1, s[4:7], s97 offen offset:3072 sc1
v_mul_f32 v198, v198, v170
v_mfma_f32_16x16x32_bf16 v[92:95], a[64:67], a[168:171], v[92:95]
s_add_u32 s97, s97, 4096
v_mfma_f32_16x16x32_bf16 v[96:99], a[64:67], a[172:175], v[96:99]
buffer_load_dwordx4 v1, s[8:11], s60 offen offset:0 sc1 lds
v_mul_f32 v199, v199, v171
v_mfma_f32_16x16x32_bf16 v[100:103], a[68:71], a[168:171], v[100:103]
v_mfma_f32_16x16x32_bf16 v[104:107], a[68:71], a[172:175], v[104:107]
s_waitcnt lgkmcnt(0)
v_mfma_f32_16x16x32_bf16 v[36:39], a[0:3], a[176:179], v[36:39]
ds_read_b128 a[36:39], v201 offset:9216
buffer_load_dwordx4 v1, s[8:11], s60 offen offset:1024 sc1 lds
v_mfma_f32_16x16x32_bf16 v[40:43], a[0:3], a[180:183], v[40:43]
ds_read_b128 a[40:43], v201 offset:10240
v_mfma_f32_16x16x32_bf16 v[44:47], a[4:7], a[176:179], v[44:47]
ds_read_b128 a[44:47], v201 offset:11264
buffer_load_dwordx4 v1, s[8:11], s60 offen offset:2048 sc1 lds
v_mfma_f32_16x16x32_bf16 v[48:51], a[4:7], a[180:183], v[48:51]
ds_read_b128 a[48:51], v201 offset:12288
v_mfma_f32_16x16x32_bf16 v[52:55], a[8:11], a[176:179], v[52:55]
ds_read_b128 a[52:55], v201 offset:13312
v_mfma_f32_16x16x32_bf16 v[56:59], a[8:11], a[180:183], v[56:59]
ds_read_b128 a[56:59], v201 offset:14336
buffer_load_dwordx4 v1, s[8:11], s60 offen offset:3072 sc1 lds
v_mfma_f32_16x16x32_bf16 v[60:63], a[12:15], a[176:179], v[60:63]
ds_read_b128 a[60:63], v201 offset:15360
v_mfma_f32_16x16x32_bf16 v[64:67], a[12:15], a[180:183], v[64:67]
ds_read_b128 a[64:67], v201 offset:16384
v_mfma_f32_16x16x32_bf16 v[68:71], a[16:19], a[176:179], v[68:71]
ds_read_b128 a[68:71], v201 offset:17408
s_add_u32 m0, s63, 69632
v_mfma_f32_16x16x32_bf16 v[72:75], a[16:19], a[180:183], v[72:75]
s_add_u32 s61, s61, 36864
v_exp_f32 v196, v196
v_mfma_f32_16x16x32_bf16 v[76:79], a[20:23], a[176:179], v[76:79]
v_exp_f32 v197, v197
v_mfma_f32_16x16x32_bf16 v[80:83], a[20:23], a[180:183], v[80:83]
v_exp_f32 v198, v198
v_mfma_f32_16x16x32_bf16 v[84:87], a[24:27], a[176:179], v[84:87]
v_mfma_f32_16x16x32_bf16 v[88:91], a[24:27], a[180:183], v[88:91]
v_mfma_f32_16x16x32_bf16 v[92:95], a[28:31], a[176:179], v[92:95]
buffer_load_dwordx4 v1, s[8:11], s61 offen offset:0 sc1 lds
v_mfma_f32_16x16x32_bf16 v[96:99], a[28:31], a[180:183], v[96:99]
v_exp_f32 v199, v199
v_mfma_f32_16x16x32_bf16 v[100:103], a[32:35], a[176:179], v[100:103]
v_mfma_f32_16x16x32_bf16 v[104:107], a[32:35], a[180:183], v[104:107]
s_waitcnt vmcnt(29) lgkmcnt(0)
v_mfma_f32_16x16x32_bf16 v[36:39], a[36:39], a[184:187], v[36:39]
ds_read_b128 a[0:3], v201 offset:18432
s_add_u32 m0, s62, 73728
v_mfma_f32_16x16x32_bf16 v[40:43], a[36:39], a[188:191], v[40:43]
ds_read_b128 a[4:7], v201 offset:19456
v_fma_f32 v196, v196, v255, v255
v_mfma_f32_16x16x32_bf16 v[44:47], a[40:43], a[184:187], v[44:47]
ds_read_b128 a[8:11], v201 offset:20480
s_add_u32 s60, s60, 20480
v_mfma_f32_16x16x32_bf16 v[48:51], a[40:43], a[188:191], v[48:51]
ds_read_b128 a[12:15], v201 offset:21504
v_fma_f32 v197, v197, v255, v255
v_mfma_f32_16x16x32_bf16 v[52:55], a[44:47], a[184:187], v[52:55]
ds_read_b128 a[16:19], v201 offset:22528
v_mfma_f32_16x16x32_bf16 v[56:59], a[44:47], a[188:191], v[56:59]
ds_read_b128 a[20:23], v201 offset:23552
buffer_load_dwordx4 v1, s[8:11], s60 offen offset:0 sc1 lds
v_mfma_f32_16x16x32_bf16 v[60:63], a[48:51], a[184:187], v[60:63]
ds_read_b128 a[24:27], v201 offset:24576
v_fma_f32 v198, v198, v255, v255
v_mfma_f32_16x16x32_bf16 v[64:67], a[48:51], a[188:191], v[64:67]
ds_read_b128 a[28:31], v201 offset:25600
v_fma_f32 v199, v199, v255, v255
v_mfma_f32_16x16x32_bf16 v[68:71], a[52:55], a[184:187], v[68:71]
ds_read_b128 a[32:35], v201 offset:26624
buffer_load_dwordx4 v1, s[8:11], s60 offen offset:1024 sc1 lds
v_mfma_f32_16x16x32_bf16 v[72:75], a[52:55], a[188:191], v[72:75]
v_mfma_f32_16x16x32_bf16 v[76:79], a[56:59], a[184:187], v[76:79]
v_rcp_f32 v196, v196
v_mfma_f32_16x16x32_bf16 v[80:83], a[56:59], a[188:191], v[80:83]
buffer_load_dwordx4 v1, s[8:11], s60 offen offset:2048 sc1 lds
v_mfma_f32_16x16x32_bf16 v[84:87], a[60:63], a[184:187], v[84:87]
v_mfma_f32_16x16x32_bf16 v[88:91], a[60:63], a[188:191], v[88:91]
v_mfma_f32_16x16x32_bf16 v[92:95], a[64:67], a[184:187], v[92:95]
buffer_load_dwordx4 v1, s[8:11], s60 offen offset:3072 sc1 lds
v_mfma_f32_16x16x32_bf16 v[96:99], a[64:67], a[188:191], v[96:99]
v_rcp_f32 v197, v197
v_mfma_f32_16x16x32_bf16 v[100:103], a[68:71], a[184:187], v[100:103]
v_mfma_f32_16x16x32_bf16 v[104:107], a[68:71], a[188:191], v[104:107]
s_waitcnt lgkmcnt(0)
v_mfma_f32_16x16x32_bf16 v[36:39], a[0:3], a[192:195], v[36:39]
ds_read_b128 a[36:39], v201 offset:27648
buffer_load_dwordx4 a[80:83], v1, s[4:7], s52 offen offset:2048 sc1
v_mfma_f32_16x16x32_bf16 v[40:43], a[0:3], a[196:199], v[40:43]
ds_read_b128 a[40:43], v201 offset:28672
v_mfma_f32_16x16x32_bf16 v[44:47], a[4:7], a[192:195], v[44:47]
ds_read_b128 a[44:47], v201 offset:29696
v_mfma_f32_16x16x32_bf16 v[48:51], a[4:7], a[196:199], v[48:51]
ds_read_b128 a[48:51], v201 offset:30720
v_mfma_f32_16x16x32_bf16 v[52:55], a[8:11], a[192:195], v[52:55]
ds_read_b128 a[52:55], v201 offset:31744
buffer_load_dwordx4 a[84:87], v9, s[4:7], s52 offen offset:2048 sc1
v_mfma_f32_16x16x32_bf16 v[56:59], a[8:11], a[196:199], v[56:59]
ds_read_b128 a[56:59], v201 offset:32768
v_mfma_f32_16x16x32_bf16 v[60:63], a[12:15], a[192:195], v[60:63]
ds_read_b128 a[60:63], v201 offset:33792
v_mfma_f32_16x16x32_bf16 v[64:67], a[12:15], a[196:199], v[64:67]
ds_read_b128 a[64:67], v201 offset:34816
v_mfma_f32_16x16x32_bf16 v[68:71], a[16:19], a[192:195], v[68:71]
ds_read_b128 a[68:71], v201 offset:35840
buffer_load_dwordx4 a[88:91], v1, s[4:7], s52 offen offset:3072 sc1
v_mfma_f32_16x16x32_bf16 v[72:75], a[16:19], a[196:199], v[72:75]
v_rcp_f32 v198, v198
v_mfma_f32_16x16x32_bf16 v[76:79], a[20:23], a[192:195], v[76:79]
v_rcp_f32 v199, v199
v_mfma_f32_16x16x32_bf16 v[80:83], a[20:23], a[196:199], v[80:83]
v_mul_f32 v168, v168, v196
v_mfma_f32_16x16x32_bf16 v[84:87], a[24:27], a[192:195], v[84:87]
buffer_load_dwordx4 a[92:95], v9, s[4:7], s52 offen offset:3072 sc1
v_mfma_f32_16x16x32_bf16 v[88:91], a[24:27], a[196:199], v[88:91]
v_mul_f32 v169, v169, v197
v_mfma_f32_16x16x32_bf16 v[92:95], a[28:31], a[192:195], v[92:95]
v_mfma_f32_16x16x32_bf16 v[96:99], a[28:31], a[196:199], v[96:99]
v_mul_f32 v170, v170, v198
v_mfma_f32_16x16x32_bf16 v[100:103], a[32:35], a[192:195], v[100:103]
v_mfma_f32_16x16x32_bf16 v[104:107], a[32:35], a[196:199], v[104:107]
s_waitcnt vmcnt(22) lgkmcnt(0)
s_barrier
v_mfma_f32_16x16x32_bf16 v[36:39], a[36:39], a[200:203], v[36:39]
ds_read_b128 a[0:3], v202 offset:0
v_mul_f32 v171, v171, v199
v_mfma_f32_16x16x32_bf16 v[40:43], a[36:39], a[204:207], v[40:43]
ds_read_b128 a[4:7], v202 offset:1024
v_mfma_f32_16x16x32_bf16 v[44:47], a[40:43], a[200:203], v[44:47]
ds_read_b128 a[8:11], v202 offset:2048
v_mul_f32 v192, v172, v172
v_mfma_f32_16x16x32_bf16 v[48:51], a[40:43], a[204:207], v[48:51]
ds_read_b128 a[12:15], v202 offset:3072
v_mfma_f32_16x16x32_bf16 v[52:55], a[44:47], a[200:203], v[52:55]
ds_read_b128 a[16:19], v202 offset:4096
v_mul_f32 v193, v173, v173
v_mfma_f32_16x16x32_bf16 v[56:59], a[44:47], a[204:207], v[56:59]
ds_read_b128 a[20:23], v202 offset:5120
v_mfma_f32_16x16x32_bf16 v[60:63], a[48:51], a[200:203], v[60:63]
ds_read_b128 a[24:27], v202 offset:6144
v_mfma_f32_16x16x32_bf16 v[64:67], a[48:51], a[204:207], v[64:67]
ds_read_b128 a[28:31], v202 offset:7168
v_mul_f32 v194, v174, v174
v_mfma_f32_16x16x32_bf16 v[68:71], a[52:55], a[200:203], v[68:71]
ds_read_b128 a[32:35], v202 offset:8192
v_mfma_f32_16x16x32_bf16 v[72:75], a[52:55], a[204:207], v[72:75]
s_cmp_eq_u32 s25, 13
s_cselect_b32 s99, 36864, 0
s_add_u32 s60, s60, s99
v_mfma_f32_16x16x32_bf16 v[76:79], a[56:59], a[200:203], v[76:79]
s_add_u32 s61, s61, s99
s_add_u32 m0, s62, 90112
s_add_u32 s60, s60, 16384
v_mfma_f32_16x16x32_bf16 v[80:83], a[56:59], a[204:207], v[80:83]
buffer_load_dwordx4 v1, s[8:11], s60 offen offset:0 sc1 lds
v_mul_f32 v195, v175, v175
v_mfma_f32_16x16x32_bf16 v[84:87], a[60:63], a[200:203], v[84:87]
buffer_load_dwordx4 v1, s[8:11], s60 offen offset:1024 sc1 lds
v_fma_f32 v192, v192, v252, v250
v_mfma_f32_16x16x32_bf16 v[88:91], a[60:63], a[204:207], v[88:91]
buffer_load_dwordx4 v1, s[8:11], s60 offen offset:2048 sc1 lds
v_mfma_f32_16x16x32_bf16 v[92:95], a[64:67], a[200:203], v[92:95]
v_fma_f32 v193, v193, v252, v250
v_mfma_f32_16x16x32_bf16 v[96:99], a[64:67], a[204:207], v[96:99]
buffer_load_dwordx4 v1, s[8:11], s60 offen offset:3072 sc1 lds
v_mfma_f32_16x16x32_bf16 v[100:103], a[68:71], a[200:203], v[100:103]
v_fma_f32 v194, v194, v252, v250
v_mfma_f32_16x16x32_bf16 v[104:107], a[68:71], a[204:207], v[104:107]
s_waitcnt lgkmcnt(0)
v_mfma_f32_16x16x32_bf16 v[36:39], a[0:3], a[208:211], v[36:39]
ds_read_b128 a[36:39], v202 offset:9216
s_add_u32 m0, s63, 106496
v_mfma_f32_16x16x32_bf16 v[40:43], a[0:3], a[212:215], v[40:43]
ds_read_b128 a[40:43], v202 offset:10240
v_fma_f32 v195, v195, v252, v250
v_mfma_f32_16x16x32_bf16 v[44:47], a[4:7], a[208:211], v[44:47]
ds_read_b128 a[44:47], v202 offset:11264
s_add_u32 s61, s61, 36864
v_mfma_f32_16x16x32_bf16 v[48:51], a[4:7], a[212:215], v[48:51]
ds_read_b128 a[48:51], v202 offset:12288
v_mul_f32 v192, v192, v172
v_mfma_f32_16x16x32_bf16 v[52:55], a[8:11], a[208:211], v[52:55]
ds_read_b128 a[52:55], v202 offset:13312
buffer_load_dwordx4 v1, s[8:11], s61 offen offset:0 sc1 lds
v_mfma_f32_16x16x32_bf16 v[56:59], a[8:11], a[212:215], v[56:59]
ds_read_b128 a[56:59], v202 offset:14336
v_mul_f32 v193, v193, v173
v_mfma_f32_16x16x32_bf16 v[60:63], a[12:15], a[208:211], v[60:63]
ds_read_b128 a[60:63], v202 offset:15360
s_add_u32 m0, s62, 110592
v_mfma_f32_16x16x32_bf16 v[64:67], a[12:15], a[212:215], v[64:67]
ds_read_b128 a[64:67], v202 offset:16384
v_mfma_f32_16x16x32_bf16 v[68:71], a[16:19], a[208:211], v[68:71]
ds_read_b128 a[68:71], v202 offset:17408
s_add_u32 s60, s60, 20480
v_mfma_f32_16x16x32_bf16 v[72:75], a[16:19], a[212:215], v[72:75]
v_mul_f32 v194, v194, v174
v_mfma_f32_16x16x32_bf16 v[76:79], a[20:23], a[208:211], v[76:79]
buffer_load_dwordx4 v1, s[8:11], s60 offen offset:0 sc1 lds
v_mul_f32 v195, v195, v175
v_mfma_f32_16x16x32_bf16 v[80:83], a[20:23], a[212:215], v[80:83]
v_mfma_f32_16x16x32_bf16 v[84:87], a[24:27], a[208:211], v[84:87]
buffer_load_dwordx4 v1, s[8:11], s60 offen offset:1024 sc1 lds
v_mfma_f32_16x16x32_bf16 v[88:91], a[24:27], a[212:215], v[88:91]
v_exp_f32 v192, v192
v_mfma_f32_16x16x32_bf16 v[92:95], a[28:31], a[208:211], v[92:95]
buffer_load_dwordx4 v1, s[8:11], s60 offen offset:2048 sc1 lds
v_mfma_f32_16x16x32_bf16 v[96:99], a[28:31], a[212:215], v[96:99]
v_mfma_f32_16x16x32_bf16 v[100:103], a[32:35], a[208:211], v[100:103]
buffer_load_dwordx4 a[72:75], v1, s[4:7], s97 offen offset:0 sc1
v_mfma_f32_16x16x32_bf16 v[104:107], a[32:35], a[212:215], v[104:107]
s_waitcnt vmcnt(27) lgkmcnt(0)
v_mfma_f32_16x16x32_bf16 v[36:39], a[36:39], a[216:219], v[36:39]
ds_read_b128 a[0:3], v202 offset:18432
buffer_load_dwordx4 v1, s[8:11], s60 offen offset:3072 sc1 lds
v_mfma_f32_16x16x32_bf16 v[40:43], a[36:39], a[220:223], v[40:43]
ds_read_b128 a[4:7], v202 offset:19456
v_mfma_f32_16x16x32_bf16 v[44:47], a[40:43], a[216:219], v[44:47]
ds_read_b128 a[8:11], v202 offset:20480
v_mfma_f32_16x16x32_bf16 v[48:51], a[40:43], a[220:223], v[48:51]
ds_read_b128 a[12:15], v202 offset:21504
v_mfma_f32_16x16x32_bf16 v[52:55], a[44:47], a[216:219], v[52:55]
ds_read_b128 a[16:19], v202 offset:22528
v_mfma_f32_16x16x32_bf16 v[56:59], a[44:47], a[220:223], v[56:59]
ds_read_b128 a[20:23], v202 offset:23552
v_mfma_f32_16x16x32_bf16 v[60:63], a[48:51], a[216:219], v[60:63]
ds_read_b128 a[24:27], v202 offset:24576
v_mfma_f32_16x16x32_bf16 v[64:67], a[48:51], a[220:223], v[64:67]
ds_read_b128 a[28:31], v202 offset:25600
v_mfma_f32_16x16x32_bf16 v[68:71], a[52:55], a[216:219], v[68:71]
ds_read_b128 a[32:35], v202 offset:26624
v_mfma_f32_16x16x32_bf16 v[72:75], a[52:55], a[220:223], v[72:75]
s_cmp_eq_u32 s25, 13
s_cselect_b32 s98, 4096, 0
s_add_u32 s52, s52, s98
v_mfma_f32_16x16x32_bf16 v[76:79], a[56:59], a[216:219], v[76:79]
s_add_u32 s52, s52, 4096
v_exp_f32 v193, v193
v_mfma_f32_16x16x32_bf16 v[80:83], a[56:59], a[220:223], v[80:83]
buffer_load_dwordx4 a[96:99], v1, s[4:7], s52 offen offset:0 sc1
v_mfma_f32_16x16x32_bf16 v[84:87], a[60:63], a[216:219], v[84:87]
buffer_load_dwordx4 a[100:103], v9, s[4:7], s52 offen offset:0 sc1
v_mfma_f32_16x16x32_bf16 v[88:91], a[60:63], a[220:223], v[88:91]
v_exp_f32 v194, v194
v_mfma_f32_16x16x32_bf16 v[92:95], a[64:67], a[216:219], v[92:95]
buffer_load_dwordx4 a[104:107], v1, s[4:7], s52 offen offset:1024 sc1
v_mfma_f32_16x16x32_bf16 v[96:99], a[64:67], a[220:223], v[96:99]
v_exp_f32 v195, v195
v_mfma_f32_16x16x32_bf16 v[100:103], a[68:71], a[216:219], v[100:103]
v_fma_f32 v192, v192, v254, v254
v_fma_f32 v193, v193, v254, v254
v_mfma_f32_16x16x32_bf16 v[104:107], a[68:71], a[220:223], v[104:107]
s_waitcnt lgkmcnt(0)
v_mfma_f32_16x16x32_bf16 v[36:39], a[0:3], a[224:227], v[36:39]
ds_read_b128 a[36:39], v202 offset:27648
buffer_load_dwordx4 a[108:111], v9, s[4:7], s52 offen offset:1024 sc1
v_mfma_f32_16x16x32_bf16 v[40:43], a[0:3], a[228:231], v[40:43]
ds_read_b128 a[40:43], v202 offset:28672
v_fma_f32 v194, v194, v254, v254
v_mfma_f32_16x16x32_bf16 v[44:47], a[4:7], a[224:227], v[44:47]
ds_read_b128 a[44:47], v202 offset:29696
v_fma_f32 v195, v195, v254, v254
v_mfma_f32_16x16x32_bf16 v[48:51], a[4:7], a[228:231], v[48:51]
ds_read_b128 a[48:51], v202 offset:30720
v_mfma_f32_16x16x32_bf16 v[52:55], a[8:11], a[224:227], v[52:55]
ds_read_b128 a[52:55], v202 offset:31744
buffer_load_dwordx4 a[112:115], v1, s[4:7], s52 offen offset:2048 sc1
v_mfma_f32_16x16x32_bf16 v[56:59], a[8:11], a[228:231], v[56:59]
ds_read_b128 a[56:59], v202 offset:32768
v_mfma_f32_16x16x32_bf16 v[60:63], a[12:15], a[224:227], v[60:63]
ds_read_b128 a[60:63], v202 offset:33792
v_mfma_f32_16x16x32_bf16 v[64:67], a[12:15], a[228:231], v[64:67]
ds_read_b128 a[64:67], v202 offset:34816
v_mfma_f32_16x16x32_bf16 v[68:71], a[16:19], a[224:227], v[68:71]
ds_read_b128 a[68:71], v202 offset:35840
buffer_load_dwordx4 a[116:119], v9, s[4:7], s52 offen offset:2048 sc1
v_mfma_f32_16x16x32_bf16 v[72:75], a[16:19], a[228:231], v[72:75]
v_rcp_f32 v192, v192
v_mfma_f32_16x16x32_bf16 v[76:79], a[20:23], a[224:227], v[76:79]
v_rcp_f32 v193, v193
v_mfma_f32_16x16x32_bf16 v[80:83], a[20:23], a[228:231], v[80:83]
v_mfma_f32_16x16x32_bf16 v[84:87], a[24:27], a[224:227], v[84:87]
buffer_load_dwordx4 a[120:123], v1, s[4:7], s52 offen offset:3072 sc1
v_mfma_f32_16x16x32_bf16 v[88:91], a[24:27], a[228:231], v[88:91]
v_mfma_f32_16x16x32_bf16 v[92:95], a[28:31], a[224:227], v[92:95]
v_rcp_f32 v194, v194
v_mfma_f32_16x16x32_bf16 v[96:99], a[28:31], a[228:231], v[96:99]
v_mfma_f32_16x16x32_bf16 v[100:103], a[32:35], a[224:227], v[100:103]
v_mfma_f32_16x16x32_bf16 v[104:107], a[32:35], a[228:231], v[104:107]
s_waitcnt vmcnt(21) lgkmcnt(0)
s_barrier
v_mfma_f32_16x16x32_bf16 v[36:39], a[36:39], a[232:235], v[36:39]
ds_read_b128 a[0:3], v200 offset:0
buffer_load_dwordx4 a[124:127], v9, s[4:7], s52 offen offset:3072 sc1
v_mfma_f32_16x16x32_bf16 v[40:43], a[36:39], a[236:239], v[40:43]
ds_read_b128 a[4:7], v200 offset:1024
v_mfma_f32_16x16x32_bf16 v[44:47], a[40:43], a[232:235], v[44:47]
ds_read_b128 a[8:11], v200 offset:2048
v_mfma_f32_16x16x32_bf16 v[48:51], a[40:43], a[236:239], v[48:51]
ds_read_b128 a[12:15], v200 offset:3072
v_mfma_f32_16x16x32_bf16 v[52:55], a[44:47], a[232:235], v[52:55]
ds_read_b128 a[16:19], v200 offset:4096
v_mfma_f32_16x16x32_bf16 v[56:59], a[44:47], a[236:239], v[56:59]
ds_read_b128 a[20:23], v200 offset:5120
v_mfma_f32_16x16x32_bf16 v[60:63], a[48:51], a[232:235], v[60:63]
ds_read_b128 a[24:27], v200 offset:6144
v_mfma_f32_16x16x32_bf16 v[64:67], a[48:51], a[236:239], v[64:67]
ds_read_b128 a[28:31], v200 offset:7168
v_mfma_f32_16x16x32_bf16 v[68:71], a[52:55], a[232:235], v[68:71]
ds_read_b128 a[32:35], v200 offset:8192
buffer_load_dwordx4 a[72:75], v1, s[4:7], s97 offen offset:1024 sc1
v_mfma_f32_16x16x32_bf16 v[72:75], a[52:55], a[236:239], v[72:75]
s_cmp_eq_u32 s25, 14
s_cselect_b32 s99, 36864, 0
s_add_u32 s60, s60, s99
v_mfma_f32_16x16x32_bf16 v[76:79], a[56:59], a[232:235], v[76:79]
s_add_u32 s61, s61, s99
s_add_u32 m0, s62, 126976
s_add_u32 s60, s60, 16384
v_mfma_f32_16x16x32_bf16 v[80:83], a[56:59], a[236:239], v[80:83]
buffer_load_dwordx4 v1, s[8:11], s60 offen offset:0 sc1 lds
v_mfma_f32_16x16x32_bf16 v[84:87], a[60:63], a[232:235], v[84:87]
v_rcp_f32 v195, v195
v_mfma_f32_16x16x32_bf16 v[88:91], a[60:63], a[236:239], v[88:91]
buffer_load_dwordx4 v1, s[8:11], s60 offen offset:1024 sc1 lds
v_mul_f32 v172, v172, v192
v_mfma_f32_16x16x32_bf16 v[92:95], a[64:67], a[232:235], v[92:95]
v_mul_f32 v173, v173, v193
v_mul_f32 v174, v174, v194
v_mfma_f32_16x16x32_bf16 v[96:99], a[64:67], a[236:239], v[96:99]
buffer_load_dwordx4 v1, s[8:11], s60 offen offset:2048 sc1 lds
v_mul_f32 v175, v175, v195
v_mfma_f32_16x16x32_bf16 v[100:103], a[68:71], a[232:235], v[100:103]
v_mul_f32 v196, v176, v176
v_mfma_f32_16x16x32_bf16 v[104:107], a[68:71], a[236:239], v[104:107]
v_mul_f32 v197, v177, v177
s_waitcnt lgkmcnt(0)
v_mfma_f32_16x16x32_bf16 v[36:39], a[0:3], a[240:243], v[36:39]
ds_read_b128 a[36:39], v200 offset:9216
buffer_load_dwordx4 v1, s[8:11], s60 offen offset:3072 sc1 lds
v_mfma_f32_16x16x32_bf16 v[40:43], a[0:3], a[244:247], v[40:43]
ds_read_b128 a[40:43], v200 offset:10240
v_mfma_f32_16x16x32_bf16 v[44:47], a[4:7], a[240:243], v[44:47]
ds_read_b128 a[44:47], v200 offset:11264
s_add_u32 m0, s63, 143360
v_mfma_f32_16x16x32_bf16 v[48:51], a[4:7], a[244:247], v[48:51]
ds_read_b128 a[48:51], v200 offset:12288
v_mul_f32 v198, v178, v178
v_mfma_f32_16x16x32_bf16 v[52:55], a[8:11], a[240:243], v[52:55]
ds_read_b128 a[52:55], v200 offset:13312
s_add_u32 s61, s61, 36864
v_mfma_f32_16x16x32_bf16 v[56:59], a[8:11], a[244:247], v[56:59]
ds_read_b128 a[56:59], v200 offset:14336
v_mul_f32 v199, v179, v179
v_mfma_f32_16x16x32_bf16 v[60:63], a[12:15], a[240:243], v[60:63]
ds_read_b128 a[60:63], v200 offset:15360
buffer_load_dwordx4 v1, s[8:11], s61 offen offset:0 sc1 lds
v_mfma_f32_16x16x32_bf16 v[64:67], a[12:15], a[244:247], v[64:67]
ds_read_b128 a[64:67], v200 offset:16384
v_fma_f32 v196, v196, v253, v251
v_mfma_f32_16x16x32_bf16 v[68:71], a[16:19], a[240:243], v[68:71]
ds_read_b128 a[68:71], v200 offset:17408
s_add_u32 m0, s62, 147456
v_mfma_f32_16x16x32_bf16 v[72:75], a[16:19], a[244:247], v[72:75]
s_add_u32 s60, s60, 20480
v_fma_f32 v197, v197, v253, v251
v_mfma_f32_16x16x32_bf16 v[76:79], a[20:23], a[240:243], v[76:79]
v_mfma_f32_16x16x32_bf16 v[80:83], a[20:23], a[244:247], v[80:83]
v_fma_f32 v198, v198, v253, v251
v_mfma_f32_16x16x32_bf16 v[84:87], a[24:27], a[240:243], v[84:87]
buffer_load_dwordx4 v1, s[8:11], s60 offen offset:0 sc1 lds
v_mfma_f32_16x16x32_bf16 v[88:91], a[24:27], a[244:247], v[88:91]
v_fma_f32 v199, v199, v253, v251
v_mfma_f32_16x16x32_bf16 v[92:95], a[28:31], a[240:243], v[92:95]
buffer_load_dwordx4 v1, s[8:11], s60 offen offset:1024 sc1 lds
v_mfma_f32_16x16x32_bf16 v[96:99], a[28:31], a[244:247], v[96:99]
v_mfma_f32_16x16x32_bf16 v[100:103], a[32:35], a[240:243], v[100:103]
v_mul_f32 v196, v196, v176
v_mfma_f32_16x16x32_bf16 v[104:107], a[32:35], a[244:247], v[104:107]
s_waitcnt vmcnt(26) lgkmcnt(0)
v_mfma_f32_16x16x32_bf16 v[36:39], a[36:39], a[248:251], v[36:39]
ds_read_b128 a[0:3], v200 offset:18432
buffer_load_dwordx4 v1, s[8:11], s60 offen offset:2048 sc1 lds
v_mfma_f32_16x16x32_bf16 v[40:43], a[36:39], a[252:255], v[40:43]
ds_read_b128 a[4:7], v200 offset:19456
v_mul_f32 v197, v197, v177
v_mfma_f32_16x16x32_bf16 v[44:47], a[40:43], a[248:251], v[44:47]
ds_read_b128 a[8:11], v200 offset:20480
buffer_load_dwordx4 v1, s[8:11], s60 offen offset:3072 sc1 lds
v_mfma_f32_16x16x32_bf16 v[48:51], a[40:43], a[252:255], v[48:51]
ds_read_b128 a[12:15], v200 offset:21504
v_mul_f32 v198, v198, v178
v_mfma_f32_16x16x32_bf16 v[52:55], a[44:47], a[248:251], v[52:55]
ds_read_b128 a[16:19], v200 offset:22528
v_mfma_f32_16x16x32_bf16 v[56:59], a[44:47], a[252:255], v[56:59]
ds_read_b128 a[20:23], v200 offset:23552
v_mul_f32 v199, v199, v179
v_mfma_f32_16x16x32_bf16 v[60:63], a[48:51], a[248:251], v[60:63]
ds_read_b128 a[24:27], v200 offset:24576
v_mfma_f32_16x16x32_bf16 v[64:67], a[48:51], a[252:255], v[64:67]
ds_read_b128 a[28:31], v200 offset:25600
v_mfma_f32_16x16x32_bf16 v[68:71], a[52:55], a[248:251], v[68:71]
ds_read_b128 a[32:35], v200 offset:26624
v_mfma_f32_16x16x32_bf16 v[72:75], a[52:55], a[252:255], v[72:75]
s_cmp_eq_u32 s25, 14
s_cselect_b32 s98, 4096, 0
s_add_u32 s52, s52, s98
v_mfma_f32_16x16x32_bf16 v[76:79], a[56:59], a[248:251], v[76:79]
s_add_u32 s52, s52, 4096
v_exp_f32 v196, v196
v_mfma_f32_16x16x32_bf16 v[80:83], a[56:59], a[252:255], v[80:83]
v_mfma_f32_16x16x32_bf16 v[84:87], a[60:63], a[248:251], v[84:87]
buffer_load_dwordx4 a[128:131], v1, s[4:7], s52 offen offset:0 sc1
v_mfma_f32_16x16x32_bf16 v[88:91], a[60:63], a[252:255], v[88:91]
v_exp_f32 v197, v197
v_mfma_f32_16x16x32_bf16 v[92:95], a[64:67], a[248:251], v[92:95]
buffer_load_dwordx4 a[132:135], v9, s[4:7], s52 offen offset:0 sc1
v_mfma_f32_16x16x32_bf16 v[96:99], a[64:67], a[252:255], v[96:99]
v_mfma_f32_16x16x32_bf16 v[100:103], a[68:71], a[248:251], v[100:103]
v_mfma_f32_16x16x32_bf16 v[104:107], a[68:71], a[252:255], v[104:107]
s_waitcnt lgkmcnt(0)
v_mfma_f32_16x16x32_bf16 v[36:39], a[0:3], a[80:83], v[36:39]
ds_read_b128 a[36:39], v200 offset:27648
buffer_load_dwordx4 a[136:139], v1, s[4:7], s52 offen offset:1024 sc1
v_mfma_f32_16x16x32_bf16 v[40:43], a[0:3], a[84:87], v[40:43]
ds_read_b128 a[40:43], v200 offset:28672
v_mfma_f32_16x16x32_bf16 v[44:47], a[4:7], a[80:83], v[44:47]
ds_read_b128 a[44:47], v200 offset:29696
v_mfma_f32_16x16x32_bf16 v[48:51], a[4:7], a[84:87], v[48:51]
ds_read_b128 a[48:51], v200 offset:30720
v_mfma_f32_16x16x32_bf16 v[52:55], a[8:11], a[80:83], v[52:55]
ds_read_b128 a[52:55], v200 offset:31744
buffer_load_dwordx4 a[140:143], v9, s[4:7], s52 offen offset:1024 sc1
v_mfma_f32_16x16x32_bf16 v[56:59], a[8:11], a[84:87], v[56:59]
ds_read_b128 a[56:59], v200 offset:32768
v_mfma_f32_16x16x32_bf16 v[60:63], a[12:15], a[80:83], v[60:63]
ds_read_b128 a[60:63], v200 offset:33792
v_mfma_f32_16x16x32_bf16 v[64:67], a[12:15], a[84:87], v[64:67]
ds_read_b128 a[64:67], v200 offset:34816
v_mfma_f32_16x16x32_bf16 v[68:71], a[16:19], a[80:83], v[68:71]
ds_read_b128 a[68:71], v200 offset:35840
buffer_load_dwordx4 a[144:147], v1, s[4:7], s52 offen offset:2048 sc1
v_mfma_f32_16x16x32_bf16 v[72:75], a[16:19], a[84:87], v[72:75]
v_exp_f32 v198, v198
v_mfma_f32_16x16x32_bf16 v[76:79], a[20:23], a[80:83], v[76:79]
v_exp_f32 v199, v199
v_mfma_f32_16x16x32_bf16 v[80:83], a[20:23], a[84:87], v[80:83]
v_fma_f32 v196, v196, v255, v255
v_fma_f32 v197, v197, v255, v255
v_mfma_f32_16x16x32_bf16 v[84:87], a[24:27], a[80:83], v[84:87]
buffer_load_dwordx4 a[148:151], v9, s[4:7], s52 offen offset:2048 sc1
v_mfma_f32_16x16x32_bf16 v[88:91], a[24:27], a[84:87], v[88:91]
v_fma_f32 v198, v198, v255, v255
v_mfma_f32_16x16x32_bf16 v[92:95], a[28:31], a[80:83], v[92:95]
v_mfma_f32_16x16x32_bf16 v[96:99], a[28:31], a[84:87], v[96:99]
v_fma_f32 v199, v199, v255, v255
v_mfma_f32_16x16x32_bf16 v[100:103], a[32:35], a[80:83], v[100:103]
v_mfma_f32_16x16x32_bf16 v[104:107], a[32:35], a[84:87], v[104:107]
s_waitcnt vmcnt(20) lgkmcnt(0)
s_barrier
v_mfma_f32_16x16x32_bf16 v[36:39], a[36:39], a[88:91], v[36:39]
ds_read_b128 a[0:3], v201 offset:0
buffer_load_dwordx4 a[152:155], v1, s[4:7], s52 offen offset:3072 sc1
v_mfma_f32_16x16x32_bf16 v[40:43], a[36:39], a[92:95], v[40:43]
ds_read_b128 a[4:7], v201 offset:1024
v_mfma_f32_16x16x32_bf16 v[44:47], a[40:43], a[88:91], v[44:47]
ds_read_b128 a[8:11], v201 offset:2048
buffer_load_dwordx4 a[156:159], v9, s[4:7], s52 offen offset:3072 sc1
v_mfma_f32_16x16x32_bf16 v[48:51], a[40:43], a[92:95], v[48:51]
ds_read_b128 a[12:15], v201 offset:3072
v_mfma_f32_16x16x32_bf16 v[52:55], a[44:47], a[88:91], v[52:55]
ds_read_b128 a[16:19], v201 offset:4096
s_mul_i32 s38, s24, 13312
v_mfma_f32_16x16x32_bf16 v[56:59], a[44:47], a[92:95], v[56:59]
ds_read_b128 a[20:23], v201 offset:5120
v_mfma_f32_16x16x32_bf16 v[60:63], a[48:51], a[88:91], v[60:63]
ds_read_b128 a[24:27], v201 offset:6144
v_mfma_f32_16x16x32_bf16 v[64:67], a[48:51], a[92:95], v[64:67]
ds_read_b128 a[28:31], v201 offset:7168
s_add_u32 m0, s38, 0
v_mfma_f32_16x16x32_bf16 v[68:71], a[52:55], a[88:91], v[68:71]
ds_read_b128 a[32:35], v201 offset:8192
v_mfma_f32_16x16x32_bf16 v[72:75], a[52:55], a[92:95], v[72:75]
s_add_u32 s39, s38, s83
v_rcp_f32 v196, v196
v_mfma_f32_16x16x32_bf16 v[76:79], a[56:59], a[88:91], v[76:79]
v_rcp_f32 v197, v197
v_mfma_f32_16x16x32_bf16 v[80:83], a[56:59], a[92:95], v[80:83]
v_rcp_f32 v198, v198
v_mfma_f32_16x16x32_bf16 v[84:87], a[60:63], a[88:91], v[84:87]
buffer_load_dwordx4 v1, s[4:7], s39 offen offset:0 sc1 lds
v_mfma_f32_16x16x32_bf16 v[88:91], a[60:63], a[92:95], v[88:91]
v_mfma_f32_16x16x32_bf16 v[92:95], a[64:67], a[88:91], v[92:95]
buffer_load_dwordx4 v1, s[4:7], s39 offen offset:1024 sc1 lds
v_mfma_f32_16x16x32_bf16 v[96:99], a[64:67], a[92:95], v[96:99]
v_rcp_f32 v199, v199
v_mfma_f32_16x16x32_bf16 v[100:103], a[68:71], a[88:91], v[100:103]
v_mfma_f32_16x16x32_bf16 v[104:107], a[68:71], a[92:95], v[104:107]
s_waitcnt lgkmcnt(0)
v_mfma_f32_16x16x32_bf16 v[36:39], a[0:3], a[96:99], v[36:39]
ds_read_b128 a[36:39], v201 offset:9216
buffer_load_dwordx4 v1, s[4:7], s39 offen offset:2048 sc1 lds
v_mfma_f32_16x16x32_bf16 v[40:43], a[0:3], a[100:103], v[40:43]
ds_read_b128 a[40:43], v201 offset:10240
v_mul_f32 v176, v176, v196
v_mfma_f32_16x16x32_bf16 v[44:47], a[4:7], a[96:99], v[44:47]
ds_read_b128 a[44:47], v201 offset:11264
buffer_load_dwordx4 v1, s[4:7], s39 offen offset:3072 sc1 lds
v_mfma_f32_16x16x32_bf16 v[48:51], a[4:7], a[100:103], v[48:51]
ds_read_b128 a[48:51], v201 offset:12288
v_mul_f32 v177, v177, v197
v_mfma_f32_16x16x32_bf16 v[52:55], a[8:11], a[96:99], v[52:55]
ds_read_b128 a[52:55], v201 offset:13312
v_mfma_f32_16x16x32_bf16 v[56:59], a[8:11], a[100:103], v[56:59]
ds_read_b128 a[56:59], v201 offset:14336
s_add_u32 m0, m0, 4096
v_mfma_f32_16x16x32_bf16 v[60:63], a[12:15], a[96:99], v[60:63]
ds_read_b128 a[60:63], v201 offset:15360
v_mul_f32 v178, v178, v198
v_mfma_f32_16x16x32_bf16 v[64:67], a[12:15], a[100:103], v[64:67]
ds_read_b128 a[64:67], v201 offset:16384
v_mul_f32 v179, v179, v199
v_mfma_f32_16x16x32_bf16 v[68:71], a[16:19], a[96:99], v[68:71]
ds_read_b128 a[68:71], v201 offset:17408
s_add_u32 s39, s39, 4096
v_mfma_f32_16x16x32_bf16 v[72:75], a[16:19], a[100:103], v[72:75]
s_lshl_b32 s30, s25, 3
v_mfma_f32_16x16x32_bf16 v[76:79], a[20:23], a[96:99], v[76:79]
s_lshl_b32 s31, s24, 1
v_mfma_f32_16x16x32_bf16 v[80:83], a[20:23], a[100:103], v[80:83]
buffer_load_dwordx4 v1, s[4:7], s39 offen offset:0 sc1 lds
v_mfma_f32_16x16x32_bf16 v[84:87], a[24:27], a[96:99], v[84:87]
s_add_u32 s30, s30, s31
v_mfma_f32_16x16x32_bf16 v[88:91], a[24:27], a[100:103], v[88:91]
s_mul_i32 s30, s30, 73728
v_mfma_f32_16x16x32_bf16 v[92:95], a[28:31], a[96:99], v[92:95]
buffer_load_dwordx4 v1, s[4:7], s39 offen offset:1024 sc1 lds
v_mfma_f32_16x16x32_bf16 v[96:99], a[28:31], a[100:103], v[96:99]
s_add_u32 s30, s30, 16777216
v_mfma_f32_16x16x32_bf16 v[100:103], a[32:35], a[96:99], v[100:103]
s_mul_i32 s31, s26, 4608
v_mfma_f32_16x16x32_bf16 v[104:107], a[32:35], a[100:103], v[104:107]
s_add_u32 s30, s30, s31
s_waitcnt vmcnt(24) lgkmcnt(0)
v_mfma_f32_16x16x32_bf16 v[36:39], a[36:39], a[104:107], v[36:39]
ds_read_b128 a[0:3], v201 offset:18432
buffer_load_dwordx4 v1, s[4:7], s39 offen offset:2048 sc1 lds
v_mfma_f32_16x16x32_bf16 v[40:43], a[36:39], a[108:111], v[40:43]
ds_read_b128 a[4:7], v201 offset:19456
v_mfma_f32_16x16x32_bf16 v[44:47], a[40:43], a[104:107], v[44:47]
ds_read_b128 a[8:11], v201 offset:20480
buffer_load_dwordx4 v1, s[4:7], s39 offen offset:3072 sc1 lds
v_mfma_f32_16x16x32_bf16 v[48:51], a[40:43], a[108:111], v[48:51]
ds_read_b128 a[12:15], v201 offset:21504
v_mfma_f32_16x16x32_bf16 v[52:55], a[44:47], a[104:107], v[52:55]
ds_read_b128 a[16:19], v201 offset:22528
v_mfma_f32_16x16x32_bf16 v[56:59], a[44:47], a[108:111], v[56:59]
ds_read_b128 a[20:23], v201 offset:23552
s_add_u32 m0, m0, 4096
v_mfma_f32_16x16x32_bf16 v[60:63], a[48:51], a[104:107], v[60:63]
ds_read_b128 a[24:27], v201 offset:24576
v_mfma_f32_16x16x32_bf16 v[64:67], a[48:51], a[108:111], v[64:67]
ds_read_b128 a[28:31], v201 offset:25600
v_mfma_f32_16x16x32_bf16 v[68:71], a[52:55], a[104:107], v[68:71]
ds_read_b128 a[32:35], v201 offset:26624
s_add_u32 s39, s39, 4096
v_mfma_f32_16x16x32_bf16 v[72:75], a[52:55], a[108:111], v[72:75]
s_and_b32 s65, s26, 1
v_mfma_f32_16x16x32_bf16 v[76:79], a[56:59], a[104:107], v[76:79]
s_lshl_b32 s64, s65, 9
v_mfma_f32_16x16x32_bf16 v[80:83], a[56:59], a[108:111], v[80:83]
buffer_load_dwordx4 v1, s[4:7], s39 offen offset:0 sc1 lds
v_mfma_f32_16x16x32_bf16 v[84:87], a[60:63], a[104:107], v[84:87]
s_add_u32 s64, s64, s30
v_mfma_f32_16x16x32_bf16 v[88:91], a[60:63], a[108:111], v[88:91]
s_xor_b32 s65, s65, 1
v_mfma_f32_16x16x32_bf16 v[92:95], a[64:67], a[104:107], v[92:95]
buffer_load_dwordx4 v1, s[4:7], s39 offen offset:1024 sc1 lds
v_mfma_f32_16x16x32_bf16 v[96:99], a[64:67], a[108:111], v[96:99]
s_lshl_b32 s65, s65, 12
v_mfma_f32_16x16x32_bf16 v[100:103], a[68:71], a[104:107], v[100:103]
s_add_u32 s65, s65, s30
v_mfma_f32_16x16x32_bf16 v[104:107], a[68:71], a[108:111], v[104:107]
s_waitcnt lgkmcnt(0)
v_mfma_f32_16x16x32_bf16 v[36:39], a[0:3], a[112:115], v[36:39]
ds_read_b128 a[36:39], v201 offset:27648
buffer_load_dwordx4 v1, s[4:7], s39 offen offset:2048 sc1 lds
v_mfma_f32_16x16x32_bf16 v[40:43], a[0:3], a[116:119], v[40:43]
ds_read_b128 a[40:43], v201 offset:28672
buffer_load_dwordx4 v1, s[4:7], s39 offen offset:3072 sc1 lds
v_mfma_f32_16x16x32_bf16 v[44:47], a[4:7], a[112:115], v[44:47]
ds_read_b128 a[44:47], v201 offset:29696
v_mfma_f32_16x16x32_bf16 v[48:51], a[4:7], a[116:119], v[48:51]
ds_read_b128 a[48:51], v201 offset:30720
s_add_u32 m0, m0, 4096
v_mfma_f32_16x16x32_bf16 v[52:55], a[8:11], a[112:115], v[52:55]
ds_read_b128 a[52:55], v201 offset:31744
v_add_u32 v204, 73728, v1
v_mfma_f32_16x16x32_bf16 v[56:59], a[8:11], a[116:119], v[56:59]
ds_read_b128 a[56:59], v201 offset:32768
s_add_u32 s39, s39, 4096
v_mfma_f32_16x16x32_bf16 v[60:63], a[12:15], a[112:115], v[60:63]
ds_read_b128 a[60:63], v201 offset:33792
buffer_load_dwordx4 v1, s[4:7], s39 offen offset:0 sc1 lds
v_mfma_f32_16x16x32_bf16 v[64:67], a[12:15], a[116:119], v[64:67]
ds_read_b128 a[64:67], v201 offset:34816
v_and_b32 v203, 1, v3
v_mfma_f32_16x16x32_bf16 v[68:71], a[16:19], a[112:115], v[68:71]
ds_read_b128 a[68:71], v201 offset:35840
s_mul_i32 s38, s24, 9216
v_mfma_f32_16x16x32_bf16 v[72:75], a[16:19], a[116:119], v[72:75]
s_add_u32 m0, s38, 53248
v_mul_u32_u24 v203, 73728, v203
v_mfma_f32_16x16x32_bf16 v[76:79], a[20:23], a[112:115], v[76:79]
s_add_u32 s39, s38, s83
v_mfma_f32_16x16x32_bf16 v[80:83], a[20:23], a[116:119], v[80:83]
s_add_u32 s39, s39, 53248
v_lshrrev_b32 v7, 1, v3
v_mfma_f32_16x16x32_bf16 v[84:87], a[24:27], a[112:115], v[84:87]
v_mfma_f32_16x16x32_bf16 v[88:91], a[24:27], a[116:119], v[88:91]
v_mfma_f32_16x16x32_bf16 v[92:95], a[28:31], a[112:115], v[92:95]
v_lshl_add_u32 v203, v7, 8, v203
v_mfma_f32_16x16x32_bf16 v[96:99], a[28:31], a[116:119], v[96:99]
buffer_load_dwordx4 v1, s[4:7], s39 offen offset:0 sc1 lds
v_mfma_f32_16x16x32_bf16 v[100:103], a[32:35], a[112:115], v[100:103]
v_lshl_add_u32 v203, v2, 4, v203
v_mfma_f32_16x16x32_bf16 v[104:107], a[32:35], a[116:119], v[104:107]
s_waitcnt vmcnt(14) lgkmcnt(0)
s_barrier
v_mfma_f32_16x16x32_bf16 v[36:39], a[36:39], a[120:123], v[36:39]
ds_read_b128 a[0:3], v202 offset:8192
buffer_load_dwordx4 v1, s[4:7], s39 offen offset:1024 sc1 lds
v_mfma_f32_16x16x32_bf16 v[40:43], a[36:39], a[124:127], v[40:43]
ds_read_b128 a[4:7], v202 offset:17408
v_mfma_f32_16x16x32_bf16 v[44:47], a[40:43], a[120:123], v[44:47]
ds_read_b128 a[8:11], v202 offset:26624
buffer_load_dwordx4 v1, s[4:7], s39 offen offset:2048 sc1 lds
v_mfma_f32_16x16x32_bf16 v[48:51], a[40:43], a[124:127], v[48:51]
ds_read_b128 a[12:15], v202 offset:35840
v_mfma_f32_16x16x32_bf16 v[52:55], a[44:47], a[120:123], v[52:55]
ds_read_b128 a[16:19], v202 offset:0
v_mfma_f32_16x16x32_bf16 v[56:59], a[44:47], a[124:127], v[56:59]
ds_read_b128 a[20:23], v202 offset:1024
buffer_load_dwordx4 v1, s[4:7], s39 offen offset:3072 sc1 lds
v_mfma_f32_16x16x32_bf16 v[60:63], a[48:51], a[120:123], v[60:63]
ds_read_b128 a[24:27], v202 offset:9216
v_mfma_f32_16x16x32_bf16 v[64:67], a[48:51], a[124:127], v[64:67]
ds_read_b128 a[28:31], v202 offset:10240
v_mfma_f32_16x16x32_bf16 v[68:71], a[52:55], a[120:123], v[68:71]
ds_read_b128 a[32:35], v202 offset:18432
s_add_u32 m0, m0, 4096
v_mfma_f32_16x16x32_bf16 v[72:75], a[52:55], a[124:127], v[72:75]
s_add_u32 s39, s39, 4096
v_mfma_f32_16x16x32_bf16 v[76:79], a[56:59], a[120:123], v[76:79]
v_mfma_f32_16x16x32_bf16 v[80:83], a[56:59], a[124:127], v[80:83]
v_mfma_f32_16x16x32_bf16 v[84:87], a[60:63], a[120:123], v[84:87]
v_mfma_f32_16x16x32_bf16 v[88:91], a[60:63], a[124:127], v[88:91]
v_mfma_f32_16x16x32_bf16 v[92:95], a[64:67], a[120:123], v[92:95]
buffer_load_dwordx4 v1, s[4:7], s39 offen offset:0 sc1 lds
v_mfma_f32_16x16x32_bf16 v[96:99], a[64:67], a[124:127], v[96:99]
v_mfma_f32_16x16x32_bf16 v[100:103], a[68:71], a[120:123], v[100:103]
v_mfma_f32_16x16x32_bf16 v[104:107], a[68:71], a[124:127], v[104:107]
s_waitcnt lgkmcnt(7)
v_mfma_f32_16x16x32_bf16 v[100:103], a[0:3], a[128:131], v[100:103]
ds_read_b128 a[36:39], v202 offset:19456
v_mfma_f32_16x16x32_bf16 v[104:107], a[0:3], a[132:135], v[104:107]
v_mfma_f32_16x16x32_bf16 v[100:103], a[4:7], a[136:139], v[100:103]
ds_read_b128 a[40:43], v202 offset:27648
v_mfma_f32_16x16x32_bf16 v[104:107], a[4:7], a[140:143], v[104:107]
s_waitcnt lgkmcnt(7)
v_mfma_f32_16x16x32_bf16 v[100:103], a[8:11], a[144:147], v[100:103]
ds_read_b128 a[44:47], v202 offset:28672
v_mfma_f32_16x16x32_bf16 v[104:107], a[8:11], a[148:151], v[104:107]
v_mfma_f32_16x16x32_bf16 v[100:103], a[12:15], a[152:155], v[100:103]
ds_read_b128 a[48:51], v202 offset:2048
v_mfma_f32_16x16x32_bf16 v[104:107], a[12:15], a[156:159], v[104:107]
s_waitcnt lgkmcnt(7)
v_mfma_f32_16x16x32_bf16 v[36:39], a[16:19], a[128:131], v[36:39]
ds_read_b128 a[52:55], v202 offset:3072
v_mfma_f32_16x16x32_bf16 v[40:43], a[16:19], a[132:135], v[40:43]
v_mfma_f32_16x16x32_bf16 v[44:47], a[20:23], a[128:131], v[44:47]
ds_read_b128 a[56:59], v202 offset:11264
v_mfma_f32_16x16x32_bf16 v[48:51], a[20:23], a[132:135], v[48:51]
v_mul_f32 v100, v100, v108
s_waitcnt lgkmcnt(7)
v_mfma_f32_16x16x32_bf16 v[36:39], a[24:27], a[136:139], v[36:39]
ds_read_b128 a[60:63], v202 offset:12288
v_mul_f32 v101, v101, v109
v_mfma_f32_16x16x32_bf16 v[40:43], a[24:27], a[140:143], v[40:43]
v_mul_f32 v102, v102, v110
v_mul_f32 v103, v103, v111
v_mfma_f32_16x16x32_bf16 v[44:47], a[28:31], a[136:139], v[44:47]
ds_read_b128 a[64:67], v202 offset:20480
v_cvt_pk_bf16_f32 v238, v100, v101
v_mfma_f32_16x16x32_bf16 v[48:51], a[28:31], a[140:143], v[48:51]
v_cvt_pk_bf16_f32 v239, v102, v103
s_waitcnt lgkmcnt(7)
v_mfma_f32_16x16x32_bf16 v[36:39], a[32:35], a[144:147], v[36:39]
ds_read_b128 a[68:71], v202 offset:21504
v_mul_f32 v104, v104, v112
v_mfma_f32_16x16x32_bf16 v[40:43], a[32:35], a[148:151], v[40:43]
v_mul_f32 v105, v105, v113
v_mfma_f32_16x16x32_bf16 v[44:47], a[36:39], a[144:147], v[44:47]
ds_read_b128 a[0:3], v202 offset:29696
v_mul_f32 v106, v106, v114
v_mfma_f32_16x16x32_bf16 v[48:51], a[36:39], a[148:151], v[48:51]
v_mul_f32 v107, v107, v115
s_waitcnt lgkmcnt(7)
v_mfma_f32_16x16x32_bf16 v[36:39], a[40:43], a[152:155], v[36:39]
ds_read_b128 a[4:7], v202 offset:30720
v_cvt_pk_bf16_f32 v240, v104, v105
v_mfma_f32_16x16x32_bf16 v[40:43], a[40:43], a[156:159], v[40:43]
v_cvt_pk_bf16_f32 v241, v106, v107
s_nop 0
v_mfma_f32_16x16x32_bf16 v[44:47], a[44:47], a[152:155], v[44:47]
ds_read_b128 a[8:11], v202 offset:4096
v_mfma_f32_16x16x32_bf16 v[48:51], a[44:47], a[156:159], v[48:51]
s_waitcnt lgkmcnt(7)
v_mfma_f32_16x16x32_bf16 v[52:55], a[48:51], a[128:131], v[52:55]
ds_read_b128 a[12:15], v202 offset:5120
v_permlane16_swap_b32 v238, v240
v_mfma_f32_16x16x32_bf16 v[56:59], a[48:51], a[132:135], v[56:59]
v_permlane16_swap_b32 v239, v241
v_mfma_f32_16x16x32_bf16 v[60:63], a[52:55], a[128:131], v[60:63]
ds_read_b128 a[16:19], v202 offset:13312
buffer_store_dwordx4 v[238:241], v203, s[8:11], s65 offen sc1
v_mfma_f32_16x16x32_bf16 v[64:67], a[52:55], a[132:135], v[64:67]
v_mul_f32 v36, v36, v116
s_waitcnt lgkmcnt(7)
v_mfma_f32_16x16x32_bf16 v[52:55], a[56:59], a[136:139], v[52:55]
ds_read_b128 a[20:23], v202 offset:14336
v_mul_f32 v37, v37, v117
v_mfma_f32_16x16x32_bf16 v[56:59], a[56:59], a[140:143], v[56:59]
v_mul_f32 v38, v38, v118
v_mul_f32 v39, v39, v119
v_mfma_f32_16x16x32_bf16 v[60:63], a[60:63], a[136:139], v[60:63]
ds_read_b128 a[24:27], v202 offset:22528
v_cvt_pk_bf16_f32 v206, v36, v37
v_mfma_f32_16x16x32_bf16 v[64:67], a[60:63], a[140:143], v[64:67]
v_cvt_pk_bf16_f32 v207, v38, v39
v_mul_f32 v44, v44, v124
s_waitcnt lgkmcnt(7)
v_mfma_f32_16x16x32_bf16 v[52:55], a[64:67], a[144:147], v[52:55]
ds_read_b128 a[28:31], v202 offset:23552
v_mul_f32 v45, v45, v125
v_mfma_f32_16x16x32_bf16 v[56:59], a[64:67], a[148:151], v[56:59]
v_mul_f32 v46, v46, v126
v_mul_f32 v47, v47, v127
v_mfma_f32_16x16x32_bf16 v[60:63], a[68:71], a[144:147], v[60:63]
ds_read_b128 a[32:35], v202 offset:31744
v_cvt_pk_bf16_f32 v208, v44, v45
v_mfma_f32_16x16x32_bf16 v[64:67], a[68:71], a[148:151], v[64:67]
v_cvt_pk_bf16_f32 v209, v46, v47
s_waitcnt lgkmcnt(7)
v_mfma_f32_16x16x32_bf16 v[52:55], a[0:3], a[152:155], v[52:55]
ds_read_b128 a[36:39], v202 offset:32768
buffer_store_dwordx4 v[206:209], v1, s[8:11], s64 offen offset:0 sc1
v_mul_f32 v40, v40, v120
v_mul_f32 v41, v41, v121
v_mfma_f32_16x16x32_bf16 v[56:59], a[0:3], a[156:159], v[56:59]
v_mul_f32 v42, v42, v122
v_mul_f32 v43, v43, v123
v_mfma_f32_16x16x32_bf16 v[60:63], a[4:7], a[152:155], v[60:63]
ds_read_b128 a[40:43], v202 offset:6144
v_cvt_pk_bf16_f32 v210, v40, v41
v_mfma_f32_16x16x32_bf16 v[64:67], a[4:7], a[156:159], v[64:67]
v_cvt_pk_bf16_f32 v211, v42, v43
v_mul_f32 v48, v48, v128
s_waitcnt lgkmcnt(7)
v_mfma_f32_16x16x32_bf16 v[68:71], a[8:11], a[128:131], v[68:71]
ds_read_b128 a[44:47], v202 offset:7168
v_mul_f32 v49, v49, v129
v_mfma_f32_16x16x32_bf16 v[72:75], a[8:11], a[132:135], v[72:75]
v_mul_f32 v50, v50, v130
v_mul_f32 v51, v51, v131
v_mfma_f32_16x16x32_bf16 v[76:79], a[12:15], a[128:131], v[76:79]
ds_read_b128 a[48:51], v202 offset:15360
v_cvt_pk_bf16_f32 v212, v48, v49
v_cvt_pk_bf16_f32 v213, v50, v51
buffer_store_dwordx4 v[210:213], v204, s[8:11], s64 offen offset:0 sc1
v_mfma_f32_16x16x32_bf16 v[80:83], a[12:15], a[132:135], v[80:83]
v_mul_f32 v52, v52, v132
s_waitcnt lgkmcnt(7)
v_mfma_f32_16x16x32_bf16 v[68:71], a[16:19], a[136:139], v[68:71]
ds_read_b128 a[52:55], v202 offset:16384
v_mul_f32 v53, v53, v133
v_mfma_f32_16x16x32_bf16 v[72:75], a[16:19], a[140:143], v[72:75]
v_mul_f32 v54, v54, v134
v_mul_f32 v55, v55, v135
v_mfma_f32_16x16x32_bf16 v[76:79], a[20:23], a[136:139], v[76:79]
ds_read_b128 a[56:59], v202 offset:24576
v_cvt_pk_bf16_f32 v214, v52, v53
v_mfma_f32_16x16x32_bf16 v[80:83], a[20:23], a[140:143], v[80:83]
v_cvt_pk_bf16_f32 v215, v54, v55
v_mul_f32 v60, v60, v140
s_waitcnt lgkmcnt(7)
v_mfma_f32_16x16x32_bf16 v[68:71], a[24:27], a[144:147], v[68:71]
ds_read_b128 a[60:63], v202 offset:25600
v_mul_f32 v61, v61, v141
v_mfma_f32_16x16x32_bf16 v[72:75], a[24:27], a[148:151], v[72:75]
v_mul_f32 v62, v62, v142
v_mul_f32 v63, v63, v143
v_mfma_f32_16x16x32_bf16 v[76:79], a[28:31], a[144:147], v[76:79]
ds_read_b128 a[64:67], v202 offset:33792
v_cvt_pk_bf16_f32 v216, v60, v61
v_mfma_f32_16x16x32_bf16 v[80:83], a[28:31], a[148:151], v[80:83]
v_cvt_pk_bf16_f32 v217, v62, v63
s_waitcnt lgkmcnt(7)
v_mfma_f32_16x16x32_bf16 v[68:71], a[32:35], a[152:155], v[68:71]
ds_read_b128 a[68:71], v202 offset:34816
buffer_store_dwordx4 v[214:217], v1, s[8:11], s64 offen offset:1024 sc1
v_mul_f32 v56, v56, v136
v_mul_f32 v57, v57, v137
v_mfma_f32_16x16x32_bf16 v[72:75], a[32:35], a[156:159], v[72:75]
v_mul_f32 v58, v58, v138
v_mul_f32 v59, v59, v139
v_mfma_f32_16x16x32_bf16 v[76:79], a[36:39], a[152:155], v[76:79]
v_cvt_pk_bf16_f32 v218, v56, v57
v_cvt_pk_bf16_f32 v219, v58, v59
v_mfma_f32_16x16x32_bf16 v[80:83], a[36:39], a[156:159], v[80:83]
v_mul_f32 v64, v64, v144
s_waitcnt lgkmcnt(6)
v_mfma_f32_16x16x32_bf16 v[84:87], a[40:43], a[128:131], v[84:87]
v_mul_f32 v65, v65, v145
v_mul_f32 v66, v66, v146
v_mfma_f32_16x16x32_bf16 v[88:91], a[40:43], a[132:135], v[88:91]
v_mul_f32 v67, v67, v147
v_cvt_pk_bf16_f32 v220, v64, v65
v_mfma_f32_16x16x32_bf16 v[92:95], a[44:47], a[128:131], v[92:95]
v_cvt_pk_bf16_f32 v221, v66, v67
buffer_store_dwordx4 v[218:221], v204, s[8:11], s64 offen offset:1024 sc1
v_mfma_f32_16x16x32_bf16 v[96:99], a[44:47], a[132:135], v[96:99]
v_mul_f32 v68, v68, v148
s_waitcnt lgkmcnt(4)
v_mfma_f32_16x16x32_bf16 v[84:87], a[48:51], a[136:139], v[84:87]
v_mul_f32 v69, v69, v149
v_mul_f32 v70, v70, v150
v_mfma_f32_16x16x32_bf16 v[88:91], a[48:51], a[140:143], v[88:91]
v_mul_f32 v71, v71, v151
v_cvt_pk_bf16_f32 v222, v68, v69
v_mfma_f32_16x16x32_bf16 v[92:95], a[52:55], a[136:139], v[92:95]
v_cvt_pk_bf16_f32 v223, v70, v71
v_mul_f32 v76, v76, v156
v_mfma_f32_16x16x32_bf16 v[96:99], a[52:55], a[140:143], v[96:99]
v_mul_f32 v77, v77, v157
s_waitcnt lgkmcnt(2)
v_mfma_f32_16x16x32_bf16 v[84:87], a[56:59], a[144:147], v[84:87]
v_mul_f32 v78, v78, v158
v_mul_f32 v79, v79, v159
v_mfma_f32_16x16x32_bf16 v[88:91], a[56:59], a[148:151], v[88:91]
v_cvt_pk_bf16_f32 v224, v76, v77
v_cvt_pk_bf16_f32 v225, v78, v79
v_mfma_f32_16x16x32_bf16 v[92:95], a[60:63], a[144:147], v[92:95]
buffer_store_dwordx4 v[222:225], v1, s[8:11], s64 offen offset:2048 sc1
v_mul_f32 v72, v72, v152
v_mfma_f32_16x16x32_bf16 v[96:99], a[60:63], a[148:151], v[96:99]
v_mul_f32 v73, v73, v153
v_mul_f32 v74, v74, v154
s_waitcnt lgkmcnt(0)
v_mfma_f32_16x16x32_bf16 v[84:87], a[64:67], a[152:155], v[84:87]
v_mul_f32 v75, v75, v155
v_cvt_pk_bf16_f32 v226, v72, v73
v_mfma_f32_16x16x32_bf16 v[88:91], a[64:67], a[156:159], v[88:91]
v_cvt_pk_bf16_f32 v227, v74, v75
v_mul_f32 v80, v80, v160
v_mfma_f32_16x16x32_bf16 v[92:95], a[68:71], a[152:155], v[92:95]
v_mul_f32 v81, v81, v161
v_mul_f32 v82, v82, v162
v_mfma_f32_16x16x32_bf16 v[96:99], a[68:71], a[156:159], v[96:99]
v_mul_f32 v83, v83, v163
v_cvt_pk_bf16_f32 v228, v80, v81
v_cvt_pk_bf16_f32 v229, v82, v83
buffer_store_dwordx4 v[226:229], v204, s[8:11], s64 offen offset:2048 sc1
s_nop 1
v_pk_mul_f32 v[84:85], v[84:85], v[164:165]
v_pk_mul_f32 v[86:87], v[86:87], v[166:167]
v_cvt_pk_bf16_f32 v230, v84, v85
v_cvt_pk_bf16_f32 v231, v86, v87
v_pk_mul_f32 v[92:93], v[92:93], v[172:173]
v_pk_mul_f32 v[94:95], v[94:95], v[174:175]
v_cvt_pk_bf16_f32 v232, v92, v93
v_cvt_pk_bf16_f32 v233, v94, v95
buffer_store_dwordx4 v[230:233], v1, s[8:11], s64 offen offset:3072 sc1
v_pk_mul_f32 v[88:89], v[88:89], v[168:169]
v_pk_mul_f32 v[90:91], v[90:91], v[170:171]
v_cvt_pk_bf16_f32 v234, v88, v89
v_cvt_pk_bf16_f32 v235, v90, v91
v_pk_mul_f32 v[96:97], v[96:97], v[176:177]
v_pk_mul_f32 v[98:99], v[98:99], v[178:179]
v_cvt_pk_bf16_f32 v236, v96, v97
v_cvt_pk_bf16_f32 v237, v98, v99
buffer_store_dwordx4 v[234:237], v204, s[8:11], s64 offen offset:3072 sc1
L_c5:
buffer_load_dwordx4 v1, s[4:7], s39 offen offset:1024 sc1 lds
buffer_load_dwordx4 v1, s[4:7], s39 offen offset:2048 sc1 lds
buffer_load_dwordx4 v1, s[4:7], s39 offen offset:3072 sc1 lds
s_add_u32 m0, m0, 4096
s_add_u32 s39, s39, 4096
buffer_load_dwordx4 v1, s[4:7], s39 offen offset:0 sc1 lds
s_mul_i32 s38, s24, 9216
s_add_u32 m0, s38, 90112
s_add_u32 s39, s38, s83
s_add_u32 s39, s39, 90112
buffer_load_dwordx4 v1, s[4:7], s39 offen offset:0 sc1 lds
buffer_load_dwordx4 v1, s[4:7], s39 offen offset:1024 sc1 lds
buffer_load_dwordx4 v1, s[4:7], s39 offen offset:2048 sc1 lds
v_lshlrev_b32 v7, 3, v1
s_lshl_b32 s31, s25, 11
v_add_u32 v7, s31, v7
s_cmp_eq_u32 s24, 0
s_cselect_b32 s30, 0, 1073741824
s_add_u32 s30, s30, 26574848
s_waitcnt vmcnt(7)
s_barrier
s_mov_b64 exec, 0xffff
buffer_atomic_add v4, v7, s[8:11], s30 offen sc1
s_mov_b64 exec, -1
s_lshl_b32 s35, s81, 7
s_add_u32 s35, s35, 26574848
s_cmp_eq_u32 s24, 1
s_cselect_b32 s35, s35, 1073741824
v_mov_b32 v6, 0
v_mov_b32 v244, 0
v_mov_b32 v245, 0
v_mov_b32 v246, 0
buffer_load_dwordx4 v1, s[4:7], s39 offen offset:3072 sc1 lds
s_add_u32 m0, m0, 4096
s_add_u32 s39, s39, 4096
buffer_load_dwordx4 v1, s[4:7], s39 offen offset:0 sc1 lds
buffer_load_dwordx4 v1, s[4:7], s39 offen offset:1024 sc1 lds
buffer_load_dwordx4 v1, s[4:7], s39 offen offset:2048 sc1 lds
s_mov_b64 exec, 1
buffer_atomic_add v244, v6, s[8:11], s35 offen sc0 sc1
s_mov_b64 exec, -1
buffer_load_dwordx4 v1, s[4:7], s39 offen offset:3072 sc1 lds
s_add_u32 m0, m0, 4096
s_add_u32 s39, s39, 4096
buffer_load_dwordx4 v1, s[4:7], s39 offen offset:0 sc1 lds
s_mul_i32 s38, s24, 9216
s_add_u32 m0, s38, 126976
s_add_u32 s39, s38, s83
s_add_u32 s39, s39, 126976
buffer_load_dwordx4 v1, s[4:7], s39 offen offset:0 sc1 lds
buffer_load_dwordx4 v1, s[4:7], s39 offen offset:1024 sc1 lds
s_mov_b64 exec, 1
buffer_atomic_add v245, v6, s[8:11], s35 offen sc0 sc1
s_mov_b64 exec, -1
buffer_load_dwordx4 v1, s[4:7], s39 offen offset:2048 sc1 lds
buffer_load_dwordx4 v1, s[4:7], s39 offen offset:3072 sc1 lds
s_add_u32 m0, m0, 4096
s_add_u32 s39, s39, 4096
buffer_load_dwordx4 v1, s[4:7], s39 offen offset:0 sc1 lds
buffer_load_dwordx4 v1, s[4:7], s39 offen offset:1024 sc1 lds
s_mov_b64 exec, 1
buffer_atomic_add v246, v6, s[8:11], s35 offen sc0 sc1
s_mov_b64 exec, -1
buffer_load_dwordx4 v1, s[4:7], s39 offen offset:2048 sc1 lds
buffer_load_dwordx4 v1, s[4:7], s39 offen offset:3072 sc1 lds
s_add_u32 m0, m0, 4096
s_add_u32 s39, s39, 4096
buffer_load_dwordx4 v1, s[4:7], s39 offen offset:0 sc1 lds
s_xor_b32 s30, s27, 1
s_lshl_b32 s60, s30, 2
s_add_u32 s60, s60, s24
s_mul_i32 s60, s60, 73728
s_and_b32 s32, s27, 1
s_mul_i32 s32, s32, 36864
s_add_u32 s32, s32, 16777216
s_add_u32 s60, s60, s32
s_lshl_b32 s61, s27, 2
s_add_u32 s61, s61, s24
s_mul_i32 s61, s61, 73728
s_add_u32 s61, s61, s32
s_cmp_eq_u32 s24, 1
s_cbranch_scc0 L_other_33
s_mov_b32 s31, 0
s_mov_b64 exec, 1
v_mov_b32 v247, 0
buffer_atomic_add v247, v6, s[8:11], s35 offen sc0 sc1
s_waitcnt vmcnt(14)
v_cmp_gt_u32 vcc, 16, v244
s_nop 0
s_cbranch_vccz L_polled_32
s_waitcnt vmcnt(9)
v_cmp_gt_u32 vcc, 16, v245
s_nop 0
s_cbranch_vccz L_polled_32
v_mov_b32 v244, 0
buffer_atomic_add v244, v6, s[8:11], s35 offen sc0 sc1
s_waitcnt vmcnt(5)
v_cmp_gt_u32 vcc, 16, v246
s_nop 0
s_cbranch_vccz L_polled_32
v_mov_b32 v245, 0
buffer_atomic_add v245, v6, s[8:11], s35 offen sc0 sc1
L_poll_31:
s_add_u32 s31, s31, 1
s_cmp_gt_u32 s31, 100000
s_cbranch_scc1 L_polled_32
v_mov_b32 v246, 0
buffer_atomic_add v246, v6, s[8:11], s35 offen sc0 sc1
s_waitcnt vmcnt(3)
v_cmp_gt_u32 vcc, 16, v247
s_nop 0
s_cbranch_vccz L_polled_32
v_mov_b32 v247, 0
buffer_atomic_add v247, v6, s[8:11], s35 offen sc0 sc1
s_waitcnt vmcnt(3)
v_cmp_gt_u32 vcc, 16, v244
s_nop 0
s_cbranch_vccz L_polled_32
v_mov_b32 v244, 0
buffer_atomic_add v244, v6, s[8:11], s35 offen sc0 sc1
s_waitcnt vmcnt(3)
v_cmp_gt_u32 vcc, 16, v245
s_nop 0
s_cbranch_vccz L_polled_32
v_mov_b32 v245, 0
buffer_atomic_add v245, v6, s[8:11], s35 offen sc0 sc1
s_waitcnt vmcnt(3)
v_cmp_gt_u32 vcc, 16, v246
s_nop 0
s_cbranch_vccz L_polled_32
s_branch L_poll_31
L_polled_32:
s_mov_b64 exec, -1
L_other_33:
s_barrier
buffer_load_dwordx4 a[0:3], v1, s[8:11], s60 offen offset:0 sc1
buffer_load_dwordx4 a[4:7], v1, s[8:11], s60 offen offset:1024 sc1
s_barrier
buffer_load_dwordx4 a[8:11], v1, s[8:11], s60 offen offset:2048 sc1
buffer_load_dwordx4 a[12:15], v1, s[8:11], s60 offen offset:3072 sc1
s_barrier
s_add_u32 s60, s60, 4096
buffer_load_dwordx4 a[16:19], v1, s[8:11], s60 offen offset:0 sc1
buffer_load_dwordx4 a[20:23], v1, s[8:11], s60 offen offset:1024 sc1
s_barrier
buffer_load_dwordx4 a[24:27], v1, s[8:11], s60 offen offset:2048 sc1
buffer_load_dwordx4 a[28:31], v1, s[8:11], s60 offen offset:3072 sc1
v_and_b32 v40, 7, v2
v_lshlrev_b32 v40, 4, v40
v_lshl_add_u32 v40, v3, 7, v40
v_add_u32 v40, 4096, v40
s_lshl_b32 s63, s81, 14
s_lshl_b32 s30, s24, 12
s_add_u32 s63, s63, s30
s_xor_b32 s62, s63, 131072
s_add_u32 s63, s63, 26640384
s_add_u32 s62, s62, 26640384
s_add_u32 s64, s83, 161280
v_mov_b32 v116, v40
v_add_u32 v36, 0, v1
v_add_u32 v37, 55296, v1
v_add_u32 v41, 55296, v40
v_add_u32 v38, 110592, v1
v_add_u32 v42, 110592, v40
ds_read_b128 a[160:163], v36 offset:0
ds_read_b128 a[164:167], v36 offset:1024
ds_read_b128 a[168:171], v36 offset:2048
ds_read_b128 a[172:175], v36 offset:3072
ds_read_b128 a[176:179], v40 offset:0
ds_read_b128 a[180:183], v36 offset:4608
ds_read_b128 a[184:187], v36 offset:5632
ds_read_b128 a[188:191], v36 offset:6656
ds_read_b128 a[192:195], v36 offset:7680
ds_read_b128 a[196:199], v40 offset:4608
s_lshl_b32 s30, s27, 2
s_add_u32 s30, s30, s24
v_mov_b32 v138, 1073741824
s_mul_i32 s66, s30, 18432
s_mul_i32 s32, s28, 2304
s_add_u32 s66, s66, s32
s_add_u32 s66, s66, 30834688
v_mov_b32 v140, v1
v_add_u32 v141, 2048, v140
v_cndmask_b32 v141, v138, v141, s[46:47]
s_lshl_b32 s67, s30, 7
s_lshl_b32 s32, s28, 14
s_add_u32 s67, s67, s32
s_add_u32 s67, s67, 33193984
v_lshlrev_b32 v139, 3, v2
v_cndmask_b32 v138, v138, v139, s[46:47]
s_lshl_b32 s30, s27, 2
s_add_u32 s30, s30, s24
v_mov_b32 v162, 1073741824
s_mul_i32 s68, s30, 18432
s_mul_i32 s32, s28, 144
s_add_u32 s68, s68, s32
v_mul_u32_u24 v164, 1152, v2
v_lshl_add_u32 v164, v3, 4, v164
v_add_u32 v165, 128, v164
v_cndmask_b32 v165, v162, v165, s[46:47]
s_waitcnt vmcnt(7) lgkmcnt(5)
v_mfma_f32_16x16x32_bf16 v[44:47], a[160:163], a[0:3], 0
ds_read_b128 a[200:203], v36 offset:9216
s_add_u32 s60, s60, 4096
buffer_load_dwordx4 a[32:35], v1, s[8:11], s60 offen offset:0 sc1
v_mfma_f32_16x16x32_bf16 v[48:51], a[164:167], a[0:3], 0
ds_read_b128 a[204:207], v36 offset:10240
v_mfma_f32_16x16x32_bf16 v[52:55], a[168:171], a[0:3], 0
ds_read_b128 a[208:211], v36 offset:11264
v_mfma_f32_16x16x32_bf16 v[56:59], a[172:175], a[0:3], 0
ds_read_b128 a[212:215], v36 offset:12288
v_mfma_f32_16x16x32_bf16 v[60:63], a[176:179], a[0:3], 0
ds_read_b128 a[216:219], v40 offset:9216
s_waitcnt vmcnt(7) lgkmcnt(5)
v_mfma_f32_16x16x32_bf16 v[44:47], a[180:183], a[4:7], v[44:47]
ds_read_b128 a[160:163], v36 offset:13824
buffer_load_dwordx4 a[36:39], v1, s[8:11], s60 offen offset:1024 sc1
v_mfma_f32_16x16x32_bf16 v[48:51], a[184:187], a[4:7], v[48:51]
ds_read_b128 a[164:167], v36 offset:14848
v_mfma_f32_16x16x32_bf16 v[52:55], a[188:191], a[4:7], v[52:55]
ds_read_b128 a[168:171], v36 offset:15872
v_mfma_f32_16x16x32_bf16 v[56:59], a[192:195], a[4:7], v[56:59]
ds_read_b128 a[172:175], v36 offset:16896
v_mfma_f32_16x16x32_bf16 v[60:63], a[196:199], a[4:7], v[60:63]
ds_read_b128 a[176:179], v40 offset:13824
s_waitcnt vmcnt(7) lgkmcnt(5)
v_mfma_f32_16x16x32_bf16 v[44:47], a[200:203], a[8:11], v[44:47]
ds_read_b128 a[180:183], v36 offset:18432
buffer_load_dwordx4 a[40:43], v1, s[8:11], s60 offen offset:2048 sc1
v_mfma_f32_16x16x32_bf16 v[48:51], a[204:207], a[8:11], v[48:51]
ds_read_b128 a[184:187], v36 offset:19456
v_mov_b32 v67, v248
v_mfma_f32_16x16x32_bf16 v[52:55], a[208:211], a[8:11], v[52:55]
ds_read_b128 a[188:191], v36 offset:20480
buffer_load_dwordx4 a[44:47], v1, s[8:11], s60 offen offset:3072 sc1
v_mfma_f32_16x16x32_bf16 v[56:59], a[212:215], a[8:11], v[56:59]
ds_read_b128 a[192:195], v36 offset:21504
v_mfma_f32_16x16x32_bf16 v[60:63], a[216:219], a[8:11], v[60:63]
ds_read_b128 a[196:199], v40 offset:18432
s_waitcnt vmcnt(8) lgkmcnt(5)
v_mfma_f32_16x16x32_bf16 v[44:47], a[160:163], a[12:15], v[44:47]
ds_read_b128 a[200:203], v36 offset:23040
s_add_u32 s60, s60, 4096
buffer_load_dwordx4 a[48:51], v1, s[8:11], s60 offen offset:0 sc1
v_mfma_f32_16x16x32_bf16 v[48:51], a[164:167], a[12:15], v[48:51]
ds_read_b128 a[204:207], v36 offset:24064
v_mfma_f32_16x16x32_bf16 v[52:55], a[168:171], a[12:15], v[52:55]
ds_read_b128 a[208:211], v36 offset:25088
v_mov_b32 v71, v248
v_mfma_f32_16x16x32_bf16 v[56:59], a[172:175], a[12:15], v[56:59]
ds_read_b128 a[212:215], v36 offset:26112
v_mfma_f32_16x16x32_bf16 v[60:63], a[176:179], a[12:15], v[60:63]
ds_read_b128 a[216:219], v40 offset:23040
s_waitcnt vmcnt(8) lgkmcnt(5)
v_mfma_f32_16x16x32_bf16 v[44:47], a[180:183], a[16:19], v[44:47]
ds_read_b128 a[160:163], v36 offset:27648
buffer_load_dwordx4 a[52:55], v1, s[8:11], s60 offen offset:1024 sc1
v_mfma_f32_16x16x32_bf16 v[48:51], a[184:187], a[16:19], v[48:51]
ds_read_b128 a[164:167], v36 offset:28672
v_mfma_f32_16x16x32_bf16 v[52:55], a[188:191], a[16:19], v[52:55]
ds_read_b128 a[168:171], v36 offset:29696
v_mfma_f32_16x16x32_bf16 v[56:59], a[192:195], a[16:19], v[56:59]
ds_read_b128 a[172:175], v36 offset:30720
v_mfma_f32_16x16x32_bf16 v[60:63], a[196:199], a[16:19], v[60:63]
ds_read_b128 a[176:179], v40 offset:27648
s_waitcnt vmcnt(8) lgkmcnt(5)
v_mfma_f32_16x16x32_bf16 v[44:47], a[200:203], a[20:23], v[44:47]
ds_read_b128 a[180:183], v36 offset:32256
buffer_load_dwordx4 a[56:59], v1, s[8:11], s60 offen offset:2048 sc1
v_mfma_f32_16x16x32_bf16 v[48:51], a[204:207], a[20:23], v[48:51]
ds_read_b128 a[184:187], v36 offset:33280
v_mov_b32 v75, v248
v_mfma_f32_16x16x32_bf16 v[52:55], a[208:211], a[20:23], v[52:55]
ds_read_b128 a[188:191], v36 offset:34304
buffer_load_dwordx4 a[60:63], v1, s[8:11], s60 offen offset:3072 sc1
v_mfma_f32_16x16x32_bf16 v[56:59], a[212:215], a[20:23], v[56:59]
ds_read_b128 a[192:195], v36 offset:35328
v_mfma_f32_16x16x32_bf16 v[60:63], a[216:219], a[20:23], v[60:63]
ds_read_b128 a[196:199], v40 offset:32256
s_waitcnt vmcnt(9) lgkmcnt(5)
v_mfma_f32_16x16x32_bf16 v[44:47], a[160:163], a[24:27], v[44:47]
ds_read_b128 a[200:203], v36 offset:36864
s_add_u32 s60, s60, 4096
buffer_load_dwordx4 a[64:67], v1, s[8:11], s60 offen offset:0 sc1
v_mfma_f32_16x16x32_bf16 v[48:51], a[164:167], a[24:27], v[48:51]
ds_read_b128 a[204:207], v36 offset:37888
v_mfma_f32_16x16x32_bf16 v[52:55], a[168:171], a[24:27], v[52:55]
ds_read_b128 a[208:211], v36 offset:38912
v_mfma_f32_16x16x32_bf16 v[56:59], a[172:175], a[24:27], v[56:59]
ds_read_b128 a[212:215], v36 offset:39936
v_mov_b32 v79, v248
v_mfma_f32_16x16x32_bf16 v[60:63], a[176:179], a[24:27], v[60:63]
ds_read_b128 a[216:219], v40 offset:36864
s_waitcnt vmcnt(9) lgkmcnt(5)
v_mfma_f32_16x16x32_bf16 v[44:47], a[180:183], a[28:31], v[44:47]
ds_read_b128 a[160:163], v36 offset:41472
buffer_load_dwordx4 a[0:3], v1, s[8:11], s60 offen offset:1024 sc1
v_mfma_f32_16x16x32_bf16 v[48:51], a[184:187], a[28:31], v[48:51]
ds_read_b128 a[164:167], v36 offset:42496
v_mfma_f32_16x16x32_bf16 v[52:55], a[188:191], a[28:31], v[52:55]
ds_read_b128 a[168:171], v36 offset:43520
v_mfma_f32_16x16x32_bf16 v[56:59], a[192:195], a[28:31], v[56:59]
ds_read_b128 a[172:175], v36 offset:44544
v_mfma_f32_16x16x32_bf16 v[60:63], a[196:199], a[28:31], v[60:63]
ds_read_b128 a[176:179], v40 offset:41472
s_waitcnt vmcnt(9) lgkmcnt(5)
v_mfma_f32_16x16x32_bf16 v[44:47], a[200:203], a[32:35], v[44:47]
ds_read_b128 a[180:183], v36 offset:46080
buffer_load_dwordx4 a[4:7], v1, s[8:11], s60 offen offset:2048 sc1
v_mfma_f32_16x16x32_bf16 v[48:51], a[204:207], a[32:35], v[48:51]
ds_read_b128 a[184:187], v36 offset:47104
v_mfma_f32_16x16x32_bf16 v[52:55], a[208:211], a[32:35], v[52:55]
ds_read_b128 a[188:191], v36 offset:48128
buffer_load_dwordx4 a[8:11], v1, s[8:11], s60 offen offset:3072 sc1
v_mfma_f32_16x16x32_bf16 v[56:59], a[212:215], a[32:35], v[56:59]
ds_read_b128 a[192:195], v36 offset:49152
v_mfma_f32_16x16x32_bf16 v[60:63], a[216:219], a[32:35], v[60:63]
ds_read_b128 a[196:199], v40 offset:46080
s_barrier
s_waitcnt vmcnt(10) lgkmcnt(5)
v_mfma_f32_16x16x32_bf16 v[44:47], a[160:163], a[36:39], v[44:47]
ds_read_b128 a[200:203], v36 offset:50688
s_add_u32 s60, s60, 4096
buffer_load_dwordx4 a[12:15], v1, s[8:11], s60 offen offset:0 sc1
v_mfma_f32_16x16x32_bf16 v[48:51], a[164:167], a[36:39], v[48:51]
ds_read_b128 a[204:207], v36 offset:51712
v_mfma_f32_16x16x32_bf16 v[52:55], a[168:171], a[36:39], v[52:55]
ds_read_b128 a[208:211], v36 offset:52736
v_mfma_f32_16x16x32_bf16 v[56:59], a[172:175], a[36:39], v[56:59]
ds_read_b128 a[212:215], v36 offset:53760
v_mfma_f32_16x16x32_bf16 v[60:63], a[176:179], a[36:39], v[60:63]
ds_read_b128 a[216:219], v40 offset:50688
s_waitcnt vmcnt(10) lgkmcnt(5)
v_mfma_f32_16x16x32_bf16 v[44:47], a[180:183], a[40:43], v[44:47]
ds_read_b128 a[160:163], v37 offset:0
buffer_load_dwordx4 a[16:19], v1, s[8:11], s60 offen offset:1024 sc1
v_mfma_f32_16x16x32_bf16 v[48:51], a[184:187], a[40:43], v[48:51]
ds_read_b128 a[164:167], v37 offset:1024
v_mfma_f32_16x16x32_bf16 v[52:55], a[188:191], a[40:43], v[52:55]
ds_read_b128 a[168:171], v37 offset:2048
v_mfma_f32_16x16x32_bf16 v[56:59], a[192:195], a[40:43], v[56:59]
ds_read_b128 a[172:175], v37 offset:3072
v_mfma_f32_16x16x32_bf16 v[60:63], a[196:199], a[40:43], v[60:63]
ds_read_b128 a[176:179], v41 offset:0
s_waitcnt vmcnt(10) lgkmcnt(5)
v_mfma_f32_16x16x32_bf16 v[44:47], a[200:203], a[44:47], v[44:47]
ds_read_b128 a[180:183], v37 offset:4608
buffer_load_dwordx4 a[20:23], v1, s[8:11], s60 offen offset:2048 sc1
v_mfma_f32_16x16x32_bf16 v[48:51], a[204:207], a[44:47], v[48:51]
ds_read_b128 a[184:187], v37 offset:5632
v_mfma_f32_16x16x32_bf16 v[52:55], a[208:211], a[44:47], v[52:55]
ds_read_b128 a[188:191], v37 offset:6656
buffer_load_dwordx4 a[24:27], v1, s[8:11], s60 offen offset:3072 sc1
v_mfma_f32_16x16x32_bf16 v[56:59], a[212:215], a[44:47], v[56:59]
ds_read_b128 a[192:195], v37 offset:7680
v_mfma_f32_16x16x32_bf16 v[60:63], a[216:219], a[44:47], v[60:63]
ds_read_b128 a[196:199], v41 offset:4608
s_waitcnt vmcnt(11) lgkmcnt(5)
v_mfma_f32_16x16x32_bf16 v[44:47], a[160:163], a[48:51], v[44:47]
ds_read_b128 a[200:203], v37 offset:9216
s_add_u32 s60, s60, 4096
buffer_load_dwordx4 a[28:31], v1, s[8:11], s60 offen offset:0 sc1
v_mfma_f32_16x16x32_bf16 v[48:51], a[164:167], a[48:51], v[48:51]
ds_read_b128 a[204:207], v37 offset:10240
v_mfma_f32_16x16x32_bf16 v[52:55], a[168:171], a[48:51], v[52:55]
ds_read_b128 a[208:211], v37 offset:11264
v_mfma_f32_16x16x32_bf16 v[56:59], a[172:175], a[48:51], v[56:59]
ds_read_b128 a[212:215], v37 offset:12288
v_mfma_f32_16x16x32_bf16 v[60:63], a[176:179], a[48:51], v[60:63]
ds_read_b128 a[216:219], v41 offset:9216
s_waitcnt vmcnt(11) lgkmcnt(5)
v_mfma_f32_16x16x32_bf16 v[44:47], a[180:183], a[52:55], v[44:47]
ds_read_b128 a[160:163], v37 offset:13824
buffer_load_dwordx4 a[32:35], v1, s[8:11], s60 offen offset:1024 sc1
v_mfma_f32_16x16x32_bf16 v[48:51], a[184:187], a[52:55], v[48:51]
ds_read_b128 a[164:167], v37 offset:14848
v_mfma_f32_16x16x32_bf16 v[52:55], a[188:191], a[52:55], v[52:55]
ds_read_b128 a[168:171], v37 offset:15872
v_mfma_f32_16x16x32_bf16 v[56:59], a[192:195], a[52:55], v[56:59]
ds_read_b128 a[172:175], v37 offset:16896
v_mfma_f32_16x16x32_bf16 v[60:63], a[196:199], a[52:55], v[60:63]
ds_read_b128 a[176:179], v41 offset:13824
s_waitcnt vmcnt(11) lgkmcnt(5)
v_mfma_f32_16x16x32_bf16 v[44:47], a[200:203], a[56:59], v[44:47]
ds_read_b128 a[180:183], v37 offset:18432
buffer_load_dwordx4 a[36:39], v1, s[8:11], s60 offen offset:2048 sc1
v_mfma_f32_16x16x32_bf16 v[48:51], a[204:207], a[56:59], v[48:51]
ds_read_b128 a[184:187], v37 offset:19456
v_mfma_f32_16x16x32_bf16 v[52:55], a[208:211], a[56:59], v[52:55]
ds_read_b128 a[188:191], v37 offset:20480
buffer_load_dwordx4 a[40:43], v1, s[8:11], s60 offen offset:3072 sc1
v_mfma_f32_16x16x32_bf16 v[56:59], a[212:215], a[56:59], v[56:59]
ds_read_b128 a[192:195], v37 offset:21504
v_mfma_f32_16x16x32_bf16 v[60:63], a[216:219], a[56:59], v[60:63]
ds_read_b128 a[196:199], v41 offset:18432
s_waitcnt vmcnt(12) lgkmcnt(5)
v_mfma_f32_16x16x32_bf16 v[44:47], a[160:163], a[60:63], v[44:47]
ds_read_b128 a[200:203], v37 offset:23040
s_add_u32 s60, s60, 4096
buffer_load_dwordx4 a[44:47], v1, s[8:11], s60 offen offset:0 sc1
v_mfma_f32_16x16x32_bf16 v[48:51], a[164:167], a[60:63], v[48:51]
ds_read_b128 a[204:207], v37 offset:24064
v_mfma_f32_16x16x32_bf16 v[52:55], a[168:171], a[60:63], v[52:55]
ds_read_b128 a[208:211], v37 offset:25088
v_mfma_f32_16x16x32_bf16 v[56:59], a[172:175], a[60:63], v[56:59]
ds_read_b128 a[212:215], v37 offset:26112
v_mfma_f32_16x16x32_bf16 v[60:63], a[176:179], a[60:63], v[60:63]
ds_read_b128 a[216:219], v41 offset:23040
s_waitcnt vmcnt(12) lgkmcnt(5)
v_mfma_f32_16x16x32_bf16 v[44:47], a[180:183], a[64:67], v[44:47]
ds_read_b128 a[160:163], v37 offset:27648
buffer_load_dwordx4 a[48:51], v1, s[8:11], s60 offen offset:1024 sc1
v_mfma_f32_16x16x32_bf16 v[48:51], a[184:187], a[64:67], v[48:51]
ds_read_b128 a[164:167], v37 offset:28672
buffer_load_dwordx4 a[228:231], v1, s[4:7], s64 offen offset:2048 sc1
v_mfma_f32_16x16x32_bf16 v[52:55], a[188:191], a[64:67], v[52:55]
ds_read_b128 a[168:171], v37 offset:29696
v_mfma_f32_16x16x32_bf16 v[56:59], a[192:195], a[64:67], v[56:59]
ds_read_b128 a[172:175], v37 offset:30720
v_mfma_f32_16x16x32_bf16 v[60:63], a[196:199], a[64:67], v[60:63]
ds_read_b128 a[176:179], v41 offset:27648
s_waitcnt vmcnt(13) lgkmcnt(5)
v_mfma_f32_16x16x32_bf16 v[44:47], a[200:203], a[0:3], v[44:47]
ds_read_b128 a[180:183], v37 offset:32256
buffer_load_dwordx4 a[52:55], v1, s[8:11], s60 offen offset:2048 sc1
v_mfma_f32_16x16x32_bf16 v[48:51], a[204:207], a[0:3], v[48:51]
ds_read_b128 a[184:187], v37 offset:33280
v_mfma_f32_16x16x32_bf16 v[52:55], a[208:211], a[0:3], v[52:55]
ds_read_b128 a[188:191], v37 offset:34304
buffer_load_dwordx4 a[56:59], v1, s[8:11], s60 offen offset:3072 sc1
v_mfma_f32_16x16x32_bf16 v[56:59], a[212:215], a[0:3], v[56:59]
ds_read_b128 a[192:195], v37 offset:35328
v_mfma_f32_16x16x32_bf16 v[60:63], a[216:219], a[0:3], v[60:63]
ds_read_b128 a[196:199], v41 offset:32256
s_waitcnt vmcnt(14) lgkmcnt(5)
v_mfma_f32_16x16x32_bf16 v[44:47], a[160:163], a[4:7], v[44:47]
ds_read_b128 a[200:203], v37 offset:36864
s_add_u32 s60, s60, 4096
buffer_load_dwordx4 a[60:63], v1, s[8:11], s60 offen offset:0 sc1
v_mfma_f32_16x16x32_bf16 v[48:51], a[164:167], a[4:7], v[48:51]
ds_read_b128 a[204:207], v37 offset:37888
v_mfma_f32_16x16x32_bf16 v[52:55], a[168:171], a[4:7], v[52:55]
ds_read_b128 a[208:211], v37 offset:38912
v_mfma_f32_16x16x32_bf16 v[56:59], a[172:175], a[4:7], v[56:59]
ds_read_b128 a[212:215], v37 offset:39936
buffer_load_dwordx4 a[232:235], v1, s[4:7], s64 offen offset:3072 sc1
v_mfma_f32_16x16x32_bf16 v[60:63], a[176:179], a[4:7], v[60:63]
ds_read_b128 a[216:219], v41 offset:36864
s_waitcnt vmcnt(15) lgkmcnt(5)
v_mfma_f32_16x16x32_bf16 v[44:47], a[180:183], a[8:11], v[44:47]
ds_read_b128 a[160:163], v37 offset:41472
buffer_load_dwordx4 a[64:67], v1, s[8:11], s60 offen offset:1024 sc1
v_mfma_f32_16x16x32_bf16 v[48:51], a[184:187], a[8:11], v[48:51]
ds_read_b128 a[164:167], v37 offset:42496
v_mfma_f32_16x16x32_bf16 v[52:55], a[188:191], a[8:11], v[52:55]
ds_read_b128 a[168:171], v37 offset:43520
v_mfma_f32_16x16x32_bf16 v[56:59], a[192:195], a[8:11], v[56:59]
ds_read_b128 a[172:175], v37 offset:44544
v_mfma_f32_16x16x32_bf16 v[60:63], a[196:199], a[8:11], v[60:63]
ds_read_b128 a[176:179], v41 offset:41472
s_waitcnt vmcnt(15) lgkmcnt(5)
v_mfma_f32_16x16x32_bf16 v[44:47], a[200:203], a[12:15], v[44:47]
ds_read_b128 a[180:183], v37 offset:46080
buffer_load_dwordx4 a[0:3], v1, s[8:11], s60 offen offset:2048 sc1
v_mfma_f32_16x16x32_bf16 v[48:51], a[204:207], a[12:15], v[48:51]
ds_read_b128 a[184:187], v37 offset:47104
v_mfma_f32_16x16x32_bf16 v[52:55], a[208:211], a[12:15], v[52:55]
ds_read_b128 a[188:191], v37 offset:48128
buffer_load_dwordx4 a[4:7], v1, s[8:11], s60 offen offset:3072 sc1
v_mfma_f32_16x16x32_bf16 v[56:59], a[212:215], a[12:15], v[56:59]
ds_read_b128 a[192:195], v37 offset:49152
v_mfma_f32_16x16x32_bf16 v[60:63], a[216:219], a[12:15], v[60:63]
ds_read_b128 a[196:199], v41 offset:46080
s_waitcnt vmcnt(16) lgkmcnt(5)
v_mfma_f32_16x16x32_bf16 v[44:47], a[160:163], a[16:19], v[44:47]
ds_read_b128 a[200:203], v37 offset:50688
s_mov_b32 s60, s61
buffer_load_dwordx4 a[8:11], v1, s[8:11], s60 offen offset:0 sc1
v_mfma_f32_16x16x32_bf16 v[48:51], a[164:167], a[16:19], v[48:51]
ds_read_b128 a[204:207], v37 offset:51712
v_mfma_f32_16x16x32_bf16 v[52:55], a[168:171], a[16:19], v[52:55]
ds_read_b128 a[208:211], v37 offset:52736
buffer_load_dwordx4 a[236:239], v116, s[4:7], s64 offen sc1
v_mfma_f32_16x16x32_bf16 v[56:59], a[172:175], a[16:19], v[56:59]
ds_read_b128 a[212:215], v37 offset:53760
v_mfma_f32_16x16x32_bf16 v[60:63], a[176:179], a[16:19], v[60:63]
ds_read_b128 a[216:219], v41 offset:50688
s_waitcnt vmcnt(17) lgkmcnt(5)
v_mfma_f32_16x16x32_bf16 v[44:47], a[180:183], a[20:23], v[44:47]
ds_read_b128 a[160:163], v38 offset:0
buffer_load_dwordx4 a[12:15], v1, s[8:11], s60 offen offset:1024 sc1
v_mfma_f32_16x16x32_bf16 v[48:51], a[184:187], a[20:23], v[48:51]
ds_read_b128 a[164:167], v38 offset:1024
v_mfma_f32_16x16x32_bf16 v[52:55], a[188:191], a[20:23], v[52:55]
ds_read_b128 a[168:171], v38 offset:2048
v_mfma_f32_16x16x32_bf16 v[56:59], a[192:195], a[20:23], v[56:59]
ds_read_b128 a[172:175], v38 offset:3072
v_mfma_f32_16x16x32_bf16 v[60:63], a[196:199], a[20:23], v[60:63]
ds_read_b128 a[176:179], v42 offset:0
s_waitcnt vmcnt(17) lgkmcnt(5)
v_mfma_f32_16x16x32_bf16 v[44:47], a[200:203], a[24:27], v[44:47]
ds_read_b128 a[180:183], v38 offset:4608
buffer_load_dwordx4 a[16:19], v1, s[8:11], s60 offen offset:2048 sc1
v_mfma_f32_16x16x32_bf16 v[48:51], a[204:207], a[24:27], v[48:51]
ds_read_b128 a[184:187], v38 offset:5632
v_mfma_f32_16x16x32_bf16 v[52:55], a[208:211], a[24:27], v[52:55]
ds_read_b128 a[188:191], v38 offset:6656
buffer_load_dwordx4 a[20:23], v1, s[8:11], s60 offen offset:3072 sc1
v_mfma_f32_16x16x32_bf16 v[56:59], a[212:215], a[24:27], v[56:59]
ds_read_b128 a[192:195], v38 offset:7680
v_mfma_f32_16x16x32_bf16 v[60:63], a[216:219], a[24:27], v[60:63]
ds_read_b128 a[196:199], v42 offset:4608
s_waitcnt vmcnt(18) lgkmcnt(5)
v_mfma_f32_16x16x32_bf16 v[44:47], a[160:163], a[28:31], v[44:47]
ds_read_b128 a[200:203], v38 offset:9216
s_add_u32 s60, s60, 4096
buffer_load_dwordx4 a[24:27], v1, s[8:11], s60 offen offset:0 sc1
v_mfma_f32_16x16x32_bf16 v[48:51], a[164:167], a[28:31], v[48:51]
ds_read_b128 a[204:207], v38 offset:10240
v_mfma_f32_16x16x32_bf16 v[52:55], a[168:171], a[28:31], v[52:55]
ds_read_b128 a[208:211], v38 offset:11264
v_mfma_f32_16x16x32_bf16 v[56:59], a[172:175], a[28:31], v[56:59]
ds_read_b128 a[212:215], v38 offset:12288
v_mfma_f32_16x16x32_bf16 v[60:63], a[176:179], a[28:31], v[60:63]
ds_read_b128 a[216:219], v42 offset:9216
s_waitcnt vmcnt(18) lgkmcnt(5)
v_mfma_f32_16x16x32_bf16 v[44:47], a[180:183], a[32:35], v[44:47]
ds_read_b128 a[160:163], v38 offset:13824
buffer_load_dwordx4 a[28:31], v1, s[8:11], s60 offen offset:1024 sc1
v_mfma_f32_16x16x32_bf16 v[48:51], a[184:187], a[32:35], v[48:51]
ds_read_b128 a[164:167], v38 offset:14848
v_mfma_f32_16x16x32_bf16 v[52:55], a[188:191], a[32:35], v[52:55]
ds_read_b128 a[168:171], v38 offset:15872
v_mfma_f32_16x16x32_bf16 v[56:59], a[192:195], a[32:35], v[56:59]
ds_read_b128 a[172:175], v38 offset:16896
v_mfma_f32_16x16x32_bf16 v[60:63], a[196:199], a[32:35], v[60:63]
ds_read_b128 a[176:179], v42 offset:13824
s_waitcnt vmcnt(18) lgkmcnt(5)
v_mfma_f32_16x16x32_bf16 v[44:47], a[200:203], a[36:39], v[44:47]
ds_read_b128 a[180:183], v38 offset:18432
buffer_load_dwordx4 a[32:35], v1, s[8:11], s60 offen offset:2048 sc1
v_mfma_f32_16x16x32_bf16 v[48:51], a[204:207], a[36:39], v[48:51]
ds_read_b128 a[184:187], v38 offset:19456
v_mfma_f32_16x16x32_bf16 v[52:55], a[208:211], a[36:39], v[52:55]
ds_read_b128 a[188:191], v38 offset:20480
v_mfma_f32_16x16x32_bf16 v[56:59], a[212:215], a[36:39], v[56:59]
ds_read_b128 a[192:195], v38 offset:21504
v_mfma_f32_16x16x32_bf16 v[60:63], a[216:219], a[36:39], v[60:63]
ds_read_b128 a[196:199], v42 offset:18432
s_waitcnt vmcnt(18) lgkmcnt(5)
v_mfma_f32_16x16x32_bf16 v[44:47], a[160:163], a[40:43], v[44:47]
ds_read_b128 a[200:203], v38 offset:23040
buffer_load_dwordx4 a[36:39], v1, s[8:11], s60 offen offset:3072 sc1
v_mfma_f32_16x16x32_bf16 v[48:51], a[164:167], a[40:43], v[48:51]
ds_read_b128 a[204:207], v38 offset:24064
v_mfma_f32_16x16x32_bf16 v[52:55], a[168:171], a[40:43], v[52:55]
ds_read_b128 a[208:211], v38 offset:25088
v_mfma_f32_16x16x32_bf16 v[56:59], a[172:175], a[40:43], v[56:59]
ds_read_b128 a[212:215], v38 offset:26112
v_mfma_f32_16x16x32_bf16 v[60:63], a[176:179], a[40:43], v[60:63]
ds_read_b128 a[216:219], v42 offset:23040
s_waitcnt vmcnt(18) lgkmcnt(5)
v_mfma_f32_16x16x32_bf16 v[44:47], a[180:183], a[44:47], v[44:47]
ds_read_b128 a[160:163], v38 offset:27648
s_add_u32 s60, s60, 4096
buffer_load_dwordx4 a[40:43], v1, s[8:11], s60 offen offset:0 sc1
v_mfma_f32_16x16x32_bf16 v[48:51], a[184:187], a[44:47], v[48:51]
ds_read_b128 a[164:167], v38 offset:28672
v_mfma_f32_16x16x32_bf16 v[52:55], a[188:191], a[44:47], v[52:55]
ds_read_b128 a[168:171], v38 offset:29696
v_mfma_f32_16x16x32_bf16 v[56:59], a[192:195], a[44:47], v[56:59]
ds_read_b128 a[172:175], v38 offset:30720
v_mfma_f32_16x16x32_bf16 v[60:63], a[196:199], a[44:47], v[60:63]
ds_read_b128 a[176:179], v42 offset:27648
s_waitcnt vmcnt(18) lgkmcnt(5)
v_mfma_f32_16x16x32_bf16 v[44:47], a[200:203], a[48:51], v[44:47]
ds_read_b128 a[180:183], v38 offset:32256
buffer_load_dwordx4 a[44:47], v1, s[8:11], s60 offen offset:1024 sc1
v_mfma_f32_16x16x32_bf16 v[48:51], a[204:207], a[48:51], v[48:51]
ds_read_b128 a[184:187], v38 offset:33280
v_mfma_f32_16x16x32_bf16 v[52:55], a[208:211], a[48:51], v[52:55]
ds_read_b128 a[188:191], v38 offset:34304
v_mfma_f32_16x16x32_bf16 v[56:59], a[212:215], a[48:51], v[56:59]
ds_read_b128 a[192:195], v38 offset:35328
v_mfma_f32_16x16x32_bf16 v[60:63], a[216:219], a[48:51], v[60:63]
ds_read_b128 a[196:199], v42 offset:32256
s_waitcnt vmcnt(17) lgkmcnt(5)
v_mfma_f32_16x16x32_bf16 v[44:47], a[160:163], a[52:55], v[44:47]
ds_read_b128 a[200:203], v38 offset:36864
buffer_load_dwordx4 a[48:51], v1, s[8:11], s60 offen offset:2048 sc1
v_mfma_f32_16x16x32_bf16 v[48:51], a[164:167], a[52:55], v[48:51]
ds_read_b128 a[204:207], v38 offset:37888
v_mfma_f32_16x16x32_bf16 v[52:55], a[168:171], a[52:55], v[52:55]
ds_read_b128 a[208:211], v38 offset:38912
v_mfma_f32_16x16x32_bf16 v[56:59], a[172:175], a[52:55], v[56:59]
ds_read_b128 a[212:215], v38 offset:39936
v_mfma_f32_16x16x32_bf16 v[60:63], a[176:179], a[52:55], v[60:63]
ds_read_b128 a[216:219], v42 offset:36864
s_waitcnt vmcnt(17) lgkmcnt(5)
v_mfma_f32_16x16x32_bf16 v[44:47], a[180:183], a[56:59], v[44:47]
ds_read_b128 a[160:163], v38 offset:41472
buffer_load_dwordx4 a[52:55], v1, s[8:11], s60 offen offset:3072 sc1
v_mfma_f32_16x16x32_bf16 v[48:51], a[184:187], a[56:59], v[48:51]
ds_read_b128 a[164:167], v38 offset:42496
v_mfma_f32_16x16x32_bf16 v[52:55], a[188:191], a[56:59], v[52:55]
ds_read_b128 a[168:171], v38 offset:43520
v_mfma_f32_16x16x32_bf16 v[56:59], a[192:195], a[56:59], v[56:59]
ds_read_b128 a[172:175], v38 offset:44544
v_mfma_f32_16x16x32_bf16 v[60:63], a[196:199], a[56:59], v[60:63]
ds_read_b128 a[176:179], v42 offset:41472
s_waitcnt vmcnt(17) lgkmcnt(5)
v_mfma_f32_16x16x32_bf16 v[44:47], a[200:203], a[60:63], v[44:47]
ds_read_b128 a[180:183], v38 offset:46080
s_add_u32 s60, s60, 4096
buffer_load_dwordx4 a[56:59], v1, s[8:11], s60 offen offset:0 sc1
v_mfma_f32_16x16x32_bf16 v[48:51], a[204:207], a[60:63], v[48:51]
ds_read_b128 a[184:187], v38 offset:47104
v_mfma_f32_16x16x32_bf16 v[52:55], a[208:211], a[60:63], v[52:55]
ds_read_b128 a[188:191], v38 offset:48128
v_mfma_f32_16x16x32_bf16 v[56:59], a[212:215], a[60:63], v[56:59]
ds_read_b128 a[192:195], v38 offset:49152
v_mfma_f32_16x16x32_bf16 v[60:63], a[216:219], a[60:63], v[60:63]
ds_read_b128 a[196:199], v42 offset:46080
s_waitcnt vmcnt(16) lgkmcnt(5)
v_mfma_f32_16x16x32_bf16 v[44:47], a[160:163], a[64:67], v[44:47]
ds_read_b128 a[200:203], v38 offset:50688
buffer_load_dwordx4 a[60:63], v1, s[8:11], s60 offen offset:1024 sc1
v_mfma_f32_16x16x32_bf16 v[48:51], a[164:167], a[64:67], v[48:51]
ds_read_b128 a[204:207], v38 offset:51712
v_mfma_f32_16x16x32_bf16 v[52:55], a[168:171], a[64:67], v[52:55]
v_mfma_f32_16x16x32_bf16 v[56:59], a[172:175], a[64:67], v[56:59]
v_mfma_f32_16x16x32_bf16 v[60:63], a[176:179], a[64:67], v[60:63]
s_waitcnt vmcnt(16) lgkmcnt(2)
v_mfma_f32_16x16x32_bf16 v[44:47], a[180:183], a[0:3], v[44:47]
ds_read_b128 a[160:163], v36 offset:0
buffer_load_dwordx4 a[64:67], v1, s[8:11], s60 offen offset:2048 sc1
v_mfma_f32_16x16x32_bf16 v[48:51], a[184:187], a[0:3], v[48:51]
ds_read_b128 a[164:167], v36 offset:1024
v_mfma_f32_16x16x32_bf16 v[52:55], a[188:191], a[0:3], v[52:55]
ds_read_b128 a[168:171], v36 offset:2048
v_mfma_f32_16x16x32_bf16 v[56:59], a[192:195], a[0:3], v[56:59]
ds_read_b128 a[172:175], v36 offset:3072
v_mfma_f32_16x16x32_bf16 v[60:63], a[196:199], a[0:3], v[60:63]
ds_read_b128 a[176:179], v40 offset:0
s_waitcnt vmcnt(14) lgkmcnt(5)
v_mfma_f32_16x16x32_bf16 v[44:47], a[200:203], a[4:7], v[44:47]
ds_read_b128 a[180:183], v36 offset:4608
buffer_load_dwordx4 a[0:3], v1, s[8:11], s60 offen offset:3072 sc1
v_mfma_f32_16x16x32_bf16 v[48:51], a[204:207], a[4:7], v[48:51]
ds_read_b128 a[184:187], v36 offset:5632
v_mfma_f32_16x16x32_bf16 v[52:55], a[228:231], a[4:7], v[52:55]
ds_read_b128 a[188:191], v36 offset:6656
v_mfma_f32_16x16x32_bf16 v[56:59], a[232:235], a[4:7], v[56:59]
ds_read_b128 a[192:195], v36 offset:7680
v_mfma_f32_16x16x32_bf16 v[60:63], a[236:239], a[4:7], v[60:63]
ds_read_b128 a[196:199], v40 offset:4608
s_waitcnt lgkmcnt(5)
v_mfma_f32_16x16x32_bf16 v[16:19], a[160:163], a[8:11], v[16:19]
ds_read_b128 a[200:203], v36 offset:9216
s_add_u32 s60, s60, 4096
buffer_load_dwordx4 a[4:7], v1, s[8:11], s60 offen offset:0 sc1
v_mfma_f32_16x16x32_bf16 v[20:23], a[164:167], a[8:11], v[20:23]
ds_read_b128 a[204:207], v36 offset:10240
v_mfma_f32_16x16x32_bf16 v[24:27], a[168:171], a[8:11], v[24:27]
ds_read_b128 a[208:211], v36 offset:11264
v_mfma_f32_16x16x32_bf16 v[28:31], a[172:175], a[8:11], v[28:31]
ds_read_b128 a[212:215], v36 offset:12288
v_mfma_f32_16x16x32_bf16 v[32:35], a[176:179], a[8:11], v[32:35]
ds_read_b128 a[216:219], v40 offset:9216
s_waitcnt vmcnt(15) lgkmcnt(5)
v_mfma_f32_16x16x32_bf16 v[16:19], a[180:183], a[12:15], v[16:19]
ds_read_b128 a[160:163], v36 offset:13824
buffer_load_dwordx4 a[8:11], v1, s[8:11], s60 offen offset:1024 sc1
v_mfma_f32_16x16x32_bf16 v[20:23], a[184:187], a[12:15], v[20:23]
ds_read_b128 a[164:167], v36 offset:14848
v_mfma_f32_16x16x32_bf16 v[24:27], a[188:191], a[12:15], v[24:27]
ds_read_b128 a[168:171], v36 offset:15872
v_mfma_f32_16x16x32_bf16 v[28:31], a[192:195], a[12:15], v[28:31]
ds_read_b128 a[172:175], v36 offset:16896
v_cvt_pk_bf16_f32 v64, v44, v45
v_mfma_f32_16x16x32_bf16 v[32:35], a[196:199], a[12:15], v[32:35]
ds_read_b128 a[176:179], v40 offset:13824
s_waitcnt vmcnt(15) lgkmcnt(5)
v_mfma_f32_16x16x32_bf16 v[16:19], a[200:203], a[16:19], v[16:19]
ds_read_b128 a[180:183], v36 offset:18432
buffer_load_dwordx4 a[12:15], v1, s[8:11], s60 offen offset:2048 sc1
v_mfma_f32_16x16x32_bf16 v[20:23], a[204:207], a[16:19], v[20:23]
ds_read_b128 a[184:187], v36 offset:19456
v_cvt_pk_bf16_f32 v65, v46, v47
v_mfma_f32_16x16x32_bf16 v[24:27], a[208:211], a[16:19], v[24:27]
ds_read_b128 a[188:191], v36 offset:20480
v_mfma_f32_16x16x32_bf16 v[28:31], a[212:215], a[16:19], v[28:31]
ds_read_b128 a[192:195], v36 offset:21504
v_mfma_f32_16x16x32_bf16 v[32:35], a[216:219], a[16:19], v[32:35]
ds_read_b128 a[196:199], v40 offset:18432
s_waitcnt vmcnt(15) lgkmcnt(5)
v_mfma_f32_16x16x32_bf16 v[16:19], a[160:163], a[20:23], v[16:19]
ds_read_b128 a[200:203], v36 offset:23040
buffer_load_dwordx4 a[16:19], v1, s[8:11], s60 offen offset:3072 sc1
v_mfma_f32_16x16x32_bf16 v[20:23], a[164:167], a[20:23], v[20:23]
ds_read_b128 a[204:207], v36 offset:24064
v_cvt_pk_bf16_f32 v66, v48, v49
v_mfma_f32_16x16x32_bf16 v[24:27], a[168:171], a[20:23], v[24:27]
ds_read_b128 a[208:211], v36 offset:25088
buffer_store_dwordx4 v[64:67], v1, s[8:11], s62 offen offset:0 sc1
v_mfma_f32_16x16x32_bf16 v[28:31], a[172:175], a[20:23], v[28:31]
ds_read_b128 a[212:215], v36 offset:26112
v_mfma_f32_16x16x32_bf16 v[32:35], a[176:179], a[20:23], v[32:35]
ds_read_b128 a[216:219], v40 offset:23040
s_waitcnt vmcnt(16) lgkmcnt(5)
v_mfma_f32_16x16x32_bf16 v[16:19], a[180:183], a[24:27], v[16:19]
ds_read_b128 a[160:163], v36 offset:27648
s_add_u32 s60, s60, 4096
buffer_load_dwordx4 a[20:23], v1, s[8:11], s60 offen offset:0 sc1
v_mfma_f32_16x16x32_bf16 v[20:23], a[184:187], a[24:27], v[20:23]
ds_read_b128 a[164:167], v36 offset:28672
v_cvt_pk_bf16_f32 v68, v50, v51
v_mfma_f32_16x16x32_bf16 v[24:27], a[188:191], a[24:27], v[24:27]
ds_read_b128 a[168:171], v36 offset:29696
v_mfma_f32_16x16x32_bf16 v[28:31], a[192:195], a[24:27], v[28:31]
ds_read_b128 a[172:175], v36 offset:30720
v_cvt_pk_bf16_f32 v69, v52, v53
v_mfma_f32_16x16x32_bf16 v[32:35], a[196:199], a[24:27], v[32:35]
ds_read_b128 a[176:179], v40 offset:27648
s_waitcnt vmcnt(16) lgkmcnt(5)
v_mfma_f32_16x16x32_bf16 v[16:19], a[200:203], a[28:31], v[16:19]
ds_read_b128 a[180:183], v36 offset:32256
buffer_load_dwordx4 a[24:27], v1, s[8:11], s60 offen offset:1024 sc1
v_mfma_f32_16x16x32_bf16 v[20:23], a[204:207], a[28:31], v[20:23]
ds_read_b128 a[184:187], v36 offset:33280
v_cvt_pk_bf16_f32 v70, v54, v55
v_mfma_f32_16x16x32_bf16 v[24:27], a[208:211], a[28:31], v[24:27]
ds_read_b128 a[188:191], v36 offset:34304
v_mfma_f32_16x16x32_bf16 v[28:31], a[212:215], a[28:31], v[28:31]
ds_read_b128 a[192:195], v36 offset:35328
v_mfma_f32_16x16x32_bf16 v[32:35], a[216:219], a[28:31], v[32:35]
ds_read_b128 a[196:199], v40 offset:32256
s_waitcnt vmcnt(16) lgkmcnt(5)
v_mfma_f32_16x16x32_bf16 v[16:19], a[160:163], a[32:35], v[16:19]
ds_read_b128 a[200:203], v36 offset:36864
buffer_load_dwordx4 a[28:31], v1, s[8:11], s60 offen offset:2048 sc1
v_mfma_f32_16x16x32_bf16 v[20:23], a[164:167], a[32:35], v[20:23]
ds_read_b128 a[204:207], v36 offset:37888
buffer_store_dwordx4 v[68:71], v1, s[8:11], s62 offen offset:1024 sc1
v_mfma_f32_16x16x32_bf16 v[24:27], a[168:171], a[32:35], v[24:27]
ds_read_b128 a[208:211], v36 offset:38912
v_cvt_pk_bf16_f32 v72, v56, v57
v_mfma_f32_16x16x32_bf16 v[28:31], a[172:175], a[32:35], v[28:31]
ds_read_b128 a[212:215], v36 offset:39936
v_mfma_f32_16x16x32_bf16 v[32:35], a[176:179], a[32:35], v[32:35]
ds_read_b128 a[216:219], v40 offset:36864
s_waitcnt vmcnt(17) lgkmcnt(5)
v_mfma_f32_16x16x32_bf16 v[16:19], a[180:183], a[36:39], v[16:19]
ds_read_b128 a[160:163], v36 offset:41472
buffer_load_dwordx4 a[32:35], v1, s[8:11], s60 offen offset:3072 sc1
v_mfma_f32_16x16x32_bf16 v[20:23], a[184:187], a[36:39], v[20:23]
ds_read_b128 a[164:167], v36 offset:42496
v_cvt_pk_bf16_f32 v73, v58, v59
v_mfma_f32_16x16x32_bf16 v[24:27], a[188:191], a[36:39], v[24:27]
ds_read_b128 a[168:171], v36 offset:43520
v_mfma_f32_16x16x32_bf16 v[28:31], a[192:195], a[36:39], v[28:31]
ds_read_b128 a[172:175], v36 offset:44544
v_cvt_pk_bf16_f32 v74, v60, v61
v_mfma_f32_16x16x32_bf16 v[32:35], a[196:199], a[36:39], v[32:35]
ds_read_b128 a[176:179], v40 offset:41472
s_waitcnt vmcnt(17) lgkmcnt(5)
v_mfma_f32_16x16x32_bf16 v[16:19], a[200:203], a[40:43], v[16:19]
ds_read_b128 a[180:183], v36 offset:46080
s_add_u32 s60, s60, 4096
buffer_load_dwordx4 a[36:39], v1, s[8:11], s60 offen offset:0 sc1
v_mfma_f32_16x16x32_bf16 v[20:23], a[204:207], a[40:43], v[20:23]
ds_read_b128 a[184:187], v36 offset:47104
buffer_store_dwordx4 v[72:75], v1, s[8:11], s62 offen offset:2048 sc1
v_mfma_f32_16x16x32_bf16 v[24:27], a[208:211], a[40:43], v[24:27]
ds_read_b128 a[188:191], v36 offset:48128
v_mfma_f32_16x16x32_bf16 v[28:31], a[212:215], a[40:43], v[28:31]
ds_read_b128 a[192:195], v36 offset:49152
v_mfma_f32_16x16x32_bf16 v[32:35], a[216:219], a[40:43], v[32:35]
ds_read_b128 a[196:199], v40 offset:46080
s_waitcnt vmcnt(18) lgkmcnt(5)
v_mfma_f32_16x16x32_bf16 v[16:19], a[160:163], a[44:47], v[16:19]
ds_read_b128 a[200:203], v36 offset:50688
buffer_load_dwordx4 a[40:43], v1, s[8:11], s60 offen offset:1024 sc1
v_mfma_f32_16x16x32_bf16 v[20:23], a[164:167], a[44:47], v[20:23]
ds_read_b128 a[204:207], v36 offset:51712
v_cvt_pk_bf16_f32 v76, v62, v63
v_mfma_f32_16x16x32_bf16 v[24:27], a[168:171], a[44:47], v[24:27]
ds_read_b128 a[208:211], v36 offset:52736
buffer_store_dwordx4 v[76:79], v1, s[8:11], s62 offen offset:3072 sc1
v_mfma_f32_16x16x32_bf16 v[28:31], a[172:175], a[44:47], v[28:31]
ds_read_b128 a[212:215], v36 offset:53760
v_mfma_f32_16x16x32_bf16 v[32:35], a[176:179], a[44:47], v[32:35]
ds_read_b128 a[216:219], v40 offset:50688
s_waitcnt vmcnt(19) lgkmcnt(5)
v_mfma_f32_16x16x32_bf16 v[16:19], a[180:183], a[48:51], v[16:19]
ds_read_b128 a[160:163], v37 offset:0
buffer_load_dwordx4 a[44:47], v1, s[8:11], s60 offen offset:2048 sc1
v_mfma_f32_16x16x32_bf16 v[20:23], a[184:187], a[48:51], v[20:23]
ds_read_b128 a[164:167], v37 offset:1024
v_mfma_f32_16x16x32_bf16 v[24:27], a[188:191], a[48:51], v[24:27]
ds_read_b128 a[168:171], v37 offset:2048
v_mfma_f32_16x16x32_bf16 v[28:31], a[192:195], a[48:51], v[28:31]
ds_read_b128 a[172:175], v37 offset:3072
v_mfma_f32_16x16x32_bf16 v[32:35], a[196:199], a[48:51], v[32:35]
ds_read_b128 a[176:179], v41 offset:0
s_waitcnt vmcnt(19) lgkmcnt(5)
v_mfma_f32_16x16x32_bf16 v[16:19], a[200:203], a[52:55], v[16:19]
ds_read_b128 a[180:183], v37 offset:4608
buffer_load_dwordx4 a[48:51], v1, s[8:11], s60 offen offset:3072 sc1
v_mfma_f32_16x16x32_bf16 v[20:23], a[204:207], a[52:55], v[20:23]
ds_read_b128 a[184:187], v37 offset:5632
v_mfma_f32_16x16x32_bf16 v[24:27], a[208:211], a[52:55], v[24:27]
ds_read_b128 a[188:191], v37 offset:6656
v_mfma_f32_16x16x32_bf16 v[28:31], a[212:215], a[52:55], v[28:31]
ds_read_b128 a[192:195], v37 offset:7680
v_mfma_f32_16x16x32_bf16 v[32:35], a[216:219], a[52:55], v[32:35]
ds_read_b128 a[196:199], v41 offset:4608
s_waitcnt vmcnt(19) lgkmcnt(5)
v_mfma_f32_16x16x32_bf16 v[16:19], a[160:163], a[56:59], v[16:19]
ds_read_b128 a[200:203], v37 offset:9216
s_add_u32 s60, s60, 4096
buffer_load_dwordx4 a[52:55], v1, s[8:11], s60 offen offset:0 sc1
v_mfma_f32_16x16x32_bf16 v[20:23], a[164:167], a[56:59], v[20:23]
ds_read_b128 a[204:207], v37 offset:10240
v_mfma_f32_16x16x32_bf16 v[24:27], a[168:171], a[56:59], v[24:27]
ds_read_b128 a[208:211], v37 offset:11264
v_mfma_f32_16x16x32_bf16 v[28:31], a[172:175], a[56:59], v[28:31]
ds_read_b128 a[212:215], v37 offset:12288
v_mfma_f32_16x16x32_bf16 v[32:35], a[176:179], a[56:59], v[32:35]
ds_read_b128 a[216:219], v41 offset:9216
s_waitcnt vmcnt(19) lgkmcnt(5)
v_mfma_f32_16x16x32_bf16 v[16:19], a[180:183], a[60:63], v[16:19]
ds_read_b128 a[160:163], v37 offset:13824
buffer_load_dwordx4 a[56:59], v1, s[8:11], s60 offen offset:1024 sc1
v_mfma_f32_16x16x32_bf16 v[20:23], a[184:187], a[60:63], v[20:23]
ds_read_b128 a[164:167], v37 offset:14848
v_mfma_f32_16x16x32_bf16 v[24:27], a[188:191], a[60:63], v[24:27]
ds_read_b128 a[168:171], v37 offset:15872
v_mfma_f32_16x16x32_bf16 v[28:31], a[192:195], a[60:63], v[28:31]
ds_read_b128 a[172:175], v37 offset:16896
v_mfma_f32_16x16x32_bf16 v[32:35], a[196:199], a[60:63], v[32:35]
ds_read_b128 a[176:179], v41 offset:13824
s_waitcnt vmcnt(19) lgkmcnt(5)
v_mfma_f32_16x16x32_bf16 v[16:19], a[200:203], a[64:67], v[16:19]
ds_read_b128 a[180:183], v37 offset:18432
buffer_load_dwordx4 a[60:63], v1, s[8:11], s60 offen offset:2048 sc1
v_mfma_f32_16x16x32_bf16 v[20:23], a[204:207], a[64:67], v[20:23]
ds_read_b128 a[184:187], v37 offset:19456
v_mfma_f32_16x16x32_bf16 v[24:27], a[208:211], a[64:67], v[24:27]
ds_read_b128 a[188:191], v37 offset:20480
v_mfma_f32_16x16x32_bf16 v[28:31], a[212:215], a[64:67], v[28:31]
ds_read_b128 a[192:195], v37 offset:21504
v_mfma_f32_16x16x32_bf16 v[32:35], a[216:219], a[64:67], v[32:35]
ds_read_b128 a[196:199], v41 offset:18432
s_waitcnt vmcnt(19) lgkmcnt(5)
v_mfma_f32_16x16x32_bf16 v[16:19], a[160:163], a[0:3], v[16:19]
ds_read_b128 a[200:203], v37 offset:23040
buffer_load_dwordx4 a[64:67], v1, s[8:11], s60 offen offset:3072 sc1
v_mfma_f32_16x16x32_bf16 v[20:23], a[164:167], a[0:3], v[20:23]
ds_read_b128 a[204:207], v37 offset:24064
v_mfma_f32_16x16x32_bf16 v[24:27], a[168:171], a[0:3], v[24:27]
ds_read_b128 a[208:211], v37 offset:25088
v_mfma_f32_16x16x32_bf16 v[28:31], a[172:175], a[0:3], v[28:31]
ds_read_b128 a[212:215], v37 offset:26112
v_mfma_f32_16x16x32_bf16 v[32:35], a[176:179], a[0:3], v[32:35]
ds_read_b128 a[216:219], v41 offset:23040
s_waitcnt vmcnt(19) lgkmcnt(5)
v_mfma_f32_16x16x32_bf16 v[16:19], a[180:183], a[4:7], v[16:19]
ds_read_b128 a[160:163], v37 offset:27648
s_add_u32 s60, s60, 4096
buffer_load_dwordx4 a[0:3], v1, s[8:11], s60 offen offset:0 sc1
v_mfma_f32_16x16x32_bf16 v[20:23], a[184:187], a[4:7], v[20:23]
ds_read_b128 a[164:167], v37 offset:28672
v_mfma_f32_16x16x32_bf16 v[24:27], a[188:191], a[4:7], v[24:27]
ds_read_b128 a[168:171], v37 offset:29696
v_mfma_f32_16x16x32_bf16 v[28:31], a[192:195], a[4:7], v[28:31]
ds_read_b128 a[172:175], v37 offset:30720
v_mfma_f32_16x16x32_bf16 v[32:35], a[196:199], a[4:7], v[32:35]
ds_read_b128 a[176:179], v41 offset:27648
s_waitcnt vmcnt(19) lgkmcnt(5)
v_mfma_f32_16x16x32_bf16 v[16:19], a[200:203], a[8:11], v[16:19]
ds_read_b128 a[180:183], v37 offset:32256
buffer_load_dwordx4 a[4:7], v1, s[8:11], s60 offen offset:1024 sc1
v_mfma_f32_16x16x32_bf16 v[20:23], a[204:207], a[8:11], v[20:23]
ds_read_b128 a[184:187], v37 offset:33280
v_mfma_f32_16x16x32_bf16 v[24:27], a[208:211], a[8:11], v[24:27]
ds_read_b128 a[188:191], v37 offset:34304
v_mfma_f32_16x16x32_bf16 v[28:31], a[212:215], a[8:11], v[28:31]
ds_read_b128 a[192:195], v37 offset:35328
v_mfma_f32_16x16x32_bf16 v[32:35], a[216:219], a[8:11], v[32:35]
ds_read_b128 a[196:199], v41 offset:32256
s_waitcnt vmcnt(19) lgkmcnt(5)
v_mfma_f32_16x16x32_bf16 v[16:19], a[160:163], a[12:15], v[16:19]
ds_read_b128 a[200:203], v37 offset:36864
buffer_load_dwordx4 a[8:11], v1, s[8:11], s60 offen offset:2048 sc1
v_mfma_f32_16x16x32_bf16 v[20:23], a[164:167], a[12:15], v[20:23]
ds_read_b128 a[204:207], v37 offset:37888
v_mfma_f32_16x16x32_bf16 v[24:27], a[168:171], a[12:15], v[24:27]
ds_read_b128 a[208:211], v37 offset:38912
v_mfma_f32_16x16x32_bf16 v[28:31], a[172:175], a[12:15], v[28:31]
ds_read_b128 a[212:215], v37 offset:39936
v_mfma_f32_16x16x32_bf16 v[32:35], a[176:179], a[12:15], v[32:35]
ds_read_b128 a[216:219], v41 offset:36864
s_waitcnt vmcnt(19) lgkmcnt(5)
v_mfma_f32_16x16x32_bf16 v[16:19], a[180:183], a[16:19], v[16:19]
ds_read_b128 a[160:163], v37 offset:41472
buffer_load_dwordx4 a[12:15], v1, s[8:11], s60 offen offset:3072 sc1
v_mfma_f32_16x16x32_bf16 v[20:23], a[184:187], a[16:19], v[20:23]
ds_read_b128 a[164:167], v37 offset:42496
v_mfma_f32_16x16x32_bf16 v[24:27], a[188:191], a[16:19], v[24:27]
ds_read_b128 a[168:171], v37 offset:43520
v_mfma_f32_16x16x32_bf16 v[28:31], a[192:195], a[16:19], v[28:31]
ds_read_b128 a[172:175], v37 offset:44544
v_mfma_f32_16x16x32_bf16 v[32:35], a[196:199], a[16:19], v[32:35]
ds_read_b128 a[176:179], v41 offset:41472
s_waitcnt vmcnt(18) lgkmcnt(5)
v_mfma_f32_16x16x32_bf16 v[16:19], a[200:203], a[20:23], v[16:19]
ds_read_b128 a[180:183], v37 offset:46080
v_mfma_f32_16x16x32_bf16 v[20:23], a[204:207], a[20:23], v[20:23]
ds_read_b128 a[184:187], v37 offset:47104
v_mfma_f32_16x16x32_bf16 v[24:27], a[208:211], a[20:23], v[24:27]
ds_read_b128 a[188:191], v37 offset:48128
v_mfma_f32_16x16x32_bf16 v[28:31], a[212:215], a[20:23], v[28:31]
ds_read_b128 a[192:195], v37 offset:49152
v_mfma_f32_16x16x32_bf16 v[32:35], a[216:219], a[20:23], v[32:35]
ds_read_b128 a[196:199], v41 offset:46080
s_waitcnt vmcnt(17) lgkmcnt(5)
v_mfma_f32_16x16x32_bf16 v[16:19], a[160:163], a[24:27], v[16:19]
ds_read_b128 a[200:203], v37 offset:50688
v_mfma_f32_16x16x32_bf16 v[20:23], a[164:167], a[24:27], v[20:23]
ds_read_b128 a[204:207], v37 offset:51712
v_mfma_f32_16x16x32_bf16 v[24:27], a[168:171], a[24:27], v[24:27]
ds_read_b128 a[208:211], v37 offset:52736
v_mfma_f32_16x16x32_bf16 v[28:31], a[172:175], a[24:27], v[28:31]
ds_read_b128 a[212:215], v37 offset:53760
v_mfma_f32_16x16x32_bf16 v[32:35], a[176:179], a[24:27], v[32:35]
ds_read_b128 a[216:219], v41 offset:50688
s_waitcnt vmcnt(16) lgkmcnt(5)
v_mfma_f32_16x16x32_bf16 v[16:19], a[180:183], a[28:31], v[16:19]
ds_read_b128 a[160:163], v38 offset:0
buffer_load_dwordx4 v[80:83], v1, s[8:11], s63 offen offset:0 sc1
v_mfma_f32_16x16x32_bf16 v[20:23], a[184:187], a[28:31], v[20:23]
ds_read_b128 a[164:167], v38 offset:1024
v_mfma_f32_16x16x32_bf16 v[24:27], a[188:191], a[28:31], v[24:27]
ds_read_b128 a[168:171], v38 offset:2048
v_mfma_f32_16x16x32_bf16 v[28:31], a[192:195], a[28:31], v[28:31]
ds_read_b128 a[172:175], v38 offset:3072
v_mfma_f32_16x16x32_bf16 v[32:35], a[196:199], a[28:31], v[32:35]
ds_read_b128 a[176:179], v42 offset:0
s_waitcnt vmcnt(15) lgkmcnt(5)
v_mfma_f32_16x16x32_bf16 v[16:19], a[200:203], a[32:35], v[16:19]
ds_read_b128 a[180:183], v38 offset:4608
buffer_load_dwordx4 v[84:87], v1, s[8:11], s63 offen offset:1024 sc1
v_mfma_f32_16x16x32_bf16 v[20:23], a[204:207], a[32:35], v[20:23]
ds_read_b128 a[184:187], v38 offset:5632
v_mfma_f32_16x16x32_bf16 v[24:27], a[208:211], a[32:35], v[24:27]
ds_read_b128 a[188:191], v38 offset:6656
v_mfma_f32_16x16x32_bf16 v[28:31], a[212:215], a[32:35], v[28:31]
ds_read_b128 a[192:195], v38 offset:7680
v_mfma_f32_16x16x32_bf16 v[32:35], a[216:219], a[32:35], v[32:35]
ds_read_b128 a[196:199], v42 offset:4608
s_waitcnt vmcnt(15) lgkmcnt(5)
v_mfma_f32_16x16x32_bf16 v[16:19], a[160:163], a[36:39], v[16:19]
ds_read_b128 a[200:203], v38 offset:9216
buffer_load_dwordx4 v[88:91], v1, s[8:11], s63 offen offset:2048 sc1
v_mfma_f32_16x16x32_bf16 v[20:23], a[164:167], a[36:39], v[20:23]
ds_read_b128 a[204:207], v38 offset:10240
v_mfma_f32_16x16x32_bf16 v[24:27], a[168:171], a[36:39], v[24:27]
ds_read_b128 a[208:211], v38 offset:11264
v_mfma_f32_16x16x32_bf16 v[28:31], a[172:175], a[36:39], v[28:31]
ds_read_b128 a[212:215], v38 offset:12288
v_mfma_f32_16x16x32_bf16 v[32:35], a[176:179], a[36:39], v[32:35]
ds_read_b128 a[216:219], v42 offset:9216
s_waitcnt vmcnt(14) lgkmcnt(5)
v_mfma_f32_16x16x32_bf16 v[16:19], a[180:183], a[40:43], v[16:19]
ds_read_b128 a[160:163], v38 offset:13824
buffer_load_dwordx4 v[92:95], v1, s[8:11], s63 offen offset:3072 sc1
v_mfma_f32_16x16x32_bf16 v[20:23], a[184:187], a[40:43], v[20:23]
ds_read_b128 a[164:167], v38 offset:14848
v_mfma_f32_16x16x32_bf16 v[24:27], a[188:191], a[40:43], v[24:27]
ds_read_b128 a[168:171], v38 offset:15872
v_mfma_f32_16x16x32_bf16 v[28:31], a[192:195], a[40:43], v[28:31]
ds_read_b128 a[172:175], v38 offset:16896
v_mfma_f32_16x16x32_bf16 v[32:35], a[196:199], a[40:43], v[32:35]
ds_read_b128 a[176:179], v42 offset:13824
s_waitcnt vmcnt(13) lgkmcnt(5)
v_mfma_f32_16x16x32_bf16 v[16:19], a[200:203], a[44:47], v[16:19]
ds_read_b128 a[180:183], v38 offset:18432
v_mfma_f32_16x16x32_bf16 v[20:23], a[204:207], a[44:47], v[20:23]
ds_read_b128 a[184:187], v38 offset:19456
v_mfma_f32_16x16x32_bf16 v[24:27], a[208:211], a[44:47], v[24:27]
ds_read_b128 a[188:191], v38 offset:20480
v_mfma_f32_16x16x32_bf16 v[28:31], a[212:215], a[44:47], v[28:31]
ds_read_b128 a[192:195], v38 offset:21504
v_mfma_f32_16x16x32_bf16 v[32:35], a[216:219], a[44:47], v[32:35]
ds_read_b128 a[196:199], v42 offset:18432
s_waitcnt vmcnt(12) lgkmcnt(5)
v_mfma_f32_16x16x32_bf16 v[16:19], a[160:163], a[48:51], v[16:19]
ds_read_b128 a[200:203], v38 offset:23040
v_mfma_f32_16x16x32_bf16 v[20:23], a[164:167], a[48:51], v[20:23]
ds_read_b128 a[204:207], v38 offset:24064
v_mfma_f32_16x16x32_bf16 v[24:27], a[168:171], a[48:51], v[24:27]
ds_read_b128 a[208:211], v38 offset:25088
v_mfma_f32_16x16x32_bf16 v[28:31], a[172:175], a[48:51], v[28:31]
ds_read_b128 a[212:215], v38 offset:26112
v_mfma_f32_16x16x32_bf16 v[32:35], a[176:179], a[48:51], v[32:35]
ds_read_b128 a[216:219], v42 offset:23040
s_waitcnt vmcnt(11) lgkmcnt(5)
v_mfma_f32_16x16x32_bf16 v[16:19], a[180:183], a[52:55], v[16:19]
ds_read_b128 a[160:163], v38 offset:27648
v_mfma_f32_16x16x32_bf16 v[20:23], a[184:187], a[52:55], v[20:23]
ds_read_b128 a[164:167], v38 offset:28672
v_mfma_f32_16x16x32_bf16 v[24:27], a[188:191], a[52:55], v[24:27]
ds_read_b128 a[168:171], v38 offset:29696
v_mfma_f32_16x16x32_bf16 v[28:31], a[192:195], a[52:55], v[28:31]
ds_read_b128 a[172:175], v38 offset:30720
v_mfma_f32_16x16x32_bf16 v[32:35], a[196:199], a[52:55], v[32:35]
ds_read_b128 a[176:179], v42 offset:27648
s_waitcnt vmcnt(10) lgkmcnt(5)
v_mfma_f32_16x16x32_bf16 v[16:19], a[200:203], a[56:59], v[16:19]
ds_read_b128 a[180:183], v38 offset:32256
v_mfma_f32_16x16x32_bf16 v[20:23], a[204:207], a[56:59], v[20:23]
ds_read_b128 a[184:187], v38 offset:33280
v_mfma_f32_16x16x32_bf16 v[24:27], a[208:211], a[56:59], v[24:27]
ds_read_b128 a[188:191], v38 offset:34304
v_mfma_f32_16x16x32_bf16 v[28:31], a[212:215], a[56:59], v[28:31]
ds_read_b128 a[192:195], v38 offset:35328
v_mfma_f32_16x16x32_bf16 v[32:35], a[216:219], a[56:59], v[32:35]
ds_read_b128 a[196:199], v42 offset:32256
s_waitcnt vmcnt(9) lgkmcnt(5)
v_mfma_f32_16x16x32_bf16 v[16:19], a[160:163], a[60:63], v[16:19]
ds_read_b128 a[200:203], v38 offset:36864
v_mfma_f32_16x16x32_bf16 v[20:23], a[164:167], a[60:63], v[20:23]
ds_read_b128 a[204:207], v38 offset:37888
v_mfma_f32_16x16x32_bf16 v[24:27], a[168:171], a[60:63], v[24:27]
ds_read_b128 a[208:211], v38 offset:38912
v_mfma_f32_16x16x32_bf16 v[28:31], a[172:175], a[60:63], v[28:31]
ds_read_b128 a[212:215], v38 offset:39936
v_mfma_f32_16x16x32_bf16 v[32:35], a[176:179], a[60:63], v[32:35]
ds_read_b128 a[216:219], v42 offset:36864
s_waitcnt vmcnt(8) lgkmcnt(5)
v_mfma_f32_16x16x32_bf16 v[16:19], a[180:183], a[64:67], v[16:19]
ds_read_b128 a[160:163], v38 offset:41472
v_mfma_f32_16x16x32_bf16 v[20:23], a[184:187], a[64:67], v[20:23]
ds_read_b128 a[164:167], v38 offset:42496
v_mfma_f32_16x16x32_bf16 v[24:27], a[188:191], a[64:67], v[24:27]
ds_read_b128 a[168:171], v38 offset:43520
v_mfma_f32_16x16x32_bf16 v[28:31], a[192:195], a[64:67], v[28:31]
ds_read_b128 a[172:175], v38 offset:44544
v_mfma_f32_16x16x32_bf16 v[32:35], a[196:199], a[64:67], v[32:35]
ds_read_b128 a[176:179], v42 offset:41472
s_waitcnt vmcnt(7) lgkmcnt(5)
v_mfma_f32_16x16x32_bf16 v[16:19], a[200:203], a[0:3], v[16:19]
ds_read_b128 a[180:183], v38 offset:46080
v_mfma_f32_16x16x32_bf16 v[20:23], a[204:207], a[0:3], v[20:23]
ds_read_b128 a[184:187], v38 offset:47104
v_mfma_f32_16x16x32_bf16 v[24:27], a[208:211], a[0:3], v[24:27]
ds_read_b128 a[188:191], v38 offset:48128
v_mfma_f32_16x16x32_bf16 v[28:31], a[212:215], a[0:3], v[28:31]
ds_read_b128 a[192:195], v38 offset:49152
v_mfma_f32_16x16x32_bf16 v[32:35], a[216:219], a[0:3], v[32:35]
ds_read_b128 a[196:199], v42 offset:46080
s_waitcnt vmcnt(6) lgkmcnt(5)
v_mfma_f32_16x16x32_bf16 v[16:19], a[160:163], a[4:7], v[16:19]
ds_read_b128 a[200:203], v38 offset:50688
v_mfma_f32_16x16x32_bf16 v[20:23], a[164:167], a[4:7], v[20:23]
ds_read_b128 a[204:207], v38 offset:51712
v_mfma_f32_16x16x32_bf16 v[24:27], a[168:171], a[4:7], v[24:27]
v_mfma_f32_16x16x32_bf16 v[28:31], a[172:175], a[4:7], v[28:31]
v_mfma_f32_16x16x32_bf16 v[32:35], a[176:179], a[4:7], v[32:35]
s_waitcnt vmcnt(5) lgkmcnt(2)
v_mfma_f32_16x16x32_bf16 v[16:19], a[180:183], a[8:11], v[16:19]
v_mfma_f32_16x16x32_bf16 v[20:23], a[184:187], a[8:11], v[20:23]
v_mfma_f32_16x16x32_bf16 v[24:27], a[188:191], a[8:11], v[24:27]
v_mfma_f32_16x16x32_bf16 v[28:31], a[192:195], a[8:11], v[28:31]
v_mfma_f32_16x16x32_bf16 v[32:35], a[196:199], a[8:11], v[32:35]
s_waitcnt vmcnt(4) lgkmcnt(0)
v_mfma_f32_16x16x32_bf16 v[16:19], a[200:203], a[12:15], v[16:19]
s_waitcnt vmcnt(0)
v_xor_b32 v118, v248, v83
v_xor_b32 v119, v248, v87
v_xor_b32 v120, v248, v91
v_xor_b32 v121, v248, v95
v_mfma_f32_16x16x32_bf16 v[20:23], a[204:207], a[12:15], v[20:23]
v_or3_b32 v118, v118, v119, v120
v_or_b32 v118, v118, v121
v_cmp_ne_u32 vcc, 0, v118
s_nop 0
s_cbranch_vccnz L_xslow_36
L_xback_37:
v_mfma_f32_16x16x32_bf16 v[24:27], a[228:231], a[12:15], v[24:27]
v_lshlrev_b32 v96, 16, v80
v_and_b32 v97, 0xffff0000, v80
v_lshlrev_b32 v98, 16, v81
v_and_b32 v99, 0xffff0000, v81
v_lshlrev_b32 v100, 16, v82
v_and_b32 v101, 0xffff0000, v82
v_mfma_f32_16x16x32_bf16 v[28:31], a[232:235], a[12:15], v[28:31]
v_lshlrev_b32 v102, 16, v84
v_and_b32 v103, 0xffff0000, v84
v_lshlrev_b32 v104, 16, v85
v_and_b32 v105, 0xffff0000, v85
v_lshlrev_b32 v106, 16, v86
v_and_b32 v107, 0xffff0000, v86
v_mfma_f32_16x16x32_bf16 v[32:35], a[236:239], a[12:15], v[32:35]
v_lshlrev_b32 v108, 16, v88
v_and_b32 v109, 0xffff0000, v88
v_lshlrev_b32 v110, 16, v89
v_and_b32 v111, 0xffff0000, v89
v_lshlrev_b32 v112, 16, v90
v_and_b32 v113, 0xffff0000, v90
v_lshlrev_b32 v114, 16, v92
v_and_b32 v115, 0xffff0000, v92
s_nop 3
v_pk_add_f32 v[16:17], v[16:17], v[96:97]
v_pk_add_f32 v[18:19], v[18:19], v[98:99]
v_pk_add_f32 v[20:21], v[20:21], v[100:101]
v_pk_add_f32 v[22:23], v[22:23], v[102:103]
v_pk_add_f32 v[24:25], v[24:25], v[104:105]
v_pk_add_f32 v[26:27], v[26:27], v[106:107]
v_pk_add_f32 v[28:29], v[28:29], v[108:109]
v_pk_add_f32 v[30:31], v[30:31], v[110:111]
v_pk_add_f32 v[32:33], v[32:33], v[112:113]
v_pk_add_f32 v[34:35], v[34:35], v[114:115]
s_cmp_eq_u32 s29, 1
s_cbranch_scc1 L_last
v_pk_add_f32 v[142:143], v[16:17], v[18:19]
v_pk_mul_f32 v[144:145], v[16:17], v[16:17]
v_pk_fma_f32 v[144:145], v[18:19], v[18:19], v[144:145]
v_pk_add_f32 v[142:143], v[142:143], v[20:21]
v_pk_fma_f32 v[144:145], v[20:21], v[20:21], v[144:145]
v_pk_add_f32 v[142:143], v[142:143], v[22:23]
v_pk_fma_f32 v[144:145], v[22:23], v[22:23], v[144:145]
v_pk_add_f32 v[142:143], v[142:143], v[24:25]
v_pk_fma_f32 v[144:145], v[24:25], v[24:25], v[144:145]
v_pk_add_f32 v[142:143], v[142:143], v[26:27]
v_pk_fma_f32 v[144:145], v[26:27], v[26:27], v[144:145]
v_pk_add_f32 v[142:143], v[142:143], v[28:29]
v_pk_fma_f32 v[144:145], v[28:29], v[28:29], v[144:145]
v_pk_add_f32 v[142:143], v[142:143], v[30:31]
v_pk_fma_f32 v[144:145], v[30:31], v[30:31], v[144:145]
s_mov_b32 exec_hi, 0
v_pk_add_f32 v[142:143], v[142:143], v[32:33]
v_pk_fma_f32 v[144:145], v[32:33], v[32:33], v[144:145]
v_pk_add_f32 v[142:143], v[142:143], v[34:35]
v_pk_fma_f32 v[144:145], v[34:35], v[34:35], v[144:145]
s_mov_b64 exec, -1
v_add_f32 v136, v142, v143
v_add_f32 v137, v144, v145
v_cvt_pk_bf16_f32 v132, v32, v33
v_cvt_pk_bf16_f32 v133, v34, v35
v_permlane32_swap_b32 v136, v137
v_add_f32 v136, v136, v137
v_mov_b32 v137, v136
v_cvt_pk_bf16_f32 v124, v16, v17
v_cvt_pk_bf16_f32 v125, v18, v19
v_permlane16_swap_b32 v136, v137
v_add_f32 v136, v136, v137
v_mov_b32 v137, v136
v_cvt_pk_bf16_f32 v126, v20, v21
v_cvt_pk_bf16_f32 v127, v22, v23
v_permlane32_swap_b32 v136, v137
buffer_store_dwordx4 v[124:127], v140, s[8:11], s66 offen sc1
buffer_store_dwordx2 v[136:137], v138, s[8:11], s67 offen sc1
v_cvt_pk_bf16_f32 v128, v24, v25
v_cvt_pk_bf16_f32 v129, v26, v27
v_cvt_pk_bf16_f32 v130, v28, v29
v_cvt_pk_bf16_f32 v131, v30, v31
v_permlane16_swap_b32 v132, v134
v_permlane16_swap_b32 v133, v135
buffer_store_dwordx4 v[128:131], v140, s[8:11], s66 offen offset:1024 sc1
buffer_store_dwordx4 v[132:135], v141, s[8:11], s66 offen sc1
s_barrier
s_mul_i32 s36, s26, 132608
s_mul_i32 s38, s24, 12288
s_add_u32 m0, s38, 0
s_add_u32 s39, s38, s36
buffer_load_dwordx4 v1, s[4:7], s39 offen offset:0 sc1 lds
buffer_load_dwordx4 v1, s[4:7], s39 offen offset:1024 sc1 lds
buffer_load_dwordx4 v1, s[4:7], s39 offen offset:2048 sc1 lds
buffer_load_dwordx4 v1, s[4:7], s39 offen offset:3072 sc1 lds
s_add_u32 m0, m0, 4096
s_add_u32 s39, s39, 4096
buffer_load_dwordx4 v1, s[4:7], s39 offen offset:0 sc1 lds
buffer_load_dwordx4 v1, s[4:7], s39 offen offset:1024 sc1 lds
buffer_load_dwordx4 v1, s[4:7], s39 offen offset:2048 sc1 lds
buffer_load_dwordx4 v1, s[4:7], s39 offen offset:3072 sc1 lds
s_and_b32 s33, s27, 1
s_cmp_lt_u32 s27, 31
s_cselect_b32 s33, s33, 0
s_cmp_eq_u32 s33, 1
s_cselect_b32 s34, -1, 0xffff
s_mov_b32 s35, 0
v_lshlrev_b32 v7, 3, v1
s_lshr_b32 s31, s81, 4
s_lshl_b32 s31, s31, 11
v_add_u32 v7, s31, v7
s_cmp_eq_u32 s24, 0
s_cselect_b32 s30, 0, 1073741824
s_add_u32 s30, s30, 26607616
s_waitcnt vmcnt(8)
s_barrier
s_mov_b64 exec, s[34:35]
buffer_atomic_add v4, v7, s[8:11], s30 offen sc1
s_mov_b64 exec, -1
s_cmp_eq_u32 s29, 1
s_cbranch_scc1 L_main_fin
s_cmp_eq_u32 s25, 0
s_cselect_b32 s34, 16, 24
s_lshl_b32 s35, s80, 7
s_add_u32 s35, s35, 26607616
s_cmp_eq_u32 s24, 1
s_cselect_b32 s35, s35, 1073741824
v_mov_b32 v6, 0
v_mov_b32 v244, 0
v_mov_b32 v245, 0
v_mov_b32 v246, 0
s_add_u32 m0, m0, 4096
s_add_u32 s39, s39, 4096
buffer_load_dwordx4 v1, s[4:7], s39 offen offset:0 sc1 lds
buffer_load_dwordx4 v1, s[4:7], s39 offen offset:1024 sc1 lds
buffer_load_dwordx4 v1, s[4:7], s39 offen offset:2048 sc1 lds
buffer_load_dwordx4 v1, s[4:7], s39 offen offset:3072 sc1 lds
s_mul_i32 s36, s26, 132608
s_mul_i32 s38, s24, 9216
s_add_u32 m0, s38, 49152
s_add_u32 s39, s38, s36
s_add_u32 s39, s39, 49152
s_mov_b64 exec, 1
buffer_atomic_add v244, v6, s[8:11], s35 offen sc0 sc1
s_mov_b64 exec, -1
buffer_load_dwordx4 v1, s[4:7], s39 offen offset:0 sc1 lds
buffer_load_dwordx4 v1, s[4:7], s39 offen offset:1024 sc1 lds
buffer_load_dwordx4 v1, s[4:7], s39 offen offset:2048 sc1 lds
s_mov_b64 exec, 1
buffer_atomic_add v245, v6, s[8:11], s35 offen sc0 sc1
s_mov_b64 exec, -1
buffer_load_dwordx4 v1, s[4:7], s39 offen offset:3072 sc1 lds
s_add_u32 m0, m0, 4096
s_add_u32 s39, s39, 4096
buffer_load_dwordx4 v1, s[4:7], s39 offen offset:0 sc1 lds
buffer_load_dwordx4 v1, s[4:7], s39 offen offset:1024 sc1 lds
s_mov_b64 exec, 1
buffer_atomic_add v246, v6, s[8:11], s35 offen sc0 sc1
s_mov_b64 exec, -1
buffer_load_dwordx4 v1, s[4:7], s39 offen offset:2048 sc1 lds
buffer_load_dwordx4 v1, s[4:7], s39 offen offset:3072 sc1 lds
s_add_u32 m0, m0, 4096
s_add_u32 s39, s39, 4096
buffer_load_dwordx4 v1, s[4:7], s39 offen offset:0 sc1 lds
s_lshl_b32 s60, s25, 3
s_sub_u32 s61, s60, 1
s_max_i32 s61, s61, 0
s_lshl_b32 s30, s24, 1
s_add_u32 s60, s60, s30
s_mul_i32 s30, s61, 18432
s_mul_i32 s62, s60, 18432
v_add_u32 v237, 18432, v1
s_mul_i32 s38, s24, 5120
s_add_u32 m0, s38, 135168
s_add_u32 s39, s38, s30
s_cmp_eq_u32 s24, 1
s_cbranch_scc0 L_other_41
s_mov_b32 s31, 0
s_mov_b64 exec, 1
v_mov_b32 v247, 0
buffer_atomic_add v247, v6, s[8:11], s35 offen sc0 sc1
s_waitcnt vmcnt(12)
v_cmp_gt_u32 vcc, s34, v244
s_nop 0
s_cbranch_vccz L_polled_40
s_waitcnt vmcnt(8)
v_cmp_gt_u32 vcc, s34, v245
s_nop 0
s_cbranch_vccz L_polled_40
v_mov_b32 v244, 0
buffer_atomic_add v244, v6, s[8:11], s35 offen sc0 sc1
s_waitcnt vmcnt(5)
v_cmp_gt_u32 vcc, s34, v246
s_nop 0
s_cbranch_vccz L_polled_40
v_mov_b32 v245, 0
buffer_atomic_add v245, v6, s[8:11], s35 offen sc0 sc1
L_poll_39:
s_add_u32 s31, s31, 1
s_cmp_gt_u32 s31, 100000
s_cbranch_scc1 L_polled_40
v_mov_b32 v246, 0
buffer_atomic_add v246, v6, s[8:11], s35 offen sc0 sc1
s_waitcnt vmcnt(3)
v_cmp_gt_u32 vcc, s34, v247
s_nop 0
s_cbranch_vccz L_polled_40
v_mov_b32 v247, 0
buffer_atomic_add v247, v6, s[8:11], s35 offen sc0 sc1
s_waitcnt vmcnt(3)
v_cmp_gt_u32 vcc, s34, v244
s_nop 0
s_cbranch_vccz L_polled_40
v_mov_b32 v244, 0
buffer_atomic_add v244, v6, s[8:11], s35 offen sc0 sc1
s_waitcnt vmcnt(3)
v_cmp_gt_u32 vcc, s34, v245
s_nop 0
s_cbranch_vccz L_polled_40
v_mov_b32 v245, 0
buffer_atomic_add v245, v6, s[8:11], s35 offen sc0 sc1
s_waitcnt vmcnt(3)
v_cmp_gt_u32 vcc, s34, v246
s_nop 0
s_cbranch_vccz L_polled_40
s_branch L_poll_39
L_polled_40:
s_mov_b64 exec, -1
L_other_41:
s_barrier
s_mov_b32 s29, 1
s_add_u32 s8, s8, 30834688
s_addc_u32 s9, s9, 0
s_mov_b32 s10, 30834688
s_branch L_layer
L_last:
v_cvt_pk_bf16_f32 v148, v16, v17
v_cvt_pk_bf16_f32 v149, v18, v19
v_cvt_pk_bf16_f32 v150, v20, v21
v_cvt_pk_bf16_f32 v151, v22, v23
v_cvt_pk_bf16_f32 v152, v24, v25
v_cvt_pk_bf16_f32 v153, v26, v27
v_cvt_pk_bf16_f32 v154, v28, v29
v_cvt_pk_bf16_f32 v155, v30, v31
v_cvt_pk_bf16_f32 v156, v32, v33
v_cvt_pk_bf16_f32 v157, v34, v35
buffer_store_dwordx4 v[148:151], v164, s[16:19], s68 offen
buffer_store_dwordx4 v[152:155], v164, s[16:19], s68 offen offset:64
v_permlane16_swap_b32 v156, v158
v_permlane16_swap_b32 v157, v159
buffer_store_dwordx4 v[156:159], v165, s[16:19], s68 offen
L_main_fin:
L_main_end:
s_endpgm
L_tagslow_7:
buffer_load_dwordx2 v[238:239], v48, s[84:87], 0 offen sc1
s_add_u32 s31, s31, 1
s_waitcnt vmcnt(0)
v_cmp_eq_u32 vcc, 0, v238
s_cmp_gt_u32 s31, 200000
s_cbranch_scc1 L_tagback_8
s_cbranch_vccnz L_tagslow_7
s_branch L_tagback_8
L_dbslow_11:
s_mov_b32 s67, 0
L_dbslow_11x:
buffer_load_dwordx2 v[148:149], v146, s[4:7], s66 offen sc1
s_add_u32 s67, s67, 1
s_waitcnt vmcnt(0)
v_cmp_ne_u64 vcc, v[148:149], v[238:239]
s_cmp_gt_u32 s67, 200000
s_cbranch_scc1 L_dbback_12
s_cbranch_vccnz L_dbslow_11x
s_branch L_dbback_12
L_stzslow_23:
s_mov_b32 s31, 0
L_stzloop_25:
buffer_load_dwordx2 v[182:183], v234, s[8:11], s61 offen offset:0 sc1
buffer_load_dwordx2 v[184:185], v234, s[8:11], s61 offen offset:1024 sc1
buffer_load_dwordx2 v[186:187], v234, s[8:11], s61 offen offset:2048 sc1
buffer_load_dwordx2 v[188:189], v234, s[8:11], s61 offen offset:3072 sc1
buffer_load_dwordx2 v[190:191], v235, s[8:11], s61 offen offset:0 sc1
buffer_load_dwordx2 v[192:193], v235, s[8:11], s61 offen offset:1024 sc1
buffer_load_dwordx2 v[194:195], v235, s[8:11], s61 offen offset:2048 sc1
buffer_load_dwordx2 v[196:197], v235, s[8:11], s61 offen offset:3072 sc1
s_add_u32 s31, s31, 1
s_waitcnt vmcnt(0)
v_min3_f32 v200, v183, v185, v187
v_min3_f32 v201, v189, v191, v193
v_min3_f32 v200, v200, v195, v197
v_min_f32 v200, v200, v201
v_cmp_gt_f32 vcc, 0, v200
s_cmp_gt_u32 s31, 200000
s_cbranch_scc1 L_stzback_24
s_cbranch_vccnz L_stzloop_25
s_branch L_stzback_24
L_xslow_36:
s_mov_b32 s31, 0
L_xloop_38:
buffer_load_dwordx4 v[80:83], v1, s[8:11], s63 offen offset:0 sc1
buffer_load_dwordx4 v[84:87], v1, s[8:11], s63 offen offset:1024 sc1
buffer_load_dwordx4 v[88:91], v1, s[8:11], s63 offen offset:2048 sc1
buffer_load_dwordx4 v[92:95], v1, s[8:11], s63 offen offset:3072 sc1
s_add_u32 s31, s31, 1
s_waitcnt vmcnt(0)
v_xor_b32 v118, v248, v83
v_xor_b32 v119, v248, v87
v_xor_b32 v120, v248, v91
v_xor_b32 v121, v248, v95
v_or3_b32 v118, v118, v119, v120
v_or_b32 v118, v118, v121
v_cmp_ne_u32 vcc, 0, v118
s_cmp_gt_u32 s31, 200000
s_cbranch_scc1 L_xback_37
s_cbranch_vccnz L_xloop_38
s_branch L_xback_37
L_code_end:
.section .rodata,"a"
.p2align 6
.amdhsa_kernel main_kernel
  .amdhsa_next_free_vgpr 512
  .amdhsa_next_free_sgpr 102
  .amdhsa_accum_offset 256
  .amdhsa_group_segment_fixed_size 0
  .amdhsa_kernarg_size 88
  .amdhsa_user_sgpr_count 2
  .amdhsa_user_sgpr_kernarg_segment_ptr 1
  .amdhsa_system_sgpr_workgroup_id_x 1
  .amdhsa_float_denorm_mode_32 3
.end_amdhsa_kernel
```

```asm
; @launch kernel=main_kernel grid=(256,1,1) block=(256,1,1) lds=163840
.amdgcn_target "amdgcn-amd-amdhsa--gfx950"
.text
.globl main_kernel
.p2align 8
.type main_kernel,@function
main_kernel:
s_cmp_ge_u32 s2, 256
s_cbranch_scc1 L_main_end
s_load_dwordx16 s[64:79], s[0:1], 0
s_memrealtime s[96:97]
s_load_dwordx2 s[4:5], s[0:1], 80
s_load_dwordx2 s[16:17], s[0:1], 64
s_load_dwordx2 s[84:85], s[0:1], 72
s_getpc_b64 s[88:89]
L_pc:
s_mov_b32 s90, L_code_end-L_pc
s_mov_b32 s91, 0x20000
s_lshr_b32 s31, s2, 3
s_lshl_b32 s31, s31, 10
v_lshl_add_u32 v14, v0, 2, s31
s_mov_b32 s37, L_pc-L_pc
buffer_load_dword v15, v14, s[88:91], s37 offen
v_lshrrev_b32 v6, 6, v0
v_and_b32 v0, 63, v0
v_readfirstlane_b32 s24, v6
v_lshlrev_b32 v1, 4, v0
v_and_b32 v2, 15, v0
v_lshrrev_b32 v3, 4, v0
v_cmp_gt_u32 s[50:51], 2, v3
s_nop 0
s_cmp_lt_u32 s2, 128
s_cbranch_scc1 L_p0_x1
s_sub_u32 s30, s2, 128
s_cmp_lt_u32 s30, 108
s_cselect_b32 s62, 0, 1073741824
s_cselect_b32 s30, s30, 0
s_and_b32 s60, s30, 3
s_lshr_b32 s61, s30, 2
s_mov_b32 s14, 1990656
s_mov_b32 s15, 0x20000
s_mul_i32 s30, s60, 497664
s_lshl_b32 s31, s61, 7
s_add_u32 s30, s30, s31
s_mul_i32 s31, s24, 27648
s_add_u32 s30, s30, s31
s_add_u32 s30, s30, s62
v_lshrrev_b32 v36, 7, v1
v_mul_u32_u24 v42, 3456, v36
v_and_b32 v36, 0x70, v1
v_add_u32 v42, v36, v42
s_lshl_b32 s32, s24, 10
s_waitcnt lgkmcnt(0)
s_mov_b32 s12, s66
s_mov_b32 s13, s67
s_add_u32 m0, s32, 0
s_add_u32 s31, s30, 0
buffer_load_dwordx4 v42, s[12:15], s31 offen nt lds
s_add_u32 m0, s32, 4096
s_add_u32 s31, s30, 110592
buffer_load_dwordx4 v42, s[12:15], s31 offen nt lds
s_add_u32 m0, s32, 8192
s_add_u32 s31, s30, 221184
buffer_load_dwordx4 v42, s[12:15], s31 offen nt lds
s_add_u32 m0, s32, 12288
s_add_u32 s31, s30, 331776
buffer_load_dwordx4 v42, s[12:15], s31 offen nt lds
s_add_u32 m0, s32, 16384
s_add_u32 s31, s30, 442368
s_cmp_lt_u32 s24, 2
s_cselect_b32 s31, s31, 1073741824
buffer_load_dwordx4 v42, s[12:15], s31 offen nt lds
s_branch L_p0_j1
L_p0_x1:
s_mov_b32 s14, 2359296
s_mov_b32 s15, 0x20000
s_mul_i32 s30, s24, 18
v_add_u32 v36, s30, v3
v_mul_u32_u24 v42, 1152, v2
v_lshl_add_u32 v42, v36, 4, v42
s_mul_i32 s30, s2, 18432
v_mov_b32 v37, 1073741824
v_cndmask_b32 v37, v37, v42, s[50:51]
s_waitcnt lgkmcnt(0)
s_mov_b32 s12, s64
s_mov_b32 s13, s65
buffer_load_dwordx4 v[64:67], v42, s[12:15], s30 offen offset:0
buffer_load_dwordx4 v[68:71], v42, s[12:15], s30 offen offset:64
buffer_load_dwordx4 v[72:75], v42, s[12:15], s30 offen offset:128
buffer_load_dwordx4 v[76:79], v42, s[12:15], s30 offen offset:192
buffer_load_dwordx4 v[80:83], v37, s[12:15], s30 offen offset:256
L_p0_j1:
s_mov_b32 s86, 256
s_mov_b32 s87, 0x20000
s_xor_b32 s30, s2, 248
s_or_b32 s30, s30, s24
s_cmp_eq_u32 s30, 0
s_cselect_b32 s30, 0, 1073741824
v_mov_b32 v48, 0
s_or_b32 s96, s96, 1
v_mov_b32 v238, s96
v_mov_b32 v239, s97
s_mov_b64 exec, 1
buffer_store_dwordx2 v[238:239], v48, s[84:87], s30 offen sc1
s_mov_b64 exec, -1
v_mov_b32 v4, 1
v_mov_b32 v5, 0
s_mov_b32 s56, 0
s_mov_b32 s29, 0
v_add_u32 v9, 66560, v1
v_cmp_eq_u32 s[46:47], 0, v3
v_cmp_eq_u32 s[48:49], 2, v3
s_mov_b32 s6, 19451904
s_mov_b32 s7, 0x20000
s_mov_b32 s10, 61669376
s_mov_b32 s11, 0x20000
s_mov_b32 s18, 2359296
s_mov_b32 s19, 0x20000
s_mov_b32 s22, 4096
s_mov_b32 s23, 0x20000
s_and_b32 s30, s2, 7
s_lshr_b32 s31, s2, 3
s_lshr_b32 s32, s31, 2
s_and_b32 s33, s31, 3
s_lshr_b32 s25, s30, 2
s_lshl_b32 s25, s25, 3
s_add_u32 s25, s25, s32
s_and_b32 s26, s30, 3
s_lshl_b32 s26, s26, 2
s_add_u32 s26, s26, s33
s_lshl_b32 s80, s25, 4
s_add_u32 s80, s80, s26
s_lshr_b32 s27, s80, 3
s_and_b32 s28, s26, 7
s_lshl_b32 s70, s25, 2
s_add_u32 s70, s70, s24
s_lshl_b32 s70, s70, 1
s_lshr_b32 s32, s26, 3
s_add_u32 s70, s70, s32
s_mul_i32 s71, s28, 9
s_add_u32 s71, s71, 1
s_lshr_b32 s71, s71, 1
s_add_u32 s8, s4, 19451904
s_addc_u32 s9, s5, 0
s_mov_b32 s20, s76
s_mov_b32 s21, s77
v_lshrrev_b32 v36, 2, v2
v_lshl_add_u32 v36, v3, 3, v36
v_lshlrev_b32 v45, 7, v36
v_and_b32 v36, 3, v2
v_lshl_add_u32 v45, v36, 3, v45
s_lshl_b32 s31, s24, 5
v_add_u32 v45, s31, v45
v_mov_b32 v164, 3212836864
v_mov_b32 v165, 3212836864
v_mov_b32 v166, 3212836864
v_mov_b32 v167, 3212836864
s_lshl_b32 s30, s80, 10
s_lshl_b32 s31, s24, 8
s_add_u32 s30, s30, s31
s_add_u32 s30, s30, 26214400
s_mov_b32 s31, 30834688
v_mul_lo_u32 v36, v3, s31
v_lshl_add_u32 v37, v2, 4, v36
s_mov_b32 exec_hi, 0
buffer_store_dwordx4 v[164:167], v37, s[8:11], s30 offen sc1
s_mov_b64 exec, -1
v_lshl_add_u32 v37, v2, 15, v36
s_lshl_b32 s30, s2, 7
s_add_u32 s30, s30, 26476544
s_cmp_eq_u32 s24, 0
s_cselect_b32 s30, s30, 1073741824
s_mov_b64 exec, 0x001f001f
buffer_store_dword v48, v37, s[8:11], s30 offen sc1
s_mov_b64 exec, -1
s_cmp_lt_u32 s2, 128
s_cbranch_scc1 L_p0_x2
s_mul_i32 s92, s61, 29
s_lshr_b32 s92, s92, 8
s_mul_i32 s33, s92, 9
s_sub_u32 s33, s61, s33
s_lshl_b32 s33, s33, 6
s_lshl_b32 s31, s24, 4
s_add_u32 s33, s33, s31
v_add_u32 v36, s33, v2
v_mul_u32_u24 v37, 911, v36
v_lshrrev_b32 v37, 14, v37
v_mul_u32_u24 v38, 18, v37
v_sub_u32 v36, v36, v38
v_and_b32 v38, 1, v37
v_lshrrev_b32 v37, 1, v37
s_mov_b32 s31, 132608
v_mul_lo_u32 v37, v37, s31
s_cmp_eq_u32 s92, 0
s_cselect_b32 s93, 5, 0
s_cselect_b32 s94, 8, 4
s_cmp_eq_u32 s92, 2
s_cselect_b32 s93, 2, s93
s_cselect_b32 s94, 0, s94
s_sub_u32 s94, s94, 16
v_add_u32 v39, s93, v38
v_lshl_add_u32 v40, v38, 1, v36
v_add_u32 v40, s94, v40
v_cmp_gt_u32 vcc, 16, v36
s_nop 1
v_cndmask_b32 v39, 4, v39, vcc
v_cndmask_b32 v40, v40, v36, vcc
v_lshl_add_u32 v43, v39, 10, v37
v_lshl_add_u32 v43, v40, 4, v43
v_lshl_add_u32 v44, v39, 9, v37
v_lshl_add_u32 v44, v40, 3, v44
s_lshl_b32 s31, s60, 7
s_add_u32 s31, s31, 129024
v_add_u32 v44, s31, v44
s_mul_i32 s31, s60, 18
v_add_u32 v37, s31, v3
v_and_b32 v38, 3, v37
v_lshrrev_b32 v37, 2, v37
v_mul_u32_u24 v37, 7168, v37
v_add_u32 v43, v43, v37
v_lshl_add_u32 v43, v38, 8, v43
s_waitcnt vmcnt(3)
s_barrier
ds_read_b64_tr_b16 v[64:65], v45 offset:0
ds_read_b64_tr_b16 v[66:67], v45 offset:512
ds_read_b64_tr_b16 v[68:69], v45 offset:4096
ds_read_b64_tr_b16 v[70:71], v45 offset:4608
ds_read_b64_tr_b16 v[72:73], v45 offset:8192
ds_read_b64_tr_b16 v[74:75], v45 offset:8704
ds_read_b64_tr_b16 v[76:77], v45 offset:12288
ds_read_b64_tr_b16 v[78:79], v45 offset:12800
ds_read_b64_tr_b16 v[80:81], v45 offset:16384
ds_read_b64_tr_b16 v[82:83], v45 offset:16896
v_mov_b32 v36, 1073741824
v_mov_b32 v46, 0
v_cndmask_b32 v37, v36, v43, s[50:51]
s_add_u32 s31, s62, 0
s_waitcnt lgkmcnt(8)
buffer_store_dwordx4 v[64:67], v43, s[4:7], s31 offen sc1
s_add_u32 s31, s62, 7168
s_waitcnt lgkmcnt(6)
buffer_store_dwordx4 v[68:71], v43, s[4:7], s31 offen sc1
s_add_u32 s31, s62, 14336
s_waitcnt lgkmcnt(4)
buffer_store_dwordx4 v[72:75], v43, s[4:7], s31 offen sc1
s_add_u32 s31, s62, 21504
s_waitcnt lgkmcnt(2)
buffer_store_dwordx4 v[76:79], v43, s[4:7], s31 offen sc1
s_add_u32 s31, s62, 28672
s_waitcnt lgkmcnt(0)
buffer_store_dwordx4 v[80:83], v37, s[4:7], s31 offen sc1
v_mov_b32 v37, 0x3f803f80
v_dot2c_f32_bf16 v46, v64, v37
v_dot2c_f32_bf16 v46, v65, v37
v_dot2c_f32_bf16 v46, v66, v37
v_dot2c_f32_bf16 v46, v67, v37
v_dot2c_f32_bf16 v46, v68, v37
v_dot2c_f32_bf16 v46, v69, v37
v_dot2c_f32_bf16 v46, v70, v37
v_dot2c_f32_bf16 v46, v71, v37
v_dot2c_f32_bf16 v46, v72, v37
v_dot2c_f32_bf16 v46, v73, v37
v_dot2c_f32_bf16 v46, v74, v37
v_dot2c_f32_bf16 v46, v75, v37
v_dot2c_f32_bf16 v46, v76, v37
v_dot2c_f32_bf16 v46, v77, v37
v_dot2c_f32_bf16 v46, v78, v37
v_dot2c_f32_bf16 v46, v79, v37
v_dot2c_f32_bf16 v46, v80, v37
v_dot2c_f32_bf16 v46, v81, v37
v_dot2c_f32_bf16 v46, v82, v37
v_dot2c_f32_bf16 v46, v83, v37
s_nop 2
v_mov_b32 v37, v46
s_nop 1
v_permlane32_swap_b32 v46, v37
v_add_f32 v46, v46, v37
v_mov_b32 v37, v46
s_nop 1
v_permlane16_swap_b32 v46, v37
v_add_f32 v46, v46, v37
v_cvt_pk_bf16_f32 v50, v46, v46
v_and_b32 v37, 0xffff0000, v50
v_sub_f32 v37, v46, v37
v_cvt_pk_bf16_f32 v51, v37, v37
v_cndmask_b32 v36, v36, v44, s[46:47]
buffer_store_dwordx2 v[50:51], v36, s[4:7], s62 offen sc1
s_branch L_p0_j2
L_p0_x2:
s_mul_i32 s30, s24, 4608
s_mul_i32 s31, s2, 18432
s_add_u32 s31, s31, s30
s_add_u32 s31, s31, 0
v_mov_b32 v36, 1073741824
v_add_u32 v38, 4096, v1
v_cndmask_b32 v38, v36, v38, s[50:51]
v_mov_b32 v46, 0
v_mov_b32 v47, 0
v_mov_b32 v39, 0x3f803f80
s_waitcnt vmcnt(3)
buffer_store_dwordx4 v[64:67], v1, s[8:11], s31 offen offset:0 sc1
buffer_store_dwordx4 v[68:71], v1, s[8:11], s31 offen offset:1024 sc1
buffer_store_dwordx4 v[72:75], v1, s[8:11], s31 offen offset:2048 sc1
buffer_store_dwordx4 v[76:79], v1, s[8:11], s31 offen offset:3072 sc1
buffer_store_dwordx4 v[80:83], v38, s[8:11], s31 offen offset:0 sc1
v_dot2c_f32_bf16 v46, v64, v39
v_dot2c_f32_bf16 v46, v65, v39
v_dot2c_f32_bf16 v46, v66, v39
v_dot2c_f32_bf16 v46, v67, v39
v_dot2c_f32_bf16 v46, v68, v39
v_dot2c_f32_bf16 v46, v69, v39
v_dot2c_f32_bf16 v46, v70, v39
v_dot2c_f32_bf16 v46, v71, v39
v_dot2c_f32_bf16 v46, v72, v39
v_dot2c_f32_bf16 v46, v73, v39
v_dot2c_f32_bf16 v46, v74, v39
v_dot2c_f32_bf16 v46, v75, v39
v_dot2c_f32_bf16 v46, v76, v39
v_dot2c_f32_bf16 v46, v77, v39
v_dot2c_f32_bf16 v46, v78, v39
v_dot2c_f32_bf16 v46, v79, v39
v_dot2c_f32_bf16 v46, v80, v39
v_dot2c_f32_bf16 v46, v81, v39
v_dot2c_f32_bf16 v46, v82, v39
v_dot2c_f32_bf16 v46, v83, v39
v_dot2c_f32_bf16 v47, v64, v64
v_dot2c_f32_bf16 v47, v65, v65
v_dot2c_f32_bf16 v47, v66, v66
v_dot2c_f32_bf16 v47, v67, v67
v_dot2c_f32_bf16 v47, v68, v68
v_dot2c_f32_bf16 v47, v69, v69
v_dot2c_f32_bf16 v47, v70, v70
v_dot2c_f32_bf16 v47, v71, v71
v_dot2c_f32_bf16 v47, v72, v72
v_dot2c_f32_bf16 v47, v73, v73
v_dot2c_f32_bf16 v47, v74, v74
v_dot2c_f32_bf16 v47, v75, v75
v_dot2c_f32_bf16 v47, v76, v76
v_dot2c_f32_bf16 v47, v77, v77
v_dot2c_f32_bf16 v47, v78, v78
v_dot2c_f32_bf16 v47, v79, v79
v_dot2c_f32_bf16 v47, v80, v80
v_dot2c_f32_bf16 v47, v81, v81
v_dot2c_f32_bf16 v47, v82, v82
v_dot2c_f32_bf16 v47, v83, v83
v_mov_b32 v37, v46
s_nop 1
v_permlane32_swap_b32 v46, v37
v_add_f32 v46, v46, v37
v_mov_b32 v37, v46
s_nop 1
v_permlane16_swap_b32 v46, v37
v_add_f32 v46, v46, v37
v_mov_b32 v37, v47
s_nop 1
v_permlane32_swap_b32 v47, v37
v_add_f32 v47, v47, v37
v_mov_b32 v37, v47
s_nop 1
v_permlane16_swap_b32 v47, v37
v_add_f32 v47, v47, v37
s_lshl_b32 s30, s2, 7
s_lshl_b32 s31, s24, 14
s_add_u32 s30, s30, s31
s_add_u32 s30, s30, 2359296
v_cndmask_b32 v50, 0, v46, s[46:47]
v_cndmask_b32 v51, 0, v47, s[46:47]
v_lshlrev_b32 v37, 3, v2
v_lshl_add_u32 v37, v3, 16, v37
v_cndmask_b32 v37, v36, v37, s[50:51]
buffer_store_dwordx2 v[50:51], v37, s[8:11], s30 offen sc1
L_p0_j2:
buffer_load_dwordx2 v[238:239], v48, s[84:87], 0 offen sc1
s_sub_u32 s30, s2, 0
s_cmp_lt_u32 s30, 256
s_cselect_b32 s36, 0, 1073741824
s_cselect_b32 s30, s30, 0
s_and_b32 s34, s30, 3
s_lshr_b32 s35, s30, 2
s_mov_b32 s14, 5308416
s_mov_b32 s15, 0x20000
s_mul_i32 s30, s34, 1327104
s_lshl_b32 s31, s35, 7
s_add_u32 s30, s30, s31
s_mul_i32 s31, s24, 73728
s_add_u32 s30, s30, s31
s_add_u32 s30, s30, s36
v_lshrrev_b32 v36, 7, v1
v_mul_u32_u24 v42, 9216, v36
v_and_b32 v36, 0x70, v1
v_add_u32 v42, v36, v42
s_lshl_b32 s32, s24, 10
s_mov_b32 s12, s72
s_mov_b32 s13, s73
s_add_u32 m0, s32, 20480
s_add_u32 s31, s30, 0
buffer_load_dwordx4 v42, s[12:15], s31 offen nt lds
s_add_u32 m0, s32, 24576
s_add_u32 s31, s30, 294912
buffer_load_dwordx4 v42, s[12:15], s31 offen nt lds
s_add_u32 m0, s32, 28672
s_add_u32 s31, s30, 589824
buffer_load_dwordx4 v42, s[12:15], s31 offen nt lds
s_add_u32 m0, s32, 32768
s_add_u32 s31, s30, 884736
buffer_load_dwordx4 v42, s[12:15], s31 offen nt lds
s_add_u32 m0, s32, 36864
s_add_u32 s31, s30, 1179648
s_cmp_lt_u32 s24, 2
s_cselect_b32 s31, s31, 1073741824
buffer_load_dwordx4 v42, s[12:15], s31 offen nt lds
s_sub_u32 s30, s2, 0
s_cmp_lt_u32 s30, 256
s_cselect_b32 s36, 0, 1073741824
s_cselect_b32 s30, s30, 0
s_and_b32 s34, s30, 3
s_lshr_b32 s35, s30, 2
s_lshl_b32 s92, s35, 6
s_lshl_b32 s33, s24, 4
s_add_u32 s92, s92, s33
s_cmp_ge_u32 s92, 2304
s_cselect_b32 s93, 1, 0
s_cselect_b32 s33, 2304, 0
s_sub_u32 s92, s92, s33
s_mul_i32 s94, s92, 1821
s_lshr_b32 s94, s94, 19
s_mul_i32 s33, s94, 288
s_sub_u32 s92, s92, s33
s_lshr_b32 s95, s92, 5
s_bfe_u32 s96, s92, 0x10004
s_lshl_b32 s94, s94, 1
s_cmp_ge_u32 s92, 144
s_addc_u32 s94, s94, 0
s_cmp_gt_u32 s95, 4
s_cselect_b32 s33, 5, 0
s_sub_u32 s97, s95, s33
s_cmp_eq_u32 s93, 0
s_cselect_b32 s33, 5, 0
s_add_u32 s97, s97, s33
s_cmp_eq_u32 s95, 4
s_cselect_b32 s97, 4, s97
s_mul_i32 s94, s94, 9
s_add_u32 s94, s94, s97
s_mul_i32 s94, s94, 37888
s_add_u32 s94, s94, 2785280
v_and_b32 v36, 3, v2
v_bfe_u32 v37, v2, 2, 1
v_bfe_u32 v38, v2, 3, 1
v_lshl_add_u32 v36, v38, 2, v36
s_lshl_b32 s33, s96, 3
v_add_u32 v36, s33, v36
s_cmp_eq_u32 s95, 4
s_cbranch_scc0 L_w3j_3
s_xor_b32 s33, s93, 1
v_mov_b32 v36, v2
v_mov_b32 v37, s33
L_w3j_3:
v_mul_u32_u24 v170, 18432, v37
v_lshl_add_u32 v170, v36, 4, v170
v_lshl_add_u32 v170, v3, 8, v170
s_mul_i32 s31, s34, 4608
s_add_u32 s31, s31, s94
v_add_u32 v170, s31, v170
v_lshlrev_b32 v171, 9, v37
v_lshl_add_u32 v171, v36, 3, v171
s_lshl_b32 s31, s34, 7
s_add_u32 s31, s31, s94
s_add_u32 s31, s31, 36864
v_add_u32 v171, s31, v171
v_mov_b32 v172, 1073741824
v_mov_b32 v52, 1073741824
v_mov_b32 v53, 1073741824
v_mov_b32 v54, 1073741824
v_mov_b32 v55, 1073741824
v_mov_b32 v56, 1073741824
s_cmp_lt_u32 s2, 32
s_cbranch_scc1 L_p0_a5
s_cmp_lt_u32 s2, 176
s_cbranch_scc1 L_p0_b5
s_sub_u32 s30, s2, 176
s_cmp_lt_u32 s30, 36
s_cselect_b32 s53, 0, 1073741824
s_cselect_b32 s30, s30, 0
s_and_b32 s38, s30, 3
s_lshr_b32 s52, s30, 2
v_lshrrev_b32 v39, 2, v2
v_and_b32 v40, 3, v2
v_lshlrev_b32 v40, 3, v40
s_lshl_b32 s31, s24, 5
v_add_u32 v40, s31, v40
v_lshl_add_u32 v36, v3, 2, v39
v_lshl_add_u32 v52, v36, 7, v40
v_lshrrev_b32 v36, 1, v39
v_mul_u32_u24 v36, 18, v36
v_and_b32 v41, 1, v39
v_add3_u32 v36, v36, v41, 16
v_and_b32 v41, 1, v3
v_mul_u32_u24 v41, 72, v41
v_add_u32 v36, v36, v41
v_lshl_add_u32 v53, v36, 7, v40
s_lshl_b32 s31, s52, 6
s_lshl_b32 s33, s24, 4
s_add_u32 s31, s31, s33
v_add_u32 v36, s31, v2
v_mul_u32_u24 v37, 911, v36
v_lshrrev_b32 v37, 16, v37
v_mul_u32_u24 v38, 72, v37
v_sub_u32 v36, v36, v38
s_mov_b32 s31, 82944
v_mul_lo_u32 v41, v37, s31
v_mov_b32 v173, v37
v_add_u32 v41, 2121728, v41
v_lshrrev_b32 v39, 5, v36
v_lshlrev_b32 v39, 11, v39
v_bfe_u32 v40, v36, 2, 1
v_lshl_add_u32 v39, v40, 10, v39
v_bfe_u32 v40, v36, 3, 2
v_lshl_add_u32 v39, v40, 6, v39
v_and_b32 v40, 3, v36
v_lshl_add_u32 v39, v40, 4, v39
v_lshlrev_b32 v40, 4, v36
v_add_u32 v40, 3072, v40
v_cmp_gt_u32 vcc, 64, v36
v_mov_b32 v47, 7
s_nop 0
v_cndmask_b32 v39, v40, v39, vcc
v_cndmask_b32 v47, v47, 8, vcc
v_add_u32 v41, v41, v39
s_mul_i32 s31, s38, 16
s_add_u32 s31, s31, 0
v_add_u32 v37, s31, v3
v_and_b32 v38, 3, v37
v_lshrrev_b32 v37, 2, v37
v_mul_u32_u24 v37, 4608, v37
v_lshlrev_b32 v38, v47, v38
v_add3_u32 v172, v41, v37, v38
s_mul_i32 s31, s38, 2
s_add_u32 s31, s31, 64
v_add_u32 v37, s31, v3
v_and_b32 v38, 3, v37
v_lshrrev_b32 v37, 2, v37
v_mul_u32_u24 v37, 4608, v37
v_lshlrev_b32 v38, v47, v38
v_add3_u32 v173, v41, v37, v38
s_branch L_p0_j5
L_p0_b5:
s_sub_u32 s30, s2, 32
s_cmp_lt_u32 s30, 144
s_cselect_b32 s53, 0, 1073741824
s_cselect_b32 s30, s30, 0
s_and_b32 s38, s30, 15
s_lshr_b32 s52, s30, 4
s_lshl_b32 s31, s52, 6
s_lshl_b32 s33, s24, 4
s_add_u32 s31, s31, s33
v_add_u32 v36, s31, v2
v_mul_u32_u24 v37, 911, v36
v_lshrrev_b32 v37, 16, v37
v_mul_u32_u24 v38, 72, v37
v_sub_u32 v36, v36, v38
s_mov_b32 s31, 331776
v_mul_lo_u32 v41, v37, s31
v_mov_b32 v173, v37
v_add_u32 v41, 8241152, v41
v_lshrrev_b32 v39, 5, v36
v_lshlrev_b32 v39, 11, v39
v_bfe_u32 v40, v36, 2, 1
v_lshl_add_u32 v39, v40, 10, v39
v_bfe_u32 v40, v36, 3, 2
v_lshl_add_u32 v39, v40, 6, v39
v_and_b32 v40, 3, v36
v_lshl_add_u32 v39, v40, 4, v39
v_lshlrev_b32 v40, 4, v36
v_add_u32 v40, 3072, v40
v_cmp_gt_u32 vcc, 64, v36
v_mov_b32 v47, 7
s_nop 0
v_cndmask_b32 v39, v40, v39, vcc
v_cndmask_b32 v47, v47, 8, vcc
v_add_u32 v41, v41, v39
v_mad_u32_u24 v46, v173, 9, 1
v_lshrrev_b32 v46, 1, v46
s_mul_i32 s31, s38, 18
v_add_u32 v37, s31, v3
v_and_b32 v38, 3, v37
v_lshrrev_b32 v37, 2, v37
v_lshlrev_b32 v38, v47, v38
v_add_u32 v41, v41, v38
s_cmp_ge_u32 s38, 8
s_cselect_b32 s31, 36, 0
v_add_u32 v38, s31, v46
v_sub_u32 v46, 0, v46
s_movk_i32 s31, 4608
v_add_u32 v36, 0, v37
v_sub_u32 v39, v36, v38
v_cmp_gt_u32 vcc, 4, v39
v_ashrrev_i32 v40, 31, v39
v_and_b32 v40, 4, v40
v_cndmask_b32 v40, v40, v46, vcc
v_add_u32 v36, v36, v40
v_mad_u32_u24 v52, v36, s31, v41
v_add_u32 v36, 1, v37
v_sub_u32 v39, v36, v38
v_cmp_gt_u32 vcc, 4, v39
v_ashrrev_i32 v40, 31, v39
v_and_b32 v40, 4, v40
v_cndmask_b32 v40, v40, v46, vcc
v_add_u32 v36, v36, v40
v_mad_u32_u24 v53, v36, s31, v41
v_add_u32 v36, 2, v37
v_sub_u32 v39, v36, v38
v_cmp_gt_u32 vcc, 4, v39
v_ashrrev_i32 v40, 31, v39
v_and_b32 v40, 4, v40
v_cndmask_b32 v40, v40, v46, vcc
v_add_u32 v36, v36, v40
v_mad_u32_u24 v54, v36, s31, v41
v_add_u32 v36, 3, v37
v_sub_u32 v39, v36, v38
v_cmp_gt_u32 vcc, 4, v39
v_ashrrev_i32 v40, 31, v39
v_and_b32 v40, 4, v40
v_cndmask_b32 v40, v40, v46, vcc
v_add_u32 v36, v36, v40
v_mad_u32_u24 v55, v36, s31, v41
v_add_u32 v36, 4, v37
v_sub_u32 v39, v36, v38
v_cmp_gt_u32 vcc, 4, v39
v_ashrrev_i32 v40, 31, v39
v_and_b32 v40, 4, v40
v_cndmask_b32 v40, v40, v46, vcc
v_add_u32 v36, v36, v40
v_mad_u32_u24 v56, v36, s31, v41
s_branch L_p0_j5
L_p0_a5:
s_add_u32 s30, s2, 256
s_cmp_lt_u32 s30, 288
s_cselect_b32 s53, 0, 1073741824
s_cselect_b32 s30, s30, 0
s_and_b32 s38, s30, 3
s_lshr_b32 s52, s30, 2
s_lshl_b32 s92, s52, 6
s_lshl_b32 s33, s24, 4
s_add_u32 s92, s92, s33
s_cmp_ge_u32 s92, 2304
s_cselect_b32 s93, 1, 0
s_cselect_b32 s33, 2304, 0
s_sub_u32 s92, s92, s33
s_mul_i32 s94, s92, 1821
s_lshr_b32 s94, s94, 19
s_mul_i32 s33, s94, 288
s_sub_u32 s92, s92, s33
s_lshr_b32 s95, s92, 5
s_bfe_u32 s96, s92, 0x10004
s_lshl_b32 s94, s94, 1
s_cmp_ge_u32 s92, 144
s_addc_u32 s94, s94, 0
s_cmp_gt_u32 s95, 4
s_cselect_b32 s33, 5, 0
s_sub_u32 s97, s95, s33
s_cmp_eq_u32 s93, 0
s_cselect_b32 s33, 5, 0
s_add_u32 s97, s97, s33
s_cmp_eq_u32 s95, 4
s_cselect_b32 s97, 4, s97
s_mul_i32 s94, s94, 9
s_add_u32 s94, s94, s97
s_mul_i32 s94, s94, 37888
s_add_u32 s94, s94, 2785280
v_and_b32 v36, 3, v2
v_bfe_u32 v37, v2, 2, 1
v_bfe_u32 v38, v2, 3, 1
v_lshl_add_u32 v36, v38, 2, v36
s_lshl_b32 s33, s96, 3
v_add_u32 v36, s33, v36
s_cmp_eq_u32 s95, 4
s_cbranch_scc0 L_w3j_6
s_xor_b32 s33, s93, 1
v_mov_b32 v36, v2
v_mov_b32 v37, s33
L_w3j_6:
v_mul_u32_u24 v172, 18432, v37
v_lshl_add_u32 v172, v36, 4, v172
v_lshl_add_u32 v172, v3, 8, v172
s_mul_i32 s31, s38, 4608
s_add_u32 s31, s31, s94
v_add_u32 v172, s31, v172
v_lshlrev_b32 v173, 9, v37
v_lshl_add_u32 v173, v36, 3, v173
s_lshl_b32 s31, s38, 7
s_add_u32 s31, s31, s94
s_add_u32 s31, s31, 36864
v_add_u32 v173, s31, v173
L_p0_j5:
s_lshl_b32 s30, s25, 2
s_add_u32 s30, s30, s24
s_mul_i32 s31, s30, 133120
s_lshl_b32 s30, s30, 17
s_mul_i32 s32, s24, 0
s_add_u32 s32, s32, s26
s_and_b32 s32, s32, 15
s_lshl_b32 s3, s32, 8
s_add_u32 s3, s3, s30
s_lshl_b32 s101, s32, 12
s_add_u32 s101, s101, s31
s_add_u32 s101, s101, 10895360
v_lshrrev_b32 v41, 4, v1
s_lshl_b32 s30, s25, 3
s_sub_u32 s30, s30, 1
v_add_u32 v36, s30, v41
v_max_i32 v36, 0, v36
v_bfe_u32 v37, v41, 2, 1
v_mul_u32_u24 v37, 35, v37
s_mul_i32 s30, s26, 36
v_add_u32 v37, s30, v37
v_lshrrev_b32 v37, 6, v37
v_bfe_u32 v38, v41, 3, 2
v_mad_u32_u24 v37, v38, 9, v37
v_and_b32 v38, 3, v41
v_lshl_add_u32 v37, v37, 2, v38
v_add_u32 v37, 128, v37
v_cndmask_b32 v36, v37, v36, s[50:51]
v_lshlrev_b32 v174, 7, v36
s_lshl_b32 s30, s2, 7
s_add_u32 s30, s30, 19415040
s_lshl_b32 s32, s2, 3
s_add_u32 s32, s32, 19447808
s_cmp_eq_u32 s24, 0
s_cselect_b32 s30, s30, 1073741824
s_cselect_b32 s100, s32, 1073741824
s_waitcnt vmcnt(5)
v_cmp_eq_u32 vcc, 0, v238
s_mov_b32 s31, 0
s_cbranch_vccnz L_tagslow_7
L_tagback_8:
s_barrier
s_mov_b64 exec, 1
buffer_store_dwordx2 v[238:239], v48, s[4:7], s30 offen sc1
s_mov_b64 exec, -1
s_cmp_lt_u32 s2, 32
s_cbranch_scc1 L_p0_a3
s_cmp_lt_u32 s2, 176
s_cbranch_scc1 L_p0_b3
s_mov_b32 s14, 663552
s_mov_b32 s15, 0x20000
s_mul_i32 s30, s38, 165888
s_lshl_b32 s31, s52, 7
s_add_u32 s30, s30, s31
s_mul_i32 s31, s24, 9216
s_add_u32 s30, s30, s31
s_add_u32 s30, s30, s53
v_lshrrev_b32 v36, 7, v1
v_mul_u32_u24 v42, 1152, v36
v_and_b32 v36, 0x70, v1
v_add_u32 v42, v36, v42
s_lshl_b32 s32, s24, 10
s_mov_b32 s12, s68
s_mov_b32 s13, s69
s_add_u32 m0, s32, 40960
s_add_u32 s31, s30, 0
buffer_load_dwordx4 v42, s[12:15], s31 offen nt lds
s_add_u32 m0, s32, 45056
s_add_u32 s31, s30, 36864
buffer_load_dwordx4 v42, s[12:15], s31 offen nt lds
s_add_u32 m0, s32, 49152
s_add_u32 s31, s30, 73728
buffer_load_dwordx4 v42, s[12:15], s31 offen nt lds
s_add_u32 m0, s32, 53248
s_add_u32 s31, s30, 110592
buffer_load_dwordx4 v42, s[12:15], s31 offen nt lds
s_add_u32 m0, s32, 57344
s_add_u32 s31, s30, 147456
s_cmp_lt_u32 s24, 2
s_cselect_b32 s31, s31, 1073741824
buffer_load_dwordx4 v42, s[12:15], s31 offen nt lds
s_branch L_p0_j3
L_p0_b3:
s_mov_b32 s14, 2654208
s_mov_b32 s15, 0x20000
s_mul_i32 s30, s38, 165888
s_lshl_b32 s31, s52, 7
s_add_u32 s30, s30, s31
s_mul_i32 s31, s24, 9216
s_add_u32 s30, s30, s31
s_add_u32 s30, s30, s53
v_lshrrev_b32 v36, 7, v1
v_mul_u32_u24 v42, 1152, v36
v_and_b32 v36, 0x70, v1
v_add_u32 v42, v36, v42
s_lshl_b32 s32, s24, 10
s_mov_b32 s12, s78
s_mov_b32 s13, s79
s_add_u32 m0, s32, 40960
s_add_u32 s31, s30, 0
buffer_load_dwordx4 v42, s[12:15], s31 offen nt lds
s_add_u32 m0, s32, 45056
s_add_u32 s31, s30, 36864
buffer_load_dwordx4 v42, s[12:15], s31 offen nt lds
s_add_u32 m0, s32, 49152
s_add_u32 s31, s30, 73728
buffer_load_dwordx4 v42, s[12:15], s31 offen nt lds
s_add_u32 m0, s32, 53248
s_add_u32 s31, s30, 110592
buffer_load_dwordx4 v42, s[12:15], s31 offen nt lds
s_add_u32 m0, s32, 57344
s_add_u32 s31, s30, 147456
s_cmp_lt_u32 s24, 2
s_cselect_b32 s31, s31, 1073741824
buffer_load_dwordx4 v42, s[12:15], s31 offen nt lds
s_branch L_p0_j3
L_p0_a3:
s_mov_b32 s14, 5308416
s_mov_b32 s15, 0x20000
s_mul_i32 s30, s38, 1327104
s_lshl_b32 s31, s52, 7
s_add_u32 s30, s30, s31
s_mul_i32 s31, s24, 73728
s_add_u32 s30, s30, s31
s_add_u32 s30, s30, s53
v_lshrrev_b32 v36, 7, v1
v_mul_u32_u24 v42, 9216, v36
v_and_b32 v36, 0x70, v1
v_add_u32 v42, v36, v42
s_lshl_b32 s32, s24, 10
s_mov_b32 s12, s72
s_mov_b32 s13, s73
s_add_u32 m0, s32, 40960
s_add_u32 s31, s30, 0
buffer_load_dwordx4 v42, s[12:15], s31 offen nt lds
s_add_u32 m0, s32, 45056
s_add_u32 s31, s30, 294912
buffer_load_dwordx4 v42, s[12:15], s31 offen nt lds
s_add_u32 m0, s32, 49152
s_add_u32 s31, s30, 589824
buffer_load_dwordx4 v42, s[12:15], s31 offen nt lds
s_add_u32 m0, s32, 53248
s_add_u32 s31, s30, 884736
buffer_load_dwordx4 v42, s[12:15], s31 offen nt lds
s_add_u32 m0, s32, 57344
s_add_u32 s31, s30, 1179648
s_cmp_lt_u32 s24, 2
s_cselect_b32 s31, s31, 1073741824
buffer_load_dwordx4 v42, s[12:15], s31 offen nt lds
L_p0_j3:
s_waitcnt vmcnt(6)
s_barrier
ds_read_b64_tr_b16 v[84:85], v45 offset:20480
ds_read_b64_tr_b16 v[86:87], v45 offset:20992
ds_read_b64_tr_b16 v[88:89], v45 offset:24576
ds_read_b64_tr_b16 v[90:91], v45 offset:25088
ds_read_b64_tr_b16 v[92:93], v45 offset:28672
ds_read_b64_tr_b16 v[94:95], v45 offset:29184
ds_read_b64_tr_b16 v[96:97], v45 offset:32768
ds_read_b64_tr_b16 v[98:99], v45 offset:33280
ds_read_b64_tr_b16 v[100:101], v45 offset:36864
ds_read_b64_tr_b16 v[102:103], v45 offset:37376
v_mov_b32 v36, 1073741824
v_mov_b32 v46, 0
v_cndmask_b32 v37, v36, v170, s[50:51]
s_add_u32 s31, s36, 0
s_waitcnt lgkmcnt(8)
buffer_store_dwordx4 v[84:87], v170, s[4:7], s31 offen sc1
s_add_u32 s31, s36, 1024
s_waitcnt lgkmcnt(6)
buffer_store_dwordx4 v[88:91], v170, s[4:7], s31 offen sc1
s_add_u32 s31, s36, 2048
s_waitcnt lgkmcnt(4)
buffer_store_dwordx4 v[92:95], v170, s[4:7], s31 offen sc1
s_add_u32 s31, s36, 3072
s_waitcnt lgkmcnt(2)
buffer_store_dwordx4 v[96:99], v170, s[4:7], s31 offen sc1
s_add_u32 s31, s36, 4096
s_waitcnt lgkmcnt(0)
buffer_store_dwordx4 v[100:103], v37, s[4:7], s31 offen sc1
v_mov_b32 v37, 0x3f803f80
v_dot2c_f32_bf16 v46, v84, v37
v_dot2c_f32_bf16 v46, v85, v37
v_dot2c_f32_bf16 v46, v86, v37
v_dot2c_f32_bf16 v46, v87, v37
v_dot2c_f32_bf16 v46, v88, v37
v_dot2c_f32_bf16 v46, v89, v37
v_dot2c_f32_bf16 v46, v90, v37
v_dot2c_f32_bf16 v46, v91, v37
v_dot2c_f32_bf16 v46, v92, v37
v_dot2c_f32_bf16 v46, v93, v37
v_dot2c_f32_bf16 v46, v94, v37
v_dot2c_f32_bf16 v46, v95, v37
v_dot2c_f32_bf16 v46, v96, v37
v_dot2c_f32_bf16 v46, v97, v37
v_dot2c_f32_bf16 v46, v98, v37
v_dot2c_f32_bf16 v46, v99, v37
v_dot2c_f32_bf16 v46, v100, v37
v_dot2c_f32_bf16 v46, v101, v37
v_dot2c_f32_bf16 v46, v102, v37
v_dot2c_f32_bf16 v46, v103, v37
s_nop 2
v_mov_b32 v37, v46
s_nop 1
v_permlane32_swap_b32 v46, v37
v_add_f32 v46, v46, v37
v_mov_b32 v37, v46
s_nop 1
v_permlane16_swap_b32 v46, v37
v_add_f32 v46, v46, v37
v_cvt_pk_bf16_f32 v50, v46, v46
v_and_b32 v37, 0xffff0000, v50
v_sub_f32 v37, v46, v37
v_cvt_pk_bf16_f32 v51, v37, v37
v_cndmask_b32 v36, v36, v171, s[46:47]
buffer_store_dwordx2 v[50:51], v36, s[4:7], s36 offen sc1
s_waitcnt vmcnt(6)
s_barrier
s_cmp_lt_u32 s2, 32
s_cbranch_scc1 L_p0_a4
s_cmp_lt_u32 s2, 176
s_cbranch_scc1 L_p0_b4
ds_read_b64_tr_b16 v[104:105], v52 offset:40960
ds_read_b64_tr_b16 v[106:107], v52 offset:43264
ds_read_b64_tr_b16 v[108:109], v52 offset:45568
ds_read_b64_tr_b16 v[110:111], v52 offset:47872
ds_read_b64_tr_b16 v[112:113], v52 offset:50176
ds_read_b64_tr_b16 v[114:115], v52 offset:52480
ds_read_b64_tr_b16 v[116:117], v52 offset:54784
ds_read_b64_tr_b16 v[118:119], v52 offset:57088
ds_read_b64_tr_b16 v[120:121], v53 offset:40960
ds_read_b64_tr_b16 v[122:123], v53 offset:45568
v_mov_b32 v36, 1073741824
v_mov_b32 v46, 0
v_cndmask_b32 v37, v36, v173, s[50:51]
s_add_u32 s31, s53, 0
s_waitcnt lgkmcnt(8)
buffer_store_dwordx4 v[104:107], v172, s[4:7], s31 offen sc1
s_add_u32 s31, s53, 4608
s_waitcnt lgkmcnt(6)
buffer_store_dwordx4 v[108:111], v172, s[4:7], s31 offen sc1
s_add_u32 s31, s53, 9216
s_waitcnt lgkmcnt(4)
buffer_store_dwordx4 v[112:115], v172, s[4:7], s31 offen sc1
s_add_u32 s31, s53, 13824
s_waitcnt lgkmcnt(2)
buffer_store_dwordx4 v[116:119], v172, s[4:7], s31 offen sc1
s_add_u32 s31, s53, 0
s_waitcnt lgkmcnt(0)
buffer_store_dwordx4 v[120:123], v37, s[4:7], s31 offen sc1
buffer_store_dwordx2 v[50:51], v36, s[4:7], s53 offen sc1
s_branch L_p0_j4
L_p0_b4:
ds_read_b64_tr_b16 v[104:105], v45 offset:40960
ds_read_b64_tr_b16 v[106:107], v45 offset:41472
ds_read_b64_tr_b16 v[108:109], v45 offset:45056
ds_read_b64_tr_b16 v[110:111], v45 offset:45568
ds_read_b64_tr_b16 v[112:113], v45 offset:49152
ds_read_b64_tr_b16 v[114:115], v45 offset:49664
ds_read_b64_tr_b16 v[116:117], v45 offset:53248
ds_read_b64_tr_b16 v[118:119], v45 offset:53760
ds_read_b64_tr_b16 v[120:121], v45 offset:57344
ds_read_b64_tr_b16 v[122:123], v45 offset:57856
v_mov_b32 v36, 1073741824
v_mov_b32 v46, 0
v_cndmask_b32 v37, v36, v56, s[50:51]
s_add_u32 s31, s53, 0
s_waitcnt lgkmcnt(8)
buffer_store_dwordx4 v[104:107], v52, s[4:7], s31 offen sc1
s_add_u32 s31, s53, 0
s_waitcnt lgkmcnt(6)
buffer_store_dwordx4 v[108:111], v53, s[4:7], s31 offen sc1
s_add_u32 s31, s53, 0
s_waitcnt lgkmcnt(4)
buffer_store_dwordx4 v[112:115], v54, s[4:7], s31 offen sc1
s_add_u32 s31, s53, 0
s_waitcnt lgkmcnt(2)
buffer_store_dwordx4 v[116:119], v55, s[4:7], s31 offen sc1
s_add_u32 s31, s53, 0
s_waitcnt lgkmcnt(0)
buffer_store_dwordx4 v[120:123], v37, s[4:7], s31 offen sc1
buffer_store_dwordx2 v[50:51], v36, s[4:7], s53 offen sc1
s_branch L_p0_j4
L_p0_a4:
ds_read_b64_tr_b16 v[104:105], v45 offset:40960
ds_read_b64_tr_b16 v[106:107], v45 offset:41472
ds_read_b64_tr_b16 v[108:109], v45 offset:45056
ds_read_b64_tr_b16 v[110:111], v45 offset:45568
ds_read_b64_tr_b16 v[112:113], v45 offset:49152
ds_read_b64_tr_b16 v[114:115], v45 offset:49664
ds_read_b64_tr_b16 v[116:117], v45 offset:53248
ds_read_b64_tr_b16 v[118:119], v45 offset:53760
ds_read_b64_tr_b16 v[120:121], v45 offset:57344
ds_read_b64_tr_b16 v[122:123], v45 offset:57856
v_mov_b32 v36, 1073741824
v_mov_b32 v46, 0
v_cndmask_b32 v37, v36, v172, s[50:51]
s_add_u32 s31, s53, 0
s_waitcnt lgkmcnt(8)
buffer_store_dwordx4 v[104:107], v172, s[4:7], s31 offen sc1
s_add_u32 s31, s53, 1024
s_waitcnt lgkmcnt(6)
buffer_store_dwordx4 v[108:111], v172, s[4:7], s31 offen sc1
s_add_u32 s31, s53, 2048
s_waitcnt lgkmcnt(4)
buffer_store_dwordx4 v[112:115], v172, s[4:7], s31 offen sc1
s_add_u32 s31, s53, 3072
s_waitcnt lgkmcnt(2)
buffer_store_dwordx4 v[116:119], v172, s[4:7], s31 offen sc1
s_add_u32 s31, s53, 4096
s_waitcnt lgkmcnt(0)
buffer_store_dwordx4 v[120:123], v37, s[4:7], s31 offen sc1
v_mov_b32 v37, 0x3f803f80
v_dot2c_f32_bf16 v46, v104, v37
v_dot2c_f32_bf16 v46, v105, v37
v_dot2c_f32_bf16 v46, v106, v37
v_dot2c_f32_bf16 v46, v107, v37
v_dot2c_f32_bf16 v46, v108, v37
v_dot2c_f32_bf16 v46, v109, v37
v_dot2c_f32_bf16 v46, v110, v37
v_dot2c_f32_bf16 v46, v111, v37
v_dot2c_f32_bf16 v46, v112, v37
v_dot2c_f32_bf16 v46, v113, v37
v_dot2c_f32_bf16 v46, v114, v37
v_dot2c_f32_bf16 v46, v115, v37
v_dot2c_f32_bf16 v46, v116, v37
v_dot2c_f32_bf16 v46, v117, v37
v_dot2c_f32_bf16 v46, v118, v37
v_dot2c_f32_bf16 v46, v119, v37
v_dot2c_f32_bf16 v46, v120, v37
v_dot2c_f32_bf16 v46, v121, v37
v_dot2c_f32_bf16 v46, v122, v37
v_dot2c_f32_bf16 v46, v123, v37
s_nop 2
v_mov_b32 v37, v46
s_nop 1
v_permlane32_swap_b32 v46, v37
v_add_f32 v46, v46, v37
v_mov_b32 v37, v46
s_nop 1
v_permlane16_swap_b32 v46, v37
v_add_f32 v46, v46, v37
v_cvt_pk_bf16_f32 v50, v46, v46
v_and_b32 v37, 0xffff0000, v50
v_sub_f32 v37, v46, v37
v_cvt_pk_bf16_f32 v51, v37, v37
v_cndmask_b32 v36, v36, v173, s[46:47]
buffer_store_dwordx2 v[50:51], v36, s[4:7], s53 offen sc1
L_p0_j4:
s_mov_b32 s12, s74
s_mov_b32 s13, s75
s_mov_b32 s14, 8388608
s_mov_b32 s15, 0x20000
s_cmp_eq_u32 s24, 1
s_cselect_b32 s63, 0, 1073741824
s_add_u32 s63, s63, 19415040
s_mov_b32 exec_lo, 0x000001ff
s_mov_b32 exec_hi, 0x00ffffff
buffer_load_dwordx2 v[176:177], v174, s[4:7], s63 offen sc1
s_mov_b64 exec, -1
s_cmp_eq_u32 s24, 1
s_cbranch_scc0 L_p0done_10
s_mov_b32 s31, 0
s_mov_b32 exec_lo, 0x000001ff
s_mov_b32 exec_hi, 0x00ffffff
s_waitcnt vmcnt(0)
v_cmp_ne_u64 vcc, v[176:177], v[238:239]
s_nop 0
s_cbranch_vccz L_p0done_10
L_p0poll_9:
buffer_load_dwordx2 v[176:177], v174, s[4:7], s63 offen sc1
s_add_u32 s31, s31, 1
s_waitcnt vmcnt(0)
v_cmp_ne_u64 vcc, v[176:177], v[238:239]
s_cmp_gt_u32 s31, 200000
s_cbranch_scc1 L_p0done_10
s_cbranch_vccnz L_p0poll_9
L_p0done_10:
s_mov_b64 exec, -1
s_barrier
s_lshl_b32 s33, s25, 8
s_lshl_b32 s32, s24, 6
s_add_u32 s33, s33, s32
v_lshlrev_b32 v8, 1, v2
buffer_load_ushort v0, v8, s[20:23], s33 offen
buffer_load_ushort v249, v8, s[20:23], s33 offen offset:32
s_mul_i32 s30, s70, 18432
s_mul_i32 s31, s28, 2304
s_add_u32 s30, s30, s31
s_add_u32 s30, s30, 0
v_and_b32 v6, 1, v3
v_lshlrev_b32 v6, 3, v6
v_lshl_add_u32 v6, v2, 4, v6
buffer_load_dwordx4 v[36:39], v1, s[8:11], s30 offen sc1
buffer_load_dwordx4 v[40:43], v1, s[8:11], s30 offen offset:1024 sc1
buffer_load_dwordx2 v[44:45], v6, s[8:11], s30 offen offset:2048 sc1
s_mul_i32 s36, s26, 132608
s_mul_i32 s38, s24, 12288
s_add_u32 m0, s38, 0
s_add_u32 s39, s38, s36
buffer_load_dwordx4 v1, s[4:7], s39 offen offset:0 sc1 lds
buffer_load_dwordx4 v1, s[4:7], s39 offen offset:1024 sc1 lds
buffer_load_dwordx4 v1, s[4:7], s39 offen offset:2048 sc1 lds
buffer_load_dwordx4 v1, s[4:7], s39 offen offset:3072 sc1 lds
s_add_u32 m0, m0, 4096
s_add_u32 s39, s39, 4096
buffer_load_dwordx4 v1, s[4:7], s39 offen offset:0 sc1 lds
buffer_load_dwordx4 v1, s[4:7], s39 offen offset:1024 sc1 lds
buffer_load_dwordx4 v1, s[4:7], s39 offen offset:2048 sc1 lds
buffer_load_dwordx4 v1, s[4:7], s39 offen offset:3072 sc1 lds
s_add_u32 m0, m0, 4096
s_add_u32 s39, s39, 4096
buffer_load_dwordx4 v1, s[4:7], s39 offen offset:0 sc1 lds
buffer_load_dwordx4 v1, s[4:7], s39 offen offset:1024 sc1 lds
buffer_load_dwordx4 v1, s[4:7], s39 offen offset:2048 sc1 lds
buffer_load_dwordx4 v1, s[4:7], s39 offen offset:3072 sc1 lds
v_and_b32 v6, 1, v2
v_cmp_eq_u32 s[40:41], 1, v6
v_lshl_add_u32 v6, v3, 2, v6
v_cmp_le_u32 s[42:43], v6, v2
v_add_u32 v6, 2, v6
v_cmp_le_u32 s[44:45], v6, v2
v_mov_b32 v6, 0x0c0c0100
v_mov_b32 v7, 0x01000c0c
v_cndmask_b32 v6, v6, v7, s[40:41]
v_mov_b32 v8, 0x0c0c0c0c
v_cndmask_b32 v10, v6, v8, s[42:43]
v_cndmask_b32 v12, v8, v6, s[42:43]
v_mov_b32 v6, 0x0c0c0302
v_mov_b32 v7, 0x03020c0c
v_cndmask_b32 v6, v6, v7, s[40:41]
v_cndmask_b32 v11, v6, v8, s[44:45]
v_cndmask_b32 v13, v8, v6, s[44:45]
s_mul_i32 s82, s26, 340992
s_add_u32 s82, s82, 2785280
s_mul_i32 s83, s28, 331776
s_add_u32 s83, s83, 8241152
s_and_b32 s30, s27, 1
s_mul_i32 s30, s30, 165888
s_add_u32 s83, s83, s30
s_waitcnt vmcnt(12)
v_lshlrev_b32 v16, 16, v36
v_and_b32 v17, 0xffff0000, v36
v_lshlrev_b32 v18, 16, v37
v_and_b32 v19, 0xffff0000, v37
v_lshlrev_b32 v20, 16, v38
v_and_b32 v21, 0xffff0000, v38
v_lshlrev_b32 v22, 16, v39
v_and_b32 v23, 0xffff0000, v39
v_lshlrev_b32 v24, 16, v40
v_and_b32 v25, 0xffff0000, v40
v_lshlrev_b32 v26, 16, v41
v_and_b32 v27, 0xffff0000, v41
v_lshlrev_b32 v28, 16, v42
v_and_b32 v29, 0xffff0000, v42
v_lshlrev_b32 v30, 16, v43
v_and_b32 v31, 0xffff0000, v43
v_lshlrev_b32 v32, 16, v44
v_and_b32 v33, 0xffff0000, v44
v_lshlrev_b32 v34, 16, v45
v_and_b32 v35, 0xffff0000, v45
v_mov_b32 v6, 0
s_barrier
v_mov_b32 v248, v238
s_mov_b64 exec, 1
buffer_store_dwordx2 v[238:239], v6, s[4:7], s100 offen sc1
s_mov_b64 exec, -1
s_mul_i32 s36, s26, 132608
s_mul_i32 s38, s24, 9216
s_add_u32 m0, s38, 49152
s_add_u32 s39, s38, s36
s_add_u32 s39, s39, 49152
buffer_load_dwordx4 v1, s[4:7], s39 offen offset:0 sc1 lds
buffer_load_dwordx4 v1, s[4:7], s39 offen offset:1024 sc1 lds
buffer_load_dwordx4 v1, s[4:7], s39 offen offset:2048 sc1 lds
buffer_load_dwordx4 v1, s[4:7], s39 offen offset:3072 sc1 lds
s_add_u32 m0, m0, 4096
s_add_u32 s39, s39, 4096
buffer_load_dwordx4 v1, s[4:7], s39 offen offset:0 sc1 lds
buffer_load_dwordx4 v1, s[4:7], s39 offen offset:1024 sc1 lds
buffer_load_dwordx4 v1, s[4:7], s39 offen offset:2048 sc1 lds
buffer_load_dwordx4 v1, s[4:7], s39 offen offset:3072 sc1 lds
s_add_u32 m0, m0, 4096
s_add_u32 s39, s39, 4096
buffer_load_dwordx4 v1, s[4:7], s39 offen offset:0 sc1 lds
s_lshl_b32 s60, s25, 3
s_sub_u32 s61, s60, 1
s_max_i32 s61, s61, 0
s_lshl_b32 s30, s24, 1
s_add_u32 s60, s60, s30
s_mul_i32 s30, s61, 18432
s_mul_i32 s62, s60, 18432
v_add_u32 v237, 18432, v1
s_mul_i32 s38, s24, 5120
s_add_u32 m0, s38, 135168
s_add_u32 s39, s38, s30
L_layer:
buffer_load_dwordx4 v1, s[8:11], s39 offen offset:0 sc1 lds
buffer_load_dwordx4 v1, s[8:11], s39 offen offset:1024 sc1 lds
buffer_load_dwordx4 v1, s[8:11], s39 offen offset:2048 sc1 lds
buffer_load_dwordx4 v1, s[8:11], s39 offen offset:3072 sc1 lds
s_add_u32 m0, m0, 4096
s_add_u32 s39, s39, 4096
buffer_load_dwordx4 v1, s[8:11], s39 offen offset:0 sc1 lds
s_barrier
buffer_load_dwordx4 a[0:3], v1, s[8:11], s62 offen offset:0 sc1
buffer_load_dwordx4 a[4:7], v237, s[8:11], s62 offen offset:0 sc1
s_barrier
buffer_load_dwordx4 a[8:11], v1, s[8:11], s62 offen offset:1024 sc1
buffer_load_dwordx4 a[12:15], v237, s[8:11], s62 offen offset:1024 sc1
s_barrier
buffer_load_dwordx4 a[16:19], v1, s[8:11], s62 offen offset:2048 sc1
buffer_load_dwordx4 a[20:23], v237, s[8:11], s62 offen offset:2048 sc1
s_barrier
buffer_load_dwordx4 a[24:27], v1, s[8:11], s62 offen offset:3072 sc1
buffer_load_dwordx4 a[28:31], v237, s[8:11], s62 offen offset:3072 sc1
s_barrier
s_add_u32 s62, s62, 4096
buffer_load_dwordx4 a[32:35], v1, s[8:11], s62 offen offset:0 sc1
buffer_load_dwordx4 a[36:39], v237, s[8:11], s62 offen offset:0 sc1
s_barrier
buffer_load_dwordx4 a[40:43], v1, s[8:11], s62 offen offset:1024 sc1
buffer_load_dwordx4 a[44:47], v237, s[8:11], s62 offen offset:1024 sc1
s_sub_u32 s30, s60, 2
v_add_u32 v6, s30, v3
v_max_i32 v6, 0, v6
v_mov_b32 v7, s61
v_cndmask_b32 v6, v6, v7, s[46:47]
v_lshl_add_u32 v6, v6, 4, v2
v_lshlrev_b32 v129, 3, v6
s_lshl_b32 s30, s24, 10
v_add_u32 v125, s30, v1
v_add_u32 v126, 135168, v1
v_lshrrev_b32 v127, 1, v1
v_add_u32 v127, 129024, v127
s_lshl_b32 s30, s24, 9
v_add_u32 v128, s30, v127
v_add_u32 v8, 64512, v1
s_waitcnt vmcnt(12)
s_barrier
ds_read_b128 a[144:147], v1 offset:0
ds_read_b128 a[148:151], v1 offset:1024
ds_read_b128 a[152:155], v1 offset:2048
ds_read_b128 a[156:159], v1 offset:3072
ds_read_b128 a[160:163], v1 offset:4096
ds_read_b128 a[164:167], v1 offset:5120
ds_read_b128 a[168:171], v1 offset:6144
ds_read_b128 a[172:175], v125 offset:0
ds_read_b128 a[176:179], v126 offset:0
v_lshrrev_b32 v146, 1, v1
s_lshl_b32 s66, s24, 9
s_add_u32 s66, s66, 19447808
s_waitcnt vmcnt(10) lgkmcnt(0)
v_mfma_f32_16x16x32_bf16 v[36:39], a[144:147], a[0:3], 0
ds_read_b128 a[180:183], v1 offset:7168
buffer_load_dwordx4 a[48:51], v1, s[8:11], s62 offen offset:2048 sc1
v_mfma_f32_16x16x32_bf16 v[64:67], a[144:147], a[4:7], 0
ds_read_b128 a[184:187], v1 offset:8192
v_mfma_f32_16x16x32_bf16 v[40:43], a[148:151], a[0:3], 0
ds_read_b128 a[188:191], v1 offset:9216
v_mfma_f32_16x16x32_bf16 v[68:71], a[148:151], a[4:7], 0
ds_read_b128 a[192:195], v1 offset:10240
v_mfma_f32_16x16x32_bf16 v[44:47], a[152:155], a[0:3], 0
ds_read_b128 a[196:199], v1 offset:11264
buffer_load_dwordx4 a[52:55], v237, s[8:11], s62 offen offset:2048 sc1
v_mfma_f32_16x16x32_bf16 v[72:75], a[152:155], a[4:7], 0
ds_read_b128 a[200:203], v1 offset:12288
v_mfma_f32_16x16x32_bf16 v[48:51], a[156:159], a[0:3], 0
ds_read_b128 a[204:207], v1 offset:13312
v_mfma_f32_16x16x32_bf16 v[76:79], a[156:159], a[4:7], 0
ds_read_b128 a[208:211], v125 offset:7168
v_mfma_f32_16x16x32_bf16 v[52:55], a[160:163], a[0:3], 0
ds_read_b128 a[212:215], v126 offset:1024
buffer_load_dwordx4 a[56:59], v1, s[8:11], s62 offen offset:3072 sc1
v_mfma_f32_16x16x32_bf16 v[80:83], a[160:163], a[4:7], 0
v_mfma_f32_16x16x32_bf16 v[92:95], a[172:175], a[176:179], 0
v_mfma_f32_16x16x32_bf16 v[96:99], a[160:163], a[176:179], 0
v_mfma_f32_16x16x32_bf16 v[56:59], a[164:167], a[0:3], 0
buffer_load_dwordx4 a[60:63], v237, s[8:11], s62 offen offset:3072 sc1
v_mfma_f32_16x16x32_bf16 v[84:87], a[164:167], a[4:7], 0
s_add_u32 s62, s62, 4096
v_mfma_f32_16x16x32_bf16 v[60:63], a[168:171], a[0:3], 0
v_mfma_f32_16x16x32_bf16 v[88:91], a[168:171], a[4:7], 0
s_waitcnt vmcnt(12) lgkmcnt(0)
v_mfma_f32_16x16x32_bf16 v[36:39], a[180:183], a[8:11], v[36:39]
ds_read_b128 a[144:147], v1 offset:14336
v_lshlrev_b32 v124, 2, v2
v_mfma_f32_16x16x32_bf16 v[64:67], a[180:183], a[12:15], v[64:67]
ds_read_b128 a[148:151], v1 offset:15360
v_and_b32 v6, 1, v2
v_mfma_f32_16x16x32_bf16 v[40:43], a[184:187], a[8:11], v[40:43]
ds_read_b128 a[152:155], v1 offset:16384
v_mfma_f32_16x16x32_bf16 v[68:71], a[184:187], a[12:15], v[68:71]
ds_read_b128 a[156:159], v1 offset:17408
v_lshl_add_u32 v6, v3, 2, v6
v_mfma_f32_16x16x32_bf16 v[44:47], a[188:191], a[8:11], v[44:47]
ds_read_b128 a[160:163], v1 offset:18432
v_lshlrev_b32 v6, 2, v6
v_mfma_f32_16x16x32_bf16 v[72:75], a[188:191], a[12:15], v[72:75]
ds_read_b128 a[164:167], v1 offset:19456
buffer_load_dwordx4 a[64:67], v1, s[8:11], s62 offen offset:0 sc1
v_mfma_f32_16x16x32_bf16 v[48:51], a[192:195], a[8:11], v[48:51]
ds_read_b128 a[168:171], v1 offset:20480
v_add_u32 v122, 64, v6
v_mfma_f32_16x16x32_bf16 v[76:79], a[192:195], a[12:15], v[76:79]
ds_read_b128 a[172:175], v125 offset:14336
v_mfma_f32_16x16x32_bf16 v[52:55], a[196:199], a[8:11], v[52:55]
ds_read_b128 a[176:179], v126 offset:2048
v_add_u32 v7, 128, v6
v_mfma_f32_16x16x32_bf16 v[80:83], a[196:199], a[12:15], v[80:83]
buffer_load_dwordx4 a[68:71], v237, s[8:11], s62 offen offset:0 sc1
v_cndmask_b32 v122, v122, v7, s[42:43]
v_mfma_f32_16x16x32_bf16 v[92:95], a[208:211], a[212:215], v[92:95]
v_mfma_f32_16x16x32_bf16 v[96:99], a[196:199], a[212:215], v[96:99]
v_add_u32 v123, 72, v6
v_mfma_f32_16x16x32_bf16 v[56:59], a[200:203], a[8:11], v[56:59]
v_mfma_f32_16x16x32_bf16 v[84:87], a[200:203], a[12:15], v[84:87]
v_add_u32 v7, 136, v6
v_mfma_f32_16x16x32_bf16 v[60:63], a[204:207], a[8:11], v[60:63]
buffer_load_dwordx4 a[72:75], v1, s[8:11], s62 offen offset:1024 sc1
v_cndmask_b32 v123, v123, v7, s[44:45]
v_mfma_f32_16x16x32_bf16 v[88:91], a[204:207], a[12:15], v[88:91]
s_mov_b32 s63, 2359296
s_waitcnt vmcnt(13) lgkmcnt(0)
v_mfma_f32_16x16x32_bf16 v[36:39], a[144:147], a[16:19], v[36:39]
ds_read_b128 a[180:183], v1 offset:21504
s_lshl_b32 s31, s24, 5
v_mfma_f32_16x16x32_bf16 v[64:67], a[144:147], a[20:23], v[64:67]
ds_read_b128 a[184:187], v1 offset:22528
v_mfma_f32_16x16x32_bf16 v[40:43], a[148:151], a[16:19], v[40:43]
ds_read_b128 a[188:191], v1 offset:23552
v_add_u32 v6, s31, v2
v_mfma_f32_16x16x32_bf16 v[68:71], a[148:151], a[20:23], v[68:71]
ds_read_b128 a[192:195], v1 offset:24576
v_mul_u32_u24 v220, 176, v6
v_mfma_f32_16x16x32_bf16 v[44:47], a[152:155], a[16:19], v[44:47]
ds_read_b128 a[196:199], v1 offset:25600
v_mfma_f32_16x16x32_bf16 v[72:75], a[152:155], a[20:23], v[72:75]
ds_read_b128 a[200:203], v1 offset:26624
v_add_u32 v220, 0, v220
v_mfma_f32_16x16x32_bf16 v[48:51], a[156:159], a[16:19], v[48:51]
ds_read_b128 a[204:207], v1 offset:27648
buffer_load_dwordx2 v[100:101], v129, s[8:11], s63 offen sc1
v_mfma_f32_16x16x32_bf16 v[76:79], a[156:159], a[20:23], v[76:79]
ds_read_b128 a[208:211], v125 offset:21504
v_lshl_add_u32 v218, v3, 3, v220
v_mfma_f32_16x16x32_bf16 v[52:55], a[160:163], a[16:19], v[52:55]
ds_read_b128 a[212:215], v126 offset:3072
s_mul_i32 s36, s26, 132608
v_mfma_f32_16x16x32_bf16 v[80:83], a[160:163], a[20:23], v[80:83]
s_mov_b32 s63, 2375680
v_mul_u32_u24 v219, 176, v2
v_mfma_f32_16x16x32_bf16 v[92:95], a[172:175], a[176:179], v[92:95]
s_mul_i32 s38, s24, 12288
v_lshl_add_u32 v219, v3, 3, v219
v_mfma_f32_16x16x32_bf16 v[96:99], a[160:163], a[176:179], v[96:99]
s_add_u32 m0, s38, 86016
v_mfma_f32_16x16x32_bf16 v[56:59], a[164:167], a[16:19], v[56:59]
s_add_u32 s39, s38, s36
v_add_u32 v219, 0, v219
v_mfma_f32_16x16x32_bf16 v[84:87], a[164:167], a[20:23], v[84:87]
s_add_u32 s39, s39, 86016
v_add_u32 v222, s31, v219
v_mfma_f32_16x16x32_bf16 v[60:63], a[168:171], a[16:19], v[60:63]
v_mfma_f32_16x16x32_bf16 v[88:91], a[168:171], a[20:23], v[88:91]
buffer_load_dwordx2 v[102:103], v129, s[8:11], s63 offen sc1
s_waitcnt vmcnt(13) lgkmcnt(0)
v_mfma_f32_16x16x32_bf16 v[36:39], a[180:183], a[24:27], v[36:39]
ds_read_b128 a[144:147], v1 offset:28672
v_lshrrev_b32 v6, 2, v2
v_mfma_f32_16x16x32_bf16 v[64:67], a[180:183], a[28:31], v[64:67]
ds_read_b128 a[148:151], v1 offset:29696
v_lshl_add_u32 v6, v3, 2, v6
v_mfma_f32_16x16x32_bf16 v[40:43], a[184:187], a[24:27], v[40:43]
ds_read_b128 a[152:155], v1 offset:30720
v_add_u32 v6, s31, v6
v_mfma_f32_16x16x32_bf16 v[68:71], a[184:187], a[28:31], v[68:71]
ds_read_b128 a[156:159], v1 offset:31744
s_mov_b32 s63, 2392064
v_mfma_f32_16x16x32_bf16 v[44:47], a[188:191], a[24:27], v[44:47]
ds_read_b128 a[160:163], v1 offset:32768
v_mul_u32_u24 v221, 176, v6
v_mfma_f32_16x16x32_bf16 v[72:75], a[188:191], a[28:31], v[72:75]
ds_read_b128 a[164:167], v1 offset:33792
v_and_b32 v6, 3, v2
v_mfma_f32_16x16x32_bf16 v[48:51], a[192:195], a[24:27], v[48:51]
ds_read_b128 a[168:171], v1 offset:34816
v_mfma_f32_16x16x32_bf16 v[76:79], a[192:195], a[28:31], v[76:79]
ds_read_b128 a[172:175], v125 offset:28672
buffer_load_dwordx2 v[104:105], v129, s[8:11], s63 offen sc1
v_mfma_f32_16x16x32_bf16 v[52:55], a[196:199], a[24:27], v[52:55]
ds_read_b128 a[176:179], v126 offset:4096
v_lshl_add_u32 v221, v6, 3, v221
v_mfma_f32_16x16x32_bf16 v[80:83], a[196:199], a[28:31], v[80:83]
s_mov_b32 s63, 2408448
v_add_u32 v221, 0, v221
v_mfma_f32_16x16x32_bf16 v[92:95], a[208:211], a[212:215], v[92:95]
v_mov_b32 v171, 0
v_mfma_f32_16x16x32_bf16 v[96:99], a[196:199], a[212:215], v[96:99]
v_mfma_f32_16x16x32_bf16 v[56:59], a[200:203], a[24:27], v[56:59]
buffer_load_dwordx4 v1, s[4:7], s39 offen offset:0 sc1 lds
v_mov_b32 v172, 0
v_mfma_f32_16x16x32_bf16 v[84:87], a[200:203], a[28:31], v[84:87]
v_mfma_f32_16x16x32_bf16 v[60:63], a[204:207], a[24:27], v[60:63]
v_mov_b32 v179, 0
v_mfma_f32_16x16x32_bf16 v[88:91], a[204:207], a[28:31], v[88:91]
v_mov_b32 v180, 0
s_waitcnt vmcnt(13) lgkmcnt(0)
v_mfma_f32_16x16x32_bf16 v[36:39], a[144:147], a[32:35], v[36:39]
ds_read_b128 a[180:183], v1 offset:35840
buffer_load_dwordx2 v[106:107], v129, s[8:11], s63 offen sc1
v_mfma_f32_16x16x32_bf16 v[64:67], a[144:147], a[36:39], v[64:67]
ds_read_b128 a[184:187], v1 offset:36864
buffer_load_dwordx4 v1, s[4:7], s39 offen offset:1024 sc1 lds
v_mfma_f32_16x16x32_bf16 v[40:43], a[148:151], a[32:35], v[40:43]
ds_read_b128 a[188:191], v1 offset:37888
s_mul_i32 s30, s60, 18432
v_mfma_f32_16x16x32_bf16 v[68:71], a[148:151], a[36:39], v[68:71]
ds_read_b128 a[192:195], v1 offset:38912
s_add_u32 s30, s30, 2490368
v_mfma_f32_16x16x32_bf16 v[44:47], a[152:155], a[32:35], v[44:47]
ds_read_b128 a[196:199], v1 offset:39936
buffer_load_dwordx4 v1, s[4:7], s39 offen offset:2048 sc1 lds
v_mfma_f32_16x16x32_bf16 v[72:75], a[152:155], a[36:39], v[72:75]
ds_read_b128 a[200:203], v1 offset:40960
s_mov_b32 s63, 2424832
v_mfma_f32_16x16x32_bf16 v[48:51], a[156:159], a[32:35], v[48:51]
ds_read_b128 a[204:207], v1 offset:41984
s_lshl_b32 s64, s26, 10
v_mfma_f32_16x16x32_bf16 v[76:79], a[156:159], a[36:39], v[76:79]
ds_read_b128 a[208:211], v125 offset:35840
s_add_u32 s64, s64, s30
v_mfma_f32_16x16x32_bf16 v[52:55], a[160:163], a[32:35], v[52:55]
ds_read_b128 a[212:215], v126 offset:5120
buffer_load_dwordx2 v[108:109], v129, s[8:11], s63 offen sc1
v_mfma_f32_16x16x32_bf16 v[80:83], a[160:163], a[36:39], v[80:83]
buffer_load_dwordx4 v1, s[4:7], s39 offen offset:3072 sc1 lds
s_and_b32 s65, s26, 1
v_mfma_f32_16x16x32_bf16 v[92:95], a[172:175], a[176:179], v[92:95]
s_mov_b32 s63, 2441216
s_lshl_b32 s65, s65, 10
v_mfma_f32_16x16x32_bf16 v[96:99], a[160:163], a[176:179], v[96:99]
s_add_u32 m0, m0, 4096
s_add_u32 s30, s30, s65
v_mfma_f32_16x16x32_bf16 v[56:59], a[164:167], a[32:35], v[56:59]
s_add_u32 s39, s39, 4096
v_mfma_f32_16x16x32_bf16 v[84:87], a[164:167], a[36:39], v[84:87]
s_lshr_b32 s65, s26, 1
v_mfma_f32_16x16x32_bf16 v[60:63], a[168:171], a[32:35], v[60:63]
s_lshl_b32 s65, s65, 7
v_mfma_f32_16x16x32_bf16 v[88:91], a[168:171], a[36:39], v[88:91]
s_add_u32 s65, s65, s30
s_waitcnt vmcnt(16) lgkmcnt(0)
v_mfma_f32_16x16x32_bf16 v[36:39], a[180:183], a[40:43], v[36:39]
ds_read_b128 a[144:147], v1 offset:43008
v_mfma_f32_16x16x32_bf16 v[64:67], a[180:183], a[44:47], v[64:67]
ds_read_b128 a[148:151], v1 offset:44032
buffer_load_dwordx2 v[110:111], v129, s[8:11], s63 offen sc1
v_mfma_f32_16x16x32_bf16 v[40:43], a[184:187], a[40:43], v[40:43]
ds_read_b128 a[152:155], v1 offset:45056
s_add_u32 s65, s65, 16384
v_mfma_f32_16x16x32_bf16 v[68:71], a[184:187], a[44:47], v[68:71]
ds_read_b128 a[156:159], v1 offset:46080
v_mov_b32 v224, 1073741824
v_mfma_f32_16x16x32_bf16 v[44:47], a[188:191], a[40:43], v[44:47]
ds_read_b128 a[160:163], v1 offset:47104
buffer_load_dwordx4 v1, s[4:7], s39 offen offset:0 sc1 lds
v_mfma_f32_16x16x32_bf16 v[72:75], a[188:191], a[44:47], v[72:75]
ds_read_b128 a[164:167], v1 offset:48128
s_mov_b32 s63, 2457600
v_mfma_f32_16x16x32_bf16 v[48:51], a[192:195], a[40:43], v[48:51]
ds_read_b128 a[168:171], v1 offset:49152
v_lshlrev_b32 v225, 3, v2
v_mfma_f32_16x16x32_bf16 v[76:79], a[192:195], a[44:47], v[76:79]
ds_read_b128 a[172:175], v125 offset:43008
v_cndmask_b32 v224, v224, v225, s[46:47]
v_mfma_f32_16x16x32_bf16 v[52:55], a[196:199], a[40:43], v[52:55]
ds_read_b128 a[176:179], v126 offset:6144
buffer_load_dwordx4 v1, s[4:7], s39 offen offset:1024 sc1 lds
v_mfma_f32_16x16x32_bf16 v[80:83], a[196:199], a[44:47], v[80:83]
v_add_u32 v225, 18432, v224
v_mfma_f32_16x16x32_bf16 v[92:95], a[208:211], a[212:215], v[92:95]
buffer_load_dwordx2 v[112:113], v129, s[8:11], s63 offen sc1
s_lshl_b32 s68, s24, 13
v_mfma_f32_16x16x32_bf16 v[96:99], a[196:199], a[212:215], v[96:99]
s_mov_b32 s63, 2473984
v_add_u32 v6, 0, v3
v_mfma_f32_16x16x32_bf16 v[56:59], a[200:203], a[40:43], v[56:59]
buffer_load_dwordx4 v1, s[4:7], s39 offen offset:2048 sc1 lds
v_mfma_f32_16x16x32_bf16 v[84:87], a[200:203], a[44:47], v[84:87]
v_xor_b32 v7, v6, v2
v_mfma_f32_16x16x32_bf16 v[60:63], a[204:207], a[40:43], v[60:63]
v_mfma_f32_16x16x32_bf16 v[88:91], a[204:207], a[44:47], v[88:91]
v_lshlrev_b32 v6, 12, v6
s_waitcnt vmcnt(19) lgkmcnt(0)
v_mfma_f32_16x16x32_bf16 v[36:39], a[144:147], a[48:51], v[36:39]
ds_read_b128 a[180:183], v1 offset:50176
buffer_load_dwordx4 v1, s[4:7], s39 offen offset:3072 sc1 lds
v_mfma_f32_16x16x32_bf16 v[64:67], a[144:147], a[52:55], v[64:67]
ds_read_b128 a[184:187], v1 offset:51200
v_lshl_add_u32 v240, v7, 4, v6
v_mfma_f32_16x16x32_bf16 v[40:43], a[148:151], a[48:51], v[40:43]
ds_read_b128 a[188:191], v1 offset:52224
buffer_load_dwordx2 v[114:115], v129, s[8:11], s63 offen sc1
v_mfma_f32_16x16x32_bf16 v[68:71], a[148:151], a[52:55], v[68:71]
ds_read_b128 a[192:195], v1 offset:53248
v_lshlrev_b32 v7, 4, v7
v_mfma_f32_16x16x32_bf16 v[44:47], a[152:155], a[48:51], v[44:47]
ds_read_b128 a[196:199], v1 offset:54272
s_add_u32 m0, m0, 4096
v_mfma_f32_16x16x32_bf16 v[72:75], a[152:155], a[52:55], v[72:75]
ds_read_b128 a[200:203], v1 offset:55296
v_lshl_add_u32 v7, v2, 8, v7
v_mfma_f32_16x16x32_bf16 v[48:51], a[156:159], a[48:51], v[48:51]
ds_read_b128 a[204:207], v1 offset:56320
buffer_load_dwordx4 a[76:79], v237, s[8:11], s62 offen offset:1024 sc1
v_mfma_f32_16x16x32_bf16 v[76:79], a[156:159], a[52:55], v[76:79]
ds_read_b128 a[208:211], v125 offset:50176
v_add_u32 v244, s68, v7
v_mfma_f32_16x16x32_bf16 v[52:55], a[160:163], a[48:51], v[52:55]
ds_read_b128 a[212:215], v126 offset:7168
s_add_u32 s39, s39, 4096
v_mfma_f32_16x16x32_bf16 v[80:83], a[160:163], a[52:55], v[80:83]
v_add_u32 v6, 4, v3
v_xor_b32 v7, v6, v2
v_mfma_f32_16x16x32_bf16 v[92:95], a[172:175], a[176:179], v[92:95]
v_lshlrev_b32 v6, 12, v6
v_mfma_f32_16x16x32_bf16 v[96:99], a[160:163], a[176:179], v[96:99]
buffer_load_dwordx4 a[80:83], v1, s[8:11], s62 offen offset:2048 sc1
v_mfma_f32_16x16x32_bf16 v[56:59], a[164:167], a[48:51], v[56:59]
buffer_load_dwordx4 v1, s[4:7], s39 offen offset:0 sc1 lds
v_lshl_add_u32 v241, v7, 4, v6
v_mfma_f32_16x16x32_bf16 v[84:87], a[164:167], a[52:55], v[84:87]
v_mfma_f32_16x16x32_bf16 v[60:63], a[168:171], a[48:51], v[60:63]
v_lshlrev_b32 v7, 4, v7
v_mfma_f32_16x16x32_bf16 v[88:91], a[168:171], a[52:55], v[88:91]
buffer_load_dwordx4 a[84:87], v237, s[8:11], s62 offen offset:2048 sc1
s_waitcnt vmcnt(23) lgkmcnt(0)
v_mfma_f32_16x16x32_bf16 v[36:39], a[180:183], a[56:59], v[36:39]
ds_read_b128 a[144:147], v1 offset:57344
buffer_load_dwordx4 v1, s[4:7], s39 offen offset:1024 sc1 lds
v_mfma_f32_16x16x32_bf16 v[64:67], a[180:183], a[60:63], v[64:67]
ds_read_b128 a[148:151], v1 offset:58368
v_lshl_add_u32 v7, v2, 8, v7
v_mfma_f32_16x16x32_bf16 v[40:43], a[184:187], a[56:59], v[40:43]
ds_read_b128 a[152:155], v1 offset:59392
v_add_u32 v245, s68, v7
v_mfma_f32_16x16x32_bf16 v[68:71], a[184:187], a[60:63], v[68:71]
ds_read_b128 a[156:159], v1 offset:60416
buffer_load_dwordx4 a[88:91], v1, s[8:11], s62 offen offset:3072 sc1
v_mfma_f32_16x16x32_bf16 v[44:47], a[188:191], a[56:59], v[44:47]
ds_read_b128 a[160:163], v1 offset:61440
buffer_load_dwordx4 v1, s[4:7], s39 offen offset:2048 sc1 lds
v_mfma_f32_16x16x32_bf16 v[72:75], a[188:191], a[60:63], v[72:75]
ds_read_b128 a[164:167], v1 offset:62464
v_subrev_u32 v241, 1024, v241
v_mfma_f32_16x16x32_bf16 v[48:51], a[192:195], a[56:59], v[48:51]
ds_read_b128 a[168:171], v1 offset:63488
v_add_u32 v6, 8, v3
v_mfma_f32_16x16x32_bf16 v[76:79], a[192:195], a[60:63], v[76:79]
ds_read_b128 a[172:175], v125 offset:57344
v_xor_b32 v7, v6, v2
v_mfma_f32_16x16x32_bf16 v[52:55], a[196:199], a[56:59], v[52:55]
ds_read_b128 a[176:179], v126 offset:8192
buffer_load_dwordx4 a[92:95], v237, s[8:11], s62 offen offset:3072 sc1
v_mfma_f32_16x16x32_bf16 v[80:83], a[196:199], a[60:63], v[80:83]
buffer_load_dwordx4 v1, s[4:7], s39 offen offset:3072 sc1 lds
v_lshlrev_b32 v6, 12, v6
v_mfma_f32_16x16x32_bf16 v[92:95], a[208:211], a[212:215], v[92:95]
s_add_u32 s62, s62, 4096
v_lshl_add_u32 v242, v7, 4, v6
v_mfma_f32_16x16x32_bf16 v[96:99], a[196:199], a[212:215], v[96:99]
v_lshlrev_b32 v7, 4, v7
v_mfma_f32_16x16x32_bf16 v[56:59], a[200:203], a[56:59], v[56:59]
buffer_load_dwordx2 v[148:149], v146, s[4:7], s66 offen sc1
v_lshl_add_u32 v7, v2, 8, v7
v_mfma_f32_16x16x32_bf16 v[84:87], a[200:203], a[60:63], v[84:87]
v_mfma_f32_16x16x32_bf16 v[60:63], a[204:207], a[56:59], v[60:63]
v_add_u32 v246, s68, v7
v_mfma_f32_16x16x32_bf16 v[88:91], a[204:207], a[60:63], v[88:91]
s_waitcnt vmcnt(27) lgkmcnt(0)
v_add_u32 v125, 64512, v125
v_mfma_f32_16x16x32_bf16 v[36:39], a[144:147], a[64:67], v[36:39]
ds_read_b128 a[180:183], v8 offset:0
buffer_load_dwordx4 a[96:99], v1, s[8:11], s62 offen offset:0 sc1
v_mfma_f32_16x16x32_bf16 v[64:67], a[144:147], a[68:71], v[64:67]
ds_read_b128 a[184:187], v8 offset:1024
v_subrev_u32 v242, 2048, v242
v_mfma_f32_16x16x32_bf16 v[40:43], a[148:151], a[64:67], v[40:43]
ds_read_b128 a[188:191], v8 offset:2048
v_add_u32 v6, 12, v3
v_mfma_f32_16x16x32_bf16 v[68:71], a[148:151], a[68:71], v[68:71]
ds_read_b128 a[192:195], v8 offset:3072
v_xor_b32 v7, v6, v2
v_mfma_f32_16x16x32_bf16 v[44:47], a[152:155], a[64:67], v[44:47]
ds_read_b128 a[196:199], v8 offset:4096
buffer_load_dwordx4 a[100:103], v237, s[8:11], s62 offen offset:0 sc1
v_mfma_f32_16x16x32_bf16 v[72:75], a[152:155], a[68:71], v[72:75]
ds_read_b128 a[200:203], v8 offset:5120
v_lshlrev_b32 v6, 12, v6
v_mfma_f32_16x16x32_bf16 v[48:51], a[156:159], a[64:67], v[48:51]
ds_read_b128 a[204:207], v8 offset:6144
v_lshl_add_u32 v243, v7, 4, v6
v_mfma_f32_16x16x32_bf16 v[76:79], a[156:159], a[68:71], v[76:79]
ds_read_b128 a[208:211], v125 offset:0
v_mfma_f32_16x16x32_bf16 v[52:55], a[160:163], a[64:67], v[52:55]
ds_read_b128 a[212:215], v126 offset:9216
v_lshlrev_b32 v7, 4, v7
v_mfma_f32_16x16x32_bf16 v[80:83], a[160:163], a[68:71], v[80:83]
buffer_load_dwordx4 a[104:107], v1, s[8:11], s62 offen offset:1024 sc1
v_mfma_f32_16x16x32_bf16 v[92:95], a[172:175], a[176:179], v[92:95]
v_lshl_add_u32 v7, v2, 8, v7
v_mfma_f32_16x16x32_bf16 v[96:99], a[160:163], a[176:179], v[96:99]
v_add_u32 v247, s68, v7
v_mfma_f32_16x16x32_bf16 v[56:59], a[164:167], a[64:67], v[56:59]
v_mfma_f32_16x16x32_bf16 v[84:87], a[164:167], a[68:71], v[84:87]
buffer_load_dwordx4 a[108:111], v237, s[8:11], s62 offen offset:1024 sc1
v_subrev_u32 v243, 3072, v243
v_mfma_f32_16x16x32_bf16 v[60:63], a[168:171], a[64:67], v[60:63]
v_mfma_f32_16x16x32_bf16 v[88:91], a[168:171], a[68:71], v[88:91]
s_waitcnt vmcnt(13) lgkmcnt(0)
v_mfma_f32_16x16x32_bf16 v[36:39], a[180:183], a[72:75], v[36:39]
ds_read_b128 a[144:147], v8 offset:7168
v_mfma_f32_16x16x32_bf16 v[64:67], a[180:183], a[76:79], v[64:67]
ds_read_b128 a[148:151], v8 offset:8192
buffer_load_dwordx4 a[112:115], v1, s[8:11], s62 offen offset:2048 sc1
v_mfma_f32_16x16x32_bf16 v[40:43], a[184:187], a[72:75], v[40:43]
ds_read_b128 a[152:155], v8 offset:9216
v_add_f32 v130, v100, v102
v_mfma_f32_16x16x32_bf16 v[68:71], a[184:187], a[76:79], v[68:71]
ds_read_b128 a[156:159], v8 offset:10240
v_add_f32 v131, v101, v103
v_mfma_f32_16x16x32_bf16 v[44:47], a[188:191], a[72:75], v[44:47]
ds_read_b128 a[160:163], v8 offset:11264
v_add_f32 v130, v130, v104
v_mfma_f32_16x16x32_bf16 v[72:75], a[188:191], a[76:79], v[72:75]
ds_read_b128 a[164:167], v8 offset:12288
v_add_f32 v131, v131, v105
v_mfma_f32_16x16x32_bf16 v[48:51], a[192:195], a[72:75], v[48:51]
ds_read_b128 a[168:171], v8 offset:13312
buffer_load_dwordx4 a[116:119], v237, s[8:11], s62 offen offset:2048 sc1
v_mfma_f32_16x16x32_bf16 v[76:79], a[192:195], a[76:79], v[76:79]
ds_read_b128 a[172:175], v125 offset:7168
v_add_f32 v130, v130, v106
v_mfma_f32_16x16x32_bf16 v[52:55], a[196:199], a[72:75], v[52:55]
ds_read_b128 a[176:179], v126 offset:10240
v_add_f32 v131, v131, v107
v_mfma_f32_16x16x32_bf16 v[80:83], a[196:199], a[76:79], v[80:83]
v_add_f32 v130, v130, v108
v_add_f32 v131, v131, v109
v_mfma_f32_16x16x32_bf16 v[92:95], a[208:211], a[212:215], v[92:95]
buffer_load_dwordx4 a[120:123], v1, s[8:11], s62 offen offset:3072 sc1
v_add_f32 v130, v130, v110
v_mfma_f32_16x16x32_bf16 v[96:99], a[196:199], a[212:215], v[96:99]
v_add_f32 v131, v131, v111
v_mfma_f32_16x16x32_bf16 v[56:59], a[200:203], a[72:75], v[56:59]
v_add_f32 v130, v130, v112
v_mfma_f32_16x16x32_bf16 v[84:87], a[200:203], a[76:79], v[84:87]
v_add_f32 v131, v131, v113
v_mfma_f32_16x16x32_bf16 v[60:63], a[204:207], a[72:75], v[60:63]
buffer_load_dwordx4 a[124:127], v237, s[8:11], s62 offen offset:3072 sc1
v_add_f32 v130, v130, v114
v_mfma_f32_16x16x32_bf16 v[88:91], a[204:207], a[76:79], v[88:91]
s_add_u32 s62, s62, 4096
v_add_f32 v131, v131, v115
s_waitcnt vmcnt(14) lgkmcnt(0)
v_mfma_f32_16x16x32_bf16 v[36:39], a[144:147], a[80:83], v[36:39]
ds_read_b128 a[180:183], v8 offset:14336
v_mul_f32 v130, 0x3ae38e39, v130
v_mfma_f32_16x16x32_bf16 v[64:67], a[144:147], a[84:87], v[64:67]
ds_read_b128 a[184:187], v8 offset:15360
v_mul_f32 v6, v130, v130
v_mfma_f32_16x16x32_bf16 v[40:43], a[148:151], a[80:83], v[40:43]
ds_read_b128 a[188:191], v8 offset:16384
v_mul_f32 v131, 0x3ae38e39, v131
v_mfma_f32_16x16x32_bf16 v[68:71], a[148:151], a[84:87], v[68:71]
ds_read_b128 a[192:195], v8 offset:17408
v_mfma_f32_16x16x32_bf16 v[44:47], a[152:155], a[80:83], v[44:47]
ds_read_b128 a[196:199], v8 offset:18432
v_sub_f32 v131, v131, v6
v_mfma_f32_16x16x32_bf16 v[72:75], a[152:155], a[84:87], v[72:75]
ds_read_b128 a[200:203], v8 offset:19456
v_max_f32 v131, 0, v131
v_mfma_f32_16x16x32_bf16 v[48:51], a[156:159], a[80:83], v[48:51]
ds_read_b128 a[204:207], v8 offset:20480
v_add_f32 v131, 0x3727c5ac, v131
v_mfma_f32_16x16x32_bf16 v[76:79], a[156:159], a[84:87], v[76:79]
ds_read_b128 a[208:211], v125 offset:14336
buffer_load_dwordx4 a[128:131], v1, s[8:11], s62 offen offset:0 sc1
v_mfma_f32_16x16x32_bf16 v[52:55], a[160:163], a[80:83], v[52:55]
ds_read_b128 a[212:215], v126 offset:11264
v_mfma_f32_16x16x32_bf16 v[80:83], a[160:163], a[84:87], v[80:83]
v_rsq_f32 v132, v131
v_mfma_f32_16x16x32_bf16 v[92:95], a[172:175], a[176:179], v[92:95]
v_cvt_pk_bf16_f32 v6, -v130, -v130
v_and_b32 v6, 0xffff0000, v6
v_mfma_f32_16x16x32_bf16 v[96:99], a[160:163], a[176:179], v[96:99]
buffer_load_dwordx4 a[132:135], v237, s[8:11], s62 offen offset:0 sc1
v_add_f32 v6, v130, v6
v_mfma_f32_16x16x32_bf16 v[56:59], a[164:167], a[80:83], v[56:59]
v_cvt_pk_bf16_f32 v133, -v130, -v6
v_mfma_f32_16x16x32_bf16 v[84:87], a[164:167], a[84:87], v[84:87]
v_mfma_f32_16x16x32_bf16 v[60:63], a[168:171], a[80:83], v[60:63]
v_mfma_f32_16x16x32_bf16 v[88:91], a[168:171], a[84:87], v[88:91]
s_waitcnt vmcnt(10) lgkmcnt(0)
v_cmp_ne_u64 vcc, v[148:149], v[238:239]
s_cmp_eq_u32 s29, 0
s_cselect_b64 vcc, vcc, 0
s_cbranch_vccnz L_dbslow_11
L_dbback_12:
s_barrier
v_mfma_f32_16x16x32_bf16 v[36:39], a[180:183], a[88:91], v[36:39]
ds_read_b128 a[144:147], v8 offset:21504
buffer_load_dwordx4 a[136:139], v1, s[8:11], s62 offen offset:1024 sc1
v_mfma_f32_16x16x32_bf16 v[64:67], a[180:183], a[92:95], v[64:67]
ds_read_b128 a[148:151], v8 offset:22528
v_mfma_f32_16x16x32_bf16 v[40:43], a[184:187], a[88:91], v[40:43]
ds_read_b128 a[152:155], v8 offset:23552
s_add_u32 m0, s68, 0
v_mfma_f32_16x16x32_bf16 v[68:71], a[184:187], a[92:95], v[68:71]
ds_read_b128 a[156:159], v8 offset:24576
v_mfma_f32_16x16x32_bf16 v[44:47], a[188:191], a[88:91], v[44:47]
ds_read_b128 a[160:163], v8 offset:25600
buffer_load_dwordx4 a[140:143], v237, s[8:11], s62 offen offset:1024 sc1
v_mfma_f32_16x16x32_bf16 v[72:75], a[188:191], a[92:95], v[72:75]
ds_read_b128 a[164:167], v8 offset:26624
s_add_u32 s3, s3, 0
v_mfma_f32_16x16x32_bf16 v[48:51], a[192:195], a[88:91], v[48:51]
ds_read_b128 a[168:171], v8 offset:27648
v_mfma_f32_16x16x32_bf16 v[76:79], a[192:195], a[92:95], v[76:79]
ds_read_b128 a[172:175], v125 offset:21504
buffer_load_dwordx4 v240, s[12:15], s3 offen offset:0 nt lds
v_mfma_f32_16x16x32_bf16 v[52:55], a[196:199], a[88:91], v[52:55]
ds_read_b128 a[176:179], v126 offset:12288
s_mov_b32 s37, L_c2-L_pc
v_mfma_f32_16x16x32_bf16 v[80:83], a[196:199], a[92:95], v[80:83]
ds_bpermute_b32 v116, v124, v133 offset:128
v_mfma_f32_16x16x32_bf16 v[92:95], a[208:211], a[212:215], v[92:95]
ds_bpermute_b32 v118, v124, v133 offset:192
buffer_load_dwordx4 v241, s[12:15], s3 offen offset:1024 nt lds
v_mfma_f32_16x16x32_bf16 v[96:99], a[196:199], a[212:215], v[96:99]
ds_bpermute_b32 v120, v124, v133
v_mfma_f32_16x16x32_bf16 v[56:59], a[200:203], a[88:91], v[56:59]
buffer_load_dword v15, v14, s[88:91], s37 offen
ds_bpermute_b32 v134, v124, v132 offset:128
v_mfma_f32_16x16x32_bf16 v[84:87], a[200:203], a[92:95], v[84:87]
ds_bpermute_b32 v135, v124, v132 offset:192
buffer_load_dwordx4 v242, s[12:15], s3 offen offset:2048 nt lds
v_mfma_f32_16x16x32_bf16 v[60:63], a[204:207], a[88:91], v[60:63]
v_mfma_f32_16x16x32_bf16 v[88:91], a[204:207], a[92:95], v[88:91]
buffer_load_dwordx4 v243, s[12:15], s3 offen offset:3072 nt lds
s_waitcnt vmcnt(15) lgkmcnt(0)
v_mfma_f32_16x16x32_bf16 v[36:39], a[144:147], a[96:99], v[36:39]
ds_read_b128 a[180:183], v8 offset:28672
v_mfma_f32_16x16x32_bf16 v[64:67], a[144:147], a[100:103], v[64:67]
ds_read_b128 a[184:187], v8 offset:29696
v_mfma_f32_16x16x32_bf16 v[40:43], a[148:151], a[96:99], v[40:43]
ds_read_b128 a[188:191], v8 offset:30720
s_add_u32 m0, s68, 4096
v_mfma_f32_16x16x32_bf16 v[68:71], a[148:151], a[100:103], v[68:71]
ds_read_b128 a[192:195], v8 offset:31744
v_mfma_f32_16x16x32_bf16 v[44:47], a[152:155], a[96:99], v[44:47]
ds_read_b128 a[196:199], v8 offset:32768
s_add_u32 s3, s3, 65536
v_mfma_f32_16x16x32_bf16 v[72:75], a[152:155], a[100:103], v[72:75]
ds_read_b128 a[200:203], v8 offset:33792
v_mfma_f32_16x16x32_bf16 v[48:51], a[156:159], a[96:99], v[48:51]
ds_read_b128 a[204:207], v8 offset:34816
v_mfma_f32_16x16x32_bf16 v[76:79], a[156:159], a[100:103], v[76:79]
ds_read_b128 a[208:211], v125 offset:28672
buffer_load_dwordx4 v240, s[12:15], s3 offen offset:0 nt lds
v_mfma_f32_16x16x32_bf16 v[52:55], a[160:163], a[96:99], v[52:55]
ds_read_b128 a[212:215], v126 offset:13312
v_mfma_f32_16x16x32_bf16 v[80:83], a[160:163], a[100:103], v[80:83]
ds_bpermute_b32 v136, v122, v132 offset:0
v_mfma_f32_16x16x32_bf16 v[92:95], a[172:175], a[176:179], v[92:95]
ds_bpermute_b32 v137, v123, v132 offset:0
buffer_load_dwordx4 v241, s[12:15], s3 offen offset:1024 nt lds
v_mfma_f32_16x16x32_bf16 v[96:99], a[160:163], a[176:179], v[96:99]
ds_bpermute_b32 v138, v122, v132 offset:64
v_mfma_f32_16x16x32_bf16 v[56:59], a[164:167], a[96:99], v[56:59]
ds_bpermute_b32 v139, v123, v132 offset:64
buffer_load_dwordx4 v242, s[12:15], s3 offen offset:2048 nt lds
v_mfma_f32_16x16x32_bf16 v[84:87], a[164:167], a[100:103], v[84:87]
v_mfma_f32_16x16x32_bf16 v[60:63], a[168:171], a[96:99], v[60:63]
v_mfma_f32_16x16x32_bf16 v[88:91], a[168:171], a[100:103], v[88:91]
buffer_load_dwordx4 v243, s[12:15], s3 offen offset:3072 nt lds
s_waitcnt vmcnt(17) lgkmcnt(0)
v_mfma_f32_16x16x32_bf16 v[36:39], a[180:183], a[104:107], v[36:39]
ds_read_b128 a[144:147], v8 offset:35840
v_mov_b32 v117, v116
v_mfma_f32_16x16x32_bf16 v[64:67], a[180:183], a[108:111], v[64:67]
ds_read_b128 a[148:151], v8 offset:36864
v_mfma_f32_16x16x32_bf16 v[40:43], a[184:187], a[104:107], v[40:43]
ds_read_b128 a[152:155], v8 offset:37888
s_mov_b32 s3, 1073741824
v_mfma_f32_16x16x32_bf16 v[68:71], a[184:187], a[108:111], v[68:71]
ds_read_b128 a[156:159], v8 offset:38912
v_mov_b32 v119, v118
v_mfma_f32_16x16x32_bf16 v[44:47], a[188:191], a[104:107], v[44:47]
ds_read_b128 a[160:163], v8 offset:39936
v_mov_b32 v121, v120
v_mfma_f32_16x16x32_bf16 v[72:75], a[188:191], a[108:111], v[72:75]
ds_read_b128 a[164:167], v8 offset:40960
s_mul_i32 s36, s28, 82944
v_mfma_f32_16x16x32_bf16 v[48:51], a[192:195], a[104:107], v[48:51]
ds_read_b128 a[168:171], v8 offset:41984
v_mfma_f32_16x16x32_bf16 v[76:79], a[192:195], a[108:111], v[76:79]
ds_read_b128 a[172:175], v125 offset:35840
v_mul_f32 v134, 0x3eae1a93, v134
v_mfma_f32_16x16x32_bf16 v[52:55], a[196:199], a[104:107], v[52:55]
ds_read_b128 a[176:179], v126 offset:14336
s_mul_i32 s38, s24, 8192
v_mfma_f32_16x16x32_bf16 v[80:83], a[196:199], a[108:111], v[80:83]
ds_read_b64 a[0:1], v127 offset:0
v_mul_f32 v135, 0x3eae1a93, v135
v_mfma_f32_16x16x32_bf16 v[92:95], a[208:211], a[212:215], v[92:95]
ds_read_b64 a[2:3], v127 offset:512
v_mfma_f32_16x16x32_bf16 v[96:99], a[196:199], a[212:215], v[96:99]
s_add_u32 m0, s38, 37888
v_mul_f32 v140, v134, v136
v_mfma_f32_16x16x32_bf16 v[56:59], a[200:203], a[104:107], v[56:59]
ds_read_b64 a[4:5], v127 offset:1024
v_mfma_f32_16x16x32_bf16 v[84:87], a[200:203], a[108:111], v[84:87]
ds_read_b64 a[6:7], v127 offset:1536
v_mfma_f32_16x16x32_bf16 v[60:63], a[204:207], a[104:107], v[60:63]
s_add_u32 s39, s38, s36
v_mul_f32 v141, v134, v137
v_mfma_f32_16x16x32_bf16 v[88:91], a[204:207], a[108:111], v[88:91]
s_add_u32 s39, s39, 2121728
s_waitcnt vmcnt(15) lgkmcnt(0)
v_mfma_f32_16x16x32_bf16 v[36:39], a[144:147], a[112:115], v[36:39]
ds_read_b128 a[180:183], v8 offset:43008
v_mul_f32 v142, v135, v138
v_mfma_f32_16x16x32_bf16 v[64:67], a[144:147], a[116:119], v[64:67]
ds_read_b128 a[184:187], v8 offset:44032
v_mfma_f32_16x16x32_bf16 v[40:43], a[148:151], a[112:115], v[40:43]
ds_read_b128 a[188:191], v8 offset:45056
v_mul_f32 v143, v135, v139
v_mfma_f32_16x16x32_bf16 v[68:71], a[148:151], a[116:119], v[68:71]
ds_read_b128 a[192:195], v8 offset:46080
v_mfma_f32_16x16x32_bf16 v[44:47], a[152:155], a[112:115], v[44:47]
ds_read_b128 a[196:199], v8 offset:47104
v_mfma_f32_16x16x32_bf16 v[72:75], a[152:155], a[116:119], v[72:75]
ds_read_b128 a[200:203], v8 offset:48128
v_mfma_f32_16x16x32_bf16 v[48:51], a[156:159], a[112:115], v[48:51]
ds_read_b128 a[204:207], v8 offset:49152
v_mfma_f32_16x16x32_bf16 v[76:79], a[156:159], a[116:119], v[76:79]
ds_read_b128 a[208:211], v125 offset:43008
v_mfma_f32_16x16x32_bf16 v[52:55], a[160:163], a[112:115], v[52:55]
ds_read_b128 a[212:215], v126 offset:15360
buffer_load_dwordx4 v1, s[4:7], s39 offen offset:0 sc1 lds
v_mfma_f32_16x16x32_bf16 v[80:83], a[160:163], a[116:119], v[80:83]
ds_read_b64 a[8:9], v127 offset:2048
v_mfma_f32_16x16x32_bf16 v[92:95], a[172:175], a[176:179], v[92:95]
ds_read_b64 a[10:11], v127 offset:2560
v_mfma_f32_16x16x32_bf16 v[96:99], a[160:163], a[176:179], v[96:99]
s_cmp_eq_u32 s60, 0
s_cselect_b32 s30, 0xf149f2ca, 0
v_mov_b32 v6, s30
v_mfma_f32_16x16x32_bf16 v[56:59], a[164:167], a[112:115], v[56:59]
ds_read_b64 a[12:13], v127 offset:3072
buffer_load_dwordx4 v1, s[4:7], s39 offen offset:1024 sc1 lds
v_mfma_f32_16x16x32_bf16 v[84:87], a[164:167], a[116:119], v[84:87]
ds_read_b64 a[14:15], v128
v_cndmask_b32 v144, v6, 0, s[42:43]
v_mfma_f32_16x16x32_bf16 v[60:63], a[168:171], a[112:115], v[60:63]
v_cndmask_b32 v145, v6, 0, s[44:45]
v_mfma_f32_16x16x32_bf16 v[88:91], a[168:171], a[116:119], v[88:91]
s_waitcnt vmcnt(15) lgkmcnt(0)
v_mfma_f32_16x16x32_bf16 v[36:39], a[180:183], a[120:123], v[36:39]
ds_read_b128 a[144:147], v8 offset:50176
buffer_load_dwordx4 v1, s[4:7], s39 offen offset:2048 sc1 lds
v_mfma_f32_16x16x32_bf16 v[64:67], a[180:183], a[124:127], v[64:67]
ds_read_b128 a[148:151], v8 offset:51200
v_mfma_f32_16x16x32_bf16 v[40:43], a[184:187], a[120:123], v[40:43]
ds_read_b128 a[152:155], v8 offset:52224
v_mfma_f32_16x16x32_bf16 v[68:71], a[184:187], a[124:127], v[68:71]
ds_read_b128 a[156:159], v8 offset:53248
buffer_load_dwordx4 v1, s[4:7], s39 offen offset:3072 sc1 lds
v_mfma_f32_16x16x32_bf16 v[44:47], a[188:191], a[120:123], v[44:47]
ds_read_b128 a[160:163], v8 offset:54272
v_mfma_f32_16x16x32_bf16 v[72:75], a[188:191], a[124:127], v[72:75]
ds_read_b128 a[164:167], v8 offset:55296
v_mfma_f32_16x16x32_bf16 v[48:51], a[192:195], a[120:123], v[48:51]
ds_read_b128 a[168:171], v8 offset:56320
v_mfma_f32_16x16x32_bf16 v[76:79], a[192:195], a[124:127], v[76:79]
ds_read_b128 a[172:175], v125 offset:50176
s_add_u32 m0, m0, 4096
v_mfma_f32_16x16x32_bf16 v[52:55], a[196:199], a[120:123], v[52:55]
ds_read_b128 a[176:179], v126 offset:16384
s_waitcnt vmcnt(8)
v_mfma_f32_16x16x32_bf16 v[80:83], a[196:199], a[124:127], v[80:83]
ds_read_b128 a[224:227], v244 offset:0
v_mfma_f32_16x16x32_bf16 v[92:95], a[208:211], a[212:215], v[92:95]
ds_read_b128 a[228:231], v245 offset:0
v_mfma_f32_16x16x32_bf16 v[96:99], a[196:199], a[212:215], v[96:99]
s_add_u32 s39, s39, 4096
v_mfma_f32_16x16x32_bf16 v[56:59], a[200:203], a[120:123], v[56:59]
ds_read_b128 a[232:235], v246 offset:0
v_mfma_f32_16x16x32_bf16 v[84:87], a[200:203], a[124:127], v[84:87]
ds_read_b128 a[236:239], v247 offset:0
v_mfma_f32_16x16x32_bf16 v[60:63], a[204:207], a[120:123], v[60:63]
v_mfma_f32_16x16x32_bf16 v[88:91], a[204:207], a[124:127], v[88:91]
buffer_load_dwordx4 v1, s[4:7], s39 offen offset:0 sc1 lds
s_waitcnt lgkmcnt(0)
v_mfma_f32_16x16x32_bf16 v[36:39], a[144:147], a[128:131], v[36:39]
ds_read_b128 a[180:183], v8 offset:57344
v_mfma_f32_16x16x32_bf16 v[64:67], a[144:147], a[132:135], v[64:67]
ds_read_b128 a[184:187], v8 offset:58368
v_mfma_f32_16x16x32_bf16 v[40:43], a[148:151], a[128:131], v[40:43]
ds_read_b128 a[188:191], v8 offset:59392
v_mfma_f32_16x16x32_bf16 v[68:71], a[148:151], a[132:135], v[68:71]
ds_read_b128 a[192:195], v8 offset:60416
buffer_load_dwordx4 v1, s[4:7], s39 offen offset:1024 sc1 lds
v_mfma_f32_16x16x32_bf16 v[44:47], a[152:155], a[128:131], v[44:47]
ds_read_b128 a[196:199], v8 offset:61440
v_mfma_f32_16x16x32_bf16 v[72:75], a[152:155], a[132:135], v[72:75]
ds_read_b128 a[200:203], v8 offset:62464
v_mfma_f32_16x16x32_bf16 v[48:51], a[156:159], a[128:131], v[48:51]
ds_read_b128 a[204:207], v8 offset:63488
v_mfma_f32_16x16x32_bf16 v[76:79], a[156:159], a[132:135], v[76:79]
ds_read_b128 a[208:211], v125 offset:57344
buffer_load_dwordx4 v1, s[4:7], s39 offen offset:2048 sc1 lds
v_mfma_f32_16x16x32_bf16 v[52:55], a[160:163], a[128:131], v[52:55]
ds_read_b128 a[212:215], v126 offset:17408
s_waitcnt vmcnt(7)
v_mfma_f32_16x16x32_bf16 v[80:83], a[160:163], a[132:135], v[80:83]
ds_read_b128 a[240:243], v244 offset:4096
v_mfma_f32_16x16x32_bf16 v[92:95], a[172:175], a[176:179], v[92:95]
ds_read_b128 a[244:247], v245 offset:4096
v_mfma_f32_16x16x32_bf16 v[96:99], a[160:163], a[176:179], v[96:99]
ds_read_b128 a[248:251], v246 offset:4096
buffer_load_dwordx4 v1, s[4:7], s39 offen offset:3072 sc1 lds
v_mfma_f32_16x16x32_bf16 v[56:59], a[164:167], a[128:131], v[56:59]
ds_read_b128 a[252:255], v247 offset:4096
v_mfma_f32_16x16x32_bf16 v[84:87], a[164:167], a[132:135], v[84:87]
v_mfma_f32_16x16x32_bf16 v[60:63], a[168:171], a[128:131], v[60:63]
v_mfma_f32_16x16x32_bf16 v[88:91], a[168:171], a[132:135], v[88:91]
s_waitcnt lgkmcnt(0)
s_barrier
v_mfma_f32_16x16x32_bf16 v[36:39], a[180:183], a[136:139], v[36:39]
v_mfma_f32_16x16x32_bf16 v[64:67], a[180:183], a[140:143], v[64:67]
v_mfma_f32_16x16x16_bf16 v[36:39], a[0:1], v[116:117], v[36:39]
v_mfma_f32_16x16x16_bf16 v[64:67], a[0:1], v[118:119], v[64:67]
v_mfma_f32_16x16x32_bf16 v[40:43], a[184:187], a[136:139], v[40:43]
v_mfma_f32_16x16x32_bf16 v[68:71], a[184:187], a[140:143], v[68:71]
s_nop 1
v_mfma_f32_16x16x16_bf16 v[40:43], a[2:3], v[116:117], v[40:43]
s_nop 1
v_mfma_f32_16x16x16_bf16 v[68:71], a[2:3], v[118:119], v[68:71]
v_cvt_pk_bf16_f32 v156, v36, v37
v_cvt_pk_bf16_f32 v157, v38, v39
v_mfma_f32_16x16x32_bf16 v[44:47], a[188:191], a[136:139], v[44:47]
ds_write_b64 v218, v[156:157] offset:2816
v_mfma_f32_16x16x32_bf16 v[72:75], a[188:191], a[140:143], v[72:75]
v_cvt_pk_bf16_f32 v162, v64, v65
v_cvt_pk_bf16_f32 v163, v66, v67
v_mfma_f32_16x16x16_bf16 v[44:47], a[4:5], v[116:117], v[44:47]
ds_write_b64 v218, v[162:163] offset:5632
v_mfma_f32_16x16x16_bf16 v[72:75], a[4:5], v[118:119], v[72:75]
v_cvt_pk_bf16_f32 v160, v40, v41
v_cvt_pk_bf16_f32 v161, v42, v43
v_mfma_f32_16x16x32_bf16 v[48:51], a[192:195], a[136:139], v[48:51]
ds_write_b64 v218, v[160:161] offset:2848
v_mfma_f32_16x16x32_bf16 v[76:79], a[192:195], a[140:143], v[76:79]
v_cvt_pk_bf16_f32 v166, v68, v69
v_cvt_pk_bf16_f32 v167, v70, v71
v_mfma_f32_16x16x16_bf16 v[48:51], a[6:7], v[116:117], v[48:51]
ds_write_b64 v218, v[166:167] offset:5664
v_mfma_f32_16x16x16_bf16 v[76:79], a[6:7], v[118:119], v[76:79]
v_cvt_pk_bf16_f32 v202, v44, v45
v_cvt_pk_bf16_f32 v203, v46, v47
v_mfma_f32_16x16x32_bf16 v[52:55], a[196:199], a[136:139], v[52:55]
ds_write_b64 v218, v[202:203] offset:2880
v_mfma_f32_16x16x32_bf16 v[80:83], a[196:199], a[140:143], v[80:83]
v_cvt_pk_bf16_f32 v204, v72, v73
v_cvt_pk_bf16_f32 v205, v74, v75
v_mfma_f32_16x16x16_bf16 v[52:55], a[8:9], v[116:117], v[52:55]
ds_write_b64 v218, v[204:205] offset:5696
v_mfma_f32_16x16x16_bf16 v[80:83], a[8:9], v[118:119], v[80:83]
v_cvt_pk_bf16_f32 v206, v48, v49
v_cvt_pk_bf16_f32 v207, v50, v51
v_mfma_f32_16x16x32_bf16 v[92:95], a[208:211], a[212:215], v[92:95]
ds_write_b64 v218, v[206:207] offset:2912
v_mfma_f32_16x16x32_bf16 v[96:99], a[196:199], a[212:215], v[96:99]
v_cvt_pk_bf16_f32 v208, v76, v77
v_cvt_pk_bf16_f32 v209, v78, v79
v_mfma_f32_16x16x16_bf16 v[92:95], a[14:15], v[120:121], v[92:95]
ds_write_b64 v218, v[208:209] offset:5728
v_mfma_f32_16x16x16_bf16 v[96:99], a[8:9], v[120:121], v[96:99]
v_cvt_pk_bf16_f32 v210, v52, v53
v_cvt_pk_bf16_f32 v211, v54, v55
v_mfma_f32_16x16x32_bf16 v[56:59], a[200:203], a[136:139], v[56:59]
ds_write_b64 v218, v[210:211] offset:2944
v_mfma_f32_16x16x32_bf16 v[84:87], a[200:203], a[140:143], v[84:87]
v_cvt_pk_bf16_f32 v212, v80, v81
v_cvt_pk_bf16_f32 v213, v82, v83
v_mfma_f32_16x16x16_bf16 v[56:59], a[10:11], v[116:117], v[56:59]
ds_write_b64 v218, v[212:213] offset:5760
v_mfma_f32_16x16x16_bf16 v[84:87], a[10:11], v[118:119], v[84:87]
v_cvt_pk_bf16_f32 v214, v92, v93
v_cvt_pk_bf16_f32 v215, v94, v95
v_mfma_f32_16x16x32_bf16 v[60:63], a[204:207], a[136:139], v[60:63]
ds_write_b64 v222, v[214:215]
v_mfma_f32_16x16x32_bf16 v[88:91], a[204:207], a[140:143], v[88:91]
v_cvt_pk_bf16_f32 v216, v96, v97
v_cvt_pk_bf16_f32 v217, v98, v99
v_mfma_f32_16x16x16_bf16 v[60:63], a[12:13], v[116:117], v[60:63]
ds_write_b64 v219, v[216:217] offset:128
v_mfma_f32_16x16x16_bf16 v[88:91], a[12:13], v[118:119], v[88:91]
s_waitcnt lgkmcnt(0)
s_barrier
ds_read_b64 v[150:151], v218
ds_read_b64 v[154:155], v218 offset:32
ds_read_b64 v[152:153], v220 offset:136
ds_read_b64 v[158:159], v220 offset:2952
ds_read_b64 v[164:165], v220 offset:5768
s_mul_i32 s36, s28, 82944
s_mul_i32 s38, s24, 13312
s_add_u32 m0, s38, 70656
s_add_u32 s39, s38, s36
s_add_u32 s39, s39, 2154496
buffer_load_dwordx4 v1, s[4:7], s39 offen offset:0 sc1 lds
buffer_load_dwordx4 v1, s[4:7], s39 offen offset:1024 sc1 lds
v_cndmask_b32 v170, 0, v210, s[48:49]
v_cndmask_b32 v173, 0, v211, s[48:49]
v_cndmask_b32 v178, 0, v212, s[48:49]
v_cndmask_b32 v181, 0, v213, s[48:49]
v_cvt_pk_bf16_f32 v168, v56, v57
v_cvt_pk_bf16_f32 v169, v58, v59
v_cvt_pk_bf16_f32 v176, v84, v85
v_cvt_pk_bf16_f32 v177, v86, v87
v_cvt_pk_bf16_f32 v174, v60, v61
v_cvt_pk_bf16_f32 v175, v62, v63
v_cvt_pk_bf16_f32 v182, v88, v89
v_cvt_pk_bf16_f32 v183, v90, v91
s_waitcnt lgkmcnt(0)
ds_read_b64_tr_b16 v[184:185], v221 offset:64
v_mfma_f32_16x16x32_bf16 v[36:39], v[150:153], v[168:171], 0
ds_read_b64_tr_b16 v[186:187], v221 offset:2880
v_mfma_f32_16x16x32_bf16 v[40:43], v[156:159], v[168:171], 0
ds_read_b64_tr_b16 v[188:189], v221 offset:5696
buffer_load_dwordx4 v1, s[4:7], s39 offen offset:2048 sc1 lds
v_mfma_f32_16x16x32_bf16 v[44:47], v[152:155], v[172:175], 0
ds_read_b64_tr_b16 v[190:191], v221 offset:96
v_mfma_f32_16x16x32_bf16 v[48:51], v[158:161], v[172:175], 0
ds_read_b64_tr_b16 v[192:193], v221 offset:2912
buffer_load_dwordx4 v1, s[4:7], s39 offen offset:3072 sc1 lds
v_mfma_f32_16x16x32_bf16 v[52:55], v[156:159], v[176:179], 0
ds_read_b64_tr_b16 v[194:195], v221 offset:5728
v_mfma_f32_16x16x32_bf16 v[56:59], v[162:165], v[176:179], 0
ds_read_b64_tr_b16 v[196:197], v221 offset:128
s_add_u32 m0, m0, 4096
s_add_u32 s39, s39, 4096
buffer_load_dwordx4 v1, s[4:7], s39 offen offset:0 sc1 lds
v_mfma_f32_16x16x32_bf16 v[60:63], v[158:161], v[180:183], 0
ds_read_b64_tr_b16 v[198:199], v221 offset:2944
v_mfma_f32_16x16x32_bf16 v[64:67], v[164:167], v[180:183], 0
ds_read_b64_tr_b16 v[200:201], v221 offset:5760
buffer_load_dwordx4 v1, s[4:7], s39 offen offset:1024 sc1 lds
v_cndmask_b32 v36, v36, v37, s[40:41]
v_cndmask_b32 v40, v40, v41, s[40:41]
v_cndmask_b32 v36, v36, v40, s[42:43]
v_fma_f32 v68, v36, v140, v144
v_cndmask_b32 v38, v38, v39, s[40:41]
v_cndmask_b32 v42, v42, v43, s[40:41]
v_cndmask_b32 v38, v38, v42, s[44:45]
buffer_load_dwordx4 v1, s[4:7], s39 offen offset:2048 sc1 lds
v_fma_f32 v69, v38, v141, v145
v_max_f32 v76, v68, v69
v_cndmask_b32 v44, v44, v45, s[40:41]
v_cndmask_b32 v48, v48, v49, s[40:41]
v_cndmask_b32 v44, v44, v48, s[42:43]
v_fma_f32 v70, v44, v140, v144
buffer_load_dwordx4 v1, s[4:7], s39 offen offset:3072 sc1 lds
v_cndmask_b32 v46, v46, v47, s[40:41]
v_cndmask_b32 v50, v50, v51, s[40:41]
v_cndmask_b32 v46, v46, v50, s[44:45]
v_fma_f32 v71, v46, v141, v145
v_max_f32 v77, v70, v71
v_cndmask_b32 v52, v52, v53, s[40:41]
s_add_u32 m0, m0, 4096
v_cndmask_b32 v56, v56, v57, s[40:41]
v_cndmask_b32 v52, v52, v56, s[42:43]
v_mul_f32 v72, v52, v142
v_cndmask_b32 v54, v54, v55, s[40:41]
v_cndmask_b32 v58, v58, v59, s[40:41]
v_cndmask_b32 v54, v54, v58, s[44:45]
s_add_u32 s39, s39, 4096
v_mul_f32 v73, v54, v143
v_max_f32 v78, v72, v73
v_cndmask_b32 v60, v60, v61, s[40:41]
v_cndmask_b32 v64, v64, v65, s[40:41]
v_cndmask_b32 v60, v60, v64, s[42:43]
v_mul_f32 v74, v60, v142
buffer_load_dwordx4 v1, s[4:7], s39 offen offset:0 sc1 lds
v_cndmask_b32 v62, v62, v63, s[40:41]
v_cndmask_b32 v66, v66, v67, s[40:41]
v_cndmask_b32 v62, v62, v66, s[44:45]
v_mul_f32 v75, v62, v143
v_max_f32 v79, v74, v75
s_nop 1
v_permlane32_swap_b32 v76, v77
buffer_load_dwordx4 v1, s[4:7], s39 offen offset:1024 sc1 lds
v_permlane32_swap_b32 v78, v79
v_max_f32 v76, v76, v77
v_max_f32 v78, v78, v79
s_nop 1
v_permlane16_swap_b32 v76, v78
v_max_f32 v76, v76, v78
buffer_load_dwordx4 v1, s[4:7], s39 offen offset:2048 sc1 lds
v_mov_b32 v78, v76
s_nop 1
v_permlane16_swap_b32 v76, v78
v_mov_b32 v77, v76
v_mov_b32 v79, v78
s_nop 0
buffer_load_dwordx4 v1, s[4:7], s39 offen offset:3072 sc1 lds
v_permlane32_swap_b32 v76, v77
v_permlane32_swap_b32 v78, v79
v_sub_f32 v68, v68, v76
v_sub_f32 v69, v69, v76
v_sub_f32 v70, v70, v77
v_sub_f32 v71, v71, v77
s_add_u32 m0, m0, 4096
v_sub_f32 v72, v72, v78
v_sub_f32 v73, v73, v78
v_sub_f32 v74, v74, v79
v_sub_f32 v75, v75, v79
v_exp_f32 v68, v68
v_exp_f32 v69, v69
s_add_u32 s39, s39, 4096
v_exp_f32 v70, v70
v_exp_f32 v71, v71
v_exp_f32 v72, v72
v_exp_f32 v73, v73
v_exp_f32 v74, v74
v_exp_f32 v75, v75
buffer_load_dwordx4 v1, s[4:7], s39 offen offset:0 sc1 lds
v_add_f32 v76, v68, v69
v_add_f32 v77, v70, v71
v_add_f32 v78, v72, v73
v_add_f32 v79, v74, v75
v_mul_f32 v68, v68, v136
v_mul_f32 v69, v69, v137
v_mul_f32 v70, v70, v136
v_mul_f32 v71, v71, v137
v_mul_f32 v72, v72, v138
v_mul_f32 v73, v73, v139
v_mul_f32 v74, v74, v138
v_mul_f32 v75, v75, v139
s_nop 1
v_permlane32_swap_b32 v76, v77
v_permlane32_swap_b32 v78, v79
v_add_f32 v76, v76, v77
v_add_f32 v78, v78, v79
s_nop 1
v_permlane16_swap_b32 v76, v78
v_add_f32 v76, v76, v78
v_rcp_f32 v76, v76
s_nop 0
v_mov_b32 v78, v76
s_nop 1
v_permlane16_swap_b32 v76, v78
v_mov_b32 v77, v76
v_mov_b32 v79, v78
s_nop 0
v_permlane32_swap_b32 v76, v77
v_permlane32_swap_b32 v78, v79
s_waitcnt lgkmcnt(0)
v_mul_f32 v68, v68, v76
v_mul_f32 v69, v69, v76
v_cvt_pk_bf16_f32 v68, v68, v69
v_perm_b32 v84, v68, v68, v10
v_perm_b32 v85, v68, v68, v11
v_perm_b32 v86, v68, v68, v12
v_perm_b32 v87, v68, v68, v13
v_mul_f32 v70, v70, v77
v_mul_f32 v71, v71, v77
v_mfma_f32_16x16x32_bf16 v[36:39], v[184:187], v[84:87], 0
v_cvt_pk_bf16_f32 v70, v70, v71
v_perm_b32 v88, v70, v70, v10
v_mfma_f32_16x16x32_bf16 v[40:43], v[196:199], v[84:87], 0
v_perm_b32 v89, v70, v70, v11
v_perm_b32 v90, v70, v70, v12
v_perm_b32 v91, v70, v70, v13
v_mul_f32 v72, v72, v78
v_mul_f32 v73, v73, v78
v_mfma_f32_16x16x32_bf16 v[44:47], v[190:193], v[88:91], 0
v_cvt_pk_bf16_f32 v72, v72, v73
v_perm_b32 v92, v72, v72, v10
v_mfma_f32_16x16x32_bf16 v[48:51], v[196:199], v[88:91], 0
v_perm_b32 v93, v72, v72, v11
v_perm_b32 v94, v72, v72, v12
v_perm_b32 v95, v72, v72, v13
v_mul_f32 v74, v74, v79
v_mul_f32 v75, v75, v79
v_mfma_f32_16x16x32_bf16 v[52:55], v[186:189], v[92:95], 0
v_cvt_pk_bf16_f32 v74, v74, v75
v_perm_b32 v96, v74, v74, v10
v_mfma_f32_16x16x32_bf16 v[56:59], v[198:201], v[92:95], 0
v_perm_b32 v97, v74, v74, v11
v_perm_b32 v98, v74, v74, v12
v_perm_b32 v99, v74, v74, v13
v_cvt_pk_bf16_f32 v168, v36, v37
v_cvt_pk_bf16_f32 v169, v38, v39
v_mfma_f32_16x16x32_bf16 v[60:63], v[192:195], v[96:99], 0
v_mfma_f32_16x16x32_bf16 v[64:67], v[198:201], v[96:99], 0
v_cvt_pk_bf16_f32 v172, v40, v41
v_cvt_pk_bf16_f32 v170, v44, v45
v_cvt_pk_bf16_f32 v171, v46, v47
v_cvt_pk_bf16_f32 v173, v50, v51
buffer_store_dwordx4 v[168:171], v1, s[8:11], s64 offen sc1
buffer_store_dwordx2 v[172:173], v224, s[8:11], s65 offen sc1
v_cvt_pk_bf16_f32 v176, v52, v53
v_cvt_pk_bf16_f32 v177, v54, v55
v_cvt_pk_bf16_f32 v180, v56, v57
v_cvt_pk_bf16_f32 v178, v60, v61
v_cvt_pk_bf16_f32 v179, v62, v63
v_cvt_pk_bf16_f32 v181, v66, v67
buffer_store_dwordx4 v[176:179], v237, s[8:11], s64 offen sc1
buffer_store_dwordx2 v[180:181], v225, s[8:11], s65 offen sc1
L_c2:
s_mul_i32 s38, s24, 9216
s_add_u32 m0, s38, 123904
s_add_u32 s39, s38, s82
buffer_load_dwordx4 v1, s[4:7], s39 offen offset:0 sc1 lds
buffer_load_dwordx4 v1, s[4:7], s39 offen offset:1024 sc1 lds
buffer_load_dwordx4 v1, s[4:7], s39 offen offset:2048 sc1 lds
buffer_load_dwordx4 v1, s[4:7], s39 offen offset:3072 sc1 lds
s_add_u32 m0, m0, 4096
s_add_u32 s39, s39, 4096
buffer_load_dwordx4 v1, s[4:7], s39 offen offset:0 sc1 lds
buffer_load_dwordx4 v1, s[4:7], s39 offen offset:1024 sc1 lds
buffer_load_dwordx4 v1, s[4:7], s39 offen offset:2048 sc1 lds
v_lshlrev_b32 v7, 3, v1
s_lshl_b32 s31, s25, 11
v_add_u32 v7, s31, v7
s_cmp_eq_u32 s24, 0
s_cselect_b32 s30, 0, 1073741824
s_add_u32 s30, s30, 26476544
s_waitcnt vmcnt(7)
s_barrier
s_mov_b64 exec, 0xffff
buffer_atomic_add v4, v7, s[8:11], s30 offen sc1
s_mov_b64 exec, -1
s_lshl_b32 s35, s80, 7
s_add_u32 s35, s35, 26476544
s_cmp_eq_u32 s24, 1
s_cselect_b32 s35, s35, 1073741824
v_mov_b32 v6, 0
v_mov_b32 v244, 0
v_mov_b32 v245, 0
v_mov_b32 v246, 0
buffer_load_dwordx4 v1, s[4:7], s39 offen offset:3072 sc1 lds
s_add_u32 m0, m0, 4096
s_add_u32 s39, s39, 4096
buffer_load_dwordx4 v1, s[4:7], s39 offen offset:0 sc1 lds
s_lshl_b32 s38, s24, 8
s_add_u32 m0, s38, 160768
s_add_u32 s39, s38, s82
s_add_u32 s39, s39, 36864
s_mov_b64 exec, 0xffff
buffer_load_dwordx4 v1, s[4:7], s39 offen sc1 lds
s_mov_b64 exec, -1
s_mul_i32 s38, s24, 9216
s_add_u32 m0, s38, 0
s_add_u32 s39, s38, s82
s_add_u32 s39, s39, 37888
buffer_load_dwordx4 v1, s[4:7], s39 offen offset:0 sc1 lds
s_mov_b64 exec, 1
buffer_atomic_add v244, v6, s[8:11], s35 offen sc0 sc1
s_mov_b64 exec, -1
buffer_load_dwordx4 v1, s[4:7], s39 offen offset:1024 sc1 lds
buffer_load_dwordx4 v1, s[4:7], s39 offen offset:2048 sc1 lds
buffer_load_dwordx4 v1, s[4:7], s39 offen offset:3072 sc1 lds
s_add_u32 m0, m0, 4096
s_add_u32 s39, s39, 4096
s_mov_b64 exec, 1
buffer_atomic_add v245, v6, s[8:11], s35 offen sc0 sc1
s_mov_b64 exec, -1
buffer_load_dwordx4 v1, s[4:7], s39 offen offset:0 sc1 lds
buffer_load_dwordx4 v1, s[4:7], s39 offen offset:1024 sc1 lds
buffer_load_dwordx4 v1, s[4:7], s39 offen offset:2048 sc1 lds
s_mov_b64 exec, 1
buffer_atomic_add v246, v6, s[8:11], s35 offen sc0 sc1
s_mov_b64 exec, -1
buffer_load_dwordx4 v1, s[4:7], s39 offen offset:3072 sc1 lds
s_add_u32 m0, m0, 4096
s_add_u32 s39, s39, 4096
buffer_load_dwordx4 v1, s[4:7], s39 offen offset:0 sc1 lds
s_lshl_b32 s38, s24, 8
s_add_u32 m0, s38, 36864
s_add_u32 s39, s38, s82
s_add_u32 s39, s39, 74752
s_mov_b64 exec, 0xffff
buffer_load_dwordx4 v1, s[4:7], s39 offen sc1 lds
s_mov_b64 exec, -1
s_mul_i32 s60, s70, 18432
s_add_u32 s60, s60, 2490368
s_cmp_eq_u32 s24, 1
s_cbranch_scc0 L_other_15
s_mov_b32 s31, 0
s_mov_b64 exec, 1
v_mov_b32 v247, 0
buffer_atomic_add v247, v6, s[8:11], s35 offen sc0 sc1
s_waitcnt vmcnt(12)
v_cmp_gt_u32 vcc, 16, v244
s_nop 0
s_cbranch_vccz L_polled_14
s_waitcnt vmcnt(8)
v_cmp_gt_u32 vcc, 16, v245
s_nop 0
s_cbranch_vccz L_polled_14
v_mov_b32 v244, 0
buffer_atomic_add v244, v6, s[8:11], s35 offen sc0 sc1
s_waitcnt vmcnt(5)
v_cmp_gt_u32 vcc, 16, v246
s_nop 0
s_cbranch_vccz L_polled_14
v_mov_b32 v245, 0
buffer_atomic_add v245, v6, s[8:11], s35 offen sc0 sc1
L_poll_13:
s_add_u32 s31, s31, 1
s_cmp_gt_u32 s31, 100000
s_cbranch_scc1 L_polled_14
v_mov_b32 v246, 0
buffer_atomic_add v246, v6, s[8:11], s35 offen sc0 sc1
s_waitcnt vmcnt(3)
v_cmp_gt_u32 vcc, 16, v247
s_nop 0
s_cbranch_vccz L_polled_14
v_mov_b32 v247, 0
buffer_atomic_add v247, v6, s[8:11], s35 offen sc0 sc1
s_waitcnt vmcnt(3)
v_cmp_gt_u32 vcc, 16, v244
s_nop 0
s_cbranch_vccz L_polled_14
v_mov_b32 v244, 0
buffer_atomic_add v244, v6, s[8:11], s35 offen sc0 sc1
s_waitcnt vmcnt(3)
v_cmp_gt_u32 vcc, 16, v245
s_nop 0
s_cbranch_vccz L_polled_14
v_mov_b32 v245, 0
buffer_atomic_add v245, v6, s[8:11], s35 offen sc0 sc1
s_waitcnt vmcnt(3)
v_cmp_gt_u32 vcc, 16, v246
s_nop 0
s_cbranch_vccz L_polled_14
s_branch L_poll_13
L_polled_14:
s_mov_b64 exec, -1
L_other_15:
s_barrier
buffer_load_dwordx4 a[0:3], v1, s[8:11], s60 offen offset:0 sc1
buffer_load_dwordx4 a[4:7], v1, s[8:11], s60 offen offset:1024 sc1
s_barrier
buffer_load_dwordx4 a[8:11], v1, s[8:11], s60 offen offset:2048 sc1
buffer_load_dwordx4 a[12:15], v1, s[8:11], s60 offen offset:3072 sc1
s_barrier
s_add_u32 s60, s60, 4096
buffer_load_dwordx4 a[16:19], v1, s[8:11], s60 offen offset:0 sc1
buffer_load_dwordx4 a[20:23], v1, s[8:11], s60 offen offset:1024 sc1
s_barrier
buffer_load_dwordx4 a[24:27], v1, s[8:11], s60 offen offset:2048 sc1
buffer_load_dwordx4 a[28:31], v1, s[8:11], s60 offen offset:3072 sc1
v_lshrrev_b32 v40, 1, v1
v_and_b32 v36, 7, v2
v_lshlrev_b32 v36, 4, v36
v_lshl_add_u32 v36, v3, 7, v36
v_add_u32 v36, 4096, v36
v_add_u32 v36, 37888, v36
v_add_u32 v39, 37888, v1
v_add_u32 v37, 79360, v1
v_add_u32 v38, 41472, v36
ds_read_b128 a[72:75], v39 offset:0
ds_read_b128 a[76:79], v39 offset:1024
ds_read_b128 a[80:83], v39 offset:2048
ds_read_b128 a[84:87], v39 offset:3072
ds_read_b128 a[88:91], v36 offset:0
ds_read_b128 a[92:95], v39 offset:4608
ds_read_b128 a[96:99], v39 offset:5632
ds_read_b128 a[100:103], v39 offset:6656
ds_read_b128 a[104:107], v39 offset:7680
ds_read_b128 a[108:111], v36 offset:4608
v_mov_b32 v58, 1073741824
s_mul_i32 s62, s70, 18432
s_mul_i32 s32, s28, 2304
s_add_u32 s62, s62, s32
s_add_u32 s62, s62, 4849664
v_mov_b32 v60, v1
v_add_u32 v61, 2048, v60
v_cndmask_b32 v61, v58, v61, s[46:47]
s_lshl_b32 s63, s70, 7
s_lshl_b32 s32, s28, 14
s_add_u32 s63, s63, s32
s_add_u32 s63, s63, 7208960
v_lshlrev_b32 v59, 3, v2
v_cndmask_b32 v58, v58, v59, s[46:47]
s_waitcnt vmcnt(7) lgkmcnt(5)
v_mfma_f32_16x16x32_bf16 v[16:19], a[72:75], a[0:3], v[16:19]
ds_read_b128 a[112:115], v39 offset:9216
s_add_u32 s60, s60, 4096
buffer_load_dwordx4 a[32:35], v1, s[8:11], s60 offen offset:0 sc1
v_mfma_f32_16x16x32_bf16 v[20:23], a[76:79], a[0:3], v[20:23]
ds_read_b128 a[116:119], v39 offset:10240
v_mfma_f32_16x16x32_bf16 v[24:27], a[80:83], a[0:3], v[24:27]
ds_read_b128 a[120:123], v39 offset:11264
v_mfma_f32_16x16x32_bf16 v[28:31], a[84:87], a[0:3], v[28:31]
ds_read_b128 a[124:127], v39 offset:12288
v_mfma_f32_16x16x32_bf16 v[32:35], a[88:91], a[0:3], v[32:35]
ds_read_b128 a[128:131], v36 offset:9216
s_waitcnt vmcnt(7) lgkmcnt(5)
v_mfma_f32_16x16x32_bf16 v[16:19], a[92:95], a[4:7], v[16:19]
ds_read_b128 a[72:75], v39 offset:13824
buffer_load_dwordx4 a[36:39], v1, s[8:11], s60 offen offset:1024 sc1
v_mfma_f32_16x16x32_bf16 v[20:23], a[96:99], a[4:7], v[20:23]
ds_read_b128 a[76:79], v39 offset:14848
v_mfma_f32_16x16x32_bf16 v[24:27], a[100:103], a[4:7], v[24:27]
ds_read_b128 a[80:83], v39 offset:15872
v_mfma_f32_16x16x32_bf16 v[28:31], a[104:107], a[4:7], v[28:31]
ds_read_b128 a[84:87], v39 offset:16896
v_mfma_f32_16x16x32_bf16 v[32:35], a[108:111], a[4:7], v[32:35]
ds_read_b128 a[88:91], v36 offset:13824
s_waitcnt vmcnt(7) lgkmcnt(5)
v_mfma_f32_16x16x32_bf16 v[16:19], a[112:115], a[8:11], v[16:19]
ds_read_b128 a[92:95], v39 offset:18432
buffer_load_dwordx4 a[40:43], v1, s[8:11], s60 offen offset:2048 sc1
v_mfma_f32_16x16x32_bf16 v[20:23], a[116:119], a[8:11], v[20:23]
ds_read_b128 a[96:99], v39 offset:19456
v_mfma_f32_16x16x32_bf16 v[24:27], a[120:123], a[8:11], v[24:27]
ds_read_b128 a[100:103], v39 offset:20480
v_mfma_f32_16x16x32_bf16 v[28:31], a[124:127], a[8:11], v[28:31]
ds_read_b128 a[104:107], v39 offset:21504
v_mfma_f32_16x16x32_bf16 v[32:35], a[128:131], a[8:11], v[32:35]
ds_read_b128 a[108:111], v36 offset:18432
s_waitcnt vmcnt(7) lgkmcnt(5)
v_mfma_f32_16x16x32_bf16 v[16:19], a[72:75], a[12:15], v[16:19]
ds_read_b128 a[112:115], v39 offset:23040
buffer_load_dwordx4 a[44:47], v1, s[8:11], s60 offen offset:3072 sc1
v_mfma_f32_16x16x32_bf16 v[20:23], a[76:79], a[12:15], v[20:23]
ds_read_b128 a[116:119], v39 offset:24064
v_mfma_f32_16x16x32_bf16 v[24:27], a[80:83], a[12:15], v[24:27]
ds_read_b128 a[120:123], v39 offset:25088
v_mfma_f32_16x16x32_bf16 v[28:31], a[84:87], a[12:15], v[28:31]
ds_read_b128 a[124:127], v39 offset:26112
v_mfma_f32_16x16x32_bf16 v[32:35], a[88:91], a[12:15], v[32:35]
ds_read_b128 a[128:131], v36 offset:23040
s_waitcnt vmcnt(7) lgkmcnt(5)
v_mfma_f32_16x16x32_bf16 v[16:19], a[92:95], a[16:19], v[16:19]
ds_read_b128 a[72:75], v39 offset:27648
s_add_u32 s60, s60, 4096
buffer_load_dwordx4 a[48:51], v1, s[8:11], s60 offen offset:0 sc1
v_mfma_f32_16x16x32_bf16 v[20:23], a[96:99], a[16:19], v[20:23]
ds_read_b128 a[76:79], v39 offset:28672
v_mfma_f32_16x16x32_bf16 v[24:27], a[100:103], a[16:19], v[24:27]
ds_read_b128 a[80:83], v39 offset:29696
v_mfma_f32_16x16x32_bf16 v[28:31], a[104:107], a[16:19], v[28:31]
ds_read_b128 a[84:87], v39 offset:30720
v_mfma_f32_16x16x32_bf16 v[32:35], a[108:111], a[16:19], v[32:35]
ds_read_b128 a[88:91], v36 offset:27648
s_waitcnt vmcnt(7) lgkmcnt(5)
v_mfma_f32_16x16x32_bf16 v[16:19], a[112:115], a[20:23], v[16:19]
ds_read_b128 a[92:95], v39 offset:32256
buffer_load_dwordx4 a[52:55], v1, s[8:11], s60 offen offset:1024 sc1
v_mfma_f32_16x16x32_bf16 v[20:23], a[116:119], a[20:23], v[20:23]
ds_read_b128 a[96:99], v39 offset:33280
v_mfma_f32_16x16x32_bf16 v[24:27], a[120:123], a[20:23], v[24:27]
ds_read_b128 a[100:103], v39 offset:34304
v_mfma_f32_16x16x32_bf16 v[28:31], a[124:127], a[20:23], v[28:31]
ds_read_b128 a[104:107], v39 offset:35328
v_mfma_f32_16x16x32_bf16 v[32:35], a[128:131], a[20:23], v[32:35]
ds_read_b128 a[108:111], v36 offset:32256
s_waitcnt vmcnt(7) lgkmcnt(5)
v_mfma_f32_16x16x32_bf16 v[16:19], a[72:75], a[24:27], v[16:19]
ds_read_b128 a[112:115], v39 offset:36864
buffer_load_dwordx4 a[56:59], v1, s[8:11], s60 offen offset:2048 sc1
v_mfma_f32_16x16x32_bf16 v[20:23], a[76:79], a[24:27], v[20:23]
ds_read_b128 a[116:119], v39 offset:37888
v_mfma_f32_16x16x32_bf16 v[24:27], a[80:83], a[24:27], v[24:27]
ds_read_b128 a[120:123], v39 offset:38912
v_mfma_f32_16x16x32_bf16 v[28:31], a[84:87], a[24:27], v[28:31]
ds_read_b128 a[124:127], v39 offset:39936
v_mfma_f32_16x16x32_bf16 v[32:35], a[88:91], a[24:27], v[32:35]
ds_read_b128 a[128:131], v36 offset:36864
s_waitcnt vmcnt(7) lgkmcnt(5)
v_mfma_f32_16x16x32_bf16 v[16:19], a[92:95], a[28:31], v[16:19]
ds_read_b128 a[72:75], v37 offset:0
buffer_load_dwordx4 a[60:63], v1, s[8:11], s60 offen offset:3072 sc1
v_mfma_f32_16x16x32_bf16 v[20:23], a[96:99], a[28:31], v[20:23]
ds_read_b128 a[76:79], v37 offset:1024
v_mfma_f32_16x16x32_bf16 v[24:27], a[100:103], a[28:31], v[24:27]
ds_read_b128 a[80:83], v37 offset:2048
v_mfma_f32_16x16x32_bf16 v[28:31], a[104:107], a[28:31], v[28:31]
ds_read_b128 a[84:87], v37 offset:3072
v_mfma_f32_16x16x32_bf16 v[32:35], a[108:111], a[28:31], v[32:35]
ds_read_b128 a[88:91], v38 offset:0
s_waitcnt vmcnt(7) lgkmcnt(5)
v_mfma_f32_16x16x32_bf16 v[16:19], a[112:115], a[32:35], v[16:19]
ds_read_b128 a[92:95], v37 offset:4608
s_add_u32 s60, s60, 4096
buffer_load_dwordx2 a[64:65], v40, s[8:11], s60 offen offset:0 sc1
buffer_load_dwordx2 a[66:67], v40, s[8:11], s60 offen offset:1024 sc1
v_mfma_f32_16x16x32_bf16 v[20:23], a[116:119], a[32:35], v[20:23]
ds_read_b128 a[96:99], v37 offset:5632
v_mfma_f32_16x16x32_bf16 v[24:27], a[120:123], a[32:35], v[24:27]
ds_read_b128 a[100:103], v37 offset:6656
v_mfma_f32_16x16x32_bf16 v[28:31], a[124:127], a[32:35], v[28:31]
ds_read_b128 a[104:107], v37 offset:7680
v_mfma_f32_16x16x32_bf16 v[32:35], a[128:131], a[32:35], v[32:35]
ds_read_b128 a[108:111], v38 offset:4608
s_waitcnt vmcnt(8) lgkmcnt(5)
v_mfma_f32_16x16x32_bf16 v[16:19], a[72:75], a[36:39], v[16:19]
ds_read_b128 a[112:115], v37 offset:9216
buffer_load_dwordx2 a[68:69], v40, s[8:11], s60 offen offset:512 sc1
buffer_load_dwordx2 a[70:71], v40, s[8:11], s60 offen offset:1536 sc1
v_mfma_f32_16x16x32_bf16 v[20:23], a[76:79], a[36:39], v[20:23]
ds_read_b128 a[116:119], v37 offset:10240
v_mfma_f32_16x16x32_bf16 v[24:27], a[80:83], a[36:39], v[24:27]
ds_read_b128 a[120:123], v37 offset:11264
v_mfma_f32_16x16x32_bf16 v[28:31], a[84:87], a[36:39], v[28:31]
ds_read_b128 a[124:127], v37 offset:12288
v_mfma_f32_16x16x32_bf16 v[32:35], a[88:91], a[36:39], v[32:35]
ds_read_b128 a[128:131], v38 offset:9216
s_waitcnt vmcnt(9) lgkmcnt(5)
v_mfma_f32_16x16x32_bf16 v[16:19], a[92:95], a[40:43], v[16:19]
ds_read_b128 a[72:75], v37 offset:13824
v_mfma_f32_16x16x32_bf16 v[20:23], a[96:99], a[40:43], v[20:23]
ds_read_b128 a[76:79], v37 offset:14848
v_mfma_f32_16x16x32_bf16 v[24:27], a[100:103], a[40:43], v[24:27]
ds_read_b128 a[80:83], v37 offset:15872
v_mfma_f32_16x16x32_bf16 v[28:31], a[104:107], a[40:43], v[28:31]
ds_read_b128 a[84:87], v37 offset:16896
v_mfma_f32_16x16x32_bf16 v[32:35], a[108:111], a[40:43], v[32:35]
ds_read_b128 a[88:91], v38 offset:13824
s_waitcnt vmcnt(8) lgkmcnt(5)
v_mfma_f32_16x16x32_bf16 v[16:19], a[112:115], a[44:47], v[16:19]
ds_read_b128 a[92:95], v37 offset:18432
v_mfma_f32_16x16x32_bf16 v[20:23], a[116:119], a[44:47], v[20:23]
ds_read_b128 a[96:99], v37 offset:19456
v_mfma_f32_16x16x32_bf16 v[24:27], a[120:123], a[44:47], v[24:27]
ds_read_b128 a[100:103], v37 offset:20480
v_mfma_f32_16x16x32_bf16 v[28:31], a[124:127], a[44:47], v[28:31]
ds_read_b128 a[104:107], v37 offset:21504
v_mfma_f32_16x16x32_bf16 v[32:35], a[128:131], a[44:47], v[32:35]
ds_read_b128 a[108:111], v38 offset:18432
s_waitcnt vmcnt(7) lgkmcnt(5)
v_mfma_f32_16x16x32_bf16 v[16:19], a[72:75], a[48:51], v[16:19]
ds_read_b128 a[112:115], v37 offset:23040
v_mfma_f32_16x16x32_bf16 v[20:23], a[76:79], a[48:51], v[20:23]
ds_read_b128 a[116:119], v37 offset:24064
v_mfma_f32_16x16x32_bf16 v[24:27], a[80:83], a[48:51], v[24:27]
ds_read_b128 a[120:123], v37 offset:25088
v_mfma_f32_16x16x32_bf16 v[28:31], a[84:87], a[48:51], v[28:31]
ds_read_b128 a[124:127], v37 offset:26112
v_mfma_f32_16x16x32_bf16 v[32:35], a[88:91], a[48:51], v[32:35]
ds_read_b128 a[128:131], v38 offset:23040
s_waitcnt vmcnt(6) lgkmcnt(5)
v_mfma_f32_16x16x32_bf16 v[16:19], a[92:95], a[52:55], v[16:19]
ds_read_b128 a[72:75], v37 offset:27648
v_mfma_f32_16x16x32_bf16 v[20:23], a[96:99], a[52:55], v[20:23]
ds_read_b128 a[76:79], v37 offset:28672
v_mfma_f32_16x16x32_bf16 v[24:27], a[100:103], a[52:55], v[24:27]
ds_read_b128 a[80:83], v37 offset:29696
v_mfma_f32_16x16x32_bf16 v[28:31], a[104:107], a[52:55], v[28:31]
ds_read_b128 a[84:87], v37 offset:30720
v_mfma_f32_16x16x32_bf16 v[32:35], a[108:111], a[52:55], v[32:35]
ds_read_b128 a[88:91], v38 offset:27648
s_waitcnt vmcnt(5) lgkmcnt(5)
v_mfma_f32_16x16x32_bf16 v[16:19], a[112:115], a[56:59], v[16:19]
ds_read_b128 a[92:95], v37 offset:32256
v_mfma_f32_16x16x32_bf16 v[20:23], a[116:119], a[56:59], v[20:23]
ds_read_b128 a[96:99], v37 offset:33280
v_mfma_f32_16x16x32_bf16 v[24:27], a[120:123], a[56:59], v[24:27]
ds_read_b128 a[100:103], v37 offset:34304
v_mfma_f32_16x16x32_bf16 v[28:31], a[124:127], a[56:59], v[28:31]
ds_read_b128 a[104:107], v37 offset:35328
v_mfma_f32_16x16x32_bf16 v[32:35], a[128:131], a[56:59], v[32:35]
ds_read_b128 a[108:111], v38 offset:32256
s_waitcnt vmcnt(4) lgkmcnt(5)
v_mfma_f32_16x16x32_bf16 v[16:19], a[72:75], a[60:63], v[16:19]
ds_read_b128 a[112:115], v37 offset:36864
v_mfma_f32_16x16x32_bf16 v[20:23], a[76:79], a[60:63], v[20:23]
ds_read_b128 a[116:119], v37 offset:37888
v_mfma_f32_16x16x32_bf16 v[24:27], a[80:83], a[60:63], v[24:27]
ds_read_b128 a[120:123], v37 offset:38912
v_mfma_f32_16x16x32_bf16 v[28:31], a[84:87], a[60:63], v[28:31]
ds_read_b128 a[124:127], v37 offset:39936
v_mfma_f32_16x16x32_bf16 v[32:35], a[88:91], a[60:63], v[32:35]
ds_read_b128 a[128:131], v38 offset:36864
s_waitcnt vmcnt(2) lgkmcnt(5)
v_mfma_f32_16x16x32_bf16 v[16:19], a[92:95], a[64:67], v[16:19]
v_mfma_f32_16x16x32_bf16 v[20:23], a[96:99], a[64:67], v[20:23]
v_mfma_f32_16x16x32_bf16 v[24:27], a[100:103], a[64:67], v[24:27]
v_mfma_f32_16x16x32_bf16 v[28:31], a[104:107], a[64:67], v[28:31]
v_mfma_f32_16x16x32_bf16 v[32:35], a[108:111], a[64:67], v[32:35]
s_waitcnt vmcnt(0) lgkmcnt(0)
v_mfma_f32_16x16x32_bf16 v[16:19], a[112:115], a[68:71], v[16:19]
v_mfma_f32_16x16x32_bf16 v[20:23], a[116:119], a[68:71], v[20:23]
v_mfma_f32_16x16x32_bf16 v[24:27], a[120:123], a[68:71], v[24:27]
v_mfma_f32_16x16x32_bf16 v[28:31], a[124:127], a[68:71], v[28:31]
v_mfma_f32_16x16x32_bf16 v[32:35], a[128:131], a[68:71], v[32:35]
s_nop 3
v_pk_add_f32 v[62:63], v[16:17], v[18:19]
v_pk_mul_f32 v[64:65], v[16:17], v[16:17]
v_pk_fma_f32 v[64:65], v[18:19], v[18:19], v[64:65]
v_pk_add_f32 v[62:63], v[62:63], v[20:21]
v_pk_fma_f32 v[64:65], v[20:21], v[20:21], v[64:65]
v_pk_add_f32 v[62:63], v[62:63], v[22:23]
v_pk_fma_f32 v[64:65], v[22:23], v[22:23], v[64:65]
v_pk_add_f32 v[62:63], v[62:63], v[24:25]
v_pk_fma_f32 v[64:65], v[24:25], v[24:25], v[64:65]
v_pk_add_f32 v[62:63], v[62:63], v[26:27]
v_pk_fma_f32 v[64:65], v[26:27], v[26:27], v[64:65]
v_pk_add_f32 v[62:63], v[62:63], v[28:29]
v_pk_fma_f32 v[64:65], v[28:29], v[28:29], v[64:65]
v_pk_add_f32 v[62:63], v[62:63], v[30:31]
v_pk_fma_f32 v[64:65], v[30:31], v[30:31], v[64:65]
s_mov_b32 exec_hi, 0
v_pk_add_f32 v[62:63], v[62:63], v[32:33]
v_pk_fma_f32 v[64:65], v[32:33], v[32:33], v[64:65]
v_pk_add_f32 v[62:63], v[62:63], v[34:35]
v_pk_fma_f32 v[64:65], v[34:35], v[34:35], v[64:65]
s_mov_b64 exec, -1
v_add_f32 v56, v62, v63
v_add_f32 v57, v64, v65
v_cvt_pk_bf16_f32 v52, v32, v33
v_cvt_pk_bf16_f32 v53, v34, v35
v_permlane32_swap_b32 v56, v57
v_add_f32 v56, v56, v57
v_mov_b32 v57, v56
v_cvt_pk_bf16_f32 v44, v16, v17
v_cvt_pk_bf16_f32 v45, v18, v19
v_permlane16_swap_b32 v56, v57
v_add_f32 v56, v56, v57
v_mov_b32 v57, v56
v_cvt_pk_bf16_f32 v46, v20, v21
v_cvt_pk_bf16_f32 v47, v22, v23
v_permlane32_swap_b32 v56, v57
buffer_store_dwordx4 v[44:47], v60, s[8:11], s62 offen sc1
buffer_store_dwordx2 v[56:57], v58, s[8:11], s63 offen sc1
v_cvt_pk_bf16_f32 v48, v24, v25
v_cvt_pk_bf16_f32 v49, v26, v27
v_cvt_pk_bf16_f32 v50, v28, v29
v_cvt_pk_bf16_f32 v51, v30, v31
v_permlane16_swap_b32 v52, v54
v_permlane16_swap_b32 v53, v55
buffer_store_dwordx4 v[48:51], v60, s[8:11], s62 offen offset:1024 sc1
buffer_store_dwordx4 v[52:55], v61, s[8:11], s62 offen sc1
s_barrier
s_mul_i32 s38, s24, 9216
s_add_u32 m0, s38, 37888
s_add_u32 s39, s38, s82
s_add_u32 s39, s39, 75776
buffer_load_dwordx4 v1, s[4:7], s39 offen offset:0 sc1 lds
buffer_load_dwordx4 v1, s[4:7], s39 offen offset:1024 sc1 lds
buffer_load_dwordx4 v1, s[4:7], s39 offen offset:2048 sc1 lds
buffer_load_dwordx4 v1, s[4:7], s39 offen offset:3072 sc1 lds
s_add_u32 m0, m0, 4096
s_add_u32 s39, s39, 4096
buffer_load_dwordx4 v1, s[4:7], s39 offen offset:0 sc1 lds
buffer_load_dwordx4 v1, s[4:7], s39 offen offset:1024 sc1 lds
buffer_load_dwordx4 v1, s[4:7], s39 offen offset:2048 sc1 lds
v_lshlrev_b32 v7, 3, v1
s_lshr_b32 s31, s80, 4
s_lshl_b32 s31, s31, 11
v_add_u32 v7, s31, v7
s_cmp_eq_u32 s24, 0
s_cselect_b32 s30, 0, 1073741824
s_add_u32 s30, s30, 26509312
s_waitcnt vmcnt(7)
s_barrier
s_mov_b64 exec, 0xffff
buffer_atomic_add v4, v7, s[8:11], s30 offen sc1
s_mov_b64 exec, -1
s_lshl_b32 s35, s80, 7
s_add_u32 s35, s35, 26509312
s_cmp_eq_u32 s24, 1
s_cselect_b32 s35, s35, 1073741824
v_mov_b32 v6, 0
v_mov_b32 v244, 0
v_mov_b32 v245, 0
v_mov_b32 v246, 0
buffer_load_dwordx4 v1, s[4:7], s39 offen offset:3072 sc1 lds
s_add_u32 m0, m0, 4096
s_add_u32 s39, s39, 4096
buffer_load_dwordx4 v1, s[4:7], s39 offen offset:0 sc1 lds
s_lshl_b32 s38, s24, 8
s_add_u32 m0, s38, 74752
s_add_u32 s39, s38, s82
s_add_u32 s39, s39, 112640
s_mov_b64 exec, 0xffff
buffer_load_dwordx4 v1, s[4:7], s39 offen sc1 lds
s_mov_b64 exec, -1
s_mul_i32 s38, s24, 9216
s_add_u32 m0, s38, 75776
s_add_u32 s39, s38, s82
s_add_u32 s39, s39, 113664
buffer_load_dwordx4 v1, s[4:7], s39 offen offset:0 sc1 lds
s_mov_b64 exec, 1
buffer_atomic_add v244, v6, s[8:11], s35 offen sc0 sc1
s_mov_b64 exec, -1
buffer_load_dwordx4 v1, s[4:7], s39 offen offset:1024 sc1 lds
buffer_load_dwordx4 v1, s[4:7], s39 offen offset:2048 sc1 lds
buffer_load_dwordx4 v1, s[4:7], s39 offen offset:3072 sc1 lds
s_add_u32 m0, m0, 4096
s_add_u32 s39, s39, 4096
s_mov_b64 exec, 1
buffer_atomic_add v245, v6, s[8:11], s35 offen sc0 sc1
s_mov_b64 exec, -1
buffer_load_dwordx4 v1, s[4:7], s39 offen offset:0 sc1 lds
buffer_load_dwordx4 v1, s[4:7], s39 offen offset:1024 sc1 lds
buffer_load_dwordx4 v1, s[4:7], s39 offen offset:2048 sc1 lds
s_mov_b64 exec, 1
buffer_atomic_add v246, v6, s[8:11], s35 offen sc0 sc1
s_mov_b64 exec, -1
buffer_load_dwordx4 v1, s[4:7], s39 offen offset:3072 sc1 lds
s_add_u32 m0, m0, 4096
s_add_u32 s39, s39, 4096
buffer_load_dwordx4 v1, s[4:7], s39 offen offset:0 sc1 lds
s_lshl_b32 s38, s24, 8
s_add_u32 m0, s38, 112640
s_add_u32 s39, s38, s82
s_add_u32 s39, s39, 150528
s_mov_b64 exec, 0xffff
buffer_load_dwordx4 v1, s[4:7], s39 offen sc1 lds
s_mov_b64 exec, -1
s_lshl_b32 s60, s25, 2
s_add_u32 s60, s60, s24
s_mul_i32 s62, s60, 36864
s_add_u32 s62, s62, 4849664
v_add_u32 v180, 18432, v1
s_cmp_eq_u32 s24, 1
s_cbranch_scc0 L_other_20
s_mov_b32 s31, 0
s_mov_b64 exec, 1
v_mov_b32 v247, 0
buffer_atomic_add v247, v6, s[8:11], s35 offen sc0 sc1
s_waitcnt vmcnt(12)
v_cmp_gt_u32 vcc, 16, v244
s_nop 0
s_cbranch_vccz L_polled_19
s_waitcnt vmcnt(8)
v_cmp_gt_u32 vcc, 16, v245
s_nop 0
s_cbranch_vccz L_polled_19
v_mov_b32 v244, 0
buffer_atomic_add v244, v6, s[8:11], s35 offen sc0 sc1
s_waitcnt vmcnt(5)
v_cmp_gt_u32 vcc, 16, v246
s_nop 0
s_cbranch_vccz L_polled_19
v_mov_b32 v245, 0
buffer_atomic_add v245, v6, s[8:11], s35 offen sc0 sc1
L_poll_18:
s_add_u32 s31, s31, 1
s_cmp_gt_u32 s31, 100000
s_cbranch_scc1 L_polled_19
v_mov_b32 v246, 0
buffer_atomic_add v246, v6, s[8:11], s35 offen sc0 sc1
s_waitcnt vmcnt(3)
v_cmp_gt_u32 vcc, 16, v247
s_nop 0
s_cbranch_vccz L_polled_19
v_mov_b32 v247, 0
buffer_atomic_add v247, v6, s[8:11], s35 offen sc0 sc1
s_waitcnt vmcnt(3)
v_cmp_gt_u32 vcc, 16, v244
s_nop 0
s_cbranch_vccz L_polled_19
v_mov_b32 v244, 0
buffer_atomic_add v244, v6, s[8:11], s35 offen sc0 sc1
s_waitcnt vmcnt(3)
v_cmp_gt_u32 vcc, 16, v245
s_nop 0
s_cbranch_vccz L_polled_19
v_mov_b32 v245, 0
buffer_atomic_add v245, v6, s[8:11], s35 offen sc0 sc1
s_waitcnt vmcnt(3)
v_cmp_gt_u32 vcc, 16, v246
s_nop 0
s_cbranch_vccz L_polled_19
s_branch L_poll_18
L_polled_19:
s_mov_b64 exec, -1
L_other_20:
s_barrier
buffer_load_dwordx4 a[0:3], v1, s[8:11], s62 offen offset:0 sc1
buffer_load_dwordx4 a[4:7], v180, s[8:11], s62 offen offset:0 sc1
s_barrier
buffer_load_dwordx4 a[8:11], v1, s[8:11], s62 offen offset:1024 sc1
buffer_load_dwordx4 a[12:15], v180, s[8:11], s62 offen offset:1024 sc1
s_barrier
buffer_load_dwordx4 a[16:19], v1, s[8:11], s62 offen offset:2048 sc1
buffer_load_dwordx4 a[20:23], v180, s[8:11], s62 offen offset:2048 sc1
s_barrier
buffer_load_dwordx4 a[24:27], v1, s[8:11], s62 offen offset:3072 sc1
buffer_load_dwordx4 a[28:31], v180, s[8:11], s62 offen offset:3072 sc1
s_barrier
s_add_u32 s62, s62, 4096
buffer_load_dwordx4 a[32:35], v1, s[8:11], s62 offen offset:0 sc1
buffer_load_dwordx4 a[36:39], v180, s[8:11], s62 offen offset:0 sc1
s_barrier
buffer_load_dwordx4 a[40:43], v1, s[8:11], s62 offen offset:1024 sc1
buffer_load_dwordx4 a[44:47], v180, s[8:11], s62 offen offset:1024 sc1
s_lshl_b32 s53, s25, 2
s_add_u32 s53, s53, s24
s_mul_i32 s53, s53, 133120
s_add_u32 s53, s53, 10895360
s_lshl_b32 s52, s25, 12
s_add_u32 s52, s52, s53
v_lshrrev_b32 v239, 1, v1
v_and_b32 v6, 0xf8, v239
v_lshrrev_b32 v7, 1, v3
v_lshl_add_u32 v232, v7, 16, v6
s_lshl_b32 s63, s60, 8
s_add_u32 s63, s63, 7208960
v_add_u32 v208, 123904, v1
v_add_u32 v209, 0, v1
v_add_u32 v210, 37888, v1
v_add_u32 v211, 75776, v1
ds_read_b128 a[144:147], v208 offset:0
ds_read_b128 a[148:151], v208 offset:18432
ds_read_b128 a[152:155], v209 offset:0
ds_read_b128 a[156:159], v209 offset:18432
ds_read_b128 a[160:163], v208 offset:1024
ds_read_b128 a[164:167], v208 offset:19456
s_waitcnt vmcnt(10) lgkmcnt(4)
v_mfma_f32_16x16x32_bf16 v[36:39], a[144:147], a[0:3], 0
ds_read_b128 a[168:171], v209 offset:1024
ds_read_b128 a[172:175], v209 offset:19456
v_mfma_f32_16x16x32_bf16 v[40:43], a[144:147], a[4:7], 0
buffer_load_dwordx4 a[48:51], v1, s[8:11], s62 offen offset:2048 sc1
v_mfma_f32_16x16x32_bf16 v[44:47], a[148:151], a[0:3], 0
buffer_load_dwordx4 a[52:55], v180, s[8:11], s62 offen offset:2048 sc1
v_mfma_f32_16x16x32_bf16 v[48:51], a[148:151], a[4:7], 0
s_waitcnt lgkmcnt(4)
v_mfma_f32_16x16x32_bf16 v[52:55], a[152:155], a[0:3], 0
ds_read_b128 a[144:147], v208 offset:2048
ds_read_b128 a[148:151], v208 offset:20480
v_mfma_f32_16x16x32_bf16 v[56:59], a[152:155], a[4:7], 0
buffer_load_dwordx4 a[56:59], v1, s[8:11], s62 offen offset:3072 sc1
v_lshl_add_u32 v234, v7, 13, v6
v_mfma_f32_16x16x32_bf16 v[60:63], a[156:159], a[0:3], 0
v_add_u32 v235, 4096, v234
v_mfma_f32_16x16x32_bf16 v[64:67], a[156:159], a[4:7], 0
s_waitcnt vmcnt(11) lgkmcnt(4)
s_barrier
v_mfma_f32_16x16x32_bf16 v[36:39], a[160:163], a[8:11], v[36:39]
ds_read_b128 a[152:155], v209 offset:2048
ds_read_b128 a[156:159], v209 offset:20480
v_mfma_f32_16x16x32_bf16 v[40:43], a[160:163], a[12:15], v[40:43]
buffer_load_dwordx4 a[60:63], v180, s[8:11], s62 offen offset:3072 sc1
s_mul_i32 s30, s24, 9216
v_mfma_f32_16x16x32_bf16 v[44:47], a[164:167], a[8:11], v[44:47]
s_add_u32 s62, s62, 4096
v_mfma_f32_16x16x32_bf16 v[48:51], a[164:167], a[12:15], v[48:51]
s_waitcnt lgkmcnt(4)
s_add_u32 s30, s30, 0
v_mfma_f32_16x16x32_bf16 v[52:55], a[168:171], a[8:11], v[52:55]
ds_read_b128 a[160:163], v208 offset:3072
ds_read_b128 a[164:167], v208 offset:21504
v_mfma_f32_16x16x32_bf16 v[56:59], a[168:171], a[12:15], v[56:59]
buffer_load_dwordx4 a[64:67], v1, s[8:11], s62 offen offset:0 sc1
v_mul_u32_u24 v236, 288, v2
v_mfma_f32_16x16x32_bf16 v[60:63], a[172:175], a[8:11], v[60:63]
v_mfma_f32_16x16x32_bf16 v[64:67], a[172:175], a[12:15], v[64:67]
s_waitcnt lgkmcnt(4)
v_add_u32 v236, s30, v236
s_waitcnt vmcnt(11)
v_mfma_f32_16x16x32_bf16 v[36:39], a[144:147], a[16:19], v[36:39]
ds_read_b128 a[168:171], v209 offset:3072
ds_read_b128 a[172:175], v209 offset:21504
v_mfma_f32_16x16x32_bf16 v[40:43], a[144:147], a[20:23], v[40:43]
buffer_load_dwordx2 v[182:183], v232, s[8:11], s63 offen sc1
v_mfma_f32_16x16x32_bf16 v[44:47], a[148:151], a[16:19], v[44:47]
s_add_u32 s63, s63, 16384
v_lshl_add_u32 v7, v3, 3, v236
v_mfma_f32_16x16x32_bf16 v[48:51], a[148:151], a[20:23], v[48:51]
s_waitcnt lgkmcnt(4)
v_mfma_f32_16x16x32_bf16 v[52:55], a[152:155], a[16:19], v[52:55]
ds_read_b128 a[144:147], v208 offset:4096
ds_read_b128 a[148:151], v208 offset:22528
v_mfma_f32_16x16x32_bf16 v[56:59], a[152:155], a[20:23], v[56:59]
v_lshl_add_u32 v236, v3, 4, v236
v_mfma_f32_16x16x32_bf16 v[60:63], a[156:159], a[16:19], v[60:63]
buffer_load_dwordx2 v[184:185], v232, s[8:11], s63 offen sc1
v_lshrrev_b32 v8, 2, v2
v_mfma_f32_16x16x32_bf16 v[64:67], a[156:159], a[20:23], v[64:67]
s_waitcnt vmcnt(11) lgkmcnt(4)
v_mfma_f32_16x16x32_bf16 v[36:39], a[160:163], a[24:27], v[36:39]
ds_read_b128 a[152:155], v209 offset:4096
ds_read_b128 a[156:159], v209 offset:22528
v_mfma_f32_16x16x32_bf16 v[40:43], a[160:163], a[28:31], v[40:43]
s_add_u32 s63, s63, 16384
v_lshl_add_u32 v8, v3, 3, v8
v_mfma_f32_16x16x32_bf16 v[44:47], a[164:167], a[24:27], v[44:47]
v_mfma_f32_16x16x32_bf16 v[48:51], a[164:167], a[28:31], v[48:51]
s_waitcnt lgkmcnt(4)
v_mul_u32_u24 v237, 288, v8
v_mfma_f32_16x16x32_bf16 v[52:55], a[168:171], a[24:27], v[52:55]
ds_read_b128 a[160:163], v208 offset:5120
ds_read_b128 a[164:167], v208 offset:23552
v_mfma_f32_16x16x32_bf16 v[56:59], a[168:171], a[28:31], v[56:59]
buffer_load_dwordx2 v[186:187], v232, s[8:11], s63 offen sc1
v_add_u32 v237, s30, v237
v_mfma_f32_16x16x32_bf16 v[60:63], a[172:175], a[24:27], v[60:63]
s_add_u32 s63, s63, 16384
v_mfma_f32_16x16x32_bf16 v[64:67], a[172:175], a[28:31], v[64:67]
s_waitcnt vmcnt(10) lgkmcnt(4)
v_mfma_f32_16x16x32_bf16 v[36:39], a[144:147], a[32:35], v[36:39]
ds_read_b128 a[168:171], v209 offset:5120
ds_read_b128 a[172:175], v209 offset:23552
v_mfma_f32_16x16x32_bf16 v[40:43], a[144:147], a[36:39], v[40:43]
buffer_load_dwordx2 v[188:189], v232, s[8:11], s63 offen sc1
v_and_b32 v8, 3, v2
v_mfma_f32_16x16x32_bf16 v[44:47], a[148:151], a[32:35], v[44:47]
s_add_u32 s63, s63, 16384
v_lshl_add_u32 v238, v8, 3, v237
v_mfma_f32_16x16x32_bf16 v[48:51], a[148:151], a[36:39], v[48:51]
s_waitcnt lgkmcnt(4)
v_mfma_f32_16x16x32_bf16 v[52:55], a[152:155], a[32:35], v[52:55]
ds_read_b128 a[144:147], v208 offset:6144
ds_read_b128 a[148:151], v208 offset:24576
v_mfma_f32_16x16x32_bf16 v[56:59], a[152:155], a[36:39], v[56:59]
v_lshl_add_u32 v237, v8, 4, v237
v_mfma_f32_16x16x32_bf16 v[60:63], a[156:159], a[32:35], v[60:63]
buffer_load_dwordx4 a[68:71], v180, s[8:11], s62 offen offset:0 sc1
v_mfma_f32_16x16x32_bf16 v[64:67], a[156:159], a[36:39], v[64:67]
s_waitcnt lgkmcnt(4)
s_mul_i32 s66, s26, 589824
s_waitcnt vmcnt(10)
v_mfma_f32_16x16x32_bf16 v[36:39], a[160:163], a[40:43], v[36:39]
ds_read_b128 a[152:155], v209 offset:6144
ds_read_b128 a[156:159], v209 offset:24576
v_mfma_f32_16x16x32_bf16 v[40:43], a[160:163], a[44:47], v[40:43]
buffer_load_dwordx4 a[72:75], v1, s[8:11], s62 offen offset:1024 sc1
s_mul_i32 s31, s60, 9216
v_mfma_f32_16x16x32_bf16 v[44:47], a[164:167], a[40:43], v[44:47]
s_add_u32 s66, s66, s31
v_mfma_f32_16x16x32_bf16 v[48:51], a[164:167], a[44:47], v[48:51]
s_waitcnt lgkmcnt(4)
v_mfma_f32_16x16x32_bf16 v[52:55], a[168:171], a[40:43], v[52:55]
ds_read_b128 a[160:163], v208 offset:7168
ds_read_b128 a[164:167], v208 offset:25600
v_mfma_f32_16x16x32_bf16 v[56:59], a[168:171], a[44:47], v[56:59]
buffer_load_dwordx4 a[76:79], v180, s[8:11], s62 offen offset:1024 sc1
v_mfma_f32_16x16x32_bf16 v[60:63], a[172:175], a[40:43], v[60:63]
s_add_u32 s66, s66, 7340032
v_mfma_f32_16x16x32_bf16 v[64:67], a[172:175], a[44:47], v[64:67]
s_waitcnt vmcnt(10) lgkmcnt(4)
v_mfma_f32_16x16x32_bf16 v[36:39], a[144:147], a[48:51], v[36:39]
ds_read_b128 a[168:171], v209 offset:7168
ds_read_b128 a[172:175], v209 offset:25600
v_mfma_f32_16x16x32_bf16 v[40:43], a[144:147], a[52:55], v[40:43]
buffer_load_dwordx4 a[80:83], v1, s[8:11], s62 offen offset:2048 sc1
v_lshlrev_b32 v233, 7, v1
v_mfma_f32_16x16x32_bf16 v[44:47], a[148:151], a[48:51], v[44:47]
buffer_load_dwordx4 a[84:87], v180, s[8:11], s62 offen offset:2048 sc1
v_mfma_f32_16x16x32_bf16 v[48:51], a[148:151], a[52:55], v[48:51]
s_waitcnt lgkmcnt(4)
s_lshl_b32 s31, s26, 7
v_mfma_f32_16x16x32_bf16 v[52:55], a[152:155], a[48:51], v[52:55]
ds_read_b128 a[144:147], v208 offset:8192
ds_read_b128 a[148:151], v208 offset:26624
v_mfma_f32_16x16x32_bf16 v[56:59], a[152:155], a[52:55], v[56:59]
buffer_load_dwordx4 a[88:91], v1, s[8:11], s62 offen offset:3072 sc1
v_add_u32 v233, s31, v233
v_mfma_f32_16x16x32_bf16 v[60:63], a[156:159], a[48:51], v[60:63]
s_lshl_b32 s61, s25, 14
v_mfma_f32_16x16x32_bf16 v[64:67], a[156:159], a[52:55], v[64:67]
s_waitcnt vmcnt(11) lgkmcnt(4)
v_mfma_f32_16x16x32_bf16 v[36:39], a[160:163], a[56:59], v[36:39]
ds_read_b128 a[152:155], v209 offset:8192
ds_read_b128 a[156:159], v209 offset:26624
v_mfma_f32_16x16x32_bf16 v[40:43], a[160:163], a[60:63], v[40:43]
buffer_load_dwordx4 a[92:95], v180, s[8:11], s62 offen offset:3072 sc1
v_mfma_f32_16x16x32_bf16 v[44:47], a[164:167], a[56:59], v[44:47]
s_add_u32 s62, s62, 4096
s_lshl_b32 s30, s24, 8
v_mfma_f32_16x16x32_bf16 v[48:51], a[164:167], a[60:63], v[48:51]
s_waitcnt lgkmcnt(4)
v_mfma_f32_16x16x32_bf16 v[52:55], a[168:171], a[56:59], v[52:55]
ds_read_b128 a[160:163], v208 offset:9216
ds_read_b128 a[164:167], v208 offset:27648
v_mfma_f32_16x16x32_bf16 v[56:59], a[168:171], a[60:63], v[56:59]
buffer_load_dwordx4 a[96:99], v1, s[8:11], s62 offen offset:0 sc1
s_add_u32 s61, s61, s30
v_mfma_f32_16x16x32_bf16 v[60:63], a[172:175], a[56:59], v[60:63]
s_add_u32 s61, s61, 26214400
v_mfma_f32_16x16x32_bf16 v[64:67], a[172:175], a[60:63], v[64:67]
s_waitcnt vmcnt(7) lgkmcnt(4)
v_mfma_f32_16x16x32_bf16 v[36:39], a[144:147], a[64:67], v[36:39]
ds_read_b128 a[168:171], v209 offset:9216
ds_read_b128 a[172:175], v209 offset:27648
v_mfma_f32_16x16x32_bf16 v[40:43], a[144:147], a[68:71], v[40:43]
buffer_load_dwordx4 a[100:103], v180, s[8:11], s62 offen offset:0 sc1
s_mul_i32 s30, s24, 9216
v_mfma_f32_16x16x32_bf16 v[44:47], a[148:151], a[64:67], v[44:47]
buffer_load_dwordx4 a[104:107], v1, s[8:11], s62 offen offset:1024 sc1
v_mfma_f32_16x16x32_bf16 v[48:51], a[148:151], a[68:71], v[48:51]
s_waitcnt lgkmcnt(4)
s_add_u32 s30, s30, 0
v_mfma_f32_16x16x32_bf16 v[52:55], a[152:155], a[64:67], v[52:55]
ds_read_b128 a[144:147], v208 offset:10240
ds_read_b128 a[148:151], v208 offset:28672
v_mfma_f32_16x16x32_bf16 v[56:59], a[152:155], a[68:71], v[56:59]
buffer_load_dwordx4 a[108:111], v180, s[8:11], s62 offen offset:1024 sc1
v_add_u32 v240, s30, v1
v_mfma_f32_16x16x32_bf16 v[60:63], a[156:159], a[64:67], v[60:63]
s_lshl_b32 s30, s26, 10
v_mfma_f32_16x16x32_bf16 v[64:67], a[156:159], a[68:71], v[64:67]
s_waitcnt vmcnt(8) lgkmcnt(4)
v_mfma_f32_16x16x32_bf16 v[36:39], a[160:163], a[72:75], v[36:39]
ds_read_b128 a[152:155], v209 offset:10240
ds_read_b128 a[156:159], v209 offset:28672
v_mfma_f32_16x16x32_bf16 v[40:43], a[160:163], a[76:79], v[40:43]
buffer_load_dwordx4 a[112:115], v1, s[8:11], s62 offen offset:2048 sc1
v_mfma_f32_16x16x32_bf16 v[44:47], a[164:167], a[72:75], v[44:47]
buffer_load_dwordx4 a[116:119], v180, s[8:11], s62 offen offset:2048 sc1
s_add_u32 s30, s30, s61
v_mfma_f32_16x16x32_bf16 v[48:51], a[164:167], a[76:79], v[48:51]
s_waitcnt lgkmcnt(4)
v_mfma_f32_16x16x32_bf16 v[52:55], a[168:171], a[72:75], v[52:55]
ds_read_b128 a[160:163], v208 offset:11264
ds_read_b128 a[164:167], v208 offset:29696
v_mfma_f32_16x16x32_bf16 v[56:59], a[168:171], a[76:79], v[56:59]
buffer_load_dwordx4 a[120:123], v1, s[8:11], s62 offen offset:3072 sc1
v_mfma_f32_16x16x32_bf16 v[60:63], a[172:175], a[72:75], v[60:63]
v_mfma_f32_16x16x32_bf16 v[64:67], a[172:175], a[76:79], v[64:67]
s_waitcnt vmcnt(9) lgkmcnt(4)
v_mfma_f32_16x16x32_bf16 v[36:39], a[144:147], a[80:83], v[36:39]
ds_read_b128 a[168:171], v209 offset:11264
ds_read_b128 a[172:175], v209 offset:29696
v_mfma_f32_16x16x32_bf16 v[40:43], a[144:147], a[84:87], v[40:43]
buffer_load_dwordx4 a[124:127], v180, s[8:11], s62 offen offset:3072 sc1
v_mfma_f32_16x16x32_bf16 v[44:47], a[148:151], a[80:83], v[44:47]
s_add_u32 s62, s62, 4096
v_add_f32 v198, v182, v184
v_add_f32 v199, v183, v185
v_mfma_f32_16x16x32_bf16 v[48:51], a[148:151], a[84:87], v[48:51]
s_waitcnt lgkmcnt(4)
v_add_f32 v198, v198, v186
v_mfma_f32_16x16x32_bf16 v[52:55], a[152:155], a[80:83], v[52:55]
ds_read_b128 a[144:147], v208 offset:12288
ds_read_b128 a[148:151], v208 offset:30720
v_mfma_f32_16x16x32_bf16 v[56:59], a[152:155], a[84:87], v[56:59]
buffer_load_dwordx4 a[128:131], v1, s[8:11], s62 offen offset:0 sc1
v_add_f32 v199, v199, v187
v_mfma_f32_16x16x32_bf16 v[60:63], a[156:159], a[80:83], v[60:63]
v_add_f32 v198, v198, v188
v_mfma_f32_16x16x32_bf16 v[64:67], a[156:159], a[84:87], v[64:67]
s_waitcnt lgkmcnt(4)
v_add_f32 v199, v199, v189
s_waitcnt vmcnt(9)
v_mfma_f32_16x16x32_bf16 v[36:39], a[160:163], a[88:91], v[36:39]
ds_read_b128 a[152:155], v209 offset:12288
ds_read_b128 a[156:159], v209 offset:30720
v_mfma_f32_16x16x32_bf16 v[40:43], a[160:163], a[92:95], v[40:43]
buffer_load_dwordx4 a[132:135], v180, s[8:11], s62 offen offset:0 sc1
v_mov_b32 v200, v198
v_mfma_f32_16x16x32_bf16 v[44:47], a[164:167], a[88:91], v[44:47]
v_mov_b32 v201, v199
v_mfma_f32_16x16x32_bf16 v[48:51], a[164:167], a[92:95], v[48:51]
s_waitcnt lgkmcnt(4)
s_nop 0
v_mfma_f32_16x16x32_bf16 v[52:55], a[168:171], a[88:91], v[52:55]
ds_read_b128 a[160:163], v208 offset:13312
ds_read_b128 a[164:167], v208 offset:31744
v_mfma_f32_16x16x32_bf16 v[56:59], a[168:171], a[92:95], v[56:59]
buffer_load_dwordx4 a[136:139], v1, s[8:11], s62 offen offset:1024 sc1
v_mfma_f32_16x16x32_bf16 v[60:63], a[172:175], a[88:91], v[60:63]
buffer_load_dwordx4 a[140:143], v180, s[8:11], s62 offen offset:1024 sc1
v_mfma_f32_16x16x32_bf16 v[64:67], a[172:175], a[92:95], v[64:67]
s_waitcnt vmcnt(10) lgkmcnt(4)
v_mfma_f32_16x16x32_bf16 v[36:39], a[144:147], a[96:99], v[36:39]
ds_read_b128 a[168:171], v209 offset:13312
ds_read_b128 a[172:175], v209 offset:31744
v_mfma_f32_16x16x32_bf16 v[40:43], a[144:147], a[100:103], v[40:43]
v_permlane32_swap_b32 v198, v200
v_mfma_f32_16x16x32_bf16 v[44:47], a[148:151], a[96:99], v[44:47]
v_permlane32_swap_b32 v199, v201
v_mfma_f32_16x16x32_bf16 v[48:51], a[148:151], a[100:103], v[48:51]
s_waitcnt lgkmcnt(4)
v_add_f32 v198, v198, v200
v_add_f32 v199, v199, v201
v_mfma_f32_16x16x32_bf16 v[52:55], a[152:155], a[96:99], v[52:55]
ds_read_b128 a[144:147], v208 offset:14336
ds_read_b128 a[148:151], v208 offset:32768
v_mfma_f32_16x16x32_bf16 v[56:59], a[152:155], a[100:103], v[56:59]
v_mul_f32 v198, 0x3ae38e39, v198
v_mul_f32 v200, v198, v198
v_mfma_f32_16x16x32_bf16 v[60:63], a[156:159], a[96:99], v[60:63]
v_mul_f32 v199, 0x3ae38e39, v199
v_mfma_f32_16x16x32_bf16 v[64:67], a[156:159], a[100:103], v[64:67]
s_waitcnt vmcnt(8) lgkmcnt(4)
v_mfma_f32_16x16x32_bf16 v[36:39], a[160:163], a[104:107], v[36:39]
ds_read_b128 a[152:155], v209 offset:14336
ds_read_b128 a[156:159], v209 offset:32768
v_mfma_f32_16x16x32_bf16 v[40:43], a[160:163], a[108:111], v[40:43]
v_sub_f32 v199, v199, v200
v_max_f32 v199, 0, v199
v_mfma_f32_16x16x32_bf16 v[44:47], a[164:167], a[104:107], v[44:47]
v_add_f32 v199, 0x3727c5ac, v199
v_mfma_f32_16x16x32_bf16 v[48:51], a[164:167], a[108:111], v[48:51]
s_waitcnt lgkmcnt(4)
v_rsq_f32 v250, v199
v_mfma_f32_16x16x32_bf16 v[52:55], a[168:171], a[104:107], v[52:55]
ds_read_b128 a[160:163], v208 offset:15360
ds_read_b128 a[164:167], v208 offset:33792
v_mfma_f32_16x16x32_bf16 v[56:59], a[168:171], a[108:111], v[56:59]
v_mfma_f32_16x16x32_bf16 v[60:63], a[172:175], a[104:107], v[60:63]
v_sqrt_f32 v254, v199
v_mfma_f32_16x16x32_bf16 v[64:67], a[172:175], a[108:111], v[64:67]
s_waitcnt vmcnt(6) lgkmcnt(4)
v_mfma_f32_16x16x32_bf16 v[36:39], a[144:147], a[112:115], v[36:39]
ds_read_b128 a[168:171], v209 offset:15360
ds_read_b128 a[172:175], v209 offset:33792
v_mfma_f32_16x16x32_bf16 v[40:43], a[144:147], a[116:119], v[40:43]
v_cvt_pk_bf16_f32 v200, -v198, -v198
v_mfma_f32_16x16x32_bf16 v[44:47], a[148:151], a[112:115], v[44:47]
v_and_b32 v200, 0xffff0000, v200
v_mfma_f32_16x16x32_bf16 v[48:51], a[148:151], a[116:119], v[48:51]
s_waitcnt lgkmcnt(4)
v_add_f32 v200, v198, v200
v_mfma_f32_16x16x32_bf16 v[52:55], a[152:155], a[112:115], v[52:55]
ds_read_b128 a[144:147], v208 offset:16384
ds_read_b128 a[148:151], v208 offset:34816
v_mfma_f32_16x16x32_bf16 v[56:59], a[152:155], a[116:119], v[56:59]
v_cvt_pk_bf16_f32 v212, -v198, -v200
v_mfma_f32_16x16x32_bf16 v[60:63], a[156:159], a[112:115], v[60:63]
v_mul_f32 v252, v250, v250
v_mfma_f32_16x16x32_bf16 v[64:67], a[156:159], a[116:119], v[64:67]
s_waitcnt lgkmcnt(4)
v_mul_f32 v252, v252, v250
s_waitcnt vmcnt(4)
v_mfma_f32_16x16x32_bf16 v[36:39], a[160:163], a[120:123], v[36:39]
ds_read_b128 a[152:155], v209 offset:16384
ds_read_b128 a[156:159], v209 offset:34816
v_mfma_f32_16x16x32_bf16 v[40:43], a[160:163], a[124:127], v[40:43]
v_mul_f32 v252, 0xbdd2d3e8, v252
v_mul_f32 v250, 0xc0135761, v250
v_mfma_f32_16x16x32_bf16 v[44:47], a[164:167], a[120:123], v[44:47]
v_mfma_f32_16x16x32_bf16 v[48:51], a[164:167], a[124:127], v[48:51]
s_waitcnt lgkmcnt(4)
v_mov_b32 v214, v212
v_mfma_f32_16x16x32_bf16 v[52:55], a[168:171], a[120:123], v[52:55]
ds_read_b128 a[160:163], v208 offset:17408
ds_read_b128 a[164:167], v208 offset:35840
v_mfma_f32_16x16x32_bf16 v[56:59], a[168:171], a[124:127], v[56:59]
v_mov_b32 v255, v254
v_mov_b32 v253, v252
v_mfma_f32_16x16x32_bf16 v[60:63], a[172:175], a[120:123], v[60:63]
v_mfma_f32_16x16x32_bf16 v[64:67], a[172:175], a[124:127], v[64:67]
s_waitcnt lgkmcnt(4)
v_mov_b32 v251, v250
s_waitcnt vmcnt(2)
v_mfma_f32_16x16x32_bf16 v[36:39], a[144:147], a[128:131], v[36:39]
ds_read_b128 a[168:171], v209 offset:17408
ds_read_b128 a[172:175], v209 offset:35840
v_mfma_f32_16x16x32_bf16 v[40:43], a[144:147], a[132:135], v[40:43]
v_permlane16_swap_b32 v212, v214
v_mfma_f32_16x16x32_bf16 v[44:47], a[148:151], a[128:131], v[44:47]
v_permlane16_swap_b32 v254, v255
v_mfma_f32_16x16x32_bf16 v[48:51], a[148:151], a[132:135], v[48:51]
s_waitcnt lgkmcnt(4)
v_add_u32 v181, 160768, v239
v_mfma_f32_16x16x32_bf16 v[52:55], a[152:155], a[128:131], v[52:55]
ds_read_b64 a[144:145], v181 offset:0
ds_read_b64 a[148:149], v181 offset:512
v_mfma_f32_16x16x32_bf16 v[56:59], a[152:155], a[132:135], v[56:59]
v_permlane16_swap_b32 v252, v253
v_mfma_f32_16x16x32_bf16 v[60:63], a[156:159], a[128:131], v[60:63]
v_mfma_f32_16x16x32_bf16 v[64:67], a[156:159], a[132:135], v[64:67]
s_waitcnt vmcnt(0) lgkmcnt(4)
v_add_u32 v181, 36864, v239
v_mfma_f32_16x16x32_bf16 v[36:39], a[160:163], a[136:139], v[36:39]
ds_read_b64 a[152:153], v181 offset:0
ds_read_b64 a[156:157], v181 offset:512
v_mfma_f32_16x16x32_bf16 v[40:43], a[160:163], a[140:143], v[40:43]
v_permlane16_swap_b32 v250, v251
v_mfma_f32_16x16x32_bf16 v[44:47], a[164:167], a[136:139], v[44:47]
v_mov_b32 v213, v212
v_mfma_f32_16x16x32_bf16 v[48:51], a[164:167], a[140:143], v[48:51]
s_waitcnt lgkmcnt(4)
v_mov_b32 v215, v214
v_mfma_f32_16x16x32_bf16 v[52:55], a[168:171], a[136:139], v[52:55]
ds_read_b128 a[160:163], v210 offset:0
ds_read_b128 a[164:167], v210 offset:18432
v_mfma_f32_16x16x32_bf16 v[56:59], a[168:171], a[140:143], v[56:59]
v_mfma_f32_16x16x32_bf16 v[60:63], a[172:175], a[136:139], v[60:63]
v_mfma_f32_16x16x32_bf16 v[64:67], a[172:175], a[140:143], v[64:67]
s_waitcnt lgkmcnt(4)
v_mfma_f32_16x16x16_bf16 v[36:39], a[144:145], v[212:213], v[36:39]
ds_read_b128 a[168:171], v210 offset:1024
ds_read_b128 a[172:175], v210 offset:19456
v_mfma_f32_16x16x16_bf16 v[40:43], a[144:145], v[214:215], v[40:43]
v_mfma_f32_16x16x16_bf16 v[44:47], a[148:149], v[212:213], v[44:47]
v_mfma_f32_16x16x16_bf16 v[48:51], a[148:149], v[214:215], v[48:51]
s_waitcnt lgkmcnt(4)
v_mfma_f32_16x16x16_bf16 v[52:55], a[152:153], v[212:213], v[52:55]
ds_read_b128 a[144:147], v210 offset:2048
ds_read_b128 a[148:151], v210 offset:20480
v_mfma_f32_16x16x16_bf16 v[56:59], a[152:153], v[214:215], v[56:59]
v_mfma_f32_16x16x16_bf16 v[60:63], a[156:157], v[212:213], v[60:63]
v_mfma_f32_16x16x16_bf16 v[64:67], a[156:157], v[214:215], v[64:67]
s_waitcnt lgkmcnt(4)
s_barrier
v_mfma_f32_16x16x32_bf16 v[68:71], a[160:163], a[0:3], 0
ds_read_b128 a[152:155], v210 offset:3072
ds_read_b128 a[156:159], v210 offset:21504
v_mfma_f32_16x16x32_bf16 v[72:75], a[160:163], a[4:7], 0
s_mul_i32 s38, s24, 9216
s_add_u32 m0, s38, 123904
v_mfma_f32_16x16x32_bf16 v[76:79], a[164:167], a[0:3], 0
s_add_u32 s39, s38, s82
v_mfma_f32_16x16x32_bf16 v[80:83], a[164:167], a[4:7], 0
s_waitcnt lgkmcnt(4)
v_mfma_f32_16x16x32_bf16 v[68:71], a[168:171], a[8:11], v[68:71]
ds_read_b128 a[160:163], v210 offset:4096
ds_read_b128 a[164:167], v210 offset:22528
v_mfma_f32_16x16x32_bf16 v[72:75], a[168:171], a[12:15], v[72:75]
s_add_u32 s39, s39, 151552
v_mfma_f32_16x16x32_bf16 v[76:79], a[172:175], a[8:11], v[76:79]
buffer_load_dwordx4 v1, s[4:7], s39 offen offset:0 sc1 lds
buffer_load_dwordx4 v1, s[4:7], s39 offen offset:1024 sc1 lds
v_pk_mul_f32 v[216:217], v[36:37], v[36:37]
v_pk_mul_f32 v[218:219], v[38:39], v[38:39]
v_pk_mul_f32 v[220:221], v[40:41], v[40:41]
v_pk_mul_f32 v[222:223], v[42:43], v[42:43]
v_pk_fma_f32 v[216:217], v[216:217], v[252:253], v[250:251] op_sel:[0,0,0] op_sel_hi:[1,0,0]
v_pk_fma_f32 v[218:219], v[218:219], v[252:253], v[250:251] op_sel:[0,0,0] op_sel_hi:[1,0,0]
v_pk_fma_f32 v[220:221], v[220:221], v[252:253], v[250:251] op_sel:[0,1,1] op_sel_hi:[1,1,1]
v_pk_fma_f32 v[222:223], v[222:223], v[252:253], v[250:251] op_sel:[0,1,1] op_sel_hi:[1,1,1]
v_pk_mul_f32 v[216:217], v[216:217], v[36:37]
v_pk_mul_f32 v[218:219], v[218:219], v[38:39]
v_pk_mul_f32 v[220:221], v[220:221], v[40:41]
v_pk_mul_f32 v[222:223], v[222:223], v[42:43]
v_mfma_f32_16x16x32_bf16 v[80:83], a[172:175], a[12:15], v[80:83]
s_waitcnt lgkmcnt(4)
v_exp_f32 v216, v216
v_mfma_f32_16x16x32_bf16 v[68:71], a[144:147], a[16:19], v[68:71]
ds_read_b128 a[168:171], v210 offset:5120
ds_read_b128 a[172:175], v210 offset:23552
v_mfma_f32_16x16x32_bf16 v[72:75], a[144:147], a[20:23], v[72:75]
v_exp_f32 v217, v217
v_mfma_f32_16x16x32_bf16 v[76:79], a[148:151], a[16:19], v[76:79]
buffer_load_dwordx4 v1, s[4:7], s39 offen offset:2048 sc1 lds
buffer_load_dwordx4 v1, s[4:7], s39 offen offset:3072 sc1 lds
v_mfma_f32_16x16x32_bf16 v[80:83], a[148:151], a[20:23], v[80:83]
s_waitcnt lgkmcnt(4)
v_exp_f32 v218, v218
v_mfma_f32_16x16x32_bf16 v[68:71], a[152:155], a[24:27], v[68:71]
ds_read_b128 a[144:147], v210 offset:6144
ds_read_b128 a[148:151], v210 offset:24576
v_mfma_f32_16x16x32_bf16 v[72:75], a[152:155], a[28:31], v[72:75]
s_add_u32 m0, m0, 4096
v_fma_f32 v216, v216, v254, v254
v_fma_f32 v217, v217, v254, v254
v_mfma_f32_16x16x32_bf16 v[76:79], a[156:159], a[24:27], v[76:79]
s_add_u32 s39, s39, 4096
v_exp_f32 v219, v219
v_mfma_f32_16x16x32_bf16 v[80:83], a[156:159], a[28:31], v[80:83]
s_waitcnt lgkmcnt(4)
v_exp_f32 v220, v220
v_mfma_f32_16x16x32_bf16 v[68:71], a[160:163], a[32:35], v[68:71]
ds_read_b128 a[152:155], v210 offset:7168
ds_read_b128 a[156:159], v210 offset:25600
v_mfma_f32_16x16x32_bf16 v[72:75], a[160:163], a[36:39], v[72:75]
buffer_load_dwordx4 v1, s[4:7], s39 offen offset:0 sc1 lds
buffer_load_dwordx4 v1, s[4:7], s39 offen offset:1024 sc1 lds
v_mfma_f32_16x16x32_bf16 v[76:79], a[164:167], a[32:35], v[76:79]
v_fma_f32 v218, v218, v254, v254
v_fma_f32 v219, v219, v254, v254
v_mfma_f32_16x16x32_bf16 v[80:83], a[164:167], a[36:39], v[80:83]
s_waitcnt lgkmcnt(4)
v_exp_f32 v221, v221
v_mfma_f32_16x16x32_bf16 v[68:71], a[168:171], a[40:43], v[68:71]
ds_read_b128 a[160:163], v210 offset:8192
ds_read_b128 a[164:167], v210 offset:26624
v_exp_f32 v222, v222
v_mfma_f32_16x16x32_bf16 v[72:75], a[168:171], a[44:47], v[72:75]
buffer_load_dwordx4 v1, s[4:7], s39 offen offset:2048 sc1 lds
buffer_load_dwordx4 v1, s[4:7], s39 offen offset:3072 sc1 lds
v_mfma_f32_16x16x32_bf16 v[76:79], a[172:175], a[40:43], v[76:79]
s_add_u32 m0, m0, 4096
v_fma_f32 v220, v220, v255, v255
v_fma_f32 v221, v221, v255, v255
v_mfma_f32_16x16x32_bf16 v[80:83], a[172:175], a[44:47], v[80:83]
s_waitcnt lgkmcnt(4)
v_exp_f32 v223, v223
v_mfma_f32_16x16x32_bf16 v[68:71], a[144:147], a[48:51], v[68:71]
ds_read_b128 a[168:171], v210 offset:9216
ds_read_b128 a[172:175], v210 offset:27648
v_rcp_f32 v216, v216
v_mfma_f32_16x16x32_bf16 v[72:75], a[144:147], a[52:55], v[72:75]
s_add_u32 s39, s39, 4096
v_fma_f32 v222, v222, v255, v255
v_fma_f32 v223, v223, v255, v255
v_mfma_f32_16x16x32_bf16 v[76:79], a[148:151], a[48:51], v[76:79]
buffer_load_dwordx4 v1, s[4:7], s39 offen offset:0 sc1 lds
v_mfma_f32_16x16x32_bf16 v[80:83], a[148:151], a[52:55], v[80:83]
s_waitcnt lgkmcnt(4)
v_rcp_f32 v217, v217
v_mfma_f32_16x16x32_bf16 v[68:71], a[152:155], a[56:59], v[68:71]
ds_read_b128 a[144:147], v210 offset:10240
ds_read_b128 a[148:151], v210 offset:28672
v_rcp_f32 v218, v218
v_mfma_f32_16x16x32_bf16 v[72:75], a[152:155], a[60:63], v[72:75]
s_lshl_b32 s38, s24, 8
v_rcp_f32 v219, v219
v_mfma_f32_16x16x32_bf16 v[76:79], a[156:159], a[56:59], v[76:79]
buffer_store_dwordx4 a[224:227], v1, s[4:7], s101 offen offset:0 sc1
s_add_u32 m0, s38, 160768
v_mfma_f32_16x16x32_bf16 v[80:83], a[156:159], a[60:63], v[80:83]
s_waitcnt lgkmcnt(4)
s_add_u32 s39, s38, s82
v_rcp_f32 v220, v220
v_mfma_f32_16x16x32_bf16 v[68:71], a[160:163], a[64:67], v[68:71]
ds_read_b128 a[152:155], v210 offset:11264
ds_read_b128 a[156:159], v210 offset:29696
v_mfma_f32_16x16x32_bf16 v[72:75], a[160:163], a[68:71], v[72:75]
s_add_u32 s39, s39, 188416
v_rcp_f32 v221, v221
v_mfma_f32_16x16x32_bf16 v[76:79], a[164:167], a[64:67], v[76:79]
v_rcp_f32 v222, v222
v_mfma_f32_16x16x32_bf16 v[80:83], a[164:167], a[68:71], v[80:83]
s_waitcnt lgkmcnt(4)
v_rcp_f32 v223, v223
v_mfma_f32_16x16x32_bf16 v[68:71], a[168:171], a[72:75], v[68:71]
ds_read_b128 a[160:163], v210 offset:12288
ds_read_b128 a[164:167], v210 offset:30720
v_pk_mul_f32 v[224:225], v[44:45], v[44:45]
v_pk_mul_f32 v[226:227], v[46:47], v[46:47]
v_pk_mul_f32 v[228:229], v[48:49], v[48:49]
v_pk_mul_f32 v[230:231], v[50:51], v[50:51]
v_pk_fma_f32 v[224:225], v[224:225], v[252:253], v[250:251] op_sel:[0,0,0] op_sel_hi:[1,0,0]
v_pk_fma_f32 v[226:227], v[226:227], v[252:253], v[250:251] op_sel:[0,0,0] op_sel_hi:[1,0,0]
v_pk_fma_f32 v[228:229], v[228:229], v[252:253], v[250:251] op_sel:[0,1,1] op_sel_hi:[1,1,1]
v_pk_fma_f32 v[230:231], v[230:231], v[252:253], v[250:251] op_sel:[0,1,1] op_sel_hi:[1,1,1]
v_pk_mul_f32 v[36:37], v[36:37], v[216:217]
v_pk_mul_f32 v[38:39], v[38:39], v[218:219]
v_pk_mul_f32 v[40:41], v[40:41], v[220:221]
v_pk_mul_f32 v[42:43], v[42:43], v[222:223]
v_pk_mul_f32 v[224:225], v[224:225], v[44:45]
v_pk_mul_f32 v[226:227], v[226:227], v[46:47]
v_pk_mul_f32 v[228:229], v[228:229], v[48:49]
v_pk_mul_f32 v[230:231], v[230:231], v[50:51]
v_mfma_f32_16x16x32_bf16 v[72:75], a[168:171], a[76:79], v[72:75]
s_mov_b64 exec, 0xffff
buffer_load_dwordx4 v1, s[4:7], s39 offen sc1 lds
s_mov_b64 exec, -1
v_exp_f32 v224, v224
v_mfma_f32_16x16x32_bf16 v[76:79], a[172:175], a[72:75], v[76:79]
v_exp_f32 v225, v225
v_mfma_f32_16x16x32_bf16 v[80:83], a[172:175], a[76:79], v[80:83]
s_waitcnt lgkmcnt(4)
v_exp_f32 v226, v226
v_mfma_f32_16x16x32_bf16 v[68:71], a[144:147], a[80:83], v[68:71]
ds_read_b128 a[168:171], v210 offset:13312
ds_read_b128 a[172:175], v210 offset:31744
v_mfma_f32_16x16x32_bf16 v[72:75], a[144:147], a[84:87], v[72:75]
s_mul_i32 s38, s24, 9216
v_fma_f32 v224, v224, v254, v254
v_fma_f32 v225, v225, v254, v254
v_mfma_f32_16x16x32_bf16 v[76:79], a[148:151], a[80:83], v[76:79]
s_add_u32 m0, s38, 0
v_exp_f32 v227, v227
v_mfma_f32_16x16x32_bf16 v[80:83], a[148:151], a[84:87], v[80:83]
s_waitcnt lgkmcnt(4)
v_exp_f32 v228, v228
v_mfma_f32_16x16x32_bf16 v[68:71], a[152:155], a[88:91], v[68:71]
ds_read_b128 a[144:147], v210 offset:14336
ds_read_b128 a[148:151], v210 offset:32768
v_mfma_f32_16x16x32_bf16 v[72:75], a[152:155], a[92:95], v[72:75]
s_add_u32 s39, s38, s82
v_fma_f32 v226, v226, v254, v254
v_fma_f32 v227, v227, v254, v254
v_mfma_f32_16x16x32_bf16 v[76:79], a[156:159], a[88:91], v[76:79]
s_add_u32 s39, s39, 189440
v_exp_f32 v229, v229
v_mfma_f32_16x16x32_bf16 v[80:83], a[156:159], a[92:95], v[80:83]
s_waitcnt lgkmcnt(4)
v_exp_f32 v230, v230
v_mfma_f32_16x16x32_bf16 v[68:71], a[160:163], a[96:99], v[68:71]
ds_read_b128 a[152:155], v210 offset:15360
ds_read_b128 a[156:159], v210 offset:33792
v_mfma_f32_16x16x32_bf16 v[72:75], a[160:163], a[100:103], v[72:75]
buffer_store_dwordx4 a[228:231], v1, s[4:7], s101 offen offset:1024 sc1
v_fma_f32 v228, v228, v255, v255
v_fma_f32 v229, v229, v255, v255
v_mfma_f32_16x16x32_bf16 v[76:79], a[164:167], a[96:99], v[76:79]
buffer_load_dwordx4 v1, s[4:7], s39 offen offset:0 sc1 lds
buffer_load_dwordx4 v1, s[4:7], s39 offen offset:1024 sc1 lds
v_exp_f32 v231, v231
v_mfma_f32_16x16x32_bf16 v[80:83], a[164:167], a[100:103], v[80:83]
s_waitcnt lgkmcnt(4)
v_rcp_f32 v224, v224
v_mfma_f32_16x16x32_bf16 v[68:71], a[168:171], a[104:107], v[68:71]
ds_read_b128 a[160:163], v210 offset:16384
ds_read_b128 a[164:167], v210 offset:34816
v_mfma_f32_16x16x32_bf16 v[72:75], a[168:171], a[108:111], v[72:75]
v_fma_f32 v230, v230, v255, v255
v_fma_f32 v231, v231, v255, v255
v_mfma_f32_16x16x32_bf16 v[76:79], a[172:175], a[104:107], v[76:79]
v_rcp_f32 v225, v225
v_mfma_f32_16x16x32_bf16 v[80:83], a[172:175], a[108:111], v[80:83]
s_waitcnt lgkmcnt(4)
v_rcp_f32 v226, v226
v_mfma_f32_16x16x32_bf16 v[68:71], a[144:147], a[112:115], v[68:71]
ds_read_b128 a[168:171], v210 offset:17408
ds_read_b128 a[172:175], v210 offset:35840
v_mfma_f32_16x16x32_bf16 v[72:75], a[144:147], a[116:119], v[72:75]
buffer_load_dwordx4 v1, s[4:7], s39 offen offset:2048 sc1 lds
buffer_load_dwordx4 v1, s[4:7], s39 offen offset:3072 sc1 lds
v_rcp_f32 v227, v227
v_mfma_f32_16x16x32_bf16 v[76:79], a[148:151], a[112:115], v[76:79]
s_add_u32 m0, m0, 4096
v_rcp_f32 v228, v228
v_mfma_f32_16x16x32_bf16 v[80:83], a[148:151], a[116:119], v[80:83]
s_waitcnt lgkmcnt(4)
v_add_u32 v181, 74752, v239
v_mfma_f32_16x16x32_bf16 v[68:71], a[152:155], a[120:123], v[68:71]
ds_read_b64 a[144:145], v181 offset:0
ds_read_b64 a[148:149], v181 offset:512
v_rcp_f32 v229, v229
v_mfma_f32_16x16x32_bf16 v[72:75], a[152:155], a[124:127], v[72:75]
s_add_u32 s39, s39, 4096
v_rcp_f32 v230, v230
v_mfma_f32_16x16x32_bf16 v[76:79], a[156:159], a[120:123], v[76:79]
v_rcp_f32 v231, v231
v_mfma_f32_16x16x32_bf16 v[80:83], a[156:159], a[124:127], v[80:83]
s_waitcnt lgkmcnt(4)
v_pk_mul_f32 v[216:217], v[52:53], v[52:53]
v_pk_mul_f32 v[218:219], v[54:55], v[54:55]
v_pk_mul_f32 v[220:221], v[56:57], v[56:57]
v_pk_mul_f32 v[222:223], v[58:59], v[58:59]
v_pk_fma_f32 v[216:217], v[216:217], v[252:253], v[250:251] op_sel:[0,0,0] op_sel_hi:[1,0,0]
v_pk_fma_f32 v[218:219], v[218:219], v[252:253], v[250:251] op_sel:[0,0,0] op_sel_hi:[1,0,0]
v_pk_fma_f32 v[220:221], v[220:221], v[252:253], v[250:251] op_sel:[0,1,1] op_sel_hi:[1,1,1]
v_pk_fma_f32 v[222:223], v[222:223], v[252:253], v[250:251] op_sel:[0,1,1] op_sel_hi:[1,1,1]
v_pk_mul_f32 v[44:45], v[44:45], v[224:225]
v_pk_mul_f32 v[46:47], v[46:47], v[226:227]
v_pk_mul_f32 v[48:49], v[48:49], v[228:229]
v_pk_mul_f32 v[50:51], v[50:51], v[230:231]
v_pk_mul_f32 v[216:217], v[216:217], v[52:53]
v_pk_mul_f32 v[218:219], v[218:219], v[54:55]
v_pk_mul_f32 v[220:221], v[220:221], v[56:57]
v_pk_mul_f32 v[222:223], v[222:223], v[58:59]
v_mfma_f32_16x16x32_bf16 v[68:71], a[160:163], a[128:131], v[68:71]
ds_read_b128 a[152:155], v211 offset:0
ds_read_b128 a[156:159], v211 offset:18432
v_exp_f32 v216, v216
v_mfma_f32_16x16x32_bf16 v[72:75], a[160:163], a[132:135], v[72:75]
buffer_load_dwordx4 v1, s[4:7], s39 offen offset:0 sc1 lds
buffer_load_dwordx4 v1, s[4:7], s39 offen offset:1024 sc1 lds
v_exp_f32 v217, v217
v_mfma_f32_16x16x32_bf16 v[76:79], a[164:167], a[128:131], v[76:79]
buffer_store_dwordx4 a[232:235], v1, s[4:7], s101 offen offset:2048 sc1
v_exp_f32 v218, v218
v_mfma_f32_16x16x32_bf16 v[80:83], a[164:167], a[132:135], v[80:83]
s_waitcnt lgkmcnt(4)
v_fma_f32 v216, v216, v254, v254
v_fma_f32 v217, v217, v254, v254
v_mfma_f32_16x16x32_bf16 v[68:71], a[168:171], a[136:139], v[68:71]
ds_read_b128 a[160:163], v211 offset:1024
ds_read_b128 a[164:167], v211 offset:19456
v_mfma_f32_16x16x32_bf16 v[72:75], a[168:171], a[140:143], v[72:75]
v_exp_f32 v219, v219
v_mfma_f32_16x16x32_bf16 v[76:79], a[172:175], a[136:139], v[76:79]
v_exp_f32 v220, v220
v_mfma_f32_16x16x32_bf16 v[80:83], a[172:175], a[140:143], v[80:83]
s_waitcnt lgkmcnt(4)
v_fma_f32 v218, v218, v254, v254
v_fma_f32 v219, v219, v254, v254
v_mfma_f32_16x16x16_bf16 v[68:71], a[144:145], v[212:213], v[68:71]
ds_read_b128 a[168:171], v211 offset:2048
ds_read_b128 a[172:175], v211 offset:20480
v_mfma_f32_16x16x16_bf16 v[72:75], a[144:145], v[214:215], v[72:75]
buffer_load_dwordx4 v1, s[4:7], s39 offen offset:2048 sc1 lds
buffer_load_dwordx4 v1, s[4:7], s39 offen offset:3072 sc1 lds
v_exp_f32 v221, v221
v_mfma_f32_16x16x16_bf16 v[76:79], a[148:149], v[212:213], v[76:79]
s_add_u32 m0, m0, 4096
v_exp_f32 v222, v222
v_mfma_f32_16x16x16_bf16 v[80:83], a[148:149], v[214:215], v[80:83]
s_waitcnt vmcnt(10) lgkmcnt(4)
s_barrier
v_mfma_f32_16x16x32_bf16 v[84:87], a[152:155], a[0:3], 0
ds_read_b128 a[144:147], v211 offset:3072
ds_read_b128 a[148:151], v211 offset:21504
v_fma_f32 v220, v220, v255, v255
v_fma_f32 v221, v221, v255, v255
v_mfma_f32_16x16x32_bf16 v[88:91], a[152:155], a[4:7], 0
s_add_u32 s39, s39, 4096
v_exp_f32 v223, v223
v_mfma_f32_16x16x32_bf16 v[92:95], a[156:159], a[0:3], 0
v_rcp_f32 v216, v216
v_mfma_f32_16x16x32_bf16 v[96:99], a[156:159], a[4:7], 0
s_waitcnt lgkmcnt(4)
v_fma_f32 v222, v222, v255, v255
v_fma_f32 v223, v223, v255, v255
v_mfma_f32_16x16x32_bf16 v[84:87], a[160:163], a[8:11], v[84:87]
ds_read_b128 a[152:155], v211 offset:4096
ds_read_b128 a[156:159], v211 offset:22528
v_mfma_f32_16x16x32_bf16 v[88:91], a[160:163], a[12:15], v[88:91]
buffer_load_dwordx4 v1, s[4:7], s39 offen offset:0 sc1 lds
v_rcp_f32 v217, v217
v_mfma_f32_16x16x32_bf16 v[92:95], a[164:167], a[8:11], v[92:95]
s_lshl_b32 s38, s24, 8
v_rcp_f32 v218, v218
v_mfma_f32_16x16x32_bf16 v[96:99], a[164:167], a[12:15], v[96:99]
s_waitcnt lgkmcnt(4)
v_rcp_f32 v219, v219
v_mfma_f32_16x16x32_bf16 v[84:87], a[168:171], a[16:19], v[84:87]
ds_read_b128 a[160:163], v211 offset:5120
ds_read_b128 a[164:167], v211 offset:23552
v_mfma_f32_16x16x32_bf16 v[88:91], a[168:171], a[20:23], v[88:91]
buffer_store_dwordx4 a[236:239], v1, s[4:7], s101 offen offset:3072 sc1
v_rcp_f32 v220, v220
v_mfma_f32_16x16x32_bf16 v[92:95], a[172:175], a[16:19], v[92:95]
s_add_u32 m0, s38, 36864
v_rcp_f32 v221, v221
v_mfma_f32_16x16x32_bf16 v[96:99], a[172:175], a[20:23], v[96:99]
s_waitcnt lgkmcnt(4)
v_rcp_f32 v222, v222
v_mfma_f32_16x16x32_bf16 v[84:87], a[144:147], a[24:27], v[84:87]
ds_read_b128 a[168:171], v211 offset:6144
ds_read_b128 a[172:175], v211 offset:24576
v_mfma_f32_16x16x32_bf16 v[88:91], a[144:147], a[28:31], v[88:91]
s_add_u32 s39, s38, s82
v_rcp_f32 v223, v223
v_mfma_f32_16x16x32_bf16 v[92:95], a[148:151], a[24:27], v[92:95]
s_add_u32 s39, s39, 226304
v_pk_mul_f32 v[224:225], v[60:61], v[60:61]
v_pk_mul_f32 v[226:227], v[62:63], v[62:63]
v_pk_mul_f32 v[228:229], v[64:65], v[64:65]
v_pk_mul_f32 v[230:231], v[66:67], v[66:67]
v_pk_fma_f32 v[224:225], v[224:225], v[252:253], v[250:251] op_sel:[0,0,0] op_sel_hi:[1,0,0]
v_pk_fma_f32 v[226:227], v[226:227], v[252:253], v[250:251] op_sel:[0,0,0] op_sel_hi:[1,0,0]
v_pk_fma_f32 v[228:229], v[228:229], v[252:253], v[250:251] op_sel:[0,1,1] op_sel_hi:[1,1,1]
v_pk_fma_f32 v[230:231], v[230:231], v[252:253], v[250:251] op_sel:[0,1,1] op_sel_hi:[1,1,1]
v_pk_mul_f32 v[52:53], v[52:53], v[216:217]
v_pk_mul_f32 v[54:55], v[54:55], v[218:219]
v_pk_mul_f32 v[56:57], v[56:57], v[220:221]
v_pk_mul_f32 v[58:59], v[58:59], v[222:223]
v_pk_mul_f32 v[224:225], v[224:225], v[60:61]
v_pk_mul_f32 v[226:227], v[226:227], v[62:63]
v_pk_mul_f32 v[228:229], v[228:229], v[64:65]
v_pk_mul_f32 v[230:231], v[230:231], v[66:67]
v_mfma_f32_16x16x32_bf16 v[96:99], a[148:151], a[28:31], v[96:99]
s_waitcnt lgkmcnt(4)
v_exp_f32 v224, v224
v_mfma_f32_16x16x32_bf16 v[84:87], a[152:155], a[32:35], v[84:87]
ds_read_b128 a[144:147], v211 offset:7168
ds_read_b128 a[148:151], v211 offset:25600
v_exp_f32 v225, v225
v_mfma_f32_16x16x32_bf16 v[88:91], a[152:155], a[36:39], v[88:91]
v_exp_f32 v226, v226
v_mfma_f32_16x16x32_bf16 v[92:95], a[156:159], a[32:35], v[92:95]
s_mov_b64 exec, 0xffff
buffer_load_dwordx4 v1, s[4:7], s39 offen sc1 lds
s_mov_b64 exec, -1
v_mfma_f32_16x16x32_bf16 v[96:99], a[156:159], a[36:39], v[96:99]
s_waitcnt lgkmcnt(4)
v_fma_f32 v224, v224, v254, v254
v_fma_f32 v225, v225, v254, v254
v_mfma_f32_16x16x32_bf16 v[84:87], a[160:163], a[40:43], v[84:87]
ds_read_b128 a[152:155], v211 offset:8192
ds_read_b128 a[156:159], v211 offset:26624
v_exp_f32 v227, v227
v_mfma_f32_16x16x32_bf16 v[88:91], a[160:163], a[44:47], v[88:91]
v_exp_f32 v228, v228
v_mfma_f32_16x16x32_bf16 v[92:95], a[164:167], a[40:43], v[92:95]
v_fma_f32 v226, v226, v254, v254
v_fma_f32 v227, v227, v254, v254
v_mfma_f32_16x16x32_bf16 v[96:99], a[164:167], a[44:47], v[96:99]
s_waitcnt lgkmcnt(4)
v_exp_f32 v229, v229
v_mfma_f32_16x16x32_bf16 v[84:87], a[168:171], a[48:51], v[84:87]
ds_read_b128 a[160:163], v211 offset:9216
ds_read_b128 a[164:167], v211 offset:27648
v_mfma_f32_16x16x32_bf16 v[88:91], a[168:171], a[52:55], v[88:91]
v_exp_f32 v230, v230
v_mfma_f32_16x16x32_bf16 v[92:95], a[172:175], a[48:51], v[92:95]
buffer_store_dwordx4 a[240:243], v9, s[4:7], s101 offen offset:0 sc1
s_mul_i32 s38, s24, 9216
v_mfma_f32_16x16x32_bf16 v[96:99], a[172:175], a[52:55], v[96:99]
s_waitcnt lgkmcnt(4)
v_fma_f32 v228, v228, v255, v255
v_fma_f32 v229, v229, v255, v255
v_mfma_f32_16x16x32_bf16 v[84:87], a[144:147], a[56:59], v[84:87]
ds_read_b128 a[168:171], v211 offset:10240
ds_read_b128 a[172:175], v211 offset:28672
v_exp_f32 v231, v231
v_mfma_f32_16x16x32_bf16 v[88:91], a[144:147], a[60:63], v[88:91]
s_add_u32 m0, s38, 37888
v_rcp_f32 v224, v224
v_mfma_f32_16x16x32_bf16 v[92:95], a[148:151], a[56:59], v[92:95]
s_add_u32 s39, s38, s82
v_fma_f32 v230, v230, v255, v255
v_fma_f32 v231, v231, v255, v255
v_mfma_f32_16x16x32_bf16 v[96:99], a[148:151], a[60:63], v[96:99]
s_waitcnt lgkmcnt(4)
v_rcp_f32 v225, v225
v_mfma_f32_16x16x32_bf16 v[84:87], a[152:155], a[64:67], v[84:87]
ds_read_b128 a[144:147], v211 offset:11264
ds_read_b128 a[148:151], v211 offset:29696
v_mfma_f32_16x16x32_bf16 v[88:91], a[152:155], a[68:71], v[88:91]
s_add_u32 s39, s39, 227328
v_rcp_f32 v226, v226
v_mfma_f32_16x16x32_bf16 v[92:95], a[156:159], a[64:67], v[92:95]
v_rcp_f32 v227, v227
v_mfma_f32_16x16x32_bf16 v[96:99], a[156:159], a[68:71], v[96:99]
s_waitcnt lgkmcnt(4)
v_rcp_f32 v228, v228
v_mfma_f32_16x16x32_bf16 v[84:87], a[160:163], a[72:75], v[84:87]
ds_read_b128 a[152:155], v211 offset:12288
ds_read_b128 a[156:159], v211 offset:30720
v_mfma_f32_16x16x32_bf16 v[88:91], a[160:163], a[76:79], v[88:91]
buffer_load_dwordx4 v1, s[4:7], s39 offen offset:0 sc1 lds
buffer_load_dwordx4 v1, s[4:7], s39 offen offset:1024 sc1 lds
v_mfma_f32_16x16x32_bf16 v[92:95], a[164:167], a[72:75], v[92:95]
v_rcp_f32 v229, v229
v_mfma_f32_16x16x32_bf16 v[96:99], a[164:167], a[76:79], v[96:99]
s_waitcnt lgkmcnt(4)
v_rcp_f32 v230, v230
v_mfma_f32_16x16x32_bf16 v[84:87], a[168:171], a[80:83], v[84:87]
ds_read_b128 a[160:163], v211 offset:13312
ds_read_b128 a[164:167], v211 offset:31744
v_rcp_f32 v231, v231
v_mfma_f32_16x16x32_bf16 v[88:91], a[168:171], a[84:87], v[88:91]
buffer_load_dwordx4 v1, s[4:7], s39 offen offset:2048 sc1 lds
buffer_load_dwordx4 v1, s[4:7], s39 offen offset:3072 sc1 lds
v_pk_mul_f32 v[216:217], v[68:69], v[68:69]
v_pk_mul_f32 v[218:219], v[70:71], v[70:71]
v_pk_mul_f32 v[220:221], v[72:73], v[72:73]
v_pk_mul_f32 v[222:223], v[74:75], v[74:75]
v_pk_fma_f32 v[216:217], v[216:217], v[252:253], v[250:251] op_sel:[0,0,0] op_sel_hi:[1,0,0]
v_pk_fma_f32 v[218:219], v[218:219], v[252:253], v[250:251] op_sel:[0,0,0] op_sel_hi:[1,0,0]
v_pk_fma_f32 v[220:221], v[220:221], v[252:253], v[250:251] op_sel:[0,1,1] op_sel_hi:[1,1,1]
v_pk_fma_f32 v[222:223], v[222:223], v[252:253], v[250:251] op_sel:[0,1,1] op_sel_hi:[1,1,1]
v_pk_mul_f32 v[60:61], v[60:61], v[224:225]
v_pk_mul_f32 v[62:63], v[62:63], v[226:227]
v_pk_mul_f32 v[64:65], v[64:65], v[228:229]
v_pk_mul_f32 v[66:67], v[66:67], v[230:231]
v_pk_mul_f32 v[216:217], v[216:217], v[68:69]
v_pk_mul_f32 v[218:219], v[218:219], v[70:71]
v_pk_mul_f32 v[220:221], v[220:221], v[72:73]
v_pk_mul_f32 v[222:223], v[222:223], v[74:75]
v_mfma_f32_16x16x32_bf16 v[92:95], a[172:175], a[80:83], v[92:95]
s_add_u32 m0, m0, 4096
v_exp_f32 v216, v216
v_mfma_f32_16x16x32_bf16 v[96:99], a[172:175], a[84:87], v[96:99]
s_waitcnt lgkmcnt(4)
v_exp_f32 v217, v217
v_mfma_f32_16x16x32_bf16 v[84:87], a[144:147], a[88:91], v[84:87]
ds_read_b128 a[168:171], v211 offset:14336
ds_read_b128 a[172:175], v211 offset:32768
v_exp_f32 v218, v218
v_mfma_f32_16x16x32_bf16 v[88:91], a[144:147], a[92:95], v[88:91]
buffer_store_dwordx4 a[244:247], v9, s[4:7], s101 offen offset:1024 sc1
v_fma_f32 v216, v216, v254, v254
v_mfma_f32_16x16x32_bf16 v[92:95], a[148:151], a[88:91], v[92:95]
s_add_u32 s39, s39, 4096
v_fma_f32 v217, v217, v254, v254
v_mfma_f32_16x16x32_bf16 v[96:99], a[148:151], a[92:95], v[96:99]
s_waitcnt lgkmcnt(4)
v_exp_f32 v219, v219
v_mfma_f32_16x16x32_bf16 v[84:87], a[152:155], a[96:99], v[84:87]
ds_read_b128 a[144:147], v211 offset:15360
ds_read_b128 a[148:151], v211 offset:33792
v_exp_f32 v220, v220
v_mfma_f32_16x16x32_bf16 v[88:91], a[152:155], a[100:103], v[88:91]
v_fma_f32 v218, v218, v254, v254
v_fma_f32 v219, v219, v254, v254
v_mfma_f32_16x16x32_bf16 v[92:95], a[156:159], a[96:99], v[92:95]
v_exp_f32 v221, v221
v_mfma_f32_16x16x32_bf16 v[96:99], a[156:159], a[100:103], v[96:99]
s_waitcnt lgkmcnt(4)
v_exp_f32 v222, v222
v_mfma_f32_16x16x32_bf16 v[84:87], a[160:163], a[104:107], v[84:87]
ds_read_b128 a[152:155], v211 offset:16384
ds_read_b128 a[156:159], v211 offset:34816
v_mfma_f32_16x16x32_bf16 v[88:91], a[160:163], a[108:111], v[88:91]
buffer_load_dwordx4 v1, s[4:7], s39 offen offset:0 sc1 lds
buffer_load_dwordx4 v1, s[4:7], s39 offen offset:1024 sc1 lds
v_mfma_f32_16x16x32_bf16 v[92:95], a[164:167], a[104:107], v[92:95]
v_fma_f32 v220, v220, v255, v255
v_fma_f32 v221, v221, v255, v255
v_mfma_f32_16x16x32_bf16 v[96:99], a[164:167], a[108:111], v[96:99]
s_waitcnt lgkmcnt(4)
v_exp_f32 v223, v223
v_mfma_f32_16x16x32_bf16 v[84:87], a[168:171], a[112:115], v[84:87]
ds_read_b128 a[160:163], v211 offset:17408
ds_read_b128 a[164:167], v211 offset:35840
v_rcp_f32 v216, v216
v_mfma_f32_16x16x32_bf16 v[88:91], a[168:171], a[116:119], v[88:91]
buffer_load_dwordx4 v1, s[4:7], s39 offen offset:2048 sc1 lds
buffer_load_dwordx4 v1, s[4:7], s39 offen offset:3072 sc1 lds
v_mfma_f32_16x16x32_bf16 v[92:95], a[172:175], a[112:115], v[92:95]
s_add_u32 m0, m0, 4096
v_fma_f32 v222, v222, v255, v255
v_fma_f32 v223, v223, v255, v255
v_mfma_f32_16x16x32_bf16 v[96:99], a[172:175], a[116:119], v[96:99]
s_waitcnt lgkmcnt(4)
v_rcp_f32 v217, v217
v_add_u32 v181, 112640, v239
v_mfma_f32_16x16x32_bf16 v[84:87], a[144:147], a[120:123], v[84:87]
ds_read_b64 a[168:169], v181 offset:0
ds_read_b64 a[172:173], v181 offset:512
v_rcp_f32 v218, v218
v_mfma_f32_16x16x32_bf16 v[88:91], a[144:147], a[124:127], v[88:91]
s_add_u32 s39, s39, 4096
v_rcp_f32 v219, v219
v_mfma_f32_16x16x32_bf16 v[92:95], a[148:151], a[120:123], v[92:95]
buffer_store_dwordx4 a[248:251], v9, s[4:7], s101 offen offset:2048 sc1
v_mfma_f32_16x16x32_bf16 v[96:99], a[148:151], a[124:127], v[96:99]
s_waitcnt lgkmcnt(4)
v_rcp_f32 v220, v220
v_mfma_f32_16x16x32_bf16 v[84:87], a[152:155], a[128:131], v[84:87]
ds_read_b128 a[144:147], v208 offset:0
ds_read_b128 a[148:151], v208 offset:18432
v_mfma_f32_16x16x32_bf16 v[88:91], a[152:155], a[132:135], v[88:91]
v_rcp_f32 v221, v221
v_mfma_f32_16x16x32_bf16 v[92:95], a[156:159], a[128:131], v[92:95]
v_rcp_f32 v222, v222
v_mfma_f32_16x16x32_bf16 v[96:99], a[156:159], a[132:135], v[96:99]
s_waitcnt lgkmcnt(4)
v_rcp_f32 v223, v223
v_mfma_f32_16x16x32_bf16 v[84:87], a[160:163], a[136:139], v[84:87]
ds_read_b128 a[152:155], v208 offset:1024
ds_read_b128 a[156:159], v208 offset:19456
v_pk_mul_f32 v[224:225], v[76:77], v[76:77]
v_pk_mul_f32 v[226:227], v[78:79], v[78:79]
v_pk_mul_f32 v[228:229], v[80:81], v[80:81]
v_pk_mul_f32 v[230:231], v[82:83], v[82:83]
v_pk_fma_f32 v[224:225], v[224:225], v[252:253], v[250:251] op_sel:[0,0,0] op_sel_hi:[1,0,0]
v_pk_fma_f32 v[226:227], v[226:227], v[252:253], v[250:251] op_sel:[0,0,0] op_sel_hi:[1,0,0]
v_pk_fma_f32 v[228:229], v[228:229], v[252:253], v[250:251] op_sel:[0,1,1] op_sel_hi:[1,1,1]
v_pk_fma_f32 v[230:231], v[230:231], v[252:253], v[250:251] op_sel:[0,1,1] op_sel_hi:[1,1,1]
v_pk_mul_f32 v[68:69], v[68:69], v[216:217]
v_pk_mul_f32 v[70:71], v[70:71], v[218:219]
v_pk_mul_f32 v[72:73], v[72:73], v[220:221]
v_pk_mul_f32 v[74:75], v[74:75], v[222:223]
v_pk_mul_f32 v[224:225], v[224:225], v[76:77]
v_pk_mul_f32 v[226:227], v[226:227], v[78:79]
v_pk_mul_f32 v[228:229], v[228:229], v[80:81]
v_pk_mul_f32 v[230:231], v[230:231], v[82:83]
v_mfma_f32_16x16x32_bf16 v[88:91], a[160:163], a[140:143], v[88:91]
buffer_load_dwordx4 v1, s[4:7], s39 offen offset:0 sc1 lds
s_lshl_b32 s38, s24, 8
v_exp_f32 v224, v224
v_mfma_f32_16x16x32_bf16 v[92:95], a[164:167], a[136:139], v[92:95]
s_add_u32 m0, s38, 74752
v_exp_f32 v225, v225
v_mfma_f32_16x16x32_bf16 v[96:99], a[164:167], a[140:143], v[96:99]
s_waitcnt lgkmcnt(4)
v_exp_f32 v226, v226
v_mfma_f32_16x16x16_bf16 v[84:87], a[168:169], v[212:213], v[84:87]
ds_read_b128 a[160:163], v208 offset:2048
ds_read_b128 a[164:167], v208 offset:20480
v_mfma_f32_16x16x16_bf16 v[88:91], a[168:169], v[214:215], v[88:91]
s_add_u32 s39, s38, s82
v_fma_f32 v224, v224, v254, v254
v_fma_f32 v225, v225, v254, v254
v_mfma_f32_16x16x16_bf16 v[92:95], a[172:173], v[212:213], v[92:95]
s_add_u32 s39, s39, 264192
v_exp_f32 v227, v227
v_mfma_f32_16x16x16_bf16 v[96:99], a[172:173], v[214:215], v[96:99]
s_waitcnt lgkmcnt(4)
v_exp_f32 v228, v228
s_waitcnt vmcnt(12)
s_barrier
v_mfma_f32_16x16x32_bf16 v[100:103], a[144:147], a[0:3], 0
ds_read_b128 a[168:171], v208 offset:3072
ds_read_b128 a[172:175], v208 offset:21504
v_mfma_f32_16x16x32_bf16 v[104:107], a[144:147], a[4:7], 0
s_mov_b32 s37, L_c4-L_pc
v_fma_f32 v226, v226, v254, v254
v_fma_f32 v227, v227, v254, v254
v_mfma_f32_16x16x32_bf16 v[108:111], a[148:151], a[0:3], 0
v_exp_f32 v229, v229
v_mfma_f32_16x16x32_bf16 v[112:115], a[148:151], a[4:7], 0
s_waitcnt lgkmcnt(4)
v_exp_f32 v230, v230
v_mfma_f32_16x16x32_bf16 v[100:103], a[152:155], a[8:11], v[100:103]
ds_read_b128 a[144:147], v208 offset:4096
ds_read_b128 a[148:151], v208 offset:22528
v_mfma_f32_16x16x32_bf16 v[104:107], a[152:155], a[12:15], v[104:107]
s_mov_b64 exec, 0xffff
buffer_load_dwordx4 v1, s[4:7], s39 offen sc1 lds
s_mov_b64 exec, -1
v_fma_f32 v228, v228, v255, v255
v_fma_f32 v229, v229, v255, v255
v_mfma_f32_16x16x32_bf16 v[108:111], a[156:159], a[8:11], v[108:111]
buffer_store_dwordx4 a[252:255], v9, s[4:7], s101 offen offset:3072 sc1
buffer_load_dword v15, v14, s[88:91], s37 offen
v_exp_f32 v231, v231
v_mfma_f32_16x16x32_bf16 v[112:115], a[156:159], a[12:15], v[112:115]
s_waitcnt lgkmcnt(4)
v_rcp_f32 v224, v224
v_mfma_f32_16x16x32_bf16 v[100:103], a[160:163], a[16:19], v[100:103]
ds_read_b128 a[152:155], v208 offset:5120
ds_read_b128 a[156:159], v208 offset:23552
v_mfma_f32_16x16x32_bf16 v[104:107], a[160:163], a[20:23], v[104:107]
s_mov_b32 s101, 1073741824
v_fma_f32 v230, v230, v255, v255
v_fma_f32 v231, v231, v255, v255
v_mfma_f32_16x16x32_bf16 v[108:111], a[164:167], a[16:19], v[108:111]
v_rcp_f32 v225, v225
v_mfma_f32_16x16x32_bf16 v[112:115], a[164:167], a[20:23], v[112:115]
s_waitcnt lgkmcnt(4)
v_rcp_f32 v226, v226
v_mfma_f32_16x16x32_bf16 v[100:103], a[168:171], a[24:27], v[100:103]
ds_read_b128 a[160:163], v208 offset:6144
ds_read_b128 a[164:167], v208 offset:24576
v_mfma_f32_16x16x32_bf16 v[104:107], a[168:171], a[28:31], v[104:107]
s_mul_i32 s38, s24, 9216
v_rcp_f32 v227, v227
v_mfma_f32_16x16x32_bf16 v[108:111], a[172:175], a[24:27], v[108:111]
s_add_u32 m0, s38, 75776
v_rcp_f32 v228, v228
v_mfma_f32_16x16x32_bf16 v[112:115], a[172:175], a[28:31], v[112:115]
s_waitcnt lgkmcnt(4)
v_rcp_f32 v229, v229
v_mfma_f32_16x16x32_bf16 v[100:103], a[144:147], a[32:35], v[100:103]
ds_read_b128 a[168:171], v208 offset:7168
ds_read_b128 a[172:175], v208 offset:25600
v_mfma_f32_16x16x32_bf16 v[104:107], a[144:147], a[36:39], v[104:107]
s_add_u32 s39, s38, s82
v_rcp_f32 v230, v230
v_mfma_f32_16x16x32_bf16 v[108:111], a[148:151], a[32:35], v[108:111]
s_add_u32 s39, s39, 265216
v_rcp_f32 v231, v231
v_mfma_f32_16x16x32_bf16 v[112:115], a[148:151], a[36:39], v[112:115]
s_waitcnt lgkmcnt(4)
v_pk_mul_f32 v[216:217], v[84:85], v[84:85]
v_pk_mul_f32 v[218:219], v[86:87], v[86:87]
v_pk_mul_f32 v[220:221], v[88:89], v[88:89]
v_pk_mul_f32 v[222:223], v[90:91], v[90:91]
v_pk_fma_f32 v[216:217], v[216:217], v[252:253], v[250:251] op_sel:[0,0,0] op_sel_hi:[1,0,0]
v_pk_fma_f32 v[218:219], v[218:219], v[252:253], v[250:251] op_sel:[0,0,0] op_sel_hi:[1,0,0]
v_pk_fma_f32 v[220:221], v[220:221], v[252:253], v[250:251] op_sel:[0,1,1] op_sel_hi:[1,1,1]
v_pk_fma_f32 v[222:223], v[222:223], v[252:253], v[250:251] op_sel:[0,1,1] op_sel_hi:[1,1,1]
v_pk_mul_f32 v[76:77], v[76:77], v[224:225]
v_pk_mul_f32 v[78:79], v[78:79], v[226:227]
v_pk_mul_f32 v[80:81], v[80:81], v[228:229]
v_pk_mul_f32 v[82:83], v[82:83], v[230:231]
v_pk_mul_f32 v[216:217], v[216:217], v[84:85]
v_pk_mul_f32 v[218:219], v[218:219], v[86:87]
v_pk_mul_f32 v[220:221], v[220:221], v[88:89]
v_pk_mul_f32 v[222:223], v[222:223], v[90:91]
v_mfma_f32_16x16x32_bf16 v[100:103], a[152:155], a[40:43], v[100:103]
ds_read_b128 a[144:147], v208 offset:8192
ds_read_b128 a[148:151], v208 offset:26624
v_exp_f32 v216, v216
v_mfma_f32_16x16x32_bf16 v[104:107], a[152:155], a[44:47], v[104:107]
v_exp_f32 v217, v217
v_mfma_f32_16x16x32_bf16 v[108:111], a[156:159], a[40:43], v[108:111]
buffer_load_dwordx4 v1, s[4:7], s39 offen offset:0 sc1 lds
buffer_load_dwordx4 v1, s[4:7], s39 offen offset:1024 sc1 lds
v_exp_f32 v218, v218
v_mfma_f32_16x16x32_bf16 v[112:115], a[156:159], a[44:47], v[112:115]
s_waitcnt lgkmcnt(4)
v_fma_f32 v216, v216, v254, v254
v_fma_f32 v217, v217, v254, v254
v_mfma_f32_16x16x32_bf16 v[100:103], a[160:163], a[48:51], v[100:103]
ds_read_b128 a[152:155], v208 offset:9216
ds_read_b128 a[156:159], v208 offset:27648
v_mfma_f32_16x16x32_bf16 v[104:107], a[160:163], a[52:55], v[104:107]
v_exp_f32 v219, v219
v_mfma_f32_16x16x32_bf16 v[108:111], a[164:167], a[48:51], v[108:111]
v_exp_f32 v220, v220
v_mfma_f32_16x16x32_bf16 v[112:115], a[164:167], a[52:55], v[112:115]
s_waitcnt lgkmcnt(4)
v_fma_f32 v218, v218, v254, v254
v_fma_f32 v219, v219, v254, v254
v_mfma_f32_16x16x32_bf16 v[100:103], a[168:171], a[56:59], v[100:103]
ds_read_b128 a[160:163], v208 offset:10240
ds_read_b128 a[164:167], v208 offset:28672
v_mfma_f32_16x16x32_bf16 v[104:107], a[168:171], a[60:63], v[104:107]
buffer_load_dwordx4 v1, s[4:7], s39 offen offset:2048 sc1 lds
buffer_load_dwordx4 v1, s[4:7], s39 offen offset:3072 sc1 lds
v_exp_f32 v221, v221
v_mfma_f32_16x16x32_bf16 v[108:111], a[172:175], a[56:59], v[108:111]
s_add_u32 m0, m0, 4096
v_exp_f32 v222, v222
v_mfma_f32_16x16x32_bf16 v[112:115], a[172:175], a[60:63], v[112:115]
s_waitcnt lgkmcnt(4)
v_fma_f32 v220, v220, v255, v255
v_fma_f32 v221, v221, v255, v255
v_mfma_f32_16x16x32_bf16 v[100:103], a[144:147], a[64:67], v[100:103]
ds_read_b128 a[168:171], v208 offset:11264
ds_read_b128 a[172:175], v208 offset:29696
v_mfma_f32_16x16x32_bf16 v[104:107], a[144:147], a[68:71], v[104:107]
s_add_u32 s39, s39, 4096
v_exp_f32 v223, v223
v_mfma_f32_16x16x32_bf16 v[108:111], a[148:151], a[64:67], v[108:111]
v_rcp_f32 v216, v216
v_mfma_f32_16x16x32_bf16 v[112:115], a[148:151], a[68:71], v[112:115]
s_waitcnt lgkmcnt(4)
v_fma_f32 v222, v222, v255, v255
v_fma_f32 v223, v223, v255, v255
v_mfma_f32_16x16x32_bf16 v[100:103], a[152:155], a[72:75], v[100:103]
ds_read_b128 a[144:147], v208 offset:12288
ds_read_b128 a[148:151], v208 offset:30720
v_mfma_f32_16x16x32_bf16 v[104:107], a[152:155], a[76:79], v[104:107]
buffer_load_dwordx4 v1, s[4:7], s39 offen offset:0 sc1 lds
buffer_load_dwordx4 v1, s[4:7], s39 offen offset:1024 sc1 lds
v_rcp_f32 v217, v217
v_mfma_f32_16x16x32_bf16 v[108:111], a[156:159], a[72:75], v[108:111]
v_rcp_f32 v218, v218
v_mfma_f32_16x16x32_bf16 v[112:115], a[156:159], a[76:79], v[112:115]
s_waitcnt lgkmcnt(4)
v_rcp_f32 v219, v219
v_mfma_f32_16x16x32_bf16 v[100:103], a[160:163], a[80:83], v[100:103]
ds_read_b128 a[152:155], v208 offset:13312
ds_read_b128 a[156:159], v208 offset:31744
v_mfma_f32_16x16x32_bf16 v[104:107], a[160:163], a[84:87], v[104:107]
v_rcp_f32 v220, v220
v_mfma_f32_16x16x32_bf16 v[108:111], a[164:167], a[80:83], v[108:111]
v_rcp_f32 v221, v221
v_mfma_f32_16x16x32_bf16 v[112:115], a[164:167], a[84:87], v[112:115]
s_waitcnt lgkmcnt(4)
v_rcp_f32 v222, v222
v_mfma_f32_16x16x32_bf16 v[100:103], a[168:171], a[88:91], v[100:103]
ds_read_b128 a[160:163], v208 offset:14336
ds_read_b128 a[164:167], v208 offset:32768
v_mfma_f32_16x16x32_bf16 v[104:107], a[168:171], a[92:95], v[104:107]
buffer_load_dwordx4 v1, s[4:7], s39 offen offset:2048 sc1 lds
buffer_load_dwordx4 v1, s[4:7], s39 offen offset:3072 sc1 lds
v_rcp_f32 v223, v223
v_mfma_f32_16x16x32_bf16 v[108:111], a[172:175], a[88:91], v[108:111]
s_add_u32 m0, m0, 4096
v_pk_mul_f32 v[224:225], v[92:93], v[92:93]
v_pk_mul_f32 v[226:227], v[94:95], v[94:95]
v_pk_mul_f32 v[228:229], v[96:97], v[96:97]
v_pk_mul_f32 v[230:231], v[98:99], v[98:99]
v_pk_fma_f32 v[224:225], v[224:225], v[252:253], v[250:251] op_sel:[0,0,0] op_sel_hi:[1,0,0]
v_pk_fma_f32 v[226:227], v[226:227], v[252:253], v[250:251] op_sel:[0,0,0] op_sel_hi:[1,0,0]
v_pk_fma_f32 v[228:229], v[228:229], v[252:253], v[250:251] op_sel:[0,1,1] op_sel_hi:[1,1,1]
v_pk_fma_f32 v[230:231], v[230:231], v[252:253], v[250:251] op_sel:[0,1,1] op_sel_hi:[1,1,1]
v_pk_mul_f32 v[84:85], v[84:85], v[216:217]
v_pk_mul_f32 v[86:87], v[86:87], v[218:219]
v_pk_mul_f32 v[88:89], v[88:89], v[220:221]
v_pk_mul_f32 v[90:91], v[90:91], v[222:223]
v_pk_mul_f32 v[224:225], v[224:225], v[92:93]
v_pk_mul_f32 v[226:227], v[226:227], v[94:95]
v_pk_mul_f32 v[228:229], v[228:229], v[96:97]
v_pk_mul_f32 v[230:231], v[230:231], v[98:99]
v_mfma_f32_16x16x32_bf16 v[112:115], a[172:175], a[92:95], v[112:115]
s_waitcnt lgkmcnt(4)
v_exp_f32 v224, v224
v_mfma_f32_16x16x32_bf16 v[100:103], a[144:147], a[96:99], v[100:103]
ds_read_b128 a[168:171], v208 offset:15360
ds_read_b128 a[172:175], v208 offset:33792
v_exp_f32 v225, v225
v_mfma_f32_16x16x32_bf16 v[104:107], a[144:147], a[100:103], v[104:107]
s_add_u32 s39, s39, 4096
v_exp_f32 v226, v226
v_mfma_f32_16x16x32_bf16 v[108:111], a[148:151], a[96:99], v[108:111]
v_fma_f32 v224, v224, v254, v254
v_fma_f32 v225, v225, v254, v254
v_mfma_f32_16x16x32_bf16 v[112:115], a[148:151], a[100:103], v[112:115]
s_waitcnt lgkmcnt(4)
v_exp_f32 v227, v227
v_mfma_f32_16x16x32_bf16 v[100:103], a[152:155], a[104:107], v[100:103]
ds_read_b128 a[144:147], v208 offset:16384
ds_read_b128 a[148:151], v208 offset:34816
v_mfma_f32_16x16x32_bf16 v[104:107], a[152:155], a[108:111], v[104:107]
buffer_load_dwordx4 v1, s[4:7], s39 offen offset:0 sc1 lds
v_exp_f32 v228, v228
v_mfma_f32_16x16x32_bf16 v[108:111], a[156:159], a[104:107], v[108:111]
s_lshl_b32 s38, s24, 8
v_fma_f32 v226, v226, v254, v254
v_fma_f32 v227, v227, v254, v254
v_mfma_f32_16x16x32_bf16 v[112:115], a[156:159], a[108:111], v[112:115]
s_waitcnt lgkmcnt(4)
v_exp_f32 v229, v229
v_mfma_f32_16x16x32_bf16 v[100:103], a[160:163], a[112:115], v[100:103]
ds_read_b128 a[152:155], v208 offset:17408
ds_read_b128 a[156:159], v208 offset:35840
v_mfma_f32_16x16x32_bf16 v[104:107], a[160:163], a[116:119], v[104:107]
s_add_u32 m0, s38, 112640
v_exp_f32 v230, v230
v_mfma_f32_16x16x32_bf16 v[108:111], a[164:167], a[112:115], v[108:111]
s_add_u32 s39, s38, s82
v_fma_f32 v228, v228, v255, v255
v_fma_f32 v229, v229, v255, v255
v_mfma_f32_16x16x32_bf16 v[112:115], a[164:167], a[116:119], v[112:115]
s_waitcnt lgkmcnt(4)
v_add_u32 v181, 160768, v239
v_mfma_f32_16x16x32_bf16 v[100:103], a[168:171], a[120:123], v[100:103]
ds_read_b64 a[160:161], v181 offset:0
ds_read_b64 a[164:165], v181 offset:512
v_exp_f32 v231, v231
v_mfma_f32_16x16x32_bf16 v[104:107], a[168:171], a[124:127], v[104:107]
s_add_u32 s39, s39, 302080
v_rcp_f32 v224, v224
v_mfma_f32_16x16x32_bf16 v[108:111], a[172:175], a[120:123], v[108:111]
v_fma_f32 v230, v230, v255, v255
v_fma_f32 v231, v231, v255, v255
v_mfma_f32_16x16x32_bf16 v[112:115], a[172:175], a[124:127], v[112:115]
s_waitcnt lgkmcnt(4)
v_rcp_f32 v225, v225
v_mfma_f32_16x16x32_bf16 v[100:103], a[144:147], a[128:131], v[100:103]
ds_read_b128 a[168:171], v209 offset:0
ds_read_b128 a[172:175], v209 offset:18432
v_mfma_f32_16x16x32_bf16 v[104:107], a[144:147], a[132:135], v[104:107]
v_rcp_f32 v226, v226
v_mfma_f32_16x16x32_bf16 v[108:111], a[148:151], a[128:131], v[108:111]
s_mov_b64 exec, 0xffff
buffer_load_dwordx4 v1, s[4:7], s39 offen sc1 lds
s_mov_b64 exec, -1
v_mfma_f32_16x16x32_bf16 v[112:115], a[148:151], a[132:135], v[112:115]
s_waitcnt lgkmcnt(4)
v_rcp_f32 v227, v227
v_mfma_f32_16x16x32_bf16 v[100:103], a[152:155], a[136:139], v[100:103]
ds_read_b128 a[144:147], v209 offset:1024
ds_read_b128 a[148:151], v209 offset:19456
v_rcp_f32 v228, v228
v_mfma_f32_16x16x32_bf16 v[104:107], a[152:155], a[140:143], v[104:107]
v_rcp_f32 v229, v229
v_mfma_f32_16x16x32_bf16 v[108:111], a[156:159], a[136:139], v[108:111]
v_rcp_f32 v230, v230
v_mfma_f32_16x16x32_bf16 v[112:115], a[156:159], a[140:143], v[112:115]
s_waitcnt lgkmcnt(4)
v_rcp_f32 v231, v231
v_mfma_f32_16x16x16_bf16 v[100:103], a[160:161], v[212:213], v[100:103]
ds_read_b128 a[152:155], v209 offset:2048
ds_read_b128 a[156:159], v209 offset:20480
v_mfma_f32_16x16x16_bf16 v[104:107], a[160:161], v[214:215], v[104:107]
v_mfma_f32_16x16x16_bf16 v[108:111], a[164:165], v[212:213], v[108:111]
v_mfma_f32_16x16x16_bf16 v[112:115], a[164:165], v[214:215], v[112:115]
s_waitcnt vmcnt(12) lgkmcnt(4)
s_barrier
v_mfma_f32_16x16x32_bf16 v[116:119], a[168:171], a[0:3], 0
ds_read_b128 a[160:163], v209 offset:3072
ds_read_b128 a[164:167], v209 offset:21504
v_mfma_f32_16x16x32_bf16 v[120:123], a[168:171], a[4:7], 0
s_mul_i32 s38, s24, 9216
s_add_u32 m0, s38, 123904
v_mfma_f32_16x16x32_bf16 v[124:127], a[172:175], a[0:3], 0
s_add_u32 s39, s38, s82
v_mfma_f32_16x16x32_bf16 v[128:131], a[172:175], a[4:7], 0
s_waitcnt lgkmcnt(4)
s_add_u32 s39, s39, 303104
v_mfma_f32_16x16x32_bf16 v[116:119], a[144:147], a[8:11], v[116:119]
ds_read_b128 a[168:171], v209 offset:4096
ds_read_b128 a[172:175], v209 offset:22528
v_mfma_f32_16x16x32_bf16 v[120:123], a[144:147], a[12:15], v[120:123]
buffer_load_dwordx4 v1, s[4:7], s39 offen offset:0 sc1 lds
buffer_load_dwordx4 v1, s[4:7], s39 offen offset:1024 sc1 lds
v_mfma_f32_16x16x32_bf16 v[124:127], a[148:151], a[8:11], v[124:127]
v_pk_mul_f32 v[216:217], v[100:101], v[100:101]
v_pk_mul_f32 v[218:219], v[102:103], v[102:103]
v_pk_mul_f32 v[220:221], v[104:105], v[104:105]
v_pk_mul_f32 v[222:223], v[106:107], v[106:107]
v_pk_fma_f32 v[216:217], v[216:217], v[252:253], v[250:251] op_sel:[0,0,0] op_sel_hi:[1,0,0]
v_pk_fma_f32 v[218:219], v[218:219], v[252:253], v[250:251] op_sel:[0,0,0] op_sel_hi:[1,0,0]
v_pk_fma_f32 v[220:221], v[220:221], v[252:253], v[250:251] op_sel:[0,1,1] op_sel_hi:[1,1,1]
v_pk_fma_f32 v[222:223], v[222:223], v[252:253], v[250:251] op_sel:[0,1,1] op_sel_hi:[1,1,1]
v_pk_mul_f32 v[92:93], v[92:93], v[224:225]
v_pk_mul_f32 v[94:95], v[94:95], v[226:227]
v_pk_mul_f32 v[96:97], v[96:97], v[228:229]
v_pk_mul_f32 v[98:99], v[98:99], v[230:231]
v_pk_mul_f32 v[216:217], v[216:217], v[100:101]
v_pk_mul_f32 v[218:219], v[218:219], v[102:103]
v_pk_mul_f32 v[220:221], v[220:221], v[104:105]
v_pk_mul_f32 v[222:223], v[222:223], v[106:107]
v_mfma_f32_16x16x32_bf16 v[128:131], a[148:151], a[12:15], v[128:131]
s_waitcnt lgkmcnt(4)
v_exp_f32 v216, v216
v_exp_f32 v217, v217
v_exp_f32 v218, v218
v_fma_f32 v216, v216, v254, v254
v_fma_f32 v217, v217, v254, v254
v_exp_f32 v219, v219
v_exp_f32 v220, v220
v_fma_f32 v218, v218, v254, v254
v_fma_f32 v219, v219, v254, v254
v_exp_f32 v221, v221
v_mfma_f32_16x16x32_bf16 v[116:119], a[152:155], a[16:19], v[116:119]
ds_read_b128 a[144:147], v209 offset:5120
ds_read_b128 a[148:151], v209 offset:23552
v_exp_f32 v222, v222
v_mfma_f32_16x16x32_bf16 v[120:123], a[152:155], a[20:23], v[120:123]
buffer_load_dwordx4 v1, s[4:7], s39 offen offset:2048 sc1 lds
buffer_load_dwordx4 v1, s[4:7], s39 offen offset:3072 sc1 lds
v_mfma_f32_16x16x32_bf16 v[124:127], a[156:159], a[16:19], v[124:127]
s_add_u32 m0, m0, 4096
v_fma_f32 v220, v220, v255, v255
v_fma_f32 v221, v221, v255, v255
v_mfma_f32_16x16x32_bf16 v[128:131], a[156:159], a[20:23], v[128:131]
s_waitcnt lgkmcnt(4)
s_add_u32 s39, s39, 4096
v_exp_f32 v223, v223
v_mfma_f32_16x16x32_bf16 v[116:119], a[160:163], a[24:27], v[116:119]
ds_read_b128 a[152:155], v209 offset:6144
ds_read_b128 a[156:159], v209 offset:24576
v_rcp_f32 v216, v216
v_mfma_f32_16x16x32_bf16 v[120:123], a[160:163], a[28:31], v[120:123]
buffer_load_dwordx4 v1, s[4:7], s39 offen offset:0 sc1 lds
buffer_load_dwordx4 v1, s[4:7], s39 offen offset:1024 sc1 lds
v_mfma_f32_16x16x32_bf16 v[124:127], a[164:167], a[24:27], v[124:127]
v_fma_f32 v222, v222, v255, v255
v_fma_f32 v223, v223, v255, v255
v_mfma_f32_16x16x32_bf16 v[128:131], a[164:167], a[28:31], v[128:131]
s_waitcnt lgkmcnt(4)
v_rcp_f32 v217, v217
v_mfma_f32_16x16x32_bf16 v[116:119], a[168:171], a[32:35], v[116:119]
ds_read_b128 a[160:163], v209 offset:7168
ds_read_b128 a[164:167], v209 offset:25600
v_rcp_f32 v218, v218
v_mfma_f32_16x16x32_bf16 v[120:123], a[168:171], a[36:39], v[120:123]
buffer_load_dwordx4 v1, s[4:7], s39 offen offset:2048 sc1 lds
buffer_load_dwordx4 v1, s[4:7], s39 offen offset:3072 sc1 lds
v_mfma_f32_16x16x32_bf16 v[124:127], a[172:175], a[32:35], v[124:127]
s_add_u32 m0, m0, 4096
s_add_u32 s39, s39, 4096
v_rcp_f32 v219, v219
v_mfma_f32_16x16x32_bf16 v[128:131], a[172:175], a[36:39], v[128:131]
s_waitcnt lgkmcnt(4)
v_rcp_f32 v220, v220
v_mfma_f32_16x16x32_bf16 v[116:119], a[144:147], a[40:43], v[116:119]
ds_read_b128 a[168:171], v209 offset:8192
ds_read_b128 a[172:175], v209 offset:26624
v_rcp_f32 v221, v221
v_rcp_f32 v222, v222
v_rcp_f32 v223, v223
v_mfma_f32_16x16x32_bf16 v[120:123], a[144:147], a[44:47], v[120:123]
buffer_load_dwordx4 v1, s[4:7], s39 offen offset:0 sc1 lds
s_lshl_b32 s38, s24, 8
s_nop 0
v_pk_mul_f32 v[100:101], v[100:101], v[216:217]
v_pk_mul_f32 v[102:103], v[102:103], v[218:219]
v_pk_mul_f32 v[104:105], v[104:105], v[220:221]
v_pk_mul_f32 v[106:107], v[106:107], v[222:223]
v_pk_add_f32 v[198:199], v[36:37], v[38:39]
v_pk_mul_f32 v[200:201], v[36:37], v[36:37]
v_pk_fma_f32 v[200:201], v[38:39], v[38:39], v[200:201]
v_pk_add_f32 v[202:203], v[40:41], v[42:43]
v_pk_mul_f32 v[204:205], v[40:41], v[40:41]
v_pk_fma_f32 v[204:205], v[42:43], v[42:43], v[204:205]
v_pk_add_f32 v[198:199], v[198:199], v[44:45]
v_pk_fma_f32 v[200:201], v[44:45], v[44:45], v[200:201]
v_pk_add_f32 v[198:199], v[198:199], v[46:47]
v_pk_fma_f32 v[200:201], v[46:47], v[46:47], v[200:201]
v_pk_add_f32 v[202:203], v[202:203], v[48:49]
v_pk_fma_f32 v[204:205], v[48:49], v[48:49], v[204:205]
v_pk_add_f32 v[202:203], v[202:203], v[50:51]
v_pk_fma_f32 v[204:205], v[50:51], v[50:51], v[204:205]
v_pk_add_f32 v[198:199], v[198:199], v[52:53]
v_pk_fma_f32 v[200:201], v[52:53], v[52:53], v[200:201]
v_pk_add_f32 v[198:199], v[198:199], v[54:55]
v_pk_fma_f32 v[200:201], v[54:55], v[54:55], v[200:201]
v_pk_add_f32 v[202:203], v[202:203], v[56:57]
v_pk_fma_f32 v[204:205], v[56:57], v[56:57], v[204:205]
v_pk_add_f32 v[202:203], v[202:203], v[58:59]
v_pk_fma_f32 v[204:205], v[58:59], v[58:59], v[204:205]
v_pk_add_f32 v[198:199], v[198:199], v[60:61]
v_pk_fma_f32 v[200:201], v[60:61], v[60:61], v[200:201]
v_pk_add_f32 v[198:199], v[198:199], v[62:63]
v_pk_fma_f32 v[200:201], v[62:63], v[62:63], v[200:201]
v_pk_add_f32 v[202:203], v[202:203], v[64:65]
v_pk_fma_f32 v[204:205], v[64:65], v[64:65], v[204:205]
v_pk_add_f32 v[202:203], v[202:203], v[66:67]
v_pk_fma_f32 v[204:205], v[66:67], v[66:67], v[204:205]
v_pk_add_f32 v[198:199], v[198:199], v[68:69]
v_pk_fma_f32 v[200:201], v[68:69], v[68:69], v[200:201]
v_pk_add_f32 v[198:199], v[198:199], v[70:71]
v_pk_fma_f32 v[200:201], v[70:71], v[70:71], v[200:201]
v_pk_add_f32 v[202:203], v[202:203], v[72:73]
v_pk_fma_f32 v[204:205], v[72:73], v[72:73], v[204:205]
v_pk_add_f32 v[202:203], v[202:203], v[74:75]
v_pk_fma_f32 v[204:205], v[74:75], v[74:75], v[204:205]
v_pk_add_f32 v[198:199], v[198:199], v[76:77]
v_pk_fma_f32 v[200:201], v[76:77], v[76:77], v[200:201]
v_pk_add_f32 v[198:199], v[198:199], v[78:79]
v_pk_fma_f32 v[200:201], v[78:79], v[78:79], v[200:201]
v_pk_add_f32 v[202:203], v[202:203], v[80:81]
v_pk_fma_f32 v[204:205], v[80:81], v[80:81], v[204:205]
v_pk_add_f32 v[202:203], v[202:203], v[82:83]
v_pk_fma_f32 v[204:205], v[82:83], v[82:83], v[204:205]
v_pk_add_f32 v[198:199], v[198:199], v[84:85]
v_pk_fma_f32 v[200:201], v[84:85], v[84:85], v[200:201]
v_pk_add_f32 v[198:199], v[198:199], v[86:87]
v_pk_fma_f32 v[200:201], v[86:87], v[86:87], v[200:201]
v_pk_add_f32 v[202:203], v[202:203], v[88:89]
v_pk_fma_f32 v[204:205], v[88:89], v[88:89], v[204:205]
v_pk_add_f32 v[202:203], v[202:203], v[90:91]
v_pk_fma_f32 v[204:205], v[90:91], v[90:91], v[204:205]
v_pk_add_f32 v[198:199], v[198:199], v[92:93]
v_pk_fma_f32 v[200:201], v[92:93], v[92:93], v[200:201]
v_pk_add_f32 v[198:199], v[198:199], v[94:95]
v_pk_fma_f32 v[200:201], v[94:95], v[94:95], v[200:201]
v_pk_add_f32 v[202:203], v[202:203], v[96:97]
v_pk_fma_f32 v[204:205], v[96:97], v[96:97], v[204:205]
v_pk_add_f32 v[202:203], v[202:203], v[98:99]
v_pk_fma_f32 v[204:205], v[98:99], v[98:99], v[204:205]
v_pk_add_f32 v[198:199], v[198:199], v[100:101]
v_pk_fma_f32 v[200:201], v[100:101], v[100:101], v[200:201]
v_pk_add_f32 v[198:199], v[198:199], v[102:103]
v_pk_fma_f32 v[200:201], v[102:103], v[102:103], v[200:201]
v_pk_add_f32 v[202:203], v[202:203], v[104:105]
v_pk_fma_f32 v[204:205], v[104:105], v[104:105], v[204:205]
v_pk_add_f32 v[202:203], v[202:203], v[106:107]
v_pk_fma_f32 v[204:205], v[106:107], v[106:107], v[204:205]
v_mfma_f32_16x16x32_bf16 v[124:127], a[148:151], a[40:43], v[124:127]
s_add_u32 m0, s38, 160768
v_add_f32 v198, v198, v199
v_add_f32 v202, v202, v203
v_mfma_f32_16x16x32_bf16 v[128:131], a[148:151], a[44:47], v[128:131]
s_waitcnt lgkmcnt(4)
s_add_u32 s39, s38, s82
v_add_f32 v200, v200, v201
v_add_f32 v204, v204, v205
v_permlane16_swap_b32 v198, v202
v_mfma_f32_16x16x32_bf16 v[116:119], a[152:155], a[48:51], v[116:119]
ds_read_b128 a[144:147], v209 offset:9216
ds_read_b128 a[148:151], v209 offset:27648
s_nop 0
v_mfma_f32_16x16x32_bf16 v[120:123], a[152:155], a[52:55], v[120:123]
s_add_u32 s39, s39, 339968
v_permlane16_swap_b32 v200, v204
v_add_f32 v198, v198, v202
v_mfma_f32_16x16x32_bf16 v[124:127], a[156:159], a[48:51], v[124:127]
s_mov_b64 exec, 0xffff
buffer_load_dwordx4 v1, s[4:7], s39 offen sc1 lds
s_mov_b64 exec, -1
v_add_f32 v199, v200, v204
v_mov_b32 v200, v198
v_mfma_f32_16x16x32_bf16 v[128:131], a[156:159], a[52:55], v[128:131]
s_waitcnt lgkmcnt(4)
v_mov_b32 v201, v199
s_nop 0
v_permlane32_swap_b32 v198, v200
v_mfma_f32_16x16x32_bf16 v[116:119], a[160:163], a[56:59], v[116:119]
ds_read_b128 a[152:155], v209 offset:10240
ds_read_b128 a[156:159], v209 offset:28672
v_permlane32_swap_b32 v199, v201
v_mfma_f32_16x16x32_bf16 v[120:123], a[160:163], a[60:63], v[120:123]
v_add_f32 v198, v198, v200
v_add_f32 v199, v199, v201
v_mfma_f32_16x16x32_bf16 v[124:127], a[164:167], a[56:59], v[124:127]
s_waitcnt vmcnt(21)
s_mov_b32 exec_hi, 0
buffer_store_dwordx2 v[198:199], v239, s[8:11], s30 offen sc1
s_mov_b64 exec, -1
v_mfma_f32_16x16x32_bf16 v[128:131], a[164:167], a[60:63], v[128:131]
s_waitcnt lgkmcnt(4)
v_mfma_f32_16x16x32_bf16 v[116:119], a[168:171], a[64:67], v[116:119]
ds_read_b128 a[160:163], v209 offset:11264
ds_read_b128 a[164:167], v209 offset:29696
v_mfma_f32_16x16x32_bf16 v[120:123], a[168:171], a[68:71], v[120:123]
v_mfma_f32_16x16x32_bf16 v[124:127], a[172:175], a[64:67], v[124:127]
v_mfma_f32_16x16x32_bf16 v[128:131], a[172:175], a[68:71], v[128:131]
s_waitcnt lgkmcnt(4)
v_mfma_f32_16x16x32_bf16 v[116:119], a[144:147], a[72:75], v[116:119]
ds_read_b128 a[168:171], v209 offset:12288
ds_read_b128 a[172:175], v209 offset:30720
v_mfma_f32_16x16x32_bf16 v[120:123], a[144:147], a[76:79], v[120:123]
v_mfma_f32_16x16x32_bf16 v[124:127], a[148:151], a[72:75], v[124:127]
v_mfma_f32_16x16x32_bf16 v[128:131], a[148:151], a[76:79], v[128:131]
s_waitcnt lgkmcnt(4)
v_mfma_f32_16x16x32_bf16 v[116:119], a[152:155], a[80:83], v[116:119]
ds_read_b128 a[144:147], v209 offset:13312
ds_read_b128 a[148:151], v209 offset:31744
v_mfma_f32_16x16x32_bf16 v[120:123], a[152:155], a[84:87], v[120:123]
v_mfma_f32_16x16x32_bf16 v[124:127], a[156:159], a[80:83], v[124:127]
v_mfma_f32_16x16x32_bf16 v[128:131], a[156:159], a[84:87], v[128:131]
s_waitcnt lgkmcnt(4)
v_mfma_f32_16x16x32_bf16 v[116:119], a[160:163], a[88:91], v[116:119]
ds_read_b128 a[152:155], v209 offset:14336
ds_read_b128 a[156:159], v209 offset:32768
v_mfma_f32_16x16x32_bf16 v[120:123], a[160:163], a[92:95], v[120:123]
v_mfma_f32_16x16x32_bf16 v[124:127], a[164:167], a[88:91], v[124:127]
v_mfma_f32_16x16x32_bf16 v[128:131], a[164:167], a[92:95], v[128:131]
s_waitcnt lgkmcnt(4)
v_mfma_f32_16x16x32_bf16 v[116:119], a[168:171], a[96:99], v[116:119]
ds_read_b128 a[160:163], v209 offset:15360
ds_read_b128 a[164:167], v209 offset:33792
v_mfma_f32_16x16x32_bf16 v[120:123], a[168:171], a[100:103], v[120:123]
v_mfma_f32_16x16x32_bf16 v[124:127], a[172:175], a[96:99], v[124:127]
v_mfma_f32_16x16x32_bf16 v[128:131], a[172:175], a[100:103], v[128:131]
s_waitcnt lgkmcnt(4)
v_mfma_f32_16x16x32_bf16 v[116:119], a[144:147], a[104:107], v[116:119]
ds_read_b128 a[168:171], v209 offset:16384
ds_read_b128 a[172:175], v209 offset:34816
v_mfma_f32_16x16x32_bf16 v[120:123], a[144:147], a[108:111], v[120:123]
v_mfma_f32_16x16x32_bf16 v[124:127], a[148:151], a[104:107], v[124:127]
v_mfma_f32_16x16x32_bf16 v[128:131], a[148:151], a[108:111], v[128:131]
s_waitcnt lgkmcnt(4)
v_mfma_f32_16x16x32_bf16 v[116:119], a[152:155], a[112:115], v[116:119]
ds_read_b128 a[144:147], v209 offset:17408
ds_read_b128 a[148:151], v209 offset:35840
v_mfma_f32_16x16x32_bf16 v[120:123], a[152:155], a[116:119], v[120:123]
v_mfma_f32_16x16x32_bf16 v[124:127], a[156:159], a[112:115], v[124:127]
v_mfma_f32_16x16x32_bf16 v[128:131], a[156:159], a[116:119], v[128:131]
s_waitcnt lgkmcnt(4)
v_add_u32 v181, 36864, v239
v_mfma_f32_16x16x32_bf16 v[116:119], a[160:163], a[120:123], v[116:119]
ds_read_b64 a[152:153], v181 offset:0
ds_read_b64 a[156:157], v181 offset:512
v_mfma_f32_16x16x32_bf16 v[120:123], a[160:163], a[124:127], v[120:123]
v_mfma_f32_16x16x32_bf16 v[124:127], a[164:167], a[120:123], v[124:127]
v_mfma_f32_16x16x32_bf16 v[128:131], a[164:167], a[124:127], v[128:131]
s_waitcnt lgkmcnt(4)
v_mfma_f32_16x16x32_bf16 v[116:119], a[168:171], a[128:131], v[116:119]
ds_read_b128 a[160:163], v210 offset:0
ds_read_b128 a[164:167], v210 offset:18432
v_mfma_f32_16x16x32_bf16 v[120:123], a[168:171], a[132:135], v[120:123]
buffer_load_dwordx2 v[182:183], v234, s[8:11], s61 offen offset:0 sc1
v_mfma_f32_16x16x32_bf16 v[124:127], a[172:175], a[128:131], v[124:127]
buffer_load_dwordx2 v[184:185], v234, s[8:11], s61 offen offset:1024 sc1
v_mfma_f32_16x16x32_bf16 v[128:131], a[172:175], a[132:135], v[128:131]
s_waitcnt lgkmcnt(4)
v_mfma_f32_16x16x32_bf16 v[116:119], a[144:147], a[136:139], v[116:119]
ds_read_b128 a[168:171], v210 offset:1024
ds_read_b128 a[172:175], v210 offset:19456
v_mfma_f32_16x16x32_bf16 v[120:123], a[144:147], a[140:143], v[120:123]
buffer_load_dwordx2 v[186:187], v234, s[8:11], s61 offen offset:2048 sc1
v_mfma_f32_16x16x32_bf16 v[124:127], a[148:151], a[136:139], v[124:127]
buffer_load_dwordx2 v[188:189], v234, s[8:11], s61 offen offset:3072 sc1
v_mfma_f32_16x16x32_bf16 v[128:131], a[148:151], a[140:143], v[128:131]
s_waitcnt lgkmcnt(4)
v_mfma_f32_16x16x16_bf16 v[116:119], a[152:153], v[212:213], v[116:119]
ds_read_b128 a[144:147], v210 offset:2048
ds_read_b128 a[148:151], v210 offset:20480
v_mfma_f32_16x16x16_bf16 v[120:123], a[152:153], v[214:215], v[120:123]
buffer_load_dwordx2 v[190:191], v235, s[8:11], s61 offen offset:0 sc1
v_mfma_f32_16x16x16_bf16 v[124:127], a[156:157], v[212:213], v[124:127]
buffer_load_dwordx2 v[192:193], v235, s[8:11], s61 offen offset:1024 sc1
v_mfma_f32_16x16x16_bf16 v[128:131], a[156:157], v[214:215], v[128:131]
s_waitcnt vmcnt(17) lgkmcnt(4)
s_barrier
v_mfma_f32_16x16x32_bf16 v[132:135], a[160:163], a[0:3], 0
ds_read_b128 a[152:155], v210 offset:3072
ds_read_b128 a[156:159], v210 offset:21504
v_mfma_f32_16x16x32_bf16 v[136:139], a[160:163], a[4:7], 0
buffer_load_dwordx2 v[194:195], v235, s[8:11], s61 offen offset:2048 sc1
v_mfma_f32_16x16x32_bf16 v[140:143], a[164:167], a[0:3], 0
buffer_load_dwordx2 v[196:197], v235, s[8:11], s61 offen offset:3072 sc1
v_mfma_f32_16x16x32_bf16 v[144:147], a[164:167], a[4:7], 0
s_waitcnt lgkmcnt(4)
v_mfma_f32_16x16x32_bf16 v[132:135], a[168:171], a[8:11], v[132:135]
ds_read_b128 a[160:163], v210 offset:4096
ds_read_b128 a[164:167], v210 offset:22528
v_mfma_f32_16x16x32_bf16 v[136:139], a[168:171], a[12:15], v[136:139]
v_mfma_f32_16x16x32_bf16 v[140:143], a[172:175], a[8:11], v[140:143]
v_mfma_f32_16x16x32_bf16 v[144:147], a[172:175], a[12:15], v[144:147]
s_waitcnt lgkmcnt(4)
v_mfma_f32_16x16x32_bf16 v[132:135], a[144:147], a[16:19], v[132:135]
ds_read_b128 a[168:171], v210 offset:5120
ds_read_b128 a[172:175], v210 offset:23552
v_mfma_f32_16x16x32_bf16 v[136:139], a[144:147], a[20:23], v[136:139]
v_mfma_f32_16x16x32_bf16 v[140:143], a[148:151], a[16:19], v[140:143]
v_mfma_f32_16x16x32_bf16 v[144:147], a[148:151], a[20:23], v[144:147]
s_waitcnt lgkmcnt(4)
v_mfma_f32_16x16x32_bf16 v[132:135], a[152:155], a[24:27], v[132:135]
ds_read_b128 a[144:147], v210 offset:6144
ds_read_b128 a[148:151], v210 offset:24576
v_mfma_f32_16x16x32_bf16 v[136:139], a[152:155], a[28:31], v[136:139]
v_mfma_f32_16x16x32_bf16 v[140:143], a[156:159], a[24:27], v[140:143]
v_mfma_f32_16x16x32_bf16 v[144:147], a[156:159], a[28:31], v[144:147]
s_waitcnt lgkmcnt(4)
v_mfma_f32_16x16x32_bf16 v[132:135], a[160:163], a[32:35], v[132:135]
ds_read_b128 a[152:155], v210 offset:7168
ds_read_b128 a[156:159], v210 offset:25600
v_mfma_f32_16x16x32_bf16 v[136:139], a[160:163], a[36:39], v[136:139]
v_mfma_f32_16x16x32_bf16 v[140:143], a[164:167], a[32:35], v[140:143]
v_mfma_f32_16x16x32_bf16 v[144:147], a[164:167], a[36:39], v[144:147]
s_waitcnt lgkmcnt(4)
v_mfma_f32_16x16x32_bf16 v[132:135], a[168:171], a[40:43], v[132:135]
ds_read_b128 a[160:163], v210 offset:8192
ds_read_b128 a[164:167], v210 offset:26624
v_mfma_f32_16x16x32_bf16 v[136:139], a[168:171], a[44:47], v[136:139]
v_mfma_f32_16x16x32_bf16 v[140:143], a[172:175], a[40:43], v[140:143]
v_mfma_f32_16x16x32_bf16 v[144:147], a[172:175], a[44:47], v[144:147]
s_waitcnt lgkmcnt(4)
v_mfma_f32_16x16x32_bf16 v[132:135], a[144:147], a[48:51], v[132:135]
ds_read_b128 a[168:171], v210 offset:9216
ds_read_b128 a[172:175], v210 offset:27648
v_mfma_f32_16x16x32_bf16 v[136:139], a[144:147], a[52:55], v[136:139]
v_mfma_f32_16x16x32_bf16 v[140:143], a[148:151], a[48:51], v[140:143]
v_mfma_f32_16x16x32_bf16 v[144:147], a[148:151], a[52:55], v[144:147]
s_waitcnt lgkmcnt(4)
v_mfma_f32_16x16x32_bf16 v[132:135], a[152:155], a[56:59], v[132:135]
ds_read_b128 a[144:147], v210 offset:10240
ds_read_b128 a[148:151], v210 offset:28672
v_mfma_f32_16x16x32_bf16 v[136:139], a[152:155], a[60:63], v[136:139]
v_mfma_f32_16x16x32_bf16 v[140:143], a[156:159], a[56:59], v[140:143]
v_mfma_f32_16x16x32_bf16 v[144:147], a[156:159], a[60:63], v[144:147]
s_waitcnt lgkmcnt(4)
v_mfma_f32_16x16x32_bf16 v[132:135], a[160:163], a[64:67], v[132:135]
ds_read_b128 a[152:155], v210 offset:11264
ds_read_b128 a[156:159], v210 offset:29696
v_mfma_f32_16x16x32_bf16 v[136:139], a[160:163], a[68:71], v[136:139]
v_mfma_f32_16x16x32_bf16 v[140:143], a[164:167], a[64:67], v[140:143]
v_mfma_f32_16x16x32_bf16 v[144:147], a[164:167], a[68:71], v[144:147]
s_waitcnt lgkmcnt(4)
v_mfma_f32_16x16x32_bf16 v[132:135], a[168:171], a[72:75], v[132:135]
ds_read_b128 a[160:163], v210 offset:12288
ds_read_b128 a[164:167], v210 offset:30720
v_mfma_f32_16x16x32_bf16 v[136:139], a[168:171], a[76:79], v[136:139]
v_mfma_f32_16x16x32_bf16 v[140:143], a[172:175], a[72:75], v[140:143]
s_waitcnt vmcnt(0)
v_min3_f32 v200, v183, v185, v187
v_mfma_f32_16x16x32_bf16 v[144:147], a[172:175], a[76:79], v[144:147]
s_waitcnt lgkmcnt(4)
v_min3_f32 v201, v189, v191, v193
v_mfma_f32_16x16x32_bf16 v[132:135], a[144:147], a[80:83], v[132:135]
ds_read_b128 a[168:171], v210 offset:13312
ds_read_b128 a[172:175], v210 offset:31744
v_mfma_f32_16x16x32_bf16 v[136:139], a[144:147], a[84:87], v[136:139]
v_min3_f32 v200, v200, v195, v197
v_min_f32 v200, v200, v201
v_mfma_f32_16x16x32_bf16 v[140:143], a[148:151], a[80:83], v[140:143]
v_cmp_gt_f32 vcc, 0, v200
v_mfma_f32_16x16x32_bf16 v[144:147], a[148:151], a[84:87], v[144:147]
s_waitcnt lgkmcnt(4)
s_nop 0
s_cbranch_vccnz L_stzslow_23
L_stzback_24:
v_mfma_f32_16x16x32_bf16 v[132:135], a[152:155], a[88:91], v[132:135]
ds_read_b128 a[144:147], v210 offset:14336
ds_read_b128 a[148:151], v210 offset:32768
v_mfma_f32_16x16x32_bf16 v[136:139], a[152:155], a[92:95], v[136:139]
v_add_f32 v198, v182, v184
v_add_f32 v199, v183, v185
v_mfma_f32_16x16x32_bf16 v[140:143], a[156:159], a[88:91], v[140:143]
buffer_load_dwordx4 a[176:179], v1, s[4:7], s52 offen offset:0 sc1
buffer_load_dwordx4 a[180:183], v9, s[4:7], s52 offen offset:0 sc1
v_add_f32 v198, v198, v186
v_add_f32 v199, v199, v187
v_mfma_f32_16x16x32_bf16 v[144:147], a[156:159], a[92:95], v[144:147]
s_waitcnt lgkmcnt(4)
v_add_f32 v198, v198, v188
v_add_f32 v199, v199, v189
v_mfma_f32_16x16x32_bf16 v[132:135], a[160:163], a[96:99], v[132:135]
ds_read_b128 a[152:155], v210 offset:15360
ds_read_b128 a[156:159], v210 offset:33792
v_add_f32 v198, v198, v190
v_mfma_f32_16x16x32_bf16 v[136:139], a[160:163], a[100:103], v[136:139]
v_add_f32 v199, v199, v191
v_add_f32 v198, v198, v192
v_mfma_f32_16x16x32_bf16 v[140:143], a[164:167], a[96:99], v[140:143]
buffer_load_dwordx4 a[184:187], v1, s[4:7], s52 offen offset:1024 sc1
buffer_load_dwordx4 a[188:191], v9, s[4:7], s52 offen offset:1024 sc1
v_add_f32 v199, v199, v193
v_add_f32 v198, v198, v194
v_mfma_f32_16x16x32_bf16 v[144:147], a[164:167], a[100:103], v[144:147]
s_waitcnt lgkmcnt(4)
v_add_f32 v199, v199, v195
v_add_f32 v198, v198, v196
v_mfma_f32_16x16x32_bf16 v[132:135], a[168:171], a[104:107], v[132:135]
ds_read_b128 a[160:163], v210 offset:16384
ds_read_b128 a[164:167], v210 offset:34816
v_add_f32 v199, v199, v197
v_mov_b32 v200, v198
v_mfma_f32_16x16x32_bf16 v[136:139], a[168:171], a[108:111], v[136:139]
v_mov_b32 v201, v199
s_nop 0
v_mfma_f32_16x16x32_bf16 v[140:143], a[172:175], a[104:107], v[140:143]
v_permlane32_swap_b32 v198, v200
v_mfma_f32_16x16x32_bf16 v[144:147], a[172:175], a[108:111], v[144:147]
s_waitcnt lgkmcnt(4)
v_permlane32_swap_b32 v199, v201
v_mfma_f32_16x16x32_bf16 v[132:135], a[144:147], a[112:115], v[132:135]
ds_read_b128 a[168:171], v210 offset:17408
ds_read_b128 a[172:175], v210 offset:35840
v_add_f32 v198, v198, v200
v_mfma_f32_16x16x32_bf16 v[136:139], a[144:147], a[116:119], v[136:139]
buffer_load_dwordx4 a[192:195], v1, s[4:7], s52 offen offset:2048 sc1
buffer_load_dwordx4 a[196:199], v9, s[4:7], s52 offen offset:2048 sc1
v_add_f32 v199, v199, v201
v_mul_f32 v198, 0x39e38e39, v198
v_mfma_f32_16x16x32_bf16 v[140:143], a[148:151], a[112:115], v[140:143]
v_mul_f32 v200, v198, v198
v_mul_f32 v199, 0x39e38e39, v199
v_mfma_f32_16x16x32_bf16 v[144:147], a[148:151], a[116:119], v[144:147]
s_waitcnt lgkmcnt(4)
v_sub_f32 v199, v199, v200
v_add_u32 v181, 74752, v239
v_mfma_f32_16x16x32_bf16 v[132:135], a[152:155], a[120:123], v[132:135]
ds_read_b64 a[144:145], v181 offset:0
ds_read_b64 a[148:149], v181 offset:512
v_max_f32 v199, 0, v199
v_add_f32 v199, 0x3727c5ac, v199
v_mfma_f32_16x16x32_bf16 v[136:139], a[152:155], a[124:127], v[136:139]
buffer_load_dwordx4 a[200:203], v1, s[4:7], s52 offen offset:3072 sc1
buffer_load_dwordx4 a[204:207], v9, s[4:7], s52 offen offset:3072 sc1
v_rsq_f32 v202, v199
v_mfma_f32_16x16x32_bf16 v[140:143], a[156:159], a[120:123], v[140:143]
s_nop 0
v_mul_f32 v204, v198, v202
v_mov_b32 v203, v202
v_mfma_f32_16x16x32_bf16 v[144:147], a[156:159], a[124:127], v[144:147]
s_waitcnt lgkmcnt(4)
v_mov_b32 v205, v204
s_nop 0
v_mfma_f32_16x16x32_bf16 v[132:135], a[160:163], a[128:131], v[132:135]
ds_read_b128 a[152:155], v211 offset:0
ds_read_b128 a[156:159], v211 offset:18432
v_mfma_f32_16x16x32_bf16 v[136:139], a[160:163], a[132:135], v[136:139]
s_mov_b32 s52, s53
v_permlane16_swap_b32 v202, v203
v_mfma_f32_16x16x32_bf16 v[140:143], a[164:167], a[128:131], v[140:143]
s_cmp_eq_u32 s25, 0
s_cselect_b32 s98, 4096, 0
v_permlane16_swap_b32 v204, v205
v_mfma_f32_16x16x32_bf16 v[144:147], a[164:167], a[132:135], v[144:147]
s_waitcnt lgkmcnt(4)
v_fma_f32 v36, v36, v202, -v204
v_fma_f32 v37, v37, v202, -v204
v_mfma_f32_16x16x32_bf16 v[132:135], a[168:171], a[136:139], v[132:135]
ds_read_b128 a[160:163], v211 offset:1024
ds_read_b128 a[164:167], v211 offset:19456
v_fma_f32 v38, v38, v202, -v204
v_mfma_f32_16x16x32_bf16 v[136:139], a[168:171], a[140:143], v[136:139]
s_add_u32 s52, s52, s98
v_fma_f32 v39, v39, v202, -v204
v_fma_f32 v44, v44, v202, -v204
v_mfma_f32_16x16x32_bf16 v[140:143], a[172:175], a[136:139], v[140:143]
v_fma_f32 v45, v45, v202, -v204
v_fma_f32 v46, v46, v202, -v204
v_mfma_f32_16x16x32_bf16 v[144:147], a[172:175], a[140:143], v[144:147]
s_waitcnt lgkmcnt(4)
v_fma_f32 v47, v47, v202, -v204
v_cvt_pk_bf16_f32 v216, v36, v37
v_mfma_f32_16x16x16_bf16 v[132:135], a[144:145], v[212:213], v[132:135]
ds_read_b128 a[168:171], v211 offset:2048
ds_read_b128 a[172:175], v211 offset:20480
v_cvt_pk_bf16_f32 v217, v38, v39
v_cvt_pk_bf16_f32 v218, v44, v45
v_mfma_f32_16x16x16_bf16 v[136:139], a[144:145], v[214:215], v[136:139]
v_cvt_pk_bf16_f32 v219, v46, v47
v_mfma_f32_16x16x16_bf16 v[140:143], a[148:149], v[212:213], v[140:143]
ds_write_b128 v236, v[216:219] offset:0
v_fma_f32 v40, v40, v203, -v205
v_mfma_f32_16x16x16_bf16 v[144:147], a[148:149], v[214:215], v[144:147]
s_waitcnt lgkmcnt(5)
v_fma_f32 v41, v41, v203, -v205
v_fma_f32 v42, v42, v203, -v205
s_barrier
v_mfma_f32_16x16x32_bf16 v[148:151], a[152:155], a[0:3], 0
ds_read_b128 a[144:147], v211 offset:3072
ds_read_b128 a[148:151], v211 offset:21504
v_fma_f32 v43, v43, v203, -v205
v_fma_f32 v48, v48, v203, -v205
v_mfma_f32_16x16x32_bf16 v[152:155], a[152:155], a[4:7], 0
buffer_load_dwordx4 a[208:211], v1, s[4:7], s52 offen offset:0 sc1
buffer_load_dwordx4 a[212:215], v9, s[4:7], s52 offen offset:0 sc1
v_fma_f32 v49, v49, v203, -v205
v_fma_f32 v50, v50, v203, -v205
v_mfma_f32_16x16x32_bf16 v[156:159], a[156:159], a[0:3], 0
buffer_load_dwordx4 a[216:219], v1, s[4:7], s52 offen offset:1024 sc1
buffer_load_dwordx4 a[220:223], v9, s[4:7], s52 offen offset:1024 sc1
v_fma_f32 v51, v51, v203, -v205
v_mfma_f32_16x16x32_bf16 v[160:163], a[156:159], a[4:7], 0
s_waitcnt lgkmcnt(5)
v_cvt_pk_bf16_f32 v220, v40, v41
v_cvt_pk_bf16_f32 v221, v42, v43
v_mfma_f32_16x16x32_bf16 v[148:151], a[160:163], a[8:11], v[148:151]
ds_read_b128 a[152:155], v211 offset:4096
ds_read_b128 a[156:159], v211 offset:22528
v_cvt_pk_bf16_f32 v222, v48, v49
v_cvt_pk_bf16_f32 v223, v50, v51
v_mfma_f32_16x16x32_bf16 v[152:155], a[160:163], a[12:15], v[152:155]
ds_write_b128 v236, v[220:223] offset:4608
v_mfma_f32_16x16x32_bf16 v[156:159], a[164:167], a[8:11], v[156:159]
ds_read_b64_tr_b16 v[36:37], v237 offset:0
ds_read_b64_tr_b16 v[38:39], v237 offset:1152
ds_read_b64_tr_b16 v[40:41], v237 offset:8
ds_read_b64_tr_b16 v[42:43], v237 offset:1160
v_mfma_f32_16x16x32_bf16 v[160:163], a[164:167], a[12:15], v[160:163]
s_waitcnt lgkmcnt(10)
v_fma_f32 v52, v52, v202, -v204
v_fma_f32 v53, v53, v202, -v204
v_mfma_f32_16x16x32_bf16 v[148:151], a[168:171], a[16:19], v[148:151]
ds_read_b128 a[160:163], v211 offset:5120
ds_read_b128 a[164:167], v211 offset:23552
v_mfma_f32_16x16x32_bf16 v[152:155], a[168:171], a[20:23], v[152:155]
buffer_load_dwordx4 a[224:227], v1, s[4:7], s52 offen offset:2048 sc1
buffer_load_dwordx4 a[228:231], v9, s[4:7], s52 offen offset:2048 sc1
v_mfma_f32_16x16x32_bf16 v[156:159], a[172:175], a[16:19], v[156:159]
v_fma_f32 v54, v54, v202, -v204
v_fma_f32 v55, v55, v202, -v204
v_mfma_f32_16x16x32_bf16 v[160:163], a[172:175], a[20:23], v[160:163]
s_waitcnt lgkmcnt(9)
v_fma_f32 v60, v60, v202, -v204
v_fma_f32 v61, v61, v202, -v204
v_mfma_f32_16x16x32_bf16 v[148:151], a[144:147], a[24:27], v[148:151]
ds_read_b128 a[168:171], v211 offset:6144
ds_read_b128 a[172:175], v211 offset:24576
v_mfma_f32_16x16x32_bf16 v[152:155], a[144:147], a[28:31], v[152:155]
buffer_load_dwordx4 a[232:235], v1, s[4:7], s52 offen offset:3072 sc1
buffer_load_dwordx4 a[236:239], v9, s[4:7], s52 offen offset:3072 sc1
v_fma_f32 v62, v62, v202, -v204
v_mfma_f32_16x16x32_bf16 v[156:159], a[148:151], a[24:27], v[156:159]
v_fma_f32 v63, v63, v202, -v204
v_cvt_pk_bf16_f32 v224, v52, v53
v_mfma_f32_16x16x32_bf16 v[160:163], a[148:151], a[28:31], v[160:163]
s_waitcnt lgkmcnt(9)
v_cvt_pk_bf16_f32 v225, v54, v55
v_cvt_pk_bf16_f32 v226, v60, v61
v_mfma_f32_16x16x32_bf16 v[148:151], a[152:155], a[32:35], v[148:151]
ds_read_b128 a[144:147], v211 offset:7168
ds_read_b128 a[148:151], v211 offset:25600
v_mfma_f32_16x16x32_bf16 v[152:155], a[152:155], a[36:39], v[152:155]
v_cvt_pk_bf16_f32 v227, v62, v63
v_mfma_f32_16x16x32_bf16 v[156:159], a[156:159], a[32:35], v[156:159]
ds_write_b128 v236, v[224:227] offset:64
v_mfma_f32_16x16x32_bf16 v[160:163], a[156:159], a[36:39], v[160:163]
s_waitcnt lgkmcnt(5)
buffer_store_dwordx4 v[36:39], v1, s[8:11], s66 offen offset:0 sc1
v_mfma_f32_16x16x32_bf16 v[148:151], a[160:163], a[40:43], v[148:151]
ds_read_b128 a[152:155], v211 offset:8192
ds_read_b128 a[156:159], v211 offset:26624
v_mfma_f32_16x16x32_bf16 v[152:155], a[160:163], a[44:47], v[152:155]
v_fma_f32 v56, v56, v203, -v205
v_fma_f32 v57, v57, v203, -v205
v_mfma_f32_16x16x32_bf16 v[156:159], a[164:167], a[40:43], v[156:159]
v_fma_f32 v58, v58, v203, -v205
v_fma_f32 v59, v59, v203, -v205
v_mfma_f32_16x16x32_bf16 v[160:163], a[164:167], a[44:47], v[160:163]
s_waitcnt lgkmcnt(5)
v_fma_f32 v64, v64, v203, -v205
v_fma_f32 v65, v65, v203, -v205
v_mfma_f32_16x16x32_bf16 v[148:151], a[168:171], a[48:51], v[148:151]
ds_read_b128 a[160:163], v211 offset:9216
ds_read_b128 a[164:167], v211 offset:27648
v_mfma_f32_16x16x32_bf16 v[152:155], a[168:171], a[52:55], v[152:155]
v_fma_f32 v66, v66, v203, -v205
v_fma_f32 v67, v67, v203, -v205
v_mfma_f32_16x16x32_bf16 v[156:159], a[172:175], a[48:51], v[156:159]
v_cvt_pk_bf16_f32 v228, v56, v57
v_cvt_pk_bf16_f32 v229, v58, v59
v_mfma_f32_16x16x32_bf16 v[160:163], a[172:175], a[52:55], v[160:163]
s_waitcnt lgkmcnt(5)
v_cvt_pk_bf16_f32 v230, v64, v65
v_cvt_pk_bf16_f32 v231, v66, v67
v_mfma_f32_16x16x32_bf16 v[148:151], a[144:147], a[56:59], v[148:151]
ds_read_b128 a[168:171], v211 offset:10240
ds_read_b128 a[172:175], v211 offset:28672
v_mfma_f32_16x16x32_bf16 v[152:155], a[144:147], a[60:63], v[152:155]
ds_write_b128 v236, v[228:231] offset:4672
v_mfma_f32_16x16x32_bf16 v[156:159], a[148:151], a[56:59], v[156:159]
ds_read_b64_tr_b16 v[52:53], v237 offset:64
ds_read_b64_tr_b16 v[54:55], v237 offset:1216
v_mfma_f32_16x16x32_bf16 v[160:163], a[148:151], a[60:63], v[160:163]
s_waitcnt lgkmcnt(7)
v_mfma_f32_16x16x32_bf16 v[148:151], a[152:155], a[64:67], v[148:151]
ds_read_b128 a[144:147], v211 offset:11264
ds_read_b128 a[148:151], v211 offset:29696
ds_read_b64_tr_b16 v[56:57], v237 offset:72
ds_read_b64_tr_b16 v[58:59], v237 offset:1224
buffer_store_dwordx4 v[40:43], v1, s[8:11], s66 offen offset:1024 sc1
v_mfma_f32_16x16x32_bf16 v[152:155], a[152:155], a[68:71], v[152:155]
v_fma_f32 v68, v68, v202, -v204
v_fma_f32 v69, v69, v202, -v204
v_mfma_f32_16x16x32_bf16 v[156:159], a[156:159], a[64:67], v[156:159]
v_fma_f32 v70, v70, v202, -v204
v_mfma_f32_16x16x32_bf16 v[160:163], a[156:159], a[68:71], v[160:163]
s_waitcnt lgkmcnt(9)
v_fma_f32 v71, v71, v202, -v204
v_mfma_f32_16x16x32_bf16 v[148:151], a[160:163], a[72:75], v[148:151]
ds_read_b128 a[152:155], v211 offset:12288
ds_read_b128 a[156:159], v211 offset:30720
v_mfma_f32_16x16x32_bf16 v[152:155], a[160:163], a[76:79], v[152:155]
v_fma_f32 v76, v76, v202, -v204
v_fma_f32 v77, v77, v202, -v204
v_mfma_f32_16x16x32_bf16 v[156:159], a[164:167], a[72:75], v[156:159]
v_fma_f32 v78, v78, v202, -v204
v_mfma_f32_16x16x32_bf16 v[160:163], a[164:167], a[76:79], v[160:163]
s_waitcnt lgkmcnt(9)
v_fma_f32 v79, v79, v202, -v204
v_cvt_pk_bf16_f32 v216, v68, v69
v_mfma_f32_16x16x32_bf16 v[148:151], a[168:171], a[80:83], v[148:151]
ds_read_b128 a[160:163], v211 offset:13312
ds_read_b128 a[164:167], v211 offset:31744
v_mfma_f32_16x16x32_bf16 v[152:155], a[168:171], a[84:87], v[152:155]
v_cvt_pk_bf16_f32 v217, v70, v71
v_cvt_pk_bf16_f32 v218, v76, v77
v_mfma_f32_16x16x32_bf16 v[156:159], a[172:175], a[80:83], v[156:159]
v_cvt_pk_bf16_f32 v219, v78, v79
v_mfma_f32_16x16x32_bf16 v[160:163], a[172:175], a[84:87], v[160:163]
s_waitcnt lgkmcnt(6)
v_mfma_f32_16x16x32_bf16 v[148:151], a[144:147], a[88:91], v[148:151]
ds_read_b128 a[168:171], v211 offset:14336
ds_read_b128 a[172:175], v211 offset:32768
v_mfma_f32_16x16x32_bf16 v[152:155], a[144:147], a[92:95], v[152:155]
ds_write_b128 v236, v[216:219] offset:128
buffer_store_dwordx4 v[52:55], v1, s[8:11], s66 offen offset:2048 sc1
v_mfma_f32_16x16x32_bf16 v[156:159], a[148:151], a[88:91], v[156:159]
v_fma_f32 v72, v72, v203, -v205
v_fma_f32 v73, v73, v203, -v205
v_mfma_f32_16x16x32_bf16 v[160:163], a[148:151], a[92:95], v[160:163]
s_waitcnt lgkmcnt(5)
v_fma_f32 v74, v74, v203, -v205
v_mfma_f32_16x16x32_bf16 v[148:151], a[152:155], a[96:99], v[148:151]
ds_read_b128 a[144:147], v211 offset:15360
ds_read_b128 a[148:151], v211 offset:33792
v_mfma_f32_16x16x32_bf16 v[152:155], a[152:155], a[100:103], v[152:155]
v_fma_f32 v75, v75, v203, -v205
v_fma_f32 v80, v80, v203, -v205
v_mfma_f32_16x16x32_bf16 v[156:159], a[156:159], a[96:99], v[156:159]
v_fma_f32 v81, v81, v203, -v205
v_fma_f32 v82, v82, v203, -v205
v_mfma_f32_16x16x32_bf16 v[160:163], a[156:159], a[100:103], v[160:163]
s_waitcnt lgkmcnt(5)
v_fma_f32 v83, v83, v203, -v205
v_cvt_pk_bf16_f32 v220, v72, v73
v_mfma_f32_16x16x32_bf16 v[148:151], a[160:163], a[104:107], v[148:151]
ds_read_b128 a[152:155], v211 offset:16384
ds_read_b128 a[156:159], v211 offset:34816
v_mfma_f32_16x16x32_bf16 v[152:155], a[160:163], a[108:111], v[152:155]
v_cvt_pk_bf16_f32 v221, v74, v75
v_cvt_pk_bf16_f32 v222, v80, v81
v_mfma_f32_16x16x32_bf16 v[156:159], a[164:167], a[104:107], v[156:159]
v_cvt_pk_bf16_f32 v223, v82, v83
v_mfma_f32_16x16x32_bf16 v[160:163], a[164:167], a[108:111], v[160:163]
s_waitcnt lgkmcnt(5)
v_mfma_f32_16x16x32_bf16 v[148:151], a[168:171], a[112:115], v[148:151]
ds_read_b128 a[160:163], v211 offset:17408
ds_read_b128 a[164:167], v211 offset:35840
v_mfma_f32_16x16x32_bf16 v[152:155], a[168:171], a[116:119], v[152:155]
ds_write_b128 v236, v[220:223] offset:4736
v_mfma_f32_16x16x32_bf16 v[156:159], a[172:175], a[112:115], v[156:159]
ds_read_b64_tr_b16 v[68:69], v237 offset:128
ds_read_b64_tr_b16 v[70:71], v237 offset:1280
ds_read_b64_tr_b16 v[72:73], v237 offset:136
ds_read_b64_tr_b16 v[74:75], v237 offset:1288
buffer_store_dwordx4 v[56:59], v1, s[8:11], s66 offen offset:3072 sc1
v_mfma_f32_16x16x32_bf16 v[160:163], a[172:175], a[116:119], v[160:163]
s_waitcnt lgkmcnt(9)
v_fma_f32 v84, v84, v202, -v204
v_add_u32 v181, 112640, v239
v_mfma_f32_16x16x32_bf16 v[148:151], a[144:147], a[120:123], v[148:151]
ds_read_b64 a[168:169], v181 offset:0
ds_read_b64 a[172:173], v181 offset:512
v_mfma_f32_16x16x32_bf16 v[152:155], a[144:147], a[124:127], v[152:155]
v_fma_f32 v85, v85, v202, -v204
v_fma_f32 v86, v86, v202, -v204
v_mfma_f32_16x16x32_bf16 v[156:159], a[148:151], a[120:123], v[156:159]
v_fma_f32 v87, v87, v202, -v204
v_fma_f32 v92, v92, v202, -v204
v_mfma_f32_16x16x32_bf16 v[160:163], a[148:151], a[124:127], v[160:163]
s_waitcnt lgkmcnt(9)
v_fma_f32 v93, v93, v202, -v204
v_fma_f32 v94, v94, v202, -v204
v_mfma_f32_16x16x32_bf16 v[148:151], a[152:155], a[128:131], v[148:151]
ds_read_b128 a[144:147], v208 offset:0
ds_read_b128 a[148:151], v208 offset:18432
v_mfma_f32_16x16x32_bf16 v[152:155], a[152:155], a[132:135], v[152:155]
v_fma_f32 v95, v95, v202, -v204
v_cvt_pk_bf16_f32 v224, v84, v85
v_mfma_f32_16x16x32_bf16 v[156:159], a[156:159], a[128:131], v[156:159]
v_cvt_pk_bf16_f32 v225, v86, v87
v_mfma_f32_16x16x32_bf16 v[160:163], a[156:159], a[132:135], v[160:163]
s_waitcnt lgkmcnt(9)
v_cvt_pk_bf16_f32 v226, v92, v93
v_cvt_pk_bf16_f32 v227, v94, v95
v_mfma_f32_16x16x32_bf16 v[148:151], a[160:163], a[136:139], v[148:151]
ds_read_b128 a[152:155], v208 offset:1024
ds_read_b128 a[156:159], v208 offset:19456
v_mfma_f32_16x16x32_bf16 v[152:155], a[160:163], a[140:143], v[152:155]
ds_write_b128 v236, v[224:227] offset:192
v_mfma_f32_16x16x32_bf16 v[156:159], a[164:167], a[136:139], v[156:159]
s_add_u32 s66, s66, 4096
s_waitcnt lgkmcnt(9)
v_mfma_f32_16x16x32_bf16 v[160:163], a[164:167], a[140:143], v[160:163]
s_waitcnt lgkmcnt(5)
buffer_store_dwordx4 v[68:71], v1, s[8:11], s66 offen offset:0 sc1
v_mfma_f32_16x16x16_bf16 v[148:151], a[168:169], v[212:213], v[148:151]
ds_read_b128 a[160:163], v208 offset:2048
ds_read_b128 a[164:167], v208 offset:20480
v_mfma_f32_16x16x16_bf16 v[152:155], a[168:169], v[214:215], v[152:155]
v_fma_f32 v88, v88, v203, -v205
v_fma_f32 v89, v89, v203, -v205
v_mfma_f32_16x16x16_bf16 v[156:159], a[172:173], v[212:213], v[156:159]
v_fma_f32 v90, v90, v203, -v205
v_fma_f32 v91, v91, v203, -v205
v_mfma_f32_16x16x16_bf16 v[160:163], a[172:173], v[214:215], v[160:163]
s_waitcnt lgkmcnt(5)
v_fma_f32 v96, v96, v203, -v205
v_fma_f32 v97, v97, v203, -v205
v_mfma_f32_16x16x32_bf16 v[164:167], a[144:147], a[0:3], 0
ds_read_b128 a[168:171], v208 offset:3072
ds_read_b128 a[172:175], v208 offset:21504
v_mfma_f32_16x16x32_bf16 v[168:171], a[144:147], a[4:7], 0
v_fma_f32 v98, v98, v203, -v205
v_fma_f32 v99, v99, v203, -v205
v_mfma_f32_16x16x32_bf16 v[172:175], a[148:151], a[0:3], 0
v_cvt_pk_bf16_f32 v228, v88, v89
v_cvt_pk_bf16_f32 v229, v90, v91
v_mfma_f32_16x16x32_bf16 v[176:179], a[148:151], a[4:7], 0
s_waitcnt lgkmcnt(5)
v_cvt_pk_bf16_f32 v230, v96, v97
v_cvt_pk_bf16_f32 v231, v98, v99
v_mfma_f32_16x16x32_bf16 v[164:167], a[152:155], a[8:11], v[164:167]
ds_read_b128 a[144:147], v208 offset:4096
ds_read_b128 a[148:151], v208 offset:22528
v_mfma_f32_16x16x32_bf16 v[168:171], a[152:155], a[12:15], v[168:171]
ds_write_b128 v236, v[228:231] offset:4800
v_mfma_f32_16x16x32_bf16 v[172:175], a[156:159], a[8:11], v[172:175]
ds_read_b64_tr_b16 v[84:85], v237 offset:192
ds_read_b64_tr_b16 v[86:87], v237 offset:1344
v_mfma_f32_16x16x32_bf16 v[176:179], a[156:159], a[12:15], v[176:179]
s_waitcnt lgkmcnt(7)
v_mfma_f32_16x16x32_bf16 v[164:167], a[160:163], a[16:19], v[164:167]
ds_read_b128 a[152:155], v208 offset:5120
ds_read_b128 a[156:159], v208 offset:23552
ds_read_b64_tr_b16 v[88:89], v237 offset:200
ds_read_b64_tr_b16 v[90:91], v237 offset:1352
buffer_store_dwordx4 v[72:75], v1, s[8:11], s66 offen offset:1024 sc1
v_mfma_f32_16x16x32_bf16 v[168:171], a[160:163], a[20:23], v[168:171]
v_fma_f32 v100, v100, v202, -v204
v_fma_f32 v101, v101, v202, -v204
v_mfma_f32_16x16x32_bf16 v[172:175], a[164:167], a[16:19], v[172:175]
v_fma_f32 v102, v102, v202, -v204
v_mfma_f32_16x16x32_bf16 v[176:179], a[164:167], a[20:23], v[176:179]
s_waitcnt lgkmcnt(9)
v_fma_f32 v103, v103, v202, -v204
v_fma_f32 v104, v104, v203, -v205
v_mfma_f32_16x16x32_bf16 v[164:167], a[168:171], a[24:27], v[164:167]
ds_read_b128 a[160:163], v208 offset:6144
ds_read_b128 a[164:167], v208 offset:24576
v_mfma_f32_16x16x32_bf16 v[168:171], a[168:171], a[28:31], v[168:171]
v_fma_f32 v105, v105, v203, -v205
v_fma_f32 v106, v106, v203, -v205
v_mfma_f32_16x16x32_bf16 v[172:175], a[172:175], a[24:27], v[172:175]
v_fma_f32 v107, v107, v203, -v205
v_cvt_pk_bf16_f32 v216, v100, v101
v_mfma_f32_16x16x32_bf16 v[176:179], a[172:175], a[28:31], v[176:179]
s_waitcnt lgkmcnt(9)
v_cvt_pk_bf16_f32 v217, v102, v103
v_mfma_f32_16x16x32_bf16 v[164:167], a[144:147], a[32:35], v[164:167]
ds_read_b128 a[168:171], v208 offset:7168
ds_read_b128 a[172:175], v208 offset:25600
v_mfma_f32_16x16x32_bf16 v[168:171], a[144:147], a[36:39], v[168:171]
v_cvt_pk_bf16_f32 v218, v104, v105
v_cvt_pk_bf16_f32 v219, v106, v107
v_mfma_f32_16x16x32_bf16 v[172:175], a[148:151], a[32:35], v[172:175]
ds_write_b64 v7, v[216:217] offset:256
v_mfma_f32_16x16x32_bf16 v[176:179], a[148:151], a[36:39], v[176:179]
s_waitcnt lgkmcnt(7)
v_mfma_f32_16x16x32_bf16 v[164:167], a[152:155], a[40:43], v[164:167]
ds_read_b128 a[144:147], v208 offset:8192
ds_read_b128 a[148:151], v208 offset:26624
v_mfma_f32_16x16x32_bf16 v[168:171], a[152:155], a[44:47], v[168:171]
ds_write_b64 v7, v[218:219] offset:4864
ds_read_b64_tr_b16 v[100:101], v238 offset:256
ds_read_b64_tr_b16 v[102:103], v238 offset:1408
buffer_store_dwordx4 v[84:87], v1, s[8:11], s66 offen offset:2048 sc1
v_mfma_f32_16x16x32_bf16 v[172:175], a[156:159], a[40:43], v[172:175]
v_mfma_f32_16x16x32_bf16 v[176:179], a[156:159], a[44:47], v[176:179]
s_waitcnt lgkmcnt(8)
v_mfma_f32_16x16x32_bf16 v[164:167], a[160:163], a[48:51], v[164:167]
ds_read_b128 a[152:155], v208 offset:9216
ds_read_b128 a[156:159], v208 offset:27648
v_mfma_f32_16x16x32_bf16 v[168:171], a[160:163], a[52:55], v[168:171]
v_mfma_f32_16x16x32_bf16 v[172:175], a[164:167], a[48:51], v[172:175]
v_mfma_f32_16x16x32_bf16 v[176:179], a[164:167], a[52:55], v[176:179]
s_waitcnt lgkmcnt(8)
v_mfma_f32_16x16x32_bf16 v[164:167], a[168:171], a[56:59], v[164:167]
ds_read_b128 a[160:163], v208 offset:10240
ds_read_b128 a[164:167], v208 offset:28672
v_mfma_f32_16x16x32_bf16 v[168:171], a[168:171], a[60:63], v[168:171]
v_mfma_f32_16x16x32_bf16 v[172:175], a[172:175], a[56:59], v[172:175]
v_mfma_f32_16x16x32_bf16 v[176:179], a[172:175], a[60:63], v[176:179]
s_waitcnt lgkmcnt(7)
v_mfma_f32_16x16x32_bf16 v[164:167], a[144:147], a[64:67], v[164:167]
ds_read_b128 a[168:171], v208 offset:11264
ds_read_b128 a[172:175], v208 offset:29696
v_mfma_f32_16x16x32_bf16 v[168:171], a[144:147], a[68:71], v[168:171]
v_mfma_f32_16x16x32_bf16 v[172:175], a[148:151], a[64:67], v[172:175]
buffer_store_dwordx4 v[88:91], v1, s[8:11], s66 offen offset:3072 sc1
v_mfma_f32_16x16x32_bf16 v[176:179], a[148:151], a[68:71], v[176:179]
s_waitcnt lgkmcnt(4)
v_mfma_f32_16x16x32_bf16 v[164:167], a[152:155], a[72:75], v[164:167]
ds_read_b128 a[144:147], v208 offset:12288
ds_read_b128 a[148:151], v208 offset:30720
v_mfma_f32_16x16x32_bf16 v[168:171], a[152:155], a[76:79], v[168:171]
s_cmp_eq_u32 s25, 1
s_cselect_b32 s98, 4096, 0
v_mfma_f32_16x16x32_bf16 v[172:175], a[156:159], a[72:75], v[172:175]
s_add_u32 s52, s52, s98
v_mfma_f32_16x16x32_bf16 v[176:179], a[156:159], a[76:79], v[176:179]
s_waitcnt lgkmcnt(4)
v_mfma_f32_16x16x32_bf16 v[164:167], a[160:163], a[80:83], v[164:167]
ds_read_b128 a[152:155], v208 offset:13312
ds_read_b128 a[156:159], v208 offset:31744
v_mfma_f32_16x16x32_bf16 v[168:171], a[160:163], a[84:87], v[168:171]
s_add_u32 s52, s52, 4096
v_mfma_f32_16x16x32_bf16 v[172:175], a[164:167], a[80:83], v[172:175]
v_mfma_f32_16x16x32_bf16 v[176:179], a[164:167], a[84:87], v[176:179]
s_waitcnt lgkmcnt(4)
v_mfma_f32_16x16x32_bf16 v[164:167], a[168:171], a[88:91], v[164:167]
ds_read_b128 a[160:163], v208 offset:14336
ds_read_b128 a[164:167], v208 offset:32768
v_mfma_f32_16x16x32_bf16 v[168:171], a[168:171], a[92:95], v[168:171]
v_mfma_f32_16x16x32_bf16 v[172:175], a[172:175], a[88:91], v[172:175]
s_add_u32 s66, s66, 4096
v_mfma_f32_16x16x32_bf16 v[176:179], a[172:175], a[92:95], v[176:179]
s_waitcnt lgkmcnt(4)
buffer_store_dwordx4 v[100:103], v1, s[8:11], s66 offen offset:0 sc1
v_mfma_f32_16x16x32_bf16 v[164:167], a[144:147], a[96:99], v[164:167]
ds_read_b128 a[168:171], v208 offset:15360
ds_read_b128 a[172:175], v208 offset:33792
v_mfma_f32_16x16x32_bf16 v[168:171], a[144:147], a[100:103], v[168:171]
v_mfma_f32_16x16x32_bf16 v[172:175], a[148:151], a[96:99], v[172:175]
v_mfma_f32_16x16x32_bf16 v[176:179], a[148:151], a[100:103], v[176:179]
s_waitcnt lgkmcnt(4)
v_mfma_f32_16x16x32_bf16 v[164:167], a[152:155], a[104:107], v[164:167]
ds_read_b128 a[144:147], v208 offset:16384
ds_read_b128 a[148:151], v208 offset:34816
v_mfma_f32_16x16x32_bf16 v[168:171], a[152:155], a[108:111], v[168:171]
v_mfma_f32_16x16x32_bf16 v[172:175], a[156:159], a[104:107], v[172:175]
v_mfma_f32_16x16x32_bf16 v[176:179], a[156:159], a[108:111], v[176:179]
s_waitcnt lgkmcnt(4)
v_mfma_f32_16x16x32_bf16 v[164:167], a[160:163], a[112:115], v[164:167]
ds_read_b128 a[152:155], v208 offset:17408
ds_read_b128 a[156:159], v208 offset:35840
v_mfma_f32_16x16x32_bf16 v[168:171], a[160:163], a[116:119], v[168:171]
buffer_load_dwordx4 a[240:243], v1, s[4:7], s52 offen offset:0 sc1
buffer_load_dwordx4 a[244:247], v9, s[4:7], s52 offen offset:0 sc1
v_mfma_f32_16x16x32_bf16 v[172:175], a[164:167], a[112:115], v[172:175]
v_mfma_f32_16x16x32_bf16 v[176:179], a[164:167], a[116:119], v[176:179]
s_waitcnt lgkmcnt(4)
v_add_u32 v181, 160768, v239
v_mfma_f32_16x16x32_bf16 v[164:167], a[168:171], a[120:123], v[164:167]
ds_read_b64 a[160:161], v181 offset:0
ds_read_b64 a[164:165], v181 offset:512
v_mfma_f32_16x16x32_bf16 v[168:171], a[168:171], a[124:127], v[168:171]
v_mfma_f32_16x16x32_bf16 v[172:175], a[172:175], a[120:123], v[172:175]
v_mfma_f32_16x16x32_bf16 v[176:179], a[172:175], a[124:127], v[176:179]
s_waitcnt lgkmcnt(4)
v_mfma_f32_16x16x32_bf16 v[164:167], a[144:147], a[128:131], v[164:167]
v_mfma_f32_16x16x32_bf16 v[168:171], a[144:147], a[132:135], v[168:171]
v_mfma_f32_16x16x32_bf16 v[172:175], a[148:151], a[128:131], v[172:175]
buffer_load_dwordx4 a[248:251], v1, s[4:7], s52 offen offset:1024 sc1
buffer_load_dwordx4 a[252:255], v9, s[4:7], s52 offen offset:1024 sc1
v_mfma_f32_16x16x32_bf16 v[176:179], a[148:151], a[132:135], v[176:179]
s_waitcnt lgkmcnt(2)
v_mfma_f32_16x16x32_bf16 v[164:167], a[152:155], a[136:139], v[164:167]
v_mfma_f32_16x16x32_bf16 v[168:171], a[152:155], a[140:143], v[168:171]
v_mfma_f32_16x16x32_bf16 v[172:175], a[156:159], a[136:139], v[172:175]
v_mfma_f32_16x16x32_bf16 v[176:179], a[156:159], a[140:143], v[176:179]
s_waitcnt lgkmcnt(0)
v_mfma_f32_16x16x16_bf16 v[164:167], a[160:161], v[212:213], v[164:167]
v_mfma_f32_16x16x16_bf16 v[168:171], a[160:161], v[214:215], v[168:171]
v_mfma_f32_16x16x16_bf16 v[172:175], a[164:165], v[212:213], v[172:175]
v_mfma_f32_16x16x16_bf16 v[176:179], a[164:165], v[214:215], v[176:179]
L_c4:
v_add_u32 v180, 0, v1
v_lshlrev_b32 v184, 16, v0
v_lshlrev_b32 v185, 16, v0
v_lshlrev_b32 v186, 16, v0
v_lshlrev_b32 v187, 16, v0
v_lshlrev_b32 v188, 16, v249
v_lshlrev_b32 v189, 16, v249
v_lshlrev_b32 v190, 16, v249
v_lshlrev_b32 v191, 16, v249
s_waitcnt lgkmcnt(0)
ds_write_b128 v240, v[36:39] offset:0
ds_write_b128 v240, v[40:43] offset:1024
ds_write_b128 v240, v[52:55] offset:2048
ds_write_b128 v240, v[56:59] offset:3072
s_cmp_eq_u32 s24, 0
s_cselect_b32 s67, 0, 1073741824
s_add_u32 s67, s67, 26542080
s_waitcnt vmcnt(4)
s_barrier
s_mov_b64 exec, 0xffff
buffer_atomic_add v4, v233, s[8:11], s67 offen sc1
s_mov_b64 exec, -1
v_add_u32 v200, 53248, v1
v_add_u32 v201, 90112, v1
v_add_u32 v202, 126976, v1
s_lshl_b32 s35, s80, 7
s_add_u32 s35, s35, 26542080
s_cmp_eq_u32 s24, 1
s_cselect_b32 s35, s35, 1073741824
v_mov_b32 v6, 0
v_mov_b32 v244, 0
v_mov_b32 v245, 0
v_mov_b32 v246, 0
buffer_load_dwordx4 a[80:83], v1, s[4:7], s52 offen offset:2048 sc1
buffer_load_dwordx4 a[84:87], v9, s[4:7], s52 offen offset:2048 sc1
ds_write_b128 v240, v[68:71] offset:4096
ds_write_b128 v240, v[72:75] offset:5120
ds_write_b128 v240, v[84:87] offset:6144
ds_write_b128 v240, v[88:91] offset:7168
ds_write_b128 v240, v[100:103] offset:8192
v_pk_mul_f32 v[192:193], v[108:109], v[108:109]
v_pk_mul_f32 v[194:195], v[110:111], v[110:111]
v_pk_mul_f32 v[196:197], v[112:113], v[112:113]
v_pk_mul_f32 v[198:199], v[114:115], v[114:115]
v_pk_fma_f32 v[192:193], v[192:193], v[252:253], v[250:251] op_sel:[0,0,0] op_sel_hi:[1,0,0]
v_pk_fma_f32 v[194:195], v[194:195], v[252:253], v[250:251] op_sel:[0,0,0] op_sel_hi:[1,0,0]
v_pk_fma_f32 v[196:197], v[196:197], v[252:253], v[250:251] op_sel:[0,1,1] op_sel_hi:[1,1,1]
v_pk_fma_f32 v[198:199], v[198:199], v[252:253], v[250:251] op_sel:[0,1,1] op_sel_hi:[1,1,1]
v_pk_mul_f32 v[192:193], v[192:193], v[108:109]
buffer_load_dwordx4 a[88:91], v1, s[4:7], s52 offen offset:3072 sc1
buffer_load_dwordx4 a[92:95], v9, s[4:7], s52 offen offset:3072 sc1
v_pk_mul_f32 v[194:195], v[194:195], v[110:111]
v_pk_mul_f32 v[196:197], v[196:197], v[112:113]
v_pk_mul_f32 v[198:199], v[198:199], v[114:115]
v_exp_f32 v192, v192
v_exp_f32 v193, v193
v_exp_f32 v194, v194
v_exp_f32 v195, v195
v_exp_f32 v196, v196
v_exp_f32 v197, v197
v_exp_f32 v198, v198
v_exp_f32 v199, v199
v_pk_fma_f32 v[192:193], v[192:193], v[254:255], v[254:255] op_sel:[0,0,0] op_sel_hi:[1,0,0]
v_pk_fma_f32 v[194:195], v[194:195], v[254:255], v[254:255] op_sel:[0,0,0] op_sel_hi:[1,0,0]
v_pk_fma_f32 v[196:197], v[196:197], v[254:255], v[254:255] op_sel:[0,1,1] op_sel_hi:[1,1,1]
s_cmp_eq_u32 s25, 2
s_cselect_b32 s98, 4096, 0
s_add_u32 s52, s52, s98
s_add_u32 s52, s52, 4096
buffer_load_dwordx4 a[96:99], v1, s[4:7], s52 offen offset:0 sc1
s_mov_b64 exec, 1
buffer_atomic_add v244, v6, s[8:11], s35 offen sc0 sc1
s_mov_b64 exec, -1
buffer_load_dwordx4 a[100:103], v9, s[4:7], s52 offen offset:0 sc1
v_pk_fma_f32 v[198:199], v[198:199], v[254:255], v[254:255] op_sel:[0,1,1] op_sel_hi:[1,1,1]
v_rcp_f32 v192, v192
v_rcp_f32 v193, v193
v_rcp_f32 v194, v194
v_rcp_f32 v195, v195
v_rcp_f32 v196, v196
v_rcp_f32 v197, v197
v_rcp_f32 v198, v198
v_rcp_f32 v199, v199
v_pk_mul_f32 v[108:109], v[108:109], v[192:193]
v_pk_mul_f32 v[110:111], v[110:111], v[194:195]
v_pk_mul_f32 v[112:113], v[112:113], v[196:197]
v_pk_mul_f32 v[114:115], v[114:115], v[198:199]
v_pk_mul_f32 v[192:193], v[116:117], v[116:117]
buffer_load_dwordx4 a[104:107], v1, s[4:7], s52 offen offset:1024 sc1
buffer_load_dwordx4 a[108:111], v9, s[4:7], s52 offen offset:1024 sc1
v_pk_mul_f32 v[194:195], v[118:119], v[118:119]
v_pk_mul_f32 v[196:197], v[120:121], v[120:121]
v_pk_mul_f32 v[198:199], v[122:123], v[122:123]
v_pk_fma_f32 v[192:193], v[192:193], v[252:253], v[250:251] op_sel:[0,0,0] op_sel_hi:[1,0,0]
v_pk_fma_f32 v[194:195], v[194:195], v[252:253], v[250:251] op_sel:[0,0,0] op_sel_hi:[1,0,0]
v_pk_fma_f32 v[196:197], v[196:197], v[252:253], v[250:251] op_sel:[0,1,1] op_sel_hi:[1,1,1]
v_pk_fma_f32 v[198:199], v[198:199], v[252:253], v[250:251] op_sel:[0,1,1] op_sel_hi:[1,1,1]
v_pk_mul_f32 v[192:193], v[192:193], v[116:117]
v_pk_mul_f32 v[194:195], v[194:195], v[118:119]
v_pk_mul_f32 v[196:197], v[196:197], v[120:121]
v_pk_mul_f32 v[198:199], v[198:199], v[122:123]
v_exp_f32 v192, v192
v_exp_f32 v193, v193
v_exp_f32 v194, v194
buffer_load_dwordx4 a[112:115], v1, s[4:7], s52 offen offset:2048 sc1
s_mov_b64 exec, 1
buffer_atomic_add v245, v6, s[8:11], s35 offen sc0 sc1
s_mov_b64 exec, -1
buffer_load_dwordx4 a[116:119], v9, s[4:7], s52 offen offset:2048 sc1
v_exp_f32 v195, v195
v_exp_f32 v196, v196
v_exp_f32 v197, v197
v_exp_f32 v198, v198
v_exp_f32 v199, v199
v_pk_fma_f32 v[192:193], v[192:193], v[254:255], v[254:255] op_sel:[0,0,0] op_sel_hi:[1,0,0]
v_pk_fma_f32 v[194:195], v[194:195], v[254:255], v[254:255] op_sel:[0,0,0] op_sel_hi:[1,0,0]
v_pk_fma_f32 v[196:197], v[196:197], v[254:255], v[254:255] op_sel:[0,1,1] op_sel_hi:[1,1,1]
v_pk_fma_f32 v[198:199], v[198:199], v[254:255], v[254:255] op_sel:[0,1,1] op_sel_hi:[1,1,1]
v_rcp_f32 v192, v192
v_rcp_f32 v193, v193
v_rcp_f32 v194, v194
v_rcp_f32 v195, v195
v_rcp_f32 v196, v196
buffer_load_dwordx4 a[120:123], v1, s[4:7], s52 offen offset:3072 sc1
buffer_load_dwordx4 a[124:127], v9, s[4:7], s52 offen offset:3072 sc1
v_rcp_f32 v197, v197
v_rcp_f32 v198, v198
v_rcp_f32 v199, v199
v_pk_mul_f32 v[116:117], v[116:117], v[192:193]
v_pk_mul_f32 v[118:119], v[118:119], v[194:195]
v_pk_mul_f32 v[120:121], v[120:121], v[196:197]
v_pk_mul_f32 v[122:123], v[122:123], v[198:199]
v_pk_mul_f32 v[192:193], v[124:125], v[124:125]
v_pk_mul_f32 v[194:195], v[126:127], v[126:127]
v_pk_mul_f32 v[196:197], v[128:129], v[128:129]
v_pk_mul_f32 v[198:199], v[130:131], v[130:131]
v_pk_fma_f32 v[192:193], v[192:193], v[252:253], v[250:251] op_sel:[0,0,0] op_sel_hi:[1,0,0]
v_pk_fma_f32 v[194:195], v[194:195], v[252:253], v[250:251] op_sel:[0,0,0] op_sel_hi:[1,0,0]
v_pk_fma_f32 v[196:197], v[196:197], v[252:253], v[250:251] op_sel:[0,1,1] op_sel_hi:[1,1,1]
s_cmp_eq_u32 s25, 3
s_cselect_b32 s98, 4096, 0
s_add_u32 s52, s52, s98
s_add_u32 s52, s52, 4096
buffer_load_dwordx4 a[128:131], v1, s[4:7], s52 offen offset:0 sc1
s_mov_b64 exec, 1
buffer_atomic_add v246, v6, s[8:11], s35 offen sc0 sc1
s_mov_b64 exec, -1
buffer_load_dwordx4 a[132:135], v9, s[4:7], s52 offen offset:0 sc1
v_pk_fma_f32 v[198:199], v[198:199], v[252:253], v[250:251] op_sel:[0,1,1] op_sel_hi:[1,1,1]
v_pk_mul_f32 v[192:193], v[192:193], v[124:125]
v_pk_mul_f32 v[194:195], v[194:195], v[126:127]
v_pk_mul_f32 v[196:197], v[196:197], v[128:129]
v_pk_mul_f32 v[198:199], v[198:199], v[130:131]
v_exp_f32 v192, v192
v_exp_f32 v193, v193
v_exp_f32 v194, v194
v_exp_f32 v195, v195
v_exp_f32 v196, v196
v_exp_f32 v197, v197
v_exp_f32 v198, v198
v_exp_f32 v199, v199
v_pk_fma_f32 v[192:193], v[192:193], v[254:255], v[254:255] op_sel:[0,0,0] op_sel_hi:[1,0,0]
buffer_load_dwordx4 a[136:139], v1, s[4:7], s52 offen offset:1024 sc1
buffer_load_dwordx4 a[140:143], v9, s[4:7], s52 offen offset:1024 sc1
v_pk_fma_f32 v[194:195], v[194:195], v[254:255], v[254:255] op_sel:[0,0,0] op_sel_hi:[1,0,0]
v_pk_fma_f32 v[196:197], v[196:197], v[254:255], v[254:255] op_sel:[0,1,1] op_sel_hi:[1,1,1]
v_pk_fma_f32 v[198:199], v[198:199], v[254:255], v[254:255] op_sel:[0,1,1] op_sel_hi:[1,1,1]
v_rcp_f32 v192, v192
v_rcp_f32 v193, v193
v_rcp_f32 v194, v194
v_rcp_f32 v195, v195
v_rcp_f32 v196, v196
v_rcp_f32 v197, v197
v_rcp_f32 v198, v198
v_rcp_f32 v199, v199
v_pk_mul_f32 v[124:125], v[124:125], v[192:193]
v_pk_mul_f32 v[126:127], v[126:127], v[194:195]
v_pk_mul_f32 v[128:129], v[128:129], v[196:197]
v_pk_mul_f32 v[130:131], v[130:131], v[198:199]
s_mul_i32 s30, s26, 589824
s_add_u32 s30, s30, 7340032
s_lshl_b32 s62, s24, 12
s_lshl_b32 s63, s24, 10
s_add_u32 s60, s30, s62
s_add_u32 s61, s30, s63
s_add_u32 s61, s61, 16384
s_cmp_eq_u32 s25, 0
s_cselect_b32 s99, 36864, 0
s_add_u32 s60, s60, s99
s_add_u32 s61, s61, s99
s_add_u32 m0, s62, 53248
s_add_u32 s60, s60, 0
s_waitcnt lgkmcnt(0)
s_cmp_eq_u32 s24, 1
s_cbranch_scc0 L_other_28
s_mov_b32 s31, 0
s_mov_b64 exec, 1
v_mov_b32 v247, 0
buffer_atomic_add v247, v6, s[8:11], s35 offen sc0 sc1
s_waitcnt vmcnt(14)
v_cmp_gt_u32 vcc, 16, v244
s_nop 0
s_cbranch_vccz L_polled_27
s_waitcnt vmcnt(9)
v_cmp_gt_u32 vcc, 16, v245
s_nop 0
s_cbranch_vccz L_polled_27
v_mov_b32 v244, 0
buffer_atomic_add v244, v6, s[8:11], s35 offen sc0 sc1
s_waitcnt vmcnt(5)
v_cmp_gt_u32 vcc, 16, v246
s_nop 0
s_cbranch_vccz L_polled_27
v_mov_b32 v245, 0
buffer_atomic_add v245, v6, s[8:11], s35 offen sc0 sc1
L_poll_26:
s_add_u32 s31, s31, 1
s_cmp_gt_u32 s31, 100000
s_cbranch_scc1 L_polled_27
v_mov_b32 v246, 0
buffer_atomic_add v246, v6, s[8:11], s35 offen sc0 sc1
s_waitcnt vmcnt(3)
v_cmp_gt_u32 vcc, 16, v247
s_nop 0
s_cbranch_vccz L_polled_27
v_mov_b32 v247, 0
buffer_atomic_add v247, v6, s[8:11], s35 offen sc0 sc1
s_waitcnt vmcnt(3)
v_cmp_gt_u32 vcc, 16, v244
s_nop 0
s_cbranch_vccz L_polled_27
v_mov_b32 v244, 0
buffer_atomic_add v244, v6, s[8:11], s35 offen sc0 sc1
s_waitcnt vmcnt(3)
v_cmp_gt_u32 vcc, 16, v245
s_nop 0
s_cbranch_vccz L_polled_27
v_mov_b32 v245, 0
buffer_atomic_add v245, v6, s[8:11], s35 offen sc0 sc1
s_waitcnt vmcnt(3)
v_cmp_gt_u32 vcc, 16, v246
s_nop 0
s_cbranch_vccz L_polled_27
s_branch L_poll_26
L_polled_27:
s_mov_b64 exec, -1
L_other_28:
s_barrier
buffer_load_dwordx4 v1, s[8:11], s60 offen offset:0 sc1 lds
buffer_load_dwordx4 v1, s[8:11], s60 offen offset:1024 sc1 lds
ds_read_b128 a[0:3], v180 offset:0
ds_read_b128 a[4:7], v180 offset:1024
ds_read_b128 a[8:11], v180 offset:2048
ds_read_b128 a[12:15], v180 offset:3072
ds_read_b128 a[16:19], v180 offset:4096
ds_read_b128 a[20:23], v180 offset:5120
ds_read_b128 a[24:27], v180 offset:6144
ds_read_b128 a[28:31], v180 offset:7168
ds_read_b128 a[32:35], v180 offset:8192
buffer_load_dwordx4 v1, s[8:11], s60 offen offset:2048 sc1 lds
buffer_load_dwordx4 v1, s[8:11], s60 offen offset:3072 sc1 lds
s_add_u32 m0, s63, 69632
s_add_u32 s61, s61, 0
buffer_load_dwordx4 v1, s[8:11], s61 offen offset:0 sc1 lds
s_waitcnt lgkmcnt(0)
v_mfma_f32_16x16x32_bf16 v[36:39], a[0:3], a[176:179], v[184:187]
ds_read_b128 a[36:39], v180 offset:9216
s_add_u32 m0, s62, 73728
v_mfma_f32_16x16x32_bf16 v[40:43], a[0:3], a[180:183], v[188:191]
ds_read_b128 a[40:43], v180 offset:10240
v_mul_f32 v192, v132, v132
v_mfma_f32_16x16x32_bf16 v[44:47], a[4:7], a[176:179], v[184:187]
ds_read_b128 a[44:47], v180 offset:11264
s_add_u32 s60, s60, 20480
v_mfma_f32_16x16x32_bf16 v[48:51], a[4:7], a[180:183], v[188:191]
ds_read_b128 a[48:51], v180 offset:12288
v_mul_f32 v193, v133, v133
v_mfma_f32_16x16x32_bf16 v[52:55], a[8:11], a[176:179], v[184:187]
ds_read_b128 a[52:55], v180 offset:13312
v_mul_f32 v194, v134, v134
v_mfma_f32_16x16x32_bf16 v[56:59], a[8:11], a[180:183], v[188:191]
ds_read_b128 a[56:59], v180 offset:14336
buffer_load_dwordx4 v1, s[8:11], s60 offen offset:0 sc1 lds
v_mfma_f32_16x16x32_bf16 v[60:63], a[12:15], a[176:179], v[184:187]
ds_read_b128 a[60:63], v180 offset:15360
v_mfma_f32_16x16x32_bf16 v[64:67], a[12:15], a[180:183], v[188:191]
ds_read_b128 a[64:67], v180 offset:16384
v_mul_f32 v195, v135, v135
v_mfma_f32_16x16x32_bf16 v[68:71], a[16:19], a[176:179], v[184:187]
ds_read_b128 a[68:71], v180 offset:17408
buffer_load_dwordx4 v1, s[8:11], s60 offen offset:1024 sc1 lds
v_mfma_f32_16x16x32_bf16 v[72:75], a[16:19], a[180:183], v[188:191]
v_fma_f32 v192, v192, v252, v250
v_mfma_f32_16x16x32_bf16 v[76:79], a[20:23], a[176:179], v[184:187]
v_mfma_f32_16x16x32_bf16 v[80:83], a[20:23], a[180:183], v[188:191]
buffer_load_dwordx4 v1, s[8:11], s60 offen offset:2048 sc1 lds
v_fma_f32 v193, v193, v252, v250
v_mfma_f32_16x16x32_bf16 v[84:87], a[24:27], a[176:179], v[184:187]
v_mfma_f32_16x16x32_bf16 v[88:91], a[24:27], a[180:183], v[188:191]
v_mfma_f32_16x16x32_bf16 v[92:95], a[28:31], a[176:179], v[184:187]
buffer_load_dwordx4 v1, s[8:11], s60 offen offset:3072 sc1 lds
v_fma_f32 v194, v194, v252, v250
v_mfma_f32_16x16x32_bf16 v[96:99], a[28:31], a[180:183], v[188:191]
v_mfma_f32_16x16x32_bf16 v[100:103], a[32:35], a[176:179], v[184:187]
v_fma_f32 v195, v195, v252, v250
v_mfma_f32_16x16x32_bf16 v[104:107], a[32:35], a[180:183], v[188:191]
s_waitcnt lgkmcnt(0)
v_mfma_f32_16x16x32_bf16 v[36:39], a[36:39], a[184:187], v[36:39]
ds_read_b128 a[0:3], v180 offset:18432
v_mul_f32 v192, v192, v132
v_mfma_f32_16x16x32_bf16 v[40:43], a[36:39], a[188:191], v[40:43]
ds_read_b128 a[4:7], v180 offset:19456
v_mfma_f32_16x16x32_bf16 v[44:47], a[40:43], a[184:187], v[44:47]
ds_read_b128 a[8:11], v180 offset:20480
v_mfma_f32_16x16x32_bf16 v[48:51], a[40:43], a[188:191], v[48:51]
ds_read_b128 a[12:15], v180 offset:21504
v_mul_f32 v193, v193, v133
v_mfma_f32_16x16x32_bf16 v[52:55], a[44:47], a[184:187], v[52:55]
ds_read_b128 a[16:19], v180 offset:22528
v_mfma_f32_16x16x32_bf16 v[56:59], a[44:47], a[188:191], v[56:59]
ds_read_b128 a[20:23], v180 offset:23552
v_mul_f32 v194, v194, v134
v_mfma_f32_16x16x32_bf16 v[60:63], a[48:51], a[184:187], v[60:63]
ds_read_b128 a[24:27], v180 offset:24576
v_mfma_f32_16x16x32_bf16 v[64:67], a[48:51], a[188:191], v[64:67]
ds_read_b128 a[28:31], v180 offset:25600
v_mul_f32 v195, v195, v135
v_mfma_f32_16x16x32_bf16 v[68:71], a[52:55], a[184:187], v[68:71]
ds_read_b128 a[32:35], v180 offset:26624
v_mfma_f32_16x16x32_bf16 v[72:75], a[52:55], a[188:191], v[72:75]
s_cmp_eq_u32 s25, 1
s_cselect_b32 s99, 36864, 0
s_add_u32 s60, s60, s99
v_mfma_f32_16x16x32_bf16 v[76:79], a[56:59], a[184:187], v[76:79]
s_add_u32 s61, s61, s99
s_add_u32 m0, s62, 90112
s_add_u32 s60, s60, 16384
v_mfma_f32_16x16x32_bf16 v[80:83], a[56:59], a[188:191], v[80:83]
buffer_load_dwordx4 v1, s[8:11], s60 offen offset:0 sc1 lds
v_mfma_f32_16x16x32_bf16 v[84:87], a[60:63], a[184:187], v[84:87]
buffer_load_dwordx4 v1, s[8:11], s60 offen offset:1024 sc1 lds
v_mfma_f32_16x16x32_bf16 v[88:91], a[60:63], a[188:191], v[88:91]
buffer_load_dwordx4 v1, s[8:11], s60 offen offset:2048 sc1 lds
v_mfma_f32_16x16x32_bf16 v[92:95], a[64:67], a[184:187], v[92:95]
v_exp_f32 v192, v192
v_mfma_f32_16x16x32_bf16 v[96:99], a[64:67], a[188:191], v[96:99]
buffer_load_dwordx4 v1, s[8:11], s60 offen offset:3072 sc1 lds
v_mfma_f32_16x16x32_bf16 v[100:103], a[68:71], a[184:187], v[100:103]
v_exp_f32 v193, v193
v_mfma_f32_16x16x32_bf16 v[104:107], a[68:71], a[188:191], v[104:107]
s_waitcnt lgkmcnt(0)
v_mfma_f32_16x16x32_bf16 v[36:39], a[0:3], a[192:195], v[36:39]
ds_read_b128 a[36:39], v180 offset:27648
s_add_u32 m0, s63, 106496
v_mfma_f32_16x16x32_bf16 v[40:43], a[0:3], a[196:199], v[40:43]
ds_read_b128 a[40:43], v180 offset:28672
v_mfma_f32_16x16x32_bf16 v[44:47], a[4:7], a[192:195], v[44:47]
ds_read_b128 a[44:47], v180 offset:29696
s_add_u32 s61, s61, 36864
v_mfma_f32_16x16x32_bf16 v[48:51], a[4:7], a[196:199], v[48:51]
ds_read_b128 a[48:51], v180 offset:30720
v_mfma_f32_16x16x32_bf16 v[52:55], a[8:11], a[192:195], v[52:55]
ds_read_b128 a[52:55], v180 offset:31744
buffer_load_dwordx4 v1, s[8:11], s61 offen offset:0 sc1 lds
v_mfma_f32_16x16x32_bf16 v[56:59], a[8:11], a[196:199], v[56:59]
ds_read_b128 a[56:59], v180 offset:32768
v_mfma_f32_16x16x32_bf16 v[60:63], a[12:15], a[192:195], v[60:63]
ds_read_b128 a[60:63], v180 offset:33792
s_add_u32 m0, s62, 110592
v_mfma_f32_16x16x32_bf16 v[64:67], a[12:15], a[196:199], v[64:67]
ds_read_b128 a[64:67], v180 offset:34816
v_mfma_f32_16x16x32_bf16 v[68:71], a[16:19], a[192:195], v[68:71]
ds_read_b128 a[68:71], v180 offset:35840
s_add_u32 s60, s60, 20480
v_mfma_f32_16x16x32_bf16 v[72:75], a[16:19], a[196:199], v[72:75]
v_exp_f32 v194, v194
v_mfma_f32_16x16x32_bf16 v[76:79], a[20:23], a[192:195], v[76:79]
buffer_load_dwordx4 v1, s[8:11], s60 offen offset:0 sc1 lds
v_mfma_f32_16x16x32_bf16 v[80:83], a[20:23], a[196:199], v[80:83]
v_exp_f32 v195, v195
v_mfma_f32_16x16x32_bf16 v[84:87], a[24:27], a[192:195], v[84:87]
buffer_load_dwordx4 v1, s[8:11], s60 offen offset:1024 sc1 lds
v_fma_f32 v192, v192, v254, v254
v_mfma_f32_16x16x32_bf16 v[88:91], a[24:27], a[196:199], v[88:91]
v_fma_f32 v193, v193, v254, v254
v_mfma_f32_16x16x32_bf16 v[92:95], a[28:31], a[192:195], v[92:95]
buffer_load_dwordx4 v1, s[8:11], s60 offen offset:2048 sc1 lds
v_mfma_f32_16x16x32_bf16 v[96:99], a[28:31], a[196:199], v[96:99]
v_fma_f32 v194, v194, v254, v254
v_mfma_f32_16x16x32_bf16 v[100:103], a[32:35], a[192:195], v[100:103]
v_mfma_f32_16x16x32_bf16 v[104:107], a[32:35], a[196:199], v[104:107]
s_waitcnt vmcnt(12) lgkmcnt(0)
s_barrier
v_mfma_f32_16x16x32_bf16 v[36:39], a[36:39], a[200:203], v[36:39]
ds_read_b128 a[0:3], v200 offset:0
buffer_load_dwordx4 v1, s[8:11], s60 offen offset:3072 sc1 lds
v_mfma_f32_16x16x32_bf16 v[40:43], a[36:39], a[204:207], v[40:43]
ds_read_b128 a[4:7], v200 offset:1024
v_fma_f32 v195, v195, v254, v254
v_mfma_f32_16x16x32_bf16 v[44:47], a[40:43], a[200:203], v[44:47]
ds_read_b128 a[8:11], v200 offset:2048
v_mfma_f32_16x16x32_bf16 v[48:51], a[40:43], a[204:207], v[48:51]
ds_read_b128 a[12:15], v200 offset:3072
v_mfma_f32_16x16x32_bf16 v[52:55], a[44:47], a[200:203], v[52:55]
ds_read_b128 a[16:19], v200 offset:4096
v_mfma_f32_16x16x32_bf16 v[56:59], a[44:47], a[204:207], v[56:59]
ds_read_b128 a[20:23], v200 offset:5120
v_mfma_f32_16x16x32_bf16 v[60:63], a[48:51], a[200:203], v[60:63]
ds_read_b128 a[24:27], v200 offset:6144
v_mfma_f32_16x16x32_bf16 v[64:67], a[48:51], a[204:207], v[64:67]
ds_read_b128 a[28:31], v200 offset:7168
v_mfma_f32_16x16x32_bf16 v[68:71], a[52:55], a[200:203], v[68:71]
ds_read_b128 a[32:35], v200 offset:8192
v_mfma_f32_16x16x32_bf16 v[72:75], a[52:55], a[204:207], v[72:75]
s_cmp_eq_u32 s25, 2
s_cselect_b32 s99, 36864, 0
s_add_u32 s60, s60, s99
v_mfma_f32_16x16x32_bf16 v[76:79], a[56:59], a[200:203], v[76:79]
s_add_u32 s61, s61, s99
s_add_u32 m0, s62, 126976
s_add_u32 s60, s60, 16384
v_mfma_f32_16x16x32_bf16 v[80:83], a[56:59], a[204:207], v[80:83]
buffer_load_dwordx4 v1, s[8:11], s60 offen offset:0 sc1 lds
v_mfma_f32_16x16x32_bf16 v[84:87], a[60:63], a[200:203], v[84:87]
v_rcp_f32 v192, v192
v_mfma_f32_16x16x32_bf16 v[88:91], a[60:63], a[204:207], v[88:91]
buffer_load_dwordx4 v1, s[8:11], s60 offen offset:1024 sc1 lds
v_mfma_f32_16x16x32_bf16 v[92:95], a[64:67], a[200:203], v[92:95]
v_rcp_f32 v193, v193
v_mfma_f32_16x16x32_bf16 v[96:99], a[64:67], a[204:207], v[96:99]
buffer_load_dwordx4 v1, s[8:11], s60 offen offset:2048 sc1 lds
v_mfma_f32_16x16x32_bf16 v[100:103], a[68:71], a[200:203], v[100:103]
v_rcp_f32 v194, v194
v_mfma_f32_16x16x32_bf16 v[104:107], a[68:71], a[204:207], v[104:107]
s_waitcnt lgkmcnt(0)
v_mfma_f32_16x16x32_bf16 v[36:39], a[0:3], a[208:211], v[36:39]
ds_read_b128 a[36:39], v200 offset:9216
buffer_load_dwordx4 v1, s[8:11], s60 offen offset:3072 sc1 lds
v_mfma_f32_16x16x32_bf16 v[40:43], a[0:3], a[212:215], v[40:43]
ds_read_b128 a[40:43], v200 offset:10240
v_mfma_f32_16x16x32_bf16 v[44:47], a[4:7], a[208:211], v[44:47]
ds_read_b128 a[44:47], v200 offset:11264
s_add_u32 m0, s63, 143360
v_mfma_f32_16x16x32_bf16 v[48:51], a[4:7], a[212:215], v[48:51]
ds_read_b128 a[48:51], v200 offset:12288
v_mfma_f32_16x16x32_bf16 v[52:55], a[8:11], a[208:211], v[52:55]
ds_read_b128 a[52:55], v200 offset:13312
s_add_u32 s61, s61, 36864
v_mfma_f32_16x16x32_bf16 v[56:59], a[8:11], a[212:215], v[56:59]
ds_read_b128 a[56:59], v200 offset:14336
v_mfma_f32_16x16x32_bf16 v[60:63], a[12:15], a[208:211], v[60:63]
ds_read_b128 a[60:63], v200 offset:15360
buffer_load_dwordx4 v1, s[8:11], s61 offen offset:0 sc1 lds
v_mfma_f32_16x16x32_bf16 v[64:67], a[12:15], a[212:215], v[64:67]
ds_read_b128 a[64:67], v200 offset:16384
v_mfma_f32_16x16x32_bf16 v[68:71], a[16:19], a[208:211], v[68:71]
ds_read_b128 a[68:71], v200 offset:17408
s_add_u32 m0, s62, 147456
v_mfma_f32_16x16x32_bf16 v[72:75], a[16:19], a[212:215], v[72:75]
s_add_u32 s60, s60, 20480
v_rcp_f32 v195, v195
v_mfma_f32_16x16x32_bf16 v[76:79], a[20:23], a[208:211], v[76:79]
v_mul_f32 v132, v132, v192
v_mul_f32 v133, v133, v193
v_mfma_f32_16x16x32_bf16 v[80:83], a[20:23], a[212:215], v[80:83]
v_mul_f32 v134, v134, v194
v_mul_f32 v135, v135, v195
v_mfma_f32_16x16x32_bf16 v[84:87], a[24:27], a[208:211], v[84:87]
buffer_load_dwordx4 v1, s[8:11], s60 offen offset:0 sc1 lds
v_mul_f32 v196, v136, v136
v_mfma_f32_16x16x32_bf16 v[88:91], a[24:27], a[212:215], v[88:91]
v_mfma_f32_16x16x32_bf16 v[92:95], a[28:31], a[208:211], v[92:95]
buffer_load_dwordx4 v1, s[8:11], s60 offen offset:1024 sc1 lds
v_mfma_f32_16x16x32_bf16 v[96:99], a[28:31], a[212:215], v[96:99]
v_mul_f32 v197, v137, v137
v_mfma_f32_16x16x32_bf16 v[100:103], a[32:35], a[208:211], v[100:103]
v_mfma_f32_16x16x32_bf16 v[104:107], a[32:35], a[212:215], v[104:107]
s_waitcnt vmcnt(16) lgkmcnt(0)
s_barrier
v_mfma_f32_16x16x32_bf16 v[36:39], a[36:39], a[216:219], v[36:39]
ds_read_b128 a[0:3], v200 offset:18432
buffer_load_dwordx4 v1, s[8:11], s60 offen offset:2048 sc1 lds
v_mfma_f32_16x16x32_bf16 v[40:43], a[36:39], a[220:223], v[40:43]
ds_read_b128 a[4:7], v200 offset:19456
v_mul_f32 v198, v138, v138
v_mfma_f32_16x16x32_bf16 v[44:47], a[40:43], a[216:219], v[44:47]
ds_read_b128 a[8:11], v200 offset:20480
v_mul_f32 v199, v139, v139
v_mfma_f32_16x16x32_bf16 v[48:51], a[40:43], a[220:223], v[48:51]
ds_read_b128 a[12:15], v200 offset:21504
v_mfma_f32_16x16x32_bf16 v[52:55], a[44:47], a[216:219], v[52:55]
ds_read_b128 a[16:19], v200 offset:22528
buffer_load_dwordx4 v1, s[8:11], s60 offen offset:3072 sc1 lds
v_mfma_f32_16x16x32_bf16 v[56:59], a[44:47], a[220:223], v[56:59]
ds_read_b128 a[20:23], v200 offset:23552
v_fma_f32 v196, v196, v253, v251
v_mfma_f32_16x16x32_bf16 v[60:63], a[48:51], a[216:219], v[60:63]
ds_read_b128 a[24:27], v200 offset:24576
v_fma_f32 v197, v197, v253, v251
v_mfma_f32_16x16x32_bf16 v[64:67], a[48:51], a[220:223], v[64:67]
ds_read_b128 a[28:31], v200 offset:25600
v_mfma_f32_16x16x32_bf16 v[68:71], a[52:55], a[216:219], v[68:71]
ds_read_b128 a[32:35], v200 offset:26624
buffer_load_dwordx4 a[144:147], v1, s[4:7], s52 offen offset:2048 sc1
v_mfma_f32_16x16x32_bf16 v[72:75], a[52:55], a[220:223], v[72:75]
v_fma_f32 v198, v198, v253, v251
v_mfma_f32_16x16x32_bf16 v[76:79], a[56:59], a[216:219], v[76:79]
v_mfma_f32_16x16x32_bf16 v[80:83], a[56:59], a[220:223], v[80:83]
v_fma_f32 v199, v199, v253, v251
v_mfma_f32_16x16x32_bf16 v[84:87], a[60:63], a[216:219], v[84:87]
buffer_load_dwordx4 a[148:151], v9, s[4:7], s52 offen offset:2048 sc1
v_mfma_f32_16x16x32_bf16 v[88:91], a[60:63], a[220:223], v[88:91]
v_mul_f32 v196, v196, v136
v_mfma_f32_16x16x32_bf16 v[92:95], a[64:67], a[216:219], v[92:95]
v_mfma_f32_16x16x32_bf16 v[96:99], a[64:67], a[220:223], v[96:99]
v_mfma_f32_16x16x32_bf16 v[100:103], a[68:71], a[216:219], v[100:103]
v_mul_f32 v197, v197, v137
v_mfma_f32_16x16x32_bf16 v[104:107], a[68:71], a[220:223], v[104:107]
s_waitcnt lgkmcnt(0)
v_mfma_f32_16x16x32_bf16 v[36:39], a[0:3], a[224:227], v[36:39]
ds_read_b128 a[36:39], v200 offset:27648
buffer_load_dwordx4 a[152:155], v1, s[4:7], s52 offen offset:3072 sc1
v_mfma_f32_16x16x32_bf16 v[40:43], a[0:3], a[228:231], v[40:43]
ds_read_b128 a[40:43], v200 offset:28672
v_mul_f32 v198, v198, v138
v_mfma_f32_16x16x32_bf16 v[44:47], a[4:7], a[224:227], v[44:47]
ds_read_b128 a[44:47], v200 offset:29696
buffer_load_dwordx4 a[156:159], v9, s[4:7], s52 offen offset:3072 sc1
v_mfma_f32_16x16x32_bf16 v[48:51], a[4:7], a[228:231], v[48:51]
ds_read_b128 a[48:51], v200 offset:30720
v_mul_f32 v199, v199, v139
v_mfma_f32_16x16x32_bf16 v[52:55], a[8:11], a[224:227], v[52:55]
ds_read_b128 a[52:55], v200 offset:31744
v_mfma_f32_16x16x32_bf16 v[56:59], a[8:11], a[228:231], v[56:59]
ds_read_b128 a[56:59], v200 offset:32768
v_mfma_f32_16x16x32_bf16 v[60:63], a[12:15], a[224:227], v[60:63]
ds_read_b128 a[60:63], v200 offset:33792
v_mfma_f32_16x16x32_bf16 v[64:67], a[12:15], a[228:231], v[64:67]
ds_read_b128 a[64:67], v200 offset:34816
v_mfma_f32_16x16x32_bf16 v[68:71], a[16:19], a[224:227], v[68:71]
ds_read_b128 a[68:71], v200 offset:35840
v_mfma_f32_16x16x32_bf16 v[72:75], a[16:19], a[228:231], v[72:75]
s_cmp_eq_u32 s25, 4
s_cselect_b32 s98, 4096, 0
s_add_u32 s52, s52, s98
v_mfma_f32_16x16x32_bf16 v[76:79], a[20:23], a[224:227], v[76:79]
s_add_u32 s52, s52, 4096
v_exp_f32 v196, v196
v_mfma_f32_16x16x32_bf16 v[80:83], a[20:23], a[228:231], v[80:83]
v_exp_f32 v197, v197
v_mfma_f32_16x16x32_bf16 v[84:87], a[24:27], a[224:227], v[84:87]
buffer_load_dwordx4 a[160:163], v1, s[4:7], s52 offen offset:0 sc1
v_mfma_f32_16x16x32_bf16 v[88:91], a[24:27], a[228:231], v[88:91]
v_mfma_f32_16x16x32_bf16 v[92:95], a[28:31], a[224:227], v[92:95]
buffer_load_dwordx4 a[164:167], v9, s[4:7], s52 offen offset:0 sc1
v_mfma_f32_16x16x32_bf16 v[96:99], a[28:31], a[228:231], v[96:99]
v_exp_f32 v198, v198
v_mfma_f32_16x16x32_bf16 v[100:103], a[32:35], a[224:227], v[100:103]
v_mfma_f32_16x16x32_bf16 v[104:107], a[32:35], a[228:231], v[104:107]
s_waitcnt vmcnt(19) lgkmcnt(0)
s_barrier
v_mfma_f32_16x16x32_bf16 v[36:39], a[36:39], a[232:235], v[36:39]
ds_read_b128 a[0:3], v201 offset:0
buffer_load_dwordx4 a[168:171], v1, s[4:7], s52 offen offset:1024 sc1
v_mfma_f32_16x16x32_bf16 v[40:43], a[36:39], a[236:239], v[40:43]
ds_read_b128 a[4:7], v201 offset:1024
buffer_load_dwordx4 a[172:175], v9, s[4:7], s52 offen offset:1024 sc1
v_mfma_f32_16x16x32_bf16 v[44:47], a[40:43], a[232:235], v[44:47]
ds_read_b128 a[8:11], v201 offset:2048
v_mfma_f32_16x16x32_bf16 v[48:51], a[40:43], a[236:239], v[48:51]
ds_read_b128 a[12:15], v201 offset:3072
v_mfma_f32_16x16x32_bf16 v[52:55], a[44:47], a[232:235], v[52:55]
ds_read_b128 a[16:19], v201 offset:4096
v_mfma_f32_16x16x32_bf16 v[56:59], a[44:47], a[236:239], v[56:59]
ds_read_b128 a[20:23], v201 offset:5120
v_mfma_f32_16x16x32_bf16 v[60:63], a[48:51], a[232:235], v[60:63]
ds_read_b128 a[24:27], v201 offset:6144
v_mfma_f32_16x16x32_bf16 v[64:67], a[48:51], a[236:239], v[64:67]
ds_read_b128 a[28:31], v201 offset:7168
v_mfma_f32_16x16x32_bf16 v[68:71], a[52:55], a[232:235], v[68:71]
ds_read_b128 a[32:35], v201 offset:8192
v_mfma_f32_16x16x32_bf16 v[72:75], a[52:55], a[236:239], v[72:75]
s_cmp_eq_u32 s25, 3
s_cselect_b32 s99, 36864, 0
s_add_u32 s60, s60, s99
v_mfma_f32_16x16x32_bf16 v[76:79], a[56:59], a[232:235], v[76:79]
s_add_u32 s61, s61, s99
s_add_u32 m0, s62, 53248
v_mfma_f32_16x16x32_bf16 v[80:83], a[56:59], a[236:239], v[80:83]
s_add_u32 s60, s60, 16384
v_exp_f32 v199, v199
v_mfma_f32_16x16x32_bf16 v[84:87], a[60:63], a[232:235], v[84:87]
v_fma_f32 v196, v196, v255, v255
v_fma_f32 v197, v197, v255, v255
v_mfma_f32_16x16x32_bf16 v[88:91], a[60:63], a[236:239], v[88:91]
buffer_load_dwordx4 v1, s[8:11], s60 offen offset:0 sc1 lds
v_fma_f32 v198, v198, v255, v255
v_mfma_f32_16x16x32_bf16 v[92:95], a[64:67], a[232:235], v[92:95]
v_fma_f32 v199, v199, v255, v255
v_mfma_f32_16x16x32_bf16 v[96:99], a[64:67], a[236:239], v[96:99]
buffer_load_dwordx4 v1, s[8:11], s60 offen offset:1024 sc1 lds
v_mfma_f32_16x16x32_bf16 v[100:103], a[68:71], a[232:235], v[100:103]
v_rcp_f32 v196, v196
v_mfma_f32_16x16x32_bf16 v[104:107], a[68:71], a[236:239], v[104:107]
s_waitcnt lgkmcnt(0)
v_mfma_f32_16x16x32_bf16 v[36:39], a[0:3], a[240:243], v[36:39]
ds_read_b128 a[36:39], v201 offset:9216
buffer_load_dwordx4 v1, s[8:11], s60 offen offset:2048 sc1 lds
v_mfma_f32_16x16x32_bf16 v[40:43], a[0:3], a[244:247], v[40:43]
ds_read_b128 a[40:43], v201 offset:10240
v_mfma_f32_16x16x32_bf16 v[44:47], a[4:7], a[240:243], v[44:47]
ds_read_b128 a[44:47], v201 offset:11264
buffer_load_dwordx4 v1, s[8:11], s60 offen offset:3072 sc1 lds
v_mfma_f32_16x16x32_bf16 v[48:51], a[4:7], a[244:247], v[48:51]
ds_read_b128 a[48:51], v201 offset:12288
v_mfma_f32_16x16x32_bf16 v[52:55], a[8:11], a[240:243], v[52:55]
ds_read_b128 a[52:55], v201 offset:13312
s_add_u32 m0, s63, 69632
v_mfma_f32_16x16x32_bf16 v[56:59], a[8:11], a[244:247], v[56:59]
ds_read_b128 a[56:59], v201 offset:14336
v_mfma_f32_16x16x32_bf16 v[60:63], a[12:15], a[240:243], v[60:63]
ds_read_b128 a[60:63], v201 offset:15360
s_add_u32 s61, s61, 36864
v_mfma_f32_16x16x32_bf16 v[64:67], a[12:15], a[244:247], v[64:67]
ds_read_b128 a[64:67], v201 offset:16384
v_mfma_f32_16x16x32_bf16 v[68:71], a[16:19], a[240:243], v[68:71]
ds_read_b128 a[68:71], v201 offset:17408
buffer_load_dwordx4 v1, s[8:11], s61 offen offset:0 sc1 lds
v_mfma_f32_16x16x32_bf16 v[72:75], a[16:19], a[244:247], v[72:75]
s_add_u32 m0, s62, 73728
v_rcp_f32 v197, v197
v_mfma_f32_16x16x32_bf16 v[76:79], a[20:23], a[240:243], v[76:79]
s_add_u32 s60, s60, 20480
v_rcp_f32 v198, v198
v_mfma_f32_16x16x32_bf16 v[80:83], a[20:23], a[244:247], v[80:83]
v_rcp_f32 v199, v199
v_mfma_f32_16x16x32_bf16 v[84:87], a[24:27], a[240:243], v[84:87]
v_mfma_f32_16x16x32_bf16 v[88:91], a[24:27], a[244:247], v[88:91]
v_mfma_f32_16x16x32_bf16 v[92:95], a[28:31], a[240:243], v[92:95]
buffer_load_dwordx4 v1, s[8:11], s60 offen offset:0 sc1 lds
v_mfma_f32_16x16x32_bf16 v[96:99], a[28:31], a[244:247], v[96:99]
v_mfma_f32_16x16x32_bf16 v[100:103], a[32:35], a[240:243], v[100:103]
v_mul_f32 v136, v136, v196
v_mfma_f32_16x16x32_bf16 v[104:107], a[32:35], a[244:247], v[104:107]
s_waitcnt vmcnt(23) lgkmcnt(0)
s_barrier
v_mfma_f32_16x16x32_bf16 v[36:39], a[36:39], a[248:251], v[36:39]
ds_read_b128 a[0:3], v201 offset:18432
buffer_load_dwordx4 v1, s[8:11], s60 offen offset:1024 sc1 lds
v_mfma_f32_16x16x32_bf16 v[40:43], a[36:39], a[252:255], v[40:43]
ds_read_b128 a[4:7], v201 offset:19456
v_mul_f32 v137, v137, v197
v_mfma_f32_16x16x32_bf16 v[44:47], a[40:43], a[248:251], v[44:47]
ds_read_b128 a[8:11], v201 offset:20480
v_mul_f32 v138, v138, v198
v_mfma_f32_16x16x32_bf16 v[48:51], a[40:43], a[252:255], v[48:51]
ds_read_b128 a[12:15], v201 offset:21504
v_mfma_f32_16x16x32_bf16 v[52:55], a[44:47], a[248:251], v[52:55]
ds_read_b128 a[16:19], v201 offset:22528
buffer_load_dwordx4 v1, s[8:11], s60 offen offset:2048 sc1 lds
v_mfma_f32_16x16x32_bf16 v[56:59], a[44:47], a[252:255], v[56:59]
ds_read_b128 a[20:23], v201 offset:23552
v_mul_f32 v139, v139, v199
v_mfma_f32_16x16x32_bf16 v[60:63], a[48:51], a[248:251], v[60:63]
ds_read_b128 a[24:27], v201 offset:24576
v_mfma_f32_16x16x32_bf16 v[64:67], a[48:51], a[252:255], v[64:67]
ds_read_b128 a[28:31], v201 offset:25600
v_mul_f32 v192, v140, v140
v_mfma_f32_16x16x32_bf16 v[68:71], a[52:55], a[248:251], v[68:71]
ds_read_b128 a[32:35], v201 offset:26624
buffer_load_dwordx4 v1, s[8:11], s60 offen offset:3072 sc1 lds
v_mfma_f32_16x16x32_bf16 v[72:75], a[52:55], a[252:255], v[72:75]
v_mfma_f32_16x16x32_bf16 v[76:79], a[56:59], a[248:251], v[76:79]
v_mul_f32 v193, v141, v141
v_mfma_f32_16x16x32_bf16 v[80:83], a[56:59], a[252:255], v[80:83]
v_mfma_f32_16x16x32_bf16 v[84:87], a[60:63], a[248:251], v[84:87]
buffer_load_dwordx4 a[176:179], v1, s[4:7], s52 offen offset:2048 sc1
v_mul_f32 v194, v142, v142
v_mfma_f32_16x16x32_bf16 v[88:91], a[60:63], a[252:255], v[88:91]
v_mfma_f32_16x16x32_bf16 v[92:95], a[64:67], a[248:251], v[92:95]
v_mul_f32 v195, v143, v143
v_mfma_f32_16x16x32_bf16 v[96:99], a[64:67], a[252:255], v[96:99]
v_mfma_f32_16x16x32_bf16 v[100:103], a[68:71], a[248:251], v[100:103]
v_mfma_f32_16x16x32_bf16 v[104:107], a[68:71], a[252:255], v[104:107]
v_fma_f32 v192, v192, v252, v250
s_waitcnt lgkmcnt(0)
v_mfma_f32_16x16x32_bf16 v[36:39], a[0:3], a[80:83], v[36:39]
ds_read_b128 a[36:39], v201 offset:27648
buffer_load_dwordx4 a[180:183], v9, s[4:7], s52 offen offset:2048 sc1
v_mfma_f32_16x16x32_bf16 v[40:43], a[0:3], a[84:87], v[40:43]
ds_read_b128 a[40:43], v201 offset:28672
v_fma_f32 v193, v193, v252, v250
v_mfma_f32_16x16x32_bf16 v[44:47], a[4:7], a[80:83], v[44:47]
ds_read_b128 a[44:47], v201 offset:29696
buffer_load_dwordx4 a[184:187], v1, s[4:7], s52 offen offset:3072 sc1
v_mfma_f32_16x16x32_bf16 v[48:51], a[4:7], a[84:87], v[48:51]
ds_read_b128 a[48:51], v201 offset:30720
v_fma_f32 v194, v194, v252, v250
v_mfma_f32_16x16x32_bf16 v[52:55], a[8:11], a[80:83], v[52:55]
ds_read_b128 a[52:55], v201 offset:31744
buffer_load_dwordx4 a[188:191], v9, s[4:7], s52 offen offset:3072 sc1
v_mfma_f32_16x16x32_bf16 v[56:59], a[8:11], a[84:87], v[56:59]
ds_read_b128 a[56:59], v201 offset:32768
v_mfma_f32_16x16x32_bf16 v[60:63], a[12:15], a[80:83], v[60:63]
ds_read_b128 a[60:63], v201 offset:33792
v_fma_f32 v195, v195, v252, v250
v_mfma_f32_16x16x32_bf16 v[64:67], a[12:15], a[84:87], v[64:67]
ds_read_b128 a[64:67], v201 offset:34816
v_mfma_f32_16x16x32_bf16 v[68:71], a[16:19], a[80:83], v[68:71]
ds_read_b128 a[68:71], v201 offset:35840
v_mul_f32 v192, v192, v140
v_mfma_f32_16x16x32_bf16 v[72:75], a[16:19], a[84:87], v[72:75]
s_cmp_eq_u32 s25, 5
s_cselect_b32 s98, 4096, 0
v_mfma_f32_16x16x32_bf16 v[76:79], a[20:23], a[80:83], v[76:79]
s_add_u32 s52, s52, s98
v_mul_f32 v193, v193, v141
v_mfma_f32_16x16x32_bf16 v[80:83], a[20:23], a[84:87], v[80:83]
s_add_u32 s52, s52, 4096
v_mfma_f32_16x16x32_bf16 v[84:87], a[24:27], a[80:83], v[84:87]
v_mfma_f32_16x16x32_bf16 v[88:91], a[24:27], a[84:87], v[88:91]
v_mul_f32 v194, v194, v142
v_mfma_f32_16x16x32_bf16 v[92:95], a[28:31], a[80:83], v[92:95]
buffer_load_dwordx4 a[192:195], v1, s[4:7], s52 offen offset:0 sc1
v_mfma_f32_16x16x32_bf16 v[96:99], a[28:31], a[84:87], v[96:99]
v_mul_f32 v195, v195, v143
v_mfma_f32_16x16x32_bf16 v[100:103], a[32:35], a[80:83], v[100:103]
v_mfma_f32_16x16x32_bf16 v[104:107], a[32:35], a[84:87], v[104:107]
s_waitcnt vmcnt(22) lgkmcnt(0)
s_barrier
v_mfma_f32_16x16x32_bf16 v[36:39], a[36:39], a[88:91], v[36:39]
ds_read_b128 a[0:3], v202 offset:0
buffer_load_dwordx4 a[196:199], v9, s[4:7], s52 offen offset:0 sc1
v_mfma_f32_16x16x32_bf16 v[40:43], a[36:39], a[92:95], v[40:43]
ds_read_b128 a[4:7], v202 offset:1024
buffer_load_dwordx4 a[200:203], v1, s[4:7], s52 offen offset:1024 sc1
v_mfma_f32_16x16x32_bf16 v[44:47], a[40:43], a[88:91], v[44:47]
ds_read_b128 a[8:11], v202 offset:2048
v_mfma_f32_16x16x32_bf16 v[48:51], a[40:43], a[92:95], v[48:51]
ds_read_b128 a[12:15], v202 offset:3072
buffer_load_dwordx4 a[204:207], v9, s[4:7], s52 offen offset:1024 sc1
v_mfma_f32_16x16x32_bf16 v[52:55], a[44:47], a[88:91], v[52:55]
ds_read_b128 a[16:19], v202 offset:4096
v_mfma_f32_16x16x32_bf16 v[56:59], a[44:47], a[92:95], v[56:59]
ds_read_b128 a[20:23], v202 offset:5120
v_mfma_f32_16x16x32_bf16 v[60:63], a[48:51], a[88:91], v[60:63]
ds_read_b128 a[24:27], v202 offset:6144
v_mfma_f32_16x16x32_bf16 v[64:67], a[48:51], a[92:95], v[64:67]
ds_read_b128 a[28:31], v202 offset:7168
v_mfma_f32_16x16x32_bf16 v[68:71], a[52:55], a[88:91], v[68:71]
ds_read_b128 a[32:35], v202 offset:8192
v_mfma_f32_16x16x32_bf16 v[72:75], a[52:55], a[92:95], v[72:75]
s_cmp_eq_u32 s25, 4
s_cselect_b32 s99, 36864, 0
s_add_u32 s60, s60, s99
v_mfma_f32_16x16x32_bf16 v[76:79], a[56:59], a[88:91], v[76:79]
s_add_u32 s61, s61, s99
v_exp_f32 v192, v192
v_mfma_f32_16x16x32_bf16 v[80:83], a[56:59], a[92:95], v[80:83]
s_add_u32 m0, s62, 90112
v_exp_f32 v193, v193
v_mfma_f32_16x16x32_bf16 v[84:87], a[60:63], a[88:91], v[84:87]
s_add_u32 s60, s60, 16384
v_exp_f32 v194, v194
v_mfma_f32_16x16x32_bf16 v[88:91], a[60:63], a[92:95], v[88:91]
v_mfma_f32_16x16x32_bf16 v[92:95], a[64:67], a[88:91], v[92:95]
v_exp_f32 v195, v195
v_mfma_f32_16x16x32_bf16 v[96:99], a[64:67], a[92:95], v[96:99]
buffer_load_dwordx4 v1, s[8:11], s60 offen offset:0 sc1 lds
v_mfma_f32_16x16x32_bf16 v[100:103], a[68:71], a[88:91], v[100:103]
v_mfma_f32_16x16x32_bf16 v[104:107], a[68:71], a[92:95], v[104:107]
s_waitcnt lgkmcnt(0)
v_mfma_f32_16x16x32_bf16 v[36:39], a[0:3], a[96:99], v[36:39]
ds_read_b128 a[36:39], v202 offset:9216
buffer_load_dwordx4 v1, s[8:11], s60 offen offset:1024 sc1 lds
v_mfma_f32_16x16x32_bf16 v[40:43], a[0:3], a[100:103], v[40:43]
ds_read_b128 a[40:43], v202 offset:10240
v_fma_f32 v192, v192, v254, v254
v_mfma_f32_16x16x32_bf16 v[44:47], a[4:7], a[96:99], v[44:47]
ds_read_b128 a[44:47], v202 offset:11264
buffer_load_dwordx4 v1, s[8:11], s60 offen offset:2048 sc1 lds
v_mfma_f32_16x16x32_bf16 v[48:51], a[4:7], a[100:103], v[48:51]
ds_read_b128 a[48:51], v202 offset:12288
v_fma_f32 v193, v193, v254, v254
v_mfma_f32_16x16x32_bf16 v[52:55], a[8:11], a[96:99], v[52:55]
ds_read_b128 a[52:55], v202 offset:13312
v_mfma_f32_16x16x32_bf16 v[56:59], a[8:11], a[100:103], v[56:59]
ds_read_b128 a[56:59], v202 offset:14336
buffer_load_dwordx4 v1, s[8:11], s60 offen offset:3072 sc1 lds
v_mfma_f32_16x16x32_bf16 v[60:63], a[12:15], a[96:99], v[60:63]
ds_read_b128 a[60:63], v202 offset:15360
v_fma_f32 v194, v194, v254, v254
v_mfma_f32_16x16x32_bf16 v[64:67], a[12:15], a[100:103], v[64:67]
ds_read_b128 a[64:67], v202 offset:16384
v_fma_f32 v195, v195, v254, v254
v_mfma_f32_16x16x32_bf16 v[68:71], a[16:19], a[96:99], v[68:71]
ds_read_b128 a[68:71], v202 offset:17408
s_add_u32 m0, s63, 106496
v_mfma_f32_16x16x32_bf16 v[72:75], a[16:19], a[100:103], v[72:75]
s_add_u32 s61, s61, 36864
v_mfma_f32_16x16x32_bf16 v[76:79], a[20:23], a[96:99], v[76:79]
v_rcp_f32 v192, v192
v_mfma_f32_16x16x32_bf16 v[80:83], a[20:23], a[100:103], v[80:83]
v_mfma_f32_16x16x32_bf16 v[84:87], a[24:27], a[96:99], v[84:87]
v_mfma_f32_16x16x32_bf16 v[88:91], a[24:27], a[100:103], v[88:91]
v_mfma_f32_16x16x32_bf16 v[92:95], a[28:31], a[96:99], v[92:95]
buffer_load_dwordx4 v1, s[8:11], s61 offen offset:0 sc1 lds
v_mfma_f32_16x16x32_bf16 v[96:99], a[28:31], a[100:103], v[96:99]
v_rcp_f32 v193, v193
v_mfma_f32_16x16x32_bf16 v[100:103], a[32:35], a[96:99], v[100:103]
v_mfma_f32_16x16x32_bf16 v[104:107], a[32:35], a[100:103], v[104:107]
s_waitcnt lgkmcnt(0)
v_mfma_f32_16x16x32_bf16 v[36:39], a[36:39], a[104:107], v[36:39]
ds_read_b128 a[0:3], v202 offset:18432
s_add_u32 m0, s62, 110592
v_mfma_f32_16x16x32_bf16 v[40:43], a[36:39], a[108:111], v[40:43]
ds_read_b128 a[4:7], v202 offset:19456
v_mfma_f32_16x16x32_bf16 v[44:47], a[40:43], a[104:107], v[44:47]
ds_read_b128 a[8:11], v202 offset:20480
s_add_u32 s60, s60, 20480
v_mfma_f32_16x16x32_bf16 v[48:51], a[40:43], a[108:111], v[48:51]
ds_read_b128 a[12:15], v202 offset:21504
v_mfma_f32_16x16x32_bf16 v[52:55], a[44:47], a[104:107], v[52:55]
ds_read_b128 a[16:19], v202 offset:22528
v_mfma_f32_16x16x32_bf16 v[56:59], a[44:47], a[108:111], v[56:59]
ds_read_b128 a[20:23], v202 offset:23552
buffer_load_dwordx4 v1, s[8:11], s60 offen offset:0 sc1 lds
v_mfma_f32_16x16x32_bf16 v[60:63], a[48:51], a[104:107], v[60:63]
ds_read_b128 a[24:27], v202 offset:24576
v_mfma_f32_16x16x32_bf16 v[64:67], a[48:51], a[108:111], v[64:67]
ds_read_b128 a[28:31], v202 offset:25600
v_mfma_f32_16x16x32_bf16 v[68:71], a[52:55], a[104:107], v[68:71]
ds_read_b128 a[32:35], v202 offset:26624
buffer_load_dwordx4 v1, s[8:11], s60 offen offset:1024 sc1 lds
v_mfma_f32_16x16x32_bf16 v[72:75], a[52:55], a[108:111], v[72:75]
v_rcp_f32 v194, v194
v_mfma_f32_16x16x32_bf16 v[76:79], a[56:59], a[104:107], v[76:79]
v_rcp_f32 v195, v195
v_mfma_f32_16x16x32_bf16 v[80:83], a[56:59], a[108:111], v[80:83]
buffer_load_dwordx4 v1, s[8:11], s60 offen offset:2048 sc1 lds
v_mul_f32 v140, v140, v192
v_mfma_f32_16x16x32_bf16 v[84:87], a[60:63], a[104:107], v[84:87]
v_mfma_f32_16x16x32_bf16 v[88:91], a[60:63], a[108:111], v[88:91]
v_mul_f32 v141, v141, v193
v_mfma_f32_16x16x32_bf16 v[92:95], a[64:67], a[104:107], v[92:95]
buffer_load_dwordx4 v1, s[8:11], s60 offen offset:3072 sc1 lds
v_mfma_f32_16x16x32_bf16 v[96:99], a[64:67], a[108:111], v[96:99]
v_mul_f32 v142, v142, v194
v_mfma_f32_16x16x32_bf16 v[100:103], a[68:71], a[104:107], v[100:103]
v_mfma_f32_16x16x32_bf16 v[104:107], a[68:71], a[108:111], v[104:107]
s_waitcnt lgkmcnt(0)
v_mfma_f32_16x16x32_bf16 v[36:39], a[0:3], a[112:115], v[36:39]
ds_read_b128 a[36:39], v202 offset:27648
buffer_load_dwordx4 a[208:211], v1, s[4:7], s52 offen offset:2048 sc1
v_mfma_f32_16x16x32_bf16 v[40:43], a[0:3], a[116:119], v[40:43]
ds_read_b128 a[40:43], v202 offset:28672
v_mul_f32 v143, v143, v195
v_mfma_f32_16x16x32_bf16 v[44:47], a[4:7], a[112:115], v[44:47]
ds_read_b128 a[44:47], v202 offset:29696
v_mul_f32 v196, v144, v144
v_mfma_f32_16x16x32_bf16 v[48:51], a[4:7], a[116:119], v[48:51]
ds_read_b128 a[48:51], v202 offset:30720
v_mfma_f32_16x16x32_bf16 v[52:55], a[8:11], a[112:115], v[52:55]
ds_read_b128 a[52:55], v202 offset:31744
buffer_load_dwordx4 a[212:215], v9, s[4:7], s52 offen offset:2048 sc1
v_mfma_f32_16x16x32_bf16 v[56:59], a[8:11], a[116:119], v[56:59]
ds_read_b128 a[56:59], v202 offset:32768
v_mul_f32 v197, v145, v145
v_mfma_f32_16x16x32_bf16 v[60:63], a[12:15], a[112:115], v[60:63]
ds_read_b128 a[60:63], v202 offset:33792
v_mfma_f32_16x16x32_bf16 v[64:67], a[12:15], a[116:119], v[64:67]
ds_read_b128 a[64:67], v202 offset:34816
v_mul_f32 v198, v146, v146
v_mfma_f32_16x16x32_bf16 v[68:71], a[16:19], a[112:115], v[68:71]
ds_read_b128 a[68:71], v202 offset:35840
buffer_load_dwordx4 a[216:219], v1, s[4:7], s52 offen offset:3072 sc1
v_mfma_f32_16x16x32_bf16 v[72:75], a[16:19], a[116:119], v[72:75]
v_mul_f32 v199, v147, v147
v_mfma_f32_16x16x32_bf16 v[76:79], a[20:23], a[112:115], v[76:79]
v_mfma_f32_16x16x32_bf16 v[80:83], a[20:23], a[116:119], v[80:83]
v_fma_f32 v196, v196, v253, v251
v_mfma_f32_16x16x32_bf16 v[84:87], a[24:27], a[112:115], v[84:87]
buffer_load_dwordx4 a[220:223], v9, s[4:7], s52 offen offset:3072 sc1
v_mfma_f32_16x16x32_bf16 v[88:91], a[24:27], a[116:119], v[88:91]
v_mfma_f32_16x16x32_bf16 v[92:95], a[28:31], a[112:115], v[92:95]
v_fma_f32 v197, v197, v253, v251
v_mfma_f32_16x16x32_bf16 v[96:99], a[28:31], a[116:119], v[96:99]
v_mfma_f32_16x16x32_bf16 v[100:103], a[32:35], a[112:115], v[100:103]
v_fma_f32 v198, v198, v253, v251
v_mfma_f32_16x16x32_bf16 v[104:107], a[32:35], a[116:119], v[104:107]
s_waitcnt vmcnt(21) lgkmcnt(0)
s_barrier
v_mfma_f32_16x16x32_bf16 v[36:39], a[36:39], a[120:123], v[36:39]
ds_read_b128 a[0:3], v200 offset:0
v_mfma_f32_16x16x32_bf16 v[40:43], a[36:39], a[124:127], v[40:43]
ds_read_b128 a[4:7], v200 offset:1024
v_fma_f32 v199, v199, v253, v251
v_mfma_f32_16x16x32_bf16 v[44:47], a[40:43], a[120:123], v[44:47]
ds_read_b128 a[8:11], v200 offset:2048
v_mfma_f32_16x16x32_bf16 v[48:51], a[40:43], a[124:127], v[48:51]
ds_read_b128 a[12:15], v200 offset:3072
v_mul_f32 v196, v196, v144
v_mfma_f32_16x16x32_bf16 v[52:55], a[44:47], a[120:123], v[52:55]
ds_read_b128 a[16:19], v200 offset:4096
v_mfma_f32_16x16x32_bf16 v[56:59], a[44:47], a[124:127], v[56:59]
ds_read_b128 a[20:23], v200 offset:5120
v_mul_f32 v197, v197, v145
v_mfma_f32_16x16x32_bf16 v[60:63], a[48:51], a[120:123], v[60:63]
ds_read_b128 a[24:27], v200 offset:6144
v_mfma_f32_16x16x32_bf16 v[64:67], a[48:51], a[124:127], v[64:67]
ds_read_b128 a[28:31], v200 offset:7168
v_mfma_f32_16x16x32_bf16 v[68:71], a[52:55], a[120:123], v[68:71]
ds_read_b128 a[32:35], v200 offset:8192
v_mul_f32 v198, v198, v146
v_mfma_f32_16x16x32_bf16 v[72:75], a[52:55], a[124:127], v[72:75]
s_cmp_eq_u32 s25, 5
s_cselect_b32 s99, 36864, 0
s_add_u32 s60, s60, s99
v_mfma_f32_16x16x32_bf16 v[76:79], a[56:59], a[120:123], v[76:79]
s_add_u32 s61, s61, s99
s_add_u32 m0, s62, 126976
s_add_u32 s60, s60, 16384
v_mfma_f32_16x16x32_bf16 v[80:83], a[56:59], a[124:127], v[80:83]
buffer_load_dwordx4 v1, s[8:11], s60 offen offset:0 sc1 lds
v_mul_f32 v199, v199, v147
v_mfma_f32_16x16x32_bf16 v[84:87], a[60:63], a[120:123], v[84:87]
buffer_load_dwordx4 v1, s[8:11], s60 offen offset:1024 sc1 lds
v_mfma_f32_16x16x32_bf16 v[88:91], a[60:63], a[124:127], v[88:91]
buffer_load_dwordx4 v1, s[8:11], s60 offen offset:2048 sc1 lds
v_mfma_f32_16x16x32_bf16 v[92:95], a[64:67], a[120:123], v[92:95]
v_exp_f32 v196, v196
v_mfma_f32_16x16x32_bf16 v[96:99], a[64:67], a[124:127], v[96:99]
buffer_load_dwordx4 v1, s[8:11], s60 offen offset:3072 sc1 lds
v_mfma_f32_16x16x32_bf16 v[100:103], a[68:71], a[120:123], v[100:103]
v_mfma_f32_16x16x32_bf16 v[104:107], a[68:71], a[124:127], v[104:107]
s_waitcnt lgkmcnt(0)
v_mfma_f32_16x16x32_bf16 v[36:39], a[0:3], a[128:131], v[36:39]
ds_read_b128 a[36:39], v200 offset:9216
s_add_u32 m0, s63, 143360
v_mfma_f32_16x16x32_bf16 v[40:43], a[0:3], a[132:135], v[40:43]
ds_read_b128 a[40:43], v200 offset:10240
v_mfma_f32_16x16x32_bf16 v[44:47], a[4:7], a[128:131], v[44:47]
ds_read_b128 a[44:47], v200 offset:11264
s_add_u32 s61, s61, 36864
v_mfma_f32_16x16x32_bf16 v[48:51], a[4:7], a[132:135], v[48:51]
ds_read_b128 a[48:51], v200 offset:12288
v_mfma_f32_16x16x32_bf16 v[52:55], a[8:11], a[128:131], v[52:55]
ds_read_b128 a[52:55], v200 offset:13312
buffer_load_dwordx4 v1, s[8:11], s61 offen offset:0 sc1 lds
v_mfma_f32_16x16x32_bf16 v[56:59], a[8:11], a[132:135], v[56:59]
ds_read_b128 a[56:59], v200 offset:14336
v_mfma_f32_16x16x32_bf16 v[60:63], a[12:15], a[128:131], v[60:63]
ds_read_b128 a[60:63], v200 offset:15360
s_add_u32 m0, s62, 147456
v_mfma_f32_16x16x32_bf16 v[64:67], a[12:15], a[132:135], v[64:67]
ds_read_b128 a[64:67], v200 offset:16384
v_mfma_f32_16x16x32_bf16 v[68:71], a[16:19], a[128:131], v[68:71]
ds_read_b128 a[68:71], v200 offset:17408
s_add_u32 s60, s60, 20480
v_mfma_f32_16x16x32_bf16 v[72:75], a[16:19], a[132:135], v[72:75]
v_exp_f32 v197, v197
v_mfma_f32_16x16x32_bf16 v[76:79], a[20:23], a[128:131], v[76:79]
buffer_load_dwordx4 v1, s[8:11], s60 offen offset:0 sc1 lds
v_mfma_f32_16x16x32_bf16 v[80:83], a[20:23], a[132:135], v[80:83]
v_exp_f32 v198, v198
v_mfma_f32_16x16x32_bf16 v[84:87], a[24:27], a[128:131], v[84:87]
buffer_load_dwordx4 v1, s[8:11], s60 offen offset:1024 sc1 lds
v_mfma_f32_16x16x32_bf16 v[88:91], a[24:27], a[132:135], v[88:91]
v_exp_f32 v199, v199
v_mfma_f32_16x16x32_bf16 v[92:95], a[28:31], a[128:131], v[92:95]
buffer_load_dwordx4 v1, s[8:11], s60 offen offset:2048 sc1 lds
v_fma_f32 v196, v196, v255, v255
v_mfma_f32_16x16x32_bf16 v[96:99], a[28:31], a[132:135], v[96:99]
v_mfma_f32_16x16x32_bf16 v[100:103], a[32:35], a[128:131], v[100:103]
v_fma_f32 v197, v197, v255, v255
v_mfma_f32_16x16x32_bf16 v[104:107], a[32:35], a[132:135], v[104:107]
s_waitcnt lgkmcnt(0)
v_mfma_f32_16x16x32_bf16 v[36:39], a[36:39], a[136:139], v[36:39]
ds_read_b128 a[0:3], v200 offset:18432
buffer_load_dwordx4 v1, s[8:11], s60 offen offset:3072 sc1 lds
v_mfma_f32_16x16x32_bf16 v[40:43], a[36:39], a[140:143], v[40:43]
ds_read_b128 a[4:7], v200 offset:19456
v_fma_f32 v198, v198, v255, v255
v_mfma_f32_16x16x32_bf16 v[44:47], a[40:43], a[136:139], v[44:47]
ds_read_b128 a[8:11], v200 offset:20480
v_fma_f32 v199, v199, v255, v255
v_mfma_f32_16x16x32_bf16 v[48:51], a[40:43], a[140:143], v[48:51]
ds_read_b128 a[12:15], v200 offset:21504
v_mfma_f32_16x16x32_bf16 v[52:55], a[44:47], a[136:139], v[52:55]
ds_read_b128 a[16:19], v200 offset:22528
v_mfma_f32_16x16x32_bf16 v[56:59], a[44:47], a[140:143], v[56:59]
ds_read_b128 a[20:23], v200 offset:23552
v_mfma_f32_16x16x32_bf16 v[60:63], a[48:51], a[136:139], v[60:63]
ds_read_b128 a[24:27], v200 offset:24576
v_mfma_f32_16x16x32_bf16 v[64:67], a[48:51], a[140:143], v[64:67]
ds_read_b128 a[28:31], v200 offset:25600
v_mfma_f32_16x16x32_bf16 v[68:71], a[52:55], a[136:139], v[68:71]
ds_read_b128 a[32:35], v200 offset:26624
v_mfma_f32_16x16x32_bf16 v[72:75], a[52:55], a[140:143], v[72:75]
s_cmp_eq_u32 s25, 6
s_cselect_b32 s98, 4096, 0
s_add_u32 s52, s52, s98
v_mfma_f32_16x16x32_bf16 v[76:79], a[56:59], a[136:139], v[76:79]
s_add_u32 s52, s52, 4096
v_rcp_f32 v196, v196
v_mfma_f32_16x16x32_bf16 v[80:83], a[56:59], a[140:143], v[80:83]
buffer_load_dwordx4 a[224:227], v1, s[4:7], s52 offen offset:0 sc1
v_mfma_f32_16x16x32_bf16 v[84:87], a[60:63], a[136:139], v[84:87]
buffer_load_dwordx4 a[228:231], v9, s[4:7], s52 offen offset:0 sc1
v_mfma_f32_16x16x32_bf16 v[88:91], a[60:63], a[140:143], v[88:91]
v_rcp_f32 v197, v197
v_mfma_f32_16x16x32_bf16 v[92:95], a[64:67], a[136:139], v[92:95]
buffer_load_dwordx4 a[232:235], v1, s[4:7], s52 offen offset:1024 sc1
v_mfma_f32_16x16x32_bf16 v[96:99], a[64:67], a[140:143], v[96:99]
v_rcp_f32 v198, v198
v_mfma_f32_16x16x32_bf16 v[100:103], a[68:71], a[136:139], v[100:103]
v_mfma_f32_16x16x32_bf16 v[104:107], a[68:71], a[140:143], v[104:107]
s_waitcnt lgkmcnt(0)
v_mfma_f32_16x16x32_bf16 v[36:39], a[0:3], a[144:147], v[36:39]
ds_read_b128 a[36:39], v200 offset:27648
buffer_load_dwordx4 a[236:239], v9, s[4:7], s52 offen offset:1024 sc1
v_mfma_f32_16x16x32_bf16 v[40:43], a[0:3], a[148:151], v[40:43]
ds_read_b128 a[40:43], v200 offset:28672
v_mfma_f32_16x16x32_bf16 v[44:47], a[4:7], a[144:147], v[44:47]
ds_read_b128 a[44:47], v200 offset:29696
v_mfma_f32_16x16x32_bf16 v[48:51], a[4:7], a[148:151], v[48:51]
ds_read_b128 a[48:51], v200 offset:30720
v_mfma_f32_16x16x32_bf16 v[52:55], a[8:11], a[144:147], v[52:55]
ds_read_b128 a[52:55], v200 offset:31744
buffer_load_dwordx4 a[240:243], v1, s[4:7], s52 offen offset:2048 sc1
v_mfma_f32_16x16x32_bf16 v[56:59], a[8:11], a[148:151], v[56:59]
ds_read_b128 a[56:59], v200 offset:32768
v_mfma_f32_16x16x32_bf16 v[60:63], a[12:15], a[144:147], v[60:63]
ds_read_b128 a[60:63], v200 offset:33792
v_mfma_f32_16x16x32_bf16 v[64:67], a[12:15], a[148:151], v[64:67]
ds_read_b128 a[64:67], v200 offset:34816
v_mfma_f32_16x16x32_bf16 v[68:71], a[16:19], a[144:147], v[68:71]
ds_read_b128 a[68:71], v200 offset:35840
buffer_load_dwordx4 a[244:247], v9, s[4:7], s52 offen offset:2048 sc1
v_mfma_f32_16x16x32_bf16 v[72:75], a[16:19], a[148:151], v[72:75]
v_rcp_f32 v199, v199
v_mfma_f32_16x16x32_bf16 v[76:79], a[20:23], a[144:147], v[76:79]
v_mul_f32 v144, v144, v196
v_mul_f32 v145, v145, v197
v_mfma_f32_16x16x32_bf16 v[80:83], a[20:23], a[148:151], v[80:83]
v_mul_f32 v146, v146, v198
v_mfma_f32_16x16x32_bf16 v[84:87], a[24:27], a[144:147], v[84:87]
buffer_load_dwordx4 a[248:251], v1, s[4:7], s52 offen offset:3072 sc1
v_mfma_f32_16x16x32_bf16 v[88:91], a[24:27], a[148:151], v[88:91]
v_mul_f32 v147, v147, v199
v_mfma_f32_16x16x32_bf16 v[92:95], a[28:31], a[144:147], v[92:95]
v_mfma_f32_16x16x32_bf16 v[96:99], a[28:31], a[148:151], v[96:99]
v_mul_f32 v192, v148, v148
v_mfma_f32_16x16x32_bf16 v[100:103], a[32:35], a[144:147], v[100:103]
v_mfma_f32_16x16x32_bf16 v[104:107], a[32:35], a[148:151], v[104:107]
s_waitcnt vmcnt(20) lgkmcnt(0)
s_barrier
v_mfma_f32_16x16x32_bf16 v[36:39], a[36:39], a[152:155], v[36:39]
ds_read_b128 a[0:3], v201 offset:0
buffer_load_dwordx4 a[252:255], v9, s[4:7], s52 offen offset:3072 sc1
v_mfma_f32_16x16x32_bf16 v[40:43], a[36:39], a[156:159], v[40:43]
ds_read_b128 a[4:7], v201 offset:1024
v_mul_f32 v193, v149, v149
v_mfma_f32_16x16x32_bf16 v[44:47], a[40:43], a[152:155], v[44:47]
ds_read_b128 a[8:11], v201 offset:2048
v_mul_f32 v194, v150, v150
v_mfma_f32_16x16x32_bf16 v[48:51], a[40:43], a[156:159], v[48:51]
ds_read_b128 a[12:15], v201 offset:3072
v_mfma_f32_16x16x32_bf16 v[52:55], a[44:47], a[152:155], v[52:55]
ds_read_b128 a[16:19], v201 offset:4096
v_mul_f32 v195, v151, v151
v_mfma_f32_16x16x32_bf16 v[56:59], a[44:47], a[156:159], v[56:59]
ds_read_b128 a[20:23], v201 offset:5120
v_mfma_f32_16x16x32_bf16 v[60:63], a[48:51], a[152:155], v[60:63]
ds_read_b128 a[24:27], v201 offset:6144
v_fma_f32 v192, v192, v252, v250
v_mfma_f32_16x16x32_bf16 v[64:67], a[48:51], a[156:159], v[64:67]
ds_read_b128 a[28:31], v201 offset:7168
v_mfma_f32_16x16x32_bf16 v[68:71], a[52:55], a[152:155], v[68:71]
ds_read_b128 a[32:35], v201 offset:8192
v_mfma_f32_16x16x32_bf16 v[72:75], a[52:55], a[156:159], v[72:75]
s_cmp_eq_u32 s25, 6
s_cselect_b32 s99, 36864, 0
s_add_u32 s60, s60, s99
v_mfma_f32_16x16x32_bf16 v[76:79], a[56:59], a[152:155], v[76:79]
s_add_u32 s61, s61, s99
s_add_u32 m0, s62, 53248
s_add_u32 s60, s60, 16384
v_mfma_f32_16x16x32_bf16 v[80:83], a[56:59], a[156:159], v[80:83]
buffer_load_dwordx4 v1, s[8:11], s60 offen offset:0 sc1 lds
v_fma_f32 v193, v193, v252, v250
v_mfma_f32_16x16x32_bf16 v[84:87], a[60:63], a[152:155], v[84:87]
v_fma_f32 v194, v194, v252, v250
v_mfma_f32_16x16x32_bf16 v[88:91], a[60:63], a[156:159], v[88:91]
buffer_load_dwordx4 v1, s[8:11], s60 offen offset:1024 sc1 lds
v_fma_f32 v195, v195, v252, v250
v_mfma_f32_16x16x32_bf16 v[92:95], a[64:67], a[152:155], v[92:95]
v_mfma_f32_16x16x32_bf16 v[96:99], a[64:67], a[156:159], v[96:99]
buffer_load_dwordx4 v1, s[8:11], s60 offen offset:2048 sc1 lds
v_mfma_f32_16x16x32_bf16 v[100:103], a[68:71], a[152:155], v[100:103]
v_mul_f32 v192, v192, v148
v_mfma_f32_16x16x32_bf16 v[104:107], a[68:71], a[156:159], v[104:107]
s_waitcnt lgkmcnt(0)
v_mfma_f32_16x16x32_bf16 v[36:39], a[0:3], a[160:163], v[36:39]
ds_read_b128 a[36:39], v201 offset:9216
buffer_load_dwordx4 v1, s[8:11], s60 offen offset:3072 sc1 lds
v_mfma_f32_16x16x32_bf16 v[40:43], a[0:3], a[164:167], v[40:43]
ds_read_b128 a[40:43], v201 offset:10240
v_mul_f32 v193, v193, v149
v_mfma_f32_16x16x32_bf16 v[44:47], a[4:7], a[160:163], v[44:47]
ds_read_b128 a[44:47], v201 offset:11264
s_add_u32 m0, s63, 69632
v_mfma_f32_16x16x32_bf16 v[48:51], a[4:7], a[164:167], v[48:51]
ds_read_b128 a[48:51], v201 offset:12288
v_mul_f32 v194, v194, v150
v_mfma_f32_16x16x32_bf16 v[52:55], a[8:11], a[160:163], v[52:55]
ds_read_b128 a[52:55], v201 offset:13312
s_add_u32 s61, s61, 36864
v_mfma_f32_16x16x32_bf16 v[56:59], a[8:11], a[164:167], v[56:59]
ds_read_b128 a[56:59], v201 offset:14336
v_mul_f32 v195, v195, v151
v_mfma_f32_16x16x32_bf16 v[60:63], a[12:15], a[160:163], v[60:63]
ds_read_b128 a[60:63], v201 offset:15360
buffer_load_dwordx4 v1, s[8:11], s61 offen offset:0 sc1 lds
v_mfma_f32_16x16x32_bf16 v[64:67], a[12:15], a[164:167], v[64:67]
ds_read_b128 a[64:67], v201 offset:16384
v_mfma_f32_16x16x32_bf16 v[68:71], a[16:19], a[160:163], v[68:71]
ds_read_b128 a[68:71], v201 offset:17408
s_add_u32 m0, s62, 73728
v_mfma_f32_16x16x32_bf16 v[72:75], a[16:19], a[164:167], v[72:75]
s_add_u32 s60, s60, 20480
v_exp_f32 v192, v192
v_mfma_f32_16x16x32_bf16 v[76:79], a[20:23], a[160:163], v[76:79]
v_mfma_f32_16x16x32_bf16 v[80:83], a[20:23], a[164:167], v[80:83]
v_mfma_f32_16x16x32_bf16 v[84:87], a[24:27], a[160:163], v[84:87]
buffer_load_dwordx4 v1, s[8:11], s60 offen offset:0 sc1 lds
v_mfma_f32_16x16x32_bf16 v[88:91], a[24:27], a[164:167], v[88:91]
v_exp_f32 v193, v193
v_mfma_f32_16x16x32_bf16 v[92:95], a[28:31], a[160:163], v[92:95]
buffer_load_dwordx4 v1, s[8:11], s60 offen offset:1024 sc1 lds
v_mfma_f32_16x16x32_bf16 v[96:99], a[28:31], a[164:167], v[96:99]
v_mfma_f32_16x16x32_bf16 v[100:103], a[32:35], a[160:163], v[100:103]
v_mfma_f32_16x16x32_bf16 v[104:107], a[32:35], a[164:167], v[104:107]
s_waitcnt lgkmcnt(0)
v_mfma_f32_16x16x32_bf16 v[36:39], a[36:39], a[168:171], v[36:39]
ds_read_b128 a[0:3], v201 offset:18432
buffer_load_dwordx4 v1, s[8:11], s60 offen offset:2048 sc1 lds
v_mfma_f32_16x16x32_bf16 v[40:43], a[36:39], a[172:175], v[40:43]
ds_read_b128 a[4:7], v201 offset:19456
v_mfma_f32_16x16x32_bf16 v[44:47], a[40:43], a[168:171], v[44:47]
ds_read_b128 a[8:11], v201 offset:20480
buffer_load_dwordx4 v1, s[8:11], s60 offen offset:3072 sc1 lds
v_mfma_f32_16x16x32_bf16 v[48:51], a[40:43], a[172:175], v[48:51]
ds_read_b128 a[12:15], v201 offset:21504
v_mfma_f32_16x16x32_bf16 v[52:55], a[44:47], a[168:171], v[52:55]
ds_read_b128 a[16:19], v201 offset:22528
v_mfma_f32_16x16x32_bf16 v[56:59], a[44:47], a[172:175], v[56:59]
ds_read_b128 a[20:23], v201 offset:23552
v_mfma_f32_16x16x32_bf16 v[60:63], a[48:51], a[168:171], v[60:63]
ds_read_b128 a[24:27], v201 offset:24576
v_mfma_f32_16x16x32_bf16 v[64:67], a[48:51], a[172:175], v[64:67]
ds_read_b128 a[28:31], v201 offset:25600
v_mfma_f32_16x16x32_bf16 v[68:71], a[52:55], a[168:171], v[68:71]
ds_read_b128 a[32:35], v201 offset:26624
v_mfma_f32_16x16x32_bf16 v[72:75], a[52:55], a[172:175], v[72:75]
s_cmp_eq_u32 s25, 7
s_cselect_b32 s98, 4096, 0
s_add_u32 s52, s52, s98
v_mfma_f32_16x16x32_bf16 v[76:79], a[56:59], a[168:171], v[76:79]
s_add_u32 s52, s52, 4096
v_exp_f32 v194, v194
v_mfma_f32_16x16x32_bf16 v[80:83], a[56:59], a[172:175], v[80:83]
v_exp_f32 v195, v195
v_mfma_f32_16x16x32_bf16 v[84:87], a[60:63], a[168:171], v[84:87]
buffer_load_dwordx4 a[80:83], v1, s[4:7], s52 offen offset:0 sc1
v_fma_f32 v192, v192, v254, v254
v_mfma_f32_16x16x32_bf16 v[88:91], a[60:63], a[172:175], v[88:91]
v_fma_f32 v193, v193, v254, v254
v_fma_f32 v194, v194, v254, v254
v_mfma_f32_16x16x32_bf16 v[92:95], a[64:67], a[168:171], v[92:95]
buffer_load_dwordx4 a[84:87], v9, s[4:7], s52 offen offset:0 sc1
v_mfma_f32_16x16x32_bf16 v[96:99], a[64:67], a[172:175], v[96:99]
v_fma_f32 v195, v195, v254, v254
v_mfma_f32_16x16x32_bf16 v[100:103], a[68:71], a[168:171], v[100:103]
v_mfma_f32_16x16x32_bf16 v[104:107], a[68:71], a[172:175], v[104:107]
s_waitcnt lgkmcnt(0)
v_mfma_f32_16x16x32_bf16 v[36:39], a[0:3], a[176:179], v[36:39]
ds_read_b128 a[36:39], v201 offset:27648
buffer_load_dwordx4 a[88:91], v1, s[4:7], s52 offen offset:1024 sc1
v_mfma_f32_16x16x32_bf16 v[40:43], a[0:3], a[180:183], v[40:43]
ds_read_b128 a[40:43], v201 offset:28672
v_mfma_f32_16x16x32_bf16 v[44:47], a[4:7], a[176:179], v[44:47]
ds_read_b128 a[44:47], v201 offset:29696
v_mfma_f32_16x16x32_bf16 v[48:51], a[4:7], a[180:183], v[48:51]
ds_read_b128 a[48:51], v201 offset:30720
v_mfma_f32_16x16x32_bf16 v[52:55], a[8:11], a[176:179], v[52:55]
ds_read_b128 a[52:55], v201 offset:31744
buffer_load_dwordx4 a[92:95], v9, s[4:7], s52 offen offset:1024 sc1
v_mfma_f32_16x16x32_bf16 v[56:59], a[8:11], a[180:183], v[56:59]
ds_read_b128 a[56:59], v201 offset:32768
v_mfma_f32_16x16x32_bf16 v[60:63], a[12:15], a[176:179], v[60:63]
ds_read_b128 a[60:63], v201 offset:33792
v_mfma_f32_16x16x32_bf16 v[64:67], a[12:15], a[180:183], v[64:67]
ds_read_b128 a[64:67], v201 offset:34816
v_mfma_f32_16x16x32_bf16 v[68:71], a[16:19], a[176:179], v[68:71]
ds_read_b128 a[68:71], v201 offset:35840
buffer_load_dwordx4 a[96:99], v1, s[4:7], s52 offen offset:2048 sc1
v_mfma_f32_16x16x32_bf16 v[72:75], a[16:19], a[180:183], v[72:75]
v_rcp_f32 v192, v192
v_mfma_f32_16x16x32_bf16 v[76:79], a[20:23], a[176:179], v[76:79]
v_rcp_f32 v193, v193
v_mfma_f32_16x16x32_bf16 v[80:83], a[20:23], a[180:183], v[80:83]
v_rcp_f32 v194, v194
v_mfma_f32_16x16x32_bf16 v[84:87], a[24:27], a[176:179], v[84:87]
buffer_load_dwordx4 a[100:103], v9, s[4:7], s52 offen offset:2048 sc1
v_mfma_f32_16x16x32_bf16 v[88:91], a[24:27], a[180:183], v[88:91]
v_mfma_f32_16x16x32_bf16 v[92:95], a[28:31], a[176:179], v[92:95]
v_rcp_f32 v195, v195
v_mfma_f32_16x16x32_bf16 v[96:99], a[28:31], a[180:183], v[96:99]
v_mfma_f32_16x16x32_bf16 v[100:103], a[32:35], a[176:179], v[100:103]
v_mfma_f32_16x16x32_bf16 v[104:107], a[32:35], a[180:183], v[104:107]
s_waitcnt vmcnt(23) lgkmcnt(0)
s_barrier
v_mfma_f32_16x16x32_bf16 v[36:39], a[36:39], a[184:187], v[36:39]
ds_read_b128 a[0:3], v202 offset:0
buffer_load_dwordx4 a[104:107], v1, s[4:7], s52 offen offset:3072 sc1
v_mfma_f32_16x16x32_bf16 v[40:43], a[36:39], a[188:191], v[40:43]
ds_read_b128 a[4:7], v202 offset:1024
buffer_load_dwordx4 a[108:111], v9, s[4:7], s52 offen offset:3072 sc1
v_mfma_f32_16x16x32_bf16 v[44:47], a[40:43], a[184:187], v[44:47]
ds_read_b128 a[8:11], v202 offset:2048
v_mul_f32 v148, v148, v192
v_mfma_f32_16x16x32_bf16 v[48:51], a[40:43], a[188:191], v[48:51]
ds_read_b128 a[12:15], v202 offset:3072
v_mul_f32 v149, v149, v193
v_mfma_f32_16x16x32_bf16 v[52:55], a[44:47], a[184:187], v[52:55]
ds_read_b128 a[16:19], v202 offset:4096
v_mfma_f32_16x16x32_bf16 v[56:59], a[44:47], a[188:191], v[56:59]
ds_read_b128 a[20:23], v202 offset:5120
v_mul_f32 v150, v150, v194
v_mfma_f32_16x16x32_bf16 v[60:63], a[48:51], a[184:187], v[60:63]
ds_read_b128 a[24:27], v202 offset:6144
v_mfma_f32_16x16x32_bf16 v[64:67], a[48:51], a[188:191], v[64:67]
ds_read_b128 a[28:31], v202 offset:7168
v_mul_f32 v151, v151, v195
v_mfma_f32_16x16x32_bf16 v[68:71], a[52:55], a[184:187], v[68:71]
ds_read_b128 a[32:35], v202 offset:8192
v_mfma_f32_16x16x32_bf16 v[72:75], a[52:55], a[188:191], v[72:75]
s_cmp_eq_u32 s25, 7
s_cselect_b32 s99, 36864, 0
s_add_u32 s60, s60, s99
v_mfma_f32_16x16x32_bf16 v[76:79], a[56:59], a[184:187], v[76:79]
s_add_u32 s61, s61, s99
s_add_u32 m0, s62, 90112
v_mul_f32 v196, v152, v152
v_mfma_f32_16x16x32_bf16 v[80:83], a[56:59], a[188:191], v[80:83]
s_add_u32 s60, s60, 16384
v_mfma_f32_16x16x32_bf16 v[84:87], a[60:63], a[184:187], v[84:87]
v_mul_f32 v197, v153, v153
v_mfma_f32_16x16x32_bf16 v[88:91], a[60:63], a[188:191], v[88:91]
buffer_load_dwordx4 v1, s[8:11], s60 offen offset:0 sc1 lds
v_mfma_f32_16x16x32_bf16 v[92:95], a[64:67], a[184:187], v[92:95]
v_mul_f32 v198, v154, v154
v_mfma_f32_16x16x32_bf16 v[96:99], a[64:67], a[188:191], v[96:99]
buffer_load_dwordx4 v1, s[8:11], s60 offen offset:1024 sc1 lds
v_mfma_f32_16x16x32_bf16 v[100:103], a[68:71], a[184:187], v[100:103]
v_mfma_f32_16x16x32_bf16 v[104:107], a[68:71], a[188:191], v[104:107]
v_mul_f32 v199, v155, v155
s_waitcnt lgkmcnt(0)
v_mfma_f32_16x16x32_bf16 v[36:39], a[0:3], a[192:195], v[36:39]
ds_read_b128 a[36:39], v202 offset:9216
buffer_load_dwordx4 v1, s[8:11], s60 offen offset:2048 sc1 lds
v_mfma_f32_16x16x32_bf16 v[40:43], a[0:3], a[196:199], v[40:43]
ds_read_b128 a[40:43], v202 offset:10240
v_fma_f32 v196, v196, v253, v251
v_mfma_f32_16x16x32_bf16 v[44:47], a[4:7], a[192:195], v[44:47]
ds_read_b128 a[44:47], v202 offset:11264
buffer_load_dwordx4 v1, s[8:11], s60 offen offset:3072 sc1 lds
v_mfma_f32_16x16x32_bf16 v[48:51], a[4:7], a[196:199], v[48:51]
ds_read_b128 a[48:51], v202 offset:12288
v_mfma_f32_16x16x32_bf16 v[52:55], a[8:11], a[192:195], v[52:55]
ds_read_b128 a[52:55], v202 offset:13312
s_add_u32 m0, s63, 106496
v_mfma_f32_16x16x32_bf16 v[56:59], a[8:11], a[196:199], v[56:59]
ds_read_b128 a[56:59], v202 offset:14336
v_fma_f32 v197, v197, v253, v251
v_mfma_f32_16x16x32_bf16 v[60:63], a[12:15], a[192:195], v[60:63]
ds_read_b128 a[60:63], v202 offset:15360
s_add_u32 s61, s61, 36864
v_mfma_f32_16x16x32_bf16 v[64:67], a[12:15], a[196:199], v[64:67]
ds_read_b128 a[64:67], v202 offset:16384
v_fma_f32 v198, v198, v253, v251
v_mfma_f32_16x16x32_bf16 v[68:71], a[16:19], a[192:195], v[68:71]
ds_read_b128 a[68:71], v202 offset:17408
buffer_load_dwordx4 v1, s[8:11], s61 offen offset:0 sc1 lds
v_mfma_f32_16x16x32_bf16 v[72:75], a[16:19], a[196:199], v[72:75]
s_add_u32 m0, s62, 110592
v_fma_f32 v199, v199, v253, v251
v_mfma_f32_16x16x32_bf16 v[76:79], a[20:23], a[192:195], v[76:79]
s_add_u32 s60, s60, 20480
v_mfma_f32_16x16x32_bf16 v[80:83], a[20:23], a[196:199], v[80:83]
v_mul_f32 v196, v196, v152
v_mfma_f32_16x16x32_bf16 v[84:87], a[24:27], a[192:195], v[84:87]
v_mfma_f32_16x16x32_bf16 v[88:91], a[24:27], a[196:199], v[88:91]
v_mul_f32 v197, v197, v153
v_mfma_f32_16x16x32_bf16 v[92:95], a[28:31], a[192:195], v[92:95]
buffer_load_dwordx4 v1, s[8:11], s60 offen offset:0 sc1 lds
v_mfma_f32_16x16x32_bf16 v[96:99], a[28:31], a[196:199], v[96:99]
v_mul_f32 v198, v198, v154
v_mfma_f32_16x16x32_bf16 v[100:103], a[32:35], a[192:195], v[100:103]
v_mfma_f32_16x16x32_bf16 v[104:107], a[32:35], a[196:199], v[104:107]
s_waitcnt lgkmcnt(0)
v_mfma_f32_16x16x32_bf16 v[36:39], a[36:39], a[200:203], v[36:39]
ds_read_b128 a[0:3], v202 offset:18432
buffer_load_dwordx4 v1, s[8:11], s60 offen offset:1024 sc1 lds
v_mfma_f32_16x16x32_bf16 v[40:43], a[36:39], a[204:207], v[40:43]
ds_read_b128 a[4:7], v202 offset:19456
v_mul_f32 v199, v199, v155
v_mfma_f32_16x16x32_bf16 v[44:47], a[40:43], a[200:203], v[44:47]
ds_read_b128 a[8:11], v202 offset:20480
buffer_load_dwordx4 v1, s[8:11], s60 offen offset:2048 sc1 lds
v_mfma_f32_16x16x32_bf16 v[48:51], a[40:43], a[204:207], v[48:51]
ds_read_b128 a[12:15], v202 offset:21504
v_mfma_f32_16x16x32_bf16 v[52:55], a[44:47], a[200:203], v[52:55]
ds_read_b128 a[16:19], v202 offset:22528
buffer_load_dwordx4 v1, s[8:11], s60 offen offset:3072 sc1 lds
v_mfma_f32_16x16x32_bf16 v[56:59], a[44:47], a[204:207], v[56:59]
ds_read_b128 a[20:23], v202 offset:23552
v_mfma_f32_16x16x32_bf16 v[60:63], a[48:51], a[200:203], v[60:63]
ds_read_b128 a[24:27], v202 offset:24576
v_mfma_f32_16x16x32_bf16 v[64:67], a[48:51], a[204:207], v[64:67]
ds_read_b128 a[28:31], v202 offset:25600
v_mfma_f32_16x16x32_bf16 v[68:71], a[52:55], a[200:203], v[68:71]
ds_read_b128 a[32:35], v202 offset:26624
v_mfma_f32_16x16x32_bf16 v[72:75], a[52:55], a[204:207], v[72:75]
s_cmp_eq_u32 s25, 8
s_cselect_b32 s98, 4096, 0
v_mfma_f32_16x16x32_bf16 v[76:79], a[56:59], a[200:203], v[76:79]
s_add_u32 s52, s52, s98
v_exp_f32 v196, v196
v_mfma_f32_16x16x32_bf16 v[80:83], a[56:59], a[204:207], v[80:83]
s_add_u32 s52, s52, 4096
v_exp_f32 v197, v197
v_mfma_f32_16x16x32_bf16 v[84:87], a[60:63], a[200:203], v[84:87]
v_exp_f32 v198, v198
v_mfma_f32_16x16x32_bf16 v[88:91], a[60:63], a[204:207], v[88:91]
v_mfma_f32_16x16x32_bf16 v[92:95], a[64:67], a[200:203], v[92:95]
buffer_load_dwordx4 a[112:115], v1, s[4:7], s52 offen offset:0 sc1
v_mfma_f32_16x16x32_bf16 v[96:99], a[64:67], a[204:207], v[96:99]
v_mfma_f32_16x16x32_bf16 v[100:103], a[68:71], a[200:203], v[100:103]
v_exp_f32 v199, v199
v_mfma_f32_16x16x32_bf16 v[104:107], a[68:71], a[204:207], v[104:107]
s_waitcnt lgkmcnt(0)
v_mfma_f32_16x16x32_bf16 v[36:39], a[0:3], a[208:211], v[36:39]
ds_read_b128 a[36:39], v202 offset:27648
buffer_load_dwordx4 a[116:119], v9, s[4:7], s52 offen offset:0 sc1
v_mfma_f32_16x16x32_bf16 v[40:43], a[0:3], a[212:215], v[40:43]
ds_read_b128 a[40:43], v202 offset:28672
v_mfma_f32_16x16x32_bf16 v[44:47], a[4:7], a[208:211], v[44:47]
ds_read_b128 a[44:47], v202 offset:29696
v_mfma_f32_16x16x32_bf16 v[48:51], a[4:7], a[212:215], v[48:51]
ds_read_b128 a[48:51], v202 offset:30720
v_fma_f32 v196, v196, v255, v255
v_mfma_f32_16x16x32_bf16 v[52:55], a[8:11], a[208:211], v[52:55]
ds_read_b128 a[52:55], v202 offset:31744
buffer_load_dwordx4 a[120:123], v1, s[4:7], s52 offen offset:1024 sc1
v_mfma_f32_16x16x32_bf16 v[56:59], a[8:11], a[212:215], v[56:59]
ds_read_b128 a[56:59], v202 offset:32768
v_fma_f32 v197, v197, v255, v255
v_mfma_f32_16x16x32_bf16 v[60:63], a[12:15], a[208:211], v[60:63]
ds_read_b128 a[60:63], v202 offset:33792
v_mfma_f32_16x16x32_bf16 v[64:67], a[12:15], a[212:215], v[64:67]
ds_read_b128 a[64:67], v202 offset:34816
v_mfma_f32_16x16x32_bf16 v[68:71], a[16:19], a[208:211], v[68:71]
ds_read_b128 a[68:71], v202 offset:35840
buffer_load_dwordx4 a[124:127], v9, s[4:7], s52 offen offset:1024 sc1
v_mfma_f32_16x16x32_bf16 v[72:75], a[16:19], a[212:215], v[72:75]
v_fma_f32 v198, v198, v255, v255
v_mfma_f32_16x16x32_bf16 v[76:79], a[20:23], a[208:211], v[76:79]
v_fma_f32 v199, v199, v255, v255
v_mfma_f32_16x16x32_bf16 v[80:83], a[20:23], a[212:215], v[80:83]
v_mfma_f32_16x16x32_bf16 v[84:87], a[24:27], a[208:211], v[84:87]
buffer_load_dwordx4 a[128:131], v1, s[4:7], s52 offen offset:2048 sc1
v_mfma_f32_16x16x32_bf16 v[88:91], a[24:27], a[212:215], v[88:91]
v_rcp_f32 v196, v196
v_mfma_f32_16x16x32_bf16 v[92:95], a[28:31], a[208:211], v[92:95]
v_mfma_f32_16x16x32_bf16 v[96:99], a[28:31], a[212:215], v[96:99]
v_mfma_f32_16x16x32_bf16 v[100:103], a[32:35], a[208:211], v[100:103]
v_mfma_f32_16x16x32_bf16 v[104:107], a[32:35], a[212:215], v[104:107]
s_waitcnt vmcnt(22) lgkmcnt(0)
s_barrier
v_mfma_f32_16x16x32_bf16 v[36:39], a[36:39], a[216:219], v[36:39]
ds_read_b128 a[0:3], v200 offset:0
buffer_load_dwordx4 a[132:135], v9, s[4:7], s52 offen offset:2048 sc1
v_mfma_f32_16x16x32_bf16 v[40:43], a[36:39], a[220:223], v[40:43]
ds_read_b128 a[4:7], v200 offset:1024
buffer_load_dwordx4 a[136:139], v1, s[4:7], s52 offen offset:3072 sc1
v_mfma_f32_16x16x32_bf16 v[44:47], a[40:43], a[216:219], v[44:47]
ds_read_b128 a[8:11], v200 offset:2048
v_mfma_f32_16x16x32_bf16 v[48:51], a[40:43], a[220:223], v[48:51]
ds_read_b128 a[12:15], v200 offset:3072
buffer_load_dwordx4 a[140:143], v9, s[4:7], s52 offen offset:3072 sc1
v_mfma_f32_16x16x32_bf16 v[52:55], a[44:47], a[216:219], v[52:55]
ds_read_b128 a[16:19], v200 offset:4096
v_mfma_f32_16x16x32_bf16 v[56:59], a[44:47], a[220:223], v[56:59]
ds_read_b128 a[20:23], v200 offset:5120
v_mfma_f32_16x16x32_bf16 v[60:63], a[48:51], a[216:219], v[60:63]
ds_read_b128 a[24:27], v200 offset:6144
v_mfma_f32_16x16x32_bf16 v[64:67], a[48:51], a[220:223], v[64:67]
ds_read_b128 a[28:31], v200 offset:7168
v_mfma_f32_16x16x32_bf16 v[68:71], a[52:55], a[216:219], v[68:71]
ds_read_b128 a[32:35], v200 offset:8192
v_mfma_f32_16x16x32_bf16 v[72:75], a[52:55], a[220:223], v[72:75]
s_cmp_eq_u32 s25, 8
s_cselect_b32 s99, 36864, 0
s_add_u32 s60, s60, s99
v_mfma_f32_16x16x32_bf16 v[76:79], a[56:59], a[216:219], v[76:79]
s_add_u32 s61, s61, s99
v_rcp_f32 v197, v197
v_mfma_f32_16x16x32_bf16 v[80:83], a[56:59], a[220:223], v[80:83]
s_add_u32 m0, s62, 126976
v_rcp_f32 v198, v198
v_mfma_f32_16x16x32_bf16 v[84:87], a[60:63], a[216:219], v[84:87]
s_add_u32 s60, s60, 16384
v_rcp_f32 v199, v199
v_mfma_f32_16x16x32_bf16 v[88:91], a[60:63], a[220:223], v[88:91]
v_mul_f32 v152, v152, v196
v_mfma_f32_16x16x32_bf16 v[92:95], a[64:67], a[216:219], v[92:95]
v_mfma_f32_16x16x32_bf16 v[96:99], a[64:67], a[220:223], v[96:99]
buffer_load_dwordx4 v1, s[8:11], s60 offen offset:0 sc1 lds
v_mfma_f32_16x16x32_bf16 v[100:103], a[68:71], a[216:219], v[100:103]
v_mul_f32 v153, v153, v197
v_mfma_f32_16x16x32_bf16 v[104:107], a[68:71], a[220:223], v[104:107]
s_waitcnt lgkmcnt(0)
v_mfma_f32_16x16x32_bf16 v[36:39], a[0:3], a[224:227], v[36:39]
ds_read_b128 a[36:39], v200 offset:9216
buffer_load_dwordx4 v1, s[8:11], s60 offen offset:1024 sc1 lds
v_mfma_f32_16x16x32_bf16 v[40:43], a[0:3], a[228:231], v[40:43]
ds_read_b128 a[40:43], v200 offset:10240
v_mul_f32 v154, v154, v198
v_mfma_f32_16x16x32_bf16 v[44:47], a[4:7], a[224:227], v[44:47]
ds_read_b128 a[44:47], v200 offset:11264
buffer_load_dwordx4 v1, s[8:11], s60 offen offset:2048 sc1 lds
v_mfma_f32_16x16x32_bf16 v[48:51], a[4:7], a[228:231], v[48:51]
ds_read_b128 a[48:51], v200 offset:12288
v_mul_f32 v155, v155, v199
v_mfma_f32_16x16x32_bf16 v[52:55], a[8:11], a[224:227], v[52:55]
ds_read_b128 a[52:55], v200 offset:13312
v_mfma_f32_16x16x32_bf16 v[56:59], a[8:11], a[228:231], v[56:59]
ds_read_b128 a[56:59], v200 offset:14336
buffer_load_dwordx4 v1, s[8:11], s60 offen offset:3072 sc1 lds
v_mfma_f32_16x16x32_bf16 v[60:63], a[12:15], a[224:227], v[60:63]
ds_read_b128 a[60:63], v200 offset:15360
v_mul_f32 v192, v156, v156
v_mfma_f32_16x16x32_bf16 v[64:67], a[12:15], a[228:231], v[64:67]
ds_read_b128 a[64:67], v200 offset:16384
v_mul_f32 v193, v157, v157
v_mfma_f32_16x16x32_bf16 v[68:71], a[16:19], a[224:227], v[68:71]
ds_read_b128 a[68:71], v200 offset:17408
s_add_u32 m0, s63, 143360
v_mfma_f32_16x16x32_bf16 v[72:75], a[16:19], a[228:231], v[72:75]
s_add_u32 s61, s61, 36864
v_mul_f32 v194, v158, v158
v_mfma_f32_16x16x32_bf16 v[76:79], a[20:23], a[224:227], v[76:79]
v_mfma_f32_16x16x32_bf16 v[80:83], a[20:23], a[228:231], v[80:83]
v_mfma_f32_16x16x32_bf16 v[84:87], a[24:27], a[224:227], v[84:87]
v_mul_f32 v195, v159, v159
v_mfma_f32_16x16x32_bf16 v[88:91], a[24:27], a[228:231], v[88:91]
v_mfma_f32_16x16x32_bf16 v[92:95], a[28:31], a[224:227], v[92:95]
buffer_load_dwordx4 v1, s[8:11], s61 offen offset:0 sc1 lds
v_fma_f32 v192, v192, v252, v250
v_mfma_f32_16x16x32_bf16 v[96:99], a[28:31], a[228:231], v[96:99]
v_mfma_f32_16x16x32_bf16 v[100:103], a[32:35], a[224:227], v[100:103]
v_fma_f32 v193, v193, v252, v250
v_mfma_f32_16x16x32_bf16 v[104:107], a[32:35], a[228:231], v[104:107]
s_waitcnt lgkmcnt(0)
v_mfma_f32_16x16x32_bf16 v[36:39], a[36:39], a[232:235], v[36:39]
ds_read_b128 a[0:3], v200 offset:18432
s_add_u32 m0, s62, 147456
v_mfma_f32_16x16x32_bf16 v[40:43], a[36:39], a[236:239], v[40:43]
ds_read_b128 a[4:7], v200 offset:19456
v_fma_f32 v194, v194, v252, v250
v_mfma_f32_16x16x32_bf16 v[44:47], a[40:43], a[232:235], v[44:47]
ds_read_b128 a[8:11], v200 offset:20480
s_add_u32 s60, s60, 20480
v_mfma_f32_16x16x32_bf16 v[48:51], a[40:43], a[236:239], v[48:51]
ds_read_b128 a[12:15], v200 offset:21504
v_fma_f32 v195, v195, v252, v250
v_mfma_f32_16x16x32_bf16 v[52:55], a[44:47], a[232:235], v[52:55]
ds_read_b128 a[16:19], v200 offset:22528
v_mfma_f32_16x16x32_bf16 v[56:59], a[44:47], a[236:239], v[56:59]
ds_read_b128 a[20:23], v200 offset:23552
buffer_load_dwordx4 v1, s[8:11], s60 offen offset:0 sc1 lds
v_mfma_f32_16x16x32_bf16 v[60:63], a[48:51], a[232:235], v[60:63]
ds_read_b128 a[24:27], v200 offset:24576
v_mul_f32 v192, v192, v156
v_mfma_f32_16x16x32_bf16 v[64:67], a[48:51], a[236:239], v[64:67]
ds_read_b128 a[28:31], v200 offset:25600
v_mfma_f32_16x16x32_bf16 v[68:71], a[52:55], a[232:235], v[68:71]
ds_read_b128 a[32:35], v200 offset:26624
buffer_load_dwordx4 v1, s[8:11], s60 offen offset:1024 sc1 lds
v_mfma_f32_16x16x32_bf16 v[72:75], a[52:55], a[236:239], v[72:75]
v_mul_f32 v193, v193, v157
v_mfma_f32_16x16x32_bf16 v[76:79], a[56:59], a[232:235], v[76:79]
v_mul_f32 v194, v194, v158
v_mfma_f32_16x16x32_bf16 v[80:83], a[56:59], a[236:239], v[80:83]
buffer_load_dwordx4 v1, s[8:11], s60 offen offset:2048 sc1 lds
v_mfma_f32_16x16x32_bf16 v[84:87], a[60:63], a[232:235], v[84:87]
v_mfma_f32_16x16x32_bf16 v[88:91], a[60:63], a[236:239], v[88:91]
v_mul_f32 v195, v195, v159
v_mfma_f32_16x16x32_bf16 v[92:95], a[64:67], a[232:235], v[92:95]
buffer_load_dwordx4 v1, s[8:11], s60 offen offset:3072 sc1 lds
v_mfma_f32_16x16x32_bf16 v[96:99], a[64:67], a[236:239], v[96:99]
v_exp_f32 v192, v192
v_mfma_f32_16x16x32_bf16 v[100:103], a[68:71], a[232:235], v[100:103]
v_mfma_f32_16x16x32_bf16 v[104:107], a[68:71], a[236:239], v[104:107]
s_waitcnt lgkmcnt(0)
v_mfma_f32_16x16x32_bf16 v[36:39], a[0:3], a[240:243], v[36:39]
ds_read_b128 a[36:39], v200 offset:27648
v_mfma_f32_16x16x32_bf16 v[40:43], a[0:3], a[244:247], v[40:43]
ds_read_b128 a[40:43], v200 offset:28672
v_mfma_f32_16x16x32_bf16 v[44:47], a[4:7], a[240:243], v[44:47]
ds_read_b128 a[44:47], v200 offset:29696
v_mfma_f32_16x16x32_bf16 v[48:51], a[4:7], a[244:247], v[48:51]
ds_read_b128 a[48:51], v200 offset:30720
v_mfma_f32_16x16x32_bf16 v[52:55], a[8:11], a[240:243], v[52:55]
ds_read_b128 a[52:55], v200 offset:31744
v_mfma_f32_16x16x32_bf16 v[56:59], a[8:11], a[244:247], v[56:59]
ds_read_b128 a[56:59], v200 offset:32768
v_mfma_f32_16x16x32_bf16 v[60:63], a[12:15], a[240:243], v[60:63]
ds_read_b128 a[60:63], v200 offset:33792
v_mfma_f32_16x16x32_bf16 v[64:67], a[12:15], a[244:247], v[64:67]
ds_read_b128 a[64:67], v200 offset:34816
v_mfma_f32_16x16x32_bf16 v[68:71], a[16:19], a[240:243], v[68:71]
ds_read_b128 a[68:71], v200 offset:35840
v_mfma_f32_16x16x32_bf16 v[72:75], a[16:19], a[244:247], v[72:75]
s_cmp_eq_u32 s25, 9
s_cselect_b32 s98, 4096, 0
s_add_u32 s52, s52, s98
v_mfma_f32_16x16x32_bf16 v[76:79], a[20:23], a[240:243], v[76:79]
s_add_u32 s52, s52, 4096
v_exp_f32 v193, v193
v_mfma_f32_16x16x32_bf16 v[80:83], a[20:23], a[244:247], v[80:83]
buffer_load_dwordx4 a[144:147], v1, s[4:7], s52 offen offset:0 sc1
v_mfma_f32_16x16x32_bf16 v[84:87], a[24:27], a[240:243], v[84:87]
buffer_load_dwordx4 a[148:151], v9, s[4:7], s52 offen offset:0 sc1
v_mfma_f32_16x16x32_bf16 v[88:91], a[24:27], a[244:247], v[88:91]
buffer_load_dwordx4 a[152:155], v1, s[4:7], s52 offen offset:1024 sc1
v_mfma_f32_16x16x32_bf16 v[92:95], a[28:31], a[240:243], v[92:95]
buffer_load_dwordx4 a[156:159], v9, s[4:7], s52 offen offset:1024 sc1
v_mfma_f32_16x16x32_bf16 v[96:99], a[28:31], a[244:247], v[96:99]
v_exp_f32 v194, v194
v_mfma_f32_16x16x32_bf16 v[100:103], a[32:35], a[240:243], v[100:103]
v_exp_f32 v195, v195
v_mfma_f32_16x16x32_bf16 v[104:107], a[32:35], a[244:247], v[104:107]
s_waitcnt vmcnt(21) lgkmcnt(0)
s_barrier
v_mfma_f32_16x16x32_bf16 v[36:39], a[36:39], a[248:251], v[36:39]
ds_read_b128 a[0:3], v201 offset:0
v_fma_f32 v192, v192, v254, v254
v_mfma_f32_16x16x32_bf16 v[40:43], a[36:39], a[252:255], v[40:43]
ds_read_b128 a[4:7], v201 offset:1024
v_fma_f32 v193, v193, v254, v254
v_mfma_f32_16x16x32_bf16 v[44:47], a[40:43], a[248:251], v[44:47]
ds_read_b128 a[8:11], v201 offset:2048
v_fma_f32 v194, v194, v254, v254
v_mfma_f32_16x16x32_bf16 v[48:51], a[40:43], a[252:255], v[48:51]
ds_read_b128 a[12:15], v201 offset:3072
v_mfma_f32_16x16x32_bf16 v[52:55], a[44:47], a[248:251], v[52:55]
ds_read_b128 a[16:19], v201 offset:4096
v_mfma_f32_16x16x32_bf16 v[56:59], a[44:47], a[252:255], v[56:59]
ds_read_b128 a[20:23], v201 offset:5120
v_fma_f32 v195, v195, v254, v254
v_mfma_f32_16x16x32_bf16 v[60:63], a[48:51], a[248:251], v[60:63]
ds_read_b128 a[24:27], v201 offset:6144
v_mfma_f32_16x16x32_bf16 v[64:67], a[48:51], a[252:255], v[64:67]
ds_read_b128 a[28:31], v201 offset:7168
v_mfma_f32_16x16x32_bf16 v[68:71], a[52:55], a[248:251], v[68:71]
ds_read_b128 a[32:35], v201 offset:8192
v_mfma_f32_16x16x32_bf16 v[72:75], a[52:55], a[252:255], v[72:75]
s_cmp_eq_u32 s25, 9
s_cselect_b32 s99, 36864, 0
s_add_u32 s60, s60, s99
v_mfma_f32_16x16x32_bf16 v[76:79], a[56:59], a[248:251], v[76:79]
s_add_u32 s61, s61, s99
s_add_u32 m0, s62, 53248
s_add_u32 s60, s60, 16384
v_mfma_f32_16x16x32_bf16 v[80:83], a[56:59], a[252:255], v[80:83]
buffer_load_dwordx4 v1, s[8:11], s60 offen offset:0 sc1 lds
v_mfma_f32_16x16x32_bf16 v[84:87], a[60:63], a[248:251], v[84:87]
buffer_load_dwordx4 v1, s[8:11], s60 offen offset:1024 sc1 lds
v_mfma_f32_16x16x32_bf16 v[88:91], a[60:63], a[252:255], v[88:91]
buffer_load_dwordx4 v1, s[8:11], s60 offen offset:2048 sc1 lds
v_mfma_f32_16x16x32_bf16 v[92:95], a[64:67], a[248:251], v[92:95]
v_rcp_f32 v192, v192
v_mfma_f32_16x16x32_bf16 v[96:99], a[64:67], a[252:255], v[96:99]
buffer_load_dwordx4 v1, s[8:11], s60 offen offset:3072 sc1 lds
v_mfma_f32_16x16x32_bf16 v[100:103], a[68:71], a[248:251], v[100:103]
v_rcp_f32 v193, v193
v_mfma_f32_16x16x32_bf16 v[104:107], a[68:71], a[252:255], v[104:107]
s_waitcnt lgkmcnt(0)
v_mfma_f32_16x16x32_bf16 v[36:39], a[0:3], a[80:83], v[36:39]
ds_read_b128 a[36:39], v201 offset:9216
s_add_u32 m0, s63, 69632
v_mfma_f32_16x16x32_bf16 v[40:43], a[0:3], a[84:87], v[40:43]
ds_read_b128 a[40:43], v201 offset:10240
v_mfma_f32_16x16x32_bf16 v[44:47], a[4:7], a[80:83], v[44:47]
ds_read_b128 a[44:47], v201 offset:11264
s_add_u32 s61, s61, 36864
v_mfma_f32_16x16x32_bf16 v[48:51], a[4:7], a[84:87], v[48:51]
ds_read_b128 a[48:51], v201 offset:12288
v_mfma_f32_16x16x32_bf16 v[52:55], a[8:11], a[80:83], v[52:55]
ds_read_b128 a[52:55], v201 offset:13312
buffer_load_dwordx4 v1, s[8:11], s61 offen offset:0 sc1 lds
v_mfma_f32_16x16x32_bf16 v[56:59], a[8:11], a[84:87], v[56:59]
ds_read_b128 a[56:59], v201 offset:14336
v_mfma_f32_16x16x32_bf16 v[60:63], a[12:15], a[80:83], v[60:63]
ds_read_b128 a[60:63], v201 offset:15360
s_add_u32 m0, s62, 73728
v_mfma_f32_16x16x32_bf16 v[64:67], a[12:15], a[84:87], v[64:67]
ds_read_b128 a[64:67], v201 offset:16384
v_mfma_f32_16x16x32_bf16 v[68:71], a[16:19], a[80:83], v[68:71]
ds_read_b128 a[68:71], v201 offset:17408
s_add_u32 s60, s60, 20480
v_mfma_f32_16x16x32_bf16 v[72:75], a[16:19], a[84:87], v[72:75]
v_rcp_f32 v194, v194
v_mfma_f32_16x16x32_bf16 v[76:79], a[20:23], a[80:83], v[76:79]
buffer_load_dwordx4 v1, s[8:11], s60 offen offset:0 sc1 lds
v_mfma_f32_16x16x32_bf16 v[80:83], a[20:23], a[84:87], v[80:83]
v_rcp_f32 v195, v195
v_mfma_f32_16x16x32_bf16 v[84:87], a[24:27], a[80:83], v[84:87]
buffer_load_dwordx4 v1, s[8:11], s60 offen offset:1024 sc1 lds
v_mul_f32 v156, v156, v192
v_mfma_f32_16x16x32_bf16 v[88:91], a[24:27], a[84:87], v[88:91]
v_mul_f32 v157, v157, v193
v_mul_f32 v158, v158, v194
v_mfma_f32_16x16x32_bf16 v[92:95], a[28:31], a[80:83], v[92:95]
buffer_load_dwordx4 v1, s[8:11], s60 offen offset:2048 sc1 lds
v_mfma_f32_16x16x32_bf16 v[96:99], a[28:31], a[84:87], v[96:99]
v_mul_f32 v159, v159, v195
v_mfma_f32_16x16x32_bf16 v[100:103], a[32:35], a[80:83], v[100:103]
v_mfma_f32_16x16x32_bf16 v[104:107], a[32:35], a[84:87], v[104:107]
v_mul_f32 v196, v160, v160
s_waitcnt lgkmcnt(0)
v_mfma_f32_16x16x32_bf16 v[36:39], a[36:39], a[88:91], v[36:39]
ds_read_b128 a[0:3], v201 offset:18432
buffer_load_dwordx4 v1, s[8:11], s60 offen offset:3072 sc1 lds
v_mfma_f32_16x16x32_bf16 v[40:43], a[36:39], a[92:95], v[40:43]
ds_read_b128 a[4:7], v201 offset:19456
v_mfma_f32_16x16x32_bf16 v[44:47], a[40:43], a[88:91], v[44:47]
ds_read_b128 a[8:11], v201 offset:20480
v_mul_f32 v197, v161, v161
v_mfma_f32_16x16x32_bf16 v[48:51], a[40:43], a[92:95], v[48:51]
ds_read_b128 a[12:15], v201 offset:21504
v_mfma_f32_16x16x32_bf16 v[52:55], a[44:47], a[88:91], v[52:55]
ds_read_b128 a[16:19], v201 offset:22528
buffer_load_dwordx4 a[160:163], v1, s[4:7], s52 offen offset:2048 sc1
v_mfma_f32_16x16x32_bf16 v[56:59], a[44:47], a[92:95], v[56:59]
ds_read_b128 a[20:23], v201 offset:23552
v_mul_f32 v198, v162, v162
v_mfma_f32_16x16x32_bf16 v[60:63], a[48:51], a[88:91], v[60:63]
ds_read_b128 a[24:27], v201 offset:24576
v_mfma_f32_16x16x32_bf16 v[64:67], a[48:51], a[92:95], v[64:67]
ds_read_b128 a[28:31], v201 offset:25600
v_mul_f32 v199, v163, v163
v_mfma_f32_16x16x32_bf16 v[68:71], a[52:55], a[88:91], v[68:71]
ds_read_b128 a[32:35], v201 offset:26624
buffer_load_dwordx4 a[164:167], v9, s[4:7], s52 offen offset:2048 sc1
v_mfma_f32_16x16x32_bf16 v[72:75], a[52:55], a[92:95], v[72:75]
v_fma_f32 v196, v196, v253, v251
v_mfma_f32_16x16x32_bf16 v[76:79], a[56:59], a[88:91], v[76:79]
v_mfma_f32_16x16x32_bf16 v[80:83], a[56:59], a[92:95], v[80:83]
v_fma_f32 v197, v197, v253, v251
v_mfma_f32_16x16x32_bf16 v[84:87], a[60:63], a[88:91], v[84:87]
buffer_load_dwordx4 a[168:171], v1, s[4:7], s52 offen offset:3072 sc1
v_mfma_f32_16x16x32_bf16 v[88:91], a[60:63], a[92:95], v[88:91]
v_mfma_f32_16x16x32_bf16 v[92:95], a[64:67], a[88:91], v[92:95]
v_fma_f32 v198, v198, v253, v251
v_mfma_f32_16x16x32_bf16 v[96:99], a[64:67], a[92:95], v[96:99]
v_mfma_f32_16x16x32_bf16 v[100:103], a[68:71], a[88:91], v[100:103]
v_fma_f32 v199, v199, v253, v251
v_mfma_f32_16x16x32_bf16 v[104:107], a[68:71], a[92:95], v[104:107]
s_waitcnt lgkmcnt(0)
v_mfma_f32_16x16x32_bf16 v[36:39], a[0:3], a[96:99], v[36:39]
ds_read_b128 a[36:39], v201 offset:27648
buffer_load_dwordx4 a[172:175], v9, s[4:7], s52 offen offset:3072 sc1
v_mfma_f32_16x16x32_bf16 v[40:43], a[0:3], a[100:103], v[40:43]
ds_read_b128 a[40:43], v201 offset:28672
v_mul_f32 v196, v196, v160
v_mfma_f32_16x16x32_bf16 v[44:47], a[4:7], a[96:99], v[44:47]
ds_read_b128 a[44:47], v201 offset:29696
v_mfma_f32_16x16x32_bf16 v[48:51], a[4:7], a[100:103], v[48:51]
ds_read_b128 a[48:51], v201 offset:30720
v_mul_f32 v197, v197, v161
v_mfma_f32_16x16x32_bf16 v[52:55], a[8:11], a[96:99], v[52:55]
ds_read_b128 a[52:55], v201 offset:31744
v_mfma_f32_16x16x32_bf16 v[56:59], a[8:11], a[100:103], v[56:59]
ds_read_b128 a[56:59], v201 offset:32768
v_mul_f32 v198, v198, v162
v_mfma_f32_16x16x32_bf16 v[60:63], a[12:15], a[96:99], v[60:63]
ds_read_b128 a[60:63], v201 offset:33792
v_mfma_f32_16x16x32_bf16 v[64:67], a[12:15], a[100:103], v[64:67]
ds_read_b128 a[64:67], v201 offset:34816
v_mul_f32 v199, v199, v163
v_mfma_f32_16x16x32_bf16 v[68:71], a[16:19], a[96:99], v[68:71]
ds_read_b128 a[68:71], v201 offset:35840
v_mfma_f32_16x16x32_bf16 v[72:75], a[16:19], a[100:103], v[72:75]
s_cmp_eq_u32 s25, 10
s_cselect_b32 s98, 4096, 0
s_add_u32 s52, s52, s98
v_mfma_f32_16x16x32_bf16 v[76:79], a[20:23], a[96:99], v[76:79]
s_add_u32 s52, s52, 4096
v_exp_f32 v196, v196
v_mfma_f32_16x16x32_bf16 v[80:83], a[20:23], a[100:103], v[80:83]
buffer_load_dwordx4 a[176:179], v1, s[4:7], s52 offen offset:0 sc1
v_mfma_f32_16x16x32_bf16 v[84:87], a[24:27], a[96:99], v[84:87]
buffer_load_dwordx4 a[180:183], v9, s[4:7], s52 offen offset:0 sc1
v_mfma_f32_16x16x32_bf16 v[88:91], a[24:27], a[100:103], v[88:91]
v_mfma_f32_16x16x32_bf16 v[92:95], a[28:31], a[96:99], v[92:95]
buffer_load_dwordx4 a[184:187], v1, s[4:7], s52 offen offset:1024 sc1
v_mfma_f32_16x16x32_bf16 v[96:99], a[28:31], a[100:103], v[96:99]
v_exp_f32 v197, v197
v_mfma_f32_16x16x32_bf16 v[100:103], a[32:35], a[96:99], v[100:103]
v_mfma_f32_16x16x32_bf16 v[104:107], a[32:35], a[100:103], v[104:107]
s_waitcnt vmcnt(20) lgkmcnt(0)
s_barrier
v_mfma_f32_16x16x32_bf16 v[36:39], a[36:39], a[104:107], v[36:39]
ds_read_b128 a[0:3], v202 offset:0
buffer_load_dwordx4 a[188:191], v9, s[4:7], s52 offen offset:1024 sc1
v_mfma_f32_16x16x32_bf16 v[40:43], a[36:39], a[108:111], v[40:43]
ds_read_b128 a[4:7], v202 offset:1024
v_mfma_f32_16x16x32_bf16 v[44:47], a[40:43], a[104:107], v[44:47]
ds_read_b128 a[8:11], v202 offset:2048
v_mfma_f32_16x16x32_bf16 v[48:51], a[40:43], a[108:111], v[48:51]
ds_read_b128 a[12:15], v202 offset:3072
v_mfma_f32_16x16x32_bf16 v[52:55], a[44:47], a[104:107], v[52:55]
ds_read_b128 a[16:19], v202 offset:4096
v_mfma_f32_16x16x32_bf16 v[56:59], a[44:47], a[108:111], v[56:59]
ds_read_b128 a[20:23], v202 offset:5120
v_mfma_f32_16x16x32_bf16 v[60:63], a[48:51], a[104:107], v[60:63]
ds_read_b128 a[24:27], v202 offset:6144
v_mfma_f32_16x16x32_bf16 v[64:67], a[48:51], a[108:111], v[64:67]
ds_read_b128 a[28:31], v202 offset:7168
v_mfma_f32_16x16x32_bf16 v[68:71], a[52:55], a[104:107], v[68:71]
ds_read_b128 a[32:35], v202 offset:8192
v_mfma_f32_16x16x32_bf16 v[72:75], a[52:55], a[108:111], v[72:75]
s_cmp_eq_u32 s25, 10
s_cselect_b32 s99, 36864, 0
s_add_u32 s60, s60, s99
v_mfma_f32_16x16x32_bf16 v[76:79], a[56:59], a[104:107], v[76:79]
s_add_u32 s61, s61, s99
s_add_u32 m0, s62, 90112
s_add_u32 s60, s60, 16384
v_mfma_f32_16x16x32_bf16 v[80:83], a[56:59], a[108:111], v[80:83]
buffer_load_dwordx4 v1, s[8:11], s60 offen offset:0 sc1 lds
v_mfma_f32_16x16x32_bf16 v[84:87], a[60:63], a[104:107], v[84:87]
v_exp_f32 v198, v198
v_mfma_f32_16x16x32_bf16 v[88:91], a[60:63], a[108:111], v[88:91]
buffer_load_dwordx4 v1, s[8:11], s60 offen offset:1024 sc1 lds
v_mfma_f32_16x16x32_bf16 v[92:95], a[64:67], a[104:107], v[92:95]
v_exp_f32 v199, v199
v_mfma_f32_16x16x32_bf16 v[96:99], a[64:67], a[108:111], v[96:99]
buffer_load_dwordx4 v1, s[8:11], s60 offen offset:2048 sc1 lds
v_fma_f32 v196, v196, v255, v255
v_mfma_f32_16x16x32_bf16 v[100:103], a[68:71], a[104:107], v[100:103]
v_fma_f32 v197, v197, v255, v255
v_fma_f32 v198, v198, v255, v255
v_mfma_f32_16x16x32_bf16 v[104:107], a[68:71], a[108:111], v[104:107]
s_waitcnt lgkmcnt(0)
v_mfma_f32_16x16x32_bf16 v[36:39], a[0:3], a[112:115], v[36:39]
ds_read_b128 a[36:39], v202 offset:9216
buffer_load_dwordx4 v1, s[8:11], s60 offen offset:3072 sc1 lds
v_mfma_f32_16x16x32_bf16 v[40:43], a[0:3], a[116:119], v[40:43]
ds_read_b128 a[40:43], v202 offset:10240
s_mov_b32 s37, L_c5-L_pc
v_mfma_f32_16x16x32_bf16 v[44:47], a[4:7], a[112:115], v[44:47]
ds_read_b128 a[44:47], v202 offset:11264
s_add_u32 m0, s63, 106496
v_mfma_f32_16x16x32_bf16 v[48:51], a[4:7], a[116:119], v[48:51]
ds_read_b128 a[48:51], v202 offset:12288
v_fma_f32 v199, v199, v255, v255
v_mfma_f32_16x16x32_bf16 v[52:55], a[8:11], a[112:115], v[52:55]
ds_read_b128 a[52:55], v202 offset:13312
buffer_load_dword v15, v14, s[88:91], s37 offen
v_mfma_f32_16x16x32_bf16 v[56:59], a[8:11], a[116:119], v[56:59]
ds_read_b128 a[56:59], v202 offset:14336
s_add_u32 s61, s61, 36864
v_mfma_f32_16x16x32_bf16 v[60:63], a[12:15], a[112:115], v[60:63]
ds_read_b128 a[60:63], v202 offset:15360
buffer_load_dwordx4 v1, s[8:11], s61 offen offset:0 sc1 lds
v_mfma_f32_16x16x32_bf16 v[64:67], a[12:15], a[116:119], v[64:67]
ds_read_b128 a[64:67], v202 offset:16384
v_mfma_f32_16x16x32_bf16 v[68:71], a[16:19], a[112:115], v[68:71]
ds_read_b128 a[68:71], v202 offset:17408
s_add_u32 m0, s62, 110592
v_mfma_f32_16x16x32_bf16 v[72:75], a[16:19], a[116:119], v[72:75]
s_add_u32 s60, s60, 20480
v_rcp_f32 v196, v196
v_mfma_f32_16x16x32_bf16 v[76:79], a[20:23], a[112:115], v[76:79]
v_rcp_f32 v197, v197
v_mfma_f32_16x16x32_bf16 v[80:83], a[20:23], a[116:119], v[80:83]
v_rcp_f32 v198, v198
v_mfma_f32_16x16x32_bf16 v[84:87], a[24:27], a[112:115], v[84:87]
buffer_load_dwordx4 v1, s[8:11], s60 offen offset:0 sc1 lds
v_mfma_f32_16x16x32_bf16 v[88:91], a[24:27], a[116:119], v[88:91]
v_mfma_f32_16x16x32_bf16 v[92:95], a[28:31], a[112:115], v[92:95]
buffer_load_dwordx4 v1, s[8:11], s60 offen offset:1024 sc1 lds
v_mfma_f32_16x16x32_bf16 v[96:99], a[28:31], a[116:119], v[96:99]
v_mfma_f32_16x16x32_bf16 v[100:103], a[32:35], a[112:115], v[100:103]
v_rcp_f32 v199, v199
v_mfma_f32_16x16x32_bf16 v[104:107], a[32:35], a[116:119], v[104:107]
s_waitcnt lgkmcnt(0)
v_mfma_f32_16x16x32_bf16 v[36:39], a[36:39], a[120:123], v[36:39]
ds_read_b128 a[0:3], v202 offset:18432
buffer_load_dwordx4 v1, s[8:11], s60 offen offset:2048 sc1 lds
v_mfma_f32_16x16x32_bf16 v[40:43], a[36:39], a[124:127], v[40:43]
ds_read_b128 a[4:7], v202 offset:19456
v_mfma_f32_16x16x32_bf16 v[44:47], a[40:43], a[120:123], v[44:47]
ds_read_b128 a[8:11], v202 offset:20480
v_mfma_f32_16x16x32_bf16 v[48:51], a[40:43], a[124:127], v[48:51]
ds_read_b128 a[12:15], v202 offset:21504
v_mul_f32 v160, v160, v196
v_mfma_f32_16x16x32_bf16 v[52:55], a[44:47], a[120:123], v[52:55]
ds_read_b128 a[16:19], v202 offset:22528
buffer_load_dwordx4 v1, s[8:11], s60 offen offset:3072 sc1 lds
v_mfma_f32_16x16x32_bf16 v[56:59], a[44:47], a[124:127], v[56:59]
ds_read_b128 a[20:23], v202 offset:23552
v_mul_f32 v161, v161, v197
v_mfma_f32_16x16x32_bf16 v[60:63], a[48:51], a[120:123], v[60:63]
ds_read_b128 a[24:27], v202 offset:24576
v_mfma_f32_16x16x32_bf16 v[64:67], a[48:51], a[124:127], v[64:67]
ds_read_b128 a[28:31], v202 offset:25600
v_mfma_f32_16x16x32_bf16 v[68:71], a[52:55], a[120:123], v[68:71]
ds_read_b128 a[32:35], v202 offset:26624
buffer_load_dwordx4 a[192:195], v1, s[4:7], s52 offen offset:2048 sc1
v_mfma_f32_16x16x32_bf16 v[72:75], a[52:55], a[124:127], v[72:75]
v_mul_f32 v162, v162, v198
v_mfma_f32_16x16x32_bf16 v[76:79], a[56:59], a[120:123], v[76:79]
v_mul_f32 v163, v163, v199
v_mfma_f32_16x16x32_bf16 v[80:83], a[56:59], a[124:127], v[80:83]
v_mfma_f32_16x16x32_bf16 v[84:87], a[60:63], a[120:123], v[84:87]
buffer_load_dwordx4 a[196:199], v9, s[4:7], s52 offen offset:2048 sc1
v_mul_f32 v192, v164, v164
v_mfma_f32_16x16x32_bf16 v[88:91], a[60:63], a[124:127], v[88:91]
v_mfma_f32_16x16x32_bf16 v[92:95], a[64:67], a[120:123], v[92:95]
v_mfma_f32_16x16x32_bf16 v[96:99], a[64:67], a[124:127], v[96:99]
v_mul_f32 v193, v165, v165
v_mfma_f32_16x16x32_bf16 v[100:103], a[68:71], a[120:123], v[100:103]
v_mfma_f32_16x16x32_bf16 v[104:107], a[68:71], a[124:127], v[104:107]
v_mul_f32 v194, v166, v166
s_waitcnt lgkmcnt(0)
v_mfma_f32_16x16x32_bf16 v[36:39], a[0:3], a[128:131], v[36:39]
ds_read_b128 a[36:39], v202 offset:27648
buffer_load_dwordx4 a[200:203], v1, s[4:7], s52 offen offset:3072 sc1
v_mfma_f32_16x16x32_bf16 v[40:43], a[0:3], a[132:135], v[40:43]
ds_read_b128 a[40:43], v202 offset:28672
v_mul_f32 v195, v167, v167
v_mfma_f32_16x16x32_bf16 v[44:47], a[4:7], a[128:131], v[44:47]
ds_read_b128 a[44:47], v202 offset:29696
buffer_load_dwordx4 a[204:207], v9, s[4:7], s52 offen offset:3072 sc1
v_mfma_f32_16x16x32_bf16 v[48:51], a[4:7], a[132:135], v[48:51]
ds_read_b128 a[48:51], v202 offset:30720
v_mfma_f32_16x16x32_bf16 v[52:55], a[8:11], a[128:131], v[52:55]
ds_read_b128 a[52:55], v202 offset:31744
v_fma_f32 v192, v192, v252, v250
v_mfma_f32_16x16x32_bf16 v[56:59], a[8:11], a[132:135], v[56:59]
ds_read_b128 a[56:59], v202 offset:32768
v_mfma_f32_16x16x32_bf16 v[60:63], a[12:15], a[128:131], v[60:63]
ds_read_b128 a[60:63], v202 offset:33792
v_fma_f32 v193, v193, v252, v250
v_mfma_f32_16x16x32_bf16 v[64:67], a[12:15], a[132:135], v[64:67]
ds_read_b128 a[64:67], v202 offset:34816
v_mfma_f32_16x16x32_bf16 v[68:71], a[16:19], a[128:131], v[68:71]
ds_read_b128 a[68:71], v202 offset:35840
v_fma_f32 v194, v194, v252, v250
v_mfma_f32_16x16x32_bf16 v[72:75], a[16:19], a[132:135], v[72:75]
s_cmp_eq_u32 s25, 11
s_cselect_b32 s98, 4096, 0
s_add_u32 s52, s52, s98
v_mfma_f32_16x16x32_bf16 v[76:79], a[20:23], a[128:131], v[76:79]
s_add_u32 s52, s52, 4096
v_mfma_f32_16x16x32_bf16 v[80:83], a[20:23], a[132:135], v[80:83]
v_fma_f32 v195, v195, v252, v250
v_mfma_f32_16x16x32_bf16 v[84:87], a[24:27], a[128:131], v[84:87]
buffer_load_dwordx4 a[208:211], v1, s[4:7], s52 offen offset:0 sc1
v_mfma_f32_16x16x32_bf16 v[88:91], a[24:27], a[132:135], v[88:91]
v_mul_f32 v192, v192, v164
v_mfma_f32_16x16x32_bf16 v[92:95], a[28:31], a[128:131], v[92:95]
buffer_load_dwordx4 a[212:215], v9, s[4:7], s52 offen offset:0 sc1
v_mfma_f32_16x16x32_bf16 v[96:99], a[28:31], a[132:135], v[96:99]
v_mfma_f32_16x16x32_bf16 v[100:103], a[32:35], a[128:131], v[100:103]
v_mul_f32 v193, v193, v165
v_mfma_f32_16x16x32_bf16 v[104:107], a[32:35], a[132:135], v[104:107]
s_waitcnt vmcnt(24) lgkmcnt(0)
s_barrier
v_mfma_f32_16x16x32_bf16 v[36:39], a[36:39], a[136:139], v[36:39]
ds_read_b128 a[0:3], v200 offset:0
buffer_load_dwordx4 a[216:219], v1, s[4:7], s52 offen offset:1024 sc1
v_mfma_f32_16x16x32_bf16 v[40:43], a[36:39], a[140:143], v[40:43]
ds_read_b128 a[4:7], v200 offset:1024
buffer_load_dwordx4 a[220:223], v9, s[4:7], s52 offen offset:1024 sc1
v_mfma_f32_16x16x32_bf16 v[44:47], a[40:43], a[136:139], v[44:47]
ds_read_b128 a[8:11], v200 offset:2048
v_mul_f32 v194, v194, v166
v_mfma_f32_16x16x32_bf16 v[48:51], a[40:43], a[140:143], v[48:51]
ds_read_b128 a[12:15], v200 offset:3072
v_mul_f32 v195, v195, v167
v_mfma_f32_16x16x32_bf16 v[52:55], a[44:47], a[136:139], v[52:55]
ds_read_b128 a[16:19], v200 offset:4096
v_mfma_f32_16x16x32_bf16 v[56:59], a[44:47], a[140:143], v[56:59]
ds_read_b128 a[20:23], v200 offset:5120
v_mfma_f32_16x16x32_bf16 v[60:63], a[48:51], a[136:139], v[60:63]
ds_read_b128 a[24:27], v200 offset:6144
v_mfma_f32_16x16x32_bf16 v[64:67], a[48:51], a[140:143], v[64:67]
ds_read_b128 a[28:31], v200 offset:7168
v_mfma_f32_16x16x32_bf16 v[68:71], a[52:55], a[136:139], v[68:71]
ds_read_b128 a[32:35], v200 offset:8192
v_mfma_f32_16x16x32_bf16 v[72:75], a[52:55], a[140:143], v[72:75]
s_cmp_eq_u32 s25, 11
s_cselect_b32 s99, 36864, 0
s_add_u32 s60, s60, s99
v_mfma_f32_16x16x32_bf16 v[76:79], a[56:59], a[136:139], v[76:79]
s_add_u32 s61, s61, s99
s_add_u32 m0, s62, 126976
v_mfma_f32_16x16x32_bf16 v[80:83], a[56:59], a[140:143], v[80:83]
s_add_u32 s60, s60, 16384
v_exp_f32 v192, v192
v_mfma_f32_16x16x32_bf16 v[84:87], a[60:63], a[136:139], v[84:87]
v_exp_f32 v193, v193
v_mfma_f32_16x16x32_bf16 v[88:91], a[60:63], a[140:143], v[88:91]
buffer_load_dwordx4 v1, s[8:11], s60 offen offset:0 sc1 lds
v_mfma_f32_16x16x32_bf16 v[92:95], a[64:67], a[136:139], v[92:95]
v_exp_f32 v194, v194
v_mfma_f32_16x16x32_bf16 v[96:99], a[64:67], a[140:143], v[96:99]
buffer_load_dwordx4 v1, s[8:11], s60 offen offset:1024 sc1 lds
v_mfma_f32_16x16x32_bf16 v[100:103], a[68:71], a[136:139], v[100:103]
v_mfma_f32_16x16x32_bf16 v[104:107], a[68:71], a[140:143], v[104:107]
s_waitcnt lgkmcnt(0)
v_mfma_f32_16x16x32_bf16 v[36:39], a[0:3], a[144:147], v[36:39]
ds_read_b128 a[36:39], v200 offset:9216
buffer_load_dwordx4 v1, s[8:11], s60 offen offset:2048 sc1 lds
v_mfma_f32_16x16x32_bf16 v[40:43], a[0:3], a[148:151], v[40:43]
ds_read_b128 a[40:43], v200 offset:10240
v_mfma_f32_16x16x32_bf16 v[44:47], a[4:7], a[144:147], v[44:47]
ds_read_b128 a[44:47], v200 offset:11264
buffer_load_dwordx4 v1, s[8:11], s60 offen offset:3072 sc1 lds
v_mfma_f32_16x16x32_bf16 v[48:51], a[4:7], a[148:151], v[48:51]
ds_read_b128 a[48:51], v200 offset:12288
v_mfma_f32_16x16x32_bf16 v[52:55], a[8:11], a[144:147], v[52:55]
ds_read_b128 a[52:55], v200 offset:13312
s_add_u32 m0, s63, 143360
v_mfma_f32_16x16x32_bf16 v[56:59], a[8:11], a[148:151], v[56:59]
ds_read_b128 a[56:59], v200 offset:14336
v_mfma_f32_16x16x32_bf16 v[60:63], a[12:15], a[144:147], v[60:63]
ds_read_b128 a[60:63], v200 offset:15360
s_add_u32 s61, s61, 36864
v_mfma_f32_16x16x32_bf16 v[64:67], a[12:15], a[148:151], v[64:67]
ds_read_b128 a[64:67], v200 offset:16384
v_mfma_f32_16x16x32_bf16 v[68:71], a[16:19], a[144:147], v[68:71]
ds_read_b128 a[68:71], v200 offset:17408
buffer_load_dwordx4 v1, s[8:11], s61 offen offset:0 sc1 lds
v_mfma_f32_16x16x32_bf16 v[72:75], a[16:19], a[148:151], v[72:75]
s_add_u32 m0, s62, 147456
v_exp_f32 v195, v195
v_mfma_f32_16x16x32_bf16 v[76:79], a[20:23], a[144:147], v[76:79]
s_add_u32 s60, s60, 20480
v_fma_f32 v192, v192, v254, v254
v_fma_f32 v193, v193, v254, v254
v_mfma_f32_16x16x32_bf16 v[80:83], a[20:23], a[148:151], v[80:83]
v_fma_f32 v194, v194, v254, v254
v_mfma_f32_16x16x32_bf16 v[84:87], a[24:27], a[144:147], v[84:87]
v_mfma_f32_16x16x32_bf16 v[88:91], a[24:27], a[148:151], v[88:91]
v_fma_f32 v195, v195, v254, v254
v_mfma_f32_16x16x32_bf16 v[92:95], a[28:31], a[144:147], v[92:95]
buffer_load_dwordx4 v1, s[8:11], s60 offen offset:0 sc1 lds
v_mfma_f32_16x16x32_bf16 v[96:99], a[28:31], a[148:151], v[96:99]
v_rcp_f32 v192, v192
v_mfma_f32_16x16x32_bf16 v[100:103], a[32:35], a[144:147], v[100:103]
v_mfma_f32_16x16x32_bf16 v[104:107], a[32:35], a[148:151], v[104:107]
s_waitcnt vmcnt(28) lgkmcnt(0)
v_mfma_f32_16x16x32_bf16 v[36:39], a[36:39], a[152:155], v[36:39]
ds_read_b128 a[0:3], v200 offset:18432
buffer_load_dwordx4 v1, s[8:11], s60 offen offset:1024 sc1 lds
v_mfma_f32_16x16x32_bf16 v[40:43], a[36:39], a[156:159], v[40:43]
ds_read_b128 a[4:7], v200 offset:19456
v_mfma_f32_16x16x32_bf16 v[44:47], a[40:43], a[152:155], v[44:47]
ds_read_b128 a[8:11], v200 offset:20480
v_mfma_f32_16x16x32_bf16 v[48:51], a[40:43], a[156:159], v[48:51]
ds_read_b128 a[12:15], v200 offset:21504
v_mfma_f32_16x16x32_bf16 v[52:55], a[44:47], a[152:155], v[52:55]
ds_read_b128 a[16:19], v200 offset:22528
buffer_load_dwordx4 v1, s[8:11], s60 offen offset:2048 sc1 lds
v_mfma_f32_16x16x32_bf16 v[56:59], a[44:47], a[156:159], v[56:59]
ds_read_b128 a[20:23], v200 offset:23552
v_mfma_f32_16x16x32_bf16 v[60:63], a[48:51], a[152:155], v[60:63]
ds_read_b128 a[24:27], v200 offset:24576
v_mfma_f32_16x16x32_bf16 v[64:67], a[48:51], a[156:159], v[64:67]
ds_read_b128 a[28:31], v200 offset:25600
v_mfma_f32_16x16x32_bf16 v[68:71], a[52:55], a[152:155], v[68:71]
ds_read_b128 a[32:35], v200 offset:26624
buffer_load_dwordx4 v1, s[8:11], s60 offen offset:3072 sc1 lds
v_mfma_f32_16x16x32_bf16 v[72:75], a[52:55], a[156:159], v[72:75]
v_rcp_f32 v193, v193
v_mfma_f32_16x16x32_bf16 v[76:79], a[56:59], a[152:155], v[76:79]
v_rcp_f32 v194, v194
v_mfma_f32_16x16x32_bf16 v[80:83], a[56:59], a[156:159], v[80:83]
v_rcp_f32 v195, v195
v_mfma_f32_16x16x32_bf16 v[84:87], a[60:63], a[152:155], v[84:87]
buffer_load_dwordx4 a[224:227], v1, s[4:7], s52 offen offset:2048 sc1
v_mfma_f32_16x16x32_bf16 v[88:91], a[60:63], a[156:159], v[88:91]
v_mfma_f32_16x16x32_bf16 v[92:95], a[64:67], a[152:155], v[92:95]
v_mfma_f32_16x16x32_bf16 v[96:99], a[64:67], a[156:159], v[96:99]
v_mfma_f32_16x16x32_bf16 v[100:103], a[68:71], a[152:155], v[100:103]
v_mul_f32 v164, v164, v192
v_mfma_f32_16x16x32_bf16 v[104:107], a[68:71], a[156:159], v[104:107]
s_waitcnt lgkmcnt(0)
v_mfma_f32_16x16x32_bf16 v[36:39], a[0:3], a[160:163], v[36:39]
ds_read_b128 a[36:39], v200 offset:27648
buffer_load_dwordx4 a[228:231], v9, s[4:7], s52 offen offset:2048 sc1
v_mfma_f32_16x16x32_bf16 v[40:43], a[0:3], a[164:167], v[40:43]
ds_read_b128 a[40:43], v200 offset:28672
v_mul_f32 v165, v165, v193
v_mfma_f32_16x16x32_bf16 v[44:47], a[4:7], a[160:163], v[44:47]
ds_read_b128 a[44:47], v200 offset:29696
buffer_load_dwordx4 a[232:235], v1, s[4:7], s52 offen offset:3072 sc1
v_mfma_f32_16x16x32_bf16 v[48:51], a[4:7], a[164:167], v[48:51]
ds_read_b128 a[48:51], v200 offset:30720
v_mul_f32 v166, v166, v194
v_mfma_f32_16x16x32_bf16 v[52:55], a[8:11], a[160:163], v[52:55]
ds_read_b128 a[52:55], v200 offset:31744
buffer_load_dwordx4 a[236:239], v9, s[4:7], s52 offen offset:3072 sc1
v_mfma_f32_16x16x32_bf16 v[56:59], a[8:11], a[164:167], v[56:59]
ds_read_b128 a[56:59], v200 offset:32768
v_mul_f32 v167, v167, v195
v_mfma_f32_16x16x32_bf16 v[60:63], a[12:15], a[160:163], v[60:63]
ds_read_b128 a[60:63], v200 offset:33792
v_mfma_f32_16x16x32_bf16 v[64:67], a[12:15], a[164:167], v[64:67]
ds_read_b128 a[64:67], v200 offset:34816
v_mul_f32 v196, v168, v168
v_mfma_f32_16x16x32_bf16 v[68:71], a[16:19], a[160:163], v[68:71]
ds_read_b128 a[68:71], v200 offset:35840
v_mfma_f32_16x16x32_bf16 v[72:75], a[16:19], a[164:167], v[72:75]
s_cmp_eq_u32 s25, 12
s_cselect_b32 s98, 4096, 0
v_mfma_f32_16x16x32_bf16 v[76:79], a[20:23], a[160:163], v[76:79]
s_add_u32 s52, s52, s98
v_mul_f32 v197, v169, v169
v_mfma_f32_16x16x32_bf16 v[80:83], a[20:23], a[164:167], v[80:83]
s_add_u32 s52, s52, 4096
v_mfma_f32_16x16x32_bf16 v[84:87], a[24:27], a[160:163], v[84:87]
v_mul_f32 v198, v170, v170
v_mfma_f32_16x16x32_bf16 v[88:91], a[24:27], a[164:167], v[88:91]
v_mfma_f32_16x16x32_bf16 v[92:95], a[28:31], a[160:163], v[92:95]
buffer_load_dwordx4 a[240:243], v1, s[4:7], s52 offen offset:0 sc1
v_mul_f32 v199, v171, v171
v_mfma_f32_16x16x32_bf16 v[96:99], a[28:31], a[164:167], v[96:99]
v_mfma_f32_16x16x32_bf16 v[100:103], a[32:35], a[160:163], v[100:103]
v_mfma_f32_16x16x32_bf16 v[104:107], a[32:35], a[164:167], v[104:107]
s_waitcnt vmcnt(22) lgkmcnt(0)
s_barrier
v_mfma_f32_16x16x32_bf16 v[36:39], a[36:39], a[168:171], v[36:39]
ds_read_b128 a[0:3], v201 offset:0
buffer_load_dwordx4 a[244:247], v9, s[4:7], s52 offen offset:0 sc1
v_mfma_f32_16x16x32_bf16 v[40:43], a[36:39], a[172:175], v[40:43]
ds_read_b128 a[4:7], v201 offset:1024
buffer_load_dwordx4 a[248:251], v1, s[4:7], s52 offen offset:1024 sc1
v_mfma_f32_16x16x32_bf16 v[44:47], a[40:43], a[168:171], v[44:47]
ds_read_b128 a[8:11], v201 offset:2048
v_fma_f32 v196, v196, v253, v251
v_mfma_f32_16x16x32_bf16 v[48:51], a[40:43], a[172:175], v[48:51]
ds_read_b128 a[12:15], v201 offset:3072
buffer_load_dwordx4 a[252:255], v9, s[4:7], s52 offen offset:1024 sc1
v_mfma_f32_16x16x32_bf16 v[52:55], a[44:47], a[168:171], v[52:55]
ds_read_b128 a[16:19], v201 offset:4096
v_fma_f32 v197, v197, v253, v251
v_mfma_f32_16x16x32_bf16 v[56:59], a[44:47], a[172:175], v[56:59]
ds_read_b128 a[20:23], v201 offset:5120
v_fma_f32 v198, v198, v253, v251
v_mfma_f32_16x16x32_bf16 v[60:63], a[48:51], a[168:171], v[60:63]
ds_read_b128 a[24:27], v201 offset:6144
v_fma_f32 v199, v199, v253, v251
v_mfma_f32_16x16x32_bf16 v[64:67], a[48:51], a[172:175], v[64:67]
ds_read_b128 a[28:31], v201 offset:7168
v_mfma_f32_16x16x32_bf16 v[68:71], a[52:55], a[168:171], v[68:71]
ds_read_b128 a[32:35], v201 offset:8192
v_mul_f32 v196, v196, v168
v_mfma_f32_16x16x32_bf16 v[72:75], a[52:55], a[172:175], v[72:75]
s_cmp_eq_u32 s25, 12
s_cselect_b32 s99, 36864, 0
s_add_u32 s60, s60, s99
v_mfma_f32_16x16x32_bf16 v[76:79], a[56:59], a[168:171], v[76:79]
s_add_u32 s61, s61, s99
v_mul_f32 v197, v197, v169
v_mfma_f32_16x16x32_bf16 v[80:83], a[56:59], a[172:175], v[80:83]
s_add_u32 m0, s62, 53248
v_mfma_f32_16x16x32_bf16 v[84:87], a[60:63], a[168:171], v[84:87]
s_add_u32 s60, s60, 16384
v_mfma_f32_16x16x32_bf16 v[88:91], a[60:63], a[172:175], v[88:91]
v_mul_f32 v198, v198, v170
v_mfma_f32_16x16x32_bf16 v[92:95], a[64:67], a[168:171], v[92:95]
v_mfma_f32_16x16x32_bf16 v[96:99], a[64:67], a[172:175], v[96:99]
buffer_load_dwordx4 v1, s[8:11], s60 offen offset:0 sc1 lds
v_mul_f32 v199, v199, v171
v_mfma_f32_16x16x32_bf16 v[100:103], a[68:71], a[168:171], v[100:103]
v_mfma_f32_16x16x32_bf16 v[104:107], a[68:71], a[172:175], v[104:107]
s_waitcnt lgkmcnt(0)
v_mfma_f32_16x16x32_bf16 v[36:39], a[0:3], a[176:179], v[36:39]
ds_read_b128 a[36:39], v201 offset:9216
buffer_load_dwordx4 v1, s[8:11], s60 offen offset:1024 sc1 lds
v_mfma_f32_16x16x32_bf16 v[40:43], a[0:3], a[180:183], v[40:43]
ds_read_b128 a[40:43], v201 offset:10240
v_mfma_f32_16x16x32_bf16 v[44:47], a[4:7], a[176:179], v[44:47]
ds_read_b128 a[44:47], v201 offset:11264
buffer_load_dwordx4 v1, s[8:11], s60 offen offset:2048 sc1 lds
v_mfma_f32_16x16x32_bf16 v[48:51], a[4:7], a[180:183], v[48:51]
ds_read_b128 a[48:51], v201 offset:12288
v_mfma_f32_16x16x32_bf16 v[52:55], a[8:11], a[176:179], v[52:55]
ds_read_b128 a[52:55], v201 offset:13312
v_mfma_f32_16x16x32_bf16 v[56:59], a[8:11], a[180:183], v[56:59]
ds_read_b128 a[56:59], v201 offset:14336
buffer_load_dwordx4 v1, s[8:11], s60 offen offset:3072 sc1 lds
v_mfma_f32_16x16x32_bf16 v[60:63], a[12:15], a[176:179], v[60:63]
ds_read_b128 a[60:63], v201 offset:15360
v_mfma_f32_16x16x32_bf16 v[64:67], a[12:15], a[180:183], v[64:67]
ds_read_b128 a[64:67], v201 offset:16384
v_mfma_f32_16x16x32_bf16 v[68:71], a[16:19], a[176:179], v[68:71]
ds_read_b128 a[68:71], v201 offset:17408
s_add_u32 m0, s63, 69632
v_mfma_f32_16x16x32_bf16 v[72:75], a[16:19], a[180:183], v[72:75]
s_add_u32 s61, s61, 36864
v_exp_f32 v196, v196
v_mfma_f32_16x16x32_bf16 v[76:79], a[20:23], a[176:179], v[76:79]
v_exp_f32 v197, v197
v_mfma_f32_16x16x32_bf16 v[80:83], a[20:23], a[180:183], v[80:83]
v_exp_f32 v198, v198
v_mfma_f32_16x16x32_bf16 v[84:87], a[24:27], a[176:179], v[84:87]
v_mfma_f32_16x16x32_bf16 v[88:91], a[24:27], a[180:183], v[88:91]
v_mfma_f32_16x16x32_bf16 v[92:95], a[28:31], a[176:179], v[92:95]
buffer_load_dwordx4 v1, s[8:11], s61 offen offset:0 sc1 lds
v_mfma_f32_16x16x32_bf16 v[96:99], a[28:31], a[180:183], v[96:99]
v_exp_f32 v199, v199
v_mfma_f32_16x16x32_bf16 v[100:103], a[32:35], a[176:179], v[100:103]
v_mfma_f32_16x16x32_bf16 v[104:107], a[32:35], a[180:183], v[104:107]
s_waitcnt vmcnt(26) lgkmcnt(0)
v_mfma_f32_16x16x32_bf16 v[36:39], a[36:39], a[184:187], v[36:39]
ds_read_b128 a[0:3], v201 offset:18432
s_add_u32 m0, s62, 73728
v_mfma_f32_16x16x32_bf16 v[40:43], a[36:39], a[188:191], v[40:43]
ds_read_b128 a[4:7], v201 offset:19456
v_fma_f32 v196, v196, v255, v255
v_mfma_f32_16x16x32_bf16 v[44:47], a[40:43], a[184:187], v[44:47]
ds_read_b128 a[8:11], v201 offset:20480
s_add_u32 s60, s60, 20480
v_mfma_f32_16x16x32_bf16 v[48:51], a[40:43], a[188:191], v[48:51]
ds_read_b128 a[12:15], v201 offset:21504
v_fma_f32 v197, v197, v255, v255
v_mfma_f32_16x16x32_bf16 v[52:55], a[44:47], a[184:187], v[52:55]
ds_read_b128 a[16:19], v201 offset:22528
v_mfma_f32_16x16x32_bf16 v[56:59], a[44:47], a[188:191], v[56:59]
ds_read_b128 a[20:23], v201 offset:23552
buffer_load_dwordx4 v1, s[8:11], s60 offen offset:0 sc1 lds
v_mfma_f32_16x16x32_bf16 v[60:63], a[48:51], a[184:187], v[60:63]
ds_read_b128 a[24:27], v201 offset:24576
v_fma_f32 v198, v198, v255, v255
v_mfma_f32_16x16x32_bf16 v[64:67], a[48:51], a[188:191], v[64:67]
ds_read_b128 a[28:31], v201 offset:25600
v_fma_f32 v199, v199, v255, v255
v_mfma_f32_16x16x32_bf16 v[68:71], a[52:55], a[184:187], v[68:71]
ds_read_b128 a[32:35], v201 offset:26624
buffer_load_dwordx4 v1, s[8:11], s60 offen offset:1024 sc1 lds
v_mfma_f32_16x16x32_bf16 v[72:75], a[52:55], a[188:191], v[72:75]
v_mfma_f32_16x16x32_bf16 v[76:79], a[56:59], a[184:187], v[76:79]
v_rcp_f32 v196, v196
v_mfma_f32_16x16x32_bf16 v[80:83], a[56:59], a[188:191], v[80:83]
buffer_load_dwordx4 v1, s[8:11], s60 offen offset:2048 sc1 lds
v_mfma_f32_16x16x32_bf16 v[84:87], a[60:63], a[184:187], v[84:87]
v_mfma_f32_16x16x32_bf16 v[88:91], a[60:63], a[188:191], v[88:91]
v_mfma_f32_16x16x32_bf16 v[92:95], a[64:67], a[184:187], v[92:95]
buffer_load_dwordx4 v1, s[8:11], s60 offen offset:3072 sc1 lds
v_mfma_f32_16x16x32_bf16 v[96:99], a[64:67], a[188:191], v[96:99]
v_rcp_f32 v197, v197
v_mfma_f32_16x16x32_bf16 v[100:103], a[68:71], a[184:187], v[100:103]
v_mfma_f32_16x16x32_bf16 v[104:107], a[68:71], a[188:191], v[104:107]
s_waitcnt lgkmcnt(0)
v_mfma_f32_16x16x32_bf16 v[36:39], a[0:3], a[192:195], v[36:39]
ds_read_b128 a[36:39], v201 offset:27648
buffer_load_dwordx4 a[80:83], v1, s[4:7], s52 offen offset:2048 sc1
v_mfma_f32_16x16x32_bf16 v[40:43], a[0:3], a[196:199], v[40:43]
ds_read_b128 a[40:43], v201 offset:28672
v_mfma_f32_16x16x32_bf16 v[44:47], a[4:7], a[192:195], v[44:47]
ds_read_b128 a[44:47], v201 offset:29696
v_mfma_f32_16x16x32_bf16 v[48:51], a[4:7], a[196:199], v[48:51]
ds_read_b128 a[48:51], v201 offset:30720
v_mfma_f32_16x16x32_bf16 v[52:55], a[8:11], a[192:195], v[52:55]
ds_read_b128 a[52:55], v201 offset:31744
buffer_load_dwordx4 a[84:87], v9, s[4:7], s52 offen offset:2048 sc1
v_mfma_f32_16x16x32_bf16 v[56:59], a[8:11], a[196:199], v[56:59]
ds_read_b128 a[56:59], v201 offset:32768
v_mfma_f32_16x16x32_bf16 v[60:63], a[12:15], a[192:195], v[60:63]
ds_read_b128 a[60:63], v201 offset:33792
v_mfma_f32_16x16x32_bf16 v[64:67], a[12:15], a[196:199], v[64:67]
ds_read_b128 a[64:67], v201 offset:34816
v_mfma_f32_16x16x32_bf16 v[68:71], a[16:19], a[192:195], v[68:71]
ds_read_b128 a[68:71], v201 offset:35840
buffer_load_dwordx4 a[88:91], v1, s[4:7], s52 offen offset:3072 sc1
v_mfma_f32_16x16x32_bf16 v[72:75], a[16:19], a[196:199], v[72:75]
v_rcp_f32 v198, v198
v_mfma_f32_16x16x32_bf16 v[76:79], a[20:23], a[192:195], v[76:79]
v_rcp_f32 v199, v199
v_mfma_f32_16x16x32_bf16 v[80:83], a[20:23], a[196:199], v[80:83]
v_mul_f32 v168, v168, v196
v_mfma_f32_16x16x32_bf16 v[84:87], a[24:27], a[192:195], v[84:87]
buffer_load_dwordx4 a[92:95], v9, s[4:7], s52 offen offset:3072 sc1
v_mfma_f32_16x16x32_bf16 v[88:91], a[24:27], a[196:199], v[88:91]
v_mul_f32 v169, v169, v197
v_mfma_f32_16x16x32_bf16 v[92:95], a[28:31], a[192:195], v[92:95]
v_mfma_f32_16x16x32_bf16 v[96:99], a[28:31], a[196:199], v[96:99]
v_mul_f32 v170, v170, v198
v_mfma_f32_16x16x32_bf16 v[100:103], a[32:35], a[192:195], v[100:103]
v_mfma_f32_16x16x32_bf16 v[104:107], a[32:35], a[196:199], v[104:107]
s_waitcnt vmcnt(21) lgkmcnt(0)
s_barrier
v_mfma_f32_16x16x32_bf16 v[36:39], a[36:39], a[200:203], v[36:39]
ds_read_b128 a[0:3], v202 offset:0
v_mul_f32 v171, v171, v199
v_mfma_f32_16x16x32_bf16 v[40:43], a[36:39], a[204:207], v[40:43]
ds_read_b128 a[4:7], v202 offset:1024
v_mfma_f32_16x16x32_bf16 v[44:47], a[40:43], a[200:203], v[44:47]
ds_read_b128 a[8:11], v202 offset:2048
v_mul_f32 v192, v172, v172
v_mfma_f32_16x16x32_bf16 v[48:51], a[40:43], a[204:207], v[48:51]
ds_read_b128 a[12:15], v202 offset:3072
v_mfma_f32_16x16x32_bf16 v[52:55], a[44:47], a[200:203], v[52:55]
ds_read_b128 a[16:19], v202 offset:4096
v_mul_f32 v193, v173, v173
v_mfma_f32_16x16x32_bf16 v[56:59], a[44:47], a[204:207], v[56:59]
ds_read_b128 a[20:23], v202 offset:5120
v_mfma_f32_16x16x32_bf16 v[60:63], a[48:51], a[200:203], v[60:63]
ds_read_b128 a[24:27], v202 offset:6144
v_mfma_f32_16x16x32_bf16 v[64:67], a[48:51], a[204:207], v[64:67]
ds_read_b128 a[28:31], v202 offset:7168
v_mul_f32 v194, v174, v174
v_mfma_f32_16x16x32_bf16 v[68:71], a[52:55], a[200:203], v[68:71]
ds_read_b128 a[32:35], v202 offset:8192
v_mfma_f32_16x16x32_bf16 v[72:75], a[52:55], a[204:207], v[72:75]
s_cmp_eq_u32 s25, 13
s_cselect_b32 s99, 36864, 0
s_add_u32 s60, s60, s99
v_mfma_f32_16x16x32_bf16 v[76:79], a[56:59], a[200:203], v[76:79]
s_add_u32 s61, s61, s99
s_add_u32 m0, s62, 90112
s_add_u32 s60, s60, 16384
v_mfma_f32_16x16x32_bf16 v[80:83], a[56:59], a[204:207], v[80:83]
buffer_load_dwordx4 v1, s[8:11], s60 offen offset:0 sc1 lds
v_mul_f32 v195, v175, v175
v_mfma_f32_16x16x32_bf16 v[84:87], a[60:63], a[200:203], v[84:87]
buffer_load_dwordx4 v1, s[8:11], s60 offen offset:1024 sc1 lds
v_fma_f32 v192, v192, v252, v250
v_mfma_f32_16x16x32_bf16 v[88:91], a[60:63], a[204:207], v[88:91]
buffer_load_dwordx4 v1, s[8:11], s60 offen offset:2048 sc1 lds
v_mfma_f32_16x16x32_bf16 v[92:95], a[64:67], a[200:203], v[92:95]
v_fma_f32 v193, v193, v252, v250
v_mfma_f32_16x16x32_bf16 v[96:99], a[64:67], a[204:207], v[96:99]
buffer_load_dwordx4 v1, s[8:11], s60 offen offset:3072 sc1 lds
v_mfma_f32_16x16x32_bf16 v[100:103], a[68:71], a[200:203], v[100:103]
v_fma_f32 v194, v194, v252, v250
v_mfma_f32_16x16x32_bf16 v[104:107], a[68:71], a[204:207], v[104:107]
s_waitcnt lgkmcnt(0)
v_mfma_f32_16x16x32_bf16 v[36:39], a[0:3], a[208:211], v[36:39]
ds_read_b128 a[36:39], v202 offset:9216
s_add_u32 m0, s63, 106496
v_mfma_f32_16x16x32_bf16 v[40:43], a[0:3], a[212:215], v[40:43]
ds_read_b128 a[40:43], v202 offset:10240
v_fma_f32 v195, v195, v252, v250
v_mfma_f32_16x16x32_bf16 v[44:47], a[4:7], a[208:211], v[44:47]
ds_read_b128 a[44:47], v202 offset:11264
s_add_u32 s61, s61, 36864
v_mfma_f32_16x16x32_bf16 v[48:51], a[4:7], a[212:215], v[48:51]
ds_read_b128 a[48:51], v202 offset:12288
v_mul_f32 v192, v192, v172
v_mfma_f32_16x16x32_bf16 v[52:55], a[8:11], a[208:211], v[52:55]
ds_read_b128 a[52:55], v202 offset:13312
buffer_load_dwordx4 v1, s[8:11], s61 offen offset:0 sc1 lds
v_mfma_f32_16x16x32_bf16 v[56:59], a[8:11], a[212:215], v[56:59]
ds_read_b128 a[56:59], v202 offset:14336
v_mul_f32 v193, v193, v173
v_mfma_f32_16x16x32_bf16 v[60:63], a[12:15], a[208:211], v[60:63]
ds_read_b128 a[60:63], v202 offset:15360
s_add_u32 m0, s62, 110592
v_mfma_f32_16x16x32_bf16 v[64:67], a[12:15], a[212:215], v[64:67]
ds_read_b128 a[64:67], v202 offset:16384
v_mfma_f32_16x16x32_bf16 v[68:71], a[16:19], a[208:211], v[68:71]
ds_read_b128 a[68:71], v202 offset:17408
s_add_u32 s60, s60, 20480
v_mfma_f32_16x16x32_bf16 v[72:75], a[16:19], a[212:215], v[72:75]
v_mul_f32 v194, v194, v174
v_mfma_f32_16x16x32_bf16 v[76:79], a[20:23], a[208:211], v[76:79]
buffer_load_dwordx4 v1, s[8:11], s60 offen offset:0 sc1 lds
v_mul_f32 v195, v195, v175
v_mfma_f32_16x16x32_bf16 v[80:83], a[20:23], a[212:215], v[80:83]
v_mfma_f32_16x16x32_bf16 v[84:87], a[24:27], a[208:211], v[84:87]
buffer_load_dwordx4 v1, s[8:11], s60 offen offset:1024 sc1 lds
v_mfma_f32_16x16x32_bf16 v[88:91], a[24:27], a[212:215], v[88:91]
v_exp_f32 v192, v192
v_mfma_f32_16x16x32_bf16 v[92:95], a[28:31], a[208:211], v[92:95]
buffer_load_dwordx4 v1, s[8:11], s60 offen offset:2048 sc1 lds
v_mfma_f32_16x16x32_bf16 v[96:99], a[28:31], a[212:215], v[96:99]
v_mfma_f32_16x16x32_bf16 v[100:103], a[32:35], a[208:211], v[100:103]
v_mfma_f32_16x16x32_bf16 v[104:107], a[32:35], a[212:215], v[104:107]
s_waitcnt vmcnt(25) lgkmcnt(0)
v_mfma_f32_16x16x32_bf16 v[36:39], a[36:39], a[216:219], v[36:39]
ds_read_b128 a[0:3], v202 offset:18432
buffer_load_dwordx4 v1, s[8:11], s60 offen offset:3072 sc1 lds
v_mfma_f32_16x16x32_bf16 v[40:43], a[36:39], a[220:223], v[40:43]
ds_read_b128 a[4:7], v202 offset:19456
v_mfma_f32_16x16x32_bf16 v[44:47], a[40:43], a[216:219], v[44:47]
ds_read_b128 a[8:11], v202 offset:20480
v_mfma_f32_16x16x32_bf16 v[48:51], a[40:43], a[220:223], v[48:51]
ds_read_b128 a[12:15], v202 offset:21504
v_mfma_f32_16x16x32_bf16 v[52:55], a[44:47], a[216:219], v[52:55]
ds_read_b128 a[16:19], v202 offset:22528
v_mfma_f32_16x16x32_bf16 v[56:59], a[44:47], a[220:223], v[56:59]
ds_read_b128 a[20:23], v202 offset:23552
v_mfma_f32_16x16x32_bf16 v[60:63], a[48:51], a[216:219], v[60:63]
ds_read_b128 a[24:27], v202 offset:24576
v_mfma_f32_16x16x32_bf16 v[64:67], a[48:51], a[220:223], v[64:67]
ds_read_b128 a[28:31], v202 offset:25600
v_mfma_f32_16x16x32_bf16 v[68:71], a[52:55], a[216:219], v[68:71]
ds_read_b128 a[32:35], v202 offset:26624
v_mfma_f32_16x16x32_bf16 v[72:75], a[52:55], a[220:223], v[72:75]
s_cmp_eq_u32 s25, 13
s_cselect_b32 s98, 4096, 0
s_add_u32 s52, s52, s98
v_mfma_f32_16x16x32_bf16 v[76:79], a[56:59], a[216:219], v[76:79]
s_add_u32 s52, s52, 4096
v_exp_f32 v193, v193
v_mfma_f32_16x16x32_bf16 v[80:83], a[56:59], a[220:223], v[80:83]
buffer_load_dwordx4 a[96:99], v1, s[4:7], s52 offen offset:0 sc1
v_mfma_f32_16x16x32_bf16 v[84:87], a[60:63], a[216:219], v[84:87]
buffer_load_dwordx4 a[100:103], v9, s[4:7], s52 offen offset:0 sc1
v_mfma_f32_16x16x32_bf16 v[88:91], a[60:63], a[220:223], v[88:91]
v_exp_f32 v194, v194
v_mfma_f32_16x16x32_bf16 v[92:95], a[64:67], a[216:219], v[92:95]
buffer_load_dwordx4 a[104:107], v1, s[4:7], s52 offen offset:1024 sc1
v_mfma_f32_16x16x32_bf16 v[96:99], a[64:67], a[220:223], v[96:99]
v_exp_f32 v195, v195
v_mfma_f32_16x16x32_bf16 v[100:103], a[68:71], a[216:219], v[100:103]
v_fma_f32 v192, v192, v254, v254
v_fma_f32 v193, v193, v254, v254
v_mfma_f32_16x16x32_bf16 v[104:107], a[68:71], a[220:223], v[104:107]
s_waitcnt lgkmcnt(0)
v_mfma_f32_16x16x32_bf16 v[36:39], a[0:3], a[224:227], v[36:39]
ds_read_b128 a[36:39], v202 offset:27648
buffer_load_dwordx4 a[108:111], v9, s[4:7], s52 offen offset:1024 sc1
v_mfma_f32_16x16x32_bf16 v[40:43], a[0:3], a[228:231], v[40:43]
ds_read_b128 a[40:43], v202 offset:28672
v_fma_f32 v194, v194, v254, v254
v_mfma_f32_16x16x32_bf16 v[44:47], a[4:7], a[224:227], v[44:47]
ds_read_b128 a[44:47], v202 offset:29696
v_fma_f32 v195, v195, v254, v254
v_mfma_f32_16x16x32_bf16 v[48:51], a[4:7], a[228:231], v[48:51]
ds_read_b128 a[48:51], v202 offset:30720
v_mfma_f32_16x16x32_bf16 v[52:55], a[8:11], a[224:227], v[52:55]
ds_read_b128 a[52:55], v202 offset:31744
buffer_load_dwordx4 a[112:115], v1, s[4:7], s52 offen offset:2048 sc1
v_mfma_f32_16x16x32_bf16 v[56:59], a[8:11], a[228:231], v[56:59]
ds_read_b128 a[56:59], v202 offset:32768
v_mfma_f32_16x16x32_bf16 v[60:63], a[12:15], a[224:227], v[60:63]
ds_read_b128 a[60:63], v202 offset:33792
v_mfma_f32_16x16x32_bf16 v[64:67], a[12:15], a[228:231], v[64:67]
ds_read_b128 a[64:67], v202 offset:34816
v_mfma_f32_16x16x32_bf16 v[68:71], a[16:19], a[224:227], v[68:71]
ds_read_b128 a[68:71], v202 offset:35840
buffer_load_dwordx4 a[116:119], v9, s[4:7], s52 offen offset:2048 sc1
v_mfma_f32_16x16x32_bf16 v[72:75], a[16:19], a[228:231], v[72:75]
v_rcp_f32 v192, v192
v_mfma_f32_16x16x32_bf16 v[76:79], a[20:23], a[224:227], v[76:79]
v_rcp_f32 v193, v193
v_mfma_f32_16x16x32_bf16 v[80:83], a[20:23], a[228:231], v[80:83]
v_mfma_f32_16x16x32_bf16 v[84:87], a[24:27], a[224:227], v[84:87]
buffer_load_dwordx4 a[120:123], v1, s[4:7], s52 offen offset:3072 sc1
v_mfma_f32_16x16x32_bf16 v[88:91], a[24:27], a[228:231], v[88:91]
v_mfma_f32_16x16x32_bf16 v[92:95], a[28:31], a[224:227], v[92:95]
v_rcp_f32 v194, v194
v_mfma_f32_16x16x32_bf16 v[96:99], a[28:31], a[228:231], v[96:99]
v_mfma_f32_16x16x32_bf16 v[100:103], a[32:35], a[224:227], v[100:103]
v_mfma_f32_16x16x32_bf16 v[104:107], a[32:35], a[228:231], v[104:107]
s_waitcnt vmcnt(20) lgkmcnt(0)
s_barrier
v_mfma_f32_16x16x32_bf16 v[36:39], a[36:39], a[232:235], v[36:39]
ds_read_b128 a[0:3], v200 offset:0
buffer_load_dwordx4 a[124:127], v9, s[4:7], s52 offen offset:3072 sc1
v_mfma_f32_16x16x32_bf16 v[40:43], a[36:39], a[236:239], v[40:43]
ds_read_b128 a[4:7], v200 offset:1024
v_mfma_f32_16x16x32_bf16 v[44:47], a[40:43], a[232:235], v[44:47]
ds_read_b128 a[8:11], v200 offset:2048
v_mfma_f32_16x16x32_bf16 v[48:51], a[40:43], a[236:239], v[48:51]
ds_read_b128 a[12:15], v200 offset:3072
v_mfma_f32_16x16x32_bf16 v[52:55], a[44:47], a[232:235], v[52:55]
ds_read_b128 a[16:19], v200 offset:4096
v_mfma_f32_16x16x32_bf16 v[56:59], a[44:47], a[236:239], v[56:59]
ds_read_b128 a[20:23], v200 offset:5120
v_mfma_f32_16x16x32_bf16 v[60:63], a[48:51], a[232:235], v[60:63]
ds_read_b128 a[24:27], v200 offset:6144
v_mfma_f32_16x16x32_bf16 v[64:67], a[48:51], a[236:239], v[64:67]
ds_read_b128 a[28:31], v200 offset:7168
v_mfma_f32_16x16x32_bf16 v[68:71], a[52:55], a[232:235], v[68:71]
ds_read_b128 a[32:35], v200 offset:8192
v_mfma_f32_16x16x32_bf16 v[72:75], a[52:55], a[236:239], v[72:75]
s_cmp_eq_u32 s25, 14
s_cselect_b32 s99, 36864, 0
s_add_u32 s60, s60, s99
v_mfma_f32_16x16x32_bf16 v[76:79], a[56:59], a[232:235], v[76:79]
s_add_u32 s61, s61, s99
s_add_u32 m0, s62, 126976
s_add_u32 s60, s60, 16384
v_mfma_f32_16x16x32_bf16 v[80:83], a[56:59], a[236:239], v[80:83]
buffer_load_dwordx4 v1, s[8:11], s60 offen offset:0 sc1 lds
v_mfma_f32_16x16x32_bf16 v[84:87], a[60:63], a[232:235], v[84:87]
v_rcp_f32 v195, v195
v_mfma_f32_16x16x32_bf16 v[88:91], a[60:63], a[236:239], v[88:91]
buffer_load_dwordx4 v1, s[8:11], s60 offen offset:1024 sc1 lds
v_mul_f32 v172, v172, v192
v_mfma_f32_16x16x32_bf16 v[92:95], a[64:67], a[232:235], v[92:95]
v_mul_f32 v173, v173, v193
v_mul_f32 v174, v174, v194
v_mfma_f32_16x16x32_bf16 v[96:99], a[64:67], a[236:239], v[96:99]
buffer_load_dwordx4 v1, s[8:11], s60 offen offset:2048 sc1 lds
v_mul_f32 v175, v175, v195
v_mfma_f32_16x16x32_bf16 v[100:103], a[68:71], a[232:235], v[100:103]
v_mul_f32 v196, v176, v176
v_mfma_f32_16x16x32_bf16 v[104:107], a[68:71], a[236:239], v[104:107]
v_mul_f32 v197, v177, v177
s_waitcnt lgkmcnt(0)
v_mfma_f32_16x16x32_bf16 v[36:39], a[0:3], a[240:243], v[36:39]
ds_read_b128 a[36:39], v200 offset:9216
buffer_load_dwordx4 v1, s[8:11], s60 offen offset:3072 sc1 lds
v_mfma_f32_16x16x32_bf16 v[40:43], a[0:3], a[244:247], v[40:43]
ds_read_b128 a[40:43], v200 offset:10240
v_mfma_f32_16x16x32_bf16 v[44:47], a[4:7], a[240:243], v[44:47]
ds_read_b128 a[44:47], v200 offset:11264
s_add_u32 m0, s63, 143360
v_mfma_f32_16x16x32_bf16 v[48:51], a[4:7], a[244:247], v[48:51]
ds_read_b128 a[48:51], v200 offset:12288
v_mul_f32 v198, v178, v178
v_mfma_f32_16x16x32_bf16 v[52:55], a[8:11], a[240:243], v[52:55]
ds_read_b128 a[52:55], v200 offset:13312
s_add_u32 s61, s61, 36864
v_mfma_f32_16x16x32_bf16 v[56:59], a[8:11], a[244:247], v[56:59]
ds_read_b128 a[56:59], v200 offset:14336
v_mul_f32 v199, v179, v179
v_mfma_f32_16x16x32_bf16 v[60:63], a[12:15], a[240:243], v[60:63]
ds_read_b128 a[60:63], v200 offset:15360
buffer_load_dwordx4 v1, s[8:11], s61 offen offset:0 sc1 lds
v_mfma_f32_16x16x32_bf16 v[64:67], a[12:15], a[244:247], v[64:67]
ds_read_b128 a[64:67], v200 offset:16384
v_fma_f32 v196, v196, v253, v251
v_mfma_f32_16x16x32_bf16 v[68:71], a[16:19], a[240:243], v[68:71]
ds_read_b128 a[68:71], v200 offset:17408
s_add_u32 m0, s62, 147456
v_mfma_f32_16x16x32_bf16 v[72:75], a[16:19], a[244:247], v[72:75]
s_add_u32 s60, s60, 20480
v_fma_f32 v197, v197, v253, v251
v_mfma_f32_16x16x32_bf16 v[76:79], a[20:23], a[240:243], v[76:79]
v_mfma_f32_16x16x32_bf16 v[80:83], a[20:23], a[244:247], v[80:83]
v_fma_f32 v198, v198, v253, v251
v_mfma_f32_16x16x32_bf16 v[84:87], a[24:27], a[240:243], v[84:87]
buffer_load_dwordx4 v1, s[8:11], s60 offen offset:0 sc1 lds
v_mfma_f32_16x16x32_bf16 v[88:91], a[24:27], a[244:247], v[88:91]
v_fma_f32 v199, v199, v253, v251
v_mfma_f32_16x16x32_bf16 v[92:95], a[28:31], a[240:243], v[92:95]
buffer_load_dwordx4 v1, s[8:11], s60 offen offset:1024 sc1 lds
v_mfma_f32_16x16x32_bf16 v[96:99], a[28:31], a[244:247], v[96:99]
v_mfma_f32_16x16x32_bf16 v[100:103], a[32:35], a[240:243], v[100:103]
v_mul_f32 v196, v196, v176
v_mfma_f32_16x16x32_bf16 v[104:107], a[32:35], a[244:247], v[104:107]
s_waitcnt vmcnt(24) lgkmcnt(0)
v_mfma_f32_16x16x32_bf16 v[36:39], a[36:39], a[248:251], v[36:39]
ds_read_b128 a[0:3], v200 offset:18432
buffer_load_dwordx4 v1, s[8:11], s60 offen offset:2048 sc1 lds
v_mfma_f32_16x16x32_bf16 v[40:43], a[36:39], a[252:255], v[40:43]
ds_read_b128 a[4:7], v200 offset:19456
v_mul_f32 v197, v197, v177
v_mfma_f32_16x16x32_bf16 v[44:47], a[40:43], a[248:251], v[44:47]
ds_read_b128 a[8:11], v200 offset:20480
buffer_load_dwordx4 v1, s[8:11], s60 offen offset:3072 sc1 lds
v_mfma_f32_16x16x32_bf16 v[48:51], a[40:43], a[252:255], v[48:51]
ds_read_b128 a[12:15], v200 offset:21504
v_mul_f32 v198, v198, v178
v_mfma_f32_16x16x32_bf16 v[52:55], a[44:47], a[248:251], v[52:55]
ds_read_b128 a[16:19], v200 offset:22528
v_mfma_f32_16x16x32_bf16 v[56:59], a[44:47], a[252:255], v[56:59]
ds_read_b128 a[20:23], v200 offset:23552
v_mul_f32 v199, v199, v179
v_mfma_f32_16x16x32_bf16 v[60:63], a[48:51], a[248:251], v[60:63]
ds_read_b128 a[24:27], v200 offset:24576
v_mfma_f32_16x16x32_bf16 v[64:67], a[48:51], a[252:255], v[64:67]
ds_read_b128 a[28:31], v200 offset:25600
v_mfma_f32_16x16x32_bf16 v[68:71], a[52:55], a[248:251], v[68:71]
ds_read_b128 a[32:35], v200 offset:26624
v_mfma_f32_16x16x32_bf16 v[72:75], a[52:55], a[252:255], v[72:75]
s_cmp_eq_u32 s25, 14
s_cselect_b32 s98, 4096, 0
s_add_u32 s52, s52, s98
v_mfma_f32_16x16x32_bf16 v[76:79], a[56:59], a[248:251], v[76:79]
s_add_u32 s52, s52, 4096
v_exp_f32 v196, v196
v_mfma_f32_16x16x32_bf16 v[80:83], a[56:59], a[252:255], v[80:83]
v_mfma_f32_16x16x32_bf16 v[84:87], a[60:63], a[248:251], v[84:87]
buffer_load_dwordx4 a[128:131], v1, s[4:7], s52 offen offset:0 sc1
v_mfma_f32_16x16x32_bf16 v[88:91], a[60:63], a[252:255], v[88:91]
v_exp_f32 v197, v197
v_mfma_f32_16x16x32_bf16 v[92:95], a[64:67], a[248:251], v[92:95]
buffer_load_dwordx4 a[132:135], v9, s[4:7], s52 offen offset:0 sc1
v_mfma_f32_16x16x32_bf16 v[96:99], a[64:67], a[252:255], v[96:99]
v_mfma_f32_16x16x32_bf16 v[100:103], a[68:71], a[248:251], v[100:103]
v_mfma_f32_16x16x32_bf16 v[104:107], a[68:71], a[252:255], v[104:107]
s_waitcnt lgkmcnt(0)
v_mfma_f32_16x16x32_bf16 v[36:39], a[0:3], a[80:83], v[36:39]
ds_read_b128 a[36:39], v200 offset:27648
buffer_load_dwordx4 a[136:139], v1, s[4:7], s52 offen offset:1024 sc1
v_mfma_f32_16x16x32_bf16 v[40:43], a[0:3], a[84:87], v[40:43]
ds_read_b128 a[40:43], v200 offset:28672
v_mfma_f32_16x16x32_bf16 v[44:47], a[4:7], a[80:83], v[44:47]
ds_read_b128 a[44:47], v200 offset:29696
v_mfma_f32_16x16x32_bf16 v[48:51], a[4:7], a[84:87], v[48:51]
ds_read_b128 a[48:51], v200 offset:30720
v_mfma_f32_16x16x32_bf16 v[52:55], a[8:11], a[80:83], v[52:55]
ds_read_b128 a[52:55], v200 offset:31744
buffer_load_dwordx4 a[140:143], v9, s[4:7], s52 offen offset:1024 sc1
v_mfma_f32_16x16x32_bf16 v[56:59], a[8:11], a[84:87], v[56:59]
ds_read_b128 a[56:59], v200 offset:32768
v_mfma_f32_16x16x32_bf16 v[60:63], a[12:15], a[80:83], v[60:63]
ds_read_b128 a[60:63], v200 offset:33792
v_mfma_f32_16x16x32_bf16 v[64:67], a[12:15], a[84:87], v[64:67]
ds_read_b128 a[64:67], v200 offset:34816
v_mfma_f32_16x16x32_bf16 v[68:71], a[16:19], a[80:83], v[68:71]
ds_read_b128 a[68:71], v200 offset:35840
buffer_load_dwordx4 a[144:147], v1, s[4:7], s52 offen offset:2048 sc1
v_mfma_f32_16x16x32_bf16 v[72:75], a[16:19], a[84:87], v[72:75]
v_exp_f32 v198, v198
v_mfma_f32_16x16x32_bf16 v[76:79], a[20:23], a[80:83], v[76:79]
v_exp_f32 v199, v199
v_mfma_f32_16x16x32_bf16 v[80:83], a[20:23], a[84:87], v[80:83]
v_fma_f32 v196, v196, v255, v255
v_fma_f32 v197, v197, v255, v255
v_mfma_f32_16x16x32_bf16 v[84:87], a[24:27], a[80:83], v[84:87]
buffer_load_dwordx4 a[148:151], v9, s[4:7], s52 offen offset:2048 sc1
v_mfma_f32_16x16x32_bf16 v[88:91], a[24:27], a[84:87], v[88:91]
v_fma_f32 v198, v198, v255, v255
v_mfma_f32_16x16x32_bf16 v[92:95], a[28:31], a[80:83], v[92:95]
v_mfma_f32_16x16x32_bf16 v[96:99], a[28:31], a[84:87], v[96:99]
v_fma_f32 v199, v199, v255, v255
v_mfma_f32_16x16x32_bf16 v[100:103], a[32:35], a[80:83], v[100:103]
v_mfma_f32_16x16x32_bf16 v[104:107], a[32:35], a[84:87], v[104:107]
s_waitcnt vmcnt(19) lgkmcnt(0)
s_barrier
v_mfma_f32_16x16x32_bf16 v[36:39], a[36:39], a[88:91], v[36:39]
ds_read_b128 a[0:3], v201 offset:0
buffer_load_dwordx4 a[152:155], v1, s[4:7], s52 offen offset:3072 sc1
v_mfma_f32_16x16x32_bf16 v[40:43], a[36:39], a[92:95], v[40:43]
ds_read_b128 a[4:7], v201 offset:1024
v_mfma_f32_16x16x32_bf16 v[44:47], a[40:43], a[88:91], v[44:47]
ds_read_b128 a[8:11], v201 offset:2048
buffer_load_dwordx4 a[156:159], v9, s[4:7], s52 offen offset:3072 sc1
v_mfma_f32_16x16x32_bf16 v[48:51], a[40:43], a[92:95], v[48:51]
ds_read_b128 a[12:15], v201 offset:3072
v_mfma_f32_16x16x32_bf16 v[52:55], a[44:47], a[88:91], v[52:55]
ds_read_b128 a[16:19], v201 offset:4096
s_mul_i32 s38, s24, 13312
v_mfma_f32_16x16x32_bf16 v[56:59], a[44:47], a[92:95], v[56:59]
ds_read_b128 a[20:23], v201 offset:5120
v_mfma_f32_16x16x32_bf16 v[60:63], a[48:51], a[88:91], v[60:63]
ds_read_b128 a[24:27], v201 offset:6144
v_mfma_f32_16x16x32_bf16 v[64:67], a[48:51], a[92:95], v[64:67]
ds_read_b128 a[28:31], v201 offset:7168
s_add_u32 m0, s38, 0
v_mfma_f32_16x16x32_bf16 v[68:71], a[52:55], a[88:91], v[68:71]
ds_read_b128 a[32:35], v201 offset:8192
v_mfma_f32_16x16x32_bf16 v[72:75], a[52:55], a[92:95], v[72:75]
s_add_u32 s39, s38, s83
v_rcp_f32 v196, v196
v_mfma_f32_16x16x32_bf16 v[76:79], a[56:59], a[88:91], v[76:79]
v_rcp_f32 v197, v197
v_mfma_f32_16x16x32_bf16 v[80:83], a[56:59], a[92:95], v[80:83]
v_rcp_f32 v198, v198
v_mfma_f32_16x16x32_bf16 v[84:87], a[60:63], a[88:91], v[84:87]
buffer_load_dwordx4 v1, s[4:7], s39 offen offset:0 sc1 lds
v_mfma_f32_16x16x32_bf16 v[88:91], a[60:63], a[92:95], v[88:91]
v_mfma_f32_16x16x32_bf16 v[92:95], a[64:67], a[88:91], v[92:95]
buffer_load_dwordx4 v1, s[4:7], s39 offen offset:1024 sc1 lds
v_mfma_f32_16x16x32_bf16 v[96:99], a[64:67], a[92:95], v[96:99]
v_rcp_f32 v199, v199
v_mfma_f32_16x16x32_bf16 v[100:103], a[68:71], a[88:91], v[100:103]
v_mfma_f32_16x16x32_bf16 v[104:107], a[68:71], a[92:95], v[104:107]
s_waitcnt lgkmcnt(0)
v_mfma_f32_16x16x32_bf16 v[36:39], a[0:3], a[96:99], v[36:39]
ds_read_b128 a[36:39], v201 offset:9216
buffer_load_dwordx4 v1, s[4:7], s39 offen offset:2048 sc1 lds
v_mfma_f32_16x16x32_bf16 v[40:43], a[0:3], a[100:103], v[40:43]
ds_read_b128 a[40:43], v201 offset:10240
v_mul_f32 v176, v176, v196
v_mfma_f32_16x16x32_bf16 v[44:47], a[4:7], a[96:99], v[44:47]
ds_read_b128 a[44:47], v201 offset:11264
buffer_load_dwordx4 v1, s[4:7], s39 offen offset:3072 sc1 lds
v_mfma_f32_16x16x32_bf16 v[48:51], a[4:7], a[100:103], v[48:51]
ds_read_b128 a[48:51], v201 offset:12288
v_mul_f32 v177, v177, v197
v_mfma_f32_16x16x32_bf16 v[52:55], a[8:11], a[96:99], v[52:55]
ds_read_b128 a[52:55], v201 offset:13312
v_mfma_f32_16x16x32_bf16 v[56:59], a[8:11], a[100:103], v[56:59]
ds_read_b128 a[56:59], v201 offset:14336
s_add_u32 m0, m0, 4096
v_mfma_f32_16x16x32_bf16 v[60:63], a[12:15], a[96:99], v[60:63]
ds_read_b128 a[60:63], v201 offset:15360
v_mul_f32 v178, v178, v198
v_mfma_f32_16x16x32_bf16 v[64:67], a[12:15], a[100:103], v[64:67]
ds_read_b128 a[64:67], v201 offset:16384
v_mul_f32 v179, v179, v199
v_mfma_f32_16x16x32_bf16 v[68:71], a[16:19], a[96:99], v[68:71]
ds_read_b128 a[68:71], v201 offset:17408
s_add_u32 s39, s39, 4096
v_mfma_f32_16x16x32_bf16 v[72:75], a[16:19], a[100:103], v[72:75]
s_lshl_b32 s30, s25, 3
v_mfma_f32_16x16x32_bf16 v[76:79], a[20:23], a[96:99], v[76:79]
s_lshl_b32 s31, s24, 1
v_mfma_f32_16x16x32_bf16 v[80:83], a[20:23], a[100:103], v[80:83]
buffer_load_dwordx4 v1, s[4:7], s39 offen offset:0 sc1 lds
v_mfma_f32_16x16x32_bf16 v[84:87], a[24:27], a[96:99], v[84:87]
s_add_u32 s30, s30, s31
v_mfma_f32_16x16x32_bf16 v[88:91], a[24:27], a[100:103], v[88:91]
s_mul_i32 s30, s30, 73728
v_mfma_f32_16x16x32_bf16 v[92:95], a[28:31], a[96:99], v[92:95]
buffer_load_dwordx4 v1, s[4:7], s39 offen offset:1024 sc1 lds
v_mfma_f32_16x16x32_bf16 v[96:99], a[28:31], a[100:103], v[96:99]
s_add_u32 s30, s30, 16777216
v_mfma_f32_16x16x32_bf16 v[100:103], a[32:35], a[96:99], v[100:103]
s_mul_i32 s31, s26, 4608
v_mfma_f32_16x16x32_bf16 v[104:107], a[32:35], a[100:103], v[104:107]
s_add_u32 s30, s30, s31
s_waitcnt vmcnt(23) lgkmcnt(0)
v_mfma_f32_16x16x32_bf16 v[36:39], a[36:39], a[104:107], v[36:39]
ds_read_b128 a[0:3], v201 offset:18432
buffer_load_dwordx4 v1, s[4:7], s39 offen offset:2048 sc1 lds
v_mfma_f32_16x16x32_bf16 v[40:43], a[36:39], a[108:111], v[40:43]
ds_read_b128 a[4:7], v201 offset:19456
v_mfma_f32_16x16x32_bf16 v[44:47], a[40:43], a[104:107], v[44:47]
ds_read_b128 a[8:11], v201 offset:20480
buffer_load_dwordx4 v1, s[4:7], s39 offen offset:3072 sc1 lds
v_mfma_f32_16x16x32_bf16 v[48:51], a[40:43], a[108:111], v[48:51]
ds_read_b128 a[12:15], v201 offset:21504
v_mfma_f32_16x16x32_bf16 v[52:55], a[44:47], a[104:107], v[52:55]
ds_read_b128 a[16:19], v201 offset:22528
v_mfma_f32_16x16x32_bf16 v[56:59], a[44:47], a[108:111], v[56:59]
ds_read_b128 a[20:23], v201 offset:23552
s_add_u32 m0, m0, 4096
v_mfma_f32_16x16x32_bf16 v[60:63], a[48:51], a[104:107], v[60:63]
ds_read_b128 a[24:27], v201 offset:24576
v_mfma_f32_16x16x32_bf16 v[64:67], a[48:51], a[108:111], v[64:67]
ds_read_b128 a[28:31], v201 offset:25600
v_mfma_f32_16x16x32_bf16 v[68:71], a[52:55], a[104:107], v[68:71]
ds_read_b128 a[32:35], v201 offset:26624
s_add_u32 s39, s39, 4096
v_mfma_f32_16x16x32_bf16 v[72:75], a[52:55], a[108:111], v[72:75]
s_and_b32 s65, s26, 1
v_mfma_f32_16x16x32_bf16 v[76:79], a[56:59], a[104:107], v[76:79]
s_lshl_b32 s64, s65, 9
v_mfma_f32_16x16x32_bf16 v[80:83], a[56:59], a[108:111], v[80:83]
buffer_load_dwordx4 v1, s[4:7], s39 offen offset:0 sc1 lds
v_mfma_f32_16x16x32_bf16 v[84:87], a[60:63], a[104:107], v[84:87]
s_add_u32 s64, s64, s30
v_mfma_f32_16x16x32_bf16 v[88:91], a[60:63], a[108:111], v[88:91]
s_xor_b32 s65, s65, 1
v_mfma_f32_16x16x32_bf16 v[92:95], a[64:67], a[104:107], v[92:95]
buffer_load_dwordx4 v1, s[4:7], s39 offen offset:1024 sc1 lds
v_mfma_f32_16x16x32_bf16 v[96:99], a[64:67], a[108:111], v[96:99]
s_lshl_b32 s65, s65, 12
v_mfma_f32_16x16x32_bf16 v[100:103], a[68:71], a[104:107], v[100:103]
s_add_u32 s65, s65, s30
v_mfma_f32_16x16x32_bf16 v[104:107], a[68:71], a[108:111], v[104:107]
s_waitcnt lgkmcnt(0)
v_mfma_f32_16x16x32_bf16 v[36:39], a[0:3], a[112:115], v[36:39]
ds_read_b128 a[36:39], v201 offset:27648
buffer_load_dwordx4 v1, s[4:7], s39 offen offset:2048 sc1 lds
v_mfma_f32_16x16x32_bf16 v[40:43], a[0:3], a[116:119], v[40:43]
ds_read_b128 a[40:43], v201 offset:28672
buffer_load_dwordx4 v1, s[4:7], s39 offen offset:3072 sc1 lds
v_mfma_f32_16x16x32_bf16 v[44:47], a[4:7], a[112:115], v[44:47]
ds_read_b128 a[44:47], v201 offset:29696
v_mfma_f32_16x16x32_bf16 v[48:51], a[4:7], a[116:119], v[48:51]
ds_read_b128 a[48:51], v201 offset:30720
s_add_u32 m0, m0, 4096
v_mfma_f32_16x16x32_bf16 v[52:55], a[8:11], a[112:115], v[52:55]
ds_read_b128 a[52:55], v201 offset:31744
v_add_u32 v204, 73728, v1
v_mfma_f32_16x16x32_bf16 v[56:59], a[8:11], a[116:119], v[56:59]
ds_read_b128 a[56:59], v201 offset:32768
s_add_u32 s39, s39, 4096
v_mfma_f32_16x16x32_bf16 v[60:63], a[12:15], a[112:115], v[60:63]
ds_read_b128 a[60:63], v201 offset:33792
buffer_load_dwordx4 v1, s[4:7], s39 offen offset:0 sc1 lds
v_mfma_f32_16x16x32_bf16 v[64:67], a[12:15], a[116:119], v[64:67]
ds_read_b128 a[64:67], v201 offset:34816
v_and_b32 v203, 1, v3
v_mfma_f32_16x16x32_bf16 v[68:71], a[16:19], a[112:115], v[68:71]
ds_read_b128 a[68:71], v201 offset:35840
s_mul_i32 s38, s24, 9216
v_mfma_f32_16x16x32_bf16 v[72:75], a[16:19], a[116:119], v[72:75]
s_add_u32 m0, s38, 53248
v_mul_u32_u24 v203, 73728, v203
v_mfma_f32_16x16x32_bf16 v[76:79], a[20:23], a[112:115], v[76:79]
s_add_u32 s39, s38, s83
v_mfma_f32_16x16x32_bf16 v[80:83], a[20:23], a[116:119], v[80:83]
s_add_u32 s39, s39, 53248
v_lshrrev_b32 v7, 1, v3
v_mfma_f32_16x16x32_bf16 v[84:87], a[24:27], a[112:115], v[84:87]
v_mfma_f32_16x16x32_bf16 v[88:91], a[24:27], a[116:119], v[88:91]
v_mfma_f32_16x16x32_bf16 v[92:95], a[28:31], a[112:115], v[92:95]
v_lshl_add_u32 v203, v7, 8, v203
v_mfma_f32_16x16x32_bf16 v[96:99], a[28:31], a[116:119], v[96:99]
buffer_load_dwordx4 v1, s[4:7], s39 offen offset:0 sc1 lds
v_mfma_f32_16x16x32_bf16 v[100:103], a[32:35], a[112:115], v[100:103]
v_lshl_add_u32 v203, v2, 4, v203
v_mfma_f32_16x16x32_bf16 v[104:107], a[32:35], a[116:119], v[104:107]
s_waitcnt vmcnt(14) lgkmcnt(0)
s_barrier
v_mfma_f32_16x16x32_bf16 v[36:39], a[36:39], a[120:123], v[36:39]
ds_read_b128 a[0:3], v202 offset:8192
buffer_load_dwordx4 v1, s[4:7], s39 offen offset:1024 sc1 lds
v_mfma_f32_16x16x32_bf16 v[40:43], a[36:39], a[124:127], v[40:43]
ds_read_b128 a[4:7], v202 offset:17408
v_mfma_f32_16x16x32_bf16 v[44:47], a[40:43], a[120:123], v[44:47]
ds_read_b128 a[8:11], v202 offset:26624
buffer_load_dwordx4 v1, s[4:7], s39 offen offset:2048 sc1 lds
v_mfma_f32_16x16x32_bf16 v[48:51], a[40:43], a[124:127], v[48:51]
ds_read_b128 a[12:15], v202 offset:35840
v_mfma_f32_16x16x32_bf16 v[52:55], a[44:47], a[120:123], v[52:55]
ds_read_b128 a[16:19], v202 offset:0
v_mfma_f32_16x16x32_bf16 v[56:59], a[44:47], a[124:127], v[56:59]
ds_read_b128 a[20:23], v202 offset:1024
buffer_load_dwordx4 v1, s[4:7], s39 offen offset:3072 sc1 lds
v_mfma_f32_16x16x32_bf16 v[60:63], a[48:51], a[120:123], v[60:63]
ds_read_b128 a[24:27], v202 offset:9216
v_mfma_f32_16x16x32_bf16 v[64:67], a[48:51], a[124:127], v[64:67]
ds_read_b128 a[28:31], v202 offset:10240
v_mfma_f32_16x16x32_bf16 v[68:71], a[52:55], a[120:123], v[68:71]
ds_read_b128 a[32:35], v202 offset:18432
s_add_u32 m0, m0, 4096
v_mfma_f32_16x16x32_bf16 v[72:75], a[52:55], a[124:127], v[72:75]
s_add_u32 s39, s39, 4096
v_mfma_f32_16x16x32_bf16 v[76:79], a[56:59], a[120:123], v[76:79]
v_mfma_f32_16x16x32_bf16 v[80:83], a[56:59], a[124:127], v[80:83]
v_mfma_f32_16x16x32_bf16 v[84:87], a[60:63], a[120:123], v[84:87]
v_mfma_f32_16x16x32_bf16 v[88:91], a[60:63], a[124:127], v[88:91]
v_mfma_f32_16x16x32_bf16 v[92:95], a[64:67], a[120:123], v[92:95]
buffer_load_dwordx4 v1, s[4:7], s39 offen offset:0 sc1 lds
v_mfma_f32_16x16x32_bf16 v[96:99], a[64:67], a[124:127], v[96:99]
v_mfma_f32_16x16x32_bf16 v[100:103], a[68:71], a[120:123], v[100:103]
v_mfma_f32_16x16x32_bf16 v[104:107], a[68:71], a[124:127], v[104:107]
s_waitcnt lgkmcnt(7)
v_mfma_f32_16x16x32_bf16 v[100:103], a[0:3], a[128:131], v[100:103]
ds_read_b128 a[36:39], v202 offset:19456
v_mfma_f32_16x16x32_bf16 v[104:107], a[0:3], a[132:135], v[104:107]
v_mfma_f32_16x16x32_bf16 v[100:103], a[4:7], a[136:139], v[100:103]
ds_read_b128 a[40:43], v202 offset:27648
v_mfma_f32_16x16x32_bf16 v[104:107], a[4:7], a[140:143], v[104:107]
s_waitcnt lgkmcnt(7)
v_mfma_f32_16x16x32_bf16 v[100:103], a[8:11], a[144:147], v[100:103]
ds_read_b128 a[44:47], v202 offset:28672
v_mfma_f32_16x16x32_bf16 v[104:107], a[8:11], a[148:151], v[104:107]
v_mfma_f32_16x16x32_bf16 v[100:103], a[12:15], a[152:155], v[100:103]
ds_read_b128 a[48:51], v202 offset:2048
v_mfma_f32_16x16x32_bf16 v[104:107], a[12:15], a[156:159], v[104:107]
s_waitcnt lgkmcnt(7)
v_mfma_f32_16x16x32_bf16 v[36:39], a[16:19], a[128:131], v[36:39]
ds_read_b128 a[52:55], v202 offset:3072
v_mfma_f32_16x16x32_bf16 v[40:43], a[16:19], a[132:135], v[40:43]
v_mfma_f32_16x16x32_bf16 v[44:47], a[20:23], a[128:131], v[44:47]
ds_read_b128 a[56:59], v202 offset:11264
v_mfma_f32_16x16x32_bf16 v[48:51], a[20:23], a[132:135], v[48:51]
v_mul_f32 v100, v100, v108
s_waitcnt lgkmcnt(7)
v_mfma_f32_16x16x32_bf16 v[36:39], a[24:27], a[136:139], v[36:39]
ds_read_b128 a[60:63], v202 offset:12288
v_mul_f32 v101, v101, v109
v_mfma_f32_16x16x32_bf16 v[40:43], a[24:27], a[140:143], v[40:43]
v_mul_f32 v102, v102, v110
v_mul_f32 v103, v103, v111
v_mfma_f32_16x16x32_bf16 v[44:47], a[28:31], a[136:139], v[44:47]
ds_read_b128 a[64:67], v202 offset:20480
v_cvt_pk_bf16_f32 v238, v100, v101
v_mfma_f32_16x16x32_bf16 v[48:51], a[28:31], a[140:143], v[48:51]
v_cvt_pk_bf16_f32 v239, v102, v103
s_waitcnt lgkmcnt(7)
v_mfma_f32_16x16x32_bf16 v[36:39], a[32:35], a[144:147], v[36:39]
ds_read_b128 a[68:71], v202 offset:21504
v_mul_f32 v104, v104, v112
v_mfma_f32_16x16x32_bf16 v[40:43], a[32:35], a[148:151], v[40:43]
v_mul_f32 v105, v105, v113
v_mfma_f32_16x16x32_bf16 v[44:47], a[36:39], a[144:147], v[44:47]
ds_read_b128 a[0:3], v202 offset:29696
v_mul_f32 v106, v106, v114
v_mfma_f32_16x16x32_bf16 v[48:51], a[36:39], a[148:151], v[48:51]
v_mul_f32 v107, v107, v115
s_waitcnt lgkmcnt(7)
v_mfma_f32_16x16x32_bf16 v[36:39], a[40:43], a[152:155], v[36:39]
ds_read_b128 a[4:7], v202 offset:30720
v_cvt_pk_bf16_f32 v240, v104, v105
v_mfma_f32_16x16x32_bf16 v[40:43], a[40:43], a[156:159], v[40:43]
v_cvt_pk_bf16_f32 v241, v106, v107
s_nop 0
v_mfma_f32_16x16x32_bf16 v[44:47], a[44:47], a[152:155], v[44:47]
ds_read_b128 a[8:11], v202 offset:4096
v_mfma_f32_16x16x32_bf16 v[48:51], a[44:47], a[156:159], v[48:51]
s_waitcnt lgkmcnt(7)
v_mfma_f32_16x16x32_bf16 v[52:55], a[48:51], a[128:131], v[52:55]
ds_read_b128 a[12:15], v202 offset:5120
v_permlane16_swap_b32 v238, v240
v_mfma_f32_16x16x32_bf16 v[56:59], a[48:51], a[132:135], v[56:59]
v_permlane16_swap_b32 v239, v241
v_mfma_f32_16x16x32_bf16 v[60:63], a[52:55], a[128:131], v[60:63]
ds_read_b128 a[16:19], v202 offset:13312
buffer_store_dwordx4 v[238:241], v203, s[8:11], s65 offen sc1
v_mfma_f32_16x16x32_bf16 v[64:67], a[52:55], a[132:135], v[64:67]
v_mul_f32 v36, v36, v116
s_waitcnt lgkmcnt(7)
v_mfma_f32_16x16x32_bf16 v[52:55], a[56:59], a[136:139], v[52:55]
ds_read_b128 a[20:23], v202 offset:14336
v_mul_f32 v37, v37, v117
v_mfma_f32_16x16x32_bf16 v[56:59], a[56:59], a[140:143], v[56:59]
v_mul_f32 v38, v38, v118
v_mul_f32 v39, v39, v119
v_mfma_f32_16x16x32_bf16 v[60:63], a[60:63], a[136:139], v[60:63]
ds_read_b128 a[24:27], v202 offset:22528
v_cvt_pk_bf16_f32 v206, v36, v37
v_mfma_f32_16x16x32_bf16 v[64:67], a[60:63], a[140:143], v[64:67]
v_cvt_pk_bf16_f32 v207, v38, v39
v_mul_f32 v44, v44, v124
s_waitcnt lgkmcnt(7)
v_mfma_f32_16x16x32_bf16 v[52:55], a[64:67], a[144:147], v[52:55]
ds_read_b128 a[28:31], v202 offset:23552
v_mul_f32 v45, v45, v125
v_mfma_f32_16x16x32_bf16 v[56:59], a[64:67], a[148:151], v[56:59]
v_mul_f32 v46, v46, v126
v_mul_f32 v47, v47, v127
v_mfma_f32_16x16x32_bf16 v[60:63], a[68:71], a[144:147], v[60:63]
ds_read_b128 a[32:35], v202 offset:31744
v_cvt_pk_bf16_f32 v208, v44, v45
v_mfma_f32_16x16x32_bf16 v[64:67], a[68:71], a[148:151], v[64:67]
v_cvt_pk_bf16_f32 v209, v46, v47
s_waitcnt lgkmcnt(7)
v_mfma_f32_16x16x32_bf16 v[52:55], a[0:3], a[152:155], v[52:55]
ds_read_b128 a[36:39], v202 offset:32768
buffer_store_dwordx4 v[206:209], v1, s[8:11], s64 offen offset:0 sc1
v_mul_f32 v40, v40, v120
v_mul_f32 v41, v41, v121
v_mfma_f32_16x16x32_bf16 v[56:59], a[0:3], a[156:159], v[56:59]
v_mul_f32 v42, v42, v122
v_mul_f32 v43, v43, v123
v_mfma_f32_16x16x32_bf16 v[60:63], a[4:7], a[152:155], v[60:63]
ds_read_b128 a[40:43], v202 offset:6144
v_cvt_pk_bf16_f32 v210, v40, v41
v_mfma_f32_16x16x32_bf16 v[64:67], a[4:7], a[156:159], v[64:67]
v_cvt_pk_bf16_f32 v211, v42, v43
v_mul_f32 v48, v48, v128
s_waitcnt lgkmcnt(7)
v_mfma_f32_16x16x32_bf16 v[68:71], a[8:11], a[128:131], v[68:71]
ds_read_b128 a[44:47], v202 offset:7168
v_mul_f32 v49, v49, v129
v_mfma_f32_16x16x32_bf16 v[72:75], a[8:11], a[132:135], v[72:75]
v_mul_f32 v50, v50, v130
v_mul_f32 v51, v51, v131
v_mfma_f32_16x16x32_bf16 v[76:79], a[12:15], a[128:131], v[76:79]
ds_read_b128 a[48:51], v202 offset:15360
v_cvt_pk_bf16_f32 v212, v48, v49
v_cvt_pk_bf16_f32 v213, v50, v51
buffer_store_dwordx4 v[210:213], v204, s[8:11], s64 offen offset:0 sc1
v_mfma_f32_16x16x32_bf16 v[80:83], a[12:15], a[132:135], v[80:83]
v_mul_f32 v52, v52, v132
s_waitcnt lgkmcnt(7)
v_mfma_f32_16x16x32_bf16 v[68:71], a[16:19], a[136:139], v[68:71]
ds_read_b128 a[52:55], v202 offset:16384
v_mul_f32 v53, v53, v133
v_mfma_f32_16x16x32_bf16 v[72:75], a[16:19], a[140:143], v[72:75]
v_mul_f32 v54, v54, v134
v_mul_f32 v55, v55, v135
v_mfma_f32_16x16x32_bf16 v[76:79], a[20:23], a[136:139], v[76:79]
ds_read_b128 a[56:59], v202 offset:24576
v_cvt_pk_bf16_f32 v214, v52, v53
v_mfma_f32_16x16x32_bf16 v[80:83], a[20:23], a[140:143], v[80:83]
v_cvt_pk_bf16_f32 v215, v54, v55
v_mul_f32 v60, v60, v140
s_waitcnt lgkmcnt(7)
v_mfma_f32_16x16x32_bf16 v[68:71], a[24:27], a[144:147], v[68:71]
ds_read_b128 a[60:63], v202 offset:25600
v_mul_f32 v61, v61, v141
v_mfma_f32_16x16x32_bf16 v[72:75], a[24:27], a[148:151], v[72:75]
v_mul_f32 v62, v62, v142
v_mul_f32 v63, v63, v143
v_mfma_f32_16x16x32_bf16 v[76:79], a[28:31], a[144:147], v[76:79]
ds_read_b128 a[64:67], v202 offset:33792
v_cvt_pk_bf16_f32 v216, v60, v61
v_mfma_f32_16x16x32_bf16 v[80:83], a[28:31], a[148:151], v[80:83]
v_cvt_pk_bf16_f32 v217, v62, v63
s_waitcnt lgkmcnt(7)
v_mfma_f32_16x16x32_bf16 v[68:71], a[32:35], a[152:155], v[68:71]
ds_read_b128 a[68:71], v202 offset:34816
buffer_store_dwordx4 v[214:217], v1, s[8:11], s64 offen offset:1024 sc1
v_mul_f32 v56, v56, v136
v_mul_f32 v57, v57, v137
v_mfma_f32_16x16x32_bf16 v[72:75], a[32:35], a[156:159], v[72:75]
v_mul_f32 v58, v58, v138
v_mul_f32 v59, v59, v139
v_mfma_f32_16x16x32_bf16 v[76:79], a[36:39], a[152:155], v[76:79]
v_cvt_pk_bf16_f32 v218, v56, v57
v_cvt_pk_bf16_f32 v219, v58, v59
v_mfma_f32_16x16x32_bf16 v[80:83], a[36:39], a[156:159], v[80:83]
v_mul_f32 v64, v64, v144
s_waitcnt lgkmcnt(6)
v_mfma_f32_16x16x32_bf16 v[84:87], a[40:43], a[128:131], v[84:87]
v_mul_f32 v65, v65, v145
v_mul_f32 v66, v66, v146
v_mfma_f32_16x16x32_bf16 v[88:91], a[40:43], a[132:135], v[88:91]
v_mul_f32 v67, v67, v147
v_cvt_pk_bf16_f32 v220, v64, v65
v_mfma_f32_16x16x32_bf16 v[92:95], a[44:47], a[128:131], v[92:95]
v_cvt_pk_bf16_f32 v221, v66, v67
buffer_store_dwordx4 v[218:221], v204, s[8:11], s64 offen offset:1024 sc1
v_mfma_f32_16x16x32_bf16 v[96:99], a[44:47], a[132:135], v[96:99]
v_mul_f32 v68, v68, v148
s_waitcnt lgkmcnt(4)
v_mfma_f32_16x16x32_bf16 v[84:87], a[48:51], a[136:139], v[84:87]
v_mul_f32 v69, v69, v149
v_mul_f32 v70, v70, v150
v_mfma_f32_16x16x32_bf16 v[88:91], a[48:51], a[140:143], v[88:91]
v_mul_f32 v71, v71, v151
v_cvt_pk_bf16_f32 v222, v68, v69
v_mfma_f32_16x16x32_bf16 v[92:95], a[52:55], a[136:139], v[92:95]
v_cvt_pk_bf16_f32 v223, v70, v71
v_mul_f32 v76, v76, v156
v_mfma_f32_16x16x32_bf16 v[96:99], a[52:55], a[140:143], v[96:99]
v_mul_f32 v77, v77, v157
s_waitcnt lgkmcnt(2)
v_mfma_f32_16x16x32_bf16 v[84:87], a[56:59], a[144:147], v[84:87]
v_mul_f32 v78, v78, v158
v_mul_f32 v79, v79, v159
v_mfma_f32_16x16x32_bf16 v[88:91], a[56:59], a[148:151], v[88:91]
v_cvt_pk_bf16_f32 v224, v76, v77
v_cvt_pk_bf16_f32 v225, v78, v79
v_mfma_f32_16x16x32_bf16 v[92:95], a[60:63], a[144:147], v[92:95]
buffer_store_dwordx4 v[222:225], v1, s[8:11], s64 offen offset:2048 sc1
v_mul_f32 v72, v72, v152
v_mfma_f32_16x16x32_bf16 v[96:99], a[60:63], a[148:151], v[96:99]
v_mul_f32 v73, v73, v153
v_mul_f32 v74, v74, v154
s_waitcnt lgkmcnt(0)
v_mfma_f32_16x16x32_bf16 v[84:87], a[64:67], a[152:155], v[84:87]
v_mul_f32 v75, v75, v155
v_cvt_pk_bf16_f32 v226, v72, v73
v_mfma_f32_16x16x32_bf16 v[88:91], a[64:67], a[156:159], v[88:91]
v_cvt_pk_bf16_f32 v227, v74, v75
v_mul_f32 v80, v80, v160
v_mfma_f32_16x16x32_bf16 v[92:95], a[68:71], a[152:155], v[92:95]
v_mul_f32 v81, v81, v161
v_mul_f32 v82, v82, v162
v_mfma_f32_16x16x32_bf16 v[96:99], a[68:71], a[156:159], v[96:99]
v_mul_f32 v83, v83, v163
v_cvt_pk_bf16_f32 v228, v80, v81
v_cvt_pk_bf16_f32 v229, v82, v83
buffer_store_dwordx4 v[226:229], v204, s[8:11], s64 offen offset:2048 sc1
s_nop 1
v_pk_mul_f32 v[84:85], v[84:85], v[164:165]
v_pk_mul_f32 v[86:87], v[86:87], v[166:167]
v_cvt_pk_bf16_f32 v230, v84, v85
v_cvt_pk_bf16_f32 v231, v86, v87
v_pk_mul_f32 v[92:93], v[92:93], v[172:173]
v_pk_mul_f32 v[94:95], v[94:95], v[174:175]
v_cvt_pk_bf16_f32 v232, v92, v93
v_cvt_pk_bf16_f32 v233, v94, v95
buffer_store_dwordx4 v[230:233], v1, s[8:11], s64 offen offset:3072 sc1
v_pk_mul_f32 v[88:89], v[88:89], v[168:169]
v_pk_mul_f32 v[90:91], v[90:91], v[170:171]
v_cvt_pk_bf16_f32 v234, v88, v89
v_cvt_pk_bf16_f32 v235, v90, v91
v_pk_mul_f32 v[96:97], v[96:97], v[176:177]
v_pk_mul_f32 v[98:99], v[98:99], v[178:179]
v_cvt_pk_bf16_f32 v236, v96, v97
v_cvt_pk_bf16_f32 v237, v98, v99
buffer_store_dwordx4 v[234:237], v204, s[8:11], s64 offen offset:3072 sc1
L_c5:
buffer_load_dwordx4 v1, s[4:7], s39 offen offset:1024 sc1 lds
buffer_load_dwordx4 v1, s[4:7], s39 offen offset:2048 sc1 lds
buffer_load_dwordx4 v1, s[4:7], s39 offen offset:3072 sc1 lds
s_add_u32 m0, m0, 4096
s_add_u32 s39, s39, 4096
buffer_load_dwordx4 v1, s[4:7], s39 offen offset:0 sc1 lds
s_mul_i32 s38, s24, 9216
s_add_u32 m0, s38, 90112
s_add_u32 s39, s38, s83
s_add_u32 s39, s39, 90112
buffer_load_dwordx4 v1, s[4:7], s39 offen offset:0 sc1 lds
buffer_load_dwordx4 v1, s[4:7], s39 offen offset:1024 sc1 lds
buffer_load_dwordx4 v1, s[4:7], s39 offen offset:2048 sc1 lds
v_lshlrev_b32 v7, 3, v1
s_lshl_b32 s31, s27, 10
v_add_u32 v7, s31, v7
s_cmp_eq_u32 s24, 0
s_cselect_b32 s30, 0, 1073741824
s_add_u32 s30, s30, 26574848
s_waitcnt vmcnt(7)
s_barrier
s_mov_b64 exec, 0xff
buffer_atomic_add v4, v7, s[8:11], s30 offen sc1
s_mov_b64 exec, -1
s_lshl_b32 s35, s80, 7
s_add_u32 s35, s35, 26574848
s_cmp_eq_u32 s24, 1
s_cselect_b32 s35, s35, 1073741824
v_mov_b32 v6, 0
v_mov_b32 v244, 0
v_mov_b32 v245, 0
v_mov_b32 v246, 0
buffer_load_dwordx4 v1, s[4:7], s39 offen offset:3072 sc1 lds
s_add_u32 m0, m0, 4096
s_add_u32 s39, s39, 4096
buffer_load_dwordx4 v1, s[4:7], s39 offen offset:0 sc1 lds
buffer_load_dwordx4 v1, s[4:7], s39 offen offset:1024 sc1 lds
buffer_load_dwordx4 v1, s[4:7], s39 offen offset:2048 sc1 lds
s_xor_b32 s30, s70, 1
s_mul_i32 s60, s30, 73728
s_and_b32 s32, s27, 1
s_mul_i32 s32, s32, 36864
s_add_u32 s32, s32, 16777216
s_add_u32 s60, s60, s32
s_mul_i32 s61, s70, 73728
s_add_u32 s61, s61, s32
v_and_b32 v40, 7, v2
v_lshlrev_b32 v40, 4, v40
v_lshl_add_u32 v40, v3, 7, v40
v_add_u32 v40, 4096, v40
s_mov_b64 exec, 1
buffer_atomic_add v244, v6, s[8:11], s35 offen sc0 sc1
s_mov_b64 exec, -1
buffer_load_dwordx4 v1, s[4:7], s39 offen offset:3072 sc1 lds
s_add_u32 m0, m0, 4096
s_add_u32 s39, s39, 4096
buffer_load_dwordx4 v1, s[4:7], s39 offen offset:0 sc1 lds
s_mul_i32 s38, s24, 9216
s_add_u32 m0, s38, 126976
s_add_u32 s39, s38, s83
s_add_u32 s39, s39, 126976
buffer_load_dwordx4 v1, s[4:7], s39 offen offset:0 sc1 lds
buffer_load_dwordx4 v1, s[4:7], s39 offen offset:1024 sc1 lds
s_lshl_b32 s63, s80, 14
s_lshl_b32 s30, s24, 12
s_add_u32 s63, s63, s30
s_xor_b32 s62, s63, 131072
s_add_u32 s63, s63, 26640384
s_add_u32 s62, s62, 26640384
s_add_u32 s64, s83, 161280
v_mov_b32 v116, v40
v_add_u32 v36, 0, v1
v_add_u32 v37, 55296, v1
v_add_u32 v41, 55296, v40
v_add_u32 v38, 110592, v1
s_mov_b64 exec, 1
buffer_atomic_add v245, v6, s[8:11], s35 offen sc0 sc1
s_mov_b64 exec, -1
buffer_load_dwordx4 v1, s[4:7], s39 offen offset:2048 sc1 lds
buffer_load_dwordx4 v1, s[4:7], s39 offen offset:3072 sc1 lds
s_add_u32 m0, m0, 4096
s_add_u32 s39, s39, 4096
buffer_load_dwordx4 v1, s[4:7], s39 offen offset:0 sc1 lds
buffer_load_dwordx4 v1, s[4:7], s39 offen offset:1024 sc1 lds
v_add_u32 v42, 110592, v40
s_bitcmp1_b32 s27, 0
s_cbranch_scc1 L_kh_31
v_swap_b32 v206, v210
v_swap_b32 v207, v211
v_swap_b32 v208, v212
v_swap_b32 v209, v213
v_swap_b32 v214, v218
v_swap_b32 v215, v219
v_swap_b32 v216, v220
v_swap_b32 v217, v221
v_swap_b32 v222, v226
v_swap_b32 v223, v227
v_swap_b32 v224, v228
v_swap_b32 v225, v229
v_swap_b32 v230, v234
v_swap_b32 v231, v235
v_swap_b32 v232, v236
v_swap_b32 v233, v237
L_kh_31:
v_mov_b32 v138, 1073741824
s_mul_i32 s66, s70, 18432
s_mul_i32 s32, s28, 2304
s_add_u32 s66, s66, s32
s_add_u32 s66, s66, 30834688
v_mov_b32 v140, v1
v_add_u32 v141, 2048, v140
v_cndmask_b32 v141, v138, v141, s[46:47]
s_lshl_b32 s67, s70, 7
s_lshl_b32 s32, s28, 14
s_mov_b64 exec, 1
buffer_atomic_add v246, v6, s[8:11], s35 offen sc0 sc1
s_mov_b64 exec, -1
buffer_load_dwordx4 v1, s[4:7], s39 offen offset:2048 sc1 lds
buffer_load_dwordx4 v1, s[4:7], s39 offen offset:3072 sc1 lds
s_add_u32 m0, m0, 4096
s_add_u32 s39, s39, 4096
buffer_load_dwordx4 v1, s[4:7], s39 offen offset:0 sc1 lds
s_add_u32 s67, s67, s32
s_add_u32 s67, s67, 33193984
v_lshlrev_b32 v139, 3, v2
v_cndmask_b32 v138, v138, v139, s[46:47]
v_mov_b32 v162, 1073741824
s_mul_i32 s68, s70, 18432
s_mul_i32 s32, s28, 144
s_add_u32 s68, s68, s32
v_mul_u32_u24 v164, 1152, v2
v_lshl_add_u32 v164, v3, 4, v164
v_add_u32 v165, 128, v164
v_cndmask_b32 v165, v162, v165, s[46:47]
ds_read_b128 a[160:163], v36 offset:0
ds_read_b128 a[164:167], v36 offset:1024
ds_read_b128 a[168:171], v36 offset:2048
ds_read_b128 a[172:175], v36 offset:3072
ds_read_b128 a[176:179], v40 offset:0
ds_read_b128 a[180:183], v36 offset:4608
ds_read_b128 a[184:187], v36 offset:5632
ds_read_b128 a[188:191], v36 offset:6656
ds_read_b128 a[192:195], v36 offset:7680
ds_read_b128 a[196:199], v40 offset:4608
s_cmp_eq_u32 s71, 0
s_cselect_b32 s98, 4096, 0
s_add_u32 s60, s60, s98
s_cmp_eq_u32 s24, 1
s_cbranch_scc0 L_other_34
s_mov_b32 s31, 0
s_mov_b64 exec, 1
v_mov_b32 v247, 0
buffer_atomic_add v247, v6, s[8:11], s35 offen sc0 sc1
s_waitcnt vmcnt(14)
v_cmp_gt_u32 vcc, 8, v244
s_nop 0
s_cbranch_vccz L_polled_33
s_waitcnt vmcnt(9)
v_cmp_gt_u32 vcc, 8, v245
s_nop 0
s_cbranch_vccz L_polled_33
v_mov_b32 v244, 0
buffer_atomic_add v244, v6, s[8:11], s35 offen sc0 sc1
s_waitcnt vmcnt(5)
v_cmp_gt_u32 vcc, 8, v246
s_nop 0
s_cbranch_vccz L_polled_33
v_mov_b32 v245, 0
buffer_atomic_add v245, v6, s[8:11], s35 offen sc0 sc1
L_poll_32:
s_add_u32 s31, s31, 1
s_cmp_gt_u32 s31, 100000
s_cbranch_scc1 L_polled_33
v_mov_b32 v246, 0
buffer_atomic_add v246, v6, s[8:11], s35 offen sc0 sc1
s_waitcnt vmcnt(3)
v_cmp_gt_u32 vcc, 8, v247
s_nop 0
s_cbranch_vccz L_polled_33
v_mov_b32 v247, 0
buffer_atomic_add v247, v6, s[8:11], s35 offen sc0 sc1
s_waitcnt vmcnt(3)
v_cmp_gt_u32 vcc, 8, v244
s_nop 0
s_cbranch_vccz L_polled_33
v_mov_b32 v244, 0
buffer_atomic_add v244, v6, s[8:11], s35 offen sc0 sc1
s_waitcnt vmcnt(3)
v_cmp_gt_u32 vcc, 8, v245
s_nop 0
s_cbranch_vccz L_polled_33
v_mov_b32 v245, 0
buffer_atomic_add v245, v6, s[8:11], s35 offen sc0 sc1
s_waitcnt vmcnt(3)
v_cmp_gt_u32 vcc, 8, v246
s_nop 0
s_cbranch_vccz L_polled_33
s_branch L_poll_32
L_polled_33:
s_mov_b64 exec, -1
L_other_34:
s_barrier
buffer_load_dwordx4 a[0:3], v1, s[8:11], s60 offen offset:0 sc1
buffer_load_dwordx4 a[4:7], v1, s[8:11], s60 offen offset:1024 sc1
s_waitcnt lgkmcnt(5)
v_mfma_f32_16x16x32_bf16 v[44:47], a[160:163], v[206:209], 0
ds_read_b128 a[200:203], v36 offset:9216
buffer_load_dwordx4 a[8:11], v1, s[8:11], s60 offen offset:2048 sc1
v_mfma_f32_16x16x32_bf16 v[16:19], a[160:163], v[210:213], v[16:19]
v_mfma_f32_16x16x32_bf16 v[48:51], a[164:167], v[206:209], 0
ds_read_b128 a[204:207], v36 offset:10240
buffer_load_dwordx4 a[12:15], v1, s[8:11], s60 offen offset:3072 sc1
v_mfma_f32_16x16x32_bf16 v[20:23], a[164:167], v[210:213], v[20:23]
s_add_u32 s60, s60, 4096
v_mfma_f32_16x16x32_bf16 v[52:55], a[168:171], v[206:209], 0
ds_read_b128 a[208:211], v36 offset:11264
v_mfma_f32_16x16x32_bf16 v[24:27], a[168:171], v[210:213], v[24:27]
v_mfma_f32_16x16x32_bf16 v[56:59], a[172:175], v[206:209], 0
ds_read_b128 a[212:215], v36 offset:12288
buffer_load_dwordx4 a[16:19], v1, s[8:11], s60 offen offset:0 sc1
v_mfma_f32_16x16x32_bf16 v[28:31], a[172:175], v[210:213], v[28:31]
s_cmp_eq_u32 s71, 5
s_cselect_b32 s98, 4096, 0
v_mfma_f32_16x16x32_bf16 v[60:63], a[176:179], v[206:209], 0
ds_read_b128 a[216:219], v40 offset:9216
v_mfma_f32_16x16x32_bf16 v[32:35], a[176:179], v[210:213], v[32:35]
s_add_u32 s60, s60, s98
s_waitcnt lgkmcnt(5)
v_mfma_f32_16x16x32_bf16 v[44:47], a[180:183], v[214:217], v[44:47]
ds_read_b128 a[160:163], v36 offset:13824
v_mov_b32 v67, v248
v_mfma_f32_16x16x32_bf16 v[16:19], a[180:183], v[218:221], v[16:19]
v_mfma_f32_16x16x32_bf16 v[48:51], a[184:187], v[214:217], v[48:51]
ds_read_b128 a[164:167], v36 offset:14848
v_mfma_f32_16x16x32_bf16 v[20:23], a[184:187], v[218:221], v[20:23]
v_mfma_f32_16x16x32_bf16 v[52:55], a[188:191], v[214:217], v[52:55]
ds_read_b128 a[168:171], v36 offset:15872
v_mfma_f32_16x16x32_bf16 v[24:27], a[188:191], v[218:221], v[24:27]
buffer_load_dwordx4 a[20:23], v1, s[8:11], s60 offen offset:1024 sc1
v_mfma_f32_16x16x32_bf16 v[56:59], a[192:195], v[214:217], v[56:59]
ds_read_b128 a[172:175], v36 offset:16896
v_mfma_f32_16x16x32_bf16 v[28:31], a[192:195], v[218:221], v[28:31]
buffer_load_dwordx4 a[24:27], v1, s[8:11], s60 offen offset:2048 sc1
v_mov_b32 v71, v248
v_mfma_f32_16x16x32_bf16 v[60:63], a[196:199], v[214:217], v[60:63]
ds_read_b128 a[176:179], v40 offset:13824
v_mfma_f32_16x16x32_bf16 v[32:35], a[196:199], v[218:221], v[32:35]
buffer_load_dwordx4 a[28:31], v1, s[8:11], s60 offen offset:3072 sc1
s_waitcnt lgkmcnt(5)
v_mfma_f32_16x16x32_bf16 v[44:47], a[200:203], v[222:225], v[44:47]
ds_read_b128 a[180:183], v36 offset:18432
v_mfma_f32_16x16x32_bf16 v[16:19], a[200:203], v[226:229], v[16:19]
s_add_u32 s60, s60, 4096
v_mfma_f32_16x16x32_bf16 v[48:51], a[204:207], v[222:225], v[48:51]
ds_read_b128 a[184:187], v36 offset:19456
v_mfma_f32_16x16x32_bf16 v[20:23], a[204:207], v[226:229], v[20:23]
v_mfma_f32_16x16x32_bf16 v[52:55], a[208:211], v[222:225], v[52:55]
ds_read_b128 a[188:191], v36 offset:20480
buffer_load_dwordx4 a[32:35], v1, s[8:11], s60 offen offset:0 sc1
v_mfma_f32_16x16x32_bf16 v[24:27], a[208:211], v[226:229], v[24:27]
s_cmp_eq_u32 s71, 9
s_cselect_b32 s98, 4096, 0
v_mov_b32 v75, v248
v_mfma_f32_16x16x32_bf16 v[56:59], a[212:215], v[222:225], v[56:59]
ds_read_b128 a[192:195], v36 offset:21504
v_mfma_f32_16x16x32_bf16 v[28:31], a[212:215], v[226:229], v[28:31]
s_add_u32 s60, s60, s98
v_mfma_f32_16x16x32_bf16 v[60:63], a[216:219], v[222:225], v[60:63]
ds_read_b128 a[196:199], v40 offset:18432
v_mfma_f32_16x16x32_bf16 v[32:35], a[216:219], v[226:229], v[32:35]
s_waitcnt lgkmcnt(5)
v_mfma_f32_16x16x32_bf16 v[44:47], a[160:163], v[230:233], v[44:47]
ds_read_b128 a[200:203], v36 offset:23040
v_mfma_f32_16x16x32_bf16 v[16:19], a[160:163], v[234:237], v[16:19]
v_mfma_f32_16x16x32_bf16 v[48:51], a[164:167], v[230:233], v[48:51]
ds_read_b128 a[204:207], v36 offset:24064
buffer_load_dwordx4 a[36:39], v1, s[8:11], s60 offen offset:1024 sc1
v_mfma_f32_16x16x32_bf16 v[20:23], a[164:167], v[234:237], v[20:23]
v_mov_b32 v79, v248
v_mfma_f32_16x16x32_bf16 v[52:55], a[168:171], v[230:233], v[52:55]
ds_read_b128 a[208:211], v36 offset:25088
v_mfma_f32_16x16x32_bf16 v[24:27], a[168:171], v[234:237], v[24:27]
v_mfma_f32_16x16x32_bf16 v[56:59], a[172:175], v[230:233], v[56:59]
ds_read_b128 a[212:215], v36 offset:26112
v_mfma_f32_16x16x32_bf16 v[28:31], a[172:175], v[234:237], v[28:31]
v_mfma_f32_16x16x32_bf16 v[60:63], a[176:179], v[230:233], v[60:63]
ds_read_b128 a[216:219], v40 offset:23040
v_mfma_f32_16x16x32_bf16 v[32:35], a[176:179], v[234:237], v[32:35]
s_waitcnt vmcnt(9) lgkmcnt(5)
v_mfma_f32_16x16x32_bf16 v[44:47], a[180:183], a[0:3], v[44:47]
ds_read_b128 a[160:163], v36 offset:27648
buffer_load_dwordx4 a[40:43], v1, s[8:11], s60 offen offset:2048 sc1
v_mfma_f32_16x16x32_bf16 v[48:51], a[184:187], a[0:3], v[48:51]
ds_read_b128 a[164:167], v36 offset:28672
v_mfma_f32_16x16x32_bf16 v[52:55], a[188:191], a[0:3], v[52:55]
ds_read_b128 a[168:171], v36 offset:29696
v_mfma_f32_16x16x32_bf16 v[56:59], a[192:195], a[0:3], v[56:59]
ds_read_b128 a[172:175], v36 offset:30720
v_mfma_f32_16x16x32_bf16 v[60:63], a[196:199], a[0:3], v[60:63]
ds_read_b128 a[176:179], v40 offset:27648
s_waitcnt vmcnt(9) lgkmcnt(5)
v_mfma_f32_16x16x32_bf16 v[44:47], a[200:203], a[4:7], v[44:47]
ds_read_b128 a[180:183], v36 offset:32256
buffer_load_dwordx4 a[44:47], v1, s[8:11], s60 offen offset:3072 sc1
v_mfma_f32_16x16x32_bf16 v[48:51], a[204:207], a[4:7], v[48:51]
ds_read_b128 a[184:187], v36 offset:33280
v_mfma_f32_16x16x32_bf16 v[52:55], a[208:211], a[4:7], v[52:55]
ds_read_b128 a[188:191], v36 offset:34304
v_mfma_f32_16x16x32_bf16 v[56:59], a[212:215], a[4:7], v[56:59]
ds_read_b128 a[192:195], v36 offset:35328
v_mfma_f32_16x16x32_bf16 v[60:63], a[216:219], a[4:7], v[60:63]
ds_read_b128 a[196:199], v40 offset:32256
s_waitcnt vmcnt(9) lgkmcnt(5)
v_mfma_f32_16x16x32_bf16 v[44:47], a[160:163], a[8:11], v[44:47]
ds_read_b128 a[200:203], v36 offset:36864
s_add_u32 s60, s60, 4096
v_mfma_f32_16x16x32_bf16 v[48:51], a[164:167], a[8:11], v[48:51]
ds_read_b128 a[204:207], v36 offset:37888
buffer_load_dwordx4 a[48:51], v1, s[8:11], s60 offen offset:0 sc1
v_mfma_f32_16x16x32_bf16 v[52:55], a[168:171], a[8:11], v[52:55]
ds_read_b128 a[208:211], v36 offset:38912
buffer_load_dwordx4 a[52:55], v1, s[8:11], s60 offen offset:1024 sc1
v_mfma_f32_16x16x32_bf16 v[56:59], a[172:175], a[8:11], v[56:59]
ds_read_b128 a[212:215], v36 offset:39936
v_mfma_f32_16x16x32_bf16 v[60:63], a[176:179], a[8:11], v[60:63]
ds_read_b128 a[216:219], v40 offset:36864
s_waitcnt vmcnt(10) lgkmcnt(5)
v_mfma_f32_16x16x32_bf16 v[44:47], a[180:183], a[12:15], v[44:47]
ds_read_b128 a[160:163], v36 offset:41472
v_mfma_f32_16x16x32_bf16 v[48:51], a[184:187], a[12:15], v[48:51]
ds_read_b128 a[164:167], v36 offset:42496
v_mfma_f32_16x16x32_bf16 v[52:55], a[188:191], a[12:15], v[52:55]
ds_read_b128 a[168:171], v36 offset:43520
v_mfma_f32_16x16x32_bf16 v[56:59], a[192:195], a[12:15], v[56:59]
ds_read_b128 a[172:175], v36 offset:44544
s_cmp_eq_u32 s71, 14
s_cselect_b32 s98, 4096, 0
s_add_u32 s60, s60, s98
buffer_load_dwordx4 a[56:59], v1, s[8:11], s60 offen offset:2048 sc1
v_mfma_f32_16x16x32_bf16 v[60:63], a[196:199], a[12:15], v[60:63]
ds_read_b128 a[176:179], v40 offset:41472
s_waitcnt vmcnt(10) lgkmcnt(5)
v_mfma_f32_16x16x32_bf16 v[44:47], a[200:203], a[16:19], v[44:47]
ds_read_b128 a[180:183], v36 offset:46080
buffer_load_dwordx4 a[60:63], v1, s[8:11], s60 offen offset:3072 sc1
v_mfma_f32_16x16x32_bf16 v[48:51], a[204:207], a[16:19], v[48:51]
ds_read_b128 a[184:187], v36 offset:47104
v_mfma_f32_16x16x32_bf16 v[52:55], a[208:211], a[16:19], v[52:55]
ds_read_b128 a[188:191], v36 offset:48128
v_mfma_f32_16x16x32_bf16 v[56:59], a[212:215], a[16:19], v[56:59]
ds_read_b128 a[192:195], v36 offset:49152
v_mfma_f32_16x16x32_bf16 v[60:63], a[216:219], a[16:19], v[60:63]
ds_read_b128 a[196:199], v40 offset:46080
s_barrier
s_waitcnt vmcnt(10) lgkmcnt(5)
v_mfma_f32_16x16x32_bf16 v[44:47], a[160:163], a[20:23], v[44:47]
ds_read_b128 a[200:203], v36 offset:50688
s_add_u32 s60, s60, 4096
v_mfma_f32_16x16x32_bf16 v[48:51], a[164:167], a[20:23], v[48:51]
ds_read_b128 a[204:207], v36 offset:51712
buffer_load_dwordx4 a[64:67], v1, s[8:11], s60 offen offset:0 sc1
v_mfma_f32_16x16x32_bf16 v[52:55], a[168:171], a[20:23], v[52:55]
ds_read_b128 a[208:211], v36 offset:52736
buffer_load_dwordx4 a[0:3], v1, s[8:11], s60 offen offset:1024 sc1
v_mfma_f32_16x16x32_bf16 v[56:59], a[172:175], a[20:23], v[56:59]
ds_read_b128 a[212:215], v36 offset:53760
v_mfma_f32_16x16x32_bf16 v[60:63], a[176:179], a[20:23], v[60:63]
ds_read_b128 a[216:219], v40 offset:50688
s_waitcnt vmcnt(11) lgkmcnt(5)
v_mfma_f32_16x16x32_bf16 v[44:47], a[180:183], a[24:27], v[44:47]
ds_read_b128 a[160:163], v37 offset:0
v_mfma_f32_16x16x32_bf16 v[48:51], a[184:187], a[24:27], v[48:51]
ds_read_b128 a[164:167], v37 offset:1024
v_mfma_f32_16x16x32_bf16 v[52:55], a[188:191], a[24:27], v[52:55]
ds_read_b128 a[168:171], v37 offset:2048
v_mfma_f32_16x16x32_bf16 v[56:59], a[192:195], a[24:27], v[56:59]
ds_read_b128 a[172:175], v37 offset:3072
s_cmp_eq_u32 s71, 18
s_cselect_b32 s98, 4096, 0
s_add_u32 s60, s60, s98
buffer_load_dwordx4 a[4:7], v1, s[8:11], s60 offen offset:2048 sc1
v_mfma_f32_16x16x32_bf16 v[60:63], a[196:199], a[24:27], v[60:63]
ds_read_b128 a[176:179], v41 offset:0
s_waitcnt vmcnt(11) lgkmcnt(5)
v_mfma_f32_16x16x32_bf16 v[44:47], a[200:203], a[28:31], v[44:47]
ds_read_b128 a[180:183], v37 offset:4608
buffer_load_dwordx4 a[8:11], v1, s[8:11], s60 offen offset:3072 sc1
v_mfma_f32_16x16x32_bf16 v[48:51], a[204:207], a[28:31], v[48:51]
ds_read_b128 a[184:187], v37 offset:5632
v_mfma_f32_16x16x32_bf16 v[52:55], a[208:211], a[28:31], v[52:55]
ds_read_b128 a[188:191], v37 offset:6656
v_mfma_f32_16x16x32_bf16 v[56:59], a[212:215], a[28:31], v[56:59]
ds_read_b128 a[192:195], v37 offset:7680
v_mfma_f32_16x16x32_bf16 v[60:63], a[216:219], a[28:31], v[60:63]
ds_read_b128 a[196:199], v41 offset:4608
s_waitcnt vmcnt(11) lgkmcnt(5)
v_mfma_f32_16x16x32_bf16 v[44:47], a[160:163], a[32:35], v[44:47]
ds_read_b128 a[200:203], v37 offset:9216
s_add_u32 s60, s60, 4096
v_mfma_f32_16x16x32_bf16 v[48:51], a[164:167], a[32:35], v[48:51]
ds_read_b128 a[204:207], v37 offset:10240
buffer_load_dwordx4 a[12:15], v1, s[8:11], s60 offen offset:0 sc1
v_mfma_f32_16x16x32_bf16 v[52:55], a[168:171], a[32:35], v[52:55]
ds_read_b128 a[208:211], v37 offset:11264
buffer_load_dwordx4 a[16:19], v1, s[8:11], s60 offen offset:1024 sc1
v_mfma_f32_16x16x32_bf16 v[56:59], a[172:175], a[32:35], v[56:59]
ds_read_b128 a[212:215], v37 offset:12288
v_mfma_f32_16x16x32_bf16 v[60:63], a[176:179], a[32:35], v[60:63]
ds_read_b128 a[216:219], v41 offset:9216
s_waitcnt vmcnt(12) lgkmcnt(5)
v_mfma_f32_16x16x32_bf16 v[44:47], a[180:183], a[36:39], v[44:47]
ds_read_b128 a[160:163], v37 offset:13824
buffer_load_dwordx4 a[20:23], v1, s[8:11], s60 offen offset:2048 sc1
v_mfma_f32_16x16x32_bf16 v[48:51], a[184:187], a[36:39], v[48:51]
ds_read_b128 a[164:167], v37 offset:14848
v_mfma_f32_16x16x32_bf16 v[52:55], a[188:191], a[36:39], v[52:55]
ds_read_b128 a[168:171], v37 offset:15872
v_mfma_f32_16x16x32_bf16 v[56:59], a[192:195], a[36:39], v[56:59]
ds_read_b128 a[172:175], v37 offset:16896
v_mfma_f32_16x16x32_bf16 v[60:63], a[196:199], a[36:39], v[60:63]
ds_read_b128 a[176:179], v41 offset:13824
s_waitcnt vmcnt(12) lgkmcnt(5)
v_mfma_f32_16x16x32_bf16 v[44:47], a[200:203], a[40:43], v[44:47]
ds_read_b128 a[180:183], v37 offset:18432
buffer_load_dwordx4 a[228:231], v1, s[4:7], s64 offen offset:2048 sc1
v_mfma_f32_16x16x32_bf16 v[48:51], a[204:207], a[40:43], v[48:51]
ds_read_b128 a[184:187], v37 offset:19456
v_mfma_f32_16x16x32_bf16 v[52:55], a[208:211], a[40:43], v[52:55]
ds_read_b128 a[188:191], v37 offset:20480
v_mfma_f32_16x16x32_bf16 v[56:59], a[212:215], a[40:43], v[56:59]
ds_read_b128 a[192:195], v37 offset:21504
s_cmp_eq_u32 s71, 23
s_cselect_b32 s98, 4096, 0
s_add_u32 s60, s60, s98
buffer_load_dwordx4 a[24:27], v1, s[8:11], s60 offen offset:3072 sc1
v_mfma_f32_16x16x32_bf16 v[60:63], a[216:219], a[40:43], v[60:63]
ds_read_b128 a[196:199], v41 offset:18432
s_waitcnt vmcnt(13) lgkmcnt(5)
v_mfma_f32_16x16x32_bf16 v[44:47], a[160:163], a[44:47], v[44:47]
ds_read_b128 a[200:203], v37 offset:23040
s_add_u32 s60, s60, 4096
v_mfma_f32_16x16x32_bf16 v[48:51], a[164:167], a[44:47], v[48:51]
ds_read_b128 a[204:207], v37 offset:24064
buffer_load_dwordx4 a[28:31], v1, s[8:11], s60 offen offset:0 sc1
v_mfma_f32_16x16x32_bf16 v[52:55], a[168:171], a[44:47], v[52:55]
ds_read_b128 a[208:211], v37 offset:25088
buffer_load_dwordx4 a[32:35], v1, s[8:11], s60 offen offset:1024 sc1
v_mfma_f32_16x16x32_bf16 v[56:59], a[172:175], a[44:47], v[56:59]
ds_read_b128 a[212:215], v37 offset:26112
v_mfma_f32_16x16x32_bf16 v[60:63], a[176:179], a[44:47], v[60:63]
ds_read_b128 a[216:219], v41 offset:23040
s_waitcnt vmcnt(14) lgkmcnt(5)
v_mfma_f32_16x16x32_bf16 v[44:47], a[180:183], a[48:51], v[44:47]
ds_read_b128 a[160:163], v37 offset:27648
buffer_load_dwordx4 a[36:39], v1, s[8:11], s60 offen offset:2048 sc1
v_mfma_f32_16x16x32_bf16 v[48:51], a[184:187], a[48:51], v[48:51]
ds_read_b128 a[164:167], v37 offset:28672
v_mfma_f32_16x16x32_bf16 v[52:55], a[188:191], a[48:51], v[52:55]
ds_read_b128 a[168:171], v37 offset:29696
v_mfma_f32_16x16x32_bf16 v[56:59], a[192:195], a[48:51], v[56:59]
ds_read_b128 a[172:175], v37 offset:30720
buffer_load_dwordx4 a[232:235], v1, s[4:7], s64 offen offset:3072 sc1
v_mfma_f32_16x16x32_bf16 v[60:63], a[196:199], a[48:51], v[60:63]
ds_read_b128 a[176:179], v41 offset:27648
s_waitcnt vmcnt(15) lgkmcnt(5)
v_mfma_f32_16x16x32_bf16 v[44:47], a[200:203], a[52:55], v[44:47]
ds_read_b128 a[180:183], v37 offset:32256
v_mfma_f32_16x16x32_bf16 v[48:51], a[204:207], a[52:55], v[48:51]
ds_read_b128 a[184:187], v37 offset:33280
v_mfma_f32_16x16x32_bf16 v[52:55], a[208:211], a[52:55], v[52:55]
ds_read_b128 a[188:191], v37 offset:34304
v_mfma_f32_16x16x32_bf16 v[56:59], a[212:215], a[52:55], v[56:59]
ds_read_b128 a[192:195], v37 offset:35328
s_cmp_eq_u32 s71, 27
s_cselect_b32 s98, 4096, 0
s_add_u32 s60, s60, s98
buffer_load_dwordx4 a[40:43], v1, s[8:11], s60 offen offset:3072 sc1
v_mfma_f32_16x16x32_bf16 v[60:63], a[216:219], a[52:55], v[60:63]
ds_read_b128 a[196:199], v41 offset:32256
s_waitcnt vmcnt(15) lgkmcnt(5)
v_mfma_f32_16x16x32_bf16 v[44:47], a[160:163], a[56:59], v[44:47]
ds_read_b128 a[200:203], v37 offset:36864
s_add_u32 s60, s60, 4096
v_mfma_f32_16x16x32_bf16 v[48:51], a[164:167], a[56:59], v[48:51]
ds_read_b128 a[204:207], v37 offset:37888
buffer_load_dwordx4 a[44:47], v1, s[8:11], s60 offen offset:0 sc1
v_mfma_f32_16x16x32_bf16 v[52:55], a[168:171], a[56:59], v[52:55]
ds_read_b128 a[208:211], v37 offset:38912
buffer_load_dwordx4 a[48:51], v1, s[8:11], s60 offen offset:1024 sc1
v_mfma_f32_16x16x32_bf16 v[56:59], a[172:175], a[56:59], v[56:59]
ds_read_b128 a[212:215], v37 offset:39936
v_mfma_f32_16x16x32_bf16 v[60:63], a[176:179], a[56:59], v[60:63]
ds_read_b128 a[216:219], v41 offset:36864
s_waitcnt vmcnt(16) lgkmcnt(5)
v_mfma_f32_16x16x32_bf16 v[44:47], a[180:183], a[60:63], v[44:47]
ds_read_b128 a[160:163], v37 offset:41472
buffer_load_dwordx4 a[52:55], v1, s[8:11], s60 offen offset:2048 sc1
v_mfma_f32_16x16x32_bf16 v[48:51], a[184:187], a[60:63], v[48:51]
ds_read_b128 a[164:167], v37 offset:42496
v_mfma_f32_16x16x32_bf16 v[52:55], a[188:191], a[60:63], v[52:55]
ds_read_b128 a[168:171], v37 offset:43520
buffer_load_dwordx4 a[236:239], v116, s[4:7], s64 offen sc1
v_mfma_f32_16x16x32_bf16 v[56:59], a[192:195], a[60:63], v[56:59]
ds_read_b128 a[172:175], v37 offset:44544
v_mfma_f32_16x16x32_bf16 v[60:63], a[196:199], a[60:63], v[60:63]
ds_read_b128 a[176:179], v41 offset:41472
s_waitcnt vmcnt(17) lgkmcnt(5)
v_mfma_f32_16x16x32_bf16 v[44:47], a[200:203], a[64:67], v[44:47]
ds_read_b128 a[180:183], v37 offset:46080
buffer_load_dwordx4 a[56:59], v1, s[8:11], s60 offen offset:3072 sc1
v_mfma_f32_16x16x32_bf16 v[48:51], a[204:207], a[64:67], v[48:51]
ds_read_b128 a[184:187], v37 offset:47104
v_mfma_f32_16x16x32_bf16 v[52:55], a[208:211], a[64:67], v[52:55]
ds_read_b128 a[188:191], v37 offset:48128
v_mfma_f32_16x16x32_bf16 v[56:59], a[212:215], a[64:67], v[56:59]
ds_read_b128 a[192:195], v37 offset:49152
v_mfma_f32_16x16x32_bf16 v[60:63], a[216:219], a[64:67], v[60:63]
ds_read_b128 a[196:199], v41 offset:46080
s_waitcnt vmcnt(17) lgkmcnt(5)
v_mfma_f32_16x16x32_bf16 v[44:47], a[160:163], a[0:3], v[44:47]
ds_read_b128 a[200:203], v37 offset:50688
s_mov_b32 s60, s61
v_mfma_f32_16x16x32_bf16 v[48:51], a[164:167], a[0:3], v[48:51]
ds_read_b128 a[204:207], v37 offset:51712
v_mfma_f32_16x16x32_bf16 v[52:55], a[168:171], a[0:3], v[52:55]
ds_read_b128 a[208:211], v37 offset:52736
v_mfma_f32_16x16x32_bf16 v[56:59], a[172:175], a[0:3], v[56:59]
ds_read_b128 a[212:215], v37 offset:53760
s_cmp_eq_u32 s71, 0
s_cselect_b32 s98, 4096, 0
s_add_u32 s60, s60, s98
buffer_load_dwordx4 a[60:63], v1, s[8:11], s60 offen offset:0 sc1
buffer_load_dwordx4 a[64:67], v1, s[8:11], s60 offen offset:1024 sc1
v_mfma_f32_16x16x32_bf16 v[60:63], a[176:179], a[0:3], v[60:63]
ds_read_b128 a[216:219], v41 offset:50688
s_waitcnt vmcnt(18) lgkmcnt(5)
v_mfma_f32_16x16x32_bf16 v[44:47], a[180:183], a[4:7], v[44:47]
ds_read_b128 a[160:163], v38 offset:0
buffer_load_dwordx4 a[0:3], v1, s[8:11], s60 offen offset:2048 sc1
v_mfma_f32_16x16x32_bf16 v[48:51], a[184:187], a[4:7], v[48:51]
ds_read_b128 a[164:167], v38 offset:1024
v_mfma_f32_16x16x32_bf16 v[52:55], a[188:191], a[4:7], v[52:55]
ds_read_b128 a[168:171], v38 offset:2048
v_mfma_f32_16x16x32_bf16 v[56:59], a[192:195], a[4:7], v[56:59]
ds_read_b128 a[172:175], v38 offset:3072
v_mfma_f32_16x16x32_bf16 v[60:63], a[196:199], a[4:7], v[60:63]
ds_read_b128 a[176:179], v42 offset:0
s_waitcnt vmcnt(18) lgkmcnt(5)
v_mfma_f32_16x16x32_bf16 v[44:47], a[200:203], a[8:11], v[44:47]
ds_read_b128 a[180:183], v38 offset:4608
buffer_load_dwordx4 a[4:7], v1, s[8:11], s60 offen offset:3072 sc1
v_mfma_f32_16x16x32_bf16 v[48:51], a[204:207], a[8:11], v[48:51]
ds_read_b128 a[184:187], v38 offset:5632
v_mfma_f32_16x16x32_bf16 v[52:55], a[208:211], a[8:11], v[52:55]
ds_read_b128 a[188:191], v38 offset:6656
v_mfma_f32_16x16x32_bf16 v[56:59], a[212:215], a[8:11], v[56:59]
ds_read_b128 a[192:195], v38 offset:7680
v_mfma_f32_16x16x32_bf16 v[60:63], a[216:219], a[8:11], v[60:63]
ds_read_b128 a[196:199], v42 offset:4608
s_waitcnt vmcnt(18) lgkmcnt(5)
v_mfma_f32_16x16x32_bf16 v[44:47], a[160:163], a[12:15], v[44:47]
ds_read_b128 a[200:203], v38 offset:9216
s_add_u32 s60, s60, 4096
v_mfma_f32_16x16x32_bf16 v[48:51], a[164:167], a[12:15], v[48:51]
ds_read_b128 a[204:207], v38 offset:10240
v_mfma_f32_16x16x32_bf16 v[52:55], a[168:171], a[12:15], v[52:55]
ds_read_b128 a[208:211], v38 offset:11264
buffer_load_dwordx4 a[8:11], v1, s[8:11], s60 offen offset:0 sc1
v_mfma_f32_16x16x32_bf16 v[56:59], a[172:175], a[12:15], v[56:59]
ds_read_b128 a[212:215], v38 offset:12288
v_mfma_f32_16x16x32_bf16 v[60:63], a[176:179], a[12:15], v[60:63]
ds_read_b128 a[216:219], v42 offset:9216
s_waitcnt vmcnt(18) lgkmcnt(5)
v_mfma_f32_16x16x32_bf16 v[44:47], a[180:183], a[16:19], v[44:47]
ds_read_b128 a[160:163], v38 offset:13824
v_mfma_f32_16x16x32_bf16 v[48:51], a[184:187], a[16:19], v[48:51]
ds_read_b128 a[164:167], v38 offset:14848
v_mfma_f32_16x16x32_bf16 v[52:55], a[188:191], a[16:19], v[52:55]
ds_read_b128 a[168:171], v38 offset:15872
v_mfma_f32_16x16x32_bf16 v[56:59], a[192:195], a[16:19], v[56:59]
ds_read_b128 a[172:175], v38 offset:16896
s_cmp_eq_u32 s71, 5
s_cselect_b32 s98, 4096, 0
s_add_u32 s60, s60, s98
buffer_load_dwordx4 a[12:15], v1, s[8:11], s60 offen offset:1024 sc1
v_mfma_f32_16x16x32_bf16 v[60:63], a[196:199], a[16:19], v[60:63]
ds_read_b128 a[176:179], v42 offset:13824
s_waitcnt vmcnt(18) lgkmcnt(5)
v_mfma_f32_16x16x32_bf16 v[44:47], a[200:203], a[20:23], v[44:47]
ds_read_b128 a[180:183], v38 offset:18432
buffer_load_dwordx4 a[16:19], v1, s[8:11], s60 offen offset:2048 sc1
v_mfma_f32_16x16x32_bf16 v[48:51], a[204:207], a[20:23], v[48:51]
ds_read_b128 a[184:187], v38 offset:19456
v_mfma_f32_16x16x32_bf16 v[52:55], a[208:211], a[20:23], v[52:55]
ds_read_b128 a[188:191], v38 offset:20480
v_mfma_f32_16x16x32_bf16 v[56:59], a[212:215], a[20:23], v[56:59]
ds_read_b128 a[192:195], v38 offset:21504
v_mfma_f32_16x16x32_bf16 v[60:63], a[216:219], a[20:23], v[60:63]
ds_read_b128 a[196:199], v42 offset:18432
s_waitcnt vmcnt(17) lgkmcnt(5)
v_mfma_f32_16x16x32_bf16 v[44:47], a[160:163], a[24:27], v[44:47]
ds_read_b128 a[200:203], v38 offset:23040
buffer_load_dwordx4 a[20:23], v1, s[8:11], s60 offen offset:3072 sc1
v_mfma_f32_16x16x32_bf16 v[48:51], a[164:167], a[24:27], v[48:51]
ds_read_b128 a[204:207], v38 offset:24064
v_mfma_f32_16x16x32_bf16 v[52:55], a[168:171], a[24:27], v[52:55]
ds_read_b128 a[208:211], v38 offset:25088
v_mfma_f32_16x16x32_bf16 v[56:59], a[172:175], a[24:27], v[56:59]
ds_read_b128 a[212:215], v38 offset:26112
v_mfma_f32_16x16x32_bf16 v[60:63], a[176:179], a[24:27], v[60:63]
ds_read_b128 a[216:219], v42 offset:23040
s_waitcnt vmcnt(17) lgkmcnt(5)
v_mfma_f32_16x16x32_bf16 v[44:47], a[180:183], a[28:31], v[44:47]
ds_read_b128 a[160:163], v38 offset:27648
s_add_u32 s60, s60, 4096
v_mfma_f32_16x16x32_bf16 v[48:51], a[184:187], a[28:31], v[48:51]
ds_read_b128 a[164:167], v38 offset:28672
v_mfma_f32_16x16x32_bf16 v[52:55], a[188:191], a[28:31], v[52:55]
ds_read_b128 a[168:171], v38 offset:29696
buffer_load_dwordx4 a[24:27], v1, s[8:11], s60 offen offset:0 sc1
v_mfma_f32_16x16x32_bf16 v[56:59], a[192:195], a[28:31], v[56:59]
ds_read_b128 a[172:175], v38 offset:30720
v_mfma_f32_16x16x32_bf16 v[60:63], a[196:199], a[28:31], v[60:63]
ds_read_b128 a[176:179], v42 offset:27648
s_waitcnt vmcnt(17) lgkmcnt(5)
v_mfma_f32_16x16x32_bf16 v[44:47], a[200:203], a[32:35], v[44:47]
ds_read_b128 a[180:183], v38 offset:32256
v_mfma_f32_16x16x32_bf16 v[48:51], a[204:207], a[32:35], v[48:51]
ds_read_b128 a[184:187], v38 offset:33280
v_mfma_f32_16x16x32_bf16 v[52:55], a[208:211], a[32:35], v[52:55]
ds_read_b128 a[188:191], v38 offset:34304
v_mfma_f32_16x16x32_bf16 v[56:59], a[212:215], a[32:35], v[56:59]
ds_read_b128 a[192:195], v38 offset:35328
s_cmp_eq_u32 s71, 9
s_cselect_b32 s98, 4096, 0
s_add_u32 s60, s60, s98
buffer_load_dwordx4 a[28:31], v1, s[8:11], s60 offen offset:1024 sc1
v_mfma_f32_16x16x32_bf16 v[60:63], a[216:219], a[32:35], v[60:63]
ds_read_b128 a[196:199], v42 offset:32256
s_waitcnt vmcnt(17) lgkmcnt(5)
v_mfma_f32_16x16x32_bf16 v[44:47], a[160:163], a[36:39], v[44:47]
ds_read_b128 a[200:203], v38 offset:36864
buffer_load_dwordx4 a[32:35], v1, s[8:11], s60 offen offset:2048 sc1
v_mfma_f32_16x16x32_bf16 v[48:51], a[164:167], a[36:39], v[48:51]
ds_read_b128 a[204:207], v38 offset:37888
v_mfma_f32_16x16x32_bf16 v[52:55], a[168:171], a[36:39], v[52:55]
ds_read_b128 a[208:211], v38 offset:38912
v_mfma_f32_16x16x32_bf16 v[56:59], a[172:175], a[36:39], v[56:59]
ds_read_b128 a[212:215], v38 offset:39936
v_mfma_f32_16x16x32_bf16 v[60:63], a[176:179], a[36:39], v[60:63]
ds_read_b128 a[216:219], v42 offset:36864
s_waitcnt vmcnt(16) lgkmcnt(5)
v_mfma_f32_16x16x32_bf16 v[44:47], a[180:183], a[40:43], v[44:47]
ds_read_b128 a[160:163], v38 offset:41472
buffer_load_dwordx4 a[36:39], v1, s[8:11], s60 offen offset:3072 sc1
v_mfma_f32_16x16x32_bf16 v[48:51], a[184:187], a[40:43], v[48:51]
ds_read_b128 a[164:167], v38 offset:42496
v_mfma_f32_16x16x32_bf16 v[52:55], a[188:191], a[40:43], v[52:55]
ds_read_b128 a[168:171], v38 offset:43520
v_mfma_f32_16x16x32_bf16 v[56:59], a[192:195], a[40:43], v[56:59]
ds_read_b128 a[172:175], v38 offset:44544
v_mfma_f32_16x16x32_bf16 v[60:63], a[196:199], a[40:43], v[60:63]
ds_read_b128 a[176:179], v42 offset:41472
s_waitcnt vmcnt(16) lgkmcnt(5)
v_mfma_f32_16x16x32_bf16 v[44:47], a[200:203], a[44:47], v[44:47]
ds_read_b128 a[180:183], v38 offset:46080
s_add_u32 s60, s60, 4096
v_mfma_f32_16x16x32_bf16 v[48:51], a[204:207], a[44:47], v[48:51]
ds_read_b128 a[184:187], v38 offset:47104
v_mfma_f32_16x16x32_bf16 v[52:55], a[208:211], a[44:47], v[52:55]
ds_read_b128 a[188:191], v38 offset:48128
buffer_load_dwordx4 a[40:43], v1, s[8:11], s60 offen offset:0 sc1
v_mfma_f32_16x16x32_bf16 v[56:59], a[212:215], a[44:47], v[56:59]
ds_read_b128 a[192:195], v38 offset:49152
v_mfma_f32_16x16x32_bf16 v[60:63], a[216:219], a[44:47], v[60:63]
ds_read_b128 a[196:199], v42 offset:46080
s_waitcnt vmcnt(16) lgkmcnt(5)
v_mfma_f32_16x16x32_bf16 v[44:47], a[160:163], a[48:51], v[44:47]
ds_read_b128 a[200:203], v38 offset:50688
buffer_load_dwordx4 a[44:47], v1, s[8:11], s60 offen offset:1024 sc1
v_mfma_f32_16x16x32_bf16 v[48:51], a[164:167], a[48:51], v[48:51]
ds_read_b128 a[204:207], v38 offset:51712
v_mfma_f32_16x16x32_bf16 v[52:55], a[168:171], a[48:51], v[52:55]
v_mfma_f32_16x16x32_bf16 v[56:59], a[172:175], a[48:51], v[56:59]
v_mfma_f32_16x16x32_bf16 v[60:63], a[176:179], a[48:51], v[60:63]
s_waitcnt vmcnt(16) lgkmcnt(2)
v_mfma_f32_16x16x32_bf16 v[44:47], a[180:183], a[52:55], v[44:47]
ds_read_b128 a[160:163], v36 offset:18432
v_mfma_f32_16x16x32_bf16 v[48:51], a[184:187], a[52:55], v[48:51]
ds_read_b128 a[164:167], v36 offset:19456
v_mfma_f32_16x16x32_bf16 v[52:55], a[188:191], a[52:55], v[52:55]
ds_read_b128 a[168:171], v36 offset:20480
v_mfma_f32_16x16x32_bf16 v[56:59], a[192:195], a[52:55], v[56:59]
ds_read_b128 a[172:175], v36 offset:21504
s_cmp_eq_u32 s71, 14
s_cselect_b32 s98, 4096, 0
s_add_u32 s60, s60, s98
buffer_load_dwordx4 a[48:51], v1, s[8:11], s60 offen offset:2048 sc1
v_mfma_f32_16x16x32_bf16 v[60:63], a[196:199], a[52:55], v[60:63]
ds_read_b128 a[176:179], v40 offset:18432
s_waitcnt vmcnt(15) lgkmcnt(5)
v_mfma_f32_16x16x32_bf16 v[44:47], a[200:203], a[56:59], v[44:47]
ds_read_b128 a[180:183], v36 offset:23040
buffer_load_dwordx4 a[52:55], v1, s[8:11], s60 offen offset:3072 sc1
v_mfma_f32_16x16x32_bf16 v[48:51], a[204:207], a[56:59], v[48:51]
ds_read_b128 a[184:187], v36 offset:24064
v_mfma_f32_16x16x32_bf16 v[52:55], a[228:231], a[56:59], v[52:55]
ds_read_b128 a[188:191], v36 offset:25088
v_mfma_f32_16x16x32_bf16 v[56:59], a[232:235], a[56:59], v[56:59]
ds_read_b128 a[192:195], v36 offset:26112
v_mfma_f32_16x16x32_bf16 v[60:63], a[236:239], a[56:59], v[60:63]
ds_read_b128 a[196:199], v40 offset:23040
s_waitcnt vmcnt(15) lgkmcnt(5)
v_mfma_f32_16x16x32_bf16 v[16:19], a[160:163], a[60:63], v[16:19]
ds_read_b128 a[200:203], v36 offset:27648
s_add_u32 s60, s60, 4096
v_mfma_f32_16x16x32_bf16 v[20:23], a[164:167], a[60:63], v[20:23]
ds_read_b128 a[204:207], v36 offset:28672
v_mfma_f32_16x16x32_bf16 v[24:27], a[168:171], a[60:63], v[24:27]
ds_read_b128 a[208:211], v36 offset:29696
buffer_load_dwordx4 a[56:59], v1, s[8:11], s60 offen offset:0 sc1
v_mfma_f32_16x16x32_bf16 v[28:31], a[172:175], a[60:63], v[28:31]
ds_read_b128 a[212:215], v36 offset:30720
v_mfma_f32_16x16x32_bf16 v[32:35], a[176:179], a[60:63], v[32:35]
ds_read_b128 a[216:219], v40 offset:27648
s_waitcnt vmcnt(15) lgkmcnt(5)
v_mfma_f32_16x16x32_bf16 v[16:19], a[180:183], a[64:67], v[16:19]
ds_read_b128 a[160:163], v36 offset:32256
buffer_load_dwordx4 a[60:63], v1, s[8:11], s60 offen offset:1024 sc1
v_mfma_f32_16x16x32_bf16 v[20:23], a[184:187], a[64:67], v[20:23]
ds_read_b128 a[164:167], v36 offset:33280
v_mfma_f32_16x16x32_bf16 v[24:27], a[188:191], a[64:67], v[24:27]
ds_read_b128 a[168:171], v36 offset:34304
v_mfma_f32_16x16x32_bf16 v[28:31], a[192:195], a[64:67], v[28:31]
ds_read_b128 a[172:175], v36 offset:35328
v_cvt_pk_bf16_f32 v64, v44, v45
v_mfma_f32_16x16x32_bf16 v[32:35], a[196:199], a[64:67], v[32:35]
ds_read_b128 a[176:179], v40 offset:32256
s_waitcnt vmcnt(15) lgkmcnt(5)
v_mfma_f32_16x16x32_bf16 v[16:19], a[200:203], a[0:3], v[16:19]
ds_read_b128 a[180:183], v36 offset:36864
v_cvt_pk_bf16_f32 v65, v46, v47
v_mfma_f32_16x16x32_bf16 v[20:23], a[204:207], a[0:3], v[20:23]
ds_read_b128 a[184:187], v36 offset:37888
v_mfma_f32_16x16x32_bf16 v[24:27], a[208:211], a[0:3], v[24:27]
ds_read_b128 a[188:191], v36 offset:38912
v_cvt_pk_bf16_f32 v66, v48, v49
v_mfma_f32_16x16x32_bf16 v[28:31], a[212:215], a[0:3], v[28:31]
ds_read_b128 a[192:195], v36 offset:39936
s_cmp_eq_u32 s71, 18
s_cselect_b32 s98, 4096, 0
s_add_u32 s60, s60, s98
buffer_load_dwordx4 a[64:67], v1, s[8:11], s60 offen offset:2048 sc1
v_mfma_f32_16x16x32_bf16 v[32:35], a[216:219], a[0:3], v[32:35]
ds_read_b128 a[196:199], v40 offset:36864
s_waitcnt vmcnt(15) lgkmcnt(5)
v_mfma_f32_16x16x32_bf16 v[16:19], a[160:163], a[4:7], v[16:19]
ds_read_b128 a[200:203], v36 offset:41472
buffer_load_dwordx4 a[0:3], v1, s[8:11], s60 offen offset:3072 sc1
v_mfma_f32_16x16x32_bf16 v[20:23], a[164:167], a[4:7], v[20:23]
ds_read_b128 a[204:207], v36 offset:42496
buffer_store_dwordx4 v[64:67], v1, s[8:11], s62 offen offset:0 sc1
v_mfma_f32_16x16x32_bf16 v[24:27], a[168:171], a[4:7], v[24:27]
ds_read_b128 a[208:211], v36 offset:43520
v_cvt_pk_bf16_f32 v68, v50, v51
v_mfma_f32_16x16x32_bf16 v[28:31], a[172:175], a[4:7], v[28:31]
ds_read_b128 a[212:215], v36 offset:44544
v_cvt_pk_bf16_f32 v69, v52, v53
v_mfma_f32_16x16x32_bf16 v[32:35], a[176:179], a[4:7], v[32:35]
ds_read_b128 a[216:219], v40 offset:41472
s_waitcnt vmcnt(16) lgkmcnt(5)
v_mfma_f32_16x16x32_bf16 v[16:19], a[180:183], a[8:11], v[16:19]
ds_read_b128 a[160:163], v36 offset:46080
s_add_u32 s60, s60, 4096
v_mfma_f32_16x16x32_bf16 v[20:23], a[184:187], a[8:11], v[20:23]
ds_read_b128 a[164:167], v36 offset:47104
v_cvt_pk_bf16_f32 v70, v54, v55
v_mfma_f32_16x16x32_bf16 v[24:27], a[188:191], a[8:11], v[24:27]
ds_read_b128 a[168:171], v36 offset:48128
buffer_load_dwordx4 a[4:7], v1, s[8:11], s60 offen offset:0 sc1
v_mfma_f32_16x16x32_bf16 v[28:31], a[192:195], a[8:11], v[28:31]
ds_read_b128 a[172:175], v36 offset:49152
buffer_store_dwordx4 v[68:71], v1, s[8:11], s62 offen offset:1024 sc1
v_mfma_f32_16x16x32_bf16 v[32:35], a[196:199], a[8:11], v[32:35]
ds_read_b128 a[176:179], v40 offset:46080
s_waitcnt vmcnt(17) lgkmcnt(5)
v_mfma_f32_16x16x32_bf16 v[16:19], a[200:203], a[12:15], v[16:19]
ds_read_b128 a[180:183], v36 offset:50688
buffer_load_dwordx4 a[8:11], v1, s[8:11], s60 offen offset:1024 sc1
v_mfma_f32_16x16x32_bf16 v[20:23], a[204:207], a[12:15], v[20:23]
ds_read_b128 a[184:187], v36 offset:51712
v_cvt_pk_bf16_f32 v72, v56, v57
v_mfma_f32_16x16x32_bf16 v[24:27], a[208:211], a[12:15], v[24:27]
ds_read_b128 a[188:191], v36 offset:52736
v_cvt_pk_bf16_f32 v73, v58, v59
v_mfma_f32_16x16x32_bf16 v[28:31], a[212:215], a[12:15], v[28:31]
ds_read_b128 a[192:195], v36 offset:53760
v_cvt_pk_bf16_f32 v74, v60, v61
v_mfma_f32_16x16x32_bf16 v[32:35], a[216:219], a[12:15], v[32:35]
ds_read_b128 a[196:199], v40 offset:50688
s_waitcnt vmcnt(17) lgkmcnt(5)
v_mfma_f32_16x16x32_bf16 v[16:19], a[160:163], a[16:19], v[16:19]
ds_read_b128 a[200:203], v37 offset:0
buffer_load_dwordx4 a[12:15], v1, s[8:11], s60 offen offset:2048 sc1
v_mfma_f32_16x16x32_bf16 v[20:23], a[164:167], a[16:19], v[20:23]
ds_read_b128 a[204:207], v37 offset:1024
buffer_store_dwordx4 v[72:75], v1, s[8:11], s62 offen offset:2048 sc1
v_mfma_f32_16x16x32_bf16 v[24:27], a[168:171], a[16:19], v[24:27]
ds_read_b128 a[208:211], v37 offset:2048
v_cvt_pk_bf16_f32 v76, v62, v63
v_mfma_f32_16x16x32_bf16 v[28:31], a[172:175], a[16:19], v[28:31]
ds_read_b128 a[212:215], v37 offset:3072
v_mfma_f32_16x16x32_bf16 v[32:35], a[176:179], a[16:19], v[32:35]
ds_read_b128 a[216:219], v41 offset:0
s_waitcnt vmcnt(18) lgkmcnt(5)
v_mfma_f32_16x16x32_bf16 v[16:19], a[180:183], a[20:23], v[16:19]
ds_read_b128 a[160:163], v37 offset:4608
buffer_store_dwordx4 v[76:79], v1, s[8:11], s62 offen offset:3072 sc1
v_mfma_f32_16x16x32_bf16 v[20:23], a[184:187], a[20:23], v[20:23]
ds_read_b128 a[164:167], v37 offset:5632
v_mfma_f32_16x16x32_bf16 v[24:27], a[188:191], a[20:23], v[24:27]
ds_read_b128 a[168:171], v37 offset:6656
v_mfma_f32_16x16x32_bf16 v[28:31], a[192:195], a[20:23], v[28:31]
ds_read_b128 a[172:175], v37 offset:7680
s_cmp_eq_u32 s71, 23
s_cselect_b32 s98, 4096, 0
s_add_u32 s60, s60, s98
buffer_load_dwordx4 a[16:19], v1, s[8:11], s60 offen offset:3072 sc1
v_mfma_f32_16x16x32_bf16 v[32:35], a[196:199], a[20:23], v[32:35]
ds_read_b128 a[176:179], v41 offset:4608
s_waitcnt vmcnt(19) lgkmcnt(5)
v_mfma_f32_16x16x32_bf16 v[16:19], a[200:203], a[24:27], v[16:19]
ds_read_b128 a[180:183], v37 offset:9216
s_add_u32 s60, s60, 4096
v_mfma_f32_16x16x32_bf16 v[20:23], a[204:207], a[24:27], v[20:23]
ds_read_b128 a[184:187], v37 offset:10240
v_mfma_f32_16x16x32_bf16 v[24:27], a[208:211], a[24:27], v[24:27]
ds_read_b128 a[188:191], v37 offset:11264
buffer_load_dwordx4 a[20:23], v1, s[8:11], s60 offen offset:0 sc1
v_mfma_f32_16x16x32_bf16 v[28:31], a[212:215], a[24:27], v[28:31]
ds_read_b128 a[192:195], v37 offset:12288
v_mfma_f32_16x16x32_bf16 v[32:35], a[216:219], a[24:27], v[32:35]
ds_read_b128 a[196:199], v41 offset:9216
s_waitcnt vmcnt(19) lgkmcnt(5)
v_mfma_f32_16x16x32_bf16 v[16:19], a[160:163], a[28:31], v[16:19]
ds_read_b128 a[200:203], v37 offset:13824
buffer_load_dwordx4 a[24:27], v1, s[8:11], s60 offen offset:1024 sc1
v_mfma_f32_16x16x32_bf16 v[20:23], a[164:167], a[28:31], v[20:23]
ds_read_b128 a[204:207], v37 offset:14848
v_mfma_f32_16x16x32_bf16 v[24:27], a[168:171], a[28:31], v[24:27]
ds_read_b128 a[208:211], v37 offset:15872
v_mfma_f32_16x16x32_bf16 v[28:31], a[172:175], a[28:31], v[28:31]
ds_read_b128 a[212:215], v37 offset:16896
v_mfma_f32_16x16x32_bf16 v[32:35], a[176:179], a[28:31], v[32:35]
ds_read_b128 a[216:219], v41 offset:13824
s_waitcnt vmcnt(19) lgkmcnt(5)
v_mfma_f32_16x16x32_bf16 v[16:19], a[180:183], a[32:35], v[16:19]
ds_read_b128 a[160:163], v37 offset:18432
buffer_load_dwordx4 a[28:31], v1, s[8:11], s60 offen offset:2048 sc1
v_mfma_f32_16x16x32_bf16 v[20:23], a[184:187], a[32:35], v[20:23]
ds_read_b128 a[164:167], v37 offset:19456
v_mfma_f32_16x16x32_bf16 v[24:27], a[188:191], a[32:35], v[24:27]
ds_read_b128 a[168:171], v37 offset:20480
v_mfma_f32_16x16x32_bf16 v[28:31], a[192:195], a[32:35], v[28:31]
ds_read_b128 a[172:175], v37 offset:21504
v_mfma_f32_16x16x32_bf16 v[32:35], a[196:199], a[32:35], v[32:35]
ds_read_b128 a[176:179], v41 offset:18432
s_waitcnt vmcnt(19) lgkmcnt(5)
v_mfma_f32_16x16x32_bf16 v[16:19], a[200:203], a[36:39], v[16:19]
ds_read_b128 a[180:183], v37 offset:23040
v_mfma_f32_16x16x32_bf16 v[20:23], a[204:207], a[36:39], v[20:23]
ds_read_b128 a[184:187], v37 offset:24064
v_mfma_f32_16x16x32_bf16 v[24:27], a[208:211], a[36:39], v[24:27]
ds_read_b128 a[188:191], v37 offset:25088
v_mfma_f32_16x16x32_bf16 v[28:31], a[212:215], a[36:39], v[28:31]
ds_read_b128 a[192:195], v37 offset:26112
s_cmp_eq_u32 s71, 27
s_cselect_b32 s98, 4096, 0
s_add_u32 s60, s60, s98
buffer_load_dwordx4 a[32:35], v1, s[8:11], s60 offen offset:3072 sc1
v_mfma_f32_16x16x32_bf16 v[32:35], a[216:219], a[36:39], v[32:35]
ds_read_b128 a[196:199], v41 offset:23040
s_waitcnt vmcnt(19) lgkmcnt(5)
v_mfma_f32_16x16x32_bf16 v[16:19], a[160:163], a[40:43], v[16:19]
ds_read_b128 a[200:203], v37 offset:27648
s_add_u32 s60, s60, 4096
v_mfma_f32_16x16x32_bf16 v[20:23], a[164:167], a[40:43], v[20:23]
ds_read_b128 a[204:207], v37 offset:28672
v_mfma_f32_16x16x32_bf16 v[24:27], a[168:171], a[40:43], v[24:27]
ds_read_b128 a[208:211], v37 offset:29696
buffer_load_dwordx4 a[36:39], v1, s[8:11], s60 offen offset:0 sc1
v_mfma_f32_16x16x32_bf16 v[28:31], a[172:175], a[40:43], v[28:31]
ds_read_b128 a[212:215], v37 offset:30720
v_mfma_f32_16x16x32_bf16 v[32:35], a[176:179], a[40:43], v[32:35]
ds_read_b128 a[216:219], v41 offset:27648
s_waitcnt vmcnt(19) lgkmcnt(5)
v_mfma_f32_16x16x32_bf16 v[16:19], a[180:183], a[44:47], v[16:19]
ds_read_b128 a[160:163], v37 offset:32256
buffer_load_dwordx4 a[40:43], v1, s[8:11], s60 offen offset:1024 sc1
v_mfma_f32_16x16x32_bf16 v[20:23], a[184:187], a[44:47], v[20:23]
ds_read_b128 a[164:167], v37 offset:33280
v_mfma_f32_16x16x32_bf16 v[24:27], a[188:191], a[44:47], v[24:27]
ds_read_b128 a[168:171], v37 offset:34304
v_mfma_f32_16x16x32_bf16 v[28:31], a[192:195], a[44:47], v[28:31]
ds_read_b128 a[172:175], v37 offset:35328
v_mfma_f32_16x16x32_bf16 v[32:35], a[196:199], a[44:47], v[32:35]
ds_read_b128 a[176:179], v41 offset:32256
s_waitcnt vmcnt(19) lgkmcnt(5)
v_mfma_f32_16x16x32_bf16 v[16:19], a[200:203], a[48:51], v[16:19]
ds_read_b128 a[180:183], v37 offset:36864
buffer_load_dwordx4 a[44:47], v1, s[8:11], s60 offen offset:2048 sc1
v_mfma_f32_16x16x32_bf16 v[20:23], a[204:207], a[48:51], v[20:23]
ds_read_b128 a[184:187], v37 offset:37888
v_mfma_f32_16x16x32_bf16 v[24:27], a[208:211], a[48:51], v[24:27]
ds_read_b128 a[188:191], v37 offset:38912
v_mfma_f32_16x16x32_bf16 v[28:31], a[212:215], a[48:51], v[28:31]
ds_read_b128 a[192:195], v37 offset:39936
v_mfma_f32_16x16x32_bf16 v[32:35], a[216:219], a[48:51], v[32:35]
ds_read_b128 a[196:199], v41 offset:36864
s_waitcnt vmcnt(19) lgkmcnt(5)
v_mfma_f32_16x16x32_bf16 v[16:19], a[160:163], a[52:55], v[16:19]
ds_read_b128 a[200:203], v37 offset:41472
buffer_load_dwordx4 a[48:51], v1, s[8:11], s60 offen offset:3072 sc1
v_mfma_f32_16x16x32_bf16 v[20:23], a[164:167], a[52:55], v[20:23]
ds_read_b128 a[204:207], v37 offset:42496
v_mfma_f32_16x16x32_bf16 v[24:27], a[168:171], a[52:55], v[24:27]
ds_read_b128 a[208:211], v37 offset:43520
v_mfma_f32_16x16x32_bf16 v[28:31], a[172:175], a[52:55], v[28:31]
ds_read_b128 a[212:215], v37 offset:44544
v_mfma_f32_16x16x32_bf16 v[32:35], a[176:179], a[52:55], v[32:35]
ds_read_b128 a[216:219], v41 offset:41472
s_waitcnt vmcnt(19) lgkmcnt(5)
v_mfma_f32_16x16x32_bf16 v[16:19], a[180:183], a[56:59], v[16:19]
ds_read_b128 a[160:163], v37 offset:46080
v_mfma_f32_16x16x32_bf16 v[20:23], a[184:187], a[56:59], v[20:23]
ds_read_b128 a[164:167], v37 offset:47104
v_mfma_f32_16x16x32_bf16 v[24:27], a[188:191], a[56:59], v[24:27]
ds_read_b128 a[168:171], v37 offset:48128
v_mfma_f32_16x16x32_bf16 v[28:31], a[192:195], a[56:59], v[28:31]
ds_read_b128 a[172:175], v37 offset:49152
v_mfma_f32_16x16x32_bf16 v[32:35], a[196:199], a[56:59], v[32:35]
ds_read_b128 a[176:179], v41 offset:46080
s_waitcnt vmcnt(18) lgkmcnt(5)
v_mfma_f32_16x16x32_bf16 v[16:19], a[200:203], a[60:63], v[16:19]
ds_read_b128 a[180:183], v37 offset:50688
v_mfma_f32_16x16x32_bf16 v[20:23], a[204:207], a[60:63], v[20:23]
ds_read_b128 a[184:187], v37 offset:51712
v_mfma_f32_16x16x32_bf16 v[24:27], a[208:211], a[60:63], v[24:27]
ds_read_b128 a[188:191], v37 offset:52736
v_mfma_f32_16x16x32_bf16 v[28:31], a[212:215], a[60:63], v[28:31]
ds_read_b128 a[192:195], v37 offset:53760
v_mfma_f32_16x16x32_bf16 v[32:35], a[216:219], a[60:63], v[32:35]
ds_read_b128 a[196:199], v41 offset:50688
s_waitcnt vmcnt(17) lgkmcnt(5)
v_mfma_f32_16x16x32_bf16 v[16:19], a[160:163], a[64:67], v[16:19]
ds_read_b128 a[200:203], v38 offset:0
buffer_load_dwordx4 v[80:83], v1, s[8:11], s63 offen offset:0 sc1
v_mfma_f32_16x16x32_bf16 v[20:23], a[164:167], a[64:67], v[20:23]
ds_read_b128 a[204:207], v38 offset:1024
v_mfma_f32_16x16x32_bf16 v[24:27], a[168:171], a[64:67], v[24:27]
ds_read_b128 a[208:211], v38 offset:2048
v_mfma_f32_16x16x32_bf16 v[28:31], a[172:175], a[64:67], v[28:31]
ds_read_b128 a[212:215], v38 offset:3072
v_mfma_f32_16x16x32_bf16 v[32:35], a[176:179], a[64:67], v[32:35]
ds_read_b128 a[216:219], v42 offset:0
s_waitcnt vmcnt(17) lgkmcnt(5)
v_mfma_f32_16x16x32_bf16 v[16:19], a[180:183], a[0:3], v[16:19]
ds_read_b128 a[160:163], v38 offset:4608
buffer_load_dwordx4 v[84:87], v1, s[8:11], s63 offen offset:1024 sc1
v_mfma_f32_16x16x32_bf16 v[20:23], a[184:187], a[0:3], v[20:23]
ds_read_b128 a[164:167], v38 offset:5632
v_mfma_f32_16x16x32_bf16 v[24:27], a[188:191], a[0:3], v[24:27]
ds_read_b128 a[168:171], v38 offset:6656
v_mfma_f32_16x16x32_bf16 v[28:31], a[192:195], a[0:3], v[28:31]
ds_read_b128 a[172:175], v38 offset:7680
v_mfma_f32_16x16x32_bf16 v[32:35], a[196:199], a[0:3], v[32:35]
ds_read_b128 a[176:179], v42 offset:4608
s_waitcnt vmcnt(16) lgkmcnt(5)
v_mfma_f32_16x16x32_bf16 v[16:19], a[200:203], a[4:7], v[16:19]
ds_read_b128 a[180:183], v38 offset:9216
buffer_load_dwordx4 v[88:91], v1, s[8:11], s63 offen offset:2048 sc1
v_mfma_f32_16x16x32_bf16 v[20:23], a[204:207], a[4:7], v[20:23]
ds_read_b128 a[184:187], v38 offset:10240
v_mfma_f32_16x16x32_bf16 v[24:27], a[208:211], a[4:7], v[24:27]
ds_read_b128 a[188:191], v38 offset:11264
v_mfma_f32_16x16x32_bf16 v[28:31], a[212:215], a[4:7], v[28:31]
ds_read_b128 a[192:195], v38 offset:12288
v_mfma_f32_16x16x32_bf16 v[32:35], a[216:219], a[4:7], v[32:35]
ds_read_b128 a[196:199], v42 offset:9216
s_waitcnt vmcnt(15) lgkmcnt(5)
v_mfma_f32_16x16x32_bf16 v[16:19], a[160:163], a[8:11], v[16:19]
ds_read_b128 a[200:203], v38 offset:13824
buffer_load_dwordx4 v[92:95], v1, s[8:11], s63 offen offset:3072 sc1
v_mfma_f32_16x16x32_bf16 v[20:23], a[164:167], a[8:11], v[20:23]
ds_read_b128 a[204:207], v38 offset:14848
v_mfma_f32_16x16x32_bf16 v[24:27], a[168:171], a[8:11], v[24:27]
ds_read_b128 a[208:211], v38 offset:15872
v_mfma_f32_16x16x32_bf16 v[28:31], a[172:175], a[8:11], v[28:31]
ds_read_b128 a[212:215], v38 offset:16896
v_mfma_f32_16x16x32_bf16 v[32:35], a[176:179], a[8:11], v[32:35]
ds_read_b128 a[216:219], v42 offset:13824
s_waitcnt vmcnt(15) lgkmcnt(5)
v_mfma_f32_16x16x32_bf16 v[16:19], a[180:183], a[12:15], v[16:19]
ds_read_b128 a[160:163], v38 offset:18432
v_mfma_f32_16x16x32_bf16 v[20:23], a[184:187], a[12:15], v[20:23]
ds_read_b128 a[164:167], v38 offset:19456
v_mfma_f32_16x16x32_bf16 v[24:27], a[188:191], a[12:15], v[24:27]
ds_read_b128 a[168:171], v38 offset:20480
v_mfma_f32_16x16x32_bf16 v[28:31], a[192:195], a[12:15], v[28:31]
ds_read_b128 a[172:175], v38 offset:21504
v_mfma_f32_16x16x32_bf16 v[32:35], a[196:199], a[12:15], v[32:35]
ds_read_b128 a[176:179], v42 offset:18432
s_waitcnt vmcnt(12) lgkmcnt(5)
v_mfma_f32_16x16x32_bf16 v[16:19], a[200:203], a[16:19], v[16:19]
ds_read_b128 a[180:183], v38 offset:23040
v_mfma_f32_16x16x32_bf16 v[20:23], a[204:207], a[16:19], v[20:23]
ds_read_b128 a[184:187], v38 offset:24064
v_mfma_f32_16x16x32_bf16 v[24:27], a[208:211], a[16:19], v[24:27]
ds_read_b128 a[188:191], v38 offset:25088
v_mfma_f32_16x16x32_bf16 v[28:31], a[212:215], a[16:19], v[28:31]
ds_read_b128 a[192:195], v38 offset:26112
v_mfma_f32_16x16x32_bf16 v[32:35], a[216:219], a[16:19], v[32:35]
ds_read_b128 a[196:199], v42 offset:23040
s_waitcnt vmcnt(11) lgkmcnt(5)
v_mfma_f32_16x16x32_bf16 v[16:19], a[160:163], a[20:23], v[16:19]
ds_read_b128 a[200:203], v38 offset:27648
v_mfma_f32_16x16x32_bf16 v[20:23], a[164:167], a[20:23], v[20:23]
ds_read_b128 a[204:207], v38 offset:28672
v_mfma_f32_16x16x32_bf16 v[24:27], a[168:171], a[20:23], v[24:27]
ds_read_b128 a[208:211], v38 offset:29696
v_mfma_f32_16x16x32_bf16 v[28:31], a[172:175], a[20:23], v[28:31]
ds_read_b128 a[212:215], v38 offset:30720
v_mfma_f32_16x16x32_bf16 v[32:35], a[176:179], a[20:23], v[32:35]
ds_read_b128 a[216:219], v42 offset:27648
s_waitcnt vmcnt(10) lgkmcnt(5)
v_mfma_f32_16x16x32_bf16 v[16:19], a[180:183], a[24:27], v[16:19]
ds_read_b128 a[160:163], v38 offset:32256
v_mfma_f32_16x16x32_bf16 v[20:23], a[184:187], a[24:27], v[20:23]
ds_read_b128 a[164:167], v38 offset:33280
v_mfma_f32_16x16x32_bf16 v[24:27], a[188:191], a[24:27], v[24:27]
ds_read_b128 a[168:171], v38 offset:34304
v_mfma_f32_16x16x32_bf16 v[28:31], a[192:195], a[24:27], v[28:31]
ds_read_b128 a[172:175], v38 offset:35328
v_mfma_f32_16x16x32_bf16 v[32:35], a[196:199], a[24:27], v[32:35]
ds_read_b128 a[176:179], v42 offset:32256
s_waitcnt vmcnt(9) lgkmcnt(5)
v_mfma_f32_16x16x32_bf16 v[16:19], a[200:203], a[28:31], v[16:19]
ds_read_b128 a[180:183], v38 offset:36864
v_mfma_f32_16x16x32_bf16 v[20:23], a[204:207], a[28:31], v[20:23]
ds_read_b128 a[184:187], v38 offset:37888
v_mfma_f32_16x16x32_bf16 v[24:27], a[208:211], a[28:31], v[24:27]
ds_read_b128 a[188:191], v38 offset:38912
v_mfma_f32_16x16x32_bf16 v[28:31], a[212:215], a[28:31], v[28:31]
ds_read_b128 a[192:195], v38 offset:39936
v_mfma_f32_16x16x32_bf16 v[32:35], a[216:219], a[28:31], v[32:35]
ds_read_b128 a[196:199], v42 offset:36864
s_waitcnt vmcnt(8) lgkmcnt(5)
v_mfma_f32_16x16x32_bf16 v[16:19], a[160:163], a[32:35], v[16:19]
ds_read_b128 a[200:203], v38 offset:41472
v_mfma_f32_16x16x32_bf16 v[20:23], a[164:167], a[32:35], v[20:23]
ds_read_b128 a[204:207], v38 offset:42496
v_mfma_f32_16x16x32_bf16 v[24:27], a[168:171], a[32:35], v[24:27]
ds_read_b128 a[208:211], v38 offset:43520
v_mfma_f32_16x16x32_bf16 v[28:31], a[172:175], a[32:35], v[28:31]
ds_read_b128 a[212:215], v38 offset:44544
v_mfma_f32_16x16x32_bf16 v[32:35], a[176:179], a[32:35], v[32:35]
ds_read_b128 a[216:219], v42 offset:41472
s_waitcnt vmcnt(7) lgkmcnt(5)
v_mfma_f32_16x16x32_bf16 v[16:19], a[180:183], a[36:39], v[16:19]
ds_read_b128 a[160:163], v38 offset:46080
v_mfma_f32_16x16x32_bf16 v[20:23], a[184:187], a[36:39], v[20:23]
ds_read_b128 a[164:167], v38 offset:47104
v_mfma_f32_16x16x32_bf16 v[24:27], a[188:191], a[36:39], v[24:27]
ds_read_b128 a[168:171], v38 offset:48128
v_mfma_f32_16x16x32_bf16 v[28:31], a[192:195], a[36:39], v[28:31]
ds_read_b128 a[172:175], v38 offset:49152
v_mfma_f32_16x16x32_bf16 v[32:35], a[196:199], a[36:39], v[32:35]
ds_read_b128 a[176:179], v42 offset:46080
s_waitcnt vmcnt(6) lgkmcnt(5)
v_mfma_f32_16x16x32_bf16 v[16:19], a[200:203], a[40:43], v[16:19]
ds_read_b128 a[180:183], v38 offset:50688
v_mfma_f32_16x16x32_bf16 v[20:23], a[204:207], a[40:43], v[20:23]
ds_read_b128 a[184:187], v38 offset:51712
v_mfma_f32_16x16x32_bf16 v[24:27], a[208:211], a[40:43], v[24:27]
v_mfma_f32_16x16x32_bf16 v[28:31], a[212:215], a[40:43], v[28:31]
v_mfma_f32_16x16x32_bf16 v[32:35], a[216:219], a[40:43], v[32:35]
s_waitcnt vmcnt(5) lgkmcnt(2)
v_mfma_f32_16x16x32_bf16 v[16:19], a[160:163], a[44:47], v[16:19]
v_mfma_f32_16x16x32_bf16 v[20:23], a[164:167], a[44:47], v[20:23]
v_mfma_f32_16x16x32_bf16 v[24:27], a[168:171], a[44:47], v[24:27]
v_mfma_f32_16x16x32_bf16 v[28:31], a[172:175], a[44:47], v[28:31]
v_mfma_f32_16x16x32_bf16 v[32:35], a[176:179], a[44:47], v[32:35]
s_waitcnt vmcnt(4) lgkmcnt(0)
v_mfma_f32_16x16x32_bf16 v[16:19], a[180:183], a[48:51], v[16:19]
s_waitcnt vmcnt(0)
v_xor_b32 v118, v248, v83
v_xor_b32 v119, v248, v87
v_xor_b32 v120, v248, v91
v_xor_b32 v121, v248, v95
v_mfma_f32_16x16x32_bf16 v[20:23], a[184:187], a[48:51], v[20:23]
v_or3_b32 v118, v118, v119, v120
v_or_b32 v118, v118, v121
v_cmp_ne_u32 vcc, 0, v118
s_nop 0
s_cbranch_vccnz L_xslow_37
L_xback_38:
v_mfma_f32_16x16x32_bf16 v[24:27], a[228:231], a[48:51], v[24:27]
v_lshlrev_b32 v96, 16, v80
v_and_b32 v97, 0xffff0000, v80
v_lshlrev_b32 v98, 16, v81
v_and_b32 v99, 0xffff0000, v81
v_lshlrev_b32 v100, 16, v82
v_and_b32 v101, 0xffff0000, v82
v_mfma_f32_16x16x32_bf16 v[28:31], a[232:235], a[48:51], v[28:31]
v_lshlrev_b32 v102, 16, v84
v_and_b32 v103, 0xffff0000, v84
v_lshlrev_b32 v104, 16, v85
v_and_b32 v105, 0xffff0000, v85
v_lshlrev_b32 v106, 16, v86
v_and_b32 v107, 0xffff0000, v86
v_mfma_f32_16x16x32_bf16 v[32:35], a[236:239], a[48:51], v[32:35]
v_lshlrev_b32 v108, 16, v88
v_and_b32 v109, 0xffff0000, v88
v_lshlrev_b32 v110, 16, v89
v_and_b32 v111, 0xffff0000, v89
v_lshlrev_b32 v112, 16, v90
v_and_b32 v113, 0xffff0000, v90
v_lshlrev_b32 v114, 16, v92
v_and_b32 v115, 0xffff0000, v92
s_nop 3
v_pk_add_f32 v[16:17], v[16:17], v[96:97]
v_pk_add_f32 v[18:19], v[18:19], v[98:99]
v_pk_add_f32 v[20:21], v[20:21], v[100:101]
v_pk_add_f32 v[22:23], v[22:23], v[102:103]
v_pk_add_f32 v[24:25], v[24:25], v[104:105]
v_pk_add_f32 v[26:27], v[26:27], v[106:107]
v_pk_add_f32 v[28:29], v[28:29], v[108:109]
v_pk_add_f32 v[30:31], v[30:31], v[110:111]
v_pk_add_f32 v[32:33], v[32:33], v[112:113]
v_pk_add_f32 v[34:35], v[34:35], v[114:115]
s_cmp_eq_u32 s29, 1
s_cbranch_scc1 L_last
v_pk_add_f32 v[142:143], v[16:17], v[18:19]
v_pk_mul_f32 v[144:145], v[16:17], v[16:17]
v_pk_fma_f32 v[144:145], v[18:19], v[18:19], v[144:145]
v_pk_add_f32 v[142:143], v[142:143], v[20:21]
v_pk_fma_f32 v[144:145], v[20:21], v[20:21], v[144:145]
v_pk_add_f32 v[142:143], v[142:143], v[22:23]
v_pk_fma_f32 v[144:145], v[22:23], v[22:23], v[144:145]
v_pk_add_f32 v[142:143], v[142:143], v[24:25]
v_pk_fma_f32 v[144:145], v[24:25], v[24:25], v[144:145]
v_pk_add_f32 v[142:143], v[142:143], v[26:27]
v_pk_fma_f32 v[144:145], v[26:27], v[26:27], v[144:145]
v_pk_add_f32 v[142:143], v[142:143], v[28:29]
v_pk_fma_f32 v[144:145], v[28:29], v[28:29], v[144:145]
v_pk_add_f32 v[142:143], v[142:143], v[30:31]
v_pk_fma_f32 v[144:145], v[30:31], v[30:31], v[144:145]
s_mov_b32 exec_hi, 0
v_pk_add_f32 v[142:143], v[142:143], v[32:33]
v_pk_fma_f32 v[144:145], v[32:33], v[32:33], v[144:145]
v_pk_add_f32 v[142:143], v[142:143], v[34:35]
v_pk_fma_f32 v[144:145], v[34:35], v[34:35], v[144:145]
s_mov_b64 exec, -1
v_add_f32 v136, v142, v143
v_add_f32 v137, v144, v145
v_cvt_pk_bf16_f32 v132, v32, v33
v_cvt_pk_bf16_f32 v133, v34, v35
v_permlane32_swap_b32 v136, v137
v_add_f32 v136, v136, v137
v_mov_b32 v137, v136
v_cvt_pk_bf16_f32 v124, v16, v17
v_cvt_pk_bf16_f32 v125, v18, v19
v_permlane16_swap_b32 v136, v137
v_add_f32 v136, v136, v137
v_mov_b32 v137, v136
v_cvt_pk_bf16_f32 v126, v20, v21
v_cvt_pk_bf16_f32 v127, v22, v23
v_permlane32_swap_b32 v136, v137
buffer_store_dwordx4 v[124:127], v140, s[8:11], s66 offen sc1
buffer_store_dwordx2 v[136:137], v138, s[8:11], s67 offen sc1
v_cvt_pk_bf16_f32 v128, v24, v25
v_cvt_pk_bf16_f32 v129, v26, v27
v_cvt_pk_bf16_f32 v130, v28, v29
v_cvt_pk_bf16_f32 v131, v30, v31
v_permlane16_swap_b32 v132, v134
v_permlane16_swap_b32 v133, v135
buffer_store_dwordx4 v[128:131], v140, s[8:11], s66 offen offset:1024 sc1
buffer_store_dwordx4 v[132:135], v141, s[8:11], s66 offen sc1
s_barrier
s_mul_i32 s36, s26, 132608
s_mul_i32 s38, s24, 12288
s_add_u32 m0, s38, 0
s_add_u32 s39, s38, s36
buffer_load_dwordx4 v1, s[4:7], s39 offen offset:0 sc1 lds
buffer_load_dwordx4 v1, s[4:7], s39 offen offset:1024 sc1 lds
buffer_load_dwordx4 v1, s[4:7], s39 offen offset:2048 sc1 lds
buffer_load_dwordx4 v1, s[4:7], s39 offen offset:3072 sc1 lds
s_add_u32 m0, m0, 4096
s_add_u32 s39, s39, 4096
buffer_load_dwordx4 v1, s[4:7], s39 offen offset:0 sc1 lds
buffer_load_dwordx4 v1, s[4:7], s39 offen offset:1024 sc1 lds
buffer_load_dwordx4 v1, s[4:7], s39 offen offset:2048 sc1 lds
buffer_load_dwordx4 v1, s[4:7], s39 offen offset:3072 sc1 lds
s_and_b32 s33, s27, 1
s_cmp_lt_u32 s27, 31
s_cselect_b32 s33, s33, 0
s_cmp_eq_u32 s33, 1
s_cselect_b32 s34, -1, 0xffff
s_mov_b32 s35, 0
v_lshlrev_b32 v7, 3, v1
s_lshr_b32 s31, s80, 4
s_lshl_b32 s31, s31, 11
v_add_u32 v7, s31, v7
s_cmp_eq_u32 s24, 0
s_cselect_b32 s30, 0, 1073741824
s_add_u32 s30, s30, 26607616
s_waitcnt vmcnt(8)
s_barrier
s_mov_b64 exec, s[34:35]
buffer_atomic_add v4, v7, s[8:11], s30 offen sc1
s_mov_b64 exec, -1
s_cmp_eq_u32 s29, 1
s_cbranch_scc1 L_main_fin
s_cmp_eq_u32 s25, 0
s_cselect_b32 s34, 16, 24
s_lshl_b32 s35, s80, 7
s_add_u32 s35, s35, 26607616
s_cmp_eq_u32 s24, 1
s_cselect_b32 s35, s35, 1073741824
v_mov_b32 v6, 0
v_mov_b32 v244, 0
v_mov_b32 v245, 0
v_mov_b32 v246, 0
s_add_u32 m0, m0, 4096
s_add_u32 s39, s39, 4096
buffer_load_dwordx4 v1, s[4:7], s39 offen offset:0 sc1 lds
buffer_load_dwordx4 v1, s[4:7], s39 offen offset:1024 sc1 lds
buffer_load_dwordx4 v1, s[4:7], s39 offen offset:2048 sc1 lds
buffer_load_dwordx4 v1, s[4:7], s39 offen offset:3072 sc1 lds
s_mul_i32 s36, s26, 132608
s_mul_i32 s38, s24, 9216
s_add_u32 m0, s38, 49152
s_add_u32 s39, s38, s36
s_add_u32 s39, s39, 49152
s_mov_b64 exec, 1
buffer_atomic_add v244, v6, s[8:11], s35 offen sc0 sc1
s_mov_b64 exec, -1
buffer_load_dwordx4 v1, s[4:7], s39 offen offset:0 sc1 lds
buffer_load_dwordx4 v1, s[4:7], s39 offen offset:1024 sc1 lds
buffer_load_dwordx4 v1, s[4:7], s39 offen offset:2048 sc1 lds
s_mov_b64 exec, 1
buffer_atomic_add v245, v6, s[8:11], s35 offen sc0 sc1
s_mov_b64 exec, -1
buffer_load_dwordx4 v1, s[4:7], s39 offen offset:3072 sc1 lds
s_add_u32 m0, m0, 4096
s_add_u32 s39, s39, 4096
buffer_load_dwordx4 v1, s[4:7], s39 offen offset:0 sc1 lds
buffer_load_dwordx4 v1, s[4:7], s39 offen offset:1024 sc1 lds
s_mov_b64 exec, 1
buffer_atomic_add v246, v6, s[8:11], s35 offen sc0 sc1
s_mov_b64 exec, -1
buffer_load_dwordx4 v1, s[4:7], s39 offen offset:2048 sc1 lds
buffer_load_dwordx4 v1, s[4:7], s39 offen offset:3072 sc1 lds
s_add_u32 m0, m0, 4096
s_add_u32 s39, s39, 4096
buffer_load_dwordx4 v1, s[4:7], s39 offen offset:0 sc1 lds
s_lshl_b32 s60, s25, 3
s_sub_u32 s61, s60, 1
s_max_i32 s61, s61, 0
s_lshl_b32 s30, s24, 1
s_add_u32 s60, s60, s30
s_mul_i32 s30, s61, 18432
s_mul_i32 s62, s60, 18432
v_add_u32 v237, 18432, v1
s_mul_i32 s38, s24, 5120
s_add_u32 m0, s38, 135168
s_add_u32 s39, s38, s30
s_cmp_eq_u32 s24, 1
s_cbranch_scc0 L_other_42
s_mov_b32 s31, 0
s_mov_b64 exec, 1
v_mov_b32 v247, 0
buffer_atomic_add v247, v6, s[8:11], s35 offen sc0 sc1
s_waitcnt vmcnt(12)
v_cmp_gt_u32 vcc, s34, v244
s_nop 0
s_cbranch_vccz L_polled_41
s_waitcnt vmcnt(8)
v_cmp_gt_u32 vcc, s34, v245
s_nop 0
s_cbranch_vccz L_polled_41
v_mov_b32 v244, 0
buffer_atomic_add v244, v6, s[8:11], s35 offen sc0 sc1
s_waitcnt vmcnt(5)
v_cmp_gt_u32 vcc, s34, v246
s_nop 0
s_cbranch_vccz L_polled_41
v_mov_b32 v245, 0
buffer_atomic_add v245, v6, s[8:11], s35 offen sc0 sc1
L_poll_40:
s_add_u32 s31, s31, 1
s_cmp_gt_u32 s31, 100000
s_cbranch_scc1 L_polled_41
v_mov_b32 v246, 0
buffer_atomic_add v246, v6, s[8:11], s35 offen sc0 sc1
s_waitcnt vmcnt(3)
v_cmp_gt_u32 vcc, s34, v247
s_nop 0
s_cbranch_vccz L_polled_41
v_mov_b32 v247, 0
buffer_atomic_add v247, v6, s[8:11], s35 offen sc0 sc1
s_waitcnt vmcnt(3)
v_cmp_gt_u32 vcc, s34, v244
s_nop 0
s_cbranch_vccz L_polled_41
v_mov_b32 v244, 0
buffer_atomic_add v244, v6, s[8:11], s35 offen sc0 sc1
s_waitcnt vmcnt(3)
v_cmp_gt_u32 vcc, s34, v245
s_nop 0
s_cbranch_vccz L_polled_41
v_mov_b32 v245, 0
buffer_atomic_add v245, v6, s[8:11], s35 offen sc0 sc1
s_waitcnt vmcnt(3)
v_cmp_gt_u32 vcc, s34, v246
s_nop 0
s_cbranch_vccz L_polled_41
s_branch L_poll_40
L_polled_41:
s_mov_b64 exec, -1
L_other_42:
s_barrier
s_mov_b32 s29, 1
s_add_u32 s8, s8, 30834688
s_addc_u32 s9, s9, 0
s_mov_b32 s10, 30834688
s_branch L_layer
L_last:
v_cvt_pk_bf16_f32 v148, v16, v17
v_cvt_pk_bf16_f32 v149, v18, v19
v_cvt_pk_bf16_f32 v150, v20, v21
v_cvt_pk_bf16_f32 v151, v22, v23
v_cvt_pk_bf16_f32 v152, v24, v25
v_cvt_pk_bf16_f32 v153, v26, v27
v_cvt_pk_bf16_f32 v154, v28, v29
v_cvt_pk_bf16_f32 v155, v30, v31
v_cvt_pk_bf16_f32 v156, v32, v33
v_cvt_pk_bf16_f32 v157, v34, v35
buffer_store_dwordx4 v[148:151], v164, s[16:19], s68 offen
buffer_store_dwordx4 v[152:155], v164, s[16:19], s68 offen offset:64
v_permlane16_swap_b32 v156, v158
v_permlane16_swap_b32 v157, v159
buffer_store_dwordx4 v[156:159], v165, s[16:19], s68 offen
L_main_fin:
L_main_end:
s_endpgm
L_tagslow_7:
buffer_load_dwordx2 v[238:239], v48, s[84:87], 0 offen sc1
s_add_u32 s31, s31, 1
s_waitcnt vmcnt(0)
v_cmp_eq_u32 vcc, 0, v238
s_cmp_gt_u32 s31, 200000
s_cbranch_scc1 L_tagback_8
s_cbranch_vccnz L_tagslow_7
s_branch L_tagback_8
L_dbslow_11:
s_mov_b32 s67, 0
L_dbslow_11x:
buffer_load_dwordx2 v[148:149], v146, s[4:7], s66 offen sc1
s_add_u32 s67, s67, 1
s_waitcnt vmcnt(0)
v_cmp_ne_u64 vcc, v[148:149], v[238:239]
s_cmp_gt_u32 s67, 200000
s_cbranch_scc1 L_dbback_12
s_cbranch_vccnz L_dbslow_11x
s_branch L_dbback_12
L_stzslow_23:
s_mov_b32 s31, 0
L_stzloop_25:
buffer_load_dwordx2 v[182:183], v234, s[8:11], s61 offen offset:0 sc1
buffer_load_dwordx2 v[184:185], v234, s[8:11], s61 offen offset:1024 sc1
buffer_load_dwordx2 v[186:187], v234, s[8:11], s61 offen offset:2048 sc1
buffer_load_dwordx2 v[188:189], v234, s[8:11], s61 offen offset:3072 sc1
buffer_load_dwordx2 v[190:191], v235, s[8:11], s61 offen offset:0 sc1
buffer_load_dwordx2 v[192:193], v235, s[8:11], s61 offen offset:1024 sc1
buffer_load_dwordx2 v[194:195], v235, s[8:11], s61 offen offset:2048 sc1
buffer_load_dwordx2 v[196:197], v235, s[8:11], s61 offen offset:3072 sc1
s_add_u32 s31, s31, 1
s_waitcnt vmcnt(0)
v_min3_f32 v200, v183, v185, v187
v_min3_f32 v201, v189, v191, v193
v_min3_f32 v200, v200, v195, v197
v_min_f32 v200, v200, v201
v_cmp_gt_f32 vcc, 0, v200
s_cmp_gt_u32 s31, 200000
s_cbranch_scc1 L_stzback_24
s_cbranch_vccnz L_stzloop_25
s_branch L_stzback_24
L_xslow_37:
s_mov_b32 s31, 0
L_xloop_39:
buffer_load_dwordx4 v[80:83], v1, s[8:11], s63 offen offset:0 sc1
buffer_load_dwordx4 v[84:87], v1, s[8:11], s63 offen offset:1024 sc1
buffer_load_dwordx4 v[88:91], v1, s[8:11], s63 offen offset:2048 sc1
buffer_load_dwordx4 v[92:95], v1, s[8:11], s63 offen offset:3072 sc1
s_add_u32 s31, s31, 1
s_waitcnt vmcnt(0)
v_xor_b32 v118, v248, v83
v_xor_b32 v119, v248, v87
v_xor_b32 v120, v248, v91
v_xor_b32 v121, v248, v95
v_or3_b32 v118, v118, v119, v120
v_or_b32 v118, v118, v121
v_cmp_ne_u32 vcc, 0, v118
s_cmp_gt_u32 s31, 200000
s_cbranch_scc1 L_xback_38
s_cbranch_vccnz L_xloop_39
s_branch L_xback_38
L_code_end:
.section .rodata,"a"
.p2align 6
.amdhsa_kernel main_kernel
  .amdhsa_next_free_vgpr 512
  .amdhsa_next_free_sgpr 102
  .amdhsa_accum_offset 256
  .amdhsa_group_segment_fixed_size 0
  .amdhsa_kernarg_size 88
  .amdhsa_user_sgpr_count 2
  .amdhsa_user_sgpr_kernarg_segment_ptr 1
  .amdhsa_system_sgpr_workgroup_id_x 1
  .amdhsa_float_denorm_mode_32 3
.end_amdhsa_kernel
```

```asm
; @launch kernel=main_kernel grid=(256,1,1) block=(256,1,1) lds=163840
.amdgcn_target "amdgcn-amd-amdhsa--gfx950"
.text
.globl main_kernel
.p2align 8
.type main_kernel,@function
main_kernel:
s_cmp_ge_u32 s2, 256
s_cbranch_scc1 L_main_end
s_load_dwordx16 s[64:79], s[0:1], 0
s_memrealtime s[96:97]
s_load_dwordx2 s[4:5], s[0:1], 80
s_load_dwordx2 s[16:17], s[0:1], 64
s_load_dwordx2 s[84:85], s[0:1], 72
s_getpc_b64 s[88:89]
L_pc:
s_mov_b32 s90, L_code_end-L_pc
s_mov_b32 s91, 0x20000
s_lshr_b32 s31, s2, 3
s_lshl_b32 s31, s31, 10
v_lshl_add_u32 v14, v0, 2, s31
s_mov_b32 s37, L_pc-L_pc
buffer_load_dword v15, v14, s[88:91], s37 offen
v_lshrrev_b32 v6, 6, v0
v_and_b32 v0, 63, v0
v_readfirstlane_b32 s24, v6
v_lshlrev_b32 v1, 4, v0
v_and_b32 v2, 15, v0
v_lshrrev_b32 v3, 4, v0
v_cmp_gt_u32 s[50:51], 2, v3
s_nop 0
s_cmp_lt_u32 s2, 128
s_cbranch_scc1 L_p0_x1
s_sub_u32 s30, s2, 128
s_cmp_lt_u32 s30, 108
s_cselect_b32 s62, 0, 1073741824
s_cselect_b32 s30, s30, 0
s_and_b32 s60, s30, 3
s_lshr_b32 s61, s30, 2
s_mov_b32 s14, 1990656
s_mov_b32 s15, 0x20000
s_mul_i32 s30, s60, 497664
s_lshl_b32 s31, s61, 7
s_add_u32 s30, s30, s31
s_mul_i32 s31, s24, 27648
s_add_u32 s30, s30, s31
s_add_u32 s30, s30, s62
v_lshrrev_b32 v36, 7, v1
v_mul_u32_u24 v42, 3456, v36
v_and_b32 v36, 0x70, v1
v_add_u32 v42, v36, v42
s_lshl_b32 s32, s24, 10
s_waitcnt lgkmcnt(0)
s_mov_b32 s12, s66
s_mov_b32 s13, s67
s_add_u32 m0, s32, 0
s_add_u32 s31, s30, 0
buffer_load_dwordx4 v42, s[12:15], s31 offen nt lds
s_add_u32 m0, s32, 4096
s_add_u32 s31, s30, 110592
buffer_load_dwordx4 v42, s[12:15], s31 offen nt lds
s_add_u32 m0, s32, 8192
s_add_u32 s31, s30, 221184
buffer_load_dwordx4 v42, s[12:15], s31 offen nt lds
s_add_u32 m0, s32, 12288
s_add_u32 s31, s30, 331776
buffer_load_dwordx4 v42, s[12:15], s31 offen nt lds
s_add_u32 m0, s32, 16384
s_add_u32 s31, s30, 442368
s_cmp_lt_u32 s24, 2
s_cselect_b32 s31, s31, 1073741824
buffer_load_dwordx4 v42, s[12:15], s31 offen nt lds
s_branch L_p0_j1
L_p0_x1:
s_mov_b32 s14, 2359296
s_mov_b32 s15, 0x20000
s_mul_i32 s30, s24, 18
v_add_u32 v36, s30, v3
v_mul_u32_u24 v42, 1152, v2
v_lshl_add_u32 v42, v36, 4, v42
s_mul_i32 s30, s2, 18432
v_mov_b32 v37, 1073741824
v_cndmask_b32 v37, v37, v42, s[50:51]
s_waitcnt lgkmcnt(0)
s_mov_b32 s12, s64
s_mov_b32 s13, s65
buffer_load_dwordx4 v[64:67], v42, s[12:15], s30 offen offset:0
buffer_load_dwordx4 v[68:71], v42, s[12:15], s30 offen offset:64
buffer_load_dwordx4 v[72:75], v42, s[12:15], s30 offen offset:128
buffer_load_dwordx4 v[76:79], v42, s[12:15], s30 offen offset:192
buffer_load_dwordx4 v[80:83], v37, s[12:15], s30 offen offset:256
L_p0_j1:
s_mov_b32 s86, 256
s_mov_b32 s87, 0x20000
s_xor_b32 s30, s2, 248
s_or_b32 s30, s30, s24
s_cmp_eq_u32 s30, 0
s_cselect_b32 s30, 0, 1073741824
v_mov_b32 v48, 0
s_or_b32 s96, s96, 1
v_mov_b32 v238, s96
v_mov_b32 v239, s97
s_mov_b64 exec, 1
buffer_store_dwordx2 v[238:239], v48, s[84:87], s30 offen sc1
s_mov_b64 exec, -1
v_mov_b32 v4, 1
v_mov_b32 v5, 0
s_mov_b32 s56, 0
s_mov_b32 s29, 0
v_add_u32 v9, 66560, v1
v_cmp_eq_u32 s[46:47], 0, v3
v_cmp_eq_u32 s[48:49], 2, v3
s_mov_b32 s6, 19451904
s_mov_b32 s7, 0x20000
s_mov_b32 s10, 61669376
s_mov_b32 s11, 0x20000
s_mov_b32 s18, 2359296
s_mov_b32 s19, 0x20000
s_mov_b32 s22, 4096
s_mov_b32 s23, 0x20000
s_and_b32 s30, s2, 7
s_lshr_b32 s31, s2, 3
s_lshr_b32 s32, s31, 2
s_and_b32 s33, s31, 3
s_lshr_b32 s25, s30, 2
s_lshl_b32 s25, s25, 3
s_add_u32 s25, s25, s32
s_and_b32 s26, s30, 3
s_lshl_b32 s26, s26, 2
s_add_u32 s26, s26, s33
s_lshl_b32 s80, s25, 4
s_add_u32 s80, s80, s26
s_lshr_b32 s27, s80, 3
s_and_b32 s28, s26, 7
s_lshl_b32 s70, s25, 2
s_add_u32 s70, s70, s24
s_lshl_b32 s70, s70, 1
s_lshr_b32 s32, s26, 3
s_add_u32 s70, s70, s32
s_mul_i32 s71, s28, 9
s_add_u32 s71, s71, 1
s_lshr_b32 s71, s71, 1
s_add_u32 s8, s4, 19451904
s_addc_u32 s9, s5, 0
s_mov_b32 s20, s76
s_mov_b32 s21, s77
v_lshrrev_b32 v36, 2, v2
v_lshl_add_u32 v36, v3, 3, v36
v_lshlrev_b32 v45, 7, v36
v_and_b32 v36, 3, v2
v_lshl_add_u32 v45, v36, 3, v45
s_lshl_b32 s31, s24, 5
v_add_u32 v45, s31, v45
v_mov_b32 v164, 3212836864
v_mov_b32 v165, 3212836864
v_mov_b32 v166, 3212836864
v_mov_b32 v167, 3212836864
s_lshl_b32 s30, s80, 10
s_lshl_b32 s31, s24, 8
s_add_u32 s30, s30, s31
s_add_u32 s30, s30, 26214400
s_mov_b32 s31, 30834688
v_mul_lo_u32 v36, v3, s31
v_lshl_add_u32 v37, v2, 4, v36
s_mov_b32 exec_hi, 0
buffer_store_dwordx4 v[164:167], v37, s[8:11], s30 offen sc1
s_mov_b64 exec, -1
v_lshl_add_u32 v37, v2, 15, v36
s_lshl_b32 s30, s2, 7
s_add_u32 s30, s30, 26476544
s_cmp_eq_u32 s24, 0
s_cselect_b32 s30, s30, 1073741824
s_mov_b64 exec, 0x001f001f
buffer_store_dword v48, v37, s[8:11], s30 offen sc1
s_mov_b64 exec, -1
s_cmp_lt_u32 s2, 128
s_cbranch_scc1 L_p0_x2
s_mul_i32 s92, s61, 29
s_lshr_b32 s92, s92, 8
s_mul_i32 s33, s92, 9
s_sub_u32 s33, s61, s33
s_lshl_b32 s33, s33, 6
s_lshl_b32 s31, s24, 4
s_add_u32 s33, s33, s31
v_add_u32 v36, s33, v2
v_mul_u32_u24 v37, 911, v36
v_lshrrev_b32 v37, 14, v37
v_mul_u32_u24 v38, 18, v37
v_sub_u32 v36, v36, v38
v_and_b32 v38, 1, v37
v_lshrrev_b32 v37, 1, v37
s_mov_b32 s31, 132608
v_mul_lo_u32 v37, v37, s31
s_cmp_eq_u32 s92, 0
s_cselect_b32 s93, 5, 0
s_cselect_b32 s94, 8, 4
s_cmp_eq_u32 s92, 2
s_cselect_b32 s93, 2, s93
s_cselect_b32 s94, 0, s94
s_sub_u32 s94, s94, 16
v_add_u32 v39, s93, v38
v_lshl_add_u32 v40, v38, 1, v36
v_add_u32 v40, s94, v40
v_cmp_gt_u32 vcc, 16, v36
s_nop 1
v_cndmask_b32 v39, 4, v39, vcc
v_cndmask_b32 v40, v40, v36, vcc
v_lshl_add_u32 v43, v39, 10, v37
v_lshl_add_u32 v43, v40, 4, v43
v_lshl_add_u32 v44, v39, 9, v37
v_lshl_add_u32 v44, v40, 3, v44
s_lshl_b32 s31, s60, 7
s_add_u32 s31, s31, 129024
v_add_u32 v44, s31, v44
s_mul_i32 s31, s60, 18
v_add_u32 v37, s31, v3
v_and_b32 v38, 3, v37
v_lshrrev_b32 v37, 2, v37
v_mul_u32_u24 v37, 7168, v37
v_add_u32 v43, v43, v37
v_lshl_add_u32 v43, v38, 8, v43
s_waitcnt vmcnt(3)
s_barrier
ds_read_b64_tr_b16 v[64:65], v45 offset:0
ds_read_b64_tr_b16 v[66:67], v45 offset:512
ds_read_b64_tr_b16 v[68:69], v45 offset:4096
ds_read_b64_tr_b16 v[70:71], v45 offset:4608
ds_read_b64_tr_b16 v[72:73], v45 offset:8192
ds_read_b64_tr_b16 v[74:75], v45 offset:8704
ds_read_b64_tr_b16 v[76:77], v45 offset:12288
ds_read_b64_tr_b16 v[78:79], v45 offset:12800
ds_read_b64_tr_b16 v[80:81], v45 offset:16384
ds_read_b64_tr_b16 v[82:83], v45 offset:16896
v_mov_b32 v36, 1073741824
v_mov_b32 v46, 0
v_cndmask_b32 v37, v36, v43, s[50:51]
s_add_u32 s31, s62, 0
s_waitcnt lgkmcnt(8)
buffer_store_dwordx4 v[64:67], v43, s[4:7], s31 offen sc1
s_add_u32 s31, s62, 7168
s_waitcnt lgkmcnt(6)
buffer_store_dwordx4 v[68:71], v43, s[4:7], s31 offen sc1
s_add_u32 s31, s62, 14336
s_waitcnt lgkmcnt(4)
buffer_store_dwordx4 v[72:75], v43, s[4:7], s31 offen sc1
s_add_u32 s31, s62, 21504
s_waitcnt lgkmcnt(2)
buffer_store_dwordx4 v[76:79], v43, s[4:7], s31 offen sc1
s_add_u32 s31, s62, 28672
s_waitcnt lgkmcnt(0)
buffer_store_dwordx4 v[80:83], v37, s[4:7], s31 offen sc1
v_mov_b32 v37, 0x3f803f80
v_dot2c_f32_bf16 v46, v64, v37
v_dot2c_f32_bf16 v46, v65, v37
v_dot2c_f32_bf16 v46, v66, v37
v_dot2c_f32_bf16 v46, v67, v37
v_dot2c_f32_bf16 v46, v68, v37
v_dot2c_f32_bf16 v46, v69, v37
v_dot2c_f32_bf16 v46, v70, v37
v_dot2c_f32_bf16 v46, v71, v37
v_dot2c_f32_bf16 v46, v72, v37
v_dot2c_f32_bf16 v46, v73, v37
v_dot2c_f32_bf16 v46, v74, v37
v_dot2c_f32_bf16 v46, v75, v37
v_dot2c_f32_bf16 v46, v76, v37
v_dot2c_f32_bf16 v46, v77, v37
v_dot2c_f32_bf16 v46, v78, v37
v_dot2c_f32_bf16 v46, v79, v37
v_dot2c_f32_bf16 v46, v80, v37
v_dot2c_f32_bf16 v46, v81, v37
v_dot2c_f32_bf16 v46, v82, v37
v_dot2c_f32_bf16 v46, v83, v37
s_nop 2
v_mov_b32 v37, v46
s_nop 1
v_permlane32_swap_b32 v46, v37
v_add_f32 v46, v46, v37
v_mov_b32 v37, v46
s_nop 1
v_permlane16_swap_b32 v46, v37
v_add_f32 v46, v46, v37
v_cvt_pk_bf16_f32 v50, v46, v46
v_and_b32 v37, 0xffff0000, v50
v_sub_f32 v37, v46, v37
v_cvt_pk_bf16_f32 v51, v37, v37
v_cndmask_b32 v36, v36, v44, s[46:47]
buffer_store_dwordx2 v[50:51], v36, s[4:7], s62 offen sc1
s_branch L_p0_j2
L_p0_x2:
s_mul_i32 s30, s24, 4608
s_mul_i32 s31, s2, 18432
s_add_u32 s31, s31, s30
s_add_u32 s31, s31, 0
v_mov_b32 v36, 1073741824
v_add_u32 v38, 4096, v1
v_cndmask_b32 v38, v36, v38, s[50:51]
v_mov_b32 v46, 0
v_mov_b32 v47, 0
v_mov_b32 v39, 0x3f803f80
s_waitcnt vmcnt(3)
buffer_store_dwordx4 v[64:67], v1, s[8:11], s31 offen offset:0 sc1
buffer_store_dwordx4 v[68:71], v1, s[8:11], s31 offen offset:1024 sc1
buffer_store_dwordx4 v[72:75], v1, s[8:11], s31 offen offset:2048 sc1
buffer_store_dwordx4 v[76:79], v1, s[8:11], s31 offen offset:3072 sc1
buffer_store_dwordx4 v[80:83], v38, s[8:11], s31 offen offset:0 sc1
v_dot2c_f32_bf16 v46, v64, v39
v_dot2c_f32_bf16 v46, v65, v39
v_dot2c_f32_bf16 v46, v66, v39
v_dot2c_f32_bf16 v46, v67, v39
v_dot2c_f32_bf16 v46, v68, v39
v_dot2c_f32_bf16 v46, v69, v39
v_dot2c_f32_bf16 v46, v70, v39
v_dot2c_f32_bf16 v46, v71, v39
v_dot2c_f32_bf16 v46, v72, v39
v_dot2c_f32_bf16 v46, v73, v39
v_dot2c_f32_bf16 v46, v74, v39
v_dot2c_f32_bf16 v46, v75, v39
v_dot2c_f32_bf16 v46, v76, v39
v_dot2c_f32_bf16 v46, v77, v39
v_dot2c_f32_bf16 v46, v78, v39
v_dot2c_f32_bf16 v46, v79, v39
v_dot2c_f32_bf16 v46, v80, v39
v_dot2c_f32_bf16 v46, v81, v39
v_dot2c_f32_bf16 v46, v82, v39
v_dot2c_f32_bf16 v46, v83, v39
v_dot2c_f32_bf16 v47, v64, v64
v_dot2c_f32_bf16 v47, v65, v65
v_dot2c_f32_bf16 v47, v66, v66
v_dot2c_f32_bf16 v47, v67, v67
v_dot2c_f32_bf16 v47, v68, v68
v_dot2c_f32_bf16 v47, v69, v69
v_dot2c_f32_bf16 v47, v70, v70
v_dot2c_f32_bf16 v47, v71, v71
v_dot2c_f32_bf16 v47, v72, v72
v_dot2c_f32_bf16 v47, v73, v73
v_dot2c_f32_bf16 v47, v74, v74
v_dot2c_f32_bf16 v47, v75, v75
v_dot2c_f32_bf16 v47, v76, v76
v_dot2c_f32_bf16 v47, v77, v77
v_dot2c_f32_bf16 v47, v78, v78
v_dot2c_f32_bf16 v47, v79, v79
v_dot2c_f32_bf16 v47, v80, v80
v_dot2c_f32_bf16 v47, v81, v81
v_dot2c_f32_bf16 v47, v82, v82
v_dot2c_f32_bf16 v47, v83, v83
v_mov_b32 v37, v46
s_nop 1
v_permlane32_swap_b32 v46, v37
v_add_f32 v46, v46, v37
v_mov_b32 v37, v46
s_nop 1
v_permlane16_swap_b32 v46, v37
v_add_f32 v46, v46, v37
v_mov_b32 v37, v47
s_nop 1
v_permlane32_swap_b32 v47, v37
v_add_f32 v47, v47, v37
v_mov_b32 v37, v47
s_nop 1
v_permlane16_swap_b32 v47, v37
v_add_f32 v47, v47, v37
s_lshl_b32 s30, s2, 7
s_lshl_b32 s31, s24, 14
s_add_u32 s30, s30, s31
s_add_u32 s30, s30, 2359296
v_cndmask_b32 v50, 0, v46, s[46:47]
v_cndmask_b32 v51, 0, v47, s[46:47]
v_lshlrev_b32 v37, 3, v2
v_lshl_add_u32 v37, v3, 16, v37
v_cndmask_b32 v37, v36, v37, s[50:51]
buffer_store_dwordx2 v[50:51], v37, s[8:11], s30 offen sc1
L_p0_j2:
buffer_load_dwordx2 v[238:239], v48, s[84:87], 0 offen sc1
s_sub_u32 s30, s2, 0
s_cmp_lt_u32 s30, 256
s_cselect_b32 s36, 0, 1073741824
s_cselect_b32 s30, s30, 0
s_and_b32 s34, s30, 3
s_lshr_b32 s35, s30, 2
s_mov_b32 s14, 5308416
s_mov_b32 s15, 0x20000
s_mul_i32 s30, s34, 1327104
s_lshl_b32 s31, s35, 7
s_add_u32 s30, s30, s31
s_mul_i32 s31, s24, 73728
s_add_u32 s30, s30, s31
s_add_u32 s30, s30, s36
v_lshrrev_b32 v36, 7, v1
v_mul_u32_u24 v42, 9216, v36
v_and_b32 v36, 0x70, v1
v_add_u32 v42, v36, v42
s_lshl_b32 s32, s24, 10
s_mov_b32 s12, s72
s_mov_b32 s13, s73
s_add_u32 m0, s32, 20480
s_add_u32 s31, s30, 0
buffer_load_dwordx4 v42, s[12:15], s31 offen nt lds
s_add_u32 m0, s32, 24576
s_add_u32 s31, s30, 294912
buffer_load_dwordx4 v42, s[12:15], s31 offen nt lds
s_add_u32 m0, s32, 28672
s_add_u32 s31, s30, 589824
buffer_load_dwordx4 v42, s[12:15], s31 offen nt lds
s_add_u32 m0, s32, 32768
s_add_u32 s31, s30, 884736
buffer_load_dwordx4 v42, s[12:15], s31 offen nt lds
s_add_u32 m0, s32, 36864
s_add_u32 s31, s30, 1179648
s_cmp_lt_u32 s24, 2
s_cselect_b32 s31, s31, 1073741824
buffer_load_dwordx4 v42, s[12:15], s31 offen nt lds
s_sub_u32 s30, s2, 0
s_cmp_lt_u32 s30, 256
s_cselect_b32 s36, 0, 1073741824
s_cselect_b32 s30, s30, 0
s_and_b32 s34, s30, 3
s_lshr_b32 s35, s30, 2
s_lshl_b32 s92, s35, 6
s_lshl_b32 s33, s24, 4
s_add_u32 s92, s92, s33
s_cmp_ge_u32 s92, 2304
s_cselect_b32 s93, 1, 0
s_cselect_b32 s33, 2304, 0
s_sub_u32 s92, s92, s33
s_mul_i32 s94, s92, 1821
s_lshr_b32 s94, s94, 19
s_mul_i32 s33, s94, 288
s_sub_u32 s92, s92, s33
s_lshr_b32 s95, s92, 5
s_bfe_u32 s96, s92, 0x10004
s_lshl_b32 s94, s94, 1
s_cmp_ge_u32 s92, 144
s_addc_u32 s94, s94, 0
s_cmp_gt_u32 s95, 4
s_cselect_b32 s33, 5, 0
s_sub_u32 s97, s95, s33
s_cmp_eq_u32 s93, 0
s_cselect_b32 s33, 5, 0
s_add_u32 s97, s97, s33
s_cmp_eq_u32 s95, 4
s_cselect_b32 s97, 4, s97
s_mul_i32 s94, s94, 9
s_add_u32 s94, s94, s97
s_mul_i32 s94, s94, 37888
s_add_u32 s94, s94, 2785280
v_and_b32 v36, 3, v2
v_bfe_u32 v37, v2, 2, 1
v_bfe_u32 v38, v2, 3, 1
v_lshl_add_u32 v36, v38, 2, v36
s_lshl_b32 s33, s96, 3
v_add_u32 v36, s33, v36
s_cmp_eq_u32 s95, 4
s_cbranch_scc0 L_w3j_3
s_xor_b32 s33, s93, 1
v_mov_b32 v36, v2
v_mov_b32 v37, s33
L_w3j_3:
v_mul_u32_u24 v170, 18432, v37
v_lshl_add_u32 v170, v36, 4, v170
v_lshl_add_u32 v170, v3, 8, v170
s_mul_i32 s31, s34, 4608
s_add_u32 s31, s31, s94
v_add_u32 v170, s31, v170
v_lshlrev_b32 v171, 9, v37
v_lshl_add_u32 v171, v36, 3, v171
s_lshl_b32 s31, s34, 7
s_add_u32 s31, s31, s94
s_add_u32 s31, s31, 36864
v_add_u32 v171, s31, v171
v_mov_b32 v172, 1073741824
v_mov_b32 v52, 1073741824
v_mov_b32 v53, 1073741824
v_mov_b32 v54, 1073741824
v_mov_b32 v55, 1073741824
v_mov_b32 v56, 1073741824
s_cmp_lt_u32 s2, 32
s_cbranch_scc1 L_p0_a5
s_cmp_lt_u32 s2, 176
s_cbranch_scc1 L_p0_b5
s_sub_u32 s30, s2, 176
s_cmp_lt_u32 s30, 36
s_cselect_b32 s53, 0, 1073741824
s_cselect_b32 s30, s30, 0
s_and_b32 s38, s30, 3
s_lshr_b32 s52, s30, 2
v_lshrrev_b32 v39, 2, v2
v_and_b32 v40, 3, v2
v_lshlrev_b32 v40, 3, v40
s_lshl_b32 s31, s24, 5
v_add_u32 v40, s31, v40
v_lshl_add_u32 v36, v3, 2, v39
v_lshl_add_u32 v52, v36, 7, v40
v_lshrrev_b32 v36, 1, v39
v_mul_u32_u24 v36, 18, v36
v_and_b32 v41, 1, v39
v_add3_u32 v36, v36, v41, 16
v_and_b32 v41, 1, v3
v_mul_u32_u24 v41, 72, v41
v_add_u32 v36, v36, v41
v_lshl_add_u32 v53, v36, 7, v40
s_lshl_b32 s31, s52, 6
s_lshl_b32 s33, s24, 4
s_add_u32 s31, s31, s33
v_add_u32 v36, s31, v2
v_mul_u32_u24 v37, 911, v36
v_lshrrev_b32 v37, 16, v37
v_mul_u32_u24 v38, 72, v37
v_sub_u32 v36, v36, v38
s_mov_b32 s31, 82944
v_mul_lo_u32 v41, v37, s31
v_mov_b32 v173, v37
v_add_u32 v41, 2121728, v41
v_lshrrev_b32 v39, 5, v36
v_lshlrev_b32 v39, 11, v39
v_bfe_u32 v40, v36, 2, 1
v_lshl_add_u32 v39, v40, 10, v39
v_bfe_u32 v40, v36, 3, 2
v_lshl_add_u32 v39, v40, 6, v39
v_and_b32 v40, 3, v36
v_lshl_add_u32 v39, v40, 4, v39
v_lshlrev_b32 v40, 4, v36
v_add_u32 v40, 3072, v40
v_cmp_gt_u32 vcc, 64, v36
v_mov_b32 v47, 7
s_nop 0
v_cndmask_b32 v39, v40, v39, vcc
v_cndmask_b32 v47, v47, 8, vcc
v_add_u32 v41, v41, v39
s_mul_i32 s31, s38, 16
s_add_u32 s31, s31, 0
v_add_u32 v37, s31, v3
v_and_b32 v38, 3, v37
v_lshrrev_b32 v37, 2, v37
v_mul_u32_u24 v37, 4608, v37
v_lshlrev_b32 v38, v47, v38
v_add3_u32 v172, v41, v37, v38
s_mul_i32 s31, s38, 2
s_add_u32 s31, s31, 64
v_add_u32 v37, s31, v3
v_and_b32 v38, 3, v37
v_lshrrev_b32 v37, 2, v37
v_mul_u32_u24 v37, 4608, v37
v_lshlrev_b32 v38, v47, v38
v_add3_u32 v173, v41, v37, v38
s_branch L_p0_j5
L_p0_b5:
s_sub_u32 s30, s2, 32
s_cmp_lt_u32 s30, 144
s_cselect_b32 s53, 0, 1073741824
s_cselect_b32 s30, s30, 0
s_and_b32 s38, s30, 15
s_lshr_b32 s52, s30, 4
s_lshl_b32 s31, s52, 6
s_lshl_b32 s33, s24, 4
s_add_u32 s31, s31, s33
v_add_u32 v36, s31, v2
v_mul_u32_u24 v37, 911, v36
v_lshrrev_b32 v37, 16, v37
v_mul_u32_u24 v38, 72, v37
v_sub_u32 v36, v36, v38
s_mov_b32 s31, 331776
v_mul_lo_u32 v41, v37, s31
v_mov_b32 v173, v37
v_add_u32 v41, 8241152, v41
v_lshrrev_b32 v39, 5, v36
v_lshlrev_b32 v39, 11, v39
v_bfe_u32 v40, v36, 2, 1
v_lshl_add_u32 v39, v40, 10, v39
v_bfe_u32 v40, v36, 3, 2
v_lshl_add_u32 v39, v40, 6, v39
v_and_b32 v40, 3, v36
v_lshl_add_u32 v39, v40, 4, v39
v_lshlrev_b32 v40, 4, v36
v_add_u32 v40, 3072, v40
v_cmp_gt_u32 vcc, 64, v36
v_mov_b32 v47, 7
s_nop 0
v_cndmask_b32 v39, v40, v39, vcc
v_cndmask_b32 v47, v47, 8, vcc
v_add_u32 v41, v41, v39
v_mad_u32_u24 v46, v173, 9, 1
v_lshrrev_b32 v46, 1, v46
s_mul_i32 s31, s38, 18
v_add_u32 v37, s31, v3
v_and_b32 v38, 3, v37
v_lshrrev_b32 v37, 2, v37
v_lshlrev_b32 v38, v47, v38
v_add_u32 v41, v41, v38
s_cmp_ge_u32 s38, 8
s_cselect_b32 s31, 36, 0
v_add_u32 v38, s31, v46
v_sub_u32 v46, 0, v46
s_movk_i32 s31, 4608
v_add_u32 v36, 0, v37
v_sub_u32 v39, v36, v38
v_cmp_gt_u32 vcc, 4, v39
v_ashrrev_i32 v40, 31, v39
v_and_b32 v40, 4, v40
v_cndmask_b32 v40, v40, v46, vcc
v_add_u32 v36, v36, v40
v_mad_u32_u24 v52, v36, s31, v41
v_add_u32 v36, 1, v37
v_sub_u32 v39, v36, v38
v_cmp_gt_u32 vcc, 4, v39
v_ashrrev_i32 v40, 31, v39
v_and_b32 v40, 4, v40
v_cndmask_b32 v40, v40, v46, vcc
v_add_u32 v36, v36, v40
v_mad_u32_u24 v53, v36, s31, v41
v_add_u32 v36, 2, v37
v_sub_u32 v39, v36, v38
v_cmp_gt_u32 vcc, 4, v39
v_ashrrev_i32 v40, 31, v39
v_and_b32 v40, 4, v40
v_cndmask_b32 v40, v40, v46, vcc
v_add_u32 v36, v36, v40
v_mad_u32_u24 v54, v36, s31, v41
v_add_u32 v36, 3, v37
v_sub_u32 v39, v36, v38
v_cmp_gt_u32 vcc, 4, v39
v_ashrrev_i32 v40, 31, v39
v_and_b32 v40, 4, v40
v_cndmask_b32 v40, v40, v46, vcc
v_add_u32 v36, v36, v40
v_mad_u32_u24 v55, v36, s31, v41
v_add_u32 v36, 4, v37
v_sub_u32 v39, v36, v38
v_cmp_gt_u32 vcc, 4, v39
v_ashrrev_i32 v40, 31, v39
v_and_b32 v40, 4, v40
v_cndmask_b32 v40, v40, v46, vcc
v_add_u32 v36, v36, v40
v_mad_u32_u24 v56, v36, s31, v41
s_branch L_p0_j5
L_p0_a5:
s_add_u32 s30, s2, 256
s_cmp_lt_u32 s30, 288
s_cselect_b32 s53, 0, 1073741824
s_cselect_b32 s30, s30, 0
s_and_b32 s38, s30, 3
s_lshr_b32 s52, s30, 2
s_lshl_b32 s92, s52, 6
s_lshl_b32 s33, s24, 4
s_add_u32 s92, s92, s33
s_cmp_ge_u32 s92, 2304
s_cselect_b32 s93, 1, 0
s_cselect_b32 s33, 2304, 0
s_sub_u32 s92, s92, s33
s_mul_i32 s94, s92, 1821
s_lshr_b32 s94, s94, 19
s_mul_i32 s33, s94, 288
s_sub_u32 s92, s92, s33
s_lshr_b32 s95, s92, 5
s_bfe_u32 s96, s92, 0x10004
s_lshl_b32 s94, s94, 1
s_cmp_ge_u32 s92, 144
s_addc_u32 s94, s94, 0
s_cmp_gt_u32 s95, 4
s_cselect_b32 s33, 5, 0
s_sub_u32 s97, s95, s33
s_cmp_eq_u32 s93, 0
s_cselect_b32 s33, 5, 0
s_add_u32 s97, s97, s33
s_cmp_eq_u32 s95, 4
s_cselect_b32 s97, 4, s97
s_mul_i32 s94, s94, 9
s_add_u32 s94, s94, s97
s_mul_i32 s94, s94, 37888
s_add_u32 s94, s94, 2785280
v_and_b32 v36, 3, v2
v_bfe_u32 v37, v2, 2, 1
v_bfe_u32 v38, v2, 3, 1
v_lshl_add_u32 v36, v38, 2, v36
s_lshl_b32 s33, s96, 3
v_add_u32 v36, s33, v36
s_cmp_eq_u32 s95, 4
s_cbranch_scc0 L_w3j_6
s_xor_b32 s33, s93, 1
v_mov_b32 v36, v2
v_mov_b32 v37, s33
L_w3j_6:
v_mul_u32_u24 v172, 18432, v37
v_lshl_add_u32 v172, v36, 4, v172
v_lshl_add_u32 v172, v3, 8, v172
s_mul_i32 s31, s38, 4608
s_add_u32 s31, s31, s94
v_add_u32 v172, s31, v172
v_lshlrev_b32 v173, 9, v37
v_lshl_add_u32 v173, v36, 3, v173
s_lshl_b32 s31, s38, 7
s_add_u32 s31, s31, s94
s_add_u32 s31, s31, 36864
v_add_u32 v173, s31, v173
L_p0_j5:
s_lshl_b32 s30, s25, 2
s_add_u32 s30, s30, s24
s_mul_i32 s31, s30, 133120
s_lshl_b32 s30, s30, 17
s_mul_i32 s32, s24, 0
s_add_u32 s32, s32, s26
s_and_b32 s32, s32, 15
s_lshl_b32 s3, s32, 8
s_add_u32 s3, s3, s30
s_lshl_b32 s101, s32, 12
s_add_u32 s101, s101, s31
s_add_u32 s101, s101, 10895360
v_lshrrev_b32 v41, 4, v1
s_lshl_b32 s30, s25, 3
s_sub_u32 s30, s30, 1
v_add_u32 v36, s30, v41
v_max_i32 v36, 0, v36
v_bfe_u32 v37, v41, 2, 1
v_mul_u32_u24 v37, 35, v37
s_mul_i32 s30, s26, 36
v_add_u32 v37, s30, v37
v_lshrrev_b32 v37, 6, v37
v_bfe_u32 v38, v41, 3, 2
v_mad_u32_u24 v37, v38, 9, v37
v_and_b32 v38, 3, v41
v_lshl_add_u32 v37, v37, 2, v38
v_add_u32 v37, 128, v37
v_cndmask_b32 v36, v37, v36, s[50:51]
v_lshlrev_b32 v174, 7, v36
s_lshl_b32 s30, s2, 7
s_add_u32 s30, s30, 19415040
s_lshl_b32 s32, s2, 3
s_add_u32 s32, s32, 19447808
s_cmp_eq_u32 s24, 0
s_cselect_b32 s30, s30, 1073741824
s_cselect_b32 s100, s32, 1073741824
s_waitcnt vmcnt(5)
v_cmp_eq_u32 vcc, 0, v238
s_mov_b32 s31, 0
s_cbranch_vccnz L_tagslow_7
L_tagback_8:
s_barrier
s_mov_b64 exec, 1
buffer_store_dwordx2 v[238:239], v48, s[4:7], s30 offen sc1
s_mov_b64 exec, -1
s_cmp_lt_u32 s2, 32
s_cbranch_scc1 L_p0_a3
s_cmp_lt_u32 s2, 176
s_cbranch_scc1 L_p0_b3
s_mov_b32 s14, 663552
s_mov_b32 s15, 0x20000
s_mul_i32 s30, s38, 165888
s_lshl_b32 s31, s52, 7
s_add_u32 s30, s30, s31
s_mul_i32 s31, s24, 9216
s_add_u32 s30, s30, s31
s_add_u32 s30, s30, s53
v_lshrrev_b32 v36, 7, v1
v_mul_u32_u24 v42, 1152, v36
v_and_b32 v36, 0x70, v1
v_add_u32 v42, v36, v42
s_lshl_b32 s32, s24, 10
s_mov_b32 s12, s68
s_mov_b32 s13, s69
s_add_u32 m0, s32, 40960
s_add_u32 s31, s30, 0
buffer_load_dwordx4 v42, s[12:15], s31 offen nt lds
s_add_u32 m0, s32, 45056
s_add_u32 s31, s30, 36864
buffer_load_dwordx4 v42, s[12:15], s31 offen nt lds
s_add_u32 m0, s32, 49152
s_add_u32 s31, s30, 73728
buffer_load_dwordx4 v42, s[12:15], s31 offen nt lds
s_add_u32 m0, s32, 53248
s_add_u32 s31, s30, 110592
buffer_load_dwordx4 v42, s[12:15], s31 offen nt lds
s_add_u32 m0, s32, 57344
s_add_u32 s31, s30, 147456
s_cmp_lt_u32 s24, 2
s_cselect_b32 s31, s31, 1073741824
buffer_load_dwordx4 v42, s[12:15], s31 offen nt lds
s_branch L_p0_j3
L_p0_b3:
s_mov_b32 s14, 2654208
s_mov_b32 s15, 0x20000
s_mul_i32 s30, s38, 165888
s_lshl_b32 s31, s52, 7
s_add_u32 s30, s30, s31
s_mul_i32 s31, s24, 9216
s_add_u32 s30, s30, s31
s_add_u32 s30, s30, s53
v_lshrrev_b32 v36, 7, v1
v_mul_u32_u24 v42, 1152, v36
v_and_b32 v36, 0x70, v1
v_add_u32 v42, v36, v42
s_lshl_b32 s32, s24, 10
s_mov_b32 s12, s78
s_mov_b32 s13, s79
s_add_u32 m0, s32, 40960
s_add_u32 s31, s30, 0
buffer_load_dwordx4 v42, s[12:15], s31 offen nt lds
s_add_u32 m0, s32, 45056
s_add_u32 s31, s30, 36864
buffer_load_dwordx4 v42, s[12:15], s31 offen nt lds
s_add_u32 m0, s32, 49152
s_add_u32 s31, s30, 73728
buffer_load_dwordx4 v42, s[12:15], s31 offen nt lds
s_add_u32 m0, s32, 53248
s_add_u32 s31, s30, 110592
buffer_load_dwordx4 v42, s[12:15], s31 offen nt lds
s_add_u32 m0, s32, 57344
s_add_u32 s31, s30, 147456
s_cmp_lt_u32 s24, 2
s_cselect_b32 s31, s31, 1073741824
buffer_load_dwordx4 v42, s[12:15], s31 offen nt lds
s_branch L_p0_j3
L_p0_a3:
s_mov_b32 s14, 5308416
s_mov_b32 s15, 0x20000
s_mul_i32 s30, s38, 1327104
s_lshl_b32 s31, s52, 7
s_add_u32 s30, s30, s31
s_mul_i32 s31, s24, 73728
s_add_u32 s30, s30, s31
s_add_u32 s30, s30, s53
v_lshrrev_b32 v36, 7, v1
v_mul_u32_u24 v42, 9216, v36
v_and_b32 v36, 0x70, v1
v_add_u32 v42, v36, v42
s_lshl_b32 s32, s24, 10
s_mov_b32 s12, s72
s_mov_b32 s13, s73
s_add_u32 m0, s32, 40960
s_add_u32 s31, s30, 0
buffer_load_dwordx4 v42, s[12:15], s31 offen nt lds
s_add_u32 m0, s32, 45056
s_add_u32 s31, s30, 294912
buffer_load_dwordx4 v42, s[12:15], s31 offen nt lds
s_add_u32 m0, s32, 49152
s_add_u32 s31, s30, 589824
buffer_load_dwordx4 v42, s[12:15], s31 offen nt lds
s_add_u32 m0, s32, 53248
s_add_u32 s31, s30, 884736
buffer_load_dwordx4 v42, s[12:15], s31 offen nt lds
s_add_u32 m0, s32, 57344
s_add_u32 s31, s30, 1179648
s_cmp_lt_u32 s24, 2
s_cselect_b32 s31, s31, 1073741824
buffer_load_dwordx4 v42, s[12:15], s31 offen nt lds
L_p0_j3:
s_waitcnt vmcnt(6)
s_barrier
ds_read_b64_tr_b16 v[84:85], v45 offset:20480
ds_read_b64_tr_b16 v[86:87], v45 offset:20992
ds_read_b64_tr_b16 v[88:89], v45 offset:24576
ds_read_b64_tr_b16 v[90:91], v45 offset:25088
ds_read_b64_tr_b16 v[92:93], v45 offset:28672
ds_read_b64_tr_b16 v[94:95], v45 offset:29184
ds_read_b64_tr_b16 v[96:97], v45 offset:32768
ds_read_b64_tr_b16 v[98:99], v45 offset:33280
ds_read_b64_tr_b16 v[100:101], v45 offset:36864
ds_read_b64_tr_b16 v[102:103], v45 offset:37376
v_mov_b32 v36, 1073741824
v_mov_b32 v46, 0
v_cndmask_b32 v37, v36, v170, s[50:51]
s_add_u32 s31, s36, 0
s_waitcnt lgkmcnt(8)
buffer_store_dwordx4 v[84:87], v170, s[4:7], s31 offen sc1
s_add_u32 s31, s36, 1024
s_waitcnt lgkmcnt(6)
buffer_store_dwordx4 v[88:91], v170, s[4:7], s31 offen sc1
s_add_u32 s31, s36, 2048
s_waitcnt lgkmcnt(4)
buffer_store_dwordx4 v[92:95], v170, s[4:7], s31 offen sc1
s_add_u32 s31, s36, 3072
s_waitcnt lgkmcnt(2)
buffer_store_dwordx4 v[96:99], v170, s[4:7], s31 offen sc1
s_add_u32 s31, s36, 4096
s_waitcnt lgkmcnt(0)
buffer_store_dwordx4 v[100:103], v37, s[4:7], s31 offen sc1
v_mov_b32 v37, 0x3f803f80
v_dot2c_f32_bf16 v46, v84, v37
v_dot2c_f32_bf16 v46, v85, v37
v_dot2c_f32_bf16 v46, v86, v37
v_dot2c_f32_bf16 v46, v87, v37
v_dot2c_f32_bf16 v46, v88, v37
v_dot2c_f32_bf16 v46, v89, v37
v_dot2c_f32_bf16 v46, v90, v37
v_dot2c_f32_bf16 v46, v91, v37
v_dot2c_f32_bf16 v46, v92, v37
v_dot2c_f32_bf16 v46, v93, v37
v_dot2c_f32_bf16 v46, v94, v37
v_dot2c_f32_bf16 v46, v95, v37
v_dot2c_f32_bf16 v46, v96, v37
v_dot2c_f32_bf16 v46, v97, v37
v_dot2c_f32_bf16 v46, v98, v37
v_dot2c_f32_bf16 v46, v99, v37
v_dot2c_f32_bf16 v46, v100, v37
v_dot2c_f32_bf16 v46, v101, v37
v_dot2c_f32_bf16 v46, v102, v37
v_dot2c_f32_bf16 v46, v103, v37
s_nop 2
v_mov_b32 v37, v46
s_nop 1
v_permlane32_swap_b32 v46, v37
v_add_f32 v46, v46, v37
v_mov_b32 v37, v46
s_nop 1
v_permlane16_swap_b32 v46, v37
v_add_f32 v46, v46, v37
v_cvt_pk_bf16_f32 v50, v46, v46
v_and_b32 v37, 0xffff0000, v50
v_sub_f32 v37, v46, v37
v_cvt_pk_bf16_f32 v51, v37, v37
v_cndmask_b32 v36, v36, v171, s[46:47]
buffer_store_dwordx2 v[50:51], v36, s[4:7], s36 offen sc1
s_waitcnt vmcnt(6)
s_barrier
s_cmp_lt_u32 s2, 32
s_cbranch_scc1 L_p0_a4
s_cmp_lt_u32 s2, 176
s_cbranch_scc1 L_p0_b4
ds_read_b64_tr_b16 v[104:105], v52 offset:40960
ds_read_b64_tr_b16 v[106:107], v52 offset:43264
ds_read_b64_tr_b16 v[108:109], v52 offset:45568
ds_read_b64_tr_b16 v[110:111], v52 offset:47872
ds_read_b64_tr_b16 v[112:113], v52 offset:50176
ds_read_b64_tr_b16 v[114:115], v52 offset:52480
ds_read_b64_tr_b16 v[116:117], v52 offset:54784
ds_read_b64_tr_b16 v[118:119], v52 offset:57088
ds_read_b64_tr_b16 v[120:121], v53 offset:40960
ds_read_b64_tr_b16 v[122:123], v53 offset:45568
v_mov_b32 v36, 1073741824
v_mov_b32 v46, 0
v_cndmask_b32 v37, v36, v173, s[50:51]
s_add_u32 s31, s53, 0
s_waitcnt lgkmcnt(8)
buffer_store_dwordx4 v[104:107], v172, s[4:7], s31 offen sc1
s_add_u32 s31, s53, 4608
s_waitcnt lgkmcnt(6)
buffer_store_dwordx4 v[108:111], v172, s[4:7], s31 offen sc1
s_add_u32 s31, s53, 9216
s_waitcnt lgkmcnt(4)
buffer_store_dwordx4 v[112:115], v172, s[4:7], s31 offen sc1
s_add_u32 s31, s53, 13824
s_waitcnt lgkmcnt(2)
buffer_store_dwordx4 v[116:119], v172, s[4:7], s31 offen sc1
s_add_u32 s31, s53, 0
s_waitcnt lgkmcnt(0)
buffer_store_dwordx4 v[120:123], v37, s[4:7], s31 offen sc1
buffer_store_dwordx2 v[50:51], v36, s[4:7], s53 offen sc1
s_branch L_p0_j4
L_p0_b4:
ds_read_b64_tr_b16 v[104:105], v45 offset:40960
ds_read_b64_tr_b16 v[106:107], v45 offset:41472
ds_read_b64_tr_b16 v[108:109], v45 offset:45056
ds_read_b64_tr_b16 v[110:111], v45 offset:45568
ds_read_b64_tr_b16 v[112:113], v45 offset:49152
ds_read_b64_tr_b16 v[114:115], v45 offset:49664
ds_read_b64_tr_b16 v[116:117], v45 offset:53248
ds_read_b64_tr_b16 v[118:119], v45 offset:53760
ds_read_b64_tr_b16 v[120:121], v45 offset:57344
ds_read_b64_tr_b16 v[122:123], v45 offset:57856
v_mov_b32 v36, 1073741824
v_mov_b32 v46, 0
v_cndmask_b32 v37, v36, v56, s[50:51]
s_add_u32 s31, s53, 0
s_waitcnt lgkmcnt(8)
buffer_store_dwordx4 v[104:107], v52, s[4:7], s31 offen sc1
s_add_u32 s31, s53, 0
s_waitcnt lgkmcnt(6)
buffer_store_dwordx4 v[108:111], v53, s[4:7], s31 offen sc1
s_add_u32 s31, s53, 0
s_waitcnt lgkmcnt(4)
buffer_store_dwordx4 v[112:115], v54, s[4:7], s31 offen sc1
s_add_u32 s31, s53, 0
s_waitcnt lgkmcnt(2)
buffer_store_dwordx4 v[116:119], v55, s[4:7], s31 offen sc1
s_add_u32 s31, s53, 0
s_waitcnt lgkmcnt(0)
buffer_store_dwordx4 v[120:123], v37, s[4:7], s31 offen sc1
buffer_store_dwordx2 v[50:51], v36, s[4:7], s53 offen sc1
s_branch L_p0_j4
L_p0_a4:
ds_read_b64_tr_b16 v[104:105], v45 offset:40960
ds_read_b64_tr_b16 v[106:107], v45 offset:41472
ds_read_b64_tr_b16 v[108:109], v45 offset:45056
ds_read_b64_tr_b16 v[110:111], v45 offset:45568
ds_read_b64_tr_b16 v[112:113], v45 offset:49152
ds_read_b64_tr_b16 v[114:115], v45 offset:49664
ds_read_b64_tr_b16 v[116:117], v45 offset:53248
ds_read_b64_tr_b16 v[118:119], v45 offset:53760
ds_read_b64_tr_b16 v[120:121], v45 offset:57344
ds_read_b64_tr_b16 v[122:123], v45 offset:57856
v_mov_b32 v36, 1073741824
v_mov_b32 v46, 0
v_cndmask_b32 v37, v36, v172, s[50:51]
s_add_u32 s31, s53, 0
s_waitcnt lgkmcnt(8)
buffer_store_dwordx4 v[104:107], v172, s[4:7], s31 offen sc1
s_add_u32 s31, s53, 1024
s_waitcnt lgkmcnt(6)
buffer_store_dwordx4 v[108:111], v172, s[4:7], s31 offen sc1
s_add_u32 s31, s53, 2048
s_waitcnt lgkmcnt(4)
buffer_store_dwordx4 v[112:115], v172, s[4:7], s31 offen sc1
s_add_u32 s31, s53, 3072
s_waitcnt lgkmcnt(2)
buffer_store_dwordx4 v[116:119], v172, s[4:7], s31 offen sc1
s_add_u32 s31, s53, 4096
s_waitcnt lgkmcnt(0)
buffer_store_dwordx4 v[120:123], v37, s[4:7], s31 offen sc1
v_mov_b32 v37, 0x3f803f80
v_dot2c_f32_bf16 v46, v104, v37
v_dot2c_f32_bf16 v46, v105, v37
v_dot2c_f32_bf16 v46, v106, v37
v_dot2c_f32_bf16 v46, v107, v37
v_dot2c_f32_bf16 v46, v108, v37
v_dot2c_f32_bf16 v46, v109, v37
v_dot2c_f32_bf16 v46, v110, v37
v_dot2c_f32_bf16 v46, v111, v37
v_dot2c_f32_bf16 v46, v112, v37
v_dot2c_f32_bf16 v46, v113, v37
v_dot2c_f32_bf16 v46, v114, v37
v_dot2c_f32_bf16 v46, v115, v37
v_dot2c_f32_bf16 v46, v116, v37
v_dot2c_f32_bf16 v46, v117, v37
v_dot2c_f32_bf16 v46, v118, v37
v_dot2c_f32_bf16 v46, v119, v37
v_dot2c_f32_bf16 v46, v120, v37
v_dot2c_f32_bf16 v46, v121, v37
v_dot2c_f32_bf16 v46, v122, v37
v_dot2c_f32_bf16 v46, v123, v37
s_nop 2
v_mov_b32 v37, v46
s_nop 1
v_permlane32_swap_b32 v46, v37
v_add_f32 v46, v46, v37
v_mov_b32 v37, v46
s_nop 1
v_permlane16_swap_b32 v46, v37
v_add_f32 v46, v46, v37
v_cvt_pk_bf16_f32 v50, v46, v46
v_and_b32 v37, 0xffff0000, v50
v_sub_f32 v37, v46, v37
v_cvt_pk_bf16_f32 v51, v37, v37
v_cndmask_b32 v36, v36, v173, s[46:47]
buffer_store_dwordx2 v[50:51], v36, s[4:7], s53 offen sc1
L_p0_j4:
s_mov_b32 s12, s74
s_mov_b32 s13, s75
s_mov_b32 s14, 8388608
s_mov_b32 s15, 0x20000
s_cmp_eq_u32 s24, 1
s_cselect_b32 s63, 0, 1073741824
s_add_u32 s63, s63, 19415040
s_mov_b32 exec_lo, 0x000001ff
s_mov_b32 exec_hi, 0x00ffffff
buffer_load_dwordx2 v[176:177], v174, s[4:7], s63 offen sc1
s_mov_b64 exec, -1
s_cmp_eq_u32 s24, 1
s_cbranch_scc0 L_p0done_10
s_mov_b32 s31, 0
s_mov_b32 exec_lo, 0x000001ff
s_mov_b32 exec_hi, 0x00ffffff
s_waitcnt vmcnt(0)
v_cmp_ne_u64 vcc, v[176:177], v[238:239]
s_nop 0
s_cbranch_vccz L_p0done_10
L_p0poll_9:
buffer_load_dwordx2 v[176:177], v174, s[4:7], s63 offen sc1
s_add_u32 s31, s31, 1
s_waitcnt vmcnt(0)
v_cmp_ne_u64 vcc, v[176:177], v[238:239]
s_cmp_gt_u32 s31, 200000
s_cbranch_scc1 L_p0done_10
s_cbranch_vccnz L_p0poll_9
L_p0done_10:
s_mov_b64 exec, -1
s_barrier
s_lshl_b32 s33, s25, 8
s_lshl_b32 s32, s24, 6
s_add_u32 s33, s33, s32
v_lshlrev_b32 v8, 1, v2
buffer_load_ushort v0, v8, s[20:23], s33 offen
buffer_load_ushort v249, v8, s[20:23], s33 offen offset:32
s_mul_i32 s30, s70, 18432
s_mul_i32 s31, s28, 2304
s_add_u32 s30, s30, s31
s_add_u32 s30, s30, 0
v_and_b32 v6, 1, v3
v_lshlrev_b32 v6, 3, v6
v_lshl_add_u32 v6, v2, 4, v6
buffer_load_dwordx4 v[36:39], v1, s[8:11], s30 offen sc1
buffer_load_dwordx4 v[40:43], v1, s[8:11], s30 offen offset:1024 sc1
buffer_load_dwordx2 v[44:45], v6, s[8:11], s30 offen offset:2048 sc1
s_mul_i32 s36, s26, 132608
s_mul_i32 s38, s24, 12288
s_add_u32 m0, s38, 0
s_add_u32 s39, s38, s36
buffer_load_dwordx4 v1, s[4:7], s39 offen offset:0 sc1 lds
buffer_load_dwordx4 v1, s[4:7], s39 offen offset:1024 sc1 lds
buffer_load_dwordx4 v1, s[4:7], s39 offen offset:2048 sc1 lds
buffer_load_dwordx4 v1, s[4:7], s39 offen offset:3072 sc1 lds
s_add_u32 m0, m0, 4096
s_add_u32 s39, s39, 4096
buffer_load_dwordx4 v1, s[4:7], s39 offen offset:0 sc1 lds
buffer_load_dwordx4 v1, s[4:7], s39 offen offset:1024 sc1 lds
buffer_load_dwordx4 v1, s[4:7], s39 offen offset:2048 sc1 lds
buffer_load_dwordx4 v1, s[4:7], s39 offen offset:3072 sc1 lds
s_add_u32 m0, m0, 4096
s_add_u32 s39, s39, 4096
buffer_load_dwordx4 v1, s[4:7], s39 offen offset:0 sc1 lds
buffer_load_dwordx4 v1, s[4:7], s39 offen offset:1024 sc1 lds
buffer_load_dwordx4 v1, s[4:7], s39 offen offset:2048 sc1 lds
buffer_load_dwordx4 v1, s[4:7], s39 offen offset:3072 sc1 lds
v_and_b32 v6, 1, v2
v_cmp_eq_u32 s[40:41], 1, v6
v_lshl_add_u32 v6, v3, 2, v6
v_cmp_le_u32 s[42:43], v6, v2
v_add_u32 v6, 2, v6
v_cmp_le_u32 s[44:45], v6, v2
v_mov_b32 v6, 0x0c0c0100
v_mov_b32 v7, 0x01000c0c
v_cndmask_b32 v6, v6, v7, s[40:41]
v_mov_b32 v8, 0x0c0c0c0c
v_cndmask_b32 v10, v6, v8, s[42:43]
v_cndmask_b32 v12, v8, v6, s[42:43]
v_mov_b32 v6, 0x0c0c0302
v_mov_b32 v7, 0x03020c0c
v_cndmask_b32 v6, v6, v7, s[40:41]
v_cndmask_b32 v11, v6, v8, s[44:45]
v_cndmask_b32 v13, v8, v6, s[44:45]
s_mul_i32 s82, s26, 340992
s_add_u32 s82, s82, 2785280
s_mul_i32 s83, s28, 331776
s_add_u32 s83, s83, 8241152
s_and_b32 s30, s27, 1
s_mul_i32 s30, s30, 165888
s_add_u32 s83, s83, s30
s_waitcnt vmcnt(12)
v_lshlrev_b32 v16, 16, v36
v_and_b32 v17, 0xffff0000, v36
v_lshlrev_b32 v18, 16, v37
v_and_b32 v19, 0xffff0000, v37
v_lshlrev_b32 v20, 16, v38
v_and_b32 v21, 0xffff0000, v38
v_lshlrev_b32 v22, 16, v39
v_and_b32 v23, 0xffff0000, v39
v_lshlrev_b32 v24, 16, v40
v_and_b32 v25, 0xffff0000, v40
v_lshlrev_b32 v26, 16, v41
v_and_b32 v27, 0xffff0000, v41
v_lshlrev_b32 v28, 16, v42
v_and_b32 v29, 0xffff0000, v42
v_lshlrev_b32 v30, 16, v43
v_and_b32 v31, 0xffff0000, v43
v_lshlrev_b32 v32, 16, v44
v_and_b32 v33, 0xffff0000, v44
v_lshlrev_b32 v34, 16, v45
v_and_b32 v35, 0xffff0000, v45
v_mov_b32 v6, 0
s_barrier
v_mov_b32 v248, v238
s_mov_b64 exec, 1
buffer_store_dwordx2 v[238:239], v6, s[4:7], s100 offen sc1
s_mov_b64 exec, -1
s_mul_i32 s36, s26, 132608
s_mul_i32 s38, s24, 9216
s_add_u32 m0, s38, 49152
s_add_u32 s39, s38, s36
s_add_u32 s39, s39, 49152
buffer_load_dwordx4 v1, s[4:7], s39 offen offset:0 sc1 lds
buffer_load_dwordx4 v1, s[4:7], s39 offen offset:1024 sc1 lds
buffer_load_dwordx4 v1, s[4:7], s39 offen offset:2048 sc1 lds
buffer_load_dwordx4 v1, s[4:7], s39 offen offset:3072 sc1 lds
s_add_u32 m0, m0, 4096
s_add_u32 s39, s39, 4096
buffer_load_dwordx4 v1, s[4:7], s39 offen offset:0 sc1 lds
buffer_load_dwordx4 v1, s[4:7], s39 offen offset:1024 sc1 lds
buffer_load_dwordx4 v1, s[4:7], s39 offen offset:2048 sc1 lds
buffer_load_dwordx4 v1, s[4:7], s39 offen offset:3072 sc1 lds
s_add_u32 m0, m0, 4096
s_add_u32 s39, s39, 4096
buffer_load_dwordx4 v1, s[4:7], s39 offen offset:0 sc1 lds
s_lshl_b32 s60, s25, 3
s_sub_u32 s61, s60, 1
s_max_i32 s61, s61, 0
s_lshl_b32 s30, s24, 1
s_add_u32 s60, s60, s30
s_mul_i32 s30, s61, 18432
s_mul_i32 s62, s60, 18432
v_add_u32 v237, 18432, v1
s_mul_i32 s38, s24, 5120
s_add_u32 m0, s38, 135168
s_add_u32 s39, s38, s30
L_layer:
buffer_load_dwordx4 v1, s[8:11], s39 offen offset:0 sc1 lds
buffer_load_dwordx4 v1, s[8:11], s39 offen offset:1024 sc1 lds
buffer_load_dwordx4 v1, s[8:11], s39 offen offset:2048 sc1 lds
buffer_load_dwordx4 v1, s[8:11], s39 offen offset:3072 sc1 lds
s_add_u32 m0, m0, 4096
s_add_u32 s39, s39, 4096
buffer_load_dwordx4 v1, s[8:11], s39 offen offset:0 sc1 lds
s_barrier
buffer_load_dwordx4 a[0:3], v1, s[8:11], s62 offen offset:0 sc1
buffer_load_dwordx4 a[4:7], v237, s[8:11], s62 offen offset:0 sc1
s_barrier
buffer_load_dwordx4 a[8:11], v1, s[8:11], s62 offen offset:1024 sc1
buffer_load_dwordx4 a[12:15], v237, s[8:11], s62 offen offset:1024 sc1
s_barrier
buffer_load_dwordx4 a[16:19], v1, s[8:11], s62 offen offset:2048 sc1
buffer_load_dwordx4 a[20:23], v237, s[8:11], s62 offen offset:2048 sc1
s_barrier
buffer_load_dwordx4 a[24:27], v1, s[8:11], s62 offen offset:3072 sc1
buffer_load_dwordx4 a[28:31], v237, s[8:11], s62 offen offset:3072 sc1
s_barrier
s_add_u32 s62, s62, 4096
buffer_load_dwordx4 a[32:35], v1, s[8:11], s62 offen offset:0 sc1
buffer_load_dwordx4 a[36:39], v237, s[8:11], s62 offen offset:0 sc1
s_barrier
buffer_load_dwordx4 a[40:43], v1, s[8:11], s62 offen offset:1024 sc1
buffer_load_dwordx4 a[44:47], v237, s[8:11], s62 offen offset:1024 sc1
s_sub_u32 s30, s60, 2
v_add_u32 v6, s30, v3
v_max_i32 v6, 0, v6
v_mov_b32 v7, s61
v_cndmask_b32 v6, v6, v7, s[46:47]
v_lshl_add_u32 v6, v6, 4, v2
v_lshlrev_b32 v129, 3, v6
s_lshl_b32 s30, s24, 10
v_add_u32 v125, s30, v1
v_add_u32 v126, 135168, v1
v_lshrrev_b32 v127, 1, v1
v_add_u32 v127, 129024, v127
s_lshl_b32 s30, s24, 9
v_add_u32 v128, s30, v127
v_add_u32 v8, 64512, v1
s_waitcnt vmcnt(12)
s_barrier
ds_read_b128 a[144:147], v1 offset:0
ds_read_b128 a[148:151], v1 offset:1024
ds_read_b128 a[152:155], v1 offset:2048
ds_read_b128 a[156:159], v1 offset:3072
ds_read_b128 a[160:163], v1 offset:4096
ds_read_b128 a[164:167], v1 offset:5120
ds_read_b128 a[168:171], v1 offset:6144
ds_read_b128 a[172:175], v125 offset:0
ds_read_b128 a[176:179], v126 offset:0
v_lshrrev_b32 v146, 1, v1
s_lshl_b32 s66, s24, 9
s_add_u32 s66, s66, 19447808
s_waitcnt vmcnt(10) lgkmcnt(0)
v_mfma_f32_16x16x32_bf16 v[36:39], a[144:147], a[0:3], 0
ds_read_b128 a[180:183], v1 offset:7168
buffer_load_dwordx4 a[48:51], v1, s[8:11], s62 offen offset:2048 sc1
v_mfma_f32_16x16x32_bf16 v[64:67], a[144:147], a[4:7], 0
ds_read_b128 a[184:187], v1 offset:8192
v_mfma_f32_16x16x32_bf16 v[40:43], a[148:151], a[0:3], 0
ds_read_b128 a[188:191], v1 offset:9216
v_mfma_f32_16x16x32_bf16 v[68:71], a[148:151], a[4:7], 0
ds_read_b128 a[192:195], v1 offset:10240
v_mfma_f32_16x16x32_bf16 v[44:47], a[152:155], a[0:3], 0
ds_read_b128 a[196:199], v1 offset:11264
buffer_load_dwordx4 a[52:55], v237, s[8:11], s62 offen offset:2048 sc1
v_mfma_f32_16x16x32_bf16 v[72:75], a[152:155], a[4:7], 0
ds_read_b128 a[200:203], v1 offset:12288
v_mfma_f32_16x16x32_bf16 v[48:51], a[156:159], a[0:3], 0
ds_read_b128 a[204:207], v1 offset:13312
v_mfma_f32_16x16x32_bf16 v[76:79], a[156:159], a[4:7], 0
ds_read_b128 a[208:211], v125 offset:7168
v_mfma_f32_16x16x32_bf16 v[52:55], a[160:163], a[0:3], 0
ds_read_b128 a[212:215], v126 offset:1024
buffer_load_dwordx4 a[56:59], v1, s[8:11], s62 offen offset:3072 sc1
v_mfma_f32_16x16x32_bf16 v[80:83], a[160:163], a[4:7], 0
v_mfma_f32_16x16x32_bf16 v[92:95], a[172:175], a[176:179], 0
v_mfma_f32_16x16x32_bf16 v[96:99], a[160:163], a[176:179], 0
v_mfma_f32_16x16x32_bf16 v[56:59], a[164:167], a[0:3], 0
buffer_load_dwordx4 a[60:63], v237, s[8:11], s62 offen offset:3072 sc1
v_mfma_f32_16x16x32_bf16 v[84:87], a[164:167], a[4:7], 0
s_add_u32 s62, s62, 4096
v_mfma_f32_16x16x32_bf16 v[60:63], a[168:171], a[0:3], 0
v_mfma_f32_16x16x32_bf16 v[88:91], a[168:171], a[4:7], 0
s_waitcnt vmcnt(12) lgkmcnt(0)
v_mfma_f32_16x16x32_bf16 v[36:39], a[180:183], a[8:11], v[36:39]
ds_read_b128 a[144:147], v1 offset:14336
v_lshlrev_b32 v124, 2, v2
v_mfma_f32_16x16x32_bf16 v[64:67], a[180:183], a[12:15], v[64:67]
ds_read_b128 a[148:151], v1 offset:15360
v_and_b32 v6, 1, v2
v_mfma_f32_16x16x32_bf16 v[40:43], a[184:187], a[8:11], v[40:43]
ds_read_b128 a[152:155], v1 offset:16384
v_mfma_f32_16x16x32_bf16 v[68:71], a[184:187], a[12:15], v[68:71]
ds_read_b128 a[156:159], v1 offset:17408
v_lshl_add_u32 v6, v3, 2, v6
v_mfma_f32_16x16x32_bf16 v[44:47], a[188:191], a[8:11], v[44:47]
ds_read_b128 a[160:163], v1 offset:18432
v_lshlrev_b32 v6, 2, v6
v_mfma_f32_16x16x32_bf16 v[72:75], a[188:191], a[12:15], v[72:75]
ds_read_b128 a[164:167], v1 offset:19456
buffer_load_dwordx4 a[64:67], v1, s[8:11], s62 offen offset:0 sc1
v_mfma_f32_16x16x32_bf16 v[48:51], a[192:195], a[8:11], v[48:51]
ds_read_b128 a[168:171], v1 offset:20480
v_add_u32 v122, 64, v6
v_mfma_f32_16x16x32_bf16 v[76:79], a[192:195], a[12:15], v[76:79]
ds_read_b128 a[172:175], v125 offset:14336
v_mfma_f32_16x16x32_bf16 v[52:55], a[196:199], a[8:11], v[52:55]
ds_read_b128 a[176:179], v126 offset:2048
v_add_u32 v7, 128, v6
v_mfma_f32_16x16x32_bf16 v[80:83], a[196:199], a[12:15], v[80:83]
buffer_load_dwordx4 a[68:71], v237, s[8:11], s62 offen offset:0 sc1
v_cndmask_b32 v122, v122, v7, s[42:43]
v_mfma_f32_16x16x32_bf16 v[92:95], a[208:211], a[212:215], v[92:95]
v_mfma_f32_16x16x32_bf16 v[96:99], a[196:199], a[212:215], v[96:99]
v_add_u32 v123, 72, v6
v_mfma_f32_16x16x32_bf16 v[56:59], a[200:203], a[8:11], v[56:59]
v_mfma_f32_16x16x32_bf16 v[84:87], a[200:203], a[12:15], v[84:87]
v_add_u32 v7, 136, v6
v_mfma_f32_16x16x32_bf16 v[60:63], a[204:207], a[8:11], v[60:63]
buffer_load_dwordx4 a[72:75], v1, s[8:11], s62 offen offset:1024 sc1
v_cndmask_b32 v123, v123, v7, s[44:45]
v_mfma_f32_16x16x32_bf16 v[88:91], a[204:207], a[12:15], v[88:91]
s_mov_b32 s63, 2359296
s_waitcnt vmcnt(13) lgkmcnt(0)
v_mfma_f32_16x16x32_bf16 v[36:39], a[144:147], a[16:19], v[36:39]
ds_read_b128 a[180:183], v1 offset:21504
s_lshl_b32 s31, s24, 5
v_mfma_f32_16x16x32_bf16 v[64:67], a[144:147], a[20:23], v[64:67]
ds_read_b128 a[184:187], v1 offset:22528
v_mfma_f32_16x16x32_bf16 v[40:43], a[148:151], a[16:19], v[40:43]
ds_read_b128 a[188:191], v1 offset:23552
v_add_u32 v6, s31, v2
v_mfma_f32_16x16x32_bf16 v[68:71], a[148:151], a[20:23], v[68:71]
ds_read_b128 a[192:195], v1 offset:24576
v_mul_u32_u24 v220, 176, v6
v_mfma_f32_16x16x32_bf16 v[44:47], a[152:155], a[16:19], v[44:47]
ds_read_b128 a[196:199], v1 offset:25600
v_mfma_f32_16x16x32_bf16 v[72:75], a[152:155], a[20:23], v[72:75]
ds_read_b128 a[200:203], v1 offset:26624
v_add_u32 v220, 0, v220
v_mfma_f32_16x16x32_bf16 v[48:51], a[156:159], a[16:19], v[48:51]
ds_read_b128 a[204:207], v1 offset:27648
buffer_load_dwordx2 v[100:101], v129, s[8:11], s63 offen sc1
v_mfma_f32_16x16x32_bf16 v[76:79], a[156:159], a[20:23], v[76:79]
ds_read_b128 a[208:211], v125 offset:21504
v_lshl_add_u32 v218, v3, 3, v220
v_mfma_f32_16x16x32_bf16 v[52:55], a[160:163], a[16:19], v[52:55]
ds_read_b128 a[212:215], v126 offset:3072
s_mul_i32 s36, s26, 132608
v_mfma_f32_16x16x32_bf16 v[80:83], a[160:163], a[20:23], v[80:83]
s_mov_b32 s63, 2375680
v_mul_u32_u24 v219, 176, v2
v_mfma_f32_16x16x32_bf16 v[92:95], a[172:175], a[176:179], v[92:95]
s_mul_i32 s38, s24, 12288
v_lshl_add_u32 v219, v3, 3, v219
v_mfma_f32_16x16x32_bf16 v[96:99], a[160:163], a[176:179], v[96:99]
s_add_u32 m0, s38, 86016
v_mfma_f32_16x16x32_bf16 v[56:59], a[164:167], a[16:19], v[56:59]
s_add_u32 s39, s38, s36
v_add_u32 v219, 0, v219
v_mfma_f32_16x16x32_bf16 v[84:87], a[164:167], a[20:23], v[84:87]
s_add_u32 s39, s39, 86016
v_add_u32 v222, s31, v219
v_mfma_f32_16x16x32_bf16 v[60:63], a[168:171], a[16:19], v[60:63]
v_mfma_f32_16x16x32_bf16 v[88:91], a[168:171], a[20:23], v[88:91]
buffer_load_dwordx2 v[102:103], v129, s[8:11], s63 offen sc1
s_waitcnt vmcnt(13) lgkmcnt(0)
v_mfma_f32_16x16x32_bf16 v[36:39], a[180:183], a[24:27], v[36:39]
ds_read_b128 a[144:147], v1 offset:28672
v_lshrrev_b32 v6, 2, v2
v_mfma_f32_16x16x32_bf16 v[64:67], a[180:183], a[28:31], v[64:67]
ds_read_b128 a[148:151], v1 offset:29696
v_lshl_add_u32 v6, v3, 2, v6
v_mfma_f32_16x16x32_bf16 v[40:43], a[184:187], a[24:27], v[40:43]
ds_read_b128 a[152:155], v1 offset:30720
v_add_u32 v6, s31, v6
v_mfma_f32_16x16x32_bf16 v[68:71], a[184:187], a[28:31], v[68:71]
ds_read_b128 a[156:159], v1 offset:31744
s_mov_b32 s63, 2392064
v_mfma_f32_16x16x32_bf16 v[44:47], a[188:191], a[24:27], v[44:47]
ds_read_b128 a[160:163], v1 offset:32768
v_mul_u32_u24 v221, 176, v6
v_mfma_f32_16x16x32_bf16 v[72:75], a[188:191], a[28:31], v[72:75]
ds_read_b128 a[164:167], v1 offset:33792
v_and_b32 v6, 3, v2
v_mfma_f32_16x16x32_bf16 v[48:51], a[192:195], a[24:27], v[48:51]
ds_read_b128 a[168:171], v1 offset:34816
v_mfma_f32_16x16x32_bf16 v[76:79], a[192:195], a[28:31], v[76:79]
ds_read_b128 a[172:175], v125 offset:28672
buffer_load_dwordx2 v[104:105], v129, s[8:11], s63 offen sc1
v_mfma_f32_16x16x32_bf16 v[52:55], a[196:199], a[24:27], v[52:55]
ds_read_b128 a[176:179], v126 offset:4096
v_lshl_add_u32 v221, v6, 3, v221
v_mfma_f32_16x16x32_bf16 v[80:83], a[196:199], a[28:31], v[80:83]
s_mov_b32 s63, 2408448
v_add_u32 v221, 0, v221
v_mfma_f32_16x16x32_bf16 v[92:95], a[208:211], a[212:215], v[92:95]
v_mov_b32 v171, 0
v_mfma_f32_16x16x32_bf16 v[96:99], a[196:199], a[212:215], v[96:99]
v_mfma_f32_16x16x32_bf16 v[56:59], a[200:203], a[24:27], v[56:59]
buffer_load_dwordx4 v1, s[4:7], s39 offen offset:0 sc1 lds
v_mov_b32 v172, 0
v_mfma_f32_16x16x32_bf16 v[84:87], a[200:203], a[28:31], v[84:87]
v_mfma_f32_16x16x32_bf16 v[60:63], a[204:207], a[24:27], v[60:63]
v_mov_b32 v179, 0
v_mfma_f32_16x16x32_bf16 v[88:91], a[204:207], a[28:31], v[88:91]
v_mov_b32 v180, 0
s_waitcnt vmcnt(13) lgkmcnt(0)
v_mfma_f32_16x16x32_bf16 v[36:39], a[144:147], a[32:35], v[36:39]
ds_read_b128 a[180:183], v1 offset:35840
buffer_load_dwordx2 v[106:107], v129, s[8:11], s63 offen sc1
v_mfma_f32_16x16x32_bf16 v[64:67], a[144:147], a[36:39], v[64:67]
ds_read_b128 a[184:187], v1 offset:36864
buffer_load_dwordx4 v1, s[4:7], s39 offen offset:1024 sc1 lds
v_mfma_f32_16x16x32_bf16 v[40:43], a[148:151], a[32:35], v[40:43]
ds_read_b128 a[188:191], v1 offset:37888
s_mul_i32 s30, s60, 18432
v_mfma_f32_16x16x32_bf16 v[68:71], a[148:151], a[36:39], v[68:71]
ds_read_b128 a[192:195], v1 offset:38912
s_add_u32 s30, s30, 2490368
v_mfma_f32_16x16x32_bf16 v[44:47], a[152:155], a[32:35], v[44:47]
ds_read_b128 a[196:199], v1 offset:39936
buffer_load_dwordx4 v1, s[4:7], s39 offen offset:2048 sc1 lds
v_mfma_f32_16x16x32_bf16 v[72:75], a[152:155], a[36:39], v[72:75]
ds_read_b128 a[200:203], v1 offset:40960
s_mov_b32 s63, 2424832
v_mfma_f32_16x16x32_bf16 v[48:51], a[156:159], a[32:35], v[48:51]
ds_read_b128 a[204:207], v1 offset:41984
s_lshl_b32 s64, s26, 10
v_mfma_f32_16x16x32_bf16 v[76:79], a[156:159], a[36:39], v[76:79]
ds_read_b128 a[208:211], v125 offset:35840
s_add_u32 s64, s64, s30
v_mfma_f32_16x16x32_bf16 v[52:55], a[160:163], a[32:35], v[52:55]
ds_read_b128 a[212:215], v126 offset:5120
buffer_load_dwordx2 v[108:109], v129, s[8:11], s63 offen sc1
v_mfma_f32_16x16x32_bf16 v[80:83], a[160:163], a[36:39], v[80:83]
buffer_load_dwordx4 v1, s[4:7], s39 offen offset:3072 sc1 lds
s_and_b32 s65, s26, 1
v_mfma_f32_16x16x32_bf16 v[92:95], a[172:175], a[176:179], v[92:95]
s_mov_b32 s63, 2441216
s_lshl_b32 s65, s65, 10
v_mfma_f32_16x16x32_bf16 v[96:99], a[160:163], a[176:179], v[96:99]
s_add_u32 m0, m0, 4096
s_add_u32 s30, s30, s65
v_mfma_f32_16x16x32_bf16 v[56:59], a[164:167], a[32:35], v[56:59]
s_add_u32 s39, s39, 4096
v_mfma_f32_16x16x32_bf16 v[84:87], a[164:167], a[36:39], v[84:87]
s_lshr_b32 s65, s26, 1
v_mfma_f32_16x16x32_bf16 v[60:63], a[168:171], a[32:35], v[60:63]
s_lshl_b32 s65, s65, 7
v_mfma_f32_16x16x32_bf16 v[88:91], a[168:171], a[36:39], v[88:91]
s_add_u32 s65, s65, s30
s_waitcnt vmcnt(16) lgkmcnt(0)
v_mfma_f32_16x16x32_bf16 v[36:39], a[180:183], a[40:43], v[36:39]
ds_read_b128 a[144:147], v1 offset:43008
v_mfma_f32_16x16x32_bf16 v[64:67], a[180:183], a[44:47], v[64:67]
ds_read_b128 a[148:151], v1 offset:44032
buffer_load_dwordx2 v[110:111], v129, s[8:11], s63 offen sc1
v_mfma_f32_16x16x32_bf16 v[40:43], a[184:187], a[40:43], v[40:43]
ds_read_b128 a[152:155], v1 offset:45056
s_add_u32 s65, s65, 16384
v_mfma_f32_16x16x32_bf16 v[68:71], a[184:187], a[44:47], v[68:71]
ds_read_b128 a[156:159], v1 offset:46080
v_mov_b32 v224, 1073741824
v_mfma_f32_16x16x32_bf16 v[44:47], a[188:191], a[40:43], v[44:47]
ds_read_b128 a[160:163], v1 offset:47104
buffer_load_dwordx4 v1, s[4:7], s39 offen offset:0 sc1 lds
v_mfma_f32_16x16x32_bf16 v[72:75], a[188:191], a[44:47], v[72:75]
ds_read_b128 a[164:167], v1 offset:48128
s_mov_b32 s63, 2457600
v_mfma_f32_16x16x32_bf16 v[48:51], a[192:195], a[40:43], v[48:51]
ds_read_b128 a[168:171], v1 offset:49152
v_lshlrev_b32 v225, 3, v2
v_mfma_f32_16x16x32_bf16 v[76:79], a[192:195], a[44:47], v[76:79]
ds_read_b128 a[172:175], v125 offset:43008
v_cndmask_b32 v224, v224, v225, s[46:47]
v_mfma_f32_16x16x32_bf16 v[52:55], a[196:199], a[40:43], v[52:55]
ds_read_b128 a[176:179], v126 offset:6144
buffer_load_dwordx4 v1, s[4:7], s39 offen offset:1024 sc1 lds
v_mfma_f32_16x16x32_bf16 v[80:83], a[196:199], a[44:47], v[80:83]
v_add_u32 v225, 18432, v224
v_mfma_f32_16x16x32_bf16 v[92:95], a[208:211], a[212:215], v[92:95]
buffer_load_dwordx2 v[112:113], v129, s[8:11], s63 offen sc1
s_lshl_b32 s68, s24, 13
v_mfma_f32_16x16x32_bf16 v[96:99], a[196:199], a[212:215], v[96:99]
s_mov_b32 s63, 2473984
v_add_u32 v6, 0, v3
v_mfma_f32_16x16x32_bf16 v[56:59], a[200:203], a[40:43], v[56:59]
buffer_load_dwordx4 v1, s[4:7], s39 offen offset:2048 sc1 lds
v_mfma_f32_16x16x32_bf16 v[84:87], a[200:203], a[44:47], v[84:87]
v_xor_b32 v7, v6, v2
v_mfma_f32_16x16x32_bf16 v[60:63], a[204:207], a[40:43], v[60:63]
v_mfma_f32_16x16x32_bf16 v[88:91], a[204:207], a[44:47], v[88:91]
v_lshlrev_b32 v6, 12, v6
s_waitcnt vmcnt(19) lgkmcnt(0)
v_mfma_f32_16x16x32_bf16 v[36:39], a[144:147], a[48:51], v[36:39]
ds_read_b128 a[180:183], v1 offset:50176
buffer_load_dwordx4 v1, s[4:7], s39 offen offset:3072 sc1 lds
v_mfma_f32_16x16x32_bf16 v[64:67], a[144:147], a[52:55], v[64:67]
ds_read_b128 a[184:187], v1 offset:51200
v_lshl_add_u32 v240, v7, 4, v6
v_mfma_f32_16x16x32_bf16 v[40:43], a[148:151], a[48:51], v[40:43]
ds_read_b128 a[188:191], v1 offset:52224
buffer_load_dwordx2 v[114:115], v129, s[8:11], s63 offen sc1
v_mfma_f32_16x16x32_bf16 v[68:71], a[148:151], a[52:55], v[68:71]
ds_read_b128 a[192:195], v1 offset:53248
v_lshlrev_b32 v7, 4, v7
v_mfma_f32_16x16x32_bf16 v[44:47], a[152:155], a[48:51], v[44:47]
ds_read_b128 a[196:199], v1 offset:54272
s_add_u32 m0, m0, 4096
v_mfma_f32_16x16x32_bf16 v[72:75], a[152:155], a[52:55], v[72:75]
ds_read_b128 a[200:203], v1 offset:55296
v_lshl_add_u32 v7, v2, 8, v7
v_mfma_f32_16x16x32_bf16 v[48:51], a[156:159], a[48:51], v[48:51]
ds_read_b128 a[204:207], v1 offset:56320
buffer_load_dwordx4 a[76:79], v237, s[8:11], s62 offen offset:1024 sc1
v_mfma_f32_16x16x32_bf16 v[76:79], a[156:159], a[52:55], v[76:79]
ds_read_b128 a[208:211], v125 offset:50176
v_add_u32 v244, s68, v7
v_mfma_f32_16x16x32_bf16 v[52:55], a[160:163], a[48:51], v[52:55]
ds_read_b128 a[212:215], v126 offset:7168
s_add_u32 s39, s39, 4096
v_mfma_f32_16x16x32_bf16 v[80:83], a[160:163], a[52:55], v[80:83]
v_add_u32 v6, 4, v3
v_xor_b32 v7, v6, v2
v_mfma_f32_16x16x32_bf16 v[92:95], a[172:175], a[176:179], v[92:95]
v_lshlrev_b32 v6, 12, v6
v_mfma_f32_16x16x32_bf16 v[96:99], a[160:163], a[176:179], v[96:99]
buffer_load_dwordx4 a[80:83], v1, s[8:11], s62 offen offset:2048 sc1
v_mfma_f32_16x16x32_bf16 v[56:59], a[164:167], a[48:51], v[56:59]
buffer_load_dwordx4 v1, s[4:7], s39 offen offset:0 sc1 lds
v_lshl_add_u32 v241, v7, 4, v6
v_mfma_f32_16x16x32_bf16 v[84:87], a[164:167], a[52:55], v[84:87]
v_mfma_f32_16x16x32_bf16 v[60:63], a[168:171], a[48:51], v[60:63]
v_lshlrev_b32 v7, 4, v7
v_mfma_f32_16x16x32_bf16 v[88:91], a[168:171], a[52:55], v[88:91]
buffer_load_dwordx4 a[84:87], v237, s[8:11], s62 offen offset:2048 sc1
s_waitcnt vmcnt(23) lgkmcnt(0)
v_mfma_f32_16x16x32_bf16 v[36:39], a[180:183], a[56:59], v[36:39]
ds_read_b128 a[144:147], v1 offset:57344
buffer_load_dwordx4 v1, s[4:7], s39 offen offset:1024 sc1 lds
v_mfma_f32_16x16x32_bf16 v[64:67], a[180:183], a[60:63], v[64:67]
ds_read_b128 a[148:151], v1 offset:58368
v_lshl_add_u32 v7, v2, 8, v7
v_mfma_f32_16x16x32_bf16 v[40:43], a[184:187], a[56:59], v[40:43]
ds_read_b128 a[152:155], v1 offset:59392
v_add_u32 v245, s68, v7
v_mfma_f32_16x16x32_bf16 v[68:71], a[184:187], a[60:63], v[68:71]
ds_read_b128 a[156:159], v1 offset:60416
buffer_load_dwordx4 a[88:91], v1, s[8:11], s62 offen offset:3072 sc1
v_mfma_f32_16x16x32_bf16 v[44:47], a[188:191], a[56:59], v[44:47]
ds_read_b128 a[160:163], v1 offset:61440
buffer_load_dwordx4 v1, s[4:7], s39 offen offset:2048 sc1 lds
v_mfma_f32_16x16x32_bf16 v[72:75], a[188:191], a[60:63], v[72:75]
ds_read_b128 a[164:167], v1 offset:62464
v_subrev_u32 v241, 1024, v241
v_mfma_f32_16x16x32_bf16 v[48:51], a[192:195], a[56:59], v[48:51]
ds_read_b128 a[168:171], v1 offset:63488
v_add_u32 v6, 8, v3
v_mfma_f32_16x16x32_bf16 v[76:79], a[192:195], a[60:63], v[76:79]
ds_read_b128 a[172:175], v125 offset:57344
v_xor_b32 v7, v6, v2
v_mfma_f32_16x16x32_bf16 v[52:55], a[196:199], a[56:59], v[52:55]
ds_read_b128 a[176:179], v126 offset:8192
buffer_load_dwordx4 a[92:95], v237, s[8:11], s62 offen offset:3072 sc1
v_mfma_f32_16x16x32_bf16 v[80:83], a[196:199], a[60:63], v[80:83]
buffer_load_dwordx4 v1, s[4:7], s39 offen offset:3072 sc1 lds
v_lshlrev_b32 v6, 12, v6
v_mfma_f32_16x16x32_bf16 v[92:95], a[208:211], a[212:215], v[92:95]
s_add_u32 s62, s62, 4096
v_lshl_add_u32 v242, v7, 4, v6
v_mfma_f32_16x16x32_bf16 v[96:99], a[196:199], a[212:215], v[96:99]
v_lshlrev_b32 v7, 4, v7
v_mfma_f32_16x16x32_bf16 v[56:59], a[200:203], a[56:59], v[56:59]
buffer_load_dwordx2 v[148:149], v146, s[4:7], s66 offen sc1
v_lshl_add_u32 v7, v2, 8, v7
v_mfma_f32_16x16x32_bf16 v[84:87], a[200:203], a[60:63], v[84:87]
v_mfma_f32_16x16x32_bf16 v[60:63], a[204:207], a[56:59], v[60:63]
v_add_u32 v246, s68, v7
v_mfma_f32_16x16x32_bf16 v[88:91], a[204:207], a[60:63], v[88:91]
s_waitcnt vmcnt(27) lgkmcnt(0)
v_add_u32 v125, 64512, v125
v_mfma_f32_16x16x32_bf16 v[36:39], a[144:147], a[64:67], v[36:39]
ds_read_b128 a[180:183], v8 offset:0
buffer_load_dwordx4 a[96:99], v1, s[8:11], s62 offen offset:0 sc1
v_mfma_f32_16x16x32_bf16 v[64:67], a[144:147], a[68:71], v[64:67]
ds_read_b128 a[184:187], v8 offset:1024
v_subrev_u32 v242, 2048, v242
v_mfma_f32_16x16x32_bf16 v[40:43], a[148:151], a[64:67], v[40:43]
ds_read_b128 a[188:191], v8 offset:2048
v_add_u32 v6, 12, v3
v_mfma_f32_16x16x32_bf16 v[68:71], a[148:151], a[68:71], v[68:71]
ds_read_b128 a[192:195], v8 offset:3072
v_xor_b32 v7, v6, v2
v_mfma_f32_16x16x32_bf16 v[44:47], a[152:155], a[64:67], v[44:47]
ds_read_b128 a[196:199], v8 offset:4096
buffer_load_dwordx4 a[100:103], v237, s[8:11], s62 offen offset:0 sc1
v_mfma_f32_16x16x32_bf16 v[72:75], a[152:155], a[68:71], v[72:75]
ds_read_b128 a[200:203], v8 offset:5120
v_lshlrev_b32 v6, 12, v6
v_mfma_f32_16x16x32_bf16 v[48:51], a[156:159], a[64:67], v[48:51]
ds_read_b128 a[204:207], v8 offset:6144
v_lshl_add_u32 v243, v7, 4, v6
v_mfma_f32_16x16x32_bf16 v[76:79], a[156:159], a[68:71], v[76:79]
ds_read_b128 a[208:211], v125 offset:0
v_mfma_f32_16x16x32_bf16 v[52:55], a[160:163], a[64:67], v[52:55]
ds_read_b128 a[212:215], v126 offset:9216
v_lshlrev_b32 v7, 4, v7
v_mfma_f32_16x16x32_bf16 v[80:83], a[160:163], a[68:71], v[80:83]
buffer_load_dwordx4 a[104:107], v1, s[8:11], s62 offen offset:1024 sc1
v_mfma_f32_16x16x32_bf16 v[92:95], a[172:175], a[176:179], v[92:95]
v_lshl_add_u32 v7, v2, 8, v7
v_mfma_f32_16x16x32_bf16 v[96:99], a[160:163], a[176:179], v[96:99]
v_add_u32 v247, s68, v7
v_mfma_f32_16x16x32_bf16 v[56:59], a[164:167], a[64:67], v[56:59]
v_mfma_f32_16x16x32_bf16 v[84:87], a[164:167], a[68:71], v[84:87]
buffer_load_dwordx4 a[108:111], v237, s[8:11], s62 offen offset:1024 sc1
v_subrev_u32 v243, 3072, v243
v_mfma_f32_16x16x32_bf16 v[60:63], a[168:171], a[64:67], v[60:63]
v_mfma_f32_16x16x32_bf16 v[88:91], a[168:171], a[68:71], v[88:91]
s_waitcnt vmcnt(13) lgkmcnt(0)
v_mfma_f32_16x16x32_bf16 v[36:39], a[180:183], a[72:75], v[36:39]
ds_read_b128 a[144:147], v8 offset:7168
v_mfma_f32_16x16x32_bf16 v[64:67], a[180:183], a[76:79], v[64:67]
ds_read_b128 a[148:151], v8 offset:8192
buffer_load_dwordx4 a[112:115], v1, s[8:11], s62 offen offset:2048 sc1
v_mfma_f32_16x16x32_bf16 v[40:43], a[184:187], a[72:75], v[40:43]
ds_read_b128 a[152:155], v8 offset:9216
v_add_f32 v130, v100, v102
v_mfma_f32_16x16x32_bf16 v[68:71], a[184:187], a[76:79], v[68:71]
ds_read_b128 a[156:159], v8 offset:10240
v_add_f32 v131, v101, v103
v_mfma_f32_16x16x32_bf16 v[44:47], a[188:191], a[72:75], v[44:47]
ds_read_b128 a[160:163], v8 offset:11264
v_add_f32 v130, v130, v104
v_mfma_f32_16x16x32_bf16 v[72:75], a[188:191], a[76:79], v[72:75]
ds_read_b128 a[164:167], v8 offset:12288
v_add_f32 v131, v131, v105
v_mfma_f32_16x16x32_bf16 v[48:51], a[192:195], a[72:75], v[48:51]
ds_read_b128 a[168:171], v8 offset:13312
buffer_load_dwordx4 a[116:119], v237, s[8:11], s62 offen offset:2048 sc1
v_mfma_f32_16x16x32_bf16 v[76:79], a[192:195], a[76:79], v[76:79]
ds_read_b128 a[172:175], v125 offset:7168
v_add_f32 v130, v130, v106
v_mfma_f32_16x16x32_bf16 v[52:55], a[196:199], a[72:75], v[52:55]
ds_read_b128 a[176:179], v126 offset:10240
v_add_f32 v131, v131, v107
v_mfma_f32_16x16x32_bf16 v[80:83], a[196:199], a[76:79], v[80:83]
v_add_f32 v130, v130, v108
v_add_f32 v131, v131, v109
v_mfma_f32_16x16x32_bf16 v[92:95], a[208:211], a[212:215], v[92:95]
buffer_load_dwordx4 a[120:123], v1, s[8:11], s62 offen offset:3072 sc1
v_add_f32 v130, v130, v110
v_mfma_f32_16x16x32_bf16 v[96:99], a[196:199], a[212:215], v[96:99]
v_add_f32 v131, v131, v111
v_mfma_f32_16x16x32_bf16 v[56:59], a[200:203], a[72:75], v[56:59]
v_add_f32 v130, v130, v112
v_mfma_f32_16x16x32_bf16 v[84:87], a[200:203], a[76:79], v[84:87]
v_add_f32 v131, v131, v113
v_mfma_f32_16x16x32_bf16 v[60:63], a[204:207], a[72:75], v[60:63]
buffer_load_dwordx4 a[124:127], v237, s[8:11], s62 offen offset:3072 sc1
v_add_f32 v130, v130, v114
v_mfma_f32_16x16x32_bf16 v[88:91], a[204:207], a[76:79], v[88:91]
s_add_u32 s62, s62, 4096
v_add_f32 v131, v131, v115
s_waitcnt vmcnt(14) lgkmcnt(0)
v_mfma_f32_16x16x32_bf16 v[36:39], a[144:147], a[80:83], v[36:39]
ds_read_b128 a[180:183], v8 offset:14336
v_mul_f32 v130, 0x3ae38e39, v130
v_mfma_f32_16x16x32_bf16 v[64:67], a[144:147], a[84:87], v[64:67]
ds_read_b128 a[184:187], v8 offset:15360
v_mul_f32 v6, v130, v130
v_mfma_f32_16x16x32_bf16 v[40:43], a[148:151], a[80:83], v[40:43]
ds_read_b128 a[188:191], v8 offset:16384
v_mul_f32 v131, 0x3ae38e39, v131
v_mfma_f32_16x16x32_bf16 v[68:71], a[148:151], a[84:87], v[68:71]
ds_read_b128 a[192:195], v8 offset:17408
v_mfma_f32_16x16x32_bf16 v[44:47], a[152:155], a[80:83], v[44:47]
ds_read_b128 a[196:199], v8 offset:18432
v_sub_f32 v131, v131, v6
v_mfma_f32_16x16x32_bf16 v[72:75], a[152:155], a[84:87], v[72:75]
ds_read_b128 a[200:203], v8 offset:19456
v_max_f32 v131, 0, v131
v_mfma_f32_16x16x32_bf16 v[48:51], a[156:159], a[80:83], v[48:51]
ds_read_b128 a[204:207], v8 offset:20480
v_add_f32 v131, 0x3727c5ac, v131
v_mfma_f32_16x16x32_bf16 v[76:79], a[156:159], a[84:87], v[76:79]
ds_read_b128 a[208:211], v125 offset:14336
buffer_load_dwordx4 a[128:131], v1, s[8:11], s62 offen offset:0 sc1
v_mfma_f32_16x16x32_bf16 v[52:55], a[160:163], a[80:83], v[52:55]
ds_read_b128 a[212:215], v126 offset:11264
v_mfma_f32_16x16x32_bf16 v[80:83], a[160:163], a[84:87], v[80:83]
v_rsq_f32 v132, v131
v_mfma_f32_16x16x32_bf16 v[92:95], a[172:175], a[176:179], v[92:95]
v_cvt_pk_bf16_f32 v6, -v130, -v130
v_and_b32 v6, 0xffff0000, v6
v_mfma_f32_16x16x32_bf16 v[96:99], a[160:163], a[176:179], v[96:99]
buffer_load_dwordx4 a[132:135], v237, s[8:11], s62 offen offset:0 sc1
v_add_f32 v6, v130, v6
v_mfma_f32_16x16x32_bf16 v[56:59], a[164:167], a[80:83], v[56:59]
v_cvt_pk_bf16_f32 v133, -v130, -v6
v_mfma_f32_16x16x32_bf16 v[84:87], a[164:167], a[84:87], v[84:87]
v_mfma_f32_16x16x32_bf16 v[60:63], a[168:171], a[80:83], v[60:63]
v_mfma_f32_16x16x32_bf16 v[88:91], a[168:171], a[84:87], v[88:91]
s_waitcnt vmcnt(10) lgkmcnt(0)
v_cmp_ne_u64 vcc, v[148:149], v[238:239]
s_cmp_eq_u32 s29, 0
s_cselect_b64 vcc, vcc, 0
s_cbranch_vccnz L_dbslow_11
L_dbback_12:
s_barrier
v_mfma_f32_16x16x32_bf16 v[36:39], a[180:183], a[88:91], v[36:39]
ds_read_b128 a[144:147], v8 offset:21504
buffer_load_dwordx4 a[136:139], v1, s[8:11], s62 offen offset:1024 sc1
v_mfma_f32_16x16x32_bf16 v[64:67], a[180:183], a[92:95], v[64:67]
ds_read_b128 a[148:151], v8 offset:22528
v_mfma_f32_16x16x32_bf16 v[40:43], a[184:187], a[88:91], v[40:43]
ds_read_b128 a[152:155], v8 offset:23552
s_add_u32 m0, s68, 0
v_mfma_f32_16x16x32_bf16 v[68:71], a[184:187], a[92:95], v[68:71]
ds_read_b128 a[156:159], v8 offset:24576
v_mfma_f32_16x16x32_bf16 v[44:47], a[188:191], a[88:91], v[44:47]
ds_read_b128 a[160:163], v8 offset:25600
buffer_load_dwordx4 a[140:143], v237, s[8:11], s62 offen offset:1024 sc1
v_mfma_f32_16x16x32_bf16 v[72:75], a[188:191], a[92:95], v[72:75]
ds_read_b128 a[164:167], v8 offset:26624
s_add_u32 s3, s3, 0
v_mfma_f32_16x16x32_bf16 v[48:51], a[192:195], a[88:91], v[48:51]
ds_read_b128 a[168:171], v8 offset:27648
v_mfma_f32_16x16x32_bf16 v[76:79], a[192:195], a[92:95], v[76:79]
ds_read_b128 a[172:175], v125 offset:21504
buffer_load_dwordx4 v240, s[12:15], s3 offen offset:0 nt lds
v_mfma_f32_16x16x32_bf16 v[52:55], a[196:199], a[88:91], v[52:55]
ds_read_b128 a[176:179], v126 offset:12288
s_mov_b32 s37, L_c2-L_pc
v_mfma_f32_16x16x32_bf16 v[80:83], a[196:199], a[92:95], v[80:83]
ds_bpermute_b32 v116, v124, v133 offset:128
v_mfma_f32_16x16x32_bf16 v[92:95], a[208:211], a[212:215], v[92:95]
ds_bpermute_b32 v118, v124, v133 offset:192
buffer_load_dwordx4 v241, s[12:15], s3 offen offset:1024 nt lds
v_mfma_f32_16x16x32_bf16 v[96:99], a[196:199], a[212:215], v[96:99]
ds_bpermute_b32 v120, v124, v133
v_mfma_f32_16x16x32_bf16 v[56:59], a[200:203], a[88:91], v[56:59]
buffer_load_dword v15, v14, s[88:91], s37 offen
ds_bpermute_b32 v134, v124, v132 offset:128
v_mfma_f32_16x16x32_bf16 v[84:87], a[200:203], a[92:95], v[84:87]
ds_bpermute_b32 v135, v124, v132 offset:192
buffer_load_dwordx4 v242, s[12:15], s3 offen offset:2048 nt lds
v_mfma_f32_16x16x32_bf16 v[60:63], a[204:207], a[88:91], v[60:63]
v_mfma_f32_16x16x32_bf16 v[88:91], a[204:207], a[92:95], v[88:91]
buffer_load_dwordx4 v243, s[12:15], s3 offen offset:3072 nt lds
s_waitcnt vmcnt(15) lgkmcnt(0)
v_mfma_f32_16x16x32_bf16 v[36:39], a[144:147], a[96:99], v[36:39]
ds_read_b128 a[180:183], v8 offset:28672
v_mfma_f32_16x16x32_bf16 v[64:67], a[144:147], a[100:103], v[64:67]
ds_read_b128 a[184:187], v8 offset:29696
v_mfma_f32_16x16x32_bf16 v[40:43], a[148:151], a[96:99], v[40:43]
ds_read_b128 a[188:191], v8 offset:30720
s_add_u32 m0, s68, 4096
v_mfma_f32_16x16x32_bf16 v[68:71], a[148:151], a[100:103], v[68:71]
ds_read_b128 a[192:195], v8 offset:31744
v_mfma_f32_16x16x32_bf16 v[44:47], a[152:155], a[96:99], v[44:47]
ds_read_b128 a[196:199], v8 offset:32768
s_add_u32 s3, s3, 65536
v_mfma_f32_16x16x32_bf16 v[72:75], a[152:155], a[100:103], v[72:75]
ds_read_b128 a[200:203], v8 offset:33792
v_mfma_f32_16x16x32_bf16 v[48:51], a[156:159], a[96:99], v[48:51]
ds_read_b128 a[204:207], v8 offset:34816
v_mfma_f32_16x16x32_bf16 v[76:79], a[156:159], a[100:103], v[76:79]
ds_read_b128 a[208:211], v125 offset:28672
buffer_load_dwordx4 v240, s[12:15], s3 offen offset:0 nt lds
v_mfma_f32_16x16x32_bf16 v[52:55], a[160:163], a[96:99], v[52:55]
ds_read_b128 a[212:215], v126 offset:13312
v_mfma_f32_16x16x32_bf16 v[80:83], a[160:163], a[100:103], v[80:83]
ds_bpermute_b32 v136, v122, v132 offset:0
v_mfma_f32_16x16x32_bf16 v[92:95], a[172:175], a[176:179], v[92:95]
ds_bpermute_b32 v137, v123, v132 offset:0
buffer_load_dwordx4 v241, s[12:15], s3 offen offset:1024 nt lds
v_mfma_f32_16x16x32_bf16 v[96:99], a[160:163], a[176:179], v[96:99]
ds_bpermute_b32 v138, v122, v132 offset:64
v_mfma_f32_16x16x32_bf16 v[56:59], a[164:167], a[96:99], v[56:59]
ds_bpermute_b32 v139, v123, v132 offset:64
buffer_load_dwordx4 v242, s[12:15], s3 offen offset:2048 nt lds
v_mfma_f32_16x16x32_bf16 v[84:87], a[164:167], a[100:103], v[84:87]
v_mfma_f32_16x16x32_bf16 v[60:63], a[168:171], a[96:99], v[60:63]
v_mfma_f32_16x16x32_bf16 v[88:91], a[168:171], a[100:103], v[88:91]
buffer_load_dwordx4 v243, s[12:15], s3 offen offset:3072 nt lds
s_waitcnt vmcnt(17) lgkmcnt(0)
v_mfma_f32_16x16x32_bf16 v[36:39], a[180:183], a[104:107], v[36:39]
ds_read_b128 a[144:147], v8 offset:35840
v_mov_b32 v117, v116
v_mfma_f32_16x16x32_bf16 v[64:67], a[180:183], a[108:111], v[64:67]
ds_read_b128 a[148:151], v8 offset:36864
v_mov_b32 v119, v118
v_mfma_f32_16x16x32_bf16 v[40:43], a[184:187], a[104:107], v[40:43]
ds_read_b128 a[152:155], v8 offset:37888
s_mov_b32 s3, 1073741824
v_mfma_f32_16x16x32_bf16 v[68:71], a[184:187], a[108:111], v[68:71]
ds_read_b128 a[156:159], v8 offset:38912
v_mov_b32 v121, v120
v_mfma_f32_16x16x32_bf16 v[44:47], a[188:191], a[104:107], v[44:47]
ds_read_b128 a[160:163], v8 offset:39936
v_mul_f32 v134, 0x3eae1a93, v134
v_mfma_f32_16x16x32_bf16 v[72:75], a[188:191], a[108:111], v[72:75]
ds_read_b128 a[164:167], v8 offset:40960
s_mul_i32 s36, s28, 82944
v_mfma_f32_16x16x32_bf16 v[48:51], a[192:195], a[104:107], v[48:51]
ds_read_b128 a[168:171], v8 offset:41984
v_mul_f32 v135, 0x3eae1a93, v135
v_mfma_f32_16x16x32_bf16 v[76:79], a[192:195], a[108:111], v[76:79]
ds_read_b128 a[172:175], v125 offset:35840
v_mfma_f32_16x16x32_bf16 v[52:55], a[196:199], a[104:107], v[52:55]
ds_read_b128 a[176:179], v126 offset:14336
s_mul_i32 s38, s24, 8192
v_mfma_f32_16x16x32_bf16 v[80:83], a[196:199], a[108:111], v[80:83]
ds_read_b64 a[0:1], v127 offset:0
v_mul_f32 v140, v134, v136
v_mfma_f32_16x16x32_bf16 v[92:95], a[208:211], a[212:215], v[92:95]
ds_read_b64 a[2:3], v127 offset:512
v_mul_f32 v141, v134, v137
v_mfma_f32_16x16x32_bf16 v[96:99], a[196:199], a[212:215], v[96:99]
s_add_u32 m0, s38, 37888
v_mul_f32 v142, v135, v138
v_mfma_f32_16x16x32_bf16 v[56:59], a[200:203], a[104:107], v[56:59]
ds_read_b64 a[4:5], v127 offset:1024
v_mfma_f32_16x16x32_bf16 v[84:87], a[200:203], a[108:111], v[84:87]
ds_read_b64 a[6:7], v127 offset:1536
v_mul_f32 v143, v135, v139
v_mfma_f32_16x16x32_bf16 v[60:63], a[204:207], a[104:107], v[60:63]
s_cmp_eq_u32 s60, 0
s_cselect_b32 s30, 0xf149f2ca, 0
v_mfma_f32_16x16x32_bf16 v[88:91], a[204:207], a[108:111], v[88:91]
s_add_u32 s39, s38, s36
s_waitcnt vmcnt(15) lgkmcnt(0)
v_mfma_f32_16x16x32_bf16 v[36:39], a[144:147], a[112:115], v[36:39]
ds_read_b128 a[180:183], v8 offset:43008
v_mfma_f32_16x16x32_bf16 v[64:67], a[144:147], a[116:119], v[64:67]
ds_read_b128 a[184:187], v8 offset:44032
v_mfma_f32_16x16x32_bf16 v[40:43], a[148:151], a[112:115], v[40:43]
ds_read_b128 a[188:191], v8 offset:45056
v_mov_b32 v6, s30
v_mfma_f32_16x16x32_bf16 v[68:71], a[148:151], a[116:119], v[68:71]
ds_read_b128 a[192:195], v8 offset:46080
v_cndmask_b32 v144, v6, 0, s[42:43]
v_mfma_f32_16x16x32_bf16 v[44:47], a[152:155], a[112:115], v[44:47]
ds_read_b128 a[196:199], v8 offset:47104
s_add_u32 s39, s39, 2121728
v_mfma_f32_16x16x32_bf16 v[72:75], a[152:155], a[116:119], v[72:75]
ds_read_b128 a[200:203], v8 offset:48128
v_cndmask_b32 v145, v6, 0, s[44:45]
v_mfma_f32_16x16x32_bf16 v[48:51], a[156:159], a[112:115], v[48:51]
ds_read_b128 a[204:207], v8 offset:49152
v_mfma_f32_16x16x32_bf16 v[76:79], a[156:159], a[116:119], v[76:79]
ds_read_b128 a[208:211], v125 offset:43008
v_mov_b32 v100, v136
v_mfma_f32_16x16x32_bf16 v[52:55], a[160:163], a[112:115], v[52:55]
ds_read_b128 a[212:215], v126 offset:15360
buffer_load_dwordx4 v1, s[4:7], s39 offen offset:0 sc1 lds
v_mfma_f32_16x16x32_bf16 v[80:83], a[160:163], a[116:119], v[80:83]
ds_read_b64 a[8:9], v127 offset:2048
v_mov_b32 v104, v138
v_mfma_f32_16x16x32_bf16 v[92:95], a[172:175], a[176:179], v[92:95]
ds_read_b64 a[10:11], v127 offset:2560
v_mov_b32 v102, v136
v_mfma_f32_16x16x32_bf16 v[96:99], a[160:163], a[176:179], v[96:99]
v_mfma_f32_16x16x32_bf16 v[56:59], a[164:167], a[112:115], v[56:59]
ds_read_b64 a[12:13], v127 offset:3072
buffer_load_dwordx4 v1, s[4:7], s39 offen offset:1024 sc1 lds
v_mfma_f32_16x16x32_bf16 v[84:87], a[164:167], a[116:119], v[84:87]
ds_read_b64 a[14:15], v128
v_mov_b32 v106, v138
v_mfma_f32_16x16x32_bf16 v[60:63], a[168:171], a[112:115], v[60:63]
v_mov_b32 v101, v137
v_mfma_f32_16x16x32_bf16 v[88:91], a[168:171], a[116:119], v[88:91]
v_mov_b32 v105, v139
s_waitcnt vmcnt(15) lgkmcnt(0)
v_mfma_f32_16x16x32_bf16 v[36:39], a[180:183], a[120:123], v[36:39]
ds_read_b128 a[144:147], v8 offset:50176
buffer_load_dwordx4 v1, s[4:7], s39 offen offset:2048 sc1 lds
v_mfma_f32_16x16x32_bf16 v[64:67], a[180:183], a[124:127], v[64:67]
ds_read_b128 a[148:151], v8 offset:51200
v_mov_b32 v103, v137
v_mfma_f32_16x16x32_bf16 v[40:43], a[184:187], a[120:123], v[40:43]
ds_read_b128 a[152:155], v8 offset:52224
v_mov_b32 v107, v139
v_mfma_f32_16x16x32_bf16 v[68:71], a[184:187], a[124:127], v[68:71]
ds_read_b128 a[156:159], v8 offset:53248
buffer_load_dwordx4 v1, s[4:7], s39 offen offset:3072 sc1 lds
v_mfma_f32_16x16x32_bf16 v[44:47], a[188:191], a[120:123], v[44:47]
ds_read_b128 a[160:163], v8 offset:54272
v_mfma_f32_16x16x32_bf16 v[72:75], a[188:191], a[124:127], v[72:75]
ds_read_b128 a[164:167], v8 offset:55296
v_mfma_f32_16x16x32_bf16 v[48:51], a[192:195], a[120:123], v[48:51]
ds_read_b128 a[168:171], v8 offset:56320
v_mfma_f32_16x16x32_bf16 v[76:79], a[192:195], a[124:127], v[76:79]
ds_read_b128 a[172:175], v125 offset:50176
s_add_u32 m0, m0, 4096
v_mfma_f32_16x16x32_bf16 v[52:55], a[196:199], a[120:123], v[52:55]
ds_read_b128 a[176:179], v126 offset:16384
s_waitcnt vmcnt(8)
v_mfma_f32_16x16x32_bf16 v[80:83], a[196:199], a[124:127], v[80:83]
ds_read_b128 a[224:227], v244 offset:0
v_mfma_f32_16x16x32_bf16 v[92:95], a[208:211], a[212:215], v[92:95]
ds_read_b128 a[228:231], v245 offset:0
v_mfma_f32_16x16x32_bf16 v[96:99], a[196:199], a[212:215], v[96:99]
s_add_u32 s39, s39, 4096
v_permlane32_swap_b32 v100, v104
v_mfma_f32_16x16x32_bf16 v[56:59], a[200:203], a[120:123], v[56:59]
ds_read_b128 a[232:235], v246 offset:0
v_mfma_f32_16x16x32_bf16 v[84:87], a[200:203], a[124:127], v[84:87]
ds_read_b128 a[236:239], v247 offset:0
v_mfma_f32_16x16x32_bf16 v[60:63], a[204:207], a[120:123], v[60:63]
v_permlane32_swap_b32 v102, v106
v_mfma_f32_16x16x32_bf16 v[88:91], a[204:207], a[124:127], v[88:91]
buffer_load_dwordx4 v1, s[4:7], s39 offen offset:0 sc1 lds
s_waitcnt lgkmcnt(0)
v_mfma_f32_16x16x32_bf16 v[36:39], a[144:147], a[128:131], v[36:39]
ds_read_b128 a[180:183], v8 offset:57344
v_mfma_f32_16x16x32_bf16 v[64:67], a[144:147], a[132:135], v[64:67]
ds_read_b128 a[184:187], v8 offset:58368
v_mfma_f32_16x16x32_bf16 v[40:43], a[148:151], a[128:131], v[40:43]
ds_read_b128 a[188:191], v8 offset:59392
v_mfma_f32_16x16x32_bf16 v[68:71], a[148:151], a[132:135], v[68:71]
ds_read_b128 a[192:195], v8 offset:60416
buffer_load_dwordx4 v1, s[4:7], s39 offen offset:1024 sc1 lds
v_mfma_f32_16x16x32_bf16 v[44:47], a[152:155], a[128:131], v[44:47]
ds_read_b128 a[196:199], v8 offset:61440
v_mfma_f32_16x16x32_bf16 v[72:75], a[152:155], a[132:135], v[72:75]
ds_read_b128 a[200:203], v8 offset:62464
v_mfma_f32_16x16x32_bf16 v[48:51], a[156:159], a[128:131], v[48:51]
ds_read_b128 a[204:207], v8 offset:63488
v_mfma_f32_16x16x32_bf16 v[76:79], a[156:159], a[132:135], v[76:79]
ds_read_b128 a[208:211], v125 offset:57344
buffer_load_dwordx4 v1, s[4:7], s39 offen offset:2048 sc1 lds
v_mfma_f32_16x16x32_bf16 v[52:55], a[160:163], a[128:131], v[52:55]
ds_read_b128 a[212:215], v126 offset:17408
s_waitcnt vmcnt(7)
v_mfma_f32_16x16x32_bf16 v[80:83], a[160:163], a[132:135], v[80:83]
ds_read_b128 a[240:243], v244 offset:4096
v_mfma_f32_16x16x32_bf16 v[92:95], a[172:175], a[176:179], v[92:95]
ds_read_b128 a[244:247], v245 offset:4096
v_mfma_f32_16x16x32_bf16 v[96:99], a[160:163], a[176:179], v[96:99]
ds_read_b128 a[248:251], v246 offset:4096
buffer_load_dwordx4 v1, s[4:7], s39 offen offset:3072 sc1 lds
v_mfma_f32_16x16x32_bf16 v[56:59], a[164:167], a[128:131], v[56:59]
ds_read_b128 a[252:255], v247 offset:4096
v_mfma_f32_16x16x32_bf16 v[84:87], a[164:167], a[132:135], v[84:87]
v_permlane32_swap_b32 v101, v105
v_mfma_f32_16x16x32_bf16 v[60:63], a[168:171], a[128:131], v[60:63]
v_permlane32_swap_b32 v103, v107
v_permlane16_swap_b32 v100, v102
v_permlane16_swap_b32 v104, v106
v_permlane16_swap_b32 v101, v103
v_permlane16_swap_b32 v105, v107
v_mfma_f32_16x16x32_bf16 v[88:91], a[168:171], a[132:135], v[88:91]
s_waitcnt lgkmcnt(0)
s_barrier
v_mfma_f32_16x16x32_bf16 v[36:39], a[180:183], a[136:139], v[36:39]
v_mfma_f32_16x16x32_bf16 v[64:67], a[180:183], a[140:143], v[64:67]
v_mfma_f32_16x16x16_bf16 v[36:39], a[0:1], v[116:117], v[36:39]
v_mfma_f32_16x16x16_bf16 v[64:67], a[0:1], v[118:119], v[64:67]
v_mfma_f32_16x16x32_bf16 v[40:43], a[184:187], a[136:139], v[40:43]
v_mfma_f32_16x16x32_bf16 v[68:71], a[184:187], a[140:143], v[68:71]
s_nop 1
v_mfma_f32_16x16x16_bf16 v[40:43], a[2:3], v[116:117], v[40:43]
s_nop 1
v_mfma_f32_16x16x16_bf16 v[68:71], a[2:3], v[118:119], v[68:71]
v_cvt_pk_bf16_f32 v156, v36, v37
v_cvt_pk_bf16_f32 v157, v38, v39
v_mfma_f32_16x16x32_bf16 v[44:47], a[188:191], a[136:139], v[44:47]
ds_write_b64 v218, v[156:157] offset:2816
v_mfma_f32_16x16x32_bf16 v[72:75], a[188:191], a[140:143], v[72:75]
v_cvt_pk_bf16_f32 v162, v64, v65
v_cvt_pk_bf16_f32 v163, v66, v67
v_mfma_f32_16x16x16_bf16 v[44:47], a[4:5], v[116:117], v[44:47]
ds_write_b64 v218, v[162:163] offset:5632
v_mfma_f32_16x16x16_bf16 v[72:75], a[4:5], v[118:119], v[72:75]
v_cvt_pk_bf16_f32 v160, v40, v41
v_cvt_pk_bf16_f32 v161, v42, v43
v_mfma_f32_16x16x32_bf16 v[48:51], a[192:195], a[136:139], v[48:51]
ds_write_b64 v218, v[160:161] offset:2848
v_mfma_f32_16x16x32_bf16 v[76:79], a[192:195], a[140:143], v[76:79]
v_cvt_pk_bf16_f32 v166, v68, v69
v_cvt_pk_bf16_f32 v167, v70, v71
v_mfma_f32_16x16x16_bf16 v[48:51], a[6:7], v[116:117], v[48:51]
ds_write_b64 v218, v[166:167] offset:5664
v_mfma_f32_16x16x16_bf16 v[76:79], a[6:7], v[118:119], v[76:79]
v_cvt_pk_bf16_f32 v202, v44, v45
v_cvt_pk_bf16_f32 v203, v46, v47
v_mfma_f32_16x16x32_bf16 v[52:55], a[196:199], a[136:139], v[52:55]
ds_write_b64 v218, v[202:203] offset:2880
v_mfma_f32_16x16x32_bf16 v[80:83], a[196:199], a[140:143], v[80:83]
v_cvt_pk_bf16_f32 v204, v72, v73
v_cvt_pk_bf16_f32 v205, v74, v75
v_mfma_f32_16x16x16_bf16 v[52:55], a[8:9], v[116:117], v[52:55]
ds_write_b64 v218, v[204:205] offset:5696
v_mfma_f32_16x16x16_bf16 v[80:83], a[8:9], v[118:119], v[80:83]
v_cvt_pk_bf16_f32 v206, v48, v49
v_cvt_pk_bf16_f32 v207, v50, v51
v_mfma_f32_16x16x32_bf16 v[92:95], a[208:211], a[212:215], v[92:95]
ds_write_b64 v218, v[206:207] offset:2912
v_mfma_f32_16x16x32_bf16 v[96:99], a[196:199], a[212:215], v[96:99]
v_cvt_pk_bf16_f32 v208, v76, v77
v_cvt_pk_bf16_f32 v209, v78, v79
v_mfma_f32_16x16x16_bf16 v[92:95], a[14:15], v[120:121], v[92:95]
ds_write_b64 v218, v[208:209] offset:5728
v_mfma_f32_16x16x16_bf16 v[96:99], a[8:9], v[120:121], v[96:99]
v_cvt_pk_bf16_f32 v210, v52, v53
v_cvt_pk_bf16_f32 v211, v54, v55
v_mfma_f32_16x16x32_bf16 v[56:59], a[200:203], a[136:139], v[56:59]
ds_write_b64 v218, v[210:211] offset:2944
v_mfma_f32_16x16x32_bf16 v[84:87], a[200:203], a[140:143], v[84:87]
v_cvt_pk_bf16_f32 v212, v80, v81
v_cvt_pk_bf16_f32 v213, v82, v83
v_mfma_f32_16x16x16_bf16 v[56:59], a[10:11], v[116:117], v[56:59]
ds_write_b64 v218, v[212:213] offset:5760
v_mfma_f32_16x16x16_bf16 v[84:87], a[10:11], v[118:119], v[84:87]
v_cvt_pk_bf16_f32 v214, v92, v93
v_cvt_pk_bf16_f32 v215, v94, v95
v_mfma_f32_16x16x32_bf16 v[60:63], a[204:207], a[136:139], v[60:63]
ds_write_b64 v222, v[214:215]
v_mfma_f32_16x16x32_bf16 v[88:91], a[204:207], a[140:143], v[88:91]
v_cvt_pk_bf16_f32 v216, v96, v97
v_cvt_pk_bf16_f32 v217, v98, v99
v_mfma_f32_16x16x16_bf16 v[60:63], a[12:13], v[116:117], v[60:63]
ds_write_b64 v219, v[216:217] offset:128
v_mfma_f32_16x16x16_bf16 v[88:91], a[12:13], v[118:119], v[88:91]
s_waitcnt lgkmcnt(0)
s_barrier
ds_read_b64 v[150:151], v218
ds_read_b64 v[154:155], v218 offset:32
ds_read_b64 v[152:153], v220 offset:136
ds_read_b64 v[158:159], v220 offset:2952
ds_read_b64 v[164:165], v220 offset:5768
s_mul_i32 s36, s28, 82944
s_mul_i32 s38, s24, 13312
s_add_u32 m0, s38, 70656
s_add_u32 s39, s38, s36
s_add_u32 s39, s39, 2154496
buffer_load_dwordx4 v1, s[4:7], s39 offen offset:0 sc1 lds
buffer_load_dwordx4 v1, s[4:7], s39 offen offset:1024 sc1 lds
v_cndmask_b32 v170, 0, v210, s[48:49]
v_cndmask_b32 v173, 0, v211, s[48:49]
v_cndmask_b32 v178, 0, v212, s[48:49]
v_cndmask_b32 v181, 0, v213, s[48:49]
v_cvt_pk_bf16_f32 v168, v56, v57
v_cvt_pk_bf16_f32 v169, v58, v59
v_cvt_pk_bf16_f32 v176, v84, v85
v_cvt_pk_bf16_f32 v177, v86, v87
v_cvt_pk_bf16_f32 v174, v60, v61
v_cvt_pk_bf16_f32 v175, v62, v63
v_cvt_pk_bf16_f32 v182, v88, v89
v_cvt_pk_bf16_f32 v183, v90, v91
s_waitcnt lgkmcnt(0)
ds_read_b64_tr_b16 v[184:185], v221 offset:64
v_mfma_f32_16x16x32_bf16 v[36:39], v[150:153], v[168:171], 0
ds_read_b64_tr_b16 v[186:187], v221 offset:2880
v_mfma_f32_16x16x32_bf16 v[40:43], v[156:159], v[168:171], 0
ds_read_b64_tr_b16 v[188:189], v221 offset:5696
buffer_load_dwordx4 v1, s[4:7], s39 offen offset:2048 sc1 lds
v_mfma_f32_16x16x32_bf16 v[44:47], v[152:155], v[172:175], 0
ds_read_b64_tr_b16 v[190:191], v221 offset:96
v_mfma_f32_16x16x32_bf16 v[48:51], v[158:161], v[172:175], 0
ds_read_b64_tr_b16 v[192:193], v221 offset:2912
buffer_load_dwordx4 v1, s[4:7], s39 offen offset:3072 sc1 lds
v_mfma_f32_16x16x32_bf16 v[52:55], v[156:159], v[176:179], 0
ds_read_b64_tr_b16 v[194:195], v221 offset:5728
v_mfma_f32_16x16x32_bf16 v[56:59], v[162:165], v[176:179], 0
ds_read_b64_tr_b16 v[196:197], v221 offset:128
s_add_u32 m0, m0, 4096
s_add_u32 s39, s39, 4096
buffer_load_dwordx4 v1, s[4:7], s39 offen offset:0 sc1 lds
v_mfma_f32_16x16x32_bf16 v[60:63], v[158:161], v[180:183], 0
ds_read_b64_tr_b16 v[198:199], v221 offset:2944
v_mfma_f32_16x16x32_bf16 v[64:67], v[164:167], v[180:183], 0
ds_read_b64_tr_b16 v[200:201], v221 offset:5760
buffer_load_dwordx4 v1, s[4:7], s39 offen offset:1024 sc1 lds
v_cndmask_b32 v36, v36, v37, s[40:41]
v_cndmask_b32 v40, v40, v41, s[40:41]
v_cndmask_b32 v68, v36, v40, s[42:43]
v_cndmask_b32 v38, v38, v39, s[40:41]
v_cndmask_b32 v42, v42, v43, s[40:41]
v_cndmask_b32 v69, v38, v42, s[44:45]
v_cndmask_b32 v44, v44, v45, s[40:41]
v_cndmask_b32 v48, v48, v49, s[40:41]
buffer_load_dwordx4 v1, s[4:7], s39 offen offset:2048 sc1 lds
buffer_load_dwordx4 v1, s[4:7], s39 offen offset:3072 sc1 lds
v_cndmask_b32 v70, v44, v48, s[42:43]
v_cndmask_b32 v46, v46, v47, s[40:41]
v_cndmask_b32 v50, v50, v51, s[40:41]
v_cndmask_b32 v71, v46, v50, s[44:45]
v_cndmask_b32 v52, v52, v53, s[40:41]
v_cndmask_b32 v56, v56, v57, s[40:41]
v_cndmask_b32 v72, v52, v56, s[42:43]
s_add_u32 m0, m0, 4096
v_cndmask_b32 v54, v54, v55, s[40:41]
v_cndmask_b32 v58, v58, v59, s[40:41]
v_cndmask_b32 v73, v54, v58, s[44:45]
v_cndmask_b32 v60, v60, v61, s[40:41]
v_cndmask_b32 v64, v64, v65, s[40:41]
v_cndmask_b32 v74, v60, v64, s[42:43]
v_cndmask_b32 v62, v62, v63, s[40:41]
v_cndmask_b32 v66, v66, v67, s[40:41]
s_add_u32 s39, s39, 4096
v_cndmask_b32 v75, v62, v66, s[44:45]
v_pk_fma_f32 v[68:69], v[68:69], v[140:141], v[144:145]
v_pk_mul_f32 v[72:73], v[72:73], v[142:143]
v_pk_fma_f32 v[70:71], v[70:71], v[140:141], v[144:145]
v_pk_mul_f32 v[74:75], v[74:75], v[142:143]
v_permlane32_swap_b32 v68, v72
s_nop 0
buffer_load_dwordx4 v1, s[4:7], s39 offen offset:0 sc1 lds
buffer_load_dwordx4 v1, s[4:7], s39 offen offset:1024 sc1 lds
v_permlane32_swap_b32 v70, v74
v_permlane32_swap_b32 v69, v73
v_permlane32_swap_b32 v71, v75
v_permlane16_swap_b32 v68, v70
v_permlane16_swap_b32 v72, v74
v_permlane16_swap_b32 v69, v71
v_permlane16_swap_b32 v73, v75
v_max3_f32 v76, v68, v69, v70
buffer_load_dwordx4 v1, s[4:7], s39 offen offset:2048 sc1 lds
buffer_load_dwordx4 v1, s[4:7], s39 offen offset:3072 sc1 lds
v_max3_f32 v77, v71, v72, v73
v_max3_f32 v76, v76, v74, v75
v_max_f32 v76, v76, v77
v_pk_add_f32 v[68:69], v[68:69], v[76:77] op_sel_hi:[1,0] neg_lo:[0,1] neg_hi:[0,1]
v_pk_add_f32 v[70:71], v[70:71], v[76:77] op_sel_hi:[1,0] neg_lo:[0,1] neg_hi:[0,1]
v_pk_add_f32 v[72:73], v[72:73], v[76:77] op_sel_hi:[1,0] neg_lo:[0,1] neg_hi:[0,1]
v_pk_add_f32 v[74:75], v[74:75], v[76:77] op_sel_hi:[1,0] neg_lo:[0,1] neg_hi:[0,1]
s_add_u32 m0, m0, 4096
v_exp_f32 v68, v68
v_exp_f32 v69, v69
v_exp_f32 v70, v70
v_exp_f32 v71, v71
v_exp_f32 v72, v72
v_exp_f32 v73, v73
v_exp_f32 v74, v74
v_exp_f32 v75, v75
s_add_u32 s39, s39, 4096
v_pk_add_f32 v[76:77], v[68:69], v[70:71]
v_pk_add_f32 v[78:79], v[72:73], v[74:75]
v_pk_add_f32 v[76:77], v[76:77], v[78:79]
v_add_f32 v76, v76, v77
v_rcp_f32 v76, v76
v_pk_mul_f32 v[68:69], v[68:69], v[100:101]
v_pk_mul_f32 v[70:71], v[70:71], v[102:103]
buffer_load_dwordx4 v1, s[4:7], s39 offen offset:0 sc1 lds
v_pk_mul_f32 v[72:73], v[72:73], v[104:105]
v_pk_mul_f32 v[74:75], v[74:75], v[106:107]
v_pk_mul_f32 v[68:69], v[68:69], v[76:77] op_sel_hi:[1,0]
v_pk_mul_f32 v[70:71], v[70:71], v[76:77] op_sel_hi:[1,0]
v_pk_mul_f32 v[72:73], v[72:73], v[76:77] op_sel_hi:[1,0]
v_pk_mul_f32 v[74:75], v[74:75], v[76:77] op_sel_hi:[1,0]
v_cvt_pk_bf16_f32 v80, v68, v69
v_cvt_pk_bf16_f32 v82, v72, v73
v_cvt_pk_bf16_f32 v81, v70, v71
v_cvt_pk_bf16_f32 v83, v74, v75
v_permlane32_swap_b32 v80, v82
s_waitcnt lgkmcnt(0)
v_permlane32_swap_b32 v81, v83
s_nop 1
v_permlane16_swap_b32 v80, v81
v_permlane16_swap_b32 v82, v83
v_perm_b32 v84, v80, v80, v10
v_perm_b32 v85, v80, v80, v11
v_perm_b32 v86, v80, v80, v12
v_perm_b32 v87, v80, v80, v13
v_perm_b32 v88, v81, v81, v10
v_perm_b32 v89, v81, v81, v11
v_mfma_f32_16x16x32_bf16 v[36:39], v[184:187], v[84:87], 0
v_perm_b32 v90, v81, v81, v12
v_perm_b32 v91, v81, v81, v13
v_mfma_f32_16x16x32_bf16 v[40:43], v[196:199], v[84:87], 0
v_perm_b32 v92, v82, v82, v10
v_perm_b32 v93, v82, v82, v11
v_mfma_f32_16x16x32_bf16 v[44:47], v[190:193], v[88:91], 0
v_perm_b32 v94, v82, v82, v12
v_perm_b32 v95, v82, v82, v13
v_mfma_f32_16x16x32_bf16 v[48:51], v[196:199], v[88:91], 0
v_perm_b32 v96, v83, v83, v10
v_perm_b32 v97, v83, v83, v11
v_mfma_f32_16x16x32_bf16 v[52:55], v[186:189], v[92:95], 0
v_perm_b32 v98, v83, v83, v12
v_perm_b32 v99, v83, v83, v13
v_mfma_f32_16x16x32_bf16 v[56:59], v[198:201], v[92:95], 0
v_cvt_pk_bf16_f32 v168, v36, v37
v_cvt_pk_bf16_f32 v169, v38, v39
v_mfma_f32_16x16x32_bf16 v[60:63], v[192:195], v[96:99], 0
v_mfma_f32_16x16x32_bf16 v[64:67], v[198:201], v[96:99], 0
v_cvt_pk_bf16_f32 v172, v40, v41
v_cvt_pk_bf16_f32 v170, v44, v45
v_cvt_pk_bf16_f32 v171, v46, v47
v_cvt_pk_bf16_f32 v173, v50, v51
buffer_store_dwordx4 v[168:171], v1, s[8:11], s64 offen sc1
buffer_store_dwordx2 v[172:173], v224, s[8:11], s65 offen sc1
v_cvt_pk_bf16_f32 v176, v52, v53
v_cvt_pk_bf16_f32 v177, v54, v55
v_cvt_pk_bf16_f32 v180, v56, v57
v_cvt_pk_bf16_f32 v178, v60, v61
v_cvt_pk_bf16_f32 v179, v62, v63
v_cvt_pk_bf16_f32 v181, v66, v67
buffer_store_dwordx4 v[176:179], v237, s[8:11], s64 offen sc1
buffer_store_dwordx2 v[180:181], v225, s[8:11], s65 offen sc1
L_c2:
s_mul_i32 s38, s24, 9216
s_add_u32 m0, s38, 123904
s_add_u32 s39, s38, s82
buffer_load_dwordx4 v1, s[4:7], s39 offen offset:0 sc1 lds
buffer_load_dwordx4 v1, s[4:7], s39 offen offset:1024 sc1 lds
buffer_load_dwordx4 v1, s[4:7], s39 offen offset:2048 sc1 lds
buffer_load_dwordx4 v1, s[4:7], s39 offen offset:3072 sc1 lds
s_add_u32 m0, m0, 4096
s_add_u32 s39, s39, 4096
buffer_load_dwordx4 v1, s[4:7], s39 offen offset:0 sc1 lds
buffer_load_dwordx4 v1, s[4:7], s39 offen offset:1024 sc1 lds
buffer_load_dwordx4 v1, s[4:7], s39 offen offset:2048 sc1 lds
v_lshlrev_b32 v7, 3, v1
s_lshl_b32 s31, s25, 11
v_add_u32 v7, s31, v7
s_cmp_eq_u32 s24, 0
s_cselect_b32 s30, 0, 1073741824
s_add_u32 s30, s30, 26476544
s_waitcnt vmcnt(7)
s_barrier
s_mov_b64 exec, 0xffff
buffer_atomic_add v4, v7, s[8:11], s30 offen sc1
s_mov_b64 exec, -1
s_lshl_b32 s35, s80, 7
s_add_u32 s35, s35, 26476544
s_cmp_eq_u32 s24, 1
s_cselect_b32 s35, s35, 1073741824
v_mov_b32 v6, 0
v_mov_b32 v244, 0
v_mov_b32 v245, 0
v_mov_b32 v246, 0
buffer_load_dwordx4 v1, s[4:7], s39 offen offset:3072 sc1 lds
s_add_u32 m0, m0, 4096
s_add_u32 s39, s39, 4096
buffer_load_dwordx4 v1, s[4:7], s39 offen offset:0 sc1 lds
s_lshl_b32 s38, s24, 8
s_add_u32 m0, s38, 160768
s_add_u32 s39, s38, s82
s_add_u32 s39, s39, 36864
s_mov_b64 exec, 0xffff
buffer_load_dwordx4 v1, s[4:7], s39 offen sc1 lds
s_mov_b64 exec, -1
s_mul_i32 s38, s24, 9216
s_add_u32 m0, s38, 0
s_add_u32 s39, s38, s82
s_add_u32 s39, s39, 37888
buffer_load_dwordx4 v1, s[4:7], s39 offen offset:0 sc1 lds
s_mov_b64 exec, 1
buffer_atomic_add v244, v6, s[8:11], s35 offen sc0 sc1
s_mov_b64 exec, -1
buffer_load_dwordx4 v1, s[4:7], s39 offen offset:1024 sc1 lds
buffer_load_dwordx4 v1, s[4:7], s39 offen offset:2048 sc1 lds
buffer_load_dwordx4 v1, s[4:7], s39 offen offset:3072 sc1 lds
s_add_u32 m0, m0, 4096
s_add_u32 s39, s39, 4096
s_mov_b64 exec, 1
buffer_atomic_add v245, v6, s[8:11], s35 offen sc0 sc1
s_mov_b64 exec, -1
buffer_load_dwordx4 v1, s[4:7], s39 offen offset:0 sc1 lds
buffer_load_dwordx4 v1, s[4:7], s39 offen offset:1024 sc1 lds
buffer_load_dwordx4 v1, s[4:7], s39 offen offset:2048 sc1 lds
s_mov_b64 exec, 1
buffer_atomic_add v246, v6, s[8:11], s35 offen sc0 sc1
s_mov_b64 exec, -1
buffer_load_dwordx4 v1, s[4:7], s39 offen offset:3072 sc1 lds
s_add_u32 m0, m0, 4096
s_add_u32 s39, s39, 4096
buffer_load_dwordx4 v1, s[4:7], s39 offen offset:0 sc1 lds
s_lshl_b32 s38, s24, 8
s_add_u32 m0, s38, 36864
s_add_u32 s39, s38, s82
s_add_u32 s39, s39, 74752
s_mov_b64 exec, 0xffff
buffer_load_dwordx4 v1, s[4:7], s39 offen sc1 lds
s_mov_b64 exec, -1
s_mul_i32 s60, s70, 18432
s_add_u32 s60, s60, 2490368
s_cmp_eq_u32 s24, 1
s_cbranch_scc0 L_other_15
s_mov_b32 s31, 0
s_mov_b64 exec, 1
v_mov_b32 v247, 0
buffer_atomic_add v247, v6, s[8:11], s35 offen sc0 sc1
s_waitcnt vmcnt(12)
v_cmp_gt_u32 vcc, 16, v244
s_nop 0
s_cbranch_vccz L_polled_14
s_waitcnt vmcnt(8)
v_cmp_gt_u32 vcc, 16, v245
s_nop 0
s_cbranch_vccz L_polled_14
v_mov_b32 v244, 0
buffer_atomic_add v244, v6, s[8:11], s35 offen sc0 sc1
s_waitcnt vmcnt(5)
v_cmp_gt_u32 vcc, 16, v246
s_nop 0
s_cbranch_vccz L_polled_14
v_mov_b32 v245, 0
buffer_atomic_add v245, v6, s[8:11], s35 offen sc0 sc1
L_poll_13:
s_add_u32 s31, s31, 1
s_cmp_gt_u32 s31, 100000
s_cbranch_scc1 L_polled_14
v_mov_b32 v246, 0
buffer_atomic_add v246, v6, s[8:11], s35 offen sc0 sc1
s_waitcnt vmcnt(3)
v_cmp_gt_u32 vcc, 16, v247
s_nop 0
s_cbranch_vccz L_polled_14
v_mov_b32 v247, 0
buffer_atomic_add v247, v6, s[8:11], s35 offen sc0 sc1
s_waitcnt vmcnt(3)
v_cmp_gt_u32 vcc, 16, v244
s_nop 0
s_cbranch_vccz L_polled_14
v_mov_b32 v244, 0
buffer_atomic_add v244, v6, s[8:11], s35 offen sc0 sc1
s_waitcnt vmcnt(3)
v_cmp_gt_u32 vcc, 16, v245
s_nop 0
s_cbranch_vccz L_polled_14
v_mov_b32 v245, 0
buffer_atomic_add v245, v6, s[8:11], s35 offen sc0 sc1
s_waitcnt vmcnt(3)
v_cmp_gt_u32 vcc, 16, v246
s_nop 0
s_cbranch_vccz L_polled_14
s_branch L_poll_13
L_polled_14:
s_mov_b64 exec, -1
L_other_15:
s_barrier
buffer_load_dwordx4 a[0:3], v1, s[8:11], s60 offen offset:0 sc1
buffer_load_dwordx4 a[4:7], v1, s[8:11], s60 offen offset:1024 sc1
s_barrier
buffer_load_dwordx4 a[8:11], v1, s[8:11], s60 offen offset:2048 sc1
buffer_load_dwordx4 a[12:15], v1, s[8:11], s60 offen offset:3072 sc1
s_barrier
s_add_u32 s60, s60, 4096
buffer_load_dwordx4 a[16:19], v1, s[8:11], s60 offen offset:0 sc1
buffer_load_dwordx4 a[20:23], v1, s[8:11], s60 offen offset:1024 sc1
s_barrier
buffer_load_dwordx4 a[24:27], v1, s[8:11], s60 offen offset:2048 sc1
buffer_load_dwordx4 a[28:31], v1, s[8:11], s60 offen offset:3072 sc1
v_lshrrev_b32 v40, 1, v1
v_and_b32 v36, 7, v2
v_lshlrev_b32 v36, 4, v36
v_lshl_add_u32 v36, v3, 7, v36
v_add_u32 v36, 4096, v36
v_add_u32 v36, 37888, v36
v_add_u32 v39, 37888, v1
v_add_u32 v37, 79360, v1
v_add_u32 v38, 41472, v36
ds_read_b128 a[72:75], v39 offset:0
ds_read_b128 a[76:79], v39 offset:1024
ds_read_b128 a[80:83], v39 offset:2048
ds_read_b128 a[84:87], v39 offset:3072
ds_read_b128 a[88:91], v36 offset:0
ds_read_b128 a[92:95], v39 offset:4608
ds_read_b128 a[96:99], v39 offset:5632
ds_read_b128 a[100:103], v39 offset:6656
ds_read_b128 a[104:107], v39 offset:7680
ds_read_b128 a[108:111], v36 offset:4608
v_mov_b32 v58, 1073741824
s_mul_i32 s62, s70, 18432
s_mul_i32 s32, s28, 2304
s_add_u32 s62, s62, s32
s_add_u32 s62, s62, 4849664
v_mov_b32 v60, v1
v_add_u32 v61, 2048, v60
v_cndmask_b32 v61, v58, v61, s[46:47]
s_lshl_b32 s63, s70, 7
s_lshl_b32 s32, s28, 14
s_add_u32 s63, s63, s32
s_add_u32 s63, s63, 7208960
v_lshlrev_b32 v59, 3, v2
v_cndmask_b32 v58, v58, v59, s[46:47]
s_waitcnt vmcnt(7) lgkmcnt(5)
v_mfma_f32_16x16x32_bf16 v[16:19], a[72:75], a[0:3], v[16:19]
ds_read_b128 a[112:115], v39 offset:9216
s_add_u32 s60, s60, 4096
buffer_load_dwordx4 a[32:35], v1, s[8:11], s60 offen offset:0 sc1
v_mfma_f32_16x16x32_bf16 v[20:23], a[76:79], a[0:3], v[20:23]
ds_read_b128 a[116:119], v39 offset:10240
v_mfma_f32_16x16x32_bf16 v[24:27], a[80:83], a[0:3], v[24:27]
ds_read_b128 a[120:123], v39 offset:11264
v_mfma_f32_16x16x32_bf16 v[28:31], a[84:87], a[0:3], v[28:31]
ds_read_b128 a[124:127], v39 offset:12288
v_mfma_f32_16x16x32_bf16 v[32:35], a[88:91], a[0:3], v[32:35]
ds_read_b128 a[128:131], v36 offset:9216
s_waitcnt vmcnt(7) lgkmcnt(5)
v_mfma_f32_16x16x32_bf16 v[16:19], a[92:95], a[4:7], v[16:19]
ds_read_b128 a[72:75], v39 offset:13824
buffer_load_dwordx4 a[36:39], v1, s[8:11], s60 offen offset:1024 sc1
v_mfma_f32_16x16x32_bf16 v[20:23], a[96:99], a[4:7], v[20:23]
ds_read_b128 a[76:79], v39 offset:14848
v_mfma_f32_16x16x32_bf16 v[24:27], a[100:103], a[4:7], v[24:27]
ds_read_b128 a[80:83], v39 offset:15872
v_mfma_f32_16x16x32_bf16 v[28:31], a[104:107], a[4:7], v[28:31]
ds_read_b128 a[84:87], v39 offset:16896
v_mfma_f32_16x16x32_bf16 v[32:35], a[108:111], a[4:7], v[32:35]
ds_read_b128 a[88:91], v36 offset:13824
s_waitcnt vmcnt(7) lgkmcnt(5)
v_mfma_f32_16x16x32_bf16 v[16:19], a[112:115], a[8:11], v[16:19]
ds_read_b128 a[92:95], v39 offset:18432
buffer_load_dwordx4 a[40:43], v1, s[8:11], s60 offen offset:2048 sc1
v_mfma_f32_16x16x32_bf16 v[20:23], a[116:119], a[8:11], v[20:23]
ds_read_b128 a[96:99], v39 offset:19456
v_mfma_f32_16x16x32_bf16 v[24:27], a[120:123], a[8:11], v[24:27]
ds_read_b128 a[100:103], v39 offset:20480
v_mfma_f32_16x16x32_bf16 v[28:31], a[124:127], a[8:11], v[28:31]
ds_read_b128 a[104:107], v39 offset:21504
v_mfma_f32_16x16x32_bf16 v[32:35], a[128:131], a[8:11], v[32:35]
ds_read_b128 a[108:111], v36 offset:18432
s_waitcnt vmcnt(7) lgkmcnt(5)
v_mfma_f32_16x16x32_bf16 v[16:19], a[72:75], a[12:15], v[16:19]
ds_read_b128 a[112:115], v39 offset:23040
buffer_load_dwordx4 a[44:47], v1, s[8:11], s60 offen offset:3072 sc1
v_mfma_f32_16x16x32_bf16 v[20:23], a[76:79], a[12:15], v[20:23]
ds_read_b128 a[116:119], v39 offset:24064
v_mfma_f32_16x16x32_bf16 v[24:27], a[80:83], a[12:15], v[24:27]
ds_read_b128 a[120:123], v39 offset:25088
v_mfma_f32_16x16x32_bf16 v[28:31], a[84:87], a[12:15], v[28:31]
ds_read_b128 a[124:127], v39 offset:26112
v_mfma_f32_16x16x32_bf16 v[32:35], a[88:91], a[12:15], v[32:35]
ds_read_b128 a[128:131], v36 offset:23040
s_waitcnt vmcnt(7) lgkmcnt(5)
v_mfma_f32_16x16x32_bf16 v[16:19], a[92:95], a[16:19], v[16:19]
ds_read_b128 a[72:75], v39 offset:27648
s_add_u32 s60, s60, 4096
buffer_load_dwordx4 a[48:51], v1, s[8:11], s60 offen offset:0 sc1
v_mfma_f32_16x16x32_bf16 v[20:23], a[96:99], a[16:19], v[20:23]
ds_read_b128 a[76:79], v39 offset:28672
v_mfma_f32_16x16x32_bf16 v[24:27], a[100:103], a[16:19], v[24:27]
ds_read_b128 a[80:83], v39 offset:29696
v_mfma_f32_16x16x32_bf16 v[28:31], a[104:107], a[16:19], v[28:31]
ds_read_b128 a[84:87], v39 offset:30720
v_mfma_f32_16x16x32_bf16 v[32:35], a[108:111], a[16:19], v[32:35]
ds_read_b128 a[88:91], v36 offset:27648
s_waitcnt vmcnt(7) lgkmcnt(5)
v_mfma_f32_16x16x32_bf16 v[16:19], a[112:115], a[20:23], v[16:19]
ds_read_b128 a[92:95], v39 offset:32256
buffer_load_dwordx4 a[52:55], v1, s[8:11], s60 offen offset:1024 sc1
v_mfma_f32_16x16x32_bf16 v[20:23], a[116:119], a[20:23], v[20:23]
ds_read_b128 a[96:99], v39 offset:33280
v_mfma_f32_16x16x32_bf16 v[24:27], a[120:123], a[20:23], v[24:27]
ds_read_b128 a[100:103], v39 offset:34304
v_mfma_f32_16x16x32_bf16 v[28:31], a[124:127], a[20:23], v[28:31]
ds_read_b128 a[104:107], v39 offset:35328
v_mfma_f32_16x16x32_bf16 v[32:35], a[128:131], a[20:23], v[32:35]
ds_read_b128 a[108:111], v36 offset:32256
s_waitcnt vmcnt(7) lgkmcnt(5)
v_mfma_f32_16x16x32_bf16 v[16:19], a[72:75], a[24:27], v[16:19]
ds_read_b128 a[112:115], v39 offset:36864
buffer_load_dwordx4 a[56:59], v1, s[8:11], s60 offen offset:2048 sc1
v_mfma_f32_16x16x32_bf16 v[20:23], a[76:79], a[24:27], v[20:23]
ds_read_b128 a[116:119], v39 offset:37888
v_mfma_f32_16x16x32_bf16 v[24:27], a[80:83], a[24:27], v[24:27]
ds_read_b128 a[120:123], v39 offset:38912
v_mfma_f32_16x16x32_bf16 v[28:31], a[84:87], a[24:27], v[28:31]
ds_read_b128 a[124:127], v39 offset:39936
v_mfma_f32_16x16x32_bf16 v[32:35], a[88:91], a[24:27], v[32:35]
ds_read_b128 a[128:131], v36 offset:36864
s_waitcnt vmcnt(7) lgkmcnt(5)
v_mfma_f32_16x16x32_bf16 v[16:19], a[92:95], a[28:31], v[16:19]
ds_read_b128 a[72:75], v37 offset:0
buffer_load_dwordx4 a[60:63], v1, s[8:11], s60 offen offset:3072 sc1
v_mfma_f32_16x16x32_bf16 v[20:23], a[96:99], a[28:31], v[20:23]
ds_read_b128 a[76:79], v37 offset:1024
v_mfma_f32_16x16x32_bf16 v[24:27], a[100:103], a[28:31], v[24:27]
ds_read_b128 a[80:83], v37 offset:2048
v_mfma_f32_16x16x32_bf16 v[28:31], a[104:107], a[28:31], v[28:31]
ds_read_b128 a[84:87], v37 offset:3072
v_mfma_f32_16x16x32_bf16 v[32:35], a[108:111], a[28:31], v[32:35]
ds_read_b128 a[88:91], v38 offset:0
s_waitcnt vmcnt(7) lgkmcnt(5)
v_mfma_f32_16x16x32_bf16 v[16:19], a[112:115], a[32:35], v[16:19]
ds_read_b128 a[92:95], v37 offset:4608
s_add_u32 s60, s60, 4096
buffer_load_dwordx2 a[64:65], v40, s[8:11], s60 offen offset:0 sc1
buffer_load_dwordx2 a[66:67], v40, s[8:11], s60 offen offset:1024 sc1
v_mfma_f32_16x16x32_bf16 v[20:23], a[116:119], a[32:35], v[20:23]
ds_read_b128 a[96:99], v37 offset:5632
v_mfma_f32_16x16x32_bf16 v[24:27], a[120:123], a[32:35], v[24:27]
ds_read_b128 a[100:103], v37 offset:6656
v_mfma_f32_16x16x32_bf16 v[28:31], a[124:127], a[32:35], v[28:31]
ds_read_b128 a[104:107], v37 offset:7680
v_mfma_f32_16x16x32_bf16 v[32:35], a[128:131], a[32:35], v[32:35]
ds_read_b128 a[108:111], v38 offset:4608
s_waitcnt vmcnt(8) lgkmcnt(5)
v_mfma_f32_16x16x32_bf16 v[16:19], a[72:75], a[36:39], v[16:19]
ds_read_b128 a[112:115], v37 offset:9216
buffer_load_dwordx2 a[68:69], v40, s[8:11], s60 offen offset:512 sc1
buffer_load_dwordx2 a[70:71], v40, s[8:11], s60 offen offset:1536 sc1
v_mfma_f32_16x16x32_bf16 v[20:23], a[76:79], a[36:39], v[20:23]
ds_read_b128 a[116:119], v37 offset:10240
v_mfma_f32_16x16x32_bf16 v[24:27], a[80:83], a[36:39], v[24:27]
ds_read_b128 a[120:123], v37 offset:11264
v_mfma_f32_16x16x32_bf16 v[28:31], a[84:87], a[36:39], v[28:31]
ds_read_b128 a[124:127], v37 offset:12288
v_mfma_f32_16x16x32_bf16 v[32:35], a[88:91], a[36:39], v[32:35]
ds_read_b128 a[128:131], v38 offset:9216
s_waitcnt vmcnt(9) lgkmcnt(5)
v_mfma_f32_16x16x32_bf16 v[16:19], a[92:95], a[40:43], v[16:19]
ds_read_b128 a[72:75], v37 offset:13824
v_mfma_f32_16x16x32_bf16 v[20:23], a[96:99], a[40:43], v[20:23]
ds_read_b128 a[76:79], v37 offset:14848
v_mfma_f32_16x16x32_bf16 v[24:27], a[100:103], a[40:43], v[24:27]
ds_read_b128 a[80:83], v37 offset:15872
v_mfma_f32_16x16x32_bf16 v[28:31], a[104:107], a[40:43], v[28:31]
ds_read_b128 a[84:87], v37 offset:16896
v_mfma_f32_16x16x32_bf16 v[32:35], a[108:111], a[40:43], v[32:35]
ds_read_b128 a[88:91], v38 offset:13824
s_waitcnt vmcnt(8) lgkmcnt(5)
v_mfma_f32_16x16x32_bf16 v[16:19], a[112:115], a[44:47], v[16:19]
ds_read_b128 a[92:95], v37 offset:18432
v_mfma_f32_16x16x32_bf16 v[20:23], a[116:119], a[44:47], v[20:23]
ds_read_b128 a[96:99], v37 offset:19456
v_mfma_f32_16x16x32_bf16 v[24:27], a[120:123], a[44:47], v[24:27]
ds_read_b128 a[100:103], v37 offset:20480
v_mfma_f32_16x16x32_bf16 v[28:31], a[124:127], a[44:47], v[28:31]
ds_read_b128 a[104:107], v37 offset:21504
v_mfma_f32_16x16x32_bf16 v[32:35], a[128:131], a[44:47], v[32:35]
ds_read_b128 a[108:111], v38 offset:18432
s_waitcnt vmcnt(7) lgkmcnt(5)
v_mfma_f32_16x16x32_bf16 v[16:19], a[72:75], a[48:51], v[16:19]
ds_read_b128 a[112:115], v37 offset:23040
v_mfma_f32_16x16x32_bf16 v[20:23], a[76:79], a[48:51], v[20:23]
ds_read_b128 a[116:119], v37 offset:24064
v_mfma_f32_16x16x32_bf16 v[24:27], a[80:83], a[48:51], v[24:27]
ds_read_b128 a[120:123], v37 offset:25088
v_mfma_f32_16x16x32_bf16 v[28:31], a[84:87], a[48:51], v[28:31]
ds_read_b128 a[124:127], v37 offset:26112
v_mfma_f32_16x16x32_bf16 v[32:35], a[88:91], a[48:51], v[32:35]
ds_read_b128 a[128:131], v38 offset:23040
s_waitcnt vmcnt(6) lgkmcnt(5)
v_mfma_f32_16x16x32_bf16 v[16:19], a[92:95], a[52:55], v[16:19]
ds_read_b128 a[72:75], v37 offset:27648
v_mfma_f32_16x16x32_bf16 v[20:23], a[96:99], a[52:55], v[20:23]
ds_read_b128 a[76:79], v37 offset:28672
v_mfma_f32_16x16x32_bf16 v[24:27], a[100:103], a[52:55], v[24:27]
ds_read_b128 a[80:83], v37 offset:29696
v_mfma_f32_16x16x32_bf16 v[28:31], a[104:107], a[52:55], v[28:31]
ds_read_b128 a[84:87], v37 offset:30720
v_mfma_f32_16x16x32_bf16 v[32:35], a[108:111], a[52:55], v[32:35]
ds_read_b128 a[88:91], v38 offset:27648
s_waitcnt vmcnt(5) lgkmcnt(5)
v_mfma_f32_16x16x32_bf16 v[16:19], a[112:115], a[56:59], v[16:19]
ds_read_b128 a[92:95], v37 offset:32256
v_mfma_f32_16x16x32_bf16 v[20:23], a[116:119], a[56:59], v[20:23]
ds_read_b128 a[96:99], v37 offset:33280
v_mfma_f32_16x16x32_bf16 v[24:27], a[120:123], a[56:59], v[24:27]
ds_read_b128 a[100:103], v37 offset:34304
v_mfma_f32_16x16x32_bf16 v[28:31], a[124:127], a[56:59], v[28:31]
ds_read_b128 a[104:107], v37 offset:35328
v_mfma_f32_16x16x32_bf16 v[32:35], a[128:131], a[56:59], v[32:35]
ds_read_b128 a[108:111], v38 offset:32256
s_waitcnt vmcnt(4) lgkmcnt(5)
v_mfma_f32_16x16x32_bf16 v[16:19], a[72:75], a[60:63], v[16:19]
ds_read_b128 a[112:115], v37 offset:36864
v_mfma_f32_16x16x32_bf16 v[20:23], a[76:79], a[60:63], v[20:23]
ds_read_b128 a[116:119], v37 offset:37888
v_mfma_f32_16x16x32_bf16 v[24:27], a[80:83], a[60:63], v[24:27]
ds_read_b128 a[120:123], v37 offset:38912
v_mfma_f32_16x16x32_bf16 v[28:31], a[84:87], a[60:63], v[28:31]
ds_read_b128 a[124:127], v37 offset:39936
v_mfma_f32_16x16x32_bf16 v[32:35], a[88:91], a[60:63], v[32:35]
ds_read_b128 a[128:131], v38 offset:36864
s_waitcnt vmcnt(2) lgkmcnt(5)
v_mfma_f32_16x16x32_bf16 v[16:19], a[92:95], a[64:67], v[16:19]
v_mfma_f32_16x16x32_bf16 v[20:23], a[96:99], a[64:67], v[20:23]
v_mfma_f32_16x16x32_bf16 v[24:27], a[100:103], a[64:67], v[24:27]
v_mfma_f32_16x16x32_bf16 v[28:31], a[104:107], a[64:67], v[28:31]
v_mfma_f32_16x16x32_bf16 v[32:35], a[108:111], a[64:67], v[32:35]
s_waitcnt vmcnt(0) lgkmcnt(0)
v_mfma_f32_16x16x32_bf16 v[16:19], a[112:115], a[68:71], v[16:19]
v_mfma_f32_16x16x32_bf16 v[20:23], a[116:119], a[68:71], v[20:23]
v_mfma_f32_16x16x32_bf16 v[24:27], a[120:123], a[68:71], v[24:27]
v_mfma_f32_16x16x32_bf16 v[28:31], a[124:127], a[68:71], v[28:31]
v_mfma_f32_16x16x32_bf16 v[32:35], a[128:131], a[68:71], v[32:35]
s_nop 3
v_pk_add_f32 v[62:63], v[16:17], v[18:19]
v_pk_mul_f32 v[64:65], v[16:17], v[16:17]
v_pk_fma_f32 v[64:65], v[18:19], v[18:19], v[64:65]
v_pk_add_f32 v[62:63], v[62:63], v[20:21]
v_pk_fma_f32 v[64:65], v[20:21], v[20:21], v[64:65]
v_pk_add_f32 v[62:63], v[62:63], v[22:23]
v_pk_fma_f32 v[64:65], v[22:23], v[22:23], v[64:65]
v_pk_add_f32 v[62:63], v[62:63], v[24:25]
v_pk_fma_f32 v[64:65], v[24:25], v[24:25], v[64:65]
v_pk_add_f32 v[62:63], v[62:63], v[26:27]
v_pk_fma_f32 v[64:65], v[26:27], v[26:27], v[64:65]
v_pk_add_f32 v[62:63], v[62:63], v[28:29]
v_pk_fma_f32 v[64:65], v[28:29], v[28:29], v[64:65]
v_pk_add_f32 v[62:63], v[62:63], v[30:31]
v_pk_fma_f32 v[64:65], v[30:31], v[30:31], v[64:65]
s_mov_b32 exec_hi, 0
v_pk_add_f32 v[62:63], v[62:63], v[32:33]
v_pk_fma_f32 v[64:65], v[32:33], v[32:33], v[64:65]
v_pk_add_f32 v[62:63], v[62:63], v[34:35]
v_pk_fma_f32 v[64:65], v[34:35], v[34:35], v[64:65]
s_mov_b64 exec, -1
v_add_f32 v56, v62, v63
v_add_f32 v57, v64, v65
v_cvt_pk_bf16_f32 v52, v32, v33
v_cvt_pk_bf16_f32 v53, v34, v35
v_permlane32_swap_b32 v56, v57
v_add_f32 v56, v56, v57
v_mov_b32 v57, v56
v_cvt_pk_bf16_f32 v44, v16, v17
v_cvt_pk_bf16_f32 v45, v18, v19
v_permlane16_swap_b32 v56, v57
v_add_f32 v56, v56, v57
v_mov_b32 v57, v56
v_cvt_pk_bf16_f32 v46, v20, v21
v_cvt_pk_bf16_f32 v47, v22, v23
v_permlane32_swap_b32 v56, v57
buffer_store_dwordx4 v[44:47], v60, s[8:11], s62 offen sc1
buffer_store_dwordx2 v[56:57], v58, s[8:11], s63 offen sc1
v_cvt_pk_bf16_f32 v48, v24, v25
v_cvt_pk_bf16_f32 v49, v26, v27
v_cvt_pk_bf16_f32 v50, v28, v29
v_cvt_pk_bf16_f32 v51, v30, v31
v_permlane16_swap_b32 v52, v54
v_permlane16_swap_b32 v53, v55
buffer_store_dwordx4 v[48:51], v60, s[8:11], s62 offen offset:1024 sc1
buffer_store_dwordx4 v[52:55], v61, s[8:11], s62 offen sc1
s_barrier
s_mul_i32 s38, s24, 9216
s_add_u32 m0, s38, 37888
s_add_u32 s39, s38, s82
s_add_u32 s39, s39, 75776
buffer_load_dwordx4 v1, s[4:7], s39 offen offset:0 sc1 lds
buffer_load_dwordx4 v1, s[4:7], s39 offen offset:1024 sc1 lds
buffer_load_dwordx4 v1, s[4:7], s39 offen offset:2048 sc1 lds
buffer_load_dwordx4 v1, s[4:7], s39 offen offset:3072 sc1 lds
s_add_u32 m0, m0, 4096
s_add_u32 s39, s39, 4096
buffer_load_dwordx4 v1, s[4:7], s39 offen offset:0 sc1 lds
buffer_load_dwordx4 v1, s[4:7], s39 offen offset:1024 sc1 lds
buffer_load_dwordx4 v1, s[4:7], s39 offen offset:2048 sc1 lds
v_lshlrev_b32 v7, 3, v1
s_lshr_b32 s31, s80, 4
s_lshl_b32 s31, s31, 11
v_add_u32 v7, s31, v7
s_cmp_eq_u32 s24, 0
s_cselect_b32 s30, 0, 1073741824
s_add_u32 s30, s30, 26509312
s_waitcnt vmcnt(7)
s_barrier
s_mov_b64 exec, 0xffff
buffer_atomic_add v4, v7, s[8:11], s30 offen sc1
s_mov_b64 exec, -1
s_lshl_b32 s35, s80, 7
s_add_u32 s35, s35, 26509312
s_cmp_eq_u32 s24, 1
s_cselect_b32 s35, s35, 1073741824
v_mov_b32 v6, 0
v_mov_b32 v244, 0
v_mov_b32 v245, 0
v_mov_b32 v246, 0
buffer_load_dwordx4 v1, s[4:7], s39 offen offset:3072 sc1 lds
s_add_u32 m0, m0, 4096
s_add_u32 s39, s39, 4096
buffer_load_dwordx4 v1, s[4:7], s39 offen offset:0 sc1 lds
s_lshl_b32 s38, s24, 8
s_add_u32 m0, s38, 74752
s_add_u32 s39, s38, s82
s_add_u32 s39, s39, 112640
s_mov_b64 exec, 0xffff
buffer_load_dwordx4 v1, s[4:7], s39 offen sc1 lds
s_mov_b64 exec, -1
s_mul_i32 s38, s24, 9216
s_add_u32 m0, s38, 75776
s_add_u32 s39, s38, s82
s_add_u32 s39, s39, 113664
buffer_load_dwordx4 v1, s[4:7], s39 offen offset:0 sc1 lds
s_mov_b64 exec, 1
buffer_atomic_add v244, v6, s[8:11], s35 offen sc0 sc1
s_mov_b64 exec, -1
buffer_load_dwordx4 v1, s[4:7], s39 offen offset:1024 sc1 lds
buffer_load_dwordx4 v1, s[4:7], s39 offen offset:2048 sc1 lds
buffer_load_dwordx4 v1, s[4:7], s39 offen offset:3072 sc1 lds
s_add_u32 m0, m0, 4096
s_add_u32 s39, s39, 4096
s_mov_b64 exec, 1
buffer_atomic_add v245, v6, s[8:11], s35 offen sc0 sc1
s_mov_b64 exec, -1
buffer_load_dwordx4 v1, s[4:7], s39 offen offset:0 sc1 lds
buffer_load_dwordx4 v1, s[4:7], s39 offen offset:1024 sc1 lds
buffer_load_dwordx4 v1, s[4:7], s39 offen offset:2048 sc1 lds
s_mov_b64 exec, 1
buffer_atomic_add v246, v6, s[8:11], s35 offen sc0 sc1
s_mov_b64 exec, -1
buffer_load_dwordx4 v1, s[4:7], s39 offen offset:3072 sc1 lds
s_add_u32 m0, m0, 4096
s_add_u32 s39, s39, 4096
buffer_load_dwordx4 v1, s[4:7], s39 offen offset:0 sc1 lds
s_lshl_b32 s38, s24, 8
s_add_u32 m0, s38, 112640
s_add_u32 s39, s38, s82
s_add_u32 s39, s39, 150528
s_mov_b64 exec, 0xffff
buffer_load_dwordx4 v1, s[4:7], s39 offen sc1 lds
s_mov_b64 exec, -1
s_lshl_b32 s60, s25, 2
s_add_u32 s60, s60, s24
s_mul_i32 s62, s60, 36864
s_add_u32 s62, s62, 4849664
v_add_u32 v180, 18432, v1
s_cmp_eq_u32 s24, 1
s_cbranch_scc0 L_other_20
s_mov_b32 s31, 0
s_mov_b64 exec, 1
v_mov_b32 v247, 0
buffer_atomic_add v247, v6, s[8:11], s35 offen sc0 sc1
s_waitcnt vmcnt(12)
v_cmp_gt_u32 vcc, 16, v244
s_nop 0
s_cbranch_vccz L_polled_19
s_waitcnt vmcnt(8)
v_cmp_gt_u32 vcc, 16, v245
s_nop 0
s_cbranch_vccz L_polled_19
v_mov_b32 v244, 0
buffer_atomic_add v244, v6, s[8:11], s35 offen sc0 sc1
s_waitcnt vmcnt(5)
v_cmp_gt_u32 vcc, 16, v246
s_nop 0
s_cbranch_vccz L_polled_19
v_mov_b32 v245, 0
buffer_atomic_add v245, v6, s[8:11], s35 offen sc0 sc1
L_poll_18:
s_add_u32 s31, s31, 1
s_cmp_gt_u32 s31, 100000
s_cbranch_scc1 L_polled_19
v_mov_b32 v246, 0
buffer_atomic_add v246, v6, s[8:11], s35 offen sc0 sc1
s_waitcnt vmcnt(3)
v_cmp_gt_u32 vcc, 16, v247
s_nop 0
s_cbranch_vccz L_polled_19
v_mov_b32 v247, 0
buffer_atomic_add v247, v6, s[8:11], s35 offen sc0 sc1
s_waitcnt vmcnt(3)
v_cmp_gt_u32 vcc, 16, v244
s_nop 0
s_cbranch_vccz L_polled_19
v_mov_b32 v244, 0
buffer_atomic_add v244, v6, s[8:11], s35 offen sc0 sc1
s_waitcnt vmcnt(3)
v_cmp_gt_u32 vcc, 16, v245
s_nop 0
s_cbranch_vccz L_polled_19
v_mov_b32 v245, 0
buffer_atomic_add v245, v6, s[8:11], s35 offen sc0 sc1
s_waitcnt vmcnt(3)
v_cmp_gt_u32 vcc, 16, v246
s_nop 0
s_cbranch_vccz L_polled_19
s_branch L_poll_18
L_polled_19:
s_mov_b64 exec, -1
L_other_20:
s_barrier
buffer_load_dwordx4 a[0:3], v1, s[8:11], s62 offen offset:0 sc1
buffer_load_dwordx4 a[4:7], v180, s[8:11], s62 offen offset:0 sc1
s_barrier
buffer_load_dwordx4 a[8:11], v1, s[8:11], s62 offen offset:1024 sc1
buffer_load_dwordx4 a[12:15], v180, s[8:11], s62 offen offset:1024 sc1
s_barrier
buffer_load_dwordx4 a[16:19], v1, s[8:11], s62 offen offset:2048 sc1
buffer_load_dwordx4 a[20:23], v180, s[8:11], s62 offen offset:2048 sc1
s_barrier
buffer_load_dwordx4 a[24:27], v1, s[8:11], s62 offen offset:3072 sc1
buffer_load_dwordx4 a[28:31], v180, s[8:11], s62 offen offset:3072 sc1
s_barrier
s_add_u32 s62, s62, 4096
buffer_load_dwordx4 a[32:35], v1, s[8:11], s62 offen offset:0 sc1
buffer_load_dwordx4 a[36:39], v180, s[8:11], s62 offen offset:0 sc1
s_barrier
buffer_load_dwordx4 a[40:43], v1, s[8:11], s62 offen offset:1024 sc1
buffer_load_dwordx4 a[44:47], v180, s[8:11], s62 offen offset:1024 sc1
s_lshl_b32 s53, s25, 2
s_add_u32 s53, s53, s24
s_mul_i32 s53, s53, 133120
s_add_u32 s53, s53, 10895360
s_lshl_b32 s52, s25, 12
s_add_u32 s52, s52, s53
v_lshrrev_b32 v239, 1, v1
v_and_b32 v6, 0xf8, v239
v_lshrrev_b32 v7, 1, v3
v_lshl_add_u32 v232, v7, 16, v6
s_lshl_b32 s63, s60, 8
s_add_u32 s63, s63, 7208960
v_add_u32 v208, 123904, v1
v_add_u32 v209, 0, v1
v_add_u32 v210, 37888, v1
v_add_u32 v211, 75776, v1
ds_read_b128 a[144:147], v208 offset:0
ds_read_b128 a[148:151], v208 offset:18432
ds_read_b128 a[152:155], v209 offset:0
ds_read_b128 a[156:159], v209 offset:18432
ds_read_b128 a[160:163], v208 offset:1024
ds_read_b128 a[164:167], v208 offset:19456
s_waitcnt vmcnt(10) lgkmcnt(4)
v_mfma_f32_16x16x32_bf16 v[36:39], a[144:147], a[0:3], 0
ds_read_b128 a[168:171], v209 offset:1024
ds_read_b128 a[172:175], v209 offset:19456
v_mfma_f32_16x16x32_bf16 v[40:43], a[144:147], a[4:7], 0
buffer_load_dwordx4 a[48:51], v1, s[8:11], s62 offen offset:2048 sc1
v_mfma_f32_16x16x32_bf16 v[44:47], a[148:151], a[0:3], 0
buffer_load_dwordx4 a[52:55], v180, s[8:11], s62 offen offset:2048 sc1
v_mfma_f32_16x16x32_bf16 v[48:51], a[148:151], a[4:7], 0
s_waitcnt lgkmcnt(4)
v_mfma_f32_16x16x32_bf16 v[52:55], a[152:155], a[0:3], 0
ds_read_b128 a[144:147], v208 offset:2048
ds_read_b128 a[148:151], v208 offset:20480
v_mfma_f32_16x16x32_bf16 v[56:59], a[152:155], a[4:7], 0
buffer_load_dwordx4 a[56:59], v1, s[8:11], s62 offen offset:3072 sc1
v_lshl_add_u32 v234, v7, 13, v6
v_mfma_f32_16x16x32_bf16 v[60:63], a[156:159], a[0:3], 0
v_add_u32 v235, 4096, v234
v_mfma_f32_16x16x32_bf16 v[64:67], a[156:159], a[4:7], 0
s_waitcnt vmcnt(11) lgkmcnt(4)
s_barrier
v_mfma_f32_16x16x32_bf16 v[36:39], a[160:163], a[8:11], v[36:39]
ds_read_b128 a[152:155], v209 offset:2048
ds_read_b128 a[156:159], v209 offset:20480
v_mfma_f32_16x16x32_bf16 v[40:43], a[160:163], a[12:15], v[40:43]
buffer_load_dwordx4 a[60:63], v180, s[8:11], s62 offen offset:3072 sc1
s_mul_i32 s30, s24, 9216
v_mfma_f32_16x16x32_bf16 v[44:47], a[164:167], a[8:11], v[44:47]
s_add_u32 s62, s62, 4096
v_mfma_f32_16x16x32_bf16 v[48:51], a[164:167], a[12:15], v[48:51]
s_waitcnt lgkmcnt(4)
s_add_u32 s30, s30, 0
v_mfma_f32_16x16x32_bf16 v[52:55], a[168:171], a[8:11], v[52:55]
ds_read_b128 a[160:163], v208 offset:3072
ds_read_b128 a[164:167], v208 offset:21504
v_mfma_f32_16x16x32_bf16 v[56:59], a[168:171], a[12:15], v[56:59]
buffer_load_dwordx4 a[64:67], v1, s[8:11], s62 offen offset:0 sc1
v_mul_u32_u24 v236, 288, v2
v_mfma_f32_16x16x32_bf16 v[60:63], a[172:175], a[8:11], v[60:63]
v_mfma_f32_16x16x32_bf16 v[64:67], a[172:175], a[12:15], v[64:67]
s_waitcnt lgkmcnt(4)
v_add_u32 v236, s30, v236
s_waitcnt vmcnt(11)
v_mfma_f32_16x16x32_bf16 v[36:39], a[144:147], a[16:19], v[36:39]
ds_read_b128 a[168:171], v209 offset:3072
ds_read_b128 a[172:175], v209 offset:21504
v_mfma_f32_16x16x32_bf16 v[40:43], a[144:147], a[20:23], v[40:43]
buffer_load_dwordx2 v[182:183], v232, s[8:11], s63 offen sc1
v_mfma_f32_16x16x32_bf16 v[44:47], a[148:151], a[16:19], v[44:47]
s_add_u32 s63, s63, 16384
v_lshl_add_u32 v7, v3, 3, v236
v_mfma_f32_16x16x32_bf16 v[48:51], a[148:151], a[20:23], v[48:51]
s_waitcnt lgkmcnt(4)
v_mfma_f32_16x16x32_bf16 v[52:55], a[152:155], a[16:19], v[52:55]
ds_read_b128 a[144:147], v208 offset:4096
ds_read_b128 a[148:151], v208 offset:22528
v_mfma_f32_16x16x32_bf16 v[56:59], a[152:155], a[20:23], v[56:59]
v_lshl_add_u32 v236, v3, 4, v236
v_mfma_f32_16x16x32_bf16 v[60:63], a[156:159], a[16:19], v[60:63]
buffer_load_dwordx2 v[184:185], v232, s[8:11], s63 offen sc1
v_lshrrev_b32 v8, 2, v2
v_mfma_f32_16x16x32_bf16 v[64:67], a[156:159], a[20:23], v[64:67]
s_waitcnt vmcnt(11) lgkmcnt(4)
v_mfma_f32_16x16x32_bf16 v[36:39], a[160:163], a[24:27], v[36:39]
ds_read_b128 a[152:155], v209 offset:4096
ds_read_b128 a[156:159], v209 offset:22528
v_mfma_f32_16x16x32_bf16 v[40:43], a[160:163], a[28:31], v[40:43]
s_add_u32 s63, s63, 16384
v_lshl_add_u32 v8, v3, 3, v8
v_mfma_f32_16x16x32_bf16 v[44:47], a[164:167], a[24:27], v[44:47]
v_mfma_f32_16x16x32_bf16 v[48:51], a[164:167], a[28:31], v[48:51]
s_waitcnt lgkmcnt(4)
v_mul_u32_u24 v237, 288, v8
v_mfma_f32_16x16x32_bf16 v[52:55], a[168:171], a[24:27], v[52:55]
ds_read_b128 a[160:163], v208 offset:5120
ds_read_b128 a[164:167], v208 offset:23552
v_mfma_f32_16x16x32_bf16 v[56:59], a[168:171], a[28:31], v[56:59]
buffer_load_dwordx2 v[186:187], v232, s[8:11], s63 offen sc1
v_add_u32 v237, s30, v237
v_mfma_f32_16x16x32_bf16 v[60:63], a[172:175], a[24:27], v[60:63]
s_add_u32 s63, s63, 16384
v_mfma_f32_16x16x32_bf16 v[64:67], a[172:175], a[28:31], v[64:67]
s_waitcnt vmcnt(10) lgkmcnt(4)
v_mfma_f32_16x16x32_bf16 v[36:39], a[144:147], a[32:35], v[36:39]
ds_read_b128 a[168:171], v209 offset:5120
ds_read_b128 a[172:175], v209 offset:23552
v_mfma_f32_16x16x32_bf16 v[40:43], a[144:147], a[36:39], v[40:43]
buffer_load_dwordx2 v[188:189], v232, s[8:11], s63 offen sc1
v_and_b32 v8, 3, v2
v_mfma_f32_16x16x32_bf16 v[44:47], a[148:151], a[32:35], v[44:47]
s_add_u32 s63, s63, 16384
v_lshl_add_u32 v238, v8, 3, v237
v_mfma_f32_16x16x32_bf16 v[48:51], a[148:151], a[36:39], v[48:51]
s_waitcnt lgkmcnt(4)
v_mfma_f32_16x16x32_bf16 v[52:55], a[152:155], a[32:35], v[52:55]
ds_read_b128 a[144:147], v208 offset:6144
ds_read_b128 a[148:151], v208 offset:24576
v_mfma_f32_16x16x32_bf16 v[56:59], a[152:155], a[36:39], v[56:59]
v_lshl_add_u32 v237, v8, 4, v237
v_mfma_f32_16x16x32_bf16 v[60:63], a[156:159], a[32:35], v[60:63]
buffer_load_dwordx4 a[68:71], v180, s[8:11], s62 offen offset:0 sc1
v_mfma_f32_16x16x32_bf16 v[64:67], a[156:159], a[36:39], v[64:67]
s_waitcnt lgkmcnt(4)
s_mul_i32 s66, s26, 589824
s_waitcnt vmcnt(10)
v_mfma_f32_16x16x32_bf16 v[36:39], a[160:163], a[40:43], v[36:39]
ds_read_b128 a[152:155], v209 offset:6144
ds_read_b128 a[156:159], v209 offset:24576
v_mfma_f32_16x16x32_bf16 v[40:43], a[160:163], a[44:47], v[40:43]
buffer_load_dwordx4 a[72:75], v1, s[8:11], s62 offen offset:1024 sc1
s_mul_i32 s31, s60, 9216
v_mfma_f32_16x16x32_bf16 v[44:47], a[164:167], a[40:43], v[44:47]
s_add_u32 s66, s66, s31
v_mfma_f32_16x16x32_bf16 v[48:51], a[164:167], a[44:47], v[48:51]
s_waitcnt lgkmcnt(4)
v_mfma_f32_16x16x32_bf16 v[52:55], a[168:171], a[40:43], v[52:55]
ds_read_b128 a[160:163], v208 offset:7168
ds_read_b128 a[164:167], v208 offset:25600
v_mfma_f32_16x16x32_bf16 v[56:59], a[168:171], a[44:47], v[56:59]
buffer_load_dwordx4 a[76:79], v180, s[8:11], s62 offen offset:1024 sc1
v_mfma_f32_16x16x32_bf16 v[60:63], a[172:175], a[40:43], v[60:63]
s_add_u32 s66, s66, 7340032
v_mfma_f32_16x16x32_bf16 v[64:67], a[172:175], a[44:47], v[64:67]
s_waitcnt vmcnt(10) lgkmcnt(4)
v_mfma_f32_16x16x32_bf16 v[36:39], a[144:147], a[48:51], v[36:39]
ds_read_b128 a[168:171], v209 offset:7168
ds_read_b128 a[172:175], v209 offset:25600
v_mfma_f32_16x16x32_bf16 v[40:43], a[144:147], a[52:55], v[40:43]
buffer_load_dwordx4 a[80:83], v1, s[8:11], s62 offen offset:2048 sc1
v_lshlrev_b32 v233, 7, v1
v_mfma_f32_16x16x32_bf16 v[44:47], a[148:151], a[48:51], v[44:47]
buffer_load_dwordx4 a[84:87], v180, s[8:11], s62 offen offset:2048 sc1
v_mfma_f32_16x16x32_bf16 v[48:51], a[148:151], a[52:55], v[48:51]
s_waitcnt lgkmcnt(4)
s_lshl_b32 s31, s26, 7
v_mfma_f32_16x16x32_bf16 v[52:55], a[152:155], a[48:51], v[52:55]
ds_read_b128 a[144:147], v208 offset:8192
ds_read_b128 a[148:151], v208 offset:26624
v_mfma_f32_16x16x32_bf16 v[56:59], a[152:155], a[52:55], v[56:59]
buffer_load_dwordx4 a[88:91], v1, s[8:11], s62 offen offset:3072 sc1
v_add_u32 v233, s31, v233
v_mfma_f32_16x16x32_bf16 v[60:63], a[156:159], a[48:51], v[60:63]
s_lshl_b32 s61, s25, 14
v_mfma_f32_16x16x32_bf16 v[64:67], a[156:159], a[52:55], v[64:67]
s_waitcnt vmcnt(11) lgkmcnt(4)
v_mfma_f32_16x16x32_bf16 v[36:39], a[160:163], a[56:59], v[36:39]
ds_read_b128 a[152:155], v209 offset:8192
ds_read_b128 a[156:159], v209 offset:26624
v_mfma_f32_16x16x32_bf16 v[40:43], a[160:163], a[60:63], v[40:43]
buffer_load_dwordx4 a[92:95], v180, s[8:11], s62 offen offset:3072 sc1
v_mfma_f32_16x16x32_bf16 v[44:47], a[164:167], a[56:59], v[44:47]
s_add_u32 s62, s62, 4096
s_lshl_b32 s30, s24, 8
v_mfma_f32_16x16x32_bf16 v[48:51], a[164:167], a[60:63], v[48:51]
s_waitcnt lgkmcnt(4)
v_mfma_f32_16x16x32_bf16 v[52:55], a[168:171], a[56:59], v[52:55]
ds_read_b128 a[160:163], v208 offset:9216
ds_read_b128 a[164:167], v208 offset:27648
v_mfma_f32_16x16x32_bf16 v[56:59], a[168:171], a[60:63], v[56:59]
buffer_load_dwordx4 a[96:99], v1, s[8:11], s62 offen offset:0 sc1
s_add_u32 s61, s61, s30
v_mfma_f32_16x16x32_bf16 v[60:63], a[172:175], a[56:59], v[60:63]
s_add_u32 s61, s61, 26214400
v_mfma_f32_16x16x32_bf16 v[64:67], a[172:175], a[60:63], v[64:67]
s_waitcnt vmcnt(7) lgkmcnt(4)
v_mfma_f32_16x16x32_bf16 v[36:39], a[144:147], a[64:67], v[36:39]
ds_read_b128 a[168:171], v209 offset:9216
ds_read_b128 a[172:175], v209 offset:27648
v_mfma_f32_16x16x32_bf16 v[40:43], a[144:147], a[68:71], v[40:43]
buffer_load_dwordx4 a[100:103], v180, s[8:11], s62 offen offset:0 sc1
s_mul_i32 s30, s24, 9216
v_mfma_f32_16x16x32_bf16 v[44:47], a[148:151], a[64:67], v[44:47]
buffer_load_dwordx4 a[104:107], v1, s[8:11], s62 offen offset:1024 sc1
v_mfma_f32_16x16x32_bf16 v[48:51], a[148:151], a[68:71], v[48:51]
s_waitcnt lgkmcnt(4)
s_add_u32 s30, s30, 0
v_mfma_f32_16x16x32_bf16 v[52:55], a[152:155], a[64:67], v[52:55]
ds_read_b128 a[144:147], v208 offset:10240
ds_read_b128 a[148:151], v208 offset:28672
v_mfma_f32_16x16x32_bf16 v[56:59], a[152:155], a[68:71], v[56:59]
buffer_load_dwordx4 a[108:111], v180, s[8:11], s62 offen offset:1024 sc1
v_add_u32 v240, s30, v1
v_mfma_f32_16x16x32_bf16 v[60:63], a[156:159], a[64:67], v[60:63]
s_lshl_b32 s30, s26, 10
v_mfma_f32_16x16x32_bf16 v[64:67], a[156:159], a[68:71], v[64:67]
s_waitcnt vmcnt(8) lgkmcnt(4)
v_mfma_f32_16x16x32_bf16 v[36:39], a[160:163], a[72:75], v[36:39]
ds_read_b128 a[152:155], v209 offset:10240
ds_read_b128 a[156:159], v209 offset:28672
v_mfma_f32_16x16x32_bf16 v[40:43], a[160:163], a[76:79], v[40:43]
buffer_load_dwordx4 a[112:115], v1, s[8:11], s62 offen offset:2048 sc1
v_mfma_f32_16x16x32_bf16 v[44:47], a[164:167], a[72:75], v[44:47]
buffer_load_dwordx4 a[116:119], v180, s[8:11], s62 offen offset:2048 sc1
s_add_u32 s30, s30, s61
v_mfma_f32_16x16x32_bf16 v[48:51], a[164:167], a[76:79], v[48:51]
s_waitcnt lgkmcnt(4)
v_mfma_f32_16x16x32_bf16 v[52:55], a[168:171], a[72:75], v[52:55]
ds_read_b128 a[160:163], v208 offset:11264
ds_read_b128 a[164:167], v208 offset:29696
v_mfma_f32_16x16x32_bf16 v[56:59], a[168:171], a[76:79], v[56:59]
buffer_load_dwordx4 a[120:123], v1, s[8:11], s62 offen offset:3072 sc1
v_mfma_f32_16x16x32_bf16 v[60:63], a[172:175], a[72:75], v[60:63]
v_mfma_f32_16x16x32_bf16 v[64:67], a[172:175], a[76:79], v[64:67]
s_waitcnt vmcnt(9) lgkmcnt(4)
v_mfma_f32_16x16x32_bf16 v[36:39], a[144:147], a[80:83], v[36:39]
ds_read_b128 a[168:171], v209 offset:11264
ds_read_b128 a[172:175], v209 offset:29696
v_mfma_f32_16x16x32_bf16 v[40:43], a[144:147], a[84:87], v[40:43]
buffer_load_dwordx4 a[124:127], v180, s[8:11], s62 offen offset:3072 sc1
v_mfma_f32_16x16x32_bf16 v[44:47], a[148:151], a[80:83], v[44:47]
s_add_u32 s62, s62, 4096
v_add_f32 v198, v182, v184
v_add_f32 v199, v183, v185
v_mfma_f32_16x16x32_bf16 v[48:51], a[148:151], a[84:87], v[48:51]
s_waitcnt lgkmcnt(4)
v_add_f32 v198, v198, v186
v_mfma_f32_16x16x32_bf16 v[52:55], a[152:155], a[80:83], v[52:55]
ds_read_b128 a[144:147], v208 offset:12288
ds_read_b128 a[148:151], v208 offset:30720
v_mfma_f32_16x16x32_bf16 v[56:59], a[152:155], a[84:87], v[56:59]
buffer_load_dwordx4 a[128:131], v1, s[8:11], s62 offen offset:0 sc1
v_add_f32 v199, v199, v187
v_mfma_f32_16x16x32_bf16 v[60:63], a[156:159], a[80:83], v[60:63]
v_add_f32 v198, v198, v188
v_mfma_f32_16x16x32_bf16 v[64:67], a[156:159], a[84:87], v[64:67]
s_waitcnt lgkmcnt(4)
v_add_f32 v199, v199, v189
s_waitcnt vmcnt(9)
v_mfma_f32_16x16x32_bf16 v[36:39], a[160:163], a[88:91], v[36:39]
ds_read_b128 a[152:155], v209 offset:12288
ds_read_b128 a[156:159], v209 offset:30720
v_mfma_f32_16x16x32_bf16 v[40:43], a[160:163], a[92:95], v[40:43]
buffer_load_dwordx4 a[132:135], v180, s[8:11], s62 offen offset:0 sc1
v_mov_b32 v200, v198
v_mfma_f32_16x16x32_bf16 v[44:47], a[164:167], a[88:91], v[44:47]
v_mov_b32 v201, v199
v_mfma_f32_16x16x32_bf16 v[48:51], a[164:167], a[92:95], v[48:51]
s_waitcnt lgkmcnt(4)
s_nop 0
v_mfma_f32_16x16x32_bf16 v[52:55], a[168:171], a[88:91], v[52:55]
ds_read_b128 a[160:163], v208 offset:13312
ds_read_b128 a[164:167], v208 offset:31744
v_mfma_f32_16x16x32_bf16 v[56:59], a[168:171], a[92:95], v[56:59]
buffer_load_dwordx4 a[136:139], v1, s[8:11], s62 offen offset:1024 sc1
v_mfma_f32_16x16x32_bf16 v[60:63], a[172:175], a[88:91], v[60:63]
buffer_load_dwordx4 a[140:143], v180, s[8:11], s62 offen offset:1024 sc1
v_mfma_f32_16x16x32_bf16 v[64:67], a[172:175], a[92:95], v[64:67]
s_waitcnt vmcnt(10) lgkmcnt(4)
v_mfma_f32_16x16x32_bf16 v[36:39], a[144:147], a[96:99], v[36:39]
ds_read_b128 a[168:171], v209 offset:13312
ds_read_b128 a[172:175], v209 offset:31744
v_mfma_f32_16x16x32_bf16 v[40:43], a[144:147], a[100:103], v[40:43]
v_permlane32_swap_b32 v198, v200
v_mfma_f32_16x16x32_bf16 v[44:47], a[148:151], a[96:99], v[44:47]
v_permlane32_swap_b32 v199, v201
v_mfma_f32_16x16x32_bf16 v[48:51], a[148:151], a[100:103], v[48:51]
s_waitcnt lgkmcnt(4)
v_add_f32 v198, v198, v200
v_add_f32 v199, v199, v201
v_mfma_f32_16x16x32_bf16 v[52:55], a[152:155], a[96:99], v[52:55]
ds_read_b128 a[144:147], v208 offset:14336
ds_read_b128 a[148:151], v208 offset:32768
v_mfma_f32_16x16x32_bf16 v[56:59], a[152:155], a[100:103], v[56:59]
v_mul_f32 v198, 0x3ae38e39, v198
v_mul_f32 v200, v198, v198
v_mfma_f32_16x16x32_bf16 v[60:63], a[156:159], a[96:99], v[60:63]
v_mul_f32 v199, 0x3ae38e39, v199
v_mfma_f32_16x16x32_bf16 v[64:67], a[156:159], a[100:103], v[64:67]
s_waitcnt vmcnt(8) lgkmcnt(4)
v_mfma_f32_16x16x32_bf16 v[36:39], a[160:163], a[104:107], v[36:39]
ds_read_b128 a[152:155], v209 offset:14336
ds_read_b128 a[156:159], v209 offset:32768
v_mfma_f32_16x16x32_bf16 v[40:43], a[160:163], a[108:111], v[40:43]
v_sub_f32 v199, v199, v200
v_max_f32 v199, 0, v199
v_mfma_f32_16x16x32_bf16 v[44:47], a[164:167], a[104:107], v[44:47]
v_add_f32 v199, 0x3727c5ac, v199
v_mfma_f32_16x16x32_bf16 v[48:51], a[164:167], a[108:111], v[48:51]
s_waitcnt lgkmcnt(4)
v_rsq_f32 v250, v199
v_mfma_f32_16x16x32_bf16 v[52:55], a[168:171], a[104:107], v[52:55]
ds_read_b128 a[160:163], v208 offset:15360
ds_read_b128 a[164:167], v208 offset:33792
v_mfma_f32_16x16x32_bf16 v[56:59], a[168:171], a[108:111], v[56:59]
v_mfma_f32_16x16x32_bf16 v[60:63], a[172:175], a[104:107], v[60:63]
v_sqrt_f32 v254, v199
v_mfma_f32_16x16x32_bf16 v[64:67], a[172:175], a[108:111], v[64:67]
s_waitcnt vmcnt(6) lgkmcnt(4)
v_mfma_f32_16x16x32_bf16 v[36:39], a[144:147], a[112:115], v[36:39]
ds_read_b128 a[168:171], v209 offset:15360
ds_read_b128 a[172:175], v209 offset:33792
v_mfma_f32_16x16x32_bf16 v[40:43], a[144:147], a[116:119], v[40:43]
v_cvt_pk_bf16_f32 v200, -v198, -v198
v_mfma_f32_16x16x32_bf16 v[44:47], a[148:151], a[112:115], v[44:47]
v_and_b32 v200, 0xffff0000, v200
v_mfma_f32_16x16x32_bf16 v[48:51], a[148:151], a[116:119], v[48:51]
s_waitcnt lgkmcnt(4)
v_add_f32 v200, v198, v200
v_mfma_f32_16x16x32_bf16 v[52:55], a[152:155], a[112:115], v[52:55]
ds_read_b128 a[144:147], v208 offset:16384
ds_read_b128 a[148:151], v208 offset:34816
v_mfma_f32_16x16x32_bf16 v[56:59], a[152:155], a[116:119], v[56:59]
v_cvt_pk_bf16_f32 v212, -v198, -v200
v_mfma_f32_16x16x32_bf16 v[60:63], a[156:159], a[112:115], v[60:63]
v_mul_f32 v252, v250, v250
v_mfma_f32_16x16x32_bf16 v[64:67], a[156:159], a[116:119], v[64:67]
s_waitcnt lgkmcnt(4)
v_mul_f32 v252, v252, v250
s_waitcnt vmcnt(4)
v_mfma_f32_16x16x32_bf16 v[36:39], a[160:163], a[120:123], v[36:39]
ds_read_b128 a[152:155], v209 offset:16384
ds_read_b128 a[156:159], v209 offset:34816
v_mfma_f32_16x16x32_bf16 v[40:43], a[160:163], a[124:127], v[40:43]
v_mul_f32 v252, 0xbdd2d3e8, v252
v_mul_f32 v250, 0xc0135761, v250
v_mfma_f32_16x16x32_bf16 v[44:47], a[164:167], a[120:123], v[44:47]
v_mfma_f32_16x16x32_bf16 v[48:51], a[164:167], a[124:127], v[48:51]
s_waitcnt lgkmcnt(4)
v_mov_b32 v214, v212
v_mfma_f32_16x16x32_bf16 v[52:55], a[168:171], a[120:123], v[52:55]
ds_read_b128 a[160:163], v208 offset:17408
ds_read_b128 a[164:167], v208 offset:35840
v_mfma_f32_16x16x32_bf16 v[56:59], a[168:171], a[124:127], v[56:59]
v_mov_b32 v255, v254
v_mov_b32 v253, v252
v_mfma_f32_16x16x32_bf16 v[60:63], a[172:175], a[120:123], v[60:63]
v_mfma_f32_16x16x32_bf16 v[64:67], a[172:175], a[124:127], v[64:67]
s_waitcnt lgkmcnt(4)
v_mov_b32 v251, v250
s_waitcnt vmcnt(2)
v_mfma_f32_16x16x32_bf16 v[36:39], a[144:147], a[128:131], v[36:39]
ds_read_b128 a[168:171], v209 offset:17408
ds_read_b128 a[172:175], v209 offset:35840
v_mfma_f32_16x16x32_bf16 v[40:43], a[144:147], a[132:135], v[40:43]
v_permlane16_swap_b32 v212, v214
v_mfma_f32_16x16x32_bf16 v[44:47], a[148:151], a[128:131], v[44:47]
v_permlane16_swap_b32 v254, v255
v_mfma_f32_16x16x32_bf16 v[48:51], a[148:151], a[132:135], v[48:51]
s_waitcnt lgkmcnt(4)
v_add_u32 v181, 160768, v239
v_mfma_f32_16x16x32_bf16 v[52:55], a[152:155], a[128:131], v[52:55]
ds_read_b64 a[144:145], v181 offset:0
ds_read_b64 a[148:149], v181 offset:512
v_mfma_f32_16x16x32_bf16 v[56:59], a[152:155], a[132:135], v[56:59]
v_permlane16_swap_b32 v252, v253
v_mfma_f32_16x16x32_bf16 v[60:63], a[156:159], a[128:131], v[60:63]
v_mfma_f32_16x16x32_bf16 v[64:67], a[156:159], a[132:135], v[64:67]
s_waitcnt vmcnt(0) lgkmcnt(4)
v_add_u32 v181, 36864, v239
v_mfma_f32_16x16x32_bf16 v[36:39], a[160:163], a[136:139], v[36:39]
ds_read_b64 a[152:153], v181 offset:0
ds_read_b64 a[156:157], v181 offset:512
v_mfma_f32_16x16x32_bf16 v[40:43], a[160:163], a[140:143], v[40:43]
v_permlane16_swap_b32 v250, v251
v_mfma_f32_16x16x32_bf16 v[44:47], a[164:167], a[136:139], v[44:47]
v_mov_b32 v213, v212
v_mfma_f32_16x16x32_bf16 v[48:51], a[164:167], a[140:143], v[48:51]
s_waitcnt lgkmcnt(4)
v_mov_b32 v215, v214
v_mfma_f32_16x16x32_bf16 v[52:55], a[168:171], a[136:139], v[52:55]
ds_read_b128 a[160:163], v210 offset:0
ds_read_b128 a[164:167], v210 offset:18432
v_mfma_f32_16x16x32_bf16 v[56:59], a[168:171], a[140:143], v[56:59]
v_mfma_f32_16x16x32_bf16 v[60:63], a[172:175], a[136:139], v[60:63]
v_mfma_f32_16x16x32_bf16 v[64:67], a[172:175], a[140:143], v[64:67]
s_waitcnt lgkmcnt(4)
v_mfma_f32_16x16x16_bf16 v[36:39], a[144:145], v[212:213], v[36:39]
ds_read_b128 a[168:171], v210 offset:1024
ds_read_b128 a[172:175], v210 offset:19456
v_mfma_f32_16x16x16_bf16 v[40:43], a[144:145], v[214:215], v[40:43]
v_mfma_f32_16x16x16_bf16 v[44:47], a[148:149], v[212:213], v[44:47]
v_mfma_f32_16x16x16_bf16 v[48:51], a[148:149], v[214:215], v[48:51]
s_waitcnt lgkmcnt(4)
v_mfma_f32_16x16x16_bf16 v[52:55], a[152:153], v[212:213], v[52:55]
ds_read_b128 a[144:147], v210 offset:2048
ds_read_b128 a[148:151], v210 offset:20480
v_mfma_f32_16x16x16_bf16 v[56:59], a[152:153], v[214:215], v[56:59]
v_mfma_f32_16x16x16_bf16 v[60:63], a[156:157], v[212:213], v[60:63]
v_mfma_f32_16x16x16_bf16 v[64:67], a[156:157], v[214:215], v[64:67]
s_waitcnt lgkmcnt(4)
s_barrier
v_mfma_f32_16x16x32_bf16 v[68:71], a[160:163], a[0:3], 0
ds_read_b128 a[152:155], v210 offset:3072
ds_read_b128 a[156:159], v210 offset:21504
v_mfma_f32_16x16x32_bf16 v[72:75], a[160:163], a[4:7], 0
s_mul_i32 s38, s24, 9216
s_add_u32 m0, s38, 123904
v_mfma_f32_16x16x32_bf16 v[76:79], a[164:167], a[0:3], 0
s_add_u32 s39, s38, s82
v_mfma_f32_16x16x32_bf16 v[80:83], a[164:167], a[4:7], 0
s_waitcnt lgkmcnt(4)
v_mfma_f32_16x16x32_bf16 v[68:71], a[168:171], a[8:11], v[68:71]
ds_read_b128 a[160:163], v210 offset:4096
ds_read_b128 a[164:167], v210 offset:22528
v_mfma_f32_16x16x32_bf16 v[72:75], a[168:171], a[12:15], v[72:75]
s_add_u32 s39, s39, 151552
v_mfma_f32_16x16x32_bf16 v[76:79], a[172:175], a[8:11], v[76:79]
buffer_load_dwordx4 v1, s[4:7], s39 offen offset:0 sc1 lds
buffer_load_dwordx4 v1, s[4:7], s39 offen offset:1024 sc1 lds
v_pk_mul_f32 v[216:217], v[36:37], v[36:37]
v_pk_mul_f32 v[218:219], v[38:39], v[38:39]
v_pk_mul_f32 v[220:221], v[40:41], v[40:41]
v_pk_mul_f32 v[222:223], v[42:43], v[42:43]
v_pk_fma_f32 v[216:217], v[216:217], v[252:253], v[250:251] op_sel:[0,0,0] op_sel_hi:[1,0,0]
v_pk_fma_f32 v[218:219], v[218:219], v[252:253], v[250:251] op_sel:[0,0,0] op_sel_hi:[1,0,0]
v_pk_fma_f32 v[220:221], v[220:221], v[252:253], v[250:251] op_sel:[0,1,1] op_sel_hi:[1,1,1]
v_pk_fma_f32 v[222:223], v[222:223], v[252:253], v[250:251] op_sel:[0,1,1] op_sel_hi:[1,1,1]
v_pk_mul_f32 v[216:217], v[216:217], v[36:37]
v_pk_mul_f32 v[218:219], v[218:219], v[38:39]
v_pk_mul_f32 v[220:221], v[220:221], v[40:41]
v_pk_mul_f32 v[222:223], v[222:223], v[42:43]
v_mfma_f32_16x16x32_bf16 v[80:83], a[172:175], a[12:15], v[80:83]
s_waitcnt lgkmcnt(4)
v_exp_f32 v216, v216
v_mfma_f32_16x16x32_bf16 v[68:71], a[144:147], a[16:19], v[68:71]
ds_read_b128 a[168:171], v210 offset:5120
ds_read_b128 a[172:175], v210 offset:23552
v_mfma_f32_16x16x32_bf16 v[72:75], a[144:147], a[20:23], v[72:75]
v_exp_f32 v217, v217
v_mfma_f32_16x16x32_bf16 v[76:79], a[148:151], a[16:19], v[76:79]
buffer_load_dwordx4 v1, s[4:7], s39 offen offset:2048 sc1 lds
buffer_load_dwordx4 v1, s[4:7], s39 offen offset:3072 sc1 lds
v_mfma_f32_16x16x32_bf16 v[80:83], a[148:151], a[20:23], v[80:83]
s_waitcnt lgkmcnt(4)
v_exp_f32 v218, v218
v_mfma_f32_16x16x32_bf16 v[68:71], a[152:155], a[24:27], v[68:71]
ds_read_b128 a[144:147], v210 offset:6144
ds_read_b128 a[148:151], v210 offset:24576
v_mfma_f32_16x16x32_bf16 v[72:75], a[152:155], a[28:31], v[72:75]
s_add_u32 m0, m0, 4096
v_fma_f32 v216, v216, v254, v254
v_fma_f32 v217, v217, v254, v254
v_mfma_f32_16x16x32_bf16 v[76:79], a[156:159], a[24:27], v[76:79]
s_add_u32 s39, s39, 4096
v_exp_f32 v219, v219
v_mfma_f32_16x16x32_bf16 v[80:83], a[156:159], a[28:31], v[80:83]
s_waitcnt lgkmcnt(4)
v_exp_f32 v220, v220
v_mfma_f32_16x16x32_bf16 v[68:71], a[160:163], a[32:35], v[68:71]
ds_read_b128 a[152:155], v210 offset:7168
ds_read_b128 a[156:159], v210 offset:25600
v_mfma_f32_16x16x32_bf16 v[72:75], a[160:163], a[36:39], v[72:75]
buffer_load_dwordx4 v1, s[4:7], s39 offen offset:0 sc1 lds
buffer_load_dwordx4 v1, s[4:7], s39 offen offset:1024 sc1 lds
v_mfma_f32_16x16x32_bf16 v[76:79], a[164:167], a[32:35], v[76:79]
v_fma_f32 v218, v218, v254, v254
v_fma_f32 v219, v219, v254, v254
v_mfma_f32_16x16x32_bf16 v[80:83], a[164:167], a[36:39], v[80:83]
s_waitcnt lgkmcnt(4)
v_exp_f32 v221, v221
v_mfma_f32_16x16x32_bf16 v[68:71], a[168:171], a[40:43], v[68:71]
ds_read_b128 a[160:163], v210 offset:8192
ds_read_b128 a[164:167], v210 offset:26624
v_exp_f32 v222, v222
v_mfma_f32_16x16x32_bf16 v[72:75], a[168:171], a[44:47], v[72:75]
buffer_load_dwordx4 v1, s[4:7], s39 offen offset:2048 sc1 lds
buffer_load_dwordx4 v1, s[4:7], s39 offen offset:3072 sc1 lds
v_mfma_f32_16x16x32_bf16 v[76:79], a[172:175], a[40:43], v[76:79]
s_add_u32 m0, m0, 4096
v_fma_f32 v220, v220, v255, v255
v_fma_f32 v221, v221, v255, v255
v_mfma_f32_16x16x32_bf16 v[80:83], a[172:175], a[44:47], v[80:83]
s_waitcnt lgkmcnt(4)
v_exp_f32 v223, v223
v_mfma_f32_16x16x32_bf16 v[68:71], a[144:147], a[48:51], v[68:71]
ds_read_b128 a[168:171], v210 offset:9216
ds_read_b128 a[172:175], v210 offset:27648
v_rcp_f32 v216, v216
v_mfma_f32_16x16x32_bf16 v[72:75], a[144:147], a[52:55], v[72:75]
s_add_u32 s39, s39, 4096
v_fma_f32 v222, v222, v255, v255
v_fma_f32 v223, v223, v255, v255
v_mfma_f32_16x16x32_bf16 v[76:79], a[148:151], a[48:51], v[76:79]
buffer_load_dwordx4 v1, s[4:7], s39 offen offset:0 sc1 lds
v_mfma_f32_16x16x32_bf16 v[80:83], a[148:151], a[52:55], v[80:83]
s_waitcnt lgkmcnt(4)
v_rcp_f32 v217, v217
v_mfma_f32_16x16x32_bf16 v[68:71], a[152:155], a[56:59], v[68:71]
ds_read_b128 a[144:147], v210 offset:10240
ds_read_b128 a[148:151], v210 offset:28672
v_rcp_f32 v218, v218
v_mfma_f32_16x16x32_bf16 v[72:75], a[152:155], a[60:63], v[72:75]
s_lshl_b32 s38, s24, 8
v_rcp_f32 v219, v219
v_mfma_f32_16x16x32_bf16 v[76:79], a[156:159], a[56:59], v[76:79]
buffer_store_dwordx4 a[224:227], v1, s[4:7], s101 offen offset:0 sc1
s_add_u32 m0, s38, 160768
v_mfma_f32_16x16x32_bf16 v[80:83], a[156:159], a[60:63], v[80:83]
s_waitcnt lgkmcnt(4)
s_add_u32 s39, s38, s82
v_rcp_f32 v220, v220
v_mfma_f32_16x16x32_bf16 v[68:71], a[160:163], a[64:67], v[68:71]
ds_read_b128 a[152:155], v210 offset:11264
ds_read_b128 a[156:159], v210 offset:29696
v_mfma_f32_16x16x32_bf16 v[72:75], a[160:163], a[68:71], v[72:75]
s_add_u32 s39, s39, 188416
v_rcp_f32 v221, v221
v_mfma_f32_16x16x32_bf16 v[76:79], a[164:167], a[64:67], v[76:79]
v_rcp_f32 v222, v222
v_mfma_f32_16x16x32_bf16 v[80:83], a[164:167], a[68:71], v[80:83]
s_waitcnt lgkmcnt(4)
v_rcp_f32 v223, v223
v_mfma_f32_16x16x32_bf16 v[68:71], a[168:171], a[72:75], v[68:71]
ds_read_b128 a[160:163], v210 offset:12288
ds_read_b128 a[164:167], v210 offset:30720
v_pk_mul_f32 v[224:225], v[44:45], v[44:45]
v_pk_mul_f32 v[226:227], v[46:47], v[46:47]
v_pk_mul_f32 v[228:229], v[48:49], v[48:49]
v_pk_mul_f32 v[230:231], v[50:51], v[50:51]
v_pk_fma_f32 v[224:225], v[224:225], v[252:253], v[250:251] op_sel:[0,0,0] op_sel_hi:[1,0,0]
v_pk_fma_f32 v[226:227], v[226:227], v[252:253], v[250:251] op_sel:[0,0,0] op_sel_hi:[1,0,0]
v_pk_fma_f32 v[228:229], v[228:229], v[252:253], v[250:251] op_sel:[0,1,1] op_sel_hi:[1,1,1]
v_pk_fma_f32 v[230:231], v[230:231], v[252:253], v[250:251] op_sel:[0,1,1] op_sel_hi:[1,1,1]
v_pk_mul_f32 v[36:37], v[36:37], v[216:217]
v_pk_mul_f32 v[38:39], v[38:39], v[218:219]
v_pk_mul_f32 v[40:41], v[40:41], v[220:221]
v_pk_mul_f32 v[42:43], v[42:43], v[222:223]
v_pk_mul_f32 v[224:225], v[224:225], v[44:45]
v_pk_mul_f32 v[226:227], v[226:227], v[46:47]
v_pk_mul_f32 v[228:229], v[228:229], v[48:49]
v_pk_mul_f32 v[230:231], v[230:231], v[50:51]
v_mfma_f32_16x16x32_bf16 v[72:75], a[168:171], a[76:79], v[72:75]
s_mov_b64 exec, 0xffff
buffer_load_dwordx4 v1, s[4:7], s39 offen sc1 lds
s_mov_b64 exec, -1
v_exp_f32 v224, v224
v_mfma_f32_16x16x32_bf16 v[76:79], a[172:175], a[72:75], v[76:79]
v_exp_f32 v225, v225
v_mfma_f32_16x16x32_bf16 v[80:83], a[172:175], a[76:79], v[80:83]
s_waitcnt lgkmcnt(4)
v_exp_f32 v226, v226
v_mfma_f32_16x16x32_bf16 v[68:71], a[144:147], a[80:83], v[68:71]
ds_read_b128 a[168:171], v210 offset:13312
ds_read_b128 a[172:175], v210 offset:31744
v_mfma_f32_16x16x32_bf16 v[72:75], a[144:147], a[84:87], v[72:75]
s_mul_i32 s38, s24, 9216
v_fma_f32 v224, v224, v254, v254
v_fma_f32 v225, v225, v254, v254
v_mfma_f32_16x16x32_bf16 v[76:79], a[148:151], a[80:83], v[76:79]
s_add_u32 m0, s38, 0
v_exp_f32 v227, v227
v_mfma_f32_16x16x32_bf16 v[80:83], a[148:151], a[84:87], v[80:83]
s_waitcnt lgkmcnt(4)
v_exp_f32 v228, v228
v_mfma_f32_16x16x32_bf16 v[68:71], a[152:155], a[88:91], v[68:71]
ds_read_b128 a[144:147], v210 offset:14336
ds_read_b128 a[148:151], v210 offset:32768
v_mfma_f32_16x16x32_bf16 v[72:75], a[152:155], a[92:95], v[72:75]
s_add_u32 s39, s38, s82
v_fma_f32 v226, v226, v254, v254
v_fma_f32 v227, v227, v254, v254
v_mfma_f32_16x16x32_bf16 v[76:79], a[156:159], a[88:91], v[76:79]
s_add_u32 s39, s39, 189440
v_exp_f32 v229, v229
v_mfma_f32_16x16x32_bf16 v[80:83], a[156:159], a[92:95], v[80:83]
s_waitcnt lgkmcnt(4)
v_exp_f32 v230, v230
v_mfma_f32_16x16x32_bf16 v[68:71], a[160:163], a[96:99], v[68:71]
ds_read_b128 a[152:155], v210 offset:15360
ds_read_b128 a[156:159], v210 offset:33792
v_mfma_f32_16x16x32_bf16 v[72:75], a[160:163], a[100:103], v[72:75]
buffer_store_dwordx4 a[228:231], v1, s[4:7], s101 offen offset:1024 sc1
v_fma_f32 v228, v228, v255, v255
v_fma_f32 v229, v229, v255, v255
v_mfma_f32_16x16x32_bf16 v[76:79], a[164:167], a[96:99], v[76:79]
buffer_load_dwordx4 v1, s[4:7], s39 offen offset:0 sc1 lds
buffer_load_dwordx4 v1, s[4:7], s39 offen offset:1024 sc1 lds
v_exp_f32 v231, v231
v_mfma_f32_16x16x32_bf16 v[80:83], a[164:167], a[100:103], v[80:83]
s_waitcnt lgkmcnt(4)
v_rcp_f32 v224, v224
v_mfma_f32_16x16x32_bf16 v[68:71], a[168:171], a[104:107], v[68:71]
ds_read_b128 a[160:163], v210 offset:16384
ds_read_b128 a[164:167], v210 offset:34816
v_mfma_f32_16x16x32_bf16 v[72:75], a[168:171], a[108:111], v[72:75]
v_fma_f32 v230, v230, v255, v255
v_fma_f32 v231, v231, v255, v255
v_mfma_f32_16x16x32_bf16 v[76:79], a[172:175], a[104:107], v[76:79]
v_rcp_f32 v225, v225
v_mfma_f32_16x16x32_bf16 v[80:83], a[172:175], a[108:111], v[80:83]
s_waitcnt lgkmcnt(4)
v_rcp_f32 v226, v226
v_mfma_f32_16x16x32_bf16 v[68:71], a[144:147], a[112:115], v[68:71]
ds_read_b128 a[168:171], v210 offset:17408
ds_read_b128 a[172:175], v210 offset:35840
v_mfma_f32_16x16x32_bf16 v[72:75], a[144:147], a[116:119], v[72:75]
buffer_load_dwordx4 v1, s[4:7], s39 offen offset:2048 sc1 lds
buffer_load_dwordx4 v1, s[4:7], s39 offen offset:3072 sc1 lds
v_rcp_f32 v227, v227
v_mfma_f32_16x16x32_bf16 v[76:79], a[148:151], a[112:115], v[76:79]
s_add_u32 m0, m0, 4096
v_rcp_f32 v228, v228
v_mfma_f32_16x16x32_bf16 v[80:83], a[148:151], a[116:119], v[80:83]
s_waitcnt lgkmcnt(4)
v_add_u32 v181, 74752, v239
v_mfma_f32_16x16x32_bf16 v[68:71], a[152:155], a[120:123], v[68:71]
ds_read_b64 a[144:145], v181 offset:0
ds_read_b64 a[148:149], v181 offset:512
v_rcp_f32 v229, v229
v_mfma_f32_16x16x32_bf16 v[72:75], a[152:155], a[124:127], v[72:75]
s_add_u32 s39, s39, 4096
v_rcp_f32 v230, v230
v_mfma_f32_16x16x32_bf16 v[76:79], a[156:159], a[120:123], v[76:79]
v_rcp_f32 v231, v231
v_mfma_f32_16x16x32_bf16 v[80:83], a[156:159], a[124:127], v[80:83]
s_waitcnt lgkmcnt(4)
v_pk_mul_f32 v[216:217], v[52:53], v[52:53]
v_pk_mul_f32 v[218:219], v[54:55], v[54:55]
v_pk_mul_f32 v[220:221], v[56:57], v[56:57]
v_pk_mul_f32 v[222:223], v[58:59], v[58:59]
v_pk_fma_f32 v[216:217], v[216:217], v[252:253], v[250:251] op_sel:[0,0,0] op_sel_hi:[1,0,0]
v_pk_fma_f32 v[218:219], v[218:219], v[252:253], v[250:251] op_sel:[0,0,0] op_sel_hi:[1,0,0]
v_pk_fma_f32 v[220:221], v[220:221], v[252:253], v[250:251] op_sel:[0,1,1] op_sel_hi:[1,1,1]
v_pk_fma_f32 v[222:223], v[222:223], v[252:253], v[250:251] op_sel:[0,1,1] op_sel_hi:[1,1,1]
v_pk_mul_f32 v[44:45], v[44:45], v[224:225]
v_pk_mul_f32 v[46:47], v[46:47], v[226:227]
v_pk_mul_f32 v[48:49], v[48:49], v[228:229]
v_pk_mul_f32 v[50:51], v[50:51], v[230:231]
v_pk_mul_f32 v[216:217], v[216:217], v[52:53]
v_pk_mul_f32 v[218:219], v[218:219], v[54:55]
v_pk_mul_f32 v[220:221], v[220:221], v[56:57]
v_pk_mul_f32 v[222:223], v[222:223], v[58:59]
v_mfma_f32_16x16x32_bf16 v[68:71], a[160:163], a[128:131], v[68:71]
ds_read_b128 a[152:155], v211 offset:0
ds_read_b128 a[156:159], v211 offset:18432
v_exp_f32 v216, v216
v_mfma_f32_16x16x32_bf16 v[72:75], a[160:163], a[132:135], v[72:75]
buffer_load_dwordx4 v1, s[4:7], s39 offen offset:0 sc1 lds
buffer_load_dwordx4 v1, s[4:7], s39 offen offset:1024 sc1 lds
v_exp_f32 v217, v217
v_mfma_f32_16x16x32_bf16 v[76:79], a[164:167], a[128:131], v[76:79]
buffer_store_dwordx4 a[232:235], v1, s[4:7], s101 offen offset:2048 sc1
v_exp_f32 v218, v218
v_mfma_f32_16x16x32_bf16 v[80:83], a[164:167], a[132:135], v[80:83]
s_waitcnt lgkmcnt(4)
v_fma_f32 v216, v216, v254, v254
v_fma_f32 v217, v217, v254, v254
v_mfma_f32_16x16x32_bf16 v[68:71], a[168:171], a[136:139], v[68:71]
ds_read_b128 a[160:163], v211 offset:1024
ds_read_b128 a[164:167], v211 offset:19456
v_mfma_f32_16x16x32_bf16 v[72:75], a[168:171], a[140:143], v[72:75]
v_exp_f32 v219, v219
v_mfma_f32_16x16x32_bf16 v[76:79], a[172:175], a[136:139], v[76:79]
v_exp_f32 v220, v220
v_mfma_f32_16x16x32_bf16 v[80:83], a[172:175], a[140:143], v[80:83]
s_waitcnt lgkmcnt(4)
v_fma_f32 v218, v218, v254, v254
v_fma_f32 v219, v219, v254, v254
v_mfma_f32_16x16x16_bf16 v[68:71], a[144:145], v[212:213], v[68:71]
ds_read_b128 a[168:171], v211 offset:2048
ds_read_b128 a[172:175], v211 offset:20480
v_mfma_f32_16x16x16_bf16 v[72:75], a[144:145], v[214:215], v[72:75]
buffer_load_dwordx4 v1, s[4:7], s39 offen offset:2048 sc1 lds
buffer_load_dwordx4 v1, s[4:7], s39 offen offset:3072 sc1 lds
v_exp_f32 v221, v221
v_mfma_f32_16x16x16_bf16 v[76:79], a[148:149], v[212:213], v[76:79]
s_add_u32 m0, m0, 4096
v_exp_f32 v222, v222
v_mfma_f32_16x16x16_bf16 v[80:83], a[148:149], v[214:215], v[80:83]
s_waitcnt vmcnt(10) lgkmcnt(4)
s_barrier
v_mfma_f32_16x16x32_bf16 v[84:87], a[152:155], a[0:3], 0
ds_read_b128 a[144:147], v211 offset:3072
ds_read_b128 a[148:151], v211 offset:21504
v_fma_f32 v220, v220, v255, v255
v_fma_f32 v221, v221, v255, v255
v_mfma_f32_16x16x32_bf16 v[88:91], a[152:155], a[4:7], 0
s_add_u32 s39, s39, 4096
v_exp_f32 v223, v223
v_mfma_f32_16x16x32_bf16 v[92:95], a[156:159], a[0:3], 0
v_rcp_f32 v216, v216
v_mfma_f32_16x16x32_bf16 v[96:99], a[156:159], a[4:7], 0
s_waitcnt lgkmcnt(4)
v_fma_f32 v222, v222, v255, v255
v_fma_f32 v223, v223, v255, v255
v_mfma_f32_16x16x32_bf16 v[84:87], a[160:163], a[8:11], v[84:87]
ds_read_b128 a[152:155], v211 offset:4096
ds_read_b128 a[156:159], v211 offset:22528
v_mfma_f32_16x16x32_bf16 v[88:91], a[160:163], a[12:15], v[88:91]
buffer_load_dwordx4 v1, s[4:7], s39 offen offset:0 sc1 lds
v_rcp_f32 v217, v217
v_mfma_f32_16x16x32_bf16 v[92:95], a[164:167], a[8:11], v[92:95]
s_lshl_b32 s38, s24, 8
v_rcp_f32 v218, v218
v_mfma_f32_16x16x32_bf16 v[96:99], a[164:167], a[12:15], v[96:99]
s_waitcnt lgkmcnt(4)
v_rcp_f32 v219, v219
v_mfma_f32_16x16x32_bf16 v[84:87], a[168:171], a[16:19], v[84:87]
ds_read_b128 a[160:163], v211 offset:5120
ds_read_b128 a[164:167], v211 offset:23552
v_mfma_f32_16x16x32_bf16 v[88:91], a[168:171], a[20:23], v[88:91]
buffer_store_dwordx4 a[236:239], v1, s[4:7], s101 offen offset:3072 sc1
v_rcp_f32 v220, v220
v_mfma_f32_16x16x32_bf16 v[92:95], a[172:175], a[16:19], v[92:95]
s_add_u32 m0, s38, 36864
v_rcp_f32 v221, v221
v_mfma_f32_16x16x32_bf16 v[96:99], a[172:175], a[20:23], v[96:99]
s_waitcnt lgkmcnt(4)
v_rcp_f32 v222, v222
v_mfma_f32_16x16x32_bf16 v[84:87], a[144:147], a[24:27], v[84:87]
ds_read_b128 a[168:171], v211 offset:6144
ds_read_b128 a[172:175], v211 offset:24576
v_mfma_f32_16x16x32_bf16 v[88:91], a[144:147], a[28:31], v[88:91]
s_add_u32 s39, s38, s82
v_rcp_f32 v223, v223
v_mfma_f32_16x16x32_bf16 v[92:95], a[148:151], a[24:27], v[92:95]
s_add_u32 s39, s39, 226304
v_pk_mul_f32 v[224:225], v[60:61], v[60:61]
v_pk_mul_f32 v[226:227], v[62:63], v[62:63]
v_pk_mul_f32 v[228:229], v[64:65], v[64:65]
v_pk_mul_f32 v[230:231], v[66:67], v[66:67]
v_pk_fma_f32 v[224:225], v[224:225], v[252:253], v[250:251] op_sel:[0,0,0] op_sel_hi:[1,0,0]
v_pk_fma_f32 v[226:227], v[226:227], v[252:253], v[250:251] op_sel:[0,0,0] op_sel_hi:[1,0,0]
v_pk_fma_f32 v[228:229], v[228:229], v[252:253], v[250:251] op_sel:[0,1,1] op_sel_hi:[1,1,1]
v_pk_fma_f32 v[230:231], v[230:231], v[252:253], v[250:251] op_sel:[0,1,1] op_sel_hi:[1,1,1]
v_pk_mul_f32 v[52:53], v[52:53], v[216:217]
v_pk_mul_f32 v[54:55], v[54:55], v[218:219]
v_pk_mul_f32 v[56:57], v[56:57], v[220:221]
v_pk_mul_f32 v[58:59], v[58:59], v[222:223]
v_pk_mul_f32 v[224:225], v[224:225], v[60:61]
v_pk_mul_f32 v[226:227], v[226:227], v[62:63]
v_pk_mul_f32 v[228:229], v[228:229], v[64:65]
v_pk_mul_f32 v[230:231], v[230:231], v[66:67]
v_mfma_f32_16x16x32_bf16 v[96:99], a[148:151], a[28:31], v[96:99]
s_waitcnt lgkmcnt(4)
v_exp_f32 v224, v224
v_mfma_f32_16x16x32_bf16 v[84:87], a[152:155], a[32:35], v[84:87]
ds_read_b128 a[144:147], v211 offset:7168
ds_read_b128 a[148:151], v211 offset:25600
v_exp_f32 v225, v225
v_mfma_f32_16x16x32_bf16 v[88:91], a[152:155], a[36:39], v[88:91]
v_exp_f32 v226, v226
v_mfma_f32_16x16x32_bf16 v[92:95], a[156:159], a[32:35], v[92:95]
s_mov_b64 exec, 0xffff
buffer_load_dwordx4 v1, s[4:7], s39 offen sc1 lds
s_mov_b64 exec, -1
v_mfma_f32_16x16x32_bf16 v[96:99], a[156:159], a[36:39], v[96:99]
s_waitcnt lgkmcnt(4)
v_fma_f32 v224, v224, v254, v254
v_fma_f32 v225, v225, v254, v254
v_mfma_f32_16x16x32_bf16 v[84:87], a[160:163], a[40:43], v[84:87]
ds_read_b128 a[152:155], v211 offset:8192
ds_read_b128 a[156:159], v211 offset:26624
v_exp_f32 v227, v227
v_mfma_f32_16x16x32_bf16 v[88:91], a[160:163], a[44:47], v[88:91]
v_exp_f32 v228, v228
v_mfma_f32_16x16x32_bf16 v[92:95], a[164:167], a[40:43], v[92:95]
v_fma_f32 v226, v226, v254, v254
v_fma_f32 v227, v227, v254, v254
v_mfma_f32_16x16x32_bf16 v[96:99], a[164:167], a[44:47], v[96:99]
s_waitcnt lgkmcnt(4)
v_exp_f32 v229, v229
v_mfma_f32_16x16x32_bf16 v[84:87], a[168:171], a[48:51], v[84:87]
ds_read_b128 a[160:163], v211 offset:9216
ds_read_b128 a[164:167], v211 offset:27648
v_mfma_f32_16x16x32_bf16 v[88:91], a[168:171], a[52:55], v[88:91]
v_exp_f32 v230, v230
v_mfma_f32_16x16x32_bf16 v[92:95], a[172:175], a[48:51], v[92:95]
buffer_store_dwordx4 a[240:243], v9, s[4:7], s101 offen offset:0 sc1
s_mul_i32 s38, s24, 9216
v_mfma_f32_16x16x32_bf16 v[96:99], a[172:175], a[52:55], v[96:99]
s_waitcnt lgkmcnt(4)
v_fma_f32 v228, v228, v255, v255
v_fma_f32 v229, v229, v255, v255
v_mfma_f32_16x16x32_bf16 v[84:87], a[144:147], a[56:59], v[84:87]
ds_read_b128 a[168:171], v211 offset:10240
ds_read_b128 a[172:175], v211 offset:28672
v_exp_f32 v231, v231
v_mfma_f32_16x16x32_bf16 v[88:91], a[144:147], a[60:63], v[88:91]
s_add_u32 m0, s38, 37888
v_rcp_f32 v224, v224
v_mfma_f32_16x16x32_bf16 v[92:95], a[148:151], a[56:59], v[92:95]
s_add_u32 s39, s38, s82
v_fma_f32 v230, v230, v255, v255
v_fma_f32 v231, v231, v255, v255
v_mfma_f32_16x16x32_bf16 v[96:99], a[148:151], a[60:63], v[96:99]
s_waitcnt lgkmcnt(4)
v_rcp_f32 v225, v225
v_mfma_f32_16x16x32_bf16 v[84:87], a[152:155], a[64:67], v[84:87]
ds_read_b128 a[144:147], v211 offset:11264
ds_read_b128 a[148:151], v211 offset:29696
v_mfma_f32_16x16x32_bf16 v[88:91], a[152:155], a[68:71], v[88:91]
s_add_u32 s39, s39, 227328
v_rcp_f32 v226, v226
v_mfma_f32_16x16x32_bf16 v[92:95], a[156:159], a[64:67], v[92:95]
v_rcp_f32 v227, v227
v_mfma_f32_16x16x32_bf16 v[96:99], a[156:159], a[68:71], v[96:99]
s_waitcnt lgkmcnt(4)
v_rcp_f32 v228, v228
v_mfma_f32_16x16x32_bf16 v[84:87], a[160:163], a[72:75], v[84:87]
ds_read_b128 a[152:155], v211 offset:12288
ds_read_b128 a[156:159], v211 offset:30720
v_mfma_f32_16x16x32_bf16 v[88:91], a[160:163], a[76:79], v[88:91]
buffer_load_dwordx4 v1, s[4:7], s39 offen offset:0 sc1 lds
buffer_load_dwordx4 v1, s[4:7], s39 offen offset:1024 sc1 lds
v_mfma_f32_16x16x32_bf16 v[92:95], a[164:167], a[72:75], v[92:95]
v_rcp_f32 v229, v229
v_mfma_f32_16x16x32_bf16 v[96:99], a[164:167], a[76:79], v[96:99]
s_waitcnt lgkmcnt(4)
v_rcp_f32 v230, v230
v_mfma_f32_16x16x32_bf16 v[84:87], a[168:171], a[80:83], v[84:87]
ds_read_b128 a[160:163], v211 offset:13312
ds_read_b128 a[164:167], v211 offset:31744
v_rcp_f32 v231, v231
v_mfma_f32_16x16x32_bf16 v[88:91], a[168:171], a[84:87], v[88:91]
buffer_load_dwordx4 v1, s[4:7], s39 offen offset:2048 sc1 lds
buffer_load_dwordx4 v1, s[4:7], s39 offen offset:3072 sc1 lds
v_pk_mul_f32 v[216:217], v[68:69], v[68:69]
v_pk_mul_f32 v[218:219], v[70:71], v[70:71]
v_pk_mul_f32 v[220:221], v[72:73], v[72:73]
v_pk_mul_f32 v[222:223], v[74:75], v[74:75]
v_pk_fma_f32 v[216:217], v[216:217], v[252:253], v[250:251] op_sel:[0,0,0] op_sel_hi:[1,0,0]
v_pk_fma_f32 v[218:219], v[218:219], v[252:253], v[250:251] op_sel:[0,0,0] op_sel_hi:[1,0,0]
v_pk_fma_f32 v[220:221], v[220:221], v[252:253], v[250:251] op_sel:[0,1,1] op_sel_hi:[1,1,1]
v_pk_fma_f32 v[222:223], v[222:223], v[252:253], v[250:251] op_sel:[0,1,1] op_sel_hi:[1,1,1]
v_pk_mul_f32 v[60:61], v[60:61], v[224:225]
v_pk_mul_f32 v[62:63], v[62:63], v[226:227]
v_pk_mul_f32 v[64:65], v[64:65], v[228:229]
v_pk_mul_f32 v[66:67], v[66:67], v[230:231]
v_pk_mul_f32 v[216:217], v[216:217], v[68:69]
v_pk_mul_f32 v[218:219], v[218:219], v[70:71]
v_pk_mul_f32 v[220:221], v[220:221], v[72:73]
v_pk_mul_f32 v[222:223], v[222:223], v[74:75]
v_mfma_f32_16x16x32_bf16 v[92:95], a[172:175], a[80:83], v[92:95]
s_add_u32 m0, m0, 4096
v_exp_f32 v216, v216
v_mfma_f32_16x16x32_bf16 v[96:99], a[172:175], a[84:87], v[96:99]
s_waitcnt lgkmcnt(4)
v_exp_f32 v217, v217
v_mfma_f32_16x16x32_bf16 v[84:87], a[144:147], a[88:91], v[84:87]
ds_read_b128 a[168:171], v211 offset:14336
ds_read_b128 a[172:175], v211 offset:32768
v_exp_f32 v218, v218
v_mfma_f32_16x16x32_bf16 v[88:91], a[144:147], a[92:95], v[88:91]
buffer_store_dwordx4 a[244:247], v9, s[4:7], s101 offen offset:1024 sc1
v_fma_f32 v216, v216, v254, v254
v_mfma_f32_16x16x32_bf16 v[92:95], a[148:151], a[88:91], v[92:95]
s_add_u32 s39, s39, 4096
v_fma_f32 v217, v217, v254, v254
v_mfma_f32_16x16x32_bf16 v[96:99], a[148:151], a[92:95], v[96:99]
s_waitcnt lgkmcnt(4)
v_exp_f32 v219, v219
v_mfma_f32_16x16x32_bf16 v[84:87], a[152:155], a[96:99], v[84:87]
ds_read_b128 a[144:147], v211 offset:15360
ds_read_b128 a[148:151], v211 offset:33792
v_exp_f32 v220, v220
v_mfma_f32_16x16x32_bf16 v[88:91], a[152:155], a[100:103], v[88:91]
v_fma_f32 v218, v218, v254, v254
v_fma_f32 v219, v219, v254, v254
v_mfma_f32_16x16x32_bf16 v[92:95], a[156:159], a[96:99], v[92:95]
v_exp_f32 v221, v221
v_mfma_f32_16x16x32_bf16 v[96:99], a[156:159], a[100:103], v[96:99]
s_waitcnt lgkmcnt(4)
v_exp_f32 v222, v222
v_mfma_f32_16x16x32_bf16 v[84:87], a[160:163], a[104:107], v[84:87]
ds_read_b128 a[152:155], v211 offset:16384
ds_read_b128 a[156:159], v211 offset:34816
v_mfma_f32_16x16x32_bf16 v[88:91], a[160:163], a[108:111], v[88:91]
buffer_load_dwordx4 v1, s[4:7], s39 offen offset:0 sc1 lds
buffer_load_dwordx4 v1, s[4:7], s39 offen offset:1024 sc1 lds
v_mfma_f32_16x16x32_bf16 v[92:95], a[164:167], a[104:107], v[92:95]
v_fma_f32 v220, v220, v255, v255
v_fma_f32 v221, v221, v255, v255
v_mfma_f32_16x16x32_bf16 v[96:99], a[164:167], a[108:111], v[96:99]
s_waitcnt lgkmcnt(4)
v_exp_f32 v223, v223
v_mfma_f32_16x16x32_bf16 v[84:87], a[168:171], a[112:115], v[84:87]
ds_read_b128 a[160:163], v211 offset:17408
ds_read_b128 a[164:167], v211 offset:35840
v_rcp_f32 v216, v216
v_mfma_f32_16x16x32_bf16 v[88:91], a[168:171], a[116:119], v[88:91]
buffer_load_dwordx4 v1, s[4:7], s39 offen offset:2048 sc1 lds
buffer_load_dwordx4 v1, s[4:7], s39 offen offset:3072 sc1 lds
v_mfma_f32_16x16x32_bf16 v[92:95], a[172:175], a[112:115], v[92:95]
s_add_u32 m0, m0, 4096
v_fma_f32 v222, v222, v255, v255
v_fma_f32 v223, v223, v255, v255
v_mfma_f32_16x16x32_bf16 v[96:99], a[172:175], a[116:119], v[96:99]
s_waitcnt lgkmcnt(4)
v_rcp_f32 v217, v217
v_add_u32 v181, 112640, v239
v_mfma_f32_16x16x32_bf16 v[84:87], a[144:147], a[120:123], v[84:87]
ds_read_b64 a[168:169], v181 offset:0
ds_read_b64 a[172:173], v181 offset:512
v_rcp_f32 v218, v218
v_mfma_f32_16x16x32_bf16 v[88:91], a[144:147], a[124:127], v[88:91]
s_add_u32 s39, s39, 4096
v_rcp_f32 v219, v219
v_mfma_f32_16x16x32_bf16 v[92:95], a[148:151], a[120:123], v[92:95]
buffer_store_dwordx4 a[248:251], v9, s[4:7], s101 offen offset:2048 sc1
v_mfma_f32_16x16x32_bf16 v[96:99], a[148:151], a[124:127], v[96:99]
s_waitcnt lgkmcnt(4)
v_rcp_f32 v220, v220
v_mfma_f32_16x16x32_bf16 v[84:87], a[152:155], a[128:131], v[84:87]
ds_read_b128 a[144:147], v208 offset:0
ds_read_b128 a[148:151], v208 offset:1024
v_mfma_f32_16x16x32_bf16 v[88:91], a[152:155], a[132:135], v[88:91]
v_rcp_f32 v221, v221
v_mfma_f32_16x16x32_bf16 v[92:95], a[156:159], a[128:131], v[92:95]
v_rcp_f32 v222, v222
v_mfma_f32_16x16x32_bf16 v[96:99], a[156:159], a[132:135], v[96:99]
s_waitcnt lgkmcnt(4)
v_rcp_f32 v223, v223
v_mfma_f32_16x16x32_bf16 v[84:87], a[160:163], a[136:139], v[84:87]
ds_read_b128 a[152:155], v208 offset:2048
ds_read_b128 a[156:159], v208 offset:3072
v_pk_mul_f32 v[224:225], v[76:77], v[76:77]
v_pk_mul_f32 v[226:227], v[78:79], v[78:79]
v_pk_mul_f32 v[228:229], v[80:81], v[80:81]
v_pk_mul_f32 v[230:231], v[82:83], v[82:83]
v_pk_fma_f32 v[224:225], v[224:225], v[252:253], v[250:251] op_sel:[0,0,0] op_sel_hi:[1,0,0]
v_pk_fma_f32 v[226:227], v[226:227], v[252:253], v[250:251] op_sel:[0,0,0] op_sel_hi:[1,0,0]
v_pk_fma_f32 v[228:229], v[228:229], v[252:253], v[250:251] op_sel:[0,1,1] op_sel_hi:[1,1,1]
v_pk_fma_f32 v[230:231], v[230:231], v[252:253], v[250:251] op_sel:[0,1,1] op_sel_hi:[1,1,1]
v_pk_mul_f32 v[68:69], v[68:69], v[216:217]
v_pk_mul_f32 v[70:71], v[70:71], v[218:219]
v_pk_mul_f32 v[72:73], v[72:73], v[220:221]
v_pk_mul_f32 v[74:75], v[74:75], v[222:223]
v_pk_mul_f32 v[224:225], v[224:225], v[76:77]
v_pk_mul_f32 v[226:227], v[226:227], v[78:79]
v_pk_mul_f32 v[228:229], v[228:229], v[80:81]
v_pk_mul_f32 v[230:231], v[230:231], v[82:83]
v_mfma_f32_16x16x32_bf16 v[88:91], a[160:163], a[140:143], v[88:91]
buffer_load_dwordx4 v1, s[4:7], s39 offen offset:0 sc1 lds
s_lshl_b32 s38, s24, 8
v_exp_f32 v224, v224
v_mfma_f32_16x16x32_bf16 v[92:95], a[164:167], a[136:139], v[92:95]
s_add_u32 m0, s38, 74752
v_exp_f32 v225, v225
v_mfma_f32_16x16x32_bf16 v[96:99], a[164:167], a[140:143], v[96:99]
s_waitcnt lgkmcnt(4)
v_exp_f32 v226, v226
v_mfma_f32_16x16x16_bf16 v[84:87], a[168:169], v[212:213], v[84:87]
ds_read_b128 a[160:163], v208 offset:4096
ds_read_b128 a[164:167], v208 offset:5120
v_mfma_f32_16x16x16_bf16 v[88:91], a[168:169], v[214:215], v[88:91]
s_add_u32 s39, s38, s82
v_fma_f32 v224, v224, v254, v254
v_fma_f32 v225, v225, v254, v254
v_mfma_f32_16x16x16_bf16 v[92:95], a[172:173], v[212:213], v[92:95]
s_add_u32 s39, s39, 264192
v_exp_f32 v227, v227
v_mfma_f32_16x16x16_bf16 v[96:99], a[172:173], v[214:215], v[96:99]
s_waitcnt lgkmcnt(4)
v_exp_f32 v228, v228
s_waitcnt vmcnt(12)
s_barrier
v_mfma_f32_16x16x32_bf16 v[100:103], a[144:147], a[0:3], 0
ds_read_b128 a[168:171], v208 offset:6144
ds_read_b128 a[172:175], v208 offset:7168
v_mfma_f32_16x16x32_bf16 v[104:107], a[144:147], a[4:7], 0
s_mov_b32 s37, L_c4-L_pc
v_fma_f32 v226, v226, v254, v254
v_fma_f32 v227, v227, v254, v254
v_mfma_f32_16x16x32_bf16 v[100:103], a[148:151], a[8:11], v[100:103]
v_exp_f32 v229, v229
v_mfma_f32_16x16x32_bf16 v[104:107], a[148:151], a[12:15], v[104:107]
s_waitcnt lgkmcnt(4)
v_exp_f32 v230, v230
v_mfma_f32_16x16x32_bf16 v[100:103], a[152:155], a[16:19], v[100:103]
ds_read_b128 a[144:147], v208 offset:8192
ds_read_b128 a[148:151], v208 offset:9216
v_mfma_f32_16x16x32_bf16 v[104:107], a[152:155], a[20:23], v[104:107]
s_mov_b64 exec, 0xffff
buffer_load_dwordx4 v1, s[4:7], s39 offen sc1 lds
s_mov_b64 exec, -1
v_fma_f32 v228, v228, v255, v255
v_fma_f32 v229, v229, v255, v255
v_mfma_f32_16x16x32_bf16 v[100:103], a[156:159], a[24:27], v[100:103]
buffer_store_dwordx4 a[252:255], v9, s[4:7], s101 offen offset:3072 sc1
buffer_load_dword v15, v14, s[88:91], s37 offen
v_exp_f32 v231, v231
v_mfma_f32_16x16x32_bf16 v[104:107], a[156:159], a[28:31], v[104:107]
s_waitcnt lgkmcnt(4)
v_rcp_f32 v224, v224
v_mfma_f32_16x16x32_bf16 v[100:103], a[160:163], a[32:35], v[100:103]
ds_read_b128 a[152:155], v208 offset:10240
ds_read_b128 a[156:159], v208 offset:11264
v_mfma_f32_16x16x32_bf16 v[104:107], a[160:163], a[36:39], v[104:107]
s_mov_b32 s101, 1073741824
v_fma_f32 v230, v230, v255, v255
v_fma_f32 v231, v231, v255, v255
v_mfma_f32_16x16x32_bf16 v[100:103], a[164:167], a[40:43], v[100:103]
v_rcp_f32 v225, v225
v_mfma_f32_16x16x32_bf16 v[104:107], a[164:167], a[44:47], v[104:107]
s_waitcnt lgkmcnt(4)
v_rcp_f32 v226, v226
v_mfma_f32_16x16x32_bf16 v[100:103], a[168:171], a[48:51], v[100:103]
ds_read_b128 a[160:163], v208 offset:12288
ds_read_b128 a[164:167], v208 offset:13312
v_mfma_f32_16x16x32_bf16 v[104:107], a[168:171], a[52:55], v[104:107]
s_mul_i32 s38, s24, 9216
v_rcp_f32 v227, v227
v_mfma_f32_16x16x32_bf16 v[100:103], a[172:175], a[56:59], v[100:103]
s_add_u32 m0, s38, 75776
v_rcp_f32 v228, v228
v_mfma_f32_16x16x32_bf16 v[104:107], a[172:175], a[60:63], v[104:107]
s_waitcnt lgkmcnt(4)
v_rcp_f32 v229, v229
v_mfma_f32_16x16x32_bf16 v[100:103], a[144:147], a[64:67], v[100:103]
ds_read_b128 a[168:171], v208 offset:14336
ds_read_b128 a[172:175], v208 offset:15360
v_mfma_f32_16x16x32_bf16 v[104:107], a[144:147], a[68:71], v[104:107]
s_add_u32 s39, s38, s82
v_rcp_f32 v230, v230
v_mfma_f32_16x16x32_bf16 v[100:103], a[148:151], a[72:75], v[100:103]
s_add_u32 s39, s39, 265216
v_rcp_f32 v231, v231
v_mfma_f32_16x16x32_bf16 v[104:107], a[148:151], a[76:79], v[104:107]
s_waitcnt lgkmcnt(4)
v_pk_mul_f32 v[216:217], v[84:85], v[84:85]
v_pk_mul_f32 v[218:219], v[86:87], v[86:87]
v_pk_mul_f32 v[220:221], v[88:89], v[88:89]
v_pk_mul_f32 v[222:223], v[90:91], v[90:91]
v_pk_fma_f32 v[216:217], v[216:217], v[252:253], v[250:251] op_sel:[0,0,0] op_sel_hi:[1,0,0]
v_pk_fma_f32 v[218:219], v[218:219], v[252:253], v[250:251] op_sel:[0,0,0] op_sel_hi:[1,0,0]
v_pk_fma_f32 v[220:221], v[220:221], v[252:253], v[250:251] op_sel:[0,1,1] op_sel_hi:[1,1,1]
v_pk_fma_f32 v[222:223], v[222:223], v[252:253], v[250:251] op_sel:[0,1,1] op_sel_hi:[1,1,1]
v_pk_mul_f32 v[76:77], v[76:77], v[224:225]
v_pk_mul_f32 v[78:79], v[78:79], v[226:227]
v_pk_mul_f32 v[80:81], v[80:81], v[228:229]
v_pk_mul_f32 v[82:83], v[82:83], v[230:231]
v_pk_mul_f32 v[216:217], v[216:217], v[84:85]
v_pk_mul_f32 v[218:219], v[218:219], v[86:87]
v_pk_mul_f32 v[220:221], v[220:221], v[88:89]
v_pk_mul_f32 v[222:223], v[222:223], v[90:91]
v_mfma_f32_16x16x32_bf16 v[100:103], a[152:155], a[80:83], v[100:103]
ds_read_b128 a[144:147], v208 offset:16384
ds_read_b128 a[148:151], v208 offset:17408
v_exp_f32 v216, v216
v_mfma_f32_16x16x32_bf16 v[104:107], a[152:155], a[84:87], v[104:107]
v_exp_f32 v217, v217
v_mfma_f32_16x16x32_bf16 v[100:103], a[156:159], a[88:91], v[100:103]
buffer_load_dwordx4 v1, s[4:7], s39 offen offset:0 sc1 lds
buffer_load_dwordx4 v1, s[4:7], s39 offen offset:1024 sc1 lds
v_exp_f32 v218, v218
v_mfma_f32_16x16x32_bf16 v[104:107], a[156:159], a[92:95], v[104:107]
s_waitcnt lgkmcnt(4)
v_fma_f32 v216, v216, v254, v254
v_add_u32 v181, 160768, v239
v_mfma_f32_16x16x32_bf16 v[100:103], a[160:163], a[96:99], v[100:103]
ds_read_b64 a[152:153], v181 offset:0
ds_read_b128 a[156:159], v208 offset:18432
v_fma_f32 v217, v217, v254, v254
v_mfma_f32_16x16x32_bf16 v[104:107], a[160:163], a[100:103], v[104:107]
v_exp_f32 v219, v219
v_mfma_f32_16x16x32_bf16 v[100:103], a[164:167], a[104:107], v[100:103]
v_exp_f32 v220, v220
v_mfma_f32_16x16x32_bf16 v[104:107], a[164:167], a[108:111], v[104:107]
s_waitcnt lgkmcnt(4)
v_fma_f32 v218, v218, v254, v254
v_fma_f32 v219, v219, v254, v254
v_mfma_f32_16x16x32_bf16 v[100:103], a[168:171], a[112:115], v[100:103]
ds_read_b128 a[160:163], v208 offset:19456
ds_read_b128 a[164:167], v208 offset:20480
v_mfma_f32_16x16x32_bf16 v[104:107], a[168:171], a[116:119], v[104:107]
buffer_load_dwordx4 v1, s[4:7], s39 offen offset:2048 sc1 lds
buffer_load_dwordx4 v1, s[4:7], s39 offen offset:3072 sc1 lds
v_exp_f32 v221, v221
v_mfma_f32_16x16x32_bf16 v[100:103], a[172:175], a[120:123], v[100:103]
s_add_u32 m0, m0, 4096
v_exp_f32 v222, v222
v_mfma_f32_16x16x32_bf16 v[104:107], a[172:175], a[124:127], v[104:107]
s_waitcnt lgkmcnt(4)
v_fma_f32 v220, v220, v255, v255
v_fma_f32 v221, v221, v255, v255
v_mfma_f32_16x16x32_bf16 v[100:103], a[144:147], a[128:131], v[100:103]
ds_read_b128 a[168:171], v208 offset:21504
ds_read_b128 a[172:175], v208 offset:22528
v_mfma_f32_16x16x32_bf16 v[104:107], a[144:147], a[132:135], v[104:107]
s_add_u32 s39, s39, 4096
v_exp_f32 v223, v223
v_mfma_f32_16x16x32_bf16 v[100:103], a[148:151], a[136:139], v[100:103]
v_rcp_f32 v216, v216
v_mfma_f32_16x16x32_bf16 v[104:107], a[148:151], a[140:143], v[104:107]
s_waitcnt lgkmcnt(4)
v_fma_f32 v222, v222, v255, v255
v_fma_f32 v223, v223, v255, v255
v_mfma_f32_16x16x16_bf16 v[100:103], a[152:153], v[212:213], v[100:103]
ds_read_b128 a[144:147], v208 offset:23552
ds_read_b128 a[148:151], v208 offset:24576
v_mfma_f32_16x16x16_bf16 v[104:107], a[152:153], v[214:215], v[104:107]
buffer_load_dwordx4 v1, s[4:7], s39 offen offset:0 sc1 lds
buffer_load_dwordx4 v1, s[4:7], s39 offen offset:1024 sc1 lds
v_rcp_f32 v217, v217
v_mfma_f32_16x16x32_bf16 v[108:111], a[156:159], a[0:3], 0
v_rcp_f32 v218, v218
v_mfma_f32_16x16x32_bf16 v[112:115], a[156:159], a[4:7], 0
s_waitcnt lgkmcnt(4)
v_rcp_f32 v219, v219
v_mfma_f32_16x16x32_bf16 v[108:111], a[160:163], a[8:11], v[108:111]
ds_read_b128 a[152:155], v208 offset:25600
ds_read_b128 a[156:159], v208 offset:26624
v_mfma_f32_16x16x32_bf16 v[112:115], a[160:163], a[12:15], v[112:115]
v_rcp_f32 v220, v220
v_mfma_f32_16x16x32_bf16 v[108:111], a[164:167], a[16:19], v[108:111]
v_rcp_f32 v221, v221
v_mfma_f32_16x16x32_bf16 v[112:115], a[164:167], a[20:23], v[112:115]
s_waitcnt lgkmcnt(4)
v_rcp_f32 v222, v222
v_mfma_f32_16x16x32_bf16 v[108:111], a[168:171], a[24:27], v[108:111]
ds_read_b128 a[160:163], v208 offset:27648
ds_read_b128 a[164:167], v208 offset:28672
v_mfma_f32_16x16x32_bf16 v[112:115], a[168:171], a[28:31], v[112:115]
buffer_load_dwordx4 v1, s[4:7], s39 offen offset:2048 sc1 lds
buffer_load_dwordx4 v1, s[4:7], s39 offen offset:3072 sc1 lds
v_rcp_f32 v223, v223
v_mfma_f32_16x16x32_bf16 v[108:111], a[172:175], a[32:35], v[108:111]
s_add_u32 m0, m0, 4096
v_pk_mul_f32 v[224:225], v[92:93], v[92:93]
v_pk_mul_f32 v[226:227], v[94:95], v[94:95]
v_pk_mul_f32 v[228:229], v[96:97], v[96:97]
v_pk_mul_f32 v[230:231], v[98:99], v[98:99]
v_pk_fma_f32 v[224:225], v[224:225], v[252:253], v[250:251] op_sel:[0,0,0] op_sel_hi:[1,0,0]
v_pk_fma_f32 v[226:227], v[226:227], v[252:253], v[250:251] op_sel:[0,0,0] op_sel_hi:[1,0,0]
v_pk_fma_f32 v[228:229], v[228:229], v[252:253], v[250:251] op_sel:[0,1,1] op_sel_hi:[1,1,1]
v_pk_fma_f32 v[230:231], v[230:231], v[252:253], v[250:251] op_sel:[0,1,1] op_sel_hi:[1,1,1]
v_pk_mul_f32 v[84:85], v[84:85], v[216:217]
v_pk_mul_f32 v[86:87], v[86:87], v[218:219]
v_pk_mul_f32 v[88:89], v[88:89], v[220:221]
v_pk_mul_f32 v[90:91], v[90:91], v[222:223]
v_pk_mul_f32 v[224:225], v[224:225], v[92:93]
v_pk_mul_f32 v[226:227], v[226:227], v[94:95]
v_pk_mul_f32 v[228:229], v[228:229], v[96:97]
v_pk_mul_f32 v[230:231], v[230:231], v[98:99]
v_mfma_f32_16x16x32_bf16 v[112:115], a[172:175], a[36:39], v[112:115]
s_waitcnt lgkmcnt(4)
v_exp_f32 v224, v224
v_mfma_f32_16x16x32_bf16 v[108:111], a[144:147], a[40:43], v[108:111]
ds_read_b128 a[168:171], v208 offset:29696
ds_read_b128 a[172:175], v208 offset:30720
v_exp_f32 v225, v225
v_mfma_f32_16x16x32_bf16 v[112:115], a[144:147], a[44:47], v[112:115]
s_add_u32 s39, s39, 4096
v_exp_f32 v226, v226
v_mfma_f32_16x16x32_bf16 v[108:111], a[148:151], a[48:51], v[108:111]
v_fma_f32 v224, v224, v254, v254
v_fma_f32 v225, v225, v254, v254
v_mfma_f32_16x16x32_bf16 v[112:115], a[148:151], a[52:55], v[112:115]
s_waitcnt lgkmcnt(4)
v_exp_f32 v227, v227
v_mfma_f32_16x16x32_bf16 v[108:111], a[152:155], a[56:59], v[108:111]
ds_read_b128 a[144:147], v208 offset:31744
ds_read_b128 a[148:151], v208 offset:32768
v_mfma_f32_16x16x32_bf16 v[112:115], a[152:155], a[60:63], v[112:115]
buffer_load_dwordx4 v1, s[4:7], s39 offen offset:0 sc1 lds
v_exp_f32 v228, v228
v_mfma_f32_16x16x32_bf16 v[108:111], a[156:159], a[64:67], v[108:111]
s_lshl_b32 s38, s24, 8
v_fma_f32 v226, v226, v254, v254
v_fma_f32 v227, v227, v254, v254
v_mfma_f32_16x16x32_bf16 v[112:115], a[156:159], a[68:71], v[112:115]
s_waitcnt lgkmcnt(4)
v_exp_f32 v229, v229
v_mfma_f32_16x16x32_bf16 v[108:111], a[160:163], a[72:75], v[108:111]
ds_read_b128 a[152:155], v208 offset:33792
ds_read_b128 a[156:159], v208 offset:34816
v_mfma_f32_16x16x32_bf16 v[112:115], a[160:163], a[76:79], v[112:115]
s_add_u32 m0, s38, 112640
v_exp_f32 v230, v230
v_mfma_f32_16x16x32_bf16 v[108:111], a[164:167], a[80:83], v[108:111]
s_add_u32 s39, s38, s82
v_fma_f32 v228, v228, v255, v255
v_fma_f32 v229, v229, v255, v255
v_mfma_f32_16x16x32_bf16 v[112:115], a[164:167], a[84:87], v[112:115]
s_waitcnt lgkmcnt(4)
v_exp_f32 v231, v231
v_mfma_f32_16x16x32_bf16 v[108:111], a[168:171], a[88:91], v[108:111]
ds_read_b128 a[160:163], v208 offset:35840
ds_read_b64 a[164:165], v181 offset:512
v_mfma_f32_16x16x32_bf16 v[112:115], a[168:171], a[92:95], v[112:115]
s_add_u32 s39, s39, 302080
v_rcp_f32 v224, v224
v_mfma_f32_16x16x32_bf16 v[108:111], a[172:175], a[96:99], v[108:111]
v_fma_f32 v230, v230, v255, v255
v_fma_f32 v231, v231, v255, v255
v_mfma_f32_16x16x32_bf16 v[112:115], a[172:175], a[100:103], v[112:115]
s_waitcnt lgkmcnt(4)
v_rcp_f32 v225, v225
v_mfma_f32_16x16x32_bf16 v[108:111], a[144:147], a[104:107], v[108:111]
ds_read_b128 a[168:171], v209 offset:0
ds_read_b128 a[172:175], v209 offset:18432
v_mfma_f32_16x16x32_bf16 v[112:115], a[144:147], a[108:111], v[112:115]
v_rcp_f32 v226, v226
v_mfma_f32_16x16x32_bf16 v[108:111], a[148:151], a[112:115], v[108:111]
s_mov_b64 exec, 0xffff
buffer_load_dwordx4 v1, s[4:7], s39 offen sc1 lds
s_mov_b64 exec, -1
v_mfma_f32_16x16x32_bf16 v[112:115], a[148:151], a[116:119], v[112:115]
s_waitcnt lgkmcnt(4)
v_rcp_f32 v227, v227
v_mfma_f32_16x16x32_bf16 v[108:111], a[152:155], a[120:123], v[108:111]
ds_read_b128 a[144:147], v209 offset:1024
ds_read_b128 a[148:151], v209 offset:19456
v_rcp_f32 v228, v228
v_mfma_f32_16x16x32_bf16 v[112:115], a[152:155], a[124:127], v[112:115]
v_rcp_f32 v229, v229
v_mfma_f32_16x16x32_bf16 v[108:111], a[156:159], a[128:131], v[108:111]
v_rcp_f32 v230, v230
v_mfma_f32_16x16x32_bf16 v[112:115], a[156:159], a[132:135], v[112:115]
s_waitcnt lgkmcnt(4)
v_rcp_f32 v231, v231
v_mfma_f32_16x16x32_bf16 v[108:111], a[160:163], a[136:139], v[108:111]
ds_read_b128 a[152:155], v209 offset:2048
ds_read_b128 a[156:159], v209 offset:20480
v_pk_mul_f32 v[216:217], v[100:101], v[100:101]
v_pk_mul_f32 v[218:219], v[102:103], v[102:103]
v_pk_mul_f32 v[220:221], v[104:105], v[104:105]
v_pk_mul_f32 v[222:223], v[106:107], v[106:107]
v_pk_fma_f32 v[216:217], v[216:217], v[252:253], v[250:251] op_sel:[0,0,0] op_sel_hi:[1,0,0]
v_pk_fma_f32 v[218:219], v[218:219], v[252:253], v[250:251] op_sel:[0,0,0] op_sel_hi:[1,0,0]
v_pk_fma_f32 v[220:221], v[220:221], v[252:253], v[250:251] op_sel:[0,1,1] op_sel_hi:[1,1,1]
v_pk_fma_f32 v[222:223], v[222:223], v[252:253], v[250:251] op_sel:[0,1,1] op_sel_hi:[1,1,1]
v_pk_mul_f32 v[92:93], v[92:93], v[224:225]
v_pk_mul_f32 v[94:95], v[94:95], v[226:227]
v_pk_mul_f32 v[96:97], v[96:97], v[228:229]
v_pk_mul_f32 v[98:99], v[98:99], v[230:231]
v_pk_mul_f32 v[216:217], v[216:217], v[100:101]
v_pk_mul_f32 v[218:219], v[218:219], v[102:103]
v_pk_mul_f32 v[220:221], v[220:221], v[104:105]
v_pk_mul_f32 v[222:223], v[222:223], v[106:107]
v_mfma_f32_16x16x32_bf16 v[112:115], a[160:163], a[140:143], v[112:115]
v_exp_f32 v216, v216
v_mfma_f32_16x16x16_bf16 v[108:111], a[164:165], v[212:213], v[108:111]
v_exp_f32 v217, v217
v_mfma_f32_16x16x16_bf16 v[112:115], a[164:165], v[214:215], v[112:115]
s_waitcnt vmcnt(12) lgkmcnt(4)
s_barrier
v_mfma_f32_16x16x32_bf16 v[116:119], a[168:171], a[0:3], 0
ds_read_b128 a[160:163], v209 offset:3072
ds_read_b128 a[164:167], v209 offset:21504
v_exp_f32 v218, v218
v_mfma_f32_16x16x32_bf16 v[120:123], a[168:171], a[4:7], 0
s_mul_i32 s38, s24, 9216
s_add_u32 m0, s38, 123904
v_fma_f32 v216, v216, v254, v254
v_mfma_f32_16x16x32_bf16 v[124:127], a[172:175], a[0:3], 0
s_add_u32 s39, s38, s82
v_fma_f32 v217, v217, v254, v254
v_mfma_f32_16x16x32_bf16 v[128:131], a[172:175], a[4:7], 0
s_waitcnt lgkmcnt(4)
s_add_u32 s39, s39, 303104
v_exp_f32 v219, v219
v_mfma_f32_16x16x32_bf16 v[116:119], a[144:147], a[8:11], v[116:119]
ds_read_b128 a[168:171], v209 offset:4096
ds_read_b128 a[172:175], v209 offset:22528
v_exp_f32 v220, v220
v_mfma_f32_16x16x32_bf16 v[120:123], a[144:147], a[12:15], v[120:123]
buffer_load_dwordx4 v1, s[4:7], s39 offen offset:0 sc1 lds
buffer_load_dwordx4 v1, s[4:7], s39 offen offset:1024 sc1 lds
v_mfma_f32_16x16x32_bf16 v[124:127], a[148:151], a[8:11], v[124:127]
v_fma_f32 v218, v218, v254, v254
v_fma_f32 v219, v219, v254, v254
v_mfma_f32_16x16x32_bf16 v[128:131], a[148:151], a[12:15], v[128:131]
s_waitcnt lgkmcnt(4)
v_exp_f32 v221, v221
v_mfma_f32_16x16x32_bf16 v[116:119], a[152:155], a[16:19], v[116:119]
ds_read_b128 a[144:147], v209 offset:5120
ds_read_b128 a[148:151], v209 offset:23552
v_exp_f32 v222, v222
v_mfma_f32_16x16x32_bf16 v[120:123], a[152:155], a[20:23], v[120:123]
buffer_load_dwordx4 v1, s[4:7], s39 offen offset:2048 sc1 lds
buffer_load_dwordx4 v1, s[4:7], s39 offen offset:3072 sc1 lds
v_mfma_f32_16x16x32_bf16 v[124:127], a[156:159], a[16:19], v[124:127]
s_add_u32 m0, m0, 4096
v_fma_f32 v220, v220, v255, v255
v_fma_f32 v221, v221, v255, v255
v_mfma_f32_16x16x32_bf16 v[128:131], a[156:159], a[20:23], v[128:131]
s_waitcnt lgkmcnt(4)
s_add_u32 s39, s39, 4096
v_exp_f32 v223, v223
v_mfma_f32_16x16x32_bf16 v[116:119], a[160:163], a[24:27], v[116:119]
ds_read_b128 a[152:155], v209 offset:6144
ds_read_b128 a[156:159], v209 offset:24576
v_rcp_f32 v216, v216
v_mfma_f32_16x16x32_bf16 v[120:123], a[160:163], a[28:31], v[120:123]
buffer_load_dwordx4 v1, s[4:7], s39 offen offset:0 sc1 lds
buffer_load_dwordx4 v1, s[4:7], s39 offen offset:1024 sc1 lds
v_mfma_f32_16x16x32_bf16 v[124:127], a[164:167], a[24:27], v[124:127]
v_fma_f32 v222, v222, v255, v255
v_fma_f32 v223, v223, v255, v255
v_mfma_f32_16x16x32_bf16 v[128:131], a[164:167], a[28:31], v[128:131]
s_waitcnt lgkmcnt(4)
v_rcp_f32 v217, v217
v_mfma_f32_16x16x32_bf16 v[116:119], a[168:171], a[32:35], v[116:119]
ds_read_b128 a[160:163], v209 offset:7168
ds_read_b128 a[164:167], v209 offset:25600
v_rcp_f32 v218, v218
v_mfma_f32_16x16x32_bf16 v[120:123], a[168:171], a[36:39], v[120:123]
buffer_load_dwordx4 v1, s[4:7], s39 offen offset:2048 sc1 lds
buffer_load_dwordx4 v1, s[4:7], s39 offen offset:3072 sc1 lds
v_mfma_f32_16x16x32_bf16 v[124:127], a[172:175], a[32:35], v[124:127]
s_add_u32 m0, m0, 4096
s_add_u32 s39, s39, 4096
v_rcp_f32 v219, v219
v_mfma_f32_16x16x32_bf16 v[128:131], a[172:175], a[36:39], v[128:131]
s_waitcnt lgkmcnt(4)
v_rcp_f32 v220, v220
v_mfma_f32_16x16x32_bf16 v[116:119], a[144:147], a[40:43], v[116:119]
ds_read_b128 a[168:171], v209 offset:8192
ds_read_b128 a[172:175], v209 offset:26624
v_rcp_f32 v221, v221
v_rcp_f32 v222, v222
v_rcp_f32 v223, v223
v_mfma_f32_16x16x32_bf16 v[120:123], a[144:147], a[44:47], v[120:123]
buffer_load_dwordx4 v1, s[4:7], s39 offen offset:0 sc1 lds
s_lshl_b32 s38, s24, 8
s_nop 0
v_pk_mul_f32 v[100:101], v[100:101], v[216:217]
v_pk_mul_f32 v[102:103], v[102:103], v[218:219]
v_pk_mul_f32 v[104:105], v[104:105], v[220:221]
v_pk_mul_f32 v[106:107], v[106:107], v[222:223]
v_pk_add_f32 v[198:199], v[36:37], v[38:39]
v_pk_mul_f32 v[200:201], v[36:37], v[36:37]
v_pk_fma_f32 v[200:201], v[38:39], v[38:39], v[200:201]
v_pk_add_f32 v[202:203], v[40:41], v[42:43]
v_pk_mul_f32 v[204:205], v[40:41], v[40:41]
v_pk_fma_f32 v[204:205], v[42:43], v[42:43], v[204:205]
v_pk_add_f32 v[198:199], v[198:199], v[44:45]
v_pk_fma_f32 v[200:201], v[44:45], v[44:45], v[200:201]
v_pk_add_f32 v[198:199], v[198:199], v[46:47]
v_pk_fma_f32 v[200:201], v[46:47], v[46:47], v[200:201]
v_pk_add_f32 v[202:203], v[202:203], v[48:49]
v_pk_fma_f32 v[204:205], v[48:49], v[48:49], v[204:205]
v_pk_add_f32 v[202:203], v[202:203], v[50:51]
v_pk_fma_f32 v[204:205], v[50:51], v[50:51], v[204:205]
v_pk_add_f32 v[198:199], v[198:199], v[52:53]
v_pk_fma_f32 v[200:201], v[52:53], v[52:53], v[200:201]
v_pk_add_f32 v[198:199], v[198:199], v[54:55]
v_pk_fma_f32 v[200:201], v[54:55], v[54:55], v[200:201]
v_pk_add_f32 v[202:203], v[202:203], v[56:57]
v_pk_fma_f32 v[204:205], v[56:57], v[56:57], v[204:205]
v_pk_add_f32 v[202:203], v[202:203], v[58:59]
v_pk_fma_f32 v[204:205], v[58:59], v[58:59], v[204:205]
v_pk_add_f32 v[198:199], v[198:199], v[60:61]
v_pk_fma_f32 v[200:201], v[60:61], v[60:61], v[200:201]
v_pk_add_f32 v[198:199], v[198:199], v[62:63]
v_pk_fma_f32 v[200:201], v[62:63], v[62:63], v[200:201]
v_pk_add_f32 v[202:203], v[202:203], v[64:65]
v_pk_fma_f32 v[204:205], v[64:65], v[64:65], v[204:205]
v_pk_add_f32 v[202:203], v[202:203], v[66:67]
v_pk_fma_f32 v[204:205], v[66:67], v[66:67], v[204:205]
v_pk_add_f32 v[198:199], v[198:199], v[68:69]
v_pk_fma_f32 v[200:201], v[68:69], v[68:69], v[200:201]
v_pk_add_f32 v[198:199], v[198:199], v[70:71]
v_pk_fma_f32 v[200:201], v[70:71], v[70:71], v[200:201]
v_pk_add_f32 v[202:203], v[202:203], v[72:73]
v_pk_fma_f32 v[204:205], v[72:73], v[72:73], v[204:205]
v_pk_add_f32 v[202:203], v[202:203], v[74:75]
v_pk_fma_f32 v[204:205], v[74:75], v[74:75], v[204:205]
v_pk_add_f32 v[198:199], v[198:199], v[76:77]
v_pk_fma_f32 v[200:201], v[76:77], v[76:77], v[200:201]
v_pk_add_f32 v[198:199], v[198:199], v[78:79]
v_pk_fma_f32 v[200:201], v[78:79], v[78:79], v[200:201]
v_pk_add_f32 v[202:203], v[202:203], v[80:81]
v_pk_fma_f32 v[204:205], v[80:81], v[80:81], v[204:205]
v_pk_add_f32 v[202:203], v[202:203], v[82:83]
v_pk_fma_f32 v[204:205], v[82:83], v[82:83], v[204:205]
v_pk_add_f32 v[198:199], v[198:199], v[84:85]
v_pk_fma_f32 v[200:201], v[84:85], v[84:85], v[200:201]
v_pk_add_f32 v[198:199], v[198:199], v[86:87]
v_pk_fma_f32 v[200:201], v[86:87], v[86:87], v[200:201]
v_pk_add_f32 v[202:203], v[202:203], v[88:89]
v_pk_fma_f32 v[204:205], v[88:89], v[88:89], v[204:205]
v_pk_add_f32 v[202:203], v[202:203], v[90:91]
v_pk_fma_f32 v[204:205], v[90:91], v[90:91], v[204:205]
v_pk_add_f32 v[198:199], v[198:199], v[92:93]
v_pk_fma_f32 v[200:201], v[92:93], v[92:93], v[200:201]
v_pk_add_f32 v[198:199], v[198:199], v[94:95]
v_pk_fma_f32 v[200:201], v[94:95], v[94:95], v[200:201]
v_pk_add_f32 v[202:203], v[202:203], v[96:97]
v_pk_fma_f32 v[204:205], v[96:97], v[96:97], v[204:205]
v_pk_add_f32 v[202:203], v[202:203], v[98:99]
v_pk_fma_f32 v[204:205], v[98:99], v[98:99], v[204:205]
v_pk_add_f32 v[198:199], v[198:199], v[100:101]
v_pk_fma_f32 v[200:201], v[100:101], v[100:101], v[200:201]
v_pk_add_f32 v[198:199], v[198:199], v[102:103]
v_pk_fma_f32 v[200:201], v[102:103], v[102:103], v[200:201]
v_pk_add_f32 v[202:203], v[202:203], v[104:105]
v_pk_fma_f32 v[204:205], v[104:105], v[104:105], v[204:205]
v_pk_add_f32 v[202:203], v[202:203], v[106:107]
v_pk_fma_f32 v[204:205], v[106:107], v[106:107], v[204:205]
v_mfma_f32_16x16x32_bf16 v[124:127], a[148:151], a[40:43], v[124:127]
s_add_u32 m0, s38, 160768
v_add_f32 v198, v198, v199
v_add_f32 v202, v202, v203
v_mfma_f32_16x16x32_bf16 v[128:131], a[148:151], a[44:47], v[128:131]
s_waitcnt lgkmcnt(4)
s_add_u32 s39, s38, s82
v_add_f32 v200, v200, v201
v_add_f32 v204, v204, v205
v_permlane16_swap_b32 v198, v202
v_mfma_f32_16x16x32_bf16 v[116:119], a[152:155], a[48:51], v[116:119]
ds_read_b128 a[144:147], v209 offset:9216
ds_read_b128 a[148:151], v209 offset:27648
s_nop 0
v_mfma_f32_16x16x32_bf16 v[120:123], a[152:155], a[52:55], v[120:123]
s_add_u32 s39, s39, 339968
v_permlane16_swap_b32 v200, v204
v_add_f32 v198, v198, v202
v_mfma_f32_16x16x32_bf16 v[124:127], a[156:159], a[48:51], v[124:127]
s_mov_b64 exec, 0xffff
buffer_load_dwordx4 v1, s[4:7], s39 offen sc1 lds
s_mov_b64 exec, -1
v_add_f32 v199, v200, v204
v_mov_b32 v200, v198
v_mfma_f32_16x16x32_bf16 v[128:131], a[156:159], a[52:55], v[128:131]
s_waitcnt lgkmcnt(4)
v_mov_b32 v201, v199
s_nop 0
v_permlane32_swap_b32 v198, v200
v_mfma_f32_16x16x32_bf16 v[116:119], a[160:163], a[56:59], v[116:119]
ds_read_b128 a[152:155], v209 offset:10240
ds_read_b128 a[156:159], v209 offset:28672
v_permlane32_swap_b32 v199, v201
v_mfma_f32_16x16x32_bf16 v[120:123], a[160:163], a[60:63], v[120:123]
v_add_f32 v198, v198, v200
v_add_f32 v199, v199, v201
v_mfma_f32_16x16x32_bf16 v[124:127], a[164:167], a[56:59], v[124:127]
s_waitcnt vmcnt(21)
s_mov_b32 exec_hi, 0
buffer_store_dwordx2 v[198:199], v239, s[8:11], s30 offen sc1
s_mov_b64 exec, -1
v_mfma_f32_16x16x32_bf16 v[128:131], a[164:167], a[60:63], v[128:131]
s_waitcnt lgkmcnt(4)
v_mfma_f32_16x16x32_bf16 v[116:119], a[168:171], a[64:67], v[116:119]
ds_read_b128 a[160:163], v209 offset:11264
ds_read_b128 a[164:167], v209 offset:29696
v_mfma_f32_16x16x32_bf16 v[120:123], a[168:171], a[68:71], v[120:123]
v_mfma_f32_16x16x32_bf16 v[124:127], a[172:175], a[64:67], v[124:127]
v_mfma_f32_16x16x32_bf16 v[128:131], a[172:175], a[68:71], v[128:131]
s_waitcnt lgkmcnt(4)
v_mfma_f32_16x16x32_bf16 v[116:119], a[144:147], a[72:75], v[116:119]
ds_read_b128 a[168:171], v209 offset:12288
ds_read_b128 a[172:175], v209 offset:30720
v_mfma_f32_16x16x32_bf16 v[120:123], a[144:147], a[76:79], v[120:123]
v_mfma_f32_16x16x32_bf16 v[124:127], a[148:151], a[72:75], v[124:127]
v_mfma_f32_16x16x32_bf16 v[128:131], a[148:151], a[76:79], v[128:131]
s_waitcnt lgkmcnt(4)
v_mfma_f32_16x16x32_bf16 v[116:119], a[152:155], a[80:83], v[116:119]
ds_read_b128 a[144:147], v209 offset:13312
ds_read_b128 a[148:151], v209 offset:31744
v_mfma_f32_16x16x32_bf16 v[120:123], a[152:155], a[84:87], v[120:123]
v_mfma_f32_16x16x32_bf16 v[124:127], a[156:159], a[80:83], v[124:127]
v_mfma_f32_16x16x32_bf16 v[128:131], a[156:159], a[84:87], v[128:131]
s_waitcnt lgkmcnt(4)
v_mfma_f32_16x16x32_bf16 v[116:119], a[160:163], a[88:91], v[116:119]
ds_read_b128 a[152:155], v209 offset:14336
ds_read_b128 a[156:159], v209 offset:32768
v_mfma_f32_16x16x32_bf16 v[120:123], a[160:163], a[92:95], v[120:123]
v_mfma_f32_16x16x32_bf16 v[124:127], a[164:167], a[88:91], v[124:127]
v_mfma_f32_16x16x32_bf16 v[128:131], a[164:167], a[92:95], v[128:131]
s_waitcnt lgkmcnt(4)
v_mfma_f32_16x16x32_bf16 v[116:119], a[168:171], a[96:99], v[116:119]
ds_read_b128 a[160:163], v209 offset:15360
ds_read_b128 a[164:167], v209 offset:33792
v_mfma_f32_16x16x32_bf16 v[120:123], a[168:171], a[100:103], v[120:123]
v_mfma_f32_16x16x32_bf16 v[124:127], a[172:175], a[96:99], v[124:127]
v_mfma_f32_16x16x32_bf16 v[128:131], a[172:175], a[100:103], v[128:131]
s_waitcnt lgkmcnt(4)
v_mfma_f32_16x16x32_bf16 v[116:119], a[144:147], a[104:107], v[116:119]
ds_read_b128 a[168:171], v209 offset:16384
ds_read_b128 a[172:175], v209 offset:34816
v_mfma_f32_16x16x32_bf16 v[120:123], a[144:147], a[108:111], v[120:123]
v_mfma_f32_16x16x32_bf16 v[124:127], a[148:151], a[104:107], v[124:127]
v_mfma_f32_16x16x32_bf16 v[128:131], a[148:151], a[108:111], v[128:131]
s_waitcnt lgkmcnt(4)
v_mfma_f32_16x16x32_bf16 v[116:119], a[152:155], a[112:115], v[116:119]
ds_read_b128 a[144:147], v209 offset:17408
ds_read_b128 a[148:151], v209 offset:35840
v_mfma_f32_16x16x32_bf16 v[120:123], a[152:155], a[116:119], v[120:123]
v_mfma_f32_16x16x32_bf16 v[124:127], a[156:159], a[112:115], v[124:127]
v_mfma_f32_16x16x32_bf16 v[128:131], a[156:159], a[116:119], v[128:131]
s_waitcnt lgkmcnt(4)
v_add_u32 v181, 36864, v239
v_mfma_f32_16x16x32_bf16 v[116:119], a[160:163], a[120:123], v[116:119]
ds_read_b64 a[152:153], v181 offset:0
ds_read_b64 a[156:157], v181 offset:512
v_mfma_f32_16x16x32_bf16 v[120:123], a[160:163], a[124:127], v[120:123]
v_mfma_f32_16x16x32_bf16 v[124:127], a[164:167], a[120:123], v[124:127]
v_mfma_f32_16x16x32_bf16 v[128:131], a[164:167], a[124:127], v[128:131]
s_waitcnt lgkmcnt(4)
v_mfma_f32_16x16x32_bf16 v[116:119], a[168:171], a[128:131], v[116:119]
ds_read_b128 a[160:163], v210 offset:0
ds_read_b128 a[164:167], v210 offset:18432
v_mfma_f32_16x16x32_bf16 v[120:123], a[168:171], a[132:135], v[120:123]
buffer_load_dwordx2 v[182:183], v234, s[8:11], s61 offen offset:0 sc1
v_mfma_f32_16x16x32_bf16 v[124:127], a[172:175], a[128:131], v[124:127]
buffer_load_dwordx2 v[184:185], v234, s[8:11], s61 offen offset:1024 sc1
v_mfma_f32_16x16x32_bf16 v[128:131], a[172:175], a[132:135], v[128:131]
s_waitcnt lgkmcnt(4)
v_mfma_f32_16x16x32_bf16 v[116:119], a[144:147], a[136:139], v[116:119]
ds_read_b128 a[168:171], v210 offset:1024
ds_read_b128 a[172:175], v210 offset:19456
v_mfma_f32_16x16x32_bf16 v[120:123], a[144:147], a[140:143], v[120:123]
buffer_load_dwordx2 v[186:187], v234, s[8:11], s61 offen offset:2048 sc1
v_mfma_f32_16x16x32_bf16 v[124:127], a[148:151], a[136:139], v[124:127]
buffer_load_dwordx2 v[188:189], v234, s[8:11], s61 offen offset:3072 sc1
v_mfma_f32_16x16x32_bf16 v[128:131], a[148:151], a[140:143], v[128:131]
s_waitcnt lgkmcnt(4)
v_mfma_f32_16x16x16_bf16 v[116:119], a[152:153], v[212:213], v[116:119]
ds_read_b128 a[144:147], v210 offset:2048
ds_read_b128 a[148:151], v210 offset:20480
v_mfma_f32_16x16x16_bf16 v[120:123], a[152:153], v[214:215], v[120:123]
buffer_load_dwordx2 v[190:191], v235, s[8:11], s61 offen offset:0 sc1
v_mfma_f32_16x16x16_bf16 v[124:127], a[156:157], v[212:213], v[124:127]
buffer_load_dwordx2 v[192:193], v235, s[8:11], s61 offen offset:1024 sc1
v_mfma_f32_16x16x16_bf16 v[128:131], a[156:157], v[214:215], v[128:131]
s_waitcnt vmcnt(17) lgkmcnt(4)
s_barrier
v_mfma_f32_16x16x32_bf16 v[132:135], a[160:163], a[0:3], 0
ds_read_b128 a[152:155], v210 offset:3072
ds_read_b128 a[156:159], v210 offset:21504
v_mfma_f32_16x16x32_bf16 v[136:139], a[160:163], a[4:7], 0
buffer_load_dwordx2 v[194:195], v235, s[8:11], s61 offen offset:2048 sc1
v_mfma_f32_16x16x32_bf16 v[140:143], a[164:167], a[0:3], 0
buffer_load_dwordx2 v[196:197], v235, s[8:11], s61 offen offset:3072 sc1
v_mfma_f32_16x16x32_bf16 v[144:147], a[164:167], a[4:7], 0
s_waitcnt lgkmcnt(4)
v_mfma_f32_16x16x32_bf16 v[132:135], a[168:171], a[8:11], v[132:135]
ds_read_b128 a[160:163], v210 offset:4096
ds_read_b128 a[164:167], v210 offset:22528
v_mfma_f32_16x16x32_bf16 v[136:139], a[168:171], a[12:15], v[136:139]
v_mfma_f32_16x16x32_bf16 v[140:143], a[172:175], a[8:11], v[140:143]
v_mfma_f32_16x16x32_bf16 v[144:147], a[172:175], a[12:15], v[144:147]
s_waitcnt lgkmcnt(4)
v_mfma_f32_16x16x32_bf16 v[132:135], a[144:147], a[16:19], v[132:135]
ds_read_b128 a[168:171], v210 offset:5120
ds_read_b128 a[172:175], v210 offset:23552
v_mfma_f32_16x16x32_bf16 v[136:139], a[144:147], a[20:23], v[136:139]
v_mfma_f32_16x16x32_bf16 v[140:143], a[148:151], a[16:19], v[140:143]
v_mfma_f32_16x16x32_bf16 v[144:147], a[148:151], a[20:23], v[144:147]
s_waitcnt lgkmcnt(4)
v_mfma_f32_16x16x32_bf16 v[132:135], a[152:155], a[24:27], v[132:135]
ds_read_b128 a[144:147], v210 offset:6144
ds_read_b128 a[148:151], v210 offset:24576
v_mfma_f32_16x16x32_bf16 v[136:139], a[152:155], a[28:31], v[136:139]
v_mfma_f32_16x16x32_bf16 v[140:143], a[156:159], a[24:27], v[140:143]
v_mfma_f32_16x16x32_bf16 v[144:147], a[156:159], a[28:31], v[144:147]
s_waitcnt lgkmcnt(4)
v_mfma_f32_16x16x32_bf16 v[132:135], a[160:163], a[32:35], v[132:135]
ds_read_b128 a[152:155], v210 offset:7168
ds_read_b128 a[156:159], v210 offset:25600
v_mfma_f32_16x16x32_bf16 v[136:139], a[160:163], a[36:39], v[136:139]
v_mfma_f32_16x16x32_bf16 v[140:143], a[164:167], a[32:35], v[140:143]
v_mfma_f32_16x16x32_bf16 v[144:147], a[164:167], a[36:39], v[144:147]
s_waitcnt lgkmcnt(4)
v_mfma_f32_16x16x32_bf16 v[132:135], a[168:171], a[40:43], v[132:135]
ds_read_b128 a[160:163], v210 offset:8192
ds_read_b128 a[164:167], v210 offset:26624
v_mfma_f32_16x16x32_bf16 v[136:139], a[168:171], a[44:47], v[136:139]
v_mfma_f32_16x16x32_bf16 v[140:143], a[172:175], a[40:43], v[140:143]
v_mfma_f32_16x16x32_bf16 v[144:147], a[172:175], a[44:47], v[144:147]
s_waitcnt lgkmcnt(4)
v_mfma_f32_16x16x32_bf16 v[132:135], a[144:147], a[48:51], v[132:135]
ds_read_b128 a[168:171], v210 offset:9216
ds_read_b128 a[172:175], v210 offset:27648
v_mfma_f32_16x16x32_bf16 v[136:139], a[144:147], a[52:55], v[136:139]
v_mfma_f32_16x16x32_bf16 v[140:143], a[148:151], a[48:51], v[140:143]
v_mfma_f32_16x16x32_bf16 v[144:147], a[148:151], a[52:55], v[144:147]
s_waitcnt lgkmcnt(4)
v_mfma_f32_16x16x32_bf16 v[132:135], a[152:155], a[56:59], v[132:135]
ds_read_b128 a[144:147], v210 offset:10240
ds_read_b128 a[148:151], v210 offset:28672
v_mfma_f32_16x16x32_bf16 v[136:139], a[152:155], a[60:63], v[136:139]
v_mfma_f32_16x16x32_bf16 v[140:143], a[156:159], a[56:59], v[140:143]
v_mfma_f32_16x16x32_bf16 v[144:147], a[156:159], a[60:63], v[144:147]
s_waitcnt lgkmcnt(4)
v_mfma_f32_16x16x32_bf16 v[132:135], a[160:163], a[64:67], v[132:135]
ds_read_b128 a[152:155], v210 offset:11264
ds_read_b128 a[156:159], v210 offset:29696
v_mfma_f32_16x16x32_bf16 v[136:139], a[160:163], a[68:71], v[136:139]
v_mfma_f32_16x16x32_bf16 v[140:143], a[164:167], a[64:67], v[140:143]
v_mfma_f32_16x16x32_bf16 v[144:147], a[164:167], a[68:71], v[144:147]
s_waitcnt lgkmcnt(4)
v_mfma_f32_16x16x32_bf16 v[132:135], a[168:171], a[72:75], v[132:135]
ds_read_b128 a[160:163], v210 offset:12288
ds_read_b128 a[164:167], v210 offset:30720
v_mfma_f32_16x16x32_bf16 v[136:139], a[168:171], a[76:79], v[136:139]
v_mfma_f32_16x16x32_bf16 v[140:143], a[172:175], a[72:75], v[140:143]
s_waitcnt vmcnt(0)
v_min3_f32 v200, v183, v185, v187
v_mfma_f32_16x16x32_bf16 v[144:147], a[172:175], a[76:79], v[144:147]
s_waitcnt lgkmcnt(4)
v_min3_f32 v201, v189, v191, v193
v_mfma_f32_16x16x32_bf16 v[132:135], a[144:147], a[80:83], v[132:135]
ds_read_b128 a[168:171], v210 offset:13312
ds_read_b128 a[172:175], v210 offset:31744
v_mfma_f32_16x16x32_bf16 v[136:139], a[144:147], a[84:87], v[136:139]
v_min3_f32 v200, v200, v195, v197
v_min_f32 v200, v200, v201
v_mfma_f32_16x16x32_bf16 v[140:143], a[148:151], a[80:83], v[140:143]
v_cmp_gt_f32 vcc, 0, v200
v_mfma_f32_16x16x32_bf16 v[144:147], a[148:151], a[84:87], v[144:147]
s_waitcnt lgkmcnt(4)
s_nop 0
s_cbranch_vccnz L_stzslow_23
L_stzback_24:
v_mfma_f32_16x16x32_bf16 v[132:135], a[152:155], a[88:91], v[132:135]
ds_read_b128 a[144:147], v210 offset:14336
ds_read_b128 a[148:151], v210 offset:32768
v_mfma_f32_16x16x32_bf16 v[136:139], a[152:155], a[92:95], v[136:139]
v_add_f32 v198, v182, v184
v_add_f32 v199, v183, v185
v_mfma_f32_16x16x32_bf16 v[140:143], a[156:159], a[88:91], v[140:143]
buffer_load_dwordx4 a[176:179], v1, s[4:7], s52 offen offset:0 sc1
buffer_load_dwordx4 a[180:183], v9, s[4:7], s52 offen offset:0 sc1
v_add_f32 v198, v198, v186
v_add_f32 v199, v199, v187
v_mfma_f32_16x16x32_bf16 v[144:147], a[156:159], a[92:95], v[144:147]
s_waitcnt lgkmcnt(4)
v_add_f32 v198, v198, v188
v_add_f32 v199, v199, v189
v_mfma_f32_16x16x32_bf16 v[132:135], a[160:163], a[96:99], v[132:135]
ds_read_b128 a[152:155], v210 offset:15360
ds_read_b128 a[156:159], v210 offset:33792
v_add_f32 v198, v198, v190
v_mfma_f32_16x16x32_bf16 v[136:139], a[160:163], a[100:103], v[136:139]
v_add_f32 v199, v199, v191
v_add_f32 v198, v198, v192
v_mfma_f32_16x16x32_bf16 v[140:143], a[164:167], a[96:99], v[140:143]
buffer_load_dwordx4 a[184:187], v1, s[4:7], s52 offen offset:1024 sc1
buffer_load_dwordx4 a[188:191], v9, s[4:7], s52 offen offset:1024 sc1
v_add_f32 v199, v199, v193
v_add_f32 v198, v198, v194
v_mfma_f32_16x16x32_bf16 v[144:147], a[164:167], a[100:103], v[144:147]
s_waitcnt lgkmcnt(4)
v_add_f32 v199, v199, v195
v_add_f32 v198, v198, v196
v_mfma_f32_16x16x32_bf16 v[132:135], a[168:171], a[104:107], v[132:135]
ds_read_b128 a[160:163], v210 offset:16384
ds_read_b128 a[164:167], v210 offset:34816
v_add_f32 v199, v199, v197
v_mov_b32 v200, v198
v_mfma_f32_16x16x32_bf16 v[136:139], a[168:171], a[108:111], v[136:139]
v_mov_b32 v201, v199
s_nop 0
v_mfma_f32_16x16x32_bf16 v[140:143], a[172:175], a[104:107], v[140:143]
v_permlane32_swap_b32 v198, v200
v_mfma_f32_16x16x32_bf16 v[144:147], a[172:175], a[108:111], v[144:147]
s_waitcnt lgkmcnt(4)
v_permlane32_swap_b32 v199, v201
v_mfma_f32_16x16x32_bf16 v[132:135], a[144:147], a[112:115], v[132:135]
ds_read_b128 a[168:171], v210 offset:17408
ds_read_b128 a[172:175], v210 offset:35840
v_add_f32 v198, v198, v200
v_mfma_f32_16x16x32_bf16 v[136:139], a[144:147], a[116:119], v[136:139]
buffer_load_dwordx4 a[192:195], v1, s[4:7], s52 offen offset:2048 sc1
buffer_load_dwordx4 a[196:199], v9, s[4:7], s52 offen offset:2048 sc1
v_add_f32 v199, v199, v201
v_mul_f32 v198, 0x39e38e39, v198
v_mfma_f32_16x16x32_bf16 v[140:143], a[148:151], a[112:115], v[140:143]
v_mul_f32 v200, v198, v198
v_mul_f32 v199, 0x39e38e39, v199
v_mfma_f32_16x16x32_bf16 v[144:147], a[148:151], a[116:119], v[144:147]
s_waitcnt lgkmcnt(4)
v_sub_f32 v199, v199, v200
v_add_u32 v181, 74752, v239
v_mfma_f32_16x16x32_bf16 v[132:135], a[152:155], a[120:123], v[132:135]
ds_read_b64 a[144:145], v181 offset:0
ds_read_b64 a[148:149], v181 offset:512
v_max_f32 v199, 0, v199
v_add_f32 v199, 0x3727c5ac, v199
v_mfma_f32_16x16x32_bf16 v[136:139], a[152:155], a[124:127], v[136:139]
buffer_load_dwordx4 a[200:203], v1, s[4:7], s52 offen offset:3072 sc1
buffer_load_dwordx4 a[204:207], v9, s[4:7], s52 offen offset:3072 sc1
v_rsq_f32 v202, v199
v_mfma_f32_16x16x32_bf16 v[140:143], a[156:159], a[120:123], v[140:143]
s_nop 0
v_mul_f32 v204, v198, v202
v_mov_b32 v203, v202
v_mfma_f32_16x16x32_bf16 v[144:147], a[156:159], a[124:127], v[144:147]
s_waitcnt lgkmcnt(4)
v_mov_b32 v205, v204
s_nop 0
v_mfma_f32_16x16x32_bf16 v[132:135], a[160:163], a[128:131], v[132:135]
ds_read_b128 a[152:155], v211 offset:0
ds_read_b128 a[156:159], v211 offset:18432
v_mfma_f32_16x16x32_bf16 v[136:139], a[160:163], a[132:135], v[136:139]
s_mov_b32 s52, s53
v_permlane16_swap_b32 v202, v203
v_mfma_f32_16x16x32_bf16 v[140:143], a[164:167], a[128:131], v[140:143]
s_cmp_eq_u32 s25, 0
s_cselect_b32 s98, 4096, 0
v_permlane16_swap_b32 v204, v205
v_mfma_f32_16x16x32_bf16 v[144:147], a[164:167], a[132:135], v[144:147]
s_waitcnt lgkmcnt(4)
v_fma_f32 v36, v36, v202, -v204
v_fma_f32 v37, v37, v202, -v204
v_mfma_f32_16x16x32_bf16 v[132:135], a[168:171], a[136:139], v[132:135]
ds_read_b128 a[160:163], v211 offset:1024
ds_read_b128 a[164:167], v211 offset:19456
v_fma_f32 v38, v38, v202, -v204
v_mfma_f32_16x16x32_bf16 v[136:139], a[168:171], a[140:143], v[136:139]
s_add_u32 s52, s52, s98
v_fma_f32 v39, v39, v202, -v204
v_fma_f32 v44, v44, v202, -v204
v_mfma_f32_16x16x32_bf16 v[140:143], a[172:175], a[136:139], v[140:143]
v_fma_f32 v45, v45, v202, -v204
v_fma_f32 v46, v46, v202, -v204
v_mfma_f32_16x16x32_bf16 v[144:147], a[172:175], a[140:143], v[144:147]
s_waitcnt lgkmcnt(4)
v_fma_f32 v47, v47, v202, -v204
v_cvt_pk_bf16_f32 v216, v36, v37
v_mfma_f32_16x16x16_bf16 v[132:135], a[144:145], v[212:213], v[132:135]
ds_read_b128 a[168:171], v211 offset:2048
ds_read_b128 a[172:175], v211 offset:20480
v_cvt_pk_bf16_f32 v217, v38, v39
v_cvt_pk_bf16_f32 v218, v44, v45
v_mfma_f32_16x16x16_bf16 v[136:139], a[144:145], v[214:215], v[136:139]
v_cvt_pk_bf16_f32 v219, v46, v47
v_mfma_f32_16x16x16_bf16 v[140:143], a[148:149], v[212:213], v[140:143]
ds_write_b128 v236, v[216:219] offset:0
v_fma_f32 v40, v40, v203, -v205
v_mfma_f32_16x16x16_bf16 v[144:147], a[148:149], v[214:215], v[144:147]
s_waitcnt lgkmcnt(5)
v_fma_f32 v41, v41, v203, -v205
v_fma_f32 v42, v42, v203, -v205
s_barrier
v_mfma_f32_16x16x32_bf16 v[148:151], a[152:155], a[0:3], 0
ds_read_b128 a[144:147], v211 offset:3072
ds_read_b128 a[148:151], v211 offset:21504
v_fma_f32 v43, v43, v203, -v205
v_fma_f32 v48, v48, v203, -v205
v_mfma_f32_16x16x32_bf16 v[152:155], a[152:155], a[4:7], 0
buffer_load_dwordx4 a[208:211], v1, s[4:7], s52 offen offset:0 sc1
buffer_load_dwordx4 a[212:215], v9, s[4:7], s52 offen offset:0 sc1
v_fma_f32 v49, v49, v203, -v205
v_fma_f32 v50, v50, v203, -v205
v_mfma_f32_16x16x32_bf16 v[156:159], a[156:159], a[0:3], 0
buffer_load_dwordx4 a[216:219], v1, s[4:7], s52 offen offset:1024 sc1
buffer_load_dwordx4 a[220:223], v9, s[4:7], s52 offen offset:1024 sc1
v_fma_f32 v51, v51, v203, -v205
v_mfma_f32_16x16x32_bf16 v[160:163], a[156:159], a[4:7], 0
s_waitcnt lgkmcnt(5)
v_cvt_pk_bf16_f32 v220, v40, v41
v_cvt_pk_bf16_f32 v221, v42, v43
v_mfma_f32_16x16x32_bf16 v[148:151], a[160:163], a[8:11], v[148:151]
ds_read_b128 a[152:155], v211 offset:4096
ds_read_b128 a[156:159], v211 offset:22528
v_cvt_pk_bf16_f32 v222, v48, v49
v_cvt_pk_bf16_f32 v223, v50, v51
v_mfma_f32_16x16x32_bf16 v[152:155], a[160:163], a[12:15], v[152:155]
ds_write_b128 v236, v[220:223] offset:4608
v_mfma_f32_16x16x32_bf16 v[156:159], a[164:167], a[8:11], v[156:159]
ds_read_b64_tr_b16 v[36:37], v237 offset:0
ds_read_b64_tr_b16 v[38:39], v237 offset:1152
ds_read_b64_tr_b16 v[40:41], v237 offset:8
ds_read_b64_tr_b16 v[42:43], v237 offset:1160
v_mfma_f32_16x16x32_bf16 v[160:163], a[164:167], a[12:15], v[160:163]
s_waitcnt lgkmcnt(10)
v_fma_f32 v52, v52, v202, -v204
v_fma_f32 v53, v53, v202, -v204
v_mfma_f32_16x16x32_bf16 v[148:151], a[168:171], a[16:19], v[148:151]
ds_read_b128 a[160:163], v211 offset:5120
ds_read_b128 a[164:167], v211 offset:23552
v_mfma_f32_16x16x32_bf16 v[152:155], a[168:171], a[20:23], v[152:155]
buffer_load_dwordx4 a[224:227], v1, s[4:7], s52 offen offset:2048 sc1
buffer_load_dwordx4 a[228:231], v9, s[4:7], s52 offen offset:2048 sc1
v_mfma_f32_16x16x32_bf16 v[156:159], a[172:175], a[16:19], v[156:159]
v_fma_f32 v54, v54, v202, -v204
v_fma_f32 v55, v55, v202, -v204
v_mfma_f32_16x16x32_bf16 v[160:163], a[172:175], a[20:23], v[160:163]
s_waitcnt lgkmcnt(9)
v_fma_f32 v60, v60, v202, -v204
v_fma_f32 v61, v61, v202, -v204
v_mfma_f32_16x16x32_bf16 v[148:151], a[144:147], a[24:27], v[148:151]
ds_read_b128 a[168:171], v211 offset:6144
ds_read_b128 a[172:175], v211 offset:24576
v_mfma_f32_16x16x32_bf16 v[152:155], a[144:147], a[28:31], v[152:155]
buffer_load_dwordx4 a[232:235], v1, s[4:7], s52 offen offset:3072 sc1
buffer_load_dwordx4 a[236:239], v9, s[4:7], s52 offen offset:3072 sc1
v_fma_f32 v62, v62, v202, -v204
v_mfma_f32_16x16x32_bf16 v[156:159], a[148:151], a[24:27], v[156:159]
v_fma_f32 v63, v63, v202, -v204
v_cvt_pk_bf16_f32 v224, v52, v53
v_mfma_f32_16x16x32_bf16 v[160:163], a[148:151], a[28:31], v[160:163]
s_waitcnt lgkmcnt(9)
v_cvt_pk_bf16_f32 v225, v54, v55
v_cvt_pk_bf16_f32 v226, v60, v61
v_mfma_f32_16x16x32_bf16 v[148:151], a[152:155], a[32:35], v[148:151]
ds_read_b128 a[144:147], v211 offset:7168
ds_read_b128 a[148:151], v211 offset:25600
v_mfma_f32_16x16x32_bf16 v[152:155], a[152:155], a[36:39], v[152:155]
v_cvt_pk_bf16_f32 v227, v62, v63
v_mfma_f32_16x16x32_bf16 v[156:159], a[156:159], a[32:35], v[156:159]
ds_write_b128 v236, v[224:227] offset:64
v_mfma_f32_16x16x32_bf16 v[160:163], a[156:159], a[36:39], v[160:163]
s_waitcnt lgkmcnt(5)
buffer_store_dwordx4 v[36:39], v1, s[8:11], s66 offen offset:0 sc1
v_mfma_f32_16x16x32_bf16 v[148:151], a[160:163], a[40:43], v[148:151]
ds_read_b128 a[152:155], v211 offset:8192
ds_read_b128 a[156:159], v211 offset:26624
v_mfma_f32_16x16x32_bf16 v[152:155], a[160:163], a[44:47], v[152:155]
v_fma_f32 v56, v56, v203, -v205
v_fma_f32 v57, v57, v203, -v205
v_mfma_f32_16x16x32_bf16 v[156:159], a[164:167], a[40:43], v[156:159]
v_fma_f32 v58, v58, v203, -v205
v_fma_f32 v59, v59, v203, -v205
v_mfma_f32_16x16x32_bf16 v[160:163], a[164:167], a[44:47], v[160:163]
s_waitcnt lgkmcnt(5)
v_fma_f32 v64, v64, v203, -v205
v_fma_f32 v65, v65, v203, -v205
v_mfma_f32_16x16x32_bf16 v[148:151], a[168:171], a[48:51], v[148:151]
ds_read_b128 a[160:163], v211 offset:9216
ds_read_b128 a[164:167], v211 offset:27648
v_mfma_f32_16x16x32_bf16 v[152:155], a[168:171], a[52:55], v[152:155]
v_fma_f32 v66, v66, v203, -v205
v_fma_f32 v67, v67, v203, -v205
v_mfma_f32_16x16x32_bf16 v[156:159], a[172:175], a[48:51], v[156:159]
v_cvt_pk_bf16_f32 v228, v56, v57
v_cvt_pk_bf16_f32 v229, v58, v59
v_mfma_f32_16x16x32_bf16 v[160:163], a[172:175], a[52:55], v[160:163]
s_waitcnt lgkmcnt(5)
v_cvt_pk_bf16_f32 v230, v64, v65
v_cvt_pk_bf16_f32 v231, v66, v67
v_mfma_f32_16x16x32_bf16 v[148:151], a[144:147], a[56:59], v[148:151]
ds_read_b128 a[168:171], v211 offset:10240
ds_read_b128 a[172:175], v211 offset:28672
v_mfma_f32_16x16x32_bf16 v[152:155], a[144:147], a[60:63], v[152:155]
ds_write_b128 v236, v[228:231] offset:4672
v_mfma_f32_16x16x32_bf16 v[156:159], a[148:151], a[56:59], v[156:159]
ds_read_b64_tr_b16 v[52:53], v237 offset:64
ds_read_b64_tr_b16 v[54:55], v237 offset:1216
v_mfma_f32_16x16x32_bf16 v[160:163], a[148:151], a[60:63], v[160:163]
s_waitcnt lgkmcnt(7)
v_mfma_f32_16x16x32_bf16 v[148:151], a[152:155], a[64:67], v[148:151]
ds_read_b128 a[144:147], v211 offset:11264
ds_read_b128 a[148:151], v211 offset:29696
ds_read_b64_tr_b16 v[56:57], v237 offset:72
ds_read_b64_tr_b16 v[58:59], v237 offset:1224
buffer_store_dwordx4 v[40:43], v1, s[8:11], s66 offen offset:1024 sc1
v_mfma_f32_16x16x32_bf16 v[152:155], a[152:155], a[68:71], v[152:155]
v_fma_f32 v68, v68, v202, -v204
v_fma_f32 v69, v69, v202, -v204
v_mfma_f32_16x16x32_bf16 v[156:159], a[156:159], a[64:67], v[156:159]
v_fma_f32 v70, v70, v202, -v204
v_mfma_f32_16x16x32_bf16 v[160:163], a[156:159], a[68:71], v[160:163]
s_waitcnt lgkmcnt(9)
v_fma_f32 v71, v71, v202, -v204
v_mfma_f32_16x16x32_bf16 v[148:151], a[160:163], a[72:75], v[148:151]
ds_read_b128 a[152:155], v211 offset:12288
ds_read_b128 a[156:159], v211 offset:30720
v_mfma_f32_16x16x32_bf16 v[152:155], a[160:163], a[76:79], v[152:155]
v_fma_f32 v76, v76, v202, -v204
v_fma_f32 v77, v77, v202, -v204
v_mfma_f32_16x16x32_bf16 v[156:159], a[164:167], a[72:75], v[156:159]
v_fma_f32 v78, v78, v202, -v204
v_mfma_f32_16x16x32_bf16 v[160:163], a[164:167], a[76:79], v[160:163]
s_waitcnt lgkmcnt(9)
v_fma_f32 v79, v79, v202, -v204
v_cvt_pk_bf16_f32 v216, v68, v69
v_mfma_f32_16x16x32_bf16 v[148:151], a[168:171], a[80:83], v[148:151]
ds_read_b128 a[160:163], v211 offset:13312
ds_read_b128 a[164:167], v211 offset:31744
v_mfma_f32_16x16x32_bf16 v[152:155], a[168:171], a[84:87], v[152:155]
v_cvt_pk_bf16_f32 v217, v70, v71
v_cvt_pk_bf16_f32 v218, v76, v77
v_mfma_f32_16x16x32_bf16 v[156:159], a[172:175], a[80:83], v[156:159]
v_cvt_pk_bf16_f32 v219, v78, v79
v_mfma_f32_16x16x32_bf16 v[160:163], a[172:175], a[84:87], v[160:163]
s_waitcnt lgkmcnt(6)
v_mfma_f32_16x16x32_bf16 v[148:151], a[144:147], a[88:91], v[148:151]
ds_read_b128 a[168:171], v211 offset:14336
ds_read_b128 a[172:175], v211 offset:32768
v_mfma_f32_16x16x32_bf16 v[152:155], a[144:147], a[92:95], v[152:155]
ds_write_b128 v236, v[216:219] offset:128
buffer_store_dwordx4 v[52:55], v1, s[8:11], s66 offen offset:2048 sc1
v_mfma_f32_16x16x32_bf16 v[156:159], a[148:151], a[88:91], v[156:159]
v_fma_f32 v72, v72, v203, -v205
v_fma_f32 v73, v73, v203, -v205
v_mfma_f32_16x16x32_bf16 v[160:163], a[148:151], a[92:95], v[160:163]
s_waitcnt lgkmcnt(5)
v_fma_f32 v74, v74, v203, -v205
v_mfma_f32_16x16x32_bf16 v[148:151], a[152:155], a[96:99], v[148:151]
ds_read_b128 a[144:147], v211 offset:15360
ds_read_b128 a[148:151], v211 offset:33792
v_mfma_f32_16x16x32_bf16 v[152:155], a[152:155], a[100:103], v[152:155]
v_fma_f32 v75, v75, v203, -v205
v_fma_f32 v80, v80, v203, -v205
v_mfma_f32_16x16x32_bf16 v[156:159], a[156:159], a[96:99], v[156:159]
v_fma_f32 v81, v81, v203, -v205
v_fma_f32 v82, v82, v203, -v205
v_mfma_f32_16x16x32_bf16 v[160:163], a[156:159], a[100:103], v[160:163]
s_waitcnt lgkmcnt(5)
v_fma_f32 v83, v83, v203, -v205
v_cvt_pk_bf16_f32 v220, v72, v73
v_mfma_f32_16x16x32_bf16 v[148:151], a[160:163], a[104:107], v[148:151]
ds_read_b128 a[152:155], v211 offset:16384
ds_read_b128 a[156:159], v211 offset:34816
v_mfma_f32_16x16x32_bf16 v[152:155], a[160:163], a[108:111], v[152:155]
v_cvt_pk_bf16_f32 v221, v74, v75
v_cvt_pk_bf16_f32 v222, v80, v81
v_mfma_f32_16x16x32_bf16 v[156:159], a[164:167], a[104:107], v[156:159]
v_cvt_pk_bf16_f32 v223, v82, v83
v_mfma_f32_16x16x32_bf16 v[160:163], a[164:167], a[108:111], v[160:163]
s_waitcnt lgkmcnt(5)
v_mfma_f32_16x16x32_bf16 v[148:151], a[168:171], a[112:115], v[148:151]
ds_read_b128 a[160:163], v211 offset:17408
ds_read_b128 a[164:167], v211 offset:35840
v_mfma_f32_16x16x32_bf16 v[152:155], a[168:171], a[116:119], v[152:155]
ds_write_b128 v236, v[220:223] offset:4736
v_mfma_f32_16x16x32_bf16 v[156:159], a[172:175], a[112:115], v[156:159]
ds_read_b64_tr_b16 v[68:69], v237 offset:128
ds_read_b64_tr_b16 v[70:71], v237 offset:1280
ds_read_b64_tr_b16 v[72:73], v237 offset:136
ds_read_b64_tr_b16 v[74:75], v237 offset:1288
buffer_store_dwordx4 v[56:59], v1, s[8:11], s66 offen offset:3072 sc1
v_mfma_f32_16x16x32_bf16 v[160:163], a[172:175], a[116:119], v[160:163]
s_waitcnt lgkmcnt(9)
v_fma_f32 v84, v84, v202, -v204
v_add_u32 v181, 112640, v239
v_mfma_f32_16x16x32_bf16 v[148:151], a[144:147], a[120:123], v[148:151]
ds_read_b64 a[168:169], v181 offset:0
ds_read_b64 a[172:173], v181 offset:512
v_mfma_f32_16x16x32_bf16 v[152:155], a[144:147], a[124:127], v[152:155]
v_fma_f32 v85, v85, v202, -v204
v_fma_f32 v86, v86, v202, -v204
v_mfma_f32_16x16x32_bf16 v[156:159], a[148:151], a[120:123], v[156:159]
v_fma_f32 v87, v87, v202, -v204
v_fma_f32 v92, v92, v202, -v204
v_mfma_f32_16x16x32_bf16 v[160:163], a[148:151], a[124:127], v[160:163]
s_waitcnt lgkmcnt(9)
v_fma_f32 v93, v93, v202, -v204
v_fma_f32 v94, v94, v202, -v204
v_mfma_f32_16x16x32_bf16 v[148:151], a[152:155], a[128:131], v[148:151]
ds_read_b128 a[144:147], v208 offset:0
ds_read_b128 a[148:151], v208 offset:18432
v_mfma_f32_16x16x32_bf16 v[152:155], a[152:155], a[132:135], v[152:155]
v_fma_f32 v95, v95, v202, -v204
v_cvt_pk_bf16_f32 v224, v84, v85
v_mfma_f32_16x16x32_bf16 v[156:159], a[156:159], a[128:131], v[156:159]
v_cvt_pk_bf16_f32 v225, v86, v87
v_mfma_f32_16x16x32_bf16 v[160:163], a[156:159], a[132:135], v[160:163]
s_waitcnt lgkmcnt(9)
v_cvt_pk_bf16_f32 v226, v92, v93
v_cvt_pk_bf16_f32 v227, v94, v95
v_mfma_f32_16x16x32_bf16 v[148:151], a[160:163], a[136:139], v[148:151]
ds_read_b128 a[152:155], v208 offset:1024
ds_read_b128 a[156:159], v208 offset:19456
v_mfma_f32_16x16x32_bf16 v[152:155], a[160:163], a[140:143], v[152:155]
ds_write_b128 v236, v[224:227] offset:192
v_mfma_f32_16x16x32_bf16 v[156:159], a[164:167], a[136:139], v[156:159]
s_add_u32 s66, s66, 4096
s_waitcnt lgkmcnt(9)
v_mfma_f32_16x16x32_bf16 v[160:163], a[164:167], a[140:143], v[160:163]
s_waitcnt lgkmcnt(5)
buffer_store_dwordx4 v[68:71], v1, s[8:11], s66 offen offset:0 sc1
v_mfma_f32_16x16x16_bf16 v[148:151], a[168:169], v[212:213], v[148:151]
ds_read_b128 a[160:163], v208 offset:2048
ds_read_b128 a[164:167], v208 offset:20480
v_mfma_f32_16x16x16_bf16 v[152:155], a[168:169], v[214:215], v[152:155]
v_fma_f32 v88, v88, v203, -v205
v_fma_f32 v89, v89, v203, -v205
v_mfma_f32_16x16x16_bf16 v[156:159], a[172:173], v[212:213], v[156:159]
v_fma_f32 v90, v90, v203, -v205
v_fma_f32 v91, v91, v203, -v205
v_mfma_f32_16x16x16_bf16 v[160:163], a[172:173], v[214:215], v[160:163]
s_waitcnt lgkmcnt(5)
v_fma_f32 v96, v96, v203, -v205
v_fma_f32 v97, v97, v203, -v205
v_mfma_f32_16x16x32_bf16 v[164:167], a[144:147], a[0:3], 0
ds_read_b128 a[168:171], v208 offset:3072
ds_read_b128 a[172:175], v208 offset:21504
v_mfma_f32_16x16x32_bf16 v[168:171], a[144:147], a[4:7], 0
v_fma_f32 v98, v98, v203, -v205
v_fma_f32 v99, v99, v203, -v205
v_mfma_f32_16x16x32_bf16 v[172:175], a[148:151], a[0:3], 0
v_cvt_pk_bf16_f32 v228, v88, v89
v_cvt_pk_bf16_f32 v229, v90, v91
v_mfma_f32_16x16x32_bf16 v[176:179], a[148:151], a[4:7], 0
s_waitcnt lgkmcnt(5)
v_cvt_pk_bf16_f32 v230, v96, v97
v_cvt_pk_bf16_f32 v231, v98, v99
v_mfma_f32_16x16x32_bf16 v[164:167], a[152:155], a[8:11], v[164:167]
ds_read_b128 a[144:147], v208 offset:4096
ds_read_b128 a[148:151], v208 offset:22528
v_mfma_f32_16x16x32_bf16 v[168:171], a[152:155], a[12:15], v[168:171]
ds_write_b128 v236, v[228:231] offset:4800
v_mfma_f32_16x16x32_bf16 v[172:175], a[156:159], a[8:11], v[172:175]
ds_read_b64_tr_b16 v[84:85], v237 offset:192
ds_read_b64_tr_b16 v[86:87], v237 offset:1344
v_mfma_f32_16x16x32_bf16 v[176:179], a[156:159], a[12:15], v[176:179]
s_waitcnt lgkmcnt(7)
v_mfma_f32_16x16x32_bf16 v[164:167], a[160:163], a[16:19], v[164:167]
ds_read_b128 a[152:155], v208 offset:5120
ds_read_b128 a[156:159], v208 offset:23552
ds_read_b64_tr_b16 v[88:89], v237 offset:200
ds_read_b64_tr_b16 v[90:91], v237 offset:1352
buffer_store_dwordx4 v[72:75], v1, s[8:11], s66 offen offset:1024 sc1
v_mfma_f32_16x16x32_bf16 v[168:171], a[160:163], a[20:23], v[168:171]
v_fma_f32 v100, v100, v202, -v204
v_fma_f32 v101, v101, v202, -v204
v_mfma_f32_16x16x32_bf16 v[172:175], a[164:167], a[16:19], v[172:175]
v_fma_f32 v102, v102, v202, -v204
v_mfma_f32_16x16x32_bf16 v[176:179], a[164:167], a[20:23], v[176:179]
s_waitcnt lgkmcnt(9)
v_fma_f32 v103, v103, v202, -v204
v_fma_f32 v104, v104, v203, -v205
v_mfma_f32_16x16x32_bf16 v[164:167], a[168:171], a[24:27], v[164:167]
ds_read_b128 a[160:163], v208 offset:6144
ds_read_b128 a[164:167], v208 offset:24576
v_mfma_f32_16x16x32_bf16 v[168:171], a[168:171], a[28:31], v[168:171]
v_fma_f32 v105, v105, v203, -v205
v_fma_f32 v106, v106, v203, -v205
v_mfma_f32_16x16x32_bf16 v[172:175], a[172:175], a[24:27], v[172:175]
v_fma_f32 v107, v107, v203, -v205
v_cvt_pk_bf16_f32 v216, v100, v101
v_mfma_f32_16x16x32_bf16 v[176:179], a[172:175], a[28:31], v[176:179]
s_waitcnt lgkmcnt(9)
v_cvt_pk_bf16_f32 v217, v102, v103
v_mfma_f32_16x16x32_bf16 v[164:167], a[144:147], a[32:35], v[164:167]
ds_read_b128 a[168:171], v208 offset:7168
ds_read_b128 a[172:175], v208 offset:25600
v_mfma_f32_16x16x32_bf16 v[168:171], a[144:147], a[36:39], v[168:171]
v_cvt_pk_bf16_f32 v218, v104, v105
v_cvt_pk_bf16_f32 v219, v106, v107
v_mfma_f32_16x16x32_bf16 v[172:175], a[148:151], a[32:35], v[172:175]
ds_write_b64 v7, v[216:217] offset:256
v_mfma_f32_16x16x32_bf16 v[176:179], a[148:151], a[36:39], v[176:179]
s_waitcnt lgkmcnt(7)
v_mfma_f32_16x16x32_bf16 v[164:167], a[152:155], a[40:43], v[164:167]
ds_read_b128 a[144:147], v208 offset:8192
ds_read_b128 a[148:151], v208 offset:26624
v_mfma_f32_16x16x32_bf16 v[168:171], a[152:155], a[44:47], v[168:171]
ds_write_b64 v7, v[218:219] offset:4864
ds_read_b64_tr_b16 v[100:101], v238 offset:256
ds_read_b64_tr_b16 v[102:103], v238 offset:1408
buffer_store_dwordx4 v[84:87], v1, s[8:11], s66 offen offset:2048 sc1
v_mfma_f32_16x16x32_bf16 v[172:175], a[156:159], a[40:43], v[172:175]
v_mfma_f32_16x16x32_bf16 v[176:179], a[156:159], a[44:47], v[176:179]
s_waitcnt lgkmcnt(8)
v_mfma_f32_16x16x32_bf16 v[164:167], a[160:163], a[48:51], v[164:167]
ds_read_b128 a[152:155], v208 offset:9216
ds_read_b128 a[156:159], v208 offset:27648
v_mfma_f32_16x16x32_bf16 v[168:171], a[160:163], a[52:55], v[168:171]
v_mfma_f32_16x16x32_bf16 v[172:175], a[164:167], a[48:51], v[172:175]
v_mfma_f32_16x16x32_bf16 v[176:179], a[164:167], a[52:55], v[176:179]
s_waitcnt lgkmcnt(8)
v_mfma_f32_16x16x32_bf16 v[164:167], a[168:171], a[56:59], v[164:167]
ds_read_b128 a[160:163], v208 offset:10240
ds_read_b128 a[164:167], v208 offset:28672
v_mfma_f32_16x16x32_bf16 v[168:171], a[168:171], a[60:63], v[168:171]
v_mfma_f32_16x16x32_bf16 v[172:175], a[172:175], a[56:59], v[172:175]
v_mfma_f32_16x16x32_bf16 v[176:179], a[172:175], a[60:63], v[176:179]
s_waitcnt lgkmcnt(7)
v_mfma_f32_16x16x32_bf16 v[164:167], a[144:147], a[64:67], v[164:167]
ds_read_b128 a[168:171], v208 offset:11264
ds_read_b128 a[172:175], v208 offset:29696
v_mfma_f32_16x16x32_bf16 v[168:171], a[144:147], a[68:71], v[168:171]
v_mfma_f32_16x16x32_bf16 v[172:175], a[148:151], a[64:67], v[172:175]
buffer_store_dwordx4 v[88:91], v1, s[8:11], s66 offen offset:3072 sc1
v_mfma_f32_16x16x32_bf16 v[176:179], a[148:151], a[68:71], v[176:179]
s_waitcnt lgkmcnt(4)
v_mfma_f32_16x16x32_bf16 v[164:167], a[152:155], a[72:75], v[164:167]
ds_read_b128 a[144:147], v208 offset:12288
ds_read_b128 a[148:151], v208 offset:30720
v_mfma_f32_16x16x32_bf16 v[168:171], a[152:155], a[76:79], v[168:171]
s_cmp_eq_u32 s25, 1
s_cselect_b32 s98, 4096, 0
v_mfma_f32_16x16x32_bf16 v[172:175], a[156:159], a[72:75], v[172:175]
s_add_u32 s52, s52, s98
v_mfma_f32_16x16x32_bf16 v[176:179], a[156:159], a[76:79], v[176:179]
s_waitcnt lgkmcnt(4)
v_mfma_f32_16x16x32_bf16 v[164:167], a[160:163], a[80:83], v[164:167]
ds_read_b128 a[152:155], v208 offset:13312
ds_read_b128 a[156:159], v208 offset:31744
v_mfma_f32_16x16x32_bf16 v[168:171], a[160:163], a[84:87], v[168:171]
s_add_u32 s52, s52, 4096
v_mfma_f32_16x16x32_bf16 v[172:175], a[164:167], a[80:83], v[172:175]
v_mfma_f32_16x16x32_bf16 v[176:179], a[164:167], a[84:87], v[176:179]
s_waitcnt lgkmcnt(4)
v_mfma_f32_16x16x32_bf16 v[164:167], a[168:171], a[88:91], v[164:167]
ds_read_b128 a[160:163], v208 offset:14336
ds_read_b128 a[164:167], v208 offset:32768
v_mfma_f32_16x16x32_bf16 v[168:171], a[168:171], a[92:95], v[168:171]
v_mfma_f32_16x16x32_bf16 v[172:175], a[172:175], a[88:91], v[172:175]
s_add_u32 s66, s66, 4096
v_mfma_f32_16x16x32_bf16 v[176:179], a[172:175], a[92:95], v[176:179]
s_waitcnt lgkmcnt(4)
buffer_store_dwordx4 v[100:103], v1, s[8:11], s66 offen offset:0 sc1
v_mfma_f32_16x16x32_bf16 v[164:167], a[144:147], a[96:99], v[164:167]
ds_read_b128 a[168:171], v208 offset:15360
ds_read_b128 a[172:175], v208 offset:33792
v_mfma_f32_16x16x32_bf16 v[168:171], a[144:147], a[100:103], v[168:171]
v_mfma_f32_16x16x32_bf16 v[172:175], a[148:151], a[96:99], v[172:175]
v_mfma_f32_16x16x32_bf16 v[176:179], a[148:151], a[100:103], v[176:179]
s_waitcnt lgkmcnt(4)
v_mfma_f32_16x16x32_bf16 v[164:167], a[152:155], a[104:107], v[164:167]
ds_read_b128 a[144:147], v208 offset:16384
ds_read_b128 a[148:151], v208 offset:34816
v_mfma_f32_16x16x32_bf16 v[168:171], a[152:155], a[108:111], v[168:171]
v_mfma_f32_16x16x32_bf16 v[172:175], a[156:159], a[104:107], v[172:175]
v_mfma_f32_16x16x32_bf16 v[176:179], a[156:159], a[108:111], v[176:179]
s_waitcnt lgkmcnt(4)
v_mfma_f32_16x16x32_bf16 v[164:167], a[160:163], a[112:115], v[164:167]
ds_read_b128 a[152:155], v208 offset:17408
ds_read_b128 a[156:159], v208 offset:35840
v_mfma_f32_16x16x32_bf16 v[168:171], a[160:163], a[116:119], v[168:171]
buffer_load_dwordx4 a[240:243], v1, s[4:7], s52 offen offset:0 sc1
buffer_load_dwordx4 a[244:247], v9, s[4:7], s52 offen offset:0 sc1
v_mfma_f32_16x16x32_bf16 v[172:175], a[164:167], a[112:115], v[172:175]
v_mfma_f32_16x16x32_bf16 v[176:179], a[164:167], a[116:119], v[176:179]
s_waitcnt lgkmcnt(4)
v_add_u32 v181, 160768, v239
v_mfma_f32_16x16x32_bf16 v[164:167], a[168:171], a[120:123], v[164:167]
ds_read_b64 a[160:161], v181 offset:0
ds_read_b64 a[164:165], v181 offset:512
v_mfma_f32_16x16x32_bf16 v[168:171], a[168:171], a[124:127], v[168:171]
v_mfma_f32_16x16x32_bf16 v[172:175], a[172:175], a[120:123], v[172:175]
v_mfma_f32_16x16x32_bf16 v[176:179], a[172:175], a[124:127], v[176:179]
s_waitcnt lgkmcnt(4)
v_mfma_f32_16x16x32_bf16 v[164:167], a[144:147], a[128:131], v[164:167]
v_mfma_f32_16x16x32_bf16 v[168:171], a[144:147], a[132:135], v[168:171]
v_mfma_f32_16x16x32_bf16 v[172:175], a[148:151], a[128:131], v[172:175]
buffer_load_dwordx4 a[248:251], v1, s[4:7], s52 offen offset:1024 sc1
buffer_load_dwordx4 a[252:255], v9, s[4:7], s52 offen offset:1024 sc1
v_mfma_f32_16x16x32_bf16 v[176:179], a[148:151], a[132:135], v[176:179]
s_waitcnt lgkmcnt(2)
v_mfma_f32_16x16x32_bf16 v[164:167], a[152:155], a[136:139], v[164:167]
v_mfma_f32_16x16x32_bf16 v[168:171], a[152:155], a[140:143], v[168:171]
v_mfma_f32_16x16x32_bf16 v[172:175], a[156:159], a[136:139], v[172:175]
v_mfma_f32_16x16x32_bf16 v[176:179], a[156:159], a[140:143], v[176:179]
s_waitcnt lgkmcnt(0)
v_mfma_f32_16x16x16_bf16 v[164:167], a[160:161], v[212:213], v[164:167]
v_mfma_f32_16x16x16_bf16 v[168:171], a[160:161], v[214:215], v[168:171]
v_mfma_f32_16x16x16_bf16 v[172:175], a[164:165], v[212:213], v[172:175]
v_mfma_f32_16x16x16_bf16 v[176:179], a[164:165], v[214:215], v[176:179]
L_c4:
v_add_u32 v180, 0, v1
v_lshlrev_b32 v184, 16, v0
v_lshlrev_b32 v185, 16, v0
v_lshlrev_b32 v186, 16, v0
v_lshlrev_b32 v187, 16, v0
v_lshlrev_b32 v188, 16, v249
v_lshlrev_b32 v189, 16, v249
v_lshlrev_b32 v190, 16, v249
v_lshlrev_b32 v191, 16, v249
s_waitcnt lgkmcnt(0)
ds_write_b128 v240, v[36:39] offset:0
ds_write_b128 v240, v[40:43] offset:1024
ds_write_b128 v240, v[52:55] offset:2048
ds_write_b128 v240, v[56:59] offset:3072
s_cmp_eq_u32 s24, 0
s_cselect_b32 s67, 0, 1073741824
s_add_u32 s67, s67, 26542080
s_waitcnt vmcnt(4)
s_barrier
s_mov_b64 exec, 0xffff
buffer_atomic_add v4, v233, s[8:11], s67 offen sc1
s_mov_b64 exec, -1
v_add_u32 v200, 53248, v1
v_add_u32 v201, 90112, v1
v_add_u32 v202, 126976, v1
s_lshl_b32 s35, s80, 7
s_add_u32 s35, s35, 26542080
s_cmp_eq_u32 s24, 1
s_cselect_b32 s35, s35, 1073741824
v_mov_b32 v6, 0
v_mov_b32 v244, 0
v_mov_b32 v245, 0
v_mov_b32 v246, 0
buffer_load_dwordx4 a[80:83], v1, s[4:7], s52 offen offset:2048 sc1
buffer_load_dwordx4 a[84:87], v9, s[4:7], s52 offen offset:2048 sc1
ds_write_b128 v240, v[68:71] offset:4096
ds_write_b128 v240, v[72:75] offset:5120
ds_write_b128 v240, v[84:87] offset:6144
ds_write_b128 v240, v[88:91] offset:7168
ds_write_b128 v240, v[100:103] offset:8192
v_pk_mul_f32 v[192:193], v[108:109], v[108:109]
v_pk_mul_f32 v[194:195], v[110:111], v[110:111]
v_pk_mul_f32 v[196:197], v[112:113], v[112:113]
v_pk_mul_f32 v[198:199], v[114:115], v[114:115]
v_pk_fma_f32 v[192:193], v[192:193], v[252:253], v[250:251] op_sel:[0,0,0] op_sel_hi:[1,0,0]
v_pk_fma_f32 v[194:195], v[194:195], v[252:253], v[250:251] op_sel:[0,0,0] op_sel_hi:[1,0,0]
v_pk_fma_f32 v[196:197], v[196:197], v[252:253], v[250:251] op_sel:[0,1,1] op_sel_hi:[1,1,1]
v_pk_fma_f32 v[198:199], v[198:199], v[252:253], v[250:251] op_sel:[0,1,1] op_sel_hi:[1,1,1]
v_pk_mul_f32 v[192:193], v[192:193], v[108:109]
buffer_load_dwordx4 a[88:91], v1, s[4:7], s52 offen offset:3072 sc1
buffer_load_dwordx4 a[92:95], v9, s[4:7], s52 offen offset:3072 sc1
v_pk_mul_f32 v[194:195], v[194:195], v[110:111]
v_pk_mul_f32 v[196:197], v[196:197], v[112:113]
v_pk_mul_f32 v[198:199], v[198:199], v[114:115]
v_exp_f32 v192, v192
v_exp_f32 v193, v193
v_exp_f32 v194, v194
v_exp_f32 v195, v195
v_exp_f32 v196, v196
v_exp_f32 v197, v197
v_exp_f32 v198, v198
v_exp_f32 v199, v199
v_pk_fma_f32 v[192:193], v[192:193], v[254:255], v[254:255] op_sel:[0,0,0] op_sel_hi:[1,0,0]
v_pk_fma_f32 v[194:195], v[194:195], v[254:255], v[254:255] op_sel:[0,0,0] op_sel_hi:[1,0,0]
v_pk_fma_f32 v[196:197], v[196:197], v[254:255], v[254:255] op_sel:[0,1,1] op_sel_hi:[1,1,1]
s_cmp_eq_u32 s25, 2
s_cselect_b32 s98, 4096, 0
s_add_u32 s52, s52, s98
s_add_u32 s52, s52, 4096
buffer_load_dwordx4 a[96:99], v1, s[4:7], s52 offen offset:0 sc1
s_mov_b64 exec, 1
buffer_atomic_add v244, v6, s[8:11], s35 offen sc0 sc1
s_mov_b64 exec, -1
buffer_load_dwordx4 a[100:103], v9, s[4:7], s52 offen offset:0 sc1
v_pk_fma_f32 v[198:199], v[198:199], v[254:255], v[254:255] op_sel:[0,1,1] op_sel_hi:[1,1,1]
v_rcp_f32 v192, v192
v_rcp_f32 v193, v193
v_rcp_f32 v194, v194
v_rcp_f32 v195, v195
v_rcp_f32 v196, v196
v_rcp_f32 v197, v197
v_rcp_f32 v198, v198
v_rcp_f32 v199, v199
v_pk_mul_f32 v[108:109], v[108:109], v[192:193]
v_pk_mul_f32 v[110:111], v[110:111], v[194:195]
v_pk_mul_f32 v[112:113], v[112:113], v[196:197]
v_pk_mul_f32 v[114:115], v[114:115], v[198:199]
v_pk_mul_f32 v[192:193], v[116:117], v[116:117]
buffer_load_dwordx4 a[104:107], v1, s[4:7], s52 offen offset:1024 sc1
buffer_load_dwordx4 a[108:111], v9, s[4:7], s52 offen offset:1024 sc1
v_pk_mul_f32 v[194:195], v[118:119], v[118:119]
v_pk_mul_f32 v[196:197], v[120:121], v[120:121]
v_pk_mul_f32 v[198:199], v[122:123], v[122:123]
v_pk_fma_f32 v[192:193], v[192:193], v[252:253], v[250:251] op_sel:[0,0,0] op_sel_hi:[1,0,0]
v_pk_fma_f32 v[194:195], v[194:195], v[252:253], v[250:251] op_sel:[0,0,0] op_sel_hi:[1,0,0]
v_pk_fma_f32 v[196:197], v[196:197], v[252:253], v[250:251] op_sel:[0,1,1] op_sel_hi:[1,1,1]
v_pk_fma_f32 v[198:199], v[198:199], v[252:253], v[250:251] op_sel:[0,1,1] op_sel_hi:[1,1,1]
v_pk_mul_f32 v[192:193], v[192:193], v[116:117]
v_pk_mul_f32 v[194:195], v[194:195], v[118:119]
v_pk_mul_f32 v[196:197], v[196:197], v[120:121]
v_pk_mul_f32 v[198:199], v[198:199], v[122:123]
v_exp_f32 v192, v192
v_exp_f32 v193, v193
v_exp_f32 v194, v194
buffer_load_dwordx4 a[112:115], v1, s[4:7], s52 offen offset:2048 sc1
s_mov_b64 exec, 1
buffer_atomic_add v245, v6, s[8:11], s35 offen sc0 sc1
s_mov_b64 exec, -1
buffer_load_dwordx4 a[116:119], v9, s[4:7], s52 offen offset:2048 sc1
v_exp_f32 v195, v195
v_exp_f32 v196, v196
v_exp_f32 v197, v197
v_exp_f32 v198, v198
v_exp_f32 v199, v199
v_pk_fma_f32 v[192:193], v[192:193], v[254:255], v[254:255] op_sel:[0,0,0] op_sel_hi:[1,0,0]
v_pk_fma_f32 v[194:195], v[194:195], v[254:255], v[254:255] op_sel:[0,0,0] op_sel_hi:[1,0,0]
v_pk_fma_f32 v[196:197], v[196:197], v[254:255], v[254:255] op_sel:[0,1,1] op_sel_hi:[1,1,1]
v_pk_fma_f32 v[198:199], v[198:199], v[254:255], v[254:255] op_sel:[0,1,1] op_sel_hi:[1,1,1]
v_rcp_f32 v192, v192
v_rcp_f32 v193, v193
v_rcp_f32 v194, v194
v_rcp_f32 v195, v195
v_rcp_f32 v196, v196
buffer_load_dwordx4 a[120:123], v1, s[4:7], s52 offen offset:3072 sc1
buffer_load_dwordx4 a[124:127], v9, s[4:7], s52 offen offset:3072 sc1
v_rcp_f32 v197, v197
v_rcp_f32 v198, v198
v_rcp_f32 v199, v199
v_pk_mul_f32 v[116:117], v[116:117], v[192:193]
v_pk_mul_f32 v[118:119], v[118:119], v[194:195]
v_pk_mul_f32 v[120:121], v[120:121], v[196:197]
v_pk_mul_f32 v[122:123], v[122:123], v[198:199]
v_pk_mul_f32 v[192:193], v[124:125], v[124:125]
v_pk_mul_f32 v[194:195], v[126:127], v[126:127]
v_pk_mul_f32 v[196:197], v[128:129], v[128:129]
v_pk_mul_f32 v[198:199], v[130:131], v[130:131]
v_pk_fma_f32 v[192:193], v[192:193], v[252:253], v[250:251] op_sel:[0,0,0] op_sel_hi:[1,0,0]
v_pk_fma_f32 v[194:195], v[194:195], v[252:253], v[250:251] op_sel:[0,0,0] op_sel_hi:[1,0,0]
v_pk_fma_f32 v[196:197], v[196:197], v[252:253], v[250:251] op_sel:[0,1,1] op_sel_hi:[1,1,1]
s_cmp_eq_u32 s25, 3
s_cselect_b32 s98, 4096, 0
s_add_u32 s52, s52, s98
s_add_u32 s52, s52, 4096
buffer_load_dwordx4 a[128:131], v1, s[4:7], s52 offen offset:0 sc1
s_mov_b64 exec, 1
buffer_atomic_add v246, v6, s[8:11], s35 offen sc0 sc1
s_mov_b64 exec, -1
buffer_load_dwordx4 a[132:135], v9, s[4:7], s52 offen offset:0 sc1
v_pk_fma_f32 v[198:199], v[198:199], v[252:253], v[250:251] op_sel:[0,1,1] op_sel_hi:[1,1,1]
v_pk_mul_f32 v[192:193], v[192:193], v[124:125]
v_pk_mul_f32 v[194:195], v[194:195], v[126:127]
v_pk_mul_f32 v[196:197], v[196:197], v[128:129]
v_pk_mul_f32 v[198:199], v[198:199], v[130:131]
v_exp_f32 v192, v192
v_exp_f32 v193, v193
v_exp_f32 v194, v194
v_exp_f32 v195, v195
v_exp_f32 v196, v196
v_exp_f32 v197, v197
v_exp_f32 v198, v198
v_exp_f32 v199, v199
v_pk_fma_f32 v[192:193], v[192:193], v[254:255], v[254:255] op_sel:[0,0,0] op_sel_hi:[1,0,0]
buffer_load_dwordx4 a[136:139], v1, s[4:7], s52 offen offset:1024 sc1
buffer_load_dwordx4 a[140:143], v9, s[4:7], s52 offen offset:1024 sc1
v_pk_fma_f32 v[194:195], v[194:195], v[254:255], v[254:255] op_sel:[0,0,0] op_sel_hi:[1,0,0]
v_pk_fma_f32 v[196:197], v[196:197], v[254:255], v[254:255] op_sel:[0,1,1] op_sel_hi:[1,1,1]
v_pk_fma_f32 v[198:199], v[198:199], v[254:255], v[254:255] op_sel:[0,1,1] op_sel_hi:[1,1,1]
v_rcp_f32 v192, v192
v_rcp_f32 v193, v193
v_rcp_f32 v194, v194
v_rcp_f32 v195, v195
v_rcp_f32 v196, v196
v_rcp_f32 v197, v197
v_rcp_f32 v198, v198
v_rcp_f32 v199, v199
v_pk_mul_f32 v[124:125], v[124:125], v[192:193]
v_pk_mul_f32 v[126:127], v[126:127], v[194:195]
v_pk_mul_f32 v[128:129], v[128:129], v[196:197]
v_pk_mul_f32 v[130:131], v[130:131], v[198:199]
s_mul_i32 s30, s26, 589824
s_add_u32 s30, s30, 7340032
s_lshl_b32 s62, s24, 12
s_lshl_b32 s63, s24, 10
s_add_u32 s60, s30, s62
s_add_u32 s61, s30, s63
s_add_u32 s61, s61, 16384
s_cmp_eq_u32 s25, 0
s_cselect_b32 s99, 36864, 0
s_add_u32 s60, s60, s99
s_add_u32 s61, s61, s99
s_add_u32 m0, s62, 53248
s_add_u32 s60, s60, 0
s_waitcnt lgkmcnt(0)
s_cmp_eq_u32 s24, 1
s_cbranch_scc0 L_other_28
s_mov_b32 s31, 0
s_mov_b64 exec, 1
v_mov_b32 v247, 0
buffer_atomic_add v247, v6, s[8:11], s35 offen sc0 sc1
s_waitcnt vmcnt(14)
v_cmp_gt_u32 vcc, 16, v244
s_nop 0
s_cbranch_vccz L_polled_27
s_waitcnt vmcnt(9)
v_cmp_gt_u32 vcc, 16, v245
s_nop 0
s_cbranch_vccz L_polled_27
v_mov_b32 v244, 0
buffer_atomic_add v244, v6, s[8:11], s35 offen sc0 sc1
s_waitcnt vmcnt(5)
v_cmp_gt_u32 vcc, 16, v246
s_nop 0
s_cbranch_vccz L_polled_27
v_mov_b32 v245, 0
buffer_atomic_add v245, v6, s[8:11], s35 offen sc0 sc1
L_poll_26:
s_add_u32 s31, s31, 1
s_cmp_gt_u32 s31, 100000
s_cbranch_scc1 L_polled_27
v_mov_b32 v246, 0
buffer_atomic_add v246, v6, s[8:11], s35 offen sc0 sc1
s_waitcnt vmcnt(3)
v_cmp_gt_u32 vcc, 16, v247
s_nop 0
s_cbranch_vccz L_polled_27
v_mov_b32 v247, 0
buffer_atomic_add v247, v6, s[8:11], s35 offen sc0 sc1
s_waitcnt vmcnt(3)
v_cmp_gt_u32 vcc, 16, v244
s_nop 0
s_cbranch_vccz L_polled_27
v_mov_b32 v244, 0
buffer_atomic_add v244, v6, s[8:11], s35 offen sc0 sc1
s_waitcnt vmcnt(3)
v_cmp_gt_u32 vcc, 16, v245
s_nop 0
s_cbranch_vccz L_polled_27
v_mov_b32 v245, 0
buffer_atomic_add v245, v6, s[8:11], s35 offen sc0 sc1
s_waitcnt vmcnt(3)
v_cmp_gt_u32 vcc, 16, v246
s_nop 0
s_cbranch_vccz L_polled_27
s_branch L_poll_26
L_polled_27:
s_mov_b64 exec, -1
L_other_28:
s_barrier
buffer_load_dwordx4 v1, s[8:11], s60 offen offset:0 sc1 lds
buffer_load_dwordx4 v1, s[8:11], s60 offen offset:1024 sc1 lds
ds_read_b128 a[0:3], v180 offset:0
ds_read_b128 a[4:7], v180 offset:1024
ds_read_b128 a[8:11], v180 offset:2048
ds_read_b128 a[12:15], v180 offset:3072
ds_read_b128 a[16:19], v180 offset:4096
ds_read_b128 a[20:23], v180 offset:5120
ds_read_b128 a[24:27], v180 offset:6144
ds_read_b128 a[28:31], v180 offset:7168
ds_read_b128 a[32:35], v180 offset:8192
buffer_load_dwordx4 v1, s[8:11], s60 offen offset:2048 sc1 lds
buffer_load_dwordx4 v1, s[8:11], s60 offen offset:3072 sc1 lds
s_add_u32 m0, s63, 69632
s_add_u32 s61, s61, 0
buffer_load_dwordx4 v1, s[8:11], s61 offen offset:0 sc1 lds
s_waitcnt lgkmcnt(0)
v_mfma_f32_16x16x32_bf16 v[36:39], a[0:3], a[176:179], v[184:187]
ds_read_b128 a[36:39], v180 offset:9216
s_add_u32 m0, s62, 73728
v_mfma_f32_16x16x32_bf16 v[40:43], a[0:3], a[180:183], v[188:191]
ds_read_b128 a[40:43], v180 offset:10240
v_mul_f32 v192, v132, v132
v_mfma_f32_16x16x32_bf16 v[44:47], a[4:7], a[176:179], v[184:187]
ds_read_b128 a[44:47], v180 offset:11264
s_add_u32 s60, s60, 20480
v_mfma_f32_16x16x32_bf16 v[48:51], a[4:7], a[180:183], v[188:191]
ds_read_b128 a[48:51], v180 offset:12288
v_mul_f32 v193, v133, v133
v_mfma_f32_16x16x32_bf16 v[52:55], a[8:11], a[176:179], v[184:187]
ds_read_b128 a[52:55], v180 offset:13312
v_mul_f32 v194, v134, v134
v_mfma_f32_16x16x32_bf16 v[56:59], a[8:11], a[180:183], v[188:191]
ds_read_b128 a[56:59], v180 offset:14336
buffer_load_dwordx4 v1, s[8:11], s60 offen offset:0 sc1 lds
v_mfma_f32_16x16x32_bf16 v[60:63], a[12:15], a[176:179], v[184:187]
ds_read_b128 a[60:63], v180 offset:15360
v_mfma_f32_16x16x32_bf16 v[64:67], a[12:15], a[180:183], v[188:191]
ds_read_b128 a[64:67], v180 offset:16384
v_mul_f32 v195, v135, v135
v_mfma_f32_16x16x32_bf16 v[68:71], a[16:19], a[176:179], v[184:187]
ds_read_b128 a[68:71], v180 offset:17408
buffer_load_dwordx4 v1, s[8:11], s60 offen offset:1024 sc1 lds
v_mfma_f32_16x16x32_bf16 v[72:75], a[16:19], a[180:183], v[188:191]
v_fma_f32 v192, v192, v252, v250
v_mfma_f32_16x16x32_bf16 v[76:79], a[20:23], a[176:179], v[184:187]
v_mfma_f32_16x16x32_bf16 v[80:83], a[20:23], a[180:183], v[188:191]
buffer_load_dwordx4 v1, s[8:11], s60 offen offset:2048 sc1 lds
v_fma_f32 v193, v193, v252, v250
v_mfma_f32_16x16x32_bf16 v[84:87], a[24:27], a[176:179], v[184:187]
v_mfma_f32_16x16x32_bf16 v[88:91], a[24:27], a[180:183], v[188:191]
v_mfma_f32_16x16x32_bf16 v[92:95], a[28:31], a[176:179], v[184:187]
buffer_load_dwordx4 v1, s[8:11], s60 offen offset:3072 sc1 lds
v_fma_f32 v194, v194, v252, v250
v_mfma_f32_16x16x32_bf16 v[96:99], a[28:31], a[180:183], v[188:191]
v_mfma_f32_16x16x32_bf16 v[100:103], a[32:35], a[176:179], v[184:187]
v_fma_f32 v195, v195, v252, v250
v_mfma_f32_16x16x32_bf16 v[104:107], a[32:35], a[180:183], v[188:191]
s_waitcnt lgkmcnt(0)
v_mfma_f32_16x16x32_bf16 v[36:39], a[36:39], a[184:187], v[36:39]
ds_read_b128 a[0:3], v180 offset:18432
v_mul_f32 v192, v192, v132
v_mfma_f32_16x16x32_bf16 v[40:43], a[36:39], a[188:191], v[40:43]
ds_read_b128 a[4:7], v180 offset:19456
v_mfma_f32_16x16x32_bf16 v[44:47], a[40:43], a[184:187], v[44:47]
ds_read_b128 a[8:11], v180 offset:20480
v_mfma_f32_16x16x32_bf16 v[48:51], a[40:43], a[188:191], v[48:51]
ds_read_b128 a[12:15], v180 offset:21504
v_mul_f32 v193, v193, v133
v_mfma_f32_16x16x32_bf16 v[52:55], a[44:47], a[184:187], v[52:55]
ds_read_b128 a[16:19], v180 offset:22528
v_mfma_f32_16x16x32_bf16 v[56:59], a[44:47], a[188:191], v[56:59]
ds_read_b128 a[20:23], v180 offset:23552
v_mul_f32 v194, v194, v134
v_mfma_f32_16x16x32_bf16 v[60:63], a[48:51], a[184:187], v[60:63]
ds_read_b128 a[24:27], v180 offset:24576
v_mfma_f32_16x16x32_bf16 v[64:67], a[48:51], a[188:191], v[64:67]
ds_read_b128 a[28:31], v180 offset:25600
v_mul_f32 v195, v195, v135
v_mfma_f32_16x16x32_bf16 v[68:71], a[52:55], a[184:187], v[68:71]
ds_read_b128 a[32:35], v180 offset:26624
v_mfma_f32_16x16x32_bf16 v[72:75], a[52:55], a[188:191], v[72:75]
s_cmp_eq_u32 s25, 1
s_cselect_b32 s99, 36864, 0
s_add_u32 s60, s60, s99
v_mfma_f32_16x16x32_bf16 v[76:79], a[56:59], a[184:187], v[76:79]
s_add_u32 s61, s61, s99
s_add_u32 m0, s62, 90112
s_add_u32 s60, s60, 16384
v_mfma_f32_16x16x32_bf16 v[80:83], a[56:59], a[188:191], v[80:83]
buffer_load_dwordx4 v1, s[8:11], s60 offen offset:0 sc1 lds
v_mfma_f32_16x16x32_bf16 v[84:87], a[60:63], a[184:187], v[84:87]
buffer_load_dwordx4 v1, s[8:11], s60 offen offset:1024 sc1 lds
v_mfma_f32_16x16x32_bf16 v[88:91], a[60:63], a[188:191], v[88:91]
buffer_load_dwordx4 v1, s[8:11], s60 offen offset:2048 sc1 lds
v_mfma_f32_16x16x32_bf16 v[92:95], a[64:67], a[184:187], v[92:95]
v_exp_f32 v192, v192
v_mfma_f32_16x16x32_bf16 v[96:99], a[64:67], a[188:191], v[96:99]
buffer_load_dwordx4 v1, s[8:11], s60 offen offset:3072 sc1 lds
v_mfma_f32_16x16x32_bf16 v[100:103], a[68:71], a[184:187], v[100:103]
v_exp_f32 v193, v193
v_mfma_f32_16x16x32_bf16 v[104:107], a[68:71], a[188:191], v[104:107]
s_waitcnt lgkmcnt(0)
v_mfma_f32_16x16x32_bf16 v[36:39], a[0:3], a[192:195], v[36:39]
ds_read_b128 a[36:39], v180 offset:27648
s_add_u32 m0, s63, 106496
v_mfma_f32_16x16x32_bf16 v[40:43], a[0:3], a[196:199], v[40:43]
ds_read_b128 a[40:43], v180 offset:28672
v_mfma_f32_16x16x32_bf16 v[44:47], a[4:7], a[192:195], v[44:47]
ds_read_b128 a[44:47], v180 offset:29696
s_add_u32 s61, s61, 36864
v_mfma_f32_16x16x32_bf16 v[48:51], a[4:7], a[196:199], v[48:51]
ds_read_b128 a[48:51], v180 offset:30720
v_mfma_f32_16x16x32_bf16 v[52:55], a[8:11], a[192:195], v[52:55]
ds_read_b128 a[52:55], v180 offset:31744
buffer_load_dwordx4 v1, s[8:11], s61 offen offset:0 sc1 lds
v_mfma_f32_16x16x32_bf16 v[56:59], a[8:11], a[196:199], v[56:59]
ds_read_b128 a[56:59], v180 offset:32768
v_mfma_f32_16x16x32_bf16 v[60:63], a[12:15], a[192:195], v[60:63]
ds_read_b128 a[60:63], v180 offset:33792
s_add_u32 m0, s62, 110592
v_mfma_f32_16x16x32_bf16 v[64:67], a[12:15], a[196:199], v[64:67]
ds_read_b128 a[64:67], v180 offset:34816
v_mfma_f32_16x16x32_bf16 v[68:71], a[16:19], a[192:195], v[68:71]
ds_read_b128 a[68:71], v180 offset:35840
s_add_u32 s60, s60, 20480
v_mfma_f32_16x16x32_bf16 v[72:75], a[16:19], a[196:199], v[72:75]
v_exp_f32 v194, v194
v_mfma_f32_16x16x32_bf16 v[76:79], a[20:23], a[192:195], v[76:79]
buffer_load_dwordx4 v1, s[8:11], s60 offen offset:0 sc1 lds
v_mfma_f32_16x16x32_bf16 v[80:83], a[20:23], a[196:199], v[80:83]
v_exp_f32 v195, v195
v_mfma_f32_16x16x32_bf16 v[84:87], a[24:27], a[192:195], v[84:87]
buffer_load_dwordx4 v1, s[8:11], s60 offen offset:1024 sc1 lds
v_fma_f32 v192, v192, v254, v254
v_mfma_f32_16x16x32_bf16 v[88:91], a[24:27], a[196:199], v[88:91]
v_fma_f32 v193, v193, v254, v254
v_mfma_f32_16x16x32_bf16 v[92:95], a[28:31], a[192:195], v[92:95]
buffer_load_dwordx4 v1, s[8:11], s60 offen offset:2048 sc1 lds
v_mfma_f32_16x16x32_bf16 v[96:99], a[28:31], a[196:199], v[96:99]
v_fma_f32 v194, v194, v254, v254
v_mfma_f32_16x16x32_bf16 v[100:103], a[32:35], a[192:195], v[100:103]
v_mfma_f32_16x16x32_bf16 v[104:107], a[32:35], a[196:199], v[104:107]
s_waitcnt vmcnt(12) lgkmcnt(0)
s_barrier
v_mfma_f32_16x16x32_bf16 v[36:39], a[36:39], a[200:203], v[36:39]
ds_read_b128 a[0:3], v200 offset:0
buffer_load_dwordx4 v1, s[8:11], s60 offen offset:3072 sc1 lds
v_mfma_f32_16x16x32_bf16 v[40:43], a[36:39], a[204:207], v[40:43]
ds_read_b128 a[4:7], v200 offset:1024
v_fma_f32 v195, v195, v254, v254
v_mfma_f32_16x16x32_bf16 v[44:47], a[40:43], a[200:203], v[44:47]
ds_read_b128 a[8:11], v200 offset:2048
v_mfma_f32_16x16x32_bf16 v[48:51], a[40:43], a[204:207], v[48:51]
ds_read_b128 a[12:15], v200 offset:3072
v_mfma_f32_16x16x32_bf16 v[52:55], a[44:47], a[200:203], v[52:55]
ds_read_b128 a[16:19], v200 offset:4096
v_mfma_f32_16x16x32_bf16 v[56:59], a[44:47], a[204:207], v[56:59]
ds_read_b128 a[20:23], v200 offset:5120
v_mfma_f32_16x16x32_bf16 v[60:63], a[48:51], a[200:203], v[60:63]
ds_read_b128 a[24:27], v200 offset:6144
v_mfma_f32_16x16x32_bf16 v[64:67], a[48:51], a[204:207], v[64:67]
ds_read_b128 a[28:31], v200 offset:7168
v_mfma_f32_16x16x32_bf16 v[68:71], a[52:55], a[200:203], v[68:71]
ds_read_b128 a[32:35], v200 offset:8192
v_mfma_f32_16x16x32_bf16 v[72:75], a[52:55], a[204:207], v[72:75]
s_cmp_eq_u32 s25, 2
s_cselect_b32 s99, 36864, 0
s_add_u32 s60, s60, s99
v_mfma_f32_16x16x32_bf16 v[76:79], a[56:59], a[200:203], v[76:79]
s_add_u32 s61, s61, s99
s_add_u32 m0, s62, 126976
s_add_u32 s60, s60, 16384
v_mfma_f32_16x16x32_bf16 v[80:83], a[56:59], a[204:207], v[80:83]
buffer_load_dwordx4 v1, s[8:11], s60 offen offset:0 sc1 lds
v_mfma_f32_16x16x32_bf16 v[84:87], a[60:63], a[200:203], v[84:87]
v_rcp_f32 v192, v192
v_mfma_f32_16x16x32_bf16 v[88:91], a[60:63], a[204:207], v[88:91]
buffer_load_dwordx4 v1, s[8:11], s60 offen offset:1024 sc1 lds
v_mfma_f32_16x16x32_bf16 v[92:95], a[64:67], a[200:203], v[92:95]
v_rcp_f32 v193, v193
v_mfma_f32_16x16x32_bf16 v[96:99], a[64:67], a[204:207], v[96:99]
buffer_load_dwordx4 v1, s[8:11], s60 offen offset:2048 sc1 lds
v_mfma_f32_16x16x32_bf16 v[100:103], a[68:71], a[200:203], v[100:103]
v_rcp_f32 v194, v194
v_mfma_f32_16x16x32_bf16 v[104:107], a[68:71], a[204:207], v[104:107]
s_waitcnt lgkmcnt(0)
v_mfma_f32_16x16x32_bf16 v[36:39], a[0:3], a[208:211], v[36:39]
ds_read_b128 a[36:39], v200 offset:9216
buffer_load_dwordx4 v1, s[8:11], s60 offen offset:3072 sc1 lds
v_mfma_f32_16x16x32_bf16 v[40:43], a[0:3], a[212:215], v[40:43]
ds_read_b128 a[40:43], v200 offset:10240
v_mfma_f32_16x16x32_bf16 v[44:47], a[4:7], a[208:211], v[44:47]
ds_read_b128 a[44:47], v200 offset:11264
s_add_u32 m0, s63, 143360
v_mfma_f32_16x16x32_bf16 v[48:51], a[4:7], a[212:215], v[48:51]
ds_read_b128 a[48:51], v200 offset:12288
v_mfma_f32_16x16x32_bf16 v[52:55], a[8:11], a[208:211], v[52:55]
ds_read_b128 a[52:55], v200 offset:13312
s_add_u32 s61, s61, 36864
v_mfma_f32_16x16x32_bf16 v[56:59], a[8:11], a[212:215], v[56:59]
ds_read_b128 a[56:59], v200 offset:14336
v_mfma_f32_16x16x32_bf16 v[60:63], a[12:15], a[208:211], v[60:63]
ds_read_b128 a[60:63], v200 offset:15360
buffer_load_dwordx4 v1, s[8:11], s61 offen offset:0 sc1 lds
v_mfma_f32_16x16x32_bf16 v[64:67], a[12:15], a[212:215], v[64:67]
ds_read_b128 a[64:67], v200 offset:16384
v_mfma_f32_16x16x32_bf16 v[68:71], a[16:19], a[208:211], v[68:71]
ds_read_b128 a[68:71], v200 offset:17408
s_add_u32 m0, s62, 147456
v_mfma_f32_16x16x32_bf16 v[72:75], a[16:19], a[212:215], v[72:75]
s_add_u32 s60, s60, 20480
v_rcp_f32 v195, v195
v_mfma_f32_16x16x32_bf16 v[76:79], a[20:23], a[208:211], v[76:79]
v_mul_f32 v132, v132, v192
v_mul_f32 v133, v133, v193
v_mfma_f32_16x16x32_bf16 v[80:83], a[20:23], a[212:215], v[80:83]
v_mul_f32 v134, v134, v194
v_mul_f32 v135, v135, v195
v_mfma_f32_16x16x32_bf16 v[84:87], a[24:27], a[208:211], v[84:87]
buffer_load_dwordx4 v1, s[8:11], s60 offen offset:0 sc1 lds
v_mul_f32 v196, v136, v136
v_mfma_f32_16x16x32_bf16 v[88:91], a[24:27], a[212:215], v[88:91]
v_mfma_f32_16x16x32_bf16 v[92:95], a[28:31], a[208:211], v[92:95]
buffer_load_dwordx4 v1, s[8:11], s60 offen offset:1024 sc1 lds
v_mfma_f32_16x16x32_bf16 v[96:99], a[28:31], a[212:215], v[96:99]
v_mul_f32 v197, v137, v137
v_mfma_f32_16x16x32_bf16 v[100:103], a[32:35], a[208:211], v[100:103]
v_mfma_f32_16x16x32_bf16 v[104:107], a[32:35], a[212:215], v[104:107]
s_waitcnt vmcnt(16) lgkmcnt(0)
s_barrier
v_mfma_f32_16x16x32_bf16 v[36:39], a[36:39], a[216:219], v[36:39]
ds_read_b128 a[0:3], v200 offset:18432
buffer_load_dwordx4 v1, s[8:11], s60 offen offset:2048 sc1 lds
v_mfma_f32_16x16x32_bf16 v[40:43], a[36:39], a[220:223], v[40:43]
ds_read_b128 a[4:7], v200 offset:19456
v_mul_f32 v198, v138, v138
v_mfma_f32_16x16x32_bf16 v[44:47], a[40:43], a[216:219], v[44:47]
ds_read_b128 a[8:11], v200 offset:20480
v_mul_f32 v199, v139, v139
v_mfma_f32_16x16x32_bf16 v[48:51], a[40:43], a[220:223], v[48:51]
ds_read_b128 a[12:15], v200 offset:21504
v_mfma_f32_16x16x32_bf16 v[52:55], a[44:47], a[216:219], v[52:55]
ds_read_b128 a[16:19], v200 offset:22528
buffer_load_dwordx4 v1, s[8:11], s60 offen offset:3072 sc1 lds
v_mfma_f32_16x16x32_bf16 v[56:59], a[44:47], a[220:223], v[56:59]
ds_read_b128 a[20:23], v200 offset:23552
v_fma_f32 v196, v196, v253, v251
v_mfma_f32_16x16x32_bf16 v[60:63], a[48:51], a[216:219], v[60:63]
ds_read_b128 a[24:27], v200 offset:24576
v_fma_f32 v197, v197, v253, v251
v_mfma_f32_16x16x32_bf16 v[64:67], a[48:51], a[220:223], v[64:67]
ds_read_b128 a[28:31], v200 offset:25600
v_mfma_f32_16x16x32_bf16 v[68:71], a[52:55], a[216:219], v[68:71]
ds_read_b128 a[32:35], v200 offset:26624
buffer_load_dwordx4 a[144:147], v1, s[4:7], s52 offen offset:2048 sc1
v_mfma_f32_16x16x32_bf16 v[72:75], a[52:55], a[220:223], v[72:75]
v_fma_f32 v198, v198, v253, v251
v_mfma_f32_16x16x32_bf16 v[76:79], a[56:59], a[216:219], v[76:79]
v_mfma_f32_16x16x32_bf16 v[80:83], a[56:59], a[220:223], v[80:83]
v_fma_f32 v199, v199, v253, v251
v_mfma_f32_16x16x32_bf16 v[84:87], a[60:63], a[216:219], v[84:87]
buffer_load_dwordx4 a[148:151], v9, s[4:7], s52 offen offset:2048 sc1
v_mfma_f32_16x16x32_bf16 v[88:91], a[60:63], a[220:223], v[88:91]
v_mul_f32 v196, v196, v136
v_mfma_f32_16x16x32_bf16 v[92:95], a[64:67], a[216:219], v[92:95]
v_mfma_f32_16x16x32_bf16 v[96:99], a[64:67], a[220:223], v[96:99]
v_mfma_f32_16x16x32_bf16 v[100:103], a[68:71], a[216:219], v[100:103]
v_mul_f32 v197, v197, v137
v_mfma_f32_16x16x32_bf16 v[104:107], a[68:71], a[220:223], v[104:107]
s_waitcnt lgkmcnt(0)
v_mfma_f32_16x16x32_bf16 v[36:39], a[0:3], a[224:227], v[36:39]
ds_read_b128 a[36:39], v200 offset:27648
buffer_load_dwordx4 a[152:155], v1, s[4:7], s52 offen offset:3072 sc1
v_mfma_f32_16x16x32_bf16 v[40:43], a[0:3], a[228:231], v[40:43]
ds_read_b128 a[40:43], v200 offset:28672
v_mul_f32 v198, v198, v138
v_mfma_f32_16x16x32_bf16 v[44:47], a[4:7], a[224:227], v[44:47]
ds_read_b128 a[44:47], v200 offset:29696
buffer_load_dwordx4 a[156:159], v9, s[4:7], s52 offen offset:3072 sc1
v_mfma_f32_16x16x32_bf16 v[48:51], a[4:7], a[228:231], v[48:51]
ds_read_b128 a[48:51], v200 offset:30720
v_mul_f32 v199, v199, v139
v_mfma_f32_16x16x32_bf16 v[52:55], a[8:11], a[224:227], v[52:55]
ds_read_b128 a[52:55], v200 offset:31744
v_mfma_f32_16x16x32_bf16 v[56:59], a[8:11], a[228:231], v[56:59]
ds_read_b128 a[56:59], v200 offset:32768
v_mfma_f32_16x16x32_bf16 v[60:63], a[12:15], a[224:227], v[60:63]
ds_read_b128 a[60:63], v200 offset:33792
v_mfma_f32_16x16x32_bf16 v[64:67], a[12:15], a[228:231], v[64:67]
ds_read_b128 a[64:67], v200 offset:34816
v_mfma_f32_16x16x32_bf16 v[68:71], a[16:19], a[224:227], v[68:71]
ds_read_b128 a[68:71], v200 offset:35840
v_mfma_f32_16x16x32_bf16 v[72:75], a[16:19], a[228:231], v[72:75]
s_cmp_eq_u32 s25, 4
s_cselect_b32 s98, 4096, 0
s_add_u32 s52, s52, s98
v_mfma_f32_16x16x32_bf16 v[76:79], a[20:23], a[224:227], v[76:79]
s_add_u32 s52, s52, 4096
v_exp_f32 v196, v196
v_mfma_f32_16x16x32_bf16 v[80:83], a[20:23], a[228:231], v[80:83]
v_exp_f32 v197, v197
v_mfma_f32_16x16x32_bf16 v[84:87], a[24:27], a[224:227], v[84:87]
buffer_load_dwordx4 a[160:163], v1, s[4:7], s52 offen offset:0 sc1
v_mfma_f32_16x16x32_bf16 v[88:91], a[24:27], a[228:231], v[88:91]
v_mfma_f32_16x16x32_bf16 v[92:95], a[28:31], a[224:227], v[92:95]
buffer_load_dwordx4 a[164:167], v9, s[4:7], s52 offen offset:0 sc1
v_mfma_f32_16x16x32_bf16 v[96:99], a[28:31], a[228:231], v[96:99]
v_exp_f32 v198, v198
v_mfma_f32_16x16x32_bf16 v[100:103], a[32:35], a[224:227], v[100:103]
v_mfma_f32_16x16x32_bf16 v[104:107], a[32:35], a[228:231], v[104:107]
s_waitcnt vmcnt(19) lgkmcnt(0)
s_barrier
v_mfma_f32_16x16x32_bf16 v[36:39], a[36:39], a[232:235], v[36:39]
ds_read_b128 a[0:3], v201 offset:0
buffer_load_dwordx4 a[168:171], v1, s[4:7], s52 offen offset:1024 sc1
v_mfma_f32_16x16x32_bf16 v[40:43], a[36:39], a[236:239], v[40:43]
ds_read_b128 a[4:7], v201 offset:1024
buffer_load_dwordx4 a[172:175], v9, s[4:7], s52 offen offset:1024 sc1
v_mfma_f32_16x16x32_bf16 v[44:47], a[40:43], a[232:235], v[44:47]
ds_read_b128 a[8:11], v201 offset:2048
v_mfma_f32_16x16x32_bf16 v[48:51], a[40:43], a[236:239], v[48:51]
ds_read_b128 a[12:15], v201 offset:3072
v_mfma_f32_16x16x32_bf16 v[52:55], a[44:47], a[232:235], v[52:55]
ds_read_b128 a[16:19], v201 offset:4096
v_mfma_f32_16x16x32_bf16 v[56:59], a[44:47], a[236:239], v[56:59]
ds_read_b128 a[20:23], v201 offset:5120
v_mfma_f32_16x16x32_bf16 v[60:63], a[48:51], a[232:235], v[60:63]
ds_read_b128 a[24:27], v201 offset:6144
v_mfma_f32_16x16x32_bf16 v[64:67], a[48:51], a[236:239], v[64:67]
ds_read_b128 a[28:31], v201 offset:7168
v_mfma_f32_16x16x32_bf16 v[68:71], a[52:55], a[232:235], v[68:71]
ds_read_b128 a[32:35], v201 offset:8192
v_mfma_f32_16x16x32_bf16 v[72:75], a[52:55], a[236:239], v[72:75]
s_cmp_eq_u32 s25, 3
s_cselect_b32 s99, 36864, 0
s_add_u32 s60, s60, s99
v_mfma_f32_16x16x32_bf16 v[76:79], a[56:59], a[232:235], v[76:79]
s_add_u32 s61, s61, s99
s_add_u32 m0, s62, 53248
v_mfma_f32_16x16x32_bf16 v[80:83], a[56:59], a[236:239], v[80:83]
s_add_u32 s60, s60, 16384
v_exp_f32 v199, v199
v_mfma_f32_16x16x32_bf16 v[84:87], a[60:63], a[232:235], v[84:87]
v_fma_f32 v196, v196, v255, v255
v_fma_f32 v197, v197, v255, v255
v_mfma_f32_16x16x32_bf16 v[88:91], a[60:63], a[236:239], v[88:91]
buffer_load_dwordx4 v1, s[8:11], s60 offen offset:0 sc1 lds
v_fma_f32 v198, v198, v255, v255
v_mfma_f32_16x16x32_bf16 v[92:95], a[64:67], a[232:235], v[92:95]
v_fma_f32 v199, v199, v255, v255
v_mfma_f32_16x16x32_bf16 v[96:99], a[64:67], a[236:239], v[96:99]
buffer_load_dwordx4 v1, s[8:11], s60 offen offset:1024 sc1 lds
v_mfma_f32_16x16x32_bf16 v[100:103], a[68:71], a[232:235], v[100:103]
v_rcp_f32 v196, v196
v_mfma_f32_16x16x32_bf16 v[104:107], a[68:71], a[236:239], v[104:107]
s_waitcnt lgkmcnt(0)
v_mfma_f32_16x16x32_bf16 v[36:39], a[0:3], a[240:243], v[36:39]
ds_read_b128 a[36:39], v201 offset:9216
buffer_load_dwordx4 v1, s[8:11], s60 offen offset:2048 sc1 lds
v_mfma_f32_16x16x32_bf16 v[40:43], a[0:3], a[244:247], v[40:43]
ds_read_b128 a[40:43], v201 offset:10240
v_mfma_f32_16x16x32_bf16 v[44:47], a[4:7], a[240:243], v[44:47]
ds_read_b128 a[44:47], v201 offset:11264
buffer_load_dwordx4 v1, s[8:11], s60 offen offset:3072 sc1 lds
v_mfma_f32_16x16x32_bf16 v[48:51], a[4:7], a[244:247], v[48:51]
ds_read_b128 a[48:51], v201 offset:12288
v_mfma_f32_16x16x32_bf16 v[52:55], a[8:11], a[240:243], v[52:55]
ds_read_b128 a[52:55], v201 offset:13312
s_add_u32 m0, s63, 69632
v_mfma_f32_16x16x32_bf16 v[56:59], a[8:11], a[244:247], v[56:59]
ds_read_b128 a[56:59], v201 offset:14336
v_mfma_f32_16x16x32_bf16 v[60:63], a[12:15], a[240:243], v[60:63]
ds_read_b128 a[60:63], v201 offset:15360
s_add_u32 s61, s61, 36864
v_mfma_f32_16x16x32_bf16 v[64:67], a[12:15], a[244:247], v[64:67]
ds_read_b128 a[64:67], v201 offset:16384
v_mfma_f32_16x16x32_bf16 v[68:71], a[16:19], a[240:243], v[68:71]
ds_read_b128 a[68:71], v201 offset:17408
buffer_load_dwordx4 v1, s[8:11], s61 offen offset:0 sc1 lds
v_mfma_f32_16x16x32_bf16 v[72:75], a[16:19], a[244:247], v[72:75]
s_add_u32 m0, s62, 73728
v_rcp_f32 v197, v197
v_mfma_f32_16x16x32_bf16 v[76:79], a[20:23], a[240:243], v[76:79]
s_add_u32 s60, s60, 20480
v_rcp_f32 v198, v198
v_mfma_f32_16x16x32_bf16 v[80:83], a[20:23], a[244:247], v[80:83]
v_rcp_f32 v199, v199
v_mfma_f32_16x16x32_bf16 v[84:87], a[24:27], a[240:243], v[84:87]
v_mfma_f32_16x16x32_bf16 v[88:91], a[24:27], a[244:247], v[88:91]
v_mfma_f32_16x16x32_bf16 v[92:95], a[28:31], a[240:243], v[92:95]
buffer_load_dwordx4 v1, s[8:11], s60 offen offset:0 sc1 lds
v_mfma_f32_16x16x32_bf16 v[96:99], a[28:31], a[244:247], v[96:99]
v_mfma_f32_16x16x32_bf16 v[100:103], a[32:35], a[240:243], v[100:103]
v_mul_f32 v136, v136, v196
v_mfma_f32_16x16x32_bf16 v[104:107], a[32:35], a[244:247], v[104:107]
s_waitcnt vmcnt(23) lgkmcnt(0)
s_barrier
v_mfma_f32_16x16x32_bf16 v[36:39], a[36:39], a[248:251], v[36:39]
ds_read_b128 a[0:3], v201 offset:18432
buffer_load_dwordx4 v1, s[8:11], s60 offen offset:1024 sc1 lds
v_mfma_f32_16x16x32_bf16 v[40:43], a[36:39], a[252:255], v[40:43]
ds_read_b128 a[4:7], v201 offset:19456
v_mul_f32 v137, v137, v197
v_mfma_f32_16x16x32_bf16 v[44:47], a[40:43], a[248:251], v[44:47]
ds_read_b128 a[8:11], v201 offset:20480
v_mul_f32 v138, v138, v198
v_mfma_f32_16x16x32_bf16 v[48:51], a[40:43], a[252:255], v[48:51]
ds_read_b128 a[12:15], v201 offset:21504
v_mfma_f32_16x16x32_bf16 v[52:55], a[44:47], a[248:251], v[52:55]
ds_read_b128 a[16:19], v201 offset:22528
buffer_load_dwordx4 v1, s[8:11], s60 offen offset:2048 sc1 lds
v_mfma_f32_16x16x32_bf16 v[56:59], a[44:47], a[252:255], v[56:59]
ds_read_b128 a[20:23], v201 offset:23552
v_mul_f32 v139, v139, v199
v_mfma_f32_16x16x32_bf16 v[60:63], a[48:51], a[248:251], v[60:63]
ds_read_b128 a[24:27], v201 offset:24576
v_mfma_f32_16x16x32_bf16 v[64:67], a[48:51], a[252:255], v[64:67]
ds_read_b128 a[28:31], v201 offset:25600
v_mul_f32 v192, v140, v140
v_mfma_f32_16x16x32_bf16 v[68:71], a[52:55], a[248:251], v[68:71]
ds_read_b128 a[32:35], v201 offset:26624
buffer_load_dwordx4 v1, s[8:11], s60 offen offset:3072 sc1 lds
v_mfma_f32_16x16x32_bf16 v[72:75], a[52:55], a[252:255], v[72:75]
v_mfma_f32_16x16x32_bf16 v[76:79], a[56:59], a[248:251], v[76:79]
v_mul_f32 v193, v141, v141
v_mfma_f32_16x16x32_bf16 v[80:83], a[56:59], a[252:255], v[80:83]
v_mfma_f32_16x16x32_bf16 v[84:87], a[60:63], a[248:251], v[84:87]
buffer_load_dwordx4 a[176:179], v1, s[4:7], s52 offen offset:2048 sc1
v_mul_f32 v194, v142, v142
v_mfma_f32_16x16x32_bf16 v[88:91], a[60:63], a[252:255], v[88:91]
v_mfma_f32_16x16x32_bf16 v[92:95], a[64:67], a[248:251], v[92:95]
v_mul_f32 v195, v143, v143
v_mfma_f32_16x16x32_bf16 v[96:99], a[64:67], a[252:255], v[96:99]
v_mfma_f32_16x16x32_bf16 v[100:103], a[68:71], a[248:251], v[100:103]
v_mfma_f32_16x16x32_bf16 v[104:107], a[68:71], a[252:255], v[104:107]
v_fma_f32 v192, v192, v252, v250
s_waitcnt lgkmcnt(0)
v_mfma_f32_16x16x32_bf16 v[36:39], a[0:3], a[80:83], v[36:39]
ds_read_b128 a[36:39], v201 offset:27648
buffer_load_dwordx4 a[180:183], v9, s[4:7], s52 offen offset:2048 sc1
v_mfma_f32_16x16x32_bf16 v[40:43], a[0:3], a[84:87], v[40:43]
ds_read_b128 a[40:43], v201 offset:28672
v_fma_f32 v193, v193, v252, v250
v_mfma_f32_16x16x32_bf16 v[44:47], a[4:7], a[80:83], v[44:47]
ds_read_b128 a[44:47], v201 offset:29696
buffer_load_dwordx4 a[184:187], v1, s[4:7], s52 offen offset:3072 sc1
v_mfma_f32_16x16x32_bf16 v[48:51], a[4:7], a[84:87], v[48:51]
ds_read_b128 a[48:51], v201 offset:30720
v_fma_f32 v194, v194, v252, v250
v_mfma_f32_16x16x32_bf16 v[52:55], a[8:11], a[80:83], v[52:55]
ds_read_b128 a[52:55], v201 offset:31744
buffer_load_dwordx4 a[188:191], v9, s[4:7], s52 offen offset:3072 sc1
v_mfma_f32_16x16x32_bf16 v[56:59], a[8:11], a[84:87], v[56:59]
ds_read_b128 a[56:59], v201 offset:32768
v_mfma_f32_16x16x32_bf16 v[60:63], a[12:15], a[80:83], v[60:63]
ds_read_b128 a[60:63], v201 offset:33792
v_fma_f32 v195, v195, v252, v250
v_mfma_f32_16x16x32_bf16 v[64:67], a[12:15], a[84:87], v[64:67]
ds_read_b128 a[64:67], v201 offset:34816
v_mfma_f32_16x16x32_bf16 v[68:71], a[16:19], a[80:83], v[68:71]
ds_read_b128 a[68:71], v201 offset:35840
v_mul_f32 v192, v192, v140
v_mfma_f32_16x16x32_bf16 v[72:75], a[16:19], a[84:87], v[72:75]
s_cmp_eq_u32 s25, 5
s_cselect_b32 s98, 4096, 0
v_mfma_f32_16x16x32_bf16 v[76:79], a[20:23], a[80:83], v[76:79]
s_add_u32 s52, s52, s98
v_mul_f32 v193, v193, v141
v_mfma_f32_16x16x32_bf16 v[80:83], a[20:23], a[84:87], v[80:83]
s_add_u32 s52, s52, 4096
v_mfma_f32_16x16x32_bf16 v[84:87], a[24:27], a[80:83], v[84:87]
v_mfma_f32_16x16x32_bf16 v[88:91], a[24:27], a[84:87], v[88:91]
v_mul_f32 v194, v194, v142
v_mfma_f32_16x16x32_bf16 v[92:95], a[28:31], a[80:83], v[92:95]
buffer_load_dwordx4 a[192:195], v1, s[4:7], s52 offen offset:0 sc1
v_mfma_f32_16x16x32_bf16 v[96:99], a[28:31], a[84:87], v[96:99]
v_mul_f32 v195, v195, v143
v_mfma_f32_16x16x32_bf16 v[100:103], a[32:35], a[80:83], v[100:103]
v_mfma_f32_16x16x32_bf16 v[104:107], a[32:35], a[84:87], v[104:107]
s_waitcnt vmcnt(22) lgkmcnt(0)
s_barrier
v_mfma_f32_16x16x32_bf16 v[36:39], a[36:39], a[88:91], v[36:39]
ds_read_b128 a[0:3], v202 offset:0
buffer_load_dwordx4 a[196:199], v9, s[4:7], s52 offen offset:0 sc1
v_mfma_f32_16x16x32_bf16 v[40:43], a[36:39], a[92:95], v[40:43]
ds_read_b128 a[4:7], v202 offset:1024
buffer_load_dwordx4 a[200:203], v1, s[4:7], s52 offen offset:1024 sc1
v_mfma_f32_16x16x32_bf16 v[44:47], a[40:43], a[88:91], v[44:47]
ds_read_b128 a[8:11], v202 offset:2048
v_mfma_f32_16x16x32_bf16 v[48:51], a[40:43], a[92:95], v[48:51]
ds_read_b128 a[12:15], v202 offset:3072
buffer_load_dwordx4 a[204:207], v9, s[4:7], s52 offen offset:1024 sc1
v_mfma_f32_16x16x32_bf16 v[52:55], a[44:47], a[88:91], v[52:55]
ds_read_b128 a[16:19], v202 offset:4096
v_mfma_f32_16x16x32_bf16 v[56:59], a[44:47], a[92:95], v[56:59]
ds_read_b128 a[20:23], v202 offset:5120
v_mfma_f32_16x16x32_bf16 v[60:63], a[48:51], a[88:91], v[60:63]
ds_read_b128 a[24:27], v202 offset:6144
v_mfma_f32_16x16x32_bf16 v[64:67], a[48:51], a[92:95], v[64:67]
ds_read_b128 a[28:31], v202 offset:7168
v_mfma_f32_16x16x32_bf16 v[68:71], a[52:55], a[88:91], v[68:71]
ds_read_b128 a[32:35], v202 offset:8192
v_mfma_f32_16x16x32_bf16 v[72:75], a[52:55], a[92:95], v[72:75]
s_cmp_eq_u32 s25, 4
s_cselect_b32 s99, 36864, 0
s_add_u32 s60, s60, s99
v_mfma_f32_16x16x32_bf16 v[76:79], a[56:59], a[88:91], v[76:79]
s_add_u32 s61, s61, s99
v_exp_f32 v192, v192
v_mfma_f32_16x16x32_bf16 v[80:83], a[56:59], a[92:95], v[80:83]
s_add_u32 m0, s62, 90112
v_exp_f32 v193, v193
v_mfma_f32_16x16x32_bf16 v[84:87], a[60:63], a[88:91], v[84:87]
s_add_u32 s60, s60, 16384
v_exp_f32 v194, v194
v_mfma_f32_16x16x32_bf16 v[88:91], a[60:63], a[92:95], v[88:91]
v_mfma_f32_16x16x32_bf16 v[92:95], a[64:67], a[88:91], v[92:95]
v_exp_f32 v195, v195
v_mfma_f32_16x16x32_bf16 v[96:99], a[64:67], a[92:95], v[96:99]
buffer_load_dwordx4 v1, s[8:11], s60 offen offset:0 sc1 lds
v_mfma_f32_16x16x32_bf16 v[100:103], a[68:71], a[88:91], v[100:103]
v_mfma_f32_16x16x32_bf16 v[104:107], a[68:71], a[92:95], v[104:107]
s_waitcnt lgkmcnt(0)
v_mfma_f32_16x16x32_bf16 v[36:39], a[0:3], a[96:99], v[36:39]
ds_read_b128 a[36:39], v202 offset:9216
buffer_load_dwordx4 v1, s[8:11], s60 offen offset:1024 sc1 lds
v_mfma_f32_16x16x32_bf16 v[40:43], a[0:3], a[100:103], v[40:43]
ds_read_b128 a[40:43], v202 offset:10240
v_fma_f32 v192, v192, v254, v254
v_mfma_f32_16x16x32_bf16 v[44:47], a[4:7], a[96:99], v[44:47]
ds_read_b128 a[44:47], v202 offset:11264
buffer_load_dwordx4 v1, s[8:11], s60 offen offset:2048 sc1 lds
v_mfma_f32_16x16x32_bf16 v[48:51], a[4:7], a[100:103], v[48:51]
ds_read_b128 a[48:51], v202 offset:12288
v_fma_f32 v193, v193, v254, v254
v_mfma_f32_16x16x32_bf16 v[52:55], a[8:11], a[96:99], v[52:55]
ds_read_b128 a[52:55], v202 offset:13312
v_mfma_f32_16x16x32_bf16 v[56:59], a[8:11], a[100:103], v[56:59]
ds_read_b128 a[56:59], v202 offset:14336
buffer_load_dwordx4 v1, s[8:11], s60 offen offset:3072 sc1 lds
v_mfma_f32_16x16x32_bf16 v[60:63], a[12:15], a[96:99], v[60:63]
ds_read_b128 a[60:63], v202 offset:15360
v_fma_f32 v194, v194, v254, v254
v_mfma_f32_16x16x32_bf16 v[64:67], a[12:15], a[100:103], v[64:67]
ds_read_b128 a[64:67], v202 offset:16384
v_fma_f32 v195, v195, v254, v254
v_mfma_f32_16x16x32_bf16 v[68:71], a[16:19], a[96:99], v[68:71]
ds_read_b128 a[68:71], v202 offset:17408
s_add_u32 m0, s63, 106496
v_mfma_f32_16x16x32_bf16 v[72:75], a[16:19], a[100:103], v[72:75]
s_add_u32 s61, s61, 36864
v_mfma_f32_16x16x32_bf16 v[76:79], a[20:23], a[96:99], v[76:79]
v_rcp_f32 v192, v192
v_mfma_f32_16x16x32_bf16 v[80:83], a[20:23], a[100:103], v[80:83]
v_mfma_f32_16x16x32_bf16 v[84:87], a[24:27], a[96:99], v[84:87]
v_mfma_f32_16x16x32_bf16 v[88:91], a[24:27], a[100:103], v[88:91]
v_mfma_f32_16x16x32_bf16 v[92:95], a[28:31], a[96:99], v[92:95]
buffer_load_dwordx4 v1, s[8:11], s61 offen offset:0 sc1 lds
v_mfma_f32_16x16x32_bf16 v[96:99], a[28:31], a[100:103], v[96:99]
v_rcp_f32 v193, v193
v_mfma_f32_16x16x32_bf16 v[100:103], a[32:35], a[96:99], v[100:103]
v_mfma_f32_16x16x32_bf16 v[104:107], a[32:35], a[100:103], v[104:107]
s_waitcnt lgkmcnt(0)
v_mfma_f32_16x16x32_bf16 v[36:39], a[36:39], a[104:107], v[36:39]
ds_read_b128 a[0:3], v202 offset:18432
s_add_u32 m0, s62, 110592
v_mfma_f32_16x16x32_bf16 v[40:43], a[36:39], a[108:111], v[40:43]
ds_read_b128 a[4:7], v202 offset:19456
v_mfma_f32_16x16x32_bf16 v[44:47], a[40:43], a[104:107], v[44:47]
ds_read_b128 a[8:11], v202 offset:20480
s_add_u32 s60, s60, 20480
v_mfma_f32_16x16x32_bf16 v[48:51], a[40:43], a[108:111], v[48:51]
ds_read_b128 a[12:15], v202 offset:21504
v_mfma_f32_16x16x32_bf16 v[52:55], a[44:47], a[104:107], v[52:55]
ds_read_b128 a[16:19], v202 offset:22528
v_mfma_f32_16x16x32_bf16 v[56:59], a[44:47], a[108:111], v[56:59]
ds_read_b128 a[20:23], v202 offset:23552
buffer_load_dwordx4 v1, s[8:11], s60 offen offset:0 sc1 lds
v_mfma_f32_16x16x32_bf16 v[60:63], a[48:51], a[104:107], v[60:63]
ds_read_b128 a[24:27], v202 offset:24576
v_mfma_f32_16x16x32_bf16 v[64:67], a[48:51], a[108:111], v[64:67]
ds_read_b128 a[28:31], v202 offset:25600
v_mfma_f32_16x16x32_bf16 v[68:71], a[52:55], a[104:107], v[68:71]
ds_read_b128 a[32:35], v202 offset:26624
buffer_load_dwordx4 v1, s[8:11], s60 offen offset:1024 sc1 lds
v_mfma_f32_16x16x32_bf16 v[72:75], a[52:55], a[108:111], v[72:75]
v_rcp_f32 v194, v194
v_mfma_f32_16x16x32_bf16 v[76:79], a[56:59], a[104:107], v[76:79]
v_rcp_f32 v195, v195
v_mfma_f32_16x16x32_bf16 v[80:83], a[56:59], a[108:111], v[80:83]
buffer_load_dwordx4 v1, s[8:11], s60 offen offset:2048 sc1 lds
v_mul_f32 v140, v140, v192
v_mfma_f32_16x16x32_bf16 v[84:87], a[60:63], a[104:107], v[84:87]
v_mfma_f32_16x16x32_bf16 v[88:91], a[60:63], a[108:111], v[88:91]
v_mul_f32 v141, v141, v193
v_mfma_f32_16x16x32_bf16 v[92:95], a[64:67], a[104:107], v[92:95]
buffer_load_dwordx4 v1, s[8:11], s60 offen offset:3072 sc1 lds
v_mfma_f32_16x16x32_bf16 v[96:99], a[64:67], a[108:111], v[96:99]
v_mul_f32 v142, v142, v194
v_mfma_f32_16x16x32_bf16 v[100:103], a[68:71], a[104:107], v[100:103]
v_mfma_f32_16x16x32_bf16 v[104:107], a[68:71], a[108:111], v[104:107]
s_waitcnt lgkmcnt(0)
v_mfma_f32_16x16x32_bf16 v[36:39], a[0:3], a[112:115], v[36:39]
ds_read_b128 a[36:39], v202 offset:27648
buffer_load_dwordx4 a[208:211], v1, s[4:7], s52 offen offset:2048 sc1
v_mfma_f32_16x16x32_bf16 v[40:43], a[0:3], a[116:119], v[40:43]
ds_read_b128 a[40:43], v202 offset:28672
v_mul_f32 v143, v143, v195
v_mfma_f32_16x16x32_bf16 v[44:47], a[4:7], a[112:115], v[44:47]
ds_read_b128 a[44:47], v202 offset:29696
v_mul_f32 v196, v144, v144
v_mfma_f32_16x16x32_bf16 v[48:51], a[4:7], a[116:119], v[48:51]
ds_read_b128 a[48:51], v202 offset:30720
v_mfma_f32_16x16x32_bf16 v[52:55], a[8:11], a[112:115], v[52:55]
ds_read_b128 a[52:55], v202 offset:31744
buffer_load_dwordx4 a[212:215], v9, s[4:7], s52 offen offset:2048 sc1
v_mfma_f32_16x16x32_bf16 v[56:59], a[8:11], a[116:119], v[56:59]
ds_read_b128 a[56:59], v202 offset:32768
v_mul_f32 v197, v145, v145
v_mfma_f32_16x16x32_bf16 v[60:63], a[12:15], a[112:115], v[60:63]
ds_read_b128 a[60:63], v202 offset:33792
v_mfma_f32_16x16x32_bf16 v[64:67], a[12:15], a[116:119], v[64:67]
ds_read_b128 a[64:67], v202 offset:34816
v_mul_f32 v198, v146, v146
v_mfma_f32_16x16x32_bf16 v[68:71], a[16:19], a[112:115], v[68:71]
ds_read_b128 a[68:71], v202 offset:35840
buffer_load_dwordx4 a[216:219], v1, s[4:7], s52 offen offset:3072 sc1
v_mfma_f32_16x16x32_bf16 v[72:75], a[16:19], a[116:119], v[72:75]
v_mul_f32 v199, v147, v147
v_mfma_f32_16x16x32_bf16 v[76:79], a[20:23], a[112:115], v[76:79]
v_mfma_f32_16x16x32_bf16 v[80:83], a[20:23], a[116:119], v[80:83]
v_fma_f32 v196, v196, v253, v251
v_mfma_f32_16x16x32_bf16 v[84:87], a[24:27], a[112:115], v[84:87]
buffer_load_dwordx4 a[220:223], v9, s[4:7], s52 offen offset:3072 sc1
v_mfma_f32_16x16x32_bf16 v[88:91], a[24:27], a[116:119], v[88:91]
v_mfma_f32_16x16x32_bf16 v[92:95], a[28:31], a[112:115], v[92:95]
v_fma_f32 v197, v197, v253, v251
v_mfma_f32_16x16x32_bf16 v[96:99], a[28:31], a[116:119], v[96:99]
v_mfma_f32_16x16x32_bf16 v[100:103], a[32:35], a[112:115], v[100:103]
v_fma_f32 v198, v198, v253, v251
v_mfma_f32_16x16x32_bf16 v[104:107], a[32:35], a[116:119], v[104:107]
s_waitcnt vmcnt(21) lgkmcnt(0)
s_barrier
v_mfma_f32_16x16x32_bf16 v[36:39], a[36:39], a[120:123], v[36:39]
ds_read_b128 a[0:3], v200 offset:0
v_mfma_f32_16x16x32_bf16 v[40:43], a[36:39], a[124:127], v[40:43]
ds_read_b128 a[4:7], v200 offset:1024
v_fma_f32 v199, v199, v253, v251
v_mfma_f32_16x16x32_bf16 v[44:47], a[40:43], a[120:123], v[44:47]
ds_read_b128 a[8:11], v200 offset:2048
v_mfma_f32_16x16x32_bf16 v[48:51], a[40:43], a[124:127], v[48:51]
ds_read_b128 a[12:15], v200 offset:3072
v_mul_f32 v196, v196, v144
v_mfma_f32_16x16x32_bf16 v[52:55], a[44:47], a[120:123], v[52:55]
ds_read_b128 a[16:19], v200 offset:4096
v_mfma_f32_16x16x32_bf16 v[56:59], a[44:47], a[124:127], v[56:59]
ds_read_b128 a[20:23], v200 offset:5120
v_mul_f32 v197, v197, v145
v_mfma_f32_16x16x32_bf16 v[60:63], a[48:51], a[120:123], v[60:63]
ds_read_b128 a[24:27], v200 offset:6144
v_mfma_f32_16x16x32_bf16 v[64:67], a[48:51], a[124:127], v[64:67]
ds_read_b128 a[28:31], v200 offset:7168
v_mfma_f32_16x16x32_bf16 v[68:71], a[52:55], a[120:123], v[68:71]
ds_read_b128 a[32:35], v200 offset:8192
v_mul_f32 v198, v198, v146
v_mfma_f32_16x16x32_bf16 v[72:75], a[52:55], a[124:127], v[72:75]
s_cmp_eq_u32 s25, 5
s_cselect_b32 s99, 36864, 0
s_add_u32 s60, s60, s99
v_mfma_f32_16x16x32_bf16 v[76:79], a[56:59], a[120:123], v[76:79]
s_add_u32 s61, s61, s99
s_add_u32 m0, s62, 126976
s_add_u32 s60, s60, 16384
v_mfma_f32_16x16x32_bf16 v[80:83], a[56:59], a[124:127], v[80:83]
buffer_load_dwordx4 v1, s[8:11], s60 offen offset:0 sc1 lds
v_mul_f32 v199, v199, v147
v_mfma_f32_16x16x32_bf16 v[84:87], a[60:63], a[120:123], v[84:87]
buffer_load_dwordx4 v1, s[8:11], s60 offen offset:1024 sc1 lds
v_mfma_f32_16x16x32_bf16 v[88:91], a[60:63], a[124:127], v[88:91]
buffer_load_dwordx4 v1, s[8:11], s60 offen offset:2048 sc1 lds
v_mfma_f32_16x16x32_bf16 v[92:95], a[64:67], a[120:123], v[92:95]
v_exp_f32 v196, v196
v_mfma_f32_16x16x32_bf16 v[96:99], a[64:67], a[124:127], v[96:99]
buffer_load_dwordx4 v1, s[8:11], s60 offen offset:3072 sc1 lds
v_mfma_f32_16x16x32_bf16 v[100:103], a[68:71], a[120:123], v[100:103]
v_mfma_f32_16x16x32_bf16 v[104:107], a[68:71], a[124:127], v[104:107]
s_waitcnt lgkmcnt(0)
v_mfma_f32_16x16x32_bf16 v[36:39], a[0:3], a[128:131], v[36:39]
ds_read_b128 a[36:39], v200 offset:9216
s_add_u32 m0, s63, 143360
v_mfma_f32_16x16x32_bf16 v[40:43], a[0:3], a[132:135], v[40:43]
ds_read_b128 a[40:43], v200 offset:10240
v_mfma_f32_16x16x32_bf16 v[44:47], a[4:7], a[128:131], v[44:47]
ds_read_b128 a[44:47], v200 offset:11264
s_add_u32 s61, s61, 36864
v_mfma_f32_16x16x32_bf16 v[48:51], a[4:7], a[132:135], v[48:51]
ds_read_b128 a[48:51], v200 offset:12288
v_mfma_f32_16x16x32_bf16 v[52:55], a[8:11], a[128:131], v[52:55]
ds_read_b128 a[52:55], v200 offset:13312
buffer_load_dwordx4 v1, s[8:11], s61 offen offset:0 sc1 lds
v_mfma_f32_16x16x32_bf16 v[56:59], a[8:11], a[132:135], v[56:59]
ds_read_b128 a[56:59], v200 offset:14336
v_mfma_f32_16x16x32_bf16 v[60:63], a[12:15], a[128:131], v[60:63]
ds_read_b128 a[60:63], v200 offset:15360
s_add_u32 m0, s62, 147456
v_mfma_f32_16x16x32_bf16 v[64:67], a[12:15], a[132:135], v[64:67]
ds_read_b128 a[64:67], v200 offset:16384
v_mfma_f32_16x16x32_bf16 v[68:71], a[16:19], a[128:131], v[68:71]
ds_read_b128 a[68:71], v200 offset:17408
s_add_u32 s60, s60, 20480
v_mfma_f32_16x16x32_bf16 v[72:75], a[16:19], a[132:135], v[72:75]
v_exp_f32 v197, v197
v_mfma_f32_16x16x32_bf16 v[76:79], a[20:23], a[128:131], v[76:79]
buffer_load_dwordx4 v1, s[8:11], s60 offen offset:0 sc1 lds
v_mfma_f32_16x16x32_bf16 v[80:83], a[20:23], a[132:135], v[80:83]
v_exp_f32 v198, v198
v_mfma_f32_16x16x32_bf16 v[84:87], a[24:27], a[128:131], v[84:87]
buffer_load_dwordx4 v1, s[8:11], s60 offen offset:1024 sc1 lds
v_mfma_f32_16x16x32_bf16 v[88:91], a[24:27], a[132:135], v[88:91]
v_exp_f32 v199, v199
v_mfma_f32_16x16x32_bf16 v[92:95], a[28:31], a[128:131], v[92:95]
buffer_load_dwordx4 v1, s[8:11], s60 offen offset:2048 sc1 lds
v_fma_f32 v196, v196, v255, v255
v_mfma_f32_16x16x32_bf16 v[96:99], a[28:31], a[132:135], v[96:99]
v_mfma_f32_16x16x32_bf16 v[100:103], a[32:35], a[128:131], v[100:103]
v_fma_f32 v197, v197, v255, v255
v_mfma_f32_16x16x32_bf16 v[104:107], a[32:35], a[132:135], v[104:107]
s_waitcnt lgkmcnt(0)
v_mfma_f32_16x16x32_bf16 v[36:39], a[36:39], a[136:139], v[36:39]
ds_read_b128 a[0:3], v200 offset:18432
buffer_load_dwordx4 v1, s[8:11], s60 offen offset:3072 sc1 lds
v_mfma_f32_16x16x32_bf16 v[40:43], a[36:39], a[140:143], v[40:43]
ds_read_b128 a[4:7], v200 offset:19456
v_fma_f32 v198, v198, v255, v255
v_mfma_f32_16x16x32_bf16 v[44:47], a[40:43], a[136:139], v[44:47]
ds_read_b128 a[8:11], v200 offset:20480
v_fma_f32 v199, v199, v255, v255
v_mfma_f32_16x16x32_bf16 v[48:51], a[40:43], a[140:143], v[48:51]
ds_read_b128 a[12:15], v200 offset:21504
v_mfma_f32_16x16x32_bf16 v[52:55], a[44:47], a[136:139], v[52:55]
ds_read_b128 a[16:19], v200 offset:22528
v_mfma_f32_16x16x32_bf16 v[56:59], a[44:47], a[140:143], v[56:59]
ds_read_b128 a[20:23], v200 offset:23552
v_mfma_f32_16x16x32_bf16 v[60:63], a[48:51], a[136:139], v[60:63]
ds_read_b128 a[24:27], v200 offset:24576
v_mfma_f32_16x16x32_bf16 v[64:67], a[48:51], a[140:143], v[64:67]
ds_read_b128 a[28:31], v200 offset:25600
v_mfma_f32_16x16x32_bf16 v[68:71], a[52:55], a[136:139], v[68:71]
ds_read_b128 a[32:35], v200 offset:26624
v_mfma_f32_16x16x32_bf16 v[72:75], a[52:55], a[140:143], v[72:75]
s_cmp_eq_u32 s25, 6
s_cselect_b32 s98, 4096, 0
s_add_u32 s52, s52, s98
v_mfma_f32_16x16x32_bf16 v[76:79], a[56:59], a[136:139], v[76:79]
s_add_u32 s52, s52, 4096
v_rcp_f32 v196, v196
v_mfma_f32_16x16x32_bf16 v[80:83], a[56:59], a[140:143], v[80:83]
buffer_load_dwordx4 a[224:227], v1, s[4:7], s52 offen offset:0 sc1
v_mfma_f32_16x16x32_bf16 v[84:87], a[60:63], a[136:139], v[84:87]
buffer_load_dwordx4 a[228:231], v9, s[4:7], s52 offen offset:0 sc1
v_mfma_f32_16x16x32_bf16 v[88:91], a[60:63], a[140:143], v[88:91]
v_rcp_f32 v197, v197
v_mfma_f32_16x16x32_bf16 v[92:95], a[64:67], a[136:139], v[92:95]
buffer_load_dwordx4 a[232:235], v1, s[4:7], s52 offen offset:1024 sc1
v_mfma_f32_16x16x32_bf16 v[96:99], a[64:67], a[140:143], v[96:99]
v_rcp_f32 v198, v198
v_mfma_f32_16x16x32_bf16 v[100:103], a[68:71], a[136:139], v[100:103]
v_mfma_f32_16x16x32_bf16 v[104:107], a[68:71], a[140:143], v[104:107]
s_waitcnt lgkmcnt(0)
v_mfma_f32_16x16x32_bf16 v[36:39], a[0:3], a[144:147], v[36:39]
ds_read_b128 a[36:39], v200 offset:27648
buffer_load_dwordx4 a[236:239], v9, s[4:7], s52 offen offset:1024 sc1
v_mfma_f32_16x16x32_bf16 v[40:43], a[0:3], a[148:151], v[40:43]
ds_read_b128 a[40:43], v200 offset:28672
v_mfma_f32_16x16x32_bf16 v[44:47], a[4:7], a[144:147], v[44:47]
ds_read_b128 a[44:47], v200 offset:29696
v_mfma_f32_16x16x32_bf16 v[48:51], a[4:7], a[148:151], v[48:51]
ds_read_b128 a[48:51], v200 offset:30720
v_mfma_f32_16x16x32_bf16 v[52:55], a[8:11], a[144:147], v[52:55]
ds_read_b128 a[52:55], v200 offset:31744
buffer_load_dwordx4 a[240:243], v1, s[4:7], s52 offen offset:2048 sc1
v_mfma_f32_16x16x32_bf16 v[56:59], a[8:11], a[148:151], v[56:59]
ds_read_b128 a[56:59], v200 offset:32768
v_mfma_f32_16x16x32_bf16 v[60:63], a[12:15], a[144:147], v[60:63]
ds_read_b128 a[60:63], v200 offset:33792
v_mfma_f32_16x16x32_bf16 v[64:67], a[12:15], a[148:151], v[64:67]
ds_read_b128 a[64:67], v200 offset:34816
v_mfma_f32_16x16x32_bf16 v[68:71], a[16:19], a[144:147], v[68:71]
ds_read_b128 a[68:71], v200 offset:35840
buffer_load_dwordx4 a[244:247], v9, s[4:7], s52 offen offset:2048 sc1
v_mfma_f32_16x16x32_bf16 v[72:75], a[16:19], a[148:151], v[72:75]
v_rcp_f32 v199, v199
v_mfma_f32_16x16x32_bf16 v[76:79], a[20:23], a[144:147], v[76:79]
v_mul_f32 v144, v144, v196
v_mul_f32 v145, v145, v197
v_mfma_f32_16x16x32_bf16 v[80:83], a[20:23], a[148:151], v[80:83]
v_mul_f32 v146, v146, v198
v_mfma_f32_16x16x32_bf16 v[84:87], a[24:27], a[144:147], v[84:87]
buffer_load_dwordx4 a[248:251], v1, s[4:7], s52 offen offset:3072 sc1
v_mfma_f32_16x16x32_bf16 v[88:91], a[24:27], a[148:151], v[88:91]
v_mul_f32 v147, v147, v199
v_mfma_f32_16x16x32_bf16 v[92:95], a[28:31], a[144:147], v[92:95]
v_mfma_f32_16x16x32_bf16 v[96:99], a[28:31], a[148:151], v[96:99]
v_mul_f32 v192, v148, v148
v_mfma_f32_16x16x32_bf16 v[100:103], a[32:35], a[144:147], v[100:103]
v_mfma_f32_16x16x32_bf16 v[104:107], a[32:35], a[148:151], v[104:107]
s_waitcnt vmcnt(20) lgkmcnt(0)
s_barrier
v_mfma_f32_16x16x32_bf16 v[36:39], a[36:39], a[152:155], v[36:39]
ds_read_b128 a[0:3], v201 offset:0
buffer_load_dwordx4 a[252:255], v9, s[4:7], s52 offen offset:3072 sc1
v_mfma_f32_16x16x32_bf16 v[40:43], a[36:39], a[156:159], v[40:43]
ds_read_b128 a[4:7], v201 offset:1024
v_mul_f32 v193, v149, v149
v_mfma_f32_16x16x32_bf16 v[44:47], a[40:43], a[152:155], v[44:47]
ds_read_b128 a[8:11], v201 offset:2048
v_mul_f32 v194, v150, v150
v_mfma_f32_16x16x32_bf16 v[48:51], a[40:43], a[156:159], v[48:51]
ds_read_b128 a[12:15], v201 offset:3072
v_mfma_f32_16x16x32_bf16 v[52:55], a[44:47], a[152:155], v[52:55]
ds_read_b128 a[16:19], v201 offset:4096
v_mul_f32 v195, v151, v151
v_mfma_f32_16x16x32_bf16 v[56:59], a[44:47], a[156:159], v[56:59]
ds_read_b128 a[20:23], v201 offset:5120
v_mfma_f32_16x16x32_bf16 v[60:63], a[48:51], a[152:155], v[60:63]
ds_read_b128 a[24:27], v201 offset:6144
v_fma_f32 v192, v192, v252, v250
v_mfma_f32_16x16x32_bf16 v[64:67], a[48:51], a[156:159], v[64:67]
ds_read_b128 a[28:31], v201 offset:7168
v_mfma_f32_16x16x32_bf16 v[68:71], a[52:55], a[152:155], v[68:71]
ds_read_b128 a[32:35], v201 offset:8192
v_mfma_f32_16x16x32_bf16 v[72:75], a[52:55], a[156:159], v[72:75]
s_cmp_eq_u32 s25, 6
s_cselect_b32 s99, 36864, 0
s_add_u32 s60, s60, s99
v_mfma_f32_16x16x32_bf16 v[76:79], a[56:59], a[152:155], v[76:79]
s_add_u32 s61, s61, s99
s_add_u32 m0, s62, 53248
s_add_u32 s60, s60, 16384
v_mfma_f32_16x16x32_bf16 v[80:83], a[56:59], a[156:159], v[80:83]
buffer_load_dwordx4 v1, s[8:11], s60 offen offset:0 sc1 lds
v_fma_f32 v193, v193, v252, v250
v_mfma_f32_16x16x32_bf16 v[84:87], a[60:63], a[152:155], v[84:87]
v_fma_f32 v194, v194, v252, v250
v_mfma_f32_16x16x32_bf16 v[88:91], a[60:63], a[156:159], v[88:91]
buffer_load_dwordx4 v1, s[8:11], s60 offen offset:1024 sc1 lds
v_fma_f32 v195, v195, v252, v250
v_mfma_f32_16x16x32_bf16 v[92:95], a[64:67], a[152:155], v[92:95]
v_mfma_f32_16x16x32_bf16 v[96:99], a[64:67], a[156:159], v[96:99]
buffer_load_dwordx4 v1, s[8:11], s60 offen offset:2048 sc1 lds
v_mfma_f32_16x16x32_bf16 v[100:103], a[68:71], a[152:155], v[100:103]
v_mul_f32 v192, v192, v148
v_mfma_f32_16x16x32_bf16 v[104:107], a[68:71], a[156:159], v[104:107]
s_waitcnt lgkmcnt(0)
v_mfma_f32_16x16x32_bf16 v[36:39], a[0:3], a[160:163], v[36:39]
ds_read_b128 a[36:39], v201 offset:9216
buffer_load_dwordx4 v1, s[8:11], s60 offen offset:3072 sc1 lds
v_mfma_f32_16x16x32_bf16 v[40:43], a[0:3], a[164:167], v[40:43]
ds_read_b128 a[40:43], v201 offset:10240
v_mul_f32 v193, v193, v149
v_mfma_f32_16x16x32_bf16 v[44:47], a[4:7], a[160:163], v[44:47]
ds_read_b128 a[44:47], v201 offset:11264
s_add_u32 m0, s63, 69632
v_mfma_f32_16x16x32_bf16 v[48:51], a[4:7], a[164:167], v[48:51]
ds_read_b128 a[48:51], v201 offset:12288
v_mul_f32 v194, v194, v150
v_mfma_f32_16x16x32_bf16 v[52:55], a[8:11], a[160:163], v[52:55]
ds_read_b128 a[52:55], v201 offset:13312
s_add_u32 s61, s61, 36864
v_mfma_f32_16x16x32_bf16 v[56:59], a[8:11], a[164:167], v[56:59]
ds_read_b128 a[56:59], v201 offset:14336
v_mul_f32 v195, v195, v151
v_mfma_f32_16x16x32_bf16 v[60:63], a[12:15], a[160:163], v[60:63]
ds_read_b128 a[60:63], v201 offset:15360
buffer_load_dwordx4 v1, s[8:11], s61 offen offset:0 sc1 lds
v_mfma_f32_16x16x32_bf16 v[64:67], a[12:15], a[164:167], v[64:67]
ds_read_b128 a[64:67], v201 offset:16384
v_mfma_f32_16x16x32_bf16 v[68:71], a[16:19], a[160:163], v[68:71]
ds_read_b128 a[68:71], v201 offset:17408
s_add_u32 m0, s62, 73728
v_mfma_f32_16x16x32_bf16 v[72:75], a[16:19], a[164:167], v[72:75]
s_add_u32 s60, s60, 20480
v_exp_f32 v192, v192
v_mfma_f32_16x16x32_bf16 v[76:79], a[20:23], a[160:163], v[76:79]
v_mfma_f32_16x16x32_bf16 v[80:83], a[20:23], a[164:167], v[80:83]
v_mfma_f32_16x16x32_bf16 v[84:87], a[24:27], a[160:163], v[84:87]
buffer_load_dwordx4 v1, s[8:11], s60 offen offset:0 sc1 lds
v_mfma_f32_16x16x32_bf16 v[88:91], a[24:27], a[164:167], v[88:91]
v_exp_f32 v193, v193
v_mfma_f32_16x16x32_bf16 v[92:95], a[28:31], a[160:163], v[92:95]
buffer_load_dwordx4 v1, s[8:11], s60 offen offset:1024 sc1 lds
v_mfma_f32_16x16x32_bf16 v[96:99], a[28:31], a[164:167], v[96:99]
v_mfma_f32_16x16x32_bf16 v[100:103], a[32:35], a[160:163], v[100:103]
v_mfma_f32_16x16x32_bf16 v[104:107], a[32:35], a[164:167], v[104:107]
s_waitcnt lgkmcnt(0)
v_mfma_f32_16x16x32_bf16 v[36:39], a[36:39], a[168:171], v[36:39]
ds_read_b128 a[0:3], v201 offset:18432
buffer_load_dwordx4 v1, s[8:11], s60 offen offset:2048 sc1 lds
v_mfma_f32_16x16x32_bf16 v[40:43], a[36:39], a[172:175], v[40:43]
ds_read_b128 a[4:7], v201 offset:19456
v_mfma_f32_16x16x32_bf16 v[44:47], a[40:43], a[168:171], v[44:47]
ds_read_b128 a[8:11], v201 offset:20480
buffer_load_dwordx4 v1, s[8:11], s60 offen offset:3072 sc1 lds
v_mfma_f32_16x16x32_bf16 v[48:51], a[40:43], a[172:175], v[48:51]
ds_read_b128 a[12:15], v201 offset:21504
v_mfma_f32_16x16x32_bf16 v[52:55], a[44:47], a[168:171], v[52:55]
ds_read_b128 a[16:19], v201 offset:22528
v_mfma_f32_16x16x32_bf16 v[56:59], a[44:47], a[172:175], v[56:59]
ds_read_b128 a[20:23], v201 offset:23552
v_mfma_f32_16x16x32_bf16 v[60:63], a[48:51], a[168:171], v[60:63]
ds_read_b128 a[24:27], v201 offset:24576
v_mfma_f32_16x16x32_bf16 v[64:67], a[48:51], a[172:175], v[64:67]
ds_read_b128 a[28:31], v201 offset:25600
v_mfma_f32_16x16x32_bf16 v[68:71], a[52:55], a[168:171], v[68:71]
ds_read_b128 a[32:35], v201 offset:26624
v_mfma_f32_16x16x32_bf16 v[72:75], a[52:55], a[172:175], v[72:75]
s_cmp_eq_u32 s25, 7
s_cselect_b32 s98, 4096, 0
s_add_u32 s52, s52, s98
v_mfma_f32_16x16x32_bf16 v[76:79], a[56:59], a[168:171], v[76:79]
s_add_u32 s52, s52, 4096
v_exp_f32 v194, v194
v_mfma_f32_16x16x32_bf16 v[80:83], a[56:59], a[172:175], v[80:83]
v_exp_f32 v195, v195
v_mfma_f32_16x16x32_bf16 v[84:87], a[60:63], a[168:171], v[84:87]
buffer_load_dwordx4 a[80:83], v1, s[4:7], s52 offen offset:0 sc1
v_fma_f32 v192, v192, v254, v254
v_mfma_f32_16x16x32_bf16 v[88:91], a[60:63], a[172:175], v[88:91]
v_fma_f32 v193, v193, v254, v254
v_fma_f32 v194, v194, v254, v254
v_mfma_f32_16x16x32_bf16 v[92:95], a[64:67], a[168:171], v[92:95]
buffer_load_dwordx4 a[84:87], v9, s[4:7], s52 offen offset:0 sc1
v_mfma_f32_16x16x32_bf16 v[96:99], a[64:67], a[172:175], v[96:99]
v_fma_f32 v195, v195, v254, v254
v_mfma_f32_16x16x32_bf16 v[100:103], a[68:71], a[168:171], v[100:103]
v_mfma_f32_16x16x32_bf16 v[104:107], a[68:71], a[172:175], v[104:107]
s_waitcnt lgkmcnt(0)
v_mfma_f32_16x16x32_bf16 v[36:39], a[0:3], a[176:179], v[36:39]
ds_read_b128 a[36:39], v201 offset:27648
buffer_load_dwordx4 a[88:91], v1, s[4:7], s52 offen offset:1024 sc1
v_mfma_f32_16x16x32_bf16 v[40:43], a[0:3], a[180:183], v[40:43]
ds_read_b128 a[40:43], v201 offset:28672
v_mfma_f32_16x16x32_bf16 v[44:47], a[4:7], a[176:179], v[44:47]
ds_read_b128 a[44:47], v201 offset:29696
v_mfma_f32_16x16x32_bf16 v[48:51], a[4:7], a[180:183], v[48:51]
ds_read_b128 a[48:51], v201 offset:30720
v_mfma_f32_16x16x32_bf16 v[52:55], a[8:11], a[176:179], v[52:55]
ds_read_b128 a[52:55], v201 offset:31744
buffer_load_dwordx4 a[92:95], v9, s[4:7], s52 offen offset:1024 sc1
v_mfma_f32_16x16x32_bf16 v[56:59], a[8:11], a[180:183], v[56:59]
ds_read_b128 a[56:59], v201 offset:32768
v_mfma_f32_16x16x32_bf16 v[60:63], a[12:15], a[176:179], v[60:63]
ds_read_b128 a[60:63], v201 offset:33792
v_mfma_f32_16x16x32_bf16 v[64:67], a[12:15], a[180:183], v[64:67]
ds_read_b128 a[64:67], v201 offset:34816
v_mfma_f32_16x16x32_bf16 v[68:71], a[16:19], a[176:179], v[68:71]
ds_read_b128 a[68:71], v201 offset:35840
buffer_load_dwordx4 a[96:99], v1, s[4:7], s52 offen offset:2048 sc1
v_mfma_f32_16x16x32_bf16 v[72:75], a[16:19], a[180:183], v[72:75]
v_rcp_f32 v192, v192
v_mfma_f32_16x16x32_bf16 v[76:79], a[20:23], a[176:179], v[76:79]
v_rcp_f32 v193, v193
v_mfma_f32_16x16x32_bf16 v[80:83], a[20:23], a[180:183], v[80:83]
v_rcp_f32 v194, v194
v_mfma_f32_16x16x32_bf16 v[84:87], a[24:27], a[176:179], v[84:87]
buffer_load_dwordx4 a[100:103], v9, s[4:7], s52 offen offset:2048 sc1
v_mfma_f32_16x16x32_bf16 v[88:91], a[24:27], a[180:183], v[88:91]
v_mfma_f32_16x16x32_bf16 v[92:95], a[28:31], a[176:179], v[92:95]
v_rcp_f32 v195, v195
v_mfma_f32_16x16x32_bf16 v[96:99], a[28:31], a[180:183], v[96:99]
v_mfma_f32_16x16x32_bf16 v[100:103], a[32:35], a[176:179], v[100:103]
v_mfma_f32_16x16x32_bf16 v[104:107], a[32:35], a[180:183], v[104:107]
s_waitcnt vmcnt(23) lgkmcnt(0)
s_barrier
v_mfma_f32_16x16x32_bf16 v[36:39], a[36:39], a[184:187], v[36:39]
ds_read_b128 a[0:3], v202 offset:0
buffer_load_dwordx4 a[104:107], v1, s[4:7], s52 offen offset:3072 sc1
v_mfma_f32_16x16x32_bf16 v[40:43], a[36:39], a[188:191], v[40:43]
ds_read_b128 a[4:7], v202 offset:1024
buffer_load_dwordx4 a[108:111], v9, s[4:7], s52 offen offset:3072 sc1
v_mfma_f32_16x16x32_bf16 v[44:47], a[40:43], a[184:187], v[44:47]
ds_read_b128 a[8:11], v202 offset:2048
v_mul_f32 v148, v148, v192
v_mfma_f32_16x16x32_bf16 v[48:51], a[40:43], a[188:191], v[48:51]
ds_read_b128 a[12:15], v202 offset:3072
v_mul_f32 v149, v149, v193
v_mfma_f32_16x16x32_bf16 v[52:55], a[44:47], a[184:187], v[52:55]
ds_read_b128 a[16:19], v202 offset:4096
v_mfma_f32_16x16x32_bf16 v[56:59], a[44:47], a[188:191], v[56:59]
ds_read_b128 a[20:23], v202 offset:5120
v_mul_f32 v150, v150, v194
v_mfma_f32_16x16x32_bf16 v[60:63], a[48:51], a[184:187], v[60:63]
ds_read_b128 a[24:27], v202 offset:6144
v_mfma_f32_16x16x32_bf16 v[64:67], a[48:51], a[188:191], v[64:67]
ds_read_b128 a[28:31], v202 offset:7168
v_mul_f32 v151, v151, v195
v_mfma_f32_16x16x32_bf16 v[68:71], a[52:55], a[184:187], v[68:71]
ds_read_b128 a[32:35], v202 offset:8192
v_mfma_f32_16x16x32_bf16 v[72:75], a[52:55], a[188:191], v[72:75]
s_cmp_eq_u32 s25, 7
s_cselect_b32 s99, 36864, 0
s_add_u32 s60, s60, s99
v_mfma_f32_16x16x32_bf16 v[76:79], a[56:59], a[184:187], v[76:79]
s_add_u32 s61, s61, s99
s_add_u32 m0, s62, 90112
v_mul_f32 v196, v152, v152
v_mfma_f32_16x16x32_bf16 v[80:83], a[56:59], a[188:191], v[80:83]
s_add_u32 s60, s60, 16384
v_mfma_f32_16x16x32_bf16 v[84:87], a[60:63], a[184:187], v[84:87]
v_mul_f32 v197, v153, v153
v_mfma_f32_16x16x32_bf16 v[88:91], a[60:63], a[188:191], v[88:91]
buffer_load_dwordx4 v1, s[8:11], s60 offen offset:0 sc1 lds
v_mfma_f32_16x16x32_bf16 v[92:95], a[64:67], a[184:187], v[92:95]
v_mul_f32 v198, v154, v154
v_mfma_f32_16x16x32_bf16 v[96:99], a[64:67], a[188:191], v[96:99]
buffer_load_dwordx4 v1, s[8:11], s60 offen offset:1024 sc1 lds
v_mfma_f32_16x16x32_bf16 v[100:103], a[68:71], a[184:187], v[100:103]
v_mfma_f32_16x16x32_bf16 v[104:107], a[68:71], a[188:191], v[104:107]
v_mul_f32 v199, v155, v155
s_waitcnt lgkmcnt(0)
v_mfma_f32_16x16x32_bf16 v[36:39], a[0:3], a[192:195], v[36:39]
ds_read_b128 a[36:39], v202 offset:9216
buffer_load_dwordx4 v1, s[8:11], s60 offen offset:2048 sc1 lds
v_mfma_f32_16x16x32_bf16 v[40:43], a[0:3], a[196:199], v[40:43]
ds_read_b128 a[40:43], v202 offset:10240
v_fma_f32 v196, v196, v253, v251
v_mfma_f32_16x16x32_bf16 v[44:47], a[4:7], a[192:195], v[44:47]
ds_read_b128 a[44:47], v202 offset:11264
buffer_load_dwordx4 v1, s[8:11], s60 offen offset:3072 sc1 lds
v_mfma_f32_16x16x32_bf16 v[48:51], a[4:7], a[196:199], v[48:51]
ds_read_b128 a[48:51], v202 offset:12288
v_mfma_f32_16x16x32_bf16 v[52:55], a[8:11], a[192:195], v[52:55]
ds_read_b128 a[52:55], v202 offset:13312
s_add_u32 m0, s63, 106496
v_mfma_f32_16x16x32_bf16 v[56:59], a[8:11], a[196:199], v[56:59]
ds_read_b128 a[56:59], v202 offset:14336
v_fma_f32 v197, v197, v253, v251
v_mfma_f32_16x16x32_bf16 v[60:63], a[12:15], a[192:195], v[60:63]
ds_read_b128 a[60:63], v202 offset:15360
s_add_u32 s61, s61, 36864
v_mfma_f32_16x16x32_bf16 v[64:67], a[12:15], a[196:199], v[64:67]
ds_read_b128 a[64:67], v202 offset:16384
v_fma_f32 v198, v198, v253, v251
v_mfma_f32_16x16x32_bf16 v[68:71], a[16:19], a[192:195], v[68:71]
ds_read_b128 a[68:71], v202 offset:17408
buffer_load_dwordx4 v1, s[8:11], s61 offen offset:0 sc1 lds
v_mfma_f32_16x16x32_bf16 v[72:75], a[16:19], a[196:199], v[72:75]
s_add_u32 m0, s62, 110592
v_fma_f32 v199, v199, v253, v251
v_mfma_f32_16x16x32_bf16 v[76:79], a[20:23], a[192:195], v[76:79]
s_add_u32 s60, s60, 20480
v_mfma_f32_16x16x32_bf16 v[80:83], a[20:23], a[196:199], v[80:83]
v_mul_f32 v196, v196, v152
v_mfma_f32_16x16x32_bf16 v[84:87], a[24:27], a[192:195], v[84:87]
v_mfma_f32_16x16x32_bf16 v[88:91], a[24:27], a[196:199], v[88:91]
v_mul_f32 v197, v197, v153
v_mfma_f32_16x16x32_bf16 v[92:95], a[28:31], a[192:195], v[92:95]
buffer_load_dwordx4 v1, s[8:11], s60 offen offset:0 sc1 lds
v_mfma_f32_16x16x32_bf16 v[96:99], a[28:31], a[196:199], v[96:99]
v_mul_f32 v198, v198, v154
v_mfma_f32_16x16x32_bf16 v[100:103], a[32:35], a[192:195], v[100:103]
v_mfma_f32_16x16x32_bf16 v[104:107], a[32:35], a[196:199], v[104:107]
s_waitcnt lgkmcnt(0)
v_mfma_f32_16x16x32_bf16 v[36:39], a[36:39], a[200:203], v[36:39]
ds_read_b128 a[0:3], v202 offset:18432
buffer_load_dwordx4 v1, s[8:11], s60 offen offset:1024 sc1 lds
v_mfma_f32_16x16x32_bf16 v[40:43], a[36:39], a[204:207], v[40:43]
ds_read_b128 a[4:7], v202 offset:19456
v_mul_f32 v199, v199, v155
v_mfma_f32_16x16x32_bf16 v[44:47], a[40:43], a[200:203], v[44:47]
ds_read_b128 a[8:11], v202 offset:20480
buffer_load_dwordx4 v1, s[8:11], s60 offen offset:2048 sc1 lds
v_mfma_f32_16x16x32_bf16 v[48:51], a[40:43], a[204:207], v[48:51]
ds_read_b128 a[12:15], v202 offset:21504
v_mfma_f32_16x16x32_bf16 v[52:55], a[44:47], a[200:203], v[52:55]
ds_read_b128 a[16:19], v202 offset:22528
buffer_load_dwordx4 v1, s[8:11], s60 offen offset:3072 sc1 lds
v_mfma_f32_16x16x32_bf16 v[56:59], a[44:47], a[204:207], v[56:59]
ds_read_b128 a[20:23], v202 offset:23552
v_mfma_f32_16x16x32_bf16 v[60:63], a[48:51], a[200:203], v[60:63]
ds_read_b128 a[24:27], v202 offset:24576
v_mfma_f32_16x16x32_bf16 v[64:67], a[48:51], a[204:207], v[64:67]
ds_read_b128 a[28:31], v202 offset:25600
v_mfma_f32_16x16x32_bf16 v[68:71], a[52:55], a[200:203], v[68:71]
ds_read_b128 a[32:35], v202 offset:26624
v_mfma_f32_16x16x32_bf16 v[72:75], a[52:55], a[204:207], v[72:75]
s_cmp_eq_u32 s25, 8
s_cselect_b32 s98, 4096, 0
v_mfma_f32_16x16x32_bf16 v[76:79], a[56:59], a[200:203], v[76:79]
s_add_u32 s52, s52, s98
v_exp_f32 v196, v196
v_mfma_f32_16x16x32_bf16 v[80:83], a[56:59], a[204:207], v[80:83]
s_add_u32 s52, s52, 4096
v_exp_f32 v197, v197
v_mfma_f32_16x16x32_bf16 v[84:87], a[60:63], a[200:203], v[84:87]
v_exp_f32 v198, v198
v_mfma_f32_16x16x32_bf16 v[88:91], a[60:63], a[204:207], v[88:91]
v_mfma_f32_16x16x32_bf16 v[92:95], a[64:67], a[200:203], v[92:95]
buffer_load_dwordx4 a[112:115], v1, s[4:7], s52 offen offset:0 sc1
v_mfma_f32_16x16x32_bf16 v[96:99], a[64:67], a[204:207], v[96:99]
v_mfma_f32_16x16x32_bf16 v[100:103], a[68:71], a[200:203], v[100:103]
v_exp_f32 v199, v199
v_mfma_f32_16x16x32_bf16 v[104:107], a[68:71], a[204:207], v[104:107]
s_waitcnt lgkmcnt(0)
v_mfma_f32_16x16x32_bf16 v[36:39], a[0:3], a[208:211], v[36:39]
ds_read_b128 a[36:39], v202 offset:27648
buffer_load_dwordx4 a[116:119], v9, s[4:7], s52 offen offset:0 sc1
v_mfma_f32_16x16x32_bf16 v[40:43], a[0:3], a[212:215], v[40:43]
ds_read_b128 a[40:43], v202 offset:28672
v_mfma_f32_16x16x32_bf16 v[44:47], a[4:7], a[208:211], v[44:47]
ds_read_b128 a[44:47], v202 offset:29696
v_mfma_f32_16x16x32_bf16 v[48:51], a[4:7], a[212:215], v[48:51]
ds_read_b128 a[48:51], v202 offset:30720
v_fma_f32 v196, v196, v255, v255
v_mfma_f32_16x16x32_bf16 v[52:55], a[8:11], a[208:211], v[52:55]
ds_read_b128 a[52:55], v202 offset:31744
buffer_load_dwordx4 a[120:123], v1, s[4:7], s52 offen offset:1024 sc1
v_mfma_f32_16x16x32_bf16 v[56:59], a[8:11], a[212:215], v[56:59]
ds_read_b128 a[56:59], v202 offset:32768
v_fma_f32 v197, v197, v255, v255
v_mfma_f32_16x16x32_bf16 v[60:63], a[12:15], a[208:211], v[60:63]
ds_read_b128 a[60:63], v202 offset:33792
v_mfma_f32_16x16x32_bf16 v[64:67], a[12:15], a[212:215], v[64:67]
ds_read_b128 a[64:67], v202 offset:34816
v_mfma_f32_16x16x32_bf16 v[68:71], a[16:19], a[208:211], v[68:71]
ds_read_b128 a[68:71], v202 offset:35840
buffer_load_dwordx4 a[124:127], v9, s[4:7], s52 offen offset:1024 sc1
v_mfma_f32_16x16x32_bf16 v[72:75], a[16:19], a[212:215], v[72:75]
v_fma_f32 v198, v198, v255, v255
v_mfma_f32_16x16x32_bf16 v[76:79], a[20:23], a[208:211], v[76:79]
v_fma_f32 v199, v199, v255, v255
v_mfma_f32_16x16x32_bf16 v[80:83], a[20:23], a[212:215], v[80:83]
v_mfma_f32_16x16x32_bf16 v[84:87], a[24:27], a[208:211], v[84:87]
buffer_load_dwordx4 a[128:131], v1, s[4:7], s52 offen offset:2048 sc1
v_mfma_f32_16x16x32_bf16 v[88:91], a[24:27], a[212:215], v[88:91]
v_rcp_f32 v196, v196
v_mfma_f32_16x16x32_bf16 v[92:95], a[28:31], a[208:211], v[92:95]
v_mfma_f32_16x16x32_bf16 v[96:99], a[28:31], a[212:215], v[96:99]
v_mfma_f32_16x16x32_bf16 v[100:103], a[32:35], a[208:211], v[100:103]
v_mfma_f32_16x16x32_bf16 v[104:107], a[32:35], a[212:215], v[104:107]
s_waitcnt vmcnt(22) lgkmcnt(0)
s_barrier
v_mfma_f32_16x16x32_bf16 v[36:39], a[36:39], a[216:219], v[36:39]
ds_read_b128 a[0:3], v200 offset:0
buffer_load_dwordx4 a[132:135], v9, s[4:7], s52 offen offset:2048 sc1
v_mfma_f32_16x16x32_bf16 v[40:43], a[36:39], a[220:223], v[40:43]
ds_read_b128 a[4:7], v200 offset:1024
buffer_load_dwordx4 a[136:139], v1, s[4:7], s52 offen offset:3072 sc1
v_mfma_f32_16x16x32_bf16 v[44:47], a[40:43], a[216:219], v[44:47]
ds_read_b128 a[8:11], v200 offset:2048
v_mfma_f32_16x16x32_bf16 v[48:51], a[40:43], a[220:223], v[48:51]
ds_read_b128 a[12:15], v200 offset:3072
buffer_load_dwordx4 a[140:143], v9, s[4:7], s52 offen offset:3072 sc1
v_mfma_f32_16x16x32_bf16 v[52:55], a[44:47], a[216:219], v[52:55]
ds_read_b128 a[16:19], v200 offset:4096
v_mfma_f32_16x16x32_bf16 v[56:59], a[44:47], a[220:223], v[56:59]
ds_read_b128 a[20:23], v200 offset:5120
v_mfma_f32_16x16x32_bf16 v[60:63], a[48:51], a[216:219], v[60:63]
ds_read_b128 a[24:27], v200 offset:6144
v_mfma_f32_16x16x32_bf16 v[64:67], a[48:51], a[220:223], v[64:67]
ds_read_b128 a[28:31], v200 offset:7168
v_mfma_f32_16x16x32_bf16 v[68:71], a[52:55], a[216:219], v[68:71]
ds_read_b128 a[32:35], v200 offset:8192
v_mfma_f32_16x16x32_bf16 v[72:75], a[52:55], a[220:223], v[72:75]
s_cmp_eq_u32 s25, 8
s_cselect_b32 s99, 36864, 0
s_add_u32 s60, s60, s99
v_mfma_f32_16x16x32_bf16 v[76:79], a[56:59], a[216:219], v[76:79]
s_add_u32 s61, s61, s99
v_rcp_f32 v197, v197
v_mfma_f32_16x16x32_bf16 v[80:83], a[56:59], a[220:223], v[80:83]
s_add_u32 m0, s62, 126976
v_rcp_f32 v198, v198
v_mfma_f32_16x16x32_bf16 v[84:87], a[60:63], a[216:219], v[84:87]
s_add_u32 s60, s60, 16384
v_rcp_f32 v199, v199
v_mfma_f32_16x16x32_bf16 v[88:91], a[60:63], a[220:223], v[88:91]
v_mul_f32 v152, v152, v196
v_mfma_f32_16x16x32_bf16 v[92:95], a[64:67], a[216:219], v[92:95]
v_mfma_f32_16x16x32_bf16 v[96:99], a[64:67], a[220:223], v[96:99]
buffer_load_dwordx4 v1, s[8:11], s60 offen offset:0 sc1 lds
v_mfma_f32_16x16x32_bf16 v[100:103], a[68:71], a[216:219], v[100:103]
v_mul_f32 v153, v153, v197
v_mfma_f32_16x16x32_bf16 v[104:107], a[68:71], a[220:223], v[104:107]
s_waitcnt lgkmcnt(0)
v_mfma_f32_16x16x32_bf16 v[36:39], a[0:3], a[224:227], v[36:39]
ds_read_b128 a[36:39], v200 offset:9216
buffer_load_dwordx4 v1, s[8:11], s60 offen offset:1024 sc1 lds
v_mfma_f32_16x16x32_bf16 v[40:43], a[0:3], a[228:231], v[40:43]
ds_read_b128 a[40:43], v200 offset:10240
v_mul_f32 v154, v154, v198
v_mfma_f32_16x16x32_bf16 v[44:47], a[4:7], a[224:227], v[44:47]
ds_read_b128 a[44:47], v200 offset:11264
buffer_load_dwordx4 v1, s[8:11], s60 offen offset:2048 sc1 lds
v_mfma_f32_16x16x32_bf16 v[48:51], a[4:7], a[228:231], v[48:51]
ds_read_b128 a[48:51], v200 offset:12288
v_mul_f32 v155, v155, v199
v_mfma_f32_16x16x32_bf16 v[52:55], a[8:11], a[224:227], v[52:55]
ds_read_b128 a[52:55], v200 offset:13312
v_mfma_f32_16x16x32_bf16 v[56:59], a[8:11], a[228:231], v[56:59]
ds_read_b128 a[56:59], v200 offset:14336
buffer_load_dwordx4 v1, s[8:11], s60 offen offset:3072 sc1 lds
v_mfma_f32_16x16x32_bf16 v[60:63], a[12:15], a[224:227], v[60:63]
ds_read_b128 a[60:63], v200 offset:15360
v_mul_f32 v192, v156, v156
v_mfma_f32_16x16x32_bf16 v[64:67], a[12:15], a[228:231], v[64:67]
ds_read_b128 a[64:67], v200 offset:16384
v_mul_f32 v193, v157, v157
v_mfma_f32_16x16x32_bf16 v[68:71], a[16:19], a[224:227], v[68:71]
ds_read_b128 a[68:71], v200 offset:17408
s_add_u32 m0, s63, 143360
v_mfma_f32_16x16x32_bf16 v[72:75], a[16:19], a[228:231], v[72:75]
s_add_u32 s61, s61, 36864
v_mul_f32 v194, v158, v158
v_mfma_f32_16x16x32_bf16 v[76:79], a[20:23], a[224:227], v[76:79]
v_mfma_f32_16x16x32_bf16 v[80:83], a[20:23], a[228:231], v[80:83]
v_mfma_f32_16x16x32_bf16 v[84:87], a[24:27], a[224:227], v[84:87]
v_mul_f32 v195, v159, v159
v_mfma_f32_16x16x32_bf16 v[88:91], a[24:27], a[228:231], v[88:91]
v_mfma_f32_16x16x32_bf16 v[92:95], a[28:31], a[224:227], v[92:95]
buffer_load_dwordx4 v1, s[8:11], s61 offen offset:0 sc1 lds
v_fma_f32 v192, v192, v252, v250
v_mfma_f32_16x16x32_bf16 v[96:99], a[28:31], a[228:231], v[96:99]
v_mfma_f32_16x16x32_bf16 v[100:103], a[32:35], a[224:227], v[100:103]
v_fma_f32 v193, v193, v252, v250
v_mfma_f32_16x16x32_bf16 v[104:107], a[32:35], a[228:231], v[104:107]
s_waitcnt lgkmcnt(0)
v_mfma_f32_16x16x32_bf16 v[36:39], a[36:39], a[232:235], v[36:39]
ds_read_b128 a[0:3], v200 offset:18432
s_add_u32 m0, s62, 147456
v_mfma_f32_16x16x32_bf16 v[40:43], a[36:39], a[236:239], v[40:43]
ds_read_b128 a[4:7], v200 offset:19456
v_fma_f32 v194, v194, v252, v250
v_mfma_f32_16x16x32_bf16 v[44:47], a[40:43], a[232:235], v[44:47]
ds_read_b128 a[8:11], v200 offset:20480
s_add_u32 s60, s60, 20480
v_mfma_f32_16x16x32_bf16 v[48:51], a[40:43], a[236:239], v[48:51]
ds_read_b128 a[12:15], v200 offset:21504
v_fma_f32 v195, v195, v252, v250
v_mfma_f32_16x16x32_bf16 v[52:55], a[44:47], a[232:235], v[52:55]
ds_read_b128 a[16:19], v200 offset:22528
v_mfma_f32_16x16x32_bf16 v[56:59], a[44:47], a[236:239], v[56:59]
ds_read_b128 a[20:23], v200 offset:23552
buffer_load_dwordx4 v1, s[8:11], s60 offen offset:0 sc1 lds
v_mfma_f32_16x16x32_bf16 v[60:63], a[48:51], a[232:235], v[60:63]
ds_read_b128 a[24:27], v200 offset:24576
v_mul_f32 v192, v192, v156
v_mfma_f32_16x16x32_bf16 v[64:67], a[48:51], a[236:239], v[64:67]
ds_read_b128 a[28:31], v200 offset:25600
v_mfma_f32_16x16x32_bf16 v[68:71], a[52:55], a[232:235], v[68:71]
ds_read_b128 a[32:35], v200 offset:26624
buffer_load_dwordx4 v1, s[8:11], s60 offen offset:1024 sc1 lds
v_mfma_f32_16x16x32_bf16 v[72:75], a[52:55], a[236:239], v[72:75]
v_mul_f32 v193, v193, v157
v_mfma_f32_16x16x32_bf16 v[76:79], a[56:59], a[232:235], v[76:79]
v_mul_f32 v194, v194, v158
v_mfma_f32_16x16x32_bf16 v[80:83], a[56:59], a[236:239], v[80:83]
buffer_load_dwordx4 v1, s[8:11], s60 offen offset:2048 sc1 lds
v_mfma_f32_16x16x32_bf16 v[84:87], a[60:63], a[232:235], v[84:87]
v_mfma_f32_16x16x32_bf16 v[88:91], a[60:63], a[236:239], v[88:91]
v_mul_f32 v195, v195, v159
v_mfma_f32_16x16x32_bf16 v[92:95], a[64:67], a[232:235], v[92:95]
buffer_load_dwordx4 v1, s[8:11], s60 offen offset:3072 sc1 lds
v_mfma_f32_16x16x32_bf16 v[96:99], a[64:67], a[236:239], v[96:99]
v_exp_f32 v192, v192
v_mfma_f32_16x16x32_bf16 v[100:103], a[68:71], a[232:235], v[100:103]
v_mfma_f32_16x16x32_bf16 v[104:107], a[68:71], a[236:239], v[104:107]
s_waitcnt lgkmcnt(0)
v_mfma_f32_16x16x32_bf16 v[36:39], a[0:3], a[240:243], v[36:39]
ds_read_b128 a[36:39], v200 offset:27648
v_mfma_f32_16x16x32_bf16 v[40:43], a[0:3], a[244:247], v[40:43]
ds_read_b128 a[40:43], v200 offset:28672
v_mfma_f32_16x16x32_bf16 v[44:47], a[4:7], a[240:243], v[44:47]
ds_read_b128 a[44:47], v200 offset:29696
v_mfma_f32_16x16x32_bf16 v[48:51], a[4:7], a[244:247], v[48:51]
ds_read_b128 a[48:51], v200 offset:30720
v_mfma_f32_16x16x32_bf16 v[52:55], a[8:11], a[240:243], v[52:55]
ds_read_b128 a[52:55], v200 offset:31744
v_mfma_f32_16x16x32_bf16 v[56:59], a[8:11], a[244:247], v[56:59]
ds_read_b128 a[56:59], v200 offset:32768
v_mfma_f32_16x16x32_bf16 v[60:63], a[12:15], a[240:243], v[60:63]
ds_read_b128 a[60:63], v200 offset:33792
v_mfma_f32_16x16x32_bf16 v[64:67], a[12:15], a[244:247], v[64:67]
ds_read_b128 a[64:67], v200 offset:34816
v_mfma_f32_16x16x32_bf16 v[68:71], a[16:19], a[240:243], v[68:71]
ds_read_b128 a[68:71], v200 offset:35840
v_mfma_f32_16x16x32_bf16 v[72:75], a[16:19], a[244:247], v[72:75]
s_cmp_eq_u32 s25, 9
s_cselect_b32 s98, 4096, 0
s_add_u32 s52, s52, s98
v_mfma_f32_16x16x32_bf16 v[76:79], a[20:23], a[240:243], v[76:79]
s_add_u32 s52, s52, 4096
v_exp_f32 v193, v193
v_mfma_f32_16x16x32_bf16 v[80:83], a[20:23], a[244:247], v[80:83]
buffer_load_dwordx4 a[144:147], v1, s[4:7], s52 offen offset:0 sc1
v_mfma_f32_16x16x32_bf16 v[84:87], a[24:27], a[240:243], v[84:87]
buffer_load_dwordx4 a[148:151], v9, s[4:7], s52 offen offset:0 sc1
v_mfma_f32_16x16x32_bf16 v[88:91], a[24:27], a[244:247], v[88:91]
buffer_load_dwordx4 a[152:155], v1, s[4:7], s52 offen offset:1024 sc1
v_mfma_f32_16x16x32_bf16 v[92:95], a[28:31], a[240:243], v[92:95]
buffer_load_dwordx4 a[156:159], v9, s[4:7], s52 offen offset:1024 sc1
v_mfma_f32_16x16x32_bf16 v[96:99], a[28:31], a[244:247], v[96:99]
v_exp_f32 v194, v194
v_mfma_f32_16x16x32_bf16 v[100:103], a[32:35], a[240:243], v[100:103]
v_exp_f32 v195, v195
v_mfma_f32_16x16x32_bf16 v[104:107], a[32:35], a[244:247], v[104:107]
s_waitcnt vmcnt(21) lgkmcnt(0)
s_barrier
v_mfma_f32_16x16x32_bf16 v[36:39], a[36:39], a[248:251], v[36:39]
ds_read_b128 a[0:3], v201 offset:0
v_fma_f32 v192, v192, v254, v254
v_mfma_f32_16x16x32_bf16 v[40:43], a[36:39], a[252:255], v[40:43]
ds_read_b128 a[4:7], v201 offset:1024
v_fma_f32 v193, v193, v254, v254
v_mfma_f32_16x16x32_bf16 v[44:47], a[40:43], a[248:251], v[44:47]
ds_read_b128 a[8:11], v201 offset:2048
v_fma_f32 v194, v194, v254, v254
v_mfma_f32_16x16x32_bf16 v[48:51], a[40:43], a[252:255], v[48:51]
ds_read_b128 a[12:15], v201 offset:3072
v_mfma_f32_16x16x32_bf16 v[52:55], a[44:47], a[248:251], v[52:55]
ds_read_b128 a[16:19], v201 offset:4096
v_mfma_f32_16x16x32_bf16 v[56:59], a[44:47], a[252:255], v[56:59]
ds_read_b128 a[20:23], v201 offset:5120
v_fma_f32 v195, v195, v254, v254
v_mfma_f32_16x16x32_bf16 v[60:63], a[48:51], a[248:251], v[60:63]
ds_read_b128 a[24:27], v201 offset:6144
v_mfma_f32_16x16x32_bf16 v[64:67], a[48:51], a[252:255], v[64:67]
ds_read_b128 a[28:31], v201 offset:7168
v_mfma_f32_16x16x32_bf16 v[68:71], a[52:55], a[248:251], v[68:71]
ds_read_b128 a[32:35], v201 offset:8192
v_mfma_f32_16x16x32_bf16 v[72:75], a[52:55], a[252:255], v[72:75]
s_cmp_eq_u32 s25, 9
s_cselect_b32 s99, 36864, 0
s_add_u32 s60, s60, s99
v_mfma_f32_16x16x32_bf16 v[76:79], a[56:59], a[248:251], v[76:79]
s_add_u32 s61, s61, s99
s_add_u32 m0, s62, 53248
s_add_u32 s60, s60, 16384
v_mfma_f32_16x16x32_bf16 v[80:83], a[56:59], a[252:255], v[80:83]
buffer_load_dwordx4 v1, s[8:11], s60 offen offset:0 sc1 lds
v_mfma_f32_16x16x32_bf16 v[84:87], a[60:63], a[248:251], v[84:87]
buffer_load_dwordx4 v1, s[8:11], s60 offen offset:1024 sc1 lds
v_mfma_f32_16x16x32_bf16 v[88:91], a[60:63], a[252:255], v[88:91]
buffer_load_dwordx4 v1, s[8:11], s60 offen offset:2048 sc1 lds
v_mfma_f32_16x16x32_bf16 v[92:95], a[64:67], a[248:251], v[92:95]
v_rcp_f32 v192, v192
v_mfma_f32_16x16x32_bf16 v[96:99], a[64:67], a[252:255], v[96:99]
buffer_load_dwordx4 v1, s[8:11], s60 offen offset:3072 sc1 lds
v_mfma_f32_16x16x32_bf16 v[100:103], a[68:71], a[248:251], v[100:103]
v_rcp_f32 v193, v193
v_mfma_f32_16x16x32_bf16 v[104:107], a[68:71], a[252:255], v[104:107]
s_waitcnt lgkmcnt(0)
v_mfma_f32_16x16x32_bf16 v[36:39], a[0:3], a[80:83], v[36:39]
ds_read_b128 a[36:39], v201 offset:9216
s_add_u32 m0, s63, 69632
v_mfma_f32_16x16x32_bf16 v[40:43], a[0:3], a[84:87], v[40:43]
ds_read_b128 a[40:43], v201 offset:10240
v_mfma_f32_16x16x32_bf16 v[44:47], a[4:7], a[80:83], v[44:47]
ds_read_b128 a[44:47], v201 offset:11264
s_add_u32 s61, s61, 36864
v_mfma_f32_16x16x32_bf16 v[48:51], a[4:7], a[84:87], v[48:51]
ds_read_b128 a[48:51], v201 offset:12288
v_mfma_f32_16x16x32_bf16 v[52:55], a[8:11], a[80:83], v[52:55]
ds_read_b128 a[52:55], v201 offset:13312
buffer_load_dwordx4 v1, s[8:11], s61 offen offset:0 sc1 lds
v_mfma_f32_16x16x32_bf16 v[56:59], a[8:11], a[84:87], v[56:59]
ds_read_b128 a[56:59], v201 offset:14336
v_mfma_f32_16x16x32_bf16 v[60:63], a[12:15], a[80:83], v[60:63]
ds_read_b128 a[60:63], v201 offset:15360
s_add_u32 m0, s62, 73728
v_mfma_f32_16x16x32_bf16 v[64:67], a[12:15], a[84:87], v[64:67]
ds_read_b128 a[64:67], v201 offset:16384
v_mfma_f32_16x16x32_bf16 v[68:71], a[16:19], a[80:83], v[68:71]
ds_read_b128 a[68:71], v201 offset:17408
s_add_u32 s60, s60, 20480
v_mfma_f32_16x16x32_bf16 v[72:75], a[16:19], a[84:87], v[72:75]
v_rcp_f32 v194, v194
v_mfma_f32_16x16x32_bf16 v[76:79], a[20:23], a[80:83], v[76:79]
buffer_load_dwordx4 v1, s[8:11], s60 offen offset:0 sc1 lds
v_mfma_f32_16x16x32_bf16 v[80:83], a[20:23], a[84:87], v[80:83]
v_rcp_f32 v195, v195
v_mfma_f32_16x16x32_bf16 v[84:87], a[24:27], a[80:83], v[84:87]
buffer_load_dwordx4 v1, s[8:11], s60 offen offset:1024 sc1 lds
v_mul_f32 v156, v156, v192
v_mfma_f32_16x16x32_bf16 v[88:91], a[24:27], a[84:87], v[88:91]
v_mul_f32 v157, v157, v193
v_mul_f32 v158, v158, v194
v_mfma_f32_16x16x32_bf16 v[92:95], a[28:31], a[80:83], v[92:95]
buffer_load_dwordx4 v1, s[8:11], s60 offen offset:2048 sc1 lds
v_mfma_f32_16x16x32_bf16 v[96:99], a[28:31], a[84:87], v[96:99]
v_mul_f32 v159, v159, v195
v_mfma_f32_16x16x32_bf16 v[100:103], a[32:35], a[80:83], v[100:103]
v_mfma_f32_16x16x32_bf16 v[104:107], a[32:35], a[84:87], v[104:107]
v_mul_f32 v196, v160, v160
s_waitcnt lgkmcnt(0)
v_mfma_f32_16x16x32_bf16 v[36:39], a[36:39], a[88:91], v[36:39]
ds_read_b128 a[0:3], v201 offset:18432
buffer_load_dwordx4 v1, s[8:11], s60 offen offset:3072 sc1 lds
v_mfma_f32_16x16x32_bf16 v[40:43], a[36:39], a[92:95], v[40:43]
ds_read_b128 a[4:7], v201 offset:19456
v_mfma_f32_16x16x32_bf16 v[44:47], a[40:43], a[88:91], v[44:47]
ds_read_b128 a[8:11], v201 offset:20480
v_mul_f32 v197, v161, v161
v_mfma_f32_16x16x32_bf16 v[48:51], a[40:43], a[92:95], v[48:51]
ds_read_b128 a[12:15], v201 offset:21504
v_mfma_f32_16x16x32_bf16 v[52:55], a[44:47], a[88:91], v[52:55]
ds_read_b128 a[16:19], v201 offset:22528
buffer_load_dwordx4 a[160:163], v1, s[4:7], s52 offen offset:2048 sc1
v_mfma_f32_16x16x32_bf16 v[56:59], a[44:47], a[92:95], v[56:59]
ds_read_b128 a[20:23], v201 offset:23552
v_mul_f32 v198, v162, v162
v_mfma_f32_16x16x32_bf16 v[60:63], a[48:51], a[88:91], v[60:63]
ds_read_b128 a[24:27], v201 offset:24576
v_mfma_f32_16x16x32_bf16 v[64:67], a[48:51], a[92:95], v[64:67]
ds_read_b128 a[28:31], v201 offset:25600
v_mul_f32 v199, v163, v163
v_mfma_f32_16x16x32_bf16 v[68:71], a[52:55], a[88:91], v[68:71]
ds_read_b128 a[32:35], v201 offset:26624
buffer_load_dwordx4 a[164:167], v9, s[4:7], s52 offen offset:2048 sc1
v_mfma_f32_16x16x32_bf16 v[72:75], a[52:55], a[92:95], v[72:75]
v_fma_f32 v196, v196, v253, v251
v_mfma_f32_16x16x32_bf16 v[76:79], a[56:59], a[88:91], v[76:79]
v_mfma_f32_16x16x32_bf16 v[80:83], a[56:59], a[92:95], v[80:83]
v_fma_f32 v197, v197, v253, v251
v_mfma_f32_16x16x32_bf16 v[84:87], a[60:63], a[88:91], v[84:87]
buffer_load_dwordx4 a[168:171], v1, s[4:7], s52 offen offset:3072 sc1
v_mfma_f32_16x16x32_bf16 v[88:91], a[60:63], a[92:95], v[88:91]
v_mfma_f32_16x16x32_bf16 v[92:95], a[64:67], a[88:91], v[92:95]
v_fma_f32 v198, v198, v253, v251
v_mfma_f32_16x16x32_bf16 v[96:99], a[64:67], a[92:95], v[96:99]
v_mfma_f32_16x16x32_bf16 v[100:103], a[68:71], a[88:91], v[100:103]
v_fma_f32 v199, v199, v253, v251
v_mfma_f32_16x16x32_bf16 v[104:107], a[68:71], a[92:95], v[104:107]
s_waitcnt lgkmcnt(0)
v_mfma_f32_16x16x32_bf16 v[36:39], a[0:3], a[96:99], v[36:39]
ds_read_b128 a[36:39], v201 offset:27648
buffer_load_dwordx4 a[172:175], v9, s[4:7], s52 offen offset:3072 sc1
v_mfma_f32_16x16x32_bf16 v[40:43], a[0:3], a[100:103], v[40:43]
ds_read_b128 a[40:43], v201 offset:28672
v_mul_f32 v196, v196, v160
v_mfma_f32_16x16x32_bf16 v[44:47], a[4:7], a[96:99], v[44:47]
ds_read_b128 a[44:47], v201 offset:29696
v_mfma_f32_16x16x32_bf16 v[48:51], a[4:7], a[100:103], v[48:51]
ds_read_b128 a[48:51], v201 offset:30720
v_mul_f32 v197, v197, v161
v_mfma_f32_16x16x32_bf16 v[52:55], a[8:11], a[96:99], v[52:55]
ds_read_b128 a[52:55], v201 offset:31744
v_mfma_f32_16x16x32_bf16 v[56:59], a[8:11], a[100:103], v[56:59]
ds_read_b128 a[56:59], v201 offset:32768
v_mul_f32 v198, v198, v162
v_mfma_f32_16x16x32_bf16 v[60:63], a[12:15], a[96:99], v[60:63]
ds_read_b128 a[60:63], v201 offset:33792
v_mfma_f32_16x16x32_bf16 v[64:67], a[12:15], a[100:103], v[64:67]
ds_read_b128 a[64:67], v201 offset:34816
v_mul_f32 v199, v199, v163
v_mfma_f32_16x16x32_bf16 v[68:71], a[16:19], a[96:99], v[68:71]
ds_read_b128 a[68:71], v201 offset:35840
v_mfma_f32_16x16x32_bf16 v[72:75], a[16:19], a[100:103], v[72:75]
s_cmp_eq_u32 s25, 10
s_cselect_b32 s98, 4096, 0
s_add_u32 s52, s52, s98
v_mfma_f32_16x16x32_bf16 v[76:79], a[20:23], a[96:99], v[76:79]
s_add_u32 s52, s52, 4096
v_exp_f32 v196, v196
v_mfma_f32_16x16x32_bf16 v[80:83], a[20:23], a[100:103], v[80:83]
buffer_load_dwordx4 a[176:179], v1, s[4:7], s52 offen offset:0 sc1
v_mfma_f32_16x16x32_bf16 v[84:87], a[24:27], a[96:99], v[84:87]
buffer_load_dwordx4 a[180:183], v9, s[4:7], s52 offen offset:0 sc1
v_mfma_f32_16x16x32_bf16 v[88:91], a[24:27], a[100:103], v[88:91]
v_mfma_f32_16x16x32_bf16 v[92:95], a[28:31], a[96:99], v[92:95]
buffer_load_dwordx4 a[184:187], v1, s[4:7], s52 offen offset:1024 sc1
v_mfma_f32_16x16x32_bf16 v[96:99], a[28:31], a[100:103], v[96:99]
v_exp_f32 v197, v197
v_mfma_f32_16x16x32_bf16 v[100:103], a[32:35], a[96:99], v[100:103]
v_mfma_f32_16x16x32_bf16 v[104:107], a[32:35], a[100:103], v[104:107]
s_waitcnt vmcnt(20) lgkmcnt(0)
s_barrier
v_mfma_f32_16x16x32_bf16 v[36:39], a[36:39], a[104:107], v[36:39]
ds_read_b128 a[0:3], v202 offset:0
buffer_load_dwordx4 a[188:191], v9, s[4:7], s52 offen offset:1024 sc1
v_mfma_f32_16x16x32_bf16 v[40:43], a[36:39], a[108:111], v[40:43]
ds_read_b128 a[4:7], v202 offset:1024
v_mfma_f32_16x16x32_bf16 v[44:47], a[40:43], a[104:107], v[44:47]
ds_read_b128 a[8:11], v202 offset:2048
v_mfma_f32_16x16x32_bf16 v[48:51], a[40:43], a[108:111], v[48:51]
ds_read_b128 a[12:15], v202 offset:3072
v_mfma_f32_16x16x32_bf16 v[52:55], a[44:47], a[104:107], v[52:55]
ds_read_b128 a[16:19], v202 offset:4096
v_mfma_f32_16x16x32_bf16 v[56:59], a[44:47], a[108:111], v[56:59]
ds_read_b128 a[20:23], v202 offset:5120
v_mfma_f32_16x16x32_bf16 v[60:63], a[48:51], a[104:107], v[60:63]
ds_read_b128 a[24:27], v202 offset:6144
v_mfma_f32_16x16x32_bf16 v[64:67], a[48:51], a[108:111], v[64:67]
ds_read_b128 a[28:31], v202 offset:7168
v_mfma_f32_16x16x32_bf16 v[68:71], a[52:55], a[104:107], v[68:71]
ds_read_b128 a[32:35], v202 offset:8192
v_mfma_f32_16x16x32_bf16 v[72:75], a[52:55], a[108:111], v[72:75]
s_cmp_eq_u32 s25, 10
s_cselect_b32 s99, 36864, 0
s_add_u32 s60, s60, s99
v_mfma_f32_16x16x32_bf16 v[76:79], a[56:59], a[104:107], v[76:79]
s_add_u32 s61, s61, s99
s_add_u32 m0, s62, 90112
s_add_u32 s60, s60, 16384
v_mfma_f32_16x16x32_bf16 v[80:83], a[56:59], a[108:111], v[80:83]
buffer_load_dwordx4 v1, s[8:11], s60 offen offset:0 sc1 lds
v_mfma_f32_16x16x32_bf16 v[84:87], a[60:63], a[104:107], v[84:87]
v_exp_f32 v198, v198
v_mfma_f32_16x16x32_bf16 v[88:91], a[60:63], a[108:111], v[88:91]
buffer_load_dwordx4 v1, s[8:11], s60 offen offset:1024 sc1 lds
v_mfma_f32_16x16x32_bf16 v[92:95], a[64:67], a[104:107], v[92:95]
v_exp_f32 v199, v199
v_mfma_f32_16x16x32_bf16 v[96:99], a[64:67], a[108:111], v[96:99]
buffer_load_dwordx4 v1, s[8:11], s60 offen offset:2048 sc1 lds
v_fma_f32 v196, v196, v255, v255
v_mfma_f32_16x16x32_bf16 v[100:103], a[68:71], a[104:107], v[100:103]
v_fma_f32 v197, v197, v255, v255
v_fma_f32 v198, v198, v255, v255
v_mfma_f32_16x16x32_bf16 v[104:107], a[68:71], a[108:111], v[104:107]
s_waitcnt lgkmcnt(0)
v_mfma_f32_16x16x32_bf16 v[36:39], a[0:3], a[112:115], v[36:39]
ds_read_b128 a[36:39], v202 offset:9216
buffer_load_dwordx4 v1, s[8:11], s60 offen offset:3072 sc1 lds
v_mfma_f32_16x16x32_bf16 v[40:43], a[0:3], a[116:119], v[40:43]
ds_read_b128 a[40:43], v202 offset:10240
s_mov_b32 s37, L_c5-L_pc
v_mfma_f32_16x16x32_bf16 v[44:47], a[4:7], a[112:115], v[44:47]
ds_read_b128 a[44:47], v202 offset:11264
s_add_u32 m0, s63, 106496
v_mfma_f32_16x16x32_bf16 v[48:51], a[4:7], a[116:119], v[48:51]
ds_read_b128 a[48:51], v202 offset:12288
v_fma_f32 v199, v199, v255, v255
v_mfma_f32_16x16x32_bf16 v[52:55], a[8:11], a[112:115], v[52:55]
ds_read_b128 a[52:55], v202 offset:13312
buffer_load_dword v15, v14, s[88:91], s37 offen
v_mfma_f32_16x16x32_bf16 v[56:59], a[8:11], a[116:119], v[56:59]
ds_read_b128 a[56:59], v202 offset:14336
s_add_u32 s61, s61, 36864
v_mfma_f32_16x16x32_bf16 v[60:63], a[12:15], a[112:115], v[60:63]
ds_read_b128 a[60:63], v202 offset:15360
buffer_load_dwordx4 v1, s[8:11], s61 offen offset:0 sc1 lds
v_mfma_f32_16x16x32_bf16 v[64:67], a[12:15], a[116:119], v[64:67]
ds_read_b128 a[64:67], v202 offset:16384
v_mfma_f32_16x16x32_bf16 v[68:71], a[16:19], a[112:115], v[68:71]
ds_read_b128 a[68:71], v202 offset:17408
s_add_u32 m0, s62, 110592
v_mfma_f32_16x16x32_bf16 v[72:75], a[16:19], a[116:119], v[72:75]
s_add_u32 s60, s60, 20480
v_rcp_f32 v196, v196
v_mfma_f32_16x16x32_bf16 v[76:79], a[20:23], a[112:115], v[76:79]
v_rcp_f32 v197, v197
v_mfma_f32_16x16x32_bf16 v[80:83], a[20:23], a[116:119], v[80:83]
v_rcp_f32 v198, v198
v_mfma_f32_16x16x32_bf16 v[84:87], a[24:27], a[112:115], v[84:87]
buffer_load_dwordx4 v1, s[8:11], s60 offen offset:0 sc1 lds
v_mfma_f32_16x16x32_bf16 v[88:91], a[24:27], a[116:119], v[88:91]
v_mfma_f32_16x16x32_bf16 v[92:95], a[28:31], a[112:115], v[92:95]
buffer_load_dwordx4 v1, s[8:11], s60 offen offset:1024 sc1 lds
v_mfma_f32_16x16x32_bf16 v[96:99], a[28:31], a[116:119], v[96:99]
v_mfma_f32_16x16x32_bf16 v[100:103], a[32:35], a[112:115], v[100:103]
v_rcp_f32 v199, v199
v_mfma_f32_16x16x32_bf16 v[104:107], a[32:35], a[116:119], v[104:107]
s_waitcnt lgkmcnt(0)
v_mfma_f32_16x16x32_bf16 v[36:39], a[36:39], a[120:123], v[36:39]
ds_read_b128 a[0:3], v202 offset:18432
buffer_load_dwordx4 v1, s[8:11], s60 offen offset:2048 sc1 lds
v_mfma_f32_16x16x32_bf16 v[40:43], a[36:39], a[124:127], v[40:43]
ds_read_b128 a[4:7], v202 offset:19456
v_mfma_f32_16x16x32_bf16 v[44:47], a[40:43], a[120:123], v[44:47]
ds_read_b128 a[8:11], v202 offset:20480
v_mfma_f32_16x16x32_bf16 v[48:51], a[40:43], a[124:127], v[48:51]
ds_read_b128 a[12:15], v202 offset:21504
v_mul_f32 v160, v160, v196
v_mfma_f32_16x16x32_bf16 v[52:55], a[44:47], a[120:123], v[52:55]
ds_read_b128 a[16:19], v202 offset:22528
buffer_load_dwordx4 v1, s[8:11], s60 offen offset:3072 sc1 lds
v_mfma_f32_16x16x32_bf16 v[56:59], a[44:47], a[124:127], v[56:59]
ds_read_b128 a[20:23], v202 offset:23552
v_mul_f32 v161, v161, v197
v_mfma_f32_16x16x32_bf16 v[60:63], a[48:51], a[120:123], v[60:63]
ds_read_b128 a[24:27], v202 offset:24576
v_mfma_f32_16x16x32_bf16 v[64:67], a[48:51], a[124:127], v[64:67]
ds_read_b128 a[28:31], v202 offset:25600
v_mfma_f32_16x16x32_bf16 v[68:71], a[52:55], a[120:123], v[68:71]
ds_read_b128 a[32:35], v202 offset:26624
buffer_load_dwordx4 a[192:195], v1, s[4:7], s52 offen offset:2048 sc1
v_mfma_f32_16x16x32_bf16 v[72:75], a[52:55], a[124:127], v[72:75]
v_mul_f32 v162, v162, v198
v_mfma_f32_16x16x32_bf16 v[76:79], a[56:59], a[120:123], v[76:79]
v_mul_f32 v163, v163, v199
v_mfma_f32_16x16x32_bf16 v[80:83], a[56:59], a[124:127], v[80:83]
v_mfma_f32_16x16x32_bf16 v[84:87], a[60:63], a[120:123], v[84:87]
buffer_load_dwordx4 a[196:199], v9, s[4:7], s52 offen offset:2048 sc1
v_mul_f32 v192, v164, v164
v_mfma_f32_16x16x32_bf16 v[88:91], a[60:63], a[124:127], v[88:91]
v_mfma_f32_16x16x32_bf16 v[92:95], a[64:67], a[120:123], v[92:95]
v_mfma_f32_16x16x32_bf16 v[96:99], a[64:67], a[124:127], v[96:99]
v_mul_f32 v193, v165, v165
v_mfma_f32_16x16x32_bf16 v[100:103], a[68:71], a[120:123], v[100:103]
v_mfma_f32_16x16x32_bf16 v[104:107], a[68:71], a[124:127], v[104:107]
v_mul_f32 v194, v166, v166
s_waitcnt lgkmcnt(0)
v_mfma_f32_16x16x32_bf16 v[36:39], a[0:3], a[128:131], v[36:39]
ds_read_b128 a[36:39], v202 offset:27648
buffer_load_dwordx4 a[200:203], v1, s[4:7], s52 offen offset:3072 sc1
v_mfma_f32_16x16x32_bf16 v[40:43], a[0:3], a[132:135], v[40:43]
ds_read_b128 a[40:43], v202 offset:28672
v_mul_f32 v195, v167, v167
v_mfma_f32_16x16x32_bf16 v[44:47], a[4:7], a[128:131], v[44:47]
ds_read_b128 a[44:47], v202 offset:29696
buffer_load_dwordx4 a[204:207], v9, s[4:7], s52 offen offset:3072 sc1
v_mfma_f32_16x16x32_bf16 v[48:51], a[4:7], a[132:135], v[48:51]
ds_read_b128 a[48:51], v202 offset:30720
v_mfma_f32_16x16x32_bf16 v[52:55], a[8:11], a[128:131], v[52:55]
ds_read_b128 a[52:55], v202 offset:31744
v_fma_f32 v192, v192, v252, v250
v_mfma_f32_16x16x32_bf16 v[56:59], a[8:11], a[132:135], v[56:59]
ds_read_b128 a[56:59], v202 offset:32768
v_mfma_f32_16x16x32_bf16 v[60:63], a[12:15], a[128:131], v[60:63]
ds_read_b128 a[60:63], v202 offset:33792
v_fma_f32 v193, v193, v252, v250
v_mfma_f32_16x16x32_bf16 v[64:67], a[12:15], a[132:135], v[64:67]
ds_read_b128 a[64:67], v202 offset:34816
v_mfma_f32_16x16x32_bf16 v[68:71], a[16:19], a[128:131], v[68:71]
ds_read_b128 a[68:71], v202 offset:35840
v_fma_f32 v194, v194, v252, v250
v_mfma_f32_16x16x32_bf16 v[72:75], a[16:19], a[132:135], v[72:75]
s_cmp_eq_u32 s25, 11
s_cselect_b32 s98, 4096, 0
s_add_u32 s52, s52, s98
v_mfma_f32_16x16x32_bf16 v[76:79], a[20:23], a[128:131], v[76:79]
s_add_u32 s52, s52, 4096
v_mfma_f32_16x16x32_bf16 v[80:83], a[20:23], a[132:135], v[80:83]
v_fma_f32 v195, v195, v252, v250
v_mfma_f32_16x16x32_bf16 v[84:87], a[24:27], a[128:131], v[84:87]
buffer_load_dwordx4 a[208:211], v1, s[4:7], s52 offen offset:0 sc1
v_mfma_f32_16x16x32_bf16 v[88:91], a[24:27], a[132:135], v[88:91]
v_mul_f32 v192, v192, v164
v_mfma_f32_16x16x32_bf16 v[92:95], a[28:31], a[128:131], v[92:95]
buffer_load_dwordx4 a[212:215], v9, s[4:7], s52 offen offset:0 sc1
v_mfma_f32_16x16x32_bf16 v[96:99], a[28:31], a[132:135], v[96:99]
v_mfma_f32_16x16x32_bf16 v[100:103], a[32:35], a[128:131], v[100:103]
v_mul_f32 v193, v193, v165
v_mfma_f32_16x16x32_bf16 v[104:107], a[32:35], a[132:135], v[104:107]
s_waitcnt vmcnt(24) lgkmcnt(0)
s_barrier
v_mfma_f32_16x16x32_bf16 v[36:39], a[36:39], a[136:139], v[36:39]
ds_read_b128 a[0:3], v200 offset:0
buffer_load_dwordx4 a[216:219], v1, s[4:7], s52 offen offset:1024 sc1
v_mfma_f32_16x16x32_bf16 v[40:43], a[36:39], a[140:143], v[40:43]
ds_read_b128 a[4:7], v200 offset:1024
buffer_load_dwordx4 a[220:223], v9, s[4:7], s52 offen offset:1024 sc1
v_mfma_f32_16x16x32_bf16 v[44:47], a[40:43], a[136:139], v[44:47]
ds_read_b128 a[8:11], v200 offset:2048
v_mul_f32 v194, v194, v166
v_mfma_f32_16x16x32_bf16 v[48:51], a[40:43], a[140:143], v[48:51]
ds_read_b128 a[12:15], v200 offset:3072
v_mul_f32 v195, v195, v167
v_mfma_f32_16x16x32_bf16 v[52:55], a[44:47], a[136:139], v[52:55]
ds_read_b128 a[16:19], v200 offset:4096
v_mfma_f32_16x16x32_bf16 v[56:59], a[44:47], a[140:143], v[56:59]
ds_read_b128 a[20:23], v200 offset:5120
v_mfma_f32_16x16x32_bf16 v[60:63], a[48:51], a[136:139], v[60:63]
ds_read_b128 a[24:27], v200 offset:6144
v_mfma_f32_16x16x32_bf16 v[64:67], a[48:51], a[140:143], v[64:67]
ds_read_b128 a[28:31], v200 offset:7168
v_mfma_f32_16x16x32_bf16 v[68:71], a[52:55], a[136:139], v[68:71]
ds_read_b128 a[32:35], v200 offset:8192
v_mfma_f32_16x16x32_bf16 v[72:75], a[52:55], a[140:143], v[72:75]
s_cmp_eq_u32 s25, 11
s_cselect_b32 s99, 36864, 0
s_add_u32 s60, s60, s99
v_mfma_f32_16x16x32_bf16 v[76:79], a[56:59], a[136:139], v[76:79]
s_add_u32 s61, s61, s99
s_add_u32 m0, s62, 126976
v_mfma_f32_16x16x32_bf16 v[80:83], a[56:59], a[140:143], v[80:83]
s_add_u32 s60, s60, 16384
v_exp_f32 v192, v192
v_mfma_f32_16x16x32_bf16 v[84:87], a[60:63], a[136:139], v[84:87]
v_exp_f32 v193, v193
v_mfma_f32_16x16x32_bf16 v[88:91], a[60:63], a[140:143], v[88:91]
buffer_load_dwordx4 v1, s[8:11], s60 offen offset:0 sc1 lds
v_mfma_f32_16x16x32_bf16 v[92:95], a[64:67], a[136:139], v[92:95]
v_exp_f32 v194, v194
v_mfma_f32_16x16x32_bf16 v[96:99], a[64:67], a[140:143], v[96:99]
buffer_load_dwordx4 v1, s[8:11], s60 offen offset:1024 sc1 lds
v_mfma_f32_16x16x32_bf16 v[100:103], a[68:71], a[136:139], v[100:103]
v_mfma_f32_16x16x32_bf16 v[104:107], a[68:71], a[140:143], v[104:107]
s_waitcnt lgkmcnt(0)
v_mfma_f32_16x16x32_bf16 v[36:39], a[0:3], a[144:147], v[36:39]
ds_read_b128 a[36:39], v200 offset:9216
buffer_load_dwordx4 v1, s[8:11], s60 offen offset:2048 sc1 lds
v_mfma_f32_16x16x32_bf16 v[40:43], a[0:3], a[148:151], v[40:43]
ds_read_b128 a[40:43], v200 offset:10240
v_mfma_f32_16x16x32_bf16 v[44:47], a[4:7], a[144:147], v[44:47]
ds_read_b128 a[44:47], v200 offset:11264
buffer_load_dwordx4 v1, s[8:11], s60 offen offset:3072 sc1 lds
v_mfma_f32_16x16x32_bf16 v[48:51], a[4:7], a[148:151], v[48:51]
ds_read_b128 a[48:51], v200 offset:12288
v_mfma_f32_16x16x32_bf16 v[52:55], a[8:11], a[144:147], v[52:55]
ds_read_b128 a[52:55], v200 offset:13312
s_add_u32 m0, s63, 143360
v_mfma_f32_16x16x32_bf16 v[56:59], a[8:11], a[148:151], v[56:59]
ds_read_b128 a[56:59], v200 offset:14336
v_mfma_f32_16x16x32_bf16 v[60:63], a[12:15], a[144:147], v[60:63]
ds_read_b128 a[60:63], v200 offset:15360
s_add_u32 s61, s61, 36864
v_mfma_f32_16x16x32_bf16 v[64:67], a[12:15], a[148:151], v[64:67]
ds_read_b128 a[64:67], v200 offset:16384
v_mfma_f32_16x16x32_bf16 v[68:71], a[16:19], a[144:147], v[68:71]
ds_read_b128 a[68:71], v200 offset:17408
buffer_load_dwordx4 v1, s[8:11], s61 offen offset:0 sc1 lds
v_mfma_f32_16x16x32_bf16 v[72:75], a[16:19], a[148:151], v[72:75]
s_add_u32 m0, s62, 147456
v_exp_f32 v195, v195
v_mfma_f32_16x16x32_bf16 v[76:79], a[20:23], a[144:147], v[76:79]
s_add_u32 s60, s60, 20480
v_fma_f32 v192, v192, v254, v254
v_fma_f32 v193, v193, v254, v254
v_mfma_f32_16x16x32_bf16 v[80:83], a[20:23], a[148:151], v[80:83]
v_fma_f32 v194, v194, v254, v254
v_mfma_f32_16x16x32_bf16 v[84:87], a[24:27], a[144:147], v[84:87]
v_mfma_f32_16x16x32_bf16 v[88:91], a[24:27], a[148:151], v[88:91]
v_fma_f32 v195, v195, v254, v254
v_mfma_f32_16x16x32_bf16 v[92:95], a[28:31], a[144:147], v[92:95]
buffer_load_dwordx4 v1, s[8:11], s60 offen offset:0 sc1 lds
v_mfma_f32_16x16x32_bf16 v[96:99], a[28:31], a[148:151], v[96:99]
v_rcp_f32 v192, v192
v_mfma_f32_16x16x32_bf16 v[100:103], a[32:35], a[144:147], v[100:103]
v_mfma_f32_16x16x32_bf16 v[104:107], a[32:35], a[148:151], v[104:107]
s_waitcnt vmcnt(28) lgkmcnt(0)
v_mfma_f32_16x16x32_bf16 v[36:39], a[36:39], a[152:155], v[36:39]
ds_read_b128 a[0:3], v200 offset:18432
buffer_load_dwordx4 v1, s[8:11], s60 offen offset:1024 sc1 lds
v_mfma_f32_16x16x32_bf16 v[40:43], a[36:39], a[156:159], v[40:43]
ds_read_b128 a[4:7], v200 offset:19456
v_mfma_f32_16x16x32_bf16 v[44:47], a[40:43], a[152:155], v[44:47]
ds_read_b128 a[8:11], v200 offset:20480
v_mfma_f32_16x16x32_bf16 v[48:51], a[40:43], a[156:159], v[48:51]
ds_read_b128 a[12:15], v200 offset:21504
v_mfma_f32_16x16x32_bf16 v[52:55], a[44:47], a[152:155], v[52:55]
ds_read_b128 a[16:19], v200 offset:22528
buffer_load_dwordx4 v1, s[8:11], s60 offen offset:2048 sc1 lds
v_mfma_f32_16x16x32_bf16 v[56:59], a[44:47], a[156:159], v[56:59]
ds_read_b128 a[20:23], v200 offset:23552
v_mfma_f32_16x16x32_bf16 v[60:63], a[48:51], a[152:155], v[60:63]
ds_read_b128 a[24:27], v200 offset:24576
v_mfma_f32_16x16x32_bf16 v[64:67], a[48:51], a[156:159], v[64:67]
ds_read_b128 a[28:31], v200 offset:25600
v_mfma_f32_16x16x32_bf16 v[68:71], a[52:55], a[152:155], v[68:71]
ds_read_b128 a[32:35], v200 offset:26624
buffer_load_dwordx4 v1, s[8:11], s60 offen offset:3072 sc1 lds
v_mfma_f32_16x16x32_bf16 v[72:75], a[52:55], a[156:159], v[72:75]
v_rcp_f32 v193, v193
v_mfma_f32_16x16x32_bf16 v[76:79], a[56:59], a[152:155], v[76:79]
v_rcp_f32 v194, v194
v_mfma_f32_16x16x32_bf16 v[80:83], a[56:59], a[156:159], v[80:83]
v_rcp_f32 v195, v195
v_mfma_f32_16x16x32_bf16 v[84:87], a[60:63], a[152:155], v[84:87]
buffer_load_dwordx4 a[224:227], v1, s[4:7], s52 offen offset:2048 sc1
v_mfma_f32_16x16x32_bf16 v[88:91], a[60:63], a[156:159], v[88:91]
v_mfma_f32_16x16x32_bf16 v[92:95], a[64:67], a[152:155], v[92:95]
v_mfma_f32_16x16x32_bf16 v[96:99], a[64:67], a[156:159], v[96:99]
v_mfma_f32_16x16x32_bf16 v[100:103], a[68:71], a[152:155], v[100:103]
v_mul_f32 v164, v164, v192
v_mfma_f32_16x16x32_bf16 v[104:107], a[68:71], a[156:159], v[104:107]
s_waitcnt lgkmcnt(0)
v_mfma_f32_16x16x32_bf16 v[36:39], a[0:3], a[160:163], v[36:39]
ds_read_b128 a[36:39], v200 offset:27648
buffer_load_dwordx4 a[228:231], v9, s[4:7], s52 offen offset:2048 sc1
v_mfma_f32_16x16x32_bf16 v[40:43], a[0:3], a[164:167], v[40:43]
ds_read_b128 a[40:43], v200 offset:28672
v_mul_f32 v165, v165, v193
v_mfma_f32_16x16x32_bf16 v[44:47], a[4:7], a[160:163], v[44:47]
ds_read_b128 a[44:47], v200 offset:29696
buffer_load_dwordx4 a[232:235], v1, s[4:7], s52 offen offset:3072 sc1
v_mfma_f32_16x16x32_bf16 v[48:51], a[4:7], a[164:167], v[48:51]
ds_read_b128 a[48:51], v200 offset:30720
v_mul_f32 v166, v166, v194
v_mfma_f32_16x16x32_bf16 v[52:55], a[8:11], a[160:163], v[52:55]
ds_read_b128 a[52:55], v200 offset:31744
buffer_load_dwordx4 a[236:239], v9, s[4:7], s52 offen offset:3072 sc1
v_mfma_f32_16x16x32_bf16 v[56:59], a[8:11], a[164:167], v[56:59]
ds_read_b128 a[56:59], v200 offset:32768
v_mul_f32 v167, v167, v195
v_mfma_f32_16x16x32_bf16 v[60:63], a[12:15], a[160:163], v[60:63]
ds_read_b128 a[60:63], v200 offset:33792
v_mfma_f32_16x16x32_bf16 v[64:67], a[12:15], a[164:167], v[64:67]
ds_read_b128 a[64:67], v200 offset:34816
v_mul_f32 v196, v168, v168
v_mfma_f32_16x16x32_bf16 v[68:71], a[16:19], a[160:163], v[68:71]
ds_read_b128 a[68:71], v200 offset:35840
v_mfma_f32_16x16x32_bf16 v[72:75], a[16:19], a[164:167], v[72:75]
s_cmp_eq_u32 s25, 12
s_cselect_b32 s98, 4096, 0
v_mfma_f32_16x16x32_bf16 v[76:79], a[20:23], a[160:163], v[76:79]
s_add_u32 s52, s52, s98
v_mul_f32 v197, v169, v169
v_mfma_f32_16x16x32_bf16 v[80:83], a[20:23], a[164:167], v[80:83]
s_add_u32 s52, s52, 4096
v_mfma_f32_16x16x32_bf16 v[84:87], a[24:27], a[160:163], v[84:87]
v_mul_f32 v198, v170, v170
v_mfma_f32_16x16x32_bf16 v[88:91], a[24:27], a[164:167], v[88:91]
v_mfma_f32_16x16x32_bf16 v[92:95], a[28:31], a[160:163], v[92:95]
buffer_load_dwordx4 a[240:243], v1, s[4:7], s52 offen offset:0 sc1
v_mul_f32 v199, v171, v171
v_mfma_f32_16x16x32_bf16 v[96:99], a[28:31], a[164:167], v[96:99]
v_mfma_f32_16x16x32_bf16 v[100:103], a[32:35], a[160:163], v[100:103]
v_mfma_f32_16x16x32_bf16 v[104:107], a[32:35], a[164:167], v[104:107]
s_waitcnt vmcnt(22) lgkmcnt(0)
s_barrier
v_mfma_f32_16x16x32_bf16 v[36:39], a[36:39], a[168:171], v[36:39]
ds_read_b128 a[0:3], v201 offset:0
buffer_load_dwordx4 a[244:247], v9, s[4:7], s52 offen offset:0 sc1
v_mfma_f32_16x16x32_bf16 v[40:43], a[36:39], a[172:175], v[40:43]
ds_read_b128 a[4:7], v201 offset:1024
buffer_load_dwordx4 a[248:251], v1, s[4:7], s52 offen offset:1024 sc1
v_mfma_f32_16x16x32_bf16 v[44:47], a[40:43], a[168:171], v[44:47]
ds_read_b128 a[8:11], v201 offset:2048
v_fma_f32 v196, v196, v253, v251
v_mfma_f32_16x16x32_bf16 v[48:51], a[40:43], a[172:175], v[48:51]
ds_read_b128 a[12:15], v201 offset:3072
buffer_load_dwordx4 a[252:255], v9, s[4:7], s52 offen offset:1024 sc1
v_mfma_f32_16x16x32_bf16 v[52:55], a[44:47], a[168:171], v[52:55]
ds_read_b128 a[16:19], v201 offset:4096
v_fma_f32 v197, v197, v253, v251
v_mfma_f32_16x16x32_bf16 v[56:59], a[44:47], a[172:175], v[56:59]
ds_read_b128 a[20:23], v201 offset:5120
v_fma_f32 v198, v198, v253, v251
v_mfma_f32_16x16x32_bf16 v[60:63], a[48:51], a[168:171], v[60:63]
ds_read_b128 a[24:27], v201 offset:6144
v_fma_f32 v199, v199, v253, v251
v_mfma_f32_16x16x32_bf16 v[64:67], a[48:51], a[172:175], v[64:67]
ds_read_b128 a[28:31], v201 offset:7168
v_mfma_f32_16x16x32_bf16 v[68:71], a[52:55], a[168:171], v[68:71]
ds_read_b128 a[32:35], v201 offset:8192
v_mul_f32 v196, v196, v168
v_mfma_f32_16x16x32_bf16 v[72:75], a[52:55], a[172:175], v[72:75]
s_cmp_eq_u32 s25, 12
s_cselect_b32 s99, 36864, 0
s_add_u32 s60, s60, s99
v_mfma_f32_16x16x32_bf16 v[76:79], a[56:59], a[168:171], v[76:79]
s_add_u32 s61, s61, s99
v_mul_f32 v197, v197, v169
v_mfma_f32_16x16x32_bf16 v[80:83], a[56:59], a[172:175], v[80:83]
s_add_u32 m0, s62, 53248
v_mfma_f32_16x16x32_bf16 v[84:87], a[60:63], a[168:171], v[84:87]
s_add_u32 s60, s60, 16384
v_mfma_f32_16x16x32_bf16 v[88:91], a[60:63], a[172:175], v[88:91]
v_mul_f32 v198, v198, v170
v_mfma_f32_16x16x32_bf16 v[92:95], a[64:67], a[168:171], v[92:95]
v_mfma_f32_16x16x32_bf16 v[96:99], a[64:67], a[172:175], v[96:99]
buffer_load_dwordx4 v1, s[8:11], s60 offen offset:0 sc1 lds
v_mul_f32 v199, v199, v171
v_mfma_f32_16x16x32_bf16 v[100:103], a[68:71], a[168:171], v[100:103]
v_mfma_f32_16x16x32_bf16 v[104:107], a[68:71], a[172:175], v[104:107]
s_waitcnt lgkmcnt(0)
v_mfma_f32_16x16x32_bf16 v[36:39], a[0:3], a[176:179], v[36:39]
ds_read_b128 a[36:39], v201 offset:9216
buffer_load_dwordx4 v1, s[8:11], s60 offen offset:1024 sc1 lds
v_mfma_f32_16x16x32_bf16 v[40:43], a[0:3], a[180:183], v[40:43]
ds_read_b128 a[40:43], v201 offset:10240
v_mfma_f32_16x16x32_bf16 v[44:47], a[4:7], a[176:179], v[44:47]
ds_read_b128 a[44:47], v201 offset:11264
buffer_load_dwordx4 v1, s[8:11], s60 offen offset:2048 sc1 lds
v_mfma_f32_16x16x32_bf16 v[48:51], a[4:7], a[180:183], v[48:51]
ds_read_b128 a[48:51], v201 offset:12288
v_mfma_f32_16x16x32_bf16 v[52:55], a[8:11], a[176:179], v[52:55]
ds_read_b128 a[52:55], v201 offset:13312
v_mfma_f32_16x16x32_bf16 v[56:59], a[8:11], a[180:183], v[56:59]
ds_read_b128 a[56:59], v201 offset:14336
buffer_load_dwordx4 v1, s[8:11], s60 offen offset:3072 sc1 lds
v_mfma_f32_16x16x32_bf16 v[60:63], a[12:15], a[176:179], v[60:63]
ds_read_b128 a[60:63], v201 offset:15360
v_mfma_f32_16x16x32_bf16 v[64:67], a[12:15], a[180:183], v[64:67]
ds_read_b128 a[64:67], v201 offset:16384
v_mfma_f32_16x16x32_bf16 v[68:71], a[16:19], a[176:179], v[68:71]
ds_read_b128 a[68:71], v201 offset:17408
s_add_u32 m0, s63, 69632
v_mfma_f32_16x16x32_bf16 v[72:75], a[16:19], a[180:183], v[72:75]
s_add_u32 s61, s61, 36864
v_exp_f32 v196, v196
v_mfma_f32_16x16x32_bf16 v[76:79], a[20:23], a[176:179], v[76:79]
v_exp_f32 v197, v197
v_mfma_f32_16x16x32_bf16 v[80:83], a[20:23], a[180:183], v[80:83]
v_exp_f32 v198, v198
v_mfma_f32_16x16x32_bf16 v[84:87], a[24:27], a[176:179], v[84:87]
v_mfma_f32_16x16x32_bf16 v[88:91], a[24:27], a[180:183], v[88:91]
v_mfma_f32_16x16x32_bf16 v[92:95], a[28:31], a[176:179], v[92:95]
buffer_load_dwordx4 v1, s[8:11], s61 offen offset:0 sc1 lds
v_mfma_f32_16x16x32_bf16 v[96:99], a[28:31], a[180:183], v[96:99]
v_exp_f32 v199, v199
v_mfma_f32_16x16x32_bf16 v[100:103], a[32:35], a[176:179], v[100:103]
v_mfma_f32_16x16x32_bf16 v[104:107], a[32:35], a[180:183], v[104:107]
s_waitcnt vmcnt(26) lgkmcnt(0)
v_mfma_f32_16x16x32_bf16 v[36:39], a[36:39], a[184:187], v[36:39]
ds_read_b128 a[0:3], v201 offset:18432
s_add_u32 m0, s62, 73728
v_mfma_f32_16x16x32_bf16 v[40:43], a[36:39], a[188:191], v[40:43]
ds_read_b128 a[4:7], v201 offset:19456
v_fma_f32 v196, v196, v255, v255
v_mfma_f32_16x16x32_bf16 v[44:47], a[40:43], a[184:187], v[44:47]
ds_read_b128 a[8:11], v201 offset:20480
s_add_u32 s60, s60, 20480
v_mfma_f32_16x16x32_bf16 v[48:51], a[40:43], a[188:191], v[48:51]
ds_read_b128 a[12:15], v201 offset:21504
v_fma_f32 v197, v197, v255, v255
v_mfma_f32_16x16x32_bf16 v[52:55], a[44:47], a[184:187], v[52:55]
ds_read_b128 a[16:19], v201 offset:22528
v_mfma_f32_16x16x32_bf16 v[56:59], a[44:47], a[188:191], v[56:59]
ds_read_b128 a[20:23], v201 offset:23552
buffer_load_dwordx4 v1, s[8:11], s60 offen offset:0 sc1 lds
v_mfma_f32_16x16x32_bf16 v[60:63], a[48:51], a[184:187], v[60:63]
ds_read_b128 a[24:27], v201 offset:24576
v_fma_f32 v198, v198, v255, v255
v_mfma_f32_16x16x32_bf16 v[64:67], a[48:51], a[188:191], v[64:67]
ds_read_b128 a[28:31], v201 offset:25600
v_fma_f32 v199, v199, v255, v255
v_mfma_f32_16x16x32_bf16 v[68:71], a[52:55], a[184:187], v[68:71]
ds_read_b128 a[32:35], v201 offset:26624
buffer_load_dwordx4 v1, s[8:11], s60 offen offset:1024 sc1 lds
v_mfma_f32_16x16x32_bf16 v[72:75], a[52:55], a[188:191], v[72:75]
v_mfma_f32_16x16x32_bf16 v[76:79], a[56:59], a[184:187], v[76:79]
v_rcp_f32 v196, v196
v_mfma_f32_16x16x32_bf16 v[80:83], a[56:59], a[188:191], v[80:83]
buffer_load_dwordx4 v1, s[8:11], s60 offen offset:2048 sc1 lds
v_mfma_f32_16x16x32_bf16 v[84:87], a[60:63], a[184:187], v[84:87]
v_mfma_f32_16x16x32_bf16 v[88:91], a[60:63], a[188:191], v[88:91]
v_mfma_f32_16x16x32_bf16 v[92:95], a[64:67], a[184:187], v[92:95]
buffer_load_dwordx4 v1, s[8:11], s60 offen offset:3072 sc1 lds
v_mfma_f32_16x16x32_bf16 v[96:99], a[64:67], a[188:191], v[96:99]
v_rcp_f32 v197, v197
v_mfma_f32_16x16x32_bf16 v[100:103], a[68:71], a[184:187], v[100:103]
v_mfma_f32_16x16x32_bf16 v[104:107], a[68:71], a[188:191], v[104:107]
s_waitcnt lgkmcnt(0)
v_mfma_f32_16x16x32_bf16 v[36:39], a[0:3], a[192:195], v[36:39]
ds_read_b128 a[36:39], v201 offset:27648
buffer_load_dwordx4 a[80:83], v1, s[4:7], s52 offen offset:2048 sc1
v_mfma_f32_16x16x32_bf16 v[40:43], a[0:3], a[196:199], v[40:43]
ds_read_b128 a[40:43], v201 offset:28672
v_mfma_f32_16x16x32_bf16 v[44:47], a[4:7], a[192:195], v[44:47]
ds_read_b128 a[44:47], v201 offset:29696
v_mfma_f32_16x16x32_bf16 v[48:51], a[4:7], a[196:199], v[48:51]
ds_read_b128 a[48:51], v201 offset:30720
v_mfma_f32_16x16x32_bf16 v[52:55], a[8:11], a[192:195], v[52:55]
ds_read_b128 a[52:55], v201 offset:31744
buffer_load_dwordx4 a[84:87], v9, s[4:7], s52 offen offset:2048 sc1
v_mfma_f32_16x16x32_bf16 v[56:59], a[8:11], a[196:199], v[56:59]
ds_read_b128 a[56:59], v201 offset:32768
v_mfma_f32_16x16x32_bf16 v[60:63], a[12:15], a[192:195], v[60:63]
ds_read_b128 a[60:63], v201 offset:33792
v_mfma_f32_16x16x32_bf16 v[64:67], a[12:15], a[196:199], v[64:67]
ds_read_b128 a[64:67], v201 offset:34816
v_mfma_f32_16x16x32_bf16 v[68:71], a[16:19], a[192:195], v[68:71]
ds_read_b128 a[68:71], v201 offset:35840
buffer_load_dwordx4 a[88:91], v1, s[4:7], s52 offen offset:3072 sc1
v_mfma_f32_16x16x32_bf16 v[72:75], a[16:19], a[196:199], v[72:75]
v_rcp_f32 v198, v198
v_mfma_f32_16x16x32_bf16 v[76:79], a[20:23], a[192:195], v[76:79]
v_rcp_f32 v199, v199
v_mfma_f32_16x16x32_bf16 v[80:83], a[20:23], a[196:199], v[80:83]
v_mul_f32 v168, v168, v196
v_mfma_f32_16x16x32_bf16 v[84:87], a[24:27], a[192:195], v[84:87]
buffer_load_dwordx4 a[92:95], v9, s[4:7], s52 offen offset:3072 sc1
v_mfma_f32_16x16x32_bf16 v[88:91], a[24:27], a[196:199], v[88:91]
v_mul_f32 v169, v169, v197
v_mfma_f32_16x16x32_bf16 v[92:95], a[28:31], a[192:195], v[92:95]
v_mfma_f32_16x16x32_bf16 v[96:99], a[28:31], a[196:199], v[96:99]
v_mul_f32 v170, v170, v198
v_mfma_f32_16x16x32_bf16 v[100:103], a[32:35], a[192:195], v[100:103]
v_mfma_f32_16x16x32_bf16 v[104:107], a[32:35], a[196:199], v[104:107]
s_waitcnt vmcnt(21) lgkmcnt(0)
s_barrier
v_mfma_f32_16x16x32_bf16 v[36:39], a[36:39], a[200:203], v[36:39]
ds_read_b128 a[0:3], v202 offset:0
v_mul_f32 v171, v171, v199
v_mfma_f32_16x16x32_bf16 v[40:43], a[36:39], a[204:207], v[40:43]
ds_read_b128 a[4:7], v202 offset:1024
v_mfma_f32_16x16x32_bf16 v[44:47], a[40:43], a[200:203], v[44:47]
ds_read_b128 a[8:11], v202 offset:2048
v_mul_f32 v192, v172, v172
v_mfma_f32_16x16x32_bf16 v[48:51], a[40:43], a[204:207], v[48:51]
ds_read_b128 a[12:15], v202 offset:3072
v_mfma_f32_16x16x32_bf16 v[52:55], a[44:47], a[200:203], v[52:55]
ds_read_b128 a[16:19], v202 offset:4096
v_mul_f32 v193, v173, v173
v_mfma_f32_16x16x32_bf16 v[56:59], a[44:47], a[204:207], v[56:59]
ds_read_b128 a[20:23], v202 offset:5120
v_mfma_f32_16x16x32_bf16 v[60:63], a[48:51], a[200:203], v[60:63]
ds_read_b128 a[24:27], v202 offset:6144
v_mfma_f32_16x16x32_bf16 v[64:67], a[48:51], a[204:207], v[64:67]
ds_read_b128 a[28:31], v202 offset:7168
v_mul_f32 v194, v174, v174
v_mfma_f32_16x16x32_bf16 v[68:71], a[52:55], a[200:203], v[68:71]
ds_read_b128 a[32:35], v202 offset:8192
v_mfma_f32_16x16x32_bf16 v[72:75], a[52:55], a[204:207], v[72:75]
s_cmp_eq_u32 s25, 13
s_cselect_b32 s99, 36864, 0
s_add_u32 s60, s60, s99
v_mfma_f32_16x16x32_bf16 v[76:79], a[56:59], a[200:203], v[76:79]
s_add_u32 s61, s61, s99
s_add_u32 m0, s62, 90112
s_add_u32 s60, s60, 16384
v_mfma_f32_16x16x32_bf16 v[80:83], a[56:59], a[204:207], v[80:83]
buffer_load_dwordx4 v1, s[8:11], s60 offen offset:0 sc1 lds
v_mul_f32 v195, v175, v175
v_mfma_f32_16x16x32_bf16 v[84:87], a[60:63], a[200:203], v[84:87]
buffer_load_dwordx4 v1, s[8:11], s60 offen offset:1024 sc1 lds
v_fma_f32 v192, v192, v252, v250
v_mfma_f32_16x16x32_bf16 v[88:91], a[60:63], a[204:207], v[88:91]
buffer_load_dwordx4 v1, s[8:11], s60 offen offset:2048 sc1 lds
v_mfma_f32_16x16x32_bf16 v[92:95], a[64:67], a[200:203], v[92:95]
v_fma_f32 v193, v193, v252, v250
v_mfma_f32_16x16x32_bf16 v[96:99], a[64:67], a[204:207], v[96:99]
buffer_load_dwordx4 v1, s[8:11], s60 offen offset:3072 sc1 lds
v_mfma_f32_16x16x32_bf16 v[100:103], a[68:71], a[200:203], v[100:103]
v_fma_f32 v194, v194, v252, v250
v_mfma_f32_16x16x32_bf16 v[104:107], a[68:71], a[204:207], v[104:107]
s_waitcnt lgkmcnt(0)
v_mfma_f32_16x16x32_bf16 v[36:39], a[0:3], a[208:211], v[36:39]
ds_read_b128 a[36:39], v202 offset:9216
s_add_u32 m0, s63, 106496
v_mfma_f32_16x16x32_bf16 v[40:43], a[0:3], a[212:215], v[40:43]
ds_read_b128 a[40:43], v202 offset:10240
v_fma_f32 v195, v195, v252, v250
v_mfma_f32_16x16x32_bf16 v[44:47], a[4:7], a[208:211], v[44:47]
ds_read_b128 a[44:47], v202 offset:11264
s_add_u32 s61, s61, 36864
v_mfma_f32_16x16x32_bf16 v[48:51], a[4:7], a[212:215], v[48:51]
ds_read_b128 a[48:51], v202 offset:12288
v_mul_f32 v192, v192, v172
v_mfma_f32_16x16x32_bf16 v[52:55], a[8:11], a[208:211], v[52:55]
ds_read_b128 a[52:55], v202 offset:13312
buffer_load_dwordx4 v1, s[8:11], s61 offen offset:0 sc1 lds
v_mfma_f32_16x16x32_bf16 v[56:59], a[8:11], a[212:215], v[56:59]
ds_read_b128 a[56:59], v202 offset:14336
v_mul_f32 v193, v193, v173
v_mfma_f32_16x16x32_bf16 v[60:63], a[12:15], a[208:211], v[60:63]
ds_read_b128 a[60:63], v202 offset:15360
s_add_u32 m0, s62, 110592
v_mfma_f32_16x16x32_bf16 v[64:67], a[12:15], a[212:215], v[64:67]
ds_read_b128 a[64:67], v202 offset:16384
v_mfma_f32_16x16x32_bf16 v[68:71], a[16:19], a[208:211], v[68:71]
ds_read_b128 a[68:71], v202 offset:17408
s_add_u32 s60, s60, 20480
v_mfma_f32_16x16x32_bf16 v[72:75], a[16:19], a[212:215], v[72:75]
v_mul_f32 v194, v194, v174
v_mfma_f32_16x16x32_bf16 v[76:79], a[20:23], a[208:211], v[76:79]
buffer_load_dwordx4 v1, s[8:11], s60 offen offset:0 sc1 lds
v_mul_f32 v195, v195, v175
v_mfma_f32_16x16x32_bf16 v[80:83], a[20:23], a[212:215], v[80:83]
v_mfma_f32_16x16x32_bf16 v[84:87], a[24:27], a[208:211], v[84:87]
buffer_load_dwordx4 v1, s[8:11], s60 offen offset:1024 sc1 lds
v_mfma_f32_16x16x32_bf16 v[88:91], a[24:27], a[212:215], v[88:91]
v_exp_f32 v192, v192
v_mfma_f32_16x16x32_bf16 v[92:95], a[28:31], a[208:211], v[92:95]
buffer_load_dwordx4 v1, s[8:11], s60 offen offset:2048 sc1 lds
v_mfma_f32_16x16x32_bf16 v[96:99], a[28:31], a[212:215], v[96:99]
v_mfma_f32_16x16x32_bf16 v[100:103], a[32:35], a[208:211], v[100:103]
v_mfma_f32_16x16x32_bf16 v[104:107], a[32:35], a[212:215], v[104:107]
s_waitcnt vmcnt(25) lgkmcnt(0)
v_mfma_f32_16x16x32_bf16 v[36:39], a[36:39], a[216:219], v[36:39]
ds_read_b128 a[0:3], v202 offset:18432
buffer_load_dwordx4 v1, s[8:11], s60 offen offset:3072 sc1 lds
v_mfma_f32_16x16x32_bf16 v[40:43], a[36:39], a[220:223], v[40:43]
ds_read_b128 a[4:7], v202 offset:19456
v_mfma_f32_16x16x32_bf16 v[44:47], a[40:43], a[216:219], v[44:47]
ds_read_b128 a[8:11], v202 offset:20480
v_mfma_f32_16x16x32_bf16 v[48:51], a[40:43], a[220:223], v[48:51]
ds_read_b128 a[12:15], v202 offset:21504
v_mfma_f32_16x16x32_bf16 v[52:55], a[44:47], a[216:219], v[52:55]
ds_read_b128 a[16:19], v202 offset:22528
v_mfma_f32_16x16x32_bf16 v[56:59], a[44:47], a[220:223], v[56:59]
ds_read_b128 a[20:23], v202 offset:23552
v_mfma_f32_16x16x32_bf16 v[60:63], a[48:51], a[216:219], v[60:63]
ds_read_b128 a[24:27], v202 offset:24576
v_mfma_f32_16x16x32_bf16 v[64:67], a[48:51], a[220:223], v[64:67]
ds_read_b128 a[28:31], v202 offset:25600
v_mfma_f32_16x16x32_bf16 v[68:71], a[52:55], a[216:219], v[68:71]
ds_read_b128 a[32:35], v202 offset:26624
v_mfma_f32_16x16x32_bf16 v[72:75], a[52:55], a[220:223], v[72:75]
s_cmp_eq_u32 s25, 13
s_cselect_b32 s98, 4096, 0
s_add_u32 s52, s52, s98
v_mfma_f32_16x16x32_bf16 v[76:79], a[56:59], a[216:219], v[76:79]
s_add_u32 s52, s52, 4096
v_exp_f32 v193, v193
v_mfma_f32_16x16x32_bf16 v[80:83], a[56:59], a[220:223], v[80:83]
buffer_load_dwordx4 a[96:99], v1, s[4:7], s52 offen offset:0 sc1
v_mfma_f32_16x16x32_bf16 v[84:87], a[60:63], a[216:219], v[84:87]
buffer_load_dwordx4 a[100:103], v9, s[4:7], s52 offen offset:0 sc1
v_mfma_f32_16x16x32_bf16 v[88:91], a[60:63], a[220:223], v[88:91]
v_exp_f32 v194, v194
v_mfma_f32_16x16x32_bf16 v[92:95], a[64:67], a[216:219], v[92:95]
buffer_load_dwordx4 a[104:107], v1, s[4:7], s52 offen offset:1024 sc1
v_mfma_f32_16x16x32_bf16 v[96:99], a[64:67], a[220:223], v[96:99]
v_exp_f32 v195, v195
v_mfma_f32_16x16x32_bf16 v[100:103], a[68:71], a[216:219], v[100:103]
v_fma_f32 v192, v192, v254, v254
v_fma_f32 v193, v193, v254, v254
v_mfma_f32_16x16x32_bf16 v[104:107], a[68:71], a[220:223], v[104:107]
s_waitcnt lgkmcnt(0)
v_mfma_f32_16x16x32_bf16 v[36:39], a[0:3], a[224:227], v[36:39]
ds_read_b128 a[36:39], v202 offset:27648
buffer_load_dwordx4 a[108:111], v9, s[4:7], s52 offen offset:1024 sc1
v_mfma_f32_16x16x32_bf16 v[40:43], a[0:3], a[228:231], v[40:43]
ds_read_b128 a[40:43], v202 offset:28672
v_fma_f32 v194, v194, v254, v254
v_mfma_f32_16x16x32_bf16 v[44:47], a[4:7], a[224:227], v[44:47]
ds_read_b128 a[44:47], v202 offset:29696
v_fma_f32 v195, v195, v254, v254
v_mfma_f32_16x16x32_bf16 v[48:51], a[4:7], a[228:231], v[48:51]
ds_read_b128 a[48:51], v202 offset:30720
v_mfma_f32_16x16x32_bf16 v[52:55], a[8:11], a[224:227], v[52:55]
ds_read_b128 a[52:55], v202 offset:31744
buffer_load_dwordx4 a[112:115], v1, s[4:7], s52 offen offset:2048 sc1
v_mfma_f32_16x16x32_bf16 v[56:59], a[8:11], a[228:231], v[56:59]
ds_read_b128 a[56:59], v202 offset:32768
v_mfma_f32_16x16x32_bf16 v[60:63], a[12:15], a[224:227], v[60:63]
ds_read_b128 a[60:63], v202 offset:33792
v_mfma_f32_16x16x32_bf16 v[64:67], a[12:15], a[228:231], v[64:67]
ds_read_b128 a[64:67], v202 offset:34816
v_mfma_f32_16x16x32_bf16 v[68:71], a[16:19], a[224:227], v[68:71]
ds_read_b128 a[68:71], v202 offset:35840
buffer_load_dwordx4 a[116:119], v9, s[4:7], s52 offen offset:2048 sc1
v_mfma_f32_16x16x32_bf16 v[72:75], a[16:19], a[228:231], v[72:75]
v_rcp_f32 v192, v192
v_mfma_f32_16x16x32_bf16 v[76:79], a[20:23], a[224:227], v[76:79]
v_rcp_f32 v193, v193
v_mfma_f32_16x16x32_bf16 v[80:83], a[20:23], a[228:231], v[80:83]
v_mfma_f32_16x16x32_bf16 v[84:87], a[24:27], a[224:227], v[84:87]
buffer_load_dwordx4 a[120:123], v1, s[4:7], s52 offen offset:3072 sc1
v_mfma_f32_16x16x32_bf16 v[88:91], a[24:27], a[228:231], v[88:91]
v_mfma_f32_16x16x32_bf16 v[92:95], a[28:31], a[224:227], v[92:95]
v_rcp_f32 v194, v194
v_mfma_f32_16x16x32_bf16 v[96:99], a[28:31], a[228:231], v[96:99]
v_mfma_f32_16x16x32_bf16 v[100:103], a[32:35], a[224:227], v[100:103]
v_mfma_f32_16x16x32_bf16 v[104:107], a[32:35], a[228:231], v[104:107]
s_waitcnt vmcnt(20) lgkmcnt(0)
s_barrier
v_mfma_f32_16x16x32_bf16 v[36:39], a[36:39], a[232:235], v[36:39]
ds_read_b128 a[0:3], v200 offset:0
buffer_load_dwordx4 a[124:127], v9, s[4:7], s52 offen offset:3072 sc1
v_mfma_f32_16x16x32_bf16 v[40:43], a[36:39], a[236:239], v[40:43]
ds_read_b128 a[4:7], v200 offset:1024
v_mfma_f32_16x16x32_bf16 v[44:47], a[40:43], a[232:235], v[44:47]
ds_read_b128 a[8:11], v200 offset:2048
v_mfma_f32_16x16x32_bf16 v[48:51], a[40:43], a[236:239], v[48:51]
ds_read_b128 a[12:15], v200 offset:3072
v_mfma_f32_16x16x32_bf16 v[52:55], a[44:47], a[232:235], v[52:55]
ds_read_b128 a[16:19], v200 offset:4096
v_mfma_f32_16x16x32_bf16 v[56:59], a[44:47], a[236:239], v[56:59]
ds_read_b128 a[20:23], v200 offset:5120
v_mfma_f32_16x16x32_bf16 v[60:63], a[48:51], a[232:235], v[60:63]
ds_read_b128 a[24:27], v200 offset:6144
v_mfma_f32_16x16x32_bf16 v[64:67], a[48:51], a[236:239], v[64:67]
ds_read_b128 a[28:31], v200 offset:7168
v_mfma_f32_16x16x32_bf16 v[68:71], a[52:55], a[232:235], v[68:71]
ds_read_b128 a[32:35], v200 offset:8192
v_mfma_f32_16x16x32_bf16 v[72:75], a[52:55], a[236:239], v[72:75]
s_cmp_eq_u32 s25, 14
s_cselect_b32 s99, 36864, 0
s_add_u32 s60, s60, s99
v_mfma_f32_16x16x32_bf16 v[76:79], a[56:59], a[232:235], v[76:79]
s_add_u32 s61, s61, s99
s_add_u32 m0, s62, 126976
s_add_u32 s60, s60, 16384
v_mfma_f32_16x16x32_bf16 v[80:83], a[56:59], a[236:239], v[80:83]
buffer_load_dwordx4 v1, s[8:11], s60 offen offset:0 sc1 lds
v_mfma_f32_16x16x32_bf16 v[84:87], a[60:63], a[232:235], v[84:87]
v_rcp_f32 v195, v195
v_mfma_f32_16x16x32_bf16 v[88:91], a[60:63], a[236:239], v[88:91]
buffer_load_dwordx4 v1, s[8:11], s60 offen offset:1024 sc1 lds
v_mul_f32 v172, v172, v192
v_mfma_f32_16x16x32_bf16 v[92:95], a[64:67], a[232:235], v[92:95]
v_mul_f32 v173, v173, v193
v_mul_f32 v174, v174, v194
v_mfma_f32_16x16x32_bf16 v[96:99], a[64:67], a[236:239], v[96:99]
buffer_load_dwordx4 v1, s[8:11], s60 offen offset:2048 sc1 lds
v_mul_f32 v175, v175, v195
v_mfma_f32_16x16x32_bf16 v[100:103], a[68:71], a[232:235], v[100:103]
v_mul_f32 v196, v176, v176
v_mfma_f32_16x16x32_bf16 v[104:107], a[68:71], a[236:239], v[104:107]
v_mul_f32 v197, v177, v177
s_waitcnt lgkmcnt(0)
v_mfma_f32_16x16x32_bf16 v[36:39], a[0:3], a[240:243], v[36:39]
ds_read_b128 a[36:39], v200 offset:9216
buffer_load_dwordx4 v1, s[8:11], s60 offen offset:3072 sc1 lds
v_mfma_f32_16x16x32_bf16 v[40:43], a[0:3], a[244:247], v[40:43]
ds_read_b128 a[40:43], v200 offset:10240
v_mfma_f32_16x16x32_bf16 v[44:47], a[4:7], a[240:243], v[44:47]
ds_read_b128 a[44:47], v200 offset:11264
s_add_u32 m0, s63, 143360
v_mfma_f32_16x16x32_bf16 v[48:51], a[4:7], a[244:247], v[48:51]
ds_read_b128 a[48:51], v200 offset:12288
v_mul_f32 v198, v178, v178
v_mfma_f32_16x16x32_bf16 v[52:55], a[8:11], a[240:243], v[52:55]
ds_read_b128 a[52:55], v200 offset:13312
s_add_u32 s61, s61, 36864
v_mfma_f32_16x16x32_bf16 v[56:59], a[8:11], a[244:247], v[56:59]
ds_read_b128 a[56:59], v200 offset:14336
v_mul_f32 v199, v179, v179
v_mfma_f32_16x16x32_bf16 v[60:63], a[12:15], a[240:243], v[60:63]
ds_read_b128 a[60:63], v200 offset:15360
buffer_load_dwordx4 v1, s[8:11], s61 offen offset:0 sc1 lds
v_mfma_f32_16x16x32_bf16 v[64:67], a[12:15], a[244:247], v[64:67]
ds_read_b128 a[64:67], v200 offset:16384
v_fma_f32 v196, v196, v253, v251
v_mfma_f32_16x16x32_bf16 v[68:71], a[16:19], a[240:243], v[68:71]
ds_read_b128 a[68:71], v200 offset:17408
s_add_u32 m0, s62, 147456
v_mfma_f32_16x16x32_bf16 v[72:75], a[16:19], a[244:247], v[72:75]
s_add_u32 s60, s60, 20480
v_fma_f32 v197, v197, v253, v251
v_mfma_f32_16x16x32_bf16 v[76:79], a[20:23], a[240:243], v[76:79]
v_mfma_f32_16x16x32_bf16 v[80:83], a[20:23], a[244:247], v[80:83]
v_fma_f32 v198, v198, v253, v251
v_mfma_f32_16x16x32_bf16 v[84:87], a[24:27], a[240:243], v[84:87]
buffer_load_dwordx4 v1, s[8:11], s60 offen offset:0 sc1 lds
v_mfma_f32_16x16x32_bf16 v[88:91], a[24:27], a[244:247], v[88:91]
v_fma_f32 v199, v199, v253, v251
v_mfma_f32_16x16x32_bf16 v[92:95], a[28:31], a[240:243], v[92:95]
buffer_load_dwordx4 v1, s[8:11], s60 offen offset:1024 sc1 lds
v_mfma_f32_16x16x32_bf16 v[96:99], a[28:31], a[244:247], v[96:99]
v_mfma_f32_16x16x32_bf16 v[100:103], a[32:35], a[240:243], v[100:103]
v_mul_f32 v196, v196, v176
v_mfma_f32_16x16x32_bf16 v[104:107], a[32:35], a[244:247], v[104:107]
s_waitcnt vmcnt(24) lgkmcnt(0)
v_mfma_f32_16x16x32_bf16 v[36:39], a[36:39], a[248:251], v[36:39]
ds_read_b128 a[0:3], v200 offset:18432
buffer_load_dwordx4 v1, s[8:11], s60 offen offset:2048 sc1 lds
v_mfma_f32_16x16x32_bf16 v[40:43], a[36:39], a[252:255], v[40:43]
ds_read_b128 a[4:7], v200 offset:19456
v_mul_f32 v197, v197, v177
v_mfma_f32_16x16x32_bf16 v[44:47], a[40:43], a[248:251], v[44:47]
ds_read_b128 a[8:11], v200 offset:20480
buffer_load_dwordx4 v1, s[8:11], s60 offen offset:3072 sc1 lds
v_mfma_f32_16x16x32_bf16 v[48:51], a[40:43], a[252:255], v[48:51]
ds_read_b128 a[12:15], v200 offset:21504
v_mul_f32 v198, v198, v178
v_mfma_f32_16x16x32_bf16 v[52:55], a[44:47], a[248:251], v[52:55]
ds_read_b128 a[16:19], v200 offset:22528
v_mfma_f32_16x16x32_bf16 v[56:59], a[44:47], a[252:255], v[56:59]
ds_read_b128 a[20:23], v200 offset:23552
v_mul_f32 v199, v199, v179
v_mfma_f32_16x16x32_bf16 v[60:63], a[48:51], a[248:251], v[60:63]
ds_read_b128 a[24:27], v200 offset:24576
v_mfma_f32_16x16x32_bf16 v[64:67], a[48:51], a[252:255], v[64:67]
ds_read_b128 a[28:31], v200 offset:25600
v_mfma_f32_16x16x32_bf16 v[68:71], a[52:55], a[248:251], v[68:71]
ds_read_b128 a[32:35], v200 offset:26624
v_mfma_f32_16x16x32_bf16 v[72:75], a[52:55], a[252:255], v[72:75]
s_cmp_eq_u32 s25, 14
s_cselect_b32 s98, 4096, 0
s_add_u32 s52, s52, s98
v_mfma_f32_16x16x32_bf16 v[76:79], a[56:59], a[248:251], v[76:79]
s_add_u32 s52, s52, 4096
v_exp_f32 v196, v196
v_mfma_f32_16x16x32_bf16 v[80:83], a[56:59], a[252:255], v[80:83]
v_mfma_f32_16x16x32_bf16 v[84:87], a[60:63], a[248:251], v[84:87]
buffer_load_dwordx4 a[128:131], v1, s[4:7], s52 offen offset:0 sc1
v_mfma_f32_16x16x32_bf16 v[88:91], a[60:63], a[252:255], v[88:91]
v_exp_f32 v197, v197
v_mfma_f32_16x16x32_bf16 v[92:95], a[64:67], a[248:251], v[92:95]
buffer_load_dwordx4 a[132:135], v9, s[4:7], s52 offen offset:0 sc1
v_mfma_f32_16x16x32_bf16 v[96:99], a[64:67], a[252:255], v[96:99]
v_mfma_f32_16x16x32_bf16 v[100:103], a[68:71], a[248:251], v[100:103]
v_mfma_f32_16x16x32_bf16 v[104:107], a[68:71], a[252:255], v[104:107]
s_waitcnt lgkmcnt(0)
v_mfma_f32_16x16x32_bf16 v[36:39], a[0:3], a[80:83], v[36:39]
ds_read_b128 a[36:39], v200 offset:27648
buffer_load_dwordx4 a[136:139], v1, s[4:7], s52 offen offset:1024 sc1
v_mfma_f32_16x16x32_bf16 v[40:43], a[0:3], a[84:87], v[40:43]
ds_read_b128 a[40:43], v200 offset:28672
v_mfma_f32_16x16x32_bf16 v[44:47], a[4:7], a[80:83], v[44:47]
ds_read_b128 a[44:47], v200 offset:29696
v_mfma_f32_16x16x32_bf16 v[48:51], a[4:7], a[84:87], v[48:51]
ds_read_b128 a[48:51], v200 offset:30720
v_mfma_f32_16x16x32_bf16 v[52:55], a[8:11], a[80:83], v[52:55]
ds_read_b128 a[52:55], v200 offset:31744
buffer_load_dwordx4 a[140:143], v9, s[4:7], s52 offen offset:1024 sc1
v_mfma_f32_16x16x32_bf16 v[56:59], a[8:11], a[84:87], v[56:59]
ds_read_b128 a[56:59], v200 offset:32768
v_mfma_f32_16x16x32_bf16 v[60:63], a[12:15], a[80:83], v[60:63]
ds_read_b128 a[60:63], v200 offset:33792
v_mfma_f32_16x16x32_bf16 v[64:67], a[12:15], a[84:87], v[64:67]
ds_read_b128 a[64:67], v200 offset:34816
v_mfma_f32_16x16x32_bf16 v[68:71], a[16:19], a[80:83], v[68:71]
ds_read_b128 a[68:71], v200 offset:35840
buffer_load_dwordx4 a[144:147], v1, s[4:7], s52 offen offset:2048 sc1
v_mfma_f32_16x16x32_bf16 v[72:75], a[16:19], a[84:87], v[72:75]
v_exp_f32 v198, v198
v_mfma_f32_16x16x32_bf16 v[76:79], a[20:23], a[80:83], v[76:79]
v_exp_f32 v199, v199
v_mfma_f32_16x16x32_bf16 v[80:83], a[20:23], a[84:87], v[80:83]
v_fma_f32 v196, v196, v255, v255
v_fma_f32 v197, v197, v255, v255
v_mfma_f32_16x16x32_bf16 v[84:87], a[24:27], a[80:83], v[84:87]
buffer_load_dwordx4 a[148:151], v9, s[4:7], s52 offen offset:2048 sc1
v_mfma_f32_16x16x32_bf16 v[88:91], a[24:27], a[84:87], v[88:91]
v_fma_f32 v198, v198, v255, v255
v_mfma_f32_16x16x32_bf16 v[92:95], a[28:31], a[80:83], v[92:95]
v_mfma_f32_16x16x32_bf16 v[96:99], a[28:31], a[84:87], v[96:99]
v_fma_f32 v199, v199, v255, v255
v_mfma_f32_16x16x32_bf16 v[100:103], a[32:35], a[80:83], v[100:103]
v_mfma_f32_16x16x32_bf16 v[104:107], a[32:35], a[84:87], v[104:107]
s_waitcnt vmcnt(19) lgkmcnt(0)
s_barrier
v_mfma_f32_16x16x32_bf16 v[36:39], a[36:39], a[88:91], v[36:39]
ds_read_b128 a[0:3], v201 offset:0
buffer_load_dwordx4 a[152:155], v1, s[4:7], s52 offen offset:3072 sc1
v_mfma_f32_16x16x32_bf16 v[40:43], a[36:39], a[92:95], v[40:43]
ds_read_b128 a[4:7], v201 offset:1024
v_mfma_f32_16x16x32_bf16 v[44:47], a[40:43], a[88:91], v[44:47]
ds_read_b128 a[8:11], v201 offset:2048
buffer_load_dwordx4 a[156:159], v9, s[4:7], s52 offen offset:3072 sc1
v_mfma_f32_16x16x32_bf16 v[48:51], a[40:43], a[92:95], v[48:51]
ds_read_b128 a[12:15], v201 offset:3072
v_mfma_f32_16x16x32_bf16 v[52:55], a[44:47], a[88:91], v[52:55]
ds_read_b128 a[16:19], v201 offset:4096
s_mul_i32 s38, s24, 13312
v_mfma_f32_16x16x32_bf16 v[56:59], a[44:47], a[92:95], v[56:59]
ds_read_b128 a[20:23], v201 offset:5120
v_mfma_f32_16x16x32_bf16 v[60:63], a[48:51], a[88:91], v[60:63]
ds_read_b128 a[24:27], v201 offset:6144
v_mfma_f32_16x16x32_bf16 v[64:67], a[48:51], a[92:95], v[64:67]
ds_read_b128 a[28:31], v201 offset:7168
s_add_u32 m0, s38, 0
v_mfma_f32_16x16x32_bf16 v[68:71], a[52:55], a[88:91], v[68:71]
ds_read_b128 a[32:35], v201 offset:8192
v_mfma_f32_16x16x32_bf16 v[72:75], a[52:55], a[92:95], v[72:75]
s_add_u32 s39, s38, s83
v_rcp_f32 v196, v196
v_mfma_f32_16x16x32_bf16 v[76:79], a[56:59], a[88:91], v[76:79]
v_rcp_f32 v197, v197
v_mfma_f32_16x16x32_bf16 v[80:83], a[56:59], a[92:95], v[80:83]
v_rcp_f32 v198, v198
v_mfma_f32_16x16x32_bf16 v[84:87], a[60:63], a[88:91], v[84:87]
buffer_load_dwordx4 v1, s[4:7], s39 offen offset:0 sc1 lds
v_mfma_f32_16x16x32_bf16 v[88:91], a[60:63], a[92:95], v[88:91]
v_mfma_f32_16x16x32_bf16 v[92:95], a[64:67], a[88:91], v[92:95]
buffer_load_dwordx4 v1, s[4:7], s39 offen offset:1024 sc1 lds
v_mfma_f32_16x16x32_bf16 v[96:99], a[64:67], a[92:95], v[96:99]
v_rcp_f32 v199, v199
v_mfma_f32_16x16x32_bf16 v[100:103], a[68:71], a[88:91], v[100:103]
v_mfma_f32_16x16x32_bf16 v[104:107], a[68:71], a[92:95], v[104:107]
s_waitcnt lgkmcnt(0)
v_mfma_f32_16x16x32_bf16 v[36:39], a[0:3], a[96:99], v[36:39]
ds_read_b128 a[36:39], v201 offset:9216
buffer_load_dwordx4 v1, s[4:7], s39 offen offset:2048 sc1 lds
v_mfma_f32_16x16x32_bf16 v[40:43], a[0:3], a[100:103], v[40:43]
ds_read_b128 a[40:43], v201 offset:10240
v_mul_f32 v176, v176, v196
v_mfma_f32_16x16x32_bf16 v[44:47], a[4:7], a[96:99], v[44:47]
ds_read_b128 a[44:47], v201 offset:11264
buffer_load_dwordx4 v1, s[4:7], s39 offen offset:3072 sc1 lds
v_mfma_f32_16x16x32_bf16 v[48:51], a[4:7], a[100:103], v[48:51]
ds_read_b128 a[48:51], v201 offset:12288
v_mul_f32 v177, v177, v197
v_mfma_f32_16x16x32_bf16 v[52:55], a[8:11], a[96:99], v[52:55]
ds_read_b128 a[52:55], v201 offset:13312
v_mfma_f32_16x16x32_bf16 v[56:59], a[8:11], a[100:103], v[56:59]
ds_read_b128 a[56:59], v201 offset:14336
s_add_u32 m0, m0, 4096
v_mfma_f32_16x16x32_bf16 v[60:63], a[12:15], a[96:99], v[60:63]
ds_read_b128 a[60:63], v201 offset:15360
v_mul_f32 v178, v178, v198
v_mfma_f32_16x16x32_bf16 v[64:67], a[12:15], a[100:103], v[64:67]
ds_read_b128 a[64:67], v201 offset:16384
v_mul_f32 v179, v179, v199
v_mfma_f32_16x16x32_bf16 v[68:71], a[16:19], a[96:99], v[68:71]
ds_read_b128 a[68:71], v201 offset:17408
s_add_u32 s39, s39, 4096
v_mfma_f32_16x16x32_bf16 v[72:75], a[16:19], a[100:103], v[72:75]
s_lshl_b32 s30, s25, 3
v_mfma_f32_16x16x32_bf16 v[76:79], a[20:23], a[96:99], v[76:79]
s_lshl_b32 s31, s24, 1
v_mfma_f32_16x16x32_bf16 v[80:83], a[20:23], a[100:103], v[80:83]
buffer_load_dwordx4 v1, s[4:7], s39 offen offset:0 sc1 lds
v_mfma_f32_16x16x32_bf16 v[84:87], a[24:27], a[96:99], v[84:87]
s_add_u32 s30, s30, s31
v_mfma_f32_16x16x32_bf16 v[88:91], a[24:27], a[100:103], v[88:91]
s_mul_i32 s30, s30, 73728
v_mfma_f32_16x16x32_bf16 v[92:95], a[28:31], a[96:99], v[92:95]
buffer_load_dwordx4 v1, s[4:7], s39 offen offset:1024 sc1 lds
v_mfma_f32_16x16x32_bf16 v[96:99], a[28:31], a[100:103], v[96:99]
s_add_u32 s30, s30, 16777216
v_mfma_f32_16x16x32_bf16 v[100:103], a[32:35], a[96:99], v[100:103]
s_mul_i32 s31, s26, 4608
v_mfma_f32_16x16x32_bf16 v[104:107], a[32:35], a[100:103], v[104:107]
s_add_u32 s30, s30, s31
s_waitcnt vmcnt(23) lgkmcnt(0)
v_mfma_f32_16x16x32_bf16 v[36:39], a[36:39], a[104:107], v[36:39]
ds_read_b128 a[0:3], v201 offset:18432
buffer_load_dwordx4 v1, s[4:7], s39 offen offset:2048 sc1 lds
v_mfma_f32_16x16x32_bf16 v[40:43], a[36:39], a[108:111], v[40:43]
ds_read_b128 a[4:7], v201 offset:19456
v_mfma_f32_16x16x32_bf16 v[44:47], a[40:43], a[104:107], v[44:47]
ds_read_b128 a[8:11], v201 offset:20480
buffer_load_dwordx4 v1, s[4:7], s39 offen offset:3072 sc1 lds
v_mfma_f32_16x16x32_bf16 v[48:51], a[40:43], a[108:111], v[48:51]
ds_read_b128 a[12:15], v201 offset:21504
v_mfma_f32_16x16x32_bf16 v[52:55], a[44:47], a[104:107], v[52:55]
ds_read_b128 a[16:19], v201 offset:22528
v_mfma_f32_16x16x32_bf16 v[56:59], a[44:47], a[108:111], v[56:59]
ds_read_b128 a[20:23], v201 offset:23552
s_add_u32 m0, m0, 4096
v_mfma_f32_16x16x32_bf16 v[60:63], a[48:51], a[104:107], v[60:63]
ds_read_b128 a[24:27], v201 offset:24576
v_mfma_f32_16x16x32_bf16 v[64:67], a[48:51], a[108:111], v[64:67]
ds_read_b128 a[28:31], v201 offset:25600
v_mfma_f32_16x16x32_bf16 v[68:71], a[52:55], a[104:107], v[68:71]
ds_read_b128 a[32:35], v201 offset:26624
s_add_u32 s39, s39, 4096
v_mfma_f32_16x16x32_bf16 v[72:75], a[52:55], a[108:111], v[72:75]
s_and_b32 s65, s26, 1
v_mfma_f32_16x16x32_bf16 v[76:79], a[56:59], a[104:107], v[76:79]
s_lshl_b32 s64, s65, 9
v_mfma_f32_16x16x32_bf16 v[80:83], a[56:59], a[108:111], v[80:83]
buffer_load_dwordx4 v1, s[4:7], s39 offen offset:0 sc1 lds
v_mfma_f32_16x16x32_bf16 v[84:87], a[60:63], a[104:107], v[84:87]
s_add_u32 s64, s64, s30
v_mfma_f32_16x16x32_bf16 v[88:91], a[60:63], a[108:111], v[88:91]
s_xor_b32 s65, s65, 1
v_mfma_f32_16x16x32_bf16 v[92:95], a[64:67], a[104:107], v[92:95]
buffer_load_dwordx4 v1, s[4:7], s39 offen offset:1024 sc1 lds
v_mfma_f32_16x16x32_bf16 v[96:99], a[64:67], a[108:111], v[96:99]
s_lshl_b32 s65, s65, 12
v_mfma_f32_16x16x32_bf16 v[100:103], a[68:71], a[104:107], v[100:103]
s_add_u32 s65, s65, s30
v_mfma_f32_16x16x32_bf16 v[104:107], a[68:71], a[108:111], v[104:107]
s_waitcnt lgkmcnt(0)
v_mfma_f32_16x16x32_bf16 v[36:39], a[0:3], a[112:115], v[36:39]
ds_read_b128 a[36:39], v201 offset:27648
buffer_load_dwordx4 v1, s[4:7], s39 offen offset:2048 sc1 lds
v_mfma_f32_16x16x32_bf16 v[40:43], a[0:3], a[116:119], v[40:43]
ds_read_b128 a[40:43], v201 offset:28672
buffer_load_dwordx4 v1, s[4:7], s39 offen offset:3072 sc1 lds
v_mfma_f32_16x16x32_bf16 v[44:47], a[4:7], a[112:115], v[44:47]
ds_read_b128 a[44:47], v201 offset:29696
v_mfma_f32_16x16x32_bf16 v[48:51], a[4:7], a[116:119], v[48:51]
ds_read_b128 a[48:51], v201 offset:30720
s_add_u32 m0, m0, 4096
v_mfma_f32_16x16x32_bf16 v[52:55], a[8:11], a[112:115], v[52:55]
ds_read_b128 a[52:55], v201 offset:31744
v_add_u32 v204, 73728, v1
v_mfma_f32_16x16x32_bf16 v[56:59], a[8:11], a[116:119], v[56:59]
ds_read_b128 a[56:59], v201 offset:32768
s_add_u32 s39, s39, 4096
v_mfma_f32_16x16x32_bf16 v[60:63], a[12:15], a[112:115], v[60:63]
ds_read_b128 a[60:63], v201 offset:33792
buffer_load_dwordx4 v1, s[4:7], s39 offen offset:0 sc1 lds
v_mfma_f32_16x16x32_bf16 v[64:67], a[12:15], a[116:119], v[64:67]
ds_read_b128 a[64:67], v201 offset:34816
v_and_b32 v203, 1, v3
v_mfma_f32_16x16x32_bf16 v[68:71], a[16:19], a[112:115], v[68:71]
ds_read_b128 a[68:71], v201 offset:35840
s_mul_i32 s38, s24, 9216
v_mfma_f32_16x16x32_bf16 v[72:75], a[16:19], a[116:119], v[72:75]
s_add_u32 m0, s38, 53248
v_mul_u32_u24 v203, 73728, v203
v_mfma_f32_16x16x32_bf16 v[76:79], a[20:23], a[112:115], v[76:79]
s_add_u32 s39, s38, s83
v_mfma_f32_16x16x32_bf16 v[80:83], a[20:23], a[116:119], v[80:83]
s_add_u32 s39, s39, 53248
v_lshrrev_b32 v7, 1, v3
v_mfma_f32_16x16x32_bf16 v[84:87], a[24:27], a[112:115], v[84:87]
v_mfma_f32_16x16x32_bf16 v[88:91], a[24:27], a[116:119], v[88:91]
v_mfma_f32_16x16x32_bf16 v[92:95], a[28:31], a[112:115], v[92:95]
v_lshl_add_u32 v203, v7, 8, v203
v_mfma_f32_16x16x32_bf16 v[96:99], a[28:31], a[116:119], v[96:99]
buffer_load_dwordx4 v1, s[4:7], s39 offen offset:0 sc1 lds
v_mfma_f32_16x16x32_bf16 v[100:103], a[32:35], a[112:115], v[100:103]
v_lshl_add_u32 v203, v2, 4, v203
v_mfma_f32_16x16x32_bf16 v[104:107], a[32:35], a[116:119], v[104:107]
s_waitcnt vmcnt(14) lgkmcnt(0)
s_barrier
v_mfma_f32_16x16x32_bf16 v[36:39], a[36:39], a[120:123], v[36:39]
ds_read_b128 a[0:3], v202 offset:8192
buffer_load_dwordx4 v1, s[4:7], s39 offen offset:1024 sc1 lds
v_mfma_f32_16x16x32_bf16 v[40:43], a[36:39], a[124:127], v[40:43]
ds_read_b128 a[4:7], v202 offset:17408
v_mfma_f32_16x16x32_bf16 v[44:47], a[40:43], a[120:123], v[44:47]
ds_read_b128 a[8:11], v202 offset:26624
buffer_load_dwordx4 v1, s[4:7], s39 offen offset:2048 sc1 lds
v_mfma_f32_16x16x32_bf16 v[48:51], a[40:43], a[124:127], v[48:51]
ds_read_b128 a[12:15], v202 offset:35840
v_mfma_f32_16x16x32_bf16 v[52:55], a[44:47], a[120:123], v[52:55]
ds_read_b128 a[16:19], v202 offset:0
v_mfma_f32_16x16x32_bf16 v[56:59], a[44:47], a[124:127], v[56:59]
ds_read_b128 a[20:23], v202 offset:1024
buffer_load_dwordx4 v1, s[4:7], s39 offen offset:3072 sc1 lds
v_mfma_f32_16x16x32_bf16 v[60:63], a[48:51], a[120:123], v[60:63]
ds_read_b128 a[24:27], v202 offset:9216
v_mfma_f32_16x16x32_bf16 v[64:67], a[48:51], a[124:127], v[64:67]
ds_read_b128 a[28:31], v202 offset:10240
v_mfma_f32_16x16x32_bf16 v[68:71], a[52:55], a[120:123], v[68:71]
ds_read_b128 a[32:35], v202 offset:18432
s_add_u32 m0, m0, 4096
v_mfma_f32_16x16x32_bf16 v[72:75], a[52:55], a[124:127], v[72:75]
s_add_u32 s39, s39, 4096
v_mfma_f32_16x16x32_bf16 v[76:79], a[56:59], a[120:123], v[76:79]
v_mfma_f32_16x16x32_bf16 v[80:83], a[56:59], a[124:127], v[80:83]
v_mfma_f32_16x16x32_bf16 v[84:87], a[60:63], a[120:123], v[84:87]
v_mfma_f32_16x16x32_bf16 v[88:91], a[60:63], a[124:127], v[88:91]
v_mfma_f32_16x16x32_bf16 v[92:95], a[64:67], a[120:123], v[92:95]
buffer_load_dwordx4 v1, s[4:7], s39 offen offset:0 sc1 lds
v_mfma_f32_16x16x32_bf16 v[96:99], a[64:67], a[124:127], v[96:99]
v_mfma_f32_16x16x32_bf16 v[100:103], a[68:71], a[120:123], v[100:103]
v_mfma_f32_16x16x32_bf16 v[104:107], a[68:71], a[124:127], v[104:107]
s_waitcnt lgkmcnt(7)
v_mfma_f32_16x16x32_bf16 v[100:103], a[0:3], a[128:131], v[100:103]
ds_read_b128 a[36:39], v202 offset:19456
v_mfma_f32_16x16x32_bf16 v[104:107], a[0:3], a[132:135], v[104:107]
v_mfma_f32_16x16x32_bf16 v[100:103], a[4:7], a[136:139], v[100:103]
ds_read_b128 a[40:43], v202 offset:27648
v_mfma_f32_16x16x32_bf16 v[104:107], a[4:7], a[140:143], v[104:107]
s_waitcnt lgkmcnt(7)
v_mfma_f32_16x16x32_bf16 v[100:103], a[8:11], a[144:147], v[100:103]
ds_read_b128 a[44:47], v202 offset:28672
v_mfma_f32_16x16x32_bf16 v[104:107], a[8:11], a[148:151], v[104:107]
v_mfma_f32_16x16x32_bf16 v[100:103], a[12:15], a[152:155], v[100:103]
ds_read_b128 a[48:51], v202 offset:2048
v_mfma_f32_16x16x32_bf16 v[104:107], a[12:15], a[156:159], v[104:107]
s_waitcnt lgkmcnt(7)
v_mfma_f32_16x16x32_bf16 v[36:39], a[16:19], a[128:131], v[36:39]
ds_read_b128 a[52:55], v202 offset:3072
v_mfma_f32_16x16x32_bf16 v[40:43], a[16:19], a[132:135], v[40:43]
v_mfma_f32_16x16x32_bf16 v[44:47], a[20:23], a[128:131], v[44:47]
ds_read_b128 a[56:59], v202 offset:11264
v_mfma_f32_16x16x32_bf16 v[48:51], a[20:23], a[132:135], v[48:51]
v_mul_f32 v100, v100, v108
s_waitcnt lgkmcnt(7)
v_mfma_f32_16x16x32_bf16 v[36:39], a[24:27], a[136:139], v[36:39]
ds_read_b128 a[60:63], v202 offset:12288
v_mul_f32 v101, v101, v109
v_mfma_f32_16x16x32_bf16 v[40:43], a[24:27], a[140:143], v[40:43]
v_mul_f32 v102, v102, v110
v_mul_f32 v103, v103, v111
v_mfma_f32_16x16x32_bf16 v[44:47], a[28:31], a[136:139], v[44:47]
ds_read_b128 a[64:67], v202 offset:20480
v_cvt_pk_bf16_f32 v238, v100, v101
v_mfma_f32_16x16x32_bf16 v[48:51], a[28:31], a[140:143], v[48:51]
v_cvt_pk_bf16_f32 v239, v102, v103
s_waitcnt lgkmcnt(7)
v_mfma_f32_16x16x32_bf16 v[36:39], a[32:35], a[144:147], v[36:39]
ds_read_b128 a[68:71], v202 offset:21504
v_mul_f32 v104, v104, v112
v_mfma_f32_16x16x32_bf16 v[40:43], a[32:35], a[148:151], v[40:43]
v_mul_f32 v105, v105, v113
v_mfma_f32_16x16x32_bf16 v[44:47], a[36:39], a[144:147], v[44:47]
ds_read_b128 a[0:3], v202 offset:29696
v_mul_f32 v106, v106, v114
v_mfma_f32_16x16x32_bf16 v[48:51], a[36:39], a[148:151], v[48:51]
v_mul_f32 v107, v107, v115
s_waitcnt lgkmcnt(7)
v_mfma_f32_16x16x32_bf16 v[36:39], a[40:43], a[152:155], v[36:39]
ds_read_b128 a[4:7], v202 offset:30720
v_cvt_pk_bf16_f32 v240, v104, v105
v_mfma_f32_16x16x32_bf16 v[40:43], a[40:43], a[156:159], v[40:43]
v_cvt_pk_bf16_f32 v241, v106, v107
s_nop 0
v_mfma_f32_16x16x32_bf16 v[44:47], a[44:47], a[152:155], v[44:47]
ds_read_b128 a[8:11], v202 offset:4096
v_mfma_f32_16x16x32_bf16 v[48:51], a[44:47], a[156:159], v[48:51]
s_waitcnt lgkmcnt(7)
v_mfma_f32_16x16x32_bf16 v[52:55], a[48:51], a[128:131], v[52:55]
ds_read_b128 a[12:15], v202 offset:5120
v_permlane16_swap_b32 v238, v240
v_mfma_f32_16x16x32_bf16 v[56:59], a[48:51], a[132:135], v[56:59]
v_permlane16_swap_b32 v239, v241
v_mfma_f32_16x16x32_bf16 v[60:63], a[52:55], a[128:131], v[60:63]
ds_read_b128 a[16:19], v202 offset:13312
buffer_store_dwordx4 v[238:241], v203, s[8:11], s65 offen sc1
v_mfma_f32_16x16x32_bf16 v[64:67], a[52:55], a[132:135], v[64:67]
v_mul_f32 v36, v36, v116
s_waitcnt lgkmcnt(7)
v_mfma_f32_16x16x32_bf16 v[52:55], a[56:59], a[136:139], v[52:55]
ds_read_b128 a[20:23], v202 offset:14336
v_mul_f32 v37, v37, v117
v_mfma_f32_16x16x32_bf16 v[56:59], a[56:59], a[140:143], v[56:59]
v_mul_f32 v38, v38, v118
v_mul_f32 v39, v39, v119
v_mfma_f32_16x16x32_bf16 v[60:63], a[60:63], a[136:139], v[60:63]
ds_read_b128 a[24:27], v202 offset:22528
v_cvt_pk_bf16_f32 v206, v36, v37
v_mfma_f32_16x16x32_bf16 v[64:67], a[60:63], a[140:143], v[64:67]
v_cvt_pk_bf16_f32 v207, v38, v39
v_mul_f32 v44, v44, v124
s_waitcnt lgkmcnt(7)
v_mfma_f32_16x16x32_bf16 v[52:55], a[64:67], a[144:147], v[52:55]
ds_read_b128 a[28:31], v202 offset:23552
v_mul_f32 v45, v45, v125
v_mfma_f32_16x16x32_bf16 v[56:59], a[64:67], a[148:151], v[56:59]
v_mul_f32 v46, v46, v126
v_mul_f32 v47, v47, v127
v_mfma_f32_16x16x32_bf16 v[60:63], a[68:71], a[144:147], v[60:63]
ds_read_b128 a[32:35], v202 offset:31744
v_cvt_pk_bf16_f32 v208, v44, v45
v_mfma_f32_16x16x32_bf16 v[64:67], a[68:71], a[148:151], v[64:67]
v_cvt_pk_bf16_f32 v209, v46, v47
s_waitcnt lgkmcnt(7)
v_mfma_f32_16x16x32_bf16 v[52:55], a[0:3], a[152:155], v[52:55]
ds_read_b128 a[36:39], v202 offset:32768
buffer_store_dwordx4 v[206:209], v1, s[8:11], s64 offen offset:0 sc1
v_mul_f32 v40, v40, v120
v_mul_f32 v41, v41, v121
v_mfma_f32_16x16x32_bf16 v[56:59], a[0:3], a[156:159], v[56:59]
v_mul_f32 v42, v42, v122
v_mul_f32 v43, v43, v123
v_mfma_f32_16x16x32_bf16 v[60:63], a[4:7], a[152:155], v[60:63]
ds_read_b128 a[40:43], v202 offset:6144
v_cvt_pk_bf16_f32 v210, v40, v41
v_mfma_f32_16x16x32_bf16 v[64:67], a[4:7], a[156:159], v[64:67]
v_cvt_pk_bf16_f32 v211, v42, v43
v_mul_f32 v48, v48, v128
s_waitcnt lgkmcnt(7)
v_mfma_f32_16x16x32_bf16 v[68:71], a[8:11], a[128:131], v[68:71]
ds_read_b128 a[44:47], v202 offset:7168
v_mul_f32 v49, v49, v129
v_mfma_f32_16x16x32_bf16 v[72:75], a[8:11], a[132:135], v[72:75]
v_mul_f32 v50, v50, v130
v_mul_f32 v51, v51, v131
v_mfma_f32_16x16x32_bf16 v[76:79], a[12:15], a[128:131], v[76:79]
ds_read_b128 a[48:51], v202 offset:15360
v_cvt_pk_bf16_f32 v212, v48, v49
v_cvt_pk_bf16_f32 v213, v50, v51
buffer_store_dwordx4 v[210:213], v204, s[8:11], s64 offen offset:0 sc1
v_mfma_f32_16x16x32_bf16 v[80:83], a[12:15], a[132:135], v[80:83]
v_mul_f32 v52, v52, v132
s_waitcnt lgkmcnt(7)
v_mfma_f32_16x16x32_bf16 v[68:71], a[16:19], a[136:139], v[68:71]
ds_read_b128 a[52:55], v202 offset:16384
v_mul_f32 v53, v53, v133
v_mfma_f32_16x16x32_bf16 v[72:75], a[16:19], a[140:143], v[72:75]
v_mul_f32 v54, v54, v134
v_mul_f32 v55, v55, v135
v_mfma_f32_16x16x32_bf16 v[76:79], a[20:23], a[136:139], v[76:79]
ds_read_b128 a[56:59], v202 offset:24576
v_cvt_pk_bf16_f32 v214, v52, v53
v_mfma_f32_16x16x32_bf16 v[80:83], a[20:23], a[140:143], v[80:83]
v_cvt_pk_bf16_f32 v215, v54, v55
v_mul_f32 v60, v60, v140
s_waitcnt lgkmcnt(7)
v_mfma_f32_16x16x32_bf16 v[68:71], a[24:27], a[144:147], v[68:71]
ds_read_b128 a[60:63], v202 offset:25600
v_mul_f32 v61, v61, v141
v_mfma_f32_16x16x32_bf16 v[72:75], a[24:27], a[148:151], v[72:75]
v_mul_f32 v62, v62, v142
v_mul_f32 v63, v63, v143
v_mfma_f32_16x16x32_bf16 v[76:79], a[28:31], a[144:147], v[76:79]
ds_read_b128 a[64:67], v202 offset:33792
v_cvt_pk_bf16_f32 v216, v60, v61
v_mfma_f32_16x16x32_bf16 v[80:83], a[28:31], a[148:151], v[80:83]
v_cvt_pk_bf16_f32 v217, v62, v63
s_waitcnt lgkmcnt(7)
v_mfma_f32_16x16x32_bf16 v[68:71], a[32:35], a[152:155], v[68:71]
ds_read_b128 a[68:71], v202 offset:34816
buffer_store_dwordx4 v[214:217], v1, s[8:11], s64 offen offset:1024 sc1
v_mul_f32 v56, v56, v136
v_mul_f32 v57, v57, v137
v_mfma_f32_16x16x32_bf16 v[72:75], a[32:35], a[156:159], v[72:75]
v_mul_f32 v58, v58, v138
v_mul_f32 v59, v59, v139
v_mfma_f32_16x16x32_bf16 v[76:79], a[36:39], a[152:155], v[76:79]
v_cvt_pk_bf16_f32 v218, v56, v57
v_cvt_pk_bf16_f32 v219, v58, v59
v_mfma_f32_16x16x32_bf16 v[80:83], a[36:39], a[156:159], v[80:83]
v_mul_f32 v64, v64, v144
s_waitcnt lgkmcnt(6)
v_mfma_f32_16x16x32_bf16 v[84:87], a[40:43], a[128:131], v[84:87]
v_mul_f32 v65, v65, v145
v_mul_f32 v66, v66, v146
v_mfma_f32_16x16x32_bf16 v[88:91], a[40:43], a[132:135], v[88:91]
v_mul_f32 v67, v67, v147
v_cvt_pk_bf16_f32 v220, v64, v65
v_mfma_f32_16x16x32_bf16 v[92:95], a[44:47], a[128:131], v[92:95]
v_cvt_pk_bf16_f32 v221, v66, v67
buffer_store_dwordx4 v[218:221], v204, s[8:11], s64 offen offset:1024 sc1
v_mfma_f32_16x16x32_bf16 v[96:99], a[44:47], a[132:135], v[96:99]
v_mul_f32 v68, v68, v148
s_waitcnt lgkmcnt(4)
v_mfma_f32_16x16x32_bf16 v[84:87], a[48:51], a[136:139], v[84:87]
v_mul_f32 v69, v69, v149
v_mul_f32 v70, v70, v150
v_mfma_f32_16x16x32_bf16 v[88:91], a[48:51], a[140:143], v[88:91]
v_mul_f32 v71, v71, v151
v_cvt_pk_bf16_f32 v222, v68, v69
v_mfma_f32_16x16x32_bf16 v[92:95], a[52:55], a[136:139], v[92:95]
v_cvt_pk_bf16_f32 v223, v70, v71
v_mul_f32 v76, v76, v156
v_mfma_f32_16x16x32_bf16 v[96:99], a[52:55], a[140:143], v[96:99]
v_mul_f32 v77, v77, v157
s_waitcnt lgkmcnt(2)
v_mfma_f32_16x16x32_bf16 v[84:87], a[56:59], a[144:147], v[84:87]
v_mul_f32 v78, v78, v158
v_mul_f32 v79, v79, v159
v_mfma_f32_16x16x32_bf16 v[88:91], a[56:59], a[148:151], v[88:91]
v_cvt_pk_bf16_f32 v224, v76, v77
v_cvt_pk_bf16_f32 v225, v78, v79
v_mfma_f32_16x16x32_bf16 v[92:95], a[60:63], a[144:147], v[92:95]
buffer_store_dwordx4 v[222:225], v1, s[8:11], s64 offen offset:2048 sc1
v_mul_f32 v72, v72, v152
v_mfma_f32_16x16x32_bf16 v[96:99], a[60:63], a[148:151], v[96:99]
v_mul_f32 v73, v73, v153
v_mul_f32 v74, v74, v154
s_waitcnt lgkmcnt(0)
v_mfma_f32_16x16x32_bf16 v[84:87], a[64:67], a[152:155], v[84:87]
v_mul_f32 v75, v75, v155
v_cvt_pk_bf16_f32 v226, v72, v73
v_mfma_f32_16x16x32_bf16 v[88:91], a[64:67], a[156:159], v[88:91]
v_cvt_pk_bf16_f32 v227, v74, v75
v_mul_f32 v80, v80, v160
v_mfma_f32_16x16x32_bf16 v[92:95], a[68:71], a[152:155], v[92:95]
v_mul_f32 v81, v81, v161
v_mul_f32 v82, v82, v162
v_mfma_f32_16x16x32_bf16 v[96:99], a[68:71], a[156:159], v[96:99]
v_mul_f32 v83, v83, v163
v_cvt_pk_bf16_f32 v228, v80, v81
v_cvt_pk_bf16_f32 v229, v82, v83
buffer_store_dwordx4 v[226:229], v204, s[8:11], s64 offen offset:2048 sc1
s_nop 1
v_pk_mul_f32 v[84:85], v[84:85], v[164:165]
v_pk_mul_f32 v[86:87], v[86:87], v[166:167]
v_cvt_pk_bf16_f32 v230, v84, v85
v_cvt_pk_bf16_f32 v231, v86, v87
v_pk_mul_f32 v[92:93], v[92:93], v[172:173]
v_pk_mul_f32 v[94:95], v[94:95], v[174:175]
v_cvt_pk_bf16_f32 v232, v92, v93
v_cvt_pk_bf16_f32 v233, v94, v95
buffer_store_dwordx4 v[230:233], v1, s[8:11], s64 offen offset:3072 sc1
v_pk_mul_f32 v[88:89], v[88:89], v[168:169]
v_pk_mul_f32 v[90:91], v[90:91], v[170:171]
v_cvt_pk_bf16_f32 v234, v88, v89
v_cvt_pk_bf16_f32 v235, v90, v91
v_pk_mul_f32 v[96:97], v[96:97], v[176:177]
v_pk_mul_f32 v[98:99], v[98:99], v[178:179]
v_cvt_pk_bf16_f32 v236, v96, v97
v_cvt_pk_bf16_f32 v237, v98, v99
buffer_store_dwordx4 v[234:237], v204, s[8:11], s64 offen offset:3072 sc1
L_c5:
buffer_load_dwordx4 v1, s[4:7], s39 offen offset:1024 sc1 lds
buffer_load_dwordx4 v1, s[4:7], s39 offen offset:2048 sc1 lds
buffer_load_dwordx4 v1, s[4:7], s39 offen offset:3072 sc1 lds
s_add_u32 m0, m0, 4096
s_add_u32 s39, s39, 4096
buffer_load_dwordx4 v1, s[4:7], s39 offen offset:0 sc1 lds
s_mul_i32 s38, s24, 9216
s_add_u32 m0, s38, 90112
s_add_u32 s39, s38, s83
s_add_u32 s39, s39, 90112
buffer_load_dwordx4 v1, s[4:7], s39 offen offset:0 sc1 lds
buffer_load_dwordx4 v1, s[4:7], s39 offen offset:1024 sc1 lds
buffer_load_dwordx4 v1, s[4:7], s39 offen offset:2048 sc1 lds
v_lshlrev_b32 v7, 3, v1
s_lshl_b32 s31, s27, 10
v_add_u32 v7, s31, v7
s_cmp_eq_u32 s24, 0
s_cselect_b32 s30, 0, 1073741824
s_add_u32 s30, s30, 26574848
s_waitcnt vmcnt(7)
s_barrier
s_mov_b64 exec, 0xff
buffer_atomic_add v4, v7, s[8:11], s30 offen sc1
s_mov_b64 exec, -1
s_lshl_b32 s35, s80, 7
s_add_u32 s35, s35, 26574848
s_cmp_eq_u32 s24, 1
s_cselect_b32 s35, s35, 1073741824
v_mov_b32 v6, 0
v_mov_b32 v244, 0
v_mov_b32 v245, 0
v_mov_b32 v246, 0
buffer_load_dwordx4 v1, s[4:7], s39 offen offset:3072 sc1 lds
s_add_u32 m0, m0, 4096
s_add_u32 s39, s39, 4096
buffer_load_dwordx4 v1, s[4:7], s39 offen offset:0 sc1 lds
buffer_load_dwordx4 v1, s[4:7], s39 offen offset:1024 sc1 lds
buffer_load_dwordx4 v1, s[4:7], s39 offen offset:2048 sc1 lds
s_xor_b32 s30, s70, 1
s_mul_i32 s60, s30, 73728
s_and_b32 s32, s27, 1
s_mul_i32 s32, s32, 36864
s_add_u32 s32, s32, 16777216
s_add_u32 s60, s60, s32
s_mul_i32 s61, s70, 73728
s_add_u32 s61, s61, s32
v_and_b32 v40, 7, v2
v_lshlrev_b32 v40, 4, v40
v_lshl_add_u32 v40, v3, 7, v40
v_add_u32 v40, 4096, v40
s_mov_b64 exec, 1
buffer_atomic_add v244, v6, s[8:11], s35 offen sc0 sc1
s_mov_b64 exec, -1
buffer_load_dwordx4 v1, s[4:7], s39 offen offset:3072 sc1 lds
s_add_u32 m0, m0, 4096
s_add_u32 s39, s39, 4096
buffer_load_dwordx4 v1, s[4:7], s39 offen offset:0 sc1 lds
s_mul_i32 s38, s24, 9216
s_add_u32 m0, s38, 126976
s_add_u32 s39, s38, s83
s_add_u32 s39, s39, 126976
buffer_load_dwordx4 v1, s[4:7], s39 offen offset:0 sc1 lds
buffer_load_dwordx4 v1, s[4:7], s39 offen offset:1024 sc1 lds
s_lshl_b32 s63, s80, 14
s_lshl_b32 s30, s24, 12
s_add_u32 s63, s63, s30
s_xor_b32 s62, s63, 131072
s_add_u32 s63, s63, 26640384
s_add_u32 s62, s62, 26640384
s_add_u32 s64, s83, 161280
v_mov_b32 v116, v40
v_add_u32 v36, 0, v1
v_add_u32 v37, 55296, v1
v_add_u32 v41, 55296, v40
v_add_u32 v38, 110592, v1
s_mov_b64 exec, 1
buffer_atomic_add v245, v6, s[8:11], s35 offen sc0 sc1
s_mov_b64 exec, -1
buffer_load_dwordx4 v1, s[4:7], s39 offen offset:2048 sc1 lds
buffer_load_dwordx4 v1, s[4:7], s39 offen offset:3072 sc1 lds
s_add_u32 m0, m0, 4096
s_add_u32 s39, s39, 4096
buffer_load_dwordx4 v1, s[4:7], s39 offen offset:0 sc1 lds
buffer_load_dwordx4 v1, s[4:7], s39 offen offset:1024 sc1 lds
v_add_u32 v42, 110592, v40
s_bitcmp1_b32 s27, 0
s_cbranch_scc1 L_kh_31
v_swap_b32 v206, v210
v_swap_b32 v207, v211
v_swap_b32 v208, v212
v_swap_b32 v209, v213
v_swap_b32 v214, v218
v_swap_b32 v215, v219
v_swap_b32 v216, v220
v_swap_b32 v217, v221
v_swap_b32 v222, v226
v_swap_b32 v223, v227
v_swap_b32 v224, v228
v_swap_b32 v225, v229
v_swap_b32 v230, v234
v_swap_b32 v231, v235
v_swap_b32 v232, v236
v_swap_b32 v233, v237
L_kh_31:
v_mov_b32 v138, 1073741824
s_mul_i32 s66, s70, 18432
s_mul_i32 s32, s28, 2304
s_add_u32 s66, s66, s32
s_add_u32 s66, s66, 30834688
v_mov_b32 v140, v1
v_add_u32 v141, 2048, v140
v_cndmask_b32 v141, v138, v141, s[46:47]
s_lshl_b32 s67, s70, 7
s_lshl_b32 s32, s28, 14
s_mov_b64 exec, 1
buffer_atomic_add v246, v6, s[8:11], s35 offen sc0 sc1
s_mov_b64 exec, -1
buffer_load_dwordx4 v1, s[4:7], s39 offen offset:2048 sc1 lds
buffer_load_dwordx4 v1, s[4:7], s39 offen offset:3072 sc1 lds
s_add_u32 m0, m0, 4096
s_add_u32 s39, s39, 4096
buffer_load_dwordx4 v1, s[4:7], s39 offen offset:0 sc1 lds
s_add_u32 s67, s67, s32
s_add_u32 s67, s67, 33193984
v_lshlrev_b32 v139, 3, v2
v_cndmask_b32 v138, v138, v139, s[46:47]
v_mov_b32 v162, 1073741824
s_mul_i32 s68, s70, 18432
s_mul_i32 s32, s28, 144
s_add_u32 s68, s68, s32
v_mul_u32_u24 v164, 1152, v2
v_lshl_add_u32 v164, v3, 4, v164
v_add_u32 v165, 128, v164
v_cndmask_b32 v165, v162, v165, s[46:47]
ds_read_b128 a[160:163], v36 offset:0
ds_read_b128 a[164:167], v36 offset:1024
ds_read_b128 a[168:171], v36 offset:2048
ds_read_b128 a[172:175], v36 offset:3072
ds_read_b128 a[176:179], v40 offset:0
ds_read_b128 a[180:183], v36 offset:4608
ds_read_b128 a[184:187], v36 offset:5632
ds_read_b128 a[188:191], v36 offset:6656
ds_read_b128 a[192:195], v36 offset:7680
ds_read_b128 a[196:199], v40 offset:4608
s_cmp_eq_u32 s71, 0
s_cselect_b32 s98, 4096, 0
s_add_u32 s60, s60, s98
s_cmp_eq_u32 s24, 1
s_cbranch_scc0 L_other_34
s_mov_b32 s31, 0
s_mov_b64 exec, 1
v_mov_b32 v247, 0
buffer_atomic_add v247, v6, s[8:11], s35 offen sc0 sc1
s_waitcnt vmcnt(14)
v_cmp_gt_u32 vcc, 8, v244
s_nop 0
s_cbranch_vccz L_polled_33
s_waitcnt vmcnt(9)
v_cmp_gt_u32 vcc, 8, v245
s_nop 0
s_cbranch_vccz L_polled_33
v_mov_b32 v244, 0
buffer_atomic_add v244, v6, s[8:11], s35 offen sc0 sc1
s_waitcnt vmcnt(5)
v_cmp_gt_u32 vcc, 8, v246
s_nop 0
s_cbranch_vccz L_polled_33
v_mov_b32 v245, 0
buffer_atomic_add v245, v6, s[8:11], s35 offen sc0 sc1
L_poll_32:
s_add_u32 s31, s31, 1
s_cmp_gt_u32 s31, 100000
s_cbranch_scc1 L_polled_33
v_mov_b32 v246, 0
buffer_atomic_add v246, v6, s[8:11], s35 offen sc0 sc1
s_waitcnt vmcnt(3)
v_cmp_gt_u32 vcc, 8, v247
s_nop 0
s_cbranch_vccz L_polled_33
v_mov_b32 v247, 0
buffer_atomic_add v247, v6, s[8:11], s35 offen sc0 sc1
s_waitcnt vmcnt(3)
v_cmp_gt_u32 vcc, 8, v244
s_nop 0
s_cbranch_vccz L_polled_33
v_mov_b32 v244, 0
buffer_atomic_add v244, v6, s[8:11], s35 offen sc0 sc1
s_waitcnt vmcnt(3)
v_cmp_gt_u32 vcc, 8, v245
s_nop 0
s_cbranch_vccz L_polled_33
v_mov_b32 v245, 0
buffer_atomic_add v245, v6, s[8:11], s35 offen sc0 sc1
s_waitcnt vmcnt(3)
v_cmp_gt_u32 vcc, 8, v246
s_nop 0
s_cbranch_vccz L_polled_33
s_branch L_poll_32
L_polled_33:
s_mov_b64 exec, -1
L_other_34:
s_barrier
buffer_load_dwordx4 a[0:3], v1, s[8:11], s60 offen offset:0 sc1
buffer_load_dwordx4 a[4:7], v1, s[8:11], s60 offen offset:1024 sc1
s_waitcnt lgkmcnt(5)
v_mfma_f32_16x16x32_bf16 v[44:47], a[160:163], v[206:209], 0
ds_read_b128 a[200:203], v36 offset:9216
buffer_load_dwordx4 a[8:11], v1, s[8:11], s60 offen offset:2048 sc1
v_mfma_f32_16x16x32_bf16 v[16:19], a[160:163], v[210:213], v[16:19]
v_mfma_f32_16x16x32_bf16 v[48:51], a[164:167], v[206:209], 0
ds_read_b128 a[204:207], v36 offset:10240
buffer_load_dwordx4 a[12:15], v1, s[8:11], s60 offen offset:3072 sc1
v_mfma_f32_16x16x32_bf16 v[20:23], a[164:167], v[210:213], v[20:23]
s_add_u32 s60, s60, 4096
v_mfma_f32_16x16x32_bf16 v[52:55], a[168:171], v[206:209], 0
ds_read_b128 a[208:211], v36 offset:11264
v_mfma_f32_16x16x32_bf16 v[24:27], a[168:171], v[210:213], v[24:27]
v_mfma_f32_16x16x32_bf16 v[56:59], a[172:175], v[206:209], 0
ds_read_b128 a[212:215], v36 offset:12288
buffer_load_dwordx4 a[16:19], v1, s[8:11], s60 offen offset:0 sc1
v_mfma_f32_16x16x32_bf16 v[28:31], a[172:175], v[210:213], v[28:31]
s_cmp_eq_u32 s71, 5
s_cselect_b32 s98, 4096, 0
v_mfma_f32_16x16x32_bf16 v[60:63], a[176:179], v[206:209], 0
ds_read_b128 a[216:219], v40 offset:9216
v_mfma_f32_16x16x32_bf16 v[32:35], a[176:179], v[210:213], v[32:35]
s_add_u32 s60, s60, s98
s_waitcnt lgkmcnt(5)
v_mfma_f32_16x16x32_bf16 v[44:47], a[180:183], v[214:217], v[44:47]
ds_read_b128 a[160:163], v36 offset:13824
v_mov_b32 v67, v248
v_mfma_f32_16x16x32_bf16 v[16:19], a[180:183], v[218:221], v[16:19]
v_mfma_f32_16x16x32_bf16 v[48:51], a[184:187], v[214:217], v[48:51]
ds_read_b128 a[164:167], v36 offset:14848
v_mfma_f32_16x16x32_bf16 v[20:23], a[184:187], v[218:221], v[20:23]
v_mfma_f32_16x16x32_bf16 v[52:55], a[188:191], v[214:217], v[52:55]
ds_read_b128 a[168:171], v36 offset:15872
v_mfma_f32_16x16x32_bf16 v[24:27], a[188:191], v[218:221], v[24:27]
buffer_load_dwordx4 a[20:23], v1, s[8:11], s60 offen offset:1024 sc1
v_mfma_f32_16x16x32_bf16 v[56:59], a[192:195], v[214:217], v[56:59]
ds_read_b128 a[172:175], v36 offset:16896
v_mfma_f32_16x16x32_bf16 v[28:31], a[192:195], v[218:221], v[28:31]
buffer_load_dwordx4 a[24:27], v1, s[8:11], s60 offen offset:2048 sc1
v_mov_b32 v71, v248
v_mfma_f32_16x16x32_bf16 v[60:63], a[196:199], v[214:217], v[60:63]
ds_read_b128 a[176:179], v40 offset:13824
v_mfma_f32_16x16x32_bf16 v[32:35], a[196:199], v[218:221], v[32:35]
buffer_load_dwordx4 a[28:31], v1, s[8:11], s60 offen offset:3072 sc1
s_waitcnt lgkmcnt(5)
v_mfma_f32_16x16x32_bf16 v[44:47], a[200:203], v[222:225], v[44:47]
ds_read_b128 a[180:183], v36 offset:18432
v_mfma_f32_16x16x32_bf16 v[16:19], a[200:203], v[226:229], v[16:19]
s_add_u32 s60, s60, 4096
v_mfma_f32_16x16x32_bf16 v[48:51], a[204:207], v[222:225], v[48:51]
ds_read_b128 a[184:187], v36 offset:19456
v_mfma_f32_16x16x32_bf16 v[20:23], a[204:207], v[226:229], v[20:23]
v_mfma_f32_16x16x32_bf16 v[52:55], a[208:211], v[222:225], v[52:55]
ds_read_b128 a[188:191], v36 offset:20480
buffer_load_dwordx4 a[32:35], v1, s[8:11], s60 offen offset:0 sc1
v_mfma_f32_16x16x32_bf16 v[24:27], a[208:211], v[226:229], v[24:27]
s_cmp_eq_u32 s71, 9
s_cselect_b32 s98, 4096, 0
v_mov_b32 v75, v248
v_mfma_f32_16x16x32_bf16 v[56:59], a[212:215], v[222:225], v[56:59]
ds_read_b128 a[192:195], v36 offset:21504
v_mfma_f32_16x16x32_bf16 v[28:31], a[212:215], v[226:229], v[28:31]
s_add_u32 s60, s60, s98
v_mfma_f32_16x16x32_bf16 v[60:63], a[216:219], v[222:225], v[60:63]
ds_read_b128 a[196:199], v40 offset:18432
v_mfma_f32_16x16x32_bf16 v[32:35], a[216:219], v[226:229], v[32:35]
s_waitcnt lgkmcnt(5)
v_mfma_f32_16x16x32_bf16 v[44:47], a[160:163], v[230:233], v[44:47]
ds_read_b128 a[200:203], v36 offset:23040
v_mfma_f32_16x16x32_bf16 v[16:19], a[160:163], v[234:237], v[16:19]
v_mfma_f32_16x16x32_bf16 v[48:51], a[164:167], v[230:233], v[48:51]
ds_read_b128 a[204:207], v36 offset:24064
buffer_load_dwordx4 a[36:39], v1, s[8:11], s60 offen offset:1024 sc1
v_mfma_f32_16x16x32_bf16 v[20:23], a[164:167], v[234:237], v[20:23]
v_mov_b32 v79, v248
v_mfma_f32_16x16x32_bf16 v[52:55], a[168:171], v[230:233], v[52:55]
ds_read_b128 a[208:211], v36 offset:25088
v_mfma_f32_16x16x32_bf16 v[24:27], a[168:171], v[234:237], v[24:27]
v_mfma_f32_16x16x32_bf16 v[56:59], a[172:175], v[230:233], v[56:59]
ds_read_b128 a[212:215], v36 offset:26112
v_mfma_f32_16x16x32_bf16 v[28:31], a[172:175], v[234:237], v[28:31]
v_mfma_f32_16x16x32_bf16 v[60:63], a[176:179], v[230:233], v[60:63]
ds_read_b128 a[216:219], v40 offset:23040
v_mfma_f32_16x16x32_bf16 v[32:35], a[176:179], v[234:237], v[32:35]
s_waitcnt vmcnt(9) lgkmcnt(5)
v_mfma_f32_16x16x32_bf16 v[44:47], a[180:183], a[0:3], v[44:47]
ds_read_b128 a[160:163], v36 offset:27648
buffer_load_dwordx4 a[40:43], v1, s[8:11], s60 offen offset:2048 sc1
v_mfma_f32_16x16x32_bf16 v[48:51], a[184:187], a[0:3], v[48:51]
ds_read_b128 a[164:167], v36 offset:28672
v_mfma_f32_16x16x32_bf16 v[52:55], a[188:191], a[0:3], v[52:55]
ds_read_b128 a[168:171], v36 offset:29696
v_mfma_f32_16x16x32_bf16 v[56:59], a[192:195], a[0:3], v[56:59]
ds_read_b128 a[172:175], v36 offset:30720
v_mfma_f32_16x16x32_bf16 v[60:63], a[196:199], a[0:3], v[60:63]
ds_read_b128 a[176:179], v40 offset:27648
s_waitcnt vmcnt(9) lgkmcnt(5)
v_mfma_f32_16x16x32_bf16 v[44:47], a[200:203], a[4:7], v[44:47]
ds_read_b128 a[180:183], v36 offset:32256
buffer_load_dwordx4 a[44:47], v1, s[8:11], s60 offen offset:3072 sc1
v_mfma_f32_16x16x32_bf16 v[48:51], a[204:207], a[4:7], v[48:51]
ds_read_b128 a[184:187], v36 offset:33280
v_mfma_f32_16x16x32_bf16 v[52:55], a[208:211], a[4:7], v[52:55]
ds_read_b128 a[188:191], v36 offset:34304
v_mfma_f32_16x16x32_bf16 v[56:59], a[212:215], a[4:7], v[56:59]
ds_read_b128 a[192:195], v36 offset:35328
v_mfma_f32_16x16x32_bf16 v[60:63], a[216:219], a[4:7], v[60:63]
ds_read_b128 a[196:199], v40 offset:32256
s_waitcnt vmcnt(9) lgkmcnt(5)
v_mfma_f32_16x16x32_bf16 v[44:47], a[160:163], a[8:11], v[44:47]
ds_read_b128 a[200:203], v36 offset:36864
s_add_u32 s60, s60, 4096
v_mfma_f32_16x16x32_bf16 v[48:51], a[164:167], a[8:11], v[48:51]
ds_read_b128 a[204:207], v36 offset:37888
buffer_load_dwordx4 a[48:51], v1, s[8:11], s60 offen offset:0 sc1
v_mfma_f32_16x16x32_bf16 v[52:55], a[168:171], a[8:11], v[52:55]
ds_read_b128 a[208:211], v36 offset:38912
buffer_load_dwordx4 a[52:55], v1, s[8:11], s60 offen offset:1024 sc1
v_mfma_f32_16x16x32_bf16 v[56:59], a[172:175], a[8:11], v[56:59]
ds_read_b128 a[212:215], v36 offset:39936
v_mfma_f32_16x16x32_bf16 v[60:63], a[176:179], a[8:11], v[60:63]
ds_read_b128 a[216:219], v40 offset:36864
s_waitcnt vmcnt(10) lgkmcnt(5)
v_mfma_f32_16x16x32_bf16 v[44:47], a[180:183], a[12:15], v[44:47]
ds_read_b128 a[160:163], v36 offset:41472
v_mfma_f32_16x16x32_bf16 v[48:51], a[184:187], a[12:15], v[48:51]
ds_read_b128 a[164:167], v36 offset:42496
v_mfma_f32_16x16x32_bf16 v[52:55], a[188:191], a[12:15], v[52:55]
ds_read_b128 a[168:171], v36 offset:43520
v_mfma_f32_16x16x32_bf16 v[56:59], a[192:195], a[12:15], v[56:59]
ds_read_b128 a[172:175], v36 offset:44544
s_cmp_eq_u32 s71, 14
s_cselect_b32 s98, 4096, 0
s_add_u32 s60, s60, s98
buffer_load_dwordx4 a[56:59], v1, s[8:11], s60 offen offset:2048 sc1
v_mfma_f32_16x16x32_bf16 v[60:63], a[196:199], a[12:15], v[60:63]
ds_read_b128 a[176:179], v40 offset:41472
s_waitcnt vmcnt(10) lgkmcnt(5)
v_mfma_f32_16x16x32_bf16 v[44:47], a[200:203], a[16:19], v[44:47]
ds_read_b128 a[180:183], v36 offset:46080
buffer_load_dwordx4 a[60:63], v1, s[8:11], s60 offen offset:3072 sc1
v_mfma_f32_16x16x32_bf16 v[48:51], a[204:207], a[16:19], v[48:51]
ds_read_b128 a[184:187], v36 offset:47104
v_mfma_f32_16x16x32_bf16 v[52:55], a[208:211], a[16:19], v[52:55]
ds_read_b128 a[188:191], v36 offset:48128
v_mfma_f32_16x16x32_bf16 v[56:59], a[212:215], a[16:19], v[56:59]
ds_read_b128 a[192:195], v36 offset:49152
v_mfma_f32_16x16x32_bf16 v[60:63], a[216:219], a[16:19], v[60:63]
ds_read_b128 a[196:199], v40 offset:46080
s_barrier
s_waitcnt vmcnt(10) lgkmcnt(5)
v_mfma_f32_16x16x32_bf16 v[44:47], a[160:163], a[20:23], v[44:47]
ds_read_b128 a[200:203], v36 offset:50688
s_add_u32 s60, s60, 4096
v_mfma_f32_16x16x32_bf16 v[48:51], a[164:167], a[20:23], v[48:51]
ds_read_b128 a[204:207], v36 offset:51712
buffer_load_dwordx4 a[64:67], v1, s[8:11], s60 offen offset:0 sc1
v_mfma_f32_16x16x32_bf16 v[52:55], a[168:171], a[20:23], v[52:55]
ds_read_b128 a[208:211], v36 offset:52736
buffer_load_dwordx4 a[0:3], v1, s[8:11], s60 offen offset:1024 sc1
v_mfma_f32_16x16x32_bf16 v[56:59], a[172:175], a[20:23], v[56:59]
ds_read_b128 a[212:215], v36 offset:53760
v_mfma_f32_16x16x32_bf16 v[60:63], a[176:179], a[20:23], v[60:63]
ds_read_b128 a[216:219], v40 offset:50688
s_waitcnt vmcnt(11) lgkmcnt(5)
v_mfma_f32_16x16x32_bf16 v[44:47], a[180:183], a[24:27], v[44:47]
ds_read_b128 a[160:163], v37 offset:0
v_mfma_f32_16x16x32_bf16 v[48:51], a[184:187], a[24:27], v[48:51]
ds_read_b128 a[164:167], v37 offset:1024
v_mfma_f32_16x16x32_bf16 v[52:55], a[188:191], a[24:27], v[52:55]
ds_read_b128 a[168:171], v37 offset:2048
v_mfma_f32_16x16x32_bf16 v[56:59], a[192:195], a[24:27], v[56:59]
ds_read_b128 a[172:175], v37 offset:3072
s_cmp_eq_u32 s71, 18
s_cselect_b32 s98, 4096, 0
s_add_u32 s60, s60, s98
buffer_load_dwordx4 a[4:7], v1, s[8:11], s60 offen offset:2048 sc1
v_mfma_f32_16x16x32_bf16 v[60:63], a[196:199], a[24:27], v[60:63]
ds_read_b128 a[176:179], v41 offset:0
s_waitcnt vmcnt(11) lgkmcnt(5)
v_mfma_f32_16x16x32_bf16 v[44:47], a[200:203], a[28:31], v[44:47]
ds_read_b128 a[180:183], v37 offset:4608
buffer_load_dwordx4 a[8:11], v1, s[8:11], s60 offen offset:3072 sc1
v_mfma_f32_16x16x32_bf16 v[48:51], a[204:207], a[28:31], v[48:51]
ds_read_b128 a[184:187], v37 offset:5632
v_mfma_f32_16x16x32_bf16 v[52:55], a[208:211], a[28:31], v[52:55]
ds_read_b128 a[188:191], v37 offset:6656
v_mfma_f32_16x16x32_bf16 v[56:59], a[212:215], a[28:31], v[56:59]
ds_read_b128 a[192:195], v37 offset:7680
v_mfma_f32_16x16x32_bf16 v[60:63], a[216:219], a[28:31], v[60:63]
ds_read_b128 a[196:199], v41 offset:4608
s_waitcnt vmcnt(11) lgkmcnt(5)
v_mfma_f32_16x16x32_bf16 v[44:47], a[160:163], a[32:35], v[44:47]
ds_read_b128 a[200:203], v37 offset:9216
s_add_u32 s60, s60, 4096
v_mfma_f32_16x16x32_bf16 v[48:51], a[164:167], a[32:35], v[48:51]
ds_read_b128 a[204:207], v37 offset:10240
buffer_load_dwordx4 a[12:15], v1, s[8:11], s60 offen offset:0 sc1
v_mfma_f32_16x16x32_bf16 v[52:55], a[168:171], a[32:35], v[52:55]
ds_read_b128 a[208:211], v37 offset:11264
buffer_load_dwordx4 a[16:19], v1, s[8:11], s60 offen offset:1024 sc1
v_mfma_f32_16x16x32_bf16 v[56:59], a[172:175], a[32:35], v[56:59]
ds_read_b128 a[212:215], v37 offset:12288
v_mfma_f32_16x16x32_bf16 v[60:63], a[176:179], a[32:35], v[60:63]
ds_read_b128 a[216:219], v41 offset:9216
s_waitcnt vmcnt(12) lgkmcnt(5)
v_mfma_f32_16x16x32_bf16 v[44:47], a[180:183], a[36:39], v[44:47]
ds_read_b128 a[160:163], v37 offset:13824
buffer_load_dwordx4 a[20:23], v1, s[8:11], s60 offen offset:2048 sc1
v_mfma_f32_16x16x32_bf16 v[48:51], a[184:187], a[36:39], v[48:51]
ds_read_b128 a[164:167], v37 offset:14848
v_mfma_f32_16x16x32_bf16 v[52:55], a[188:191], a[36:39], v[52:55]
ds_read_b128 a[168:171], v37 offset:15872
v_mfma_f32_16x16x32_bf16 v[56:59], a[192:195], a[36:39], v[56:59]
ds_read_b128 a[172:175], v37 offset:16896
v_mfma_f32_16x16x32_bf16 v[60:63], a[196:199], a[36:39], v[60:63]
ds_read_b128 a[176:179], v41 offset:13824
s_waitcnt vmcnt(12) lgkmcnt(5)
v_mfma_f32_16x16x32_bf16 v[44:47], a[200:203], a[40:43], v[44:47]
ds_read_b128 a[180:183], v37 offset:18432
buffer_load_dwordx4 a[228:231], v1, s[4:7], s64 offen offset:2048 sc1
v_mfma_f32_16x16x32_bf16 v[48:51], a[204:207], a[40:43], v[48:51]
ds_read_b128 a[184:187], v37 offset:19456
v_mfma_f32_16x16x32_bf16 v[52:55], a[208:211], a[40:43], v[52:55]
ds_read_b128 a[188:191], v37 offset:20480
v_mfma_f32_16x16x32_bf16 v[56:59], a[212:215], a[40:43], v[56:59]
ds_read_b128 a[192:195], v37 offset:21504
s_cmp_eq_u32 s71, 23
s_cselect_b32 s98, 4096, 0
s_add_u32 s60, s60, s98
buffer_load_dwordx4 a[24:27], v1, s[8:11], s60 offen offset:3072 sc1
v_mfma_f32_16x16x32_bf16 v[60:63], a[216:219], a[40:43], v[60:63]
ds_read_b128 a[196:199], v41 offset:18432
s_waitcnt vmcnt(13) lgkmcnt(5)
v_mfma_f32_16x16x32_bf16 v[44:47], a[160:163], a[44:47], v[44:47]
ds_read_b128 a[200:203], v37 offset:23040
s_add_u32 s60, s60, 4096
v_mfma_f32_16x16x32_bf16 v[48:51], a[164:167], a[44:47], v[48:51]
ds_read_b128 a[204:207], v37 offset:24064
buffer_load_dwordx4 a[28:31], v1, s[8:11], s60 offen offset:0 sc1
v_mfma_f32_16x16x32_bf16 v[52:55], a[168:171], a[44:47], v[52:55]
ds_read_b128 a[208:211], v37 offset:25088
buffer_load_dwordx4 a[32:35], v1, s[8:11], s60 offen offset:1024 sc1
v_mfma_f32_16x16x32_bf16 v[56:59], a[172:175], a[44:47], v[56:59]
ds_read_b128 a[212:215], v37 offset:26112
v_mfma_f32_16x16x32_bf16 v[60:63], a[176:179], a[44:47], v[60:63]
ds_read_b128 a[216:219], v41 offset:23040
s_waitcnt vmcnt(14) lgkmcnt(5)
v_mfma_f32_16x16x32_bf16 v[44:47], a[180:183], a[48:51], v[44:47]
ds_read_b128 a[160:163], v37 offset:27648
buffer_load_dwordx4 a[36:39], v1, s[8:11], s60 offen offset:2048 sc1
v_mfma_f32_16x16x32_bf16 v[48:51], a[184:187], a[48:51], v[48:51]
ds_read_b128 a[164:167], v37 offset:28672
v_mfma_f32_16x16x32_bf16 v[52:55], a[188:191], a[48:51], v[52:55]
ds_read_b128 a[168:171], v37 offset:29696
v_mfma_f32_16x16x32_bf16 v[56:59], a[192:195], a[48:51], v[56:59]
ds_read_b128 a[172:175], v37 offset:30720
buffer_load_dwordx4 a[232:235], v1, s[4:7], s64 offen offset:3072 sc1
v_mfma_f32_16x16x32_bf16 v[60:63], a[196:199], a[48:51], v[60:63]
ds_read_b128 a[176:179], v41 offset:27648
s_waitcnt vmcnt(15) lgkmcnt(5)
v_mfma_f32_16x16x32_bf16 v[44:47], a[200:203], a[52:55], v[44:47]
ds_read_b128 a[180:183], v37 offset:32256
v_mfma_f32_16x16x32_bf16 v[48:51], a[204:207], a[52:55], v[48:51]
ds_read_b128 a[184:187], v37 offset:33280
v_mfma_f32_16x16x32_bf16 v[52:55], a[208:211], a[52:55], v[52:55]
ds_read_b128 a[188:191], v37 offset:34304
v_mfma_f32_16x16x32_bf16 v[56:59], a[212:215], a[52:55], v[56:59]
ds_read_b128 a[192:195], v37 offset:35328
s_cmp_eq_u32 s71, 27
s_cselect_b32 s98, 4096, 0
s_add_u32 s60, s60, s98
buffer_load_dwordx4 a[40:43], v1, s[8:11], s60 offen offset:3072 sc1
v_mfma_f32_16x16x32_bf16 v[60:63], a[216:219], a[52:55], v[60:63]
ds_read_b128 a[196:199], v41 offset:32256
s_waitcnt vmcnt(15) lgkmcnt(5)
v_mfma_f32_16x16x32_bf16 v[44:47], a[160:163], a[56:59], v[44:47]
ds_read_b128 a[200:203], v37 offset:36864
s_add_u32 s60, s60, 4096
v_mfma_f32_16x16x32_bf16 v[48:51], a[164:167], a[56:59], v[48:51]
ds_read_b128 a[204:207], v37 offset:37888
buffer_load_dwordx4 a[44:47], v1, s[8:11], s60 offen offset:0 sc1
v_mfma_f32_16x16x32_bf16 v[52:55], a[168:171], a[56:59], v[52:55]
ds_read_b128 a[208:211], v37 offset:38912
buffer_load_dwordx4 a[48:51], v1, s[8:11], s60 offen offset:1024 sc1
v_mfma_f32_16x16x32_bf16 v[56:59], a[172:175], a[56:59], v[56:59]
ds_read_b128 a[212:215], v37 offset:39936
v_mfma_f32_16x16x32_bf16 v[60:63], a[176:179], a[56:59], v[60:63]
ds_read_b128 a[216:219], v41 offset:36864
s_waitcnt vmcnt(16) lgkmcnt(5)
v_mfma_f32_16x16x32_bf16 v[44:47], a[180:183], a[60:63], v[44:47]
ds_read_b128 a[160:163], v37 offset:41472
buffer_load_dwordx4 a[52:55], v1, s[8:11], s60 offen offset:2048 sc1
v_mfma_f32_16x16x32_bf16 v[48:51], a[184:187], a[60:63], v[48:51]
ds_read_b128 a[164:167], v37 offset:42496
v_mfma_f32_16x16x32_bf16 v[52:55], a[188:191], a[60:63], v[52:55]
ds_read_b128 a[168:171], v37 offset:43520
buffer_load_dwordx4 a[236:239], v116, s[4:7], s64 offen sc1
v_mfma_f32_16x16x32_bf16 v[56:59], a[192:195], a[60:63], v[56:59]
ds_read_b128 a[172:175], v37 offset:44544
v_mfma_f32_16x16x32_bf16 v[60:63], a[196:199], a[60:63], v[60:63]
ds_read_b128 a[176:179], v41 offset:41472
s_waitcnt vmcnt(17) lgkmcnt(5)
v_mfma_f32_16x16x32_bf16 v[44:47], a[200:203], a[64:67], v[44:47]
ds_read_b128 a[180:183], v37 offset:46080
buffer_load_dwordx4 a[56:59], v1, s[8:11], s60 offen offset:3072 sc1
v_mfma_f32_16x16x32_bf16 v[48:51], a[204:207], a[64:67], v[48:51]
ds_read_b128 a[184:187], v37 offset:47104
v_mfma_f32_16x16x32_bf16 v[52:55], a[208:211], a[64:67], v[52:55]
ds_read_b128 a[188:191], v37 offset:48128
v_mfma_f32_16x16x32_bf16 v[56:59], a[212:215], a[64:67], v[56:59]
ds_read_b128 a[192:195], v37 offset:49152
v_mfma_f32_16x16x32_bf16 v[60:63], a[216:219], a[64:67], v[60:63]
ds_read_b128 a[196:199], v41 offset:46080
s_waitcnt vmcnt(17) lgkmcnt(5)
v_mfma_f32_16x16x32_bf16 v[44:47], a[160:163], a[0:3], v[44:47]
ds_read_b128 a[200:203], v37 offset:50688
s_mov_b32 s60, s61
v_mfma_f32_16x16x32_bf16 v[48:51], a[164:167], a[0:3], v[48:51]
ds_read_b128 a[204:207], v37 offset:51712
v_mfma_f32_16x16x32_bf16 v[52:55], a[168:171], a[0:3], v[52:55]
ds_read_b128 a[208:211], v37 offset:52736
v_mfma_f32_16x16x32_bf16 v[56:59], a[172:175], a[0:3], v[56:59]
ds_read_b128 a[212:215], v37 offset:53760
s_cmp_eq_u32 s71, 0
s_cselect_b32 s98, 4096, 0
s_add_u32 s60, s60, s98
buffer_load_dwordx4 a[60:63], v1, s[8:11], s60 offen offset:0 sc1
buffer_load_dwordx4 a[64:67], v1, s[8:11], s60 offen offset:1024 sc1
v_mfma_f32_16x16x32_bf16 v[60:63], a[176:179], a[0:3], v[60:63]
ds_read_b128 a[216:219], v41 offset:50688
s_waitcnt vmcnt(18) lgkmcnt(5)
v_mfma_f32_16x16x32_bf16 v[44:47], a[180:183], a[4:7], v[44:47]
ds_read_b128 a[160:163], v38 offset:0
buffer_load_dwordx4 a[0:3], v1, s[8:11], s60 offen offset:2048 sc1
v_mfma_f32_16x16x32_bf16 v[48:51], a[184:187], a[4:7], v[48:51]
ds_read_b128 a[164:167], v38 offset:1024
v_mfma_f32_16x16x32_bf16 v[52:55], a[188:191], a[4:7], v[52:55]
ds_read_b128 a[168:171], v38 offset:2048
v_mfma_f32_16x16x32_bf16 v[56:59], a[192:195], a[4:7], v[56:59]
ds_read_b128 a[172:175], v38 offset:3072
v_mfma_f32_16x16x32_bf16 v[60:63], a[196:199], a[4:7], v[60:63]
ds_read_b128 a[176:179], v42 offset:0
s_waitcnt vmcnt(18) lgkmcnt(5)
v_mfma_f32_16x16x32_bf16 v[44:47], a[200:203], a[8:11], v[44:47]
ds_read_b128 a[180:183], v38 offset:4608
buffer_load_dwordx4 a[4:7], v1, s[8:11], s60 offen offset:3072 sc1
v_mfma_f32_16x16x32_bf16 v[48:51], a[204:207], a[8:11], v[48:51]
ds_read_b128 a[184:187], v38 offset:5632
v_mfma_f32_16x16x32_bf16 v[52:55], a[208:211], a[8:11], v[52:55]
ds_read_b128 a[188:191], v38 offset:6656
v_mfma_f32_16x16x32_bf16 v[56:59], a[212:215], a[8:11], v[56:59]
ds_read_b128 a[192:195], v38 offset:7680
v_mfma_f32_16x16x32_bf16 v[60:63], a[216:219], a[8:11], v[60:63]
ds_read_b128 a[196:199], v42 offset:4608
s_waitcnt vmcnt(18) lgkmcnt(5)
v_mfma_f32_16x16x32_bf16 v[44:47], a[160:163], a[12:15], v[44:47]
ds_read_b128 a[200:203], v38 offset:9216
s_add_u32 s60, s60, 4096
v_mfma_f32_16x16x32_bf16 v[48:51], a[164:167], a[12:15], v[48:51]
ds_read_b128 a[204:207], v38 offset:10240
v_mfma_f32_16x16x32_bf16 v[52:55], a[168:171], a[12:15], v[52:55]
ds_read_b128 a[208:211], v38 offset:11264
buffer_load_dwordx4 a[8:11], v1, s[8:11], s60 offen offset:0 sc1
v_mfma_f32_16x16x32_bf16 v[56:59], a[172:175], a[12:15], v[56:59]
ds_read_b128 a[212:215], v38 offset:12288
v_mfma_f32_16x16x32_bf16 v[60:63], a[176:179], a[12:15], v[60:63]
ds_read_b128 a[216:219], v42 offset:9216
s_waitcnt vmcnt(18) lgkmcnt(5)
v_mfma_f32_16x16x32_bf16 v[44:47], a[180:183], a[16:19], v[44:47]
ds_read_b128 a[160:163], v38 offset:13824
v_mfma_f32_16x16x32_bf16 v[48:51], a[184:187], a[16:19], v[48:51]
ds_read_b128 a[164:167], v38 offset:14848
v_mfma_f32_16x16x32_bf16 v[52:55], a[188:191], a[16:19], v[52:55]
ds_read_b128 a[168:171], v38 offset:15872
v_mfma_f32_16x16x32_bf16 v[56:59], a[192:195], a[16:19], v[56:59]
ds_read_b128 a[172:175], v38 offset:16896
s_cmp_eq_u32 s71, 5
s_cselect_b32 s98, 4096, 0
s_add_u32 s60, s60, s98
buffer_load_dwordx4 a[12:15], v1, s[8:11], s60 offen offset:1024 sc1
v_mfma_f32_16x16x32_bf16 v[60:63], a[196:199], a[16:19], v[60:63]
ds_read_b128 a[176:179], v42 offset:13824
s_waitcnt vmcnt(18) lgkmcnt(5)
v_mfma_f32_16x16x32_bf16 v[44:47], a[200:203], a[20:23], v[44:47]
ds_read_b128 a[180:183], v38 offset:18432
buffer_load_dwordx4 a[16:19], v1, s[8:11], s60 offen offset:2048 sc1
v_mfma_f32_16x16x32_bf16 v[48:51], a[204:207], a[20:23], v[48:51]
ds_read_b128 a[184:187], v38 offset:19456
v_mfma_f32_16x16x32_bf16 v[52:55], a[208:211], a[20:23], v[52:55]
ds_read_b128 a[188:191], v38 offset:20480
v_mfma_f32_16x16x32_bf16 v[56:59], a[212:215], a[20:23], v[56:59]
ds_read_b128 a[192:195], v38 offset:21504
v_mfma_f32_16x16x32_bf16 v[60:63], a[216:219], a[20:23], v[60:63]
ds_read_b128 a[196:199], v42 offset:18432
s_waitcnt vmcnt(17) lgkmcnt(5)
v_mfma_f32_16x16x32_bf16 v[44:47], a[160:163], a[24:27], v[44:47]
ds_read_b128 a[200:203], v38 offset:23040
buffer_load_dwordx4 a[20:23], v1, s[8:11], s60 offen offset:3072 sc1
v_mfma_f32_16x16x32_bf16 v[48:51], a[164:167], a[24:27], v[48:51]
ds_read_b128 a[204:207], v38 offset:24064
v_mfma_f32_16x16x32_bf16 v[52:55], a[168:171], a[24:27], v[52:55]
ds_read_b128 a[208:211], v38 offset:25088
v_mfma_f32_16x16x32_bf16 v[56:59], a[172:175], a[24:27], v[56:59]
ds_read_b128 a[212:215], v38 offset:26112
v_mfma_f32_16x16x32_bf16 v[60:63], a[176:179], a[24:27], v[60:63]
ds_read_b128 a[216:219], v42 offset:23040
s_waitcnt vmcnt(17) lgkmcnt(5)
v_mfma_f32_16x16x32_bf16 v[44:47], a[180:183], a[28:31], v[44:47]
ds_read_b128 a[160:163], v38 offset:27648
s_add_u32 s60, s60, 4096
v_mfma_f32_16x16x32_bf16 v[48:51], a[184:187], a[28:31], v[48:51]
ds_read_b128 a[164:167], v38 offset:28672
v_mfma_f32_16x16x32_bf16 v[52:55], a[188:191], a[28:31], v[52:55]
ds_read_b128 a[168:171], v38 offset:29696
buffer_load_dwordx4 a[24:27], v1, s[8:11], s60 offen offset:0 sc1
v_mfma_f32_16x16x32_bf16 v[56:59], a[192:195], a[28:31], v[56:59]
ds_read_b128 a[172:175], v38 offset:30720
v_mfma_f32_16x16x32_bf16 v[60:63], a[196:199], a[28:31], v[60:63]
ds_read_b128 a[176:179], v42 offset:27648
s_waitcnt vmcnt(17) lgkmcnt(5)
v_mfma_f32_16x16x32_bf16 v[44:47], a[200:203], a[32:35], v[44:47]
ds_read_b128 a[180:183], v38 offset:32256
v_mfma_f32_16x16x32_bf16 v[48:51], a[204:207], a[32:35], v[48:51]
ds_read_b128 a[184:187], v38 offset:33280
v_mfma_f32_16x16x32_bf16 v[52:55], a[208:211], a[32:35], v[52:55]
ds_read_b128 a[188:191], v38 offset:34304
v_mfma_f32_16x16x32_bf16 v[56:59], a[212:215], a[32:35], v[56:59]
ds_read_b128 a[192:195], v38 offset:35328
s_cmp_eq_u32 s71, 9
s_cselect_b32 s98, 4096, 0
s_add_u32 s60, s60, s98
buffer_load_dwordx4 a[28:31], v1, s[8:11], s60 offen offset:1024 sc1
v_mfma_f32_16x16x32_bf16 v[60:63], a[216:219], a[32:35], v[60:63]
ds_read_b128 a[196:199], v42 offset:32256
s_waitcnt vmcnt(17) lgkmcnt(5)
v_mfma_f32_16x16x32_bf16 v[44:47], a[160:163], a[36:39], v[44:47]
ds_read_b128 a[200:203], v38 offset:36864
buffer_load_dwordx4 a[32:35], v1, s[8:11], s60 offen offset:2048 sc1
v_mfma_f32_16x16x32_bf16 v[48:51], a[164:167], a[36:39], v[48:51]
ds_read_b128 a[204:207], v38 offset:37888
v_mfma_f32_16x16x32_bf16 v[52:55], a[168:171], a[36:39], v[52:55]
ds_read_b128 a[208:211], v38 offset:38912
v_mfma_f32_16x16x32_bf16 v[56:59], a[172:175], a[36:39], v[56:59]
ds_read_b128 a[212:215], v38 offset:39936
v_mfma_f32_16x16x32_bf16 v[60:63], a[176:179], a[36:39], v[60:63]
ds_read_b128 a[216:219], v42 offset:36864
s_waitcnt vmcnt(16) lgkmcnt(5)
v_mfma_f32_16x16x32_bf16 v[44:47], a[180:183], a[40:43], v[44:47]
ds_read_b128 a[160:163], v38 offset:41472
buffer_load_dwordx4 a[36:39], v1, s[8:11], s60 offen offset:3072 sc1
v_mfma_f32_16x16x32_bf16 v[48:51], a[184:187], a[40:43], v[48:51]
ds_read_b128 a[164:167], v38 offset:42496
v_mfma_f32_16x16x32_bf16 v[52:55], a[188:191], a[40:43], v[52:55]
ds_read_b128 a[168:171], v38 offset:43520
v_mfma_f32_16x16x32_bf16 v[56:59], a[192:195], a[40:43], v[56:59]
ds_read_b128 a[172:175], v38 offset:44544
v_mfma_f32_16x16x32_bf16 v[60:63], a[196:199], a[40:43], v[60:63]
ds_read_b128 a[176:179], v42 offset:41472
s_waitcnt vmcnt(16) lgkmcnt(5)
v_mfma_f32_16x16x32_bf16 v[44:47], a[200:203], a[44:47], v[44:47]
ds_read_b128 a[180:183], v38 offset:46080
s_add_u32 s60, s60, 4096
v_mfma_f32_16x16x32_bf16 v[48:51], a[204:207], a[44:47], v[48:51]
ds_read_b128 a[184:187], v38 offset:47104
v_mfma_f32_16x16x32_bf16 v[52:55], a[208:211], a[44:47], v[52:55]
ds_read_b128 a[188:191], v38 offset:48128
buffer_load_dwordx4 a[40:43], v1, s[8:11], s60 offen offset:0 sc1
v_mfma_f32_16x16x32_bf16 v[56:59], a[212:215], a[44:47], v[56:59]
ds_read_b128 a[192:195], v38 offset:49152
v_mfma_f32_16x16x32_bf16 v[60:63], a[216:219], a[44:47], v[60:63]
ds_read_b128 a[196:199], v42 offset:46080
s_waitcnt vmcnt(16) lgkmcnt(5)
v_mfma_f32_16x16x32_bf16 v[44:47], a[160:163], a[48:51], v[44:47]
ds_read_b128 a[200:203], v38 offset:50688
buffer_load_dwordx4 a[44:47], v1, s[8:11], s60 offen offset:1024 sc1
v_mfma_f32_16x16x32_bf16 v[48:51], a[164:167], a[48:51], v[48:51]
ds_read_b128 a[204:207], v38 offset:51712
v_mfma_f32_16x16x32_bf16 v[52:55], a[168:171], a[48:51], v[52:55]
v_mfma_f32_16x16x32_bf16 v[56:59], a[172:175], a[48:51], v[56:59]
v_mfma_f32_16x16x32_bf16 v[60:63], a[176:179], a[48:51], v[60:63]
s_waitcnt vmcnt(16) lgkmcnt(2)
v_mfma_f32_16x16x32_bf16 v[44:47], a[180:183], a[52:55], v[44:47]
ds_read_b128 a[160:163], v36 offset:18432
v_mfma_f32_16x16x32_bf16 v[48:51], a[184:187], a[52:55], v[48:51]
ds_read_b128 a[164:167], v36 offset:19456
v_mfma_f32_16x16x32_bf16 v[52:55], a[188:191], a[52:55], v[52:55]
ds_read_b128 a[168:171], v36 offset:20480
v_mfma_f32_16x16x32_bf16 v[56:59], a[192:195], a[52:55], v[56:59]
ds_read_b128 a[172:175], v36 offset:21504
s_cmp_eq_u32 s71, 14
s_cselect_b32 s98, 4096, 0
s_add_u32 s60, s60, s98
buffer_load_dwordx4 a[48:51], v1, s[8:11], s60 offen offset:2048 sc1
v_mfma_f32_16x16x32_bf16 v[60:63], a[196:199], a[52:55], v[60:63]
ds_read_b128 a[176:179], v40 offset:18432
s_waitcnt vmcnt(15) lgkmcnt(5)
v_mfma_f32_16x16x32_bf16 v[44:47], a[200:203], a[56:59], v[44:47]
ds_read_b128 a[180:183], v36 offset:23040
buffer_load_dwordx4 a[52:55], v1, s[8:11], s60 offen offset:3072 sc1
v_mfma_f32_16x16x32_bf16 v[48:51], a[204:207], a[56:59], v[48:51]
ds_read_b128 a[184:187], v36 offset:24064
v_mfma_f32_16x16x32_bf16 v[52:55], a[228:231], a[56:59], v[52:55]
ds_read_b128 a[188:191], v36 offset:25088
v_mfma_f32_16x16x32_bf16 v[56:59], a[232:235], a[56:59], v[56:59]
ds_read_b128 a[192:195], v36 offset:26112
v_mfma_f32_16x16x32_bf16 v[60:63], a[236:239], a[56:59], v[60:63]
ds_read_b128 a[196:199], v40 offset:23040
s_waitcnt vmcnt(15) lgkmcnt(5)
v_mfma_f32_16x16x32_bf16 v[16:19], a[160:163], a[60:63], v[16:19]
ds_read_b128 a[200:203], v36 offset:27648
s_add_u32 s60, s60, 4096
v_mfma_f32_16x16x32_bf16 v[20:23], a[164:167], a[60:63], v[20:23]
ds_read_b128 a[204:207], v36 offset:28672
v_mfma_f32_16x16x32_bf16 v[24:27], a[168:171], a[60:63], v[24:27]
ds_read_b128 a[208:211], v36 offset:29696
buffer_load_dwordx4 a[56:59], v1, s[8:11], s60 offen offset:0 sc1
v_mfma_f32_16x16x32_bf16 v[28:31], a[172:175], a[60:63], v[28:31]
ds_read_b128 a[212:215], v36 offset:30720
v_mfma_f32_16x16x32_bf16 v[32:35], a[176:179], a[60:63], v[32:35]
ds_read_b128 a[216:219], v40 offset:27648
s_waitcnt vmcnt(15) lgkmcnt(5)
v_mfma_f32_16x16x32_bf16 v[16:19], a[180:183], a[64:67], v[16:19]
ds_read_b128 a[160:163], v36 offset:32256
buffer_load_dwordx4 a[60:63], v1, s[8:11], s60 offen offset:1024 sc1
v_mfma_f32_16x16x32_bf16 v[20:23], a[184:187], a[64:67], v[20:23]
ds_read_b128 a[164:167], v36 offset:33280
v_mfma_f32_16x16x32_bf16 v[24:27], a[188:191], a[64:67], v[24:27]
ds_read_b128 a[168:171], v36 offset:34304
v_mfma_f32_16x16x32_bf16 v[28:31], a[192:195], a[64:67], v[28:31]
ds_read_b128 a[172:175], v36 offset:35328
v_cvt_pk_bf16_f32 v64, v44, v45
v_mfma_f32_16x16x32_bf16 v[32:35], a[196:199], a[64:67], v[32:35]
ds_read_b128 a[176:179], v40 offset:32256
s_waitcnt vmcnt(15) lgkmcnt(5)
v_mfma_f32_16x16x32_bf16 v[16:19], a[200:203], a[0:3], v[16:19]
ds_read_b128 a[180:183], v36 offset:36864
v_cvt_pk_bf16_f32 v65, v46, v47
v_mfma_f32_16x16x32_bf16 v[20:23], a[204:207], a[0:3], v[20:23]
ds_read_b128 a[184:187], v36 offset:37888
v_mfma_f32_16x16x32_bf16 v[24:27], a[208:211], a[0:3], v[24:27]
ds_read_b128 a[188:191], v36 offset:38912
v_cvt_pk_bf16_f32 v66, v48, v49
v_mfma_f32_16x16x32_bf16 v[28:31], a[212:215], a[0:3], v[28:31]
ds_read_b128 a[192:195], v36 offset:39936
s_cmp_eq_u32 s71, 18
s_cselect_b32 s98, 4096, 0
s_add_u32 s60, s60, s98
buffer_load_dwordx4 a[64:67], v1, s[8:11], s60 offen offset:2048 sc1
v_mfma_f32_16x16x32_bf16 v[32:35], a[216:219], a[0:3], v[32:35]
ds_read_b128 a[196:199], v40 offset:36864
s_waitcnt vmcnt(15) lgkmcnt(5)
v_mfma_f32_16x16x32_bf16 v[16:19], a[160:163], a[4:7], v[16:19]
ds_read_b128 a[200:203], v36 offset:41472
buffer_load_dwordx4 a[0:3], v1, s[8:11], s60 offen offset:3072 sc1
v_mfma_f32_16x16x32_bf16 v[20:23], a[164:167], a[4:7], v[20:23]
ds_read_b128 a[204:207], v36 offset:42496
buffer_store_dwordx4 v[64:67], v1, s[8:11], s62 offen offset:0 sc1
v_mfma_f32_16x16x32_bf16 v[24:27], a[168:171], a[4:7], v[24:27]
ds_read_b128 a[208:211], v36 offset:43520
v_cvt_pk_bf16_f32 v68, v50, v51
v_mfma_f32_16x16x32_bf16 v[28:31], a[172:175], a[4:7], v[28:31]
ds_read_b128 a[212:215], v36 offset:44544
v_cvt_pk_bf16_f32 v69, v52, v53
v_mfma_f32_16x16x32_bf16 v[32:35], a[176:179], a[4:7], v[32:35]
ds_read_b128 a[216:219], v40 offset:41472
s_waitcnt vmcnt(16) lgkmcnt(5)
v_mfma_f32_16x16x32_bf16 v[16:19], a[180:183], a[8:11], v[16:19]
ds_read_b128 a[160:163], v36 offset:46080
s_add_u32 s60, s60, 4096
v_mfma_f32_16x16x32_bf16 v[20:23], a[184:187], a[8:11], v[20:23]
ds_read_b128 a[164:167], v36 offset:47104
v_cvt_pk_bf16_f32 v70, v54, v55
v_mfma_f32_16x16x32_bf16 v[24:27], a[188:191], a[8:11], v[24:27]
ds_read_b128 a[168:171], v36 offset:48128
buffer_load_dwordx4 a[4:7], v1, s[8:11], s60 offen offset:0 sc1
v_mfma_f32_16x16x32_bf16 v[28:31], a[192:195], a[8:11], v[28:31]
ds_read_b128 a[172:175], v36 offset:49152
buffer_store_dwordx4 v[68:71], v1, s[8:11], s62 offen offset:1024 sc1
v_mfma_f32_16x16x32_bf16 v[32:35], a[196:199], a[8:11], v[32:35]
ds_read_b128 a[176:179], v40 offset:46080
s_waitcnt vmcnt(17) lgkmcnt(5)
v_mfma_f32_16x16x32_bf16 v[16:19], a[200:203], a[12:15], v[16:19]
ds_read_b128 a[180:183], v36 offset:50688
buffer_load_dwordx4 a[8:11], v1, s[8:11], s60 offen offset:1024 sc1
v_mfma_f32_16x16x32_bf16 v[20:23], a[204:207], a[12:15], v[20:23]
ds_read_b128 a[184:187], v36 offset:51712
v_cvt_pk_bf16_f32 v72, v56, v57
v_mfma_f32_16x16x32_bf16 v[24:27], a[208:211], a[12:15], v[24:27]
ds_read_b128 a[188:191], v36 offset:52736
v_cvt_pk_bf16_f32 v73, v58, v59
v_mfma_f32_16x16x32_bf16 v[28:31], a[212:215], a[12:15], v[28:31]
ds_read_b128 a[192:195], v36 offset:53760
v_cvt_pk_bf16_f32 v74, v60, v61
v_mfma_f32_16x16x32_bf16 v[32:35], a[216:219], a[12:15], v[32:35]
ds_read_b128 a[196:199], v40 offset:50688
s_waitcnt vmcnt(17) lgkmcnt(5)
v_mfma_f32_16x16x32_bf16 v[16:19], a[160:163], a[16:19], v[16:19]
ds_read_b128 a[200:203], v37 offset:0
buffer_load_dwordx4 a[12:15], v1, s[8:11], s60 offen offset:2048 sc1
v_mfma_f32_16x16x32_bf16 v[20:23], a[164:167], a[16:19], v[20:23]
ds_read_b128 a[204:207], v37 offset:1024
buffer_store_dwordx4 v[72:75], v1, s[8:11], s62 offen offset:2048 sc1
v_mfma_f32_16x16x32_bf16 v[24:27], a[168:171], a[16:19], v[24:27]
ds_read_b128 a[208:211], v37 offset:2048
v_cvt_pk_bf16_f32 v76, v62, v63
v_mfma_f32_16x16x32_bf16 v[28:31], a[172:175], a[16:19], v[28:31]
ds_read_b128 a[212:215], v37 offset:3072
v_mfma_f32_16x16x32_bf16 v[32:35], a[176:179], a[16:19], v[32:35]
ds_read_b128 a[216:219], v41 offset:0
s_waitcnt vmcnt(18) lgkmcnt(5)
v_mfma_f32_16x16x32_bf16 v[16:19], a[180:183], a[20:23], v[16:19]
ds_read_b128 a[160:163], v37 offset:4608
buffer_store_dwordx4 v[76:79], v1, s[8:11], s62 offen offset:3072 sc1
v_mfma_f32_16x16x32_bf16 v[20:23], a[184:187], a[20:23], v[20:23]
ds_read_b128 a[164:167], v37 offset:5632
v_mfma_f32_16x16x32_bf16 v[24:27], a[188:191], a[20:23], v[24:27]
ds_read_b128 a[168:171], v37 offset:6656
v_mfma_f32_16x16x32_bf16 v[28:31], a[192:195], a[20:23], v[28:31]
ds_read_b128 a[172:175], v37 offset:7680
s_cmp_eq_u32 s71, 23
s_cselect_b32 s98, 4096, 0
s_add_u32 s60, s60, s98
buffer_load_dwordx4 a[16:19], v1, s[8:11], s60 offen offset:3072 sc1
v_mfma_f32_16x16x32_bf16 v[32:35], a[196:199], a[20:23], v[32:35]
ds_read_b128 a[176:179], v41 offset:4608
s_waitcnt vmcnt(19) lgkmcnt(5)
v_mfma_f32_16x16x32_bf16 v[16:19], a[200:203], a[24:27], v[16:19]
ds_read_b128 a[180:183], v37 offset:9216
s_add_u32 s60, s60, 4096
v_mfma_f32_16x16x32_bf16 v[20:23], a[204:207], a[24:27], v[20:23]
ds_read_b128 a[184:187], v37 offset:10240
v_mfma_f32_16x16x32_bf16 v[24:27], a[208:211], a[24:27], v[24:27]
ds_read_b128 a[188:191], v37 offset:11264
buffer_load_dwordx4 a[20:23], v1, s[8:11], s60 offen offset:0 sc1
v_mfma_f32_16x16x32_bf16 v[28:31], a[212:215], a[24:27], v[28:31]
ds_read_b128 a[192:195], v37 offset:12288
v_mfma_f32_16x16x32_bf16 v[32:35], a[216:219], a[24:27], v[32:35]
ds_read_b128 a[196:199], v41 offset:9216
s_waitcnt vmcnt(19) lgkmcnt(5)
v_mfma_f32_16x16x32_bf16 v[16:19], a[160:163], a[28:31], v[16:19]
ds_read_b128 a[200:203], v37 offset:13824
buffer_load_dwordx4 a[24:27], v1, s[8:11], s60 offen offset:1024 sc1
v_mfma_f32_16x16x32_bf16 v[20:23], a[164:167], a[28:31], v[20:23]
ds_read_b128 a[204:207], v37 offset:14848
v_mfma_f32_16x16x32_bf16 v[24:27], a[168:171], a[28:31], v[24:27]
ds_read_b128 a[208:211], v37 offset:15872
v_mfma_f32_16x16x32_bf16 v[28:31], a[172:175], a[28:31], v[28:31]
ds_read_b128 a[212:215], v37 offset:16896
v_mfma_f32_16x16x32_bf16 v[32:35], a[176:179], a[28:31], v[32:35]
ds_read_b128 a[216:219], v41 offset:13824
s_waitcnt vmcnt(19) lgkmcnt(5)
v_mfma_f32_16x16x32_bf16 v[16:19], a[180:183], a[32:35], v[16:19]
ds_read_b128 a[160:163], v37 offset:18432
buffer_load_dwordx4 a[28:31], v1, s[8:11], s60 offen offset:2048 sc1
v_mfma_f32_16x16x32_bf16 v[20:23], a[184:187], a[32:35], v[20:23]
ds_read_b128 a[164:167], v37 offset:19456
v_mfma_f32_16x16x32_bf16 v[24:27], a[188:191], a[32:35], v[24:27]
ds_read_b128 a[168:171], v37 offset:20480
v_mfma_f32_16x16x32_bf16 v[28:31], a[192:195], a[32:35], v[28:31]
ds_read_b128 a[172:175], v37 offset:21504
v_mfma_f32_16x16x32_bf16 v[32:35], a[196:199], a[32:35], v[32:35]
ds_read_b128 a[176:179], v41 offset:18432
s_waitcnt vmcnt(19) lgkmcnt(5)
v_mfma_f32_16x16x32_bf16 v[16:19], a[200:203], a[36:39], v[16:19]
ds_read_b128 a[180:183], v37 offset:23040
v_mfma_f32_16x16x32_bf16 v[20:23], a[204:207], a[36:39], v[20:23]
ds_read_b128 a[184:187], v37 offset:24064
v_mfma_f32_16x16x32_bf16 v[24:27], a[208:211], a[36:39], v[24:27]
ds_read_b128 a[188:191], v37 offset:25088
v_mfma_f32_16x16x32_bf16 v[28:31], a[212:215], a[36:39], v[28:31]
ds_read_b128 a[192:195], v37 offset:26112
s_cmp_eq_u32 s71, 27
s_cselect_b32 s98, 4096, 0
s_add_u32 s60, s60, s98
buffer_load_dwordx4 a[32:35], v1, s[8:11], s60 offen offset:3072 sc1
v_mfma_f32_16x16x32_bf16 v[32:35], a[216:219], a[36:39], v[32:35]
ds_read_b128 a[196:199], v41 offset:23040
s_waitcnt vmcnt(19) lgkmcnt(5)
v_mfma_f32_16x16x32_bf16 v[16:19], a[160:163], a[40:43], v[16:19]
ds_read_b128 a[200:203], v37 offset:27648
s_add_u32 s60, s60, 4096
v_mfma_f32_16x16x32_bf16 v[20:23], a[164:167], a[40:43], v[20:23]
ds_read_b128 a[204:207], v37 offset:28672
v_mfma_f32_16x16x32_bf16 v[24:27], a[168:171], a[40:43], v[24:27]
ds_read_b128 a[208:211], v37 offset:29696
buffer_load_dwordx4 a[36:39], v1, s[8:11], s60 offen offset:0 sc1
v_mfma_f32_16x16x32_bf16 v[28:31], a[172:175], a[40:43], v[28:31]
ds_read_b128 a[212:215], v37 offset:30720
v_mfma_f32_16x16x32_bf16 v[32:35], a[176:179], a[40:43], v[32:35]
ds_read_b128 a[216:219], v41 offset:27648
s_waitcnt vmcnt(19) lgkmcnt(5)
v_mfma_f32_16x16x32_bf16 v[16:19], a[180:183], a[44:47], v[16:19]
ds_read_b128 a[160:163], v37 offset:32256
buffer_load_dwordx4 a[40:43], v1, s[8:11], s60 offen offset:1024 sc1
v_mfma_f32_16x16x32_bf16 v[20:23], a[184:187], a[44:47], v[20:23]
ds_read_b128 a[164:167], v37 offset:33280
v_mfma_f32_16x16x32_bf16 v[24:27], a[188:191], a[44:47], v[24:27]
ds_read_b128 a[168:171], v37 offset:34304
v_mfma_f32_16x16x32_bf16 v[28:31], a[192:195], a[44:47], v[28:31]
ds_read_b128 a[172:175], v37 offset:35328
v_mfma_f32_16x16x32_bf16 v[32:35], a[196:199], a[44:47], v[32:35]
ds_read_b128 a[176:179], v41 offset:32256
s_waitcnt vmcnt(19) lgkmcnt(5)
v_mfma_f32_16x16x32_bf16 v[16:19], a[200:203], a[48:51], v[16:19]
ds_read_b128 a[180:183], v37 offset:36864
buffer_load_dwordx4 a[44:47], v1, s[8:11], s60 offen offset:2048 sc1
v_mfma_f32_16x16x32_bf16 v[20:23], a[204:207], a[48:51], v[20:23]
ds_read_b128 a[184:187], v37 offset:37888
v_mfma_f32_16x16x32_bf16 v[24:27], a[208:211], a[48:51], v[24:27]
ds_read_b128 a[188:191], v37 offset:38912
v_mfma_f32_16x16x32_bf16 v[28:31], a[212:215], a[48:51], v[28:31]
ds_read_b128 a[192:195], v37 offset:39936
v_mfma_f32_16x16x32_bf16 v[32:35], a[216:219], a[48:51], v[32:35]
ds_read_b128 a[196:199], v41 offset:36864
s_waitcnt vmcnt(19) lgkmcnt(5)
v_mfma_f32_16x16x32_bf16 v[16:19], a[160:163], a[52:55], v[16:19]
ds_read_b128 a[200:203], v37 offset:41472
buffer_load_dwordx4 a[48:51], v1, s[8:11], s60 offen offset:3072 sc1
v_mfma_f32_16x16x32_bf16 v[20:23], a[164:167], a[52:55], v[20:23]
ds_read_b128 a[204:207], v37 offset:42496
v_mfma_f32_16x16x32_bf16 v[24:27], a[168:171], a[52:55], v[24:27]
ds_read_b128 a[208:211], v37 offset:43520
v_mfma_f32_16x16x32_bf16 v[28:31], a[172:175], a[52:55], v[28:31]
ds_read_b128 a[212:215], v37 offset:44544
v_mfma_f32_16x16x32_bf16 v[32:35], a[176:179], a[52:55], v[32:35]
ds_read_b128 a[216:219], v41 offset:41472
s_waitcnt vmcnt(19) lgkmcnt(5)
v_mfma_f32_16x16x32_bf16 v[16:19], a[180:183], a[56:59], v[16:19]
ds_read_b128 a[160:163], v37 offset:46080
v_mfma_f32_16x16x32_bf16 v[20:23], a[184:187], a[56:59], v[20:23]
ds_read_b128 a[164:167], v37 offset:47104
v_mfma_f32_16x16x32_bf16 v[24:27], a[188:191], a[56:59], v[24:27]
ds_read_b128 a[168:171], v37 offset:48128
v_mfma_f32_16x16x32_bf16 v[28:31], a[192:195], a[56:59], v[28:31]
ds_read_b128 a[172:175], v37 offset:49152
v_mfma_f32_16x16x32_bf16 v[32:35], a[196:199], a[56:59], v[32:35]
ds_read_b128 a[176:179], v41 offset:46080
s_waitcnt vmcnt(18) lgkmcnt(5)
v_mfma_f32_16x16x32_bf16 v[16:19], a[200:203], a[60:63], v[16:19]
ds_read_b128 a[180:183], v37 offset:50688
v_mfma_f32_16x16x32_bf16 v[20:23], a[204:207], a[60:63], v[20:23]
ds_read_b128 a[184:187], v37 offset:51712
v_mfma_f32_16x16x32_bf16 v[24:27], a[208:211], a[60:63], v[24:27]
ds_read_b128 a[188:191], v37 offset:52736
v_mfma_f32_16x16x32_bf16 v[28:31], a[212:215], a[60:63], v[28:31]
ds_read_b128 a[192:195], v37 offset:53760
v_mfma_f32_16x16x32_bf16 v[32:35], a[216:219], a[60:63], v[32:35]
ds_read_b128 a[196:199], v41 offset:50688
s_waitcnt vmcnt(17) lgkmcnt(5)
v_mfma_f32_16x16x32_bf16 v[16:19], a[160:163], a[64:67], v[16:19]
ds_read_b128 a[200:203], v38 offset:0
buffer_load_dwordx4 v[80:83], v1, s[8:11], s63 offen offset:0 sc1
v_mfma_f32_16x16x32_bf16 v[20:23], a[164:167], a[64:67], v[20:23]
ds_read_b128 a[204:207], v38 offset:1024
v_mfma_f32_16x16x32_bf16 v[24:27], a[168:171], a[64:67], v[24:27]
ds_read_b128 a[208:211], v38 offset:2048
v_mfma_f32_16x16x32_bf16 v[28:31], a[172:175], a[64:67], v[28:31]
ds_read_b128 a[212:215], v38 offset:3072
v_mfma_f32_16x16x32_bf16 v[32:35], a[176:179], a[64:67], v[32:35]
ds_read_b128 a[216:219], v42 offset:0
s_waitcnt vmcnt(17) lgkmcnt(5)
v_mfma_f32_16x16x32_bf16 v[16:19], a[180:183], a[0:3], v[16:19]
ds_read_b128 a[160:163], v38 offset:4608
buffer_load_dwordx4 v[84:87], v1, s[8:11], s63 offen offset:1024 sc1
v_mfma_f32_16x16x32_bf16 v[20:23], a[184:187], a[0:3], v[20:23]
ds_read_b128 a[164:167], v38 offset:5632
v_mfma_f32_16x16x32_bf16 v[24:27], a[188:191], a[0:3], v[24:27]
ds_read_b128 a[168:171], v38 offset:6656
v_mfma_f32_16x16x32_bf16 v[28:31], a[192:195], a[0:3], v[28:31]
ds_read_b128 a[172:175], v38 offset:7680
v_mfma_f32_16x16x32_bf16 v[32:35], a[196:199], a[0:3], v[32:35]
ds_read_b128 a[176:179], v42 offset:4608
s_waitcnt vmcnt(16) lgkmcnt(5)
v_mfma_f32_16x16x32_bf16 v[16:19], a[200:203], a[4:7], v[16:19]
ds_read_b128 a[180:183], v38 offset:9216
buffer_load_dwordx4 v[88:91], v1, s[8:11], s63 offen offset:2048 sc1
v_mfma_f32_16x16x32_bf16 v[20:23], a[204:207], a[4:7], v[20:23]
ds_read_b128 a[184:187], v38 offset:10240
v_mfma_f32_16x16x32_bf16 v[24:27], a[208:211], a[4:7], v[24:27]
ds_read_b128 a[188:191], v38 offset:11264
v_mfma_f32_16x16x32_bf16 v[28:31], a[212:215], a[4:7], v[28:31]
ds_read_b128 a[192:195], v38 offset:12288
v_mfma_f32_16x16x32_bf16 v[32:35], a[216:219], a[4:7], v[32:35]
ds_read_b128 a[196:199], v42 offset:9216
s_waitcnt vmcnt(15) lgkmcnt(5)
v_mfma_f32_16x16x32_bf16 v[16:19], a[160:163], a[8:11], v[16:19]
ds_read_b128 a[200:203], v38 offset:13824
buffer_load_dwordx4 v[92:95], v1, s[8:11], s63 offen offset:3072 sc1
v_mfma_f32_16x16x32_bf16 v[20:23], a[164:167], a[8:11], v[20:23]
ds_read_b128 a[204:207], v38 offset:14848
v_mfma_f32_16x16x32_bf16 v[24:27], a[168:171], a[8:11], v[24:27]
ds_read_b128 a[208:211], v38 offset:15872
v_mfma_f32_16x16x32_bf16 v[28:31], a[172:175], a[8:11], v[28:31]
ds_read_b128 a[212:215], v38 offset:16896
v_mfma_f32_16x16x32_bf16 v[32:35], a[176:179], a[8:11], v[32:35]
ds_read_b128 a[216:219], v42 offset:13824
s_waitcnt vmcnt(15) lgkmcnt(5)
v_mfma_f32_16x16x32_bf16 v[16:19], a[180:183], a[12:15], v[16:19]
ds_read_b128 a[160:163], v38 offset:18432
v_mfma_f32_16x16x32_bf16 v[20:23], a[184:187], a[12:15], v[20:23]
ds_read_b128 a[164:167], v38 offset:19456
v_mfma_f32_16x16x32_bf16 v[24:27], a[188:191], a[12:15], v[24:27]
ds_read_b128 a[168:171], v38 offset:20480
v_mfma_f32_16x16x32_bf16 v[28:31], a[192:195], a[12:15], v[28:31]
ds_read_b128 a[172:175], v38 offset:21504
v_mfma_f32_16x16x32_bf16 v[32:35], a[196:199], a[12:15], v[32:35]
ds_read_b128 a[176:179], v42 offset:18432
s_waitcnt vmcnt(12) lgkmcnt(5)
v_mfma_f32_16x16x32_bf16 v[16:19], a[200:203], a[16:19], v[16:19]
ds_read_b128 a[180:183], v38 offset:23040
v_mfma_f32_16x16x32_bf16 v[20:23], a[204:207], a[16:19], v[20:23]
ds_read_b128 a[184:187], v38 offset:24064
v_mfma_f32_16x16x32_bf16 v[24:27], a[208:211], a[16:19], v[24:27]
ds_read_b128 a[188:191], v38 offset:25088
v_mfma_f32_16x16x32_bf16 v[28:31], a[212:215], a[16:19], v[28:31]
ds_read_b128 a[192:195], v38 offset:26112
v_mfma_f32_16x16x32_bf16 v[32:35], a[216:219], a[16:19], v[32:35]
ds_read_b128 a[196:199], v42 offset:23040
s_waitcnt vmcnt(11) lgkmcnt(5)
v_mfma_f32_16x16x32_bf16 v[16:19], a[160:163], a[20:23], v[16:19]
ds_read_b128 a[200:203], v38 offset:27648
v_mfma_f32_16x16x32_bf16 v[20:23], a[164:167], a[20:23], v[20:23]
ds_read_b128 a[204:207], v38 offset:28672
v_mfma_f32_16x16x32_bf16 v[24:27], a[168:171], a[20:23], v[24:27]
ds_read_b128 a[208:211], v38 offset:29696
v_mfma_f32_16x16x32_bf16 v[28:31], a[172:175], a[20:23], v[28:31]
ds_read_b128 a[212:215], v38 offset:30720
v_mfma_f32_16x16x32_bf16 v[32:35], a[176:179], a[20:23], v[32:35]
ds_read_b128 a[216:219], v42 offset:27648
s_waitcnt vmcnt(10) lgkmcnt(5)
v_mfma_f32_16x16x32_bf16 v[16:19], a[180:183], a[24:27], v[16:19]
ds_read_b128 a[160:163], v38 offset:32256
v_mfma_f32_16x16x32_bf16 v[20:23], a[184:187], a[24:27], v[20:23]
ds_read_b128 a[164:167], v38 offset:33280
v_mfma_f32_16x16x32_bf16 v[24:27], a[188:191], a[24:27], v[24:27]
ds_read_b128 a[168:171], v38 offset:34304
v_mfma_f32_16x16x32_bf16 v[28:31], a[192:195], a[24:27], v[28:31]
ds_read_b128 a[172:175], v38 offset:35328
v_mfma_f32_16x16x32_bf16 v[32:35], a[196:199], a[24:27], v[32:35]
ds_read_b128 a[176:179], v42 offset:32256
s_waitcnt vmcnt(9) lgkmcnt(5)
v_mfma_f32_16x16x32_bf16 v[16:19], a[200:203], a[28:31], v[16:19]
ds_read_b128 a[180:183], v38 offset:36864
v_mfma_f32_16x16x32_bf16 v[20:23], a[204:207], a[28:31], v[20:23]
ds_read_b128 a[184:187], v38 offset:37888
v_mfma_f32_16x16x32_bf16 v[24:27], a[208:211], a[28:31], v[24:27]
ds_read_b128 a[188:191], v38 offset:38912
v_mfma_f32_16x16x32_bf16 v[28:31], a[212:215], a[28:31], v[28:31]
ds_read_b128 a[192:195], v38 offset:39936
v_mfma_f32_16x16x32_bf16 v[32:35], a[216:219], a[28:31], v[32:35]
ds_read_b128 a[196:199], v42 offset:36864
s_waitcnt vmcnt(8) lgkmcnt(5)
v_mfma_f32_16x16x32_bf16 v[16:19], a[160:163], a[32:35], v[16:19]
ds_read_b128 a[200:203], v38 offset:41472
v_mfma_f32_16x16x32_bf16 v[20:23], a[164:167], a[32:35], v[20:23]
ds_read_b128 a[204:207], v38 offset:42496
v_mfma_f32_16x16x32_bf16 v[24:27], a[168:171], a[32:35], v[24:27]
ds_read_b128 a[208:211], v38 offset:43520
v_mfma_f32_16x16x32_bf16 v[28:31], a[172:175], a[32:35], v[28:31]
ds_read_b128 a[212:215], v38 offset:44544
v_mfma_f32_16x16x32_bf16 v[32:35], a[176:179], a[32:35], v[32:35]
ds_read_b128 a[216:219], v42 offset:41472
s_waitcnt vmcnt(7) lgkmcnt(5)
v_mfma_f32_16x16x32_bf16 v[16:19], a[180:183], a[36:39], v[16:19]
ds_read_b128 a[160:163], v38 offset:46080
v_mfma_f32_16x16x32_bf16 v[20:23], a[184:187], a[36:39], v[20:23]
ds_read_b128 a[164:167], v38 offset:47104
v_mfma_f32_16x16x32_bf16 v[24:27], a[188:191], a[36:39], v[24:27]
ds_read_b128 a[168:171], v38 offset:48128
v_mfma_f32_16x16x32_bf16 v[28:31], a[192:195], a[36:39], v[28:31]
ds_read_b128 a[172:175], v38 offset:49152
v_mfma_f32_16x16x32_bf16 v[32:35], a[196:199], a[36:39], v[32:35]
ds_read_b128 a[176:179], v42 offset:46080
s_waitcnt vmcnt(6) lgkmcnt(5)
v_mfma_f32_16x16x32_bf16 v[16:19], a[200:203], a[40:43], v[16:19]
ds_read_b128 a[180:183], v38 offset:50688
v_mfma_f32_16x16x32_bf16 v[20:23], a[204:207], a[40:43], v[20:23]
ds_read_b128 a[184:187], v38 offset:51712
v_mfma_f32_16x16x32_bf16 v[24:27], a[208:211], a[40:43], v[24:27]
v_mfma_f32_16x16x32_bf16 v[28:31], a[212:215], a[40:43], v[28:31]
v_mfma_f32_16x16x32_bf16 v[32:35], a[216:219], a[40:43], v[32:35]
s_waitcnt vmcnt(5) lgkmcnt(2)
v_mfma_f32_16x16x32_bf16 v[16:19], a[160:163], a[44:47], v[16:19]
v_mfma_f32_16x16x32_bf16 v[20:23], a[164:167], a[44:47], v[20:23]
v_mfma_f32_16x16x32_bf16 v[24:27], a[168:171], a[44:47], v[24:27]
v_mfma_f32_16x16x32_bf16 v[28:31], a[172:175], a[44:47], v[28:31]
v_mfma_f32_16x16x32_bf16 v[32:35], a[176:179], a[44:47], v[32:35]
s_waitcnt vmcnt(4) lgkmcnt(0)
v_mfma_f32_16x16x32_bf16 v[16:19], a[180:183], a[48:51], v[16:19]
s_waitcnt vmcnt(0)
v_xor_b32 v118, v248, v83
v_xor_b32 v119, v248, v87
v_xor_b32 v120, v248, v91
v_xor_b32 v121, v248, v95
v_mfma_f32_16x16x32_bf16 v[20:23], a[184:187], a[48:51], v[20:23]
v_or3_b32 v118, v118, v119, v120
v_or_b32 v118, v118, v121
v_cmp_ne_u32 vcc, 0, v118
s_nop 0
s_cbranch_vccnz L_xslow_37
L_xback_38:
v_mfma_f32_16x16x32_bf16 v[24:27], a[228:231], a[48:51], v[24:27]
v_lshlrev_b32 v96, 16, v80
v_and_b32 v97, 0xffff0000, v80
v_lshlrev_b32 v98, 16, v81
v_and_b32 v99, 0xffff0000, v81
v_lshlrev_b32 v100, 16, v82
v_and_b32 v101, 0xffff0000, v82
v_mfma_f32_16x16x32_bf16 v[28:31], a[232:235], a[48:51], v[28:31]
v_lshlrev_b32 v102, 16, v84
v_and_b32 v103, 0xffff0000, v84
v_lshlrev_b32 v104, 16, v85
v_and_b32 v105, 0xffff0000, v85
v_lshlrev_b32 v106, 16, v86
v_and_b32 v107, 0xffff0000, v86
v_mfma_f32_16x16x32_bf16 v[32:35], a[236:239], a[48:51], v[32:35]
v_lshlrev_b32 v108, 16, v88
v_and_b32 v109, 0xffff0000, v88
v_lshlrev_b32 v110, 16, v89
v_and_b32 v111, 0xffff0000, v89
v_lshlrev_b32 v112, 16, v90
v_and_b32 v113, 0xffff0000, v90
v_lshlrev_b32 v114, 16, v92
v_and_b32 v115, 0xffff0000, v92
s_nop 3
v_pk_add_f32 v[16:17], v[16:17], v[96:97]
v_pk_add_f32 v[18:19], v[18:19], v[98:99]
v_pk_add_f32 v[20:21], v[20:21], v[100:101]
v_pk_add_f32 v[22:23], v[22:23], v[102:103]
v_pk_add_f32 v[24:25], v[24:25], v[104:105]
v_pk_add_f32 v[26:27], v[26:27], v[106:107]
v_pk_add_f32 v[28:29], v[28:29], v[108:109]
v_pk_add_f32 v[30:31], v[30:31], v[110:111]
v_pk_add_f32 v[32:33], v[32:33], v[112:113]
v_pk_add_f32 v[34:35], v[34:35], v[114:115]
s_cmp_eq_u32 s29, 1
s_cbranch_scc1 L_last
v_pk_add_f32 v[142:143], v[16:17], v[18:19]
v_pk_mul_f32 v[144:145], v[16:17], v[16:17]
v_pk_fma_f32 v[144:145], v[18:19], v[18:19], v[144:145]
v_pk_add_f32 v[142:143], v[142:143], v[20:21]
v_pk_fma_f32 v[144:145], v[20:21], v[20:21], v[144:145]
v_pk_add_f32 v[142:143], v[142:143], v[22:23]
v_pk_fma_f32 v[144:145], v[22:23], v[22:23], v[144:145]
v_pk_add_f32 v[142:143], v[142:143], v[24:25]
v_pk_fma_f32 v[144:145], v[24:25], v[24:25], v[144:145]
v_pk_add_f32 v[142:143], v[142:143], v[26:27]
v_pk_fma_f32 v[144:145], v[26:27], v[26:27], v[144:145]
v_pk_add_f32 v[142:143], v[142:143], v[28:29]
v_pk_fma_f32 v[144:145], v[28:29], v[28:29], v[144:145]
v_pk_add_f32 v[142:143], v[142:143], v[30:31]
v_pk_fma_f32 v[144:145], v[30:31], v[30:31], v[144:145]
s_mov_b32 exec_hi, 0
v_pk_add_f32 v[142:143], v[142:143], v[32:33]
v_pk_fma_f32 v[144:145], v[32:33], v[32:33], v[144:145]
v_pk_add_f32 v[142:143], v[142:143], v[34:35]
v_pk_fma_f32 v[144:145], v[34:35], v[34:35], v[144:145]
s_mov_b64 exec, -1
v_add_f32 v136, v142, v143
v_add_f32 v137, v144, v145
v_cvt_pk_bf16_f32 v132, v32, v33
v_cvt_pk_bf16_f32 v133, v34, v35
v_permlane32_swap_b32 v136, v137
v_add_f32 v136, v136, v137
v_mov_b32 v137, v136
v_cvt_pk_bf16_f32 v124, v16, v17
v_cvt_pk_bf16_f32 v125, v18, v19
v_permlane16_swap_b32 v136, v137
v_add_f32 v136, v136, v137
v_mov_b32 v137, v136
v_cvt_pk_bf16_f32 v126, v20, v21
v_cvt_pk_bf16_f32 v127, v22, v23
v_permlane32_swap_b32 v136, v137
buffer_store_dwordx4 v[124:127], v140, s[8:11], s66 offen sc1
buffer_store_dwordx2 v[136:137], v138, s[8:11], s67 offen sc1
v_cvt_pk_bf16_f32 v128, v24, v25
v_cvt_pk_bf16_f32 v129, v26, v27
v_cvt_pk_bf16_f32 v130, v28, v29
v_cvt_pk_bf16_f32 v131, v30, v31
v_permlane16_swap_b32 v132, v134
v_permlane16_swap_b32 v133, v135
buffer_store_dwordx4 v[128:131], v140, s[8:11], s66 offen offset:1024 sc1
buffer_store_dwordx4 v[132:135], v141, s[8:11], s66 offen sc1
s_barrier
s_mul_i32 s36, s26, 132608
s_mul_i32 s38, s24, 12288
s_add_u32 m0, s38, 0
s_add_u32 s39, s38, s36
buffer_load_dwordx4 v1, s[4:7], s39 offen offset:0 sc1 lds
buffer_load_dwordx4 v1, s[4:7], s39 offen offset:1024 sc1 lds
buffer_load_dwordx4 v1, s[4:7], s39 offen offset:2048 sc1 lds
buffer_load_dwordx4 v1, s[4:7], s39 offen offset:3072 sc1 lds
s_add_u32 m0, m0, 4096
s_add_u32 s39, s39, 4096
buffer_load_dwordx4 v1, s[4:7], s39 offen offset:0 sc1 lds
buffer_load_dwordx4 v1, s[4:7], s39 offen offset:1024 sc1 lds
buffer_load_dwordx4 v1, s[4:7], s39 offen offset:2048 sc1 lds
buffer_load_dwordx4 v1, s[4:7], s39 offen offset:3072 sc1 lds
s_and_b32 s33, s27, 1
s_cmp_lt_u32 s27, 31
s_cselect_b32 s33, s33, 0
s_cmp_eq_u32 s33, 1
s_cselect_b32 s34, -1, 0xffff
s_mov_b32 s35, 0
v_lshlrev_b32 v7, 3, v1
s_lshr_b32 s31, s80, 4
s_lshl_b32 s31, s31, 11
v_add_u32 v7, s31, v7
s_cmp_eq_u32 s24, 0
s_cselect_b32 s30, 0, 1073741824
s_add_u32 s30, s30, 26607616
s_waitcnt vmcnt(8)
s_barrier
s_mov_b64 exec, s[34:35]
buffer_atomic_add v4, v7, s[8:11], s30 offen sc1
s_mov_b64 exec, -1
s_cmp_eq_u32 s29, 1
s_cbranch_scc1 L_main_fin
s_cmp_eq_u32 s25, 0
s_cselect_b32 s34, 16, 24
s_lshl_b32 s35, s80, 7
s_add_u32 s35, s35, 26607616
s_cmp_eq_u32 s24, 1
s_cselect_b32 s35, s35, 1073741824
v_mov_b32 v6, 0
v_mov_b32 v244, 0
v_mov_b32 v245, 0
v_mov_b32 v246, 0
s_add_u32 m0, m0, 4096
s_add_u32 s39, s39, 4096
buffer_load_dwordx4 v1, s[4:7], s39 offen offset:0 sc1 lds
buffer_load_dwordx4 v1, s[4:7], s39 offen offset:1024 sc1 lds
buffer_load_dwordx4 v1, s[4:7], s39 offen offset:2048 sc1 lds
buffer_load_dwordx4 v1, s[4:7], s39 offen offset:3072 sc1 lds
s_mul_i32 s36, s26, 132608
s_mul_i32 s38, s24, 9216
s_add_u32 m0, s38, 49152
s_add_u32 s39, s38, s36
s_add_u32 s39, s39, 49152
s_mov_b64 exec, 1
buffer_atomic_add v244, v6, s[8:11], s35 offen sc0 sc1
s_mov_b64 exec, -1
buffer_load_dwordx4 v1, s[4:7], s39 offen offset:0 sc1 lds
buffer_load_dwordx4 v1, s[4:7], s39 offen offset:1024 sc1 lds
buffer_load_dwordx4 v1, s[4:7], s39 offen offset:2048 sc1 lds
s_mov_b64 exec, 1
buffer_atomic_add v245, v6, s[8:11], s35 offen sc0 sc1
s_mov_b64 exec, -1
buffer_load_dwordx4 v1, s[4:7], s39 offen offset:3072 sc1 lds
s_add_u32 m0, m0, 4096
s_add_u32 s39, s39, 4096
buffer_load_dwordx4 v1, s[4:7], s39 offen offset:0 sc1 lds
buffer_load_dwordx4 v1, s[4:7], s39 offen offset:1024 sc1 lds
s_mov_b64 exec, 1
buffer_atomic_add v246, v6, s[8:11], s35 offen sc0 sc1
s_mov_b64 exec, -1
buffer_load_dwordx4 v1, s[4:7], s39 offen offset:2048 sc1 lds
buffer_load_dwordx4 v1, s[4:7], s39 offen offset:3072 sc1 lds
s_add_u32 m0, m0, 4096
s_add_u32 s39, s39, 4096
buffer_load_dwordx4 v1, s[4:7], s39 offen offset:0 sc1 lds
s_lshl_b32 s60, s25, 3
s_sub_u32 s61, s60, 1
s_max_i32 s61, s61, 0
s_lshl_b32 s30, s24, 1
s_add_u32 s60, s60, s30
s_mul_i32 s30, s61, 18432
s_mul_i32 s62, s60, 18432
v_add_u32 v237, 18432, v1
s_mul_i32 s38, s24, 5120
s_add_u32 m0, s38, 135168
s_add_u32 s39, s38, s30
s_cmp_eq_u32 s24, 1
s_cbranch_scc0 L_other_42
s_mov_b32 s31, 0
s_mov_b64 exec, 1
v_mov_b32 v247, 0
buffer_atomic_add v247, v6, s[8:11], s35 offen sc0 sc1
s_waitcnt vmcnt(12)
v_cmp_gt_u32 vcc, s34, v244
s_nop 0
s_cbranch_vccz L_polled_41
s_waitcnt vmcnt(8)
v_cmp_gt_u32 vcc, s34, v245
s_nop 0
s_cbranch_vccz L_polled_41
v_mov_b32 v244, 0
buffer_atomic_add v244, v6, s[8:11], s35 offen sc0 sc1
s_waitcnt vmcnt(5)
v_cmp_gt_u32 vcc, s34, v246
s_nop 0
s_cbranch_vccz L_polled_41
v_mov_b32 v245, 0
buffer_atomic_add v245, v6, s[8:11], s35 offen sc0 sc1
L_poll_40:
s_add_u32 s31, s31, 1
s_cmp_gt_u32 s31, 100000
s_cbranch_scc1 L_polled_41
v_mov_b32 v246, 0
buffer_atomic_add v246, v6, s[8:11], s35 offen sc0 sc1
s_waitcnt vmcnt(3)
v_cmp_gt_u32 vcc, s34, v247
s_nop 0
s_cbranch_vccz L_polled_41
v_mov_b32 v247, 0
buffer_atomic_add v247, v6, s[8:11], s35 offen sc0 sc1
s_waitcnt vmcnt(3)
v_cmp_gt_u32 vcc, s34, v244
s_nop 0
s_cbranch_vccz L_polled_41
v_mov_b32 v244, 0
buffer_atomic_add v244, v6, s[8:11], s35 offen sc0 sc1
s_waitcnt vmcnt(3)
v_cmp_gt_u32 vcc, s34, v245
s_nop 0
s_cbranch_vccz L_polled_41
v_mov_b32 v245, 0
buffer_atomic_add v245, v6, s[8:11], s35 offen sc0 sc1
s_waitcnt vmcnt(3)
v_cmp_gt_u32 vcc, s34, v246
s_nop 0
s_cbranch_vccz L_polled_41
s_branch L_poll_40
L_polled_41:
s_mov_b64 exec, -1
L_other_42:
s_barrier
s_mov_b32 s29, 1
s_add_u32 s8, s8, 30834688
s_addc_u32 s9, s9, 0
s_mov_b32 s10, 30834688
s_branch L_layer
L_last:
v_cvt_pk_bf16_f32 v148, v16, v17
v_cvt_pk_bf16_f32 v149, v18, v19
v_cvt_pk_bf16_f32 v150, v20, v21
v_cvt_pk_bf16_f32 v151, v22, v23
v_cvt_pk_bf16_f32 v152, v24, v25
v_cvt_pk_bf16_f32 v153, v26, v27
v_cvt_pk_bf16_f32 v154, v28, v29
v_cvt_pk_bf16_f32 v155, v30, v31
v_cvt_pk_bf16_f32 v156, v32, v33
v_cvt_pk_bf16_f32 v157, v34, v35
buffer_store_dwordx4 v[148:151], v164, s[16:19], s68 offen
buffer_store_dwordx4 v[152:155], v164, s[16:19], s68 offen offset:64
v_permlane16_swap_b32 v156, v158
v_permlane16_swap_b32 v157, v159
buffer_store_dwordx4 v[156:159], v165, s[16:19], s68 offen
L_main_fin:
L_main_end:
s_endpgm
L_tagslow_7:
buffer_load_dwordx2 v[238:239], v48, s[84:87], 0 offen sc1
s_add_u32 s31, s31, 1
s_waitcnt vmcnt(0)
v_cmp_eq_u32 vcc, 0, v238
s_cmp_gt_u32 s31, 200000
s_cbranch_scc1 L_tagback_8
s_cbranch_vccnz L_tagslow_7
s_branch L_tagback_8
L_dbslow_11:
s_mov_b32 s67, 0
L_dbslow_11x:
buffer_load_dwordx2 v[148:149], v146, s[4:7], s66 offen sc1
s_add_u32 s67, s67, 1
s_waitcnt vmcnt(0)
v_cmp_ne_u64 vcc, v[148:149], v[238:239]
s_cmp_gt_u32 s67, 200000
s_cbranch_scc1 L_dbback_12
s_cbranch_vccnz L_dbslow_11x
s_branch L_dbback_12
L_stzslow_23:
s_mov_b32 s31, 0
L_stzloop_25:
buffer_load_dwordx2 v[182:183], v234, s[8:11], s61 offen offset:0 sc1
buffer_load_dwordx2 v[184:185], v234, s[8:11], s61 offen offset:1024 sc1
buffer_load_dwordx2 v[186:187], v234, s[8:11], s61 offen offset:2048 sc1
buffer_load_dwordx2 v[188:189], v234, s[8:11], s61 offen offset:3072 sc1
buffer_load_dwordx2 v[190:191], v235, s[8:11], s61 offen offset:0 sc1
buffer_load_dwordx2 v[192:193], v235, s[8:11], s61 offen offset:1024 sc1
buffer_load_dwordx2 v[194:195], v235, s[8:11], s61 offen offset:2048 sc1
buffer_load_dwordx2 v[196:197], v235, s[8:11], s61 offen offset:3072 sc1
s_add_u32 s31, s31, 1
s_waitcnt vmcnt(0)
v_min3_f32 v200, v183, v185, v187
v_min3_f32 v201, v189, v191, v193
v_min3_f32 v200, v200, v195, v197
v_min_f32 v200, v200, v201
v_cmp_gt_f32 vcc, 0, v200
s_cmp_gt_u32 s31, 200000
s_cbranch_scc1 L_stzback_24
s_cbranch_vccnz L_stzloop_25
s_branch L_stzback_24
L_xslow_37:
s_mov_b32 s31, 0
L_xloop_39:
buffer_load_dwordx4 v[80:83], v1, s[8:11], s63 offen offset:0 sc1
buffer_load_dwordx4 v[84:87], v1, s[8:11], s63 offen offset:1024 sc1
buffer_load_dwordx4 v[88:91], v1, s[8:11], s63 offen offset:2048 sc1
buffer_load_dwordx4 v[92:95], v1, s[8:11], s63 offen offset:3072 sc1
s_add_u32 s31, s31, 1
s_waitcnt vmcnt(0)
v_xor_b32 v118, v248, v83
v_xor_b32 v119, v248, v87
v_xor_b32 v120, v248, v91
v_xor_b32 v121, v248, v95
v_or3_b32 v118, v118, v119, v120
v_or_b32 v118, v118, v121
v_cmp_ne_u32 vcc, 0, v118
s_cmp_gt_u32 s31, 200000
s_cbranch_scc1 L_xback_38
s_cbranch_vccnz L_xloop_39
s_branch L_xback_38
L_code_end:
.section .rodata,"a"
.p2align 6
.amdhsa_kernel main_kernel
  .amdhsa_next_free_vgpr 512
  .amdhsa_next_free_sgpr 102
  .amdhsa_accum_offset 256
  .amdhsa_group_segment_fixed_size 0
  .amdhsa_kernarg_size 88
  .amdhsa_user_sgpr_count 2
  .amdhsa_user_sgpr_kernarg_segment_ptr 1
  .amdhsa_system_sgpr_workgroup_id_x 1
  .amdhsa_float_denorm_mode_32 3
.end_amdhsa_kernel
```

```asm
; @launch kernel=main_kernel grid=(256,1,1) block=(256,1,1) lds=163840
.amdgcn_target "amdgcn-amd-amdhsa--gfx950"
.text
.globl main_kernel
.p2align 8
.type main_kernel,@function
main_kernel:
s_cmp_ge_u32 s2, 256
s_cbranch_scc1 L_main_end
s_load_dwordx16 s[64:79], s[0:1], 0
s_memrealtime s[96:97]
s_load_dwordx2 s[4:5], s[0:1], 80
s_load_dwordx2 s[16:17], s[0:1], 64
s_load_dwordx2 s[84:85], s[0:1], 72
s_getpc_b64 s[88:89]
L_pc:
s_mov_b32 s90, L_code_end-L_pc
s_mov_b32 s91, 0x20000
s_lshr_b32 s31, s2, 3
s_lshl_b32 s31, s31, 10
v_lshl_add_u32 v14, v0, 2, s31
s_mov_b32 s37, L_pc-L_pc
buffer_load_dword v15, v14, s[88:91], s37 offen
v_lshrrev_b32 v6, 6, v0
v_and_b32 v0, 63, v0
v_readfirstlane_b32 s24, v6
v_lshlrev_b32 v1, 4, v0
v_and_b32 v2, 15, v0
v_lshrrev_b32 v3, 4, v0
v_cmp_gt_u32 s[50:51], 2, v3
s_nop 0
s_cmp_lt_u32 s2, 128
s_cbranch_scc1 L_p0_x1
s_sub_u32 s30, s2, 128
s_cmp_lt_u32 s30, 108
s_cselect_b32 s62, 0, 1073741824
s_cselect_b32 s30, s30, 0
s_and_b32 s60, s30, 3
s_lshr_b32 s61, s30, 2
s_mov_b32 s14, 1990656
s_mov_b32 s15, 0x20000
s_mul_i32 s30, s60, 497664
s_lshl_b32 s31, s61, 7
s_add_u32 s30, s30, s31
s_mul_i32 s31, s24, 27648
s_add_u32 s30, s30, s31
s_add_u32 s30, s30, s62
v_lshrrev_b32 v36, 7, v1
v_mul_u32_u24 v42, 3456, v36
v_and_b32 v36, 0x70, v1
v_add_u32 v42, v36, v42
s_lshl_b32 s32, s24, 10
s_waitcnt lgkmcnt(0)
s_mov_b32 s12, s66
s_mov_b32 s13, s67
s_add_u32 m0, s32, 0
s_add_u32 s31, s30, 0
buffer_load_dwordx4 v42, s[12:15], s31 offen nt lds
s_add_u32 m0, s32, 4096
s_add_u32 s31, s30, 110592
buffer_load_dwordx4 v42, s[12:15], s31 offen nt lds
s_add_u32 m0, s32, 8192
s_add_u32 s31, s30, 221184
buffer_load_dwordx4 v42, s[12:15], s31 offen nt lds
s_add_u32 m0, s32, 12288
s_add_u32 s31, s30, 331776
buffer_load_dwordx4 v42, s[12:15], s31 offen nt lds
s_add_u32 m0, s32, 16384
s_add_u32 s31, s30, 442368
s_cmp_lt_u32 s24, 2
s_cselect_b32 s31, s31, 1073741824
buffer_load_dwordx4 v42, s[12:15], s31 offen nt lds
s_branch L_p0_j1
L_p0_x1:
s_mov_b32 s14, 2359296
s_mov_b32 s15, 0x20000
s_mul_i32 s30, s24, 18
v_add_u32 v36, s30, v3
v_mul_u32_u24 v42, 1152, v2
v_lshl_add_u32 v42, v36, 4, v42
s_mul_i32 s30, s2, 18432
v_mov_b32 v37, 1073741824
v_cndmask_b32 v37, v37, v42, s[50:51]
s_waitcnt lgkmcnt(0)
s_mov_b32 s12, s64
s_mov_b32 s13, s65
buffer_load_dwordx4 v[64:67], v42, s[12:15], s30 offen offset:0
buffer_load_dwordx4 v[68:71], v42, s[12:15], s30 offen offset:64
buffer_load_dwordx4 v[72:75], v42, s[12:15], s30 offen offset:128
buffer_load_dwordx4 v[76:79], v42, s[12:15], s30 offen offset:192
buffer_load_dwordx4 v[80:83], v37, s[12:15], s30 offen offset:256
L_p0_j1:
s_mov_b32 s86, 256
s_mov_b32 s87, 0x20000
s_xor_b32 s30, s2, 248
s_or_b32 s30, s30, s24
s_cmp_eq_u32 s30, 0
s_cselect_b32 s30, 0, 1073741824
v_mov_b32 v48, 0
s_or_b32 s96, s96, 1
v_mov_b32 v238, s96
v_mov_b32 v239, s97
s_mov_b64 exec, 1
buffer_store_dwordx2 v[238:239], v48, s[84:87], s30 offen sc1
s_mov_b64 exec, -1
v_mov_b32 v4, 1
v_mov_b32 v5, 0
s_mov_b32 s56, 0
s_mov_b32 s29, 0
v_add_u32 v9, 66560, v1
v_cmp_eq_u32 s[46:47], 0, v3
v_cmp_eq_u32 s[48:49], 2, v3
s_mov_b32 s6, 19451904
s_mov_b32 s7, 0x20000
s_mov_b32 s10, 61669376
s_mov_b32 s11, 0x20000
s_mov_b32 s18, 2359296
s_mov_b32 s19, 0x20000
s_mov_b32 s22, 4096
s_mov_b32 s23, 0x20000
s_and_b32 s30, s2, 7
s_lshr_b32 s31, s2, 3
s_lshr_b32 s32, s31, 2
s_and_b32 s33, s31, 3
s_lshr_b32 s25, s30, 2
s_lshl_b32 s25, s25, 3
s_add_u32 s25, s25, s32
s_and_b32 s26, s30, 3
s_lshl_b32 s26, s26, 2
s_add_u32 s26, s26, s33
s_lshl_b32 s80, s25, 4
s_add_u32 s80, s80, s26
s_lshr_b32 s27, s80, 3
s_and_b32 s28, s26, 7
s_lshl_b32 s70, s25, 2
s_add_u32 s70, s70, s24
s_lshl_b32 s70, s70, 1
s_lshr_b32 s32, s26, 3
s_add_u32 s70, s70, s32
s_mul_i32 s71, s28, 9
s_add_u32 s71, s71, 1
s_lshr_b32 s71, s71, 1
s_add_u32 s8, s4, 19451904
s_addc_u32 s9, s5, 0
s_mov_b32 s20, s76
s_mov_b32 s21, s77
v_lshrrev_b32 v36, 2, v2
v_lshl_add_u32 v36, v3, 3, v36
v_lshlrev_b32 v45, 7, v36
v_and_b32 v36, 3, v2
v_lshl_add_u32 v45, v36, 3, v45
s_lshl_b32 s31, s24, 5
v_add_u32 v45, s31, v45
v_mov_b32 v164, 3212836864
v_mov_b32 v165, 3212836864
v_mov_b32 v166, 3212836864
v_mov_b32 v167, 3212836864
s_lshl_b32 s30, s80, 10
s_lshl_b32 s31, s24, 8
s_add_u32 s30, s30, s31
s_add_u32 s30, s30, 26214400
s_mov_b32 s31, 30834688
v_mul_lo_u32 v36, v3, s31
v_lshl_add_u32 v37, v2, 4, v36
s_mov_b32 exec_hi, 0
buffer_store_dwordx4 v[164:167], v37, s[8:11], s30 offen sc1
s_mov_b64 exec, -1
v_lshl_add_u32 v37, v2, 15, v36
s_lshl_b32 s30, s2, 7
s_add_u32 s30, s30, 26476544
s_cmp_eq_u32 s24, 0
s_cselect_b32 s30, s30, 1073741824
s_mov_b64 exec, 0x001f001f
buffer_store_dword v48, v37, s[8:11], s30 offen sc1
s_mov_b64 exec, -1
s_cmp_lt_u32 s2, 128
s_cbranch_scc1 L_p0_x2
s_mul_i32 s92, s61, 29
s_lshr_b32 s92, s92, 8
s_mul_i32 s33, s92, 9
s_sub_u32 s33, s61, s33
s_lshl_b32 s33, s33, 6
s_lshl_b32 s31, s24, 4
s_add_u32 s33, s33, s31
v_add_u32 v36, s33, v2
v_mul_u32_u24 v37, 911, v36
v_lshrrev_b32 v37, 14, v37
v_mul_u32_u24 v38, 18, v37
v_sub_u32 v36, v36, v38
v_and_b32 v38, 1, v37
v_lshrrev_b32 v37, 1, v37
s_mov_b32 s31, 132608
v_mul_lo_u32 v37, v37, s31
s_cmp_eq_u32 s92, 0
s_cselect_b32 s93, 5, 0
s_cselect_b32 s94, 8, 4
s_cmp_eq_u32 s92, 2
s_cselect_b32 s93, 2, s93
s_cselect_b32 s94, 0, s94
s_sub_u32 s94, s94, 16
v_add_u32 v39, s93, v38
v_lshl_add_u32 v40, v38, 1, v36
v_add_u32 v40, s94, v40
v_cmp_gt_u32 vcc, 16, v36
s_nop 1
v_cndmask_b32 v39, 4, v39, vcc
v_cndmask_b32 v40, v40, v36, vcc
v_lshl_add_u32 v43, v39, 10, v37
v_lshl_add_u32 v43, v40, 4, v43
v_lshl_add_u32 v44, v39, 9, v37
v_lshl_add_u32 v44, v40, 3, v44
s_lshl_b32 s31, s60, 7
s_add_u32 s31, s31, 129024
v_add_u32 v44, s31, v44
s_mul_i32 s31, s60, 18
v_add_u32 v37, s31, v3
v_and_b32 v38, 3, v37
v_lshrrev_b32 v37, 2, v37
v_mul_u32_u24 v37, 7168, v37
v_add_u32 v43, v43, v37
v_lshl_add_u32 v43, v38, 8, v43
s_waitcnt vmcnt(3)
s_barrier
ds_read_b64_tr_b16 v[64:65], v45 offset:0
ds_read_b64_tr_b16 v[66:67], v45 offset:512
ds_read_b64_tr_b16 v[68:69], v45 offset:4096
ds_read_b64_tr_b16 v[70:71], v45 offset:4608
ds_read_b64_tr_b16 v[72:73], v45 offset:8192
ds_read_b64_tr_b16 v[74:75], v45 offset:8704
ds_read_b64_tr_b16 v[76:77], v45 offset:12288
ds_read_b64_tr_b16 v[78:79], v45 offset:12800
ds_read_b64_tr_b16 v[80:81], v45 offset:16384
ds_read_b64_tr_b16 v[82:83], v45 offset:16896
v_mov_b32 v36, 1073741824
v_mov_b32 v46, 0
v_cndmask_b32 v37, v36, v43, s[50:51]
s_add_u32 s31, s62, 0
s_waitcnt lgkmcnt(8)
buffer_store_dwordx4 v[64:67], v43, s[4:7], s31 offen sc1
s_add_u32 s31, s62, 7168
s_waitcnt lgkmcnt(6)
buffer_store_dwordx4 v[68:71], v43, s[4:7], s31 offen sc1
s_add_u32 s31, s62, 14336
s_waitcnt lgkmcnt(4)
buffer_store_dwordx4 v[72:75], v43, s[4:7], s31 offen sc1
s_add_u32 s31, s62, 21504
s_waitcnt lgkmcnt(2)
buffer_store_dwordx4 v[76:79], v43, s[4:7], s31 offen sc1
s_add_u32 s31, s62, 28672
s_waitcnt lgkmcnt(0)
buffer_store_dwordx4 v[80:83], v37, s[4:7], s31 offen sc1
v_mov_b32 v37, 0x3f803f80
v_dot2c_f32_bf16 v46, v64, v37
v_dot2c_f32_bf16 v46, v65, v37
v_dot2c_f32_bf16 v46, v66, v37
v_dot2c_f32_bf16 v46, v67, v37
v_dot2c_f32_bf16 v46, v68, v37
v_dot2c_f32_bf16 v46, v69, v37
v_dot2c_f32_bf16 v46, v70, v37
v_dot2c_f32_bf16 v46, v71, v37
v_dot2c_f32_bf16 v46, v72, v37
v_dot2c_f32_bf16 v46, v73, v37
v_dot2c_f32_bf16 v46, v74, v37
v_dot2c_f32_bf16 v46, v75, v37
v_dot2c_f32_bf16 v46, v76, v37
v_dot2c_f32_bf16 v46, v77, v37
v_dot2c_f32_bf16 v46, v78, v37
v_dot2c_f32_bf16 v46, v79, v37
v_dot2c_f32_bf16 v46, v80, v37
v_dot2c_f32_bf16 v46, v81, v37
v_dot2c_f32_bf16 v46, v82, v37
v_dot2c_f32_bf16 v46, v83, v37
s_nop 2
v_mov_b32 v37, v46
s_nop 1
v_permlane32_swap_b32 v46, v37
v_add_f32 v46, v46, v37
v_mov_b32 v37, v46
s_nop 1
v_permlane16_swap_b32 v46, v37
v_add_f32 v46, v46, v37
v_cvt_pk_bf16_f32 v50, v46, v46
v_and_b32 v37, 0xffff0000, v50
v_sub_f32 v37, v46, v37
v_cvt_pk_bf16_f32 v51, v37, v37
v_cndmask_b32 v36, v36, v44, s[46:47]
buffer_store_dwordx2 v[50:51], v36, s[4:7], s62 offen sc1
s_branch L_p0_j2
L_p0_x2:
s_mul_i32 s30, s24, 4608
s_mul_i32 s31, s2, 18432
s_add_u32 s31, s31, s30
s_add_u32 s31, s31, 0
v_mov_b32 v36, 1073741824
v_add_u32 v38, 4096, v1
v_cndmask_b32 v38, v36, v38, s[50:51]
v_mov_b32 v46, 0
v_mov_b32 v47, 0
v_mov_b32 v39, 0x3f803f80
s_waitcnt vmcnt(3)
buffer_store_dwordx4 v[64:67], v1, s[8:11], s31 offen offset:0 sc1
buffer_store_dwordx4 v[68:71], v1, s[8:11], s31 offen offset:1024 sc1
buffer_store_dwordx4 v[72:75], v1, s[8:11], s31 offen offset:2048 sc1
buffer_store_dwordx4 v[76:79], v1, s[8:11], s31 offen offset:3072 sc1
buffer_store_dwordx4 v[80:83], v38, s[8:11], s31 offen offset:0 sc1
v_dot2c_f32_bf16 v46, v64, v39
v_dot2c_f32_bf16 v46, v65, v39
v_dot2c_f32_bf16 v46, v66, v39
v_dot2c_f32_bf16 v46, v67, v39
v_dot2c_f32_bf16 v46, v68, v39
v_dot2c_f32_bf16 v46, v69, v39
v_dot2c_f32_bf16 v46, v70, v39
v_dot2c_f32_bf16 v46, v71, v39
v_dot2c_f32_bf16 v46, v72, v39
v_dot2c_f32_bf16 v46, v73, v39
v_dot2c_f32_bf16 v46, v74, v39
v_dot2c_f32_bf16 v46, v75, v39
v_dot2c_f32_bf16 v46, v76, v39
v_dot2c_f32_bf16 v46, v77, v39
v_dot2c_f32_bf16 v46, v78, v39
v_dot2c_f32_bf16 v46, v79, v39
v_dot2c_f32_bf16 v46, v80, v39
v_dot2c_f32_bf16 v46, v81, v39
v_dot2c_f32_bf16 v46, v82, v39
v_dot2c_f32_bf16 v46, v83, v39
v_dot2c_f32_bf16 v47, v64, v64
v_dot2c_f32_bf16 v47, v65, v65
v_dot2c_f32_bf16 v47, v66, v66
v_dot2c_f32_bf16 v47, v67, v67
v_dot2c_f32_bf16 v47, v68, v68
v_dot2c_f32_bf16 v47, v69, v69
v_dot2c_f32_bf16 v47, v70, v70
v_dot2c_f32_bf16 v47, v71, v71
v_dot2c_f32_bf16 v47, v72, v72
v_dot2c_f32_bf16 v47, v73, v73
v_dot2c_f32_bf16 v47, v74, v74
v_dot2c_f32_bf16 v47, v75, v75
v_dot2c_f32_bf16 v47, v76, v76
v_dot2c_f32_bf16 v47, v77, v77
v_dot2c_f32_bf16 v47, v78, v78
v_dot2c_f32_bf16 v47, v79, v79
v_dot2c_f32_bf16 v47, v80, v80
v_dot2c_f32_bf16 v47, v81, v81
v_dot2c_f32_bf16 v47, v82, v82
v_dot2c_f32_bf16 v47, v83, v83
v_mov_b32 v37, v46
s_nop 1
v_permlane32_swap_b32 v46, v37
v_add_f32 v46, v46, v37
v_mov_b32 v37, v46
s_nop 1
v_permlane16_swap_b32 v46, v37
v_add_f32 v46, v46, v37
v_mov_b32 v37, v47
s_nop 1
v_permlane32_swap_b32 v47, v37
v_add_f32 v47, v47, v37
v_mov_b32 v37, v47
s_nop 1
v_permlane16_swap_b32 v47, v37
v_add_f32 v47, v47, v37
s_lshl_b32 s30, s2, 7
s_lshl_b32 s31, s24, 14
s_add_u32 s30, s30, s31
s_add_u32 s30, s30, 2359296
v_cndmask_b32 v50, 0, v46, s[46:47]
v_cndmask_b32 v51, 0, v47, s[46:47]
v_lshlrev_b32 v37, 3, v2
v_lshl_add_u32 v37, v3, 16, v37
v_cndmask_b32 v37, v36, v37, s[50:51]
buffer_store_dwordx2 v[50:51], v37, s[8:11], s30 offen sc1
L_p0_j2:
buffer_load_dwordx2 v[238:239], v48, s[84:87], 0 offen sc1
s_sub_u32 s30, s2, 0
s_cmp_lt_u32 s30, 256
s_cselect_b32 s36, 0, 1073741824
s_cselect_b32 s30, s30, 0
s_and_b32 s34, s30, 3
s_lshr_b32 s35, s30, 2
s_mov_b32 s14, 5308416
s_mov_b32 s15, 0x20000
s_mul_i32 s30, s34, 1327104
s_lshl_b32 s31, s35, 7
s_add_u32 s30, s30, s31
s_mul_i32 s31, s24, 73728
s_add_u32 s30, s30, s31
s_add_u32 s30, s30, s36
v_lshrrev_b32 v36, 7, v1
v_mul_u32_u24 v42, 9216, v36
v_and_b32 v36, 0x70, v1
v_add_u32 v42, v36, v42
s_lshl_b32 s32, s24, 10
s_mov_b32 s12, s72
s_mov_b32 s13, s73
s_add_u32 m0, s32, 20480
s_add_u32 s31, s30, 0
buffer_load_dwordx4 v42, s[12:15], s31 offen nt lds
s_add_u32 m0, s32, 24576
s_add_u32 s31, s30, 294912
buffer_load_dwordx4 v42, s[12:15], s31 offen nt lds
s_add_u32 m0, s32, 28672
s_add_u32 s31, s30, 589824
buffer_load_dwordx4 v42, s[12:15], s31 offen nt lds
s_add_u32 m0, s32, 32768
s_add_u32 s31, s30, 884736
buffer_load_dwordx4 v42, s[12:15], s31 offen nt lds
s_add_u32 m0, s32, 36864
s_add_u32 s31, s30, 1179648
s_cmp_lt_u32 s24, 2
s_cselect_b32 s31, s31, 1073741824
buffer_load_dwordx4 v42, s[12:15], s31 offen nt lds
s_sub_u32 s30, s2, 0
s_cmp_lt_u32 s30, 256
s_cselect_b32 s36, 0, 1073741824
s_cselect_b32 s30, s30, 0
s_and_b32 s34, s30, 3
s_lshr_b32 s35, s30, 2
s_lshl_b32 s92, s35, 6
s_lshl_b32 s33, s24, 4
s_add_u32 s92, s92, s33
s_cmp_ge_u32 s92, 2304
s_cselect_b32 s93, 1, 0
s_cselect_b32 s33, 2304, 0
s_sub_u32 s92, s92, s33
s_mul_i32 s94, s92, 1821
s_lshr_b32 s94, s94, 19
s_mul_i32 s33, s94, 288
s_sub_u32 s92, s92, s33
s_lshr_b32 s95, s92, 5
s_bfe_u32 s96, s92, 0x10004
s_lshl_b32 s94, s94, 1
s_cmp_ge_u32 s92, 144
s_addc_u32 s94, s94, 0
s_cmp_gt_u32 s95, 4
s_cselect_b32 s33, 5, 0
s_sub_u32 s97, s95, s33
s_cmp_eq_u32 s93, 0
s_cselect_b32 s33, 5, 0
s_add_u32 s97, s97, s33
s_cmp_eq_u32 s95, 4
s_cselect_b32 s97, 4, s97
s_mul_i32 s94, s94, 9
s_add_u32 s94, s94, s97
s_mul_i32 s94, s94, 37888
s_add_u32 s94, s94, 2785280
v_and_b32 v36, 3, v2
v_bfe_u32 v37, v2, 2, 1
v_bfe_u32 v38, v2, 3, 1
v_lshl_add_u32 v36, v38, 2, v36
s_lshl_b32 s33, s96, 3
v_add_u32 v36, s33, v36
s_cmp_eq_u32 s95, 4
s_cbranch_scc0 L_w3j_3
s_xor_b32 s33, s93, 1
v_mov_b32 v36, v2
v_mov_b32 v37, s33
L_w3j_3:
v_mul_u32_u24 v170, 18432, v37
v_lshl_add_u32 v170, v36, 4, v170
v_lshl_add_u32 v170, v3, 8, v170
s_mul_i32 s31, s34, 4608
s_add_u32 s31, s31, s94
v_add_u32 v170, s31, v170
v_lshlrev_b32 v171, 9, v37
v_lshl_add_u32 v171, v36, 3, v171
s_lshl_b32 s31, s34, 7
s_add_u32 s31, s31, s94
s_add_u32 s31, s31, 36864
v_add_u32 v171, s31, v171
v_mov_b32 v172, 1073741824
v_mov_b32 v52, 1073741824
v_mov_b32 v53, 1073741824
v_mov_b32 v54, 1073741824
v_mov_b32 v55, 1073741824
v_mov_b32 v56, 1073741824
s_cmp_lt_u32 s2, 32
s_cbranch_scc1 L_p0_a5
s_cmp_lt_u32 s2, 176
s_cbranch_scc1 L_p0_b5
s_sub_u32 s30, s2, 176
s_cmp_lt_u32 s30, 36
s_cselect_b32 s53, 0, 1073741824
s_cselect_b32 s30, s30, 0
s_and_b32 s38, s30, 3
s_lshr_b32 s52, s30, 2
v_lshrrev_b32 v39, 2, v2
v_and_b32 v40, 3, v2
v_lshlrev_b32 v40, 3, v40
s_lshl_b32 s31, s24, 5
v_add_u32 v40, s31, v40
v_lshl_add_u32 v36, v3, 2, v39
v_lshl_add_u32 v52, v36, 7, v40
v_lshrrev_b32 v36, 1, v39
v_mul_u32_u24 v36, 18, v36
v_and_b32 v41, 1, v39
v_add3_u32 v36, v36, v41, 16
v_and_b32 v41, 1, v3
v_mul_u32_u24 v41, 72, v41
v_add_u32 v36, v36, v41
v_lshl_add_u32 v53, v36, 7, v40
s_lshl_b32 s31, s52, 6
s_lshl_b32 s33, s24, 4
s_add_u32 s31, s31, s33
v_add_u32 v36, s31, v2
v_mul_u32_u24 v37, 911, v36
v_lshrrev_b32 v37, 16, v37
v_mul_u32_u24 v38, 72, v37
v_sub_u32 v36, v36, v38
s_mov_b32 s31, 82944
v_mul_lo_u32 v41, v37, s31
v_mov_b32 v173, v37
v_add_u32 v41, 2121728, v41
v_lshrrev_b32 v39, 5, v36
v_lshlrev_b32 v39, 11, v39
v_bfe_u32 v40, v36, 2, 1
v_lshl_add_u32 v39, v40, 10, v39
v_bfe_u32 v40, v36, 3, 2
v_lshl_add_u32 v39, v40, 6, v39
v_and_b32 v40, 3, v36
v_lshl_add_u32 v39, v40, 4, v39
v_lshlrev_b32 v40, 4, v36
v_add_u32 v40, 3072, v40
v_cmp_gt_u32 vcc, 64, v36
v_mov_b32 v47, 7
s_nop 0
v_cndmask_b32 v39, v40, v39, vcc
v_cndmask_b32 v47, v47, 8, vcc
v_add_u32 v41, v41, v39
s_mul_i32 s31, s38, 16
s_add_u32 s31, s31, 0
v_add_u32 v37, s31, v3
v_and_b32 v38, 3, v37
v_lshrrev_b32 v37, 2, v37
v_mul_u32_u24 v37, 4608, v37
v_lshlrev_b32 v38, v47, v38
v_add3_u32 v172, v41, v37, v38
s_mul_i32 s31, s38, 2
s_add_u32 s31, s31, 64
v_add_u32 v37, s31, v3
v_and_b32 v38, 3, v37
v_lshrrev_b32 v37, 2, v37
v_mul_u32_u24 v37, 4608, v37
v_lshlrev_b32 v38, v47, v38
v_add3_u32 v173, v41, v37, v38
s_branch L_p0_j5
L_p0_b5:
s_sub_u32 s30, s2, 32
s_cmp_lt_u32 s30, 144
s_cselect_b32 s53, 0, 1073741824
s_cselect_b32 s30, s30, 0
s_and_b32 s38, s30, 15
s_lshr_b32 s52, s30, 4
s_lshl_b32 s31, s52, 6
s_lshl_b32 s33, s24, 4
s_add_u32 s31, s31, s33
v_add_u32 v36, s31, v2
v_mul_u32_u24 v37, 911, v36
v_lshrrev_b32 v37, 16, v37
v_mul_u32_u24 v38, 72, v37
v_sub_u32 v36, v36, v38
s_mov_b32 s31, 331776
v_mul_lo_u32 v41, v37, s31
v_mov_b32 v173, v37
v_add_u32 v41, 8241152, v41
v_lshrrev_b32 v39, 5, v36
v_lshlrev_b32 v39, 11, v39
v_bfe_u32 v40, v36, 2, 1
v_lshl_add_u32 v39, v40, 10, v39
v_bfe_u32 v40, v36, 3, 2
v_lshl_add_u32 v39, v40, 6, v39
v_and_b32 v40, 3, v36
v_lshl_add_u32 v39, v40, 4, v39
v_lshlrev_b32 v40, 4, v36
v_add_u32 v40, 3072, v40
v_cmp_gt_u32 vcc, 64, v36
v_mov_b32 v47, 7
s_nop 0
v_cndmask_b32 v39, v40, v39, vcc
v_cndmask_b32 v47, v47, 8, vcc
v_add_u32 v41, v41, v39
v_mad_u32_u24 v46, v173, 9, 1
v_lshrrev_b32 v46, 1, v46
s_mul_i32 s31, s38, 18
v_add_u32 v37, s31, v3
v_and_b32 v38, 3, v37
v_lshrrev_b32 v37, 2, v37
v_lshlrev_b32 v38, v47, v38
v_add_u32 v41, v41, v38
s_cmp_ge_u32 s38, 8
s_cselect_b32 s31, 36, 0
v_add_u32 v38, s31, v46
v_sub_u32 v46, 0, v46
s_movk_i32 s31, 4608
v_add_u32 v36, 0, v37
v_sub_u32 v39, v36, v38
v_cmp_gt_u32 vcc, 4, v39
v_ashrrev_i32 v40, 31, v39
v_and_b32 v40, 4, v40
v_cndmask_b32 v40, v40, v46, vcc
v_add_u32 v36, v36, v40
v_mad_u32_u24 v52, v36, s31, v41
v_add_u32 v36, 1, v37
v_sub_u32 v39, v36, v38
v_cmp_gt_u32 vcc, 4, v39
v_ashrrev_i32 v40, 31, v39
v_and_b32 v40, 4, v40
v_cndmask_b32 v40, v40, v46, vcc
v_add_u32 v36, v36, v40
v_mad_u32_u24 v53, v36, s31, v41
v_add_u32 v36, 2, v37
v_sub_u32 v39, v36, v38
v_cmp_gt_u32 vcc, 4, v39
v_ashrrev_i32 v40, 31, v39
v_and_b32 v40, 4, v40
v_cndmask_b32 v40, v40, v46, vcc
v_add_u32 v36, v36, v40
v_mad_u32_u24 v54, v36, s31, v41
v_add_u32 v36, 3, v37
v_sub_u32 v39, v36, v38
v_cmp_gt_u32 vcc, 4, v39
v_ashrrev_i32 v40, 31, v39
v_and_b32 v40, 4, v40
v_cndmask_b32 v40, v40, v46, vcc
v_add_u32 v36, v36, v40
v_mad_u32_u24 v55, v36, s31, v41
v_add_u32 v36, 4, v37
v_sub_u32 v39, v36, v38
v_cmp_gt_u32 vcc, 4, v39
v_ashrrev_i32 v40, 31, v39
v_and_b32 v40, 4, v40
v_cndmask_b32 v40, v40, v46, vcc
v_add_u32 v36, v36, v40
v_mad_u32_u24 v56, v36, s31, v41
s_branch L_p0_j5
L_p0_a5:
s_add_u32 s30, s2, 256
s_cmp_lt_u32 s30, 288
s_cselect_b32 s53, 0, 1073741824
s_cselect_b32 s30, s30, 0
s_and_b32 s38, s30, 3
s_lshr_b32 s52, s30, 2
s_lshl_b32 s92, s52, 6
s_lshl_b32 s33, s24, 4
s_add_u32 s92, s92, s33
s_cmp_ge_u32 s92, 2304
s_cselect_b32 s93, 1, 0
s_cselect_b32 s33, 2304, 0
s_sub_u32 s92, s92, s33
s_mul_i32 s94, s92, 1821
s_lshr_b32 s94, s94, 19
s_mul_i32 s33, s94, 288
s_sub_u32 s92, s92, s33
s_lshr_b32 s95, s92, 5
s_bfe_u32 s96, s92, 0x10004
s_lshl_b32 s94, s94, 1
s_cmp_ge_u32 s92, 144
s_addc_u32 s94, s94, 0
s_cmp_gt_u32 s95, 4
s_cselect_b32 s33, 5, 0
s_sub_u32 s97, s95, s33
s_cmp_eq_u32 s93, 0
s_cselect_b32 s33, 5, 0
s_add_u32 s97, s97, s33
s_cmp_eq_u32 s95, 4
s_cselect_b32 s97, 4, s97
s_mul_i32 s94, s94, 9
s_add_u32 s94, s94, s97
s_mul_i32 s94, s94, 37888
s_add_u32 s94, s94, 2785280
v_and_b32 v36, 3, v2
v_bfe_u32 v37, v2, 2, 1
v_bfe_u32 v38, v2, 3, 1
v_lshl_add_u32 v36, v38, 2, v36
s_lshl_b32 s33, s96, 3
v_add_u32 v36, s33, v36
s_cmp_eq_u32 s95, 4
s_cbranch_scc0 L_w3j_6
s_xor_b32 s33, s93, 1
v_mov_b32 v36, v2
v_mov_b32 v37, s33
L_w3j_6:
v_mul_u32_u24 v172, 18432, v37
v_lshl_add_u32 v172, v36, 4, v172
v_lshl_add_u32 v172, v3, 8, v172
s_mul_i32 s31, s38, 4608
s_add_u32 s31, s31, s94
v_add_u32 v172, s31, v172
v_lshlrev_b32 v173, 9, v37
v_lshl_add_u32 v173, v36, 3, v173
s_lshl_b32 s31, s38, 7
s_add_u32 s31, s31, s94
s_add_u32 s31, s31, 36864
v_add_u32 v173, s31, v173
L_p0_j5:
s_lshl_b32 s30, s25, 2
s_add_u32 s30, s30, s24
s_mul_i32 s31, s30, 133120
s_lshl_b32 s30, s30, 17
s_mul_i32 s32, s24, 0
s_add_u32 s32, s32, s26
s_and_b32 s32, s32, 15
s_lshl_b32 s3, s32, 8
s_add_u32 s3, s3, s30
s_lshl_b32 s101, s32, 12
s_add_u32 s101, s101, s31
s_add_u32 s101, s101, 10895360
v_lshrrev_b32 v41, 4, v1
s_lshl_b32 s30, s25, 3
s_sub_u32 s30, s30, 1
v_add_u32 v36, s30, v41
v_max_i32 v36, 0, v36
v_bfe_u32 v37, v41, 2, 1
v_mul_u32_u24 v37, 35, v37
s_mul_i32 s30, s26, 36
v_add_u32 v37, s30, v37
v_lshrrev_b32 v37, 6, v37
v_bfe_u32 v38, v41, 3, 2
v_mad_u32_u24 v37, v38, 9, v37
v_and_b32 v38, 3, v41
v_lshl_add_u32 v37, v37, 2, v38
v_add_u32 v37, 128, v37
v_cndmask_b32 v36, v37, v36, s[50:51]
v_lshlrev_b32 v174, 7, v36
s_lshl_b32 s30, s2, 7
s_add_u32 s30, s30, 19415040
s_lshl_b32 s32, s2, 3
s_add_u32 s32, s32, 19447808
s_cmp_eq_u32 s24, 0
s_cselect_b32 s30, s30, 1073741824
s_cselect_b32 s100, s32, 1073741824
s_waitcnt vmcnt(5)
v_cmp_eq_u32 vcc, 0, v238
s_mov_b32 s31, 0
s_cbranch_vccnz L_tagslow_7
L_tagback_8:
s_barrier
s_mov_b64 exec, 1
buffer_store_dwordx2 v[238:239], v48, s[4:7], s30 offen sc1
s_mov_b64 exec, -1
s_cmp_lt_u32 s2, 32
s_cbranch_scc1 L_p0_a3
s_cmp_lt_u32 s2, 176
s_cbranch_scc1 L_p0_b3
s_mov_b32 s14, 663552
s_mov_b32 s15, 0x20000
s_mul_i32 s30, s38, 165888
s_lshl_b32 s31, s52, 7
s_add_u32 s30, s30, s31
s_mul_i32 s31, s24, 9216
s_add_u32 s30, s30, s31
s_add_u32 s30, s30, s53
v_lshrrev_b32 v36, 7, v1
v_mul_u32_u24 v42, 1152, v36
v_and_b32 v36, 0x70, v1
v_add_u32 v42, v36, v42
s_lshl_b32 s32, s24, 10
s_mov_b32 s12, s68
s_mov_b32 s13, s69
s_add_u32 m0, s32, 40960
s_add_u32 s31, s30, 0
buffer_load_dwordx4 v42, s[12:15], s31 offen nt lds
s_add_u32 m0, s32, 45056
s_add_u32 s31, s30, 36864
buffer_load_dwordx4 v42, s[12:15], s31 offen nt lds
s_add_u32 m0, s32, 49152
s_add_u32 s31, s30, 73728
buffer_load_dwordx4 v42, s[12:15], s31 offen nt lds
s_add_u32 m0, s32, 53248
s_add_u32 s31, s30, 110592
buffer_load_dwordx4 v42, s[12:15], s31 offen nt lds
s_add_u32 m0, s32, 57344
s_add_u32 s31, s30, 147456
s_cmp_lt_u32 s24, 2
s_cselect_b32 s31, s31, 1073741824
buffer_load_dwordx4 v42, s[12:15], s31 offen nt lds
s_branch L_p0_j3
L_p0_b3:
s_mov_b32 s14, 2654208
s_mov_b32 s15, 0x20000
s_mul_i32 s30, s38, 165888
s_lshl_b32 s31, s52, 7
s_add_u32 s30, s30, s31
s_mul_i32 s31, s24, 9216
s_add_u32 s30, s30, s31
s_add_u32 s30, s30, s53
v_lshrrev_b32 v36, 7, v1
v_mul_u32_u24 v42, 1152, v36
v_and_b32 v36, 0x70, v1
v_add_u32 v42, v36, v42
s_lshl_b32 s32, s24, 10
s_mov_b32 s12, s78
s_mov_b32 s13, s79
s_add_u32 m0, s32, 40960
s_add_u32 s31, s30, 0
buffer_load_dwordx4 v42, s[12:15], s31 offen nt lds
s_add_u32 m0, s32, 45056
s_add_u32 s31, s30, 36864
buffer_load_dwordx4 v42, s[12:15], s31 offen nt lds
s_add_u32 m0, s32, 49152
s_add_u32 s31, s30, 73728
buffer_load_dwordx4 v42, s[12:15], s31 offen nt lds
s_add_u32 m0, s32, 53248
s_add_u32 s31, s30, 110592
buffer_load_dwordx4 v42, s[12:15], s31 offen nt lds
s_add_u32 m0, s32, 57344
s_add_u32 s31, s30, 147456
s_cmp_lt_u32 s24, 2
s_cselect_b32 s31, s31, 1073741824
buffer_load_dwordx4 v42, s[12:15], s31 offen nt lds
s_branch L_p0_j3
L_p0_a3:
s_mov_b32 s14, 5308416
s_mov_b32 s15, 0x20000
s_mul_i32 s30, s38, 1327104
s_lshl_b32 s31, s52, 7
s_add_u32 s30, s30, s31
s_mul_i32 s31, s24, 73728
s_add_u32 s30, s30, s31
s_add_u32 s30, s30, s53
v_lshrrev_b32 v36, 7, v1
v_mul_u32_u24 v42, 9216, v36
v_and_b32 v36, 0x70, v1
v_add_u32 v42, v36, v42
s_lshl_b32 s32, s24, 10
s_mov_b32 s12, s72
s_mov_b32 s13, s73
s_add_u32 m0, s32, 40960
s_add_u32 s31, s30, 0
buffer_load_dwordx4 v42, s[12:15], s31 offen nt lds
s_add_u32 m0, s32, 45056
s_add_u32 s31, s30, 294912
buffer_load_dwordx4 v42, s[12:15], s31 offen nt lds
s_add_u32 m0, s32, 49152
s_add_u32 s31, s30, 589824
buffer_load_dwordx4 v42, s[12:15], s31 offen nt lds
s_add_u32 m0, s32, 53248
s_add_u32 s31, s30, 884736
buffer_load_dwordx4 v42, s[12:15], s31 offen nt lds
s_add_u32 m0, s32, 57344
s_add_u32 s31, s30, 1179648
s_cmp_lt_u32 s24, 2
s_cselect_b32 s31, s31, 1073741824
buffer_load_dwordx4 v42, s[12:15], s31 offen nt lds
L_p0_j3:
s_waitcnt vmcnt(6)
s_barrier
ds_read_b64_tr_b16 v[84:85], v45 offset:20480
ds_read_b64_tr_b16 v[86:87], v45 offset:20992
ds_read_b64_tr_b16 v[88:89], v45 offset:24576
ds_read_b64_tr_b16 v[90:91], v45 offset:25088
ds_read_b64_tr_b16 v[92:93], v45 offset:28672
ds_read_b64_tr_b16 v[94:95], v45 offset:29184
ds_read_b64_tr_b16 v[96:97], v45 offset:32768
ds_read_b64_tr_b16 v[98:99], v45 offset:33280
ds_read_b64_tr_b16 v[100:101], v45 offset:36864
ds_read_b64_tr_b16 v[102:103], v45 offset:37376
v_mov_b32 v36, 1073741824
v_mov_b32 v46, 0
v_cndmask_b32 v37, v36, v170, s[50:51]
s_add_u32 s31, s36, 0
s_waitcnt lgkmcnt(8)
buffer_store_dwordx4 v[84:87], v170, s[4:7], s31 offen sc1
s_add_u32 s31, s36, 1024
s_waitcnt lgkmcnt(6)
buffer_store_dwordx4 v[88:91], v170, s[4:7], s31 offen sc1
s_add_u32 s31, s36, 2048
s_waitcnt lgkmcnt(4)
buffer_store_dwordx4 v[92:95], v170, s[4:7], s31 offen sc1
s_add_u32 s31, s36, 3072
s_waitcnt lgkmcnt(2)
buffer_store_dwordx4 v[96:99], v170, s[4:7], s31 offen sc1
s_add_u32 s31, s36, 4096
s_waitcnt lgkmcnt(0)
buffer_store_dwordx4 v[100:103], v37, s[4:7], s31 offen sc1
v_mov_b32 v37, 0x3f803f80
v_dot2c_f32_bf16 v46, v84, v37
v_dot2c_f32_bf16 v46, v85, v37
v_dot2c_f32_bf16 v46, v86, v37
v_dot2c_f32_bf16 v46, v87, v37
v_dot2c_f32_bf16 v46, v88, v37
v_dot2c_f32_bf16 v46, v89, v37
v_dot2c_f32_bf16 v46, v90, v37
v_dot2c_f32_bf16 v46, v91, v37
v_dot2c_f32_bf16 v46, v92, v37
v_dot2c_f32_bf16 v46, v93, v37
v_dot2c_f32_bf16 v46, v94, v37
v_dot2c_f32_bf16 v46, v95, v37
v_dot2c_f32_bf16 v46, v96, v37
v_dot2c_f32_bf16 v46, v97, v37
v_dot2c_f32_bf16 v46, v98, v37
v_dot2c_f32_bf16 v46, v99, v37
v_dot2c_f32_bf16 v46, v100, v37
v_dot2c_f32_bf16 v46, v101, v37
v_dot2c_f32_bf16 v46, v102, v37
v_dot2c_f32_bf16 v46, v103, v37
s_nop 2
v_mov_b32 v37, v46
s_nop 1
v_permlane32_swap_b32 v46, v37
v_add_f32 v46, v46, v37
v_mov_b32 v37, v46
s_nop 1
v_permlane16_swap_b32 v46, v37
v_add_f32 v46, v46, v37
v_cvt_pk_bf16_f32 v50, v46, v46
v_and_b32 v37, 0xffff0000, v50
v_sub_f32 v37, v46, v37
v_cvt_pk_bf16_f32 v51, v37, v37
v_cndmask_b32 v36, v36, v171, s[46:47]
buffer_store_dwordx2 v[50:51], v36, s[4:7], s36 offen sc1
s_waitcnt vmcnt(6)
s_barrier
s_cmp_lt_u32 s2, 32
s_cbranch_scc1 L_p0_a4
s_cmp_lt_u32 s2, 176
s_cbranch_scc1 L_p0_b4
ds_read_b64_tr_b16 v[104:105], v52 offset:40960
ds_read_b64_tr_b16 v[106:107], v52 offset:43264
ds_read_b64_tr_b16 v[108:109], v52 offset:45568
ds_read_b64_tr_b16 v[110:111], v52 offset:47872
ds_read_b64_tr_b16 v[112:113], v52 offset:50176
ds_read_b64_tr_b16 v[114:115], v52 offset:52480
ds_read_b64_tr_b16 v[116:117], v52 offset:54784
ds_read_b64_tr_b16 v[118:119], v52 offset:57088
ds_read_b64_tr_b16 v[120:121], v53 offset:40960
ds_read_b64_tr_b16 v[122:123], v53 offset:45568
v_mov_b32 v36, 1073741824
v_mov_b32 v46, 0
v_cndmask_b32 v37, v36, v173, s[50:51]
s_add_u32 s31, s53, 0
s_waitcnt lgkmcnt(8)
buffer_store_dwordx4 v[104:107], v172, s[4:7], s31 offen sc1
s_add_u32 s31, s53, 4608
s_waitcnt lgkmcnt(6)
buffer_store_dwordx4 v[108:111], v172, s[4:7], s31 offen sc1
s_add_u32 s31, s53, 9216
s_waitcnt lgkmcnt(4)
buffer_store_dwordx4 v[112:115], v172, s[4:7], s31 offen sc1
s_add_u32 s31, s53, 13824
s_waitcnt lgkmcnt(2)
buffer_store_dwordx4 v[116:119], v172, s[4:7], s31 offen sc1
s_add_u32 s31, s53, 0
s_waitcnt lgkmcnt(0)
buffer_store_dwordx4 v[120:123], v37, s[4:7], s31 offen sc1
buffer_store_dwordx2 v[50:51], v36, s[4:7], s53 offen sc1
s_branch L_p0_j4
L_p0_b4:
ds_read_b64_tr_b16 v[104:105], v45 offset:40960
ds_read_b64_tr_b16 v[106:107], v45 offset:41472
ds_read_b64_tr_b16 v[108:109], v45 offset:45056
ds_read_b64_tr_b16 v[110:111], v45 offset:45568
ds_read_b64_tr_b16 v[112:113], v45 offset:49152
ds_read_b64_tr_b16 v[114:115], v45 offset:49664
ds_read_b64_tr_b16 v[116:117], v45 offset:53248
ds_read_b64_tr_b16 v[118:119], v45 offset:53760
ds_read_b64_tr_b16 v[120:121], v45 offset:57344
ds_read_b64_tr_b16 v[122:123], v45 offset:57856
v_mov_b32 v36, 1073741824
v_mov_b32 v46, 0
v_cndmask_b32 v37, v36, v56, s[50:51]
s_add_u32 s31, s53, 0
s_waitcnt lgkmcnt(8)
buffer_store_dwordx4 v[104:107], v52, s[4:7], s31 offen sc1
s_add_u32 s31, s53, 0
s_waitcnt lgkmcnt(6)
buffer_store_dwordx4 v[108:111], v53, s[4:7], s31 offen sc1
s_add_u32 s31, s53, 0
s_waitcnt lgkmcnt(4)
buffer_store_dwordx4 v[112:115], v54, s[4:7], s31 offen sc1
s_add_u32 s31, s53, 0
s_waitcnt lgkmcnt(2)
buffer_store_dwordx4 v[116:119], v55, s[4:7], s31 offen sc1
s_add_u32 s31, s53, 0
s_waitcnt lgkmcnt(0)
buffer_store_dwordx4 v[120:123], v37, s[4:7], s31 offen sc1
buffer_store_dwordx2 v[50:51], v36, s[4:7], s53 offen sc1
s_branch L_p0_j4
L_p0_a4:
ds_read_b64_tr_b16 v[104:105], v45 offset:40960
ds_read_b64_tr_b16 v[106:107], v45 offset:41472
ds_read_b64_tr_b16 v[108:109], v45 offset:45056
ds_read_b64_tr_b16 v[110:111], v45 offset:45568
ds_read_b64_tr_b16 v[112:113], v45 offset:49152
ds_read_b64_tr_b16 v[114:115], v45 offset:49664
ds_read_b64_tr_b16 v[116:117], v45 offset:53248
ds_read_b64_tr_b16 v[118:119], v45 offset:53760
ds_read_b64_tr_b16 v[120:121], v45 offset:57344
ds_read_b64_tr_b16 v[122:123], v45 offset:57856
v_mov_b32 v36, 1073741824
v_mov_b32 v46, 0
v_cndmask_b32 v37, v36, v172, s[50:51]
s_add_u32 s31, s53, 0
s_waitcnt lgkmcnt(8)
buffer_store_dwordx4 v[104:107], v172, s[4:7], s31 offen sc1
s_add_u32 s31, s53, 1024
s_waitcnt lgkmcnt(6)
buffer_store_dwordx4 v[108:111], v172, s[4:7], s31 offen sc1
s_add_u32 s31, s53, 2048
s_waitcnt lgkmcnt(4)
buffer_store_dwordx4 v[112:115], v172, s[4:7], s31 offen sc1
s_add_u32 s31, s53, 3072
s_waitcnt lgkmcnt(2)
buffer_store_dwordx4 v[116:119], v172, s[4:7], s31 offen sc1
s_add_u32 s31, s53, 4096
s_waitcnt lgkmcnt(0)
buffer_store_dwordx4 v[120:123], v37, s[4:7], s31 offen sc1
v_mov_b32 v37, 0x3f803f80
v_dot2c_f32_bf16 v46, v104, v37
v_dot2c_f32_bf16 v46, v105, v37
v_dot2c_f32_bf16 v46, v106, v37
v_dot2c_f32_bf16 v46, v107, v37
v_dot2c_f32_bf16 v46, v108, v37
v_dot2c_f32_bf16 v46, v109, v37
v_dot2c_f32_bf16 v46, v110, v37
v_dot2c_f32_bf16 v46, v111, v37
v_dot2c_f32_bf16 v46, v112, v37
v_dot2c_f32_bf16 v46, v113, v37
v_dot2c_f32_bf16 v46, v114, v37
v_dot2c_f32_bf16 v46, v115, v37
v_dot2c_f32_bf16 v46, v116, v37
v_dot2c_f32_bf16 v46, v117, v37
v_dot2c_f32_bf16 v46, v118, v37
v_dot2c_f32_bf16 v46, v119, v37
v_dot2c_f32_bf16 v46, v120, v37
v_dot2c_f32_bf16 v46, v121, v37
v_dot2c_f32_bf16 v46, v122, v37
v_dot2c_f32_bf16 v46, v123, v37
s_nop 2
v_mov_b32 v37, v46
s_nop 1
v_permlane32_swap_b32 v46, v37
v_add_f32 v46, v46, v37
v_mov_b32 v37, v46
s_nop 1
v_permlane16_swap_b32 v46, v37
v_add_f32 v46, v46, v37
v_cvt_pk_bf16_f32 v50, v46, v46
v_and_b32 v37, 0xffff0000, v50
v_sub_f32 v37, v46, v37
v_cvt_pk_bf16_f32 v51, v37, v37
v_cndmask_b32 v36, v36, v173, s[46:47]
buffer_store_dwordx2 v[50:51], v36, s[4:7], s53 offen sc1
L_p0_j4:
s_mov_b32 s12, s74
s_mov_b32 s13, s75
s_mov_b32 s14, 8388608
s_mov_b32 s15, 0x20000
s_cmp_eq_u32 s24, 1
s_cselect_b32 s63, 0, 1073741824
s_add_u32 s63, s63, 19415040
s_mov_b32 exec_lo, 0x000001ff
s_mov_b32 exec_hi, 0x00ffffff
buffer_load_dwordx2 v[176:177], v174, s[4:7], s63 offen sc1
s_mov_b64 exec, -1
s_cmp_eq_u32 s24, 1
s_cbranch_scc0 L_p0done_10
s_mov_b32 s31, 0
s_mov_b32 exec_lo, 0x000001ff
s_mov_b32 exec_hi, 0x00ffffff
s_waitcnt vmcnt(0)
v_cmp_ne_u64 vcc, v[176:177], v[238:239]
s_nop 0
s_cbranch_vccz L_p0done_10
L_p0poll_9:
buffer_load_dwordx2 v[176:177], v174, s[4:7], s63 offen sc1
s_add_u32 s31, s31, 1
s_waitcnt vmcnt(0)
v_cmp_ne_u64 vcc, v[176:177], v[238:239]
s_cmp_gt_u32 s31, 200000
s_cbranch_scc1 L_p0done_10
s_cbranch_vccnz L_p0poll_9
L_p0done_10:
s_mov_b64 exec, -1
s_barrier
s_lshl_b32 s33, s25, 8
s_lshl_b32 s32, s24, 6
s_add_u32 s33, s33, s32
v_lshlrev_b32 v8, 1, v2
buffer_load_ushort v0, v8, s[20:23], s33 offen
buffer_load_ushort v249, v8, s[20:23], s33 offen offset:32
s_mul_i32 s30, s70, 18432
s_mul_i32 s31, s28, 2304
s_add_u32 s30, s30, s31
s_add_u32 s30, s30, 0
v_and_b32 v6, 1, v3
v_lshlrev_b32 v6, 3, v6
v_lshl_add_u32 v6, v2, 4, v6
buffer_load_dwordx4 v[36:39], v1, s[8:11], s30 offen sc1
buffer_load_dwordx4 v[40:43], v1, s[8:11], s30 offen offset:1024 sc1
buffer_load_dwordx2 v[44:45], v6, s[8:11], s30 offen offset:2048 sc1
s_mul_i32 s36, s26, 132608
s_mul_i32 s38, s24, 12288
s_add_u32 m0, s38, 0
s_add_u32 s39, s38, s36
buffer_load_dwordx4 v1, s[4:7], s39 offen offset:0 sc1 lds
buffer_load_dwordx4 v1, s[4:7], s39 offen offset:1024 sc1 lds
buffer_load_dwordx4 v1, s[4:7], s39 offen offset:2048 sc1 lds
buffer_load_dwordx4 v1, s[4:7], s39 offen offset:3072 sc1 lds
s_add_u32 m0, m0, 4096
s_add_u32 s39, s39, 4096
buffer_load_dwordx4 v1, s[4:7], s39 offen offset:0 sc1 lds
buffer_load_dwordx4 v1, s[4:7], s39 offen offset:1024 sc1 lds
buffer_load_dwordx4 v1, s[4:7], s39 offen offset:2048 sc1 lds
buffer_load_dwordx4 v1, s[4:7], s39 offen offset:3072 sc1 lds
s_add_u32 m0, m0, 4096
s_add_u32 s39, s39, 4096
buffer_load_dwordx4 v1, s[4:7], s39 offen offset:0 sc1 lds
buffer_load_dwordx4 v1, s[4:7], s39 offen offset:1024 sc1 lds
buffer_load_dwordx4 v1, s[4:7], s39 offen offset:2048 sc1 lds
buffer_load_dwordx4 v1, s[4:7], s39 offen offset:3072 sc1 lds
v_and_b32 v6, 1, v2
v_cmp_eq_u32 s[40:41], 1, v6
v_lshl_add_u32 v6, v3, 2, v6
v_cmp_le_u32 s[42:43], v6, v2
v_add_u32_e64 v6, 2, v6
v_cmp_le_u32 s[44:45], v6, v2
v_mov_b32 v6, 0x0c0c0100
v_mov_b32 v7, 0x01000c0c
v_cndmask_b32 v6, v6, v7, s[40:41]
v_mov_b32 v8, 0x0c0c0c0c
v_cndmask_b32 v10, v6, v8, s[42:43]
v_cndmask_b32 v12, v8, v6, s[42:43]
v_mov_b32 v6, 0x0c0c0302
v_mov_b32 v7, 0x03020c0c
v_cndmask_b32 v6, v6, v7, s[40:41]
v_cndmask_b32 v11, v6, v8, s[44:45]
v_cndmask_b32 v13, v8, v6, s[44:45]
s_mul_i32 s82, s26, 340992
s_add_u32 s82, s82, 2785280
s_mul_i32 s83, s28, 331776
s_add_u32 s83, s83, 8241152
s_and_b32 s30, s27, 1
s_mul_i32 s30, s30, 165888
s_add_u32 s83, s83, s30
s_waitcnt vmcnt(12)
v_lshlrev_b32 v16, 16, v36
v_and_b32 v17, 0xffff0000, v36
v_lshlrev_b32 v18, 16, v37
v_and_b32 v19, 0xffff0000, v37
v_lshlrev_b32 v20, 16, v38
v_and_b32 v21, 0xffff0000, v38
v_lshlrev_b32 v22, 16, v39
v_and_b32 v23, 0xffff0000, v39
v_lshlrev_b32 v24, 16, v40
v_and_b32 v25, 0xffff0000, v40
v_lshlrev_b32 v26, 16, v41
v_and_b32 v27, 0xffff0000, v41
v_lshlrev_b32 v28, 16, v42
v_and_b32 v29, 0xffff0000, v42
v_lshlrev_b32 v30, 16, v43
v_and_b32 v31, 0xffff0000, v43
v_lshlrev_b32 v32, 16, v44
v_and_b32 v33, 0xffff0000, v44
v_lshlrev_b32 v34, 16, v45
v_and_b32 v35, 0xffff0000, v45
v_mov_b32 v6, 0
s_barrier
v_mov_b32 v248, v238
s_mov_b64 exec, 1
buffer_store_dwordx2 v[238:239], v6, s[4:7], s100 offen sc1
s_mov_b64 exec, -1
s_mul_i32 s36, s26, 132608
s_mul_i32 s38, s24, 9216
s_add_u32 m0, s38, 49152
s_add_u32 s39, s38, s36
s_add_u32 s39, s39, 49152
buffer_load_dwordx4 v1, s[4:7], s39 offen offset:0 sc1 lds
buffer_load_dwordx4 v1, s[4:7], s39 offen offset:1024 sc1 lds
buffer_load_dwordx4 v1, s[4:7], s39 offen offset:2048 sc1 lds
buffer_load_dwordx4 v1, s[4:7], s39 offen offset:3072 sc1 lds
s_add_u32 m0, m0, 4096
s_add_u32 s39, s39, 4096
buffer_load_dwordx4 v1, s[4:7], s39 offen offset:0 sc1 lds
buffer_load_dwordx4 v1, s[4:7], s39 offen offset:1024 sc1 lds
buffer_load_dwordx4 v1, s[4:7], s39 offen offset:2048 sc1 lds
buffer_load_dwordx4 v1, s[4:7], s39 offen offset:3072 sc1 lds
s_add_u32 m0, m0, 4096
s_add_u32 s39, s39, 4096
buffer_load_dwordx4 v1, s[4:7], s39 offen offset:0 sc1 lds
s_lshl_b32 s60, s25, 3
s_sub_u32 s61, s60, 1
s_max_i32 s61, s61, 0
s_lshl_b32 s30, s24, 1
s_add_u32 s60, s60, s30
s_mul_i32 s30, s61, 18432
s_mul_i32 s62, s60, 18432
v_add_u32 v237, 18432, v1
s_mul_i32 s38, s24, 5120
s_add_u32 m0, s38, 135168
s_add_u32 s39, s38, s30
L_layer:
buffer_load_dwordx4 v1, s[8:11], s39 offen offset:0 sc1 lds
buffer_load_dwordx4 v1, s[8:11], s39 offen offset:1024 sc1 lds
buffer_load_dwordx4 v1, s[8:11], s39 offen offset:2048 sc1 lds
buffer_load_dwordx4 v1, s[8:11], s39 offen offset:3072 sc1 lds
s_add_u32 m0, m0, 4096
s_add_u32 s39, s39, 4096
buffer_load_dwordx4 v1, s[8:11], s39 offen offset:0 sc1 lds
s_barrier
buffer_load_dwordx4 a[0:3], v1, s[8:11], s62 offen offset:0 sc1
buffer_load_dwordx4 a[4:7], v237, s[8:11], s62 offen offset:0 sc1
s_barrier
buffer_load_dwordx4 a[8:11], v1, s[8:11], s62 offen offset:1024 sc1
buffer_load_dwordx4 a[12:15], v237, s[8:11], s62 offen offset:1024 sc1
s_barrier
buffer_load_dwordx4 a[16:19], v1, s[8:11], s62 offen offset:2048 sc1
buffer_load_dwordx4 a[20:23], v237, s[8:11], s62 offen offset:2048 sc1
s_barrier
buffer_load_dwordx4 a[24:27], v1, s[8:11], s62 offen offset:3072 sc1
buffer_load_dwordx4 a[28:31], v237, s[8:11], s62 offen offset:3072 sc1
s_barrier
s_add_u32 s62, s62, 4096
buffer_load_dwordx4 a[32:35], v1, s[8:11], s62 offen offset:0 sc1
buffer_load_dwordx4 a[36:39], v237, s[8:11], s62 offen offset:0 sc1
s_barrier
buffer_load_dwordx4 a[40:43], v1, s[8:11], s62 offen offset:1024 sc1
buffer_load_dwordx4 a[44:47], v237, s[8:11], s62 offen offset:1024 sc1
s_sub_u32 s30, s60, 2
v_add_u32 v6, s30, v3
v_max_i32 v6, 0, v6
v_mov_b32 v7, s61
v_cndmask_b32 v6, v6, v7, s[46:47]
v_lshl_add_u32 v6, v6, 4, v2
v_lshlrev_b32 v129, 3, v6
s_lshl_b32 s30, s24, 10
v_add_u32 v125, s30, v1
v_add_u32 v126, 135168, v1
v_lshrrev_b32 v127, 1, v1
v_add_u32 v127, 129024, v127
s_lshl_b32 s30, s24, 9
v_add_u32 v128, s30, v127
v_add_u32 v8, 64512, v1
s_waitcnt vmcnt(12)
s_barrier
ds_read_b128 a[144:147], v1 offset:0
ds_read_b128 a[148:151], v1 offset:1024
ds_read_b128 a[152:155], v1 offset:2048
ds_read_b128 a[156:159], v1 offset:3072
ds_read_b128 a[160:163], v1 offset:4096
ds_read_b128 a[164:167], v1 offset:5120
ds_read_b128 a[168:171], v1 offset:6144
ds_read_b128 a[172:175], v125 offset:0
ds_read_b128 a[176:179], v126 offset:0
v_lshrrev_b32 v146, 1, v1
s_lshl_b32 s66, s24, 9
s_add_u32 s66, s66, 19447808
s_waitcnt vmcnt(10) lgkmcnt(0)
v_mfma_f32_16x16x32_bf16 v[36:39], a[144:147], a[0:3], 0
ds_read_b128 a[180:183], v1 offset:7168
buffer_load_dwordx4 a[48:51], v1, s[8:11], s62 offen offset:2048 sc1
v_mfma_f32_16x16x32_bf16 v[64:67], a[144:147], a[4:7], 0
ds_read_b128 a[184:187], v1 offset:8192
v_mfma_f32_16x16x32_bf16 v[40:43], a[148:151], a[0:3], 0
ds_read_b128 a[188:191], v1 offset:9216
v_mfma_f32_16x16x32_bf16 v[68:71], a[148:151], a[4:7], 0
ds_read_b128 a[192:195], v1 offset:10240
v_mfma_f32_16x16x32_bf16 v[44:47], a[152:155], a[0:3], 0
ds_read_b128 a[196:199], v1 offset:11264
buffer_load_dwordx4 a[52:55], v237, s[8:11], s62 offen offset:2048 sc1
v_mfma_f32_16x16x32_bf16 v[72:75], a[152:155], a[4:7], 0
ds_read_b128 a[200:203], v1 offset:12288
v_mfma_f32_16x16x32_bf16 v[48:51], a[156:159], a[0:3], 0
ds_read_b128 a[204:207], v1 offset:13312
v_mfma_f32_16x16x32_bf16 v[76:79], a[156:159], a[4:7], 0
ds_read_b128 a[208:211], v125 offset:7168
v_mfma_f32_16x16x32_bf16 v[52:55], a[160:163], a[0:3], 0
ds_read_b128 a[212:215], v126 offset:1024
buffer_load_dwordx4 a[56:59], v1, s[8:11], s62 offen offset:3072 sc1
v_mfma_f32_16x16x32_bf16 v[80:83], a[160:163], a[4:7], 0
v_mfma_f32_16x16x32_bf16 v[92:95], a[172:175], a[176:179], 0
v_mfma_f32_16x16x32_bf16 v[96:99], a[160:163], a[176:179], 0
v_mfma_f32_16x16x32_bf16 v[56:59], a[164:167], a[0:3], 0
buffer_load_dwordx4 a[60:63], v237, s[8:11], s62 offen offset:3072 sc1
v_mfma_f32_16x16x32_bf16 v[84:87], a[164:167], a[4:7], 0
s_add_u32 s62, s62, 4096
v_mfma_f32_16x16x32_bf16 v[60:63], a[168:171], a[0:3], 0
v_mfma_f32_16x16x32_bf16 v[88:91], a[168:171], a[4:7], 0
s_waitcnt vmcnt(12) lgkmcnt(0)
v_mfma_f32_16x16x32_bf16 v[36:39], a[180:183], a[8:11], v[36:39]
ds_read_b128 a[144:147], v1 offset:14336
v_lshlrev_b32 v124, 2, v2
v_mfma_f32_16x16x32_bf16 v[64:67], a[180:183], a[12:15], v[64:67]
ds_read_b128 a[148:151], v1 offset:15360
v_and_b32 v6, 1, v2
v_mfma_f32_16x16x32_bf16 v[40:43], a[184:187], a[8:11], v[40:43]
ds_read_b128 a[152:155], v1 offset:16384
v_mfma_f32_16x16x32_bf16 v[68:71], a[184:187], a[12:15], v[68:71]
ds_read_b128 a[156:159], v1 offset:17408
v_lshl_add_u32 v6, v3, 2, v6
v_mfma_f32_16x16x32_bf16 v[44:47], a[188:191], a[8:11], v[44:47]
ds_read_b128 a[160:163], v1 offset:18432
v_lshlrev_b32 v6, 2, v6
v_mfma_f32_16x16x32_bf16 v[72:75], a[188:191], a[12:15], v[72:75]
ds_read_b128 a[164:167], v1 offset:19456
buffer_load_dwordx4 a[64:67], v1, s[8:11], s62 offen offset:0 sc1
v_mfma_f32_16x16x32_bf16 v[48:51], a[192:195], a[8:11], v[48:51]
ds_read_b128 a[168:171], v1 offset:20480
v_add_u32 v122, 64, v6
v_mfma_f32_16x16x32_bf16 v[76:79], a[192:195], a[12:15], v[76:79]
ds_read_b128 a[172:175], v125 offset:14336
v_mfma_f32_16x16x32_bf16 v[52:55], a[196:199], a[8:11], v[52:55]
ds_read_b128 a[176:179], v126 offset:2048
v_add_u32 v7, 128, v6
v_mfma_f32_16x16x32_bf16 v[80:83], a[196:199], a[12:15], v[80:83]
buffer_load_dwordx4 a[68:71], v237, s[8:11], s62 offen offset:0 sc1
v_cndmask_b32 v122, v122, v7, s[42:43]
v_mfma_f32_16x16x32_bf16 v[92:95], a[208:211], a[212:215], v[92:95]
v_mfma_f32_16x16x32_bf16 v[96:99], a[196:199], a[212:215], v[96:99]
v_add_u32 v123, 72, v6
v_mfma_f32_16x16x32_bf16 v[56:59], a[200:203], a[8:11], v[56:59]
v_mfma_f32_16x16x32_bf16 v[84:87], a[200:203], a[12:15], v[84:87]
v_add_u32 v7, 136, v6
v_mfma_f32_16x16x32_bf16 v[60:63], a[204:207], a[8:11], v[60:63]
buffer_load_dwordx4 a[72:75], v1, s[8:11], s62 offen offset:1024 sc1
v_cndmask_b32 v123, v123, v7, s[44:45]
v_mfma_f32_16x16x32_bf16 v[88:91], a[204:207], a[12:15], v[88:91]
s_mov_b32 s63, 2359296
s_waitcnt vmcnt(13) lgkmcnt(0)
v_mfma_f32_16x16x32_bf16 v[36:39], a[144:147], a[16:19], v[36:39]
ds_read_b128 a[180:183], v1 offset:21504
s_lshl_b32 s31, s24, 5
v_mfma_f32_16x16x32_bf16 v[64:67], a[144:147], a[20:23], v[64:67]
ds_read_b128 a[184:187], v1 offset:22528
v_mfma_f32_16x16x32_bf16 v[40:43], a[148:151], a[16:19], v[40:43]
ds_read_b128 a[188:191], v1 offset:23552
v_add_u32 v6, s31, v2
v_mfma_f32_16x16x32_bf16 v[68:71], a[148:151], a[20:23], v[68:71]
ds_read_b128 a[192:195], v1 offset:24576
v_mul_u32_u24 v220, 176, v6
v_mfma_f32_16x16x32_bf16 v[44:47], a[152:155], a[16:19], v[44:47]
ds_read_b128 a[196:199], v1 offset:25600
v_mfma_f32_16x16x32_bf16 v[72:75], a[152:155], a[20:23], v[72:75]
ds_read_b128 a[200:203], v1 offset:26624
v_add_u32 v220, 0, v220
v_mfma_f32_16x16x32_bf16 v[48:51], a[156:159], a[16:19], v[48:51]
ds_read_b128 a[204:207], v1 offset:27648
buffer_load_dwordx2 v[100:101], v129, s[8:11], s63 offen sc1
v_mfma_f32_16x16x32_bf16 v[76:79], a[156:159], a[20:23], v[76:79]
ds_read_b128 a[208:211], v125 offset:21504
v_lshl_add_u32 v218, v3, 3, v220
v_mfma_f32_16x16x32_bf16 v[52:55], a[160:163], a[16:19], v[52:55]
ds_read_b128 a[212:215], v126 offset:3072
s_mul_i32 s36, s26, 132608
v_mfma_f32_16x16x32_bf16 v[80:83], a[160:163], a[20:23], v[80:83]
s_mov_b32 s63, 2375680
v_mul_u32_u24 v219, 176, v2
v_mfma_f32_16x16x32_bf16 v[92:95], a[172:175], a[176:179], v[92:95]
s_mul_i32 s38, s24, 12288
v_lshl_add_u32 v219, v3, 3, v219
v_mfma_f32_16x16x32_bf16 v[96:99], a[160:163], a[176:179], v[96:99]
s_add_u32 m0, s38, 86016
v_mfma_f32_16x16x32_bf16 v[56:59], a[164:167], a[16:19], v[56:59]
s_add_u32 s39, s38, s36
v_add_u32 v219, 0, v219
v_mfma_f32_16x16x32_bf16 v[84:87], a[164:167], a[20:23], v[84:87]
s_add_u32 s39, s39, 86016
v_add_u32 v222, s31, v219
v_mfma_f32_16x16x32_bf16 v[60:63], a[168:171], a[16:19], v[60:63]
v_mfma_f32_16x16x32_bf16 v[88:91], a[168:171], a[20:23], v[88:91]
buffer_load_dwordx2 v[102:103], v129, s[8:11], s63 offen sc1
s_waitcnt vmcnt(13) lgkmcnt(0)
v_mfma_f32_16x16x32_bf16 v[36:39], a[180:183], a[24:27], v[36:39]
ds_read_b128 a[144:147], v1 offset:28672
v_lshrrev_b32 v6, 2, v2
v_mfma_f32_16x16x32_bf16 v[64:67], a[180:183], a[28:31], v[64:67]
ds_read_b128 a[148:151], v1 offset:29696
v_lshl_add_u32 v6, v3, 2, v6
v_mfma_f32_16x16x32_bf16 v[40:43], a[184:187], a[24:27], v[40:43]
ds_read_b128 a[152:155], v1 offset:30720
v_add_u32 v6, s31, v6
v_mfma_f32_16x16x32_bf16 v[68:71], a[184:187], a[28:31], v[68:71]
ds_read_b128 a[156:159], v1 offset:31744
s_mov_b32 s63, 2392064
v_mfma_f32_16x16x32_bf16 v[44:47], a[188:191], a[24:27], v[44:47]
ds_read_b128 a[160:163], v1 offset:32768
v_mul_u32_u24 v221, 176, v6
v_mfma_f32_16x16x32_bf16 v[72:75], a[188:191], a[28:31], v[72:75]
ds_read_b128 a[164:167], v1 offset:33792
v_and_b32 v6, 3, v2
v_mfma_f32_16x16x32_bf16 v[48:51], a[192:195], a[24:27], v[48:51]
ds_read_b128 a[168:171], v1 offset:34816
v_mfma_f32_16x16x32_bf16 v[76:79], a[192:195], a[28:31], v[76:79]
ds_read_b128 a[172:175], v125 offset:28672
buffer_load_dwordx2 v[104:105], v129, s[8:11], s63 offen sc1
v_mfma_f32_16x16x32_bf16 v[52:55], a[196:199], a[24:27], v[52:55]
ds_read_b128 a[176:179], v126 offset:4096
v_lshl_add_u32 v221, v6, 3, v221
v_mfma_f32_16x16x32_bf16 v[80:83], a[196:199], a[28:31], v[80:83]
s_mov_b32 s63, 2408448
v_add_u32 v221, 0, v221
v_mfma_f32_16x16x32_bf16 v[92:95], a[208:211], a[212:215], v[92:95]
v_mov_b32 v171, 0
v_mfma_f32_16x16x32_bf16 v[96:99], a[196:199], a[212:215], v[96:99]
v_mfma_f32_16x16x32_bf16 v[56:59], a[200:203], a[24:27], v[56:59]
buffer_load_dwordx4 v1, s[4:7], s39 offen offset:0 sc1 lds
v_mov_b32 v172, 0
v_mfma_f32_16x16x32_bf16 v[84:87], a[200:203], a[28:31], v[84:87]
v_mfma_f32_16x16x32_bf16 v[60:63], a[204:207], a[24:27], v[60:63]
v_mov_b32 v179, 0
v_mfma_f32_16x16x32_bf16 v[88:91], a[204:207], a[28:31], v[88:91]
v_mov_b32 v180, 0
s_waitcnt vmcnt(13) lgkmcnt(0)
v_mfma_f32_16x16x32_bf16 v[36:39], a[144:147], a[32:35], v[36:39]
ds_read_b128 a[180:183], v1 offset:35840
buffer_load_dwordx2 v[106:107], v129, s[8:11], s63 offen sc1
v_mfma_f32_16x16x32_bf16 v[64:67], a[144:147], a[36:39], v[64:67]
ds_read_b128 a[184:187], v1 offset:36864
buffer_load_dwordx4 v1, s[4:7], s39 offen offset:1024 sc1 lds
v_mfma_f32_16x16x32_bf16 v[40:43], a[148:151], a[32:35], v[40:43]
ds_read_b128 a[188:191], v1 offset:37888
s_mul_i32 s30, s60, 18432
v_mfma_f32_16x16x32_bf16 v[68:71], a[148:151], a[36:39], v[68:71]
ds_read_b128 a[192:195], v1 offset:38912
s_add_u32 s30, s30, 2490368
v_mfma_f32_16x16x32_bf16 v[44:47], a[152:155], a[32:35], v[44:47]
ds_read_b128 a[196:199], v1 offset:39936
buffer_load_dwordx4 v1, s[4:7], s39 offen offset:2048 sc1 lds
v_mfma_f32_16x16x32_bf16 v[72:75], a[152:155], a[36:39], v[72:75]
ds_read_b128 a[200:203], v1 offset:40960
s_mov_b32 s63, 2424832
v_mfma_f32_16x16x32_bf16 v[48:51], a[156:159], a[32:35], v[48:51]
ds_read_b128 a[204:207], v1 offset:41984
s_lshl_b32 s64, s26, 10
v_mfma_f32_16x16x32_bf16 v[76:79], a[156:159], a[36:39], v[76:79]
ds_read_b128 a[208:211], v125 offset:35840
s_add_u32 s64, s64, s30
v_mfma_f32_16x16x32_bf16 v[52:55], a[160:163], a[32:35], v[52:55]
ds_read_b128 a[212:215], v126 offset:5120
buffer_load_dwordx2 v[108:109], v129, s[8:11], s63 offen sc1
v_mfma_f32_16x16x32_bf16 v[80:83], a[160:163], a[36:39], v[80:83]
buffer_load_dwordx4 v1, s[4:7], s39 offen offset:3072 sc1 lds
s_and_b32 s65, s26, 1
v_mfma_f32_16x16x32_bf16 v[92:95], a[172:175], a[176:179], v[92:95]
s_mov_b32 s63, 2441216
s_lshl_b32 s65, s65, 10
v_mfma_f32_16x16x32_bf16 v[96:99], a[160:163], a[176:179], v[96:99]
s_add_u32 m0, m0, 4096
s_add_u32 s30, s30, s65
v_mfma_f32_16x16x32_bf16 v[56:59], a[164:167], a[32:35], v[56:59]
s_add_u32 s39, s39, 4096
v_mfma_f32_16x16x32_bf16 v[84:87], a[164:167], a[36:39], v[84:87]
s_lshr_b32 s65, s26, 1
v_mfma_f32_16x16x32_bf16 v[60:63], a[168:171], a[32:35], v[60:63]
s_lshl_b32 s65, s65, 7
v_mfma_f32_16x16x32_bf16 v[88:91], a[168:171], a[36:39], v[88:91]
s_add_u32 s65, s65, s30
s_waitcnt vmcnt(16) lgkmcnt(0)
v_mfma_f32_16x16x32_bf16 v[36:39], a[180:183], a[40:43], v[36:39]
ds_read_b128 a[144:147], v1 offset:43008
v_mfma_f32_16x16x32_bf16 v[64:67], a[180:183], a[44:47], v[64:67]
ds_read_b128 a[148:151], v1 offset:44032
buffer_load_dwordx2 v[110:111], v129, s[8:11], s63 offen sc1
v_mfma_f32_16x16x32_bf16 v[40:43], a[184:187], a[40:43], v[40:43]
ds_read_b128 a[152:155], v1 offset:45056
s_add_u32 s65, s65, 16384
v_mfma_f32_16x16x32_bf16 v[68:71], a[184:187], a[44:47], v[68:71]
ds_read_b128 a[156:159], v1 offset:46080
v_mov_b32 v224, 1073741824
v_mfma_f32_16x16x32_bf16 v[44:47], a[188:191], a[40:43], v[44:47]
ds_read_b128 a[160:163], v1 offset:47104
buffer_load_dwordx4 v1, s[4:7], s39 offen offset:0 sc1 lds
v_mfma_f32_16x16x32_bf16 v[72:75], a[188:191], a[44:47], v[72:75]
ds_read_b128 a[164:167], v1 offset:48128
s_mov_b32 s63, 2457600
v_mfma_f32_16x16x32_bf16 v[48:51], a[192:195], a[40:43], v[48:51]
ds_read_b128 a[168:171], v1 offset:49152
v_lshlrev_b32 v225, 3, v2
v_mfma_f32_16x16x32_bf16 v[76:79], a[192:195], a[44:47], v[76:79]
ds_read_b128 a[172:175], v125 offset:43008
v_cndmask_b32 v224, v224, v225, s[46:47]
v_mfma_f32_16x16x32_bf16 v[52:55], a[196:199], a[40:43], v[52:55]
ds_read_b128 a[176:179], v126 offset:6144
buffer_load_dwordx4 v1, s[4:7], s39 offen offset:1024 sc1 lds
v_mfma_f32_16x16x32_bf16 v[80:83], a[196:199], a[44:47], v[80:83]
v_add_u32 v225, 18432, v224
v_mfma_f32_16x16x32_bf16 v[92:95], a[208:211], a[212:215], v[92:95]
buffer_load_dwordx2 v[112:113], v129, s[8:11], s63 offen sc1
s_lshl_b32 s68, s24, 13
v_mfma_f32_16x16x32_bf16 v[96:99], a[196:199], a[212:215], v[96:99]
s_mov_b32 s63, 2473984
v_add_u32 v6, 0, v3
v_mfma_f32_16x16x32_bf16 v[56:59], a[200:203], a[40:43], v[56:59]
buffer_load_dwordx4 v1, s[4:7], s39 offen offset:2048 sc1 lds
v_mfma_f32_16x16x32_bf16 v[84:87], a[200:203], a[44:47], v[84:87]
v_xor_b32 v7, v6, v2
v_mfma_f32_16x16x32_bf16 v[60:63], a[204:207], a[40:43], v[60:63]
v_mfma_f32_16x16x32_bf16 v[88:91], a[204:207], a[44:47], v[88:91]
v_lshlrev_b32 v6, 12, v6
s_waitcnt vmcnt(19) lgkmcnt(0)
v_mfma_f32_16x16x32_bf16 v[36:39], a[144:147], a[48:51], v[36:39]
ds_read_b128 a[180:183], v1 offset:50176
buffer_load_dwordx4 v1, s[4:7], s39 offen offset:3072 sc1 lds
v_mfma_f32_16x16x32_bf16 v[64:67], a[144:147], a[52:55], v[64:67]
ds_read_b128 a[184:187], v1 offset:51200
v_lshl_add_u32 v240, v7, 4, v6
v_mfma_f32_16x16x32_bf16 v[40:43], a[148:151], a[48:51], v[40:43]
ds_read_b128 a[188:191], v1 offset:52224
buffer_load_dwordx2 v[114:115], v129, s[8:11], s63 offen sc1
v_mfma_f32_16x16x32_bf16 v[68:71], a[148:151], a[52:55], v[68:71]
ds_read_b128 a[192:195], v1 offset:53248
v_lshlrev_b32 v7, 4, v7
v_mfma_f32_16x16x32_bf16 v[44:47], a[152:155], a[48:51], v[44:47]
ds_read_b128 a[196:199], v1 offset:54272
s_add_u32 m0, m0, 4096
v_mfma_f32_16x16x32_bf16 v[72:75], a[152:155], a[52:55], v[72:75]
ds_read_b128 a[200:203], v1 offset:55296
v_lshl_add_u32 v7, v2, 8, v7
v_mfma_f32_16x16x32_bf16 v[48:51], a[156:159], a[48:51], v[48:51]
ds_read_b128 a[204:207], v1 offset:56320
buffer_load_dwordx4 a[76:79], v237, s[8:11], s62 offen offset:1024 sc1
v_mfma_f32_16x16x32_bf16 v[76:79], a[156:159], a[52:55], v[76:79]
ds_read_b128 a[208:211], v125 offset:50176
v_add_u32 v244, s68, v7
v_mfma_f32_16x16x32_bf16 v[52:55], a[160:163], a[48:51], v[52:55]
ds_read_b128 a[212:215], v126 offset:7168
s_add_u32 s39, s39, 4096
v_mfma_f32_16x16x32_bf16 v[80:83], a[160:163], a[52:55], v[80:83]
v_add_u32 v6, 4, v3
v_xor_b32 v7, v6, v2
v_mfma_f32_16x16x32_bf16 v[92:95], a[172:175], a[176:179], v[92:95]
v_lshlrev_b32 v6, 12, v6
v_mfma_f32_16x16x32_bf16 v[96:99], a[160:163], a[176:179], v[96:99]
buffer_load_dwordx4 a[80:83], v1, s[8:11], s62 offen offset:2048 sc1
v_mfma_f32_16x16x32_bf16 v[56:59], a[164:167], a[48:51], v[56:59]
buffer_load_dwordx4 v1, s[4:7], s39 offen offset:0 sc1 lds
v_lshl_add_u32 v241, v7, 4, v6
v_mfma_f32_16x16x32_bf16 v[84:87], a[164:167], a[52:55], v[84:87]
v_mfma_f32_16x16x32_bf16 v[60:63], a[168:171], a[48:51], v[60:63]
v_lshlrev_b32 v7, 4, v7
v_mfma_f32_16x16x32_bf16 v[88:91], a[168:171], a[52:55], v[88:91]
buffer_load_dwordx4 a[84:87], v237, s[8:11], s62 offen offset:2048 sc1
s_waitcnt vmcnt(23) lgkmcnt(0)
v_mfma_f32_16x16x32_bf16 v[36:39], a[180:183], a[56:59], v[36:39]
ds_read_b128 a[144:147], v1 offset:57344
buffer_load_dwordx4 v1, s[4:7], s39 offen offset:1024 sc1 lds
v_mfma_f32_16x16x32_bf16 v[64:67], a[180:183], a[60:63], v[64:67]
ds_read_b128 a[148:151], v1 offset:58368
v_lshl_add_u32 v7, v2, 8, v7
v_mfma_f32_16x16x32_bf16 v[40:43], a[184:187], a[56:59], v[40:43]
ds_read_b128 a[152:155], v1 offset:59392
v_add_u32 v245, s68, v7
v_mfma_f32_16x16x32_bf16 v[68:71], a[184:187], a[60:63], v[68:71]
ds_read_b128 a[156:159], v1 offset:60416
buffer_load_dwordx4 a[88:91], v1, s[8:11], s62 offen offset:3072 sc1
v_mfma_f32_16x16x32_bf16 v[44:47], a[188:191], a[56:59], v[44:47]
ds_read_b128 a[160:163], v1 offset:61440
buffer_load_dwordx4 v1, s[4:7], s39 offen offset:2048 sc1 lds
v_mfma_f32_16x16x32_bf16 v[72:75], a[188:191], a[60:63], v[72:75]
ds_read_b128 a[164:167], v1 offset:62464
v_subrev_u32 v241, 1024, v241
v_mfma_f32_16x16x32_bf16 v[48:51], a[192:195], a[56:59], v[48:51]
ds_read_b128 a[168:171], v1 offset:63488
v_add_u32 v6, 8, v3
v_mfma_f32_16x16x32_bf16 v[76:79], a[192:195], a[60:63], v[76:79]
ds_read_b128 a[172:175], v125 offset:57344
v_xor_b32 v7, v6, v2
v_mfma_f32_16x16x32_bf16 v[52:55], a[196:199], a[56:59], v[52:55]
ds_read_b128 a[176:179], v126 offset:8192
buffer_load_dwordx4 a[92:95], v237, s[8:11], s62 offen offset:3072 sc1
v_mfma_f32_16x16x32_bf16 v[80:83], a[196:199], a[60:63], v[80:83]
buffer_load_dwordx4 v1, s[4:7], s39 offen offset:3072 sc1 lds
v_lshlrev_b32 v6, 12, v6
v_mfma_f32_16x16x32_bf16 v[92:95], a[208:211], a[212:215], v[92:95]
s_add_u32 s62, s62, 4096
v_lshl_add_u32 v242, v7, 4, v6
v_mfma_f32_16x16x32_bf16 v[96:99], a[196:199], a[212:215], v[96:99]
v_lshlrev_b32 v7, 4, v7
v_mfma_f32_16x16x32_bf16 v[56:59], a[200:203], a[56:59], v[56:59]
buffer_load_dwordx2 v[148:149], v146, s[4:7], s66 offen sc1
v_lshl_add_u32 v7, v2, 8, v7
v_mfma_f32_16x16x32_bf16 v[84:87], a[200:203], a[60:63], v[84:87]
v_mfma_f32_16x16x32_bf16 v[60:63], a[204:207], a[56:59], v[60:63]
v_add_u32 v246, s68, v7
v_mfma_f32_16x16x32_bf16 v[88:91], a[204:207], a[60:63], v[88:91]
s_waitcnt vmcnt(27) lgkmcnt(0)
v_add_u32 v125, 64512, v125
v_mfma_f32_16x16x32_bf16 v[36:39], a[144:147], a[64:67], v[36:39]
ds_read_b128 a[180:183], v8 offset:0
buffer_load_dwordx4 a[96:99], v1, s[8:11], s62 offen offset:0 sc1
v_mfma_f32_16x16x32_bf16 v[64:67], a[144:147], a[68:71], v[64:67]
ds_read_b128 a[184:187], v8 offset:1024
v_subrev_u32 v242, 2048, v242
v_mfma_f32_16x16x32_bf16 v[40:43], a[148:151], a[64:67], v[40:43]
ds_read_b128 a[188:191], v8 offset:2048
v_add_u32 v6, 12, v3
v_mfma_f32_16x16x32_bf16 v[68:71], a[148:151], a[68:71], v[68:71]
ds_read_b128 a[192:195], v8 offset:3072
v_xor_b32 v7, v6, v2
v_mfma_f32_16x16x32_bf16 v[44:47], a[152:155], a[64:67], v[44:47]
ds_read_b128 a[196:199], v8 offset:4096
buffer_load_dwordx4 a[100:103], v237, s[8:11], s62 offen offset:0 sc1
v_mfma_f32_16x16x32_bf16 v[72:75], a[152:155], a[68:71], v[72:75]
ds_read_b128 a[200:203], v8 offset:5120
v_lshlrev_b32 v6, 12, v6
v_mfma_f32_16x16x32_bf16 v[48:51], a[156:159], a[64:67], v[48:51]
ds_read_b128 a[204:207], v8 offset:6144
v_lshl_add_u32 v243, v7, 4, v6
v_mfma_f32_16x16x32_bf16 v[76:79], a[156:159], a[68:71], v[76:79]
ds_read_b128 a[208:211], v125 offset:0
v_mfma_f32_16x16x32_bf16 v[52:55], a[160:163], a[64:67], v[52:55]
ds_read_b128 a[212:215], v126 offset:9216
v_lshlrev_b32 v7, 4, v7
v_mfma_f32_16x16x32_bf16 v[80:83], a[160:163], a[68:71], v[80:83]
buffer_load_dwordx4 a[104:107], v1, s[8:11], s62 offen offset:1024 sc1
v_mfma_f32_16x16x32_bf16 v[92:95], a[172:175], a[176:179], v[92:95]
v_lshl_add_u32 v7, v2, 8, v7
v_mfma_f32_16x16x32_bf16 v[96:99], a[160:163], a[176:179], v[96:99]
v_add_u32 v247, s68, v7
v_mfma_f32_16x16x32_bf16 v[56:59], a[164:167], a[64:67], v[56:59]
v_mfma_f32_16x16x32_bf16 v[84:87], a[164:167], a[68:71], v[84:87]
buffer_load_dwordx4 a[108:111], v237, s[8:11], s62 offen offset:1024 sc1
v_subrev_u32 v243, 3072, v243
v_mfma_f32_16x16x32_bf16 v[60:63], a[168:171], a[64:67], v[60:63]
v_mfma_f32_16x16x32_bf16 v[88:91], a[168:171], a[68:71], v[88:91]
s_waitcnt vmcnt(13) lgkmcnt(0)
v_mfma_f32_16x16x32_bf16 v[36:39], a[180:183], a[72:75], v[36:39]
ds_read_b128 a[144:147], v8 offset:7168
v_mfma_f32_16x16x32_bf16 v[64:67], a[180:183], a[76:79], v[64:67]
ds_read_b128 a[148:151], v8 offset:8192
buffer_load_dwordx4 a[112:115], v1, s[8:11], s62 offen offset:2048 sc1
v_mfma_f32_16x16x32_bf16 v[40:43], a[184:187], a[72:75], v[40:43]
ds_read_b128 a[152:155], v8 offset:9216
v_add_f32 v130, v100, v102
v_mfma_f32_16x16x32_bf16 v[68:71], a[184:187], a[76:79], v[68:71]
ds_read_b128 a[156:159], v8 offset:10240
v_add_f32 v131, v101, v103
v_mfma_f32_16x16x32_bf16 v[44:47], a[188:191], a[72:75], v[44:47]
ds_read_b128 a[160:163], v8 offset:11264
v_add_f32 v130, v130, v104
v_mfma_f32_16x16x32_bf16 v[72:75], a[188:191], a[76:79], v[72:75]
ds_read_b128 a[164:167], v8 offset:12288
v_add_f32 v131, v131, v105
v_mfma_f32_16x16x32_bf16 v[48:51], a[192:195], a[72:75], v[48:51]
ds_read_b128 a[168:171], v8 offset:13312
buffer_load_dwordx4 a[116:119], v237, s[8:11], s62 offen offset:2048 sc1
v_mfma_f32_16x16x32_bf16 v[76:79], a[192:195], a[76:79], v[76:79]
ds_read_b128 a[172:175], v125 offset:7168
v_add_f32 v130, v130, v106
v_mfma_f32_16x16x32_bf16 v[52:55], a[196:199], a[72:75], v[52:55]
ds_read_b128 a[176:179], v126 offset:10240
v_add_f32 v131, v131, v107
v_mfma_f32_16x16x32_bf16 v[80:83], a[196:199], a[76:79], v[80:83]
v_add_f32 v130, v130, v108
v_add_f32 v131, v131, v109
v_mfma_f32_16x16x32_bf16 v[92:95], a[208:211], a[212:215], v[92:95]
buffer_load_dwordx4 a[120:123], v1, s[8:11], s62 offen offset:3072 sc1
v_add_f32 v130, v130, v110
v_mfma_f32_16x16x32_bf16 v[96:99], a[196:199], a[212:215], v[96:99]
v_add_f32 v131, v131, v111
v_mfma_f32_16x16x32_bf16 v[56:59], a[200:203], a[72:75], v[56:59]
v_add_f32 v130, v130, v112
v_mfma_f32_16x16x32_bf16 v[84:87], a[200:203], a[76:79], v[84:87]
v_add_f32 v131, v131, v113
v_mfma_f32_16x16x32_bf16 v[60:63], a[204:207], a[72:75], v[60:63]
buffer_load_dwordx4 a[124:127], v237, s[8:11], s62 offen offset:3072 sc1
v_add_f32 v130, v130, v114
v_mfma_f32_16x16x32_bf16 v[88:91], a[204:207], a[76:79], v[88:91]
s_add_u32 s62, s62, 4096
v_add_f32 v131, v131, v115
s_waitcnt vmcnt(14) lgkmcnt(0)
v_mfma_f32_16x16x32_bf16 v[36:39], a[144:147], a[80:83], v[36:39]
ds_read_b128 a[180:183], v8 offset:14336
v_mul_f32 v130, 0x3ae38e39, v130
v_mfma_f32_16x16x32_bf16 v[64:67], a[144:147], a[84:87], v[64:67]
ds_read_b128 a[184:187], v8 offset:15360
v_mul_f32 v6, v130, v130
v_mfma_f32_16x16x32_bf16 v[40:43], a[148:151], a[80:83], v[40:43]
ds_read_b128 a[188:191], v8 offset:16384
v_mul_f32 v131, 0x3ae38e39, v131
v_mfma_f32_16x16x32_bf16 v[68:71], a[148:151], a[84:87], v[68:71]
ds_read_b128 a[192:195], v8 offset:17408
v_mfma_f32_16x16x32_bf16 v[44:47], a[152:155], a[80:83], v[44:47]
ds_read_b128 a[196:199], v8 offset:18432
v_sub_f32 v131, v131, v6
v_mfma_f32_16x16x32_bf16 v[72:75], a[152:155], a[84:87], v[72:75]
ds_read_b128 a[200:203], v8 offset:19456
v_max_f32 v131, 0, v131
v_mfma_f32_16x16x32_bf16 v[48:51], a[156:159], a[80:83], v[48:51]
ds_read_b128 a[204:207], v8 offset:20480
v_add_f32 v131, 0x3727c5ac, v131
v_mfma_f32_16x16x32_bf16 v[76:79], a[156:159], a[84:87], v[76:79]
ds_read_b128 a[208:211], v125 offset:14336
buffer_load_dwordx4 a[128:131], v1, s[8:11], s62 offen offset:0 sc1
v_mfma_f32_16x16x32_bf16 v[52:55], a[160:163], a[80:83], v[52:55]
ds_read_b128 a[212:215], v126 offset:11264
v_mfma_f32_16x16x32_bf16 v[80:83], a[160:163], a[84:87], v[80:83]
v_rsq_f32 v132, v131
v_mfma_f32_16x16x32_bf16 v[92:95], a[172:175], a[176:179], v[92:95]
v_cvt_pk_bf16_f32 v6, -v130, -v130
v_and_b32 v6, 0xffff0000, v6
v_mfma_f32_16x16x32_bf16 v[96:99], a[160:163], a[176:179], v[96:99]
buffer_load_dwordx4 a[132:135], v237, s[8:11], s62 offen offset:0 sc1
v_add_f32 v6, v130, v6
v_mfma_f32_16x16x32_bf16 v[56:59], a[164:167], a[80:83], v[56:59]
v_cvt_pk_bf16_f32 v133, -v130, -v6
v_mfma_f32_16x16x32_bf16 v[84:87], a[164:167], a[84:87], v[84:87]
v_mfma_f32_16x16x32_bf16 v[60:63], a[168:171], a[80:83], v[60:63]
v_mfma_f32_16x16x32_bf16 v[88:91], a[168:171], a[84:87], v[88:91]
s_waitcnt vmcnt(10) lgkmcnt(0)
v_cmp_ne_u64 vcc, v[148:149], v[238:239]
s_cmp_eq_u32 s29, 0
s_cselect_b64 vcc, vcc, 0
s_cbranch_vccnz L_dbslow_11
L_dbback_12:
s_barrier
v_mfma_f32_16x16x32_bf16 v[36:39], a[180:183], a[88:91], v[36:39]
ds_read_b128 a[144:147], v8 offset:21504
buffer_load_dwordx4 a[136:139], v1, s[8:11], s62 offen offset:1024 sc1
v_mfma_f32_16x16x32_bf16 v[64:67], a[180:183], a[92:95], v[64:67]
ds_read_b128 a[148:151], v8 offset:22528
v_mfma_f32_16x16x32_bf16 v[40:43], a[184:187], a[88:91], v[40:43]
ds_read_b128 a[152:155], v8 offset:23552
s_add_u32 m0, s68, 0
v_mfma_f32_16x16x32_bf16 v[68:71], a[184:187], a[92:95], v[68:71]
ds_read_b128 a[156:159], v8 offset:24576
v_mfma_f32_16x16x32_bf16 v[44:47], a[188:191], a[88:91], v[44:47]
ds_read_b128 a[160:163], v8 offset:25600
buffer_load_dwordx4 a[140:143], v237, s[8:11], s62 offen offset:1024 sc1
v_mfma_f32_16x16x32_bf16 v[72:75], a[188:191], a[92:95], v[72:75]
ds_read_b128 a[164:167], v8 offset:26624
s_add_u32 s3, s3, 0
v_mfma_f32_16x16x32_bf16 v[48:51], a[192:195], a[88:91], v[48:51]
ds_read_b128 a[168:171], v8 offset:27648
v_mfma_f32_16x16x32_bf16 v[76:79], a[192:195], a[92:95], v[76:79]
ds_read_b128 a[172:175], v125 offset:21504
buffer_load_dwordx4 v240, s[12:15], s3 offen offset:0 nt lds
v_mfma_f32_16x16x32_bf16 v[52:55], a[196:199], a[88:91], v[52:55]
ds_read_b128 a[176:179], v126 offset:12288
s_mov_b32 s37, L_c2-L_pc
v_mfma_f32_16x16x32_bf16 v[80:83], a[196:199], a[92:95], v[80:83]
ds_bpermute_b32 v116, v124, v133 offset:128
v_mfma_f32_16x16x32_bf16 v[92:95], a[208:211], a[212:215], v[92:95]
ds_bpermute_b32 v118, v124, v133 offset:192
buffer_load_dwordx4 v241, s[12:15], s3 offen offset:1024 nt lds
v_mfma_f32_16x16x32_bf16 v[96:99], a[196:199], a[212:215], v[96:99]
ds_bpermute_b32 v120, v124, v133
v_mfma_f32_16x16x32_bf16 v[56:59], a[200:203], a[88:91], v[56:59]
buffer_load_dword v15, v14, s[88:91], s37 offen
ds_bpermute_b32 v134, v124, v132 offset:128
v_mfma_f32_16x16x32_bf16 v[84:87], a[200:203], a[92:95], v[84:87]
ds_bpermute_b32 v135, v124, v132 offset:192
buffer_load_dwordx4 v242, s[12:15], s3 offen offset:2048 nt lds
v_mfma_f32_16x16x32_bf16 v[60:63], a[204:207], a[88:91], v[60:63]
v_mfma_f32_16x16x32_bf16 v[88:91], a[204:207], a[92:95], v[88:91]
buffer_load_dwordx4 v243, s[12:15], s3 offen offset:3072 nt lds
s_waitcnt vmcnt(15) lgkmcnt(0)
v_mfma_f32_16x16x32_bf16 v[36:39], a[144:147], a[96:99], v[36:39]
ds_read_b128 a[180:183], v8 offset:28672
v_mfma_f32_16x16x32_bf16 v[64:67], a[144:147], a[100:103], v[64:67]
ds_read_b128 a[184:187], v8 offset:29696
v_mfma_f32_16x16x32_bf16 v[40:43], a[148:151], a[96:99], v[40:43]
ds_read_b128 a[188:191], v8 offset:30720
s_add_u32 m0, s68, 4096
v_mfma_f32_16x16x32_bf16 v[68:71], a[148:151], a[100:103], v[68:71]
ds_read_b128 a[192:195], v8 offset:31744
v_mfma_f32_16x16x32_bf16 v[44:47], a[152:155], a[96:99], v[44:47]
ds_read_b128 a[196:199], v8 offset:32768
s_add_u32 s3, s3, 65536
v_mfma_f32_16x16x32_bf16 v[72:75], a[152:155], a[100:103], v[72:75]
ds_read_b128 a[200:203], v8 offset:33792
v_mfma_f32_16x16x32_bf16 v[48:51], a[156:159], a[96:99], v[48:51]
ds_read_b128 a[204:207], v8 offset:34816
v_mfma_f32_16x16x32_bf16 v[76:79], a[156:159], a[100:103], v[76:79]
ds_read_b128 a[208:211], v125 offset:28672
buffer_load_dwordx4 v240, s[12:15], s3 offen offset:0 nt lds
v_mfma_f32_16x16x32_bf16 v[52:55], a[160:163], a[96:99], v[52:55]
ds_read_b128 a[212:215], v126 offset:13312
v_mfma_f32_16x16x32_bf16 v[80:83], a[160:163], a[100:103], v[80:83]
ds_bpermute_b32 v136, v122, v132 offset:0
v_mfma_f32_16x16x32_bf16 v[92:95], a[172:175], a[176:179], v[92:95]
ds_bpermute_b32 v137, v123, v132 offset:0
buffer_load_dwordx4 v241, s[12:15], s3 offen offset:1024 nt lds
v_mfma_f32_16x16x32_bf16 v[96:99], a[160:163], a[176:179], v[96:99]
ds_bpermute_b32 v138, v122, v132 offset:64
v_mfma_f32_16x16x32_bf16 v[56:59], a[164:167], a[96:99], v[56:59]
ds_bpermute_b32 v139, v123, v132 offset:64
buffer_load_dwordx4 v242, s[12:15], s3 offen offset:2048 nt lds
v_mfma_f32_16x16x32_bf16 v[84:87], a[164:167], a[100:103], v[84:87]
v_mfma_f32_16x16x32_bf16 v[60:63], a[168:171], a[96:99], v[60:63]
v_mfma_f32_16x16x32_bf16 v[88:91], a[168:171], a[100:103], v[88:91]
buffer_load_dwordx4 v243, s[12:15], s3 offen offset:3072 nt lds
s_waitcnt vmcnt(17) lgkmcnt(0)
v_mfma_f32_16x16x32_bf16 v[36:39], a[180:183], a[104:107], v[36:39]
ds_read_b128 a[144:147], v8 offset:35840
v_mov_b32 v117, v116
v_mfma_f32_16x16x32_bf16 v[64:67], a[180:183], a[108:111], v[64:67]
ds_read_b128 a[148:151], v8 offset:36864
v_mov_b32 v119, v118
v_mfma_f32_16x16x32_bf16 v[40:43], a[184:187], a[104:107], v[40:43]
ds_read_b128 a[152:155], v8 offset:37888
s_mov_b32 s3, 1073741824
v_mfma_f32_16x16x32_bf16 v[68:71], a[184:187], a[108:111], v[68:71]
ds_read_b128 a[156:159], v8 offset:38912
v_mov_b32 v121, v120
v_mfma_f32_16x16x32_bf16 v[44:47], a[188:191], a[104:107], v[44:47]
ds_read_b128 a[160:163], v8 offset:39936
v_mul_f32 v134, 0x3eae1a93, v134
v_mfma_f32_16x16x32_bf16 v[72:75], a[188:191], a[108:111], v[72:75]
ds_read_b128 a[164:167], v8 offset:40960
s_mul_i32 s36, s28, 82944
v_mfma_f32_16x16x32_bf16 v[48:51], a[192:195], a[104:107], v[48:51]
ds_read_b128 a[168:171], v8 offset:41984
v_mul_f32 v135, 0x3eae1a93, v135
v_mfma_f32_16x16x32_bf16 v[76:79], a[192:195], a[108:111], v[76:79]
ds_read_b128 a[172:175], v125 offset:35840
v_mfma_f32_16x16x32_bf16 v[52:55], a[196:199], a[104:107], v[52:55]
ds_read_b128 a[176:179], v126 offset:14336
s_mul_i32 s38, s24, 8192
v_mfma_f32_16x16x32_bf16 v[80:83], a[196:199], a[108:111], v[80:83]
ds_read_b64 a[0:1], v127 offset:0
v_mul_f32 v140, v134, v136
v_mfma_f32_16x16x32_bf16 v[92:95], a[208:211], a[212:215], v[92:95]
ds_read_b64 a[2:3], v127 offset:512
v_mul_f32 v141, v134, v137
v_mfma_f32_16x16x32_bf16 v[96:99], a[196:199], a[212:215], v[96:99]
s_add_u32 m0, s38, 37888
v_mul_f32 v142, v135, v138
v_mfma_f32_16x16x32_bf16 v[56:59], a[200:203], a[104:107], v[56:59]
ds_read_b64 a[4:5], v127 offset:1024
v_mfma_f32_16x16x32_bf16 v[84:87], a[200:203], a[108:111], v[84:87]
ds_read_b64 a[6:7], v127 offset:1536
v_mul_f32 v143, v135, v139
v_mfma_f32_16x16x32_bf16 v[60:63], a[204:207], a[104:107], v[60:63]
s_cmp_eq_u32 s60, 0
s_cselect_b32 s30, 0xf149f2ca, 0
v_mfma_f32_16x16x32_bf16 v[88:91], a[204:207], a[108:111], v[88:91]
s_add_u32 s39, s38, s36
s_waitcnt vmcnt(15) lgkmcnt(0)
v_mfma_f32_16x16x32_bf16 v[36:39], a[144:147], a[112:115], v[36:39]
ds_read_b128 a[180:183], v8 offset:43008
v_mfma_f32_16x16x32_bf16 v[64:67], a[144:147], a[116:119], v[64:67]
ds_read_b128 a[184:187], v8 offset:44032
v_mfma_f32_16x16x32_bf16 v[40:43], a[148:151], a[112:115], v[40:43]
ds_read_b128 a[188:191], v8 offset:45056
v_mov_b32 v6, s30
v_mfma_f32_16x16x32_bf16 v[68:71], a[148:151], a[116:119], v[68:71]
ds_read_b128 a[192:195], v8 offset:46080
v_cndmask_b32 v144, v6, 0, s[42:43]
v_mfma_f32_16x16x32_bf16 v[44:47], a[152:155], a[112:115], v[44:47]
ds_read_b128 a[196:199], v8 offset:47104
s_add_u32 s39, s39, 2121728
v_mfma_f32_16x16x32_bf16 v[72:75], a[152:155], a[116:119], v[72:75]
ds_read_b128 a[200:203], v8 offset:48128
v_cndmask_b32 v145, v6, 0, s[44:45]
v_mfma_f32_16x16x32_bf16 v[48:51], a[156:159], a[112:115], v[48:51]
ds_read_b128 a[204:207], v8 offset:49152
v_mfma_f32_16x16x32_bf16 v[76:79], a[156:159], a[116:119], v[76:79]
ds_read_b128 a[208:211], v125 offset:43008
v_mov_b32 v100, v136
v_mfma_f32_16x16x32_bf16 v[52:55], a[160:163], a[112:115], v[52:55]
ds_read_b128 a[212:215], v126 offset:15360
buffer_load_dwordx4 v1, s[4:7], s39 offen offset:0 sc1 lds
v_mfma_f32_16x16x32_bf16 v[80:83], a[160:163], a[116:119], v[80:83]
ds_read_b64 a[8:9], v127 offset:2048
v_mov_b32 v104, v138
v_mfma_f32_16x16x32_bf16 v[92:95], a[172:175], a[176:179], v[92:95]
ds_read_b64 a[10:11], v127 offset:2560
v_mov_b32 v102, v136
v_mfma_f32_16x16x32_bf16 v[96:99], a[160:163], a[176:179], v[96:99]
v_mfma_f32_16x16x32_bf16 v[56:59], a[164:167], a[112:115], v[56:59]
ds_read_b64 a[12:13], v127 offset:3072
buffer_load_dwordx4 v1, s[4:7], s39 offen offset:1024 sc1 lds
v_mfma_f32_16x16x32_bf16 v[84:87], a[164:167], a[116:119], v[84:87]
ds_read_b64 a[14:15], v128
v_mov_b32 v106, v138
v_mfma_f32_16x16x32_bf16 v[60:63], a[168:171], a[112:115], v[60:63]
v_mov_b32 v101, v137
v_mfma_f32_16x16x32_bf16 v[88:91], a[168:171], a[116:119], v[88:91]
v_mov_b32 v105, v139
s_waitcnt vmcnt(15) lgkmcnt(0)
v_mfma_f32_16x16x32_bf16 v[36:39], a[180:183], a[120:123], v[36:39]
ds_read_b128 a[144:147], v8 offset:50176
buffer_load_dwordx4 v1, s[4:7], s39 offen offset:2048 sc1 lds
v_mfma_f32_16x16x32_bf16 v[64:67], a[180:183], a[124:127], v[64:67]
ds_read_b128 a[148:151], v8 offset:51200
v_mov_b32 v103, v137
v_mfma_f32_16x16x32_bf16 v[40:43], a[184:187], a[120:123], v[40:43]
ds_read_b128 a[152:155], v8 offset:52224
v_mov_b32 v107, v139
v_mfma_f32_16x16x32_bf16 v[68:71], a[184:187], a[124:127], v[68:71]
ds_read_b128 a[156:159], v8 offset:53248
buffer_load_dwordx4 v1, s[4:7], s39 offen offset:3072 sc1 lds
v_mfma_f32_16x16x32_bf16 v[44:47], a[188:191], a[120:123], v[44:47]
ds_read_b128 a[160:163], v8 offset:54272
v_mfma_f32_16x16x32_bf16 v[72:75], a[188:191], a[124:127], v[72:75]
ds_read_b128 a[164:167], v8 offset:55296
v_mfma_f32_16x16x32_bf16 v[48:51], a[192:195], a[120:123], v[48:51]
ds_read_b128 a[168:171], v8 offset:56320
v_mfma_f32_16x16x32_bf16 v[76:79], a[192:195], a[124:127], v[76:79]
ds_read_b128 a[172:175], v125 offset:50176
s_add_u32 m0, m0, 4096
v_mfma_f32_16x16x32_bf16 v[52:55], a[196:199], a[120:123], v[52:55]
ds_read_b128 a[176:179], v126 offset:16384
s_waitcnt vmcnt(8)
v_mfma_f32_16x16x32_bf16 v[80:83], a[196:199], a[124:127], v[80:83]
ds_read_b128 a[224:227], v244 offset:0
v_mfma_f32_16x16x32_bf16 v[92:95], a[208:211], a[212:215], v[92:95]
ds_read_b128 a[228:231], v245 offset:0
v_mfma_f32_16x16x32_bf16 v[96:99], a[196:199], a[212:215], v[96:99]
s_add_u32 s39, s39, 4096
v_permlane32_swap_b32 v100, v104
v_mfma_f32_16x16x32_bf16 v[56:59], a[200:203], a[120:123], v[56:59]
ds_read_b128 a[232:235], v246 offset:0
v_mfma_f32_16x16x32_bf16 v[84:87], a[200:203], a[124:127], v[84:87]
ds_read_b128 a[236:239], v247 offset:0
v_mfma_f32_16x16x32_bf16 v[60:63], a[204:207], a[120:123], v[60:63]
v_permlane32_swap_b32 v102, v106
v_mfma_f32_16x16x32_bf16 v[88:91], a[204:207], a[124:127], v[88:91]
buffer_load_dwordx4 v1, s[4:7], s39 offen offset:0 sc1 lds
s_waitcnt lgkmcnt(0)
v_mfma_f32_16x16x32_bf16 v[36:39], a[144:147], a[128:131], v[36:39]
ds_read_b128 a[180:183], v8 offset:57344
v_mfma_f32_16x16x32_bf16 v[64:67], a[144:147], a[132:135], v[64:67]
ds_read_b128 a[184:187], v8 offset:58368
v_mfma_f32_16x16x32_bf16 v[40:43], a[148:151], a[128:131], v[40:43]
ds_read_b128 a[188:191], v8 offset:59392
v_mfma_f32_16x16x32_bf16 v[68:71], a[148:151], a[132:135], v[68:71]
ds_read_b128 a[192:195], v8 offset:60416
buffer_load_dwordx4 v1, s[4:7], s39 offen offset:1024 sc1 lds
v_mfma_f32_16x16x32_bf16 v[44:47], a[152:155], a[128:131], v[44:47]
ds_read_b128 a[196:199], v8 offset:61440
v_mfma_f32_16x16x32_bf16 v[72:75], a[152:155], a[132:135], v[72:75]
ds_read_b128 a[200:203], v8 offset:62464
v_mfma_f32_16x16x32_bf16 v[48:51], a[156:159], a[128:131], v[48:51]
ds_read_b128 a[204:207], v8 offset:63488
v_mfma_f32_16x16x32_bf16 v[76:79], a[156:159], a[132:135], v[76:79]
ds_read_b128 a[208:211], v125 offset:57344
buffer_load_dwordx4 v1, s[4:7], s39 offen offset:2048 sc1 lds
v_mfma_f32_16x16x32_bf16 v[52:55], a[160:163], a[128:131], v[52:55]
ds_read_b128 a[212:215], v126 offset:17408
s_waitcnt vmcnt(7)
v_mfma_f32_16x16x32_bf16 v[80:83], a[160:163], a[132:135], v[80:83]
ds_read_b128 a[240:243], v244 offset:4096
v_mfma_f32_16x16x32_bf16 v[92:95], a[172:175], a[176:179], v[92:95]
ds_read_b128 a[244:247], v245 offset:4096
v_mfma_f32_16x16x32_bf16 v[96:99], a[160:163], a[176:179], v[96:99]
ds_read_b128 a[248:251], v246 offset:4096
buffer_load_dwordx4 v1, s[4:7], s39 offen offset:3072 sc1 lds
v_mfma_f32_16x16x32_bf16 v[56:59], a[164:167], a[128:131], v[56:59]
ds_read_b128 a[252:255], v247 offset:4096
v_mfma_f32_16x16x32_bf16 v[84:87], a[164:167], a[132:135], v[84:87]
v_permlane32_swap_b32 v101, v105
v_mfma_f32_16x16x32_bf16 v[60:63], a[168:171], a[128:131], v[60:63]
v_permlane32_swap_b32 v103, v107
v_permlane16_swap_b32 v100, v102
v_permlane16_swap_b32 v104, v106
v_permlane16_swap_b32 v101, v103
v_permlane16_swap_b32 v105, v107
v_mfma_f32_16x16x32_bf16 v[88:91], a[168:171], a[132:135], v[88:91]
s_waitcnt lgkmcnt(0)
s_barrier
v_mfma_f32_16x16x32_bf16 v[36:39], a[180:183], a[136:139], v[36:39]
v_mfma_f32_16x16x32_bf16 v[64:67], a[180:183], a[140:143], v[64:67]
v_mfma_f32_16x16x16_bf16 v[36:39], a[0:1], v[116:117], v[36:39]
v_mfma_f32_16x16x16_bf16 v[64:67], a[0:1], v[118:119], v[64:67]
v_mfma_f32_16x16x32_bf16 v[40:43], a[184:187], a[136:139], v[40:43]
v_mfma_f32_16x16x32_bf16 v[68:71], a[184:187], a[140:143], v[68:71]
s_nop 1
v_mfma_f32_16x16x16_bf16 v[40:43], a[2:3], v[116:117], v[40:43]
s_nop 1
v_mfma_f32_16x16x16_bf16 v[68:71], a[2:3], v[118:119], v[68:71]
v_cvt_pk_bf16_f32 v156, v36, v37
v_cvt_pk_bf16_f32 v157, v38, v39
v_mfma_f32_16x16x32_bf16 v[44:47], a[188:191], a[136:139], v[44:47]
ds_write_b64 v218, v[156:157] offset:2816
v_mfma_f32_16x16x32_bf16 v[72:75], a[188:191], a[140:143], v[72:75]
v_cvt_pk_bf16_f32 v162, v64, v65
v_cvt_pk_bf16_f32 v163, v66, v67
v_mfma_f32_16x16x16_bf16 v[44:47], a[4:5], v[116:117], v[44:47]
ds_write_b64 v218, v[162:163] offset:5632
v_mfma_f32_16x16x16_bf16 v[72:75], a[4:5], v[118:119], v[72:75]
v_cvt_pk_bf16_f32 v160, v40, v41
v_cvt_pk_bf16_f32 v161, v42, v43
v_mfma_f32_16x16x32_bf16 v[48:51], a[192:195], a[136:139], v[48:51]
ds_write_b64 v218, v[160:161] offset:2848
v_mfma_f32_16x16x32_bf16 v[76:79], a[192:195], a[140:143], v[76:79]
v_cvt_pk_bf16_f32 v166, v68, v69
v_cvt_pk_bf16_f32 v167, v70, v71
v_mfma_f32_16x16x16_bf16 v[48:51], a[6:7], v[116:117], v[48:51]
ds_write_b64 v218, v[166:167] offset:5664
v_mfma_f32_16x16x16_bf16 v[76:79], a[6:7], v[118:119], v[76:79]
v_cvt_pk_bf16_f32 v202, v44, v45
v_cvt_pk_bf16_f32 v203, v46, v47
v_mfma_f32_16x16x32_bf16 v[52:55], a[196:199], a[136:139], v[52:55]
ds_write_b64 v218, v[202:203] offset:2880
v_mfma_f32_16x16x32_bf16 v[80:83], a[196:199], a[140:143], v[80:83]
v_cvt_pk_bf16_f32 v204, v72, v73
v_cvt_pk_bf16_f32 v205, v74, v75
v_mfma_f32_16x16x16_bf16 v[52:55], a[8:9], v[116:117], v[52:55]
ds_write_b64 v218, v[204:205] offset:5696
v_mfma_f32_16x16x16_bf16 v[80:83], a[8:9], v[118:119], v[80:83]
v_cvt_pk_bf16_f32 v206, v48, v49
v_cvt_pk_bf16_f32 v207, v50, v51
v_mfma_f32_16x16x32_bf16 v[92:95], a[208:211], a[212:215], v[92:95]
ds_write_b64 v218, v[206:207] offset:2912
v_mfma_f32_16x16x32_bf16 v[96:99], a[196:199], a[212:215], v[96:99]
v_cvt_pk_bf16_f32 v208, v76, v77
v_cvt_pk_bf16_f32 v209, v78, v79
v_mfma_f32_16x16x16_bf16 v[92:95], a[14:15], v[120:121], v[92:95]
ds_write_b64 v218, v[208:209] offset:5728
v_mfma_f32_16x16x16_bf16 v[96:99], a[8:9], v[120:121], v[96:99]
v_cvt_pk_bf16_f32 v210, v52, v53
v_cvt_pk_bf16_f32 v211, v54, v55
v_mfma_f32_16x16x32_bf16 v[56:59], a[200:203], a[136:139], v[56:59]
ds_write_b64 v218, v[210:211] offset:2944
v_mfma_f32_16x16x32_bf16 v[84:87], a[200:203], a[140:143], v[84:87]
v_cvt_pk_bf16_f32 v212, v80, v81
v_cvt_pk_bf16_f32 v213, v82, v83
v_mfma_f32_16x16x16_bf16 v[56:59], a[10:11], v[116:117], v[56:59]
ds_write_b64 v218, v[212:213] offset:5760
v_mfma_f32_16x16x16_bf16 v[84:87], a[10:11], v[118:119], v[84:87]
v_cvt_pk_bf16_f32 v214, v92, v93
v_cvt_pk_bf16_f32 v215, v94, v95
v_mfma_f32_16x16x32_bf16 v[60:63], a[204:207], a[136:139], v[60:63]
ds_write_b64 v222, v[214:215]
v_mfma_f32_16x16x32_bf16 v[88:91], a[204:207], a[140:143], v[88:91]
v_cvt_pk_bf16_f32 v216, v96, v97
v_cvt_pk_bf16_f32 v217, v98, v99
v_mfma_f32_16x16x16_bf16 v[60:63], a[12:13], v[116:117], v[60:63]
ds_write_b64 v219, v[216:217] offset:128
v_mfma_f32_16x16x16_bf16 v[88:91], a[12:13], v[118:119], v[88:91]
s_waitcnt lgkmcnt(0)
s_barrier
ds_read_b64 v[150:151], v218
ds_read_b64 v[154:155], v218 offset:32
ds_read_b64 v[152:153], v220 offset:136
ds_read_b64 v[158:159], v220 offset:2952
ds_read_b64 v[164:165], v220 offset:5768
s_mul_i32 s36, s28, 82944
s_mul_i32 s38, s24, 13312
s_add_u32 m0, s38, 70656
s_add_u32 s39, s38, s36
s_nop 0
s_add_u32 s39, s39, 2154496
buffer_load_dwordx4 v1, s[4:7], s39 offen offset:0 sc1 lds
buffer_load_dwordx4 v1, s[4:7], s39 offen offset:1024 sc1 lds
v_cndmask_b32 v170, 0, v210, s[48:49]
v_cndmask_b32 v173, 0, v211, s[48:49]
v_cndmask_b32 v178, 0, v212, s[48:49]
v_cndmask_b32 v181, 0, v213, s[48:49]
v_cvt_pk_bf16_f32 v168, v56, v57
v_cvt_pk_bf16_f32 v169, v58, v59
v_cvt_pk_bf16_f32 v176, v84, v85
v_cvt_pk_bf16_f32 v177, v86, v87
v_cvt_pk_bf16_f32 v174, v60, v61
v_cvt_pk_bf16_f32 v175, v62, v63
v_cvt_pk_bf16_f32 v182, v88, v89
v_cvt_pk_bf16_f32 v183, v90, v91
s_waitcnt lgkmcnt(0)
s_nop 0
ds_read_b64_tr_b16 v[184:185], v221 offset:64
v_mfma_f32_16x16x32_bf16 v[36:39], v[150:153], v[168:171], 0
ds_read_b64_tr_b16 v[186:187], v221 offset:2880
v_mfma_f32_16x16x32_bf16 v[40:43], v[156:159], v[168:171], 0
ds_read_b64_tr_b16 v[188:189], v221 offset:5696
buffer_load_dwordx4 v1, s[4:7], s39 offen offset:2048 sc1 lds
v_mfma_f32_16x16x32_bf16 v[44:47], v[152:155], v[172:175], 0
ds_read_b64_tr_b16 v[190:191], v221 offset:96
v_mfma_f32_16x16x32_bf16 v[48:51], v[158:161], v[172:175], 0
ds_read_b64_tr_b16 v[192:193], v221 offset:2912
buffer_load_dwordx4 v1, s[4:7], s39 offen offset:3072 sc1 lds
v_mfma_f32_16x16x32_bf16 v[52:55], v[156:159], v[176:179], 0
ds_read_b64_tr_b16 v[194:195], v221 offset:5728
v_mfma_f32_16x16x32_bf16 v[56:59], v[162:165], v[176:179], 0
ds_read_b64_tr_b16 v[196:197], v221 offset:128
s_add_u32 m0, m0, 4096
s_add_u32 s39, s39, 4096
buffer_load_dwordx4 v1, s[4:7], s39 offen offset:0 sc1 lds
v_mfma_f32_16x16x32_bf16 v[60:63], v[158:161], v[180:183], 0
ds_read_b64_tr_b16 v[198:199], v221 offset:2944
v_mfma_f32_16x16x32_bf16 v[64:67], v[164:167], v[180:183], 0
ds_read_b64_tr_b16 v[200:201], v221 offset:5760
buffer_load_dwordx4 v1, s[4:7], s39 offen offset:1024 sc1 lds
v_cndmask_b32 v36, v36, v37, s[40:41]
v_cndmask_b32 v40, v40, v41, s[40:41]
v_cndmask_b32 v68, v36, v40, s[42:43]
v_cndmask_b32 v38, v38, v39, s[40:41]
v_cndmask_b32 v42, v42, v43, s[40:41]
v_cndmask_b32 v69, v38, v42, s[44:45]
v_cndmask_b32 v44, v44, v45, s[40:41]
v_cndmask_b32 v48, v48, v49, s[40:41]
buffer_load_dwordx4 v1, s[4:7], s39 offen offset:2048 sc1 lds
buffer_load_dwordx4 v1, s[4:7], s39 offen offset:3072 sc1 lds
v_cndmask_b32 v70, v44, v48, s[42:43]
v_cndmask_b32 v46, v46, v47, s[40:41]
v_cndmask_b32 v50, v50, v51, s[40:41]
v_cndmask_b32 v71, v46, v50, s[44:45]
v_cndmask_b32 v52, v52, v53, s[40:41]
v_cndmask_b32 v56, v56, v57, s[40:41]
v_cndmask_b32 v72, v52, v56, s[42:43]
s_add_u32 m0, m0, 4096
v_cndmask_b32 v54, v54, v55, s[40:41]
v_cndmask_b32 v58, v58, v59, s[40:41]
v_cndmask_b32 v73, v54, v58, s[44:45]
v_cndmask_b32 v60, v60, v61, s[40:41]
v_cndmask_b32 v64, v64, v65, s[40:41]
v_cndmask_b32 v74, v60, v64, s[42:43]
v_cndmask_b32 v62, v62, v63, s[40:41]
v_cndmask_b32 v66, v66, v67, s[40:41]
s_add_u32 s39, s39, 4096
v_cndmask_b32 v75, v62, v66, s[44:45]
v_pk_fma_f32 v[68:69], v[68:69], v[140:141], v[144:145]
v_pk_mul_f32 v[72:73], v[72:73], v[142:143]
v_pk_fma_f32 v[70:71], v[70:71], v[140:141], v[144:145]
v_pk_mul_f32 v[74:75], v[74:75], v[142:143]
v_permlane32_swap_b32 v68, v72
s_nop 0
buffer_load_dwordx4 v1, s[4:7], s39 offen offset:0 sc1 lds
buffer_load_dwordx4 v1, s[4:7], s39 offen offset:1024 sc1 lds
v_permlane32_swap_b32 v70, v74
v_permlane32_swap_b32 v69, v73
v_permlane32_swap_b32 v71, v75
v_permlane16_swap_b32 v68, v70
v_permlane16_swap_b32 v72, v74
v_permlane16_swap_b32 v69, v71
v_permlane16_swap_b32 v73, v75
v_max3_f32 v76, v68, v69, v70
buffer_load_dwordx4 v1, s[4:7], s39 offen offset:2048 sc1 lds
buffer_load_dwordx4 v1, s[4:7], s39 offen offset:3072 sc1 lds
v_max3_f32 v77, v71, v72, v73
v_max3_f32 v76, v76, v74, v75
v_max_f32 v76, v76, v77
v_pk_add_f32 v[68:69], v[68:69], v[76:77] op_sel_hi:[1,0] neg_lo:[0,1] neg_hi:[0,1]
v_pk_add_f32 v[70:71], v[70:71], v[76:77] op_sel_hi:[1,0] neg_lo:[0,1] neg_hi:[0,1]
v_pk_add_f32 v[72:73], v[72:73], v[76:77] op_sel_hi:[1,0] neg_lo:[0,1] neg_hi:[0,1]
v_pk_add_f32 v[74:75], v[74:75], v[76:77] op_sel_hi:[1,0] neg_lo:[0,1] neg_hi:[0,1]
s_add_u32 m0, m0, 4096
v_exp_f32 v68, v68
v_exp_f32 v69, v69
v_exp_f32 v70, v70
v_exp_f32 v71, v71
v_exp_f32 v72, v72
v_exp_f32 v73, v73
v_exp_f32 v74, v74
v_exp_f32 v75, v75
s_add_u32 s39, s39, 4096
v_pk_add_f32 v[76:77], v[68:69], v[70:71]
v_pk_add_f32 v[78:79], v[72:73], v[74:75]
v_pk_add_f32 v[76:77], v[76:77], v[78:79]
v_add_f32 v76, v76, v77
v_rcp_f32 v76, v76
v_pk_mul_f32 v[68:69], v[68:69], v[100:101]
v_pk_mul_f32 v[70:71], v[70:71], v[102:103]
buffer_load_dwordx4 v1, s[4:7], s39 offen offset:0 sc1 lds
v_pk_mul_f32 v[72:73], v[72:73], v[104:105]
v_pk_mul_f32 v[74:75], v[74:75], v[106:107]
v_pk_mul_f32 v[68:69], v[68:69], v[76:77] op_sel_hi:[1,0]
v_pk_mul_f32 v[70:71], v[70:71], v[76:77] op_sel_hi:[1,0]
v_pk_mul_f32 v[72:73], v[72:73], v[76:77] op_sel_hi:[1,0]
v_pk_mul_f32 v[74:75], v[74:75], v[76:77] op_sel_hi:[1,0]
v_cvt_pk_bf16_f32 v80, v68, v69
v_cvt_pk_bf16_f32 v82, v72, v73
v_cvt_pk_bf16_f32 v81, v70, v71
v_cvt_pk_bf16_f32 v83, v74, v75
v_permlane32_swap_b32 v80, v82
s_waitcnt lgkmcnt(0)
v_permlane32_swap_b32 v81, v83
s_nop 1
v_permlane16_swap_b32 v80, v81
v_permlane16_swap_b32 v82, v83
v_perm_b32 v84, v80, v80, v10
v_perm_b32 v85, v80, v80, v11
v_perm_b32 v86, v80, v80, v12
v_perm_b32 v87, v80, v80, v13
v_perm_b32 v88, v81, v81, v10
v_perm_b32 v89, v81, v81, v11
v_mfma_f32_16x16x32_bf16 v[36:39], v[184:187], v[84:87], 0
v_perm_b32 v90, v81, v81, v12
v_perm_b32 v91, v81, v81, v13
v_mfma_f32_16x16x32_bf16 v[40:43], v[196:199], v[84:87], 0
v_perm_b32 v92, v82, v82, v10
v_perm_b32 v93, v82, v82, v11
v_mfma_f32_16x16x32_bf16 v[44:47], v[190:193], v[88:91], 0
v_perm_b32 v94, v82, v82, v12
v_perm_b32 v95, v82, v82, v13
v_mfma_f32_16x16x32_bf16 v[48:51], v[196:199], v[88:91], 0
v_perm_b32 v96, v83, v83, v10
v_perm_b32 v97, v83, v83, v11
v_mfma_f32_16x16x32_bf16 v[52:55], v[186:189], v[92:95], 0
v_perm_b32 v98, v83, v83, v12
v_perm_b32 v99, v83, v83, v13
v_mfma_f32_16x16x32_bf16 v[56:59], v[198:201], v[92:95], 0
v_cvt_pk_bf16_f32 v168, v36, v37
v_cvt_pk_bf16_f32 v169, v38, v39
v_mfma_f32_16x16x32_bf16 v[60:63], v[192:195], v[96:99], 0
v_mfma_f32_16x16x32_bf16 v[64:67], v[198:201], v[96:99], 0
v_cvt_pk_bf16_f32 v172, v40, v41
v_cvt_pk_bf16_f32 v170, v44, v45
v_cvt_pk_bf16_f32 v171, v46, v47
v_cvt_pk_bf16_f32 v173, v50, v51
buffer_store_dwordx4 v[168:171], v1, s[8:11], s64 offen sc1
buffer_store_dwordx2 v[172:173], v224, s[8:11], s65 offen sc1
v_cvt_pk_bf16_f32 v176, v52, v53
v_cvt_pk_bf16_f32 v177, v54, v55
v_cvt_pk_bf16_f32 v180, v56, v57
v_cvt_pk_bf16_f32 v178, v60, v61
v_cvt_pk_bf16_f32 v179, v62, v63
v_cvt_pk_bf16_f32 v181, v66, v67
buffer_store_dwordx4 v[176:179], v237, s[8:11], s64 offen sc1
buffer_store_dwordx2 v[180:181], v225, s[8:11], s65 offen sc1
L_c2:
s_barrier
s_mul_i32 s38, s24, 9216
s_add_u32 m0, s38, 123904
s_add_u32 s39, s38, s82
buffer_load_dwordx4 v1, s[4:7], s39 offen offset:0 sc1 lds
buffer_load_dwordx4 v1, s[4:7], s39 offen offset:1024 sc1 lds
buffer_load_dwordx4 v1, s[4:7], s39 offen offset:2048 sc1 lds
buffer_load_dwordx4 v1, s[4:7], s39 offen offset:3072 sc1 lds
s_add_u32 m0, m0, 4096
s_add_u32 s39, s39, 4096
buffer_load_dwordx4 v1, s[4:7], s39 offen offset:0 sc1 lds
buffer_load_dwordx4 v1, s[4:7], s39 offen offset:1024 sc1 lds
buffer_load_dwordx4 v1, s[4:7], s39 offen offset:2048 sc1 lds
v_lshlrev_b32 v7, 3, v1
s_lshl_b32 s31, s25, 11
v_add_u32 v7, s31, v7
s_cmp_eq_u32 s24, 0
s_cselect_b32 s30, 0, 1073741824
s_add_u32 s30, s30, 26476544
s_waitcnt vmcnt(7)
s_barrier
s_mov_b64 exec, 0xffff
buffer_atomic_add v4, v7, s[8:11], s30 offen sc1
s_mov_b64 exec, -1
s_lshl_b32 s35, s80, 7
s_add_u32 s35, s35, 26476544
s_cmp_eq_u32 s24, 1
s_cselect_b32 s35, s35, 1073741824
v_mov_b32 v6, 0
v_mov_b32 v244, 0
v_mov_b32 v245, 0
v_mov_b32 v246, 0
buffer_load_dwordx4 v1, s[4:7], s39 offen offset:3072 sc1 lds
s_add_u32 m0, m0, 4096
s_add_u32 s39, s39, 4096
buffer_load_dwordx4 v1, s[4:7], s39 offen offset:0 sc1 lds
s_lshl_b32 s38, s24, 8
s_add_u32 m0, s38, 160768
s_add_u32 s39, s38, s82
s_add_u32 s39, s39, 36864
s_mov_b64 exec, 0xffff
buffer_load_dwordx4 v1, s[4:7], s39 offen sc1 lds
s_mov_b64 exec, -1
s_mul_i32 s38, s24, 9216
s_add_u32 m0, s38, 0
s_add_u32 s39, s38, s82
s_add_u32 s39, s39, 37888
buffer_load_dwordx4 v1, s[4:7], s39 offen offset:0 sc1 lds
s_mov_b64 exec, 1
buffer_atomic_add v244, v6, s[8:11], s35 offen sc0 sc1
s_mov_b64 exec, -1
buffer_load_dwordx4 v1, s[4:7], s39 offen offset:1024 sc1 lds
buffer_load_dwordx4 v1, s[4:7], s39 offen offset:2048 sc1 lds
buffer_load_dwordx4 v1, s[4:7], s39 offen offset:3072 sc1 lds
s_add_u32 m0, m0, 4096
s_add_u32 s39, s39, 4096
s_mov_b64 exec, 1
buffer_atomic_add v245, v6, s[8:11], s35 offen sc0 sc1
s_mov_b64 exec, -1
buffer_load_dwordx4 v1, s[4:7], s39 offen offset:0 sc1 lds
buffer_load_dwordx4 v1, s[4:7], s39 offen offset:1024 sc1 lds
buffer_load_dwordx4 v1, s[4:7], s39 offen offset:2048 sc1 lds
s_mov_b64 exec, 1
buffer_atomic_add v246, v6, s[8:11], s35 offen sc0 sc1
s_mov_b64 exec, -1
buffer_load_dwordx4 v1, s[4:7], s39 offen offset:3072 sc1 lds
s_add_u32 m0, m0, 4096
s_add_u32 s39, s39, 4096
buffer_load_dwordx4 v1, s[4:7], s39 offen offset:0 sc1 lds
s_lshl_b32 s38, s24, 8
s_add_u32 m0, s38, 36864
s_add_u32 s39, s38, s82
s_add_u32 s39, s39, 74752
s_mov_b64 exec, 0xffff
buffer_load_dwordx4 v1, s[4:7], s39 offen sc1 lds
s_mov_b64 exec, -1
s_mul_i32 s60, s70, 18432
s_add_u32 s60, s60, 2490368
s_cmp_eq_u32 s24, 1
s_cbranch_scc0 L_other_15
s_mov_b32 s31, 0
s_mov_b64 exec, 1
v_mov_b32 v247, 0
buffer_atomic_add v247, v6, s[8:11], s35 offen sc0 sc1
s_waitcnt vmcnt(12)
v_cmp_gt_u32 vcc, 16, v244
s_nop 0
s_cbranch_vccz L_polled_14
s_waitcnt vmcnt(8)
v_cmp_gt_u32 vcc, 16, v245
s_nop 0
s_cbranch_vccz L_polled_14
v_mov_b32 v244, 0
buffer_atomic_add v244, v6, s[8:11], s35 offen sc0 sc1
s_waitcnt vmcnt(5)
v_cmp_gt_u32 vcc, 16, v246
s_nop 0
s_cbranch_vccz L_polled_14
v_mov_b32 v245, 0
buffer_atomic_add v245, v6, s[8:11], s35 offen sc0 sc1
L_poll_13:
s_add_u32 s31, s31, 1
s_cmp_gt_u32 s31, 100000
s_cbranch_scc1 L_polled_14
v_mov_b32 v246, 0
buffer_atomic_add v246, v6, s[8:11], s35 offen sc0 sc1
s_waitcnt vmcnt(3)
v_cmp_gt_u32 vcc, 16, v247
s_nop 0
s_cbranch_vccz L_polled_14
v_mov_b32 v247, 0
buffer_atomic_add v247, v6, s[8:11], s35 offen sc0 sc1
s_waitcnt vmcnt(3)
v_cmp_gt_u32 vcc, 16, v244
s_nop 0
s_cbranch_vccz L_polled_14
v_mov_b32 v244, 0
buffer_atomic_add v244, v6, s[8:11], s35 offen sc0 sc1
s_waitcnt vmcnt(3)
v_cmp_gt_u32 vcc, 16, v245
s_nop 0
s_cbranch_vccz L_polled_14
v_mov_b32 v245, 0
buffer_atomic_add v245, v6, s[8:11], s35 offen sc0 sc1
s_waitcnt vmcnt(3)
v_cmp_gt_u32 vcc, 16, v246
s_nop 0
s_cbranch_vccz L_polled_14
s_branch L_poll_13
L_polled_14:
s_mov_b64 exec, -1
L_other_15:
s_barrier
buffer_load_dwordx4 a[0:3], v1, s[8:11], s60 offen offset:0 sc1
buffer_load_dwordx4 a[4:7], v1, s[8:11], s60 offen offset:1024 sc1
s_barrier
buffer_load_dwordx4 a[8:11], v1, s[8:11], s60 offen offset:2048 sc1
buffer_load_dwordx4 a[12:15], v1, s[8:11], s60 offen offset:3072 sc1
s_barrier
s_add_u32 s60, s60, 4096
buffer_load_dwordx4 a[16:19], v1, s[8:11], s60 offen offset:0 sc1
buffer_load_dwordx4 a[20:23], v1, s[8:11], s60 offen offset:1024 sc1
s_barrier
buffer_load_dwordx4 a[24:27], v1, s[8:11], s60 offen offset:2048 sc1
buffer_load_dwordx4 a[28:31], v1, s[8:11], s60 offen offset:3072 sc1
v_lshrrev_b32 v40, 1, v1
v_and_b32 v36, 7, v2
v_lshlrev_b32 v36, 4, v36
v_lshl_add_u32 v36, v3, 7, v36
v_add_u32 v36, 4096, v36
v_add_u32 v36, 37888, v36
v_add_u32 v39, 37888, v1
v_add_u32 v37, 79360, v1
v_add_u32 v38, 41472, v36
ds_read_b128 a[72:75], v39 offset:0
ds_read_b128 a[76:79], v39 offset:1024
ds_read_b128 a[80:83], v39 offset:2048
ds_read_b128 a[84:87], v39 offset:3072
ds_read_b128 a[88:91], v36 offset:0
ds_read_b128 a[92:95], v39 offset:4608
ds_read_b128 a[96:99], v39 offset:5632
ds_read_b128 a[100:103], v39 offset:6656
ds_read_b128 a[104:107], v39 offset:7680
ds_read_b128 a[108:111], v36 offset:4608
v_mov_b32 v58, 1073741824
s_mul_i32 s62, s70, 18432
s_mul_i32 s32, s28, 2304
s_add_u32 s62, s62, s32
s_add_u32 s62, s62, 4849664
v_mov_b32 v60, v1
v_add_u32 v61, 2048, v60
v_cndmask_b32 v61, v58, v61, s[46:47]
s_lshl_b32 s63, s70, 7
s_lshl_b32 s32, s28, 14
s_add_u32 s63, s63, s32
s_add_u32 s63, s63, 7208960
v_lshlrev_b32 v59, 3, v2
v_cndmask_b32 v58, v58, v59, s[46:47]
s_waitcnt vmcnt(7) lgkmcnt(5)
v_mfma_f32_16x16x32_bf16 v[16:19], a[72:75], a[0:3], v[16:19]
ds_read_b128 a[112:115], v39 offset:9216
s_add_u32 s60, s60, 4096
buffer_load_dwordx4 a[32:35], v1, s[8:11], s60 offen offset:0 sc1
v_mfma_f32_16x16x32_bf16 v[20:23], a[76:79], a[0:3], v[20:23]
ds_read_b128 a[116:119], v39 offset:10240
v_mfma_f32_16x16x32_bf16 v[24:27], a[80:83], a[0:3], v[24:27]
ds_read_b128 a[120:123], v39 offset:11264
v_mfma_f32_16x16x32_bf16 v[28:31], a[84:87], a[0:3], v[28:31]
ds_read_b128 a[124:127], v39 offset:12288
v_mfma_f32_16x16x32_bf16 v[32:35], a[88:91], a[0:3], v[32:35]
ds_read_b128 a[128:131], v36 offset:9216
s_waitcnt vmcnt(7) lgkmcnt(5)
v_mfma_f32_16x16x32_bf16 v[16:19], a[92:95], a[4:7], v[16:19]
ds_read_b128 a[72:75], v39 offset:13824
buffer_load_dwordx4 a[36:39], v1, s[8:11], s60 offen offset:1024 sc1
v_mfma_f32_16x16x32_bf16 v[20:23], a[96:99], a[4:7], v[20:23]
ds_read_b128 a[76:79], v39 offset:14848
v_mfma_f32_16x16x32_bf16 v[24:27], a[100:103], a[4:7], v[24:27]
ds_read_b128 a[80:83], v39 offset:15872
v_mfma_f32_16x16x32_bf16 v[28:31], a[104:107], a[4:7], v[28:31]
ds_read_b128 a[84:87], v39 offset:16896
v_mfma_f32_16x16x32_bf16 v[32:35], a[108:111], a[4:7], v[32:35]
ds_read_b128 a[88:91], v36 offset:13824
s_waitcnt vmcnt(7) lgkmcnt(5)
v_mfma_f32_16x16x32_bf16 v[16:19], a[112:115], a[8:11], v[16:19]
ds_read_b128 a[92:95], v39 offset:18432
buffer_load_dwordx4 a[40:43], v1, s[8:11], s60 offen offset:2048 sc1
v_mfma_f32_16x16x32_bf16 v[20:23], a[116:119], a[8:11], v[20:23]
ds_read_b128 a[96:99], v39 offset:19456
v_mfma_f32_16x16x32_bf16 v[24:27], a[120:123], a[8:11], v[24:27]
ds_read_b128 a[100:103], v39 offset:20480
v_mfma_f32_16x16x32_bf16 v[28:31], a[124:127], a[8:11], v[28:31]
ds_read_b128 a[104:107], v39 offset:21504
v_mfma_f32_16x16x32_bf16 v[32:35], a[128:131], a[8:11], v[32:35]
ds_read_b128 a[108:111], v36 offset:18432
s_waitcnt vmcnt(7) lgkmcnt(5)
v_mfma_f32_16x16x32_bf16 v[16:19], a[72:75], a[12:15], v[16:19]
ds_read_b128 a[112:115], v39 offset:23040
buffer_load_dwordx4 a[44:47], v1, s[8:11], s60 offen offset:3072 sc1
v_mfma_f32_16x16x32_bf16 v[20:23], a[76:79], a[12:15], v[20:23]
ds_read_b128 a[116:119], v39 offset:24064
v_mfma_f32_16x16x32_bf16 v[24:27], a[80:83], a[12:15], v[24:27]
ds_read_b128 a[120:123], v39 offset:25088
v_mfma_f32_16x16x32_bf16 v[28:31], a[84:87], a[12:15], v[28:31]
ds_read_b128 a[124:127], v39 offset:26112
v_mfma_f32_16x16x32_bf16 v[32:35], a[88:91], a[12:15], v[32:35]
ds_read_b128 a[128:131], v36 offset:23040
s_waitcnt vmcnt(7) lgkmcnt(5)
v_mfma_f32_16x16x32_bf16 v[16:19], a[92:95], a[16:19], v[16:19]
ds_read_b128 a[72:75], v39 offset:27648
s_add_u32 s60, s60, 4096
buffer_load_dwordx4 a[48:51], v1, s[8:11], s60 offen offset:0 sc1
v_mfma_f32_16x16x32_bf16 v[20:23], a[96:99], a[16:19], v[20:23]
ds_read_b128 a[76:79], v39 offset:28672
v_mfma_f32_16x16x32_bf16 v[24:27], a[100:103], a[16:19], v[24:27]
ds_read_b128 a[80:83], v39 offset:29696
v_mfma_f32_16x16x32_bf16 v[28:31], a[104:107], a[16:19], v[28:31]
ds_read_b128 a[84:87], v39 offset:30720
v_mfma_f32_16x16x32_bf16 v[32:35], a[108:111], a[16:19], v[32:35]
ds_read_b128 a[88:91], v36 offset:27648
s_waitcnt vmcnt(7) lgkmcnt(5)
v_mfma_f32_16x16x32_bf16 v[16:19], a[112:115], a[20:23], v[16:19]
ds_read_b128 a[92:95], v39 offset:32256
buffer_load_dwordx4 a[52:55], v1, s[8:11], s60 offen offset:1024 sc1
v_mfma_f32_16x16x32_bf16 v[20:23], a[116:119], a[20:23], v[20:23]
ds_read_b128 a[96:99], v39 offset:33280
v_mfma_f32_16x16x32_bf16 v[24:27], a[120:123], a[20:23], v[24:27]
ds_read_b128 a[100:103], v39 offset:34304
v_mfma_f32_16x16x32_bf16 v[28:31], a[124:127], a[20:23], v[28:31]
ds_read_b128 a[104:107], v39 offset:35328
v_mfma_f32_16x16x32_bf16 v[32:35], a[128:131], a[20:23], v[32:35]
ds_read_b128 a[108:111], v36 offset:32256
s_waitcnt vmcnt(7) lgkmcnt(5)
v_mfma_f32_16x16x32_bf16 v[16:19], a[72:75], a[24:27], v[16:19]
ds_read_b128 a[112:115], v39 offset:36864
buffer_load_dwordx4 a[56:59], v1, s[8:11], s60 offen offset:2048 sc1
v_mfma_f32_16x16x32_bf16 v[20:23], a[76:79], a[24:27], v[20:23]
ds_read_b128 a[116:119], v39 offset:37888
v_mfma_f32_16x16x32_bf16 v[24:27], a[80:83], a[24:27], v[24:27]
ds_read_b128 a[120:123], v39 offset:38912
v_mfma_f32_16x16x32_bf16 v[28:31], a[84:87], a[24:27], v[28:31]
ds_read_b128 a[124:127], v39 offset:39936
v_mfma_f32_16x16x32_bf16 v[32:35], a[88:91], a[24:27], v[32:35]
ds_read_b128 a[128:131], v36 offset:36864
s_waitcnt vmcnt(7) lgkmcnt(5)
v_mfma_f32_16x16x32_bf16 v[16:19], a[92:95], a[28:31], v[16:19]
ds_read_b128 a[72:75], v37 offset:0
buffer_load_dwordx4 a[60:63], v1, s[8:11], s60 offen offset:3072 sc1
v_mfma_f32_16x16x32_bf16 v[20:23], a[96:99], a[28:31], v[20:23]
ds_read_b128 a[76:79], v37 offset:1024
v_mfma_f32_16x16x32_bf16 v[24:27], a[100:103], a[28:31], v[24:27]
ds_read_b128 a[80:83], v37 offset:2048
v_mfma_f32_16x16x32_bf16 v[28:31], a[104:107], a[28:31], v[28:31]
ds_read_b128 a[84:87], v37 offset:3072
v_mfma_f32_16x16x32_bf16 v[32:35], a[108:111], a[28:31], v[32:35]
ds_read_b128 a[88:91], v38 offset:0
s_waitcnt vmcnt(7) lgkmcnt(5)
v_mfma_f32_16x16x32_bf16 v[16:19], a[112:115], a[32:35], v[16:19]
ds_read_b128 a[92:95], v37 offset:4608
s_add_u32 s60, s60, 4096
buffer_load_dwordx2 a[64:65], v40, s[8:11], s60 offen offset:0 sc1
buffer_load_dwordx2 a[66:67], v40, s[8:11], s60 offen offset:1024 sc1
v_mfma_f32_16x16x32_bf16 v[20:23], a[116:119], a[32:35], v[20:23]
ds_read_b128 a[96:99], v37 offset:5632
v_mfma_f32_16x16x32_bf16 v[24:27], a[120:123], a[32:35], v[24:27]
ds_read_b128 a[100:103], v37 offset:6656
v_mfma_f32_16x16x32_bf16 v[28:31], a[124:127], a[32:35], v[28:31]
ds_read_b128 a[104:107], v37 offset:7680
v_mfma_f32_16x16x32_bf16 v[32:35], a[128:131], a[32:35], v[32:35]
ds_read_b128 a[108:111], v38 offset:4608
s_waitcnt vmcnt(8) lgkmcnt(5)
v_mfma_f32_16x16x32_bf16 v[16:19], a[72:75], a[36:39], v[16:19]
ds_read_b128 a[112:115], v37 offset:9216
buffer_load_dwordx2 a[68:69], v40, s[8:11], s60 offen offset:512 sc1
buffer_load_dwordx2 a[70:71], v40, s[8:11], s60 offen offset:1536 sc1
v_mfma_f32_16x16x32_bf16 v[20:23], a[76:79], a[36:39], v[20:23]
ds_read_b128 a[116:119], v37 offset:10240
v_mfma_f32_16x16x32_bf16 v[24:27], a[80:83], a[36:39], v[24:27]
ds_read_b128 a[120:123], v37 offset:11264
v_mfma_f32_16x16x32_bf16 v[28:31], a[84:87], a[36:39], v[28:31]
ds_read_b128 a[124:127], v37 offset:12288
v_mfma_f32_16x16x32_bf16 v[32:35], a[88:91], a[36:39], v[32:35]
ds_read_b128 a[128:131], v38 offset:9216
s_waitcnt vmcnt(9) lgkmcnt(5)
v_mfma_f32_16x16x32_bf16 v[16:19], a[92:95], a[40:43], v[16:19]
ds_read_b128 a[72:75], v37 offset:13824
v_mfma_f32_16x16x32_bf16 v[20:23], a[96:99], a[40:43], v[20:23]
ds_read_b128 a[76:79], v37 offset:14848
v_mfma_f32_16x16x32_bf16 v[24:27], a[100:103], a[40:43], v[24:27]
ds_read_b128 a[80:83], v37 offset:15872
v_mfma_f32_16x16x32_bf16 v[28:31], a[104:107], a[40:43], v[28:31]
ds_read_b128 a[84:87], v37 offset:16896
v_mfma_f32_16x16x32_bf16 v[32:35], a[108:111], a[40:43], v[32:35]
ds_read_b128 a[88:91], v38 offset:13824
s_waitcnt vmcnt(8) lgkmcnt(5)
v_mfma_f32_16x16x32_bf16 v[16:19], a[112:115], a[44:47], v[16:19]
ds_read_b128 a[92:95], v37 offset:18432
v_mfma_f32_16x16x32_bf16 v[20:23], a[116:119], a[44:47], v[20:23]
ds_read_b128 a[96:99], v37 offset:19456
v_mfma_f32_16x16x32_bf16 v[24:27], a[120:123], a[44:47], v[24:27]
ds_read_b128 a[100:103], v37 offset:20480
v_mfma_f32_16x16x32_bf16 v[28:31], a[124:127], a[44:47], v[28:31]
ds_read_b128 a[104:107], v37 offset:21504
v_mfma_f32_16x16x32_bf16 v[32:35], a[128:131], a[44:47], v[32:35]
ds_read_b128 a[108:111], v38 offset:18432
s_waitcnt vmcnt(7) lgkmcnt(5)
v_mfma_f32_16x16x32_bf16 v[16:19], a[72:75], a[48:51], v[16:19]
ds_read_b128 a[112:115], v37 offset:23040
v_mfma_f32_16x16x32_bf16 v[20:23], a[76:79], a[48:51], v[20:23]
ds_read_b128 a[116:119], v37 offset:24064
v_mfma_f32_16x16x32_bf16 v[24:27], a[80:83], a[48:51], v[24:27]
ds_read_b128 a[120:123], v37 offset:25088
v_mfma_f32_16x16x32_bf16 v[28:31], a[84:87], a[48:51], v[28:31]
ds_read_b128 a[124:127], v37 offset:26112
v_mfma_f32_16x16x32_bf16 v[32:35], a[88:91], a[48:51], v[32:35]
ds_read_b128 a[128:131], v38 offset:23040
s_waitcnt vmcnt(6) lgkmcnt(5)
v_mfma_f32_16x16x32_bf16 v[16:19], a[92:95], a[52:55], v[16:19]
ds_read_b128 a[72:75], v37 offset:27648
v_mfma_f32_16x16x32_bf16 v[20:23], a[96:99], a[52:55], v[20:23]
ds_read_b128 a[76:79], v37 offset:28672
v_mfma_f32_16x16x32_bf16 v[24:27], a[100:103], a[52:55], v[24:27]
ds_read_b128 a[80:83], v37 offset:29696
v_mfma_f32_16x16x32_bf16 v[28:31], a[104:107], a[52:55], v[28:31]
ds_read_b128 a[84:87], v37 offset:30720
v_mfma_f32_16x16x32_bf16 v[32:35], a[108:111], a[52:55], v[32:35]
ds_read_b128 a[88:91], v38 offset:27648
s_waitcnt vmcnt(5) lgkmcnt(5)
v_mfma_f32_16x16x32_bf16 v[16:19], a[112:115], a[56:59], v[16:19]
ds_read_b128 a[92:95], v37 offset:32256
v_mfma_f32_16x16x32_bf16 v[20:23], a[116:119], a[56:59], v[20:23]
ds_read_b128 a[96:99], v37 offset:33280
v_mfma_f32_16x16x32_bf16 v[24:27], a[120:123], a[56:59], v[24:27]
ds_read_b128 a[100:103], v37 offset:34304
v_mfma_f32_16x16x32_bf16 v[28:31], a[124:127], a[56:59], v[28:31]
ds_read_b128 a[104:107], v37 offset:35328
v_mfma_f32_16x16x32_bf16 v[32:35], a[128:131], a[56:59], v[32:35]
ds_read_b128 a[108:111], v38 offset:32256
s_waitcnt vmcnt(4) lgkmcnt(5)
v_mfma_f32_16x16x32_bf16 v[16:19], a[72:75], a[60:63], v[16:19]
ds_read_b128 a[112:115], v37 offset:36864
v_mfma_f32_16x16x32_bf16 v[20:23], a[76:79], a[60:63], v[20:23]
ds_read_b128 a[116:119], v37 offset:37888
v_mfma_f32_16x16x32_bf16 v[24:27], a[80:83], a[60:63], v[24:27]
ds_read_b128 a[120:123], v37 offset:38912
v_mfma_f32_16x16x32_bf16 v[28:31], a[84:87], a[60:63], v[28:31]
ds_read_b128 a[124:127], v37 offset:39936
v_mfma_f32_16x16x32_bf16 v[32:35], a[88:91], a[60:63], v[32:35]
ds_read_b128 a[128:131], v38 offset:36864
s_waitcnt vmcnt(2) lgkmcnt(5)
v_mfma_f32_16x16x32_bf16 v[16:19], a[92:95], a[64:67], v[16:19]
v_mfma_f32_16x16x32_bf16 v[20:23], a[96:99], a[64:67], v[20:23]
v_mfma_f32_16x16x32_bf16 v[24:27], a[100:103], a[64:67], v[24:27]
v_mfma_f32_16x16x32_bf16 v[28:31], a[104:107], a[64:67], v[28:31]
v_mfma_f32_16x16x32_bf16 v[32:35], a[108:111], a[64:67], v[32:35]
s_waitcnt vmcnt(0) lgkmcnt(0)
v_mfma_f32_16x16x32_bf16 v[16:19], a[112:115], a[68:71], v[16:19]
v_mfma_f32_16x16x32_bf16 v[20:23], a[116:119], a[68:71], v[20:23]
v_mfma_f32_16x16x32_bf16 v[24:27], a[120:123], a[68:71], v[24:27]
v_mfma_f32_16x16x32_bf16 v[28:31], a[124:127], a[68:71], v[28:31]
v_mfma_f32_16x16x32_bf16 v[32:35], a[128:131], a[68:71], v[32:35]
s_nop 3
s_nop 0
v_pk_add_f32 v[62:63], v[16:17], v[18:19]
v_pk_mul_f32 v[64:65], v[16:17], v[16:17]
v_pk_fma_f32 v[64:65], v[18:19], v[18:19], v[64:65]
v_pk_add_f32 v[62:63], v[62:63], v[20:21]
v_pk_fma_f32 v[64:65], v[20:21], v[20:21], v[64:65]
v_pk_add_f32 v[62:63], v[62:63], v[22:23]
v_pk_fma_f32 v[64:65], v[22:23], v[22:23], v[64:65]
v_pk_add_f32 v[62:63], v[62:63], v[24:25]
v_pk_fma_f32 v[64:65], v[24:25], v[24:25], v[64:65]
v_pk_add_f32 v[62:63], v[62:63], v[26:27]
v_pk_fma_f32 v[64:65], v[26:27], v[26:27], v[64:65]
v_pk_add_f32 v[62:63], v[62:63], v[28:29]
v_pk_fma_f32 v[64:65], v[28:29], v[28:29], v[64:65]
v_pk_add_f32 v[62:63], v[62:63], v[30:31]
v_pk_fma_f32 v[64:65], v[30:31], v[30:31], v[64:65]
s_mov_b32 exec_hi, 0
v_pk_add_f32 v[62:63], v[62:63], v[32:33]
v_pk_fma_f32 v[64:65], v[32:33], v[32:33], v[64:65]
v_pk_add_f32 v[62:63], v[62:63], v[34:35]
v_pk_fma_f32 v[64:65], v[34:35], v[34:35], v[64:65]
s_mov_b64 exec, -1
v_add_f32 v56, v62, v63
v_add_f32 v57, v64, v65
v_cvt_pk_bf16_f32 v52, v32, v33
v_cvt_pk_bf16_f32 v53, v34, v35
v_permlane32_swap_b32 v56, v57
v_add_f32 v56, v56, v57
v_mov_b32 v57, v56
v_cvt_pk_bf16_f32 v44, v16, v17
v_cvt_pk_bf16_f32 v45, v18, v19
v_permlane16_swap_b32 v56, v57
v_add_f32 v56, v56, v57
v_mov_b32 v57, v56
v_cvt_pk_bf16_f32 v46, v20, v21
v_cvt_pk_bf16_f32 v47, v22, v23
v_permlane32_swap_b32 v56, v57
buffer_store_dwordx4 v[44:47], v60, s[8:11], s62 offen sc1
buffer_store_dwordx2 v[56:57], v58, s[8:11], s63 offen sc1
v_cvt_pk_bf16_f32 v48, v24, v25
v_cvt_pk_bf16_f32 v49, v26, v27
v_cvt_pk_bf16_f32 v50, v28, v29
v_cvt_pk_bf16_f32 v51, v30, v31
v_permlane16_swap_b32 v52, v54
v_permlane16_swap_b32 v53, v55
buffer_store_dwordx4 v[48:51], v60, s[8:11], s62 offen offset:1024 sc1
buffer_store_dwordx4 v[52:55], v61, s[8:11], s62 offen sc1
s_barrier
s_mul_i32 s38, s24, 9216
s_add_u32 m0, s38, 37888
s_add_u32 s39, s38, s82
s_add_u32 s39, s39, 75776
buffer_load_dwordx4 v1, s[4:7], s39 offen offset:0 sc1 lds
buffer_load_dwordx4 v1, s[4:7], s39 offen offset:1024 sc1 lds
buffer_load_dwordx4 v1, s[4:7], s39 offen offset:2048 sc1 lds
buffer_load_dwordx4 v1, s[4:7], s39 offen offset:3072 sc1 lds
s_add_u32 m0, m0, 4096
s_add_u32 s39, s39, 4096
buffer_load_dwordx4 v1, s[4:7], s39 offen offset:0 sc1 lds
buffer_load_dwordx4 v1, s[4:7], s39 offen offset:1024 sc1 lds
buffer_load_dwordx4 v1, s[4:7], s39 offen offset:2048 sc1 lds
v_lshlrev_b32 v7, 3, v1
s_lshr_b32 s31, s80, 4
s_lshl_b32 s31, s31, 11
v_add_u32 v7, s31, v7
s_cmp_eq_u32 s24, 0
s_cselect_b32 s30, 0, 1073741824
s_add_u32 s30, s30, 26509312
s_waitcnt vmcnt(7)
s_barrier
s_mov_b64 exec, 0xffff
buffer_atomic_add v4, v7, s[8:11], s30 offen sc1
s_mov_b64 exec, -1
s_lshl_b32 s35, s80, 7
s_add_u32 s35, s35, 26509312
s_cmp_eq_u32 s24, 1
s_cselect_b32 s35, s35, 1073741824
v_mov_b32 v6, 0
v_mov_b32 v244, 0
v_mov_b32 v245, 0
v_mov_b32 v246, 0
buffer_load_dwordx4 v1, s[4:7], s39 offen offset:3072 sc1 lds
s_add_u32 m0, m0, 4096
s_add_u32 s39, s39, 4096
buffer_load_dwordx4 v1, s[4:7], s39 offen offset:0 sc1 lds
s_lshl_b32 s38, s24, 8
s_add_u32 m0, s38, 74752
s_add_u32 s39, s38, s82
s_add_u32 s39, s39, 112640
s_mov_b64 exec, 0xffff
buffer_load_dwordx4 v1, s[4:7], s39 offen sc1 lds
s_mov_b64 exec, -1
s_mul_i32 s38, s24, 9216
s_add_u32 m0, s38, 75776
s_add_u32 s39, s38, s82
s_add_u32 s39, s39, 113664
buffer_load_dwordx4 v1, s[4:7], s39 offen offset:0 sc1 lds
s_mov_b64 exec, 1
buffer_atomic_add v244, v6, s[8:11], s35 offen sc0 sc1
s_mov_b64 exec, -1
buffer_load_dwordx4 v1, s[4:7], s39 offen offset:1024 sc1 lds
buffer_load_dwordx4 v1, s[4:7], s39 offen offset:2048 sc1 lds
buffer_load_dwordx4 v1, s[4:7], s39 offen offset:3072 sc1 lds
s_add_u32 m0, m0, 4096
s_add_u32 s39, s39, 4096
s_mov_b64 exec, 1
buffer_atomic_add v245, v6, s[8:11], s35 offen sc0 sc1
s_mov_b64 exec, -1
buffer_load_dwordx4 v1, s[4:7], s39 offen offset:0 sc1 lds
buffer_load_dwordx4 v1, s[4:7], s39 offen offset:1024 sc1 lds
buffer_load_dwordx4 v1, s[4:7], s39 offen offset:2048 sc1 lds
s_mov_b64 exec, 1
buffer_atomic_add v246, v6, s[8:11], s35 offen sc0 sc1
s_mov_b64 exec, -1
buffer_load_dwordx4 v1, s[4:7], s39 offen offset:3072 sc1 lds
s_add_u32 m0, m0, 4096
s_add_u32 s39, s39, 4096
buffer_load_dwordx4 v1, s[4:7], s39 offen offset:0 sc1 lds
s_lshl_b32 s38, s24, 8
s_add_u32 m0, s38, 112640
s_add_u32 s39, s38, s82
s_add_u32 s39, s39, 150528
s_mov_b64 exec, 0xffff
buffer_load_dwordx4 v1, s[4:7], s39 offen sc1 lds
s_mov_b64 exec, -1
s_lshl_b32 s60, s25, 2
s_add_u32 s60, s60, s24
s_mul_i32 s62, s60, 36864
s_add_u32 s62, s62, 4849664
v_add_u32 v180, 18432, v1
s_cmp_eq_u32 s24, 1
s_cbranch_scc0 L_other_20
s_mov_b32 s31, 0
s_mov_b64 exec, 1
v_mov_b32 v247, 0
buffer_atomic_add v247, v6, s[8:11], s35 offen sc0 sc1
s_waitcnt vmcnt(12)
v_cmp_gt_u32 vcc, 16, v244
s_nop 0
s_cbranch_vccz L_polled_19
s_waitcnt vmcnt(8)
v_cmp_gt_u32 vcc, 16, v245
s_nop 0
s_cbranch_vccz L_polled_19
v_mov_b32 v244, 0
buffer_atomic_add v244, v6, s[8:11], s35 offen sc0 sc1
s_waitcnt vmcnt(5)
v_cmp_gt_u32 vcc, 16, v246
s_nop 0
s_cbranch_vccz L_polled_19
v_mov_b32 v245, 0
buffer_atomic_add v245, v6, s[8:11], s35 offen sc0 sc1
L_poll_18:
s_add_u32 s31, s31, 1
s_cmp_gt_u32 s31, 100000
s_cbranch_scc1 L_polled_19
v_mov_b32 v246, 0
buffer_atomic_add v246, v6, s[8:11], s35 offen sc0 sc1
s_waitcnt vmcnt(3)
v_cmp_gt_u32 vcc, 16, v247
s_nop 0
s_cbranch_vccz L_polled_19
v_mov_b32 v247, 0
buffer_atomic_add v247, v6, s[8:11], s35 offen sc0 sc1
s_waitcnt vmcnt(3)
v_cmp_gt_u32 vcc, 16, v244
s_nop 0
s_cbranch_vccz L_polled_19
v_mov_b32 v244, 0
buffer_atomic_add v244, v6, s[8:11], s35 offen sc0 sc1
s_waitcnt vmcnt(3)
v_cmp_gt_u32 vcc, 16, v245
s_nop 0
s_cbranch_vccz L_polled_19
v_mov_b32 v245, 0
buffer_atomic_add v245, v6, s[8:11], s35 offen sc0 sc1
s_waitcnt vmcnt(3)
v_cmp_gt_u32 vcc, 16, v246
s_nop 0
s_cbranch_vccz L_polled_19
s_branch L_poll_18
L_polled_19:
s_mov_b64 exec, -1
L_other_20:
s_barrier
buffer_load_dwordx4 a[0:3], v1, s[8:11], s62 offen offset:0 sc1
buffer_load_dwordx4 a[4:7], v180, s[8:11], s62 offen offset:0 sc1
s_barrier
buffer_load_dwordx4 a[8:11], v1, s[8:11], s62 offen offset:1024 sc1
buffer_load_dwordx4 a[12:15], v180, s[8:11], s62 offen offset:1024 sc1
s_barrier
buffer_load_dwordx4 a[16:19], v1, s[8:11], s62 offen offset:2048 sc1
buffer_load_dwordx4 a[20:23], v180, s[8:11], s62 offen offset:2048 sc1
s_barrier
buffer_load_dwordx4 a[24:27], v1, s[8:11], s62 offen offset:3072 sc1
buffer_load_dwordx4 a[28:31], v180, s[8:11], s62 offen offset:3072 sc1
s_barrier
s_add_u32 s62, s62, 4096
buffer_load_dwordx4 a[32:35], v1, s[8:11], s62 offen offset:0 sc1
buffer_load_dwordx4 a[36:39], v180, s[8:11], s62 offen offset:0 sc1
s_barrier
buffer_load_dwordx4 a[40:43], v1, s[8:11], s62 offen offset:1024 sc1
buffer_load_dwordx4 a[44:47], v180, s[8:11], s62 offen offset:1024 sc1
s_lshl_b32 s53, s25, 2
s_add_u32 s53, s53, s24
s_mul_i32 s53, s53, 133120
s_add_u32 s53, s53, 10895360
s_lshl_b32 s52, s25, 12
s_add_u32 s52, s52, s53
v_lshrrev_b32 v239, 1, v1
v_and_b32 v6, 0xf8, v239
v_lshrrev_b32 v7, 1, v3
v_lshl_add_u32 v232, v7, 16, v6
s_lshl_b32 s63, s60, 8
s_add_u32 s63, s63, 7208960
v_add_u32 v208, 123904, v1
v_add_u32 v209, 0, v1
v_add_u32 v210, 37888, v1
v_add_u32 v211, 75776, v1
ds_read_b128 a[144:147], v208 offset:0
ds_read_b128 a[148:151], v208 offset:18432
ds_read_b128 a[152:155], v209 offset:0
ds_read_b128 a[156:159], v209 offset:18432
ds_read_b128 a[160:163], v208 offset:1024
ds_read_b128 a[164:167], v208 offset:19456
s_waitcnt vmcnt(10) lgkmcnt(4)
v_mfma_f32_16x16x32_bf16 v[36:39], a[144:147], a[0:3], 0
ds_read_b128 a[168:171], v209 offset:1024
ds_read_b128 a[172:175], v209 offset:19456
v_mfma_f32_16x16x32_bf16 v[40:43], a[144:147], a[4:7], 0
buffer_load_dwordx4 a[48:51], v1, s[8:11], s62 offen offset:2048 sc1
v_mfma_f32_16x16x32_bf16 v[44:47], a[148:151], a[0:3], 0
buffer_load_dwordx4 a[52:55], v180, s[8:11], s62 offen offset:2048 sc1
v_mfma_f32_16x16x32_bf16 v[48:51], a[148:151], a[4:7], 0
s_waitcnt lgkmcnt(4)
v_mfma_f32_16x16x32_bf16 v[52:55], a[152:155], a[0:3], 0
ds_read_b128 a[144:147], v208 offset:2048
ds_read_b128 a[148:151], v208 offset:20480
v_mfma_f32_16x16x32_bf16 v[56:59], a[152:155], a[4:7], 0
buffer_load_dwordx4 a[56:59], v1, s[8:11], s62 offen offset:3072 sc1
v_lshl_add_u32 v234, v7, 13, v6
v_mfma_f32_16x16x32_bf16 v[60:63], a[156:159], a[0:3], 0
v_add_u32 v235, 4096, v234
v_mfma_f32_16x16x32_bf16 v[64:67], a[156:159], a[4:7], 0
s_waitcnt vmcnt(11) lgkmcnt(4)
s_barrier
v_mfma_f32_16x16x32_bf16 v[36:39], a[160:163], a[8:11], v[36:39]
ds_read_b128 a[152:155], v209 offset:2048
ds_read_b128 a[156:159], v209 offset:20480
v_mfma_f32_16x16x32_bf16 v[40:43], a[160:163], a[12:15], v[40:43]
buffer_load_dwordx4 a[60:63], v180, s[8:11], s62 offen offset:3072 sc1
s_mul_i32 s30, s24, 9216
v_mfma_f32_16x16x32_bf16 v[44:47], a[164:167], a[8:11], v[44:47]
s_add_u32 s62, s62, 4096
v_mfma_f32_16x16x32_bf16 v[48:51], a[164:167], a[12:15], v[48:51]
s_waitcnt lgkmcnt(4)
s_add_u32 s30, s30, 0
v_mfma_f32_16x16x32_bf16 v[52:55], a[168:171], a[8:11], v[52:55]
ds_read_b128 a[160:163], v208 offset:3072
ds_read_b128 a[164:167], v208 offset:21504
v_mfma_f32_16x16x32_bf16 v[56:59], a[168:171], a[12:15], v[56:59]
buffer_load_dwordx4 a[64:67], v1, s[8:11], s62 offen offset:0 sc1
v_mul_u32_u24 v236, 288, v2
v_mfma_f32_16x16x32_bf16 v[60:63], a[172:175], a[8:11], v[60:63]
v_mfma_f32_16x16x32_bf16 v[64:67], a[172:175], a[12:15], v[64:67]
s_waitcnt lgkmcnt(4)
v_add_u32 v236, s30, v236
s_waitcnt vmcnt(11)
v_mfma_f32_16x16x32_bf16 v[36:39], a[144:147], a[16:19], v[36:39]
ds_read_b128 a[168:171], v209 offset:3072
ds_read_b128 a[172:175], v209 offset:21504
v_mfma_f32_16x16x32_bf16 v[40:43], a[144:147], a[20:23], v[40:43]
buffer_load_dwordx2 v[182:183], v232, s[8:11], s63 offen sc1
v_mfma_f32_16x16x32_bf16 v[44:47], a[148:151], a[16:19], v[44:47]
s_add_u32 s63, s63, 16384
v_lshl_add_u32 v7, v3, 3, v236
v_mfma_f32_16x16x32_bf16 v[48:51], a[148:151], a[20:23], v[48:51]
s_waitcnt lgkmcnt(4)
v_mfma_f32_16x16x32_bf16 v[52:55], a[152:155], a[16:19], v[52:55]
ds_read_b128 a[144:147], v208 offset:4096
ds_read_b128 a[148:151], v208 offset:22528
v_mfma_f32_16x16x32_bf16 v[56:59], a[152:155], a[20:23], v[56:59]
v_lshl_add_u32 v236, v3, 4, v236
v_mfma_f32_16x16x32_bf16 v[60:63], a[156:159], a[16:19], v[60:63]
buffer_load_dwordx2 v[184:185], v232, s[8:11], s63 offen sc1
v_lshrrev_b32 v8, 2, v2
v_mfma_f32_16x16x32_bf16 v[64:67], a[156:159], a[20:23], v[64:67]
s_waitcnt vmcnt(11) lgkmcnt(4)
v_mfma_f32_16x16x32_bf16 v[36:39], a[160:163], a[24:27], v[36:39]
ds_read_b128 a[152:155], v209 offset:4096
ds_read_b128 a[156:159], v209 offset:22528
v_mfma_f32_16x16x32_bf16 v[40:43], a[160:163], a[28:31], v[40:43]
s_add_u32 s63, s63, 16384
v_lshl_add_u32 v8, v3, 3, v8
v_mfma_f32_16x16x32_bf16 v[44:47], a[164:167], a[24:27], v[44:47]
v_mfma_f32_16x16x32_bf16 v[48:51], a[164:167], a[28:31], v[48:51]
s_waitcnt lgkmcnt(4)
v_mul_u32_u24 v237, 288, v8
v_mfma_f32_16x16x32_bf16 v[52:55], a[168:171], a[24:27], v[52:55]
ds_read_b128 a[160:163], v208 offset:5120
ds_read_b128 a[164:167], v208 offset:23552
v_mfma_f32_16x16x32_bf16 v[56:59], a[168:171], a[28:31], v[56:59]
buffer_load_dwordx2 v[186:187], v232, s[8:11], s63 offen sc1
v_add_u32 v237, s30, v237
v_mfma_f32_16x16x32_bf16 v[60:63], a[172:175], a[24:27], v[60:63]
s_add_u32 s63, s63, 16384
v_mfma_f32_16x16x32_bf16 v[64:67], a[172:175], a[28:31], v[64:67]
s_waitcnt vmcnt(10) lgkmcnt(4)
v_mfma_f32_16x16x32_bf16 v[36:39], a[144:147], a[32:35], v[36:39]
ds_read_b128 a[168:171], v209 offset:5120
ds_read_b128 a[172:175], v209 offset:23552
v_mfma_f32_16x16x32_bf16 v[40:43], a[144:147], a[36:39], v[40:43]
buffer_load_dwordx2 v[188:189], v232, s[8:11], s63 offen sc1
v_and_b32 v8, 3, v2
v_mfma_f32_16x16x32_bf16 v[44:47], a[148:151], a[32:35], v[44:47]
s_add_u32 s63, s63, 16384
v_lshl_add_u32 v238, v8, 3, v237
v_mfma_f32_16x16x32_bf16 v[48:51], a[148:151], a[36:39], v[48:51]
s_waitcnt lgkmcnt(4)
v_mfma_f32_16x16x32_bf16 v[52:55], a[152:155], a[32:35], v[52:55]
ds_read_b128 a[144:147], v208 offset:6144
ds_read_b128 a[148:151], v208 offset:24576
v_mfma_f32_16x16x32_bf16 v[56:59], a[152:155], a[36:39], v[56:59]
v_lshl_add_u32 v237, v8, 4, v237
v_mfma_f32_16x16x32_bf16 v[60:63], a[156:159], a[32:35], v[60:63]
buffer_load_dwordx4 a[68:71], v180, s[8:11], s62 offen offset:0 sc1
v_mfma_f32_16x16x32_bf16 v[64:67], a[156:159], a[36:39], v[64:67]
s_waitcnt lgkmcnt(4)
s_mul_i32 s66, s26, 589824
s_waitcnt vmcnt(10)
v_mfma_f32_16x16x32_bf16 v[36:39], a[160:163], a[40:43], v[36:39]
ds_read_b128 a[152:155], v209 offset:6144
ds_read_b128 a[156:159], v209 offset:24576
v_mfma_f32_16x16x32_bf16 v[40:43], a[160:163], a[44:47], v[40:43]
buffer_load_dwordx4 a[72:75], v1, s[8:11], s62 offen offset:1024 sc1
s_mul_i32 s31, s60, 9216
v_mfma_f32_16x16x32_bf16 v[44:47], a[164:167], a[40:43], v[44:47]
s_add_u32 s66, s66, s31
v_mfma_f32_16x16x32_bf16 v[48:51], a[164:167], a[44:47], v[48:51]
s_waitcnt lgkmcnt(4)
v_mfma_f32_16x16x32_bf16 v[52:55], a[168:171], a[40:43], v[52:55]
ds_read_b128 a[160:163], v208 offset:7168
ds_read_b128 a[164:167], v208 offset:25600
v_mfma_f32_16x16x32_bf16 v[56:59], a[168:171], a[44:47], v[56:59]
buffer_load_dwordx4 a[76:79], v180, s[8:11], s62 offen offset:1024 sc1
v_mfma_f32_16x16x32_bf16 v[60:63], a[172:175], a[40:43], v[60:63]
s_add_u32 s66, s66, 7340032
v_mfma_f32_16x16x32_bf16 v[64:67], a[172:175], a[44:47], v[64:67]
s_waitcnt vmcnt(10) lgkmcnt(4)
v_mfma_f32_16x16x32_bf16 v[36:39], a[144:147], a[48:51], v[36:39]
ds_read_b128 a[168:171], v209 offset:7168
ds_read_b128 a[172:175], v209 offset:25600
v_mfma_f32_16x16x32_bf16 v[40:43], a[144:147], a[52:55], v[40:43]
buffer_load_dwordx4 a[80:83], v1, s[8:11], s62 offen offset:2048 sc1
v_lshlrev_b32 v233, 7, v1
v_mfma_f32_16x16x32_bf16 v[44:47], a[148:151], a[48:51], v[44:47]
buffer_load_dwordx4 a[84:87], v180, s[8:11], s62 offen offset:2048 sc1
v_mfma_f32_16x16x32_bf16 v[48:51], a[148:151], a[52:55], v[48:51]
s_waitcnt lgkmcnt(4)
s_lshl_b32 s31, s26, 7
v_mfma_f32_16x16x32_bf16 v[52:55], a[152:155], a[48:51], v[52:55]
ds_read_b128 a[144:147], v208 offset:8192
ds_read_b128 a[148:151], v208 offset:26624
v_mfma_f32_16x16x32_bf16 v[56:59], a[152:155], a[52:55], v[56:59]
buffer_load_dwordx4 a[88:91], v1, s[8:11], s62 offen offset:3072 sc1
v_add_u32 v233, s31, v233
v_mfma_f32_16x16x32_bf16 v[60:63], a[156:159], a[48:51], v[60:63]
s_lshl_b32 s61, s25, 14
v_mfma_f32_16x16x32_bf16 v[64:67], a[156:159], a[52:55], v[64:67]
s_waitcnt vmcnt(11) lgkmcnt(4)
v_mfma_f32_16x16x32_bf16 v[36:39], a[160:163], a[56:59], v[36:39]
ds_read_b128 a[152:155], v209 offset:8192
ds_read_b128 a[156:159], v209 offset:26624
v_mfma_f32_16x16x32_bf16 v[40:43], a[160:163], a[60:63], v[40:43]
buffer_load_dwordx4 a[92:95], v180, s[8:11], s62 offen offset:3072 sc1
v_mfma_f32_16x16x32_bf16 v[44:47], a[164:167], a[56:59], v[44:47]
s_add_u32 s62, s62, 4096
s_lshl_b32 s30, s24, 8
v_mfma_f32_16x16x32_bf16 v[48:51], a[164:167], a[60:63], v[48:51]
s_waitcnt lgkmcnt(4)
v_mfma_f32_16x16x32_bf16 v[52:55], a[168:171], a[56:59], v[52:55]
ds_read_b128 a[160:163], v208 offset:9216
ds_read_b128 a[164:167], v208 offset:27648
v_mfma_f32_16x16x32_bf16 v[56:59], a[168:171], a[60:63], v[56:59]
buffer_load_dwordx4 a[96:99], v1, s[8:11], s62 offen offset:0 sc1
s_add_u32 s61, s61, s30
v_mfma_f32_16x16x32_bf16 v[60:63], a[172:175], a[56:59], v[60:63]
s_add_u32 s61, s61, 26214400
v_mfma_f32_16x16x32_bf16 v[64:67], a[172:175], a[60:63], v[64:67]
s_waitcnt vmcnt(7) lgkmcnt(4)
v_mfma_f32_16x16x32_bf16 v[36:39], a[144:147], a[64:67], v[36:39]
ds_read_b128 a[168:171], v209 offset:9216
ds_read_b128 a[172:175], v209 offset:27648
v_mfma_f32_16x16x32_bf16 v[40:43], a[144:147], a[68:71], v[40:43]
buffer_load_dwordx4 a[100:103], v180, s[8:11], s62 offen offset:0 sc1
s_mul_i32 s30, s24, 9216
v_mfma_f32_16x16x32_bf16 v[44:47], a[148:151], a[64:67], v[44:47]
buffer_load_dwordx4 a[104:107], v1, s[8:11], s62 offen offset:1024 sc1
v_mfma_f32_16x16x32_bf16 v[48:51], a[148:151], a[68:71], v[48:51]
s_waitcnt lgkmcnt(4)
s_add_u32 s30, s30, 0
v_mfma_f32_16x16x32_bf16 v[52:55], a[152:155], a[64:67], v[52:55]
ds_read_b128 a[144:147], v208 offset:10240
ds_read_b128 a[148:151], v208 offset:28672
v_mfma_f32_16x16x32_bf16 v[56:59], a[152:155], a[68:71], v[56:59]
buffer_load_dwordx4 a[108:111], v180, s[8:11], s62 offen offset:1024 sc1
v_add_u32 v240, s30, v1
v_mfma_f32_16x16x32_bf16 v[60:63], a[156:159], a[64:67], v[60:63]
s_lshl_b32 s30, s26, 10
v_mfma_f32_16x16x32_bf16 v[64:67], a[156:159], a[68:71], v[64:67]
s_waitcnt vmcnt(8) lgkmcnt(4)
v_mfma_f32_16x16x32_bf16 v[36:39], a[160:163], a[72:75], v[36:39]
ds_read_b128 a[152:155], v209 offset:10240
ds_read_b128 a[156:159], v209 offset:28672
v_mfma_f32_16x16x32_bf16 v[40:43], a[160:163], a[76:79], v[40:43]
buffer_load_dwordx4 a[112:115], v1, s[8:11], s62 offen offset:2048 sc1
v_mfma_f32_16x16x32_bf16 v[44:47], a[164:167], a[72:75], v[44:47]
buffer_load_dwordx4 a[116:119], v180, s[8:11], s62 offen offset:2048 sc1
s_add_u32 s30, s30, s61
v_mfma_f32_16x16x32_bf16 v[48:51], a[164:167], a[76:79], v[48:51]
s_waitcnt lgkmcnt(4)
v_mfma_f32_16x16x32_bf16 v[52:55], a[168:171], a[72:75], v[52:55]
ds_read_b128 a[160:163], v208 offset:11264
ds_read_b128 a[164:167], v208 offset:29696
v_mfma_f32_16x16x32_bf16 v[56:59], a[168:171], a[76:79], v[56:59]
buffer_load_dwordx4 a[120:123], v1, s[8:11], s62 offen offset:3072 sc1
v_mfma_f32_16x16x32_bf16 v[60:63], a[172:175], a[72:75], v[60:63]
v_mfma_f32_16x16x32_bf16 v[64:67], a[172:175], a[76:79], v[64:67]
s_waitcnt vmcnt(9) lgkmcnt(4)
v_mfma_f32_16x16x32_bf16 v[36:39], a[144:147], a[80:83], v[36:39]
ds_read_b128 a[168:171], v209 offset:11264
ds_read_b128 a[172:175], v209 offset:29696
v_mfma_f32_16x16x32_bf16 v[40:43], a[144:147], a[84:87], v[40:43]
buffer_load_dwordx4 a[124:127], v180, s[8:11], s62 offen offset:3072 sc1
v_mfma_f32_16x16x32_bf16 v[44:47], a[148:151], a[80:83], v[44:47]
s_add_u32 s62, s62, 4096
v_add_f32 v198, v182, v184
v_add_f32 v199, v183, v185
v_mfma_f32_16x16x32_bf16 v[48:51], a[148:151], a[84:87], v[48:51]
s_waitcnt lgkmcnt(4)
v_add_f32 v198, v198, v186
v_mfma_f32_16x16x32_bf16 v[52:55], a[152:155], a[80:83], v[52:55]
ds_read_b128 a[144:147], v208 offset:12288
ds_read_b128 a[148:151], v208 offset:30720
v_mfma_f32_16x16x32_bf16 v[56:59], a[152:155], a[84:87], v[56:59]
buffer_load_dwordx4 a[128:131], v1, s[8:11], s62 offen offset:0 sc1
v_add_f32 v199, v199, v187
v_mfma_f32_16x16x32_bf16 v[60:63], a[156:159], a[80:83], v[60:63]
v_add_f32 v198, v198, v188
v_mfma_f32_16x16x32_bf16 v[64:67], a[156:159], a[84:87], v[64:67]
s_waitcnt lgkmcnt(4)
v_add_f32 v199, v199, v189
s_waitcnt vmcnt(9)
v_mfma_f32_16x16x32_bf16 v[36:39], a[160:163], a[88:91], v[36:39]
ds_read_b128 a[152:155], v209 offset:12288
ds_read_b128 a[156:159], v209 offset:30720
v_mfma_f32_16x16x32_bf16 v[40:43], a[160:163], a[92:95], v[40:43]
buffer_load_dwordx4 a[132:135], v180, s[8:11], s62 offen offset:0 sc1
v_mov_b32 v200, v198
v_mfma_f32_16x16x32_bf16 v[44:47], a[164:167], a[88:91], v[44:47]
v_mov_b32 v201, v199
v_mfma_f32_16x16x32_bf16 v[48:51], a[164:167], a[92:95], v[48:51]
s_waitcnt lgkmcnt(4)
s_nop 0
v_mfma_f32_16x16x32_bf16 v[52:55], a[168:171], a[88:91], v[52:55]
ds_read_b128 a[160:163], v208 offset:13312
ds_read_b128 a[164:167], v208 offset:31744
v_mfma_f32_16x16x32_bf16 v[56:59], a[168:171], a[92:95], v[56:59]
buffer_load_dwordx4 a[136:139], v1, s[8:11], s62 offen offset:1024 sc1
v_mfma_f32_16x16x32_bf16 v[60:63], a[172:175], a[88:91], v[60:63]
buffer_load_dwordx4 a[140:143], v180, s[8:11], s62 offen offset:1024 sc1
v_mfma_f32_16x16x32_bf16 v[64:67], a[172:175], a[92:95], v[64:67]
s_waitcnt vmcnt(10) lgkmcnt(4)
v_mfma_f32_16x16x32_bf16 v[36:39], a[144:147], a[96:99], v[36:39]
ds_read_b128 a[168:171], v209 offset:13312
ds_read_b128 a[172:175], v209 offset:31744
v_mfma_f32_16x16x32_bf16 v[40:43], a[144:147], a[100:103], v[40:43]
v_permlane32_swap_b32 v198, v200
v_mfma_f32_16x16x32_bf16 v[44:47], a[148:151], a[96:99], v[44:47]
v_permlane32_swap_b32 v199, v201
v_mfma_f32_16x16x32_bf16 v[48:51], a[148:151], a[100:103], v[48:51]
s_waitcnt lgkmcnt(4)
v_add_f32 v198, v198, v200
v_add_f32 v199, v199, v201
v_mfma_f32_16x16x32_bf16 v[52:55], a[152:155], a[96:99], v[52:55]
ds_read_b128 a[144:147], v208 offset:14336
ds_read_b128 a[148:151], v208 offset:32768
v_mfma_f32_16x16x32_bf16 v[56:59], a[152:155], a[100:103], v[56:59]
v_mul_f32 v198, 0x3ae38e39, v198
v_mul_f32 v200, v198, v198
v_mfma_f32_16x16x32_bf16 v[60:63], a[156:159], a[96:99], v[60:63]
v_mul_f32 v199, 0x3ae38e39, v199
v_mfma_f32_16x16x32_bf16 v[64:67], a[156:159], a[100:103], v[64:67]
s_waitcnt vmcnt(8) lgkmcnt(4)
v_mfma_f32_16x16x32_bf16 v[36:39], a[160:163], a[104:107], v[36:39]
ds_read_b128 a[152:155], v209 offset:14336
ds_read_b128 a[156:159], v209 offset:32768
v_mfma_f32_16x16x32_bf16 v[40:43], a[160:163], a[108:111], v[40:43]
v_sub_f32 v199, v199, v200
v_max_f32 v199, 0, v199
v_mfma_f32_16x16x32_bf16 v[44:47], a[164:167], a[104:107], v[44:47]
v_add_f32 v199, 0x3727c5ac, v199
v_mfma_f32_16x16x32_bf16 v[48:51], a[164:167], a[108:111], v[48:51]
s_waitcnt lgkmcnt(4)
v_rsq_f32 v250, v199
v_mfma_f32_16x16x32_bf16 v[52:55], a[168:171], a[104:107], v[52:55]
ds_read_b128 a[160:163], v208 offset:15360
ds_read_b128 a[164:167], v208 offset:33792
v_mfma_f32_16x16x32_bf16 v[56:59], a[168:171], a[108:111], v[56:59]
v_mfma_f32_16x16x32_bf16 v[60:63], a[172:175], a[104:107], v[60:63]
v_sqrt_f32 v254, v199
v_mfma_f32_16x16x32_bf16 v[64:67], a[172:175], a[108:111], v[64:67]
s_waitcnt vmcnt(6) lgkmcnt(4)
v_mfma_f32_16x16x32_bf16 v[36:39], a[144:147], a[112:115], v[36:39]
ds_read_b128 a[168:171], v209 offset:15360
ds_read_b128 a[172:175], v209 offset:33792
v_mfma_f32_16x16x32_bf16 v[40:43], a[144:147], a[116:119], v[40:43]
v_cvt_pk_bf16_f32 v200, -v198, -v198
v_mfma_f32_16x16x32_bf16 v[44:47], a[148:151], a[112:115], v[44:47]
v_and_b32 v200, 0xffff0000, v200
v_mfma_f32_16x16x32_bf16 v[48:51], a[148:151], a[116:119], v[48:51]
s_waitcnt lgkmcnt(4)
v_add_f32 v200, v198, v200
v_mfma_f32_16x16x32_bf16 v[52:55], a[152:155], a[112:115], v[52:55]
ds_read_b128 a[144:147], v208 offset:16384
ds_read_b128 a[148:151], v208 offset:34816
v_mfma_f32_16x16x32_bf16 v[56:59], a[152:155], a[116:119], v[56:59]
v_cvt_pk_bf16_f32 v212, -v198, -v200
v_mfma_f32_16x16x32_bf16 v[60:63], a[156:159], a[112:115], v[60:63]
v_mul_f32 v252, v250, v250
v_mfma_f32_16x16x32_bf16 v[64:67], a[156:159], a[116:119], v[64:67]
s_waitcnt lgkmcnt(4)
v_mul_f32 v252, v252, v250
s_waitcnt vmcnt(4)
v_mfma_f32_16x16x32_bf16 v[36:39], a[160:163], a[120:123], v[36:39]
ds_read_b128 a[152:155], v209 offset:16384
ds_read_b128 a[156:159], v209 offset:34816
v_mfma_f32_16x16x32_bf16 v[40:43], a[160:163], a[124:127], v[40:43]
v_mul_f32 v252, 0xbdd2d3e8, v252
v_mul_f32 v250, 0xc0135761, v250
v_mfma_f32_16x16x32_bf16 v[44:47], a[164:167], a[120:123], v[44:47]
s_mov_b32 s37, L_c4-12288-L_pc
v_mfma_f32_16x16x32_bf16 v[48:51], a[164:167], a[124:127], v[48:51]
s_waitcnt lgkmcnt(4)
v_mov_b32 v214, v212
v_mfma_f32_16x16x32_bf16 v[52:55], a[168:171], a[120:123], v[52:55]
ds_read_b128 a[160:163], v208 offset:17408
ds_read_b128 a[164:167], v208 offset:35840
v_mfma_f32_16x16x32_bf16 v[56:59], a[168:171], a[124:127], v[56:59]
v_mov_b32 v255, v254
v_mov_b32 v253, v252
v_mfma_f32_16x16x32_bf16 v[60:63], a[172:175], a[120:123], v[60:63]
buffer_load_dword v15, v14, s[88:91], s37 offen
v_mfma_f32_16x16x32_bf16 v[64:67], a[172:175], a[124:127], v[64:67]
s_waitcnt lgkmcnt(4)
v_mov_b32 v251, v250
s_waitcnt vmcnt(3)
v_mfma_f32_16x16x32_bf16 v[36:39], a[144:147], a[128:131], v[36:39]
ds_read_b128 a[168:171], v209 offset:17408
ds_read_b128 a[172:175], v209 offset:35840
v_mfma_f32_16x16x32_bf16 v[40:43], a[144:147], a[132:135], v[40:43]
v_permlane16_swap_b32 v212, v214
v_mfma_f32_16x16x32_bf16 v[44:47], a[148:151], a[128:131], v[44:47]
v_permlane16_swap_b32 v254, v255
v_mfma_f32_16x16x32_bf16 v[48:51], a[148:151], a[132:135], v[48:51]
s_waitcnt lgkmcnt(4)
v_add_u32 v181, 160768, v239
v_mfma_f32_16x16x32_bf16 v[52:55], a[152:155], a[128:131], v[52:55]
ds_read_b64 a[144:145], v181 offset:0
ds_read_b64 a[148:149], v181 offset:512
v_mfma_f32_16x16x32_bf16 v[56:59], a[152:155], a[132:135], v[56:59]
v_permlane16_swap_b32 v252, v253
v_mfma_f32_16x16x32_bf16 v[60:63], a[156:159], a[128:131], v[60:63]
v_mfma_f32_16x16x32_bf16 v[64:67], a[156:159], a[132:135], v[64:67]
s_waitcnt vmcnt(1) lgkmcnt(4)
v_add_u32 v181, 36864, v239
v_mfma_f32_16x16x32_bf16 v[36:39], a[160:163], a[136:139], v[36:39]
ds_read_b64 a[152:153], v181 offset:0
ds_read_b64 a[156:157], v181 offset:512
v_mfma_f32_16x16x32_bf16 v[40:43], a[160:163], a[140:143], v[40:43]
v_permlane16_swap_b32 v250, v251
v_mfma_f32_16x16x32_bf16 v[44:47], a[164:167], a[136:139], v[44:47]
v_mov_b32 v213, v212
v_mfma_f32_16x16x32_bf16 v[48:51], a[164:167], a[140:143], v[48:51]
s_waitcnt lgkmcnt(4)
v_mov_b32 v215, v214
v_mfma_f32_16x16x32_bf16 v[52:55], a[168:171], a[136:139], v[52:55]
ds_read_b128 a[160:163], v210 offset:0
ds_read_b128 a[164:167], v210 offset:18432
v_mfma_f32_16x16x32_bf16 v[56:59], a[168:171], a[140:143], v[56:59]
v_mfma_f32_16x16x32_bf16 v[60:63], a[172:175], a[136:139], v[60:63]
v_mfma_f32_16x16x32_bf16 v[64:67], a[172:175], a[140:143], v[64:67]
s_waitcnt lgkmcnt(4)
v_mfma_f32_16x16x16_bf16 v[36:39], a[144:145], v[212:213], v[36:39]
ds_read_b128 a[168:171], v210 offset:1024
ds_read_b128 a[172:175], v210 offset:19456
v_mfma_f32_16x16x16_bf16 v[40:43], a[144:145], v[214:215], v[40:43]
v_mfma_f32_16x16x16_bf16 v[44:47], a[148:149], v[212:213], v[44:47]
v_mfma_f32_16x16x16_bf16 v[48:51], a[148:149], v[214:215], v[48:51]
s_waitcnt lgkmcnt(4)
v_mfma_f32_16x16x16_bf16 v[52:55], a[152:153], v[212:213], v[52:55]
ds_read_b128 a[144:147], v210 offset:2048
ds_read_b128 a[148:151], v210 offset:20480
v_mfma_f32_16x16x16_bf16 v[56:59], a[152:153], v[214:215], v[56:59]
v_mfma_f32_16x16x16_bf16 v[60:63], a[156:157], v[212:213], v[60:63]
v_mfma_f32_16x16x16_bf16 v[64:67], a[156:157], v[214:215], v[64:67]
s_waitcnt lgkmcnt(4)
s_barrier
v_mfma_f32_16x16x32_bf16 v[68:71], a[160:163], a[0:3], 0
ds_read_b128 a[152:155], v210 offset:3072
ds_read_b128 a[156:159], v210 offset:21504
v_mfma_f32_16x16x32_bf16 v[72:75], a[160:163], a[4:7], 0
s_mul_i32 s38, s24, 9216
s_add_u32 m0, s38, 123904
v_mfma_f32_16x16x32_bf16 v[76:79], a[164:167], a[0:3], 0
s_add_u32 s39, s38, s82
v_mfma_f32_16x16x32_bf16 v[80:83], a[164:167], a[4:7], 0
s_waitcnt lgkmcnt(4)
v_mfma_f32_16x16x32_bf16 v[68:71], a[168:171], a[8:11], v[68:71]
ds_read_b128 a[160:163], v210 offset:4096
ds_read_b128 a[164:167], v210 offset:22528
v_mfma_f32_16x16x32_bf16 v[72:75], a[168:171], a[12:15], v[72:75]
s_add_u32 s39, s39, 151552
v_mfma_f32_16x16x32_bf16 v[76:79], a[172:175], a[8:11], v[76:79]
buffer_load_dwordx4 v1, s[4:7], s39 offen offset:0 sc1 lds
buffer_load_dwordx4 v1, s[4:7], s39 offen offset:1024 sc1 lds
v_pk_mul_f32 v[216:217], v[36:37], v[36:37]
v_pk_mul_f32 v[218:219], v[38:39], v[38:39]
v_pk_mul_f32 v[220:221], v[40:41], v[40:41]
v_pk_mul_f32 v[222:223], v[42:43], v[42:43]
v_pk_fma_f32 v[216:217], v[216:217], v[252:253], v[250:251] op_sel:[0,0,0] op_sel_hi:[1,0,0]
v_pk_fma_f32 v[218:219], v[218:219], v[252:253], v[250:251] op_sel:[0,0,0] op_sel_hi:[1,0,0]
v_pk_fma_f32 v[220:221], v[220:221], v[252:253], v[250:251] op_sel:[0,1,1] op_sel_hi:[1,1,1]
v_pk_fma_f32 v[222:223], v[222:223], v[252:253], v[250:251] op_sel:[0,1,1] op_sel_hi:[1,1,1]
v_pk_mul_f32 v[216:217], v[216:217], v[36:37]
v_pk_mul_f32 v[218:219], v[218:219], v[38:39]
v_pk_mul_f32 v[220:221], v[220:221], v[40:41]
v_pk_mul_f32 v[222:223], v[222:223], v[42:43]
v_mfma_f32_16x16x32_bf16 v[80:83], a[172:175], a[12:15], v[80:83]
s_waitcnt lgkmcnt(4)
v_exp_f32 v216, v216
v_mfma_f32_16x16x32_bf16 v[68:71], a[144:147], a[16:19], v[68:71]
ds_read_b128 a[168:171], v210 offset:5120
ds_read_b128 a[172:175], v210 offset:23552
v_mfma_f32_16x16x32_bf16 v[72:75], a[144:147], a[20:23], v[72:75]
v_exp_f32 v217, v217
v_mfma_f32_16x16x32_bf16 v[76:79], a[148:151], a[16:19], v[76:79]
buffer_load_dwordx4 v1, s[4:7], s39 offen offset:2048 sc1 lds
buffer_load_dwordx4 v1, s[4:7], s39 offen offset:3072 sc1 lds
v_mfma_f32_16x16x32_bf16 v[80:83], a[148:151], a[20:23], v[80:83]
s_waitcnt lgkmcnt(4)
v_exp_f32 v218, v218
v_mfma_f32_16x16x32_bf16 v[68:71], a[152:155], a[24:27], v[68:71]
ds_read_b128 a[144:147], v210 offset:6144
ds_read_b128 a[148:151], v210 offset:24576
v_mfma_f32_16x16x32_bf16 v[72:75], a[152:155], a[28:31], v[72:75]
s_add_u32 m0, m0, 4096
v_fma_f32 v216, v216, v254, v254
v_fma_f32 v217, v217, v254, v254
v_mfma_f32_16x16x32_bf16 v[76:79], a[156:159], a[24:27], v[76:79]
s_add_u32 s39, s39, 4096
v_exp_f32 v219, v219
v_mfma_f32_16x16x32_bf16 v[80:83], a[156:159], a[28:31], v[80:83]
s_waitcnt lgkmcnt(4)
v_exp_f32 v220, v220
v_mfma_f32_16x16x32_bf16 v[68:71], a[160:163], a[32:35], v[68:71]
ds_read_b128 a[152:155], v210 offset:7168
ds_read_b128 a[156:159], v210 offset:25600
v_mfma_f32_16x16x32_bf16 v[72:75], a[160:163], a[36:39], v[72:75]
buffer_load_dwordx4 v1, s[4:7], s39 offen offset:0 sc1 lds
buffer_load_dwordx4 v1, s[4:7], s39 offen offset:1024 sc1 lds
v_mfma_f32_16x16x32_bf16 v[76:79], a[164:167], a[32:35], v[76:79]
v_fma_f32 v218, v218, v254, v254
v_fma_f32 v219, v219, v254, v254
v_mfma_f32_16x16x32_bf16 v[80:83], a[164:167], a[36:39], v[80:83]
s_waitcnt lgkmcnt(4)
v_exp_f32 v221, v221
v_mfma_f32_16x16x32_bf16 v[68:71], a[168:171], a[40:43], v[68:71]
ds_read_b128 a[160:163], v210 offset:8192
ds_read_b128 a[164:167], v210 offset:26624
v_exp_f32 v222, v222
v_mfma_f32_16x16x32_bf16 v[72:75], a[168:171], a[44:47], v[72:75]
buffer_load_dwordx4 v1, s[4:7], s39 offen offset:2048 sc1 lds
buffer_load_dwordx4 v1, s[4:7], s39 offen offset:3072 sc1 lds
v_mfma_f32_16x16x32_bf16 v[76:79], a[172:175], a[40:43], v[76:79]
s_add_u32 m0, m0, 4096
v_fma_f32 v220, v220, v255, v255
v_fma_f32 v221, v221, v255, v255
v_mfma_f32_16x16x32_bf16 v[80:83], a[172:175], a[44:47], v[80:83]
s_waitcnt lgkmcnt(4)
v_exp_f32 v223, v223
v_mfma_f32_16x16x32_bf16 v[68:71], a[144:147], a[48:51], v[68:71]
ds_read_b128 a[168:171], v210 offset:9216
ds_read_b128 a[172:175], v210 offset:27648
v_rcp_f32 v216, v216
v_mfma_f32_16x16x32_bf16 v[72:75], a[144:147], a[52:55], v[72:75]
s_add_u32 s39, s39, 4096
v_fma_f32 v222, v222, v255, v255
v_fma_f32 v223, v223, v255, v255
v_mfma_f32_16x16x32_bf16 v[76:79], a[148:151], a[48:51], v[76:79]
buffer_load_dwordx4 v1, s[4:7], s39 offen offset:0 sc1 lds
v_mfma_f32_16x16x32_bf16 v[80:83], a[148:151], a[52:55], v[80:83]
s_waitcnt lgkmcnt(4)
v_rcp_f32 v217, v217
v_mfma_f32_16x16x32_bf16 v[68:71], a[152:155], a[56:59], v[68:71]
ds_read_b128 a[144:147], v210 offset:10240
ds_read_b128 a[148:151], v210 offset:28672
v_rcp_f32 v218, v218
v_mfma_f32_16x16x32_bf16 v[72:75], a[152:155], a[60:63], v[72:75]
s_lshl_b32 s38, s24, 8
v_rcp_f32 v219, v219
v_mfma_f32_16x16x32_bf16 v[76:79], a[156:159], a[56:59], v[76:79]
buffer_store_dwordx4 a[224:227], v1, s[4:7], s101 offen offset:0 sc1
s_add_u32 m0, s38, 160768
v_mfma_f32_16x16x32_bf16 v[80:83], a[156:159], a[60:63], v[80:83]
s_waitcnt lgkmcnt(4)
s_add_u32 s39, s38, s82
v_rcp_f32 v220, v220
v_mfma_f32_16x16x32_bf16 v[68:71], a[160:163], a[64:67], v[68:71]
ds_read_b128 a[152:155], v210 offset:11264
ds_read_b128 a[156:159], v210 offset:29696
v_mfma_f32_16x16x32_bf16 v[72:75], a[160:163], a[68:71], v[72:75]
s_add_u32 s39, s39, 188416
v_rcp_f32 v221, v221
v_mfma_f32_16x16x32_bf16 v[76:79], a[164:167], a[64:67], v[76:79]
v_rcp_f32 v222, v222
v_mfma_f32_16x16x32_bf16 v[80:83], a[164:167], a[68:71], v[80:83]
s_waitcnt lgkmcnt(4)
v_rcp_f32 v223, v223
v_mfma_f32_16x16x32_bf16 v[68:71], a[168:171], a[72:75], v[68:71]
ds_read_b128 a[160:163], v210 offset:12288
ds_read_b128 a[164:167], v210 offset:30720
v_pk_mul_f32 v[224:225], v[44:45], v[44:45]
v_pk_mul_f32 v[226:227], v[46:47], v[46:47]
v_pk_mul_f32 v[228:229], v[48:49], v[48:49]
v_pk_mul_f32 v[230:231], v[50:51], v[50:51]
v_pk_fma_f32 v[224:225], v[224:225], v[252:253], v[250:251] op_sel:[0,0,0] op_sel_hi:[1,0,0]
v_pk_fma_f32 v[226:227], v[226:227], v[252:253], v[250:251] op_sel:[0,0,0] op_sel_hi:[1,0,0]
v_pk_fma_f32 v[228:229], v[228:229], v[252:253], v[250:251] op_sel:[0,1,1] op_sel_hi:[1,1,1]
v_pk_fma_f32 v[230:231], v[230:231], v[252:253], v[250:251] op_sel:[0,1,1] op_sel_hi:[1,1,1]
v_pk_mul_f32 v[36:37], v[36:37], v[216:217]
v_pk_mul_f32 v[38:39], v[38:39], v[218:219]
v_pk_mul_f32 v[40:41], v[40:41], v[220:221]
v_pk_mul_f32 v[42:43], v[42:43], v[222:223]
v_pk_mul_f32 v[224:225], v[224:225], v[44:45]
v_pk_mul_f32 v[226:227], v[226:227], v[46:47]
v_pk_mul_f32 v[228:229], v[228:229], v[48:49]
v_pk_mul_f32 v[230:231], v[230:231], v[50:51]
v_mfma_f32_16x16x32_bf16 v[72:75], a[168:171], a[76:79], v[72:75]
s_mov_b64 exec, 0xffff
buffer_load_dwordx4 v1, s[4:7], s39 offen sc1 lds
s_mov_b64 exec, -1
v_exp_f32 v224, v224
v_mfma_f32_16x16x32_bf16 v[76:79], a[172:175], a[72:75], v[76:79]
v_exp_f32 v225, v225
v_mfma_f32_16x16x32_bf16 v[80:83], a[172:175], a[76:79], v[80:83]
s_waitcnt lgkmcnt(4)
v_exp_f32 v226, v226
v_mfma_f32_16x16x32_bf16 v[68:71], a[144:147], a[80:83], v[68:71]
ds_read_b128 a[168:171], v210 offset:13312
ds_read_b128 a[172:175], v210 offset:31744
v_mfma_f32_16x16x32_bf16 v[72:75], a[144:147], a[84:87], v[72:75]
s_mul_i32 s38, s24, 9216
v_fma_f32 v224, v224, v254, v254
v_fma_f32 v225, v225, v254, v254
v_mfma_f32_16x16x32_bf16 v[76:79], a[148:151], a[80:83], v[76:79]
s_add_u32 m0, s38, 0
v_exp_f32 v227, v227
v_mfma_f32_16x16x32_bf16 v[80:83], a[148:151], a[84:87], v[80:83]
s_waitcnt lgkmcnt(4)
v_exp_f32 v228, v228
v_mfma_f32_16x16x32_bf16 v[68:71], a[152:155], a[88:91], v[68:71]
ds_read_b128 a[144:147], v210 offset:14336
ds_read_b128 a[148:151], v210 offset:32768
v_mfma_f32_16x16x32_bf16 v[72:75], a[152:155], a[92:95], v[72:75]
s_add_u32 s39, s38, s82
v_fma_f32 v226, v226, v254, v254
v_fma_f32 v227, v227, v254, v254
v_mfma_f32_16x16x32_bf16 v[76:79], a[156:159], a[88:91], v[76:79]
s_add_u32 s39, s39, 189440
v_exp_f32 v229, v229
v_mfma_f32_16x16x32_bf16 v[80:83], a[156:159], a[92:95], v[80:83]
s_waitcnt lgkmcnt(4)
v_exp_f32 v230, v230
v_mfma_f32_16x16x32_bf16 v[68:71], a[160:163], a[96:99], v[68:71]
ds_read_b128 a[152:155], v210 offset:15360
ds_read_b128 a[156:159], v210 offset:33792
v_mfma_f32_16x16x32_bf16 v[72:75], a[160:163], a[100:103], v[72:75]
buffer_store_dwordx4 a[228:231], v1, s[4:7], s101 offen offset:1024 sc1
v_fma_f32 v228, v228, v255, v255
v_fma_f32 v229, v229, v255, v255
v_mfma_f32_16x16x32_bf16 v[76:79], a[164:167], a[96:99], v[76:79]
buffer_load_dwordx4 v1, s[4:7], s39 offen offset:0 sc1 lds
buffer_load_dwordx4 v1, s[4:7], s39 offen offset:1024 sc1 lds
v_exp_f32 v231, v231
v_mfma_f32_16x16x32_bf16 v[80:83], a[164:167], a[100:103], v[80:83]
s_waitcnt lgkmcnt(4)
v_rcp_f32 v224, v224
v_mfma_f32_16x16x32_bf16 v[68:71], a[168:171], a[104:107], v[68:71]
ds_read_b128 a[160:163], v210 offset:16384
ds_read_b128 a[164:167], v210 offset:34816
v_mfma_f32_16x16x32_bf16 v[72:75], a[168:171], a[108:111], v[72:75]
v_fma_f32 v230, v230, v255, v255
v_fma_f32 v231, v231, v255, v255
v_mfma_f32_16x16x32_bf16 v[76:79], a[172:175], a[104:107], v[76:79]
v_rcp_f32 v225, v225
v_mfma_f32_16x16x32_bf16 v[80:83], a[172:175], a[108:111], v[80:83]
s_waitcnt lgkmcnt(4)
v_rcp_f32 v226, v226
v_mfma_f32_16x16x32_bf16 v[68:71], a[144:147], a[112:115], v[68:71]
ds_read_b128 a[168:171], v210 offset:17408
ds_read_b128 a[172:175], v210 offset:35840
v_mfma_f32_16x16x32_bf16 v[72:75], a[144:147], a[116:119], v[72:75]
buffer_load_dwordx4 v1, s[4:7], s39 offen offset:2048 sc1 lds
buffer_load_dwordx4 v1, s[4:7], s39 offen offset:3072 sc1 lds
v_rcp_f32 v227, v227
v_mfma_f32_16x16x32_bf16 v[76:79], a[148:151], a[112:115], v[76:79]
s_add_u32 m0, m0, 4096
v_rcp_f32 v228, v228
v_mfma_f32_16x16x32_bf16 v[80:83], a[148:151], a[116:119], v[80:83]
s_waitcnt lgkmcnt(4)
v_add_u32 v181, 74752, v239
v_mfma_f32_16x16x32_bf16 v[68:71], a[152:155], a[120:123], v[68:71]
ds_read_b64 a[144:145], v181 offset:0
ds_read_b64 a[148:149], v181 offset:512
v_rcp_f32 v229, v229
v_mfma_f32_16x16x32_bf16 v[72:75], a[152:155], a[124:127], v[72:75]
s_add_u32 s39, s39, 4096
v_rcp_f32 v230, v230
v_mfma_f32_16x16x32_bf16 v[76:79], a[156:159], a[120:123], v[76:79]
v_rcp_f32 v231, v231
v_mfma_f32_16x16x32_bf16 v[80:83], a[156:159], a[124:127], v[80:83]
s_waitcnt lgkmcnt(4)
v_pk_mul_f32 v[216:217], v[52:53], v[52:53]
v_pk_mul_f32 v[218:219], v[54:55], v[54:55]
v_pk_mul_f32 v[220:221], v[56:57], v[56:57]
v_pk_mul_f32 v[222:223], v[58:59], v[58:59]
v_pk_fma_f32 v[216:217], v[216:217], v[252:253], v[250:251] op_sel:[0,0,0] op_sel_hi:[1,0,0]
v_pk_fma_f32 v[218:219], v[218:219], v[252:253], v[250:251] op_sel:[0,0,0] op_sel_hi:[1,0,0]
v_pk_fma_f32 v[220:221], v[220:221], v[252:253], v[250:251] op_sel:[0,1,1] op_sel_hi:[1,1,1]
v_pk_fma_f32 v[222:223], v[222:223], v[252:253], v[250:251] op_sel:[0,1,1] op_sel_hi:[1,1,1]
v_pk_mul_f32 v[44:45], v[44:45], v[224:225]
v_pk_mul_f32 v[46:47], v[46:47], v[226:227]
v_pk_mul_f32 v[48:49], v[48:49], v[228:229]
v_pk_mul_f32 v[50:51], v[50:51], v[230:231]
v_pk_mul_f32 v[216:217], v[216:217], v[52:53]
v_pk_mul_f32 v[218:219], v[218:219], v[54:55]
v_pk_mul_f32 v[220:221], v[220:221], v[56:57]
v_pk_mul_f32 v[222:223], v[222:223], v[58:59]
v_mfma_f32_16x16x32_bf16 v[68:71], a[160:163], a[128:131], v[68:71]
ds_read_b128 a[152:155], v211 offset:0
ds_read_b128 a[156:159], v211 offset:18432
v_exp_f32 v216, v216
v_mfma_f32_16x16x32_bf16 v[72:75], a[160:163], a[132:135], v[72:75]
buffer_load_dwordx4 v1, s[4:7], s39 offen offset:0 sc1 lds
buffer_load_dwordx4 v1, s[4:7], s39 offen offset:1024 sc1 lds
v_exp_f32 v217, v217
v_mfma_f32_16x16x32_bf16 v[76:79], a[164:167], a[128:131], v[76:79]
buffer_store_dwordx4 a[232:235], v1, s[4:7], s101 offen offset:2048 sc1
v_exp_f32 v218, v218
v_mfma_f32_16x16x32_bf16 v[80:83], a[164:167], a[132:135], v[80:83]
s_waitcnt lgkmcnt(4)
v_fma_f32 v216, v216, v254, v254
v_fma_f32 v217, v217, v254, v254
v_mfma_f32_16x16x32_bf16 v[68:71], a[168:171], a[136:139], v[68:71]
ds_read_b128 a[160:163], v211 offset:1024
ds_read_b128 a[164:167], v211 offset:19456
v_mfma_f32_16x16x32_bf16 v[72:75], a[168:171], a[140:143], v[72:75]
v_exp_f32 v219, v219
v_mfma_f32_16x16x32_bf16 v[76:79], a[172:175], a[136:139], v[76:79]
v_exp_f32 v220, v220
v_mfma_f32_16x16x32_bf16 v[80:83], a[172:175], a[140:143], v[80:83]
s_waitcnt lgkmcnt(4)
v_fma_f32 v218, v218, v254, v254
v_fma_f32 v219, v219, v254, v254
v_mfma_f32_16x16x16_bf16 v[68:71], a[144:145], v[212:213], v[68:71]
ds_read_b128 a[168:171], v211 offset:2048
ds_read_b128 a[172:175], v211 offset:20480
v_mfma_f32_16x16x16_bf16 v[72:75], a[144:145], v[214:215], v[72:75]
buffer_load_dwordx4 v1, s[4:7], s39 offen offset:2048 sc1 lds
buffer_load_dwordx4 v1, s[4:7], s39 offen offset:3072 sc1 lds
v_exp_f32 v221, v221
v_mfma_f32_16x16x16_bf16 v[76:79], a[148:149], v[212:213], v[76:79]
s_add_u32 m0, m0, 4096
v_exp_f32 v222, v222
v_mfma_f32_16x16x16_bf16 v[80:83], a[148:149], v[214:215], v[80:83]
s_waitcnt vmcnt(10) lgkmcnt(4)
s_barrier
v_mfma_f32_16x16x32_bf16 v[84:87], a[152:155], a[0:3], 0
ds_read_b128 a[144:147], v211 offset:3072
ds_read_b128 a[148:151], v211 offset:21504
v_fma_f32 v220, v220, v255, v255
v_fma_f32 v221, v221, v255, v255
v_mfma_f32_16x16x32_bf16 v[88:91], a[152:155], a[4:7], 0
s_add_u32 s39, s39, 4096
v_exp_f32 v223, v223
v_mfma_f32_16x16x32_bf16 v[92:95], a[156:159], a[0:3], 0
v_rcp_f32 v216, v216
v_mfma_f32_16x16x32_bf16 v[96:99], a[156:159], a[4:7], 0
s_waitcnt lgkmcnt(4)
v_fma_f32 v222, v222, v255, v255
v_fma_f32 v223, v223, v255, v255
v_mfma_f32_16x16x32_bf16 v[84:87], a[160:163], a[8:11], v[84:87]
ds_read_b128 a[152:155], v211 offset:4096
ds_read_b128 a[156:159], v211 offset:22528
v_mfma_f32_16x16x32_bf16 v[88:91], a[160:163], a[12:15], v[88:91]
buffer_load_dwordx4 v1, s[4:7], s39 offen offset:0 sc1 lds
v_rcp_f32 v217, v217
v_mfma_f32_16x16x32_bf16 v[92:95], a[164:167], a[8:11], v[92:95]
s_lshl_b32 s38, s24, 8
v_rcp_f32 v218, v218
v_mfma_f32_16x16x32_bf16 v[96:99], a[164:167], a[12:15], v[96:99]
s_waitcnt lgkmcnt(4)
v_rcp_f32 v219, v219
v_mfma_f32_16x16x32_bf16 v[84:87], a[168:171], a[16:19], v[84:87]
ds_read_b128 a[160:163], v211 offset:5120
ds_read_b128 a[164:167], v211 offset:23552
v_mfma_f32_16x16x32_bf16 v[88:91], a[168:171], a[20:23], v[88:91]
buffer_store_dwordx4 a[236:239], v1, s[4:7], s101 offen offset:3072 sc1
v_rcp_f32 v220, v220
v_mfma_f32_16x16x32_bf16 v[92:95], a[172:175], a[16:19], v[92:95]
s_add_u32 m0, s38, 36864
v_rcp_f32 v221, v221
v_mfma_f32_16x16x32_bf16 v[96:99], a[172:175], a[20:23], v[96:99]
s_waitcnt lgkmcnt(4)
v_rcp_f32 v222, v222
v_mfma_f32_16x16x32_bf16 v[84:87], a[144:147], a[24:27], v[84:87]
ds_read_b128 a[168:171], v211 offset:6144
ds_read_b128 a[172:175], v211 offset:24576
v_mfma_f32_16x16x32_bf16 v[88:91], a[144:147], a[28:31], v[88:91]
s_add_u32 s39, s38, s82
v_rcp_f32_e64 v223, v223
v_mfma_f32_16x16x32_bf16 v[92:95], a[148:151], a[24:27], v[92:95]
s_add_u32 s39, s39, 226304
v_pk_mul_f32 v[224:225], v[60:61], v[60:61]
v_pk_mul_f32 v[226:227], v[62:63], v[62:63]
v_pk_mul_f32 v[228:229], v[64:65], v[64:65]
v_pk_mul_f32 v[230:231], v[66:67], v[66:67]
v_pk_fma_f32 v[224:225], v[224:225], v[252:253], v[250:251] op_sel:[0,0,0] op_sel_hi:[1,0,0]
v_pk_fma_f32 v[226:227], v[226:227], v[252:253], v[250:251] op_sel:[0,0,0] op_sel_hi:[1,0,0]
v_pk_fma_f32 v[228:229], v[228:229], v[252:253], v[250:251] op_sel:[0,1,1] op_sel_hi:[1,1,1]
v_pk_fma_f32 v[230:231], v[230:231], v[252:253], v[250:251] op_sel:[0,1,1] op_sel_hi:[1,1,1]
v_pk_mul_f32 v[52:53], v[52:53], v[216:217]
v_pk_mul_f32 v[54:55], v[54:55], v[218:219]
v_pk_mul_f32 v[56:57], v[56:57], v[220:221]
v_pk_mul_f32 v[58:59], v[58:59], v[222:223]
v_pk_mul_f32 v[224:225], v[224:225], v[60:61]
v_pk_mul_f32 v[226:227], v[226:227], v[62:63]
v_pk_mul_f32 v[228:229], v[228:229], v[64:65]
v_pk_mul_f32 v[230:231], v[230:231], v[66:67]
v_mfma_f32_16x16x32_bf16 v[96:99], a[148:151], a[28:31], v[96:99]
s_waitcnt lgkmcnt(4)
v_exp_f32 v224, v224
v_mfma_f32_16x16x32_bf16 v[84:87], a[152:155], a[32:35], v[84:87]
ds_read_b128 a[144:147], v211 offset:7168
ds_read_b128 a[148:151], v211 offset:25600
v_exp_f32 v225, v225
v_mfma_f32_16x16x32_bf16 v[88:91], a[152:155], a[36:39], v[88:91]
v_exp_f32 v226, v226
v_mfma_f32_16x16x32_bf16 v[92:95], a[156:159], a[32:35], v[92:95]
s_mov_b64 exec, 0xffff
buffer_load_dwordx4 v1, s[4:7], s39 offen sc1 lds
s_mov_b64 exec, -1
v_mfma_f32_16x16x32_bf16 v[96:99], a[156:159], a[36:39], v[96:99]
s_waitcnt lgkmcnt(4)
v_fma_f32 v224, v224, v254, v254
v_fma_f32 v225, v225, v254, v254
v_mfma_f32_16x16x32_bf16 v[84:87], a[160:163], a[40:43], v[84:87]
ds_read_b128 a[152:155], v211 offset:8192
ds_read_b128 a[156:159], v211 offset:26624
v_exp_f32 v227, v227
v_mfma_f32_16x16x32_bf16 v[88:91], a[160:163], a[44:47], v[88:91]
v_exp_f32 v228, v228
v_mfma_f32_16x16x32_bf16 v[92:95], a[164:167], a[40:43], v[92:95]
v_fma_f32 v226, v226, v254, v254
v_fma_f32 v227, v227, v254, v254
v_mfma_f32_16x16x32_bf16 v[96:99], a[164:167], a[44:47], v[96:99]
s_waitcnt lgkmcnt(4)
v_exp_f32 v229, v229
v_mfma_f32_16x16x32_bf16 v[84:87], a[168:171], a[48:51], v[84:87]
ds_read_b128 a[160:163], v211 offset:9216
ds_read_b128 a[164:167], v211 offset:27648
v_mfma_f32_16x16x32_bf16 v[88:91], a[168:171], a[52:55], v[88:91]
v_exp_f32 v230, v230
v_mfma_f32_16x16x32_bf16 v[92:95], a[172:175], a[48:51], v[92:95]
buffer_store_dwordx4 a[240:243], v9, s[4:7], s101 offen offset:0 sc1
s_mul_i32 s38, s24, 9216
v_mfma_f32_16x16x32_bf16 v[96:99], a[172:175], a[52:55], v[96:99]
s_waitcnt lgkmcnt(4)
v_fma_f32 v228, v228, v255, v255
v_fma_f32 v229, v229, v255, v255
v_mfma_f32_16x16x32_bf16 v[84:87], a[144:147], a[56:59], v[84:87]
ds_read_b128 a[168:171], v211 offset:10240
ds_read_b128 a[172:175], v211 offset:28672
v_exp_f32 v231, v231
v_mfma_f32_16x16x32_bf16 v[88:91], a[144:147], a[60:63], v[88:91]
s_add_u32 m0, s38, 37888
v_rcp_f32 v224, v224
v_mfma_f32_16x16x32_bf16 v[92:95], a[148:151], a[56:59], v[92:95]
s_add_u32 s39, s38, s82
v_fma_f32 v230, v230, v255, v255
v_fma_f32 v231, v231, v255, v255
v_mfma_f32_16x16x32_bf16 v[96:99], a[148:151], a[60:63], v[96:99]
s_waitcnt lgkmcnt(4)
v_rcp_f32 v225, v225
v_mfma_f32_16x16x32_bf16 v[84:87], a[152:155], a[64:67], v[84:87]
ds_read_b128 a[144:147], v211 offset:11264
ds_read_b128 a[148:151], v211 offset:29696
v_mfma_f32_16x16x32_bf16 v[88:91], a[152:155], a[68:71], v[88:91]
s_add_u32 s39, s39, 227328
v_rcp_f32 v226, v226
v_mfma_f32_16x16x32_bf16 v[92:95], a[156:159], a[64:67], v[92:95]
v_rcp_f32 v227, v227
v_mfma_f32_16x16x32_bf16 v[96:99], a[156:159], a[68:71], v[96:99]
s_waitcnt lgkmcnt(4)
v_rcp_f32 v228, v228
v_mfma_f32_16x16x32_bf16 v[84:87], a[160:163], a[72:75], v[84:87]
ds_read_b128 a[152:155], v211 offset:12288
ds_read_b128 a[156:159], v211 offset:30720
v_mfma_f32_16x16x32_bf16 v[88:91], a[160:163], a[76:79], v[88:91]
buffer_load_dwordx4 v1, s[4:7], s39 offen offset:0 sc1 lds
buffer_load_dwordx4 v1, s[4:7], s39 offen offset:1024 sc1 lds
v_mfma_f32_16x16x32_bf16 v[92:95], a[164:167], a[72:75], v[92:95]
v_rcp_f32 v229, v229
v_mfma_f32_16x16x32_bf16 v[96:99], a[164:167], a[76:79], v[96:99]
s_waitcnt lgkmcnt(4)
v_rcp_f32 v230, v230
v_mfma_f32_16x16x32_bf16 v[84:87], a[168:171], a[80:83], v[84:87]
ds_read_b128 a[160:163], v211 offset:13312
ds_read_b128 a[164:167], v211 offset:31744
v_rcp_f32_e64 v231, v231
v_mfma_f32_16x16x32_bf16 v[88:91], a[168:171], a[84:87], v[88:91]
buffer_load_dwordx4 v1, s[4:7], s39 offen offset:2048 sc1 lds
buffer_load_dwordx4 v1, s[4:7], s39 offen offset:3072 sc1 lds
v_pk_mul_f32 v[216:217], v[68:69], v[68:69]
v_pk_mul_f32 v[218:219], v[70:71], v[70:71]
v_pk_mul_f32 v[220:221], v[72:73], v[72:73]
v_pk_mul_f32 v[222:223], v[74:75], v[74:75]
v_pk_fma_f32 v[216:217], v[216:217], v[252:253], v[250:251] op_sel:[0,0,0] op_sel_hi:[1,0,0]
v_pk_fma_f32 v[218:219], v[218:219], v[252:253], v[250:251] op_sel:[0,0,0] op_sel_hi:[1,0,0]
v_pk_fma_f32 v[220:221], v[220:221], v[252:253], v[250:251] op_sel:[0,1,1] op_sel_hi:[1,1,1]
v_pk_fma_f32 v[222:223], v[222:223], v[252:253], v[250:251] op_sel:[0,1,1] op_sel_hi:[1,1,1]
v_pk_mul_f32 v[60:61], v[60:61], v[224:225]
v_pk_mul_f32 v[62:63], v[62:63], v[226:227]
v_pk_mul_f32 v[64:65], v[64:65], v[228:229]
v_pk_mul_f32 v[66:67], v[66:67], v[230:231]
v_pk_mul_f32 v[216:217], v[216:217], v[68:69]
v_pk_mul_f32 v[218:219], v[218:219], v[70:71]
v_pk_mul_f32 v[220:221], v[220:221], v[72:73]
v_pk_mul_f32 v[222:223], v[222:223], v[74:75]
v_mfma_f32_16x16x32_bf16 v[92:95], a[172:175], a[80:83], v[92:95]
s_add_u32 m0, m0, 4096
v_exp_f32 v216, v216
v_mfma_f32_16x16x32_bf16 v[96:99], a[172:175], a[84:87], v[96:99]
s_waitcnt lgkmcnt(4)
v_exp_f32 v217, v217
v_mfma_f32_16x16x32_bf16 v[84:87], a[144:147], a[88:91], v[84:87]
ds_read_b128 a[168:171], v211 offset:14336
ds_read_b128 a[172:175], v211 offset:32768
v_exp_f32 v218, v218
v_mfma_f32_16x16x32_bf16 v[88:91], a[144:147], a[92:95], v[88:91]
buffer_store_dwordx4 a[244:247], v9, s[4:7], s101 offen offset:1024 sc1
v_fma_f32 v216, v216, v254, v254
v_mfma_f32_16x16x32_bf16 v[92:95], a[148:151], a[88:91], v[92:95]
s_add_u32 s39, s39, 4096
v_fma_f32 v217, v217, v254, v254
v_mfma_f32_16x16x32_bf16 v[96:99], a[148:151], a[92:95], v[96:99]
s_waitcnt lgkmcnt(4)
v_exp_f32 v219, v219
v_mfma_f32_16x16x32_bf16 v[84:87], a[152:155], a[96:99], v[84:87]
ds_read_b128 a[144:147], v211 offset:15360
ds_read_b128 a[148:151], v211 offset:33792
v_exp_f32 v220, v220
v_mfma_f32_16x16x32_bf16 v[88:91], a[152:155], a[100:103], v[88:91]
v_fma_f32 v218, v218, v254, v254
v_fma_f32 v219, v219, v254, v254
v_mfma_f32_16x16x32_bf16 v[92:95], a[156:159], a[96:99], v[92:95]
v_exp_f32 v221, v221
v_mfma_f32_16x16x32_bf16 v[96:99], a[156:159], a[100:103], v[96:99]
s_waitcnt lgkmcnt(4)
v_exp_f32 v222, v222
v_mfma_f32_16x16x32_bf16 v[84:87], a[160:163], a[104:107], v[84:87]
ds_read_b128 a[152:155], v211 offset:16384
ds_read_b128 a[156:159], v211 offset:34816
v_mfma_f32_16x16x32_bf16 v[88:91], a[160:163], a[108:111], v[88:91]
buffer_load_dwordx4 v1, s[4:7], s39 offen offset:0 sc1 lds
buffer_load_dwordx4 v1, s[4:7], s39 offen offset:1024 sc1 lds
v_mfma_f32_16x16x32_bf16 v[92:95], a[164:167], a[104:107], v[92:95]
v_fma_f32 v220, v220, v255, v255
v_fma_f32 v221, v221, v255, v255
v_mfma_f32_16x16x32_bf16 v[96:99], a[164:167], a[108:111], v[96:99]
s_waitcnt lgkmcnt(4)
v_exp_f32 v223, v223
v_mfma_f32_16x16x32_bf16 v[84:87], a[168:171], a[112:115], v[84:87]
ds_read_b128 a[160:163], v211 offset:17408
ds_read_b128 a[164:167], v211 offset:35840
v_rcp_f32 v216, v216
v_mfma_f32_16x16x32_bf16 v[88:91], a[168:171], a[116:119], v[88:91]
buffer_load_dwordx4 v1, s[4:7], s39 offen offset:2048 sc1 lds
buffer_load_dwordx4 v1, s[4:7], s39 offen offset:3072 sc1 lds
v_mfma_f32_16x16x32_bf16 v[92:95], a[172:175], a[112:115], v[92:95]
s_add_u32 m0, m0, 4096
v_fma_f32 v222, v222, v255, v255
v_fma_f32 v223, v223, v255, v255
v_mfma_f32_16x16x32_bf16 v[96:99], a[172:175], a[116:119], v[96:99]
s_waitcnt lgkmcnt(4)
v_rcp_f32 v217, v217
v_add_u32 v181, 112640, v239
v_mfma_f32_16x16x32_bf16 v[84:87], a[144:147], a[120:123], v[84:87]
ds_read_b64 a[168:169], v181 offset:0
ds_read_b64 a[172:173], v181 offset:512
v_rcp_f32 v218, v218
v_mfma_f32_16x16x32_bf16 v[88:91], a[144:147], a[124:127], v[88:91]
s_add_u32 s39, s39, 4096
v_rcp_f32 v219, v219
v_mfma_f32_16x16x32_bf16 v[92:95], a[148:151], a[120:123], v[92:95]
buffer_store_dwordx4 a[248:251], v9, s[4:7], s101 offen offset:2048 sc1
v_mfma_f32_16x16x32_bf16 v[96:99], a[148:151], a[124:127], v[96:99]
s_waitcnt lgkmcnt(4)
v_rcp_f32 v220, v220
v_mfma_f32_16x16x32_bf16 v[84:87], a[152:155], a[128:131], v[84:87]
ds_read_b128 a[144:147], v208 offset:0
ds_read_b128 a[148:151], v208 offset:1024
v_mfma_f32_16x16x32_bf16 v[88:91], a[152:155], a[132:135], v[88:91]
v_rcp_f32 v221, v221
v_mfma_f32_16x16x32_bf16 v[92:95], a[156:159], a[128:131], v[92:95]
v_rcp_f32 v222, v222
v_mfma_f32_16x16x32_bf16 v[96:99], a[156:159], a[132:135], v[96:99]
s_waitcnt lgkmcnt(4)
v_rcp_f32_e64 v223, v223
v_mfma_f32_16x16x32_bf16 v[84:87], a[160:163], a[136:139], v[84:87]
ds_read_b128 a[152:155], v208 offset:2048
ds_read_b128 a[156:159], v208 offset:3072
v_pk_mul_f32 v[224:225], v[76:77], v[76:77]
v_pk_mul_f32 v[226:227], v[78:79], v[78:79]
v_pk_mul_f32 v[228:229], v[80:81], v[80:81]
v_pk_mul_f32 v[230:231], v[82:83], v[82:83]
v_pk_fma_f32 v[224:225], v[224:225], v[252:253], v[250:251] op_sel:[0,0,0] op_sel_hi:[1,0,0]
v_pk_fma_f32 v[226:227], v[226:227], v[252:253], v[250:251] op_sel:[0,0,0] op_sel_hi:[1,0,0]
v_pk_fma_f32 v[228:229], v[228:229], v[252:253], v[250:251] op_sel:[0,1,1] op_sel_hi:[1,1,1]
v_pk_fma_f32 v[230:231], v[230:231], v[252:253], v[250:251] op_sel:[0,1,1] op_sel_hi:[1,1,1]
v_pk_mul_f32 v[68:69], v[68:69], v[216:217]
v_pk_mul_f32 v[70:71], v[70:71], v[218:219]
v_pk_mul_f32 v[72:73], v[72:73], v[220:221]
v_pk_mul_f32 v[74:75], v[74:75], v[222:223]
v_pk_mul_f32 v[224:225], v[224:225], v[76:77]
v_pk_mul_f32 v[226:227], v[226:227], v[78:79]
v_pk_mul_f32 v[228:229], v[228:229], v[80:81]
v_pk_mul_f32 v[230:231], v[230:231], v[82:83]
v_mfma_f32_16x16x32_bf16 v[88:91], a[160:163], a[140:143], v[88:91]
buffer_load_dwordx4 v1, s[4:7], s39 offen offset:0 sc1 lds
s_lshl_b32 s38, s24, 8
v_exp_f32 v224, v224
v_mfma_f32_16x16x32_bf16 v[92:95], a[164:167], a[136:139], v[92:95]
s_add_u32 m0, s38, 74752
v_exp_f32 v225, v225
v_mfma_f32_16x16x32_bf16 v[96:99], a[164:167], a[140:143], v[96:99]
s_waitcnt lgkmcnt(4)
v_exp_f32 v226, v226
v_mfma_f32_16x16x16_bf16 v[84:87], a[168:169], v[212:213], v[84:87]
ds_read_b128 a[160:163], v208 offset:4096
ds_read_b128 a[164:167], v208 offset:5120
v_mfma_f32_16x16x16_bf16 v[88:91], a[168:169], v[214:215], v[88:91]
s_add_u32 s39, s38, s82
v_fma_f32 v224, v224, v254, v254
v_fma_f32 v225, v225, v254, v254
v_mfma_f32_16x16x16_bf16 v[92:95], a[172:173], v[212:213], v[92:95]
s_add_u32 s39, s39, 264192
v_exp_f32 v227, v227
v_mfma_f32_16x16x16_bf16 v[96:99], a[172:173], v[214:215], v[96:99]
s_waitcnt lgkmcnt(4)
v_exp_f32 v228, v228
s_waitcnt vmcnt(12)
s_barrier
v_mfma_f32_16x16x32_bf16 v[100:103], a[144:147], a[0:3], 0
ds_read_b128 a[168:171], v208 offset:6144
ds_read_b128 a[172:175], v208 offset:7168
v_mfma_f32_16x16x32_bf16 v[104:107], a[144:147], a[4:7], 0
v_fma_f32 v226, v226, v254, v254
v_fma_f32 v227, v227, v254, v254
v_mfma_f32_16x16x32_bf16 v[100:103], a[148:151], a[8:11], v[100:103]
v_exp_f32 v229, v229
v_mfma_f32_16x16x32_bf16 v[104:107], a[148:151], a[12:15], v[104:107]
s_waitcnt lgkmcnt(4)
v_exp_f32 v230, v230
v_mfma_f32_16x16x32_bf16 v[100:103], a[152:155], a[16:19], v[100:103]
ds_read_b128 a[144:147], v208 offset:8192
ds_read_b128 a[148:151], v208 offset:9216
v_mfma_f32_16x16x32_bf16 v[104:107], a[152:155], a[20:23], v[104:107]
s_mov_b64 exec, 0xffff
buffer_load_dwordx4 v1, s[4:7], s39 offen sc1 lds
s_mov_b64 exec, -1
v_fma_f32 v228, v228, v255, v255
v_fma_f32 v229, v229, v255, v255
v_mfma_f32_16x16x32_bf16 v[100:103], a[156:159], a[24:27], v[100:103]
buffer_store_dwordx4 a[252:255], v9, s[4:7], s101 offen offset:3072 sc1
v_exp_f32 v231, v231
v_mfma_f32_16x16x32_bf16 v[104:107], a[156:159], a[28:31], v[104:107]
s_waitcnt lgkmcnt(4)
v_rcp_f32 v224, v224
v_mfma_f32_16x16x32_bf16 v[100:103], a[160:163], a[32:35], v[100:103]
ds_read_b128 a[152:155], v208 offset:10240
ds_read_b128 a[156:159], v208 offset:11264
v_mfma_f32_16x16x32_bf16 v[104:107], a[160:163], a[36:39], v[104:107]
s_mov_b32 s101, 1073741824
v_fma_f32 v230, v230, v255, v255
v_fma_f32 v231, v231, v255, v255
v_mfma_f32_16x16x32_bf16 v[100:103], a[164:167], a[40:43], v[100:103]
v_rcp_f32 v225, v225
v_mfma_f32_16x16x32_bf16 v[104:107], a[164:167], a[44:47], v[104:107]
s_waitcnt lgkmcnt(4)
v_rcp_f32 v226, v226
v_mfma_f32_16x16x32_bf16 v[100:103], a[168:171], a[48:51], v[100:103]
ds_read_b128 a[160:163], v208 offset:12288
ds_read_b128 a[164:167], v208 offset:13312
v_mfma_f32_16x16x32_bf16 v[104:107], a[168:171], a[52:55], v[104:107]
s_mul_i32 s38, s24, 9216
v_rcp_f32 v227, v227
v_mfma_f32_16x16x32_bf16 v[100:103], a[172:175], a[56:59], v[100:103]
s_add_u32 m0, s38, 75776
v_rcp_f32 v228, v228
v_mfma_f32_16x16x32_bf16 v[104:107], a[172:175], a[60:63], v[104:107]
s_waitcnt lgkmcnt(4)
v_rcp_f32 v229, v229
v_mfma_f32_16x16x32_bf16 v[100:103], a[144:147], a[64:67], v[100:103]
ds_read_b128 a[168:171], v208 offset:14336
ds_read_b128 a[172:175], v208 offset:15360
v_mfma_f32_16x16x32_bf16 v[104:107], a[144:147], a[68:71], v[104:107]
s_add_u32 s39, s38, s82
v_rcp_f32 v230, v230
v_mfma_f32_16x16x32_bf16 v[100:103], a[148:151], a[72:75], v[100:103]
s_add_u32 s39, s39, 265216
v_rcp_f32 v231, v231
v_mfma_f32_16x16x32_bf16 v[104:107], a[148:151], a[76:79], v[104:107]
s_waitcnt lgkmcnt(4)
v_pk_mul_f32 v[216:217], v[84:85], v[84:85]
v_pk_mul_f32 v[218:219], v[86:87], v[86:87]
v_pk_mul_f32 v[220:221], v[88:89], v[88:89]
v_pk_mul_f32 v[222:223], v[90:91], v[90:91]
v_pk_fma_f32 v[216:217], v[216:217], v[252:253], v[250:251] op_sel:[0,0,0] op_sel_hi:[1,0,0]
v_pk_fma_f32 v[218:219], v[218:219], v[252:253], v[250:251] op_sel:[0,0,0] op_sel_hi:[1,0,0]
v_pk_fma_f32 v[220:221], v[220:221], v[252:253], v[250:251] op_sel:[0,1,1] op_sel_hi:[1,1,1]
v_pk_fma_f32 v[222:223], v[222:223], v[252:253], v[250:251] op_sel:[0,1,1] op_sel_hi:[1,1,1]
v_pk_mul_f32 v[76:77], v[76:77], v[224:225]
v_pk_mul_f32 v[78:79], v[78:79], v[226:227]
v_pk_mul_f32 v[80:81], v[80:81], v[228:229]
v_pk_mul_f32 v[82:83], v[82:83], v[230:231]
v_pk_mul_f32 v[216:217], v[216:217], v[84:85]
v_pk_mul_f32 v[218:219], v[218:219], v[86:87]
v_pk_mul_f32 v[220:221], v[220:221], v[88:89]
v_pk_mul_f32 v[222:223], v[222:223], v[90:91]
v_mfma_f32_16x16x32_bf16 v[100:103], a[152:155], a[80:83], v[100:103]
ds_read_b128 a[144:147], v208 offset:16384
ds_read_b128 a[148:151], v208 offset:17408
v_exp_f32 v216, v216
v_mfma_f32_16x16x32_bf16 v[104:107], a[152:155], a[84:87], v[104:107]
v_exp_f32 v217, v217
v_mfma_f32_16x16x32_bf16 v[100:103], a[156:159], a[88:91], v[100:103]
buffer_load_dwordx4 v1, s[4:7], s39 offen offset:0 sc1 lds
buffer_load_dwordx4 v1, s[4:7], s39 offen offset:1024 sc1 lds
v_exp_f32 v218, v218
v_mfma_f32_16x16x32_bf16 v[104:107], a[156:159], a[92:95], v[104:107]
s_waitcnt lgkmcnt(4)
v_fma_f32 v216, v216, v254, v254
v_add_u32 v181, 160768, v239
v_mfma_f32_16x16x32_bf16 v[100:103], a[160:163], a[96:99], v[100:103]
ds_read_b64 a[152:153], v181 offset:0
ds_read_b128 a[156:159], v208 offset:18432
v_fma_f32 v217, v217, v254, v254
v_mfma_f32_16x16x32_bf16 v[104:107], a[160:163], a[100:103], v[104:107]
v_exp_f32 v219, v219
v_mfma_f32_16x16x32_bf16 v[100:103], a[164:167], a[104:107], v[100:103]
v_exp_f32 v220, v220
v_mfma_f32_16x16x32_bf16 v[104:107], a[164:167], a[108:111], v[104:107]
s_waitcnt lgkmcnt(4)
v_fma_f32 v218, v218, v254, v254
v_fma_f32 v219, v219, v254, v254
v_mfma_f32_16x16x32_bf16 v[100:103], a[168:171], a[112:115], v[100:103]
ds_read_b128 a[160:163], v208 offset:19456
ds_read_b128 a[164:167], v208 offset:20480
v_mfma_f32_16x16x32_bf16 v[104:107], a[168:171], a[116:119], v[104:107]
buffer_load_dwordx4 v1, s[4:7], s39 offen offset:2048 sc1 lds
buffer_load_dwordx4 v1, s[4:7], s39 offen offset:3072 sc1 lds
v_exp_f32 v221, v221
v_mfma_f32_16x16x32_bf16 v[100:103], a[172:175], a[120:123], v[100:103]
s_add_u32 m0, m0, 4096
v_exp_f32 v222, v222
v_mfma_f32_16x16x32_bf16 v[104:107], a[172:175], a[124:127], v[104:107]
s_waitcnt lgkmcnt(4)
v_fma_f32 v220, v220, v255, v255
v_fma_f32 v221, v221, v255, v255
v_mfma_f32_16x16x32_bf16 v[100:103], a[144:147], a[128:131], v[100:103]
ds_read_b128 a[168:171], v208 offset:21504
ds_read_b128 a[172:175], v208 offset:22528
v_mfma_f32_16x16x32_bf16 v[104:107], a[144:147], a[132:135], v[104:107]
s_add_u32 s39, s39, 4096
v_exp_f32 v223, v223
v_mfma_f32_16x16x32_bf16 v[100:103], a[148:151], a[136:139], v[100:103]
v_rcp_f32 v216, v216
v_mfma_f32_16x16x32_bf16 v[104:107], a[148:151], a[140:143], v[104:107]
s_waitcnt lgkmcnt(4)
v_fma_f32 v222, v222, v255, v255
v_fma_f32 v223, v223, v255, v255
v_mfma_f32_16x16x16_bf16 v[100:103], a[152:153], v[212:213], v[100:103]
ds_read_b128 a[144:147], v208 offset:23552
ds_read_b128 a[148:151], v208 offset:24576
v_mfma_f32_16x16x16_bf16 v[104:107], a[152:153], v[214:215], v[104:107]
buffer_load_dwordx4 v1, s[4:7], s39 offen offset:0 sc1 lds
buffer_load_dwordx4 v1, s[4:7], s39 offen offset:1024 sc1 lds
v_rcp_f32 v217, v217
v_mfma_f32_16x16x32_bf16 v[108:111], a[156:159], a[0:3], 0
v_rcp_f32 v218, v218
v_mfma_f32_16x16x32_bf16 v[112:115], a[156:159], a[4:7], 0
s_waitcnt lgkmcnt(4)
v_rcp_f32 v219, v219
v_mfma_f32_16x16x32_bf16 v[108:111], a[160:163], a[8:11], v[108:111]
ds_read_b128 a[152:155], v208 offset:25600
ds_read_b128 a[156:159], v208 offset:26624
v_mfma_f32_16x16x32_bf16 v[112:115], a[160:163], a[12:15], v[112:115]
v_rcp_f32 v220, v220
v_mfma_f32_16x16x32_bf16 v[108:111], a[164:167], a[16:19], v[108:111]
v_rcp_f32 v221, v221
v_mfma_f32_16x16x32_bf16 v[112:115], a[164:167], a[20:23], v[112:115]
s_waitcnt lgkmcnt(4)
v_rcp_f32 v222, v222
v_mfma_f32_16x16x32_bf16 v[108:111], a[168:171], a[24:27], v[108:111]
ds_read_b128 a[160:163], v208 offset:27648
ds_read_b128 a[164:167], v208 offset:28672
v_mfma_f32_16x16x32_bf16 v[112:115], a[168:171], a[28:31], v[112:115]
buffer_load_dwordx4 v1, s[4:7], s39 offen offset:2048 sc1 lds
buffer_load_dwordx4 v1, s[4:7], s39 offen offset:3072 sc1 lds
v_rcp_f32 v223, v223
v_mfma_f32_16x16x32_bf16 v[108:111], a[172:175], a[32:35], v[108:111]
s_add_u32 m0, m0, 4096
v_pk_mul_f32 v[224:225], v[92:93], v[92:93]
v_pk_mul_f32 v[226:227], v[94:95], v[94:95]
v_pk_mul_f32 v[228:229], v[96:97], v[96:97]
v_pk_mul_f32 v[230:231], v[98:99], v[98:99]
v_pk_fma_f32 v[224:225], v[224:225], v[252:253], v[250:251] op_sel:[0,0,0] op_sel_hi:[1,0,0]
v_pk_fma_f32 v[226:227], v[226:227], v[252:253], v[250:251] op_sel:[0,0,0] op_sel_hi:[1,0,0]
v_pk_fma_f32 v[228:229], v[228:229], v[252:253], v[250:251] op_sel:[0,1,1] op_sel_hi:[1,1,1]
v_pk_fma_f32 v[230:231], v[230:231], v[252:253], v[250:251] op_sel:[0,1,1] op_sel_hi:[1,1,1]
v_pk_mul_f32 v[84:85], v[84:85], v[216:217]
v_pk_mul_f32 v[86:87], v[86:87], v[218:219]
v_pk_mul_f32 v[88:89], v[88:89], v[220:221]
v_pk_mul_f32 v[90:91], v[90:91], v[222:223]
v_pk_mul_f32 v[224:225], v[224:225], v[92:93]
v_pk_mul_f32 v[226:227], v[226:227], v[94:95]
v_pk_mul_f32 v[228:229], v[228:229], v[96:97]
v_pk_mul_f32 v[230:231], v[230:231], v[98:99]
v_mfma_f32_16x16x32_bf16 v[112:115], a[172:175], a[36:39], v[112:115]
s_waitcnt lgkmcnt(4)
v_exp_f32 v224, v224
v_mfma_f32_16x16x32_bf16 v[108:111], a[144:147], a[40:43], v[108:111]
ds_read_b128 a[168:171], v208 offset:29696
ds_read_b128 a[172:175], v208 offset:30720
v_exp_f32 v225, v225
v_mfma_f32_16x16x32_bf16 v[112:115], a[144:147], a[44:47], v[112:115]
s_add_u32 s39, s39, 4096
v_exp_f32 v226, v226
v_mfma_f32_16x16x32_bf16 v[108:111], a[148:151], a[48:51], v[108:111]
v_fma_f32 v224, v224, v254, v254
v_fma_f32 v225, v225, v254, v254
v_mfma_f32_16x16x32_bf16 v[112:115], a[148:151], a[52:55], v[112:115]
s_waitcnt lgkmcnt(4)
v_exp_f32 v227, v227
v_mfma_f32_16x16x32_bf16 v[108:111], a[152:155], a[56:59], v[108:111]
ds_read_b128 a[144:147], v208 offset:31744
ds_read_b128 a[148:151], v208 offset:32768
v_mfma_f32_16x16x32_bf16 v[112:115], a[152:155], a[60:63], v[112:115]
buffer_load_dwordx4 v1, s[4:7], s39 offen offset:0 sc1 lds
v_exp_f32 v228, v228
v_mfma_f32_16x16x32_bf16 v[108:111], a[156:159], a[64:67], v[108:111]
s_lshl_b32 s38, s24, 8
v_fma_f32 v226, v226, v254, v254
v_fma_f32 v227, v227, v254, v254
v_mfma_f32_16x16x32_bf16 v[112:115], a[156:159], a[68:71], v[112:115]
s_waitcnt lgkmcnt(4)
v_exp_f32 v229, v229
v_mfma_f32_16x16x32_bf16 v[108:111], a[160:163], a[72:75], v[108:111]
ds_read_b128 a[152:155], v208 offset:33792
ds_read_b128 a[156:159], v208 offset:34816
v_mfma_f32_16x16x32_bf16 v[112:115], a[160:163], a[76:79], v[112:115]
s_add_u32 m0, s38, 112640
v_exp_f32 v230, v230
v_mfma_f32_16x16x32_bf16 v[108:111], a[164:167], a[80:83], v[108:111]
s_add_u32 s39, s38, s82
v_fma_f32 v228, v228, v255, v255
v_fma_f32 v229, v229, v255, v255
v_mfma_f32_16x16x32_bf16 v[112:115], a[164:167], a[84:87], v[112:115]
s_waitcnt lgkmcnt(4)
v_exp_f32 v231, v231
v_mfma_f32_16x16x32_bf16 v[108:111], a[168:171], a[88:91], v[108:111]
ds_read_b128 a[160:163], v208 offset:35840
ds_read_b64 a[164:165], v181 offset:512
v_mfma_f32_16x16x32_bf16 v[112:115], a[168:171], a[92:95], v[112:115]
s_add_u32 s39, s39, 302080
v_rcp_f32 v224, v224
v_mfma_f32_16x16x32_bf16 v[108:111], a[172:175], a[96:99], v[108:111]
v_fma_f32 v230, v230, v255, v255
v_fma_f32 v231, v231, v255, v255
v_mfma_f32_16x16x32_bf16 v[112:115], a[172:175], a[100:103], v[112:115]
s_waitcnt lgkmcnt(4)
v_rcp_f32 v225, v225
v_mfma_f32_16x16x32_bf16 v[108:111], a[144:147], a[104:107], v[108:111]
ds_read_b128 a[168:171], v209 offset:0
ds_read_b128 a[172:175], v209 offset:18432
v_mfma_f32_16x16x32_bf16 v[112:115], a[144:147], a[108:111], v[112:115]
v_rcp_f32 v226, v226
v_mfma_f32_16x16x32_bf16 v[108:111], a[148:151], a[112:115], v[108:111]
s_mov_b64 exec, 0xffff
buffer_load_dwordx4 v1, s[4:7], s39 offen sc1 lds
s_mov_b64 exec, -1
v_mfma_f32_16x16x32_bf16 v[112:115], a[148:151], a[116:119], v[112:115]
s_waitcnt lgkmcnt(4)
v_rcp_f32 v227, v227
v_mfma_f32_16x16x32_bf16 v[108:111], a[152:155], a[120:123], v[108:111]
ds_read_b128 a[144:147], v209 offset:1024
ds_read_b128 a[148:151], v209 offset:19456
v_rcp_f32 v228, v228
v_mfma_f32_16x16x32_bf16 v[112:115], a[152:155], a[124:127], v[112:115]
v_rcp_f32 v229, v229
v_mfma_f32_16x16x32_bf16 v[108:111], a[156:159], a[128:131], v[108:111]
v_rcp_f32 v230, v230
v_mfma_f32_16x16x32_bf16 v[112:115], a[156:159], a[132:135], v[112:115]
s_waitcnt lgkmcnt(4)
v_rcp_f32 v231, v231
v_mfma_f32_16x16x32_bf16 v[108:111], a[160:163], a[136:139], v[108:111]
ds_read_b128 a[152:155], v209 offset:2048
ds_read_b128 a[156:159], v209 offset:20480
v_pk_mul_f32 v[216:217], v[100:101], v[100:101]
v_pk_mul_f32 v[218:219], v[102:103], v[102:103]
v_pk_mul_f32 v[220:221], v[104:105], v[104:105]
v_pk_mul_f32 v[222:223], v[106:107], v[106:107]
v_pk_fma_f32 v[216:217], v[216:217], v[252:253], v[250:251] op_sel:[0,0,0] op_sel_hi:[1,0,0]
v_pk_fma_f32 v[218:219], v[218:219], v[252:253], v[250:251] op_sel:[0,0,0] op_sel_hi:[1,0,0]
v_pk_fma_f32 v[220:221], v[220:221], v[252:253], v[250:251] op_sel:[0,1,1] op_sel_hi:[1,1,1]
v_pk_fma_f32 v[222:223], v[222:223], v[252:253], v[250:251] op_sel:[0,1,1] op_sel_hi:[1,1,1]
v_pk_mul_f32 v[92:93], v[92:93], v[224:225]
v_pk_mul_f32 v[94:95], v[94:95], v[226:227]
v_pk_mul_f32 v[96:97], v[96:97], v[228:229]
v_pk_mul_f32 v[98:99], v[98:99], v[230:231]
v_pk_mul_f32 v[216:217], v[216:217], v[100:101]
v_pk_mul_f32 v[218:219], v[218:219], v[102:103]
v_pk_mul_f32 v[220:221], v[220:221], v[104:105]
v_pk_mul_f32 v[222:223], v[222:223], v[106:107]
v_mfma_f32_16x16x32_bf16 v[112:115], a[160:163], a[140:143], v[112:115]
v_exp_f32 v216, v216
v_mfma_f32_16x16x16_bf16 v[108:111], a[164:165], v[212:213], v[108:111]
v_exp_f32 v217, v217
v_mfma_f32_16x16x16_bf16 v[112:115], a[164:165], v[214:215], v[112:115]
s_waitcnt vmcnt(11) lgkmcnt(4)
s_barrier
v_mfma_f32_16x16x32_bf16 v[116:119], a[168:171], a[0:3], 0
ds_read_b128 a[160:163], v209 offset:3072
ds_read_b128 a[164:167], v209 offset:21504
v_exp_f32 v218, v218
v_mfma_f32_16x16x32_bf16 v[120:123], a[168:171], a[4:7], 0
s_mul_i32 s38, s24, 9216
s_add_u32 m0, s38, 123904
v_fma_f32 v216, v216, v254, v254
v_mfma_f32_16x16x32_bf16 v[124:127], a[172:175], a[0:3], 0
s_add_u32 s39, s38, s82
v_fma_f32 v217, v217, v254, v254
v_mfma_f32_16x16x32_bf16 v[128:131], a[172:175], a[4:7], 0
s_waitcnt lgkmcnt(4)
s_add_u32 s39, s39, 303104
v_exp_f32 v219, v219
v_mfma_f32_16x16x32_bf16 v[116:119], a[144:147], a[8:11], v[116:119]
ds_read_b128 a[168:171], v209 offset:4096
ds_read_b128 a[172:175], v209 offset:22528
v_exp_f32 v220, v220
v_mfma_f32_16x16x32_bf16 v[120:123], a[144:147], a[12:15], v[120:123]
buffer_load_dwordx4 v1, s[4:7], s39 offen offset:0 sc1 lds
buffer_load_dwordx4 v1, s[4:7], s39 offen offset:1024 sc1 lds
v_mfma_f32_16x16x32_bf16 v[124:127], a[148:151], a[8:11], v[124:127]
v_fma_f32 v218, v218, v254, v254
v_fma_f32 v219, v219, v254, v254
v_mfma_f32_16x16x32_bf16 v[128:131], a[148:151], a[12:15], v[128:131]
s_waitcnt lgkmcnt(4)
v_exp_f32 v221, v221
v_mfma_f32_16x16x32_bf16 v[116:119], a[152:155], a[16:19], v[116:119]
ds_read_b128 a[144:147], v209 offset:5120
ds_read_b128 a[148:151], v209 offset:23552
v_exp_f32 v222, v222
v_mfma_f32_16x16x32_bf16 v[120:123], a[152:155], a[20:23], v[120:123]
buffer_load_dwordx4 v1, s[4:7], s39 offen offset:2048 sc1 lds
buffer_load_dwordx4 v1, s[4:7], s39 offen offset:3072 sc1 lds
v_mfma_f32_16x16x32_bf16 v[124:127], a[156:159], a[16:19], v[124:127]
s_add_u32 m0, m0, 4096
v_fma_f32 v220, v220, v255, v255
v_fma_f32 v221, v221, v255, v255
v_mfma_f32_16x16x32_bf16 v[128:131], a[156:159], a[20:23], v[128:131]
s_waitcnt lgkmcnt(4)
s_add_u32 s39, s39, 4096
v_exp_f32 v223, v223
v_mfma_f32_16x16x32_bf16 v[116:119], a[160:163], a[24:27], v[116:119]
ds_read_b128 a[152:155], v209 offset:6144
ds_read_b128 a[156:159], v209 offset:24576
v_rcp_f32 v216, v216
v_mfma_f32_16x16x32_bf16 v[120:123], a[160:163], a[28:31], v[120:123]
buffer_load_dwordx4 v1, s[4:7], s39 offen offset:0 sc1 lds
buffer_load_dwordx4 v1, s[4:7], s39 offen offset:1024 sc1 lds
v_mfma_f32_16x16x32_bf16 v[124:127], a[164:167], a[24:27], v[124:127]
v_fma_f32 v222, v222, v255, v255
v_fma_f32 v223, v223, v255, v255
v_mfma_f32_16x16x32_bf16 v[128:131], a[164:167], a[28:31], v[128:131]
s_waitcnt lgkmcnt(4)
v_rcp_f32 v217, v217
v_mfma_f32_16x16x32_bf16 v[116:119], a[168:171], a[32:35], v[116:119]
ds_read_b128 a[160:163], v209 offset:7168
ds_read_b128 a[164:167], v209 offset:25600
v_rcp_f32 v218, v218
v_mfma_f32_16x16x32_bf16 v[120:123], a[168:171], a[36:39], v[120:123]
buffer_load_dwordx4 v1, s[4:7], s39 offen offset:2048 sc1 lds
buffer_load_dwordx4 v1, s[4:7], s39 offen offset:3072 sc1 lds
v_mfma_f32_16x16x32_bf16 v[124:127], a[172:175], a[32:35], v[124:127]
s_add_u32 m0, m0, 4096
s_add_u32 s39, s39, 4096
v_rcp_f32 v219, v219
v_mfma_f32_16x16x32_bf16 v[128:131], a[172:175], a[36:39], v[128:131]
s_waitcnt lgkmcnt(4)
v_rcp_f32 v220, v220
v_mfma_f32_16x16x32_bf16 v[116:119], a[144:147], a[40:43], v[116:119]
ds_read_b128 a[168:171], v209 offset:8192
ds_read_b128 a[172:175], v209 offset:26624
v_rcp_f32 v221, v221
v_rcp_f32 v222, v222
v_rcp_f32 v223, v223
v_mfma_f32_16x16x32_bf16 v[120:123], a[144:147], a[44:47], v[120:123]
buffer_load_dwordx4 v1, s[4:7], s39 offen offset:0 sc1 lds
s_lshl_b32 s38, s24, 8
s_nop 0
v_pk_mul_f32 v[100:101], v[100:101], v[216:217]
v_pk_mul_f32 v[102:103], v[102:103], v[218:219]
v_pk_mul_f32 v[104:105], v[104:105], v[220:221]
v_pk_mul_f32 v[106:107], v[106:107], v[222:223]
v_pk_add_f32 v[198:199], v[36:37], v[38:39]
v_pk_mul_f32 v[200:201], v[36:37], v[36:37]
v_pk_fma_f32 v[200:201], v[38:39], v[38:39], v[200:201]
v_pk_add_f32 v[202:203], v[40:41], v[42:43]
v_pk_mul_f32 v[204:205], v[40:41], v[40:41]
v_pk_fma_f32 v[204:205], v[42:43], v[42:43], v[204:205]
v_pk_add_f32 v[198:199], v[198:199], v[44:45]
v_pk_fma_f32 v[200:201], v[44:45], v[44:45], v[200:201]
v_pk_add_f32 v[198:199], v[198:199], v[46:47]
v_pk_fma_f32 v[200:201], v[46:47], v[46:47], v[200:201]
v_pk_add_f32 v[202:203], v[202:203], v[48:49]
v_pk_fma_f32 v[204:205], v[48:49], v[48:49], v[204:205]
v_pk_add_f32 v[202:203], v[202:203], v[50:51]
v_pk_fma_f32 v[204:205], v[50:51], v[50:51], v[204:205]
v_pk_add_f32 v[198:199], v[198:199], v[52:53]
v_pk_fma_f32 v[200:201], v[52:53], v[52:53], v[200:201]
v_pk_add_f32 v[198:199], v[198:199], v[54:55]
v_pk_fma_f32 v[200:201], v[54:55], v[54:55], v[200:201]
v_pk_add_f32 v[202:203], v[202:203], v[56:57]
v_pk_fma_f32 v[204:205], v[56:57], v[56:57], v[204:205]
v_pk_add_f32 v[202:203], v[202:203], v[58:59]
v_pk_fma_f32 v[204:205], v[58:59], v[58:59], v[204:205]
v_pk_add_f32 v[198:199], v[198:199], v[60:61]
v_pk_fma_f32 v[200:201], v[60:61], v[60:61], v[200:201]
v_pk_add_f32 v[198:199], v[198:199], v[62:63]
v_pk_fma_f32 v[200:201], v[62:63], v[62:63], v[200:201]
v_pk_add_f32 v[202:203], v[202:203], v[64:65]
v_pk_fma_f32 v[204:205], v[64:65], v[64:65], v[204:205]
v_pk_add_f32 v[202:203], v[202:203], v[66:67]
v_pk_fma_f32 v[204:205], v[66:67], v[66:67], v[204:205]
v_pk_add_f32 v[198:199], v[198:199], v[68:69]
v_pk_fma_f32 v[200:201], v[68:69], v[68:69], v[200:201]
v_pk_add_f32 v[198:199], v[198:199], v[70:71]
v_pk_fma_f32 v[200:201], v[70:71], v[70:71], v[200:201]
v_pk_add_f32 v[202:203], v[202:203], v[72:73]
v_pk_fma_f32 v[204:205], v[72:73], v[72:73], v[204:205]
v_pk_add_f32 v[202:203], v[202:203], v[74:75]
v_pk_fma_f32 v[204:205], v[74:75], v[74:75], v[204:205]
v_pk_add_f32 v[198:199], v[198:199], v[76:77]
v_pk_fma_f32 v[200:201], v[76:77], v[76:77], v[200:201]
v_pk_add_f32 v[198:199], v[198:199], v[78:79]
v_pk_fma_f32 v[200:201], v[78:79], v[78:79], v[200:201]
v_pk_add_f32 v[202:203], v[202:203], v[80:81]
v_pk_fma_f32 v[204:205], v[80:81], v[80:81], v[204:205]
v_pk_add_f32 v[202:203], v[202:203], v[82:83]
v_pk_fma_f32 v[204:205], v[82:83], v[82:83], v[204:205]
v_pk_add_f32 v[198:199], v[198:199], v[84:85]
v_pk_fma_f32 v[200:201], v[84:85], v[84:85], v[200:201]
v_pk_add_f32 v[198:199], v[198:199], v[86:87]
v_pk_fma_f32 v[200:201], v[86:87], v[86:87], v[200:201]
v_pk_add_f32 v[202:203], v[202:203], v[88:89]
v_pk_fma_f32 v[204:205], v[88:89], v[88:89], v[204:205]
v_pk_add_f32 v[202:203], v[202:203], v[90:91]
v_pk_fma_f32 v[204:205], v[90:91], v[90:91], v[204:205]
v_pk_add_f32 v[198:199], v[198:199], v[92:93]
v_pk_fma_f32 v[200:201], v[92:93], v[92:93], v[200:201]
v_pk_add_f32 v[198:199], v[198:199], v[94:95]
v_pk_fma_f32 v[200:201], v[94:95], v[94:95], v[200:201]
v_pk_add_f32 v[202:203], v[202:203], v[96:97]
v_pk_fma_f32 v[204:205], v[96:97], v[96:97], v[204:205]
v_pk_add_f32 v[202:203], v[202:203], v[98:99]
v_pk_fma_f32 v[204:205], v[98:99], v[98:99], v[204:205]
v_pk_add_f32 v[198:199], v[198:199], v[100:101]
v_pk_fma_f32 v[200:201], v[100:101], v[100:101], v[200:201]
v_pk_add_f32 v[198:199], v[198:199], v[102:103]
v_pk_fma_f32 v[200:201], v[102:103], v[102:103], v[200:201]
v_pk_add_f32 v[202:203], v[202:203], v[104:105]
v_pk_fma_f32 v[204:205], v[104:105], v[104:105], v[204:205]
v_pk_add_f32 v[202:203], v[202:203], v[106:107]
v_pk_fma_f32 v[204:205], v[106:107], v[106:107], v[204:205]
v_mfma_f32_16x16x32_bf16 v[124:127], a[148:151], a[40:43], v[124:127]
s_add_u32 m0, s38, 160768
v_add_f32 v198, v198, v199
v_add_f32 v202, v202, v203
v_mfma_f32_16x16x32_bf16 v[128:131], a[148:151], a[44:47], v[128:131]
s_waitcnt lgkmcnt(4)
s_add_u32 s39, s38, s82
v_add_f32 v200, v200, v201
v_add_f32 v204, v204, v205
v_permlane16_swap_b32 v198, v202
v_mfma_f32_16x16x32_bf16 v[116:119], a[152:155], a[48:51], v[116:119]
ds_read_b128 a[144:147], v209 offset:9216
ds_read_b128 a[148:151], v209 offset:27648
s_nop 0
v_mfma_f32_16x16x32_bf16 v[120:123], a[152:155], a[52:55], v[120:123]
s_add_u32 s39, s39, 339968
v_permlane16_swap_b32 v200, v204
v_add_f32 v198, v198, v202
v_mfma_f32_16x16x32_bf16 v[124:127], a[156:159], a[48:51], v[124:127]
s_mov_b64 exec, 0xffff
buffer_load_dwordx4 v1, s[4:7], s39 offen sc1 lds
s_mov_b64 exec, -1
v_add_f32 v199, v200, v204
v_mov_b32 v200, v198
v_mfma_f32_16x16x32_bf16 v[128:131], a[156:159], a[52:55], v[128:131]
s_waitcnt lgkmcnt(4)
v_mov_b32 v201, v199
s_nop 0
v_permlane32_swap_b32 v198, v200
v_mfma_f32_16x16x32_bf16 v[116:119], a[160:163], a[56:59], v[116:119]
ds_read_b128 a[152:155], v209 offset:10240
ds_read_b128 a[156:159], v209 offset:28672
v_permlane32_swap_b32 v199, v201
v_mfma_f32_16x16x32_bf16 v[120:123], a[160:163], a[60:63], v[120:123]
v_add_f32 v198, v198, v200
v_add_f32 v199, v199, v201
v_mfma_f32_16x16x32_bf16 v[124:127], a[164:167], a[56:59], v[124:127]
s_waitcnt vmcnt(20)
s_mov_b32 exec_hi, 0
buffer_store_dwordx2 v[198:199], v239, s[8:11], s30 offen sc1
s_mov_b64 exec, -1
v_mfma_f32_16x16x32_bf16 v[128:131], a[164:167], a[60:63], v[128:131]
s_waitcnt lgkmcnt(4)
v_mfma_f32_16x16x32_bf16 v[116:119], a[168:171], a[64:67], v[116:119]
ds_read_b128 a[160:163], v209 offset:11264
ds_read_b128 a[164:167], v209 offset:29696
v_mfma_f32_16x16x32_bf16 v[120:123], a[168:171], a[68:71], v[120:123]
v_mfma_f32_16x16x32_bf16 v[124:127], a[172:175], a[64:67], v[124:127]
v_mfma_f32_16x16x32_bf16 v[128:131], a[172:175], a[68:71], v[128:131]
s_waitcnt lgkmcnt(4)
v_mfma_f32_16x16x32_bf16 v[116:119], a[144:147], a[72:75], v[116:119]
ds_read_b128 a[168:171], v209 offset:12288
ds_read_b128 a[172:175], v209 offset:30720
v_mfma_f32_16x16x32_bf16 v[120:123], a[144:147], a[76:79], v[120:123]
v_mfma_f32_16x16x32_bf16 v[124:127], a[148:151], a[72:75], v[124:127]
v_mfma_f32_16x16x32_bf16 v[128:131], a[148:151], a[76:79], v[128:131]
s_waitcnt lgkmcnt(4)
v_mfma_f32_16x16x32_bf16 v[116:119], a[152:155], a[80:83], v[116:119]
ds_read_b128 a[144:147], v209 offset:13312
ds_read_b128 a[148:151], v209 offset:31744
v_mfma_f32_16x16x32_bf16 v[120:123], a[152:155], a[84:87], v[120:123]
v_mfma_f32_16x16x32_bf16 v[124:127], a[156:159], a[80:83], v[124:127]
v_mfma_f32_16x16x32_bf16 v[128:131], a[156:159], a[84:87], v[128:131]
s_waitcnt lgkmcnt(4)
v_mfma_f32_16x16x32_bf16 v[116:119], a[160:163], a[88:91], v[116:119]
ds_read_b128 a[152:155], v209 offset:14336
ds_read_b128 a[156:159], v209 offset:32768
v_mfma_f32_16x16x32_bf16 v[120:123], a[160:163], a[92:95], v[120:123]
v_mfma_f32_16x16x32_bf16 v[124:127], a[164:167], a[88:91], v[124:127]
v_mfma_f32_16x16x32_bf16 v[128:131], a[164:167], a[92:95], v[128:131]
s_waitcnt lgkmcnt(4)
v_mfma_f32_16x16x32_bf16 v[116:119], a[168:171], a[96:99], v[116:119]
ds_read_b128 a[160:163], v209 offset:15360
ds_read_b128 a[164:167], v209 offset:33792
v_mfma_f32_16x16x32_bf16 v[120:123], a[168:171], a[100:103], v[120:123]
v_mfma_f32_16x16x32_bf16 v[124:127], a[172:175], a[96:99], v[124:127]
v_mfma_f32_16x16x32_bf16 v[128:131], a[172:175], a[100:103], v[128:131]
s_waitcnt lgkmcnt(4)
v_mfma_f32_16x16x32_bf16 v[116:119], a[144:147], a[104:107], v[116:119]
ds_read_b128 a[168:171], v209 offset:16384
ds_read_b128 a[172:175], v209 offset:34816
v_mfma_f32_16x16x32_bf16 v[120:123], a[144:147], a[108:111], v[120:123]
v_mfma_f32_16x16x32_bf16 v[124:127], a[148:151], a[104:107], v[124:127]
v_mfma_f32_16x16x32_bf16 v[128:131], a[148:151], a[108:111], v[128:131]
s_waitcnt lgkmcnt(4)
v_mfma_f32_16x16x32_bf16 v[116:119], a[152:155], a[112:115], v[116:119]
ds_read_b128 a[144:147], v209 offset:17408
ds_read_b128 a[148:151], v209 offset:35840
v_mfma_f32_16x16x32_bf16 v[120:123], a[152:155], a[116:119], v[120:123]
v_mfma_f32_16x16x32_bf16 v[124:127], a[156:159], a[112:115], v[124:127]
v_mfma_f32_16x16x32_bf16 v[128:131], a[156:159], a[116:119], v[128:131]
s_waitcnt lgkmcnt(4)
v_add_u32 v181, 36864, v239
v_mfma_f32_16x16x32_bf16 v[116:119], a[160:163], a[120:123], v[116:119]
ds_read_b64 a[152:153], v181 offset:0
ds_read_b64 a[156:157], v181 offset:512
v_mfma_f32_16x16x32_bf16 v[120:123], a[160:163], a[124:127], v[120:123]
v_mfma_f32_16x16x32_bf16 v[124:127], a[164:167], a[120:123], v[124:127]
v_mfma_f32_16x16x32_bf16 v[128:131], a[164:167], a[124:127], v[128:131]
s_waitcnt lgkmcnt(4)
v_mfma_f32_16x16x32_bf16 v[116:119], a[168:171], a[128:131], v[116:119]
ds_read_b128 a[160:163], v210 offset:0
ds_read_b128 a[164:167], v210 offset:18432
v_mfma_f32_16x16x32_bf16 v[120:123], a[168:171], a[132:135], v[120:123]
buffer_load_dwordx2 v[182:183], v234, s[8:11], s61 offen offset:0 sc1
v_mfma_f32_16x16x32_bf16 v[124:127], a[172:175], a[128:131], v[124:127]
buffer_load_dwordx2 v[184:185], v234, s[8:11], s61 offen offset:1024 sc1
v_mfma_f32_16x16x32_bf16 v[128:131], a[172:175], a[132:135], v[128:131]
s_waitcnt lgkmcnt(4)
v_mfma_f32_16x16x32_bf16 v[116:119], a[144:147], a[136:139], v[116:119]
ds_read_b128 a[168:171], v210 offset:1024
ds_read_b128 a[172:175], v210 offset:19456
v_mfma_f32_16x16x32_bf16 v[120:123], a[144:147], a[140:143], v[120:123]
buffer_load_dwordx2 v[186:187], v234, s[8:11], s61 offen offset:2048 sc1
v_mfma_f32_16x16x32_bf16 v[124:127], a[148:151], a[136:139], v[124:127]
buffer_load_dwordx2 v[188:189], v234, s[8:11], s61 offen offset:3072 sc1
v_mfma_f32_16x16x32_bf16 v[128:131], a[148:151], a[140:143], v[128:131]
s_waitcnt lgkmcnt(4)
v_mfma_f32_16x16x16_bf16 v[116:119], a[152:153], v[212:213], v[116:119]
ds_read_b128 a[144:147], v210 offset:2048
ds_read_b128 a[148:151], v210 offset:20480
v_mfma_f32_16x16x16_bf16 v[120:123], a[152:153], v[214:215], v[120:123]
buffer_load_dwordx2 v[190:191], v235, s[8:11], s61 offen offset:0 sc1
v_mfma_f32_16x16x16_bf16 v[124:127], a[156:157], v[212:213], v[124:127]
buffer_load_dwordx2 v[192:193], v235, s[8:11], s61 offen offset:1024 sc1
v_mfma_f32_16x16x16_bf16 v[128:131], a[156:157], v[214:215], v[128:131]
s_waitcnt vmcnt(17) lgkmcnt(4)
s_barrier
v_mfma_f32_16x16x32_bf16 v[132:135], a[160:163], a[0:3], 0
ds_read_b128 a[152:155], v210 offset:3072
ds_read_b128 a[156:159], v210 offset:21504
v_mfma_f32_16x16x32_bf16 v[136:139], a[160:163], a[4:7], 0
buffer_load_dwordx2 v[194:195], v235, s[8:11], s61 offen offset:2048 sc1
s_mov_b32 s37, L_c4-L_pc
v_mfma_f32_16x16x32_bf16 v[140:143], a[164:167], a[0:3], 0
buffer_load_dwordx2 v[196:197], v235, s[8:11], s61 offen offset:3072 sc1
v_mfma_f32_16x16x32_bf16 v[144:147], a[164:167], a[4:7], 0
s_waitcnt lgkmcnt(4)
v_mfma_f32_16x16x32_bf16 v[132:135], a[168:171], a[8:11], v[132:135]
ds_read_b128 a[160:163], v210 offset:4096
ds_read_b128 a[164:167], v210 offset:22528
v_mfma_f32_16x16x32_bf16 v[136:139], a[168:171], a[12:15], v[136:139]
buffer_load_dword v15, v14, s[88:91], s37 offen
v_mfma_f32_16x16x32_bf16 v[140:143], a[172:175], a[8:11], v[140:143]
v_mfma_f32_16x16x32_bf16 v[144:147], a[172:175], a[12:15], v[144:147]
s_waitcnt lgkmcnt(4)
v_mfma_f32_16x16x32_bf16 v[132:135], a[144:147], a[16:19], v[132:135]
ds_read_b128 a[168:171], v210 offset:5120
ds_read_b128 a[172:175], v210 offset:23552
v_mfma_f32_16x16x32_bf16 v[136:139], a[144:147], a[20:23], v[136:139]
v_mfma_f32_16x16x32_bf16 v[140:143], a[148:151], a[16:19], v[140:143]
v_mfma_f32_16x16x32_bf16 v[144:147], a[148:151], a[20:23], v[144:147]
s_waitcnt lgkmcnt(4)
v_mfma_f32_16x16x32_bf16 v[132:135], a[152:155], a[24:27], v[132:135]
ds_read_b128 a[144:147], v210 offset:6144
ds_read_b128 a[148:151], v210 offset:24576
v_mfma_f32_16x16x32_bf16 v[136:139], a[152:155], a[28:31], v[136:139]
v_mfma_f32_16x16x32_bf16 v[140:143], a[156:159], a[24:27], v[140:143]
v_mfma_f32_16x16x32_bf16 v[144:147], a[156:159], a[28:31], v[144:147]
s_waitcnt lgkmcnt(4)
v_mfma_f32_16x16x32_bf16 v[132:135], a[160:163], a[32:35], v[132:135]
ds_read_b128 a[152:155], v210 offset:7168
ds_read_b128 a[156:159], v210 offset:25600
v_mfma_f32_16x16x32_bf16 v[136:139], a[160:163], a[36:39], v[136:139]
v_mfma_f32_16x16x32_bf16 v[140:143], a[164:167], a[32:35], v[140:143]
v_mfma_f32_16x16x32_bf16 v[144:147], a[164:167], a[36:39], v[144:147]
s_waitcnt lgkmcnt(4)
v_mfma_f32_16x16x32_bf16 v[132:135], a[168:171], a[40:43], v[132:135]
ds_read_b128 a[160:163], v210 offset:8192
ds_read_b128 a[164:167], v210 offset:26624
v_mfma_f32_16x16x32_bf16 v[136:139], a[168:171], a[44:47], v[136:139]
v_mfma_f32_16x16x32_bf16 v[140:143], a[172:175], a[40:43], v[140:143]
v_mfma_f32_16x16x32_bf16 v[144:147], a[172:175], a[44:47], v[144:147]
s_waitcnt lgkmcnt(4)
v_mfma_f32_16x16x32_bf16 v[132:135], a[144:147], a[48:51], v[132:135]
ds_read_b128 a[168:171], v210 offset:9216
ds_read_b128 a[172:175], v210 offset:27648
v_mfma_f32_16x16x32_bf16 v[136:139], a[144:147], a[52:55], v[136:139]
v_mfma_f32_16x16x32_bf16 v[140:143], a[148:151], a[48:51], v[140:143]
v_mfma_f32_16x16x32_bf16 v[144:147], a[148:151], a[52:55], v[144:147]
s_waitcnt lgkmcnt(4)
v_mfma_f32_16x16x32_bf16 v[132:135], a[152:155], a[56:59], v[132:135]
ds_read_b128 a[144:147], v210 offset:10240
ds_read_b128 a[148:151], v210 offset:28672
v_mfma_f32_16x16x32_bf16 v[136:139], a[152:155], a[60:63], v[136:139]
v_mfma_f32_16x16x32_bf16 v[140:143], a[156:159], a[56:59], v[140:143]
v_mfma_f32_16x16x32_bf16 v[144:147], a[156:159], a[60:63], v[144:147]
s_waitcnt lgkmcnt(4)
v_mfma_f32_16x16x32_bf16 v[132:135], a[160:163], a[64:67], v[132:135]
ds_read_b128 a[152:155], v210 offset:11264
ds_read_b128 a[156:159], v210 offset:29696
v_mfma_f32_16x16x32_bf16 v[136:139], a[160:163], a[68:71], v[136:139]
v_mfma_f32_16x16x32_bf16 v[140:143], a[164:167], a[64:67], v[140:143]
v_mfma_f32_16x16x32_bf16 v[144:147], a[164:167], a[68:71], v[144:147]
s_waitcnt lgkmcnt(4)
v_mfma_f32_16x16x32_bf16 v[132:135], a[168:171], a[72:75], v[132:135]
ds_read_b128 a[160:163], v210 offset:12288
ds_read_b128 a[164:167], v210 offset:30720
v_mfma_f32_16x16x32_bf16 v[136:139], a[168:171], a[76:79], v[136:139]
v_mfma_f32_16x16x32_bf16 v[140:143], a[172:175], a[72:75], v[140:143]
s_waitcnt vmcnt(1)
v_min3_f32 v200, v183, v185, v187
v_mfma_f32_16x16x32_bf16 v[144:147], a[172:175], a[76:79], v[144:147]
s_waitcnt lgkmcnt(4)
v_min3_f32 v201, v189, v191, v193
v_mfma_f32_16x16x32_bf16 v[132:135], a[144:147], a[80:83], v[132:135]
ds_read_b128 a[168:171], v210 offset:13312
ds_read_b128 a[172:175], v210 offset:31744
v_mfma_f32_16x16x32_bf16 v[136:139], a[144:147], a[84:87], v[136:139]
v_min3_f32 v200, v200, v195, v197
v_min_f32 v200, v200, v201
v_mfma_f32_16x16x32_bf16 v[140:143], a[148:151], a[80:83], v[140:143]
v_cmp_gt_f32 vcc, 0, v200
v_mfma_f32_16x16x32_bf16 v[144:147], a[148:151], a[84:87], v[144:147]
s_waitcnt lgkmcnt(4)
s_nop 0
s_cbranch_vccnz L_stzslow_23
L_stzback_24:
v_mfma_f32_16x16x32_bf16 v[132:135], a[152:155], a[88:91], v[132:135]
ds_read_b128 a[144:147], v210 offset:14336
ds_read_b128 a[148:151], v210 offset:32768
v_mfma_f32_16x16x32_bf16 v[136:139], a[152:155], a[92:95], v[136:139]
v_add_f32 v198, v182, v184
v_add_f32 v199, v183, v185
v_mfma_f32_16x16x32_bf16 v[140:143], a[156:159], a[88:91], v[140:143]
buffer_load_dwordx4 a[176:179], v1, s[4:7], s52 offen offset:0 sc1
buffer_load_dwordx4 a[180:183], v9, s[4:7], s52 offen offset:0 sc1
v_add_f32 v198, v198, v186
v_add_f32 v199, v199, v187
v_mfma_f32_16x16x32_bf16 v[144:147], a[156:159], a[92:95], v[144:147]
s_waitcnt lgkmcnt(4)
v_add_f32 v198, v198, v188
v_add_f32 v199, v199, v189
v_mfma_f32_16x16x32_bf16 v[132:135], a[160:163], a[96:99], v[132:135]
ds_read_b128 a[152:155], v210 offset:15360
ds_read_b128 a[156:159], v210 offset:33792
v_add_f32 v198, v198, v190
v_mfma_f32_16x16x32_bf16 v[136:139], a[160:163], a[100:103], v[136:139]
v_add_f32 v199, v199, v191
v_add_f32 v198, v198, v192
v_mfma_f32_16x16x32_bf16 v[140:143], a[164:167], a[96:99], v[140:143]
buffer_load_dwordx4 a[184:187], v1, s[4:7], s52 offen offset:1024 sc1
buffer_load_dwordx4 a[188:191], v9, s[4:7], s52 offen offset:1024 sc1
v_add_f32 v199, v199, v193
v_add_f32 v198, v198, v194
v_mfma_f32_16x16x32_bf16 v[144:147], a[164:167], a[100:103], v[144:147]
s_waitcnt lgkmcnt(4)
v_add_f32 v199, v199, v195
v_add_f32 v198, v198, v196
v_mfma_f32_16x16x32_bf16 v[132:135], a[168:171], a[104:107], v[132:135]
ds_read_b128 a[160:163], v210 offset:16384
ds_read_b128 a[164:167], v210 offset:34816
v_add_f32 v199, v199, v197
v_mov_b32 v200, v198
v_mfma_f32_16x16x32_bf16 v[136:139], a[168:171], a[108:111], v[136:139]
v_mov_b32 v201, v199
s_nop 0
v_mfma_f32_16x16x32_bf16 v[140:143], a[172:175], a[104:107], v[140:143]
v_permlane32_swap_b32 v198, v200
v_mfma_f32_16x16x32_bf16 v[144:147], a[172:175], a[108:111], v[144:147]
s_waitcnt lgkmcnt(4)
v_permlane32_swap_b32 v199, v201
v_mfma_f32_16x16x32_bf16 v[132:135], a[144:147], a[112:115], v[132:135]
ds_read_b128 a[168:171], v210 offset:17408
ds_read_b128 a[172:175], v210 offset:35840
v_add_f32 v198, v198, v200
v_mfma_f32_16x16x32_bf16 v[136:139], a[144:147], a[116:119], v[136:139]
buffer_load_dwordx4 a[192:195], v1, s[4:7], s52 offen offset:2048 sc1
buffer_load_dwordx4 a[196:199], v9, s[4:7], s52 offen offset:2048 sc1
v_add_f32 v199, v199, v201
v_mul_f32 v198, 0x39e38e39, v198
v_mfma_f32_16x16x32_bf16 v[140:143], a[148:151], a[112:115], v[140:143]
v_mul_f32 v200, v198, v198
v_mul_f32 v199, 0x39e38e39, v199
v_mfma_f32_16x16x32_bf16 v[144:147], a[148:151], a[116:119], v[144:147]
s_waitcnt lgkmcnt(4)
v_sub_f32 v199, v199, v200
v_add_u32 v181, 74752, v239
v_mfma_f32_16x16x32_bf16 v[132:135], a[152:155], a[120:123], v[132:135]
ds_read_b64 a[144:145], v181 offset:0
ds_read_b64 a[148:149], v181 offset:512
v_max_f32 v199, 0, v199
v_add_f32 v199, 0x3727c5ac, v199
v_mfma_f32_16x16x32_bf16 v[136:139], a[152:155], a[124:127], v[136:139]
buffer_load_dwordx4 a[200:203], v1, s[4:7], s52 offen offset:3072 sc1
buffer_load_dwordx4 a[204:207], v9, s[4:7], s52 offen offset:3072 sc1
v_rsq_f32 v202, v199
v_mfma_f32_16x16x32_bf16 v[140:143], a[156:159], a[120:123], v[140:143]
s_nop 0
v_mul_f32 v204, v198, v202
v_mov_b32 v203, v202
v_mfma_f32_16x16x32_bf16 v[144:147], a[156:159], a[124:127], v[144:147]
s_waitcnt lgkmcnt(4)
v_mov_b32 v205, v204
s_nop 0
v_mfma_f32_16x16x32_bf16 v[132:135], a[160:163], a[128:131], v[132:135]
ds_read_b128 a[152:155], v211 offset:0
ds_read_b128 a[156:159], v211 offset:18432
v_mfma_f32_16x16x32_bf16 v[136:139], a[160:163], a[132:135], v[136:139]
s_mov_b32 s52, s53
v_permlane16_swap_b32 v202, v203
v_mfma_f32_16x16x32_bf16 v[140:143], a[164:167], a[128:131], v[140:143]
s_cmp_eq_u32 s25, 0
s_cselect_b32 s98, 4096, 0
v_permlane16_swap_b32 v204, v205
v_mfma_f32_16x16x32_bf16 v[144:147], a[164:167], a[132:135], v[144:147]
s_waitcnt lgkmcnt(4)
v_fma_f32 v36, v36, v202, -v204
v_fma_f32 v37, v37, v202, -v204
v_mfma_f32_16x16x32_bf16 v[132:135], a[168:171], a[136:139], v[132:135]
ds_read_b128 a[160:163], v211 offset:1024
ds_read_b128 a[164:167], v211 offset:19456
v_fma_f32 v38, v38, v202, -v204
v_mfma_f32_16x16x32_bf16 v[136:139], a[168:171], a[140:143], v[136:139]
s_add_u32 s52, s52, s98
v_fma_f32 v39, v39, v202, -v204
v_fma_f32 v44, v44, v202, -v204
v_mfma_f32_16x16x32_bf16 v[140:143], a[172:175], a[136:139], v[140:143]
v_fma_f32 v45, v45, v202, -v204
v_fma_f32 v46, v46, v202, -v204
v_mfma_f32_16x16x32_bf16 v[144:147], a[172:175], a[140:143], v[144:147]
s_waitcnt lgkmcnt(4)
v_fma_f32 v47, v47, v202, -v204
v_cvt_pk_bf16_f32 v216, v36, v37
v_mfma_f32_16x16x16_bf16 v[132:135], a[144:145], v[212:213], v[132:135]
ds_read_b128 a[168:171], v211 offset:2048
ds_read_b128 a[172:175], v211 offset:20480
v_cvt_pk_bf16_f32 v217, v38, v39
v_cvt_pk_bf16_f32 v218, v44, v45
v_mfma_f32_16x16x16_bf16 v[136:139], a[144:145], v[214:215], v[136:139]
v_cvt_pk_bf16_f32 v219, v46, v47
v_mfma_f32_16x16x16_bf16 v[140:143], a[148:149], v[212:213], v[140:143]
ds_write_b128 v236, v[216:219] offset:0
v_fma_f32 v40, v40, v203, -v205
v_mfma_f32_16x16x16_bf16 v[144:147], a[148:149], v[214:215], v[144:147]
s_waitcnt lgkmcnt(5)
v_fma_f32 v41, v41, v203, -v205
v_fma_f32 v42, v42, v203, -v205
s_barrier
v_mfma_f32_16x16x32_bf16 v[148:151], a[152:155], a[0:3], 0
ds_read_b128 a[144:147], v211 offset:3072
ds_read_b128 a[148:151], v211 offset:21504
v_fma_f32 v43, v43, v203, -v205
v_fma_f32 v48, v48, v203, -v205
v_mfma_f32_16x16x32_bf16 v[152:155], a[152:155], a[4:7], 0
buffer_load_dwordx4 a[208:211], v1, s[4:7], s52 offen offset:0 sc1
buffer_load_dwordx4 a[212:215], v9, s[4:7], s52 offen offset:0 sc1
v_fma_f32 v49, v49, v203, -v205
v_fma_f32 v50, v50, v203, -v205
v_mfma_f32_16x16x32_bf16 v[156:159], a[156:159], a[0:3], 0
buffer_load_dwordx4 a[216:219], v1, s[4:7], s52 offen offset:1024 sc1
buffer_load_dwordx4 a[220:223], v9, s[4:7], s52 offen offset:1024 sc1
v_fma_f32 v51, v51, v203, -v205
v_mfma_f32_16x16x32_bf16 v[160:163], a[156:159], a[4:7], 0
s_waitcnt lgkmcnt(5)
v_cvt_pk_bf16_f32 v220, v40, v41
v_cvt_pk_bf16_f32 v221, v42, v43
v_mfma_f32_16x16x32_bf16 v[148:151], a[160:163], a[8:11], v[148:151]
ds_read_b128 a[152:155], v211 offset:4096
ds_read_b128 a[156:159], v211 offset:22528
v_cvt_pk_bf16_f32 v222, v48, v49
v_cvt_pk_bf16_f32 v223, v50, v51
v_mfma_f32_16x16x32_bf16 v[152:155], a[160:163], a[12:15], v[152:155]
ds_write_b128 v236, v[220:223] offset:4608
v_mfma_f32_16x16x32_bf16 v[156:159], a[164:167], a[8:11], v[156:159]
ds_read_b64_tr_b16 v[36:37], v237 offset:0
ds_read_b64_tr_b16 v[38:39], v237 offset:1152
ds_read_b64_tr_b16 v[40:41], v237 offset:8
ds_read_b64_tr_b16 v[42:43], v237 offset:1160
v_mfma_f32_16x16x32_bf16 v[160:163], a[164:167], a[12:15], v[160:163]
s_waitcnt lgkmcnt(10)
v_fma_f32 v52, v52, v202, -v204
v_fma_f32 v53, v53, v202, -v204
v_mfma_f32_16x16x32_bf16 v[148:151], a[168:171], a[16:19], v[148:151]
ds_read_b128 a[160:163], v211 offset:5120
ds_read_b128 a[164:167], v211 offset:23552
v_mfma_f32_16x16x32_bf16 v[152:155], a[168:171], a[20:23], v[152:155]
buffer_load_dwordx4 a[224:227], v1, s[4:7], s52 offen offset:2048 sc1
buffer_load_dwordx4 a[228:231], v9, s[4:7], s52 offen offset:2048 sc1
v_mfma_f32_16x16x32_bf16 v[156:159], a[172:175], a[16:19], v[156:159]
v_fma_f32 v54, v54, v202, -v204
v_fma_f32 v55, v55, v202, -v204
v_mfma_f32_16x16x32_bf16 v[160:163], a[172:175], a[20:23], v[160:163]
s_waitcnt lgkmcnt(9)
v_fma_f32 v60, v60, v202, -v204
v_fma_f32 v61, v61, v202, -v204
v_mfma_f32_16x16x32_bf16 v[148:151], a[144:147], a[24:27], v[148:151]
ds_read_b128 a[168:171], v211 offset:6144
ds_read_b128 a[172:175], v211 offset:24576
v_mfma_f32_16x16x32_bf16 v[152:155], a[144:147], a[28:31], v[152:155]
buffer_load_dwordx4 a[232:235], v1, s[4:7], s52 offen offset:3072 sc1
buffer_load_dwordx4 a[236:239], v9, s[4:7], s52 offen offset:3072 sc1
v_fma_f32 v62, v62, v202, -v204
v_mfma_f32_16x16x32_bf16 v[156:159], a[148:151], a[24:27], v[156:159]
v_fma_f32 v63, v63, v202, -v204
v_cvt_pk_bf16_f32 v224, v52, v53
v_mfma_f32_16x16x32_bf16 v[160:163], a[148:151], a[28:31], v[160:163]
s_waitcnt lgkmcnt(9)
v_cvt_pk_bf16_f32 v225, v54, v55
v_cvt_pk_bf16_f32 v226, v60, v61
v_mfma_f32_16x16x32_bf16 v[148:151], a[152:155], a[32:35], v[148:151]
ds_read_b128 a[144:147], v211 offset:7168
ds_read_b128 a[148:151], v211 offset:25600
v_mfma_f32_16x16x32_bf16 v[152:155], a[152:155], a[36:39], v[152:155]
v_cvt_pk_bf16_f32 v227, v62, v63
v_mfma_f32_16x16x32_bf16 v[156:159], a[156:159], a[32:35], v[156:159]
ds_write_b128 v236, v[224:227] offset:64
v_mfma_f32_16x16x32_bf16 v[160:163], a[156:159], a[36:39], v[160:163]
s_waitcnt lgkmcnt(5)
buffer_store_dwordx4 v[36:39], v1, s[8:11], s66 offen offset:0 sc1
v_mfma_f32_16x16x32_bf16 v[148:151], a[160:163], a[40:43], v[148:151]
ds_read_b128 a[152:155], v211 offset:8192
ds_read_b128 a[156:159], v211 offset:26624
v_mfma_f32_16x16x32_bf16 v[152:155], a[160:163], a[44:47], v[152:155]
v_fma_f32 v56, v56, v203, -v205
v_fma_f32 v57, v57, v203, -v205
v_mfma_f32_16x16x32_bf16 v[156:159], a[164:167], a[40:43], v[156:159]
v_fma_f32 v58, v58, v203, -v205
v_fma_f32 v59, v59, v203, -v205
v_mfma_f32_16x16x32_bf16 v[160:163], a[164:167], a[44:47], v[160:163]
s_waitcnt lgkmcnt(5)
v_fma_f32 v64, v64, v203, -v205
v_fma_f32 v65, v65, v203, -v205
v_mfma_f32_16x16x32_bf16 v[148:151], a[168:171], a[48:51], v[148:151]
ds_read_b128 a[160:163], v211 offset:9216
ds_read_b128 a[164:167], v211 offset:27648
v_mfma_f32_16x16x32_bf16 v[152:155], a[168:171], a[52:55], v[152:155]
v_fma_f32 v66, v66, v203, -v205
v_fma_f32 v67, v67, v203, -v205
v_mfma_f32_16x16x32_bf16 v[156:159], a[172:175], a[48:51], v[156:159]
v_cvt_pk_bf16_f32 v228, v56, v57
v_cvt_pk_bf16_f32 v229, v58, v59
v_mfma_f32_16x16x32_bf16 v[160:163], a[172:175], a[52:55], v[160:163]
s_waitcnt lgkmcnt(5)
v_cvt_pk_bf16_f32 v230, v64, v65
v_cvt_pk_bf16_f32 v231, v66, v67
v_mfma_f32_16x16x32_bf16 v[148:151], a[144:147], a[56:59], v[148:151]
ds_read_b128 a[168:171], v211 offset:10240
ds_read_b128 a[172:175], v211 offset:28672
v_mfma_f32_16x16x32_bf16 v[152:155], a[144:147], a[60:63], v[152:155]
ds_write_b128 v236, v[228:231] offset:4672
v_mfma_f32_16x16x32_bf16 v[156:159], a[148:151], a[56:59], v[156:159]
ds_read_b64_tr_b16 v[52:53], v237 offset:64
ds_read_b64_tr_b16 v[54:55], v237 offset:1216
v_mfma_f32_16x16x32_bf16 v[160:163], a[148:151], a[60:63], v[160:163]
s_waitcnt lgkmcnt(7)
v_mfma_f32_16x16x32_bf16 v[148:151], a[152:155], a[64:67], v[148:151]
ds_read_b128 a[144:147], v211 offset:11264
ds_read_b128 a[148:151], v211 offset:29696
ds_read_b64_tr_b16 v[56:57], v237 offset:72
ds_read_b64_tr_b16 v[58:59], v237 offset:1224
buffer_store_dwordx4 v[40:43], v1, s[8:11], s66 offen offset:1024 sc1
v_mfma_f32_16x16x32_bf16 v[152:155], a[152:155], a[68:71], v[152:155]
v_fma_f32 v68, v68, v202, -v204
v_fma_f32 v69, v69, v202, -v204
v_mfma_f32_16x16x32_bf16 v[156:159], a[156:159], a[64:67], v[156:159]
v_fma_f32 v70, v70, v202, -v204
v_mfma_f32_16x16x32_bf16 v[160:163], a[156:159], a[68:71], v[160:163]
s_waitcnt lgkmcnt(9)
v_fma_f32 v71, v71, v202, -v204
v_mfma_f32_16x16x32_bf16 v[148:151], a[160:163], a[72:75], v[148:151]
ds_read_b128 a[152:155], v211 offset:12288
ds_read_b128 a[156:159], v211 offset:30720
v_mfma_f32_16x16x32_bf16 v[152:155], a[160:163], a[76:79], v[152:155]
v_fma_f32 v76, v76, v202, -v204
v_fma_f32 v77, v77, v202, -v204
v_mfma_f32_16x16x32_bf16 v[156:159], a[164:167], a[72:75], v[156:159]
v_fma_f32 v78, v78, v202, -v204
v_mfma_f32_16x16x32_bf16 v[160:163], a[164:167], a[76:79], v[160:163]
s_waitcnt lgkmcnt(9)
v_fma_f32 v79, v79, v202, -v204
v_cvt_pk_bf16_f32 v216, v68, v69
v_mfma_f32_16x16x32_bf16 v[148:151], a[168:171], a[80:83], v[148:151]
ds_read_b128 a[160:163], v211 offset:13312
ds_read_b128 a[164:167], v211 offset:31744
v_mfma_f32_16x16x32_bf16 v[152:155], a[168:171], a[84:87], v[152:155]
v_cvt_pk_bf16_f32 v217, v70, v71
v_cvt_pk_bf16_f32 v218, v76, v77
v_mfma_f32_16x16x32_bf16 v[156:159], a[172:175], a[80:83], v[156:159]
v_cvt_pk_bf16_f32 v219, v78, v79
v_mfma_f32_16x16x32_bf16 v[160:163], a[172:175], a[84:87], v[160:163]
s_waitcnt lgkmcnt(6)
v_mfma_f32_16x16x32_bf16 v[148:151], a[144:147], a[88:91], v[148:151]
ds_read_b128 a[168:171], v211 offset:14336
ds_read_b128 a[172:175], v211 offset:32768
v_mfma_f32_16x16x32_bf16 v[152:155], a[144:147], a[92:95], v[152:155]
ds_write_b128 v236, v[216:219] offset:128
buffer_store_dwordx4 v[52:55], v1, s[8:11], s66 offen offset:2048 sc1
v_mfma_f32_16x16x32_bf16 v[156:159], a[148:151], a[88:91], v[156:159]
v_fma_f32 v72, v72, v203, -v205
v_fma_f32 v73, v73, v203, -v205
v_mfma_f32_16x16x32_bf16 v[160:163], a[148:151], a[92:95], v[160:163]
s_waitcnt lgkmcnt(5)
v_fma_f32 v74, v74, v203, -v205
v_mfma_f32_16x16x32_bf16 v[148:151], a[152:155], a[96:99], v[148:151]
ds_read_b128 a[144:147], v211 offset:15360
ds_read_b128 a[148:151], v211 offset:33792
v_mfma_f32_16x16x32_bf16 v[152:155], a[152:155], a[100:103], v[152:155]
v_fma_f32 v75, v75, v203, -v205
v_fma_f32 v80, v80, v203, -v205
v_mfma_f32_16x16x32_bf16 v[156:159], a[156:159], a[96:99], v[156:159]
v_fma_f32 v81, v81, v203, -v205
v_fma_f32 v82, v82, v203, -v205
v_mfma_f32_16x16x32_bf16 v[160:163], a[156:159], a[100:103], v[160:163]
s_waitcnt lgkmcnt(5)
v_fma_f32 v83, v83, v203, -v205
v_cvt_pk_bf16_f32 v220, v72, v73
v_mfma_f32_16x16x32_bf16 v[148:151], a[160:163], a[104:107], v[148:151]
ds_read_b128 a[152:155], v211 offset:16384
ds_read_b128 a[156:159], v211 offset:34816
v_mfma_f32_16x16x32_bf16 v[152:155], a[160:163], a[108:111], v[152:155]
v_cvt_pk_bf16_f32 v221, v74, v75
v_cvt_pk_bf16_f32 v222, v80, v81
v_mfma_f32_16x16x32_bf16 v[156:159], a[164:167], a[104:107], v[156:159]
v_cvt_pk_bf16_f32 v223, v82, v83
v_mfma_f32_16x16x32_bf16 v[160:163], a[164:167], a[108:111], v[160:163]
s_waitcnt lgkmcnt(5)
v_mfma_f32_16x16x32_bf16 v[148:151], a[168:171], a[112:115], v[148:151]
ds_read_b128 a[160:163], v211 offset:17408
ds_read_b128 a[164:167], v211 offset:35840
v_mfma_f32_16x16x32_bf16 v[152:155], a[168:171], a[116:119], v[152:155]
ds_write_b128 v236, v[220:223] offset:4736
v_mfma_f32_16x16x32_bf16 v[156:159], a[172:175], a[112:115], v[156:159]
ds_read_b64_tr_b16 v[68:69], v237 offset:128
ds_read_b64_tr_b16 v[70:71], v237 offset:1280
ds_read_b64_tr_b16 v[72:73], v237 offset:136
ds_read_b64_tr_b16 v[74:75], v237 offset:1288
buffer_store_dwordx4 v[56:59], v1, s[8:11], s66 offen offset:3072 sc1
v_mfma_f32_16x16x32_bf16 v[160:163], a[172:175], a[116:119], v[160:163]
s_waitcnt lgkmcnt(9)
v_fma_f32 v84, v84, v202, -v204
v_add_u32 v181, 112640, v239
v_mfma_f32_16x16x32_bf16 v[148:151], a[144:147], a[120:123], v[148:151]
ds_read_b64 a[168:169], v181 offset:0
ds_read_b64 a[172:173], v181 offset:512
v_mfma_f32_16x16x32_bf16 v[152:155], a[144:147], a[124:127], v[152:155]
v_fma_f32 v85, v85, v202, -v204
v_fma_f32 v86, v86, v202, -v204
v_mfma_f32_16x16x32_bf16 v[156:159], a[148:151], a[120:123], v[156:159]
v_fma_f32 v87, v87, v202, -v204
v_fma_f32 v92, v92, v202, -v204
v_mfma_f32_16x16x32_bf16 v[160:163], a[148:151], a[124:127], v[160:163]
s_waitcnt lgkmcnt(9)
v_fma_f32 v93, v93, v202, -v204
v_fma_f32 v94, v94, v202, -v204
v_mfma_f32_16x16x32_bf16 v[148:151], a[152:155], a[128:131], v[148:151]
ds_read_b128 a[144:147], v208 offset:0
ds_read_b128 a[148:151], v208 offset:18432
v_mfma_f32_16x16x32_bf16 v[152:155], a[152:155], a[132:135], v[152:155]
v_fma_f32 v95, v95, v202, -v204
v_cvt_pk_bf16_f32 v224, v84, v85
v_mfma_f32_16x16x32_bf16 v[156:159], a[156:159], a[128:131], v[156:159]
v_cvt_pk_bf16_f32 v225, v86, v87
v_mfma_f32_16x16x32_bf16 v[160:163], a[156:159], a[132:135], v[160:163]
s_waitcnt lgkmcnt(9)
v_cvt_pk_bf16_f32 v226, v92, v93
v_cvt_pk_bf16_f32 v227, v94, v95
v_mfma_f32_16x16x32_bf16 v[148:151], a[160:163], a[136:139], v[148:151]
ds_read_b128 a[152:155], v208 offset:1024
ds_read_b128 a[156:159], v208 offset:19456
v_mfma_f32_16x16x32_bf16 v[152:155], a[160:163], a[140:143], v[152:155]
ds_write_b128 v236, v[224:227] offset:192
v_mfma_f32_16x16x32_bf16 v[156:159], a[164:167], a[136:139], v[156:159]
s_add_u32 s66, s66, 4096
s_waitcnt lgkmcnt(9)
v_mfma_f32_16x16x32_bf16 v[160:163], a[164:167], a[140:143], v[160:163]
s_waitcnt lgkmcnt(5)
buffer_store_dwordx4 v[68:71], v1, s[8:11], s66 offen offset:0 sc1
v_mfma_f32_16x16x16_bf16 v[148:151], a[168:169], v[212:213], v[148:151]
ds_read_b128 a[160:163], v208 offset:2048
ds_read_b128 a[164:167], v208 offset:20480
v_mfma_f32_16x16x16_bf16 v[152:155], a[168:169], v[214:215], v[152:155]
v_fma_f32 v88, v88, v203, -v205
v_fma_f32 v89, v89, v203, -v205
v_mfma_f32_16x16x16_bf16 v[156:159], a[172:173], v[212:213], v[156:159]
v_fma_f32 v90, v90, v203, -v205
v_fma_f32 v91, v91, v203, -v205
v_mfma_f32_16x16x16_bf16 v[160:163], a[172:173], v[214:215], v[160:163]
s_waitcnt lgkmcnt(5)
v_fma_f32 v96, v96, v203, -v205
v_fma_f32 v97, v97, v203, -v205
v_mfma_f32_16x16x32_bf16 v[164:167], a[144:147], a[0:3], 0
ds_read_b128 a[168:171], v208 offset:3072
ds_read_b128 a[172:175], v208 offset:21504
v_mfma_f32_16x16x32_bf16 v[168:171], a[144:147], a[4:7], 0
v_fma_f32 v98, v98, v203, -v205
v_fma_f32 v99, v99, v203, -v205
v_mfma_f32_16x16x32_bf16 v[172:175], a[148:151], a[0:3], 0
v_cvt_pk_bf16_f32 v228, v88, v89
v_cvt_pk_bf16_f32 v229, v90, v91
v_mfma_f32_16x16x32_bf16 v[176:179], a[148:151], a[4:7], 0
s_waitcnt lgkmcnt(5)
v_cvt_pk_bf16_f32 v230, v96, v97
v_cvt_pk_bf16_f32 v231, v98, v99
v_mfma_f32_16x16x32_bf16 v[164:167], a[152:155], a[8:11], v[164:167]
ds_read_b128 a[144:147], v208 offset:4096
ds_read_b128 a[148:151], v208 offset:22528
v_mfma_f32_16x16x32_bf16 v[168:171], a[152:155], a[12:15], v[168:171]
ds_write_b128 v236, v[228:231] offset:4800
v_mfma_f32_16x16x32_bf16 v[172:175], a[156:159], a[8:11], v[172:175]
ds_read_b64_tr_b16 v[84:85], v237 offset:192
ds_read_b64_tr_b16 v[86:87], v237 offset:1344
v_mfma_f32_16x16x32_bf16 v[176:179], a[156:159], a[12:15], v[176:179]
s_waitcnt lgkmcnt(7)
v_mfma_f32_16x16x32_bf16 v[164:167], a[160:163], a[16:19], v[164:167]
ds_read_b128 a[152:155], v208 offset:5120
ds_read_b128 a[156:159], v208 offset:23552
ds_read_b64_tr_b16 v[88:89], v237 offset:200
ds_read_b64_tr_b16 v[90:91], v237 offset:1352
buffer_store_dwordx4 v[72:75], v1, s[8:11], s66 offen offset:1024 sc1
v_mfma_f32_16x16x32_bf16 v[168:171], a[160:163], a[20:23], v[168:171]
v_fma_f32 v100, v100, v202, -v204
v_fma_f32 v101, v101, v202, -v204
v_mfma_f32_16x16x32_bf16 v[172:175], a[164:167], a[16:19], v[172:175]
v_fma_f32 v102, v102, v202, -v204
v_mfma_f32_16x16x32_bf16 v[176:179], a[164:167], a[20:23], v[176:179]
s_waitcnt lgkmcnt(9)
v_fma_f32 v103, v103, v202, -v204
v_fma_f32 v104, v104, v203, -v205
v_mfma_f32_16x16x32_bf16 v[164:167], a[168:171], a[24:27], v[164:167]
ds_read_b128 a[160:163], v208 offset:6144
ds_read_b128 a[164:167], v208 offset:24576
v_mfma_f32_16x16x32_bf16 v[168:171], a[168:171], a[28:31], v[168:171]
v_fma_f32 v105, v105, v203, -v205
v_fma_f32 v106, v106, v203, -v205
v_mfma_f32_16x16x32_bf16 v[172:175], a[172:175], a[24:27], v[172:175]
v_fma_f32 v107, v107, v203, -v205
v_cvt_pk_bf16_f32 v216, v100, v101
v_mfma_f32_16x16x32_bf16 v[176:179], a[172:175], a[28:31], v[176:179]
s_waitcnt lgkmcnt(9)
v_cvt_pk_bf16_f32 v217, v102, v103
v_mfma_f32_16x16x32_bf16 v[164:167], a[144:147], a[32:35], v[164:167]
ds_read_b128 a[168:171], v208 offset:7168
ds_read_b128 a[172:175], v208 offset:25600
v_mfma_f32_16x16x32_bf16 v[168:171], a[144:147], a[36:39], v[168:171]
v_cvt_pk_bf16_f32 v218, v104, v105
v_cvt_pk_bf16_f32 v219, v106, v107
v_mfma_f32_16x16x32_bf16 v[172:175], a[148:151], a[32:35], v[172:175]
ds_write_b64 v7, v[216:217] offset:256
v_mfma_f32_16x16x32_bf16 v[176:179], a[148:151], a[36:39], v[176:179]
s_waitcnt lgkmcnt(7)
v_mfma_f32_16x16x32_bf16 v[164:167], a[152:155], a[40:43], v[164:167]
ds_read_b128 a[144:147], v208 offset:8192
ds_read_b128 a[148:151], v208 offset:26624
v_mfma_f32_16x16x32_bf16 v[168:171], a[152:155], a[44:47], v[168:171]
ds_write_b64 v7, v[218:219] offset:4864
ds_read_b64_tr_b16 v[100:101], v238 offset:256
ds_read_b64_tr_b16 v[102:103], v238 offset:1408
buffer_store_dwordx4 v[84:87], v1, s[8:11], s66 offen offset:2048 sc1
v_mfma_f32_16x16x32_bf16 v[172:175], a[156:159], a[40:43], v[172:175]
v_mfma_f32_16x16x32_bf16 v[176:179], a[156:159], a[44:47], v[176:179]
s_waitcnt lgkmcnt(8)
v_mfma_f32_16x16x32_bf16 v[164:167], a[160:163], a[48:51], v[164:167]
ds_read_b128 a[152:155], v208 offset:9216
ds_read_b128 a[156:159], v208 offset:27648
v_mfma_f32_16x16x32_bf16 v[168:171], a[160:163], a[52:55], v[168:171]
v_mfma_f32_16x16x32_bf16 v[172:175], a[164:167], a[48:51], v[172:175]
v_mfma_f32_16x16x32_bf16 v[176:179], a[164:167], a[52:55], v[176:179]
s_waitcnt lgkmcnt(8)
v_mfma_f32_16x16x32_bf16 v[164:167], a[168:171], a[56:59], v[164:167]
ds_read_b128 a[160:163], v208 offset:10240
ds_read_b128 a[164:167], v208 offset:28672
v_mfma_f32_16x16x32_bf16 v[168:171], a[168:171], a[60:63], v[168:171]
v_mfma_f32_16x16x32_bf16 v[172:175], a[172:175], a[56:59], v[172:175]
v_mfma_f32_16x16x32_bf16 v[176:179], a[172:175], a[60:63], v[176:179]
s_waitcnt lgkmcnt(7)
v_mfma_f32_16x16x32_bf16 v[164:167], a[144:147], a[64:67], v[164:167]
ds_read_b128 a[168:171], v208 offset:11264
ds_read_b128 a[172:175], v208 offset:29696
v_mfma_f32_16x16x32_bf16 v[168:171], a[144:147], a[68:71], v[168:171]
v_mfma_f32_16x16x32_bf16 v[172:175], a[148:151], a[64:67], v[172:175]
buffer_store_dwordx4 v[88:91], v1, s[8:11], s66 offen offset:3072 sc1
v_mfma_f32_16x16x32_bf16 v[176:179], a[148:151], a[68:71], v[176:179]
s_waitcnt lgkmcnt(4)
v_mfma_f32_16x16x32_bf16 v[164:167], a[152:155], a[72:75], v[164:167]
ds_read_b128 a[144:147], v208 offset:12288
ds_read_b128 a[148:151], v208 offset:30720
v_mfma_f32_16x16x32_bf16 v[168:171], a[152:155], a[76:79], v[168:171]
s_cmp_eq_u32 s25, 1
s_cselect_b32 s98, 4096, 0
v_mfma_f32_16x16x32_bf16 v[172:175], a[156:159], a[72:75], v[172:175]
s_add_u32 s52, s52, s98
v_mfma_f32_16x16x32_bf16 v[176:179], a[156:159], a[76:79], v[176:179]
s_waitcnt lgkmcnt(4)
v_mfma_f32_16x16x32_bf16 v[164:167], a[160:163], a[80:83], v[164:167]
ds_read_b128 a[152:155], v208 offset:13312
ds_read_b128 a[156:159], v208 offset:31744
v_mfma_f32_16x16x32_bf16 v[168:171], a[160:163], a[84:87], v[168:171]
s_add_u32 s52, s52, 4096
v_mfma_f32_16x16x32_bf16 v[172:175], a[164:167], a[80:83], v[172:175]
v_mfma_f32_16x16x32_bf16 v[176:179], a[164:167], a[84:87], v[176:179]
s_waitcnt lgkmcnt(4)
v_mfma_f32_16x16x32_bf16 v[164:167], a[168:171], a[88:91], v[164:167]
ds_read_b128 a[160:163], v208 offset:14336
ds_read_b128 a[164:167], v208 offset:32768
v_mfma_f32_16x16x32_bf16 v[168:171], a[168:171], a[92:95], v[168:171]
v_mfma_f32_16x16x32_bf16 v[172:175], a[172:175], a[88:91], v[172:175]
s_add_u32 s66, s66, 4096
v_mfma_f32_16x16x32_bf16 v[176:179], a[172:175], a[92:95], v[176:179]
s_waitcnt lgkmcnt(4)
buffer_store_dwordx4 v[100:103], v1, s[8:11], s66 offen offset:0 sc1
v_mfma_f32_16x16x32_bf16 v[164:167], a[144:147], a[96:99], v[164:167]
ds_read_b128 a[168:171], v208 offset:15360
ds_read_b128 a[172:175], v208 offset:33792
v_mfma_f32_16x16x32_bf16 v[168:171], a[144:147], a[100:103], v[168:171]
v_mfma_f32_16x16x32_bf16 v[172:175], a[148:151], a[96:99], v[172:175]
v_mfma_f32_16x16x32_bf16 v[176:179], a[148:151], a[100:103], v[176:179]
s_waitcnt lgkmcnt(4)
v_mfma_f32_16x16x32_bf16 v[164:167], a[152:155], a[104:107], v[164:167]
ds_read_b128 a[144:147], v208 offset:16384
ds_read_b128 a[148:151], v208 offset:34816
v_mfma_f32_16x16x32_bf16 v[168:171], a[152:155], a[108:111], v[168:171]
v_mfma_f32_16x16x32_bf16 v[172:175], a[156:159], a[104:107], v[172:175]
v_mfma_f32_16x16x32_bf16 v[176:179], a[156:159], a[108:111], v[176:179]
s_waitcnt lgkmcnt(4)
v_mfma_f32_16x16x32_bf16 v[164:167], a[160:163], a[112:115], v[164:167]
ds_read_b128 a[152:155], v208 offset:17408
ds_read_b128 a[156:159], v208 offset:35840
v_mfma_f32_16x16x32_bf16 v[168:171], a[160:163], a[116:119], v[168:171]
buffer_load_dwordx4 a[240:243], v1, s[4:7], s52 offen offset:0 sc1
buffer_load_dwordx4 a[244:247], v9, s[4:7], s52 offen offset:0 sc1
v_mfma_f32_16x16x32_bf16 v[172:175], a[164:167], a[112:115], v[172:175]
v_mfma_f32_16x16x32_bf16 v[176:179], a[164:167], a[116:119], v[176:179]
s_waitcnt lgkmcnt(4)
v_add_u32 v181, 160768, v239
v_mfma_f32_16x16x32_bf16 v[164:167], a[168:171], a[120:123], v[164:167]
ds_read_b64 a[160:161], v181 offset:0
ds_read_b64 a[164:165], v181 offset:512
v_mfma_f32_16x16x32_bf16 v[168:171], a[168:171], a[124:127], v[168:171]
v_mfma_f32_16x16x32_bf16 v[172:175], a[172:175], a[120:123], v[172:175]
v_mfma_f32_16x16x32_bf16 v[176:179], a[172:175], a[124:127], v[176:179]
s_waitcnt lgkmcnt(4)
v_mfma_f32_16x16x32_bf16 v[164:167], a[144:147], a[128:131], v[164:167]
v_mfma_f32_16x16x32_bf16 v[168:171], a[144:147], a[132:135], v[168:171]
v_mfma_f32_16x16x32_bf16 v[172:175], a[148:151], a[128:131], v[172:175]
buffer_load_dwordx4 a[248:251], v1, s[4:7], s52 offen offset:1024 sc1
buffer_load_dwordx4 a[252:255], v9, s[4:7], s52 offen offset:1024 sc1
v_mfma_f32_16x16x32_bf16 v[176:179], a[148:151], a[132:135], v[176:179]
s_waitcnt lgkmcnt(2)
v_mfma_f32_16x16x32_bf16 v[164:167], a[152:155], a[136:139], v[164:167]
v_mfma_f32_16x16x32_bf16 v[168:171], a[152:155], a[140:143], v[168:171]
v_mfma_f32_16x16x32_bf16 v[172:175], a[156:159], a[136:139], v[172:175]
v_mfma_f32_16x16x32_bf16 v[176:179], a[156:159], a[140:143], v[176:179]
s_waitcnt lgkmcnt(0)
v_mfma_f32_16x16x16_bf16 v[164:167], a[160:161], v[212:213], v[164:167]
v_mfma_f32_16x16x16_bf16 v[168:171], a[160:161], v[214:215], v[168:171]
v_mfma_f32_16x16x16_bf16 v[172:175], a[164:165], v[212:213], v[172:175]
v_mfma_f32_16x16x16_bf16 v[176:179], a[164:165], v[214:215], v[176:179]
L_c4:
v_add_u32 v180, 0, v1
v_lshlrev_b32 v184, 16, v0
v_lshlrev_b32 v185, 16, v0
v_lshlrev_b32 v186, 16, v0
v_lshlrev_b32 v187, 16, v0
v_lshlrev_b32 v188, 16, v249
v_lshlrev_b32 v189, 16, v249
v_lshlrev_b32 v190, 16, v249
v_lshlrev_b32 v191, 16, v249
s_waitcnt lgkmcnt(0)
ds_write_b128 v240, v[36:39] offset:0
ds_write_b128 v240, v[40:43] offset:1024
ds_write_b128 v240, v[52:55] offset:2048
ds_write_b128 v240, v[56:59] offset:3072
s_cmp_eq_u32 s24, 0
s_cselect_b32 s67, 0, 1073741824
s_add_u32 s67, s67, 26542080
s_waitcnt vmcnt(4)
s_barrier
s_mov_b64 exec, 0xffff
buffer_atomic_add v4, v233, s[8:11], s67 offen sc1
s_mov_b64 exec, -1
v_add_u32 v200, 53248, v1
v_add_u32 v201, 90112, v1
v_add_u32 v202, 126976, v1
s_lshl_b32 s35, s80, 7
s_add_u32 s35, s35, 26542080
s_cmp_eq_u32 s24, 1
s_cselect_b32 s35, s35, 1073741824
v_mov_b32 v6, 0
v_mov_b32 v244, 0
v_mov_b32 v245, 0
v_mov_b32 v246, 0
buffer_load_dwordx4 a[80:83], v1, s[4:7], s52 offen offset:2048 sc1
buffer_load_dwordx4 a[84:87], v9, s[4:7], s52 offen offset:2048 sc1
ds_write_b128 v240, v[68:71] offset:4096
ds_write_b128 v240, v[72:75] offset:5120
ds_write_b128 v240, v[84:87] offset:6144
ds_write_b128 v240, v[88:91] offset:7168
ds_write_b128 v240, v[100:103] offset:8192
v_pk_mul_f32 v[192:193], v[108:109], v[108:109]
v_pk_mul_f32 v[194:195], v[110:111], v[110:111]
v_pk_mul_f32 v[196:197], v[112:113], v[112:113]
v_pk_mul_f32 v[198:199], v[114:115], v[114:115]
v_pk_fma_f32 v[192:193], v[192:193], v[252:253], v[250:251] op_sel:[0,0,0] op_sel_hi:[1,0,0]
v_pk_fma_f32 v[194:195], v[194:195], v[252:253], v[250:251] op_sel:[0,0,0] op_sel_hi:[1,0,0]
v_pk_fma_f32 v[196:197], v[196:197], v[252:253], v[250:251] op_sel:[0,1,1] op_sel_hi:[1,1,1]
v_pk_fma_f32 v[198:199], v[198:199], v[252:253], v[250:251] op_sel:[0,1,1] op_sel_hi:[1,1,1]
v_pk_mul_f32 v[192:193], v[192:193], v[108:109]
buffer_load_dwordx4 a[88:91], v1, s[4:7], s52 offen offset:3072 sc1
buffer_load_dwordx4 a[92:95], v9, s[4:7], s52 offen offset:3072 sc1
v_pk_mul_f32 v[194:195], v[194:195], v[110:111]
v_pk_mul_f32 v[196:197], v[196:197], v[112:113]
v_pk_mul_f32 v[198:199], v[198:199], v[114:115]
v_exp_f32 v192, v192
v_exp_f32 v193, v193
v_exp_f32 v194, v194
v_exp_f32 v195, v195
v_exp_f32 v196, v196
v_exp_f32 v197, v197
v_exp_f32 v198, v198
v_exp_f32 v199, v199
v_pk_fma_f32 v[192:193], v[192:193], v[254:255], v[254:255] op_sel:[0,0,0] op_sel_hi:[1,0,0]
v_pk_fma_f32 v[194:195], v[194:195], v[254:255], v[254:255] op_sel:[0,0,0] op_sel_hi:[1,0,0]
v_pk_fma_f32 v[196:197], v[196:197], v[254:255], v[254:255] op_sel:[0,1,1] op_sel_hi:[1,1,1]
s_cmp_eq_u32 s25, 2
s_cselect_b32 s98, 4096, 0
s_add_u32 s52, s52, s98
s_add_u32 s52, s52, 4096
buffer_load_dwordx4 a[96:99], v1, s[4:7], s52 offen offset:0 sc1
s_mov_b64 exec, 1
buffer_atomic_add v244, v6, s[8:11], s35 offen sc0 sc1
s_mov_b64 exec, -1
buffer_load_dwordx4 a[100:103], v9, s[4:7], s52 offen offset:0 sc1
v_pk_fma_f32 v[198:199], v[198:199], v[254:255], v[254:255] op_sel:[0,1,1] op_sel_hi:[1,1,1]
v_rcp_f32 v192, v192
v_rcp_f32 v193, v193
v_rcp_f32 v194, v194
v_rcp_f32 v195, v195
v_rcp_f32 v196, v196
v_rcp_f32 v197, v197
v_rcp_f32 v198, v198
v_rcp_f32 v199, v199
v_pk_mul_f32 v[108:109], v[108:109], v[192:193]
v_pk_mul_f32 v[110:111], v[110:111], v[194:195]
v_pk_mul_f32 v[112:113], v[112:113], v[196:197]
v_pk_mul_f32 v[114:115], v[114:115], v[198:199]
v_pk_mul_f32 v[192:193], v[116:117], v[116:117]
buffer_load_dwordx4 a[104:107], v1, s[4:7], s52 offen offset:1024 sc1
buffer_load_dwordx4 a[108:111], v9, s[4:7], s52 offen offset:1024 sc1
v_pk_mul_f32 v[194:195], v[118:119], v[118:119]
v_pk_mul_f32 v[196:197], v[120:121], v[120:121]
v_pk_mul_f32 v[198:199], v[122:123], v[122:123]
v_pk_fma_f32 v[192:193], v[192:193], v[252:253], v[250:251] op_sel:[0,0,0] op_sel_hi:[1,0,0]
v_pk_fma_f32 v[194:195], v[194:195], v[252:253], v[250:251] op_sel:[0,0,0] op_sel_hi:[1,0,0]
v_pk_fma_f32 v[196:197], v[196:197], v[252:253], v[250:251] op_sel:[0,1,1] op_sel_hi:[1,1,1]
v_pk_fma_f32 v[198:199], v[198:199], v[252:253], v[250:251] op_sel:[0,1,1] op_sel_hi:[1,1,1]
v_pk_mul_f32 v[192:193], v[192:193], v[116:117]
v_pk_mul_f32 v[194:195], v[194:195], v[118:119]
v_pk_mul_f32 v[196:197], v[196:197], v[120:121]
v_pk_mul_f32 v[198:199], v[198:199], v[122:123]
v_exp_f32 v192, v192
v_exp_f32 v193, v193
v_exp_f32 v194, v194
buffer_load_dwordx4 a[112:115], v1, s[4:7], s52 offen offset:2048 sc1
s_mov_b64 exec, 1
buffer_atomic_add v245, v6, s[8:11], s35 offen sc0 sc1
s_mov_b64 exec, -1
buffer_load_dwordx4 a[116:119], v9, s[4:7], s52 offen offset:2048 sc1
v_exp_f32 v195, v195
v_exp_f32 v196, v196
v_exp_f32 v197, v197
v_exp_f32 v198, v198
v_exp_f32 v199, v199
v_pk_fma_f32 v[192:193], v[192:193], v[254:255], v[254:255] op_sel:[0,0,0] op_sel_hi:[1,0,0]
v_pk_fma_f32 v[194:195], v[194:195], v[254:255], v[254:255] op_sel:[0,0,0] op_sel_hi:[1,0,0]
v_pk_fma_f32 v[196:197], v[196:197], v[254:255], v[254:255] op_sel:[0,1,1] op_sel_hi:[1,1,1]
v_pk_fma_f32 v[198:199], v[198:199], v[254:255], v[254:255] op_sel:[0,1,1] op_sel_hi:[1,1,1]
v_rcp_f32 v192, v192
v_rcp_f32 v193, v193
v_rcp_f32 v194, v194
v_rcp_f32 v195, v195
v_rcp_f32 v196, v196
buffer_load_dwordx4 a[120:123], v1, s[4:7], s52 offen offset:3072 sc1
buffer_load_dwordx4 a[124:127], v9, s[4:7], s52 offen offset:3072 sc1
v_rcp_f32 v197, v197
v_rcp_f32 v198, v198
v_rcp_f32 v199, v199
v_pk_mul_f32 v[116:117], v[116:117], v[192:193]
v_pk_mul_f32 v[118:119], v[118:119], v[194:195]
v_pk_mul_f32 v[120:121], v[120:121], v[196:197]
v_pk_mul_f32 v[122:123], v[122:123], v[198:199]
v_pk_mul_f32 v[192:193], v[124:125], v[124:125]
v_pk_mul_f32 v[194:195], v[126:127], v[126:127]
v_pk_mul_f32 v[196:197], v[128:129], v[128:129]
v_pk_mul_f32 v[198:199], v[130:131], v[130:131]
v_pk_fma_f32 v[192:193], v[192:193], v[252:253], v[250:251] op_sel:[0,0,0] op_sel_hi:[1,0,0]
v_pk_fma_f32 v[194:195], v[194:195], v[252:253], v[250:251] op_sel:[0,0,0] op_sel_hi:[1,0,0]
v_pk_fma_f32 v[196:197], v[196:197], v[252:253], v[250:251] op_sel:[0,1,1] op_sel_hi:[1,1,1]
s_cmp_eq_u32 s25, 3
s_cselect_b32 s98, 4096, 0
s_add_u32 s52, s52, s98
s_add_u32 s52, s52, 4096
buffer_load_dwordx4 a[128:131], v1, s[4:7], s52 offen offset:0 sc1
s_mov_b64 exec, 1
buffer_atomic_add v246, v6, s[8:11], s35 offen sc0 sc1
s_mov_b64 exec, -1
buffer_load_dwordx4 a[132:135], v9, s[4:7], s52 offen offset:0 sc1
v_pk_fma_f32 v[198:199], v[198:199], v[252:253], v[250:251] op_sel:[0,1,1] op_sel_hi:[1,1,1]
v_pk_mul_f32 v[192:193], v[192:193], v[124:125]
v_pk_mul_f32 v[194:195], v[194:195], v[126:127]
v_pk_mul_f32 v[196:197], v[196:197], v[128:129]
v_pk_mul_f32 v[198:199], v[198:199], v[130:131]
v_exp_f32 v192, v192
v_exp_f32 v193, v193
v_exp_f32 v194, v194
v_exp_f32 v195, v195
v_exp_f32 v196, v196
v_exp_f32 v197, v197
v_exp_f32 v198, v198
v_exp_f32 v199, v199
v_pk_fma_f32 v[192:193], v[192:193], v[254:255], v[254:255] op_sel:[0,0,0] op_sel_hi:[1,0,0]
buffer_load_dwordx4 a[136:139], v1, s[4:7], s52 offen offset:1024 sc1
buffer_load_dwordx4 a[140:143], v9, s[4:7], s52 offen offset:1024 sc1
v_pk_fma_f32 v[194:195], v[194:195], v[254:255], v[254:255] op_sel:[0,0,0] op_sel_hi:[1,0,0]
v_pk_fma_f32 v[196:197], v[196:197], v[254:255], v[254:255] op_sel:[0,1,1] op_sel_hi:[1,1,1]
v_pk_fma_f32 v[198:199], v[198:199], v[254:255], v[254:255] op_sel:[0,1,1] op_sel_hi:[1,1,1]
v_rcp_f32 v192, v192
v_rcp_f32 v193, v193
v_rcp_f32 v194, v194
v_rcp_f32 v195, v195
v_rcp_f32 v196, v196
v_rcp_f32 v197, v197
v_rcp_f32 v198, v198
v_rcp_f32 v199, v199
v_pk_mul_f32 v[124:125], v[124:125], v[192:193]
v_pk_mul_f32 v[126:127], v[126:127], v[194:195]
v_pk_mul_f32 v[128:129], v[128:129], v[196:197]
v_pk_mul_f32 v[130:131], v[130:131], v[198:199]
s_mul_i32 s30, s26, 589824
s_add_u32 s30, s30, 7340032
s_lshl_b32 s62, s24, 12
s_lshl_b32 s63, s24, 10
s_add_u32 s60, s30, s62
s_add_u32 s61, s30, s63
s_add_u32 s61, s61, 16384
s_cmp_eq_u32 s25, 0
s_cselect_b32 s99, 36864, 0
s_add_u32 s60, s60, s99
s_add_u32 s61, s61, s99
s_add_u32 m0, s62, 53248
s_add_u32 s60, s60, 0
s_waitcnt lgkmcnt(0)
s_cmp_eq_u32 s24, 1
s_cbranch_scc0 L_other_28
s_mov_b32 s31, 0
s_mov_b64 exec, 1
v_mov_b32 v247, 0
buffer_atomic_add v247, v6, s[8:11], s35 offen sc0 sc1
s_waitcnt vmcnt(14)
v_cmp_gt_u32 vcc, 16, v244
s_nop 0
s_cbranch_vccz L_polled_27
s_waitcnt vmcnt(9)
v_cmp_gt_u32 vcc, 16, v245
s_nop 0
s_cbranch_vccz L_polled_27
v_mov_b32 v244, 0
buffer_atomic_add v244, v6, s[8:11], s35 offen sc0 sc1
s_waitcnt vmcnt(5)
v_cmp_gt_u32 vcc, 16, v246
s_nop 0
s_cbranch_vccz L_polled_27
v_mov_b32 v245, 0
buffer_atomic_add v245, v6, s[8:11], s35 offen sc0 sc1
L_poll_26:
s_add_u32 s31, s31, 1
s_cmp_gt_u32 s31, 100000
s_cbranch_scc1 L_polled_27
v_mov_b32 v246, 0
buffer_atomic_add v246, v6, s[8:11], s35 offen sc0 sc1
s_waitcnt vmcnt(3)
v_cmp_gt_u32 vcc, 16, v247
s_nop 0
s_cbranch_vccz L_polled_27
v_mov_b32 v247, 0
buffer_atomic_add v247, v6, s[8:11], s35 offen sc0 sc1
s_waitcnt vmcnt(3)
v_cmp_gt_u32 vcc, 16, v244
s_nop 0
s_cbranch_vccz L_polled_27
v_mov_b32 v244, 0
buffer_atomic_add v244, v6, s[8:11], s35 offen sc0 sc1
s_waitcnt vmcnt(3)
v_cmp_gt_u32 vcc, 16, v245
s_nop 0
s_cbranch_vccz L_polled_27
v_mov_b32 v245, 0
buffer_atomic_add v245, v6, s[8:11], s35 offen sc0 sc1
s_waitcnt vmcnt(3)
v_cmp_gt_u32 vcc, 16, v246
s_nop 0
s_cbranch_vccz L_polled_27
s_branch L_poll_26
L_polled_27:
s_mov_b64 exec, -1
L_other_28:
s_barrier
buffer_load_dwordx4 v1, s[8:11], s60 offen offset:0 sc1 lds
buffer_load_dwordx4 v1, s[8:11], s60 offen offset:1024 sc1 lds
ds_read_b128 a[0:3], v180 offset:0
ds_read_b128 a[4:7], v180 offset:1024
ds_read_b128 a[8:11], v180 offset:2048
ds_read_b128 a[12:15], v180 offset:3072
ds_read_b128 a[16:19], v180 offset:4096
ds_read_b128 a[20:23], v180 offset:5120
ds_read_b128 a[24:27], v180 offset:6144
ds_read_b128 a[28:31], v180 offset:7168
ds_read_b128 a[32:35], v180 offset:8192
buffer_load_dwordx4 v1, s[8:11], s60 offen offset:2048 sc1 lds
buffer_load_dwordx4 v1, s[8:11], s60 offen offset:3072 sc1 lds
s_add_u32 m0, s63, 69632
s_add_u32 s61, s61, 0
buffer_load_dwordx4 v1, s[8:11], s61 offen offset:0 sc1 lds
s_waitcnt lgkmcnt(0)
v_mfma_f32_16x16x32_bf16 v[36:39], a[0:3], a[176:179], v[184:187]
ds_read_b128 a[36:39], v180 offset:9216
s_add_u32 m0, s62, 73728
v_mfma_f32_16x16x32_bf16 v[40:43], a[0:3], a[180:183], v[188:191]
ds_read_b128 a[40:43], v180 offset:10240
v_mul_f32 v192, v132, v132
v_mfma_f32_16x16x32_bf16 v[44:47], a[4:7], a[176:179], v[184:187]
ds_read_b128 a[44:47], v180 offset:11264
s_add_u32 s60, s60, 20480
v_mfma_f32_16x16x32_bf16 v[48:51], a[4:7], a[180:183], v[188:191]
ds_read_b128 a[48:51], v180 offset:12288
v_mul_f32 v193, v133, v133
v_mfma_f32_16x16x32_bf16 v[52:55], a[8:11], a[176:179], v[184:187]
ds_read_b128 a[52:55], v180 offset:13312
v_mul_f32 v194, v134, v134
v_mfma_f32_16x16x32_bf16 v[56:59], a[8:11], a[180:183], v[188:191]
ds_read_b128 a[56:59], v180 offset:14336
buffer_load_dwordx4 v1, s[8:11], s60 offen offset:0 sc1 lds
v_mfma_f32_16x16x32_bf16 v[60:63], a[12:15], a[176:179], v[184:187]
ds_read_b128 a[60:63], v180 offset:15360
v_mfma_f32_16x16x32_bf16 v[64:67], a[12:15], a[180:183], v[188:191]
ds_read_b128 a[64:67], v180 offset:16384
v_mul_f32 v195, v135, v135
v_mfma_f32_16x16x32_bf16 v[68:71], a[16:19], a[176:179], v[184:187]
ds_read_b128 a[68:71], v180 offset:17408
buffer_load_dwordx4 v1, s[8:11], s60 offen offset:1024 sc1 lds
v_mfma_f32_16x16x32_bf16 v[72:75], a[16:19], a[180:183], v[188:191]
v_fma_f32 v192, v192, v252, v250
v_mfma_f32_16x16x32_bf16 v[76:79], a[20:23], a[176:179], v[184:187]
v_mfma_f32_16x16x32_bf16 v[80:83], a[20:23], a[180:183], v[188:191]
buffer_load_dwordx4 v1, s[8:11], s60 offen offset:2048 sc1 lds
v_fma_f32 v193, v193, v252, v250
v_mfma_f32_16x16x32_bf16 v[84:87], a[24:27], a[176:179], v[184:187]
v_mfma_f32_16x16x32_bf16 v[88:91], a[24:27], a[180:183], v[188:191]
v_mfma_f32_16x16x32_bf16 v[92:95], a[28:31], a[176:179], v[184:187]
buffer_load_dwordx4 v1, s[8:11], s60 offen offset:3072 sc1 lds
v_fma_f32 v194, v194, v252, v250
v_mfma_f32_16x16x32_bf16 v[96:99], a[28:31], a[180:183], v[188:191]
v_mfma_f32_16x16x32_bf16 v[100:103], a[32:35], a[176:179], v[184:187]
v_fma_f32 v195, v195, v252, v250
v_mfma_f32_16x16x32_bf16 v[104:107], a[32:35], a[180:183], v[188:191]
s_waitcnt lgkmcnt(0)
v_mfma_f32_16x16x32_bf16 v[36:39], a[36:39], a[184:187], v[36:39]
ds_read_b128 a[0:3], v180 offset:18432
v_mul_f32 v192, v192, v132
v_mfma_f32_16x16x32_bf16 v[40:43], a[36:39], a[188:191], v[40:43]
ds_read_b128 a[4:7], v180 offset:19456
v_mfma_f32_16x16x32_bf16 v[44:47], a[40:43], a[184:187], v[44:47]
ds_read_b128 a[8:11], v180 offset:20480
v_mfma_f32_16x16x32_bf16 v[48:51], a[40:43], a[188:191], v[48:51]
ds_read_b128 a[12:15], v180 offset:21504
v_mul_f32 v193, v193, v133
v_mfma_f32_16x16x32_bf16 v[52:55], a[44:47], a[184:187], v[52:55]
ds_read_b128 a[16:19], v180 offset:22528
v_mfma_f32_16x16x32_bf16 v[56:59], a[44:47], a[188:191], v[56:59]
ds_read_b128 a[20:23], v180 offset:23552
v_mul_f32 v194, v194, v134
v_mfma_f32_16x16x32_bf16 v[60:63], a[48:51], a[184:187], v[60:63]
ds_read_b128 a[24:27], v180 offset:24576
v_mfma_f32_16x16x32_bf16 v[64:67], a[48:51], a[188:191], v[64:67]
ds_read_b128 a[28:31], v180 offset:25600
v_mul_f32 v195, v195, v135
v_mfma_f32_16x16x32_bf16 v[68:71], a[52:55], a[184:187], v[68:71]
ds_read_b128 a[32:35], v180 offset:26624
v_mfma_f32_16x16x32_bf16 v[72:75], a[52:55], a[188:191], v[72:75]
s_cmp_eq_u32 s25, 1
s_cselect_b32 s99, 36864, 0
s_add_u32 s60, s60, s99
v_mfma_f32_16x16x32_bf16 v[76:79], a[56:59], a[184:187], v[76:79]
s_add_u32 s61, s61, s99
s_add_u32 m0, s62, 90112
s_add_u32 s60, s60, 16384
v_mfma_f32_16x16x32_bf16 v[80:83], a[56:59], a[188:191], v[80:83]
buffer_load_dwordx4 v1, s[8:11], s60 offen offset:0 sc1 lds
v_mfma_f32_16x16x32_bf16 v[84:87], a[60:63], a[184:187], v[84:87]
buffer_load_dwordx4 v1, s[8:11], s60 offen offset:1024 sc1 lds
v_mfma_f32_16x16x32_bf16 v[88:91], a[60:63], a[188:191], v[88:91]
buffer_load_dwordx4 v1, s[8:11], s60 offen offset:2048 sc1 lds
v_mfma_f32_16x16x32_bf16 v[92:95], a[64:67], a[184:187], v[92:95]
v_exp_f32 v192, v192
v_mfma_f32_16x16x32_bf16 v[96:99], a[64:67], a[188:191], v[96:99]
buffer_load_dwordx4 v1, s[8:11], s60 offen offset:3072 sc1 lds
v_mfma_f32_16x16x32_bf16 v[100:103], a[68:71], a[184:187], v[100:103]
v_exp_f32 v193, v193
v_mfma_f32_16x16x32_bf16 v[104:107], a[68:71], a[188:191], v[104:107]
s_waitcnt lgkmcnt(0)
v_mfma_f32_16x16x32_bf16 v[36:39], a[0:3], a[192:195], v[36:39]
ds_read_b128 a[36:39], v180 offset:27648
s_add_u32 m0, s63, 106496
v_mfma_f32_16x16x32_bf16 v[40:43], a[0:3], a[196:199], v[40:43]
ds_read_b128 a[40:43], v180 offset:28672
v_mfma_f32_16x16x32_bf16 v[44:47], a[4:7], a[192:195], v[44:47]
ds_read_b128 a[44:47], v180 offset:29696
s_add_u32 s61, s61, 36864
v_mfma_f32_16x16x32_bf16 v[48:51], a[4:7], a[196:199], v[48:51]
ds_read_b128 a[48:51], v180 offset:30720
v_mfma_f32_16x16x32_bf16 v[52:55], a[8:11], a[192:195], v[52:55]
ds_read_b128 a[52:55], v180 offset:31744
buffer_load_dwordx4 v1, s[8:11], s61 offen offset:0 sc1 lds
v_mfma_f32_16x16x32_bf16 v[56:59], a[8:11], a[196:199], v[56:59]
ds_read_b128 a[56:59], v180 offset:32768
v_mfma_f32_16x16x32_bf16 v[60:63], a[12:15], a[192:195], v[60:63]
ds_read_b128 a[60:63], v180 offset:33792
s_add_u32 m0, s62, 110592
v_mfma_f32_16x16x32_bf16 v[64:67], a[12:15], a[196:199], v[64:67]
ds_read_b128 a[64:67], v180 offset:34816
v_mfma_f32_16x16x32_bf16 v[68:71], a[16:19], a[192:195], v[68:71]
ds_read_b128 a[68:71], v180 offset:35840
s_add_u32 s60, s60, 20480
v_mfma_f32_16x16x32_bf16 v[72:75], a[16:19], a[196:199], v[72:75]
v_exp_f32 v194, v194
v_mfma_f32_16x16x32_bf16 v[76:79], a[20:23], a[192:195], v[76:79]
buffer_load_dwordx4 v1, s[8:11], s60 offen offset:0 sc1 lds
v_mfma_f32_16x16x32_bf16 v[80:83], a[20:23], a[196:199], v[80:83]
v_exp_f32 v195, v195
v_mfma_f32_16x16x32_bf16 v[84:87], a[24:27], a[192:195], v[84:87]
buffer_load_dwordx4 v1, s[8:11], s60 offen offset:1024 sc1 lds
v_fma_f32 v192, v192, v254, v254
v_mfma_f32_16x16x32_bf16 v[88:91], a[24:27], a[196:199], v[88:91]
v_fma_f32 v193, v193, v254, v254
v_mfma_f32_16x16x32_bf16 v[92:95], a[28:31], a[192:195], v[92:95]
buffer_load_dwordx4 v1, s[8:11], s60 offen offset:2048 sc1 lds
v_mfma_f32_16x16x32_bf16 v[96:99], a[28:31], a[196:199], v[96:99]
v_fma_f32 v194, v194, v254, v254
v_mfma_f32_16x16x32_bf16 v[100:103], a[32:35], a[192:195], v[100:103]
v_mfma_f32_16x16x32_bf16 v[104:107], a[32:35], a[196:199], v[104:107]
s_waitcnt vmcnt(12) lgkmcnt(0)
s_barrier
v_mfma_f32_16x16x32_bf16 v[36:39], a[36:39], a[200:203], v[36:39]
ds_read_b128 a[0:3], v200 offset:0
buffer_load_dwordx4 v1, s[8:11], s60 offen offset:3072 sc1 lds
v_mfma_f32_16x16x32_bf16 v[40:43], a[36:39], a[204:207], v[40:43]
ds_read_b128 a[4:7], v200 offset:1024
v_fma_f32 v195, v195, v254, v254
v_mfma_f32_16x16x32_bf16 v[44:47], a[40:43], a[200:203], v[44:47]
ds_read_b128 a[8:11], v200 offset:2048
v_mfma_f32_16x16x32_bf16 v[48:51], a[40:43], a[204:207], v[48:51]
ds_read_b128 a[12:15], v200 offset:3072
v_mfma_f32_16x16x32_bf16 v[52:55], a[44:47], a[200:203], v[52:55]
ds_read_b128 a[16:19], v200 offset:4096
v_mfma_f32_16x16x32_bf16 v[56:59], a[44:47], a[204:207], v[56:59]
ds_read_b128 a[20:23], v200 offset:5120
v_mfma_f32_16x16x32_bf16 v[60:63], a[48:51], a[200:203], v[60:63]
ds_read_b128 a[24:27], v200 offset:6144
v_mfma_f32_16x16x32_bf16 v[64:67], a[48:51], a[204:207], v[64:67]
ds_read_b128 a[28:31], v200 offset:7168
v_mfma_f32_16x16x32_bf16 v[68:71], a[52:55], a[200:203], v[68:71]
ds_read_b128 a[32:35], v200 offset:8192
v_mfma_f32_16x16x32_bf16 v[72:75], a[52:55], a[204:207], v[72:75]
s_cmp_eq_u32 s25, 2
s_cselect_b32 s99, 36864, 0
s_add_u32 s60, s60, s99
v_mfma_f32_16x16x32_bf16 v[76:79], a[56:59], a[200:203], v[76:79]
s_add_u32 s61, s61, s99
s_add_u32 m0, s62, 126976
s_add_u32 s60, s60, 16384
v_mfma_f32_16x16x32_bf16 v[80:83], a[56:59], a[204:207], v[80:83]
buffer_load_dwordx4 v1, s[8:11], s60 offen offset:0 sc1 lds
v_mfma_f32_16x16x32_bf16 v[84:87], a[60:63], a[200:203], v[84:87]
v_rcp_f32 v192, v192
v_mfma_f32_16x16x32_bf16 v[88:91], a[60:63], a[204:207], v[88:91]
buffer_load_dwordx4 v1, s[8:11], s60 offen offset:1024 sc1 lds
v_mfma_f32_16x16x32_bf16 v[92:95], a[64:67], a[200:203], v[92:95]
v_rcp_f32 v193, v193
v_mfma_f32_16x16x32_bf16 v[96:99], a[64:67], a[204:207], v[96:99]
buffer_load_dwordx4 v1, s[8:11], s60 offen offset:2048 sc1 lds
v_mfma_f32_16x16x32_bf16 v[100:103], a[68:71], a[200:203], v[100:103]
v_rcp_f32 v194, v194
v_mfma_f32_16x16x32_bf16 v[104:107], a[68:71], a[204:207], v[104:107]
s_waitcnt lgkmcnt(0)
v_mfma_f32_16x16x32_bf16 v[36:39], a[0:3], a[208:211], v[36:39]
ds_read_b128 a[36:39], v200 offset:9216
buffer_load_dwordx4 v1, s[8:11], s60 offen offset:3072 sc1 lds
v_mfma_f32_16x16x32_bf16 v[40:43], a[0:3], a[212:215], v[40:43]
ds_read_b128 a[40:43], v200 offset:10240
v_mfma_f32_16x16x32_bf16 v[44:47], a[4:7], a[208:211], v[44:47]
ds_read_b128 a[44:47], v200 offset:11264
s_add_u32 m0, s63, 143360
v_mfma_f32_16x16x32_bf16 v[48:51], a[4:7], a[212:215], v[48:51]
ds_read_b128 a[48:51], v200 offset:12288
v_mfma_f32_16x16x32_bf16 v[52:55], a[8:11], a[208:211], v[52:55]
ds_read_b128 a[52:55], v200 offset:13312
s_add_u32 s61, s61, 36864
v_mfma_f32_16x16x32_bf16 v[56:59], a[8:11], a[212:215], v[56:59]
ds_read_b128 a[56:59], v200 offset:14336
v_mfma_f32_16x16x32_bf16 v[60:63], a[12:15], a[208:211], v[60:63]
ds_read_b128 a[60:63], v200 offset:15360
buffer_load_dwordx4 v1, s[8:11], s61 offen offset:0 sc1 lds
v_mfma_f32_16x16x32_bf16 v[64:67], a[12:15], a[212:215], v[64:67]
ds_read_b128 a[64:67], v200 offset:16384
v_mfma_f32_16x16x32_bf16 v[68:71], a[16:19], a[208:211], v[68:71]
ds_read_b128 a[68:71], v200 offset:17408
s_add_u32 m0, s62, 147456
v_mfma_f32_16x16x32_bf16 v[72:75], a[16:19], a[212:215], v[72:75]
s_add_u32 s60, s60, 20480
v_rcp_f32 v195, v195
v_mfma_f32_16x16x32_bf16 v[76:79], a[20:23], a[208:211], v[76:79]
v_mul_f32 v132, v132, v192
v_mul_f32 v133, v133, v193
v_mfma_f32_16x16x32_bf16 v[80:83], a[20:23], a[212:215], v[80:83]
v_mul_f32 v134, v134, v194
v_mul_f32 v135, v135, v195
v_mfma_f32_16x16x32_bf16 v[84:87], a[24:27], a[208:211], v[84:87]
buffer_load_dwordx4 v1, s[8:11], s60 offen offset:0 sc1 lds
v_mul_f32 v196, v136, v136
v_mfma_f32_16x16x32_bf16 v[88:91], a[24:27], a[212:215], v[88:91]
v_mfma_f32_16x16x32_bf16 v[92:95], a[28:31], a[208:211], v[92:95]
buffer_load_dwordx4 v1, s[8:11], s60 offen offset:1024 sc1 lds
v_mfma_f32_16x16x32_bf16 v[96:99], a[28:31], a[212:215], v[96:99]
v_mul_f32 v197, v137, v137
v_mfma_f32_16x16x32_bf16 v[100:103], a[32:35], a[208:211], v[100:103]
v_mfma_f32_16x16x32_bf16 v[104:107], a[32:35], a[212:215], v[104:107]
s_waitcnt vmcnt(16) lgkmcnt(0)
s_barrier
v_mfma_f32_16x16x32_bf16 v[36:39], a[36:39], a[216:219], v[36:39]
ds_read_b128 a[0:3], v200 offset:18432
buffer_load_dwordx4 v1, s[8:11], s60 offen offset:2048 sc1 lds
v_mfma_f32_16x16x32_bf16 v[40:43], a[36:39], a[220:223], v[40:43]
ds_read_b128 a[4:7], v200 offset:19456
v_mul_f32 v198, v138, v138
v_mfma_f32_16x16x32_bf16 v[44:47], a[40:43], a[216:219], v[44:47]
ds_read_b128 a[8:11], v200 offset:20480
v_mul_f32 v199, v139, v139
v_mfma_f32_16x16x32_bf16 v[48:51], a[40:43], a[220:223], v[48:51]
ds_read_b128 a[12:15], v200 offset:21504
v_mfma_f32_16x16x32_bf16 v[52:55], a[44:47], a[216:219], v[52:55]
ds_read_b128 a[16:19], v200 offset:22528
buffer_load_dwordx4 v1, s[8:11], s60 offen offset:3072 sc1 lds
v_mfma_f32_16x16x32_bf16 v[56:59], a[44:47], a[220:223], v[56:59]
ds_read_b128 a[20:23], v200 offset:23552
v_fma_f32 v196, v196, v253, v251
v_mfma_f32_16x16x32_bf16 v[60:63], a[48:51], a[216:219], v[60:63]
ds_read_b128 a[24:27], v200 offset:24576
v_fma_f32 v197, v197, v253, v251
v_mfma_f32_16x16x32_bf16 v[64:67], a[48:51], a[220:223], v[64:67]
ds_read_b128 a[28:31], v200 offset:25600
v_mfma_f32_16x16x32_bf16 v[68:71], a[52:55], a[216:219], v[68:71]
ds_read_b128 a[32:35], v200 offset:26624
buffer_load_dwordx4 a[144:147], v1, s[4:7], s52 offen offset:2048 sc1
v_mfma_f32_16x16x32_bf16 v[72:75], a[52:55], a[220:223], v[72:75]
v_fma_f32 v198, v198, v253, v251
v_mfma_f32_16x16x32_bf16 v[76:79], a[56:59], a[216:219], v[76:79]
v_mfma_f32_16x16x32_bf16 v[80:83], a[56:59], a[220:223], v[80:83]
v_fma_f32 v199, v199, v253, v251
v_mfma_f32_16x16x32_bf16 v[84:87], a[60:63], a[216:219], v[84:87]
buffer_load_dwordx4 a[148:151], v9, s[4:7], s52 offen offset:2048 sc1
v_mfma_f32_16x16x32_bf16 v[88:91], a[60:63], a[220:223], v[88:91]
v_mul_f32 v196, v196, v136
v_mfma_f32_16x16x32_bf16 v[92:95], a[64:67], a[216:219], v[92:95]
v_mfma_f32_16x16x32_bf16 v[96:99], a[64:67], a[220:223], v[96:99]
v_mfma_f32_16x16x32_bf16 v[100:103], a[68:71], a[216:219], v[100:103]
v_mul_f32 v197, v197, v137
v_mfma_f32_16x16x32_bf16 v[104:107], a[68:71], a[220:223], v[104:107]
s_waitcnt lgkmcnt(0)
v_mfma_f32_16x16x32_bf16 v[36:39], a[0:3], a[224:227], v[36:39]
ds_read_b128 a[36:39], v200 offset:27648
buffer_load_dwordx4 a[152:155], v1, s[4:7], s52 offen offset:3072 sc1
v_mfma_f32_16x16x32_bf16 v[40:43], a[0:3], a[228:231], v[40:43]
ds_read_b128 a[40:43], v200 offset:28672
v_mul_f32 v198, v198, v138
v_mfma_f32_16x16x32_bf16 v[44:47], a[4:7], a[224:227], v[44:47]
ds_read_b128 a[44:47], v200 offset:29696
buffer_load_dwordx4 a[156:159], v9, s[4:7], s52 offen offset:3072 sc1
v_mfma_f32_16x16x32_bf16 v[48:51], a[4:7], a[228:231], v[48:51]
ds_read_b128 a[48:51], v200 offset:30720
v_mul_f32 v199, v199, v139
v_mfma_f32_16x16x32_bf16 v[52:55], a[8:11], a[224:227], v[52:55]
ds_read_b128 a[52:55], v200 offset:31744
v_mfma_f32_16x16x32_bf16 v[56:59], a[8:11], a[228:231], v[56:59]
ds_read_b128 a[56:59], v200 offset:32768
v_mfma_f32_16x16x32_bf16 v[60:63], a[12:15], a[224:227], v[60:63]
ds_read_b128 a[60:63], v200 offset:33792
v_mfma_f32_16x16x32_bf16 v[64:67], a[12:15], a[228:231], v[64:67]
ds_read_b128 a[64:67], v200 offset:34816
v_mfma_f32_16x16x32_bf16 v[68:71], a[16:19], a[224:227], v[68:71]
ds_read_b128 a[68:71], v200 offset:35840
v_mfma_f32_16x16x32_bf16 v[72:75], a[16:19], a[228:231], v[72:75]
s_cmp_eq_u32 s25, 4
s_cselect_b32 s98, 4096, 0
s_add_u32 s52, s52, s98
v_mfma_f32_16x16x32_bf16 v[76:79], a[20:23], a[224:227], v[76:79]
s_add_u32 s52, s52, 4096
v_exp_f32 v196, v196
v_mfma_f32_16x16x32_bf16 v[80:83], a[20:23], a[228:231], v[80:83]
v_exp_f32 v197, v197
v_mfma_f32_16x16x32_bf16 v[84:87], a[24:27], a[224:227], v[84:87]
buffer_load_dwordx4 a[160:163], v1, s[4:7], s52 offen offset:0 sc1
v_mfma_f32_16x16x32_bf16 v[88:91], a[24:27], a[228:231], v[88:91]
v_mfma_f32_16x16x32_bf16 v[92:95], a[28:31], a[224:227], v[92:95]
buffer_load_dwordx4 a[164:167], v9, s[4:7], s52 offen offset:0 sc1
v_mfma_f32_16x16x32_bf16 v[96:99], a[28:31], a[228:231], v[96:99]
v_exp_f32 v198, v198
v_mfma_f32_16x16x32_bf16 v[100:103], a[32:35], a[224:227], v[100:103]
v_mfma_f32_16x16x32_bf16 v[104:107], a[32:35], a[228:231], v[104:107]
s_waitcnt vmcnt(19) lgkmcnt(0)
s_barrier
v_mfma_f32_16x16x32_bf16 v[36:39], a[36:39], a[232:235], v[36:39]
ds_read_b128 a[0:3], v201 offset:0
buffer_load_dwordx4 a[168:171], v1, s[4:7], s52 offen offset:1024 sc1
v_mfma_f32_16x16x32_bf16 v[40:43], a[36:39], a[236:239], v[40:43]
ds_read_b128 a[4:7], v201 offset:1024
buffer_load_dwordx4 a[172:175], v9, s[4:7], s52 offen offset:1024 sc1
v_mfma_f32_16x16x32_bf16 v[44:47], a[40:43], a[232:235], v[44:47]
ds_read_b128 a[8:11], v201 offset:2048
v_mfma_f32_16x16x32_bf16 v[48:51], a[40:43], a[236:239], v[48:51]
ds_read_b128 a[12:15], v201 offset:3072
v_mfma_f32_16x16x32_bf16 v[52:55], a[44:47], a[232:235], v[52:55]
ds_read_b128 a[16:19], v201 offset:4096
v_mfma_f32_16x16x32_bf16 v[56:59], a[44:47], a[236:239], v[56:59]
ds_read_b128 a[20:23], v201 offset:5120
v_mfma_f32_16x16x32_bf16 v[60:63], a[48:51], a[232:235], v[60:63]
ds_read_b128 a[24:27], v201 offset:6144
v_mfma_f32_16x16x32_bf16 v[64:67], a[48:51], a[236:239], v[64:67]
ds_read_b128 a[28:31], v201 offset:7168
v_mfma_f32_16x16x32_bf16 v[68:71], a[52:55], a[232:235], v[68:71]
ds_read_b128 a[32:35], v201 offset:8192
v_mfma_f32_16x16x32_bf16 v[72:75], a[52:55], a[236:239], v[72:75]
s_cmp_eq_u32 s25, 3
s_cselect_b32 s99, 36864, 0
s_add_u32 s60, s60, s99
v_mfma_f32_16x16x32_bf16 v[76:79], a[56:59], a[232:235], v[76:79]
s_add_u32 s61, s61, s99
s_add_u32 m0, s62, 53248
v_mfma_f32_16x16x32_bf16 v[80:83], a[56:59], a[236:239], v[80:83]
s_add_u32 s60, s60, 16384
v_exp_f32 v199, v199
v_mfma_f32_16x16x32_bf16 v[84:87], a[60:63], a[232:235], v[84:87]
v_fma_f32 v196, v196, v255, v255
v_fma_f32 v197, v197, v255, v255
v_mfma_f32_16x16x32_bf16 v[88:91], a[60:63], a[236:239], v[88:91]
buffer_load_dwordx4 v1, s[8:11], s60 offen offset:0 sc1 lds
v_fma_f32 v198, v198, v255, v255
v_mfma_f32_16x16x32_bf16 v[92:95], a[64:67], a[232:235], v[92:95]
v_fma_f32 v199, v199, v255, v255
v_mfma_f32_16x16x32_bf16 v[96:99], a[64:67], a[236:239], v[96:99]
buffer_load_dwordx4 v1, s[8:11], s60 offen offset:1024 sc1 lds
v_mfma_f32_16x16x32_bf16 v[100:103], a[68:71], a[232:235], v[100:103]
v_rcp_f32 v196, v196
v_mfma_f32_16x16x32_bf16 v[104:107], a[68:71], a[236:239], v[104:107]
s_waitcnt lgkmcnt(0)
v_mfma_f32_16x16x32_bf16 v[36:39], a[0:3], a[240:243], v[36:39]
ds_read_b128 a[36:39], v201 offset:9216
buffer_load_dwordx4 v1, s[8:11], s60 offen offset:2048 sc1 lds
v_mfma_f32_16x16x32_bf16 v[40:43], a[0:3], a[244:247], v[40:43]
ds_read_b128 a[40:43], v201 offset:10240
v_mfma_f32_16x16x32_bf16 v[44:47], a[4:7], a[240:243], v[44:47]
ds_read_b128 a[44:47], v201 offset:11264
buffer_load_dwordx4 v1, s[8:11], s60 offen offset:3072 sc1 lds
v_mfma_f32_16x16x32_bf16 v[48:51], a[4:7], a[244:247], v[48:51]
ds_read_b128 a[48:51], v201 offset:12288
v_mfma_f32_16x16x32_bf16 v[52:55], a[8:11], a[240:243], v[52:55]
ds_read_b128 a[52:55], v201 offset:13312
s_add_u32 m0, s63, 69632
v_mfma_f32_16x16x32_bf16 v[56:59], a[8:11], a[244:247], v[56:59]
ds_read_b128 a[56:59], v201 offset:14336
v_mfma_f32_16x16x32_bf16 v[60:63], a[12:15], a[240:243], v[60:63]
ds_read_b128 a[60:63], v201 offset:15360
s_add_u32 s61, s61, 36864
v_mfma_f32_16x16x32_bf16 v[64:67], a[12:15], a[244:247], v[64:67]
ds_read_b128 a[64:67], v201 offset:16384
v_mfma_f32_16x16x32_bf16 v[68:71], a[16:19], a[240:243], v[68:71]
ds_read_b128 a[68:71], v201 offset:17408
buffer_load_dwordx4 v1, s[8:11], s61 offen offset:0 sc1 lds
v_mfma_f32_16x16x32_bf16 v[72:75], a[16:19], a[244:247], v[72:75]
s_add_u32 m0, s62, 73728
v_rcp_f32 v197, v197
v_mfma_f32_16x16x32_bf16 v[76:79], a[20:23], a[240:243], v[76:79]
s_add_u32 s60, s60, 20480
v_rcp_f32 v198, v198
v_mfma_f32_16x16x32_bf16 v[80:83], a[20:23], a[244:247], v[80:83]
v_rcp_f32 v199, v199
v_mfma_f32_16x16x32_bf16 v[84:87], a[24:27], a[240:243], v[84:87]
v_mfma_f32_16x16x32_bf16 v[88:91], a[24:27], a[244:247], v[88:91]
v_mfma_f32_16x16x32_bf16 v[92:95], a[28:31], a[240:243], v[92:95]
buffer_load_dwordx4 v1, s[8:11], s60 offen offset:0 sc1 lds
v_mfma_f32_16x16x32_bf16 v[96:99], a[28:31], a[244:247], v[96:99]
v_mfma_f32_16x16x32_bf16 v[100:103], a[32:35], a[240:243], v[100:103]
v_mul_f32 v136, v136, v196
v_mfma_f32_16x16x32_bf16 v[104:107], a[32:35], a[244:247], v[104:107]
s_waitcnt vmcnt(23) lgkmcnt(0)
s_barrier
v_mfma_f32_16x16x32_bf16 v[36:39], a[36:39], a[248:251], v[36:39]
ds_read_b128 a[0:3], v201 offset:18432
buffer_load_dwordx4 v1, s[8:11], s60 offen offset:1024 sc1 lds
v_mfma_f32_16x16x32_bf16 v[40:43], a[36:39], a[252:255], v[40:43]
ds_read_b128 a[4:7], v201 offset:19456
v_mul_f32 v137, v137, v197
v_mfma_f32_16x16x32_bf16 v[44:47], a[40:43], a[248:251], v[44:47]
ds_read_b128 a[8:11], v201 offset:20480
v_mul_f32 v138, v138, v198
v_mfma_f32_16x16x32_bf16 v[48:51], a[40:43], a[252:255], v[48:51]
ds_read_b128 a[12:15], v201 offset:21504
v_mfma_f32_16x16x32_bf16 v[52:55], a[44:47], a[248:251], v[52:55]
ds_read_b128 a[16:19], v201 offset:22528
buffer_load_dwordx4 v1, s[8:11], s60 offen offset:2048 sc1 lds
v_mfma_f32_16x16x32_bf16 v[56:59], a[44:47], a[252:255], v[56:59]
ds_read_b128 a[20:23], v201 offset:23552
v_mul_f32 v139, v139, v199
v_mfma_f32_16x16x32_bf16 v[60:63], a[48:51], a[248:251], v[60:63]
ds_read_b128 a[24:27], v201 offset:24576
v_mfma_f32_16x16x32_bf16 v[64:67], a[48:51], a[252:255], v[64:67]
ds_read_b128 a[28:31], v201 offset:25600
v_mul_f32 v192, v140, v140
v_mfma_f32_16x16x32_bf16 v[68:71], a[52:55], a[248:251], v[68:71]
ds_read_b128 a[32:35], v201 offset:26624
buffer_load_dwordx4 v1, s[8:11], s60 offen offset:3072 sc1 lds
v_mfma_f32_16x16x32_bf16 v[72:75], a[52:55], a[252:255], v[72:75]
v_mfma_f32_16x16x32_bf16 v[76:79], a[56:59], a[248:251], v[76:79]
v_mul_f32 v193, v141, v141
v_mfma_f32_16x16x32_bf16 v[80:83], a[56:59], a[252:255], v[80:83]
v_mfma_f32_16x16x32_bf16 v[84:87], a[60:63], a[248:251], v[84:87]
buffer_load_dwordx4 a[176:179], v1, s[4:7], s52 offen offset:2048 sc1
v_mul_f32 v194, v142, v142
v_mfma_f32_16x16x32_bf16 v[88:91], a[60:63], a[252:255], v[88:91]
v_mfma_f32_16x16x32_bf16 v[92:95], a[64:67], a[248:251], v[92:95]
v_mul_f32 v195, v143, v143
v_mfma_f32_16x16x32_bf16 v[96:99], a[64:67], a[252:255], v[96:99]
v_mfma_f32_16x16x32_bf16 v[100:103], a[68:71], a[248:251], v[100:103]
v_mfma_f32_16x16x32_bf16 v[104:107], a[68:71], a[252:255], v[104:107]
v_fma_f32 v192, v192, v252, v250
s_waitcnt lgkmcnt(0)
v_mfma_f32_16x16x32_bf16 v[36:39], a[0:3], a[80:83], v[36:39]
ds_read_b128 a[36:39], v201 offset:27648
buffer_load_dwordx4 a[180:183], v9, s[4:7], s52 offen offset:2048 sc1
v_mfma_f32_16x16x32_bf16 v[40:43], a[0:3], a[84:87], v[40:43]
ds_read_b128 a[40:43], v201 offset:28672
v_fma_f32 v193, v193, v252, v250
v_mfma_f32_16x16x32_bf16 v[44:47], a[4:7], a[80:83], v[44:47]
ds_read_b128 a[44:47], v201 offset:29696
buffer_load_dwordx4 a[184:187], v1, s[4:7], s52 offen offset:3072 sc1
v_mfma_f32_16x16x32_bf16 v[48:51], a[4:7], a[84:87], v[48:51]
ds_read_b128 a[48:51], v201 offset:30720
v_fma_f32 v194, v194, v252, v250
v_mfma_f32_16x16x32_bf16 v[52:55], a[8:11], a[80:83], v[52:55]
ds_read_b128 a[52:55], v201 offset:31744
buffer_load_dwordx4 a[188:191], v9, s[4:7], s52 offen offset:3072 sc1
v_mfma_f32_16x16x32_bf16 v[56:59], a[8:11], a[84:87], v[56:59]
ds_read_b128 a[56:59], v201 offset:32768
v_mfma_f32_16x16x32_bf16 v[60:63], a[12:15], a[80:83], v[60:63]
ds_read_b128 a[60:63], v201 offset:33792
v_fma_f32 v195, v195, v252, v250
v_mfma_f32_16x16x32_bf16 v[64:67], a[12:15], a[84:87], v[64:67]
ds_read_b128 a[64:67], v201 offset:34816
v_mfma_f32_16x16x32_bf16 v[68:71], a[16:19], a[80:83], v[68:71]
ds_read_b128 a[68:71], v201 offset:35840
v_mul_f32 v192, v192, v140
v_mfma_f32_16x16x32_bf16 v[72:75], a[16:19], a[84:87], v[72:75]
s_cmp_eq_u32 s25, 5
s_cselect_b32 s98, 4096, 0
v_mfma_f32_16x16x32_bf16 v[76:79], a[20:23], a[80:83], v[76:79]
s_add_u32 s52, s52, s98
v_mul_f32 v193, v193, v141
v_mfma_f32_16x16x32_bf16 v[80:83], a[20:23], a[84:87], v[80:83]
s_add_u32 s52, s52, 4096
v_mfma_f32_16x16x32_bf16 v[84:87], a[24:27], a[80:83], v[84:87]
v_mfma_f32_16x16x32_bf16 v[88:91], a[24:27], a[84:87], v[88:91]
v_mul_f32 v194, v194, v142
v_mfma_f32_16x16x32_bf16 v[92:95], a[28:31], a[80:83], v[92:95]
buffer_load_dwordx4 a[192:195], v1, s[4:7], s52 offen offset:0 sc1
v_mfma_f32_16x16x32_bf16 v[96:99], a[28:31], a[84:87], v[96:99]
v_mul_f32 v195, v195, v143
v_mfma_f32_16x16x32_bf16 v[100:103], a[32:35], a[80:83], v[100:103]
v_mfma_f32_16x16x32_bf16 v[104:107], a[32:35], a[84:87], v[104:107]
s_waitcnt vmcnt(22) lgkmcnt(0)
s_barrier
v_mfma_f32_16x16x32_bf16 v[36:39], a[36:39], a[88:91], v[36:39]
ds_read_b128 a[0:3], v202 offset:0
buffer_load_dwordx4 a[196:199], v9, s[4:7], s52 offen offset:0 sc1
v_mfma_f32_16x16x32_bf16 v[40:43], a[36:39], a[92:95], v[40:43]
ds_read_b128 a[4:7], v202 offset:1024
buffer_load_dwordx4 a[200:203], v1, s[4:7], s52 offen offset:1024 sc1
v_mfma_f32_16x16x32_bf16 v[44:47], a[40:43], a[88:91], v[44:47]
ds_read_b128 a[8:11], v202 offset:2048
v_mfma_f32_16x16x32_bf16 v[48:51], a[40:43], a[92:95], v[48:51]
ds_read_b128 a[12:15], v202 offset:3072
buffer_load_dwordx4 a[204:207], v9, s[4:7], s52 offen offset:1024 sc1
v_mfma_f32_16x16x32_bf16 v[52:55], a[44:47], a[88:91], v[52:55]
ds_read_b128 a[16:19], v202 offset:4096
v_mfma_f32_16x16x32_bf16 v[56:59], a[44:47], a[92:95], v[56:59]
ds_read_b128 a[20:23], v202 offset:5120
v_mfma_f32_16x16x32_bf16 v[60:63], a[48:51], a[88:91], v[60:63]
ds_read_b128 a[24:27], v202 offset:6144
v_mfma_f32_16x16x32_bf16 v[64:67], a[48:51], a[92:95], v[64:67]
ds_read_b128 a[28:31], v202 offset:7168
v_mfma_f32_16x16x32_bf16 v[68:71], a[52:55], a[88:91], v[68:71]
ds_read_b128 a[32:35], v202 offset:8192
v_mfma_f32_16x16x32_bf16 v[72:75], a[52:55], a[92:95], v[72:75]
s_cmp_eq_u32 s25, 4
s_cselect_b32 s99, 36864, 0
s_add_u32 s60, s60, s99
v_mfma_f32_16x16x32_bf16 v[76:79], a[56:59], a[88:91], v[76:79]
s_add_u32 s61, s61, s99
v_exp_f32 v192, v192
v_mfma_f32_16x16x32_bf16 v[80:83], a[56:59], a[92:95], v[80:83]
s_add_u32 m0, s62, 90112
v_exp_f32 v193, v193
v_mfma_f32_16x16x32_bf16 v[84:87], a[60:63], a[88:91], v[84:87]
s_add_u32 s60, s60, 16384
v_exp_f32 v194, v194
v_mfma_f32_16x16x32_bf16 v[88:91], a[60:63], a[92:95], v[88:91]
v_mfma_f32_16x16x32_bf16 v[92:95], a[64:67], a[88:91], v[92:95]
v_exp_f32 v195, v195
v_mfma_f32_16x16x32_bf16 v[96:99], a[64:67], a[92:95], v[96:99]
buffer_load_dwordx4 v1, s[8:11], s60 offen offset:0 sc1 lds
v_mfma_f32_16x16x32_bf16 v[100:103], a[68:71], a[88:91], v[100:103]
v_mfma_f32_16x16x32_bf16 v[104:107], a[68:71], a[92:95], v[104:107]
s_waitcnt lgkmcnt(0)
v_mfma_f32_16x16x32_bf16 v[36:39], a[0:3], a[96:99], v[36:39]
ds_read_b128 a[36:39], v202 offset:9216
buffer_load_dwordx4 v1, s[8:11], s60 offen offset:1024 sc1 lds
v_mfma_f32_16x16x32_bf16 v[40:43], a[0:3], a[100:103], v[40:43]
ds_read_b128 a[40:43], v202 offset:10240
v_fma_f32 v192, v192, v254, v254
v_mfma_f32_16x16x32_bf16 v[44:47], a[4:7], a[96:99], v[44:47]
ds_read_b128 a[44:47], v202 offset:11264
buffer_load_dwordx4 v1, s[8:11], s60 offen offset:2048 sc1 lds
v_mfma_f32_16x16x32_bf16 v[48:51], a[4:7], a[100:103], v[48:51]
ds_read_b128 a[48:51], v202 offset:12288
v_fma_f32 v193, v193, v254, v254
v_mfma_f32_16x16x32_bf16 v[52:55], a[8:11], a[96:99], v[52:55]
ds_read_b128 a[52:55], v202 offset:13312
v_mfma_f32_16x16x32_bf16 v[56:59], a[8:11], a[100:103], v[56:59]
ds_read_b128 a[56:59], v202 offset:14336
buffer_load_dwordx4 v1, s[8:11], s60 offen offset:3072 sc1 lds
v_mfma_f32_16x16x32_bf16 v[60:63], a[12:15], a[96:99], v[60:63]
ds_read_b128 a[60:63], v202 offset:15360
v_fma_f32 v194, v194, v254, v254
v_mfma_f32_16x16x32_bf16 v[64:67], a[12:15], a[100:103], v[64:67]
ds_read_b128 a[64:67], v202 offset:16384
v_fma_f32 v195, v195, v254, v254
v_mfma_f32_16x16x32_bf16 v[68:71], a[16:19], a[96:99], v[68:71]
ds_read_b128 a[68:71], v202 offset:17408
s_add_u32 m0, s63, 106496
v_mfma_f32_16x16x32_bf16 v[72:75], a[16:19], a[100:103], v[72:75]
s_add_u32 s61, s61, 36864
v_mfma_f32_16x16x32_bf16 v[76:79], a[20:23], a[96:99], v[76:79]
v_rcp_f32 v192, v192
v_mfma_f32_16x16x32_bf16 v[80:83], a[20:23], a[100:103], v[80:83]
v_mfma_f32_16x16x32_bf16 v[84:87], a[24:27], a[96:99], v[84:87]
v_mfma_f32_16x16x32_bf16 v[88:91], a[24:27], a[100:103], v[88:91]
v_mfma_f32_16x16x32_bf16 v[92:95], a[28:31], a[96:99], v[92:95]
buffer_load_dwordx4 v1, s[8:11], s61 offen offset:0 sc1 lds
v_mfma_f32_16x16x32_bf16 v[96:99], a[28:31], a[100:103], v[96:99]
v_rcp_f32 v193, v193
v_mfma_f32_16x16x32_bf16 v[100:103], a[32:35], a[96:99], v[100:103]
v_mfma_f32_16x16x32_bf16 v[104:107], a[32:35], a[100:103], v[104:107]
s_waitcnt lgkmcnt(0)
v_mfma_f32_16x16x32_bf16 v[36:39], a[36:39], a[104:107], v[36:39]
ds_read_b128 a[0:3], v202 offset:18432
s_add_u32 m0, s62, 110592
v_mfma_f32_16x16x32_bf16 v[40:43], a[36:39], a[108:111], v[40:43]
ds_read_b128 a[4:7], v202 offset:19456
v_mfma_f32_16x16x32_bf16 v[44:47], a[40:43], a[104:107], v[44:47]
ds_read_b128 a[8:11], v202 offset:20480
s_add_u32 s60, s60, 20480
v_mfma_f32_16x16x32_bf16 v[48:51], a[40:43], a[108:111], v[48:51]
ds_read_b128 a[12:15], v202 offset:21504
v_mfma_f32_16x16x32_bf16 v[52:55], a[44:47], a[104:107], v[52:55]
ds_read_b128 a[16:19], v202 offset:22528
v_mfma_f32_16x16x32_bf16 v[56:59], a[44:47], a[108:111], v[56:59]
ds_read_b128 a[20:23], v202 offset:23552
buffer_load_dwordx4 v1, s[8:11], s60 offen offset:0 sc1 lds
v_mfma_f32_16x16x32_bf16 v[60:63], a[48:51], a[104:107], v[60:63]
ds_read_b128 a[24:27], v202 offset:24576
v_mfma_f32_16x16x32_bf16 v[64:67], a[48:51], a[108:111], v[64:67]
ds_read_b128 a[28:31], v202 offset:25600
v_mfma_f32_16x16x32_bf16 v[68:71], a[52:55], a[104:107], v[68:71]
ds_read_b128 a[32:35], v202 offset:26624
buffer_load_dwordx4 v1, s[8:11], s60 offen offset:1024 sc1 lds
v_mfma_f32_16x16x32_bf16 v[72:75], a[52:55], a[108:111], v[72:75]
v_rcp_f32 v194, v194
v_mfma_f32_16x16x32_bf16 v[76:79], a[56:59], a[104:107], v[76:79]
v_rcp_f32 v195, v195
v_mfma_f32_16x16x32_bf16 v[80:83], a[56:59], a[108:111], v[80:83]
buffer_load_dwordx4 v1, s[8:11], s60 offen offset:2048 sc1 lds
v_mul_f32 v140, v140, v192
v_mfma_f32_16x16x32_bf16 v[84:87], a[60:63], a[104:107], v[84:87]
v_mfma_f32_16x16x32_bf16 v[88:91], a[60:63], a[108:111], v[88:91]
v_mul_f32 v141, v141, v193
v_mfma_f32_16x16x32_bf16 v[92:95], a[64:67], a[104:107], v[92:95]
buffer_load_dwordx4 v1, s[8:11], s60 offen offset:3072 sc1 lds
v_mfma_f32_16x16x32_bf16 v[96:99], a[64:67], a[108:111], v[96:99]
v_mul_f32 v142, v142, v194
v_mfma_f32_16x16x32_bf16 v[100:103], a[68:71], a[104:107], v[100:103]
v_mfma_f32_16x16x32_bf16 v[104:107], a[68:71], a[108:111], v[104:107]
s_waitcnt lgkmcnt(0)
v_mfma_f32_16x16x32_bf16 v[36:39], a[0:3], a[112:115], v[36:39]
ds_read_b128 a[36:39], v202 offset:27648
buffer_load_dwordx4 a[208:211], v1, s[4:7], s52 offen offset:2048 sc1
v_mfma_f32_16x16x32_bf16 v[40:43], a[0:3], a[116:119], v[40:43]
ds_read_b128 a[40:43], v202 offset:28672
s_mov_b32 s37, L_c4+8192-L_pc
v_mfma_f32_16x16x32_bf16 v[44:47], a[4:7], a[112:115], v[44:47]
ds_read_b128 a[44:47], v202 offset:29696
v_mul_f32 v143, v143, v195
v_mfma_f32_16x16x32_bf16 v[48:51], a[4:7], a[116:119], v[48:51]
ds_read_b128 a[48:51], v202 offset:30720
v_mul_f32 v196, v144, v144
v_mfma_f32_16x16x32_bf16 v[52:55], a[8:11], a[112:115], v[52:55]
ds_read_b128 a[52:55], v202 offset:31744
buffer_load_dwordx4 a[212:215], v9, s[4:7], s52 offen offset:2048 sc1
v_mfma_f32_16x16x32_bf16 v[56:59], a[8:11], a[116:119], v[56:59]
ds_read_b128 a[56:59], v202 offset:32768
buffer_load_dword v15, v14, s[88:91], s37 offen
v_mfma_f32_16x16x32_bf16 v[60:63], a[12:15], a[112:115], v[60:63]
ds_read_b128 a[60:63], v202 offset:33792
v_mul_f32 v197, v145, v145
v_mfma_f32_16x16x32_bf16 v[64:67], a[12:15], a[116:119], v[64:67]
ds_read_b128 a[64:67], v202 offset:34816
v_mul_f32 v198, v146, v146
v_mfma_f32_16x16x32_bf16 v[68:71], a[16:19], a[112:115], v[68:71]
ds_read_b128 a[68:71], v202 offset:35840
buffer_load_dwordx4 a[216:219], v1, s[4:7], s52 offen offset:3072 sc1
v_mfma_f32_16x16x32_bf16 v[72:75], a[16:19], a[116:119], v[72:75]
v_mul_f32 v199, v147, v147
v_mfma_f32_16x16x32_bf16 v[76:79], a[20:23], a[112:115], v[76:79]
v_mfma_f32_16x16x32_bf16 v[80:83], a[20:23], a[116:119], v[80:83]
v_fma_f32 v196, v196, v253, v251
v_mfma_f32_16x16x32_bf16 v[84:87], a[24:27], a[112:115], v[84:87]
buffer_load_dwordx4 a[220:223], v9, s[4:7], s52 offen offset:3072 sc1
v_mfma_f32_16x16x32_bf16 v[88:91], a[24:27], a[116:119], v[88:91]
v_mfma_f32_16x16x32_bf16 v[92:95], a[28:31], a[112:115], v[92:95]
v_fma_f32 v197, v197, v253, v251
v_mfma_f32_16x16x32_bf16 v[96:99], a[28:31], a[116:119], v[96:99]
v_mfma_f32_16x16x32_bf16 v[100:103], a[32:35], a[112:115], v[100:103]
v_fma_f32 v198, v198, v253, v251
v_mfma_f32_16x16x32_bf16 v[104:107], a[32:35], a[116:119], v[104:107]
s_waitcnt vmcnt(22) lgkmcnt(0)
s_barrier
v_mfma_f32_16x16x32_bf16 v[36:39], a[36:39], a[120:123], v[36:39]
ds_read_b128 a[0:3], v200 offset:0
v_mfma_f32_16x16x32_bf16 v[40:43], a[36:39], a[124:127], v[40:43]
ds_read_b128 a[4:7], v200 offset:1024
v_fma_f32 v199, v199, v253, v251
v_mfma_f32_16x16x32_bf16 v[44:47], a[40:43], a[120:123], v[44:47]
ds_read_b128 a[8:11], v200 offset:2048
v_mfma_f32_16x16x32_bf16 v[48:51], a[40:43], a[124:127], v[48:51]
ds_read_b128 a[12:15], v200 offset:3072
v_mul_f32 v196, v196, v144
v_mfma_f32_16x16x32_bf16 v[52:55], a[44:47], a[120:123], v[52:55]
ds_read_b128 a[16:19], v200 offset:4096
v_mfma_f32_16x16x32_bf16 v[56:59], a[44:47], a[124:127], v[56:59]
ds_read_b128 a[20:23], v200 offset:5120
v_mul_f32 v197, v197, v145
v_mfma_f32_16x16x32_bf16 v[60:63], a[48:51], a[120:123], v[60:63]
ds_read_b128 a[24:27], v200 offset:6144
v_mfma_f32_16x16x32_bf16 v[64:67], a[48:51], a[124:127], v[64:67]
ds_read_b128 a[28:31], v200 offset:7168
v_mfma_f32_16x16x32_bf16 v[68:71], a[52:55], a[120:123], v[68:71]
ds_read_b128 a[32:35], v200 offset:8192
v_mul_f32 v198, v198, v146
v_mfma_f32_16x16x32_bf16 v[72:75], a[52:55], a[124:127], v[72:75]
s_cmp_eq_u32 s25, 5
s_cselect_b32 s99, 36864, 0
s_add_u32 s60, s60, s99
v_mfma_f32_16x16x32_bf16 v[76:79], a[56:59], a[120:123], v[76:79]
s_add_u32 s61, s61, s99
s_add_u32 m0, s62, 126976
s_add_u32 s60, s60, 16384
v_mfma_f32_16x16x32_bf16 v[80:83], a[56:59], a[124:127], v[80:83]
buffer_load_dwordx4 v1, s[8:11], s60 offen offset:0 sc1 lds
v_mul_f32 v199, v199, v147
v_mfma_f32_16x16x32_bf16 v[84:87], a[60:63], a[120:123], v[84:87]
buffer_load_dwordx4 v1, s[8:11], s60 offen offset:1024 sc1 lds
v_mfma_f32_16x16x32_bf16 v[88:91], a[60:63], a[124:127], v[88:91]
buffer_load_dwordx4 v1, s[8:11], s60 offen offset:2048 sc1 lds
v_mfma_f32_16x16x32_bf16 v[92:95], a[64:67], a[120:123], v[92:95]
v_exp_f32 v196, v196
v_mfma_f32_16x16x32_bf16 v[96:99], a[64:67], a[124:127], v[96:99]
buffer_load_dwordx4 v1, s[8:11], s60 offen offset:3072 sc1 lds
v_mfma_f32_16x16x32_bf16 v[100:103], a[68:71], a[120:123], v[100:103]
v_mfma_f32_16x16x32_bf16 v[104:107], a[68:71], a[124:127], v[104:107]
s_waitcnt lgkmcnt(0)
v_mfma_f32_16x16x32_bf16 v[36:39], a[0:3], a[128:131], v[36:39]
ds_read_b128 a[36:39], v200 offset:9216
s_add_u32 m0, s63, 143360
v_mfma_f32_16x16x32_bf16 v[40:43], a[0:3], a[132:135], v[40:43]
ds_read_b128 a[40:43], v200 offset:10240
v_mfma_f32_16x16x32_bf16 v[44:47], a[4:7], a[128:131], v[44:47]
ds_read_b128 a[44:47], v200 offset:11264
s_add_u32 s61, s61, 36864
v_mfma_f32_16x16x32_bf16 v[48:51], a[4:7], a[132:135], v[48:51]
ds_read_b128 a[48:51], v200 offset:12288
v_mfma_f32_16x16x32_bf16 v[52:55], a[8:11], a[128:131], v[52:55]
ds_read_b128 a[52:55], v200 offset:13312
buffer_load_dwordx4 v1, s[8:11], s61 offen offset:0 sc1 lds
v_mfma_f32_16x16x32_bf16 v[56:59], a[8:11], a[132:135], v[56:59]
ds_read_b128 a[56:59], v200 offset:14336
v_mfma_f32_16x16x32_bf16 v[60:63], a[12:15], a[128:131], v[60:63]
ds_read_b128 a[60:63], v200 offset:15360
s_add_u32 m0, s62, 147456
v_mfma_f32_16x16x32_bf16 v[64:67], a[12:15], a[132:135], v[64:67]
ds_read_b128 a[64:67], v200 offset:16384
v_mfma_f32_16x16x32_bf16 v[68:71], a[16:19], a[128:131], v[68:71]
ds_read_b128 a[68:71], v200 offset:17408
s_add_u32 s60, s60, 20480
v_mfma_f32_16x16x32_bf16 v[72:75], a[16:19], a[132:135], v[72:75]
v_exp_f32 v197, v197
v_mfma_f32_16x16x32_bf16 v[76:79], a[20:23], a[128:131], v[76:79]
buffer_load_dwordx4 v1, s[8:11], s60 offen offset:0 sc1 lds
v_mfma_f32_16x16x32_bf16 v[80:83], a[20:23], a[132:135], v[80:83]
v_exp_f32 v198, v198
v_mfma_f32_16x16x32_bf16 v[84:87], a[24:27], a[128:131], v[84:87]
buffer_load_dwordx4 v1, s[8:11], s60 offen offset:1024 sc1 lds
v_mfma_f32_16x16x32_bf16 v[88:91], a[24:27], a[132:135], v[88:91]
v_exp_f32 v199, v199
v_mfma_f32_16x16x32_bf16 v[92:95], a[28:31], a[128:131], v[92:95]
buffer_load_dwordx4 v1, s[8:11], s60 offen offset:2048 sc1 lds
v_fma_f32 v196, v196, v255, v255
v_mfma_f32_16x16x32_bf16 v[96:99], a[28:31], a[132:135], v[96:99]
v_mfma_f32_16x16x32_bf16 v[100:103], a[32:35], a[128:131], v[100:103]
v_fma_f32 v197, v197, v255, v255
v_mfma_f32_16x16x32_bf16 v[104:107], a[32:35], a[132:135], v[104:107]
s_waitcnt lgkmcnt(0)
v_mfma_f32_16x16x32_bf16 v[36:39], a[36:39], a[136:139], v[36:39]
ds_read_b128 a[0:3], v200 offset:18432
buffer_load_dwordx4 v1, s[8:11], s60 offen offset:3072 sc1 lds
v_mfma_f32_16x16x32_bf16 v[40:43], a[36:39], a[140:143], v[40:43]
ds_read_b128 a[4:7], v200 offset:19456
v_fma_f32 v198, v198, v255, v255
v_mfma_f32_16x16x32_bf16 v[44:47], a[40:43], a[136:139], v[44:47]
ds_read_b128 a[8:11], v200 offset:20480
v_fma_f32 v199, v199, v255, v255
v_mfma_f32_16x16x32_bf16 v[48:51], a[40:43], a[140:143], v[48:51]
ds_read_b128 a[12:15], v200 offset:21504
v_mfma_f32_16x16x32_bf16 v[52:55], a[44:47], a[136:139], v[52:55]
ds_read_b128 a[16:19], v200 offset:22528
v_mfma_f32_16x16x32_bf16 v[56:59], a[44:47], a[140:143], v[56:59]
ds_read_b128 a[20:23], v200 offset:23552
v_mfma_f32_16x16x32_bf16 v[60:63], a[48:51], a[136:139], v[60:63]
ds_read_b128 a[24:27], v200 offset:24576
v_mfma_f32_16x16x32_bf16 v[64:67], a[48:51], a[140:143], v[64:67]
ds_read_b128 a[28:31], v200 offset:25600
v_mfma_f32_16x16x32_bf16 v[68:71], a[52:55], a[136:139], v[68:71]
ds_read_b128 a[32:35], v200 offset:26624
v_mfma_f32_16x16x32_bf16 v[72:75], a[52:55], a[140:143], v[72:75]
s_cmp_eq_u32 s25, 6
s_cselect_b32 s98, 4096, 0
s_add_u32 s52, s52, s98
v_mfma_f32_16x16x32_bf16 v[76:79], a[56:59], a[136:139], v[76:79]
s_add_u32 s52, s52, 4096
v_rcp_f32 v196, v196
v_mfma_f32_16x16x32_bf16 v[80:83], a[56:59], a[140:143], v[80:83]
buffer_load_dwordx4 a[224:227], v1, s[4:7], s52 offen offset:0 sc1
v_mfma_f32_16x16x32_bf16 v[84:87], a[60:63], a[136:139], v[84:87]
buffer_load_dwordx4 a[228:231], v9, s[4:7], s52 offen offset:0 sc1
v_mfma_f32_16x16x32_bf16 v[88:91], a[60:63], a[140:143], v[88:91]
v_rcp_f32 v197, v197
v_mfma_f32_16x16x32_bf16 v[92:95], a[64:67], a[136:139], v[92:95]
buffer_load_dwordx4 a[232:235], v1, s[4:7], s52 offen offset:1024 sc1
v_mfma_f32_16x16x32_bf16 v[96:99], a[64:67], a[140:143], v[96:99]
v_rcp_f32 v198, v198
v_mfma_f32_16x16x32_bf16 v[100:103], a[68:71], a[136:139], v[100:103]
v_mfma_f32_16x16x32_bf16 v[104:107], a[68:71], a[140:143], v[104:107]
s_waitcnt lgkmcnt(0)
v_mfma_f32_16x16x32_bf16 v[36:39], a[0:3], a[144:147], v[36:39]
ds_read_b128 a[36:39], v200 offset:27648
buffer_load_dwordx4 a[236:239], v9, s[4:7], s52 offen offset:1024 sc1
v_mfma_f32_16x16x32_bf16 v[40:43], a[0:3], a[148:151], v[40:43]
ds_read_b128 a[40:43], v200 offset:28672
v_mfma_f32_16x16x32_bf16 v[44:47], a[4:7], a[144:147], v[44:47]
ds_read_b128 a[44:47], v200 offset:29696
v_mfma_f32_16x16x32_bf16 v[48:51], a[4:7], a[148:151], v[48:51]
ds_read_b128 a[48:51], v200 offset:30720
v_mfma_f32_16x16x32_bf16 v[52:55], a[8:11], a[144:147], v[52:55]
ds_read_b128 a[52:55], v200 offset:31744
buffer_load_dwordx4 a[240:243], v1, s[4:7], s52 offen offset:2048 sc1
v_mfma_f32_16x16x32_bf16 v[56:59], a[8:11], a[148:151], v[56:59]
ds_read_b128 a[56:59], v200 offset:32768
v_mfma_f32_16x16x32_bf16 v[60:63], a[12:15], a[144:147], v[60:63]
ds_read_b128 a[60:63], v200 offset:33792
v_mfma_f32_16x16x32_bf16 v[64:67], a[12:15], a[148:151], v[64:67]
ds_read_b128 a[64:67], v200 offset:34816
v_mfma_f32_16x16x32_bf16 v[68:71], a[16:19], a[144:147], v[68:71]
ds_read_b128 a[68:71], v200 offset:35840
buffer_load_dwordx4 a[244:247], v9, s[4:7], s52 offen offset:2048 sc1
v_mfma_f32_16x16x32_bf16 v[72:75], a[16:19], a[148:151], v[72:75]
v_rcp_f32 v199, v199
v_mfma_f32_16x16x32_bf16 v[76:79], a[20:23], a[144:147], v[76:79]
v_mul_f32 v144, v144, v196
v_mul_f32 v145, v145, v197
v_mfma_f32_16x16x32_bf16 v[80:83], a[20:23], a[148:151], v[80:83]
v_mul_f32 v146, v146, v198
v_mfma_f32_16x16x32_bf16 v[84:87], a[24:27], a[144:147], v[84:87]
buffer_load_dwordx4 a[248:251], v1, s[4:7], s52 offen offset:3072 sc1
v_mfma_f32_16x16x32_bf16 v[88:91], a[24:27], a[148:151], v[88:91]
v_mul_f32 v147, v147, v199
v_mfma_f32_16x16x32_bf16 v[92:95], a[28:31], a[144:147], v[92:95]
v_mfma_f32_16x16x32_bf16 v[96:99], a[28:31], a[148:151], v[96:99]
v_mul_f32 v192, v148, v148
v_mfma_f32_16x16x32_bf16 v[100:103], a[32:35], a[144:147], v[100:103]
v_mfma_f32_16x16x32_bf16 v[104:107], a[32:35], a[148:151], v[104:107]
s_waitcnt vmcnt(21) lgkmcnt(0)
s_barrier
v_mfma_f32_16x16x32_bf16 v[36:39], a[36:39], a[152:155], v[36:39]
ds_read_b128 a[0:3], v201 offset:0
buffer_load_dwordx4 a[252:255], v9, s[4:7], s52 offen offset:3072 sc1
v_mfma_f32_16x16x32_bf16 v[40:43], a[36:39], a[156:159], v[40:43]
ds_read_b128 a[4:7], v201 offset:1024
v_mul_f32 v193, v149, v149
v_mfma_f32_16x16x32_bf16 v[44:47], a[40:43], a[152:155], v[44:47]
ds_read_b128 a[8:11], v201 offset:2048
v_mul_f32 v194, v150, v150
v_mfma_f32_16x16x32_bf16 v[48:51], a[40:43], a[156:159], v[48:51]
ds_read_b128 a[12:15], v201 offset:3072
v_mfma_f32_16x16x32_bf16 v[52:55], a[44:47], a[152:155], v[52:55]
ds_read_b128 a[16:19], v201 offset:4096
v_mul_f32 v195, v151, v151
v_mfma_f32_16x16x32_bf16 v[56:59], a[44:47], a[156:159], v[56:59]
ds_read_b128 a[20:23], v201 offset:5120
v_mfma_f32_16x16x32_bf16 v[60:63], a[48:51], a[152:155], v[60:63]
ds_read_b128 a[24:27], v201 offset:6144
v_fma_f32 v192, v192, v252, v250
v_mfma_f32_16x16x32_bf16 v[64:67], a[48:51], a[156:159], v[64:67]
ds_read_b128 a[28:31], v201 offset:7168
v_mfma_f32_16x16x32_bf16 v[68:71], a[52:55], a[152:155], v[68:71]
ds_read_b128 a[32:35], v201 offset:8192
v_mfma_f32_16x16x32_bf16 v[72:75], a[52:55], a[156:159], v[72:75]
s_cmp_eq_u32 s25, 6
s_cselect_b32 s99, 36864, 0
s_add_u32 s60, s60, s99
v_mfma_f32_16x16x32_bf16 v[76:79], a[56:59], a[152:155], v[76:79]
s_add_u32 s61, s61, s99
s_add_u32 m0, s62, 53248
s_add_u32 s60, s60, 16384
v_mfma_f32_16x16x32_bf16 v[80:83], a[56:59], a[156:159], v[80:83]
buffer_load_dwordx4 v1, s[8:11], s60 offen offset:0 sc1 lds
v_fma_f32 v193, v193, v252, v250
v_mfma_f32_16x16x32_bf16 v[84:87], a[60:63], a[152:155], v[84:87]
v_fma_f32 v194, v194, v252, v250
v_mfma_f32_16x16x32_bf16 v[88:91], a[60:63], a[156:159], v[88:91]
buffer_load_dwordx4 v1, s[8:11], s60 offen offset:1024 sc1 lds
v_fma_f32 v195, v195, v252, v250
v_mfma_f32_16x16x32_bf16 v[92:95], a[64:67], a[152:155], v[92:95]
v_mfma_f32_16x16x32_bf16 v[96:99], a[64:67], a[156:159], v[96:99]
buffer_load_dwordx4 v1, s[8:11], s60 offen offset:2048 sc1 lds
v_mfma_f32_16x16x32_bf16 v[100:103], a[68:71], a[152:155], v[100:103]
v_mul_f32 v192, v192, v148
v_mfma_f32_16x16x32_bf16 v[104:107], a[68:71], a[156:159], v[104:107]
s_waitcnt lgkmcnt(0)
v_mfma_f32_16x16x32_bf16 v[36:39], a[0:3], a[160:163], v[36:39]
ds_read_b128 a[36:39], v201 offset:9216
buffer_load_dwordx4 v1, s[8:11], s60 offen offset:3072 sc1 lds
v_mfma_f32_16x16x32_bf16 v[40:43], a[0:3], a[164:167], v[40:43]
ds_read_b128 a[40:43], v201 offset:10240
v_mul_f32 v193, v193, v149
v_mfma_f32_16x16x32_bf16 v[44:47], a[4:7], a[160:163], v[44:47]
ds_read_b128 a[44:47], v201 offset:11264
s_add_u32 m0, s63, 69632
v_mfma_f32_16x16x32_bf16 v[48:51], a[4:7], a[164:167], v[48:51]
ds_read_b128 a[48:51], v201 offset:12288
v_mul_f32 v194, v194, v150
v_mfma_f32_16x16x32_bf16 v[52:55], a[8:11], a[160:163], v[52:55]
ds_read_b128 a[52:55], v201 offset:13312
s_add_u32 s61, s61, 36864
v_mfma_f32_16x16x32_bf16 v[56:59], a[8:11], a[164:167], v[56:59]
ds_read_b128 a[56:59], v201 offset:14336
v_mul_f32 v195, v195, v151
v_mfma_f32_16x16x32_bf16 v[60:63], a[12:15], a[160:163], v[60:63]
ds_read_b128 a[60:63], v201 offset:15360
buffer_load_dwordx4 v1, s[8:11], s61 offen offset:0 sc1 lds
v_mfma_f32_16x16x32_bf16 v[64:67], a[12:15], a[164:167], v[64:67]
ds_read_b128 a[64:67], v201 offset:16384
v_mfma_f32_16x16x32_bf16 v[68:71], a[16:19], a[160:163], v[68:71]
ds_read_b128 a[68:71], v201 offset:17408
s_add_u32 m0, s62, 73728
v_mfma_f32_16x16x32_bf16 v[72:75], a[16:19], a[164:167], v[72:75]
s_add_u32 s60, s60, 20480
v_exp_f32 v192, v192
v_mfma_f32_16x16x32_bf16 v[76:79], a[20:23], a[160:163], v[76:79]
v_mfma_f32_16x16x32_bf16 v[80:83], a[20:23], a[164:167], v[80:83]
v_mfma_f32_16x16x32_bf16 v[84:87], a[24:27], a[160:163], v[84:87]
buffer_load_dwordx4 v1, s[8:11], s60 offen offset:0 sc1 lds
v_mfma_f32_16x16x32_bf16 v[88:91], a[24:27], a[164:167], v[88:91]
v_exp_f32 v193, v193
v_mfma_f32_16x16x32_bf16 v[92:95], a[28:31], a[160:163], v[92:95]
buffer_load_dwordx4 v1, s[8:11], s60 offen offset:1024 sc1 lds
v_mfma_f32_16x16x32_bf16 v[96:99], a[28:31], a[164:167], v[96:99]
v_mfma_f32_16x16x32_bf16 v[100:103], a[32:35], a[160:163], v[100:103]
v_mfma_f32_16x16x32_bf16 v[104:107], a[32:35], a[164:167], v[104:107]
s_waitcnt lgkmcnt(0)
v_mfma_f32_16x16x32_bf16 v[36:39], a[36:39], a[168:171], v[36:39]
ds_read_b128 a[0:3], v201 offset:18432
buffer_load_dwordx4 v1, s[8:11], s60 offen offset:2048 sc1 lds
v_mfma_f32_16x16x32_bf16 v[40:43], a[36:39], a[172:175], v[40:43]
ds_read_b128 a[4:7], v201 offset:19456
v_mfma_f32_16x16x32_bf16 v[44:47], a[40:43], a[168:171], v[44:47]
ds_read_b128 a[8:11], v201 offset:20480
buffer_load_dwordx4 v1, s[8:11], s60 offen offset:3072 sc1 lds
v_mfma_f32_16x16x32_bf16 v[48:51], a[40:43], a[172:175], v[48:51]
ds_read_b128 a[12:15], v201 offset:21504
v_mfma_f32_16x16x32_bf16 v[52:55], a[44:47], a[168:171], v[52:55]
ds_read_b128 a[16:19], v201 offset:22528
v_mfma_f32_16x16x32_bf16 v[56:59], a[44:47], a[172:175], v[56:59]
ds_read_b128 a[20:23], v201 offset:23552
v_mfma_f32_16x16x32_bf16 v[60:63], a[48:51], a[168:171], v[60:63]
ds_read_b128 a[24:27], v201 offset:24576
v_mfma_f32_16x16x32_bf16 v[64:67], a[48:51], a[172:175], v[64:67]
ds_read_b128 a[28:31], v201 offset:25600
v_mfma_f32_16x16x32_bf16 v[68:71], a[52:55], a[168:171], v[68:71]
ds_read_b128 a[32:35], v201 offset:26624
v_mfma_f32_16x16x32_bf16 v[72:75], a[52:55], a[172:175], v[72:75]
s_cmp_eq_u32 s25, 7
s_cselect_b32 s98, 4096, 0
s_add_u32 s52, s52, s98
v_mfma_f32_16x16x32_bf16 v[76:79], a[56:59], a[168:171], v[76:79]
s_add_u32 s52, s52, 4096
v_exp_f32 v194, v194
v_mfma_f32_16x16x32_bf16 v[80:83], a[56:59], a[172:175], v[80:83]
v_exp_f32 v195, v195
v_mfma_f32_16x16x32_bf16 v[84:87], a[60:63], a[168:171], v[84:87]
buffer_load_dwordx4 a[80:83], v1, s[4:7], s52 offen offset:0 sc1
v_fma_f32 v192, v192, v254, v254
v_mfma_f32_16x16x32_bf16 v[88:91], a[60:63], a[172:175], v[88:91]
v_fma_f32 v193, v193, v254, v254
v_fma_f32 v194, v194, v254, v254
v_mfma_f32_16x16x32_bf16 v[92:95], a[64:67], a[168:171], v[92:95]
buffer_load_dwordx4 a[84:87], v9, s[4:7], s52 offen offset:0 sc1
v_mfma_f32_16x16x32_bf16 v[96:99], a[64:67], a[172:175], v[96:99]
v_fma_f32 v195, v195, v254, v254
v_mfma_f32_16x16x32_bf16 v[100:103], a[68:71], a[168:171], v[100:103]
v_mfma_f32_16x16x32_bf16 v[104:107], a[68:71], a[172:175], v[104:107]
s_waitcnt lgkmcnt(0)
v_mfma_f32_16x16x32_bf16 v[36:39], a[0:3], a[176:179], v[36:39]
ds_read_b128 a[36:39], v201 offset:27648
buffer_load_dwordx4 a[88:91], v1, s[4:7], s52 offen offset:1024 sc1
v_mfma_f32_16x16x32_bf16 v[40:43], a[0:3], a[180:183], v[40:43]
ds_read_b128 a[40:43], v201 offset:28672
v_mfma_f32_16x16x32_bf16 v[44:47], a[4:7], a[176:179], v[44:47]
ds_read_b128 a[44:47], v201 offset:29696
v_mfma_f32_16x16x32_bf16 v[48:51], a[4:7], a[180:183], v[48:51]
ds_read_b128 a[48:51], v201 offset:30720
v_mfma_f32_16x16x32_bf16 v[52:55], a[8:11], a[176:179], v[52:55]
ds_read_b128 a[52:55], v201 offset:31744
buffer_load_dwordx4 a[92:95], v9, s[4:7], s52 offen offset:1024 sc1
v_mfma_f32_16x16x32_bf16 v[56:59], a[8:11], a[180:183], v[56:59]
ds_read_b128 a[56:59], v201 offset:32768
v_mfma_f32_16x16x32_bf16 v[60:63], a[12:15], a[176:179], v[60:63]
ds_read_b128 a[60:63], v201 offset:33792
v_mfma_f32_16x16x32_bf16 v[64:67], a[12:15], a[180:183], v[64:67]
ds_read_b128 a[64:67], v201 offset:34816
v_mfma_f32_16x16x32_bf16 v[68:71], a[16:19], a[176:179], v[68:71]
ds_read_b128 a[68:71], v201 offset:35840
buffer_load_dwordx4 a[96:99], v1, s[4:7], s52 offen offset:2048 sc1
v_mfma_f32_16x16x32_bf16 v[72:75], a[16:19], a[180:183], v[72:75]
v_rcp_f32 v192, v192
v_mfma_f32_16x16x32_bf16 v[76:79], a[20:23], a[176:179], v[76:79]
v_rcp_f32 v193, v193
v_mfma_f32_16x16x32_bf16 v[80:83], a[20:23], a[180:183], v[80:83]
v_rcp_f32 v194, v194
v_mfma_f32_16x16x32_bf16 v[84:87], a[24:27], a[176:179], v[84:87]
buffer_load_dwordx4 a[100:103], v9, s[4:7], s52 offen offset:2048 sc1
v_mfma_f32_16x16x32_bf16 v[88:91], a[24:27], a[180:183], v[88:91]
v_mfma_f32_16x16x32_bf16 v[92:95], a[28:31], a[176:179], v[92:95]
v_rcp_f32 v195, v195
v_mfma_f32_16x16x32_bf16 v[96:99], a[28:31], a[180:183], v[96:99]
v_mfma_f32_16x16x32_bf16 v[100:103], a[32:35], a[176:179], v[100:103]
v_mfma_f32_16x16x32_bf16 v[104:107], a[32:35], a[180:183], v[104:107]
s_waitcnt vmcnt(23) lgkmcnt(0)
s_barrier
v_mfma_f32_16x16x32_bf16 v[36:39], a[36:39], a[184:187], v[36:39]
ds_read_b128 a[0:3], v202 offset:0
buffer_load_dwordx4 a[104:107], v1, s[4:7], s52 offen offset:3072 sc1
v_mfma_f32_16x16x32_bf16 v[40:43], a[36:39], a[188:191], v[40:43]
ds_read_b128 a[4:7], v202 offset:1024
buffer_load_dwordx4 a[108:111], v9, s[4:7], s52 offen offset:3072 sc1
v_mfma_f32_16x16x32_bf16 v[44:47], a[40:43], a[184:187], v[44:47]
ds_read_b128 a[8:11], v202 offset:2048
v_mul_f32 v148, v148, v192
v_mfma_f32_16x16x32_bf16 v[48:51], a[40:43], a[188:191], v[48:51]
ds_read_b128 a[12:15], v202 offset:3072
v_mul_f32 v149, v149, v193
v_mfma_f32_16x16x32_bf16 v[52:55], a[44:47], a[184:187], v[52:55]
ds_read_b128 a[16:19], v202 offset:4096
v_mfma_f32_16x16x32_bf16 v[56:59], a[44:47], a[188:191], v[56:59]
ds_read_b128 a[20:23], v202 offset:5120
v_mul_f32 v150, v150, v194
v_mfma_f32_16x16x32_bf16 v[60:63], a[48:51], a[184:187], v[60:63]
ds_read_b128 a[24:27], v202 offset:6144
v_mfma_f32_16x16x32_bf16 v[64:67], a[48:51], a[188:191], v[64:67]
ds_read_b128 a[28:31], v202 offset:7168
v_mul_f32 v151, v151, v195
v_mfma_f32_16x16x32_bf16 v[68:71], a[52:55], a[184:187], v[68:71]
ds_read_b128 a[32:35], v202 offset:8192
v_mfma_f32_16x16x32_bf16 v[72:75], a[52:55], a[188:191], v[72:75]
s_cmp_eq_u32 s25, 7
s_cselect_b32 s99, 36864, 0
s_add_u32 s60, s60, s99
v_mfma_f32_16x16x32_bf16 v[76:79], a[56:59], a[184:187], v[76:79]
s_add_u32 s61, s61, s99
s_add_u32 m0, s62, 90112
v_mul_f32 v196, v152, v152
v_mfma_f32_16x16x32_bf16 v[80:83], a[56:59], a[188:191], v[80:83]
s_add_u32 s60, s60, 16384
v_mfma_f32_16x16x32_bf16 v[84:87], a[60:63], a[184:187], v[84:87]
v_mul_f32 v197, v153, v153
v_mfma_f32_16x16x32_bf16 v[88:91], a[60:63], a[188:191], v[88:91]
buffer_load_dwordx4 v1, s[8:11], s60 offen offset:0 sc1 lds
v_mfma_f32_16x16x32_bf16 v[92:95], a[64:67], a[184:187], v[92:95]
v_mul_f32 v198, v154, v154
v_mfma_f32_16x16x32_bf16 v[96:99], a[64:67], a[188:191], v[96:99]
buffer_load_dwordx4 v1, s[8:11], s60 offen offset:1024 sc1 lds
v_mfma_f32_16x16x32_bf16 v[100:103], a[68:71], a[184:187], v[100:103]
v_mfma_f32_16x16x32_bf16 v[104:107], a[68:71], a[188:191], v[104:107]
v_mul_f32 v199, v155, v155
s_waitcnt lgkmcnt(0)
v_mfma_f32_16x16x32_bf16 v[36:39], a[0:3], a[192:195], v[36:39]
ds_read_b128 a[36:39], v202 offset:9216
buffer_load_dwordx4 v1, s[8:11], s60 offen offset:2048 sc1 lds
v_mfma_f32_16x16x32_bf16 v[40:43], a[0:3], a[196:199], v[40:43]
ds_read_b128 a[40:43], v202 offset:10240
v_fma_f32 v196, v196, v253, v251
v_mfma_f32_16x16x32_bf16 v[44:47], a[4:7], a[192:195], v[44:47]
ds_read_b128 a[44:47], v202 offset:11264
buffer_load_dwordx4 v1, s[8:11], s60 offen offset:3072 sc1 lds
v_mfma_f32_16x16x32_bf16 v[48:51], a[4:7], a[196:199], v[48:51]
ds_read_b128 a[48:51], v202 offset:12288
v_mfma_f32_16x16x32_bf16 v[52:55], a[8:11], a[192:195], v[52:55]
ds_read_b128 a[52:55], v202 offset:13312
s_add_u32 m0, s63, 106496
v_mfma_f32_16x16x32_bf16 v[56:59], a[8:11], a[196:199], v[56:59]
ds_read_b128 a[56:59], v202 offset:14336
v_fma_f32 v197, v197, v253, v251
v_mfma_f32_16x16x32_bf16 v[60:63], a[12:15], a[192:195], v[60:63]
ds_read_b128 a[60:63], v202 offset:15360
s_add_u32 s61, s61, 36864
v_mfma_f32_16x16x32_bf16 v[64:67], a[12:15], a[196:199], v[64:67]
ds_read_b128 a[64:67], v202 offset:16384
v_fma_f32 v198, v198, v253, v251
v_mfma_f32_16x16x32_bf16 v[68:71], a[16:19], a[192:195], v[68:71]
ds_read_b128 a[68:71], v202 offset:17408
buffer_load_dwordx4 v1, s[8:11], s61 offen offset:0 sc1 lds
v_mfma_f32_16x16x32_bf16 v[72:75], a[16:19], a[196:199], v[72:75]
s_add_u32 m0, s62, 110592
v_fma_f32 v199, v199, v253, v251
v_mfma_f32_16x16x32_bf16 v[76:79], a[20:23], a[192:195], v[76:79]
s_add_u32 s60, s60, 20480
v_mfma_f32_16x16x32_bf16 v[80:83], a[20:23], a[196:199], v[80:83]
v_mul_f32 v196, v196, v152
v_mfma_f32_16x16x32_bf16 v[84:87], a[24:27], a[192:195], v[84:87]
v_mfma_f32_16x16x32_bf16 v[88:91], a[24:27], a[196:199], v[88:91]
v_mul_f32 v197, v197, v153
v_mfma_f32_16x16x32_bf16 v[92:95], a[28:31], a[192:195], v[92:95]
buffer_load_dwordx4 v1, s[8:11], s60 offen offset:0 sc1 lds
v_mfma_f32_16x16x32_bf16 v[96:99], a[28:31], a[196:199], v[96:99]
v_mul_f32 v198, v198, v154
v_mfma_f32_16x16x32_bf16 v[100:103], a[32:35], a[192:195], v[100:103]
v_mfma_f32_16x16x32_bf16 v[104:107], a[32:35], a[196:199], v[104:107]
s_waitcnt lgkmcnt(0)
v_mfma_f32_16x16x32_bf16 v[36:39], a[36:39], a[200:203], v[36:39]
ds_read_b128 a[0:3], v202 offset:18432
buffer_load_dwordx4 v1, s[8:11], s60 offen offset:1024 sc1 lds
v_mfma_f32_16x16x32_bf16 v[40:43], a[36:39], a[204:207], v[40:43]
ds_read_b128 a[4:7], v202 offset:19456
v_mul_f32 v199, v199, v155
v_mfma_f32_16x16x32_bf16 v[44:47], a[40:43], a[200:203], v[44:47]
ds_read_b128 a[8:11], v202 offset:20480
buffer_load_dwordx4 v1, s[8:11], s60 offen offset:2048 sc1 lds
v_mfma_f32_16x16x32_bf16 v[48:51], a[40:43], a[204:207], v[48:51]
ds_read_b128 a[12:15], v202 offset:21504
v_mfma_f32_16x16x32_bf16 v[52:55], a[44:47], a[200:203], v[52:55]
ds_read_b128 a[16:19], v202 offset:22528
buffer_load_dwordx4 v1, s[8:11], s60 offen offset:3072 sc1 lds
v_mfma_f32_16x16x32_bf16 v[56:59], a[44:47], a[204:207], v[56:59]
ds_read_b128 a[20:23], v202 offset:23552
v_mfma_f32_16x16x32_bf16 v[60:63], a[48:51], a[200:203], v[60:63]
ds_read_b128 a[24:27], v202 offset:24576
v_mfma_f32_16x16x32_bf16 v[64:67], a[48:51], a[204:207], v[64:67]
ds_read_b128 a[28:31], v202 offset:25600
v_mfma_f32_16x16x32_bf16 v[68:71], a[52:55], a[200:203], v[68:71]
ds_read_b128 a[32:35], v202 offset:26624
v_mfma_f32_16x16x32_bf16 v[72:75], a[52:55], a[204:207], v[72:75]
s_cmp_eq_u32 s25, 8
s_cselect_b32 s98, 4096, 0
v_mfma_f32_16x16x32_bf16 v[76:79], a[56:59], a[200:203], v[76:79]
s_add_u32 s52, s52, s98
v_exp_f32 v196, v196
v_mfma_f32_16x16x32_bf16 v[80:83], a[56:59], a[204:207], v[80:83]
s_add_u32 s52, s52, 4096
v_exp_f32 v197, v197
v_mfma_f32_16x16x32_bf16 v[84:87], a[60:63], a[200:203], v[84:87]
v_exp_f32 v198, v198
v_mfma_f32_16x16x32_bf16 v[88:91], a[60:63], a[204:207], v[88:91]
v_mfma_f32_16x16x32_bf16 v[92:95], a[64:67], a[200:203], v[92:95]
buffer_load_dwordx4 a[112:115], v1, s[4:7], s52 offen offset:0 sc1
v_mfma_f32_16x16x32_bf16 v[96:99], a[64:67], a[204:207], v[96:99]
v_mfma_f32_16x16x32_bf16 v[100:103], a[68:71], a[200:203], v[100:103]
v_exp_f32 v199, v199
v_mfma_f32_16x16x32_bf16 v[104:107], a[68:71], a[204:207], v[104:107]
s_waitcnt lgkmcnt(0)
v_mfma_f32_16x16x32_bf16 v[36:39], a[0:3], a[208:211], v[36:39]
ds_read_b128 a[36:39], v202 offset:27648
buffer_load_dwordx4 a[116:119], v9, s[4:7], s52 offen offset:0 sc1
v_mfma_f32_16x16x32_bf16 v[40:43], a[0:3], a[212:215], v[40:43]
ds_read_b128 a[40:43], v202 offset:28672
v_mfma_f32_16x16x32_bf16 v[44:47], a[4:7], a[208:211], v[44:47]
ds_read_b128 a[44:47], v202 offset:29696
v_mfma_f32_16x16x32_bf16 v[48:51], a[4:7], a[212:215], v[48:51]
ds_read_b128 a[48:51], v202 offset:30720
v_fma_f32 v196, v196, v255, v255
v_mfma_f32_16x16x32_bf16 v[52:55], a[8:11], a[208:211], v[52:55]
ds_read_b128 a[52:55], v202 offset:31744
buffer_load_dwordx4 a[120:123], v1, s[4:7], s52 offen offset:1024 sc1
v_mfma_f32_16x16x32_bf16 v[56:59], a[8:11], a[212:215], v[56:59]
ds_read_b128 a[56:59], v202 offset:32768
v_fma_f32 v197, v197, v255, v255
v_mfma_f32_16x16x32_bf16 v[60:63], a[12:15], a[208:211], v[60:63]
ds_read_b128 a[60:63], v202 offset:33792
v_mfma_f32_16x16x32_bf16 v[64:67], a[12:15], a[212:215], v[64:67]
ds_read_b128 a[64:67], v202 offset:34816
v_mfma_f32_16x16x32_bf16 v[68:71], a[16:19], a[208:211], v[68:71]
ds_read_b128 a[68:71], v202 offset:35840
buffer_load_dwordx4 a[124:127], v9, s[4:7], s52 offen offset:1024 sc1
v_mfma_f32_16x16x32_bf16 v[72:75], a[16:19], a[212:215], v[72:75]
v_fma_f32 v198, v198, v255, v255
v_mfma_f32_16x16x32_bf16 v[76:79], a[20:23], a[208:211], v[76:79]
v_fma_f32 v199, v199, v255, v255
v_mfma_f32_16x16x32_bf16 v[80:83], a[20:23], a[212:215], v[80:83]
v_mfma_f32_16x16x32_bf16 v[84:87], a[24:27], a[208:211], v[84:87]
buffer_load_dwordx4 a[128:131], v1, s[4:7], s52 offen offset:2048 sc1
v_mfma_f32_16x16x32_bf16 v[88:91], a[24:27], a[212:215], v[88:91]
v_rcp_f32 v196, v196
v_mfma_f32_16x16x32_bf16 v[92:95], a[28:31], a[208:211], v[92:95]
v_mfma_f32_16x16x32_bf16 v[96:99], a[28:31], a[212:215], v[96:99]
v_mfma_f32_16x16x32_bf16 v[100:103], a[32:35], a[208:211], v[100:103]
v_mfma_f32_16x16x32_bf16 v[104:107], a[32:35], a[212:215], v[104:107]
s_waitcnt vmcnt(22) lgkmcnt(0)
s_barrier
v_mfma_f32_16x16x32_bf16 v[36:39], a[36:39], a[216:219], v[36:39]
ds_read_b128 a[0:3], v200 offset:0
buffer_load_dwordx4 a[132:135], v9, s[4:7], s52 offen offset:2048 sc1
v_mfma_f32_16x16x32_bf16 v[40:43], a[36:39], a[220:223], v[40:43]
ds_read_b128 a[4:7], v200 offset:1024
buffer_load_dwordx4 a[136:139], v1, s[4:7], s52 offen offset:3072 sc1
v_mfma_f32_16x16x32_bf16 v[44:47], a[40:43], a[216:219], v[44:47]
ds_read_b128 a[8:11], v200 offset:2048
v_mfma_f32_16x16x32_bf16 v[48:51], a[40:43], a[220:223], v[48:51]
ds_read_b128 a[12:15], v200 offset:3072
buffer_load_dwordx4 a[140:143], v9, s[4:7], s52 offen offset:3072 sc1
v_mfma_f32_16x16x32_bf16 v[52:55], a[44:47], a[216:219], v[52:55]
ds_read_b128 a[16:19], v200 offset:4096
v_mfma_f32_16x16x32_bf16 v[56:59], a[44:47], a[220:223], v[56:59]
ds_read_b128 a[20:23], v200 offset:5120
v_mfma_f32_16x16x32_bf16 v[60:63], a[48:51], a[216:219], v[60:63]
ds_read_b128 a[24:27], v200 offset:6144
v_mfma_f32_16x16x32_bf16 v[64:67], a[48:51], a[220:223], v[64:67]
ds_read_b128 a[28:31], v200 offset:7168
v_mfma_f32_16x16x32_bf16 v[68:71], a[52:55], a[216:219], v[68:71]
ds_read_b128 a[32:35], v200 offset:8192
v_mfma_f32_16x16x32_bf16 v[72:75], a[52:55], a[220:223], v[72:75]
s_cmp_eq_u32 s25, 8
s_cselect_b32 s99, 36864, 0
s_add_u32 s60, s60, s99
v_mfma_f32_16x16x32_bf16 v[76:79], a[56:59], a[216:219], v[76:79]
s_add_u32 s61, s61, s99
v_rcp_f32 v197, v197
v_mfma_f32_16x16x32_bf16 v[80:83], a[56:59], a[220:223], v[80:83]
s_add_u32 m0, s62, 126976
v_rcp_f32 v198, v198
v_mfma_f32_16x16x32_bf16 v[84:87], a[60:63], a[216:219], v[84:87]
s_add_u32 s60, s60, 16384
v_rcp_f32 v199, v199
v_mfma_f32_16x16x32_bf16 v[88:91], a[60:63], a[220:223], v[88:91]
v_mul_f32 v152, v152, v196
v_mfma_f32_16x16x32_bf16 v[92:95], a[64:67], a[216:219], v[92:95]
v_mfma_f32_16x16x32_bf16 v[96:99], a[64:67], a[220:223], v[96:99]
buffer_load_dwordx4 v1, s[8:11], s60 offen offset:0 sc1 lds
v_mfma_f32_16x16x32_bf16 v[100:103], a[68:71], a[216:219], v[100:103]
v_mul_f32 v153, v153, v197
v_mfma_f32_16x16x32_bf16 v[104:107], a[68:71], a[220:223], v[104:107]
s_waitcnt lgkmcnt(0)
v_mfma_f32_16x16x32_bf16 v[36:39], a[0:3], a[224:227], v[36:39]
ds_read_b128 a[36:39], v200 offset:9216
buffer_load_dwordx4 v1, s[8:11], s60 offen offset:1024 sc1 lds
v_mfma_f32_16x16x32_bf16 v[40:43], a[0:3], a[228:231], v[40:43]
ds_read_b128 a[40:43], v200 offset:10240
v_mul_f32 v154, v154, v198
v_mfma_f32_16x16x32_bf16 v[44:47], a[4:7], a[224:227], v[44:47]
ds_read_b128 a[44:47], v200 offset:11264
buffer_load_dwordx4 v1, s[8:11], s60 offen offset:2048 sc1 lds
v_mfma_f32_16x16x32_bf16 v[48:51], a[4:7], a[228:231], v[48:51]
ds_read_b128 a[48:51], v200 offset:12288
v_mul_f32 v155, v155, v199
v_mfma_f32_16x16x32_bf16 v[52:55], a[8:11], a[224:227], v[52:55]
ds_read_b128 a[52:55], v200 offset:13312
v_mfma_f32_16x16x32_bf16 v[56:59], a[8:11], a[228:231], v[56:59]
ds_read_b128 a[56:59], v200 offset:14336
buffer_load_dwordx4 v1, s[8:11], s60 offen offset:3072 sc1 lds
v_mfma_f32_16x16x32_bf16 v[60:63], a[12:15], a[224:227], v[60:63]
ds_read_b128 a[60:63], v200 offset:15360
v_mul_f32 v192, v156, v156
v_mfma_f32_16x16x32_bf16 v[64:67], a[12:15], a[228:231], v[64:67]
ds_read_b128 a[64:67], v200 offset:16384
v_mul_f32 v193, v157, v157
v_mfma_f32_16x16x32_bf16 v[68:71], a[16:19], a[224:227], v[68:71]
ds_read_b128 a[68:71], v200 offset:17408
s_add_u32 m0, s63, 143360
v_mfma_f32_16x16x32_bf16 v[72:75], a[16:19], a[228:231], v[72:75]
s_add_u32 s61, s61, 36864
v_mul_f32 v194, v158, v158
v_mfma_f32_16x16x32_bf16 v[76:79], a[20:23], a[224:227], v[76:79]
v_mfma_f32_16x16x32_bf16 v[80:83], a[20:23], a[228:231], v[80:83]
v_mfma_f32_16x16x32_bf16 v[84:87], a[24:27], a[224:227], v[84:87]
v_mul_f32 v195, v159, v159
v_mfma_f32_16x16x32_bf16 v[88:91], a[24:27], a[228:231], v[88:91]
v_mfma_f32_16x16x32_bf16 v[92:95], a[28:31], a[224:227], v[92:95]
buffer_load_dwordx4 v1, s[8:11], s61 offen offset:0 sc1 lds
v_fma_f32 v192, v192, v252, v250
v_mfma_f32_16x16x32_bf16 v[96:99], a[28:31], a[228:231], v[96:99]
v_mfma_f32_16x16x32_bf16 v[100:103], a[32:35], a[224:227], v[100:103]
v_fma_f32 v193, v193, v252, v250
v_mfma_f32_16x16x32_bf16 v[104:107], a[32:35], a[228:231], v[104:107]
s_waitcnt lgkmcnt(0)
v_mfma_f32_16x16x32_bf16 v[36:39], a[36:39], a[232:235], v[36:39]
ds_read_b128 a[0:3], v200 offset:18432
s_add_u32 m0, s62, 147456
v_mfma_f32_16x16x32_bf16 v[40:43], a[36:39], a[236:239], v[40:43]
ds_read_b128 a[4:7], v200 offset:19456
v_fma_f32 v194, v194, v252, v250
v_mfma_f32_16x16x32_bf16 v[44:47], a[40:43], a[232:235], v[44:47]
ds_read_b128 a[8:11], v200 offset:20480
s_add_u32 s60, s60, 20480
v_mfma_f32_16x16x32_bf16 v[48:51], a[40:43], a[236:239], v[48:51]
ds_read_b128 a[12:15], v200 offset:21504
v_fma_f32 v195, v195, v252, v250
v_mfma_f32_16x16x32_bf16 v[52:55], a[44:47], a[232:235], v[52:55]
ds_read_b128 a[16:19], v200 offset:22528
v_mfma_f32_16x16x32_bf16 v[56:59], a[44:47], a[236:239], v[56:59]
ds_read_b128 a[20:23], v200 offset:23552
buffer_load_dwordx4 v1, s[8:11], s60 offen offset:0 sc1 lds
v_mfma_f32_16x16x32_bf16 v[60:63], a[48:51], a[232:235], v[60:63]
ds_read_b128 a[24:27], v200 offset:24576
v_mul_f32 v192, v192, v156
v_mfma_f32_16x16x32_bf16 v[64:67], a[48:51], a[236:239], v[64:67]
ds_read_b128 a[28:31], v200 offset:25600
v_mfma_f32_16x16x32_bf16 v[68:71], a[52:55], a[232:235], v[68:71]
ds_read_b128 a[32:35], v200 offset:26624
buffer_load_dwordx4 v1, s[8:11], s60 offen offset:1024 sc1 lds
v_mfma_f32_16x16x32_bf16 v[72:75], a[52:55], a[236:239], v[72:75]
v_mul_f32 v193, v193, v157
v_mfma_f32_16x16x32_bf16 v[76:79], a[56:59], a[232:235], v[76:79]
v_mul_f32 v194, v194, v158
v_mfma_f32_16x16x32_bf16 v[80:83], a[56:59], a[236:239], v[80:83]
buffer_load_dwordx4 v1, s[8:11], s60 offen offset:2048 sc1 lds
v_mfma_f32_16x16x32_bf16 v[84:87], a[60:63], a[232:235], v[84:87]
v_mfma_f32_16x16x32_bf16 v[88:91], a[60:63], a[236:239], v[88:91]
v_mul_f32 v195, v195, v159
v_mfma_f32_16x16x32_bf16 v[92:95], a[64:67], a[232:235], v[92:95]
buffer_load_dwordx4 v1, s[8:11], s60 offen offset:3072 sc1 lds
v_mfma_f32_16x16x32_bf16 v[96:99], a[64:67], a[236:239], v[96:99]
v_exp_f32 v192, v192
v_mfma_f32_16x16x32_bf16 v[100:103], a[68:71], a[232:235], v[100:103]
v_mfma_f32_16x16x32_bf16 v[104:107], a[68:71], a[236:239], v[104:107]
s_waitcnt lgkmcnt(0)
v_mfma_f32_16x16x32_bf16 v[36:39], a[0:3], a[240:243], v[36:39]
ds_read_b128 a[36:39], v200 offset:27648
v_mfma_f32_16x16x32_bf16 v[40:43], a[0:3], a[244:247], v[40:43]
ds_read_b128 a[40:43], v200 offset:28672
v_mfma_f32_16x16x32_bf16 v[44:47], a[4:7], a[240:243], v[44:47]
ds_read_b128 a[44:47], v200 offset:29696
v_mfma_f32_16x16x32_bf16 v[48:51], a[4:7], a[244:247], v[48:51]
ds_read_b128 a[48:51], v200 offset:30720
v_mfma_f32_16x16x32_bf16 v[52:55], a[8:11], a[240:243], v[52:55]
ds_read_b128 a[52:55], v200 offset:31744
v_mfma_f32_16x16x32_bf16 v[56:59], a[8:11], a[244:247], v[56:59]
ds_read_b128 a[56:59], v200 offset:32768
v_mfma_f32_16x16x32_bf16 v[60:63], a[12:15], a[240:243], v[60:63]
ds_read_b128 a[60:63], v200 offset:33792
v_mfma_f32_16x16x32_bf16 v[64:67], a[12:15], a[244:247], v[64:67]
ds_read_b128 a[64:67], v200 offset:34816
v_mfma_f32_16x16x32_bf16 v[68:71], a[16:19], a[240:243], v[68:71]
ds_read_b128 a[68:71], v200 offset:35840
v_mfma_f32_16x16x32_bf16 v[72:75], a[16:19], a[244:247], v[72:75]
s_cmp_eq_u32 s25, 9
s_cselect_b32 s98, 4096, 0
s_add_u32 s52, s52, s98
v_mfma_f32_16x16x32_bf16 v[76:79], a[20:23], a[240:243], v[76:79]
s_add_u32 s52, s52, 4096
v_exp_f32 v193, v193
v_mfma_f32_16x16x32_bf16 v[80:83], a[20:23], a[244:247], v[80:83]
buffer_load_dwordx4 a[144:147], v1, s[4:7], s52 offen offset:0 sc1
v_mfma_f32_16x16x32_bf16 v[84:87], a[24:27], a[240:243], v[84:87]
buffer_load_dwordx4 a[148:151], v9, s[4:7], s52 offen offset:0 sc1
v_mfma_f32_16x16x32_bf16 v[88:91], a[24:27], a[244:247], v[88:91]
buffer_load_dwordx4 a[152:155], v1, s[4:7], s52 offen offset:1024 sc1
v_mfma_f32_16x16x32_bf16 v[92:95], a[28:31], a[240:243], v[92:95]
buffer_load_dwordx4 a[156:159], v9, s[4:7], s52 offen offset:1024 sc1
v_mfma_f32_16x16x32_bf16 v[96:99], a[28:31], a[244:247], v[96:99]
v_exp_f32 v194, v194
v_mfma_f32_16x16x32_bf16 v[100:103], a[32:35], a[240:243], v[100:103]
v_exp_f32 v195, v195
v_mfma_f32_16x16x32_bf16 v[104:107], a[32:35], a[244:247], v[104:107]
s_waitcnt vmcnt(21) lgkmcnt(0)
s_barrier
v_mfma_f32_16x16x32_bf16 v[36:39], a[36:39], a[248:251], v[36:39]
ds_read_b128 a[0:3], v201 offset:0
v_fma_f32 v192, v192, v254, v254
v_mfma_f32_16x16x32_bf16 v[40:43], a[36:39], a[252:255], v[40:43]
ds_read_b128 a[4:7], v201 offset:1024
v_fma_f32 v193, v193, v254, v254
v_mfma_f32_16x16x32_bf16 v[44:47], a[40:43], a[248:251], v[44:47]
ds_read_b128 a[8:11], v201 offset:2048
v_fma_f32 v194, v194, v254, v254
v_mfma_f32_16x16x32_bf16 v[48:51], a[40:43], a[252:255], v[48:51]
ds_read_b128 a[12:15], v201 offset:3072
v_mfma_f32_16x16x32_bf16 v[52:55], a[44:47], a[248:251], v[52:55]
ds_read_b128 a[16:19], v201 offset:4096
v_mfma_f32_16x16x32_bf16 v[56:59], a[44:47], a[252:255], v[56:59]
ds_read_b128 a[20:23], v201 offset:5120
v_fma_f32 v195, v195, v254, v254
v_mfma_f32_16x16x32_bf16 v[60:63], a[48:51], a[248:251], v[60:63]
ds_read_b128 a[24:27], v201 offset:6144
v_mfma_f32_16x16x32_bf16 v[64:67], a[48:51], a[252:255], v[64:67]
ds_read_b128 a[28:31], v201 offset:7168
v_mfma_f32_16x16x32_bf16 v[68:71], a[52:55], a[248:251], v[68:71]
ds_read_b128 a[32:35], v201 offset:8192
v_mfma_f32_16x16x32_bf16 v[72:75], a[52:55], a[252:255], v[72:75]
s_cmp_eq_u32 s25, 9
s_cselect_b32 s99, 36864, 0
s_add_u32 s60, s60, s99
v_mfma_f32_16x16x32_bf16 v[76:79], a[56:59], a[248:251], v[76:79]
s_add_u32 s61, s61, s99
s_add_u32 m0, s62, 53248
s_add_u32 s60, s60, 16384
v_mfma_f32_16x16x32_bf16 v[80:83], a[56:59], a[252:255], v[80:83]
buffer_load_dwordx4 v1, s[8:11], s60 offen offset:0 sc1 lds
v_mfma_f32_16x16x32_bf16 v[84:87], a[60:63], a[248:251], v[84:87]
buffer_load_dwordx4 v1, s[8:11], s60 offen offset:1024 sc1 lds
v_mfma_f32_16x16x32_bf16 v[88:91], a[60:63], a[252:255], v[88:91]
buffer_load_dwordx4 v1, s[8:11], s60 offen offset:2048 sc1 lds
v_mfma_f32_16x16x32_bf16 v[92:95], a[64:67], a[248:251], v[92:95]
v_rcp_f32 v192, v192
v_mfma_f32_16x16x32_bf16 v[96:99], a[64:67], a[252:255], v[96:99]
buffer_load_dwordx4 v1, s[8:11], s60 offen offset:3072 sc1 lds
v_mfma_f32_16x16x32_bf16 v[100:103], a[68:71], a[248:251], v[100:103]
v_rcp_f32 v193, v193
v_mfma_f32_16x16x32_bf16 v[104:107], a[68:71], a[252:255], v[104:107]
s_waitcnt lgkmcnt(0)
v_mfma_f32_16x16x32_bf16 v[36:39], a[0:3], a[80:83], v[36:39]
ds_read_b128 a[36:39], v201 offset:9216
s_add_u32 m0, s63, 69632
v_mfma_f32_16x16x32_bf16 v[40:43], a[0:3], a[84:87], v[40:43]
ds_read_b128 a[40:43], v201 offset:10240
v_mfma_f32_16x16x32_bf16 v[44:47], a[4:7], a[80:83], v[44:47]
ds_read_b128 a[44:47], v201 offset:11264
s_add_u32 s61, s61, 36864
v_mfma_f32_16x16x32_bf16 v[48:51], a[4:7], a[84:87], v[48:51]
ds_read_b128 a[48:51], v201 offset:12288
v_mfma_f32_16x16x32_bf16 v[52:55], a[8:11], a[80:83], v[52:55]
ds_read_b128 a[52:55], v201 offset:13312
buffer_load_dwordx4 v1, s[8:11], s61 offen offset:0 sc1 lds
v_mfma_f32_16x16x32_bf16 v[56:59], a[8:11], a[84:87], v[56:59]
ds_read_b128 a[56:59], v201 offset:14336
v_mfma_f32_16x16x32_bf16 v[60:63], a[12:15], a[80:83], v[60:63]
ds_read_b128 a[60:63], v201 offset:15360
s_add_u32 m0, s62, 73728
v_mfma_f32_16x16x32_bf16 v[64:67], a[12:15], a[84:87], v[64:67]
ds_read_b128 a[64:67], v201 offset:16384
v_mfma_f32_16x16x32_bf16 v[68:71], a[16:19], a[80:83], v[68:71]
ds_read_b128 a[68:71], v201 offset:17408
s_add_u32 s60, s60, 20480
v_mfma_f32_16x16x32_bf16 v[72:75], a[16:19], a[84:87], v[72:75]
v_rcp_f32 v194, v194
v_mfma_f32_16x16x32_bf16 v[76:79], a[20:23], a[80:83], v[76:79]
buffer_load_dwordx4 v1, s[8:11], s60 offen offset:0 sc1 lds
v_mfma_f32_16x16x32_bf16 v[80:83], a[20:23], a[84:87], v[80:83]
v_rcp_f32 v195, v195
v_mfma_f32_16x16x32_bf16 v[84:87], a[24:27], a[80:83], v[84:87]
buffer_load_dwordx4 v1, s[8:11], s60 offen offset:1024 sc1 lds
v_mul_f32 v156, v156, v192
v_mfma_f32_16x16x32_bf16 v[88:91], a[24:27], a[84:87], v[88:91]
v_mul_f32 v157, v157, v193
v_mul_f32 v158, v158, v194
v_mfma_f32_16x16x32_bf16 v[92:95], a[28:31], a[80:83], v[92:95]
buffer_load_dwordx4 v1, s[8:11], s60 offen offset:2048 sc1 lds
v_mfma_f32_16x16x32_bf16 v[96:99], a[28:31], a[84:87], v[96:99]
v_mul_f32 v159, v159, v195
v_mfma_f32_16x16x32_bf16 v[100:103], a[32:35], a[80:83], v[100:103]
v_mfma_f32_16x16x32_bf16 v[104:107], a[32:35], a[84:87], v[104:107]
v_mul_f32 v196, v160, v160
s_waitcnt lgkmcnt(0)
v_mfma_f32_16x16x32_bf16 v[36:39], a[36:39], a[88:91], v[36:39]
ds_read_b128 a[0:3], v201 offset:18432
buffer_load_dwordx4 v1, s[8:11], s60 offen offset:3072 sc1 lds
v_mfma_f32_16x16x32_bf16 v[40:43], a[36:39], a[92:95], v[40:43]
ds_read_b128 a[4:7], v201 offset:19456
v_mfma_f32_16x16x32_bf16 v[44:47], a[40:43], a[88:91], v[44:47]
ds_read_b128 a[8:11], v201 offset:20480
v_mul_f32 v197, v161, v161
v_mfma_f32_16x16x32_bf16 v[48:51], a[40:43], a[92:95], v[48:51]
ds_read_b128 a[12:15], v201 offset:21504
v_mfma_f32_16x16x32_bf16 v[52:55], a[44:47], a[88:91], v[52:55]
ds_read_b128 a[16:19], v201 offset:22528
buffer_load_dwordx4 a[160:163], v1, s[4:7], s52 offen offset:2048 sc1
v_mfma_f32_16x16x32_bf16 v[56:59], a[44:47], a[92:95], v[56:59]
ds_read_b128 a[20:23], v201 offset:23552
v_mul_f32 v198, v162, v162
v_mfma_f32_16x16x32_bf16 v[60:63], a[48:51], a[88:91], v[60:63]
ds_read_b128 a[24:27], v201 offset:24576
v_mfma_f32_16x16x32_bf16 v[64:67], a[48:51], a[92:95], v[64:67]
ds_read_b128 a[28:31], v201 offset:25600
v_mul_f32 v199, v163, v163
v_mfma_f32_16x16x32_bf16 v[68:71], a[52:55], a[88:91], v[68:71]
ds_read_b128 a[32:35], v201 offset:26624
buffer_load_dwordx4 a[164:167], v9, s[4:7], s52 offen offset:2048 sc1
v_mfma_f32_16x16x32_bf16 v[72:75], a[52:55], a[92:95], v[72:75]
v_fma_f32 v196, v196, v253, v251
v_mfma_f32_16x16x32_bf16 v[76:79], a[56:59], a[88:91], v[76:79]
v_mfma_f32_16x16x32_bf16 v[80:83], a[56:59], a[92:95], v[80:83]
v_fma_f32 v197, v197, v253, v251
v_mfma_f32_16x16x32_bf16 v[84:87], a[60:63], a[88:91], v[84:87]
buffer_load_dwordx4 a[168:171], v1, s[4:7], s52 offen offset:3072 sc1
v_mfma_f32_16x16x32_bf16 v[88:91], a[60:63], a[92:95], v[88:91]
v_mfma_f32_16x16x32_bf16 v[92:95], a[64:67], a[88:91], v[92:95]
v_fma_f32 v198, v198, v253, v251
v_mfma_f32_16x16x32_bf16 v[96:99], a[64:67], a[92:95], v[96:99]
v_mfma_f32_16x16x32_bf16 v[100:103], a[68:71], a[88:91], v[100:103]
v_fma_f32 v199, v199, v253, v251
v_mfma_f32_16x16x32_bf16 v[104:107], a[68:71], a[92:95], v[104:107]
s_waitcnt lgkmcnt(0)
v_mfma_f32_16x16x32_bf16 v[36:39], a[0:3], a[96:99], v[36:39]
ds_read_b128 a[36:39], v201 offset:27648
buffer_load_dwordx4 a[172:175], v9, s[4:7], s52 offen offset:3072 sc1
v_mfma_f32_16x16x32_bf16 v[40:43], a[0:3], a[100:103], v[40:43]
ds_read_b128 a[40:43], v201 offset:28672
v_mul_f32 v196, v196, v160
v_mfma_f32_16x16x32_bf16 v[44:47], a[4:7], a[96:99], v[44:47]
ds_read_b128 a[44:47], v201 offset:29696
v_mfma_f32_16x16x32_bf16 v[48:51], a[4:7], a[100:103], v[48:51]
ds_read_b128 a[48:51], v201 offset:30720
v_mul_f32 v197, v197, v161
v_mfma_f32_16x16x32_bf16 v[52:55], a[8:11], a[96:99], v[52:55]
ds_read_b128 a[52:55], v201 offset:31744
v_mfma_f32_16x16x32_bf16 v[56:59], a[8:11], a[100:103], v[56:59]
ds_read_b128 a[56:59], v201 offset:32768
v_mul_f32 v198, v198, v162
v_mfma_f32_16x16x32_bf16 v[60:63], a[12:15], a[96:99], v[60:63]
ds_read_b128 a[60:63], v201 offset:33792
v_mfma_f32_16x16x32_bf16 v[64:67], a[12:15], a[100:103], v[64:67]
ds_read_b128 a[64:67], v201 offset:34816
v_mul_f32 v199, v199, v163
v_mfma_f32_16x16x32_bf16 v[68:71], a[16:19], a[96:99], v[68:71]
ds_read_b128 a[68:71], v201 offset:35840
v_mfma_f32_16x16x32_bf16 v[72:75], a[16:19], a[100:103], v[72:75]
s_cmp_eq_u32 s25, 10
s_cselect_b32 s98, 4096, 0
s_add_u32 s52, s52, s98
v_mfma_f32_16x16x32_bf16 v[76:79], a[20:23], a[96:99], v[76:79]
s_add_u32 s52, s52, 4096
v_exp_f32 v196, v196
v_mfma_f32_16x16x32_bf16 v[80:83], a[20:23], a[100:103], v[80:83]
buffer_load_dwordx4 a[176:179], v1, s[4:7], s52 offen offset:0 sc1
v_mfma_f32_16x16x32_bf16 v[84:87], a[24:27], a[96:99], v[84:87]
buffer_load_dwordx4 a[180:183], v9, s[4:7], s52 offen offset:0 sc1
v_mfma_f32_16x16x32_bf16 v[88:91], a[24:27], a[100:103], v[88:91]
v_mfma_f32_16x16x32_bf16 v[92:95], a[28:31], a[96:99], v[92:95]
buffer_load_dwordx4 a[184:187], v1, s[4:7], s52 offen offset:1024 sc1
v_mfma_f32_16x16x32_bf16 v[96:99], a[28:31], a[100:103], v[96:99]
v_exp_f32 v197, v197
v_mfma_f32_16x16x32_bf16 v[100:103], a[32:35], a[96:99], v[100:103]
v_mfma_f32_16x16x32_bf16 v[104:107], a[32:35], a[100:103], v[104:107]
s_waitcnt vmcnt(20) lgkmcnt(0)
s_barrier
v_mfma_f32_16x16x32_bf16 v[36:39], a[36:39], a[104:107], v[36:39]
ds_read_b128 a[0:3], v202 offset:0
buffer_load_dwordx4 a[188:191], v9, s[4:7], s52 offen offset:1024 sc1
v_mfma_f32_16x16x32_bf16 v[40:43], a[36:39], a[108:111], v[40:43]
ds_read_b128 a[4:7], v202 offset:1024
v_mfma_f32_16x16x32_bf16 v[44:47], a[40:43], a[104:107], v[44:47]
ds_read_b128 a[8:11], v202 offset:2048
v_mfma_f32_16x16x32_bf16 v[48:51], a[40:43], a[108:111], v[48:51]
ds_read_b128 a[12:15], v202 offset:3072
v_mfma_f32_16x16x32_bf16 v[52:55], a[44:47], a[104:107], v[52:55]
ds_read_b128 a[16:19], v202 offset:4096
v_mfma_f32_16x16x32_bf16 v[56:59], a[44:47], a[108:111], v[56:59]
ds_read_b128 a[20:23], v202 offset:5120
v_mfma_f32_16x16x32_bf16 v[60:63], a[48:51], a[104:107], v[60:63]
ds_read_b128 a[24:27], v202 offset:6144
v_mfma_f32_16x16x32_bf16 v[64:67], a[48:51], a[108:111], v[64:67]
ds_read_b128 a[28:31], v202 offset:7168
v_mfma_f32_16x16x32_bf16 v[68:71], a[52:55], a[104:107], v[68:71]
ds_read_b128 a[32:35], v202 offset:8192
v_mfma_f32_16x16x32_bf16 v[72:75], a[52:55], a[108:111], v[72:75]
s_cmp_eq_u32 s25, 10
s_cselect_b32 s99, 36864, 0
s_add_u32 s60, s60, s99
v_mfma_f32_16x16x32_bf16 v[76:79], a[56:59], a[104:107], v[76:79]
s_add_u32 s61, s61, s99
s_add_u32 m0, s62, 90112
s_add_u32 s60, s60, 16384
v_mfma_f32_16x16x32_bf16 v[80:83], a[56:59], a[108:111], v[80:83]
buffer_load_dwordx4 v1, s[8:11], s60 offen offset:0 sc1 lds
v_mfma_f32_16x16x32_bf16 v[84:87], a[60:63], a[104:107], v[84:87]
v_exp_f32 v198, v198
v_mfma_f32_16x16x32_bf16 v[88:91], a[60:63], a[108:111], v[88:91]
buffer_load_dwordx4 v1, s[8:11], s60 offen offset:1024 sc1 lds
v_mfma_f32_16x16x32_bf16 v[92:95], a[64:67], a[104:107], v[92:95]
v_exp_f32 v199, v199
v_mfma_f32_16x16x32_bf16 v[96:99], a[64:67], a[108:111], v[96:99]
buffer_load_dwordx4 v1, s[8:11], s60 offen offset:2048 sc1 lds
v_fma_f32 v196, v196, v255, v255
v_mfma_f32_16x16x32_bf16 v[100:103], a[68:71], a[104:107], v[100:103]
v_fma_f32 v197, v197, v255, v255
v_fma_f32 v198, v198, v255, v255
v_mfma_f32_16x16x32_bf16 v[104:107], a[68:71], a[108:111], v[104:107]
s_waitcnt lgkmcnt(0)
v_mfma_f32_16x16x32_bf16 v[36:39], a[0:3], a[112:115], v[36:39]
ds_read_b128 a[36:39], v202 offset:9216
buffer_load_dwordx4 v1, s[8:11], s60 offen offset:3072 sc1 lds
v_mfma_f32_16x16x32_bf16 v[40:43], a[0:3], a[116:119], v[40:43]
ds_read_b128 a[40:43], v202 offset:10240
v_fma_f32 v199, v199, v255, v255
v_mfma_f32_16x16x32_bf16 v[44:47], a[4:7], a[112:115], v[44:47]
ds_read_b128 a[44:47], v202 offset:11264
s_add_u32 m0, s63, 106496
v_mfma_f32_16x16x32_bf16 v[48:51], a[4:7], a[116:119], v[48:51]
ds_read_b128 a[48:51], v202 offset:12288
v_mfma_f32_16x16x32_bf16 v[52:55], a[8:11], a[112:115], v[52:55]
ds_read_b128 a[52:55], v202 offset:13312
s_add_u32 s61, s61, 36864
v_mfma_f32_16x16x32_bf16 v[56:59], a[8:11], a[116:119], v[56:59]
ds_read_b128 a[56:59], v202 offset:14336
v_mfma_f32_16x16x32_bf16 v[60:63], a[12:15], a[112:115], v[60:63]
ds_read_b128 a[60:63], v202 offset:15360
buffer_load_dwordx4 v1, s[8:11], s61 offen offset:0 sc1 lds
v_mfma_f32_16x16x32_bf16 v[64:67], a[12:15], a[116:119], v[64:67]
ds_read_b128 a[64:67], v202 offset:16384
v_mfma_f32_16x16x32_bf16 v[68:71], a[16:19], a[112:115], v[68:71]
ds_read_b128 a[68:71], v202 offset:17408
s_add_u32 m0, s62, 110592
v_mfma_f32_16x16x32_bf16 v[72:75], a[16:19], a[116:119], v[72:75]
s_add_u32 s60, s60, 20480
v_rcp_f32 v196, v196
v_mfma_f32_16x16x32_bf16 v[76:79], a[20:23], a[112:115], v[76:79]
v_rcp_f32 v197, v197
v_mfma_f32_16x16x32_bf16 v[80:83], a[20:23], a[116:119], v[80:83]
v_rcp_f32 v198, v198
v_mfma_f32_16x16x32_bf16 v[84:87], a[24:27], a[112:115], v[84:87]
buffer_load_dwordx4 v1, s[8:11], s60 offen offset:0 sc1 lds
v_mfma_f32_16x16x32_bf16 v[88:91], a[24:27], a[116:119], v[88:91]
v_mfma_f32_16x16x32_bf16 v[92:95], a[28:31], a[112:115], v[92:95]
buffer_load_dwordx4 v1, s[8:11], s60 offen offset:1024 sc1 lds
v_mfma_f32_16x16x32_bf16 v[96:99], a[28:31], a[116:119], v[96:99]
v_mfma_f32_16x16x32_bf16 v[100:103], a[32:35], a[112:115], v[100:103]
v_rcp_f32 v199, v199
v_mfma_f32_16x16x32_bf16 v[104:107], a[32:35], a[116:119], v[104:107]
s_waitcnt lgkmcnt(0)
v_mfma_f32_16x16x32_bf16 v[36:39], a[36:39], a[120:123], v[36:39]
ds_read_b128 a[0:3], v202 offset:18432
buffer_load_dwordx4 v1, s[8:11], s60 offen offset:2048 sc1 lds
v_mfma_f32_16x16x32_bf16 v[40:43], a[36:39], a[124:127], v[40:43]
ds_read_b128 a[4:7], v202 offset:19456
v_mfma_f32_16x16x32_bf16 v[44:47], a[40:43], a[120:123], v[44:47]
ds_read_b128 a[8:11], v202 offset:20480
v_mfma_f32_16x16x32_bf16 v[48:51], a[40:43], a[124:127], v[48:51]
ds_read_b128 a[12:15], v202 offset:21504
v_mul_f32 v160, v160, v196
v_mfma_f32_16x16x32_bf16 v[52:55], a[44:47], a[120:123], v[52:55]
ds_read_b128 a[16:19], v202 offset:22528
buffer_load_dwordx4 v1, s[8:11], s60 offen offset:3072 sc1 lds
v_mfma_f32_16x16x32_bf16 v[56:59], a[44:47], a[124:127], v[56:59]
ds_read_b128 a[20:23], v202 offset:23552
v_mul_f32 v161, v161, v197
v_mfma_f32_16x16x32_bf16 v[60:63], a[48:51], a[120:123], v[60:63]
ds_read_b128 a[24:27], v202 offset:24576
v_mfma_f32_16x16x32_bf16 v[64:67], a[48:51], a[124:127], v[64:67]
ds_read_b128 a[28:31], v202 offset:25600
v_mfma_f32_16x16x32_bf16 v[68:71], a[52:55], a[120:123], v[68:71]
ds_read_b128 a[32:35], v202 offset:26624
buffer_load_dwordx4 a[192:195], v1, s[4:7], s52 offen offset:2048 sc1
v_mfma_f32_16x16x32_bf16 v[72:75], a[52:55], a[124:127], v[72:75]
v_mul_f32 v162, v162, v198
v_mfma_f32_16x16x32_bf16 v[76:79], a[56:59], a[120:123], v[76:79]
v_mul_f32 v163, v163, v199
v_mfma_f32_16x16x32_bf16 v[80:83], a[56:59], a[124:127], v[80:83]
v_mfma_f32_16x16x32_bf16 v[84:87], a[60:63], a[120:123], v[84:87]
buffer_load_dwordx4 a[196:199], v9, s[4:7], s52 offen offset:2048 sc1
v_mul_f32 v192, v164, v164
v_mfma_f32_16x16x32_bf16 v[88:91], a[60:63], a[124:127], v[88:91]
v_mfma_f32_16x16x32_bf16 v[92:95], a[64:67], a[120:123], v[92:95]
v_mfma_f32_16x16x32_bf16 v[96:99], a[64:67], a[124:127], v[96:99]
v_mul_f32 v193, v165, v165
v_mfma_f32_16x16x32_bf16 v[100:103], a[68:71], a[120:123], v[100:103]
v_mfma_f32_16x16x32_bf16 v[104:107], a[68:71], a[124:127], v[104:107]
v_mul_f32 v194, v166, v166
s_waitcnt lgkmcnt(0)
v_mfma_f32_16x16x32_bf16 v[36:39], a[0:3], a[128:131], v[36:39]
ds_read_b128 a[36:39], v202 offset:27648
buffer_load_dwordx4 a[200:203], v1, s[4:7], s52 offen offset:3072 sc1
v_mfma_f32_16x16x32_bf16 v[40:43], a[0:3], a[132:135], v[40:43]
ds_read_b128 a[40:43], v202 offset:28672
v_mul_f32 v195, v167, v167
v_mfma_f32_16x16x32_bf16 v[44:47], a[4:7], a[128:131], v[44:47]
ds_read_b128 a[44:47], v202 offset:29696
buffer_load_dwordx4 a[204:207], v9, s[4:7], s52 offen offset:3072 sc1
v_mfma_f32_16x16x32_bf16 v[48:51], a[4:7], a[132:135], v[48:51]
ds_read_b128 a[48:51], v202 offset:30720
v_mfma_f32_16x16x32_bf16 v[52:55], a[8:11], a[128:131], v[52:55]
ds_read_b128 a[52:55], v202 offset:31744
v_fma_f32 v192, v192, v252, v250
v_mfma_f32_16x16x32_bf16 v[56:59], a[8:11], a[132:135], v[56:59]
ds_read_b128 a[56:59], v202 offset:32768
v_mfma_f32_16x16x32_bf16 v[60:63], a[12:15], a[128:131], v[60:63]
ds_read_b128 a[60:63], v202 offset:33792
v_fma_f32 v193, v193, v252, v250
v_mfma_f32_16x16x32_bf16 v[64:67], a[12:15], a[132:135], v[64:67]
ds_read_b128 a[64:67], v202 offset:34816
v_mfma_f32_16x16x32_bf16 v[68:71], a[16:19], a[128:131], v[68:71]
ds_read_b128 a[68:71], v202 offset:35840
v_fma_f32 v194, v194, v252, v250
v_mfma_f32_16x16x32_bf16 v[72:75], a[16:19], a[132:135], v[72:75]
s_cmp_eq_u32 s25, 11
s_cselect_b32 s98, 4096, 0
s_add_u32 s52, s52, s98
v_mfma_f32_16x16x32_bf16 v[76:79], a[20:23], a[128:131], v[76:79]
s_add_u32 s52, s52, 4096
v_mfma_f32_16x16x32_bf16 v[80:83], a[20:23], a[132:135], v[80:83]
v_fma_f32 v195, v195, v252, v250
v_mfma_f32_16x16x32_bf16 v[84:87], a[24:27], a[128:131], v[84:87]
buffer_load_dwordx4 a[208:211], v1, s[4:7], s52 offen offset:0 sc1
v_mfma_f32_16x16x32_bf16 v[88:91], a[24:27], a[132:135], v[88:91]
v_mul_f32 v192, v192, v164
v_mfma_f32_16x16x32_bf16 v[92:95], a[28:31], a[128:131], v[92:95]
buffer_load_dwordx4 a[212:215], v9, s[4:7], s52 offen offset:0 sc1
v_mfma_f32_16x16x32_bf16 v[96:99], a[28:31], a[132:135], v[96:99]
v_mfma_f32_16x16x32_bf16 v[100:103], a[32:35], a[128:131], v[100:103]
v_mul_f32 v193, v193, v165
v_mfma_f32_16x16x32_bf16 v[104:107], a[32:35], a[132:135], v[104:107]
s_waitcnt vmcnt(23) lgkmcnt(0)
s_barrier
v_mfma_f32_16x16x32_bf16 v[36:39], a[36:39], a[136:139], v[36:39]
ds_read_b128 a[0:3], v200 offset:0
buffer_load_dwordx4 a[216:219], v1, s[4:7], s52 offen offset:1024 sc1
v_mfma_f32_16x16x32_bf16 v[40:43], a[36:39], a[140:143], v[40:43]
ds_read_b128 a[4:7], v200 offset:1024
buffer_load_dwordx4 a[220:223], v9, s[4:7], s52 offen offset:1024 sc1
v_mfma_f32_16x16x32_bf16 v[44:47], a[40:43], a[136:139], v[44:47]
ds_read_b128 a[8:11], v200 offset:2048
v_mul_f32 v194, v194, v166
v_mfma_f32_16x16x32_bf16 v[48:51], a[40:43], a[140:143], v[48:51]
ds_read_b128 a[12:15], v200 offset:3072
v_mul_f32 v195, v195, v167
v_mfma_f32_16x16x32_bf16 v[52:55], a[44:47], a[136:139], v[52:55]
ds_read_b128 a[16:19], v200 offset:4096
v_mfma_f32_16x16x32_bf16 v[56:59], a[44:47], a[140:143], v[56:59]
ds_read_b128 a[20:23], v200 offset:5120
v_mfma_f32_16x16x32_bf16 v[60:63], a[48:51], a[136:139], v[60:63]
ds_read_b128 a[24:27], v200 offset:6144
v_mfma_f32_16x16x32_bf16 v[64:67], a[48:51], a[140:143], v[64:67]
ds_read_b128 a[28:31], v200 offset:7168
v_mfma_f32_16x16x32_bf16 v[68:71], a[52:55], a[136:139], v[68:71]
ds_read_b128 a[32:35], v200 offset:8192
v_mfma_f32_16x16x32_bf16 v[72:75], a[52:55], a[140:143], v[72:75]
s_cmp_eq_u32 s25, 11
s_cselect_b32 s99, 36864, 0
s_add_u32 s60, s60, s99
v_mfma_f32_16x16x32_bf16 v[76:79], a[56:59], a[136:139], v[76:79]
s_add_u32 s61, s61, s99
s_add_u32 m0, s62, 126976
v_mfma_f32_16x16x32_bf16 v[80:83], a[56:59], a[140:143], v[80:83]
s_add_u32 s60, s60, 16384
v_exp_f32 v192, v192
v_mfma_f32_16x16x32_bf16 v[84:87], a[60:63], a[136:139], v[84:87]
v_exp_f32 v193, v193
v_mfma_f32_16x16x32_bf16 v[88:91], a[60:63], a[140:143], v[88:91]
buffer_load_dwordx4 v1, s[8:11], s60 offen offset:0 sc1 lds
v_mfma_f32_16x16x32_bf16 v[92:95], a[64:67], a[136:139], v[92:95]
v_exp_f32 v194, v194
v_mfma_f32_16x16x32_bf16 v[96:99], a[64:67], a[140:143], v[96:99]
buffer_load_dwordx4 v1, s[8:11], s60 offen offset:1024 sc1 lds
v_mfma_f32_16x16x32_bf16 v[100:103], a[68:71], a[136:139], v[100:103]
v_mfma_f32_16x16x32_bf16 v[104:107], a[68:71], a[140:143], v[104:107]
s_waitcnt lgkmcnt(0)
v_mfma_f32_16x16x32_bf16 v[36:39], a[0:3], a[144:147], v[36:39]
ds_read_b128 a[36:39], v200 offset:9216
buffer_load_dwordx4 v1, s[8:11], s60 offen offset:2048 sc1 lds
v_mfma_f32_16x16x32_bf16 v[40:43], a[0:3], a[148:151], v[40:43]
ds_read_b128 a[40:43], v200 offset:10240
v_mfma_f32_16x16x32_bf16 v[44:47], a[4:7], a[144:147], v[44:47]
ds_read_b128 a[44:47], v200 offset:11264
buffer_load_dwordx4 v1, s[8:11], s60 offen offset:3072 sc1 lds
v_mfma_f32_16x16x32_bf16 v[48:51], a[4:7], a[148:151], v[48:51]
ds_read_b128 a[48:51], v200 offset:12288
v_mfma_f32_16x16x32_bf16 v[52:55], a[8:11], a[144:147], v[52:55]
ds_read_b128 a[52:55], v200 offset:13312
s_add_u32 m0, s63, 143360
v_mfma_f32_16x16x32_bf16 v[56:59], a[8:11], a[148:151], v[56:59]
ds_read_b128 a[56:59], v200 offset:14336
v_mfma_f32_16x16x32_bf16 v[60:63], a[12:15], a[144:147], v[60:63]
ds_read_b128 a[60:63], v200 offset:15360
s_add_u32 s61, s61, 36864
v_mfma_f32_16x16x32_bf16 v[64:67], a[12:15], a[148:151], v[64:67]
ds_read_b128 a[64:67], v200 offset:16384
v_mfma_f32_16x16x32_bf16 v[68:71], a[16:19], a[144:147], v[68:71]
ds_read_b128 a[68:71], v200 offset:17408
buffer_load_dwordx4 v1, s[8:11], s61 offen offset:0 sc1 lds
v_mfma_f32_16x16x32_bf16 v[72:75], a[16:19], a[148:151], v[72:75]
s_add_u32 m0, s62, 147456
v_exp_f32 v195, v195
v_mfma_f32_16x16x32_bf16 v[76:79], a[20:23], a[144:147], v[76:79]
s_add_u32 s60, s60, 20480
v_fma_f32 v192, v192, v254, v254
v_fma_f32 v193, v193, v254, v254
v_mfma_f32_16x16x32_bf16 v[80:83], a[20:23], a[148:151], v[80:83]
v_fma_f32 v194, v194, v254, v254
v_mfma_f32_16x16x32_bf16 v[84:87], a[24:27], a[144:147], v[84:87]
v_mfma_f32_16x16x32_bf16 v[88:91], a[24:27], a[148:151], v[88:91]
v_fma_f32 v195, v195, v254, v254
v_mfma_f32_16x16x32_bf16 v[92:95], a[28:31], a[144:147], v[92:95]
buffer_load_dwordx4 v1, s[8:11], s60 offen offset:0 sc1 lds
v_mfma_f32_16x16x32_bf16 v[96:99], a[28:31], a[148:151], v[96:99]
v_rcp_f32 v192, v192
v_mfma_f32_16x16x32_bf16 v[100:103], a[32:35], a[144:147], v[100:103]
v_mfma_f32_16x16x32_bf16 v[104:107], a[32:35], a[148:151], v[104:107]
s_waitcnt vmcnt(27) lgkmcnt(0)
v_mfma_f32_16x16x32_bf16 v[36:39], a[36:39], a[152:155], v[36:39]
ds_read_b128 a[0:3], v200 offset:18432
buffer_load_dwordx4 v1, s[8:11], s60 offen offset:1024 sc1 lds
v_mfma_f32_16x16x32_bf16 v[40:43], a[36:39], a[156:159], v[40:43]
ds_read_b128 a[4:7], v200 offset:19456
v_mfma_f32_16x16x32_bf16 v[44:47], a[40:43], a[152:155], v[44:47]
ds_read_b128 a[8:11], v200 offset:20480
v_mfma_f32_16x16x32_bf16 v[48:51], a[40:43], a[156:159], v[48:51]
ds_read_b128 a[12:15], v200 offset:21504
v_mfma_f32_16x16x32_bf16 v[52:55], a[44:47], a[152:155], v[52:55]
ds_read_b128 a[16:19], v200 offset:22528
buffer_load_dwordx4 v1, s[8:11], s60 offen offset:2048 sc1 lds
v_mfma_f32_16x16x32_bf16 v[56:59], a[44:47], a[156:159], v[56:59]
ds_read_b128 a[20:23], v200 offset:23552
v_mfma_f32_16x16x32_bf16 v[60:63], a[48:51], a[152:155], v[60:63]
ds_read_b128 a[24:27], v200 offset:24576
v_mfma_f32_16x16x32_bf16 v[64:67], a[48:51], a[156:159], v[64:67]
ds_read_b128 a[28:31], v200 offset:25600
v_mfma_f32_16x16x32_bf16 v[68:71], a[52:55], a[152:155], v[68:71]
ds_read_b128 a[32:35], v200 offset:26624
buffer_load_dwordx4 v1, s[8:11], s60 offen offset:3072 sc1 lds
v_mfma_f32_16x16x32_bf16 v[72:75], a[52:55], a[156:159], v[72:75]
v_rcp_f32 v193, v193
v_mfma_f32_16x16x32_bf16 v[76:79], a[56:59], a[152:155], v[76:79]
v_rcp_f32 v194, v194
v_mfma_f32_16x16x32_bf16 v[80:83], a[56:59], a[156:159], v[80:83]
v_rcp_f32 v195, v195
v_mfma_f32_16x16x32_bf16 v[84:87], a[60:63], a[152:155], v[84:87]
buffer_load_dwordx4 a[224:227], v1, s[4:7], s52 offen offset:2048 sc1
v_mfma_f32_16x16x32_bf16 v[88:91], a[60:63], a[156:159], v[88:91]
v_mfma_f32_16x16x32_bf16 v[92:95], a[64:67], a[152:155], v[92:95]
v_mfma_f32_16x16x32_bf16 v[96:99], a[64:67], a[156:159], v[96:99]
v_mfma_f32_16x16x32_bf16 v[100:103], a[68:71], a[152:155], v[100:103]
v_mul_f32 v164, v164, v192
v_mfma_f32_16x16x32_bf16 v[104:107], a[68:71], a[156:159], v[104:107]
s_waitcnt lgkmcnt(0)
v_mfma_f32_16x16x32_bf16 v[36:39], a[0:3], a[160:163], v[36:39]
ds_read_b128 a[36:39], v200 offset:27648
buffer_load_dwordx4 a[228:231], v9, s[4:7], s52 offen offset:2048 sc1
v_mfma_f32_16x16x32_bf16 v[40:43], a[0:3], a[164:167], v[40:43]
ds_read_b128 a[40:43], v200 offset:28672
v_mul_f32 v165, v165, v193
v_mfma_f32_16x16x32_bf16 v[44:47], a[4:7], a[160:163], v[44:47]
ds_read_b128 a[44:47], v200 offset:29696
buffer_load_dwordx4 a[232:235], v1, s[4:7], s52 offen offset:3072 sc1
v_mfma_f32_16x16x32_bf16 v[48:51], a[4:7], a[164:167], v[48:51]
ds_read_b128 a[48:51], v200 offset:30720
v_mul_f32 v166, v166, v194
v_mfma_f32_16x16x32_bf16 v[52:55], a[8:11], a[160:163], v[52:55]
ds_read_b128 a[52:55], v200 offset:31744
buffer_load_dwordx4 a[236:239], v9, s[4:7], s52 offen offset:3072 sc1
v_mfma_f32_16x16x32_bf16 v[56:59], a[8:11], a[164:167], v[56:59]
ds_read_b128 a[56:59], v200 offset:32768
v_mul_f32 v167, v167, v195
v_mfma_f32_16x16x32_bf16 v[60:63], a[12:15], a[160:163], v[60:63]
ds_read_b128 a[60:63], v200 offset:33792
v_mfma_f32_16x16x32_bf16 v[64:67], a[12:15], a[164:167], v[64:67]
ds_read_b128 a[64:67], v200 offset:34816
v_mul_f32 v196, v168, v168
v_mfma_f32_16x16x32_bf16 v[68:71], a[16:19], a[160:163], v[68:71]
ds_read_b128 a[68:71], v200 offset:35840
v_mfma_f32_16x16x32_bf16 v[72:75], a[16:19], a[164:167], v[72:75]
s_cmp_eq_u32 s25, 12
s_cselect_b32 s98, 4096, 0
v_mfma_f32_16x16x32_bf16 v[76:79], a[20:23], a[160:163], v[76:79]
s_add_u32 s52, s52, s98
v_mul_f32 v197, v169, v169
v_mfma_f32_16x16x32_bf16 v[80:83], a[20:23], a[164:167], v[80:83]
s_add_u32 s52, s52, 4096
v_mfma_f32_16x16x32_bf16 v[84:87], a[24:27], a[160:163], v[84:87]
v_mul_f32 v198, v170, v170
v_mfma_f32_16x16x32_bf16 v[88:91], a[24:27], a[164:167], v[88:91]
v_mfma_f32_16x16x32_bf16 v[92:95], a[28:31], a[160:163], v[92:95]
buffer_load_dwordx4 a[240:243], v1, s[4:7], s52 offen offset:0 sc1
v_mul_f32 v199, v171, v171
v_mfma_f32_16x16x32_bf16 v[96:99], a[28:31], a[164:167], v[96:99]
v_mfma_f32_16x16x32_bf16 v[100:103], a[32:35], a[160:163], v[100:103]
v_mfma_f32_16x16x32_bf16 v[104:107], a[32:35], a[164:167], v[104:107]
s_waitcnt vmcnt(22) lgkmcnt(0)
s_barrier
v_mfma_f32_16x16x32_bf16 v[36:39], a[36:39], a[168:171], v[36:39]
ds_read_b128 a[0:3], v201 offset:0
buffer_load_dwordx4 a[244:247], v9, s[4:7], s52 offen offset:0 sc1
v_mfma_f32_16x16x32_bf16 v[40:43], a[36:39], a[172:175], v[40:43]
ds_read_b128 a[4:7], v201 offset:1024
buffer_load_dwordx4 a[248:251], v1, s[4:7], s52 offen offset:1024 sc1
v_mfma_f32_16x16x32_bf16 v[44:47], a[40:43], a[168:171], v[44:47]
ds_read_b128 a[8:11], v201 offset:2048
v_fma_f32 v196, v196, v253, v251
v_mfma_f32_16x16x32_bf16 v[48:51], a[40:43], a[172:175], v[48:51]
ds_read_b128 a[12:15], v201 offset:3072
buffer_load_dwordx4 a[252:255], v9, s[4:7], s52 offen offset:1024 sc1
v_mfma_f32_16x16x32_bf16 v[52:55], a[44:47], a[168:171], v[52:55]
ds_read_b128 a[16:19], v201 offset:4096
v_fma_f32 v197, v197, v253, v251
v_mfma_f32_16x16x32_bf16 v[56:59], a[44:47], a[172:175], v[56:59]
ds_read_b128 a[20:23], v201 offset:5120
v_fma_f32 v198, v198, v253, v251
v_mfma_f32_16x16x32_bf16 v[60:63], a[48:51], a[168:171], v[60:63]
ds_read_b128 a[24:27], v201 offset:6144
v_fma_f32 v199, v199, v253, v251
v_mfma_f32_16x16x32_bf16 v[64:67], a[48:51], a[172:175], v[64:67]
ds_read_b128 a[28:31], v201 offset:7168
v_mfma_f32_16x16x32_bf16 v[68:71], a[52:55], a[168:171], v[68:71]
ds_read_b128 a[32:35], v201 offset:8192
v_mul_f32 v196, v196, v168
v_mfma_f32_16x16x32_bf16 v[72:75], a[52:55], a[172:175], v[72:75]
s_cmp_eq_u32 s25, 12
s_cselect_b32 s99, 36864, 0
s_add_u32 s60, s60, s99
v_mfma_f32_16x16x32_bf16 v[76:79], a[56:59], a[168:171], v[76:79]
s_add_u32 s61, s61, s99
v_mul_f32 v197, v197, v169
v_mfma_f32_16x16x32_bf16 v[80:83], a[56:59], a[172:175], v[80:83]
s_add_u32 m0, s62, 53248
v_mfma_f32_16x16x32_bf16 v[84:87], a[60:63], a[168:171], v[84:87]
s_add_u32 s60, s60, 16384
v_mfma_f32_16x16x32_bf16 v[88:91], a[60:63], a[172:175], v[88:91]
v_mul_f32 v198, v198, v170
v_mfma_f32_16x16x32_bf16 v[92:95], a[64:67], a[168:171], v[92:95]
v_mfma_f32_16x16x32_bf16 v[96:99], a[64:67], a[172:175], v[96:99]
buffer_load_dwordx4 v1, s[8:11], s60 offen offset:0 sc1 lds
v_mul_f32 v199, v199, v171
v_mfma_f32_16x16x32_bf16 v[100:103], a[68:71], a[168:171], v[100:103]
v_mfma_f32_16x16x32_bf16 v[104:107], a[68:71], a[172:175], v[104:107]
s_waitcnt lgkmcnt(0)
v_mfma_f32_16x16x32_bf16 v[36:39], a[0:3], a[176:179], v[36:39]
ds_read_b128 a[36:39], v201 offset:9216
buffer_load_dwordx4 v1, s[8:11], s60 offen offset:1024 sc1 lds
v_mfma_f32_16x16x32_bf16 v[40:43], a[0:3], a[180:183], v[40:43]
ds_read_b128 a[40:43], v201 offset:10240
s_mov_b32 s37, L_c4+18432-L_pc
v_mfma_f32_16x16x32_bf16 v[44:47], a[4:7], a[176:179], v[44:47]
ds_read_b128 a[44:47], v201 offset:11264
buffer_load_dwordx4 v1, s[8:11], s60 offen offset:2048 sc1 lds
v_mfma_f32_16x16x32_bf16 v[48:51], a[4:7], a[180:183], v[48:51]
ds_read_b128 a[48:51], v201 offset:12288
v_mfma_f32_16x16x32_bf16 v[52:55], a[8:11], a[176:179], v[52:55]
ds_read_b128 a[52:55], v201 offset:13312
buffer_load_dword v15, v14, s[88:91], s37 offen
v_mfma_f32_16x16x32_bf16 v[56:59], a[8:11], a[180:183], v[56:59]
ds_read_b128 a[56:59], v201 offset:14336
buffer_load_dwordx4 v1, s[8:11], s60 offen offset:3072 sc1 lds
v_mfma_f32_16x16x32_bf16 v[60:63], a[12:15], a[176:179], v[60:63]
ds_read_b128 a[60:63], v201 offset:15360
v_mfma_f32_16x16x32_bf16 v[64:67], a[12:15], a[180:183], v[64:67]
ds_read_b128 a[64:67], v201 offset:16384
v_mfma_f32_16x16x32_bf16 v[68:71], a[16:19], a[176:179], v[68:71]
ds_read_b128 a[68:71], v201 offset:17408
s_add_u32 m0, s63, 69632
v_mfma_f32_16x16x32_bf16 v[72:75], a[16:19], a[180:183], v[72:75]
s_add_u32 s61, s61, 36864
v_exp_f32 v196, v196
v_mfma_f32_16x16x32_bf16 v[76:79], a[20:23], a[176:179], v[76:79]
v_exp_f32 v197, v197
v_mfma_f32_16x16x32_bf16 v[80:83], a[20:23], a[180:183], v[80:83]
v_exp_f32 v198, v198
v_mfma_f32_16x16x32_bf16 v[84:87], a[24:27], a[176:179], v[84:87]
v_mfma_f32_16x16x32_bf16 v[88:91], a[24:27], a[180:183], v[88:91]
v_mfma_f32_16x16x32_bf16 v[92:95], a[28:31], a[176:179], v[92:95]
buffer_load_dwordx4 v1, s[8:11], s61 offen offset:0 sc1 lds
v_mfma_f32_16x16x32_bf16 v[96:99], a[28:31], a[180:183], v[96:99]
v_exp_f32 v199, v199
v_mfma_f32_16x16x32_bf16 v[100:103], a[32:35], a[176:179], v[100:103]
v_mfma_f32_16x16x32_bf16 v[104:107], a[32:35], a[180:183], v[104:107]
s_waitcnt vmcnt(27) lgkmcnt(0)
v_mfma_f32_16x16x32_bf16 v[36:39], a[36:39], a[184:187], v[36:39]
ds_read_b128 a[0:3], v201 offset:18432
s_add_u32 m0, s62, 73728
v_mfma_f32_16x16x32_bf16 v[40:43], a[36:39], a[188:191], v[40:43]
ds_read_b128 a[4:7], v201 offset:19456
v_fma_f32 v196, v196, v255, v255
v_mfma_f32_16x16x32_bf16 v[44:47], a[40:43], a[184:187], v[44:47]
ds_read_b128 a[8:11], v201 offset:20480
s_add_u32 s60, s60, 20480
v_mfma_f32_16x16x32_bf16 v[48:51], a[40:43], a[188:191], v[48:51]
ds_read_b128 a[12:15], v201 offset:21504
v_fma_f32 v197, v197, v255, v255
v_mfma_f32_16x16x32_bf16 v[52:55], a[44:47], a[184:187], v[52:55]
ds_read_b128 a[16:19], v201 offset:22528
v_mfma_f32_16x16x32_bf16 v[56:59], a[44:47], a[188:191], v[56:59]
ds_read_b128 a[20:23], v201 offset:23552
buffer_load_dwordx4 v1, s[8:11], s60 offen offset:0 sc1 lds
v_mfma_f32_16x16x32_bf16 v[60:63], a[48:51], a[184:187], v[60:63]
ds_read_b128 a[24:27], v201 offset:24576
v_fma_f32 v198, v198, v255, v255
v_mfma_f32_16x16x32_bf16 v[64:67], a[48:51], a[188:191], v[64:67]
ds_read_b128 a[28:31], v201 offset:25600
v_fma_f32 v199, v199, v255, v255
v_mfma_f32_16x16x32_bf16 v[68:71], a[52:55], a[184:187], v[68:71]
ds_read_b128 a[32:35], v201 offset:26624
buffer_load_dwordx4 v1, s[8:11], s60 offen offset:1024 sc1 lds
v_mfma_f32_16x16x32_bf16 v[72:75], a[52:55], a[188:191], v[72:75]
v_mfma_f32_16x16x32_bf16 v[76:79], a[56:59], a[184:187], v[76:79]
v_rcp_f32 v196, v196
v_mfma_f32_16x16x32_bf16 v[80:83], a[56:59], a[188:191], v[80:83]
buffer_load_dwordx4 v1, s[8:11], s60 offen offset:2048 sc1 lds
v_mfma_f32_16x16x32_bf16 v[84:87], a[60:63], a[184:187], v[84:87]
v_mfma_f32_16x16x32_bf16 v[88:91], a[60:63], a[188:191], v[88:91]
v_mfma_f32_16x16x32_bf16 v[92:95], a[64:67], a[184:187], v[92:95]
buffer_load_dwordx4 v1, s[8:11], s60 offen offset:3072 sc1 lds
v_mfma_f32_16x16x32_bf16 v[96:99], a[64:67], a[188:191], v[96:99]
v_rcp_f32 v197, v197
v_mfma_f32_16x16x32_bf16 v[100:103], a[68:71], a[184:187], v[100:103]
v_mfma_f32_16x16x32_bf16 v[104:107], a[68:71], a[188:191], v[104:107]
s_waitcnt lgkmcnt(0)
v_mfma_f32_16x16x32_bf16 v[36:39], a[0:3], a[192:195], v[36:39]
ds_read_b128 a[36:39], v201 offset:27648
buffer_load_dwordx4 a[80:83], v1, s[4:7], s52 offen offset:2048 sc1
v_mfma_f32_16x16x32_bf16 v[40:43], a[0:3], a[196:199], v[40:43]
ds_read_b128 a[40:43], v201 offset:28672
v_mfma_f32_16x16x32_bf16 v[44:47], a[4:7], a[192:195], v[44:47]
ds_read_b128 a[44:47], v201 offset:29696
v_mfma_f32_16x16x32_bf16 v[48:51], a[4:7], a[196:199], v[48:51]
ds_read_b128 a[48:51], v201 offset:30720
v_mfma_f32_16x16x32_bf16 v[52:55], a[8:11], a[192:195], v[52:55]
ds_read_b128 a[52:55], v201 offset:31744
buffer_load_dwordx4 a[84:87], v9, s[4:7], s52 offen offset:2048 sc1
v_mfma_f32_16x16x32_bf16 v[56:59], a[8:11], a[196:199], v[56:59]
ds_read_b128 a[56:59], v201 offset:32768
v_mfma_f32_16x16x32_bf16 v[60:63], a[12:15], a[192:195], v[60:63]
ds_read_b128 a[60:63], v201 offset:33792
v_mfma_f32_16x16x32_bf16 v[64:67], a[12:15], a[196:199], v[64:67]
ds_read_b128 a[64:67], v201 offset:34816
v_mfma_f32_16x16x32_bf16 v[68:71], a[16:19], a[192:195], v[68:71]
ds_read_b128 a[68:71], v201 offset:35840
buffer_load_dwordx4 a[88:91], v1, s[4:7], s52 offen offset:3072 sc1
v_mfma_f32_16x16x32_bf16 v[72:75], a[16:19], a[196:199], v[72:75]
v_rcp_f32 v198, v198
v_mfma_f32_16x16x32_bf16 v[76:79], a[20:23], a[192:195], v[76:79]
v_rcp_f32 v199, v199
v_mfma_f32_16x16x32_bf16 v[80:83], a[20:23], a[196:199], v[80:83]
v_mul_f32 v168, v168, v196
v_mfma_f32_16x16x32_bf16 v[84:87], a[24:27], a[192:195], v[84:87]
buffer_load_dwordx4 a[92:95], v9, s[4:7], s52 offen offset:3072 sc1
v_mfma_f32_16x16x32_bf16 v[88:91], a[24:27], a[196:199], v[88:91]
v_mul_f32 v169, v169, v197
v_mfma_f32_16x16x32_bf16 v[92:95], a[28:31], a[192:195], v[92:95]
v_mfma_f32_16x16x32_bf16 v[96:99], a[28:31], a[196:199], v[96:99]
v_mul_f32 v170, v170, v198
v_mfma_f32_16x16x32_bf16 v[100:103], a[32:35], a[192:195], v[100:103]
v_mfma_f32_16x16x32_bf16 v[104:107], a[32:35], a[196:199], v[104:107]
s_waitcnt vmcnt(22) lgkmcnt(0)
s_barrier
v_mfma_f32_16x16x32_bf16 v[36:39], a[36:39], a[200:203], v[36:39]
ds_read_b128 a[0:3], v202 offset:0
v_mul_f32 v171, v171, v199
v_mfma_f32_16x16x32_bf16 v[40:43], a[36:39], a[204:207], v[40:43]
ds_read_b128 a[4:7], v202 offset:1024
v_mfma_f32_16x16x32_bf16 v[44:47], a[40:43], a[200:203], v[44:47]
ds_read_b128 a[8:11], v202 offset:2048
v_mul_f32 v192, v172, v172
v_mfma_f32_16x16x32_bf16 v[48:51], a[40:43], a[204:207], v[48:51]
ds_read_b128 a[12:15], v202 offset:3072
v_mfma_f32_16x16x32_bf16 v[52:55], a[44:47], a[200:203], v[52:55]
ds_read_b128 a[16:19], v202 offset:4096
v_mul_f32 v193, v173, v173
v_mfma_f32_16x16x32_bf16 v[56:59], a[44:47], a[204:207], v[56:59]
ds_read_b128 a[20:23], v202 offset:5120
v_mfma_f32_16x16x32_bf16 v[60:63], a[48:51], a[200:203], v[60:63]
ds_read_b128 a[24:27], v202 offset:6144
v_mfma_f32_16x16x32_bf16 v[64:67], a[48:51], a[204:207], v[64:67]
ds_read_b128 a[28:31], v202 offset:7168
v_mul_f32 v194, v174, v174
v_mfma_f32_16x16x32_bf16 v[68:71], a[52:55], a[200:203], v[68:71]
ds_read_b128 a[32:35], v202 offset:8192
v_mfma_f32_16x16x32_bf16 v[72:75], a[52:55], a[204:207], v[72:75]
s_cmp_eq_u32 s25, 13
s_cselect_b32 s99, 36864, 0
s_add_u32 s60, s60, s99
v_mfma_f32_16x16x32_bf16 v[76:79], a[56:59], a[200:203], v[76:79]
s_add_u32 s61, s61, s99
s_add_u32 m0, s62, 90112
s_add_u32 s60, s60, 16384
v_mfma_f32_16x16x32_bf16 v[80:83], a[56:59], a[204:207], v[80:83]
buffer_load_dwordx4 v1, s[8:11], s60 offen offset:0 sc1 lds
v_mul_f32 v195, v175, v175
v_mfma_f32_16x16x32_bf16 v[84:87], a[60:63], a[200:203], v[84:87]
buffer_load_dwordx4 v1, s[8:11], s60 offen offset:1024 sc1 lds
v_fma_f32 v192, v192, v252, v250
v_mfma_f32_16x16x32_bf16 v[88:91], a[60:63], a[204:207], v[88:91]
buffer_load_dwordx4 v1, s[8:11], s60 offen offset:2048 sc1 lds
v_mfma_f32_16x16x32_bf16 v[92:95], a[64:67], a[200:203], v[92:95]
v_fma_f32 v193, v193, v252, v250
v_mfma_f32_16x16x32_bf16 v[96:99], a[64:67], a[204:207], v[96:99]
buffer_load_dwordx4 v1, s[8:11], s60 offen offset:3072 sc1 lds
v_mfma_f32_16x16x32_bf16 v[100:103], a[68:71], a[200:203], v[100:103]
v_fma_f32 v194, v194, v252, v250
v_mfma_f32_16x16x32_bf16 v[104:107], a[68:71], a[204:207], v[104:107]
s_waitcnt lgkmcnt(0)
v_mfma_f32_16x16x32_bf16 v[36:39], a[0:3], a[208:211], v[36:39]
ds_read_b128 a[36:39], v202 offset:9216
s_add_u32 m0, s63, 106496
v_mfma_f32_16x16x32_bf16 v[40:43], a[0:3], a[212:215], v[40:43]
ds_read_b128 a[40:43], v202 offset:10240
v_fma_f32 v195, v195, v252, v250
v_mfma_f32_16x16x32_bf16 v[44:47], a[4:7], a[208:211], v[44:47]
ds_read_b128 a[44:47], v202 offset:11264
s_add_u32 s61, s61, 36864
v_mfma_f32_16x16x32_bf16 v[48:51], a[4:7], a[212:215], v[48:51]
ds_read_b128 a[48:51], v202 offset:12288
v_mul_f32 v192, v192, v172
v_mfma_f32_16x16x32_bf16 v[52:55], a[8:11], a[208:211], v[52:55]
ds_read_b128 a[52:55], v202 offset:13312
buffer_load_dwordx4 v1, s[8:11], s61 offen offset:0 sc1 lds
v_mfma_f32_16x16x32_bf16 v[56:59], a[8:11], a[212:215], v[56:59]
ds_read_b128 a[56:59], v202 offset:14336
v_mul_f32 v193, v193, v173
v_mfma_f32_16x16x32_bf16 v[60:63], a[12:15], a[208:211], v[60:63]
ds_read_b128 a[60:63], v202 offset:15360
s_add_u32 m0, s62, 110592
v_mfma_f32_16x16x32_bf16 v[64:67], a[12:15], a[212:215], v[64:67]
ds_read_b128 a[64:67], v202 offset:16384
v_mfma_f32_16x16x32_bf16 v[68:71], a[16:19], a[208:211], v[68:71]
ds_read_b128 a[68:71], v202 offset:17408
s_add_u32 s60, s60, 20480
v_mfma_f32_16x16x32_bf16 v[72:75], a[16:19], a[212:215], v[72:75]
v_mul_f32 v194, v194, v174
v_mfma_f32_16x16x32_bf16 v[76:79], a[20:23], a[208:211], v[76:79]
buffer_load_dwordx4 v1, s[8:11], s60 offen offset:0 sc1 lds
v_mul_f32 v195, v195, v175
v_mfma_f32_16x16x32_bf16 v[80:83], a[20:23], a[212:215], v[80:83]
v_mfma_f32_16x16x32_bf16 v[84:87], a[24:27], a[208:211], v[84:87]
buffer_load_dwordx4 v1, s[8:11], s60 offen offset:1024 sc1 lds
v_mfma_f32_16x16x32_bf16 v[88:91], a[24:27], a[212:215], v[88:91]
v_exp_f32 v192, v192
v_mfma_f32_16x16x32_bf16 v[92:95], a[28:31], a[208:211], v[92:95]
buffer_load_dwordx4 v1, s[8:11], s60 offen offset:2048 sc1 lds
v_mfma_f32_16x16x32_bf16 v[96:99], a[28:31], a[212:215], v[96:99]
v_mfma_f32_16x16x32_bf16 v[100:103], a[32:35], a[208:211], v[100:103]
v_mfma_f32_16x16x32_bf16 v[104:107], a[32:35], a[212:215], v[104:107]
s_waitcnt vmcnt(26) lgkmcnt(0)
v_mfma_f32_16x16x32_bf16 v[36:39], a[36:39], a[216:219], v[36:39]
ds_read_b128 a[0:3], v202 offset:18432
buffer_load_dwordx4 v1, s[8:11], s60 offen offset:3072 sc1 lds
v_mfma_f32_16x16x32_bf16 v[40:43], a[36:39], a[220:223], v[40:43]
ds_read_b128 a[4:7], v202 offset:19456
v_mfma_f32_16x16x32_bf16 v[44:47], a[40:43], a[216:219], v[44:47]
ds_read_b128 a[8:11], v202 offset:20480
v_mfma_f32_16x16x32_bf16 v[48:51], a[40:43], a[220:223], v[48:51]
ds_read_b128 a[12:15], v202 offset:21504
v_mfma_f32_16x16x32_bf16 v[52:55], a[44:47], a[216:219], v[52:55]
ds_read_b128 a[16:19], v202 offset:22528
v_mfma_f32_16x16x32_bf16 v[56:59], a[44:47], a[220:223], v[56:59]
ds_read_b128 a[20:23], v202 offset:23552
v_mfma_f32_16x16x32_bf16 v[60:63], a[48:51], a[216:219], v[60:63]
ds_read_b128 a[24:27], v202 offset:24576
v_mfma_f32_16x16x32_bf16 v[64:67], a[48:51], a[220:223], v[64:67]
ds_read_b128 a[28:31], v202 offset:25600
v_mfma_f32_16x16x32_bf16 v[68:71], a[52:55], a[216:219], v[68:71]
ds_read_b128 a[32:35], v202 offset:26624
v_mfma_f32_16x16x32_bf16 v[72:75], a[52:55], a[220:223], v[72:75]
s_cmp_eq_u32 s25, 13
s_cselect_b32 s98, 4096, 0
s_add_u32 s52, s52, s98
v_mfma_f32_16x16x32_bf16 v[76:79], a[56:59], a[216:219], v[76:79]
s_add_u32 s52, s52, 4096
v_exp_f32 v193, v193
v_mfma_f32_16x16x32_bf16 v[80:83], a[56:59], a[220:223], v[80:83]
buffer_load_dwordx4 a[96:99], v1, s[4:7], s52 offen offset:0 sc1
v_mfma_f32_16x16x32_bf16 v[84:87], a[60:63], a[216:219], v[84:87]
buffer_load_dwordx4 a[100:103], v9, s[4:7], s52 offen offset:0 sc1
v_mfma_f32_16x16x32_bf16 v[88:91], a[60:63], a[220:223], v[88:91]
v_exp_f32 v194, v194
v_mfma_f32_16x16x32_bf16 v[92:95], a[64:67], a[216:219], v[92:95]
buffer_load_dwordx4 a[104:107], v1, s[4:7], s52 offen offset:1024 sc1
v_mfma_f32_16x16x32_bf16 v[96:99], a[64:67], a[220:223], v[96:99]
v_exp_f32 v195, v195
v_mfma_f32_16x16x32_bf16 v[100:103], a[68:71], a[216:219], v[100:103]
v_fma_f32 v192, v192, v254, v254
v_fma_f32 v193, v193, v254, v254
v_mfma_f32_16x16x32_bf16 v[104:107], a[68:71], a[220:223], v[104:107]
s_waitcnt lgkmcnt(0)
v_mfma_f32_16x16x32_bf16 v[36:39], a[0:3], a[224:227], v[36:39]
ds_read_b128 a[36:39], v202 offset:27648
buffer_load_dwordx4 a[108:111], v9, s[4:7], s52 offen offset:1024 sc1
v_mfma_f32_16x16x32_bf16 v[40:43], a[0:3], a[228:231], v[40:43]
ds_read_b128 a[40:43], v202 offset:28672
v_fma_f32 v194, v194, v254, v254
v_mfma_f32_16x16x32_bf16 v[44:47], a[4:7], a[224:227], v[44:47]
ds_read_b128 a[44:47], v202 offset:29696
v_fma_f32 v195, v195, v254, v254
v_mfma_f32_16x16x32_bf16 v[48:51], a[4:7], a[228:231], v[48:51]
ds_read_b128 a[48:51], v202 offset:30720
v_mfma_f32_16x16x32_bf16 v[52:55], a[8:11], a[224:227], v[52:55]
ds_read_b128 a[52:55], v202 offset:31744
buffer_load_dwordx4 a[112:115], v1, s[4:7], s52 offen offset:2048 sc1
v_mfma_f32_16x16x32_bf16 v[56:59], a[8:11], a[228:231], v[56:59]
ds_read_b128 a[56:59], v202 offset:32768
v_mfma_f32_16x16x32_bf16 v[60:63], a[12:15], a[224:227], v[60:63]
ds_read_b128 a[60:63], v202 offset:33792
v_mfma_f32_16x16x32_bf16 v[64:67], a[12:15], a[228:231], v[64:67]
ds_read_b128 a[64:67], v202 offset:34816
v_mfma_f32_16x16x32_bf16 v[68:71], a[16:19], a[224:227], v[68:71]
ds_read_b128 a[68:71], v202 offset:35840
buffer_load_dwordx4 a[116:119], v9, s[4:7], s52 offen offset:2048 sc1
v_mfma_f32_16x16x32_bf16 v[72:75], a[16:19], a[228:231], v[72:75]
v_rcp_f32 v192, v192
v_mfma_f32_16x16x32_bf16 v[76:79], a[20:23], a[224:227], v[76:79]
v_rcp_f32 v193, v193
v_mfma_f32_16x16x32_bf16 v[80:83], a[20:23], a[228:231], v[80:83]
v_mfma_f32_16x16x32_bf16 v[84:87], a[24:27], a[224:227], v[84:87]
buffer_load_dwordx4 a[120:123], v1, s[4:7], s52 offen offset:3072 sc1
v_mfma_f32_16x16x32_bf16 v[88:91], a[24:27], a[228:231], v[88:91]
v_mfma_f32_16x16x32_bf16 v[92:95], a[28:31], a[224:227], v[92:95]
v_rcp_f32 v194, v194
v_mfma_f32_16x16x32_bf16 v[96:99], a[28:31], a[228:231], v[96:99]
v_mfma_f32_16x16x32_bf16 v[100:103], a[32:35], a[224:227], v[100:103]
v_mfma_f32_16x16x32_bf16 v[104:107], a[32:35], a[228:231], v[104:107]
s_waitcnt vmcnt(20) lgkmcnt(0)
s_barrier
v_mfma_f32_16x16x32_bf16 v[36:39], a[36:39], a[232:235], v[36:39]
ds_read_b128 a[0:3], v200 offset:0
buffer_load_dwordx4 a[124:127], v9, s[4:7], s52 offen offset:3072 sc1
v_mfma_f32_16x16x32_bf16 v[40:43], a[36:39], a[236:239], v[40:43]
ds_read_b128 a[4:7], v200 offset:1024
v_mfma_f32_16x16x32_bf16 v[44:47], a[40:43], a[232:235], v[44:47]
ds_read_b128 a[8:11], v200 offset:2048
v_mfma_f32_16x16x32_bf16 v[48:51], a[40:43], a[236:239], v[48:51]
ds_read_b128 a[12:15], v200 offset:3072
v_mfma_f32_16x16x32_bf16 v[52:55], a[44:47], a[232:235], v[52:55]
ds_read_b128 a[16:19], v200 offset:4096
v_mfma_f32_16x16x32_bf16 v[56:59], a[44:47], a[236:239], v[56:59]
ds_read_b128 a[20:23], v200 offset:5120
v_mfma_f32_16x16x32_bf16 v[60:63], a[48:51], a[232:235], v[60:63]
ds_read_b128 a[24:27], v200 offset:6144
v_mfma_f32_16x16x32_bf16 v[64:67], a[48:51], a[236:239], v[64:67]
ds_read_b128 a[28:31], v200 offset:7168
v_mfma_f32_16x16x32_bf16 v[68:71], a[52:55], a[232:235], v[68:71]
ds_read_b128 a[32:35], v200 offset:8192
v_mfma_f32_16x16x32_bf16 v[72:75], a[52:55], a[236:239], v[72:75]
s_cmp_eq_u32 s25, 14
s_cselect_b32 s99, 36864, 0
s_add_u32 s60, s60, s99
v_mfma_f32_16x16x32_bf16 v[76:79], a[56:59], a[232:235], v[76:79]
s_add_u32 s61, s61, s99
s_add_u32 m0, s62, 126976
s_add_u32 s60, s60, 16384
v_mfma_f32_16x16x32_bf16 v[80:83], a[56:59], a[236:239], v[80:83]
buffer_load_dwordx4 v1, s[8:11], s60 offen offset:0 sc1 lds
v_mfma_f32_16x16x32_bf16 v[84:87], a[60:63], a[232:235], v[84:87]
v_rcp_f32 v195, v195
v_mfma_f32_16x16x32_bf16 v[88:91], a[60:63], a[236:239], v[88:91]
buffer_load_dwordx4 v1, s[8:11], s60 offen offset:1024 sc1 lds
v_mul_f32 v172, v172, v192
v_mfma_f32_16x16x32_bf16 v[92:95], a[64:67], a[232:235], v[92:95]
v_mul_f32 v173, v173, v193
v_mul_f32 v174, v174, v194
v_mfma_f32_16x16x32_bf16 v[96:99], a[64:67], a[236:239], v[96:99]
buffer_load_dwordx4 v1, s[8:11], s60 offen offset:2048 sc1 lds
v_mul_f32 v175, v175, v195
v_mfma_f32_16x16x32_bf16 v[100:103], a[68:71], a[232:235], v[100:103]
v_mul_f32 v196, v176, v176
v_mfma_f32_16x16x32_bf16 v[104:107], a[68:71], a[236:239], v[104:107]
v_mul_f32 v197, v177, v177
s_waitcnt lgkmcnt(0)
v_mfma_f32_16x16x32_bf16 v[36:39], a[0:3], a[240:243], v[36:39]
ds_read_b128 a[36:39], v200 offset:9216
buffer_load_dwordx4 v1, s[8:11], s60 offen offset:3072 sc1 lds
v_mfma_f32_16x16x32_bf16 v[40:43], a[0:3], a[244:247], v[40:43]
ds_read_b128 a[40:43], v200 offset:10240
v_mfma_f32_16x16x32_bf16 v[44:47], a[4:7], a[240:243], v[44:47]
ds_read_b128 a[44:47], v200 offset:11264
s_add_u32 m0, s63, 143360
v_mfma_f32_16x16x32_bf16 v[48:51], a[4:7], a[244:247], v[48:51]
ds_read_b128 a[48:51], v200 offset:12288
v_mul_f32 v198, v178, v178
v_mfma_f32_16x16x32_bf16 v[52:55], a[8:11], a[240:243], v[52:55]
ds_read_b128 a[52:55], v200 offset:13312
s_add_u32 s61, s61, 36864
v_mfma_f32_16x16x32_bf16 v[56:59], a[8:11], a[244:247], v[56:59]
ds_read_b128 a[56:59], v200 offset:14336
v_mul_f32 v199, v179, v179
v_mfma_f32_16x16x32_bf16 v[60:63], a[12:15], a[240:243], v[60:63]
ds_read_b128 a[60:63], v200 offset:15360
buffer_load_dwordx4 v1, s[8:11], s61 offen offset:0 sc1 lds
v_mfma_f32_16x16x32_bf16 v[64:67], a[12:15], a[244:247], v[64:67]
ds_read_b128 a[64:67], v200 offset:16384
v_fma_f32 v196, v196, v253, v251
v_mfma_f32_16x16x32_bf16 v[68:71], a[16:19], a[240:243], v[68:71]
ds_read_b128 a[68:71], v200 offset:17408
s_add_u32 m0, s62, 147456
v_mfma_f32_16x16x32_bf16 v[72:75], a[16:19], a[244:247], v[72:75]
s_add_u32 s60, s60, 20480
v_fma_f32 v197, v197, v253, v251
v_mfma_f32_16x16x32_bf16 v[76:79], a[20:23], a[240:243], v[76:79]
v_mfma_f32_16x16x32_bf16 v[80:83], a[20:23], a[244:247], v[80:83]
v_fma_f32 v198, v198, v253, v251
v_mfma_f32_16x16x32_bf16 v[84:87], a[24:27], a[240:243], v[84:87]
buffer_load_dwordx4 v1, s[8:11], s60 offen offset:0 sc1 lds
v_mfma_f32_16x16x32_bf16 v[88:91], a[24:27], a[244:247], v[88:91]
v_fma_f32 v199, v199, v253, v251
v_mfma_f32_16x16x32_bf16 v[92:95], a[28:31], a[240:243], v[92:95]
buffer_load_dwordx4 v1, s[8:11], s60 offen offset:1024 sc1 lds
v_mfma_f32_16x16x32_bf16 v[96:99], a[28:31], a[244:247], v[96:99]
v_mfma_f32_16x16x32_bf16 v[100:103], a[32:35], a[240:243], v[100:103]
v_mul_f32 v196, v196, v176
v_mfma_f32_16x16x32_bf16 v[104:107], a[32:35], a[244:247], v[104:107]
s_waitcnt vmcnt(24) lgkmcnt(0)
v_mfma_f32_16x16x32_bf16 v[36:39], a[36:39], a[248:251], v[36:39]
ds_read_b128 a[0:3], v200 offset:18432
buffer_load_dwordx4 v1, s[8:11], s60 offen offset:2048 sc1 lds
v_mfma_f32_16x16x32_bf16 v[40:43], a[36:39], a[252:255], v[40:43]
ds_read_b128 a[4:7], v200 offset:19456
v_mul_f32 v197, v197, v177
v_mfma_f32_16x16x32_bf16 v[44:47], a[40:43], a[248:251], v[44:47]
ds_read_b128 a[8:11], v200 offset:20480
buffer_load_dwordx4 v1, s[8:11], s60 offen offset:3072 sc1 lds
v_mfma_f32_16x16x32_bf16 v[48:51], a[40:43], a[252:255], v[48:51]
ds_read_b128 a[12:15], v200 offset:21504
v_mul_f32 v198, v198, v178
v_mfma_f32_16x16x32_bf16 v[52:55], a[44:47], a[248:251], v[52:55]
ds_read_b128 a[16:19], v200 offset:22528
v_mfma_f32_16x16x32_bf16 v[56:59], a[44:47], a[252:255], v[56:59]
ds_read_b128 a[20:23], v200 offset:23552
v_mul_f32 v199, v199, v179
v_mfma_f32_16x16x32_bf16 v[60:63], a[48:51], a[248:251], v[60:63]
ds_read_b128 a[24:27], v200 offset:24576
v_mfma_f32_16x16x32_bf16 v[64:67], a[48:51], a[252:255], v[64:67]
ds_read_b128 a[28:31], v200 offset:25600
v_mfma_f32_16x16x32_bf16 v[68:71], a[52:55], a[248:251], v[68:71]
ds_read_b128 a[32:35], v200 offset:26624
v_mfma_f32_16x16x32_bf16 v[72:75], a[52:55], a[252:255], v[72:75]
s_cmp_eq_u32 s25, 14
s_cselect_b32 s98, 4096, 0
s_add_u32 s52, s52, s98
v_mfma_f32_16x16x32_bf16 v[76:79], a[56:59], a[248:251], v[76:79]
s_add_u32 s52, s52, 4096
v_exp_f32 v196, v196
v_mfma_f32_16x16x32_bf16 v[80:83], a[56:59], a[252:255], v[80:83]
v_mfma_f32_16x16x32_bf16 v[84:87], a[60:63], a[248:251], v[84:87]
buffer_load_dwordx4 a[128:131], v1, s[4:7], s52 offen offset:0 sc1
v_mfma_f32_16x16x32_bf16 v[88:91], a[60:63], a[252:255], v[88:91]
v_exp_f32 v197, v197
v_mfma_f32_16x16x32_bf16 v[92:95], a[64:67], a[248:251], v[92:95]
buffer_load_dwordx4 a[132:135], v9, s[4:7], s52 offen offset:0 sc1
v_mfma_f32_16x16x32_bf16 v[96:99], a[64:67], a[252:255], v[96:99]
v_mfma_f32_16x16x32_bf16 v[100:103], a[68:71], a[248:251], v[100:103]
v_mfma_f32_16x16x32_bf16 v[104:107], a[68:71], a[252:255], v[104:107]
s_waitcnt lgkmcnt(0)
v_mfma_f32_16x16x32_bf16 v[36:39], a[0:3], a[80:83], v[36:39]
ds_read_b128 a[36:39], v200 offset:27648
buffer_load_dwordx4 a[136:139], v1, s[4:7], s52 offen offset:1024 sc1
v_mfma_f32_16x16x32_bf16 v[40:43], a[0:3], a[84:87], v[40:43]
ds_read_b128 a[40:43], v200 offset:28672
v_mfma_f32_16x16x32_bf16 v[44:47], a[4:7], a[80:83], v[44:47]
ds_read_b128 a[44:47], v200 offset:29696
v_mfma_f32_16x16x32_bf16 v[48:51], a[4:7], a[84:87], v[48:51]
ds_read_b128 a[48:51], v200 offset:30720
v_mfma_f32_16x16x32_bf16 v[52:55], a[8:11], a[80:83], v[52:55]
ds_read_b128 a[52:55], v200 offset:31744
buffer_load_dwordx4 a[140:143], v9, s[4:7], s52 offen offset:1024 sc1
v_mfma_f32_16x16x32_bf16 v[56:59], a[8:11], a[84:87], v[56:59]
ds_read_b128 a[56:59], v200 offset:32768
v_mfma_f32_16x16x32_bf16 v[60:63], a[12:15], a[80:83], v[60:63]
ds_read_b128 a[60:63], v200 offset:33792
v_mfma_f32_16x16x32_bf16 v[64:67], a[12:15], a[84:87], v[64:67]
ds_read_b128 a[64:67], v200 offset:34816
v_mfma_f32_16x16x32_bf16 v[68:71], a[16:19], a[80:83], v[68:71]
ds_read_b128 a[68:71], v200 offset:35840
buffer_load_dwordx4 a[144:147], v1, s[4:7], s52 offen offset:2048 sc1
v_mfma_f32_16x16x32_bf16 v[72:75], a[16:19], a[84:87], v[72:75]
v_exp_f32 v198, v198
v_mfma_f32_16x16x32_bf16 v[76:79], a[20:23], a[80:83], v[76:79]
v_exp_f32 v199, v199
v_mfma_f32_16x16x32_bf16 v[80:83], a[20:23], a[84:87], v[80:83]
v_fma_f32 v196, v196, v255, v255
v_fma_f32 v197, v197, v255, v255
v_mfma_f32_16x16x32_bf16 v[84:87], a[24:27], a[80:83], v[84:87]
buffer_load_dwordx4 a[148:151], v9, s[4:7], s52 offen offset:2048 sc1
v_mfma_f32_16x16x32_bf16 v[88:91], a[24:27], a[84:87], v[88:91]
v_fma_f32 v198, v198, v255, v255
v_mfma_f32_16x16x32_bf16 v[92:95], a[28:31], a[80:83], v[92:95]
v_mfma_f32_16x16x32_bf16 v[96:99], a[28:31], a[84:87], v[96:99]
v_fma_f32 v199, v199, v255, v255
v_mfma_f32_16x16x32_bf16 v[100:103], a[32:35], a[80:83], v[100:103]
v_mfma_f32_16x16x32_bf16 v[104:107], a[32:35], a[84:87], v[104:107]
s_waitcnt vmcnt(19) lgkmcnt(0)
s_barrier
v_mfma_f32_16x16x32_bf16 v[36:39], a[36:39], a[88:91], v[36:39]
ds_read_b128 a[0:3], v201 offset:0
buffer_load_dwordx4 a[152:155], v1, s[4:7], s52 offen offset:3072 sc1
v_mfma_f32_16x16x32_bf16 v[40:43], a[36:39], a[92:95], v[40:43]
ds_read_b128 a[4:7], v201 offset:1024
v_mfma_f32_16x16x32_bf16 v[44:47], a[40:43], a[88:91], v[44:47]
ds_read_b128 a[8:11], v201 offset:2048
buffer_load_dwordx4 a[156:159], v9, s[4:7], s52 offen offset:3072 sc1
v_mfma_f32_16x16x32_bf16 v[48:51], a[40:43], a[92:95], v[48:51]
ds_read_b128 a[12:15], v201 offset:3072
v_mfma_f32_16x16x32_bf16 v[52:55], a[44:47], a[88:91], v[52:55]
ds_read_b128 a[16:19], v201 offset:4096
s_mul_i32 s38, s24, 13312
v_mfma_f32_16x16x32_bf16 v[56:59], a[44:47], a[92:95], v[56:59]
ds_read_b128 a[20:23], v201 offset:5120
v_mfma_f32_16x16x32_bf16 v[60:63], a[48:51], a[88:91], v[60:63]
ds_read_b128 a[24:27], v201 offset:6144
v_mfma_f32_16x16x32_bf16 v[64:67], a[48:51], a[92:95], v[64:67]
ds_read_b128 a[28:31], v201 offset:7168
s_add_u32 m0, s38, 0
v_mfma_f32_16x16x32_bf16 v[68:71], a[52:55], a[88:91], v[68:71]
ds_read_b128 a[32:35], v201 offset:8192
v_mfma_f32_16x16x32_bf16 v[72:75], a[52:55], a[92:95], v[72:75]
s_add_u32 s39, s38, s83
v_rcp_f32 v196, v196
v_mfma_f32_16x16x32_bf16 v[76:79], a[56:59], a[88:91], v[76:79]
v_rcp_f32 v197, v197
v_mfma_f32_16x16x32_bf16 v[80:83], a[56:59], a[92:95], v[80:83]
v_rcp_f32 v198, v198
v_mfma_f32_16x16x32_bf16 v[84:87], a[60:63], a[88:91], v[84:87]
buffer_load_dwordx4 v1, s[4:7], s39 offen offset:0 sc1 lds
v_mfma_f32_16x16x32_bf16 v[88:91], a[60:63], a[92:95], v[88:91]
v_mfma_f32_16x16x32_bf16 v[92:95], a[64:67], a[88:91], v[92:95]
buffer_load_dwordx4 v1, s[4:7], s39 offen offset:1024 sc1 lds
v_mfma_f32_16x16x32_bf16 v[96:99], a[64:67], a[92:95], v[96:99]
v_rcp_f32 v199, v199
v_mfma_f32_16x16x32_bf16 v[100:103], a[68:71], a[88:91], v[100:103]
v_mfma_f32_16x16x32_bf16 v[104:107], a[68:71], a[92:95], v[104:107]
s_waitcnt lgkmcnt(0)
v_mfma_f32_16x16x32_bf16 v[36:39], a[0:3], a[96:99], v[36:39]
ds_read_b128 a[36:39], v201 offset:9216
buffer_load_dwordx4 v1, s[4:7], s39 offen offset:2048 sc1 lds
v_mfma_f32_16x16x32_bf16 v[40:43], a[0:3], a[100:103], v[40:43]
ds_read_b128 a[40:43], v201 offset:10240
v_mul_f32 v176, v176, v196
v_mfma_f32_16x16x32_bf16 v[44:47], a[4:7], a[96:99], v[44:47]
ds_read_b128 a[44:47], v201 offset:11264
buffer_load_dwordx4 v1, s[4:7], s39 offen offset:3072 sc1 lds
v_mfma_f32_16x16x32_bf16 v[48:51], a[4:7], a[100:103], v[48:51]
ds_read_b128 a[48:51], v201 offset:12288
v_mul_f32 v177, v177, v197
v_mfma_f32_16x16x32_bf16 v[52:55], a[8:11], a[96:99], v[52:55]
ds_read_b128 a[52:55], v201 offset:13312
v_mfma_f32_16x16x32_bf16 v[56:59], a[8:11], a[100:103], v[56:59]
ds_read_b128 a[56:59], v201 offset:14336
s_add_u32 m0, m0, 4096
v_mfma_f32_16x16x32_bf16 v[60:63], a[12:15], a[96:99], v[60:63]
ds_read_b128 a[60:63], v201 offset:15360
v_mul_f32 v178, v178, v198
v_mfma_f32_16x16x32_bf16 v[64:67], a[12:15], a[100:103], v[64:67]
ds_read_b128 a[64:67], v201 offset:16384
v_mul_f32 v179, v179, v199
v_mfma_f32_16x16x32_bf16 v[68:71], a[16:19], a[96:99], v[68:71]
ds_read_b128 a[68:71], v201 offset:17408
s_add_u32 s39, s39, 4096
v_mfma_f32_16x16x32_bf16 v[72:75], a[16:19], a[100:103], v[72:75]
s_lshl_b32 s30, s25, 3
v_mfma_f32_16x16x32_bf16 v[76:79], a[20:23], a[96:99], v[76:79]
s_lshl_b32 s31, s24, 1
v_mfma_f32_16x16x32_bf16 v[80:83], a[20:23], a[100:103], v[80:83]
buffer_load_dwordx4 v1, s[4:7], s39 offen offset:0 sc1 lds
v_mfma_f32_16x16x32_bf16 v[84:87], a[24:27], a[96:99], v[84:87]
s_add_u32 s30, s30, s31
v_mfma_f32_16x16x32_bf16 v[88:91], a[24:27], a[100:103], v[88:91]
s_mul_i32 s30, s30, 73728
v_mfma_f32_16x16x32_bf16 v[92:95], a[28:31], a[96:99], v[92:95]
buffer_load_dwordx4 v1, s[4:7], s39 offen offset:1024 sc1 lds
v_mfma_f32_16x16x32_bf16 v[96:99], a[28:31], a[100:103], v[96:99]
s_add_u32 s30, s30, 16777216
v_mfma_f32_16x16x32_bf16 v[100:103], a[32:35], a[96:99], v[100:103]
s_mul_i32 s31, s26, 4608
v_mfma_f32_16x16x32_bf16 v[104:107], a[32:35], a[100:103], v[104:107]
s_add_u32 s30, s30, s31
s_waitcnt vmcnt(23) lgkmcnt(0)
v_mfma_f32_16x16x32_bf16 v[36:39], a[36:39], a[104:107], v[36:39]
ds_read_b128 a[0:3], v201 offset:18432
buffer_load_dwordx4 v1, s[4:7], s39 offen offset:2048 sc1 lds
v_mfma_f32_16x16x32_bf16 v[40:43], a[36:39], a[108:111], v[40:43]
ds_read_b128 a[4:7], v201 offset:19456
v_mfma_f32_16x16x32_bf16 v[44:47], a[40:43], a[104:107], v[44:47]
ds_read_b128 a[8:11], v201 offset:20480
buffer_load_dwordx4 v1, s[4:7], s39 offen offset:3072 sc1 lds
v_mfma_f32_16x16x32_bf16 v[48:51], a[40:43], a[108:111], v[48:51]
ds_read_b128 a[12:15], v201 offset:21504
v_mfma_f32_16x16x32_bf16 v[52:55], a[44:47], a[104:107], v[52:55]
ds_read_b128 a[16:19], v201 offset:22528
v_mfma_f32_16x16x32_bf16 v[56:59], a[44:47], a[108:111], v[56:59]
ds_read_b128 a[20:23], v201 offset:23552
s_add_u32 m0, m0, 4096
v_mfma_f32_16x16x32_bf16 v[60:63], a[48:51], a[104:107], v[60:63]
ds_read_b128 a[24:27], v201 offset:24576
v_mfma_f32_16x16x32_bf16 v[64:67], a[48:51], a[108:111], v[64:67]
ds_read_b128 a[28:31], v201 offset:25600
v_mfma_f32_16x16x32_bf16 v[68:71], a[52:55], a[104:107], v[68:71]
ds_read_b128 a[32:35], v201 offset:26624
s_add_u32 s39, s39, 4096
v_mfma_f32_16x16x32_bf16 v[72:75], a[52:55], a[108:111], v[72:75]
s_and_b32 s65, s26, 1
v_mfma_f32_16x16x32_bf16 v[76:79], a[56:59], a[104:107], v[76:79]
s_lshl_b32 s64, s65, 9
v_mfma_f32_16x16x32_bf16 v[80:83], a[56:59], a[108:111], v[80:83]
buffer_load_dwordx4 v1, s[4:7], s39 offen offset:0 sc1 lds
v_mfma_f32_16x16x32_bf16 v[84:87], a[60:63], a[104:107], v[84:87]
s_add_u32 s64, s64, s30
v_mfma_f32_16x16x32_bf16 v[88:91], a[60:63], a[108:111], v[88:91]
s_xor_b32 s65, s65, 1
v_mfma_f32_16x16x32_bf16 v[92:95], a[64:67], a[104:107], v[92:95]
buffer_load_dwordx4 v1, s[4:7], s39 offen offset:1024 sc1 lds
v_mfma_f32_16x16x32_bf16 v[96:99], a[64:67], a[108:111], v[96:99]
s_lshl_b32 s65, s65, 12
v_mfma_f32_16x16x32_bf16 v[100:103], a[68:71], a[104:107], v[100:103]
s_add_u32 s65, s65, s30
v_mfma_f32_16x16x32_bf16 v[104:107], a[68:71], a[108:111], v[104:107]
s_waitcnt lgkmcnt(0)
v_mfma_f32_16x16x32_bf16 v[36:39], a[0:3], a[112:115], v[36:39]
ds_read_b128 a[36:39], v201 offset:27648
buffer_load_dwordx4 v1, s[4:7], s39 offen offset:2048 sc1 lds
v_mfma_f32_16x16x32_bf16 v[40:43], a[0:3], a[116:119], v[40:43]
ds_read_b128 a[40:43], v201 offset:28672
buffer_load_dwordx4 v1, s[4:7], s39 offen offset:3072 sc1 lds
v_mfma_f32_16x16x32_bf16 v[44:47], a[4:7], a[112:115], v[44:47]
ds_read_b128 a[44:47], v201 offset:29696
v_mfma_f32_16x16x32_bf16 v[48:51], a[4:7], a[116:119], v[48:51]
ds_read_b128 a[48:51], v201 offset:30720
s_add_u32 m0, m0, 4096
v_mfma_f32_16x16x32_bf16 v[52:55], a[8:11], a[112:115], v[52:55]
ds_read_b128 a[52:55], v201 offset:31744
v_add_u32 v204, 73728, v1
v_mfma_f32_16x16x32_bf16 v[56:59], a[8:11], a[116:119], v[56:59]
ds_read_b128 a[56:59], v201 offset:32768
s_add_u32 s39, s39, 4096
v_mfma_f32_16x16x32_bf16 v[60:63], a[12:15], a[112:115], v[60:63]
ds_read_b128 a[60:63], v201 offset:33792
buffer_load_dwordx4 v1, s[4:7], s39 offen offset:0 sc1 lds
v_mfma_f32_16x16x32_bf16 v[64:67], a[12:15], a[116:119], v[64:67]
ds_read_b128 a[64:67], v201 offset:34816
v_and_b32 v203, 1, v3
v_mfma_f32_16x16x32_bf16 v[68:71], a[16:19], a[112:115], v[68:71]
ds_read_b128 a[68:71], v201 offset:35840
s_mul_i32 s38, s24, 9216
v_mfma_f32_16x16x32_bf16 v[72:75], a[16:19], a[116:119], v[72:75]
s_add_u32 m0, s38, 53248
v_mul_u32_u24 v203, 73728, v203
v_mfma_f32_16x16x32_bf16 v[76:79], a[20:23], a[112:115], v[76:79]
s_add_u32 s39, s38, s83
v_mfma_f32_16x16x32_bf16 v[80:83], a[20:23], a[116:119], v[80:83]
s_add_u32 s39, s39, 53248
v_lshrrev_b32 v7, 1, v3
v_mfma_f32_16x16x32_bf16 v[84:87], a[24:27], a[112:115], v[84:87]
v_mfma_f32_16x16x32_bf16 v[88:91], a[24:27], a[116:119], v[88:91]
v_mfma_f32_16x16x32_bf16 v[92:95], a[28:31], a[112:115], v[92:95]
v_lshl_add_u32 v203, v7, 8, v203
v_mfma_f32_16x16x32_bf16 v[96:99], a[28:31], a[116:119], v[96:99]
buffer_load_dwordx4 v1, s[4:7], s39 offen offset:0 sc1 lds
v_mfma_f32_16x16x32_bf16 v[100:103], a[32:35], a[112:115], v[100:103]
v_lshl_add_u32 v203, v2, 4, v203
v_mfma_f32_16x16x32_bf16 v[104:107], a[32:35], a[116:119], v[104:107]
s_waitcnt vmcnt(14) lgkmcnt(0)
s_barrier
v_mfma_f32_16x16x32_bf16 v[36:39], a[36:39], a[120:123], v[36:39]
ds_read_b128 a[0:3], v202 offset:8192
buffer_load_dwordx4 v1, s[4:7], s39 offen offset:1024 sc1 lds
v_mfma_f32_16x16x32_bf16 v[40:43], a[36:39], a[124:127], v[40:43]
ds_read_b128 a[4:7], v202 offset:17408
v_mfma_f32_16x16x32_bf16 v[44:47], a[40:43], a[120:123], v[44:47]
ds_read_b128 a[8:11], v202 offset:26624
buffer_load_dwordx4 v1, s[4:7], s39 offen offset:2048 sc1 lds
v_mfma_f32_16x16x32_bf16 v[48:51], a[40:43], a[124:127], v[48:51]
ds_read_b128 a[12:15], v202 offset:35840
v_mfma_f32_16x16x32_bf16 v[52:55], a[44:47], a[120:123], v[52:55]
ds_read_b128 a[16:19], v202 offset:0
v_mfma_f32_16x16x32_bf16 v[56:59], a[44:47], a[124:127], v[56:59]
ds_read_b128 a[20:23], v202 offset:1024
buffer_load_dwordx4 v1, s[4:7], s39 offen offset:3072 sc1 lds
v_mfma_f32_16x16x32_bf16 v[60:63], a[48:51], a[120:123], v[60:63]
ds_read_b128 a[24:27], v202 offset:9216
v_mfma_f32_16x16x32_bf16 v[64:67], a[48:51], a[124:127], v[64:67]
ds_read_b128 a[28:31], v202 offset:10240
v_mfma_f32_16x16x32_bf16 v[68:71], a[52:55], a[120:123], v[68:71]
ds_read_b128 a[32:35], v202 offset:18432
s_add_u32 m0, m0, 4096
v_mfma_f32_16x16x32_bf16 v[72:75], a[52:55], a[124:127], v[72:75]
s_add_u32 s39, s39, 4096
v_mfma_f32_16x16x32_bf16 v[76:79], a[56:59], a[120:123], v[76:79]
v_mfma_f32_16x16x32_bf16 v[80:83], a[56:59], a[124:127], v[80:83]
v_mfma_f32_16x16x32_bf16 v[84:87], a[60:63], a[120:123], v[84:87]
v_mfma_f32_16x16x32_bf16 v[88:91], a[60:63], a[124:127], v[88:91]
v_mfma_f32_16x16x32_bf16 v[92:95], a[64:67], a[120:123], v[92:95]
buffer_load_dwordx4 v1, s[4:7], s39 offen offset:0 sc1 lds
v_mfma_f32_16x16x32_bf16 v[96:99], a[64:67], a[124:127], v[96:99]
v_mfma_f32_16x16x32_bf16 v[100:103], a[68:71], a[120:123], v[100:103]
v_mfma_f32_16x16x32_bf16 v[104:107], a[68:71], a[124:127], v[104:107]
s_waitcnt lgkmcnt(7)
v_mfma_f32_16x16x32_bf16 v[100:103], a[0:3], a[128:131], v[100:103]
ds_read_b128 a[36:39], v202 offset:19456
v_mfma_f32_16x16x32_bf16 v[104:107], a[0:3], a[132:135], v[104:107]
v_mfma_f32_16x16x32_bf16 v[100:103], a[4:7], a[136:139], v[100:103]
ds_read_b128 a[40:43], v202 offset:27648
v_mfma_f32_16x16x32_bf16 v[104:107], a[4:7], a[140:143], v[104:107]
s_waitcnt lgkmcnt(7)
v_mfma_f32_16x16x32_bf16 v[100:103], a[8:11], a[144:147], v[100:103]
ds_read_b128 a[44:47], v202 offset:28672
v_mfma_f32_16x16x32_bf16 v[104:107], a[8:11], a[148:151], v[104:107]
v_mfma_f32_16x16x32_bf16 v[100:103], a[12:15], a[152:155], v[100:103]
ds_read_b128 a[48:51], v202 offset:2048
v_mfma_f32_16x16x32_bf16 v[104:107], a[12:15], a[156:159], v[104:107]
s_waitcnt lgkmcnt(7)
v_mfma_f32_16x16x32_bf16 v[36:39], a[16:19], a[128:131], v[36:39]
ds_read_b128 a[52:55], v202 offset:3072
v_mfma_f32_16x16x32_bf16 v[40:43], a[16:19], a[132:135], v[40:43]
v_mfma_f32_16x16x32_bf16 v[44:47], a[20:23], a[128:131], v[44:47]
ds_read_b128 a[56:59], v202 offset:11264
v_mfma_f32_16x16x32_bf16 v[48:51], a[20:23], a[132:135], v[48:51]
v_mul_f32 v100, v100, v108
s_waitcnt lgkmcnt(7)
v_mfma_f32_16x16x32_bf16 v[36:39], a[24:27], a[136:139], v[36:39]
ds_read_b128 a[60:63], v202 offset:12288
v_mul_f32 v101, v101, v109
v_mfma_f32_16x16x32_bf16 v[40:43], a[24:27], a[140:143], v[40:43]
v_mul_f32 v102, v102, v110
v_mul_f32 v103, v103, v111
v_mfma_f32_16x16x32_bf16 v[44:47], a[28:31], a[136:139], v[44:47]
ds_read_b128 a[64:67], v202 offset:20480
v_cvt_pk_bf16_f32 v238, v100, v101
v_mfma_f32_16x16x32_bf16 v[48:51], a[28:31], a[140:143], v[48:51]
v_cvt_pk_bf16_f32 v239, v102, v103
s_waitcnt lgkmcnt(7)
v_mfma_f32_16x16x32_bf16 v[36:39], a[32:35], a[144:147], v[36:39]
ds_read_b128 a[68:71], v202 offset:21504
v_mul_f32 v104, v104, v112
v_mfma_f32_16x16x32_bf16 v[40:43], a[32:35], a[148:151], v[40:43]
v_mul_f32 v105, v105, v113
v_mfma_f32_16x16x32_bf16 v[44:47], a[36:39], a[144:147], v[44:47]
ds_read_b128 a[0:3], v202 offset:29696
v_mul_f32 v106, v106, v114
v_mfma_f32_16x16x32_bf16 v[48:51], a[36:39], a[148:151], v[48:51]
v_mul_f32 v107, v107, v115
s_waitcnt lgkmcnt(7)
v_mfma_f32_16x16x32_bf16 v[36:39], a[40:43], a[152:155], v[36:39]
ds_read_b128 a[4:7], v202 offset:30720
v_cvt_pk_bf16_f32 v240, v104, v105
v_mfma_f32_16x16x32_bf16 v[40:43], a[40:43], a[156:159], v[40:43]
v_cvt_pk_bf16_f32 v241, v106, v107
s_nop 0
v_mfma_f32_16x16x32_bf16 v[44:47], a[44:47], a[152:155], v[44:47]
ds_read_b128 a[8:11], v202 offset:4096
v_mfma_f32_16x16x32_bf16 v[48:51], a[44:47], a[156:159], v[48:51]
s_waitcnt lgkmcnt(7)
v_mfma_f32_16x16x32_bf16 v[52:55], a[48:51], a[128:131], v[52:55]
ds_read_b128 a[12:15], v202 offset:5120
v_permlane16_swap_b32 v238, v240
v_mfma_f32_16x16x32_bf16 v[56:59], a[48:51], a[132:135], v[56:59]
v_permlane16_swap_b32 v239, v241
v_mfma_f32_16x16x32_bf16 v[60:63], a[52:55], a[128:131], v[60:63]
ds_read_b128 a[16:19], v202 offset:13312
buffer_store_dwordx4 v[238:241], v203, s[8:11], s65 offen sc1
v_mfma_f32_16x16x32_bf16 v[64:67], a[52:55], a[132:135], v[64:67]
v_mul_f32 v36, v36, v116
s_waitcnt lgkmcnt(7)
v_mfma_f32_16x16x32_bf16 v[52:55], a[56:59], a[136:139], v[52:55]
ds_read_b128 a[20:23], v202 offset:14336
v_mul_f32 v37, v37, v117
v_mfma_f32_16x16x32_bf16 v[56:59], a[56:59], a[140:143], v[56:59]
v_mul_f32 v38, v38, v118
v_mul_f32 v39, v39, v119
v_mfma_f32_16x16x32_bf16 v[60:63], a[60:63], a[136:139], v[60:63]
ds_read_b128 a[24:27], v202 offset:22528
v_cvt_pk_bf16_f32 v206, v36, v37
v_mfma_f32_16x16x32_bf16 v[64:67], a[60:63], a[140:143], v[64:67]
v_cvt_pk_bf16_f32 v207, v38, v39
v_mul_f32 v44, v44, v124
s_waitcnt lgkmcnt(7)
v_mfma_f32_16x16x32_bf16 v[52:55], a[64:67], a[144:147], v[52:55]
ds_read_b128 a[28:31], v202 offset:23552
v_mul_f32 v45, v45, v125
v_mfma_f32_16x16x32_bf16 v[56:59], a[64:67], a[148:151], v[56:59]
v_mul_f32 v46, v46, v126
v_mul_f32 v47, v47, v127
v_mfma_f32_16x16x32_bf16 v[60:63], a[68:71], a[144:147], v[60:63]
ds_read_b128 a[32:35], v202 offset:31744
v_cvt_pk_bf16_f32 v208, v44, v45
v_mfma_f32_16x16x32_bf16 v[64:67], a[68:71], a[148:151], v[64:67]
v_cvt_pk_bf16_f32 v209, v46, v47
s_waitcnt lgkmcnt(7)
v_mfma_f32_16x16x32_bf16 v[52:55], a[0:3], a[152:155], v[52:55]
ds_read_b128 a[36:39], v202 offset:32768
buffer_store_dwordx4 v[206:209], v1, s[8:11], s64 offen offset:0 sc1
v_mul_f32 v40, v40, v120
v_mul_f32 v41, v41, v121
v_mfma_f32_16x16x32_bf16 v[56:59], a[0:3], a[156:159], v[56:59]
v_mul_f32 v42, v42, v122
v_mul_f32 v43, v43, v123
v_mfma_f32_16x16x32_bf16 v[60:63], a[4:7], a[152:155], v[60:63]
ds_read_b128 a[40:43], v202 offset:6144
v_cvt_pk_bf16_f32 v210, v40, v41
v_mfma_f32_16x16x32_bf16 v[64:67], a[4:7], a[156:159], v[64:67]
v_cvt_pk_bf16_f32 v211, v42, v43
v_mul_f32 v48, v48, v128
s_waitcnt lgkmcnt(7)
v_mfma_f32_16x16x32_bf16 v[68:71], a[8:11], a[128:131], v[68:71]
ds_read_b128 a[44:47], v202 offset:7168
v_mul_f32 v49, v49, v129
v_mfma_f32_16x16x32_bf16 v[72:75], a[8:11], a[132:135], v[72:75]
v_mul_f32 v50, v50, v130
v_mul_f32 v51, v51, v131
v_mfma_f32_16x16x32_bf16 v[76:79], a[12:15], a[128:131], v[76:79]
ds_read_b128 a[48:51], v202 offset:15360
v_cvt_pk_bf16_f32 v212, v48, v49
v_cvt_pk_bf16_f32 v213, v50, v51
buffer_store_dwordx4 v[210:213], v204, s[8:11], s64 offen offset:0 sc1
v_mfma_f32_16x16x32_bf16 v[80:83], a[12:15], a[132:135], v[80:83]
v_mul_f32 v52, v52, v132
s_waitcnt lgkmcnt(7)
v_mfma_f32_16x16x32_bf16 v[68:71], a[16:19], a[136:139], v[68:71]
ds_read_b128 a[52:55], v202 offset:16384
v_mul_f32 v53, v53, v133
v_mfma_f32_16x16x32_bf16 v[72:75], a[16:19], a[140:143], v[72:75]
v_mul_f32 v54, v54, v134
v_mul_f32 v55, v55, v135
v_mfma_f32_16x16x32_bf16 v[76:79], a[20:23], a[136:139], v[76:79]
ds_read_b128 a[56:59], v202 offset:24576
v_cvt_pk_bf16_f32 v214, v52, v53
v_mfma_f32_16x16x32_bf16 v[80:83], a[20:23], a[140:143], v[80:83]
v_cvt_pk_bf16_f32 v215, v54, v55
v_mul_f32 v60, v60, v140
s_waitcnt lgkmcnt(7)
v_mfma_f32_16x16x32_bf16 v[68:71], a[24:27], a[144:147], v[68:71]
ds_read_b128 a[60:63], v202 offset:25600
v_mul_f32 v61, v61, v141
v_mfma_f32_16x16x32_bf16 v[72:75], a[24:27], a[148:151], v[72:75]
v_mul_f32 v62, v62, v142
v_mul_f32 v63, v63, v143
v_mfma_f32_16x16x32_bf16 v[76:79], a[28:31], a[144:147], v[76:79]
ds_read_b128 a[64:67], v202 offset:33792
v_cvt_pk_bf16_f32 v216, v60, v61
v_mfma_f32_16x16x32_bf16 v[80:83], a[28:31], a[148:151], v[80:83]
v_cvt_pk_bf16_f32 v217, v62, v63
s_waitcnt lgkmcnt(7)
v_mfma_f32_16x16x32_bf16 v[68:71], a[32:35], a[152:155], v[68:71]
ds_read_b128 a[68:71], v202 offset:34816
buffer_store_dwordx4 v[214:217], v1, s[8:11], s64 offen offset:1024 sc1
v_mul_f32 v56, v56, v136
v_mul_f32 v57, v57, v137
v_mfma_f32_16x16x32_bf16 v[72:75], a[32:35], a[156:159], v[72:75]
v_mul_f32 v58, v58, v138
v_mul_f32 v59, v59, v139
v_mfma_f32_16x16x32_bf16 v[76:79], a[36:39], a[152:155], v[76:79]
v_cvt_pk_bf16_f32 v218, v56, v57
v_cvt_pk_bf16_f32 v219, v58, v59
v_mfma_f32_16x16x32_bf16 v[80:83], a[36:39], a[156:159], v[80:83]
v_mul_f32 v64, v64, v144
s_waitcnt lgkmcnt(6)
v_mfma_f32_16x16x32_bf16 v[84:87], a[40:43], a[128:131], v[84:87]
v_mul_f32 v65, v65, v145
v_mul_f32 v66, v66, v146
v_mfma_f32_16x16x32_bf16 v[88:91], a[40:43], a[132:135], v[88:91]
v_mul_f32 v67, v67, v147
v_cvt_pk_bf16_f32 v220, v64, v65
v_mfma_f32_16x16x32_bf16 v[92:95], a[44:47], a[128:131], v[92:95]
v_cvt_pk_bf16_f32 v221, v66, v67
buffer_store_dwordx4 v[218:221], v204, s[8:11], s64 offen offset:1024 sc1
v_mfma_f32_16x16x32_bf16 v[96:99], a[44:47], a[132:135], v[96:99]
v_mul_f32 v68, v68, v148
s_waitcnt lgkmcnt(4)
v_mfma_f32_16x16x32_bf16 v[84:87], a[48:51], a[136:139], v[84:87]
v_mul_f32 v69, v69, v149
v_mul_f32 v70, v70, v150
v_mfma_f32_16x16x32_bf16 v[88:91], a[48:51], a[140:143], v[88:91]
v_mul_f32 v71, v71, v151
v_cvt_pk_bf16_f32 v222, v68, v69
v_mfma_f32_16x16x32_bf16 v[92:95], a[52:55], a[136:139], v[92:95]
v_cvt_pk_bf16_f32 v223, v70, v71
v_mul_f32 v76, v76, v156
v_mfma_f32_16x16x32_bf16 v[96:99], a[52:55], a[140:143], v[96:99]
v_mul_f32 v77, v77, v157
s_waitcnt lgkmcnt(2)
v_mfma_f32_16x16x32_bf16 v[84:87], a[56:59], a[144:147], v[84:87]
v_mul_f32 v78, v78, v158
v_mul_f32 v79, v79, v159
v_mfma_f32_16x16x32_bf16 v[88:91], a[56:59], a[148:151], v[88:91]
v_cvt_pk_bf16_f32 v224, v76, v77
v_cvt_pk_bf16_f32 v225, v78, v79
v_mfma_f32_16x16x32_bf16 v[92:95], a[60:63], a[144:147], v[92:95]
buffer_store_dwordx4 v[222:225], v1, s[8:11], s64 offen offset:2048 sc1
v_mul_f32 v72, v72, v152
v_mfma_f32_16x16x32_bf16 v[96:99], a[60:63], a[148:151], v[96:99]
v_mul_f32 v73, v73, v153
v_mul_f32 v74, v74, v154
s_waitcnt lgkmcnt(0)
v_mfma_f32_16x16x32_bf16 v[84:87], a[64:67], a[152:155], v[84:87]
v_mul_f32 v75, v75, v155
v_cvt_pk_bf16_f32 v226, v72, v73
v_mfma_f32_16x16x32_bf16 v[88:91], a[64:67], a[156:159], v[88:91]
v_cvt_pk_bf16_f32 v227, v74, v75
v_mul_f32 v80, v80, v160
v_mfma_f32_16x16x32_bf16 v[92:95], a[68:71], a[152:155], v[92:95]
v_mul_f32 v81, v81, v161
v_mul_f32 v82, v82, v162
v_mfma_f32_16x16x32_bf16 v[96:99], a[68:71], a[156:159], v[96:99]
v_mul_f32 v83, v83, v163
v_cvt_pk_bf16_f32 v228, v80, v81
v_cvt_pk_bf16_f32 v229, v82, v83
buffer_store_dwordx4 v[226:229], v204, s[8:11], s64 offen offset:2048 sc1
s_nop 1
v_pk_mul_f32 v[84:85], v[84:85], v[164:165]
v_pk_mul_f32 v[86:87], v[86:87], v[166:167]
v_cvt_pk_bf16_f32 v230, v84, v85
v_cvt_pk_bf16_f32 v231, v86, v87
v_pk_mul_f32 v[92:93], v[92:93], v[172:173]
v_pk_mul_f32 v[94:95], v[94:95], v[174:175]
v_cvt_pk_bf16_f32 v232, v92, v93
v_cvt_pk_bf16_f32 v233, v94, v95
buffer_store_dwordx4 v[230:233], v1, s[8:11], s64 offen offset:3072 sc1
v_pk_mul_f32 v[88:89], v[88:89], v[168:169]
v_pk_mul_f32 v[90:91], v[90:91], v[170:171]
v_cvt_pk_bf16_f32 v234, v88, v89
v_cvt_pk_bf16_f32 v235, v90, v91
v_pk_mul_f32 v[96:97], v[96:97], v[176:177]
v_pk_mul_f32 v[98:99], v[98:99], v[178:179]
v_cvt_pk_bf16_f32 v236, v96, v97
v_cvt_pk_bf16_f32 v237, v98, v99
buffer_store_dwordx4 v[234:237], v204, s[8:11], s64 offen offset:3072 sc1
L_c5:
s_barrier
buffer_load_dwordx4 v1, s[4:7], s39 offen offset:1024 sc1 lds
buffer_load_dwordx4 v1, s[4:7], s39 offen offset:2048 sc1 lds
buffer_load_dwordx4 v1, s[4:7], s39 offen offset:3072 sc1 lds
s_add_u32 m0, m0, 4096
s_add_u32 s39, s39, 4096
buffer_load_dwordx4 v1, s[4:7], s39 offen offset:0 sc1 lds
s_mul_i32 s38, s24, 9216
s_add_u32 m0, s38, 90112
s_add_u32 s39, s38, s83
s_add_u32 s39, s39, 90112
buffer_load_dwordx4 v1, s[4:7], s39 offen offset:0 sc1 lds
buffer_load_dwordx4 v1, s[4:7], s39 offen offset:1024 sc1 lds
buffer_load_dwordx4 v1, s[4:7], s39 offen offset:2048 sc1 lds
v_lshlrev_b32 v7, 3, v1
s_lshl_b32 s31, s27, 10
v_add_u32 v7, s31, v7
s_cmp_eq_u32 s24, 0
s_cselect_b32 s30, 0, 1073741824
s_add_u32 s30, s30, 26574848
s_waitcnt vmcnt(7)
s_barrier
s_mov_b64 exec, 0xff
buffer_atomic_add v4, v7, s[8:11], s30 offen sc1
s_mov_b64 exec, -1
s_lshl_b32 s35, s80, 7
s_add_u32 s35, s35, 26574848
s_cmp_eq_u32 s24, 1
s_cselect_b32 s35, s35, 1073741824
v_mov_b32 v6, 0
v_mov_b32 v244, 0
v_mov_b32 v245, 0
v_mov_b32 v246, 0
buffer_load_dwordx4 v1, s[4:7], s39 offen offset:3072 sc1 lds
s_add_u32 m0, m0, 4096
s_add_u32 s39, s39, 4096
buffer_load_dwordx4 v1, s[4:7], s39 offen offset:0 sc1 lds
buffer_load_dwordx4 v1, s[4:7], s39 offen offset:1024 sc1 lds
buffer_load_dwordx4 v1, s[4:7], s39 offen offset:2048 sc1 lds
s_xor_b32 s30, s70, 1
s_mul_i32 s60, s30, 73728
s_and_b32 s32, s27, 1
s_mul_i32 s32, s32, 36864
s_add_u32 s32, s32, 16777216
s_add_u32 s60, s60, s32
s_mul_i32 s61, s70, 73728
s_add_u32 s61, s61, s32
v_and_b32 v40, 7, v2
v_lshlrev_b32 v40, 4, v40
v_lshl_add_u32 v40, v3, 7, v40
v_add_u32 v40, 4096, v40
s_mov_b64 exec, 1
buffer_atomic_add v244, v6, s[8:11], s35 offen sc0 sc1
s_mov_b64 exec, -1
buffer_load_dwordx4 v1, s[4:7], s39 offen offset:3072 sc1 lds
s_add_u32 m0, m0, 4096
s_add_u32 s39, s39, 4096
buffer_load_dwordx4 v1, s[4:7], s39 offen offset:0 sc1 lds
s_mul_i32 s38, s24, 9216
s_add_u32 m0, s38, 126976
s_add_u32 s39, s38, s83
s_add_u32 s39, s39, 126976
buffer_load_dwordx4 v1, s[4:7], s39 offen offset:0 sc1 lds
buffer_load_dwordx4 v1, s[4:7], s39 offen offset:1024 sc1 lds
s_lshl_b32 s63, s80, 14
s_lshl_b32 s30, s24, 12
s_add_u32 s63, s63, s30
s_xor_b32 s62, s63, 131072
s_add_u32 s63, s63, 26640384
s_add_u32 s62, s62, 26640384
s_add_u32 s64, s83, 161280
v_mov_b32 v116, v40
v_add_u32 v36, 0, v1
v_add_u32 v37, 55296, v1
v_add_u32 v41, 55296, v40
v_add_u32 v38, 110592, v1
s_mov_b64 exec, 1
buffer_atomic_add v245, v6, s[8:11], s35 offen sc0 sc1
s_mov_b64 exec, -1
buffer_load_dwordx4 v1, s[4:7], s39 offen offset:2048 sc1 lds
buffer_load_dwordx4 v1, s[4:7], s39 offen offset:3072 sc1 lds
s_add_u32 m0, m0, 4096
s_add_u32 s39, s39, 4096
buffer_load_dwordx4 v1, s[4:7], s39 offen offset:0 sc1 lds
buffer_load_dwordx4 v1, s[4:7], s39 offen offset:1024 sc1 lds
v_add_u32 v42, 110592, v40
s_bitcmp1_b32 s27, 0
s_cbranch_scc1 L_kh_31
v_swap_b32 v206, v210
v_swap_b32 v207, v211
v_swap_b32 v208, v212
v_swap_b32 v209, v213
v_swap_b32 v214, v218
v_swap_b32 v215, v219
v_swap_b32 v216, v220
v_swap_b32 v217, v221
v_swap_b32 v222, v226
v_swap_b32 v223, v227
v_swap_b32 v224, v228
v_swap_b32 v225, v229
v_swap_b32 v230, v234
v_swap_b32 v231, v235
v_swap_b32 v232, v236
v_swap_b32 v233, v237
L_kh_31:
v_mov_b32 v138, 1073741824
s_mul_i32 s66, s70, 18432
s_mul_i32 s32, s28, 2304
s_add_u32 s66, s66, s32
s_add_u32 s66, s66, 30834688
v_mov_b32 v140, v1
v_add_u32 v141, 2048, v140
v_cndmask_b32 v141, v138, v141, s[46:47]
s_lshl_b32 s67, s70, 7
s_lshl_b32 s32, s28, 14
s_mov_b64 exec, 1
buffer_atomic_add v246, v6, s[8:11], s35 offen sc0 sc1
s_mov_b64 exec, -1
buffer_load_dwordx4 v1, s[4:7], s39 offen offset:2048 sc1 lds
buffer_load_dwordx4 v1, s[4:7], s39 offen offset:3072 sc1 lds
s_add_u32 m0, m0, 4096
s_add_u32 s39, s39, 4096
buffer_load_dwordx4 v1, s[4:7], s39 offen offset:0 sc1 lds
s_add_u32 s67, s67, s32
s_add_u32 s67, s67, 33193984
v_lshlrev_b32 v139, 3, v2
v_cndmask_b32 v138, v138, v139, s[46:47]
v_mov_b32 v162, 1073741824
s_mul_i32 s68, s70, 18432
s_mul_i32 s32, s28, 144
s_add_u32 s68, s68, s32
v_mul_u32_u24 v164, 1152, v2
v_lshl_add_u32 v164, v3, 4, v164
v_add_u32 v165, 128, v164
v_cndmask_b32 v165, v162, v165, s[46:47]
ds_read_b128 a[160:163], v36 offset:0
ds_read_b128 a[164:167], v36 offset:1024
ds_read_b128 a[168:171], v36 offset:2048
ds_read_b128 a[172:175], v36 offset:3072
ds_read_b128 a[176:179], v40 offset:0
ds_read_b128 a[180:183], v36 offset:4608
ds_read_b128 a[184:187], v36 offset:5632
ds_read_b128 a[188:191], v36 offset:6656
ds_read_b128 a[192:195], v36 offset:7680
ds_read_b128 a[196:199], v40 offset:4608
s_cmp_eq_u32 s71, 0
s_cselect_b32 s98, 4096, 0
s_add_u32 s60, s60, s98
s_cmp_eq_u32 s24, 1
s_cbranch_scc0 L_other_34
s_mov_b32 s31, 0
s_mov_b64 exec, 1
v_mov_b32 v247, 0
buffer_atomic_add v247, v6, s[8:11], s35 offen sc0 sc1
s_waitcnt vmcnt(14)
v_cmp_gt_u32 vcc, 8, v244
s_nop 0
s_cbranch_vccz L_polled_33
s_waitcnt vmcnt(9)
v_cmp_gt_u32 vcc, 8, v245
s_nop 0
s_cbranch_vccz L_polled_33
v_mov_b32 v244, 0
buffer_atomic_add v244, v6, s[8:11], s35 offen sc0 sc1
s_waitcnt vmcnt(5)
v_cmp_gt_u32 vcc, 8, v246
s_nop 0
s_cbranch_vccz L_polled_33
v_mov_b32 v245, 0
buffer_atomic_add v245, v6, s[8:11], s35 offen sc0 sc1
L_poll_32:
s_add_u32 s31, s31, 1
s_cmp_gt_u32 s31, 100000
s_cbranch_scc1 L_polled_33
v_mov_b32 v246, 0
buffer_atomic_add v246, v6, s[8:11], s35 offen sc0 sc1
s_waitcnt vmcnt(3)
v_cmp_gt_u32 vcc, 8, v247
s_nop 0
s_cbranch_vccz L_polled_33
v_mov_b32 v247, 0
buffer_atomic_add v247, v6, s[8:11], s35 offen sc0 sc1
s_waitcnt vmcnt(3)
v_cmp_gt_u32 vcc, 8, v244
s_nop 0
s_cbranch_vccz L_polled_33
v_mov_b32 v244, 0
buffer_atomic_add v244, v6, s[8:11], s35 offen sc0 sc1
s_waitcnt vmcnt(3)
v_cmp_gt_u32 vcc, 8, v245
s_nop 0
s_cbranch_vccz L_polled_33
v_mov_b32 v245, 0
buffer_atomic_add v245, v6, s[8:11], s35 offen sc0 sc1
s_waitcnt vmcnt(3)
v_cmp_gt_u32 vcc, 8, v246
s_nop 0
s_cbranch_vccz L_polled_33
s_branch L_poll_32
L_polled_33:
s_mov_b64 exec, -1
L_other_34:
s_barrier
buffer_load_dwordx4 a[0:3], v1, s[8:11], s60 offen offset:0 sc1
buffer_load_dwordx4 a[4:7], v1, s[8:11], s60 offen offset:1024 sc1
s_waitcnt lgkmcnt(5)
v_mfma_f32_16x16x32_bf16 v[44:47], a[160:163], v[206:209], 0
ds_read_b128 a[200:203], v36 offset:9216
buffer_load_dwordx4 a[8:11], v1, s[8:11], s60 offen offset:2048 sc1
v_mfma_f32_16x16x32_bf16 v[16:19], a[160:163], v[210:213], v[16:19]
v_mfma_f32_16x16x32_bf16 v[48:51], a[164:167], v[206:209], 0
ds_read_b128 a[204:207], v36 offset:10240
buffer_load_dwordx4 a[12:15], v1, s[8:11], s60 offen offset:3072 sc1
v_mfma_f32_16x16x32_bf16 v[20:23], a[164:167], v[210:213], v[20:23]
s_add_u32 s60, s60, 4096
v_mfma_f32_16x16x32_bf16 v[52:55], a[168:171], v[206:209], 0
ds_read_b128 a[208:211], v36 offset:11264
v_mfma_f32_16x16x32_bf16 v[24:27], a[168:171], v[210:213], v[24:27]
v_mfma_f32_16x16x32_bf16 v[56:59], a[172:175], v[206:209], 0
ds_read_b128 a[212:215], v36 offset:12288
buffer_load_dwordx4 a[16:19], v1, s[8:11], s60 offen offset:0 sc1
v_mfma_f32_16x16x32_bf16 v[28:31], a[172:175], v[210:213], v[28:31]
s_cmp_eq_u32 s71, 5
s_cselect_b32 s98, 4096, 0
v_mfma_f32_16x16x32_bf16 v[60:63], a[176:179], v[206:209], 0
ds_read_b128 a[216:219], v40 offset:9216
v_mfma_f32_16x16x32_bf16 v[32:35], a[176:179], v[210:213], v[32:35]
s_add_u32 s60, s60, s98
s_waitcnt lgkmcnt(5)
v_mfma_f32_16x16x32_bf16 v[44:47], a[180:183], v[214:217], v[44:47]
ds_read_b128 a[160:163], v36 offset:13824
v_mov_b32 v67, v248
v_mfma_f32_16x16x32_bf16 v[16:19], a[180:183], v[218:221], v[16:19]
v_mfma_f32_16x16x32_bf16 v[48:51], a[184:187], v[214:217], v[48:51]
ds_read_b128 a[164:167], v36 offset:14848
v_mfma_f32_16x16x32_bf16 v[20:23], a[184:187], v[218:221], v[20:23]
v_mfma_f32_16x16x32_bf16 v[52:55], a[188:191], v[214:217], v[52:55]
ds_read_b128 a[168:171], v36 offset:15872
v_mfma_f32_16x16x32_bf16 v[24:27], a[188:191], v[218:221], v[24:27]
buffer_load_dwordx4 a[20:23], v1, s[8:11], s60 offen offset:1024 sc1
v_mfma_f32_16x16x32_bf16 v[56:59], a[192:195], v[214:217], v[56:59]
ds_read_b128 a[172:175], v36 offset:16896
v_mfma_f32_16x16x32_bf16 v[28:31], a[192:195], v[218:221], v[28:31]
buffer_load_dwordx4 a[24:27], v1, s[8:11], s60 offen offset:2048 sc1
v_mov_b32 v71, v248
v_mfma_f32_16x16x32_bf16 v[60:63], a[196:199], v[214:217], v[60:63]
ds_read_b128 a[176:179], v40 offset:13824
v_mfma_f32_16x16x32_bf16 v[32:35], a[196:199], v[218:221], v[32:35]
buffer_load_dwordx4 a[28:31], v1, s[8:11], s60 offen offset:3072 sc1
s_waitcnt lgkmcnt(5)
v_mfma_f32_16x16x32_bf16 v[44:47], a[200:203], v[222:225], v[44:47]
ds_read_b128 a[180:183], v36 offset:18432
v_mfma_f32_16x16x32_bf16 v[16:19], a[200:203], v[226:229], v[16:19]
s_add_u32 s60, s60, 4096
v_mfma_f32_16x16x32_bf16 v[48:51], a[204:207], v[222:225], v[48:51]
ds_read_b128 a[184:187], v36 offset:19456
v_mfma_f32_16x16x32_bf16 v[20:23], a[204:207], v[226:229], v[20:23]
v_mfma_f32_16x16x32_bf16 v[52:55], a[208:211], v[222:225], v[52:55]
ds_read_b128 a[188:191], v36 offset:20480
buffer_load_dwordx4 a[32:35], v1, s[8:11], s60 offen offset:0 sc1
v_mfma_f32_16x16x32_bf16 v[24:27], a[208:211], v[226:229], v[24:27]
s_cmp_eq_u32 s71, 9
s_cselect_b32 s98, 4096, 0
v_mov_b32 v75, v248
v_mfma_f32_16x16x32_bf16 v[56:59], a[212:215], v[222:225], v[56:59]
ds_read_b128 a[192:195], v36 offset:21504
v_mfma_f32_16x16x32_bf16 v[28:31], a[212:215], v[226:229], v[28:31]
s_add_u32 s60, s60, s98
v_mfma_f32_16x16x32_bf16 v[60:63], a[216:219], v[222:225], v[60:63]
ds_read_b128 a[196:199], v40 offset:18432
v_mfma_f32_16x16x32_bf16 v[32:35], a[216:219], v[226:229], v[32:35]
s_waitcnt lgkmcnt(5)
v_mfma_f32_16x16x32_bf16 v[44:47], a[160:163], v[230:233], v[44:47]
ds_read_b128 a[200:203], v36 offset:23040
v_mfma_f32_16x16x32_bf16 v[16:19], a[160:163], v[234:237], v[16:19]
v_mfma_f32_16x16x32_bf16 v[48:51], a[164:167], v[230:233], v[48:51]
ds_read_b128 a[204:207], v36 offset:24064
buffer_load_dwordx4 a[36:39], v1, s[8:11], s60 offen offset:1024 sc1
v_mfma_f32_16x16x32_bf16 v[20:23], a[164:167], v[234:237], v[20:23]
v_mov_b32 v79, v248
v_mfma_f32_16x16x32_bf16 v[52:55], a[168:171], v[230:233], v[52:55]
ds_read_b128 a[208:211], v36 offset:25088
v_mfma_f32_16x16x32_bf16 v[24:27], a[168:171], v[234:237], v[24:27]
v_mfma_f32_16x16x32_bf16 v[56:59], a[172:175], v[230:233], v[56:59]
ds_read_b128 a[212:215], v36 offset:26112
v_mfma_f32_16x16x32_bf16 v[28:31], a[172:175], v[234:237], v[28:31]
v_mfma_f32_16x16x32_bf16 v[60:63], a[176:179], v[230:233], v[60:63]
ds_read_b128 a[216:219], v40 offset:23040
v_mfma_f32_16x16x32_bf16 v[32:35], a[176:179], v[234:237], v[32:35]
s_waitcnt vmcnt(9) lgkmcnt(5)
v_mfma_f32_16x16x32_bf16 v[44:47], a[180:183], a[0:3], v[44:47]
ds_read_b128 a[160:163], v36 offset:27648
buffer_load_dwordx4 a[40:43], v1, s[8:11], s60 offen offset:2048 sc1
v_mfma_f32_16x16x32_bf16 v[48:51], a[184:187], a[0:3], v[48:51]
ds_read_b128 a[164:167], v36 offset:28672
v_mfma_f32_16x16x32_bf16 v[52:55], a[188:191], a[0:3], v[52:55]
ds_read_b128 a[168:171], v36 offset:29696
v_mfma_f32_16x16x32_bf16 v[56:59], a[192:195], a[0:3], v[56:59]
ds_read_b128 a[172:175], v36 offset:30720
v_mfma_f32_16x16x32_bf16 v[60:63], a[196:199], a[0:3], v[60:63]
ds_read_b128 a[176:179], v40 offset:27648
s_waitcnt vmcnt(9) lgkmcnt(5)
v_mfma_f32_16x16x32_bf16 v[44:47], a[200:203], a[4:7], v[44:47]
ds_read_b128 a[180:183], v36 offset:32256
buffer_load_dwordx4 a[44:47], v1, s[8:11], s60 offen offset:3072 sc1
v_mfma_f32_16x16x32_bf16 v[48:51], a[204:207], a[4:7], v[48:51]
ds_read_b128 a[184:187], v36 offset:33280
v_mfma_f32_16x16x32_bf16 v[52:55], a[208:211], a[4:7], v[52:55]
ds_read_b128 a[188:191], v36 offset:34304
v_mfma_f32_16x16x32_bf16 v[56:59], a[212:215], a[4:7], v[56:59]
ds_read_b128 a[192:195], v36 offset:35328
v_mfma_f32_16x16x32_bf16 v[60:63], a[216:219], a[4:7], v[60:63]
ds_read_b128 a[196:199], v40 offset:32256
s_waitcnt vmcnt(9) lgkmcnt(5)
v_mfma_f32_16x16x32_bf16 v[44:47], a[160:163], a[8:11], v[44:47]
ds_read_b128 a[200:203], v36 offset:36864
s_add_u32 s60, s60, 4096
v_mfma_f32_16x16x32_bf16 v[48:51], a[164:167], a[8:11], v[48:51]
ds_read_b128 a[204:207], v36 offset:37888
buffer_load_dwordx4 a[48:51], v1, s[8:11], s60 offen offset:0 sc1
v_mfma_f32_16x16x32_bf16 v[52:55], a[168:171], a[8:11], v[52:55]
ds_read_b128 a[208:211], v36 offset:38912
buffer_load_dwordx4 a[52:55], v1, s[8:11], s60 offen offset:1024 sc1
v_mfma_f32_16x16x32_bf16 v[56:59], a[172:175], a[8:11], v[56:59]
ds_read_b128 a[212:215], v36 offset:39936
v_mfma_f32_16x16x32_bf16 v[60:63], a[176:179], a[8:11], v[60:63]
ds_read_b128 a[216:219], v40 offset:36864
s_waitcnt vmcnt(10) lgkmcnt(5)
v_mfma_f32_16x16x32_bf16 v[44:47], a[180:183], a[12:15], v[44:47]
ds_read_b128 a[160:163], v36 offset:41472
v_mfma_f32_16x16x32_bf16 v[48:51], a[184:187], a[12:15], v[48:51]
ds_read_b128 a[164:167], v36 offset:42496
v_mfma_f32_16x16x32_bf16 v[52:55], a[188:191], a[12:15], v[52:55]
ds_read_b128 a[168:171], v36 offset:43520
v_mfma_f32_16x16x32_bf16 v[56:59], a[192:195], a[12:15], v[56:59]
ds_read_b128 a[172:175], v36 offset:44544
s_cmp_eq_u32 s71, 14
s_cselect_b32 s98, 4096, 0
s_add_u32 s60, s60, s98
buffer_load_dwordx4 a[56:59], v1, s[8:11], s60 offen offset:2048 sc1
v_mfma_f32_16x16x32_bf16 v[60:63], a[196:199], a[12:15], v[60:63]
ds_read_b128 a[176:179], v40 offset:41472
s_waitcnt vmcnt(10) lgkmcnt(5)
v_mfma_f32_16x16x32_bf16 v[44:47], a[200:203], a[16:19], v[44:47]
ds_read_b128 a[180:183], v36 offset:46080
buffer_load_dwordx4 a[60:63], v1, s[8:11], s60 offen offset:3072 sc1
v_mfma_f32_16x16x32_bf16 v[48:51], a[204:207], a[16:19], v[48:51]
ds_read_b128 a[184:187], v36 offset:47104
v_mfma_f32_16x16x32_bf16 v[52:55], a[208:211], a[16:19], v[52:55]
ds_read_b128 a[188:191], v36 offset:48128
v_mfma_f32_16x16x32_bf16 v[56:59], a[212:215], a[16:19], v[56:59]
ds_read_b128 a[192:195], v36 offset:49152
v_mfma_f32_16x16x32_bf16 v[60:63], a[216:219], a[16:19], v[60:63]
ds_read_b128 a[196:199], v40 offset:46080
s_barrier
s_waitcnt vmcnt(10) lgkmcnt(5)
v_mfma_f32_16x16x32_bf16 v[44:47], a[160:163], a[20:23], v[44:47]
ds_read_b128 a[200:203], v36 offset:50688
s_add_u32 s60, s60, 4096
v_mfma_f32_16x16x32_bf16 v[48:51], a[164:167], a[20:23], v[48:51]
ds_read_b128 a[204:207], v36 offset:51712
buffer_load_dwordx4 a[64:67], v1, s[8:11], s60 offen offset:0 sc1
v_mfma_f32_16x16x32_bf16 v[52:55], a[168:171], a[20:23], v[52:55]
ds_read_b128 a[208:211], v36 offset:52736
buffer_load_dwordx4 a[0:3], v1, s[8:11], s60 offen offset:1024 sc1
v_mfma_f32_16x16x32_bf16 v[56:59], a[172:175], a[20:23], v[56:59]
ds_read_b128 a[212:215], v36 offset:53760
v_mfma_f32_16x16x32_bf16 v[60:63], a[176:179], a[20:23], v[60:63]
ds_read_b128 a[216:219], v40 offset:50688
s_waitcnt vmcnt(11) lgkmcnt(5)
v_mfma_f32_16x16x32_bf16 v[44:47], a[180:183], a[24:27], v[44:47]
ds_read_b128 a[160:163], v37 offset:0
v_mfma_f32_16x16x32_bf16 v[48:51], a[184:187], a[24:27], v[48:51]
ds_read_b128 a[164:167], v37 offset:1024
v_mfma_f32_16x16x32_bf16 v[52:55], a[188:191], a[24:27], v[52:55]
ds_read_b128 a[168:171], v37 offset:2048
v_mfma_f32_16x16x32_bf16 v[56:59], a[192:195], a[24:27], v[56:59]
ds_read_b128 a[172:175], v37 offset:3072
s_cmp_eq_u32 s71, 18
s_cselect_b32 s98, 4096, 0
s_add_u32 s60, s60, s98
buffer_load_dwordx4 a[4:7], v1, s[8:11], s60 offen offset:2048 sc1
v_mfma_f32_16x16x32_bf16 v[60:63], a[196:199], a[24:27], v[60:63]
ds_read_b128 a[176:179], v41 offset:0
s_waitcnt vmcnt(11) lgkmcnt(5)
v_mfma_f32_16x16x32_bf16 v[44:47], a[200:203], a[28:31], v[44:47]
ds_read_b128 a[180:183], v37 offset:4608
buffer_load_dwordx4 a[8:11], v1, s[8:11], s60 offen offset:3072 sc1
v_mfma_f32_16x16x32_bf16 v[48:51], a[204:207], a[28:31], v[48:51]
ds_read_b128 a[184:187], v37 offset:5632
v_mfma_f32_16x16x32_bf16 v[52:55], a[208:211], a[28:31], v[52:55]
ds_read_b128 a[188:191], v37 offset:6656
v_mfma_f32_16x16x32_bf16 v[56:59], a[212:215], a[28:31], v[56:59]
ds_read_b128 a[192:195], v37 offset:7680
v_mfma_f32_16x16x32_bf16 v[60:63], a[216:219], a[28:31], v[60:63]
ds_read_b128 a[196:199], v41 offset:4608
s_waitcnt vmcnt(11) lgkmcnt(5)
v_mfma_f32_16x16x32_bf16 v[44:47], a[160:163], a[32:35], v[44:47]
ds_read_b128 a[200:203], v37 offset:9216
s_add_u32 s60, s60, 4096
v_mfma_f32_16x16x32_bf16 v[48:51], a[164:167], a[32:35], v[48:51]
ds_read_b128 a[204:207], v37 offset:10240
buffer_load_dwordx4 a[12:15], v1, s[8:11], s60 offen offset:0 sc1
v_mfma_f32_16x16x32_bf16 v[52:55], a[168:171], a[32:35], v[52:55]
ds_read_b128 a[208:211], v37 offset:11264
buffer_load_dwordx4 a[16:19], v1, s[8:11], s60 offen offset:1024 sc1
v_mfma_f32_16x16x32_bf16 v[56:59], a[172:175], a[32:35], v[56:59]
ds_read_b128 a[212:215], v37 offset:12288
v_mfma_f32_16x16x32_bf16 v[60:63], a[176:179], a[32:35], v[60:63]
ds_read_b128 a[216:219], v41 offset:9216
s_waitcnt vmcnt(12) lgkmcnt(5)
v_mfma_f32_16x16x32_bf16 v[44:47], a[180:183], a[36:39], v[44:47]
ds_read_b128 a[160:163], v37 offset:13824
buffer_load_dwordx4 a[20:23], v1, s[8:11], s60 offen offset:2048 sc1
v_mfma_f32_16x16x32_bf16 v[48:51], a[184:187], a[36:39], v[48:51]
ds_read_b128 a[164:167], v37 offset:14848
v_mfma_f32_16x16x32_bf16 v[52:55], a[188:191], a[36:39], v[52:55]
ds_read_b128 a[168:171], v37 offset:15872
v_mfma_f32_16x16x32_bf16 v[56:59], a[192:195], a[36:39], v[56:59]
ds_read_b128 a[172:175], v37 offset:16896
v_mfma_f32_16x16x32_bf16 v[60:63], a[196:199], a[36:39], v[60:63]
ds_read_b128 a[176:179], v41 offset:13824
s_waitcnt vmcnt(12) lgkmcnt(5)
v_mfma_f32_16x16x32_bf16 v[44:47], a[200:203], a[40:43], v[44:47]
ds_read_b128 a[180:183], v37 offset:18432
buffer_load_dwordx4 a[228:231], v1, s[4:7], s64 offen offset:2048 sc1
v_mfma_f32_16x16x32_bf16 v[48:51], a[204:207], a[40:43], v[48:51]
ds_read_b128 a[184:187], v37 offset:19456
v_mfma_f32_16x16x32_bf16 v[52:55], a[208:211], a[40:43], v[52:55]
ds_read_b128 a[188:191], v37 offset:20480
v_mfma_f32_16x16x32_bf16 v[56:59], a[212:215], a[40:43], v[56:59]
ds_read_b128 a[192:195], v37 offset:21504
s_cmp_eq_u32 s71, 23
s_cselect_b32 s98, 4096, 0
s_add_u32 s60, s60, s98
buffer_load_dwordx4 a[24:27], v1, s[8:11], s60 offen offset:3072 sc1
v_mfma_f32_16x16x32_bf16 v[60:63], a[216:219], a[40:43], v[60:63]
ds_read_b128 a[196:199], v41 offset:18432
s_waitcnt vmcnt(13) lgkmcnt(5)
v_mfma_f32_16x16x32_bf16 v[44:47], a[160:163], a[44:47], v[44:47]
ds_read_b128 a[200:203], v37 offset:23040
s_add_u32 s60, s60, 4096
v_mfma_f32_16x16x32_bf16 v[48:51], a[164:167], a[44:47], v[48:51]
ds_read_b128 a[204:207], v37 offset:24064
buffer_load_dwordx4 a[28:31], v1, s[8:11], s60 offen offset:0 sc1
v_mfma_f32_16x16x32_bf16 v[52:55], a[168:171], a[44:47], v[52:55]
ds_read_b128 a[208:211], v37 offset:25088
buffer_load_dwordx4 a[32:35], v1, s[8:11], s60 offen offset:1024 sc1
v_mfma_f32_16x16x32_bf16 v[56:59], a[172:175], a[44:47], v[56:59]
ds_read_b128 a[212:215], v37 offset:26112
v_mfma_f32_16x16x32_bf16 v[60:63], a[176:179], a[44:47], v[60:63]
ds_read_b128 a[216:219], v41 offset:23040
s_waitcnt vmcnt(14) lgkmcnt(5)
v_mfma_f32_16x16x32_bf16 v[44:47], a[180:183], a[48:51], v[44:47]
ds_read_b128 a[160:163], v37 offset:27648
buffer_load_dwordx4 a[36:39], v1, s[8:11], s60 offen offset:2048 sc1
v_mfma_f32_16x16x32_bf16 v[48:51], a[184:187], a[48:51], v[48:51]
ds_read_b128 a[164:167], v37 offset:28672
v_mfma_f32_16x16x32_bf16 v[52:55], a[188:191], a[48:51], v[52:55]
ds_read_b128 a[168:171], v37 offset:29696
v_mfma_f32_16x16x32_bf16 v[56:59], a[192:195], a[48:51], v[56:59]
ds_read_b128 a[172:175], v37 offset:30720
buffer_load_dwordx4 a[232:235], v1, s[4:7], s64 offen offset:3072 sc1
v_mfma_f32_16x16x32_bf16 v[60:63], a[196:199], a[48:51], v[60:63]
ds_read_b128 a[176:179], v41 offset:27648
s_waitcnt vmcnt(15) lgkmcnt(5)
v_mfma_f32_16x16x32_bf16 v[44:47], a[200:203], a[52:55], v[44:47]
ds_read_b128 a[180:183], v37 offset:32256
v_mfma_f32_16x16x32_bf16 v[48:51], a[204:207], a[52:55], v[48:51]
ds_read_b128 a[184:187], v37 offset:33280
v_mfma_f32_16x16x32_bf16 v[52:55], a[208:211], a[52:55], v[52:55]
ds_read_b128 a[188:191], v37 offset:34304
v_mfma_f32_16x16x32_bf16 v[56:59], a[212:215], a[52:55], v[56:59]
ds_read_b128 a[192:195], v37 offset:35328
s_cmp_eq_u32 s71, 27
s_cselect_b32 s98, 4096, 0
s_add_u32 s60, s60, s98
buffer_load_dwordx4 a[40:43], v1, s[8:11], s60 offen offset:3072 sc1
v_mfma_f32_16x16x32_bf16 v[60:63], a[216:219], a[52:55], v[60:63]
ds_read_b128 a[196:199], v41 offset:32256
s_waitcnt vmcnt(15) lgkmcnt(5)
v_mfma_f32_16x16x32_bf16 v[44:47], a[160:163], a[56:59], v[44:47]
ds_read_b128 a[200:203], v37 offset:36864
s_add_u32 s60, s60, 4096
v_mfma_f32_16x16x32_bf16 v[48:51], a[164:167], a[56:59], v[48:51]
ds_read_b128 a[204:207], v37 offset:37888
buffer_load_dwordx4 a[44:47], v1, s[8:11], s60 offen offset:0 sc1
v_mfma_f32_16x16x32_bf16 v[52:55], a[168:171], a[56:59], v[52:55]
ds_read_b128 a[208:211], v37 offset:38912
buffer_load_dwordx4 a[48:51], v1, s[8:11], s60 offen offset:1024 sc1
v_mfma_f32_16x16x32_bf16 v[56:59], a[172:175], a[56:59], v[56:59]
ds_read_b128 a[212:215], v37 offset:39936
v_mfma_f32_16x16x32_bf16 v[60:63], a[176:179], a[56:59], v[60:63]
ds_read_b128 a[216:219], v41 offset:36864
s_waitcnt vmcnt(16) lgkmcnt(5)
v_mfma_f32_16x16x32_bf16 v[44:47], a[180:183], a[60:63], v[44:47]
ds_read_b128 a[160:163], v37 offset:41472
buffer_load_dwordx4 a[52:55], v1, s[8:11], s60 offen offset:2048 sc1
v_mfma_f32_16x16x32_bf16 v[48:51], a[184:187], a[60:63], v[48:51]
ds_read_b128 a[164:167], v37 offset:42496
v_mfma_f32_16x16x32_bf16 v[52:55], a[188:191], a[60:63], v[52:55]
ds_read_b128 a[168:171], v37 offset:43520
buffer_load_dwordx4 a[236:239], v116, s[4:7], s64 offen sc1
v_mfma_f32_16x16x32_bf16 v[56:59], a[192:195], a[60:63], v[56:59]
ds_read_b128 a[172:175], v37 offset:44544
v_mfma_f32_16x16x32_bf16 v[60:63], a[196:199], a[60:63], v[60:63]
ds_read_b128 a[176:179], v41 offset:41472
s_waitcnt vmcnt(17) lgkmcnt(5)
v_mfma_f32_16x16x32_bf16 v[44:47], a[200:203], a[64:67], v[44:47]
ds_read_b128 a[180:183], v37 offset:46080
buffer_load_dwordx4 a[56:59], v1, s[8:11], s60 offen offset:3072 sc1
v_mfma_f32_16x16x32_bf16 v[48:51], a[204:207], a[64:67], v[48:51]
ds_read_b128 a[184:187], v37 offset:47104
v_mfma_f32_16x16x32_bf16 v[52:55], a[208:211], a[64:67], v[52:55]
ds_read_b128 a[188:191], v37 offset:48128
v_mfma_f32_16x16x32_bf16 v[56:59], a[212:215], a[64:67], v[56:59]
ds_read_b128 a[192:195], v37 offset:49152
v_mfma_f32_16x16x32_bf16 v[60:63], a[216:219], a[64:67], v[60:63]
ds_read_b128 a[196:199], v41 offset:46080
s_waitcnt vmcnt(17) lgkmcnt(5)
v_mfma_f32_16x16x32_bf16 v[44:47], a[160:163], a[0:3], v[44:47]
ds_read_b128 a[200:203], v37 offset:50688
s_mov_b32 s60, s61
v_mfma_f32_16x16x32_bf16 v[48:51], a[164:167], a[0:3], v[48:51]
ds_read_b128 a[204:207], v37 offset:51712
v_mfma_f32_16x16x32_bf16 v[52:55], a[168:171], a[0:3], v[52:55]
ds_read_b128 a[208:211], v37 offset:52736
v_mfma_f32_16x16x32_bf16 v[56:59], a[172:175], a[0:3], v[56:59]
ds_read_b128 a[212:215], v37 offset:53760
s_cmp_eq_u32 s71, 0
s_cselect_b32 s98, 4096, 0
s_add_u32 s60, s60, s98
buffer_load_dwordx4 a[60:63], v1, s[8:11], s60 offen offset:0 sc1
buffer_load_dwordx4 a[64:67], v1, s[8:11], s60 offen offset:1024 sc1
v_mfma_f32_16x16x32_bf16 v[60:63], a[176:179], a[0:3], v[60:63]
ds_read_b128 a[216:219], v41 offset:50688
s_waitcnt vmcnt(18) lgkmcnt(5)
v_mfma_f32_16x16x32_bf16 v[44:47], a[180:183], a[4:7], v[44:47]
ds_read_b128 a[160:163], v38 offset:0
buffer_load_dwordx4 a[0:3], v1, s[8:11], s60 offen offset:2048 sc1
v_mfma_f32_16x16x32_bf16 v[48:51], a[184:187], a[4:7], v[48:51]
ds_read_b128 a[164:167], v38 offset:1024
v_mfma_f32_16x16x32_bf16 v[52:55], a[188:191], a[4:7], v[52:55]
ds_read_b128 a[168:171], v38 offset:2048
v_mfma_f32_16x16x32_bf16 v[56:59], a[192:195], a[4:7], v[56:59]
ds_read_b128 a[172:175], v38 offset:3072
v_mfma_f32_16x16x32_bf16 v[60:63], a[196:199], a[4:7], v[60:63]
ds_read_b128 a[176:179], v42 offset:0
s_waitcnt vmcnt(18) lgkmcnt(5)
v_mfma_f32_16x16x32_bf16 v[44:47], a[200:203], a[8:11], v[44:47]
ds_read_b128 a[180:183], v38 offset:4608
buffer_load_dwordx4 a[4:7], v1, s[8:11], s60 offen offset:3072 sc1
v_mfma_f32_16x16x32_bf16 v[48:51], a[204:207], a[8:11], v[48:51]
ds_read_b128 a[184:187], v38 offset:5632
v_mfma_f32_16x16x32_bf16 v[52:55], a[208:211], a[8:11], v[52:55]
ds_read_b128 a[188:191], v38 offset:6656
v_mfma_f32_16x16x32_bf16 v[56:59], a[212:215], a[8:11], v[56:59]
ds_read_b128 a[192:195], v38 offset:7680
v_mfma_f32_16x16x32_bf16 v[60:63], a[216:219], a[8:11], v[60:63]
ds_read_b128 a[196:199], v42 offset:4608
s_waitcnt vmcnt(18) lgkmcnt(5)
v_mfma_f32_16x16x32_bf16 v[44:47], a[160:163], a[12:15], v[44:47]
ds_read_b128 a[200:203], v38 offset:9216
s_add_u32 s60, s60, 4096
v_mfma_f32_16x16x32_bf16 v[48:51], a[164:167], a[12:15], v[48:51]
ds_read_b128 a[204:207], v38 offset:10240
v_mfma_f32_16x16x32_bf16 v[52:55], a[168:171], a[12:15], v[52:55]
ds_read_b128 a[208:211], v38 offset:11264
buffer_load_dwordx4 a[8:11], v1, s[8:11], s60 offen offset:0 sc1
v_mfma_f32_16x16x32_bf16 v[56:59], a[172:175], a[12:15], v[56:59]
ds_read_b128 a[212:215], v38 offset:12288
v_mfma_f32_16x16x32_bf16 v[60:63], a[176:179], a[12:15], v[60:63]
ds_read_b128 a[216:219], v42 offset:9216
s_waitcnt vmcnt(18) lgkmcnt(5)
v_mfma_f32_16x16x32_bf16 v[44:47], a[180:183], a[16:19], v[44:47]
ds_read_b128 a[160:163], v38 offset:13824
v_mfma_f32_16x16x32_bf16 v[48:51], a[184:187], a[16:19], v[48:51]
ds_read_b128 a[164:167], v38 offset:14848
v_mfma_f32_16x16x32_bf16 v[52:55], a[188:191], a[16:19], v[52:55]
ds_read_b128 a[168:171], v38 offset:15872
v_mfma_f32_16x16x32_bf16 v[56:59], a[192:195], a[16:19], v[56:59]
ds_read_b128 a[172:175], v38 offset:16896
s_cmp_eq_u32 s71, 5
s_cselect_b32 s98, 4096, 0
s_add_u32 s60, s60, s98
buffer_load_dwordx4 a[12:15], v1, s[8:11], s60 offen offset:1024 sc1
v_mfma_f32_16x16x32_bf16 v[60:63], a[196:199], a[16:19], v[60:63]
ds_read_b128 a[176:179], v42 offset:13824
s_waitcnt vmcnt(18) lgkmcnt(5)
v_mfma_f32_16x16x32_bf16 v[44:47], a[200:203], a[20:23], v[44:47]
ds_read_b128 a[180:183], v38 offset:18432
buffer_load_dwordx4 a[16:19], v1, s[8:11], s60 offen offset:2048 sc1
v_mfma_f32_16x16x32_bf16 v[48:51], a[204:207], a[20:23], v[48:51]
ds_read_b128 a[184:187], v38 offset:19456
v_mfma_f32_16x16x32_bf16 v[52:55], a[208:211], a[20:23], v[52:55]
ds_read_b128 a[188:191], v38 offset:20480
v_mfma_f32_16x16x32_bf16 v[56:59], a[212:215], a[20:23], v[56:59]
ds_read_b128 a[192:195], v38 offset:21504
v_mfma_f32_16x16x32_bf16 v[60:63], a[216:219], a[20:23], v[60:63]
ds_read_b128 a[196:199], v42 offset:18432
s_waitcnt vmcnt(17) lgkmcnt(5)
v_mfma_f32_16x16x32_bf16 v[44:47], a[160:163], a[24:27], v[44:47]
ds_read_b128 a[200:203], v38 offset:23040
buffer_load_dwordx4 a[20:23], v1, s[8:11], s60 offen offset:3072 sc1
v_mfma_f32_16x16x32_bf16 v[48:51], a[164:167], a[24:27], v[48:51]
ds_read_b128 a[204:207], v38 offset:24064
v_mfma_f32_16x16x32_bf16 v[52:55], a[168:171], a[24:27], v[52:55]
ds_read_b128 a[208:211], v38 offset:25088
v_mfma_f32_16x16x32_bf16 v[56:59], a[172:175], a[24:27], v[56:59]
ds_read_b128 a[212:215], v38 offset:26112
v_mfma_f32_16x16x32_bf16 v[60:63], a[176:179], a[24:27], v[60:63]
ds_read_b128 a[216:219], v42 offset:23040
s_waitcnt vmcnt(17) lgkmcnt(5)
v_mfma_f32_16x16x32_bf16 v[44:47], a[180:183], a[28:31], v[44:47]
ds_read_b128 a[160:163], v38 offset:27648
s_add_u32 s60, s60, 4096
v_mfma_f32_16x16x32_bf16 v[48:51], a[184:187], a[28:31], v[48:51]
ds_read_b128 a[164:167], v38 offset:28672
v_mfma_f32_16x16x32_bf16 v[52:55], a[188:191], a[28:31], v[52:55]
ds_read_b128 a[168:171], v38 offset:29696
buffer_load_dwordx4 a[24:27], v1, s[8:11], s60 offen offset:0 sc1
v_mfma_f32_16x16x32_bf16 v[56:59], a[192:195], a[28:31], v[56:59]
ds_read_b128 a[172:175], v38 offset:30720
v_mfma_f32_16x16x32_bf16 v[60:63], a[196:199], a[28:31], v[60:63]
ds_read_b128 a[176:179], v42 offset:27648
s_waitcnt vmcnt(17) lgkmcnt(5)
v_mfma_f32_16x16x32_bf16 v[44:47], a[200:203], a[32:35], v[44:47]
ds_read_b128 a[180:183], v38 offset:32256
v_mfma_f32_16x16x32_bf16 v[48:51], a[204:207], a[32:35], v[48:51]
ds_read_b128 a[184:187], v38 offset:33280
v_mfma_f32_16x16x32_bf16 v[52:55], a[208:211], a[32:35], v[52:55]
ds_read_b128 a[188:191], v38 offset:34304
v_mfma_f32_16x16x32_bf16 v[56:59], a[212:215], a[32:35], v[56:59]
ds_read_b128 a[192:195], v38 offset:35328
s_cmp_eq_u32 s71, 9
s_cselect_b32 s98, 4096, 0
s_add_u32 s60, s60, s98
buffer_load_dwordx4 a[28:31], v1, s[8:11], s60 offen offset:1024 sc1
v_mfma_f32_16x16x32_bf16 v[60:63], a[216:219], a[32:35], v[60:63]
ds_read_b128 a[196:199], v42 offset:32256
s_waitcnt vmcnt(17) lgkmcnt(5)
v_mfma_f32_16x16x32_bf16 v[44:47], a[160:163], a[36:39], v[44:47]
ds_read_b128 a[200:203], v38 offset:36864
buffer_load_dwordx4 a[32:35], v1, s[8:11], s60 offen offset:2048 sc1
v_mfma_f32_16x16x32_bf16 v[48:51], a[164:167], a[36:39], v[48:51]
ds_read_b128 a[204:207], v38 offset:37888
v_mfma_f32_16x16x32_bf16 v[52:55], a[168:171], a[36:39], v[52:55]
ds_read_b128 a[208:211], v38 offset:38912
v_mfma_f32_16x16x32_bf16 v[56:59], a[172:175], a[36:39], v[56:59]
ds_read_b128 a[212:215], v38 offset:39936
v_mfma_f32_16x16x32_bf16 v[60:63], a[176:179], a[36:39], v[60:63]
ds_read_b128 a[216:219], v42 offset:36864
s_waitcnt vmcnt(16) lgkmcnt(5)
v_mfma_f32_16x16x32_bf16 v[44:47], a[180:183], a[40:43], v[44:47]
ds_read_b128 a[160:163], v38 offset:41472
buffer_load_dwordx4 a[36:39], v1, s[8:11], s60 offen offset:3072 sc1
v_mfma_f32_16x16x32_bf16 v[48:51], a[184:187], a[40:43], v[48:51]
ds_read_b128 a[164:167], v38 offset:42496
v_mfma_f32_16x16x32_bf16 v[52:55], a[188:191], a[40:43], v[52:55]
ds_read_b128 a[168:171], v38 offset:43520
v_mfma_f32_16x16x32_bf16 v[56:59], a[192:195], a[40:43], v[56:59]
ds_read_b128 a[172:175], v38 offset:44544
v_mfma_f32_16x16x32_bf16 v[60:63], a[196:199], a[40:43], v[60:63]
ds_read_b128 a[176:179], v42 offset:41472
s_waitcnt vmcnt(16) lgkmcnt(5)
v_mfma_f32_16x16x32_bf16 v[44:47], a[200:203], a[44:47], v[44:47]
ds_read_b128 a[180:183], v38 offset:46080
s_add_u32 s60, s60, 4096
v_mfma_f32_16x16x32_bf16 v[48:51], a[204:207], a[44:47], v[48:51]
ds_read_b128 a[184:187], v38 offset:47104
v_mfma_f32_16x16x32_bf16 v[52:55], a[208:211], a[44:47], v[52:55]
ds_read_b128 a[188:191], v38 offset:48128
buffer_load_dwordx4 a[40:43], v1, s[8:11], s60 offen offset:0 sc1
v_mfma_f32_16x16x32_bf16 v[56:59], a[212:215], a[44:47], v[56:59]
ds_read_b128 a[192:195], v38 offset:49152
v_mfma_f32_16x16x32_bf16 v[60:63], a[216:219], a[44:47], v[60:63]
ds_read_b128 a[196:199], v42 offset:46080
s_waitcnt vmcnt(16) lgkmcnt(5)
v_mfma_f32_16x16x32_bf16 v[44:47], a[160:163], a[48:51], v[44:47]
ds_read_b128 a[200:203], v38 offset:50688
buffer_load_dwordx4 a[44:47], v1, s[8:11], s60 offen offset:1024 sc1
v_mfma_f32_16x16x32_bf16 v[48:51], a[164:167], a[48:51], v[48:51]
ds_read_b128 a[204:207], v38 offset:51712
v_mfma_f32_16x16x32_bf16 v[52:55], a[168:171], a[48:51], v[52:55]
v_mfma_f32_16x16x32_bf16 v[56:59], a[172:175], a[48:51], v[56:59]
v_mfma_f32_16x16x32_bf16 v[60:63], a[176:179], a[48:51], v[60:63]
s_waitcnt vmcnt(16) lgkmcnt(2)
v_mfma_f32_16x16x32_bf16 v[44:47], a[180:183], a[52:55], v[44:47]
ds_read_b128 a[160:163], v36 offset:18432
v_mfma_f32_16x16x32_bf16 v[48:51], a[184:187], a[52:55], v[48:51]
ds_read_b128 a[164:167], v36 offset:19456
v_mfma_f32_16x16x32_bf16 v[52:55], a[188:191], a[52:55], v[52:55]
ds_read_b128 a[168:171], v36 offset:20480
v_mfma_f32_16x16x32_bf16 v[56:59], a[192:195], a[52:55], v[56:59]
ds_read_b128 a[172:175], v36 offset:21504
s_cmp_eq_u32 s71, 14
s_cselect_b32 s98, 4096, 0
s_add_u32 s60, s60, s98
buffer_load_dwordx4 a[48:51], v1, s[8:11], s60 offen offset:2048 sc1
v_mfma_f32_16x16x32_bf16 v[60:63], a[196:199], a[52:55], v[60:63]
ds_read_b128 a[176:179], v40 offset:18432
s_waitcnt vmcnt(15) lgkmcnt(5)
v_mfma_f32_16x16x32_bf16 v[44:47], a[200:203], a[56:59], v[44:47]
ds_read_b128 a[180:183], v36 offset:23040
buffer_load_dwordx4 a[52:55], v1, s[8:11], s60 offen offset:3072 sc1
v_mfma_f32_16x16x32_bf16 v[48:51], a[204:207], a[56:59], v[48:51]
ds_read_b128 a[184:187], v36 offset:24064
v_mfma_f32_16x16x32_bf16 v[52:55], a[228:231], a[56:59], v[52:55]
ds_read_b128 a[188:191], v36 offset:25088
v_mfma_f32_16x16x32_bf16 v[56:59], a[232:235], a[56:59], v[56:59]
ds_read_b128 a[192:195], v36 offset:26112
v_mfma_f32_16x16x32_bf16 v[60:63], a[236:239], a[56:59], v[60:63]
ds_read_b128 a[196:199], v40 offset:23040
s_waitcnt vmcnt(15) lgkmcnt(5)
v_mfma_f32_16x16x32_bf16 v[16:19], a[160:163], a[60:63], v[16:19]
ds_read_b128 a[200:203], v36 offset:27648
s_add_u32 s60, s60, 4096
v_mfma_f32_16x16x32_bf16 v[20:23], a[164:167], a[60:63], v[20:23]
ds_read_b128 a[204:207], v36 offset:28672
v_mfma_f32_16x16x32_bf16 v[24:27], a[168:171], a[60:63], v[24:27]
ds_read_b128 a[208:211], v36 offset:29696
buffer_load_dwordx4 a[56:59], v1, s[8:11], s60 offen offset:0 sc1
v_mfma_f32_16x16x32_bf16 v[28:31], a[172:175], a[60:63], v[28:31]
ds_read_b128 a[212:215], v36 offset:30720
v_mfma_f32_16x16x32_bf16 v[32:35], a[176:179], a[60:63], v[32:35]
ds_read_b128 a[216:219], v40 offset:27648
s_waitcnt vmcnt(15) lgkmcnt(5)
v_mfma_f32_16x16x32_bf16 v[16:19], a[180:183], a[64:67], v[16:19]
ds_read_b128 a[160:163], v36 offset:32256
buffer_load_dwordx4 a[60:63], v1, s[8:11], s60 offen offset:1024 sc1
v_mfma_f32_16x16x32_bf16 v[20:23], a[184:187], a[64:67], v[20:23]
ds_read_b128 a[164:167], v36 offset:33280
v_mfma_f32_16x16x32_bf16 v[24:27], a[188:191], a[64:67], v[24:27]
ds_read_b128 a[168:171], v36 offset:34304
v_mfma_f32_16x16x32_bf16 v[28:31], a[192:195], a[64:67], v[28:31]
ds_read_b128 a[172:175], v36 offset:35328
v_cvt_pk_bf16_f32 v64, v44, v45
v_mfma_f32_16x16x32_bf16 v[32:35], a[196:199], a[64:67], v[32:35]
ds_read_b128 a[176:179], v40 offset:32256
s_waitcnt vmcnt(15) lgkmcnt(5)
v_mfma_f32_16x16x32_bf16 v[16:19], a[200:203], a[0:3], v[16:19]
ds_read_b128 a[180:183], v36 offset:36864
v_cvt_pk_bf16_f32 v65, v46, v47
v_mfma_f32_16x16x32_bf16 v[20:23], a[204:207], a[0:3], v[20:23]
ds_read_b128 a[184:187], v36 offset:37888
v_mfma_f32_16x16x32_bf16 v[24:27], a[208:211], a[0:3], v[24:27]
ds_read_b128 a[188:191], v36 offset:38912
v_cvt_pk_bf16_f32 v66, v48, v49
v_mfma_f32_16x16x32_bf16 v[28:31], a[212:215], a[0:3], v[28:31]
ds_read_b128 a[192:195], v36 offset:39936
s_cmp_eq_u32 s71, 18
s_cselect_b32 s98, 4096, 0
s_add_u32 s60, s60, s98
buffer_load_dwordx4 a[64:67], v1, s[8:11], s60 offen offset:2048 sc1
v_mfma_f32_16x16x32_bf16 v[32:35], a[216:219], a[0:3], v[32:35]
ds_read_b128 a[196:199], v40 offset:36864
s_waitcnt vmcnt(15) lgkmcnt(5)
v_mfma_f32_16x16x32_bf16 v[16:19], a[160:163], a[4:7], v[16:19]
ds_read_b128 a[200:203], v36 offset:41472
buffer_load_dwordx4 a[0:3], v1, s[8:11], s60 offen offset:3072 sc1
v_mfma_f32_16x16x32_bf16 v[20:23], a[164:167], a[4:7], v[20:23]
ds_read_b128 a[204:207], v36 offset:42496
buffer_store_dwordx4 v[64:67], v1, s[8:11], s62 offen offset:0 sc1
v_mfma_f32_16x16x32_bf16 v[24:27], a[168:171], a[4:7], v[24:27]
ds_read_b128 a[208:211], v36 offset:43520
v_cvt_pk_bf16_f32 v68, v50, v51
v_mfma_f32_16x16x32_bf16 v[28:31], a[172:175], a[4:7], v[28:31]
ds_read_b128 a[212:215], v36 offset:44544
v_cvt_pk_bf16_f32 v69, v52, v53
v_mfma_f32_16x16x32_bf16 v[32:35], a[176:179], a[4:7], v[32:35]
ds_read_b128 a[216:219], v40 offset:41472
s_waitcnt vmcnt(16) lgkmcnt(5)
v_mfma_f32_16x16x32_bf16 v[16:19], a[180:183], a[8:11], v[16:19]
ds_read_b128 a[160:163], v36 offset:46080
s_add_u32 s60, s60, 4096
v_mfma_f32_16x16x32_bf16 v[20:23], a[184:187], a[8:11], v[20:23]
ds_read_b128 a[164:167], v36 offset:47104
v_cvt_pk_bf16_f32 v70, v54, v55
v_mfma_f32_16x16x32_bf16 v[24:27], a[188:191], a[8:11], v[24:27]
ds_read_b128 a[168:171], v36 offset:48128
buffer_load_dwordx4 a[4:7], v1, s[8:11], s60 offen offset:0 sc1
v_mfma_f32_16x16x32_bf16 v[28:31], a[192:195], a[8:11], v[28:31]
ds_read_b128 a[172:175], v36 offset:49152
buffer_store_dwordx4 v[68:71], v1, s[8:11], s62 offen offset:1024 sc1
v_mfma_f32_16x16x32_bf16 v[32:35], a[196:199], a[8:11], v[32:35]
ds_read_b128 a[176:179], v40 offset:46080
s_waitcnt vmcnt(17) lgkmcnt(5)
v_mfma_f32_16x16x32_bf16 v[16:19], a[200:203], a[12:15], v[16:19]
ds_read_b128 a[180:183], v36 offset:50688
buffer_load_dwordx4 a[8:11], v1, s[8:11], s60 offen offset:1024 sc1
v_mfma_f32_16x16x32_bf16 v[20:23], a[204:207], a[12:15], v[20:23]
ds_read_b128 a[184:187], v36 offset:51712
v_cvt_pk_bf16_f32 v72, v56, v57
v_mfma_f32_16x16x32_bf16 v[24:27], a[208:211], a[12:15], v[24:27]
ds_read_b128 a[188:191], v36 offset:52736
v_cvt_pk_bf16_f32 v73, v58, v59
v_mfma_f32_16x16x32_bf16 v[28:31], a[212:215], a[12:15], v[28:31]
ds_read_b128 a[192:195], v36 offset:53760
v_cvt_pk_bf16_f32 v74, v60, v61
v_mfma_f32_16x16x32_bf16 v[32:35], a[216:219], a[12:15], v[32:35]
ds_read_b128 a[196:199], v40 offset:50688
s_waitcnt vmcnt(17) lgkmcnt(5)
v_mfma_f32_16x16x32_bf16 v[16:19], a[160:163], a[16:19], v[16:19]
ds_read_b128 a[200:203], v37 offset:0
buffer_load_dwordx4 a[12:15], v1, s[8:11], s60 offen offset:2048 sc1
v_mfma_f32_16x16x32_bf16 v[20:23], a[164:167], a[16:19], v[20:23]
ds_read_b128 a[204:207], v37 offset:1024
buffer_store_dwordx4 v[72:75], v1, s[8:11], s62 offen offset:2048 sc1
v_mfma_f32_16x16x32_bf16 v[24:27], a[168:171], a[16:19], v[24:27]
ds_read_b128 a[208:211], v37 offset:2048
v_cvt_pk_bf16_f32 v76, v62, v63
v_mfma_f32_16x16x32_bf16 v[28:31], a[172:175], a[16:19], v[28:31]
ds_read_b128 a[212:215], v37 offset:3072
v_mfma_f32_16x16x32_bf16 v[32:35], a[176:179], a[16:19], v[32:35]
ds_read_b128 a[216:219], v41 offset:0
s_waitcnt vmcnt(18) lgkmcnt(5)
v_mfma_f32_16x16x32_bf16 v[16:19], a[180:183], a[20:23], v[16:19]
ds_read_b128 a[160:163], v37 offset:4608
buffer_store_dwordx4 v[76:79], v1, s[8:11], s62 offen offset:3072 sc1
v_mfma_f32_16x16x32_bf16 v[20:23], a[184:187], a[20:23], v[20:23]
ds_read_b128 a[164:167], v37 offset:5632
v_mfma_f32_16x16x32_bf16 v[24:27], a[188:191], a[20:23], v[24:27]
ds_read_b128 a[168:171], v37 offset:6656
v_mfma_f32_16x16x32_bf16 v[28:31], a[192:195], a[20:23], v[28:31]
ds_read_b128 a[172:175], v37 offset:7680
s_cmp_eq_u32 s71, 23
s_cselect_b32 s98, 4096, 0
s_add_u32 s60, s60, s98
buffer_load_dwordx4 a[16:19], v1, s[8:11], s60 offen offset:3072 sc1
v_mfma_f32_16x16x32_bf16 v[32:35], a[196:199], a[20:23], v[32:35]
ds_read_b128 a[176:179], v41 offset:4608
s_waitcnt vmcnt(19) lgkmcnt(5)
v_mfma_f32_16x16x32_bf16 v[16:19], a[200:203], a[24:27], v[16:19]
ds_read_b128 a[180:183], v37 offset:9216
s_add_u32 s60, s60, 4096
v_mfma_f32_16x16x32_bf16 v[20:23], a[204:207], a[24:27], v[20:23]
ds_read_b128 a[184:187], v37 offset:10240
v_mfma_f32_16x16x32_bf16 v[24:27], a[208:211], a[24:27], v[24:27]
ds_read_b128 a[188:191], v37 offset:11264
buffer_load_dwordx4 a[20:23], v1, s[8:11], s60 offen offset:0 sc1
v_mfma_f32_16x16x32_bf16 v[28:31], a[212:215], a[24:27], v[28:31]
ds_read_b128 a[192:195], v37 offset:12288
v_mfma_f32_16x16x32_bf16 v[32:35], a[216:219], a[24:27], v[32:35]
ds_read_b128 a[196:199], v41 offset:9216
s_waitcnt vmcnt(19) lgkmcnt(5)
v_mfma_f32_16x16x32_bf16 v[16:19], a[160:163], a[28:31], v[16:19]
ds_read_b128 a[200:203], v37 offset:13824
buffer_load_dwordx4 a[24:27], v1, s[8:11], s60 offen offset:1024 sc1
v_mfma_f32_16x16x32_bf16 v[20:23], a[164:167], a[28:31], v[20:23]
ds_read_b128 a[204:207], v37 offset:14848
v_mfma_f32_16x16x32_bf16 v[24:27], a[168:171], a[28:31], v[24:27]
ds_read_b128 a[208:211], v37 offset:15872
v_mfma_f32_16x16x32_bf16 v[28:31], a[172:175], a[28:31], v[28:31]
ds_read_b128 a[212:215], v37 offset:16896
v_mfma_f32_16x16x32_bf16 v[32:35], a[176:179], a[28:31], v[32:35]
ds_read_b128 a[216:219], v41 offset:13824
s_waitcnt vmcnt(19) lgkmcnt(5)
v_mfma_f32_16x16x32_bf16 v[16:19], a[180:183], a[32:35], v[16:19]
ds_read_b128 a[160:163], v37 offset:18432
buffer_load_dwordx4 a[28:31], v1, s[8:11], s60 offen offset:2048 sc1
v_mfma_f32_16x16x32_bf16 v[20:23], a[184:187], a[32:35], v[20:23]
ds_read_b128 a[164:167], v37 offset:19456
v_mfma_f32_16x16x32_bf16 v[24:27], a[188:191], a[32:35], v[24:27]
ds_read_b128 a[168:171], v37 offset:20480
v_mfma_f32_16x16x32_bf16 v[28:31], a[192:195], a[32:35], v[28:31]
ds_read_b128 a[172:175], v37 offset:21504
v_mfma_f32_16x16x32_bf16 v[32:35], a[196:199], a[32:35], v[32:35]
ds_read_b128 a[176:179], v41 offset:18432
s_waitcnt vmcnt(19) lgkmcnt(5)
v_mfma_f32_16x16x32_bf16 v[16:19], a[200:203], a[36:39], v[16:19]
ds_read_b128 a[180:183], v37 offset:23040
v_mfma_f32_16x16x32_bf16 v[20:23], a[204:207], a[36:39], v[20:23]
ds_read_b128 a[184:187], v37 offset:24064
v_mfma_f32_16x16x32_bf16 v[24:27], a[208:211], a[36:39], v[24:27]
ds_read_b128 a[188:191], v37 offset:25088
v_mfma_f32_16x16x32_bf16 v[28:31], a[212:215], a[36:39], v[28:31]
ds_read_b128 a[192:195], v37 offset:26112
s_cmp_eq_u32 s71, 27
s_cselect_b32 s98, 4096, 0
s_add_u32 s60, s60, s98
buffer_load_dwordx4 a[32:35], v1, s[8:11], s60 offen offset:3072 sc1
v_mfma_f32_16x16x32_bf16 v[32:35], a[216:219], a[36:39], v[32:35]
ds_read_b128 a[196:199], v41 offset:23040
s_waitcnt vmcnt(19) lgkmcnt(5)
v_mfma_f32_16x16x32_bf16 v[16:19], a[160:163], a[40:43], v[16:19]
ds_read_b128 a[200:203], v37 offset:27648
s_add_u32 s60, s60, 4096
v_mfma_f32_16x16x32_bf16 v[20:23], a[164:167], a[40:43], v[20:23]
ds_read_b128 a[204:207], v37 offset:28672
v_mfma_f32_16x16x32_bf16 v[24:27], a[168:171], a[40:43], v[24:27]
ds_read_b128 a[208:211], v37 offset:29696
buffer_load_dwordx4 a[36:39], v1, s[8:11], s60 offen offset:0 sc1
v_mfma_f32_16x16x32_bf16 v[28:31], a[172:175], a[40:43], v[28:31]
ds_read_b128 a[212:215], v37 offset:30720
v_mfma_f32_16x16x32_bf16 v[32:35], a[176:179], a[40:43], v[32:35]
ds_read_b128 a[216:219], v41 offset:27648
s_waitcnt vmcnt(19) lgkmcnt(5)
v_mfma_f32_16x16x32_bf16 v[16:19], a[180:183], a[44:47], v[16:19]
ds_read_b128 a[160:163], v37 offset:32256
buffer_load_dwordx4 a[40:43], v1, s[8:11], s60 offen offset:1024 sc1
v_mfma_f32_16x16x32_bf16 v[20:23], a[184:187], a[44:47], v[20:23]
ds_read_b128 a[164:167], v37 offset:33280
v_mfma_f32_16x16x32_bf16 v[24:27], a[188:191], a[44:47], v[24:27]
ds_read_b128 a[168:171], v37 offset:34304
v_mfma_f32_16x16x32_bf16 v[28:31], a[192:195], a[44:47], v[28:31]
ds_read_b128 a[172:175], v37 offset:35328
v_mfma_f32_16x16x32_bf16 v[32:35], a[196:199], a[44:47], v[32:35]
ds_read_b128 a[176:179], v41 offset:32256
s_waitcnt vmcnt(19) lgkmcnt(5)
v_mfma_f32_16x16x32_bf16 v[16:19], a[200:203], a[48:51], v[16:19]
ds_read_b128 a[180:183], v37 offset:36864
buffer_load_dwordx4 a[44:47], v1, s[8:11], s60 offen offset:2048 sc1
v_mfma_f32_16x16x32_bf16 v[20:23], a[204:207], a[48:51], v[20:23]
ds_read_b128 a[184:187], v37 offset:37888
v_mfma_f32_16x16x32_bf16 v[24:27], a[208:211], a[48:51], v[24:27]
ds_read_b128 a[188:191], v37 offset:38912
v_mfma_f32_16x16x32_bf16 v[28:31], a[212:215], a[48:51], v[28:31]
ds_read_b128 a[192:195], v37 offset:39936
v_mfma_f32_16x16x32_bf16 v[32:35], a[216:219], a[48:51], v[32:35]
ds_read_b128 a[196:199], v41 offset:36864
s_waitcnt vmcnt(19) lgkmcnt(5)
v_mfma_f32_16x16x32_bf16 v[16:19], a[160:163], a[52:55], v[16:19]
ds_read_b128 a[200:203], v37 offset:41472
buffer_load_dwordx4 a[48:51], v1, s[8:11], s60 offen offset:3072 sc1
v_mfma_f32_16x16x32_bf16 v[20:23], a[164:167], a[52:55], v[20:23]
ds_read_b128 a[204:207], v37 offset:42496
v_mfma_f32_16x16x32_bf16 v[24:27], a[168:171], a[52:55], v[24:27]
ds_read_b128 a[208:211], v37 offset:43520
v_mfma_f32_16x16x32_bf16 v[28:31], a[172:175], a[52:55], v[28:31]
ds_read_b128 a[212:215], v37 offset:44544
v_mfma_f32_16x16x32_bf16 v[32:35], a[176:179], a[52:55], v[32:35]
ds_read_b128 a[216:219], v41 offset:41472
s_waitcnt vmcnt(19) lgkmcnt(5)
v_mfma_f32_16x16x32_bf16 v[16:19], a[180:183], a[56:59], v[16:19]
ds_read_b128 a[160:163], v37 offset:46080
v_mfma_f32_16x16x32_bf16 v[20:23], a[184:187], a[56:59], v[20:23]
ds_read_b128 a[164:167], v37 offset:47104
v_mfma_f32_16x16x32_bf16 v[24:27], a[188:191], a[56:59], v[24:27]
ds_read_b128 a[168:171], v37 offset:48128
v_mfma_f32_16x16x32_bf16 v[28:31], a[192:195], a[56:59], v[28:31]
ds_read_b128 a[172:175], v37 offset:49152
v_mfma_f32_16x16x32_bf16 v[32:35], a[196:199], a[56:59], v[32:35]
ds_read_b128 a[176:179], v41 offset:46080
s_waitcnt vmcnt(18) lgkmcnt(5)
v_mfma_f32_16x16x32_bf16 v[16:19], a[200:203], a[60:63], v[16:19]
ds_read_b128 a[180:183], v37 offset:50688
v_mfma_f32_16x16x32_bf16 v[20:23], a[204:207], a[60:63], v[20:23]
ds_read_b128 a[184:187], v37 offset:51712
v_mfma_f32_16x16x32_bf16 v[24:27], a[208:211], a[60:63], v[24:27]
ds_read_b128 a[188:191], v37 offset:52736
v_mfma_f32_16x16x32_bf16 v[28:31], a[212:215], a[60:63], v[28:31]
ds_read_b128 a[192:195], v37 offset:53760
v_mfma_f32_16x16x32_bf16 v[32:35], a[216:219], a[60:63], v[32:35]
ds_read_b128 a[196:199], v41 offset:50688
s_waitcnt vmcnt(17) lgkmcnt(5)
v_mfma_f32_16x16x32_bf16 v[16:19], a[160:163], a[64:67], v[16:19]
ds_read_b128 a[200:203], v38 offset:0
buffer_load_dwordx4 v[80:83], v1, s[8:11], s63 offen offset:0 sc1
v_mfma_f32_16x16x32_bf16 v[20:23], a[164:167], a[64:67], v[20:23]
ds_read_b128 a[204:207], v38 offset:1024
v_mfma_f32_16x16x32_bf16 v[24:27], a[168:171], a[64:67], v[24:27]
ds_read_b128 a[208:211], v38 offset:2048
v_mfma_f32_16x16x32_bf16 v[28:31], a[172:175], a[64:67], v[28:31]
ds_read_b128 a[212:215], v38 offset:3072
v_mfma_f32_16x16x32_bf16 v[32:35], a[176:179], a[64:67], v[32:35]
ds_read_b128 a[216:219], v42 offset:0
s_waitcnt vmcnt(17) lgkmcnt(5)
v_mfma_f32_16x16x32_bf16 v[16:19], a[180:183], a[0:3], v[16:19]
ds_read_b128 a[160:163], v38 offset:4608
buffer_load_dwordx4 v[84:87], v1, s[8:11], s63 offen offset:1024 sc1
v_mfma_f32_16x16x32_bf16 v[20:23], a[184:187], a[0:3], v[20:23]
ds_read_b128 a[164:167], v38 offset:5632
v_mfma_f32_16x16x32_bf16 v[24:27], a[188:191], a[0:3], v[24:27]
ds_read_b128 a[168:171], v38 offset:6656
v_mfma_f32_16x16x32_bf16 v[28:31], a[192:195], a[0:3], v[28:31]
ds_read_b128 a[172:175], v38 offset:7680
v_mfma_f32_16x16x32_bf16 v[32:35], a[196:199], a[0:3], v[32:35]
ds_read_b128 a[176:179], v42 offset:4608
s_waitcnt vmcnt(16) lgkmcnt(5)
v_mfma_f32_16x16x32_bf16 v[16:19], a[200:203], a[4:7], v[16:19]
ds_read_b128 a[180:183], v38 offset:9216
buffer_load_dwordx4 v[88:91], v1, s[8:11], s63 offen offset:2048 sc1
v_mfma_f32_16x16x32_bf16 v[20:23], a[204:207], a[4:7], v[20:23]
ds_read_b128 a[184:187], v38 offset:10240
v_mfma_f32_16x16x32_bf16 v[24:27], a[208:211], a[4:7], v[24:27]
ds_read_b128 a[188:191], v38 offset:11264
v_mfma_f32_16x16x32_bf16 v[28:31], a[212:215], a[4:7], v[28:31]
ds_read_b128 a[192:195], v38 offset:12288
v_mfma_f32_16x16x32_bf16 v[32:35], a[216:219], a[4:7], v[32:35]
ds_read_b128 a[196:199], v42 offset:9216
s_waitcnt vmcnt(15) lgkmcnt(5)
v_mfma_f32_16x16x32_bf16 v[16:19], a[160:163], a[8:11], v[16:19]
ds_read_b128 a[200:203], v38 offset:13824
buffer_load_dwordx4 v[92:95], v1, s[8:11], s63 offen offset:3072 sc1
v_mfma_f32_16x16x32_bf16 v[20:23], a[164:167], a[8:11], v[20:23]
ds_read_b128 a[204:207], v38 offset:14848
v_mfma_f32_16x16x32_bf16 v[24:27], a[168:171], a[8:11], v[24:27]
ds_read_b128 a[208:211], v38 offset:15872
v_mfma_f32_16x16x32_bf16 v[28:31], a[172:175], a[8:11], v[28:31]
ds_read_b128 a[212:215], v38 offset:16896
v_mfma_f32_16x16x32_bf16 v[32:35], a[176:179], a[8:11], v[32:35]
ds_read_b128 a[216:219], v42 offset:13824
s_waitcnt vmcnt(15) lgkmcnt(5)
v_mfma_f32_16x16x32_bf16 v[16:19], a[180:183], a[12:15], v[16:19]
ds_read_b128 a[160:163], v38 offset:18432
v_mfma_f32_16x16x32_bf16 v[20:23], a[184:187], a[12:15], v[20:23]
ds_read_b128 a[164:167], v38 offset:19456
v_mfma_f32_16x16x32_bf16 v[24:27], a[188:191], a[12:15], v[24:27]
ds_read_b128 a[168:171], v38 offset:20480
v_mfma_f32_16x16x32_bf16 v[28:31], a[192:195], a[12:15], v[28:31]
ds_read_b128 a[172:175], v38 offset:21504
v_mfma_f32_16x16x32_bf16 v[32:35], a[196:199], a[12:15], v[32:35]
ds_read_b128 a[176:179], v42 offset:18432
s_waitcnt vmcnt(12) lgkmcnt(5)
v_mfma_f32_16x16x32_bf16 v[16:19], a[200:203], a[16:19], v[16:19]
ds_read_b128 a[180:183], v38 offset:23040
v_mfma_f32_16x16x32_bf16 v[20:23], a[204:207], a[16:19], v[20:23]
ds_read_b128 a[184:187], v38 offset:24064
v_mfma_f32_16x16x32_bf16 v[24:27], a[208:211], a[16:19], v[24:27]
ds_read_b128 a[188:191], v38 offset:25088
v_mfma_f32_16x16x32_bf16 v[28:31], a[212:215], a[16:19], v[28:31]
ds_read_b128 a[192:195], v38 offset:26112
v_mfma_f32_16x16x32_bf16 v[32:35], a[216:219], a[16:19], v[32:35]
ds_read_b128 a[196:199], v42 offset:23040
s_waitcnt vmcnt(11) lgkmcnt(5)
v_mfma_f32_16x16x32_bf16 v[16:19], a[160:163], a[20:23], v[16:19]
ds_read_b128 a[200:203], v38 offset:27648
v_mfma_f32_16x16x32_bf16 v[20:23], a[164:167], a[20:23], v[20:23]
ds_read_b128 a[204:207], v38 offset:28672
v_mfma_f32_16x16x32_bf16 v[24:27], a[168:171], a[20:23], v[24:27]
ds_read_b128 a[208:211], v38 offset:29696
v_mfma_f32_16x16x32_bf16 v[28:31], a[172:175], a[20:23], v[28:31]
ds_read_b128 a[212:215], v38 offset:30720
v_mfma_f32_16x16x32_bf16 v[32:35], a[176:179], a[20:23], v[32:35]
ds_read_b128 a[216:219], v42 offset:27648
s_waitcnt vmcnt(10) lgkmcnt(5)
v_mfma_f32_16x16x32_bf16 v[16:19], a[180:183], a[24:27], v[16:19]
ds_read_b128 a[160:163], v38 offset:32256
v_mfma_f32_16x16x32_bf16 v[20:23], a[184:187], a[24:27], v[20:23]
ds_read_b128 a[164:167], v38 offset:33280
v_mfma_f32_16x16x32_bf16 v[24:27], a[188:191], a[24:27], v[24:27]
ds_read_b128 a[168:171], v38 offset:34304
v_mfma_f32_16x16x32_bf16 v[28:31], a[192:195], a[24:27], v[28:31]
ds_read_b128 a[172:175], v38 offset:35328
v_mfma_f32_16x16x32_bf16 v[32:35], a[196:199], a[24:27], v[32:35]
ds_read_b128 a[176:179], v42 offset:32256
s_waitcnt vmcnt(9) lgkmcnt(5)
v_mfma_f32_16x16x32_bf16 v[16:19], a[200:203], a[28:31], v[16:19]
ds_read_b128 a[180:183], v38 offset:36864
v_mfma_f32_16x16x32_bf16 v[20:23], a[204:207], a[28:31], v[20:23]
ds_read_b128 a[184:187], v38 offset:37888
v_mfma_f32_16x16x32_bf16 v[24:27], a[208:211], a[28:31], v[24:27]
ds_read_b128 a[188:191], v38 offset:38912
v_mfma_f32_16x16x32_bf16 v[28:31], a[212:215], a[28:31], v[28:31]
ds_read_b128 a[192:195], v38 offset:39936
v_mfma_f32_16x16x32_bf16 v[32:35], a[216:219], a[28:31], v[32:35]
ds_read_b128 a[196:199], v42 offset:36864
s_waitcnt vmcnt(8) lgkmcnt(5)
v_mfma_f32_16x16x32_bf16 v[16:19], a[160:163], a[32:35], v[16:19]
ds_read_b128 a[200:203], v38 offset:41472
v_mfma_f32_16x16x32_bf16 v[20:23], a[164:167], a[32:35], v[20:23]
ds_read_b128 a[204:207], v38 offset:42496
v_mfma_f32_16x16x32_bf16 v[24:27], a[168:171], a[32:35], v[24:27]
ds_read_b128 a[208:211], v38 offset:43520
v_mfma_f32_16x16x32_bf16 v[28:31], a[172:175], a[32:35], v[28:31]
ds_read_b128 a[212:215], v38 offset:44544
v_mfma_f32_16x16x32_bf16 v[32:35], a[176:179], a[32:35], v[32:35]
ds_read_b128 a[216:219], v42 offset:41472
s_waitcnt vmcnt(7) lgkmcnt(5)
v_mfma_f32_16x16x32_bf16 v[16:19], a[180:183], a[36:39], v[16:19]
ds_read_b128 a[160:163], v38 offset:46080
v_mfma_f32_16x16x32_bf16 v[20:23], a[184:187], a[36:39], v[20:23]
ds_read_b128 a[164:167], v38 offset:47104
v_mfma_f32_16x16x32_bf16 v[24:27], a[188:191], a[36:39], v[24:27]
ds_read_b128 a[168:171], v38 offset:48128
v_mfma_f32_16x16x32_bf16 v[28:31], a[192:195], a[36:39], v[28:31]
ds_read_b128 a[172:175], v38 offset:49152
v_mfma_f32_16x16x32_bf16 v[32:35], a[196:199], a[36:39], v[32:35]
ds_read_b128 a[176:179], v42 offset:46080
s_waitcnt vmcnt(6) lgkmcnt(5)
v_mfma_f32_16x16x32_bf16 v[16:19], a[200:203], a[40:43], v[16:19]
ds_read_b128 a[180:183], v38 offset:50688
v_mfma_f32_16x16x32_bf16 v[20:23], a[204:207], a[40:43], v[20:23]
ds_read_b128 a[184:187], v38 offset:51712
v_mfma_f32_16x16x32_bf16 v[24:27], a[208:211], a[40:43], v[24:27]
v_mfma_f32_16x16x32_bf16 v[28:31], a[212:215], a[40:43], v[28:31]
v_mfma_f32_16x16x32_bf16 v[32:35], a[216:219], a[40:43], v[32:35]
s_waitcnt vmcnt(5) lgkmcnt(2)
v_mfma_f32_16x16x32_bf16 v[16:19], a[160:163], a[44:47], v[16:19]
v_mfma_f32_16x16x32_bf16 v[20:23], a[164:167], a[44:47], v[20:23]
v_mfma_f32_16x16x32_bf16 v[24:27], a[168:171], a[44:47], v[24:27]
v_mfma_f32_16x16x32_bf16 v[28:31], a[172:175], a[44:47], v[28:31]
v_mfma_f32_16x16x32_bf16 v[32:35], a[176:179], a[44:47], v[32:35]
s_waitcnt vmcnt(4) lgkmcnt(0)
v_mfma_f32_16x16x32_bf16 v[16:19], a[180:183], a[48:51], v[16:19]
s_waitcnt vmcnt(0)
v_xor_b32 v118, v248, v83
v_xor_b32 v119, v248, v87
v_xor_b32 v120, v248, v91
v_xor_b32 v121, v248, v95
v_mfma_f32_16x16x32_bf16 v[20:23], a[184:187], a[48:51], v[20:23]
v_or3_b32 v118, v118, v119, v120
v_or_b32 v118, v118, v121
v_cmp_ne_u32 vcc, 0, v118
s_nop 0
s_cbranch_vccnz L_xslow_37
L_xback_38:
v_mfma_f32_16x16x32_bf16 v[24:27], a[228:231], a[48:51], v[24:27]
v_lshlrev_b32 v96, 16, v80
v_and_b32 v97, 0xffff0000, v80
v_lshlrev_b32 v98, 16, v81
v_and_b32 v99, 0xffff0000, v81
v_lshlrev_b32 v100, 16, v82
v_and_b32 v101, 0xffff0000, v82
v_mfma_f32_16x16x32_bf16 v[28:31], a[232:235], a[48:51], v[28:31]
v_lshlrev_b32 v102, 16, v84
v_and_b32 v103, 0xffff0000, v84
v_lshlrev_b32 v104, 16, v85
v_and_b32 v105, 0xffff0000, v85
v_lshlrev_b32 v106, 16, v86
v_and_b32 v107, 0xffff0000, v86
v_mfma_f32_16x16x32_bf16 v[32:35], a[236:239], a[48:51], v[32:35]
v_lshlrev_b32 v108, 16, v88
v_and_b32 v109, 0xffff0000, v88
v_lshlrev_b32 v110, 16, v89
v_and_b32 v111, 0xffff0000, v89
v_lshlrev_b32 v112, 16, v90
v_and_b32 v113, 0xffff0000, v90
v_lshlrev_b32 v114, 16, v92
v_and_b32 v115, 0xffff0000, v92
s_nop 3
v_pk_add_f32 v[16:17], v[16:17], v[96:97]
v_pk_add_f32 v[18:19], v[18:19], v[98:99]
v_pk_add_f32 v[20:21], v[20:21], v[100:101]
v_pk_add_f32 v[22:23], v[22:23], v[102:103]
v_pk_add_f32 v[24:25], v[24:25], v[104:105]
v_pk_add_f32 v[26:27], v[26:27], v[106:107]
v_pk_add_f32 v[28:29], v[28:29], v[108:109]
v_pk_add_f32 v[30:31], v[30:31], v[110:111]
v_pk_add_f32 v[32:33], v[32:33], v[112:113]
v_pk_add_f32 v[34:35], v[34:35], v[114:115]
s_cmp_eq_u32 s29, 1
s_cbranch_scc1 L_last
v_pk_add_f32 v[142:143], v[16:17], v[18:19]
v_pk_mul_f32 v[144:145], v[16:17], v[16:17]
v_pk_fma_f32 v[144:145], v[18:19], v[18:19], v[144:145]
v_pk_add_f32 v[142:143], v[142:143], v[20:21]
v_pk_fma_f32 v[144:145], v[20:21], v[20:21], v[144:145]
v_pk_add_f32 v[142:143], v[142:143], v[22:23]
v_pk_fma_f32 v[144:145], v[22:23], v[22:23], v[144:145]
v_pk_add_f32 v[142:143], v[142:143], v[24:25]
v_pk_fma_f32 v[144:145], v[24:25], v[24:25], v[144:145]
v_pk_add_f32 v[142:143], v[142:143], v[26:27]
v_pk_fma_f32 v[144:145], v[26:27], v[26:27], v[144:145]
v_pk_add_f32 v[142:143], v[142:143], v[28:29]
v_pk_fma_f32 v[144:145], v[28:29], v[28:29], v[144:145]
v_pk_add_f32 v[142:143], v[142:143], v[30:31]
v_pk_fma_f32 v[144:145], v[30:31], v[30:31], v[144:145]
s_mov_b32 exec_hi, 0
v_pk_add_f32 v[142:143], v[142:143], v[32:33]
v_pk_fma_f32 v[144:145], v[32:33], v[32:33], v[144:145]
v_pk_add_f32 v[142:143], v[142:143], v[34:35]
v_pk_fma_f32 v[144:145], v[34:35], v[34:35], v[144:145]
s_mov_b64 exec, -1
v_add_f32 v136, v142, v143
v_add_f32 v137, v144, v145
v_cvt_pk_bf16_f32 v132, v32, v33
v_cvt_pk_bf16_f32 v133, v34, v35
v_permlane32_swap_b32 v136, v137
v_add_f32 v136, v136, v137
v_mov_b32 v137, v136
v_cvt_pk_bf16_f32 v124, v16, v17
v_cvt_pk_bf16_f32 v125, v18, v19
v_permlane16_swap_b32 v136, v137
v_add_f32 v136, v136, v137
v_mov_b32 v137, v136
v_cvt_pk_bf16_f32 v126, v20, v21
v_cvt_pk_bf16_f32 v127, v22, v23
v_permlane32_swap_b32 v136, v137
buffer_store_dwordx4 v[124:127], v140, s[8:11], s66 offen sc1
buffer_store_dwordx2 v[136:137], v138, s[8:11], s67 offen sc1
v_cvt_pk_bf16_f32 v128, v24, v25
v_cvt_pk_bf16_f32 v129, v26, v27
v_cvt_pk_bf16_f32 v130, v28, v29
v_cvt_pk_bf16_f32 v131, v30, v31
v_permlane16_swap_b32 v132, v134
v_permlane16_swap_b32 v133, v135
buffer_store_dwordx4 v[128:131], v140, s[8:11], s66 offen offset:1024 sc1
buffer_store_dwordx4 v[132:135], v141, s[8:11], s66 offen sc1
s_barrier
s_mul_i32 s36, s26, 132608
s_mul_i32 s38, s24, 12288
s_add_u32 m0, s38, 0
s_add_u32 s39, s38, s36
buffer_load_dwordx4 v1, s[4:7], s39 offen offset:0 sc1 lds
buffer_load_dwordx4 v1, s[4:7], s39 offen offset:1024 sc1 lds
buffer_load_dwordx4 v1, s[4:7], s39 offen offset:2048 sc1 lds
buffer_load_dwordx4 v1, s[4:7], s39 offen offset:3072 sc1 lds
s_add_u32 m0, m0, 4096
s_add_u32 s39, s39, 4096
buffer_load_dwordx4 v1, s[4:7], s39 offen offset:0 sc1 lds
buffer_load_dwordx4 v1, s[4:7], s39 offen offset:1024 sc1 lds
buffer_load_dwordx4 v1, s[4:7], s39 offen offset:2048 sc1 lds
buffer_load_dwordx4 v1, s[4:7], s39 offen offset:3072 sc1 lds
s_and_b32 s33, s27, 1
s_cmp_lt_u32 s27, 31
s_cselect_b32 s33, s33, 0
s_cmp_eq_u32 s33, 1
s_cselect_b32 s34, -1, 0xffff
s_mov_b32 s35, 0
v_lshlrev_b32 v7, 3, v1
s_lshr_b32 s31, s80, 4
s_lshl_b32 s31, s31, 11
v_add_u32 v7, s31, v7
s_cmp_eq_u32 s24, 0
s_cselect_b32 s30, 0, 1073741824
s_add_u32 s30, s30, 26607616
s_waitcnt vmcnt(8)
s_barrier
s_mov_b64 exec, s[34:35]
buffer_atomic_add v4, v7, s[8:11], s30 offen sc1
s_mov_b64 exec, -1
s_cmp_eq_u32 s29, 1
s_cbranch_scc1 L_main_fin
s_cmp_eq_u32 s25, 0
s_cselect_b32 s34, 16, 24
s_lshl_b32 s35, s80, 7
s_add_u32 s35, s35, 26607616
s_cmp_eq_u32 s24, 1
s_cselect_b32 s35, s35, 1073741824
v_mov_b32 v6, 0
v_mov_b32 v244, 0
v_mov_b32 v245, 0
v_mov_b32 v246, 0
s_add_u32 m0, m0, 4096
s_add_u32 s39, s39, 4096
buffer_load_dwordx4 v1, s[4:7], s39 offen offset:0 sc1 lds
buffer_load_dwordx4 v1, s[4:7], s39 offen offset:1024 sc1 lds
buffer_load_dwordx4 v1, s[4:7], s39 offen offset:2048 sc1 lds
buffer_load_dwordx4 v1, s[4:7], s39 offen offset:3072 sc1 lds
s_mul_i32 s36, s26, 132608
s_mul_i32 s38, s24, 9216
s_add_u32 m0, s38, 49152
s_add_u32 s39, s38, s36
s_add_u32 s39, s39, 49152
s_mov_b64 exec, 1
buffer_atomic_add v244, v6, s[8:11], s35 offen sc0 sc1
s_mov_b64 exec, -1
buffer_load_dwordx4 v1, s[4:7], s39 offen offset:0 sc1 lds
buffer_load_dwordx4 v1, s[4:7], s39 offen offset:1024 sc1 lds
buffer_load_dwordx4 v1, s[4:7], s39 offen offset:2048 sc1 lds
s_mov_b64 exec, 1
buffer_atomic_add v245, v6, s[8:11], s35 offen sc0 sc1
s_mov_b64 exec, -1
buffer_load_dwordx4 v1, s[4:7], s39 offen offset:3072 sc1 lds
s_add_u32 m0, m0, 4096
s_add_u32 s39, s39, 4096
buffer_load_dwordx4 v1, s[4:7], s39 offen offset:0 sc1 lds
buffer_load_dwordx4 v1, s[4:7], s39 offen offset:1024 sc1 lds
s_mov_b64 exec, 1
buffer_atomic_add v246, v6, s[8:11], s35 offen sc0 sc1
s_mov_b64 exec, -1
buffer_load_dwordx4 v1, s[4:7], s39 offen offset:2048 sc1 lds
buffer_load_dwordx4 v1, s[4:7], s39 offen offset:3072 sc1 lds
s_add_u32 m0, m0, 4096
s_add_u32 s39, s39, 4096
buffer_load_dwordx4 v1, s[4:7], s39 offen offset:0 sc1 lds
s_lshl_b32 s60, s25, 3
s_sub_u32 s61, s60, 1
s_max_i32 s61, s61, 0
s_lshl_b32 s30, s24, 1
s_add_u32 s60, s60, s30
s_mul_i32 s30, s61, 18432
s_mul_i32 s62, s60, 18432
v_add_u32 v237, 18432, v1
s_mul_i32 s38, s24, 5120
s_add_u32 m0, s38, 135168
s_add_u32 s39, s38, s30
s_cmp_eq_u32 s24, 1
s_cbranch_scc0 L_other_42
s_mov_b32 s31, 0
s_mov_b64 exec, 1
v_mov_b32 v247, 0
buffer_atomic_add v247, v6, s[8:11], s35 offen sc0 sc1
s_waitcnt vmcnt(12)
v_cmp_gt_u32 vcc, s34, v244
s_nop 0
s_cbranch_vccz L_polled_41
s_waitcnt vmcnt(8)
v_cmp_gt_u32 vcc, s34, v245
s_nop 0
s_cbranch_vccz L_polled_41
v_mov_b32 v244, 0
buffer_atomic_add v244, v6, s[8:11], s35 offen sc0 sc1
s_waitcnt vmcnt(5)
v_cmp_gt_u32 vcc, s34, v246
s_nop 0
s_cbranch_vccz L_polled_41
v_mov_b32 v245, 0
buffer_atomic_add v245, v6, s[8:11], s35 offen sc0 sc1
L_poll_40:
s_add_u32 s31, s31, 1
s_cmp_gt_u32 s31, 100000
s_cbranch_scc1 L_polled_41
v_mov_b32 v246, 0
buffer_atomic_add v246, v6, s[8:11], s35 offen sc0 sc1
s_waitcnt vmcnt(3)
v_cmp_gt_u32 vcc, s34, v247
s_nop 0
s_cbranch_vccz L_polled_41
v_mov_b32 v247, 0
buffer_atomic_add v247, v6, s[8:11], s35 offen sc0 sc1
s_waitcnt vmcnt(3)
v_cmp_gt_u32 vcc, s34, v244
s_nop 0
s_cbranch_vccz L_polled_41
v_mov_b32 v244, 0
buffer_atomic_add v244, v6, s[8:11], s35 offen sc0 sc1
s_waitcnt vmcnt(3)
v_cmp_gt_u32 vcc, s34, v245
s_nop 0
s_cbranch_vccz L_polled_41
v_mov_b32 v245, 0
buffer_atomic_add v245, v6, s[8:11], s35 offen sc0 sc1
s_waitcnt vmcnt(3)
v_cmp_gt_u32 vcc, s34, v246
s_nop 0
s_cbranch_vccz L_polled_41
s_branch L_poll_40
L_polled_41:
s_mov_b64 exec, -1
L_other_42:
s_barrier
s_mov_b32 s29, 1
s_add_u32 s8, s8, 30834688
s_addc_u32 s9, s9, 0
s_mov_b32 s10, 30834688
s_branch L_layer
L_last:
v_cvt_pk_bf16_f32 v148, v16, v17
v_cvt_pk_bf16_f32 v149, v18, v19
v_cvt_pk_bf16_f32 v150, v20, v21
v_cvt_pk_bf16_f32 v151, v22, v23
v_cvt_pk_bf16_f32 v152, v24, v25
v_cvt_pk_bf16_f32 v153, v26, v27
v_cvt_pk_bf16_f32 v154, v28, v29
v_cvt_pk_bf16_f32 v155, v30, v31
v_cvt_pk_bf16_f32 v156, v32, v33
v_cvt_pk_bf16_f32 v157, v34, v35
buffer_store_dwordx4 v[148:151], v164, s[16:19], s68 offen
buffer_store_dwordx4 v[152:155], v164, s[16:19], s68 offen offset:64
v_permlane16_swap_b32 v156, v158
v_permlane16_swap_b32 v157, v159
buffer_store_dwordx4 v[156:159], v165, s[16:19], s68 offen
L_main_fin:
L_main_end:
s_endpgm
L_tagslow_7:
buffer_load_dwordx2 v[238:239], v48, s[84:87], 0 offen sc1
s_add_u32 s31, s31, 1
s_waitcnt vmcnt(0)
v_cmp_eq_u32 vcc, 0, v238
s_cmp_gt_u32 s31, 200000
s_cbranch_scc1 L_tagback_8
s_cbranch_vccnz L_tagslow_7
s_branch L_tagback_8
L_dbslow_11:
s_mov_b32 s67, 0
L_dbslow_11x:
buffer_load_dwordx2 v[148:149], v146, s[4:7], s66 offen sc1
s_add_u32 s67, s67, 1
s_waitcnt vmcnt(0)
v_cmp_ne_u64 vcc, v[148:149], v[238:239]
s_cmp_gt_u32 s67, 200000
s_cbranch_scc1 L_dbback_12
s_cbranch_vccnz L_dbslow_11x
s_branch L_dbback_12
L_stzslow_23:
s_mov_b32 s31, 0
L_stzloop_25:
buffer_load_dwordx2 v[182:183], v234, s[8:11], s61 offen offset:0 sc1
buffer_load_dwordx2 v[184:185], v234, s[8:11], s61 offen offset:1024 sc1
buffer_load_dwordx2 v[186:187], v234, s[8:11], s61 offen offset:2048 sc1
buffer_load_dwordx2 v[188:189], v234, s[8:11], s61 offen offset:3072 sc1
buffer_load_dwordx2 v[190:191], v235, s[8:11], s61 offen offset:0 sc1
buffer_load_dwordx2 v[192:193], v235, s[8:11], s61 offen offset:1024 sc1
buffer_load_dwordx2 v[194:195], v235, s[8:11], s61 offen offset:2048 sc1
buffer_load_dwordx2 v[196:197], v235, s[8:11], s61 offen offset:3072 sc1
s_add_u32 s31, s31, 1
s_waitcnt vmcnt(0)
v_min3_f32 v200, v183, v185, v187
v_min3_f32 v201, v189, v191, v193
v_min3_f32 v200, v200, v195, v197
v_min_f32 v200, v200, v201
v_cmp_gt_f32 vcc, 0, v200
s_cmp_gt_u32 s31, 200000
s_cbranch_scc1 L_stzback_24
s_cbranch_vccnz L_stzloop_25
s_branch L_stzback_24
L_xslow_37:
s_mov_b32 s31, 0
L_xloop_39:
buffer_load_dwordx4 v[80:83], v1, s[8:11], s63 offen offset:0 sc1
buffer_load_dwordx4 v[84:87], v1, s[8:11], s63 offen offset:1024 sc1
buffer_load_dwordx4 v[88:91], v1, s[8:11], s63 offen offset:2048 sc1
buffer_load_dwordx4 v[92:95], v1, s[8:11], s63 offen offset:3072 sc1
s_add_u32 s31, s31, 1
s_waitcnt vmcnt(0)
v_xor_b32 v118, v248, v83
v_xor_b32 v119, v248, v87
v_xor_b32 v120, v248, v91
v_xor_b32 v121, v248, v95
v_or3_b32 v118, v118, v119, v120
v_or_b32 v118, v118, v121
v_cmp_ne_u32 vcc, 0, v118
s_cmp_gt_u32 s31, 200000
s_cbranch_scc1 L_xback_38
s_cbranch_vccnz L_xloop_39
s_branch L_xback_38
L_code_end:
.section .rodata,"a"
.p2align 6
.amdhsa_kernel main_kernel
  .amdhsa_next_free_vgpr 512
  .amdhsa_next_free_sgpr 102
  .amdhsa_accum_offset 256
  .amdhsa_group_segment_fixed_size 0
  .amdhsa_kernarg_size 88
  .amdhsa_user_sgpr_count 2
  .amdhsa_user_sgpr_kernarg_segment_ptr 1
  .amdhsa_system_sgpr_workgroup_id_x 1
  .amdhsa_float_denorm_mode_32 3
.end_amdhsa_kernel
```

```asm
; @launch kernel=main_kernel grid=(256,1,1) block=(256,1,1) lds=163840
.amdgcn_target "amdgcn-amd-amdhsa--gfx950"
.text
.globl main_kernel
.p2align 8
.type main_kernel,@function
main_kernel:
s_cmp_ge_u32 s2, 256
s_cbranch_scc1 L_main_end
s_load_dwordx16 s[64:79], s[0:1], 0
s_memrealtime s[96:97]
s_load_dwordx2 s[4:5], s[0:1], 80
s_load_dwordx2 s[16:17], s[0:1], 64
s_load_dwordx2 s[84:85], s[0:1], 72
s_getpc_b64 s[88:89]
L_pc:
s_mov_b32 s90, L_code_end-L_pc
s_mov_b32 s91, 0x20000
s_lshr_b32 s31, s2, 3
s_lshl_b32 s31, s31, 10
v_lshl_add_u32 v14, v0, 2, s31
s_mov_b32 s37, L_pc-L_pc
buffer_load_dword v15, v14, s[88:91], s37 offen
v_lshrrev_b32 v6, 6, v0
v_and_b32 v0, 63, v0
v_readfirstlane_b32 s24, v6
v_lshlrev_b32 v1, 4, v0
v_and_b32 v2, 15, v0
v_lshrrev_b32 v3, 4, v0
v_cmp_gt_u32 s[50:51], 2, v3
s_nop 0
s_cmp_lt_u32 s2, 128
s_cbranch_scc1 L_p0_x1
s_sub_u32 s30, s2, 128
s_cmp_lt_u32 s30, 108
s_cselect_b32 s62, 0, 1073741824
s_cselect_b32 s30, s30, 0
s_and_b32 s60, s30, 3
s_lshr_b32 s61, s30, 2
s_mov_b32 s14, 1990656
s_mov_b32 s15, 0x20000
s_mul_i32 s30, s60, 497664
s_lshl_b32 s31, s61, 7
s_add_u32 s30, s30, s31
s_mul_i32 s31, s24, 27648
s_add_u32 s30, s30, s31
s_add_u32 s30, s30, s62
v_lshrrev_b32 v36, 7, v1
v_mul_u32_u24 v42, 3456, v36
v_and_b32 v36, 0x70, v1
v_add_u32 v42, v36, v42
s_lshl_b32 s32, s24, 10
s_waitcnt lgkmcnt(0)
s_mov_b32 s12, s66
s_mov_b32 s13, s67
s_add_u32 m0, s32, 0
s_add_u32 s31, s30, 0
buffer_load_dwordx4 v42, s[12:15], s31 offen nt lds
s_add_u32 m0, s32, 4096
s_add_u32 s31, s30, 110592
buffer_load_dwordx4 v42, s[12:15], s31 offen nt lds
s_add_u32 m0, s32, 8192
s_add_u32 s31, s30, 221184
buffer_load_dwordx4 v42, s[12:15], s31 offen nt lds
s_add_u32 m0, s32, 12288
s_add_u32 s31, s30, 331776
buffer_load_dwordx4 v42, s[12:15], s31 offen nt lds
s_add_u32 m0, s32, 16384
s_add_u32 s31, s30, 442368
s_cmp_lt_u32 s24, 2
s_cselect_b32 s31, s31, 1073741824
buffer_load_dwordx4 v42, s[12:15], s31 offen nt lds
s_branch L_p0_j1
L_p0_x1:
s_mov_b32 s14, 2359296
s_mov_b32 s15, 0x20000
s_mul_i32 s30, s24, 18
v_add_u32 v36, s30, v3
v_mul_u32_u24 v42, 1152, v2
v_lshl_add_u32 v42, v36, 4, v42
s_mul_i32 s30, s2, 18432
v_mov_b32 v37, 1073741824
v_cndmask_b32 v37, v37, v42, s[50:51]
s_waitcnt lgkmcnt(0)
s_mov_b32 s12, s64
s_mov_b32 s13, s65
buffer_load_dwordx4 v[64:67], v42, s[12:15], s30 offen offset:0
buffer_load_dwordx4 v[68:71], v42, s[12:15], s30 offen offset:64
buffer_load_dwordx4 v[72:75], v42, s[12:15], s30 offen offset:128
buffer_load_dwordx4 v[76:79], v42, s[12:15], s30 offen offset:192
buffer_load_dwordx4 v[80:83], v37, s[12:15], s30 offen offset:256
L_p0_j1:
s_mov_b32 s86, 256
s_mov_b32 s87, 0x20000
s_xor_b32 s30, s2, 248
s_or_b32 s30, s30, s24
s_cmp_eq_u32 s30, 0
s_cselect_b32 s30, 0, 1073741824
v_mov_b32 v48, 0
s_or_b32 s96, s96, 1
v_mov_b32 v238, s96
v_mov_b32 v239, s97
s_mov_b64 exec, 1
buffer_store_dwordx2 v[238:239], v48, s[84:87], s30 offen sc1
s_mov_b64 exec, -1
v_mov_b32 v4, 1
v_mov_b32 v5, 0
s_mov_b32 s56, 0
s_mov_b32 s29, 0
v_add_u32 v9, 66560, v1
v_cmp_eq_u32 s[46:47], 0, v3
v_cmp_eq_u32 s[48:49], 2, v3
s_mov_b32 s6, 19451904
s_mov_b32 s7, 0x20000
s_mov_b32 s10, 61669376
s_mov_b32 s11, 0x20000
s_mov_b32 s18, 2359296
s_mov_b32 s19, 0x20000
s_mov_b32 s22, 4096
s_mov_b32 s23, 0x20000
s_and_b32 s30, s2, 7
s_lshr_b32 s31, s2, 3
s_lshr_b32 s32, s31, 2
s_and_b32 s33, s31, 3
s_lshr_b32 s25, s30, 2
s_lshl_b32 s25, s25, 3
s_add_u32 s25, s25, s32
s_and_b32 s26, s30, 3
s_lshl_b32 s26, s26, 2
s_add_u32 s26, s26, s33
s_lshl_b32 s80, s25, 4
s_add_u32 s80, s80, s26
s_lshr_b32 s27, s80, 3
s_and_b32 s28, s26, 7
s_lshl_b32 s70, s25, 2
s_add_u32 s70, s70, s24
s_lshl_b32 s70, s70, 1
s_lshr_b32 s32, s26, 3
s_add_u32 s70, s70, s32
s_mul_i32 s71, s28, 9
s_add_u32 s71, s71, 1
s_lshr_b32 s71, s71, 1
s_add_u32 s8, s4, 19451904
s_addc_u32 s9, s5, 0
s_mov_b32 s20, s76
s_mov_b32 s21, s77
v_lshrrev_b32 v36, 2, v2
v_lshl_add_u32 v36, v3, 3, v36
v_lshlrev_b32 v45, 7, v36
v_and_b32 v36, 3, v2
v_lshl_add_u32 v45, v36, 3, v45
s_lshl_b32 s31, s24, 5
v_add_u32 v45, s31, v45
v_mov_b32 v164, 3212836864
v_mov_b32 v165, 3212836864
v_mov_b32 v166, 3212836864
v_mov_b32 v167, 3212836864
s_lshl_b32 s30, s80, 10
s_lshl_b32 s31, s24, 8
s_add_u32 s30, s30, s31
s_add_u32 s30, s30, 26214400
s_mov_b32 s31, 30834688
v_mul_lo_u32 v36, v3, s31
v_lshl_add_u32 v37, v2, 4, v36
s_mov_b32 exec_hi, 0
buffer_store_dwordx4 v[164:167], v37, s[8:11], s30 offen sc1
s_mov_b64 exec, -1
v_lshl_add_u32 v37, v2, 15, v36
s_lshl_b32 s30, s2, 7
s_add_u32 s30, s30, 26476544
s_cmp_eq_u32 s24, 0
s_cselect_b32 s30, s30, 1073741824
s_mov_b64 exec, 0x001f001f
buffer_store_dword v48, v37, s[8:11], s30 offen sc1
s_mov_b64 exec, -1
s_cmp_lt_u32 s2, 128
s_cbranch_scc1 L_p0_x2
s_mul_i32 s92, s61, 29
s_lshr_b32 s92, s92, 8
s_mul_i32 s33, s92, 9
s_sub_u32 s33, s61, s33
s_lshl_b32 s33, s33, 6
s_lshl_b32 s31, s24, 4
s_add_u32 s33, s33, s31
v_add_u32 v36, s33, v2
v_mul_u32_u24 v37, 911, v36
v_lshrrev_b32 v37, 14, v37
v_mul_u32_u24 v38, 18, v37
v_sub_u32 v36, v36, v38
v_and_b32 v38, 1, v37
v_lshrrev_b32 v37, 1, v37
s_mov_b32 s31, 132608
v_mul_lo_u32 v37, v37, s31
s_cmp_eq_u32 s92, 0
s_cselect_b32 s93, 5, 0
s_cselect_b32 s94, 8, 4
s_cmp_eq_u32 s92, 2
s_cselect_b32 s93, 2, s93
s_cselect_b32 s94, 0, s94
s_sub_u32 s94, s94, 16
v_add_u32 v39, s93, v38
v_lshl_add_u32 v40, v38, 1, v36
v_add_u32 v40, s94, v40
v_cmp_gt_u32 vcc, 16, v36
s_nop 1
v_cndmask_b32 v39, 4, v39, vcc
v_cndmask_b32 v40, v40, v36, vcc
v_lshl_add_u32 v43, v39, 10, v37
v_lshl_add_u32 v43, v40, 4, v43
v_lshl_add_u32 v44, v39, 9, v37
v_lshl_add_u32 v44, v40, 3, v44
s_lshl_b32 s31, s60, 7
s_add_u32 s31, s31, 129024
v_add_u32 v44, s31, v44
s_mul_i32 s31, s60, 18
v_add_u32 v37, s31, v3
v_and_b32 v38, 3, v37
v_lshrrev_b32 v37, 2, v37
v_mul_u32_u24 v37, 7168, v37
v_add_u32 v43, v43, v37
v_lshl_add_u32 v43, v38, 8, v43
s_waitcnt vmcnt(3)
s_barrier
ds_read_b64_tr_b16 v[64:65], v45 offset:0
ds_read_b64_tr_b16 v[66:67], v45 offset:512
ds_read_b64_tr_b16 v[68:69], v45 offset:4096
ds_read_b64_tr_b16 v[70:71], v45 offset:4608
ds_read_b64_tr_b16 v[72:73], v45 offset:8192
ds_read_b64_tr_b16 v[74:75], v45 offset:8704
ds_read_b64_tr_b16 v[76:77], v45 offset:12288
ds_read_b64_tr_b16 v[78:79], v45 offset:12800
ds_read_b64_tr_b16 v[80:81], v45 offset:16384
ds_read_b64_tr_b16 v[82:83], v45 offset:16896
v_mov_b32 v36, 1073741824
v_mov_b32 v46, 0
v_cndmask_b32 v37, v36, v43, s[50:51]
s_add_u32 s31, s62, 0
s_waitcnt lgkmcnt(8)
buffer_store_dwordx4 v[64:67], v43, s[4:7], s31 offen sc1
s_add_u32 s31, s62, 7168
s_waitcnt lgkmcnt(6)
buffer_store_dwordx4 v[68:71], v43, s[4:7], s31 offen sc1
s_add_u32 s31, s62, 14336
s_waitcnt lgkmcnt(4)
buffer_store_dwordx4 v[72:75], v43, s[4:7], s31 offen sc1
s_add_u32 s31, s62, 21504
s_waitcnt lgkmcnt(2)
buffer_store_dwordx4 v[76:79], v43, s[4:7], s31 offen sc1
s_add_u32 s31, s62, 28672
s_waitcnt lgkmcnt(0)
buffer_store_dwordx4 v[80:83], v37, s[4:7], s31 offen sc1
v_mov_b32 v37, 0x3f803f80
v_dot2c_f32_bf16 v46, v64, v37
v_dot2c_f32_bf16 v46, v65, v37
v_dot2c_f32_bf16 v46, v66, v37
v_dot2c_f32_bf16 v46, v67, v37
v_dot2c_f32_bf16 v46, v68, v37
v_dot2c_f32_bf16 v46, v69, v37
v_dot2c_f32_bf16 v46, v70, v37
v_dot2c_f32_bf16 v46, v71, v37
v_dot2c_f32_bf16 v46, v72, v37
v_dot2c_f32_bf16 v46, v73, v37
v_dot2c_f32_bf16 v46, v74, v37
v_dot2c_f32_bf16 v46, v75, v37
v_dot2c_f32_bf16 v46, v76, v37
v_dot2c_f32_bf16 v46, v77, v37
v_dot2c_f32_bf16 v46, v78, v37
v_dot2c_f32_bf16 v46, v79, v37
v_dot2c_f32_bf16 v46, v80, v37
v_dot2c_f32_bf16 v46, v81, v37
v_dot2c_f32_bf16 v46, v82, v37
v_dot2c_f32_bf16 v46, v83, v37
s_nop 2
v_mov_b32 v37, v46
s_nop 1
v_permlane32_swap_b32 v46, v37
v_add_f32 v46, v46, v37
v_mov_b32 v37, v46
s_nop 1
v_permlane16_swap_b32 v46, v37
v_add_f32 v46, v46, v37
v_cvt_pk_bf16_f32 v50, v46, v46
v_and_b32 v37, 0xffff0000, v50
v_sub_f32 v37, v46, v37
v_cvt_pk_bf16_f32 v51, v37, v37
v_cndmask_b32 v36, v36, v44, s[46:47]
buffer_store_dwordx2 v[50:51], v36, s[4:7], s62 offen sc1
s_branch L_p0_j2
L_p0_x2:
s_mul_i32 s30, s24, 4608
s_mul_i32 s31, s2, 18432
s_add_u32 s31, s31, s30
s_add_u32 s31, s31, 0
v_mov_b32 v36, 1073741824
v_add_u32 v38, 4096, v1
v_cndmask_b32 v38, v36, v38, s[50:51]
v_mov_b32 v46, 0
v_mov_b32 v47, 0
v_mov_b32 v39, 0x3f803f80
s_waitcnt vmcnt(3)
buffer_store_dwordx4 v[64:67], v1, s[8:11], s31 offen offset:0 sc1
buffer_store_dwordx4 v[68:71], v1, s[8:11], s31 offen offset:1024 sc1
buffer_store_dwordx4 v[72:75], v1, s[8:11], s31 offen offset:2048 sc1
buffer_store_dwordx4 v[76:79], v1, s[8:11], s31 offen offset:3072 sc1
buffer_store_dwordx4 v[80:83], v38, s[8:11], s31 offen offset:0 sc1
v_dot2c_f32_bf16 v46, v64, v39
v_dot2c_f32_bf16 v46, v65, v39
v_dot2c_f32_bf16 v46, v66, v39
v_dot2c_f32_bf16 v46, v67, v39
v_dot2c_f32_bf16 v46, v68, v39
v_dot2c_f32_bf16 v46, v69, v39
v_dot2c_f32_bf16 v46, v70, v39
v_dot2c_f32_bf16 v46, v71, v39
v_dot2c_f32_bf16 v46, v72, v39
v_dot2c_f32_bf16 v46, v73, v39
v_dot2c_f32_bf16 v46, v74, v39
v_dot2c_f32_bf16 v46, v75, v39
v_dot2c_f32_bf16 v46, v76, v39
v_dot2c_f32_bf16 v46, v77, v39
v_dot2c_f32_bf16 v46, v78, v39
v_dot2c_f32_bf16 v46, v79, v39
v_dot2c_f32_bf16 v46, v80, v39
v_dot2c_f32_bf16 v46, v81, v39
v_dot2c_f32_bf16 v46, v82, v39
v_dot2c_f32_bf16 v46, v83, v39
v_dot2c_f32_bf16 v47, v64, v64
v_dot2c_f32_bf16 v47, v65, v65
v_dot2c_f32_bf16 v47, v66, v66
v_dot2c_f32_bf16 v47, v67, v67
v_dot2c_f32_bf16 v47, v68, v68
v_dot2c_f32_bf16 v47, v69, v69
v_dot2c_f32_bf16 v47, v70, v70
v_dot2c_f32_bf16 v47, v71, v71
v_dot2c_f32_bf16 v47, v72, v72
v_dot2c_f32_bf16 v47, v73, v73
v_dot2c_f32_bf16 v47, v74, v74
v_dot2c_f32_bf16 v47, v75, v75
v_dot2c_f32_bf16 v47, v76, v76
v_dot2c_f32_bf16 v47, v77, v77
v_dot2c_f32_bf16 v47, v78, v78
v_dot2c_f32_bf16 v47, v79, v79
v_dot2c_f32_bf16 v47, v80, v80
v_dot2c_f32_bf16 v47, v81, v81
v_dot2c_f32_bf16 v47, v82, v82
v_dot2c_f32_bf16 v47, v83, v83
v_mov_b32 v37, v46
s_nop 1
v_permlane32_swap_b32 v46, v37
v_add_f32 v46, v46, v37
v_mov_b32 v37, v46
s_nop 1
v_permlane16_swap_b32 v46, v37
v_add_f32 v46, v46, v37
v_mov_b32 v37, v47
s_nop 1
v_permlane32_swap_b32 v47, v37
v_add_f32 v47, v47, v37
v_mov_b32 v37, v47
s_nop 1
v_permlane16_swap_b32 v47, v37
v_add_f32 v47, v47, v37
s_lshl_b32 s30, s2, 7
s_lshl_b32 s31, s24, 14
s_add_u32 s30, s30, s31
s_add_u32 s30, s30, 2359296
v_cndmask_b32 v50, 0, v46, s[46:47]
v_cndmask_b32 v51, 0, v47, s[46:47]
v_lshlrev_b32 v37, 3, v2
v_lshl_add_u32 v37, v3, 16, v37
v_cndmask_b32 v37, v36, v37, s[50:51]
buffer_store_dwordx2 v[50:51], v37, s[8:11], s30 offen sc1
L_p0_j2:
buffer_load_dwordx2 v[238:239], v48, s[84:87], 0 offen sc1
s_sub_u32 s30, s2, 0
s_cmp_lt_u32 s30, 256
s_cselect_b32 s36, 0, 1073741824
s_cselect_b32 s30, s30, 0
s_and_b32 s34, s30, 3
s_lshr_b32 s35, s30, 2
s_mov_b32 s14, 5308416
s_mov_b32 s15, 0x20000
s_mul_i32 s30, s34, 1327104
s_lshl_b32 s31, s35, 7
s_add_u32 s30, s30, s31
s_mul_i32 s31, s24, 73728
s_add_u32 s30, s30, s31
s_add_u32 s30, s30, s36
v_lshrrev_b32 v36, 7, v1
v_mul_u32_u24 v42, 9216, v36
v_and_b32 v36, 0x70, v1
v_add_u32 v42, v36, v42
s_lshl_b32 s32, s24, 10
s_mov_b32 s12, s72
s_mov_b32 s13, s73
s_add_u32 m0, s32, 20480
s_add_u32 s31, s30, 0
buffer_load_dwordx4 v42, s[12:15], s31 offen nt lds
s_add_u32 m0, s32, 24576
s_add_u32 s31, s30, 294912
buffer_load_dwordx4 v42, s[12:15], s31 offen nt lds
s_add_u32 m0, s32, 28672
s_add_u32 s31, s30, 589824
buffer_load_dwordx4 v42, s[12:15], s31 offen nt lds
s_add_u32 m0, s32, 32768
s_add_u32 s31, s30, 884736
buffer_load_dwordx4 v42, s[12:15], s31 offen nt lds
s_add_u32 m0, s32, 36864
s_add_u32 s31, s30, 1179648
s_cmp_lt_u32 s24, 2
s_cselect_b32 s31, s31, 1073741824
buffer_load_dwordx4 v42, s[12:15], s31 offen nt lds
s_sub_u32 s30, s2, 0
s_cmp_lt_u32 s30, 256
s_cselect_b32 s36, 0, 1073741824
s_cselect_b32 s30, s30, 0
s_and_b32 s34, s30, 3
s_lshr_b32 s35, s30, 2
s_lshl_b32 s92, s35, 6
s_lshl_b32 s33, s24, 4
s_add_u32 s92, s92, s33
s_cmp_ge_u32 s92, 2304
s_cselect_b32 s93, 1, 0
s_cselect_b32 s33, 2304, 0
s_sub_u32 s92, s92, s33
s_mul_i32 s94, s92, 1821
s_lshr_b32 s94, s94, 19
s_mul_i32 s33, s94, 288
s_sub_u32 s92, s92, s33
s_lshr_b32 s95, s92, 5
s_bfe_u32 s96, s92, 0x10004
s_lshl_b32 s94, s94, 1
s_cmp_ge_u32 s92, 144
s_addc_u32 s94, s94, 0
s_cmp_gt_u32 s95, 4
s_cselect_b32 s33, 5, 0
s_sub_u32 s97, s95, s33
s_cmp_eq_u32 s93, 0
s_cselect_b32 s33, 5, 0
s_add_u32 s97, s97, s33
s_cmp_eq_u32 s95, 4
s_cselect_b32 s97, 4, s97
s_mul_i32 s94, s94, 9
s_add_u32 s94, s94, s97
s_mul_i32 s94, s94, 37888
s_add_u32 s94, s94, 2785280
v_and_b32 v36, 3, v2
v_bfe_u32 v37, v2, 2, 1
v_bfe_u32 v38, v2, 3, 1
v_lshl_add_u32 v36, v38, 2, v36
s_lshl_b32 s33, s96, 3
v_add_u32 v36, s33, v36
s_cmp_eq_u32 s95, 4
s_cbranch_scc0 L_w3j_3
s_xor_b32 s33, s93, 1
v_mov_b32 v36, v2
v_mov_b32 v37, s33
L_w3j_3:
v_mul_u32_u24 v170, 18432, v37
v_lshl_add_u32 v170, v36, 4, v170
v_lshl_add_u32 v170, v3, 8, v170
s_mul_i32 s31, s34, 4608
s_add_u32 s31, s31, s94
v_add_u32 v170, s31, v170
v_lshlrev_b32 v171, 9, v37
v_lshl_add_u32 v171, v36, 3, v171
s_lshl_b32 s31, s34, 7
s_add_u32 s31, s31, s94
s_add_u32 s31, s31, 36864
v_add_u32 v171, s31, v171
v_mov_b32 v172, 1073741824
v_mov_b32 v52, 1073741824
v_mov_b32 v53, 1073741824
v_mov_b32 v54, 1073741824
v_mov_b32 v55, 1073741824
v_mov_b32 v56, 1073741824
s_cmp_lt_u32 s2, 32
s_cbranch_scc1 L_p0_a5
s_cmp_lt_u32 s2, 176
s_cbranch_scc1 L_p0_b5
s_sub_u32 s30, s2, 176
s_cmp_lt_u32 s30, 36
s_cselect_b32 s53, 0, 1073741824
s_cselect_b32 s30, s30, 0
s_and_b32 s38, s30, 3
s_lshr_b32 s52, s30, 2
v_lshrrev_b32 v39, 2, v2
v_and_b32 v40, 3, v2
v_lshlrev_b32 v40, 3, v40
s_lshl_b32 s31, s24, 5
v_add_u32 v40, s31, v40
v_lshl_add_u32 v36, v3, 2, v39
v_lshl_add_u32 v52, v36, 7, v40
v_lshrrev_b32 v36, 1, v39
v_mul_u32_u24 v36, 18, v36
v_and_b32 v41, 1, v39
v_add3_u32 v36, v36, v41, 16
v_and_b32 v41, 1, v3
v_mul_u32_u24 v41, 72, v41
v_add_u32 v36, v36, v41
v_lshl_add_u32 v53, v36, 7, v40
s_lshl_b32 s31, s52, 6
s_lshl_b32 s33, s24, 4
s_add_u32 s31, s31, s33
v_add_u32 v36, s31, v2
v_mul_u32_u24 v37, 911, v36
v_lshrrev_b32 v37, 16, v37
v_mul_u32_u24 v38, 72, v37
v_sub_u32 v36, v36, v38
s_mov_b32 s31, 82944
v_mul_lo_u32 v41, v37, s31
v_mov_b32 v173, v37
v_add_u32 v41, 2121728, v41
v_lshrrev_b32 v39, 5, v36
v_lshlrev_b32 v39, 11, v39
v_bfe_u32 v40, v36, 2, 1
v_lshl_add_u32 v39, v40, 10, v39
v_bfe_u32 v40, v36, 3, 2
v_lshl_add_u32 v39, v40, 6, v39
v_and_b32 v40, 3, v36
v_lshl_add_u32 v39, v40, 4, v39
v_lshlrev_b32 v40, 4, v36
v_add_u32 v40, 3072, v40
v_cmp_gt_u32 vcc, 64, v36
v_mov_b32 v47, 7
s_nop 0
v_cndmask_b32 v39, v40, v39, vcc
v_cndmask_b32 v47, v47, 8, vcc
v_add_u32 v41, v41, v39
s_mul_i32 s31, s38, 16
s_add_u32 s31, s31, 0
v_add_u32 v37, s31, v3
v_and_b32 v38, 3, v37
v_lshrrev_b32 v37, 2, v37
v_mul_u32_u24 v37, 4608, v37
v_lshlrev_b32 v38, v47, v38
v_add3_u32 v172, v41, v37, v38
s_mul_i32 s31, s38, 2
s_add_u32 s31, s31, 64
v_add_u32 v37, s31, v3
v_and_b32 v38, 3, v37
v_lshrrev_b32 v37, 2, v37
v_mul_u32_u24 v37, 4608, v37
v_lshlrev_b32 v38, v47, v38
v_add3_u32 v173, v41, v37, v38
s_branch L_p0_j5
L_p0_b5:
s_sub_u32 s30, s2, 32
s_cmp_lt_u32 s30, 144
s_cselect_b32 s53, 0, 1073741824
s_cselect_b32 s30, s30, 0
s_and_b32 s38, s30, 15
s_lshr_b32 s52, s30, 4
s_lshl_b32 s31, s52, 6
s_lshl_b32 s33, s24, 4
s_add_u32 s31, s31, s33
v_add_u32 v36, s31, v2
v_mul_u32_u24 v37, 911, v36
v_lshrrev_b32 v37, 16, v37
v_mul_u32_u24 v38, 72, v37
v_sub_u32 v36, v36, v38
s_mov_b32 s31, 331776
v_mul_lo_u32 v41, v37, s31
v_mov_b32 v173, v37
v_add_u32 v41, 8241152, v41
v_lshrrev_b32 v39, 5, v36
v_lshlrev_b32 v39, 11, v39
v_bfe_u32 v40, v36, 2, 1
v_lshl_add_u32 v39, v40, 10, v39
v_bfe_u32 v40, v36, 3, 2
v_lshl_add_u32 v39, v40, 6, v39
v_and_b32 v40, 3, v36
v_lshl_add_u32 v39, v40, 4, v39
v_lshlrev_b32 v40, 4, v36
v_add_u32 v40, 3072, v40
v_cmp_gt_u32 vcc, 64, v36
v_mov_b32 v47, 7
s_nop 0
v_cndmask_b32 v39, v40, v39, vcc
v_cndmask_b32 v47, v47, 8, vcc
v_add_u32 v41, v41, v39
v_mad_u32_u24 v46, v173, 9, 1
v_lshrrev_b32 v46, 1, v46
s_mul_i32 s31, s38, 18
v_add_u32 v37, s31, v3
v_and_b32 v38, 3, v37
v_lshrrev_b32 v37, 2, v37
v_lshlrev_b32 v38, v47, v38
v_add_u32 v41, v41, v38
s_cmp_ge_u32 s38, 8
s_cselect_b32 s31, 36, 0
v_add_u32 v38, s31, v46
v_sub_u32 v46, 0, v46
s_movk_i32 s31, 4608
v_add_u32 v36, 0, v37
v_sub_u32 v39, v36, v38
v_cmp_gt_u32 vcc, 4, v39
v_ashrrev_i32 v40, 31, v39
v_and_b32 v40, 4, v40
v_cndmask_b32 v40, v40, v46, vcc
v_add_u32 v36, v36, v40
v_mad_u32_u24 v52, v36, s31, v41
v_add_u32 v36, 1, v37
v_sub_u32 v39, v36, v38
v_cmp_gt_u32 vcc, 4, v39
v_ashrrev_i32 v40, 31, v39
v_and_b32 v40, 4, v40
v_cndmask_b32 v40, v40, v46, vcc
v_add_u32 v36, v36, v40
v_mad_u32_u24 v53, v36, s31, v41
v_add_u32 v36, 2, v37
v_sub_u32 v39, v36, v38
v_cmp_gt_u32 vcc, 4, v39
v_ashrrev_i32 v40, 31, v39
v_and_b32 v40, 4, v40
v_cndmask_b32 v40, v40, v46, vcc
v_add_u32 v36, v36, v40
v_mad_u32_u24 v54, v36, s31, v41
v_add_u32 v36, 3, v37
v_sub_u32 v39, v36, v38
v_cmp_gt_u32 vcc, 4, v39
v_ashrrev_i32 v40, 31, v39
v_and_b32 v40, 4, v40
v_cndmask_b32 v40, v40, v46, vcc
v_add_u32 v36, v36, v40
v_mad_u32_u24 v55, v36, s31, v41
v_add_u32 v36, 4, v37
v_sub_u32 v39, v36, v38
v_cmp_gt_u32 vcc, 4, v39
v_ashrrev_i32 v40, 31, v39
v_and_b32 v40, 4, v40
v_cndmask_b32 v40, v40, v46, vcc
v_add_u32 v36, v36, v40
v_mad_u32_u24 v56, v36, s31, v41
s_branch L_p0_j5
L_p0_a5:
s_add_u32 s30, s2, 256
s_cmp_lt_u32 s30, 288
s_cselect_b32 s53, 0, 1073741824
s_cselect_b32 s30, s30, 0
s_and_b32 s38, s30, 3
s_lshr_b32 s52, s30, 2
s_lshl_b32 s92, s52, 6
s_lshl_b32 s33, s24, 4
s_add_u32 s92, s92, s33
s_cmp_ge_u32 s92, 2304
s_cselect_b32 s93, 1, 0
s_cselect_b32 s33, 2304, 0
s_sub_u32 s92, s92, s33
s_mul_i32 s94, s92, 1821
s_lshr_b32 s94, s94, 19
s_mul_i32 s33, s94, 288
s_sub_u32 s92, s92, s33
s_lshr_b32 s95, s92, 5
s_bfe_u32 s96, s92, 0x10004
s_lshl_b32 s94, s94, 1
s_cmp_ge_u32 s92, 144
s_addc_u32 s94, s94, 0
s_cmp_gt_u32 s95, 4
s_cselect_b32 s33, 5, 0
s_sub_u32 s97, s95, s33
s_cmp_eq_u32 s93, 0
s_cselect_b32 s33, 5, 0
s_add_u32 s97, s97, s33
s_cmp_eq_u32 s95, 4
s_cselect_b32 s97, 4, s97
s_mul_i32 s94, s94, 9
s_add_u32 s94, s94, s97
s_mul_i32 s94, s94, 37888
s_add_u32 s94, s94, 2785280
v_and_b32 v36, 3, v2
v_bfe_u32 v37, v2, 2, 1
v_bfe_u32 v38, v2, 3, 1
v_lshl_add_u32 v36, v38, 2, v36
s_lshl_b32 s33, s96, 3
v_add_u32 v36, s33, v36
s_cmp_eq_u32 s95, 4
s_cbranch_scc0 L_w3j_6
s_xor_b32 s33, s93, 1
v_mov_b32 v36, v2
v_mov_b32 v37, s33
L_w3j_6:
v_mul_u32_u24 v172, 18432, v37
v_lshl_add_u32 v172, v36, 4, v172
v_lshl_add_u32 v172, v3, 8, v172
s_mul_i32 s31, s38, 4608
s_add_u32 s31, s31, s94
v_add_u32 v172, s31, v172
v_lshlrev_b32 v173, 9, v37
v_lshl_add_u32 v173, v36, 3, v173
s_lshl_b32 s31, s38, 7
s_add_u32 s31, s31, s94
s_add_u32 s31, s31, 36864
v_add_u32 v173, s31, v173
L_p0_j5:
s_lshl_b32 s30, s25, 2
s_add_u32 s30, s30, s24
s_mul_i32 s31, s30, 133120
s_lshl_b32 s30, s30, 17
s_mul_i32 s32, s24, 0
s_add_u32 s32, s32, s26
s_and_b32 s32, s32, 15
s_lshl_b32 s3, s32, 8
s_add_u32 s3, s3, s30
s_lshl_b32 s101, s32, 12
s_add_u32 s101, s101, s31
s_add_u32 s101, s101, 10895360
v_lshrrev_b32 v41, 4, v1
s_lshl_b32 s30, s25, 3
s_sub_u32 s30, s30, 1
v_add_u32 v36, s30, v41
v_max_i32 v36, 0, v36
v_bfe_u32 v37, v41, 2, 1
v_mul_u32_u24 v37, 35, v37
s_mul_i32 s30, s26, 36
v_add_u32 v37, s30, v37
v_lshrrev_b32 v37, 6, v37
v_bfe_u32 v38, v41, 3, 2
v_mad_u32_u24 v37, v38, 9, v37
v_and_b32 v38, 3, v41
v_lshl_add_u32 v37, v37, 2, v38
v_add_u32 v37, 128, v37
v_cndmask_b32 v36, v37, v36, s[50:51]
v_lshlrev_b32 v174, 7, v36
s_lshl_b32 s30, s2, 7
s_add_u32 s30, s30, 19415040
s_lshl_b32 s32, s2, 3
s_add_u32 s32, s32, 19447808
s_cmp_eq_u32 s24, 0
s_cselect_b32 s30, s30, 1073741824
s_cselect_b32 s100, s32, 1073741824
s_waitcnt vmcnt(5)
v_cmp_eq_u32 vcc, 0, v238
s_mov_b32 s31, 0
s_cbranch_vccnz L_tagslow_7
L_tagback_8:
s_barrier
s_mov_b64 exec, 1
buffer_store_dwordx2 v[238:239], v48, s[4:7], s30 offen sc1
s_mov_b64 exec, -1
s_cmp_lt_u32 s2, 32
s_cbranch_scc1 L_p0_a3
s_cmp_lt_u32 s2, 176
s_cbranch_scc1 L_p0_b3
s_mov_b32 s14, 663552
s_mov_b32 s15, 0x20000
s_mul_i32 s30, s38, 165888
s_lshl_b32 s31, s52, 7
s_add_u32 s30, s30, s31
s_mul_i32 s31, s24, 9216
s_add_u32 s30, s30, s31
s_add_u32 s30, s30, s53
v_lshrrev_b32 v36, 7, v1
v_mul_u32_u24 v42, 1152, v36
v_and_b32 v36, 0x70, v1
v_add_u32 v42, v36, v42
s_lshl_b32 s32, s24, 10
s_mov_b32 s12, s68
s_mov_b32 s13, s69
s_add_u32 m0, s32, 40960
s_add_u32 s31, s30, 0
buffer_load_dwordx4 v42, s[12:15], s31 offen nt lds
s_add_u32 m0, s32, 45056
s_add_u32 s31, s30, 36864
buffer_load_dwordx4 v42, s[12:15], s31 offen nt lds
s_add_u32 m0, s32, 49152
s_add_u32 s31, s30, 73728
buffer_load_dwordx4 v42, s[12:15], s31 offen nt lds
s_add_u32 m0, s32, 53248
s_add_u32 s31, s30, 110592
buffer_load_dwordx4 v42, s[12:15], s31 offen nt lds
s_add_u32 m0, s32, 57344
s_add_u32 s31, s30, 147456
s_cmp_lt_u32 s24, 2
s_cselect_b32 s31, s31, 1073741824
buffer_load_dwordx4 v42, s[12:15], s31 offen nt lds
s_branch L_p0_j3
L_p0_b3:
s_mov_b32 s14, 2654208
s_mov_b32 s15, 0x20000
s_mul_i32 s30, s38, 165888
s_lshl_b32 s31, s52, 7
s_add_u32 s30, s30, s31
s_mul_i32 s31, s24, 9216
s_add_u32 s30, s30, s31
s_add_u32 s30, s30, s53
v_lshrrev_b32 v36, 7, v1
v_mul_u32_u24 v42, 1152, v36
v_and_b32 v36, 0x70, v1
v_add_u32 v42, v36, v42
s_lshl_b32 s32, s24, 10
s_mov_b32 s12, s78
s_mov_b32 s13, s79
s_add_u32 m0, s32, 40960
s_add_u32 s31, s30, 0
buffer_load_dwordx4 v42, s[12:15], s31 offen nt lds
s_add_u32 m0, s32, 45056
s_add_u32 s31, s30, 36864
buffer_load_dwordx4 v42, s[12:15], s31 offen nt lds
s_add_u32 m0, s32, 49152
s_add_u32 s31, s30, 73728
buffer_load_dwordx4 v42, s[12:15], s31 offen nt lds
s_add_u32 m0, s32, 53248
s_add_u32 s31, s30, 110592
buffer_load_dwordx4 v42, s[12:15], s31 offen nt lds
s_add_u32 m0, s32, 57344
s_add_u32 s31, s30, 147456
s_cmp_lt_u32 s24, 2
s_cselect_b32 s31, s31, 1073741824
buffer_load_dwordx4 v42, s[12:15], s31 offen nt lds
s_branch L_p0_j3
L_p0_a3:
s_mov_b32 s14, 5308416
s_mov_b32 s15, 0x20000
s_mul_i32 s30, s38, 1327104
s_lshl_b32 s31, s52, 7
s_add_u32 s30, s30, s31
s_mul_i32 s31, s24, 73728
s_add_u32 s30, s30, s31
s_add_u32 s30, s30, s53
v_lshrrev_b32 v36, 7, v1
v_mul_u32_u24 v42, 9216, v36
v_and_b32 v36, 0x70, v1
v_add_u32 v42, v36, v42
s_lshl_b32 s32, s24, 10
s_mov_b32 s12, s72
s_mov_b32 s13, s73
s_add_u32 m0, s32, 40960
s_add_u32 s31, s30, 0
buffer_load_dwordx4 v42, s[12:15], s31 offen nt lds
s_add_u32 m0, s32, 45056
s_add_u32 s31, s30, 294912
buffer_load_dwordx4 v42, s[12:15], s31 offen nt lds
s_add_u32 m0, s32, 49152
s_add_u32 s31, s30, 589824
buffer_load_dwordx4 v42, s[12:15], s31 offen nt lds
s_add_u32 m0, s32, 53248
s_add_u32 s31, s30, 884736
buffer_load_dwordx4 v42, s[12:15], s31 offen nt lds
s_add_u32 m0, s32, 57344
s_add_u32 s31, s30, 1179648
s_cmp_lt_u32 s24, 2
s_cselect_b32 s31, s31, 1073741824
buffer_load_dwordx4 v42, s[12:15], s31 offen nt lds
L_p0_j3:
s_waitcnt vmcnt(6)
s_barrier
ds_read_b64_tr_b16 v[84:85], v45 offset:20480
ds_read_b64_tr_b16 v[86:87], v45 offset:20992
ds_read_b64_tr_b16 v[88:89], v45 offset:24576
ds_read_b64_tr_b16 v[90:91], v45 offset:25088
ds_read_b64_tr_b16 v[92:93], v45 offset:28672
ds_read_b64_tr_b16 v[94:95], v45 offset:29184
ds_read_b64_tr_b16 v[96:97], v45 offset:32768
ds_read_b64_tr_b16 v[98:99], v45 offset:33280
ds_read_b64_tr_b16 v[100:101], v45 offset:36864
ds_read_b64_tr_b16 v[102:103], v45 offset:37376
v_mov_b32 v36, 1073741824
v_mov_b32 v46, 0
v_cndmask_b32 v37, v36, v170, s[50:51]
s_add_u32 s31, s36, 0
s_waitcnt lgkmcnt(8)
buffer_store_dwordx4 v[84:87], v170, s[4:7], s31 offen sc1
s_add_u32 s31, s36, 1024
s_waitcnt lgkmcnt(6)
buffer_store_dwordx4 v[88:91], v170, s[4:7], s31 offen sc1
s_add_u32 s31, s36, 2048
s_waitcnt lgkmcnt(4)
buffer_store_dwordx4 v[92:95], v170, s[4:7], s31 offen sc1
s_add_u32 s31, s36, 3072
s_waitcnt lgkmcnt(2)
buffer_store_dwordx4 v[96:99], v170, s[4:7], s31 offen sc1
s_add_u32 s31, s36, 4096
s_waitcnt lgkmcnt(0)
buffer_store_dwordx4 v[100:103], v37, s[4:7], s31 offen sc1
v_mov_b32 v37, 0x3f803f80
v_dot2c_f32_bf16 v46, v84, v37
v_dot2c_f32_bf16 v46, v85, v37
v_dot2c_f32_bf16 v46, v86, v37
v_dot2c_f32_bf16 v46, v87, v37
v_dot2c_f32_bf16 v46, v88, v37
v_dot2c_f32_bf16 v46, v89, v37
v_dot2c_f32_bf16 v46, v90, v37
v_dot2c_f32_bf16 v46, v91, v37
v_dot2c_f32_bf16 v46, v92, v37
v_dot2c_f32_bf16 v46, v93, v37
v_dot2c_f32_bf16 v46, v94, v37
v_dot2c_f32_bf16 v46, v95, v37
v_dot2c_f32_bf16 v46, v96, v37
v_dot2c_f32_bf16 v46, v97, v37
v_dot2c_f32_bf16 v46, v98, v37
v_dot2c_f32_bf16 v46, v99, v37
v_dot2c_f32_bf16 v46, v100, v37
v_dot2c_f32_bf16 v46, v101, v37
v_dot2c_f32_bf16 v46, v102, v37
v_dot2c_f32_bf16 v46, v103, v37
s_nop 2
v_mov_b32 v37, v46
s_nop 1
v_permlane32_swap_b32 v46, v37
v_add_f32 v46, v46, v37
v_mov_b32 v37, v46
s_nop 1
v_permlane16_swap_b32 v46, v37
v_add_f32 v46, v46, v37
v_cvt_pk_bf16_f32 v50, v46, v46
v_and_b32 v37, 0xffff0000, v50
v_sub_f32 v37, v46, v37
v_cvt_pk_bf16_f32 v51, v37, v37
v_cndmask_b32 v36, v36, v171, s[46:47]
buffer_store_dwordx2 v[50:51], v36, s[4:7], s36 offen sc1
s_waitcnt vmcnt(6)
s_barrier
s_cmp_lt_u32 s2, 32
s_cbranch_scc1 L_p0_a4
s_cmp_lt_u32 s2, 176
s_cbranch_scc1 L_p0_b4
ds_read_b64_tr_b16 v[104:105], v52 offset:40960
ds_read_b64_tr_b16 v[106:107], v52 offset:43264
ds_read_b64_tr_b16 v[108:109], v52 offset:45568
ds_read_b64_tr_b16 v[110:111], v52 offset:47872
ds_read_b64_tr_b16 v[112:113], v52 offset:50176
ds_read_b64_tr_b16 v[114:115], v52 offset:52480
ds_read_b64_tr_b16 v[116:117], v52 offset:54784
ds_read_b64_tr_b16 v[118:119], v52 offset:57088
ds_read_b64_tr_b16 v[120:121], v53 offset:40960
ds_read_b64_tr_b16 v[122:123], v53 offset:45568
v_mov_b32 v36, 1073741824
v_mov_b32 v46, 0
v_cndmask_b32 v37, v36, v173, s[50:51]
s_add_u32 s31, s53, 0
s_waitcnt lgkmcnt(8)
buffer_store_dwordx4 v[104:107], v172, s[4:7], s31 offen sc1
s_add_u32 s31, s53, 4608
s_waitcnt lgkmcnt(6)
buffer_store_dwordx4 v[108:111], v172, s[4:7], s31 offen sc1
s_add_u32 s31, s53, 9216
s_waitcnt lgkmcnt(4)
buffer_store_dwordx4 v[112:115], v172, s[4:7], s31 offen sc1
s_add_u32 s31, s53, 13824
s_waitcnt lgkmcnt(2)
buffer_store_dwordx4 v[116:119], v172, s[4:7], s31 offen sc1
s_add_u32 s31, s53, 0
s_waitcnt lgkmcnt(0)
buffer_store_dwordx4 v[120:123], v37, s[4:7], s31 offen sc1
buffer_store_dwordx2 v[50:51], v36, s[4:7], s53 offen sc1
s_branch L_p0_j4
L_p0_b4:
ds_read_b64_tr_b16 v[104:105], v45 offset:40960
ds_read_b64_tr_b16 v[106:107], v45 offset:41472
ds_read_b64_tr_b16 v[108:109], v45 offset:45056
ds_read_b64_tr_b16 v[110:111], v45 offset:45568
ds_read_b64_tr_b16 v[112:113], v45 offset:49152
ds_read_b64_tr_b16 v[114:115], v45 offset:49664
ds_read_b64_tr_b16 v[116:117], v45 offset:53248
ds_read_b64_tr_b16 v[118:119], v45 offset:53760
ds_read_b64_tr_b16 v[120:121], v45 offset:57344
ds_read_b64_tr_b16 v[122:123], v45 offset:57856
v_mov_b32 v36, 1073741824
v_mov_b32 v46, 0
v_cndmask_b32 v37, v36, v56, s[50:51]
s_add_u32 s31, s53, 0
s_waitcnt lgkmcnt(8)
buffer_store_dwordx4 v[104:107], v52, s[4:7], s31 offen sc1
s_add_u32 s31, s53, 0
s_waitcnt lgkmcnt(6)
buffer_store_dwordx4 v[108:111], v53, s[4:7], s31 offen sc1
s_add_u32 s31, s53, 0
s_waitcnt lgkmcnt(4)
buffer_store_dwordx4 v[112:115], v54, s[4:7], s31 offen sc1
s_add_u32 s31, s53, 0
s_waitcnt lgkmcnt(2)
buffer_store_dwordx4 v[116:119], v55, s[4:7], s31 offen sc1
s_add_u32 s31, s53, 0
s_waitcnt lgkmcnt(0)
buffer_store_dwordx4 v[120:123], v37, s[4:7], s31 offen sc1
buffer_store_dwordx2 v[50:51], v36, s[4:7], s53 offen sc1
s_branch L_p0_j4
L_p0_a4:
ds_read_b64_tr_b16 v[104:105], v45 offset:40960
ds_read_b64_tr_b16 v[106:107], v45 offset:41472
ds_read_b64_tr_b16 v[108:109], v45 offset:45056
ds_read_b64_tr_b16 v[110:111], v45 offset:45568
ds_read_b64_tr_b16 v[112:113], v45 offset:49152
ds_read_b64_tr_b16 v[114:115], v45 offset:49664
ds_read_b64_tr_b16 v[116:117], v45 offset:53248
ds_read_b64_tr_b16 v[118:119], v45 offset:53760
ds_read_b64_tr_b16 v[120:121], v45 offset:57344
ds_read_b64_tr_b16 v[122:123], v45 offset:57856
v_mov_b32 v36, 1073741824
v_mov_b32 v46, 0
v_cndmask_b32 v37, v36, v172, s[50:51]
s_add_u32 s31, s53, 0
s_waitcnt lgkmcnt(8)
buffer_store_dwordx4 v[104:107], v172, s[4:7], s31 offen sc1
s_add_u32 s31, s53, 1024
s_waitcnt lgkmcnt(6)
buffer_store_dwordx4 v[108:111], v172, s[4:7], s31 offen sc1
s_add_u32 s31, s53, 2048
s_waitcnt lgkmcnt(4)
buffer_store_dwordx4 v[112:115], v172, s[4:7], s31 offen sc1
s_add_u32 s31, s53, 3072
s_waitcnt lgkmcnt(2)
buffer_store_dwordx4 v[116:119], v172, s[4:7], s31 offen sc1
s_add_u32 s31, s53, 4096
s_waitcnt lgkmcnt(0)
buffer_store_dwordx4 v[120:123], v37, s[4:7], s31 offen sc1
v_mov_b32 v37, 0x3f803f80
v_dot2c_f32_bf16 v46, v104, v37
v_dot2c_f32_bf16 v46, v105, v37
v_dot2c_f32_bf16 v46, v106, v37
v_dot2c_f32_bf16 v46, v107, v37
v_dot2c_f32_bf16 v46, v108, v37
v_dot2c_f32_bf16 v46, v109, v37
v_dot2c_f32_bf16 v46, v110, v37
v_dot2c_f32_bf16 v46, v111, v37
v_dot2c_f32_bf16 v46, v112, v37
v_dot2c_f32_bf16 v46, v113, v37
v_dot2c_f32_bf16 v46, v114, v37
v_dot2c_f32_bf16 v46, v115, v37
v_dot2c_f32_bf16 v46, v116, v37
v_dot2c_f32_bf16 v46, v117, v37
v_dot2c_f32_bf16 v46, v118, v37
v_dot2c_f32_bf16 v46, v119, v37
v_dot2c_f32_bf16 v46, v120, v37
v_dot2c_f32_bf16 v46, v121, v37
v_dot2c_f32_bf16 v46, v122, v37
v_dot2c_f32_bf16 v46, v123, v37
s_nop 2
v_mov_b32 v37, v46
s_nop 1
v_permlane32_swap_b32 v46, v37
v_add_f32 v46, v46, v37
v_mov_b32 v37, v46
s_nop 1
v_permlane16_swap_b32 v46, v37
v_add_f32 v46, v46, v37
v_cvt_pk_bf16_f32 v50, v46, v46
v_and_b32 v37, 0xffff0000, v50
v_sub_f32 v37, v46, v37
v_cvt_pk_bf16_f32 v51, v37, v37
v_cndmask_b32 v36, v36, v173, s[46:47]
buffer_store_dwordx2 v[50:51], v36, s[4:7], s53 offen sc1
L_p0_j4:
s_mov_b32 s12, s74
s_mov_b32 s13, s75
s_mov_b32 s14, 8388608
s_mov_b32 s15, 0x20000
s_cmp_eq_u32 s24, 1
s_cselect_b32 s63, 0, 1073741824
s_add_u32 s63, s63, 19415040
s_mov_b32 exec_lo, 0x000001ff
s_mov_b32 exec_hi, 0x00ffffff
buffer_load_dwordx2 v[176:177], v174, s[4:7], s63 offen sc1
s_mov_b64 exec, -1
s_cmp_eq_u32 s24, 1
s_cbranch_scc0 L_p0done_10
s_mov_b32 s31, 0
s_mov_b32 exec_lo, 0x000001ff
s_mov_b32 exec_hi, 0x00ffffff
s_waitcnt vmcnt(0)
v_cmp_ne_u64 vcc, v[176:177], v[238:239]
s_nop 0
s_cbranch_vccz L_p0done_10
L_p0poll_9:
buffer_load_dwordx2 v[176:177], v174, s[4:7], s63 offen sc1
s_add_u32 s31, s31, 1
s_waitcnt vmcnt(0)
v_cmp_ne_u64 vcc, v[176:177], v[238:239]
s_cmp_gt_u32 s31, 200000
s_cbranch_scc1 L_p0done_10
s_cbranch_vccnz L_p0poll_9
L_p0done_10:
s_mov_b64 exec, -1
s_barrier
s_lshl_b32 s33, s25, 8
s_lshl_b32 s32, s24, 6
s_add_u32 s33, s33, s32
v_lshlrev_b32 v8, 1, v2
buffer_load_ushort v0, v8, s[20:23], s33 offen
buffer_load_ushort v249, v8, s[20:23], s33 offen offset:32
s_mul_i32 s30, s70, 18432
s_mul_i32 s31, s28, 2304
s_add_u32 s30, s30, s31
s_add_u32 s30, s30, 0
v_and_b32 v6, 1, v3
v_lshlrev_b32 v6, 3, v6
v_lshl_add_u32 v6, v2, 4, v6
buffer_load_dwordx4 v[36:39], v1, s[8:11], s30 offen sc1
buffer_load_dwordx4 v[40:43], v1, s[8:11], s30 offen offset:1024 sc1
buffer_load_dwordx2 v[44:45], v6, s[8:11], s30 offen offset:2048 sc1
s_mul_i32 s36, s26, 132608
s_mul_i32 s38, s24, 12288
s_add_u32 m0, s38, 0
s_add_u32 s39, s38, s36
buffer_load_dwordx4 v1, s[4:7], s39 offen offset:0 sc1 lds
buffer_load_dwordx4 v1, s[4:7], s39 offen offset:1024 sc1 lds
buffer_load_dwordx4 v1, s[4:7], s39 offen offset:2048 sc1 lds
buffer_load_dwordx4 v1, s[4:7], s39 offen offset:3072 sc1 lds
s_add_u32 m0, m0, 4096
s_add_u32 s39, s39, 4096
buffer_load_dwordx4 v1, s[4:7], s39 offen offset:0 sc1 lds
buffer_load_dwordx4 v1, s[4:7], s39 offen offset:1024 sc1 lds
buffer_load_dwordx4 v1, s[4:7], s39 offen offset:2048 sc1 lds
buffer_load_dwordx4 v1, s[4:7], s39 offen offset:3072 sc1 lds
s_add_u32 m0, m0, 4096
s_add_u32 s39, s39, 4096
buffer_load_dwordx4 v1, s[4:7], s39 offen offset:0 sc1 lds
buffer_load_dwordx4 v1, s[4:7], s39 offen offset:1024 sc1 lds
buffer_load_dwordx4 v1, s[4:7], s39 offen offset:2048 sc1 lds
buffer_load_dwordx4 v1, s[4:7], s39 offen offset:3072 sc1 lds
v_and_b32 v6, 1, v2
v_cmp_eq_u32 s[40:41], 1, v6
v_lshl_add_u32 v6, v3, 2, v6
v_cmp_le_u32 s[42:43], v6, v2
v_add_u32_e64 v6, 2, v6
v_cmp_le_u32 s[44:45], v6, v2
v_mov_b32 v6, 0x0c0c0100
v_mov_b32 v7, 0x01000c0c
v_cndmask_b32 v6, v6, v7, s[40:41]
v_mov_b32 v8, 0x0c0c0c0c
v_cndmask_b32 v10, v6, v8, s[42:43]
v_cndmask_b32 v12, v8, v6, s[42:43]
v_mov_b32 v6, 0x0c0c0302
v_mov_b32 v7, 0x03020c0c
v_cndmask_b32 v6, v6, v7, s[40:41]
v_cndmask_b32 v11, v6, v8, s[44:45]
v_cndmask_b32 v13, v8, v6, s[44:45]
s_mul_i32 s82, s26, 340992
s_add_u32 s82, s82, 2785280
s_mul_i32 s83, s28, 331776
s_add_u32 s83, s83, 8241152
s_and_b32 s30, s27, 1
s_mul_i32 s30, s30, 165888
s_add_u32 s83, s83, s30
s_waitcnt vmcnt(12)
v_lshlrev_b32 v16, 16, v36
v_and_b32 v17, 0xffff0000, v36
v_lshlrev_b32 v18, 16, v37
v_and_b32 v19, 0xffff0000, v37
v_lshlrev_b32 v20, 16, v38
v_and_b32 v21, 0xffff0000, v38
v_lshlrev_b32 v22, 16, v39
v_and_b32 v23, 0xffff0000, v39
v_lshlrev_b32 v24, 16, v40
v_and_b32 v25, 0xffff0000, v40
v_lshlrev_b32 v26, 16, v41
v_and_b32 v27, 0xffff0000, v41
v_lshlrev_b32 v28, 16, v42
v_and_b32 v29, 0xffff0000, v42
v_lshlrev_b32 v30, 16, v43
v_and_b32 v31, 0xffff0000, v43
v_lshlrev_b32 v32, 16, v44
v_and_b32 v33, 0xffff0000, v44
v_lshlrev_b32 v34, 16, v45
v_and_b32 v35, 0xffff0000, v45
v_mov_b32 v6, 0
s_barrier
v_mov_b32 v248, v238
s_mov_b64 exec, 1
buffer_store_dwordx2 v[238:239], v6, s[4:7], s100 offen sc1
s_mov_b64 exec, -1
s_mul_i32 s36, s26, 132608
s_mul_i32 s38, s24, 9216
s_add_u32 m0, s38, 49152
s_add_u32 s39, s38, s36
s_add_u32 s39, s39, 49152
buffer_load_dwordx4 v1, s[4:7], s39 offen offset:0 sc1 lds
buffer_load_dwordx4 v1, s[4:7], s39 offen offset:1024 sc1 lds
buffer_load_dwordx4 v1, s[4:7], s39 offen offset:2048 sc1 lds
buffer_load_dwordx4 v1, s[4:7], s39 offen offset:3072 sc1 lds
s_add_u32 m0, m0, 4096
s_add_u32 s39, s39, 4096
buffer_load_dwordx4 v1, s[4:7], s39 offen offset:0 sc1 lds
buffer_load_dwordx4 v1, s[4:7], s39 offen offset:1024 sc1 lds
buffer_load_dwordx4 v1, s[4:7], s39 offen offset:2048 sc1 lds
buffer_load_dwordx4 v1, s[4:7], s39 offen offset:3072 sc1 lds
s_add_u32 m0, m0, 4096
s_add_u32 s39, s39, 4096
buffer_load_dwordx4 v1, s[4:7], s39 offen offset:0 sc1 lds
s_lshl_b32 s60, s25, 3
s_sub_u32 s61, s60, 1
s_max_i32 s61, s61, 0
s_lshl_b32 s30, s24, 1
s_add_u32 s60, s60, s30
s_mul_i32 s30, s61, 18432
s_mul_i32 s62, s60, 18432
v_add_u32 v237, 18432, v1
s_mul_i32 s38, s24, 5120
s_add_u32 m0, s38, 135168
s_add_u32 s39, s38, s30
L_layer:
buffer_load_dwordx4 v1, s[8:11], s39 offen offset:0 sc1 lds
buffer_load_dwordx4 v1, s[8:11], s39 offen offset:1024 sc1 lds
buffer_load_dwordx4 v1, s[8:11], s39 offen offset:2048 sc1 lds
buffer_load_dwordx4 v1, s[8:11], s39 offen offset:3072 sc1 lds
s_add_u32 m0, m0, 4096
s_add_u32 s39, s39, 4096
buffer_load_dwordx4 v1, s[8:11], s39 offen offset:0 sc1 lds
s_barrier
buffer_load_dwordx4 a[0:3], v1, s[8:11], s62 offen offset:0 sc1
buffer_load_dwordx4 a[4:7], v237, s[8:11], s62 offen offset:0 sc1
s_barrier
buffer_load_dwordx4 a[8:11], v1, s[8:11], s62 offen offset:1024 sc1
buffer_load_dwordx4 a[12:15], v237, s[8:11], s62 offen offset:1024 sc1
s_barrier
buffer_load_dwordx4 a[16:19], v1, s[8:11], s62 offen offset:2048 sc1
buffer_load_dwordx4 a[20:23], v237, s[8:11], s62 offen offset:2048 sc1
s_barrier
buffer_load_dwordx4 a[24:27], v1, s[8:11], s62 offen offset:3072 sc1
buffer_load_dwordx4 a[28:31], v237, s[8:11], s62 offen offset:3072 sc1
s_barrier
s_add_u32 s62, s62, 4096
buffer_load_dwordx4 a[32:35], v1, s[8:11], s62 offen offset:0 sc1
buffer_load_dwordx4 a[36:39], v237, s[8:11], s62 offen offset:0 sc1
s_barrier
buffer_load_dwordx4 a[40:43], v1, s[8:11], s62 offen offset:1024 sc1
buffer_load_dwordx4 a[44:47], v237, s[8:11], s62 offen offset:1024 sc1
s_sub_u32 s30, s60, 2
v_add_u32 v6, s30, v3
v_max_i32 v6, 0, v6
v_mov_b32 v7, s61
v_cndmask_b32 v6, v6, v7, s[46:47]
v_lshl_add_u32 v6, v6, 4, v2
v_lshlrev_b32 v129, 3, v6
s_lshl_b32 s30, s24, 10
v_add_u32 v125, s30, v1
v_add_u32 v126, 135168, v1
v_lshrrev_b32 v127, 1, v1
v_add_u32 v127, 129024, v127
s_lshl_b32 s30, s24, 9
v_add_u32 v128, s30, v127
v_add_u32 v8, 64512, v1
s_waitcnt vmcnt(12)
s_barrier
ds_read_b128 a[144:147], v1 offset:0
ds_read_b128 a[148:151], v1 offset:1024
ds_read_b128 a[152:155], v1 offset:2048
ds_read_b128 a[156:159], v1 offset:3072
ds_read_b128 a[160:163], v1 offset:4096
ds_read_b128 a[164:167], v1 offset:5120
ds_read_b128 a[168:171], v1 offset:6144
ds_read_b128 a[172:175], v125 offset:0
ds_read_b128 a[176:179], v126 offset:0
v_lshrrev_b32 v146, 1, v1
s_lshl_b32 s66, s24, 9
s_add_u32 s66, s66, 19447808
s_waitcnt vmcnt(10) lgkmcnt(0)
v_mfma_f32_16x16x32_bf16 v[36:39], a[144:147], a[0:3], 0
ds_read_b128 a[180:183], v1 offset:7168
buffer_load_dwordx4 a[48:51], v1, s[8:11], s62 offen offset:2048 sc1
v_mfma_f32_16x16x32_bf16 v[64:67], a[144:147], a[4:7], 0
ds_read_b128 a[184:187], v1 offset:8192
v_mfma_f32_16x16x32_bf16 v[40:43], a[148:151], a[0:3], 0
ds_read_b128 a[188:191], v1 offset:9216
v_mfma_f32_16x16x32_bf16 v[68:71], a[148:151], a[4:7], 0
ds_read_b128 a[192:195], v1 offset:10240
v_mfma_f32_16x16x32_bf16 v[44:47], a[152:155], a[0:3], 0
ds_read_b128 a[196:199], v1 offset:11264
buffer_load_dwordx4 a[52:55], v237, s[8:11], s62 offen offset:2048 sc1
v_mfma_f32_16x16x32_bf16 v[72:75], a[152:155], a[4:7], 0
ds_read_b128 a[200:203], v1 offset:12288
v_mfma_f32_16x16x32_bf16 v[48:51], a[156:159], a[0:3], 0
ds_read_b128 a[204:207], v1 offset:13312
v_mfma_f32_16x16x32_bf16 v[76:79], a[156:159], a[4:7], 0
ds_read_b128 a[208:211], v125 offset:7168
v_mfma_f32_16x16x32_bf16 v[52:55], a[160:163], a[0:3], 0
ds_read_b128 a[212:215], v126 offset:1024
buffer_load_dwordx4 a[56:59], v1, s[8:11], s62 offen offset:3072 sc1
v_mfma_f32_16x16x32_bf16 v[80:83], a[160:163], a[4:7], 0
v_mfma_f32_16x16x32_bf16 v[92:95], a[172:175], a[176:179], 0
v_mfma_f32_16x16x32_bf16 v[96:99], a[160:163], a[176:179], 0
v_mfma_f32_16x16x32_bf16 v[56:59], a[164:167], a[0:3], 0
buffer_load_dwordx4 a[60:63], v237, s[8:11], s62 offen offset:3072 sc1
v_mfma_f32_16x16x32_bf16 v[84:87], a[164:167], a[4:7], 0
s_add_u32 s62, s62, 4096
v_mfma_f32_16x16x32_bf16 v[60:63], a[168:171], a[0:3], 0
v_mfma_f32_16x16x32_bf16 v[88:91], a[168:171], a[4:7], 0
s_waitcnt vmcnt(12) lgkmcnt(0)
v_mfma_f32_16x16x32_bf16 v[36:39], a[180:183], a[8:11], v[36:39]
ds_read_b128 a[144:147], v1 offset:14336
v_lshlrev_b32 v124, 2, v2
v_mfma_f32_16x16x32_bf16 v[64:67], a[180:183], a[12:15], v[64:67]
ds_read_b128 a[148:151], v1 offset:15360
v_and_b32 v6, 1, v2
v_mfma_f32_16x16x32_bf16 v[40:43], a[184:187], a[8:11], v[40:43]
ds_read_b128 a[152:155], v1 offset:16384
v_mfma_f32_16x16x32_bf16 v[68:71], a[184:187], a[12:15], v[68:71]
ds_read_b128 a[156:159], v1 offset:17408
v_lshl_add_u32 v6, v3, 2, v6
v_mfma_f32_16x16x32_bf16 v[44:47], a[188:191], a[8:11], v[44:47]
ds_read_b128 a[160:163], v1 offset:18432
v_lshlrev_b32 v6, 2, v6
v_mfma_f32_16x16x32_bf16 v[72:75], a[188:191], a[12:15], v[72:75]
ds_read_b128 a[164:167], v1 offset:19456
buffer_load_dwordx4 a[64:67], v1, s[8:11], s62 offen offset:0 sc1
v_mfma_f32_16x16x32_bf16 v[48:51], a[192:195], a[8:11], v[48:51]
ds_read_b128 a[168:171], v1 offset:20480
v_add_u32 v122, 64, v6
v_mfma_f32_16x16x32_bf16 v[76:79], a[192:195], a[12:15], v[76:79]
ds_read_b128 a[172:175], v125 offset:14336
v_mfma_f32_16x16x32_bf16 v[52:55], a[196:199], a[8:11], v[52:55]
ds_read_b128 a[176:179], v126 offset:2048
v_add_u32 v7, 128, v6
v_mfma_f32_16x16x32_bf16 v[80:83], a[196:199], a[12:15], v[80:83]
buffer_load_dwordx4 a[68:71], v237, s[8:11], s62 offen offset:0 sc1
v_cndmask_b32 v122, v122, v7, s[42:43]
v_mfma_f32_16x16x32_bf16 v[92:95], a[208:211], a[212:215], v[92:95]
v_mfma_f32_16x16x32_bf16 v[96:99], a[196:199], a[212:215], v[96:99]
v_add_u32 v123, 72, v6
v_mfma_f32_16x16x32_bf16 v[56:59], a[200:203], a[8:11], v[56:59]
v_mfma_f32_16x16x32_bf16 v[84:87], a[200:203], a[12:15], v[84:87]
v_add_u32 v7, 136, v6
v_mfma_f32_16x16x32_bf16 v[60:63], a[204:207], a[8:11], v[60:63]
buffer_load_dwordx4 a[72:75], v1, s[8:11], s62 offen offset:1024 sc1
v_cndmask_b32 v123, v123, v7, s[44:45]
v_mfma_f32_16x16x32_bf16 v[88:91], a[204:207], a[12:15], v[88:91]
s_mov_b32 s63, 2359296
s_waitcnt vmcnt(13) lgkmcnt(0)
v_mfma_f32_16x16x32_bf16 v[36:39], a[144:147], a[16:19], v[36:39]
ds_read_b128 a[180:183], v1 offset:21504
s_lshl_b32 s31, s24, 5
v_mfma_f32_16x16x32_bf16 v[64:67], a[144:147], a[20:23], v[64:67]
ds_read_b128 a[184:187], v1 offset:22528
v_mfma_f32_16x16x32_bf16 v[40:43], a[148:151], a[16:19], v[40:43]
ds_read_b128 a[188:191], v1 offset:23552
v_add_u32 v6, s31, v2
v_mfma_f32_16x16x32_bf16 v[68:71], a[148:151], a[20:23], v[68:71]
ds_read_b128 a[192:195], v1 offset:24576
v_mul_u32_u24 v220, 176, v6
v_mfma_f32_16x16x32_bf16 v[44:47], a[152:155], a[16:19], v[44:47]
ds_read_b128 a[196:199], v1 offset:25600
v_mfma_f32_16x16x32_bf16 v[72:75], a[152:155], a[20:23], v[72:75]
ds_read_b128 a[200:203], v1 offset:26624
v_add_u32 v220, 0, v220
v_mfma_f32_16x16x32_bf16 v[48:51], a[156:159], a[16:19], v[48:51]
ds_read_b128 a[204:207], v1 offset:27648
buffer_load_dwordx2 v[100:101], v129, s[8:11], s63 offen sc1
v_mfma_f32_16x16x32_bf16 v[76:79], a[156:159], a[20:23], v[76:79]
ds_read_b128 a[208:211], v125 offset:21504
v_lshl_add_u32 v218, v3, 3, v220
v_mfma_f32_16x16x32_bf16 v[52:55], a[160:163], a[16:19], v[52:55]
ds_read_b128 a[212:215], v126 offset:3072
s_mul_i32 s36, s26, 132608
v_mfma_f32_16x16x32_bf16 v[80:83], a[160:163], a[20:23], v[80:83]
s_mov_b32 s63, 2375680
v_mul_u32_u24 v219, 176, v2
v_mfma_f32_16x16x32_bf16 v[92:95], a[172:175], a[176:179], v[92:95]
s_mul_i32 s38, s24, 12288
v_lshl_add_u32 v219, v3, 3, v219
v_mfma_f32_16x16x32_bf16 v[96:99], a[160:163], a[176:179], v[96:99]
s_add_u32 m0, s38, 86016
v_mfma_f32_16x16x32_bf16 v[56:59], a[164:167], a[16:19], v[56:59]
s_add_u32 s39, s38, s36
v_add_u32 v219, 0, v219
v_mfma_f32_16x16x32_bf16 v[84:87], a[164:167], a[20:23], v[84:87]
s_add_u32 s39, s39, 86016
v_add_u32 v222, s31, v219
v_mfma_f32_16x16x32_bf16 v[60:63], a[168:171], a[16:19], v[60:63]
v_mfma_f32_16x16x32_bf16 v[88:91], a[168:171], a[20:23], v[88:91]
buffer_load_dwordx2 v[102:103], v129, s[8:11], s63 offen sc1
s_waitcnt vmcnt(13) lgkmcnt(0)
v_mfma_f32_16x16x32_bf16 v[36:39], a[180:183], a[24:27], v[36:39]
ds_read_b128 a[144:147], v1 offset:28672
v_lshrrev_b32 v6, 2, v2
v_mfma_f32_16x16x32_bf16 v[64:67], a[180:183], a[28:31], v[64:67]
ds_read_b128 a[148:151], v1 offset:29696
v_lshl_add_u32 v6, v3, 2, v6
v_mfma_f32_16x16x32_bf16 v[40:43], a[184:187], a[24:27], v[40:43]
ds_read_b128 a[152:155], v1 offset:30720
v_add_u32 v6, s31, v6
v_mfma_f32_16x16x32_bf16 v[68:71], a[184:187], a[28:31], v[68:71]
ds_read_b128 a[156:159], v1 offset:31744
s_mov_b32 s63, 2392064
v_mfma_f32_16x16x32_bf16 v[44:47], a[188:191], a[24:27], v[44:47]
ds_read_b128 a[160:163], v1 offset:32768
v_mul_u32_u24 v221, 176, v6
v_mfma_f32_16x16x32_bf16 v[72:75], a[188:191], a[28:31], v[72:75]
ds_read_b128 a[164:167], v1 offset:33792
v_and_b32 v6, 3, v2
v_mfma_f32_16x16x32_bf16 v[48:51], a[192:195], a[24:27], v[48:51]
ds_read_b128 a[168:171], v1 offset:34816
v_mfma_f32_16x16x32_bf16 v[76:79], a[192:195], a[28:31], v[76:79]
ds_read_b128 a[172:175], v125 offset:28672
buffer_load_dwordx2 v[104:105], v129, s[8:11], s63 offen sc1
v_mfma_f32_16x16x32_bf16 v[52:55], a[196:199], a[24:27], v[52:55]
ds_read_b128 a[176:179], v126 offset:4096
v_lshl_add_u32 v221, v6, 3, v221
v_mfma_f32_16x16x32_bf16 v[80:83], a[196:199], a[28:31], v[80:83]
s_mov_b32 s63, 2408448
v_add_u32 v221, 0, v221
v_mfma_f32_16x16x32_bf16 v[92:95], a[208:211], a[212:215], v[92:95]
v_mov_b32 v171, 0
v_mfma_f32_16x16x32_bf16 v[96:99], a[196:199], a[212:215], v[96:99]
v_mfma_f32_16x16x32_bf16 v[56:59], a[200:203], a[24:27], v[56:59]
buffer_load_dwordx4 v1, s[4:7], s39 offen offset:0 sc1 lds
v_mov_b32 v172, 0
v_mfma_f32_16x16x32_bf16 v[84:87], a[200:203], a[28:31], v[84:87]
v_mfma_f32_16x16x32_bf16 v[60:63], a[204:207], a[24:27], v[60:63]
v_mov_b32 v179, 0
v_mfma_f32_16x16x32_bf16 v[88:91], a[204:207], a[28:31], v[88:91]
v_mov_b32 v180, 0
s_waitcnt vmcnt(13) lgkmcnt(0)
v_mfma_f32_16x16x32_bf16 v[36:39], a[144:147], a[32:35], v[36:39]
ds_read_b128 a[180:183], v1 offset:35840
buffer_load_dwordx2 v[106:107], v129, s[8:11], s63 offen sc1
v_mfma_f32_16x16x32_bf16 v[64:67], a[144:147], a[36:39], v[64:67]
ds_read_b128 a[184:187], v1 offset:36864
buffer_load_dwordx4 v1, s[4:7], s39 offen offset:1024 sc1 lds
v_mfma_f32_16x16x32_bf16 v[40:43], a[148:151], a[32:35], v[40:43]
ds_read_b128 a[188:191], v1 offset:37888
s_mul_i32 s30, s60, 18432
v_mfma_f32_16x16x32_bf16 v[68:71], a[148:151], a[36:39], v[68:71]
ds_read_b128 a[192:195], v1 offset:38912
s_add_u32 s30, s30, 2490368
v_mfma_f32_16x16x32_bf16 v[44:47], a[152:155], a[32:35], v[44:47]
ds_read_b128 a[196:199], v1 offset:39936
buffer_load_dwordx4 v1, s[4:7], s39 offen offset:2048 sc1 lds
v_mfma_f32_16x16x32_bf16 v[72:75], a[152:155], a[36:39], v[72:75]
ds_read_b128 a[200:203], v1 offset:40960
s_mov_b32 s63, 2424832
v_mfma_f32_16x16x32_bf16 v[48:51], a[156:159], a[32:35], v[48:51]
ds_read_b128 a[204:207], v1 offset:41984
s_lshl_b32 s64, s26, 10
v_mfma_f32_16x16x32_bf16 v[76:79], a[156:159], a[36:39], v[76:79]
ds_read_b128 a[208:211], v125 offset:35840
s_add_u32 s64, s64, s30
v_mfma_f32_16x16x32_bf16 v[52:55], a[160:163], a[32:35], v[52:55]
ds_read_b128 a[212:215], v126 offset:5120
buffer_load_dwordx2 v[108:109], v129, s[8:11], s63 offen sc1
v_mfma_f32_16x16x32_bf16 v[80:83], a[160:163], a[36:39], v[80:83]
buffer_load_dwordx4 v1, s[4:7], s39 offen offset:3072 sc1 lds
s_and_b32 s65, s26, 1
v_mfma_f32_16x16x32_bf16 v[92:95], a[172:175], a[176:179], v[92:95]
s_mov_b32 s63, 2441216
s_lshl_b32 s65, s65, 10
v_mfma_f32_16x16x32_bf16 v[96:99], a[160:163], a[176:179], v[96:99]
s_add_u32 m0, m0, 4096
s_add_u32 s30, s30, s65
v_mfma_f32_16x16x32_bf16 v[56:59], a[164:167], a[32:35], v[56:59]
s_add_u32 s39, s39, 4096
v_mfma_f32_16x16x32_bf16 v[84:87], a[164:167], a[36:39], v[84:87]
s_lshr_b32 s65, s26, 1
v_mfma_f32_16x16x32_bf16 v[60:63], a[168:171], a[32:35], v[60:63]
s_lshl_b32 s65, s65, 7
v_mfma_f32_16x16x32_bf16 v[88:91], a[168:171], a[36:39], v[88:91]
s_add_u32 s65, s65, s30
s_waitcnt vmcnt(16) lgkmcnt(0)
v_mfma_f32_16x16x32_bf16 v[36:39], a[180:183], a[40:43], v[36:39]
ds_read_b128 a[144:147], v1 offset:43008
v_mfma_f32_16x16x32_bf16 v[64:67], a[180:183], a[44:47], v[64:67]
ds_read_b128 a[148:151], v1 offset:44032
buffer_load_dwordx2 v[110:111], v129, s[8:11], s63 offen sc1
v_mfma_f32_16x16x32_bf16 v[40:43], a[184:187], a[40:43], v[40:43]
ds_read_b128 a[152:155], v1 offset:45056
s_add_u32 s65, s65, 16384
v_mfma_f32_16x16x32_bf16 v[68:71], a[184:187], a[44:47], v[68:71]
ds_read_b128 a[156:159], v1 offset:46080
v_mov_b32 v224, 1073741824
v_mfma_f32_16x16x32_bf16 v[44:47], a[188:191], a[40:43], v[44:47]
ds_read_b128 a[160:163], v1 offset:47104
buffer_load_dwordx4 v1, s[4:7], s39 offen offset:0 sc1 lds
v_mfma_f32_16x16x32_bf16 v[72:75], a[188:191], a[44:47], v[72:75]
ds_read_b128 a[164:167], v1 offset:48128
s_mov_b32 s63, 2457600
v_mfma_f32_16x16x32_bf16 v[48:51], a[192:195], a[40:43], v[48:51]
ds_read_b128 a[168:171], v1 offset:49152
v_lshlrev_b32 v225, 3, v2
v_mfma_f32_16x16x32_bf16 v[76:79], a[192:195], a[44:47], v[76:79]
ds_read_b128 a[172:175], v125 offset:43008
v_cndmask_b32 v224, v224, v225, s[46:47]
v_mfma_f32_16x16x32_bf16 v[52:55], a[196:199], a[40:43], v[52:55]
ds_read_b128 a[176:179], v126 offset:6144
buffer_load_dwordx4 v1, s[4:7], s39 offen offset:1024 sc1 lds
v_mfma_f32_16x16x32_bf16 v[80:83], a[196:199], a[44:47], v[80:83]
v_add_u32 v225, 18432, v224
v_mfma_f32_16x16x32_bf16 v[92:95], a[208:211], a[212:215], v[92:95]
buffer_load_dwordx2 v[112:113], v129, s[8:11], s63 offen sc1
s_lshl_b32 s68, s24, 13
v_mfma_f32_16x16x32_bf16 v[96:99], a[196:199], a[212:215], v[96:99]
s_mov_b32 s63, 2473984
v_add_u32 v6, 0, v3
v_mfma_f32_16x16x32_bf16 v[56:59], a[200:203], a[40:43], v[56:59]
buffer_load_dwordx4 v1, s[4:7], s39 offen offset:2048 sc1 lds
v_mfma_f32_16x16x32_bf16 v[84:87], a[200:203], a[44:47], v[84:87]
v_xor_b32 v7, v6, v2
v_mfma_f32_16x16x32_bf16 v[60:63], a[204:207], a[40:43], v[60:63]
v_mfma_f32_16x16x32_bf16 v[88:91], a[204:207], a[44:47], v[88:91]
v_lshlrev_b32 v6, 12, v6
s_waitcnt vmcnt(19) lgkmcnt(0)
v_mfma_f32_16x16x32_bf16 v[36:39], a[144:147], a[48:51], v[36:39]
ds_read_b128 a[180:183], v1 offset:50176
buffer_load_dwordx4 v1, s[4:7], s39 offen offset:3072 sc1 lds
v_mfma_f32_16x16x32_bf16 v[64:67], a[144:147], a[52:55], v[64:67]
ds_read_b128 a[184:187], v1 offset:51200
v_lshl_add_u32 v240, v7, 4, v6
v_mfma_f32_16x16x32_bf16 v[40:43], a[148:151], a[48:51], v[40:43]
ds_read_b128 a[188:191], v1 offset:52224
buffer_load_dwordx2 v[114:115], v129, s[8:11], s63 offen sc1
v_mfma_f32_16x16x32_bf16 v[68:71], a[148:151], a[52:55], v[68:71]
ds_read_b128 a[192:195], v1 offset:53248
v_lshlrev_b32 v7, 4, v7
v_mfma_f32_16x16x32_bf16 v[44:47], a[152:155], a[48:51], v[44:47]
ds_read_b128 a[196:199], v1 offset:54272
s_add_u32 m0, m0, 4096
v_mfma_f32_16x16x32_bf16 v[72:75], a[152:155], a[52:55], v[72:75]
ds_read_b128 a[200:203], v1 offset:55296
v_lshl_add_u32 v7, v2, 8, v7
v_mfma_f32_16x16x32_bf16 v[48:51], a[156:159], a[48:51], v[48:51]
ds_read_b128 a[204:207], v1 offset:56320
buffer_load_dwordx4 a[76:79], v237, s[8:11], s62 offen offset:1024 sc1
v_mfma_f32_16x16x32_bf16 v[76:79], a[156:159], a[52:55], v[76:79]
ds_read_b128 a[208:211], v125 offset:50176
v_add_u32 v244, s68, v7
v_mfma_f32_16x16x32_bf16 v[52:55], a[160:163], a[48:51], v[52:55]
ds_read_b128 a[212:215], v126 offset:7168
s_add_u32 s39, s39, 4096
v_mfma_f32_16x16x32_bf16 v[80:83], a[160:163], a[52:55], v[80:83]
v_add_u32 v6, 4, v3
v_xor_b32 v7, v6, v2
v_mfma_f32_16x16x32_bf16 v[92:95], a[172:175], a[176:179], v[92:95]
v_lshlrev_b32 v6, 12, v6
v_mfma_f32_16x16x32_bf16 v[96:99], a[160:163], a[176:179], v[96:99]
buffer_load_dwordx4 a[80:83], v1, s[8:11], s62 offen offset:2048 sc1
v_mfma_f32_16x16x32_bf16 v[56:59], a[164:167], a[48:51], v[56:59]
buffer_load_dwordx4 v1, s[4:7], s39 offen offset:0 sc1 lds
v_lshl_add_u32 v241, v7, 4, v6
v_mfma_f32_16x16x32_bf16 v[84:87], a[164:167], a[52:55], v[84:87]
v_mfma_f32_16x16x32_bf16 v[60:63], a[168:171], a[48:51], v[60:63]
v_lshlrev_b32 v7, 4, v7
v_mfma_f32_16x16x32_bf16 v[88:91], a[168:171], a[52:55], v[88:91]
buffer_load_dwordx4 a[84:87], v237, s[8:11], s62 offen offset:2048 sc1
s_waitcnt vmcnt(23) lgkmcnt(0)
v_mfma_f32_16x16x32_bf16 v[36:39], a[180:183], a[56:59], v[36:39]
ds_read_b128 a[144:147], v1 offset:57344
buffer_load_dwordx4 v1, s[4:7], s39 offen offset:1024 sc1 lds
v_mfma_f32_16x16x32_bf16 v[64:67], a[180:183], a[60:63], v[64:67]
ds_read_b128 a[148:151], v1 offset:58368
v_lshl_add_u32 v7, v2, 8, v7
v_mfma_f32_16x16x32_bf16 v[40:43], a[184:187], a[56:59], v[40:43]
ds_read_b128 a[152:155], v1 offset:59392
v_add_u32 v245, s68, v7
v_mfma_f32_16x16x32_bf16 v[68:71], a[184:187], a[60:63], v[68:71]
ds_read_b128 a[156:159], v1 offset:60416
buffer_load_dwordx4 a[88:91], v1, s[8:11], s62 offen offset:3072 sc1
v_mfma_f32_16x16x32_bf16 v[44:47], a[188:191], a[56:59], v[44:47]
ds_read_b128 a[160:163], v1 offset:61440
buffer_load_dwordx4 v1, s[4:7], s39 offen offset:2048 sc1 lds
v_mfma_f32_16x16x32_bf16 v[72:75], a[188:191], a[60:63], v[72:75]
ds_read_b128 a[164:167], v1 offset:62464
v_subrev_u32 v241, 1024, v241
v_mfma_f32_16x16x32_bf16 v[48:51], a[192:195], a[56:59], v[48:51]
ds_read_b128 a[168:171], v1 offset:63488
v_add_u32 v6, 8, v3
v_mfma_f32_16x16x32_bf16 v[76:79], a[192:195], a[60:63], v[76:79]
ds_read_b128 a[172:175], v125 offset:57344
v_xor_b32 v7, v6, v2
v_mfma_f32_16x16x32_bf16 v[52:55], a[196:199], a[56:59], v[52:55]
ds_read_b128 a[176:179], v126 offset:8192
buffer_load_dwordx4 a[92:95], v237, s[8:11], s62 offen offset:3072 sc1
v_mfma_f32_16x16x32_bf16 v[80:83], a[196:199], a[60:63], v[80:83]
buffer_load_dwordx4 v1, s[4:7], s39 offen offset:3072 sc1 lds
v_lshlrev_b32 v6, 12, v6
v_mfma_f32_16x16x32_bf16 v[92:95], a[208:211], a[212:215], v[92:95]
s_add_u32 s62, s62, 4096
v_lshl_add_u32 v242, v7, 4, v6
v_mfma_f32_16x16x32_bf16 v[96:99], a[196:199], a[212:215], v[96:99]
v_lshlrev_b32 v7, 4, v7
v_mfma_f32_16x16x32_bf16 v[56:59], a[200:203], a[56:59], v[56:59]
buffer_load_dwordx2 v[148:149], v146, s[4:7], s66 offen sc1
v_lshl_add_u32 v7, v2, 8, v7
v_mfma_f32_16x16x32_bf16 v[84:87], a[200:203], a[60:63], v[84:87]
v_mfma_f32_16x16x32_bf16 v[60:63], a[204:207], a[56:59], v[60:63]
v_add_u32 v246, s68, v7
v_mfma_f32_16x16x32_bf16 v[88:91], a[204:207], a[60:63], v[88:91]
s_waitcnt vmcnt(27) lgkmcnt(0)
v_add_u32 v125, 64512, v125
v_mfma_f32_16x16x32_bf16 v[36:39], a[144:147], a[64:67], v[36:39]
ds_read_b128 a[180:183], v8 offset:0
buffer_load_dwordx4 a[96:99], v1, s[8:11], s62 offen offset:0 sc1
v_mfma_f32_16x16x32_bf16 v[64:67], a[144:147], a[68:71], v[64:67]
ds_read_b128 a[184:187], v8 offset:1024
v_subrev_u32 v242, 2048, v242
v_mfma_f32_16x16x32_bf16 v[40:43], a[148:151], a[64:67], v[40:43]
ds_read_b128 a[188:191], v8 offset:2048
v_add_u32 v6, 12, v3
v_mfma_f32_16x16x32_bf16 v[68:71], a[148:151], a[68:71], v[68:71]
ds_read_b128 a[192:195], v8 offset:3072
v_xor_b32 v7, v6, v2
v_mfma_f32_16x16x32_bf16 v[44:47], a[152:155], a[64:67], v[44:47]
ds_read_b128 a[196:199], v8 offset:4096
buffer_load_dwordx4 a[100:103], v237, s[8:11], s62 offen offset:0 sc1
v_mfma_f32_16x16x32_bf16 v[72:75], a[152:155], a[68:71], v[72:75]
ds_read_b128 a[200:203], v8 offset:5120
v_lshlrev_b32 v6, 12, v6
v_mfma_f32_16x16x32_bf16 v[48:51], a[156:159], a[64:67], v[48:51]
ds_read_b128 a[204:207], v8 offset:6144
v_lshl_add_u32 v243, v7, 4, v6
v_mfma_f32_16x16x32_bf16 v[76:79], a[156:159], a[68:71], v[76:79]
ds_read_b128 a[208:211], v125 offset:0
v_mfma_f32_16x16x32_bf16 v[52:55], a[160:163], a[64:67], v[52:55]
ds_read_b128 a[212:215], v126 offset:9216
v_lshlrev_b32 v7, 4, v7
v_mfma_f32_16x16x32_bf16 v[80:83], a[160:163], a[68:71], v[80:83]
buffer_load_dwordx4 a[104:107], v1, s[8:11], s62 offen offset:1024 sc1
v_mfma_f32_16x16x32_bf16 v[92:95], a[172:175], a[176:179], v[92:95]
v_lshl_add_u32 v7, v2, 8, v7
v_mfma_f32_16x16x32_bf16 v[96:99], a[160:163], a[176:179], v[96:99]
v_add_u32 v247, s68, v7
v_mfma_f32_16x16x32_bf16 v[56:59], a[164:167], a[64:67], v[56:59]
v_mfma_f32_16x16x32_bf16 v[84:87], a[164:167], a[68:71], v[84:87]
buffer_load_dwordx4 a[108:111], v237, s[8:11], s62 offen offset:1024 sc1
v_subrev_u32 v243, 3072, v243
v_mfma_f32_16x16x32_bf16 v[60:63], a[168:171], a[64:67], v[60:63]
v_mfma_f32_16x16x32_bf16 v[88:91], a[168:171], a[68:71], v[88:91]
s_waitcnt vmcnt(13) lgkmcnt(0)
v_mfma_f32_16x16x32_bf16 v[36:39], a[180:183], a[72:75], v[36:39]
ds_read_b128 a[144:147], v8 offset:7168
v_mfma_f32_16x16x32_bf16 v[64:67], a[180:183], a[76:79], v[64:67]
ds_read_b128 a[148:151], v8 offset:8192
buffer_load_dwordx4 a[112:115], v1, s[8:11], s62 offen offset:2048 sc1
v_mfma_f32_16x16x32_bf16 v[40:43], a[184:187], a[72:75], v[40:43]
ds_read_b128 a[152:155], v8 offset:9216
v_add_f32 v130, v100, v102
v_mfma_f32_16x16x32_bf16 v[68:71], a[184:187], a[76:79], v[68:71]
ds_read_b128 a[156:159], v8 offset:10240
v_add_f32 v131, v101, v103
v_mfma_f32_16x16x32_bf16 v[44:47], a[188:191], a[72:75], v[44:47]
ds_read_b128 a[160:163], v8 offset:11264
v_add_f32 v130, v130, v104
v_mfma_f32_16x16x32_bf16 v[72:75], a[188:191], a[76:79], v[72:75]
ds_read_b128 a[164:167], v8 offset:12288
v_add_f32 v131, v131, v105
v_mfma_f32_16x16x32_bf16 v[48:51], a[192:195], a[72:75], v[48:51]
ds_read_b128 a[168:171], v8 offset:13312
buffer_load_dwordx4 a[116:119], v237, s[8:11], s62 offen offset:2048 sc1
v_mfma_f32_16x16x32_bf16 v[76:79], a[192:195], a[76:79], v[76:79]
ds_read_b128 a[172:175], v125 offset:7168
v_add_f32 v130, v130, v106
v_mfma_f32_16x16x32_bf16 v[52:55], a[196:199], a[72:75], v[52:55]
ds_read_b128 a[176:179], v126 offset:10240
v_add_f32 v131, v131, v107
v_mfma_f32_16x16x32_bf16 v[80:83], a[196:199], a[76:79], v[80:83]
v_add_f32 v130, v130, v108
v_add_f32 v131, v131, v109
v_mfma_f32_16x16x32_bf16 v[92:95], a[208:211], a[212:215], v[92:95]
buffer_load_dwordx4 a[120:123], v1, s[8:11], s62 offen offset:3072 sc1
v_add_f32 v130, v130, v110
v_mfma_f32_16x16x32_bf16 v[96:99], a[196:199], a[212:215], v[96:99]
v_add_f32 v131, v131, v111
v_mfma_f32_16x16x32_bf16 v[56:59], a[200:203], a[72:75], v[56:59]
v_add_f32 v130, v130, v112
v_mfma_f32_16x16x32_bf16 v[84:87], a[200:203], a[76:79], v[84:87]
v_add_f32 v131, v131, v113
v_mfma_f32_16x16x32_bf16 v[60:63], a[204:207], a[72:75], v[60:63]
buffer_load_dwordx4 a[124:127], v237, s[8:11], s62 offen offset:3072 sc1
v_add_f32 v130, v130, v114
v_mfma_f32_16x16x32_bf16 v[88:91], a[204:207], a[76:79], v[88:91]
s_add_u32 s62, s62, 4096
v_add_f32 v131, v131, v115
s_waitcnt vmcnt(14) lgkmcnt(0)
v_mfma_f32_16x16x32_bf16 v[36:39], a[144:147], a[80:83], v[36:39]
ds_read_b128 a[180:183], v8 offset:14336
v_mul_f32 v130, 0x3ae38e39, v130
v_mfma_f32_16x16x32_bf16 v[64:67], a[144:147], a[84:87], v[64:67]
ds_read_b128 a[184:187], v8 offset:15360
v_mul_f32 v6, v130, v130
v_mfma_f32_16x16x32_bf16 v[40:43], a[148:151], a[80:83], v[40:43]
ds_read_b128 a[188:191], v8 offset:16384
v_mul_f32 v131, 0x3ae38e39, v131
v_mfma_f32_16x16x32_bf16 v[68:71], a[148:151], a[84:87], v[68:71]
ds_read_b128 a[192:195], v8 offset:17408
v_mfma_f32_16x16x32_bf16 v[44:47], a[152:155], a[80:83], v[44:47]
ds_read_b128 a[196:199], v8 offset:18432
v_sub_f32 v131, v131, v6
v_mfma_f32_16x16x32_bf16 v[72:75], a[152:155], a[84:87], v[72:75]
ds_read_b128 a[200:203], v8 offset:19456
v_max_f32 v131, 0, v131
v_mfma_f32_16x16x32_bf16 v[48:51], a[156:159], a[80:83], v[48:51]
ds_read_b128 a[204:207], v8 offset:20480
v_add_f32 v131, 0x3727c5ac, v131
v_mfma_f32_16x16x32_bf16 v[76:79], a[156:159], a[84:87], v[76:79]
ds_read_b128 a[208:211], v125 offset:14336
buffer_load_dwordx4 a[128:131], v1, s[8:11], s62 offen offset:0 sc1
v_mfma_f32_16x16x32_bf16 v[52:55], a[160:163], a[80:83], v[52:55]
ds_read_b128 a[212:215], v126 offset:11264
v_mfma_f32_16x16x32_bf16 v[80:83], a[160:163], a[84:87], v[80:83]
v_rsq_f32 v132, v131
v_mfma_f32_16x16x32_bf16 v[92:95], a[172:175], a[176:179], v[92:95]
v_cvt_pk_bf16_f32 v6, -v130, -v130
v_and_b32 v6, 0xffff0000, v6
v_mfma_f32_16x16x32_bf16 v[96:99], a[160:163], a[176:179], v[96:99]
buffer_load_dwordx4 a[132:135], v237, s[8:11], s62 offen offset:0 sc1
v_add_f32 v6, v130, v6
v_mfma_f32_16x16x32_bf16 v[56:59], a[164:167], a[80:83], v[56:59]
v_cvt_pk_bf16_f32 v133, -v130, -v6
v_mfma_f32_16x16x32_bf16 v[84:87], a[164:167], a[84:87], v[84:87]
v_mfma_f32_16x16x32_bf16 v[60:63], a[168:171], a[80:83], v[60:63]
v_mfma_f32_16x16x32_bf16 v[88:91], a[168:171], a[84:87], v[88:91]
s_waitcnt vmcnt(10) lgkmcnt(0)
v_cmp_ne_u64 vcc, v[148:149], v[238:239]
s_cmp_eq_u32 s29, 0
s_cselect_b64 vcc, vcc, 0
s_cbranch_vccnz L_dbslow_11
L_dbback_12:
s_barrier
v_mfma_f32_16x16x32_bf16 v[36:39], a[180:183], a[88:91], v[36:39]
ds_read_b128 a[144:147], v8 offset:21504
buffer_load_dwordx4 a[136:139], v1, s[8:11], s62 offen offset:1024 sc1
v_mfma_f32_16x16x32_bf16 v[64:67], a[180:183], a[92:95], v[64:67]
ds_read_b128 a[148:151], v8 offset:22528
v_mfma_f32_16x16x32_bf16 v[40:43], a[184:187], a[88:91], v[40:43]
ds_read_b128 a[152:155], v8 offset:23552
s_add_u32 m0, s68, 0
v_mfma_f32_16x16x32_bf16 v[68:71], a[184:187], a[92:95], v[68:71]
ds_read_b128 a[156:159], v8 offset:24576
v_mfma_f32_16x16x32_bf16 v[44:47], a[188:191], a[88:91], v[44:47]
ds_read_b128 a[160:163], v8 offset:25600
buffer_load_dwordx4 a[140:143], v237, s[8:11], s62 offen offset:1024 sc1
v_mfma_f32_16x16x32_bf16 v[72:75], a[188:191], a[92:95], v[72:75]
ds_read_b128 a[164:167], v8 offset:26624
s_add_u32 s3, s3, 0
v_mfma_f32_16x16x32_bf16 v[48:51], a[192:195], a[88:91], v[48:51]
ds_read_b128 a[168:171], v8 offset:27648
v_mfma_f32_16x16x32_bf16 v[76:79], a[192:195], a[92:95], v[76:79]
ds_read_b128 a[172:175], v125 offset:21504
buffer_load_dwordx4 v240, s[12:15], s3 offen offset:0 nt lds
v_mfma_f32_16x16x32_bf16 v[52:55], a[196:199], a[88:91], v[52:55]
ds_read_b128 a[176:179], v126 offset:12288
s_mov_b32 s37, L_c2-L_pc
v_mfma_f32_16x16x32_bf16 v[80:83], a[196:199], a[92:95], v[80:83]
ds_bpermute_b32 v116, v124, v133 offset:128
v_mfma_f32_16x16x32_bf16 v[92:95], a[208:211], a[212:215], v[92:95]
ds_bpermute_b32 v118, v124, v133 offset:192
buffer_load_dwordx4 v241, s[12:15], s3 offen offset:1024 nt lds
v_mfma_f32_16x16x32_bf16 v[96:99], a[196:199], a[212:215], v[96:99]
ds_bpermute_b32 v120, v124, v133
v_mfma_f32_16x16x32_bf16 v[56:59], a[200:203], a[88:91], v[56:59]
buffer_load_dword v15, v14, s[88:91], s37 offen
ds_bpermute_b32 v134, v124, v132 offset:128
v_mfma_f32_16x16x32_bf16 v[84:87], a[200:203], a[92:95], v[84:87]
ds_bpermute_b32 v135, v124, v132 offset:192
buffer_load_dwordx4 v242, s[12:15], s3 offen offset:2048 nt lds
v_mfma_f32_16x16x32_bf16 v[60:63], a[204:207], a[88:91], v[60:63]
v_mfma_f32_16x16x32_bf16 v[88:91], a[204:207], a[92:95], v[88:91]
buffer_load_dwordx4 v243, s[12:15], s3 offen offset:3072 nt lds
s_waitcnt vmcnt(15) lgkmcnt(0)
v_mfma_f32_16x16x32_bf16 v[36:39], a[144:147], a[96:99], v[36:39]
ds_read_b128 a[180:183], v8 offset:28672
v_mfma_f32_16x16x32_bf16 v[64:67], a[144:147], a[100:103], v[64:67]
ds_read_b128 a[184:187], v8 offset:29696
v_mfma_f32_16x16x32_bf16 v[40:43], a[148:151], a[96:99], v[40:43]
ds_read_b128 a[188:191], v8 offset:30720
s_add_u32 m0, s68, 4096
v_mfma_f32_16x16x32_bf16 v[68:71], a[148:151], a[100:103], v[68:71]
ds_read_b128 a[192:195], v8 offset:31744
v_mfma_f32_16x16x32_bf16 v[44:47], a[152:155], a[96:99], v[44:47]
ds_read_b128 a[196:199], v8 offset:32768
s_add_u32 s3, s3, 65536
v_mfma_f32_16x16x32_bf16 v[72:75], a[152:155], a[100:103], v[72:75]
ds_read_b128 a[200:203], v8 offset:33792
v_mfma_f32_16x16x32_bf16 v[48:51], a[156:159], a[96:99], v[48:51]
ds_read_b128 a[204:207], v8 offset:34816
v_mfma_f32_16x16x32_bf16 v[76:79], a[156:159], a[100:103], v[76:79]
ds_read_b128 a[208:211], v125 offset:28672
buffer_load_dwordx4 v240, s[12:15], s3 offen offset:0 nt lds
v_mfma_f32_16x16x32_bf16 v[52:55], a[160:163], a[96:99], v[52:55]
ds_read_b128 a[212:215], v126 offset:13312
v_mfma_f32_16x16x32_bf16 v[80:83], a[160:163], a[100:103], v[80:83]
ds_bpermute_b32 v136, v122, v132 offset:0
v_mfma_f32_16x16x32_bf16 v[92:95], a[172:175], a[176:179], v[92:95]
ds_bpermute_b32 v137, v123, v132 offset:0
buffer_load_dwordx4 v241, s[12:15], s3 offen offset:1024 nt lds
v_mfma_f32_16x16x32_bf16 v[96:99], a[160:163], a[176:179], v[96:99]
ds_bpermute_b32 v138, v122, v132 offset:64
v_mfma_f32_16x16x32_bf16 v[56:59], a[164:167], a[96:99], v[56:59]
ds_bpermute_b32 v139, v123, v132 offset:64
buffer_load_dwordx4 v242, s[12:15], s3 offen offset:2048 nt lds
v_mfma_f32_16x16x32_bf16 v[84:87], a[164:167], a[100:103], v[84:87]
v_mfma_f32_16x16x32_bf16 v[60:63], a[168:171], a[96:99], v[60:63]
v_mfma_f32_16x16x32_bf16 v[88:91], a[168:171], a[100:103], v[88:91]
buffer_load_dwordx4 v243, s[12:15], s3 offen offset:3072 nt lds
s_waitcnt vmcnt(17) lgkmcnt(0)
v_mfma_f32_16x16x32_bf16 v[36:39], a[180:183], a[104:107], v[36:39]
ds_read_b128 a[144:147], v8 offset:35840
v_mov_b32 v117, v116
v_mfma_f32_16x16x32_bf16 v[64:67], a[180:183], a[108:111], v[64:67]
ds_read_b128 a[148:151], v8 offset:36864
v_mov_b32 v119, v118
v_mfma_f32_16x16x32_bf16 v[40:43], a[184:187], a[104:107], v[40:43]
ds_read_b128 a[152:155], v8 offset:37888
s_mov_b32 s3, 1073741824
v_mfma_f32_16x16x32_bf16 v[68:71], a[184:187], a[108:111], v[68:71]
ds_read_b128 a[156:159], v8 offset:38912
v_mov_b32 v121, v120
v_mfma_f32_16x16x32_bf16 v[44:47], a[188:191], a[104:107], v[44:47]
ds_read_b128 a[160:163], v8 offset:39936
v_mul_f32 v134, 0x3eae1a93, v134
v_mfma_f32_16x16x32_bf16 v[72:75], a[188:191], a[108:111], v[72:75]
ds_read_b128 a[164:167], v8 offset:40960
s_mul_i32 s36, s28, 82944
v_mfma_f32_16x16x32_bf16 v[48:51], a[192:195], a[104:107], v[48:51]
ds_read_b128 a[168:171], v8 offset:41984
v_mul_f32 v135, 0x3eae1a93, v135
v_mfma_f32_16x16x32_bf16 v[76:79], a[192:195], a[108:111], v[76:79]
ds_read_b128 a[172:175], v125 offset:35840
v_mfma_f32_16x16x32_bf16 v[52:55], a[196:199], a[104:107], v[52:55]
ds_read_b128 a[176:179], v126 offset:14336
s_mul_i32 s38, s24, 8192
v_mfma_f32_16x16x32_bf16 v[80:83], a[196:199], a[108:111], v[80:83]
ds_read_b64 a[0:1], v127 offset:0
v_mul_f32 v140, v134, v136
v_mfma_f32_16x16x32_bf16 v[92:95], a[208:211], a[212:215], v[92:95]
ds_read_b64 a[2:3], v127 offset:512
v_mul_f32 v141, v134, v137
v_mfma_f32_16x16x32_bf16 v[96:99], a[196:199], a[212:215], v[96:99]
s_add_u32 m0, s38, 37888
v_mul_f32 v142, v135, v138
v_mfma_f32_16x16x32_bf16 v[56:59], a[200:203], a[104:107], v[56:59]
ds_read_b64 a[4:5], v127 offset:1024
v_mfma_f32_16x16x32_bf16 v[84:87], a[200:203], a[108:111], v[84:87]
ds_read_b64 a[6:7], v127 offset:1536
v_mul_f32 v143, v135, v139
v_mfma_f32_16x16x32_bf16 v[60:63], a[204:207], a[104:107], v[60:63]
s_cmp_eq_u32 s60, 0
s_cselect_b32 s30, 0xf149f2ca, 0
v_mfma_f32_16x16x32_bf16 v[88:91], a[204:207], a[108:111], v[88:91]
s_add_u32 s39, s38, s36
s_waitcnt vmcnt(15) lgkmcnt(0)
v_mfma_f32_16x16x32_bf16 v[36:39], a[144:147], a[112:115], v[36:39]
ds_read_b128 a[180:183], v8 offset:43008
v_mfma_f32_16x16x32_bf16 v[64:67], a[144:147], a[116:119], v[64:67]
ds_read_b128 a[184:187], v8 offset:44032
v_mfma_f32_16x16x32_bf16 v[40:43], a[148:151], a[112:115], v[40:43]
ds_read_b128 a[188:191], v8 offset:45056
v_mov_b32 v6, s30
v_mfma_f32_16x16x32_bf16 v[68:71], a[148:151], a[116:119], v[68:71]
ds_read_b128 a[192:195], v8 offset:46080
v_cndmask_b32 v144, v6, 0, s[42:43]
v_mfma_f32_16x16x32_bf16 v[44:47], a[152:155], a[112:115], v[44:47]
ds_read_b128 a[196:199], v8 offset:47104
s_add_u32 s39, s39, 2121728
v_mfma_f32_16x16x32_bf16 v[72:75], a[152:155], a[116:119], v[72:75]
ds_read_b128 a[200:203], v8 offset:48128
v_cndmask_b32 v145, v6, 0, s[44:45]
v_mfma_f32_16x16x32_bf16 v[48:51], a[156:159], a[112:115], v[48:51]
ds_read_b128 a[204:207], v8 offset:49152
v_mfma_f32_16x16x32_bf16 v[76:79], a[156:159], a[116:119], v[76:79]
ds_read_b128 a[208:211], v125 offset:43008
v_mov_b32 v100, v136
v_mfma_f32_16x16x32_bf16 v[52:55], a[160:163], a[112:115], v[52:55]
ds_read_b128 a[212:215], v126 offset:15360
buffer_load_dwordx4 v1, s[4:7], s39 offen offset:0 sc1 lds
v_mfma_f32_16x16x32_bf16 v[80:83], a[160:163], a[116:119], v[80:83]
ds_read_b64 a[8:9], v127 offset:2048
v_mov_b32 v104, v138
v_mfma_f32_16x16x32_bf16 v[92:95], a[172:175], a[176:179], v[92:95]
ds_read_b64 a[10:11], v127 offset:2560
v_mov_b32 v102, v136
v_mfma_f32_16x16x32_bf16 v[96:99], a[160:163], a[176:179], v[96:99]
v_mfma_f32_16x16x32_bf16 v[56:59], a[164:167], a[112:115], v[56:59]
ds_read_b64 a[12:13], v127 offset:3072
buffer_load_dwordx4 v1, s[4:7], s39 offen offset:1024 sc1 lds
v_mfma_f32_16x16x32_bf16 v[84:87], a[164:167], a[116:119], v[84:87]
ds_read_b64 a[14:15], v128
v_mov_b32 v106, v138
v_mfma_f32_16x16x32_bf16 v[60:63], a[168:171], a[112:115], v[60:63]
v_mov_b32 v101, v137
v_mfma_f32_16x16x32_bf16 v[88:91], a[168:171], a[116:119], v[88:91]
v_mov_b32 v105, v139
s_waitcnt vmcnt(15) lgkmcnt(0)
v_mfma_f32_16x16x32_bf16 v[36:39], a[180:183], a[120:123], v[36:39]
ds_read_b128 a[144:147], v8 offset:50176
buffer_load_dwordx4 v1, s[4:7], s39 offen offset:2048 sc1 lds
v_mfma_f32_16x16x32_bf16 v[64:67], a[180:183], a[124:127], v[64:67]
ds_read_b128 a[148:151], v8 offset:51200
v_mov_b32 v103, v137
v_mfma_f32_16x16x32_bf16 v[40:43], a[184:187], a[120:123], v[40:43]
ds_read_b128 a[152:155], v8 offset:52224
v_mov_b32 v107, v139
v_mfma_f32_16x16x32_bf16 v[68:71], a[184:187], a[124:127], v[68:71]
ds_read_b128 a[156:159], v8 offset:53248
buffer_load_dwordx4 v1, s[4:7], s39 offen offset:3072 sc1 lds
v_mfma_f32_16x16x32_bf16 v[44:47], a[188:191], a[120:123], v[44:47]
ds_read_b128 a[160:163], v8 offset:54272
v_mfma_f32_16x16x32_bf16 v[72:75], a[188:191], a[124:127], v[72:75]
ds_read_b128 a[164:167], v8 offset:55296
v_mfma_f32_16x16x32_bf16 v[48:51], a[192:195], a[120:123], v[48:51]
ds_read_b128 a[168:171], v8 offset:56320
v_mfma_f32_16x16x32_bf16 v[76:79], a[192:195], a[124:127], v[76:79]
ds_read_b128 a[172:175], v125 offset:50176
s_add_u32 m0, m0, 4096
v_mfma_f32_16x16x32_bf16 v[52:55], a[196:199], a[120:123], v[52:55]
ds_read_b128 a[176:179], v126 offset:16384
s_waitcnt vmcnt(8)
v_mfma_f32_16x16x32_bf16 v[80:83], a[196:199], a[124:127], v[80:83]
ds_read_b128 a[224:227], v244 offset:0
v_mfma_f32_16x16x32_bf16 v[92:95], a[208:211], a[212:215], v[92:95]
ds_read_b128 a[228:231], v245 offset:0
v_mfma_f32_16x16x32_bf16 v[96:99], a[196:199], a[212:215], v[96:99]
s_add_u32 s39, s39, 4096
v_permlane32_swap_b32 v100, v104
v_mfma_f32_16x16x32_bf16 v[56:59], a[200:203], a[120:123], v[56:59]
ds_read_b128 a[232:235], v246 offset:0
v_mfma_f32_16x16x32_bf16 v[84:87], a[200:203], a[124:127], v[84:87]
ds_read_b128 a[236:239], v247 offset:0
v_mfma_f32_16x16x32_bf16 v[60:63], a[204:207], a[120:123], v[60:63]
v_permlane32_swap_b32 v102, v106
v_mfma_f32_16x16x32_bf16 v[88:91], a[204:207], a[124:127], v[88:91]
buffer_load_dwordx4 v1, s[4:7], s39 offen offset:0 sc1 lds
s_waitcnt lgkmcnt(0)
v_mfma_f32_16x16x32_bf16 v[36:39], a[144:147], a[128:131], v[36:39]
ds_read_b128 a[180:183], v8 offset:57344
v_mfma_f32_16x16x32_bf16 v[64:67], a[144:147], a[132:135], v[64:67]
ds_read_b128 a[184:187], v8 offset:58368
v_mfma_f32_16x16x32_bf16 v[40:43], a[148:151], a[128:131], v[40:43]
ds_read_b128 a[188:191], v8 offset:59392
v_mfma_f32_16x16x32_bf16 v[68:71], a[148:151], a[132:135], v[68:71]
ds_read_b128 a[192:195], v8 offset:60416
buffer_load_dwordx4 v1, s[4:7], s39 offen offset:1024 sc1 lds
v_mfma_f32_16x16x32_bf16 v[44:47], a[152:155], a[128:131], v[44:47]
ds_read_b128 a[196:199], v8 offset:61440
v_mfma_f32_16x16x32_bf16 v[72:75], a[152:155], a[132:135], v[72:75]
ds_read_b128 a[200:203], v8 offset:62464
v_mfma_f32_16x16x32_bf16 v[48:51], a[156:159], a[128:131], v[48:51]
ds_read_b128 a[204:207], v8 offset:63488
v_mfma_f32_16x16x32_bf16 v[76:79], a[156:159], a[132:135], v[76:79]
ds_read_b128 a[208:211], v125 offset:57344
buffer_load_dwordx4 v1, s[4:7], s39 offen offset:2048 sc1 lds
v_mfma_f32_16x16x32_bf16 v[52:55], a[160:163], a[128:131], v[52:55]
ds_read_b128 a[212:215], v126 offset:17408
s_waitcnt vmcnt(7)
v_mfma_f32_16x16x32_bf16 v[80:83], a[160:163], a[132:135], v[80:83]
ds_read_b128 a[240:243], v244 offset:4096
v_mfma_f32_16x16x32_bf16 v[92:95], a[172:175], a[176:179], v[92:95]
ds_read_b128 a[244:247], v245 offset:4096
v_mfma_f32_16x16x32_bf16 v[96:99], a[160:163], a[176:179], v[96:99]
ds_read_b128 a[248:251], v246 offset:4096
buffer_load_dwordx4 v1, s[4:7], s39 offen offset:3072 sc1 lds
v_mfma_f32_16x16x32_bf16 v[56:59], a[164:167], a[128:131], v[56:59]
ds_read_b128 a[252:255], v247 offset:4096
v_mfma_f32_16x16x32_bf16 v[84:87], a[164:167], a[132:135], v[84:87]
v_permlane32_swap_b32 v101, v105
v_mfma_f32_16x16x32_bf16 v[60:63], a[168:171], a[128:131], v[60:63]
v_permlane32_swap_b32 v103, v107
v_permlane16_swap_b32 v100, v102
v_permlane16_swap_b32 v104, v106
v_permlane16_swap_b32 v101, v103
v_permlane16_swap_b32 v105, v107
v_mfma_f32_16x16x32_bf16 v[88:91], a[168:171], a[132:135], v[88:91]
s_waitcnt lgkmcnt(0)
s_barrier
v_mfma_f32_16x16x32_bf16 v[36:39], a[180:183], a[136:139], v[36:39]
v_mfma_f32_16x16x32_bf16 v[64:67], a[180:183], a[140:143], v[64:67]
v_mfma_f32_16x16x16_bf16 v[36:39], a[0:1], v[116:117], v[36:39]
v_mfma_f32_16x16x16_bf16 v[64:67], a[0:1], v[118:119], v[64:67]
v_mfma_f32_16x16x32_bf16 v[40:43], a[184:187], a[136:139], v[40:43]
v_mfma_f32_16x16x32_bf16 v[68:71], a[184:187], a[140:143], v[68:71]
s_nop 1
v_mfma_f32_16x16x16_bf16 v[40:43], a[2:3], v[116:117], v[40:43]
s_nop 1
v_mfma_f32_16x16x16_bf16 v[68:71], a[2:3], v[118:119], v[68:71]
v_cvt_pk_bf16_f32 v156, v36, v37
v_cvt_pk_bf16_f32 v157, v38, v39
v_mfma_f32_16x16x32_bf16 v[44:47], a[188:191], a[136:139], v[44:47]
ds_write_b64 v218, v[156:157] offset:2816
v_mfma_f32_16x16x32_bf16 v[72:75], a[188:191], a[140:143], v[72:75]
v_cvt_pk_bf16_f32 v162, v64, v65
v_cvt_pk_bf16_f32 v163, v66, v67
v_mfma_f32_16x16x16_bf16 v[44:47], a[4:5], v[116:117], v[44:47]
ds_write_b64 v218, v[162:163] offset:5632
v_mfma_f32_16x16x16_bf16 v[72:75], a[4:5], v[118:119], v[72:75]
v_cvt_pk_bf16_f32 v160, v40, v41
v_cvt_pk_bf16_f32 v161, v42, v43
v_mfma_f32_16x16x32_bf16 v[48:51], a[192:195], a[136:139], v[48:51]
ds_write_b64 v218, v[160:161] offset:2848
v_mfma_f32_16x16x32_bf16 v[76:79], a[192:195], a[140:143], v[76:79]
v_cvt_pk_bf16_f32 v166, v68, v69
v_cvt_pk_bf16_f32 v167, v70, v71
v_mfma_f32_16x16x16_bf16 v[48:51], a[6:7], v[116:117], v[48:51]
ds_write_b64 v218, v[166:167] offset:5664
v_mfma_f32_16x16x16_bf16 v[76:79], a[6:7], v[118:119], v[76:79]
v_cvt_pk_bf16_f32 v202, v44, v45
v_cvt_pk_bf16_f32 v203, v46, v47
v_mfma_f32_16x16x32_bf16 v[52:55], a[196:199], a[136:139], v[52:55]
ds_write_b64 v218, v[202:203] offset:2880
v_mfma_f32_16x16x32_bf16 v[80:83], a[196:199], a[140:143], v[80:83]
v_cvt_pk_bf16_f32 v204, v72, v73
v_cvt_pk_bf16_f32 v205, v74, v75
v_mfma_f32_16x16x16_bf16 v[52:55], a[8:9], v[116:117], v[52:55]
ds_write_b64 v218, v[204:205] offset:5696
v_mfma_f32_16x16x16_bf16 v[80:83], a[8:9], v[118:119], v[80:83]
v_cvt_pk_bf16_f32 v206, v48, v49
v_cvt_pk_bf16_f32 v207, v50, v51
v_mfma_f32_16x16x32_bf16 v[92:95], a[208:211], a[212:215], v[92:95]
ds_write_b64 v218, v[206:207] offset:2912
v_mfma_f32_16x16x32_bf16 v[96:99], a[196:199], a[212:215], v[96:99]
v_cvt_pk_bf16_f32 v208, v76, v77
v_cvt_pk_bf16_f32 v209, v78, v79
v_mfma_f32_16x16x16_bf16 v[92:95], a[14:15], v[120:121], v[92:95]
ds_write_b64 v218, v[208:209] offset:5728
v_mfma_f32_16x16x16_bf16 v[96:99], a[8:9], v[120:121], v[96:99]
v_cvt_pk_bf16_f32 v210, v52, v53
v_cvt_pk_bf16_f32 v211, v54, v55
v_mfma_f32_16x16x32_bf16 v[56:59], a[200:203], a[136:139], v[56:59]
ds_write_b64 v218, v[210:211] offset:2944
v_mfma_f32_16x16x32_bf16 v[84:87], a[200:203], a[140:143], v[84:87]
v_cvt_pk_bf16_f32 v212, v80, v81
v_cvt_pk_bf16_f32 v213, v82, v83
v_mfma_f32_16x16x16_bf16 v[56:59], a[10:11], v[116:117], v[56:59]
ds_write_b64 v218, v[212:213] offset:5760
v_mfma_f32_16x16x16_bf16 v[84:87], a[10:11], v[118:119], v[84:87]
v_cvt_pk_bf16_f32 v214, v92, v93
v_cvt_pk_bf16_f32 v215, v94, v95
v_mfma_f32_16x16x32_bf16 v[60:63], a[204:207], a[136:139], v[60:63]
ds_write_b64 v222, v[214:215]
v_mfma_f32_16x16x32_bf16 v[88:91], a[204:207], a[140:143], v[88:91]
v_cvt_pk_bf16_f32 v216, v96, v97
v_cvt_pk_bf16_f32 v217, v98, v99
v_mfma_f32_16x16x16_bf16 v[60:63], a[12:13], v[116:117], v[60:63]
ds_write_b64 v219, v[216:217] offset:128
v_mfma_f32_16x16x16_bf16 v[88:91], a[12:13], v[118:119], v[88:91]
s_waitcnt lgkmcnt(0)
s_barrier
ds_read_b64 v[150:151], v218
ds_read_b64 v[154:155], v218 offset:32
ds_read_b64 v[152:153], v220 offset:136
ds_read_b64 v[158:159], v220 offset:2952
ds_read_b64 v[164:165], v220 offset:5768
s_mul_i32 s36, s28, 82944
s_mul_i32 s38, s24, 13312
s_add_u32 m0, s38, 70656
s_add_u32 s39, s38, s36
s_nop 0
s_add_u32 s39, s39, 2154496
buffer_load_dwordx4 v1, s[4:7], s39 offen offset:0 sc1 lds
buffer_load_dwordx4 v1, s[4:7], s39 offen offset:1024 sc1 lds
v_cndmask_b32 v170, 0, v210, s[48:49]
v_cndmask_b32 v173, 0, v211, s[48:49]
v_cndmask_b32 v178, 0, v212, s[48:49]
v_cndmask_b32 v181, 0, v213, s[48:49]
v_cvt_pk_bf16_f32 v168, v56, v57
v_cvt_pk_bf16_f32 v169, v58, v59
v_cvt_pk_bf16_f32 v176, v84, v85
v_cvt_pk_bf16_f32 v177, v86, v87
v_cvt_pk_bf16_f32 v174, v60, v61
v_cvt_pk_bf16_f32 v175, v62, v63
v_cvt_pk_bf16_f32 v182, v88, v89
v_cvt_pk_bf16_f32 v183, v90, v91
s_waitcnt lgkmcnt(0)
s_nop 0
ds_read_b64_tr_b16 v[184:185], v221 offset:64
v_mfma_f32_16x16x32_bf16 v[36:39], v[150:153], v[168:171], 0
ds_read_b64_tr_b16 v[186:187], v221 offset:2880
v_mfma_f32_16x16x32_bf16 v[40:43], v[156:159], v[168:171], 0
ds_read_b64_tr_b16 v[188:189], v221 offset:5696
buffer_load_dwordx4 v1, s[4:7], s39 offen offset:2048 sc1 lds
v_mfma_f32_16x16x32_bf16 v[44:47], v[152:155], v[172:175], 0
ds_read_b64_tr_b16 v[190:191], v221 offset:96
v_mfma_f32_16x16x32_bf16 v[48:51], v[158:161], v[172:175], 0
ds_read_b64_tr_b16 v[192:193], v221 offset:2912
buffer_load_dwordx4 v1, s[4:7], s39 offen offset:3072 sc1 lds
v_mfma_f32_16x16x32_bf16 v[52:55], v[156:159], v[176:179], 0
ds_read_b64_tr_b16 v[194:195], v221 offset:5728
v_mfma_f32_16x16x32_bf16 v[56:59], v[162:165], v[176:179], 0
ds_read_b64_tr_b16 v[196:197], v221 offset:128
s_add_u32 m0, m0, 4096
s_add_u32 s39, s39, 4096
buffer_load_dwordx4 v1, s[4:7], s39 offen offset:0 sc1 lds
v_mfma_f32_16x16x32_bf16 v[60:63], v[158:161], v[180:183], 0
ds_read_b64_tr_b16 v[198:199], v221 offset:2944
v_mfma_f32_16x16x32_bf16 v[64:67], v[164:167], v[180:183], 0
ds_read_b64_tr_b16 v[200:201], v221 offset:5760
buffer_load_dwordx4 v1, s[4:7], s39 offen offset:1024 sc1 lds
v_cndmask_b32 v36, v36, v37, s[40:41]
v_cndmask_b32 v40, v40, v41, s[40:41]
v_cndmask_b32 v68, v36, v40, s[42:43]
v_cndmask_b32 v38, v38, v39, s[40:41]
v_cndmask_b32 v42, v42, v43, s[40:41]
v_cndmask_b32 v69, v38, v42, s[44:45]
v_cndmask_b32 v44, v44, v45, s[40:41]
v_cndmask_b32 v48, v48, v49, s[40:41]
buffer_load_dwordx4 v1, s[4:7], s39 offen offset:2048 sc1 lds
buffer_load_dwordx4 v1, s[4:7], s39 offen offset:3072 sc1 lds
v_cndmask_b32 v70, v44, v48, s[42:43]
v_cndmask_b32 v46, v46, v47, s[40:41]
v_cndmask_b32 v50, v50, v51, s[40:41]
v_cndmask_b32 v71, v46, v50, s[44:45]
v_cndmask_b32 v52, v52, v53, s[40:41]
v_cndmask_b32 v56, v56, v57, s[40:41]
v_cndmask_b32 v72, v52, v56, s[42:43]
s_add_u32 m0, m0, 4096
v_cndmask_b32 v54, v54, v55, s[40:41]
v_cndmask_b32 v58, v58, v59, s[40:41]
v_cndmask_b32 v73, v54, v58, s[44:45]
v_cndmask_b32 v60, v60, v61, s[40:41]
v_cndmask_b32 v64, v64, v65, s[40:41]
v_cndmask_b32 v74, v60, v64, s[42:43]
v_cndmask_b32 v62, v62, v63, s[40:41]
v_cndmask_b32 v66, v66, v67, s[40:41]
s_add_u32 s39, s39, 4096
v_cndmask_b32 v75, v62, v66, s[44:45]
v_pk_fma_f32 v[68:69], v[68:69], v[140:141], v[144:145]
v_pk_mul_f32 v[72:73], v[72:73], v[142:143]
v_pk_fma_f32 v[70:71], v[70:71], v[140:141], v[144:145]
v_pk_mul_f32 v[74:75], v[74:75], v[142:143]
v_permlane32_swap_b32 v68, v72
s_nop 0
buffer_load_dwordx4 v1, s[4:7], s39 offen offset:0 sc1 lds
buffer_load_dwordx4 v1, s[4:7], s39 offen offset:1024 sc1 lds
v_permlane32_swap_b32 v70, v74
v_permlane32_swap_b32 v69, v73
v_permlane32_swap_b32 v71, v75
v_permlane16_swap_b32 v68, v70
v_permlane16_swap_b32 v72, v74
v_permlane16_swap_b32 v69, v71
v_permlane16_swap_b32 v73, v75
v_max3_f32 v76, v68, v69, v70
buffer_load_dwordx4 v1, s[4:7], s39 offen offset:2048 sc1 lds
buffer_load_dwordx4 v1, s[4:7], s39 offen offset:3072 sc1 lds
v_max3_f32 v77, v71, v72, v73
v_max3_f32 v76, v76, v74, v75
v_max_f32 v76, v76, v77
v_pk_add_f32 v[68:69], v[68:69], v[76:77] op_sel_hi:[1,0] neg_lo:[0,1] neg_hi:[0,1]
v_pk_add_f32 v[70:71], v[70:71], v[76:77] op_sel_hi:[1,0] neg_lo:[0,1] neg_hi:[0,1]
v_pk_add_f32 v[72:73], v[72:73], v[76:77] op_sel_hi:[1,0] neg_lo:[0,1] neg_hi:[0,1]
v_pk_add_f32 v[74:75], v[74:75], v[76:77] op_sel_hi:[1,0] neg_lo:[0,1] neg_hi:[0,1]
s_add_u32 m0, m0, 4096
v_exp_f32 v68, v68
v_exp_f32 v69, v69
v_exp_f32 v70, v70
v_exp_f32 v71, v71
v_exp_f32 v72, v72
v_exp_f32 v73, v73
v_exp_f32 v74, v74
v_exp_f32 v75, v75
s_add_u32 s39, s39, 4096
v_pk_add_f32 v[76:77], v[68:69], v[70:71]
v_pk_add_f32 v[78:79], v[72:73], v[74:75]
v_pk_add_f32 v[76:77], v[76:77], v[78:79]
v_add_f32 v76, v76, v77
v_rcp_f32 v76, v76
v_pk_mul_f32 v[68:69], v[68:69], v[100:101]
v_pk_mul_f32 v[70:71], v[70:71], v[102:103]
buffer_load_dwordx4 v1, s[4:7], s39 offen offset:0 sc1 lds
v_pk_mul_f32 v[72:73], v[72:73], v[104:105]
v_pk_mul_f32 v[74:75], v[74:75], v[106:107]
v_pk_mul_f32 v[68:69], v[68:69], v[76:77] op_sel_hi:[1,0]
v_pk_mul_f32 v[70:71], v[70:71], v[76:77] op_sel_hi:[1,0]
v_pk_mul_f32 v[72:73], v[72:73], v[76:77] op_sel_hi:[1,0]
v_pk_mul_f32 v[74:75], v[74:75], v[76:77] op_sel_hi:[1,0]
v_cvt_pk_bf16_f32 v80, v68, v69
v_cvt_pk_bf16_f32 v82, v72, v73
v_cvt_pk_bf16_f32 v81, v70, v71
v_cvt_pk_bf16_f32 v83, v74, v75
v_permlane32_swap_b32 v80, v82
s_waitcnt lgkmcnt(0)
v_permlane32_swap_b32 v81, v83
s_nop 1
v_permlane16_swap_b32 v80, v81
v_permlane16_swap_b32 v82, v83
v_perm_b32 v84, v80, v80, v10
v_perm_b32 v85, v80, v80, v11
v_perm_b32 v86, v80, v80, v12
v_perm_b32 v87, v80, v80, v13
v_perm_b32 v88, v81, v81, v10
v_perm_b32 v89, v81, v81, v11
v_mfma_f32_16x16x32_bf16 v[36:39], v[184:187], v[84:87], 0
v_perm_b32 v90, v81, v81, v12
v_perm_b32 v91, v81, v81, v13
v_mfma_f32_16x16x32_bf16 v[40:43], v[196:199], v[84:87], 0
v_perm_b32 v92, v82, v82, v10
v_perm_b32 v93, v82, v82, v11
v_mfma_f32_16x16x32_bf16 v[44:47], v[190:193], v[88:91], 0
v_perm_b32 v94, v82, v82, v12
v_perm_b32 v95, v82, v82, v13
v_mfma_f32_16x16x32_bf16 v[48:51], v[196:199], v[88:91], 0
v_perm_b32 v96, v83, v83, v10
v_perm_b32 v97, v83, v83, v11
v_mfma_f32_16x16x32_bf16 v[52:55], v[186:189], v[92:95], 0
v_perm_b32 v98, v83, v83, v12
v_perm_b32 v99, v83, v83, v13
v_mfma_f32_16x16x32_bf16 v[56:59], v[198:201], v[92:95], 0
v_cvt_pk_bf16_f32 v168, v36, v37
v_cvt_pk_bf16_f32 v169, v38, v39
v_mfma_f32_16x16x32_bf16 v[60:63], v[192:195], v[96:99], 0
v_mfma_f32_16x16x32_bf16 v[64:67], v[198:201], v[96:99], 0
v_cvt_pk_bf16_f32 v172, v40, v41
v_cvt_pk_bf16_f32 v170, v44, v45
v_cvt_pk_bf16_f32 v171, v46, v47
v_cvt_pk_bf16_f32 v173, v50, v51
buffer_store_dwordx4 v[168:171], v1, s[8:11], s64 offen sc1
buffer_store_dwordx2 v[172:173], v224, s[8:11], s65 offen sc1
v_cvt_pk_bf16_f32 v176, v52, v53
v_cvt_pk_bf16_f32 v177, v54, v55
v_cvt_pk_bf16_f32 v180, v56, v57
v_cvt_pk_bf16_f32 v178, v60, v61
v_cvt_pk_bf16_f32 v179, v62, v63
v_cvt_pk_bf16_f32 v181, v66, v67
buffer_store_dwordx4 v[176:179], v237, s[8:11], s64 offen sc1
buffer_store_dwordx2 v[180:181], v225, s[8:11], s65 offen sc1
L_c2:
s_barrier
s_mul_i32 s38, s24, 9216
s_add_u32 m0, s38, 123904
s_add_u32 s39, s38, s82
buffer_load_dwordx4 v1, s[4:7], s39 offen offset:0 sc1 lds
buffer_load_dwordx4 v1, s[4:7], s39 offen offset:1024 sc1 lds
buffer_load_dwordx4 v1, s[4:7], s39 offen offset:2048 sc1 lds
buffer_load_dwordx4 v1, s[4:7], s39 offen offset:3072 sc1 lds
s_add_u32 m0, m0, 4096
s_add_u32 s39, s39, 4096
buffer_load_dwordx4 v1, s[4:7], s39 offen offset:0 sc1 lds
buffer_load_dwordx4 v1, s[4:7], s39 offen offset:1024 sc1 lds
buffer_load_dwordx4 v1, s[4:7], s39 offen offset:2048 sc1 lds
v_lshlrev_b32 v7, 3, v1
s_lshl_b32 s31, s25, 11
v_add_u32 v7, s31, v7
s_cmp_eq_u32 s24, 0
s_cselect_b32 s30, 0, 1073741824
s_add_u32 s30, s30, 26476544
s_waitcnt vmcnt(7)
s_barrier
s_mov_b64 exec, 0xffff
buffer_atomic_add v4, v7, s[8:11], s30 offen sc1
s_mov_b64 exec, -1
s_lshl_b32 s35, s80, 7
s_add_u32 s35, s35, 26476544
s_cmp_eq_u32 s24, 1
s_cselect_b32 s35, s35, 1073741824
v_mov_b32 v6, 0
v_mov_b32 v244, 0
v_mov_b32 v245, 0
v_mov_b32 v246, 0
buffer_load_dwordx4 v1, s[4:7], s39 offen offset:3072 sc1 lds
s_add_u32 m0, m0, 4096
s_add_u32 s39, s39, 4096
buffer_load_dwordx4 v1, s[4:7], s39 offen offset:0 sc1 lds
s_lshl_b32 s38, s24, 8
s_add_u32 m0, s38, 160768
s_add_u32 s39, s38, s82
s_add_u32 s39, s39, 36864
s_mov_b64 exec, 0xffff
buffer_load_dwordx4 v1, s[4:7], s39 offen sc1 lds
s_mov_b64 exec, -1
s_mul_i32 s38, s24, 9216
s_add_u32 m0, s38, 0
s_add_u32 s39, s38, s82
s_add_u32 s39, s39, 37888
buffer_load_dwordx4 v1, s[4:7], s39 offen offset:0 sc1 lds
s_mov_b64 exec, 1
buffer_atomic_add v244, v6, s[8:11], s35 offen sc0 sc1
s_mov_b64 exec, -1
buffer_load_dwordx4 v1, s[4:7], s39 offen offset:1024 sc1 lds
buffer_load_dwordx4 v1, s[4:7], s39 offen offset:2048 sc1 lds
buffer_load_dwordx4 v1, s[4:7], s39 offen offset:3072 sc1 lds
s_add_u32 m0, m0, 4096
s_add_u32 s39, s39, 4096
s_mov_b64 exec, 1
buffer_atomic_add v245, v6, s[8:11], s35 offen sc0 sc1
s_mov_b64 exec, -1
buffer_load_dwordx4 v1, s[4:7], s39 offen offset:0 sc1 lds
buffer_load_dwordx4 v1, s[4:7], s39 offen offset:1024 sc1 lds
buffer_load_dwordx4 v1, s[4:7], s39 offen offset:2048 sc1 lds
s_mov_b64 exec, 1
buffer_atomic_add v246, v6, s[8:11], s35 offen sc0 sc1
s_mov_b64 exec, -1
buffer_load_dwordx4 v1, s[4:7], s39 offen offset:3072 sc1 lds
s_add_u32 m0, m0, 4096
s_add_u32 s39, s39, 4096
buffer_load_dwordx4 v1, s[4:7], s39 offen offset:0 sc1 lds
s_lshl_b32 s38, s24, 8
s_add_u32 m0, s38, 36864
s_add_u32 s39, s38, s82
s_add_u32 s39, s39, 74752
s_mov_b64 exec, 0xffff
buffer_load_dwordx4 v1, s[4:7], s39 offen sc1 lds
s_mov_b64 exec, -1
s_mul_i32 s60, s70, 18432
s_add_u32 s60, s60, 2490368
s_cmp_eq_u32 s24, 1
s_cbranch_scc0 L_other_15
s_mov_b32 s31, 0
s_mov_b64 exec, 1
v_mov_b32 v247, 0
buffer_atomic_add v247, v6, s[8:11], s35 offen sc0 sc1
s_waitcnt vmcnt(12)
v_cmp_gt_u32 vcc, 16, v244
s_nop 0
s_cbranch_vccz L_polled_14
s_waitcnt vmcnt(8)
v_cmp_gt_u32 vcc, 16, v245
s_nop 0
s_cbranch_vccz L_polled_14
v_mov_b32 v244, 0
buffer_atomic_add v244, v6, s[8:11], s35 offen sc0 sc1
s_waitcnt vmcnt(5)
v_cmp_gt_u32 vcc, 16, v246
s_nop 0
s_cbranch_vccz L_polled_14
v_mov_b32 v245, 0
buffer_atomic_add v245, v6, s[8:11], s35 offen sc0 sc1
L_poll_13:
s_add_u32 s31, s31, 1
s_cmp_gt_u32 s31, 100000
s_cbranch_scc1 L_polled_14
v_mov_b32 v246, 0
buffer_atomic_add v246, v6, s[8:11], s35 offen sc0 sc1
s_waitcnt vmcnt(3)
v_cmp_gt_u32 vcc, 16, v247
s_nop 0
s_cbranch_vccz L_polled_14
v_mov_b32 v247, 0
buffer_atomic_add v247, v6, s[8:11], s35 offen sc0 sc1
s_waitcnt vmcnt(3)
v_cmp_gt_u32 vcc, 16, v244
s_nop 0
s_cbranch_vccz L_polled_14
v_mov_b32 v244, 0
buffer_atomic_add v244, v6, s[8:11], s35 offen sc0 sc1
s_waitcnt vmcnt(3)
v_cmp_gt_u32 vcc, 16, v245
s_nop 0
s_cbranch_vccz L_polled_14
v_mov_b32 v245, 0
buffer_atomic_add v245, v6, s[8:11], s35 offen sc0 sc1
s_waitcnt vmcnt(3)
v_cmp_gt_u32 vcc, 16, v246
s_nop 0
s_cbranch_vccz L_polled_14
s_branch L_poll_13
L_polled_14:
s_mov_b64 exec, -1
L_other_15:
s_barrier
buffer_load_dwordx4 a[0:3], v1, s[8:11], s60 offen offset:0 sc1
buffer_load_dwordx4 a[4:7], v1, s[8:11], s60 offen offset:1024 sc1
s_barrier
buffer_load_dwordx4 a[8:11], v1, s[8:11], s60 offen offset:2048 sc1
buffer_load_dwordx4 a[12:15], v1, s[8:11], s60 offen offset:3072 sc1
s_barrier
s_add_u32 s60, s60, 4096
buffer_load_dwordx4 a[16:19], v1, s[8:11], s60 offen offset:0 sc1
buffer_load_dwordx4 a[20:23], v1, s[8:11], s60 offen offset:1024 sc1
s_barrier
buffer_load_dwordx4 a[24:27], v1, s[8:11], s60 offen offset:2048 sc1
buffer_load_dwordx4 a[28:31], v1, s[8:11], s60 offen offset:3072 sc1
v_lshrrev_b32 v40, 1, v1
v_and_b32 v36, 7, v2
v_lshlrev_b32 v36, 4, v36
v_lshl_add_u32 v36, v3, 7, v36
v_add_u32 v36, 4096, v36
v_add_u32 v36, 37888, v36
v_add_u32 v39, 37888, v1
v_add_u32 v37, 79360, v1
v_add_u32 v38, 41472, v36
ds_read_b128 a[72:75], v39 offset:0
ds_read_b128 a[76:79], v39 offset:1024
ds_read_b128 a[80:83], v39 offset:2048
ds_read_b128 a[84:87], v39 offset:3072
ds_read_b128 a[88:91], v36 offset:0
ds_read_b128 a[92:95], v39 offset:4608
ds_read_b128 a[96:99], v39 offset:5632
ds_read_b128 a[100:103], v39 offset:6656
ds_read_b128 a[104:107], v39 offset:7680
ds_read_b128 a[108:111], v36 offset:4608
v_mov_b32 v58, 1073741824
s_mul_i32 s62, s70, 18432
s_mul_i32 s32, s28, 2304
s_add_u32 s62, s62, s32
s_add_u32 s62, s62, 4849664
v_mov_b32 v60, v1
v_add_u32 v61, 2048, v60
v_cndmask_b32 v61, v58, v61, s[46:47]
s_lshl_b32 s63, s70, 7
s_lshl_b32 s32, s28, 14
s_add_u32 s63, s63, s32
s_add_u32 s63, s63, 7208960
v_lshlrev_b32 v59, 3, v2
v_cndmask_b32 v58, v58, v59, s[46:47]
s_waitcnt vmcnt(7) lgkmcnt(5)
v_mfma_f32_16x16x32_bf16 v[16:19], a[72:75], a[0:3], v[16:19]
ds_read_b128 a[112:115], v39 offset:9216
s_add_u32 s60, s60, 4096
buffer_load_dwordx4 a[32:35], v1, s[8:11], s60 offen offset:0 sc1
v_mfma_f32_16x16x32_bf16 v[20:23], a[76:79], a[0:3], v[20:23]
ds_read_b128 a[116:119], v39 offset:10240
v_mfma_f32_16x16x32_bf16 v[24:27], a[80:83], a[0:3], v[24:27]
ds_read_b128 a[120:123], v39 offset:11264
v_mfma_f32_16x16x32_bf16 v[28:31], a[84:87], a[0:3], v[28:31]
ds_read_b128 a[124:127], v39 offset:12288
v_mfma_f32_16x16x32_bf16 v[32:35], a[88:91], a[0:3], v[32:35]
ds_read_b128 a[128:131], v36 offset:9216
s_waitcnt vmcnt(7) lgkmcnt(5)
v_mfma_f32_16x16x32_bf16 v[16:19], a[92:95], a[4:7], v[16:19]
ds_read_b128 a[72:75], v39 offset:13824
buffer_load_dwordx4 a[36:39], v1, s[8:11], s60 offen offset:1024 sc1
v_mfma_f32_16x16x32_bf16 v[20:23], a[96:99], a[4:7], v[20:23]
ds_read_b128 a[76:79], v39 offset:14848
v_mfma_f32_16x16x32_bf16 v[24:27], a[100:103], a[4:7], v[24:27]
ds_read_b128 a[80:83], v39 offset:15872
v_mfma_f32_16x16x32_bf16 v[28:31], a[104:107], a[4:7], v[28:31]
ds_read_b128 a[84:87], v39 offset:16896
v_mfma_f32_16x16x32_bf16 v[32:35], a[108:111], a[4:7], v[32:35]
ds_read_b128 a[88:91], v36 offset:13824
s_waitcnt vmcnt(7) lgkmcnt(5)
v_mfma_f32_16x16x32_bf16 v[16:19], a[112:115], a[8:11], v[16:19]
ds_read_b128 a[92:95], v39 offset:18432
buffer_load_dwordx4 a[40:43], v1, s[8:11], s60 offen offset:2048 sc1
v_mfma_f32_16x16x32_bf16 v[20:23], a[116:119], a[8:11], v[20:23]
ds_read_b128 a[96:99], v39 offset:19456
v_mfma_f32_16x16x32_bf16 v[24:27], a[120:123], a[8:11], v[24:27]
ds_read_b128 a[100:103], v39 offset:20480
v_mfma_f32_16x16x32_bf16 v[28:31], a[124:127], a[8:11], v[28:31]
ds_read_b128 a[104:107], v39 offset:21504
v_mfma_f32_16x16x32_bf16 v[32:35], a[128:131], a[8:11], v[32:35]
ds_read_b128 a[108:111], v36 offset:18432
s_waitcnt vmcnt(7) lgkmcnt(5)
v_mfma_f32_16x16x32_bf16 v[16:19], a[72:75], a[12:15], v[16:19]
ds_read_b128 a[112:115], v39 offset:23040
buffer_load_dwordx4 a[44:47], v1, s[8:11], s60 offen offset:3072 sc1
v_mfma_f32_16x16x32_bf16 v[20:23], a[76:79], a[12:15], v[20:23]
ds_read_b128 a[116:119], v39 offset:24064
v_mfma_f32_16x16x32_bf16 v[24:27], a[80:83], a[12:15], v[24:27]
ds_read_b128 a[120:123], v39 offset:25088
v_mfma_f32_16x16x32_bf16 v[28:31], a[84:87], a[12:15], v[28:31]
ds_read_b128 a[124:127], v39 offset:26112
v_mfma_f32_16x16x32_bf16 v[32:35], a[88:91], a[12:15], v[32:35]
ds_read_b128 a[128:131], v36 offset:23040
s_waitcnt vmcnt(7) lgkmcnt(5)
v_mfma_f32_16x16x32_bf16 v[16:19], a[92:95], a[16:19], v[16:19]
ds_read_b128 a[72:75], v39 offset:27648
s_add_u32 s60, s60, 4096
buffer_load_dwordx4 a[48:51], v1, s[8:11], s60 offen offset:0 sc1
v_mfma_f32_16x16x32_bf16 v[20:23], a[96:99], a[16:19], v[20:23]
ds_read_b128 a[76:79], v39 offset:28672
v_mfma_f32_16x16x32_bf16 v[24:27], a[100:103], a[16:19], v[24:27]
ds_read_b128 a[80:83], v39 offset:29696
v_mfma_f32_16x16x32_bf16 v[28:31], a[104:107], a[16:19], v[28:31]
ds_read_b128 a[84:87], v39 offset:30720
v_mfma_f32_16x16x32_bf16 v[32:35], a[108:111], a[16:19], v[32:35]
ds_read_b128 a[88:91], v36 offset:27648
s_waitcnt vmcnt(7) lgkmcnt(5)
v_mfma_f32_16x16x32_bf16 v[16:19], a[112:115], a[20:23], v[16:19]
ds_read_b128 a[92:95], v39 offset:32256
buffer_load_dwordx4 a[52:55], v1, s[8:11], s60 offen offset:1024 sc1
v_mfma_f32_16x16x32_bf16 v[20:23], a[116:119], a[20:23], v[20:23]
ds_read_b128 a[96:99], v39 offset:33280
v_mfma_f32_16x16x32_bf16 v[24:27], a[120:123], a[20:23], v[24:27]
ds_read_b128 a[100:103], v39 offset:34304
v_mfma_f32_16x16x32_bf16 v[28:31], a[124:127], a[20:23], v[28:31]
ds_read_b128 a[104:107], v39 offset:35328
v_mfma_f32_16x16x32_bf16 v[32:35], a[128:131], a[20:23], v[32:35]
ds_read_b128 a[108:111], v36 offset:32256
s_waitcnt vmcnt(7) lgkmcnt(5)
v_mfma_f32_16x16x32_bf16 v[16:19], a[72:75], a[24:27], v[16:19]
ds_read_b128 a[112:115], v39 offset:36864
buffer_load_dwordx4 a[56:59], v1, s[8:11], s60 offen offset:2048 sc1
v_mfma_f32_16x16x32_bf16 v[20:23], a[76:79], a[24:27], v[20:23]
ds_read_b128 a[116:119], v39 offset:37888
v_mfma_f32_16x16x32_bf16 v[24:27], a[80:83], a[24:27], v[24:27]
ds_read_b128 a[120:123], v39 offset:38912
v_mfma_f32_16x16x32_bf16 v[28:31], a[84:87], a[24:27], v[28:31]
ds_read_b128 a[124:127], v39 offset:39936
v_mfma_f32_16x16x32_bf16 v[32:35], a[88:91], a[24:27], v[32:35]
ds_read_b128 a[128:131], v36 offset:36864
s_waitcnt vmcnt(7) lgkmcnt(5)
v_mfma_f32_16x16x32_bf16 v[16:19], a[92:95], a[28:31], v[16:19]
ds_read_b128 a[72:75], v37 offset:0
buffer_load_dwordx4 a[60:63], v1, s[8:11], s60 offen offset:3072 sc1
v_mfma_f32_16x16x32_bf16 v[20:23], a[96:99], a[28:31], v[20:23]
ds_read_b128 a[76:79], v37 offset:1024
v_mfma_f32_16x16x32_bf16 v[24:27], a[100:103], a[28:31], v[24:27]
ds_read_b128 a[80:83], v37 offset:2048
v_mfma_f32_16x16x32_bf16 v[28:31], a[104:107], a[28:31], v[28:31]
ds_read_b128 a[84:87], v37 offset:3072
v_mfma_f32_16x16x32_bf16 v[32:35], a[108:111], a[28:31], v[32:35]
ds_read_b128 a[88:91], v38 offset:0
s_waitcnt vmcnt(7) lgkmcnt(5)
v_mfma_f32_16x16x32_bf16 v[16:19], a[112:115], a[32:35], v[16:19]
ds_read_b128 a[92:95], v37 offset:4608
s_add_u32 s60, s60, 4096
buffer_load_dwordx2 a[64:65], v40, s[8:11], s60 offen offset:0 sc1
buffer_load_dwordx2 a[66:67], v40, s[8:11], s60 offen offset:1024 sc1
v_mfma_f32_16x16x32_bf16 v[20:23], a[116:119], a[32:35], v[20:23]
ds_read_b128 a[96:99], v37 offset:5632
v_mfma_f32_16x16x32_bf16 v[24:27], a[120:123], a[32:35], v[24:27]
ds_read_b128 a[100:103], v37 offset:6656
v_mfma_f32_16x16x32_bf16 v[28:31], a[124:127], a[32:35], v[28:31]
ds_read_b128 a[104:107], v37 offset:7680
v_mfma_f32_16x16x32_bf16 v[32:35], a[128:131], a[32:35], v[32:35]
ds_read_b128 a[108:111], v38 offset:4608
s_waitcnt vmcnt(8) lgkmcnt(5)
v_mfma_f32_16x16x32_bf16 v[16:19], a[72:75], a[36:39], v[16:19]
ds_read_b128 a[112:115], v37 offset:9216
buffer_load_dwordx2 a[68:69], v40, s[8:11], s60 offen offset:512 sc1
buffer_load_dwordx2 a[70:71], v40, s[8:11], s60 offen offset:1536 sc1
v_mfma_f32_16x16x32_bf16 v[20:23], a[76:79], a[36:39], v[20:23]
ds_read_b128 a[116:119], v37 offset:10240
v_mfma_f32_16x16x32_bf16 v[24:27], a[80:83], a[36:39], v[24:27]
ds_read_b128 a[120:123], v37 offset:11264
v_mfma_f32_16x16x32_bf16 v[28:31], a[84:87], a[36:39], v[28:31]
ds_read_b128 a[124:127], v37 offset:12288
v_mfma_f32_16x16x32_bf16 v[32:35], a[88:91], a[36:39], v[32:35]
ds_read_b128 a[128:131], v38 offset:9216
s_waitcnt vmcnt(9) lgkmcnt(5)
v_mfma_f32_16x16x32_bf16 v[16:19], a[92:95], a[40:43], v[16:19]
ds_read_b128 a[72:75], v37 offset:13824
v_mfma_f32_16x16x32_bf16 v[20:23], a[96:99], a[40:43], v[20:23]
ds_read_b128 a[76:79], v37 offset:14848
v_mfma_f32_16x16x32_bf16 v[24:27], a[100:103], a[40:43], v[24:27]
ds_read_b128 a[80:83], v37 offset:15872
v_mfma_f32_16x16x32_bf16 v[28:31], a[104:107], a[40:43], v[28:31]
ds_read_b128 a[84:87], v37 offset:16896
v_mfma_f32_16x16x32_bf16 v[32:35], a[108:111], a[40:43], v[32:35]
ds_read_b128 a[88:91], v38 offset:13824
s_waitcnt vmcnt(8) lgkmcnt(5)
v_mfma_f32_16x16x32_bf16 v[16:19], a[112:115], a[44:47], v[16:19]
ds_read_b128 a[92:95], v37 offset:18432
v_mfma_f32_16x16x32_bf16 v[20:23], a[116:119], a[44:47], v[20:23]
ds_read_b128 a[96:99], v37 offset:19456
v_mfma_f32_16x16x32_bf16 v[24:27], a[120:123], a[44:47], v[24:27]
ds_read_b128 a[100:103], v37 offset:20480
v_mfma_f32_16x16x32_bf16 v[28:31], a[124:127], a[44:47], v[28:31]
ds_read_b128 a[104:107], v37 offset:21504
v_mfma_f32_16x16x32_bf16 v[32:35], a[128:131], a[44:47], v[32:35]
ds_read_b128 a[108:111], v38 offset:18432
s_waitcnt vmcnt(7) lgkmcnt(5)
v_mfma_f32_16x16x32_bf16 v[16:19], a[72:75], a[48:51], v[16:19]
ds_read_b128 a[112:115], v37 offset:23040
v_mfma_f32_16x16x32_bf16 v[20:23], a[76:79], a[48:51], v[20:23]
ds_read_b128 a[116:119], v37 offset:24064
v_mfma_f32_16x16x32_bf16 v[24:27], a[80:83], a[48:51], v[24:27]
ds_read_b128 a[120:123], v37 offset:25088
v_mfma_f32_16x16x32_bf16 v[28:31], a[84:87], a[48:51], v[28:31]
ds_read_b128 a[124:127], v37 offset:26112
v_mfma_f32_16x16x32_bf16 v[32:35], a[88:91], a[48:51], v[32:35]
ds_read_b128 a[128:131], v38 offset:23040
s_waitcnt vmcnt(6) lgkmcnt(5)
v_mfma_f32_16x16x32_bf16 v[16:19], a[92:95], a[52:55], v[16:19]
ds_read_b128 a[72:75], v37 offset:27648
v_mfma_f32_16x16x32_bf16 v[20:23], a[96:99], a[52:55], v[20:23]
ds_read_b128 a[76:79], v37 offset:28672
v_mfma_f32_16x16x32_bf16 v[24:27], a[100:103], a[52:55], v[24:27]
ds_read_b128 a[80:83], v37 offset:29696
v_mfma_f32_16x16x32_bf16 v[28:31], a[104:107], a[52:55], v[28:31]
ds_read_b128 a[84:87], v37 offset:30720
v_mfma_f32_16x16x32_bf16 v[32:35], a[108:111], a[52:55], v[32:35]
ds_read_b128 a[88:91], v38 offset:27648
s_waitcnt vmcnt(5) lgkmcnt(5)
v_mfma_f32_16x16x32_bf16 v[16:19], a[112:115], a[56:59], v[16:19]
ds_read_b128 a[92:95], v37 offset:32256
v_mfma_f32_16x16x32_bf16 v[20:23], a[116:119], a[56:59], v[20:23]
ds_read_b128 a[96:99], v37 offset:33280
v_mfma_f32_16x16x32_bf16 v[24:27], a[120:123], a[56:59], v[24:27]
ds_read_b128 a[100:103], v37 offset:34304
v_mfma_f32_16x16x32_bf16 v[28:31], a[124:127], a[56:59], v[28:31]
ds_read_b128 a[104:107], v37 offset:35328
v_mfma_f32_16x16x32_bf16 v[32:35], a[128:131], a[56:59], v[32:35]
ds_read_b128 a[108:111], v38 offset:32256
s_waitcnt vmcnt(4) lgkmcnt(5)
v_mfma_f32_16x16x32_bf16 v[16:19], a[72:75], a[60:63], v[16:19]
ds_read_b128 a[112:115], v37 offset:36864
v_mfma_f32_16x16x32_bf16 v[20:23], a[76:79], a[60:63], v[20:23]
ds_read_b128 a[116:119], v37 offset:37888
v_mfma_f32_16x16x32_bf16 v[24:27], a[80:83], a[60:63], v[24:27]
ds_read_b128 a[120:123], v37 offset:38912
v_mfma_f32_16x16x32_bf16 v[28:31], a[84:87], a[60:63], v[28:31]
ds_read_b128 a[124:127], v37 offset:39936
v_mfma_f32_16x16x32_bf16 v[32:35], a[88:91], a[60:63], v[32:35]
ds_read_b128 a[128:131], v38 offset:36864
s_waitcnt vmcnt(2) lgkmcnt(5)
v_mfma_f32_16x16x32_bf16 v[16:19], a[92:95], a[64:67], v[16:19]
v_mfma_f32_16x16x32_bf16 v[20:23], a[96:99], a[64:67], v[20:23]
v_mfma_f32_16x16x32_bf16 v[24:27], a[100:103], a[64:67], v[24:27]
v_mfma_f32_16x16x32_bf16 v[28:31], a[104:107], a[64:67], v[28:31]
v_mfma_f32_16x16x32_bf16 v[32:35], a[108:111], a[64:67], v[32:35]
s_waitcnt vmcnt(0) lgkmcnt(0)
v_mfma_f32_16x16x32_bf16 v[16:19], a[112:115], a[68:71], v[16:19]
v_mfma_f32_16x16x32_bf16 v[20:23], a[116:119], a[68:71], v[20:23]
v_mfma_f32_16x16x32_bf16 v[24:27], a[120:123], a[68:71], v[24:27]
v_mfma_f32_16x16x32_bf16 v[28:31], a[124:127], a[68:71], v[28:31]
v_mfma_f32_16x16x32_bf16 v[32:35], a[128:131], a[68:71], v[32:35]
s_nop 3
s_nop 0
v_pk_add_f32 v[62:63], v[16:17], v[18:19]
v_pk_mul_f32 v[64:65], v[16:17], v[16:17]
v_pk_fma_f32 v[64:65], v[18:19], v[18:19], v[64:65]
v_pk_add_f32 v[62:63], v[62:63], v[20:21]
v_pk_fma_f32 v[64:65], v[20:21], v[20:21], v[64:65]
v_pk_add_f32 v[62:63], v[62:63], v[22:23]
v_pk_fma_f32 v[64:65], v[22:23], v[22:23], v[64:65]
v_pk_add_f32 v[62:63], v[62:63], v[24:25]
v_pk_fma_f32 v[64:65], v[24:25], v[24:25], v[64:65]
v_pk_add_f32 v[62:63], v[62:63], v[26:27]
v_pk_fma_f32 v[64:65], v[26:27], v[26:27], v[64:65]
v_pk_add_f32 v[62:63], v[62:63], v[28:29]
v_pk_fma_f32 v[64:65], v[28:29], v[28:29], v[64:65]
v_pk_add_f32 v[62:63], v[62:63], v[30:31]
v_pk_fma_f32 v[64:65], v[30:31], v[30:31], v[64:65]
s_mov_b32 exec_hi, 0
v_pk_add_f32 v[62:63], v[62:63], v[32:33]
v_pk_fma_f32 v[64:65], v[32:33], v[32:33], v[64:65]
v_pk_add_f32 v[62:63], v[62:63], v[34:35]
v_pk_fma_f32 v[64:65], v[34:35], v[34:35], v[64:65]
s_mov_b64 exec, -1
v_add_f32 v56, v62, v63
v_add_f32 v57, v64, v65
v_cvt_pk_bf16_f32 v52, v32, v33
v_cvt_pk_bf16_f32 v53, v34, v35
v_permlane32_swap_b32 v56, v57
v_add_f32 v56, v56, v57
v_mov_b32 v57, v56
v_cvt_pk_bf16_f32 v44, v16, v17
v_cvt_pk_bf16_f32 v45, v18, v19
v_permlane16_swap_b32 v56, v57
v_add_f32 v56, v56, v57
v_mov_b32 v57, v56
v_cvt_pk_bf16_f32 v46, v20, v21
v_cvt_pk_bf16_f32 v47, v22, v23
v_permlane32_swap_b32 v56, v57
buffer_store_dwordx4 v[44:47], v60, s[8:11], s62 offen sc1
buffer_store_dwordx2 v[56:57], v58, s[8:11], s63 offen sc1
v_cvt_pk_bf16_f32 v48, v24, v25
v_cvt_pk_bf16_f32 v49, v26, v27
v_cvt_pk_bf16_f32 v50, v28, v29
v_cvt_pk_bf16_f32 v51, v30, v31
v_permlane16_swap_b32 v52, v54
v_permlane16_swap_b32 v53, v55
buffer_store_dwordx4 v[48:51], v60, s[8:11], s62 offen offset:1024 sc1
buffer_store_dwordx4 v[52:55], v61, s[8:11], s62 offen sc1
s_barrier
s_mul_i32 s38, s24, 9216
s_add_u32 m0, s38, 37888
s_add_u32 s39, s38, s82
s_add_u32 s39, s39, 75776
buffer_load_dwordx4 v1, s[4:7], s39 offen offset:0 sc1 lds
buffer_load_dwordx4 v1, s[4:7], s39 offen offset:1024 sc1 lds
buffer_load_dwordx4 v1, s[4:7], s39 offen offset:2048 sc1 lds
buffer_load_dwordx4 v1, s[4:7], s39 offen offset:3072 sc1 lds
s_add_u32 m0, m0, 4096
s_add_u32 s39, s39, 4096
buffer_load_dwordx4 v1, s[4:7], s39 offen offset:0 sc1 lds
buffer_load_dwordx4 v1, s[4:7], s39 offen offset:1024 sc1 lds
buffer_load_dwordx4 v1, s[4:7], s39 offen offset:2048 sc1 lds
v_lshlrev_b32 v7, 3, v1
s_lshr_b32 s31, s80, 4
s_lshl_b32 s31, s31, 11
v_add_u32 v7, s31, v7
s_cmp_eq_u32 s24, 0
s_cselect_b32 s30, 0, 1073741824
s_add_u32 s30, s30, 26509312
s_waitcnt vmcnt(7)
s_barrier
s_mov_b64 exec, 0xffff
buffer_atomic_add v4, v7, s[8:11], s30 offen sc1
s_mov_b64 exec, -1
s_lshl_b32 s35, s80, 7
s_add_u32 s35, s35, 26509312
s_cmp_eq_u32 s24, 1
s_cselect_b32 s35, s35, 1073741824
v_mov_b32 v6, 0
v_mov_b32 v244, 0
v_mov_b32 v245, 0
v_mov_b32 v246, 0
buffer_load_dwordx4 v1, s[4:7], s39 offen offset:3072 sc1 lds
s_add_u32 m0, m0, 4096
s_add_u32 s39, s39, 4096
buffer_load_dwordx4 v1, s[4:7], s39 offen offset:0 sc1 lds
s_lshl_b32 s38, s24, 8
s_add_u32 m0, s38, 74752
s_add_u32 s39, s38, s82
s_add_u32 s39, s39, 112640
s_mov_b64 exec, 0xffff
buffer_load_dwordx4 v1, s[4:7], s39 offen sc1 lds
s_mov_b64 exec, -1
s_mul_i32 s38, s24, 9216
s_add_u32 m0, s38, 75776
s_add_u32 s39, s38, s82
s_add_u32 s39, s39, 113664
buffer_load_dwordx4 v1, s[4:7], s39 offen offset:0 sc1 lds
s_mov_b64 exec, 1
buffer_atomic_add v244, v6, s[8:11], s35 offen sc0 sc1
s_mov_b64 exec, -1
buffer_load_dwordx4 v1, s[4:7], s39 offen offset:1024 sc1 lds
buffer_load_dwordx4 v1, s[4:7], s39 offen offset:2048 sc1 lds
buffer_load_dwordx4 v1, s[4:7], s39 offen offset:3072 sc1 lds
s_add_u32 m0, m0, 4096
s_add_u32 s39, s39, 4096
s_mov_b64 exec, 1
buffer_atomic_add v245, v6, s[8:11], s35 offen sc0 sc1
s_mov_b64 exec, -1
buffer_load_dwordx4 v1, s[4:7], s39 offen offset:0 sc1 lds
buffer_load_dwordx4 v1, s[4:7], s39 offen offset:1024 sc1 lds
buffer_load_dwordx4 v1, s[4:7], s39 offen offset:2048 sc1 lds
s_mov_b64 exec, 1
buffer_atomic_add v246, v6, s[8:11], s35 offen sc0 sc1
s_mov_b64 exec, -1
buffer_load_dwordx4 v1, s[4:7], s39 offen offset:3072 sc1 lds
s_add_u32 m0, m0, 4096
s_add_u32 s39, s39, 4096
buffer_load_dwordx4 v1, s[4:7], s39 offen offset:0 sc1 lds
s_lshl_b32 s38, s24, 8
s_add_u32 m0, s38, 112640
s_add_u32 s39, s38, s82
s_add_u32 s39, s39, 150528
s_mov_b64 exec, 0xffff
buffer_load_dwordx4 v1, s[4:7], s39 offen sc1 lds
s_mov_b64 exec, -1
s_lshl_b32 s60, s25, 2
s_add_u32 s60, s60, s24
s_mul_i32 s62, s60, 36864
s_add_u32 s62, s62, 4849664
v_add_u32 v180, 18432, v1
s_cmp_eq_u32 s24, 1
s_cbranch_scc0 L_other_20
s_mov_b32 s31, 0
s_mov_b64 exec, 1
v_mov_b32 v247, 0
buffer_atomic_add v247, v6, s[8:11], s35 offen sc0 sc1
s_waitcnt vmcnt(12)
v_cmp_gt_u32 vcc, 16, v244
s_nop 0
s_cbranch_vccz L_polled_19
s_waitcnt vmcnt(8)
v_cmp_gt_u32 vcc, 16, v245
s_nop 0
s_cbranch_vccz L_polled_19
v_mov_b32 v244, 0
buffer_atomic_add v244, v6, s[8:11], s35 offen sc0 sc1
s_waitcnt vmcnt(5)
v_cmp_gt_u32 vcc, 16, v246
s_nop 0
s_cbranch_vccz L_polled_19
v_mov_b32 v245, 0
buffer_atomic_add v245, v6, s[8:11], s35 offen sc0 sc1
L_poll_18:
s_add_u32 s31, s31, 1
s_cmp_gt_u32 s31, 100000
s_cbranch_scc1 L_polled_19
v_mov_b32 v246, 0
buffer_atomic_add v246, v6, s[8:11], s35 offen sc0 sc1
s_waitcnt vmcnt(3)
v_cmp_gt_u32 vcc, 16, v247
s_nop 0
s_cbranch_vccz L_polled_19
v_mov_b32 v247, 0
buffer_atomic_add v247, v6, s[8:11], s35 offen sc0 sc1
s_waitcnt vmcnt(3)
v_cmp_gt_u32 vcc, 16, v244
s_nop 0
s_cbranch_vccz L_polled_19
v_mov_b32 v244, 0
buffer_atomic_add v244, v6, s[8:11], s35 offen sc0 sc1
s_waitcnt vmcnt(3)
v_cmp_gt_u32 vcc, 16, v245
s_nop 0
s_cbranch_vccz L_polled_19
v_mov_b32 v245, 0
buffer_atomic_add v245, v6, s[8:11], s35 offen sc0 sc1
s_waitcnt vmcnt(3)
v_cmp_gt_u32 vcc, 16, v246
s_nop 0
s_cbranch_vccz L_polled_19
s_branch L_poll_18
L_polled_19:
s_mov_b64 exec, -1
L_other_20:
s_barrier
buffer_load_dwordx4 a[0:3], v1, s[8:11], s62 offen offset:0 sc1
buffer_load_dwordx4 a[4:7], v180, s[8:11], s62 offen offset:0 sc1
s_barrier
buffer_load_dwordx4 a[8:11], v1, s[8:11], s62 offen offset:1024 sc1
buffer_load_dwordx4 a[12:15], v180, s[8:11], s62 offen offset:1024 sc1
s_barrier
buffer_load_dwordx4 a[16:19], v1, s[8:11], s62 offen offset:2048 sc1
buffer_load_dwordx4 a[20:23], v180, s[8:11], s62 offen offset:2048 sc1
s_barrier
buffer_load_dwordx4 a[24:27], v1, s[8:11], s62 offen offset:3072 sc1
buffer_load_dwordx4 a[28:31], v180, s[8:11], s62 offen offset:3072 sc1
s_barrier
s_add_u32 s62, s62, 4096
buffer_load_dwordx4 a[32:35], v1, s[8:11], s62 offen offset:0 sc1
buffer_load_dwordx4 a[36:39], v180, s[8:11], s62 offen offset:0 sc1
s_barrier
buffer_load_dwordx4 a[40:43], v1, s[8:11], s62 offen offset:1024 sc1
buffer_load_dwordx4 a[44:47], v180, s[8:11], s62 offen offset:1024 sc1
s_lshl_b32 s53, s25, 2
s_add_u32 s53, s53, s24
s_mul_i32 s53, s53, 133120
s_add_u32 s53, s53, 10895360
s_lshl_b32 s52, s25, 12
s_add_u32 s52, s52, s53
v_lshrrev_b32 v239, 1, v1
v_and_b32 v6, 0xf8, v239
v_lshrrev_b32 v7, 1, v3
v_lshl_add_u32 v232, v7, 16, v6
s_lshl_b32 s63, s60, 8
s_add_u32 s63, s63, 7208960
v_add_u32 v208, 123904, v1
v_add_u32 v209, 0, v1
v_add_u32 v210, 37888, v1
v_add_u32 v211, 75776, v1
ds_read_b128 a[144:147], v208 offset:0
ds_read_b128 a[148:151], v208 offset:18432
ds_read_b128 a[152:155], v209 offset:0
ds_read_b128 a[156:159], v209 offset:18432
ds_read_b128 a[160:163], v208 offset:1024
ds_read_b128 a[164:167], v208 offset:19456
s_waitcnt vmcnt(10) lgkmcnt(4)
v_mfma_f32_16x16x32_bf16 v[36:39], a[144:147], a[0:3], 0
ds_read_b128 a[168:171], v209 offset:1024
ds_read_b128 a[172:175], v209 offset:19456
v_mfma_f32_16x16x32_bf16 v[40:43], a[144:147], a[4:7], 0
buffer_load_dwordx4 a[48:51], v1, s[8:11], s62 offen offset:2048 sc1
v_mfma_f32_16x16x32_bf16 v[44:47], a[148:151], a[0:3], 0
buffer_load_dwordx4 a[52:55], v180, s[8:11], s62 offen offset:2048 sc1
v_mfma_f32_16x16x32_bf16 v[48:51], a[148:151], a[4:7], 0
s_waitcnt lgkmcnt(4)
v_mfma_f32_16x16x32_bf16 v[52:55], a[152:155], a[0:3], 0
ds_read_b128 a[144:147], v208 offset:2048
ds_read_b128 a[148:151], v208 offset:20480
v_mfma_f32_16x16x32_bf16 v[56:59], a[152:155], a[4:7], 0
buffer_load_dwordx4 a[56:59], v1, s[8:11], s62 offen offset:3072 sc1
v_lshl_add_u32 v234, v7, 13, v6
v_mfma_f32_16x16x32_bf16 v[60:63], a[156:159], a[0:3], 0
v_add_u32 v235, 4096, v234
v_mfma_f32_16x16x32_bf16 v[64:67], a[156:159], a[4:7], 0
s_waitcnt vmcnt(11) lgkmcnt(4)
s_barrier
v_mfma_f32_16x16x32_bf16 v[36:39], a[160:163], a[8:11], v[36:39]
ds_read_b128 a[152:155], v209 offset:2048
ds_read_b128 a[156:159], v209 offset:20480
v_mfma_f32_16x16x32_bf16 v[40:43], a[160:163], a[12:15], v[40:43]
buffer_load_dwordx4 a[60:63], v180, s[8:11], s62 offen offset:3072 sc1
s_mul_i32 s30, s24, 9216
v_mfma_f32_16x16x32_bf16 v[44:47], a[164:167], a[8:11], v[44:47]
s_add_u32 s62, s62, 4096
v_mfma_f32_16x16x32_bf16 v[48:51], a[164:167], a[12:15], v[48:51]
s_waitcnt lgkmcnt(4)
s_add_u32 s30, s30, 0
v_mfma_f32_16x16x32_bf16 v[52:55], a[168:171], a[8:11], v[52:55]
ds_read_b128 a[160:163], v208 offset:3072
ds_read_b128 a[164:167], v208 offset:21504
v_mfma_f32_16x16x32_bf16 v[56:59], a[168:171], a[12:15], v[56:59]
buffer_load_dwordx4 a[64:67], v1, s[8:11], s62 offen offset:0 sc1
v_mul_u32_u24 v236, 288, v2
v_mfma_f32_16x16x32_bf16 v[60:63], a[172:175], a[8:11], v[60:63]
v_mfma_f32_16x16x32_bf16 v[64:67], a[172:175], a[12:15], v[64:67]
s_waitcnt lgkmcnt(4)
v_add_u32 v236, s30, v236
s_waitcnt vmcnt(11)
v_mfma_f32_16x16x32_bf16 v[36:39], a[144:147], a[16:19], v[36:39]
ds_read_b128 a[168:171], v209 offset:3072
ds_read_b128 a[172:175], v209 offset:21504
v_mfma_f32_16x16x32_bf16 v[40:43], a[144:147], a[20:23], v[40:43]
buffer_load_dwordx2 v[182:183], v232, s[8:11], s63 offen sc1
v_mfma_f32_16x16x32_bf16 v[44:47], a[148:151], a[16:19], v[44:47]
s_add_u32 s63, s63, 16384
v_lshl_add_u32 v7, v3, 3, v236
v_mfma_f32_16x16x32_bf16 v[48:51], a[148:151], a[20:23], v[48:51]
s_waitcnt lgkmcnt(4)
v_mfma_f32_16x16x32_bf16 v[52:55], a[152:155], a[16:19], v[52:55]
ds_read_b128 a[144:147], v208 offset:4096
ds_read_b128 a[148:151], v208 offset:22528
v_mfma_f32_16x16x32_bf16 v[56:59], a[152:155], a[20:23], v[56:59]
v_lshl_add_u32 v236, v3, 4, v236
v_mfma_f32_16x16x32_bf16 v[60:63], a[156:159], a[16:19], v[60:63]
buffer_load_dwordx2 v[184:185], v232, s[8:11], s63 offen sc1
v_lshrrev_b32 v8, 2, v2
v_mfma_f32_16x16x32_bf16 v[64:67], a[156:159], a[20:23], v[64:67]
s_waitcnt vmcnt(11) lgkmcnt(4)
v_mfma_f32_16x16x32_bf16 v[36:39], a[160:163], a[24:27], v[36:39]
ds_read_b128 a[152:155], v209 offset:4096
ds_read_b128 a[156:159], v209 offset:22528
v_mfma_f32_16x16x32_bf16 v[40:43], a[160:163], a[28:31], v[40:43]
s_add_u32 s63, s63, 16384
v_lshl_add_u32 v8, v3, 3, v8
v_mfma_f32_16x16x32_bf16 v[44:47], a[164:167], a[24:27], v[44:47]
v_mfma_f32_16x16x32_bf16 v[48:51], a[164:167], a[28:31], v[48:51]
s_waitcnt lgkmcnt(4)
v_mul_u32_u24 v237, 288, v8
v_mfma_f32_16x16x32_bf16 v[52:55], a[168:171], a[24:27], v[52:55]
ds_read_b128 a[160:163], v208 offset:5120
ds_read_b128 a[164:167], v208 offset:23552
v_mfma_f32_16x16x32_bf16 v[56:59], a[168:171], a[28:31], v[56:59]
buffer_load_dwordx2 v[186:187], v232, s[8:11], s63 offen sc1
v_add_u32 v237, s30, v237
v_mfma_f32_16x16x32_bf16 v[60:63], a[172:175], a[24:27], v[60:63]
s_add_u32 s63, s63, 16384
v_mfma_f32_16x16x32_bf16 v[64:67], a[172:175], a[28:31], v[64:67]
s_waitcnt vmcnt(10) lgkmcnt(4)
v_mfma_f32_16x16x32_bf16 v[36:39], a[144:147], a[32:35], v[36:39]
ds_read_b128 a[168:171], v209 offset:5120
ds_read_b128 a[172:175], v209 offset:23552
v_mfma_f32_16x16x32_bf16 v[40:43], a[144:147], a[36:39], v[40:43]
buffer_load_dwordx2 v[188:189], v232, s[8:11], s63 offen sc1
v_and_b32 v8, 3, v2
v_mfma_f32_16x16x32_bf16 v[44:47], a[148:151], a[32:35], v[44:47]
s_add_u32 s63, s63, 16384
v_lshl_add_u32 v238, v8, 3, v237
v_mfma_f32_16x16x32_bf16 v[48:51], a[148:151], a[36:39], v[48:51]
s_waitcnt lgkmcnt(4)
v_mfma_f32_16x16x32_bf16 v[52:55], a[152:155], a[32:35], v[52:55]
ds_read_b128 a[144:147], v208 offset:6144
ds_read_b128 a[148:151], v208 offset:24576
v_mfma_f32_16x16x32_bf16 v[56:59], a[152:155], a[36:39], v[56:59]
v_lshl_add_u32 v237, v8, 4, v237
v_mfma_f32_16x16x32_bf16 v[60:63], a[156:159], a[32:35], v[60:63]
buffer_load_dwordx4 a[68:71], v180, s[8:11], s62 offen offset:0 sc1
v_mfma_f32_16x16x32_bf16 v[64:67], a[156:159], a[36:39], v[64:67]
s_waitcnt lgkmcnt(4)
s_mul_i32 s66, s26, 589824
s_waitcnt vmcnt(10)
v_mfma_f32_16x16x32_bf16 v[36:39], a[160:163], a[40:43], v[36:39]
ds_read_b128 a[152:155], v209 offset:6144
ds_read_b128 a[156:159], v209 offset:24576
v_mfma_f32_16x16x32_bf16 v[40:43], a[160:163], a[44:47], v[40:43]
buffer_load_dwordx4 a[72:75], v1, s[8:11], s62 offen offset:1024 sc1
s_mul_i32 s31, s60, 9216
v_mfma_f32_16x16x32_bf16 v[44:47], a[164:167], a[40:43], v[44:47]
s_add_u32 s66, s66, s31
v_mfma_f32_16x16x32_bf16 v[48:51], a[164:167], a[44:47], v[48:51]
s_waitcnt lgkmcnt(4)
v_mfma_f32_16x16x32_bf16 v[52:55], a[168:171], a[40:43], v[52:55]
ds_read_b128 a[160:163], v208 offset:7168
ds_read_b128 a[164:167], v208 offset:25600
v_mfma_f32_16x16x32_bf16 v[56:59], a[168:171], a[44:47], v[56:59]
buffer_load_dwordx4 a[76:79], v180, s[8:11], s62 offen offset:1024 sc1
v_mfma_f32_16x16x32_bf16 v[60:63], a[172:175], a[40:43], v[60:63]
s_add_u32 s66, s66, 7340032
v_mfma_f32_16x16x32_bf16 v[64:67], a[172:175], a[44:47], v[64:67]
s_waitcnt vmcnt(10) lgkmcnt(4)
v_mfma_f32_16x16x32_bf16 v[36:39], a[144:147], a[48:51], v[36:39]
ds_read_b128 a[168:171], v209 offset:7168
ds_read_b128 a[172:175], v209 offset:25600
v_mfma_f32_16x16x32_bf16 v[40:43], a[144:147], a[52:55], v[40:43]
buffer_load_dwordx4 a[80:83], v1, s[8:11], s62 offen offset:2048 sc1
v_lshlrev_b32 v233, 7, v1
v_mfma_f32_16x16x32_bf16 v[44:47], a[148:151], a[48:51], v[44:47]
buffer_load_dwordx4 a[84:87], v180, s[8:11], s62 offen offset:2048 sc1
v_mfma_f32_16x16x32_bf16 v[48:51], a[148:151], a[52:55], v[48:51]
s_waitcnt lgkmcnt(4)
s_lshl_b32 s31, s26, 7
v_mfma_f32_16x16x32_bf16 v[52:55], a[152:155], a[48:51], v[52:55]
ds_read_b128 a[144:147], v208 offset:8192
ds_read_b128 a[148:151], v208 offset:26624
v_mfma_f32_16x16x32_bf16 v[56:59], a[152:155], a[52:55], v[56:59]
buffer_load_dwordx4 a[88:91], v1, s[8:11], s62 offen offset:3072 sc1
v_add_u32 v233, s31, v233
v_mfma_f32_16x16x32_bf16 v[60:63], a[156:159], a[48:51], v[60:63]
s_lshl_b32 s61, s25, 14
v_mfma_f32_16x16x32_bf16 v[64:67], a[156:159], a[52:55], v[64:67]
s_waitcnt vmcnt(11) lgkmcnt(4)
v_mfma_f32_16x16x32_bf16 v[36:39], a[160:163], a[56:59], v[36:39]
ds_read_b128 a[152:155], v209 offset:8192
ds_read_b128 a[156:159], v209 offset:26624
v_mfma_f32_16x16x32_bf16 v[40:43], a[160:163], a[60:63], v[40:43]
buffer_load_dwordx4 a[92:95], v180, s[8:11], s62 offen offset:3072 sc1
v_mfma_f32_16x16x32_bf16 v[44:47], a[164:167], a[56:59], v[44:47]
s_add_u32 s62, s62, 4096
s_lshl_b32 s30, s24, 8
v_mfma_f32_16x16x32_bf16 v[48:51], a[164:167], a[60:63], v[48:51]
s_waitcnt lgkmcnt(4)
v_mfma_f32_16x16x32_bf16 v[52:55], a[168:171], a[56:59], v[52:55]
ds_read_b128 a[160:163], v208 offset:9216
ds_read_b128 a[164:167], v208 offset:27648
v_mfma_f32_16x16x32_bf16 v[56:59], a[168:171], a[60:63], v[56:59]
buffer_load_dwordx4 a[96:99], v1, s[8:11], s62 offen offset:0 sc1
s_add_u32 s61, s61, s30
v_mfma_f32_16x16x32_bf16 v[60:63], a[172:175], a[56:59], v[60:63]
s_add_u32 s61, s61, 26214400
v_mfma_f32_16x16x32_bf16 v[64:67], a[172:175], a[60:63], v[64:67]
s_waitcnt vmcnt(7) lgkmcnt(4)
v_mfma_f32_16x16x32_bf16 v[36:39], a[144:147], a[64:67], v[36:39]
ds_read_b128 a[168:171], v209 offset:9216
ds_read_b128 a[172:175], v209 offset:27648
v_mfma_f32_16x16x32_bf16 v[40:43], a[144:147], a[68:71], v[40:43]
buffer_load_dwordx4 a[100:103], v180, s[8:11], s62 offen offset:0 sc1
s_mul_i32 s30, s24, 9216
v_mfma_f32_16x16x32_bf16 v[44:47], a[148:151], a[64:67], v[44:47]
buffer_load_dwordx4 a[104:107], v1, s[8:11], s62 offen offset:1024 sc1
v_mfma_f32_16x16x32_bf16 v[48:51], a[148:151], a[68:71], v[48:51]
s_waitcnt lgkmcnt(4)
s_add_u32 s30, s30, 0
v_mfma_f32_16x16x32_bf16 v[52:55], a[152:155], a[64:67], v[52:55]
ds_read_b128 a[144:147], v208 offset:10240
ds_read_b128 a[148:151], v208 offset:28672
v_mfma_f32_16x16x32_bf16 v[56:59], a[152:155], a[68:71], v[56:59]
buffer_load_dwordx4 a[108:111], v180, s[8:11], s62 offen offset:1024 sc1
v_add_u32 v240, s30, v1
v_mfma_f32_16x16x32_bf16 v[60:63], a[156:159], a[64:67], v[60:63]
s_lshl_b32 s30, s26, 10
v_mfma_f32_16x16x32_bf16 v[64:67], a[156:159], a[68:71], v[64:67]
s_waitcnt vmcnt(8) lgkmcnt(4)
v_mfma_f32_16x16x32_bf16 v[36:39], a[160:163], a[72:75], v[36:39]
ds_read_b128 a[152:155], v209 offset:10240
ds_read_b128 a[156:159], v209 offset:28672
v_mfma_f32_16x16x32_bf16 v[40:43], a[160:163], a[76:79], v[40:43]
buffer_load_dwordx4 a[112:115], v1, s[8:11], s62 offen offset:2048 sc1
v_mfma_f32_16x16x32_bf16 v[44:47], a[164:167], a[72:75], v[44:47]
buffer_load_dwordx4 a[116:119], v180, s[8:11], s62 offen offset:2048 sc1
s_add_u32 s30, s30, s61
v_mfma_f32_16x16x32_bf16 v[48:51], a[164:167], a[76:79], v[48:51]
s_waitcnt lgkmcnt(4)
v_mfma_f32_16x16x32_bf16 v[52:55], a[168:171], a[72:75], v[52:55]
ds_read_b128 a[160:163], v208 offset:11264
ds_read_b128 a[164:167], v208 offset:29696
v_mfma_f32_16x16x32_bf16 v[56:59], a[168:171], a[76:79], v[56:59]
buffer_load_dwordx4 a[120:123], v1, s[8:11], s62 offen offset:3072 sc1
v_mfma_f32_16x16x32_bf16 v[60:63], a[172:175], a[72:75], v[60:63]
v_mfma_f32_16x16x32_bf16 v[64:67], a[172:175], a[76:79], v[64:67]
s_waitcnt vmcnt(9) lgkmcnt(4)
v_mfma_f32_16x16x32_bf16 v[36:39], a[144:147], a[80:83], v[36:39]
ds_read_b128 a[168:171], v209 offset:11264
ds_read_b128 a[172:175], v209 offset:29696
v_mfma_f32_16x16x32_bf16 v[40:43], a[144:147], a[84:87], v[40:43]
buffer_load_dwordx4 a[124:127], v180, s[8:11], s62 offen offset:3072 sc1
v_mfma_f32_16x16x32_bf16 v[44:47], a[148:151], a[80:83], v[44:47]
s_add_u32 s62, s62, 4096
v_add_f32 v198, v182, v184
v_add_f32 v199, v183, v185
v_mfma_f32_16x16x32_bf16 v[48:51], a[148:151], a[84:87], v[48:51]
s_waitcnt lgkmcnt(4)
v_add_f32 v198, v198, v186
v_mfma_f32_16x16x32_bf16 v[52:55], a[152:155], a[80:83], v[52:55]
ds_read_b128 a[144:147], v208 offset:12288
ds_read_b128 a[148:151], v208 offset:30720
v_mfma_f32_16x16x32_bf16 v[56:59], a[152:155], a[84:87], v[56:59]
buffer_load_dwordx4 a[128:131], v1, s[8:11], s62 offen offset:0 sc1
v_add_f32 v199, v199, v187
v_mfma_f32_16x16x32_bf16 v[60:63], a[156:159], a[80:83], v[60:63]
v_add_f32 v198, v198, v188
v_mfma_f32_16x16x32_bf16 v[64:67], a[156:159], a[84:87], v[64:67]
s_waitcnt lgkmcnt(4)
v_add_f32 v199, v199, v189
s_waitcnt vmcnt(9)
v_mfma_f32_16x16x32_bf16 v[36:39], a[160:163], a[88:91], v[36:39]
ds_read_b128 a[152:155], v209 offset:12288
ds_read_b128 a[156:159], v209 offset:30720
v_mfma_f32_16x16x32_bf16 v[40:43], a[160:163], a[92:95], v[40:43]
buffer_load_dwordx4 a[132:135], v180, s[8:11], s62 offen offset:0 sc1
v_mov_b32 v200, v198
v_mfma_f32_16x16x32_bf16 v[44:47], a[164:167], a[88:91], v[44:47]
v_mov_b32 v201, v199
v_mfma_f32_16x16x32_bf16 v[48:51], a[164:167], a[92:95], v[48:51]
s_waitcnt lgkmcnt(4)
s_nop 0
v_mfma_f32_16x16x32_bf16 v[52:55], a[168:171], a[88:91], v[52:55]
ds_read_b128 a[160:163], v208 offset:13312
ds_read_b128 a[164:167], v208 offset:31744
v_mfma_f32_16x16x32_bf16 v[56:59], a[168:171], a[92:95], v[56:59]
buffer_load_dwordx4 a[136:139], v1, s[8:11], s62 offen offset:1024 sc1
v_mfma_f32_16x16x32_bf16 v[60:63], a[172:175], a[88:91], v[60:63]
buffer_load_dwordx4 a[140:143], v180, s[8:11], s62 offen offset:1024 sc1
v_mfma_f32_16x16x32_bf16 v[64:67], a[172:175], a[92:95], v[64:67]
s_waitcnt vmcnt(10) lgkmcnt(4)
v_mfma_f32_16x16x32_bf16 v[36:39], a[144:147], a[96:99], v[36:39]
ds_read_b128 a[168:171], v209 offset:13312
ds_read_b128 a[172:175], v209 offset:31744
v_mfma_f32_16x16x32_bf16 v[40:43], a[144:147], a[100:103], v[40:43]
v_permlane32_swap_b32 v198, v200
v_mfma_f32_16x16x32_bf16 v[44:47], a[148:151], a[96:99], v[44:47]
v_permlane32_swap_b32 v199, v201
v_mfma_f32_16x16x32_bf16 v[48:51], a[148:151], a[100:103], v[48:51]
s_waitcnt lgkmcnt(4)
v_add_f32 v198, v198, v200
v_add_f32 v199, v199, v201
v_mfma_f32_16x16x32_bf16 v[52:55], a[152:155], a[96:99], v[52:55]
ds_read_b128 a[144:147], v208 offset:14336
ds_read_b128 a[148:151], v208 offset:32768
v_mfma_f32_16x16x32_bf16 v[56:59], a[152:155], a[100:103], v[56:59]
v_mul_f32 v198, 0x3ae38e39, v198
v_mul_f32 v200, v198, v198
v_mfma_f32_16x16x32_bf16 v[60:63], a[156:159], a[96:99], v[60:63]
v_mul_f32 v199, 0x3ae38e39, v199
v_mfma_f32_16x16x32_bf16 v[64:67], a[156:159], a[100:103], v[64:67]
s_waitcnt vmcnt(8) lgkmcnt(4)
v_mfma_f32_16x16x32_bf16 v[36:39], a[160:163], a[104:107], v[36:39]
ds_read_b128 a[152:155], v209 offset:14336
ds_read_b128 a[156:159], v209 offset:32768
v_mfma_f32_16x16x32_bf16 v[40:43], a[160:163], a[108:111], v[40:43]
v_sub_f32 v199, v199, v200
v_max_f32 v199, 0, v199
v_mfma_f32_16x16x32_bf16 v[44:47], a[164:167], a[104:107], v[44:47]
v_add_f32 v199, 0x3727c5ac, v199
v_mfma_f32_16x16x32_bf16 v[48:51], a[164:167], a[108:111], v[48:51]
s_waitcnt lgkmcnt(4)
v_rsq_f32 v250, v199
v_mfma_f32_16x16x32_bf16 v[52:55], a[168:171], a[104:107], v[52:55]
ds_read_b128 a[160:163], v208 offset:15360
ds_read_b128 a[164:167], v208 offset:33792
v_mfma_f32_16x16x32_bf16 v[56:59], a[168:171], a[108:111], v[56:59]
v_mfma_f32_16x16x32_bf16 v[60:63], a[172:175], a[104:107], v[60:63]
v_sqrt_f32 v254, v199
v_mfma_f32_16x16x32_bf16 v[64:67], a[172:175], a[108:111], v[64:67]
s_waitcnt vmcnt(6) lgkmcnt(4)
v_mfma_f32_16x16x32_bf16 v[36:39], a[144:147], a[112:115], v[36:39]
ds_read_b128 a[168:171], v209 offset:15360
ds_read_b128 a[172:175], v209 offset:33792
v_mfma_f32_16x16x32_bf16 v[40:43], a[144:147], a[116:119], v[40:43]
v_cvt_pk_bf16_f32 v200, -v198, -v198
v_mfma_f32_16x16x32_bf16 v[44:47], a[148:151], a[112:115], v[44:47]
v_and_b32 v200, 0xffff0000, v200
v_mfma_f32_16x16x32_bf16 v[48:51], a[148:151], a[116:119], v[48:51]
s_waitcnt lgkmcnt(4)
v_add_f32 v200, v198, v200
v_mfma_f32_16x16x32_bf16 v[52:55], a[152:155], a[112:115], v[52:55]
ds_read_b128 a[144:147], v208 offset:16384
ds_read_b128 a[148:151], v208 offset:34816
v_mfma_f32_16x16x32_bf16 v[56:59], a[152:155], a[116:119], v[56:59]
v_cvt_pk_bf16_f32 v212, -v198, -v200
v_mfma_f32_16x16x32_bf16 v[60:63], a[156:159], a[112:115], v[60:63]
v_mul_f32 v252, v250, v250
v_mfma_f32_16x16x32_bf16 v[64:67], a[156:159], a[116:119], v[64:67]
s_waitcnt lgkmcnt(4)
v_mul_f32 v252, v252, v250
s_waitcnt vmcnt(4)
v_mfma_f32_16x16x32_bf16 v[36:39], a[160:163], a[120:123], v[36:39]
ds_read_b128 a[152:155], v209 offset:16384
ds_read_b128 a[156:159], v209 offset:34816
v_mfma_f32_16x16x32_bf16 v[40:43], a[160:163], a[124:127], v[40:43]
v_mul_f32 v252, 0xbdd2d3e8, v252
v_mul_f32 v250, 0xc0135761, v250
v_mfma_f32_16x16x32_bf16 v[44:47], a[164:167], a[120:123], v[44:47]
s_mov_b32 s37, L_c4-12288-L_pc
v_mfma_f32_16x16x32_bf16 v[48:51], a[164:167], a[124:127], v[48:51]
s_waitcnt lgkmcnt(4)
v_mov_b32 v214, v212
v_mfma_f32_16x16x32_bf16 v[52:55], a[168:171], a[120:123], v[52:55]
ds_read_b128 a[160:163], v208 offset:17408
ds_read_b128 a[164:167], v208 offset:35840
v_mfma_f32_16x16x32_bf16 v[56:59], a[168:171], a[124:127], v[56:59]
v_mov_b32 v255, v254
v_mov_b32 v253, v252
v_mfma_f32_16x16x32_bf16 v[60:63], a[172:175], a[120:123], v[60:63]
buffer_load_dword v15, v14, s[88:91], s37 offen
v_mfma_f32_16x16x32_bf16 v[64:67], a[172:175], a[124:127], v[64:67]
s_waitcnt lgkmcnt(4)
v_mov_b32 v251, v250
s_waitcnt vmcnt(3)
v_mfma_f32_16x16x32_bf16 v[36:39], a[144:147], a[128:131], v[36:39]
ds_read_b128 a[168:171], v209 offset:17408
ds_read_b128 a[172:175], v209 offset:35840
v_mfma_f32_16x16x32_bf16 v[40:43], a[144:147], a[132:135], v[40:43]
v_permlane16_swap_b32 v212, v214
v_mfma_f32_16x16x32_bf16 v[44:47], a[148:151], a[128:131], v[44:47]
v_permlane16_swap_b32 v254, v255
v_mfma_f32_16x16x32_bf16 v[48:51], a[148:151], a[132:135], v[48:51]
s_waitcnt lgkmcnt(4)
v_add_u32 v181, 160768, v239
v_mfma_f32_16x16x32_bf16 v[52:55], a[152:155], a[128:131], v[52:55]
ds_read_b64 a[144:145], v181 offset:0
ds_read_b64 a[148:149], v181 offset:512
v_mfma_f32_16x16x32_bf16 v[56:59], a[152:155], a[132:135], v[56:59]
v_permlane16_swap_b32 v252, v253
v_mfma_f32_16x16x32_bf16 v[60:63], a[156:159], a[128:131], v[60:63]
v_mfma_f32_16x16x32_bf16 v[64:67], a[156:159], a[132:135], v[64:67]
s_waitcnt vmcnt(1) lgkmcnt(4)
v_add_u32 v181, 36864, v239
v_mfma_f32_16x16x32_bf16 v[36:39], a[160:163], a[136:139], v[36:39]
ds_read_b64 a[152:153], v181 offset:0
ds_read_b64 a[156:157], v181 offset:512
v_mfma_f32_16x16x32_bf16 v[40:43], a[160:163], a[140:143], v[40:43]
v_permlane16_swap_b32 v250, v251
v_mfma_f32_16x16x32_bf16 v[44:47], a[164:167], a[136:139], v[44:47]
v_mov_b32 v213, v212
v_mfma_f32_16x16x32_bf16 v[48:51], a[164:167], a[140:143], v[48:51]
s_waitcnt lgkmcnt(4)
v_mov_b32 v215, v214
v_mfma_f32_16x16x32_bf16 v[52:55], a[168:171], a[136:139], v[52:55]
ds_read_b128 a[160:163], v210 offset:0
ds_read_b128 a[164:167], v210 offset:18432
v_mfma_f32_16x16x32_bf16 v[56:59], a[168:171], a[140:143], v[56:59]
v_mfma_f32_16x16x32_bf16 v[60:63], a[172:175], a[136:139], v[60:63]
v_mfma_f32_16x16x32_bf16 v[64:67], a[172:175], a[140:143], v[64:67]
s_waitcnt lgkmcnt(4)
v_mfma_f32_16x16x16_bf16 v[36:39], a[144:145], v[212:213], v[36:39]
ds_read_b128 a[168:171], v210 offset:1024
ds_read_b128 a[172:175], v210 offset:19456
v_mfma_f32_16x16x16_bf16 v[40:43], a[144:145], v[214:215], v[40:43]
v_mfma_f32_16x16x16_bf16 v[44:47], a[148:149], v[212:213], v[44:47]
v_mfma_f32_16x16x16_bf16 v[48:51], a[148:149], v[214:215], v[48:51]
s_waitcnt lgkmcnt(4)
v_mfma_f32_16x16x16_bf16 v[52:55], a[152:153], v[212:213], v[52:55]
ds_read_b128 a[144:147], v210 offset:2048
ds_read_b128 a[148:151], v210 offset:20480
v_mfma_f32_16x16x16_bf16 v[56:59], a[152:153], v[214:215], v[56:59]
v_mfma_f32_16x16x16_bf16 v[60:63], a[156:157], v[212:213], v[60:63]
v_mfma_f32_16x16x16_bf16 v[64:67], a[156:157], v[214:215], v[64:67]
s_waitcnt lgkmcnt(4)
s_barrier
v_mfma_f32_16x16x32_bf16 v[68:71], a[160:163], a[0:3], 0
ds_read_b128 a[152:155], v210 offset:3072
ds_read_b128 a[156:159], v210 offset:21504
v_mfma_f32_16x16x32_bf16 v[72:75], a[160:163], a[4:7], 0
s_mul_i32 s38, s24, 9216
s_add_u32 m0, s38, 123904
v_mfma_f32_16x16x32_bf16 v[76:79], a[164:167], a[0:3], 0
s_add_u32 s39, s38, s82
v_mfma_f32_16x16x32_bf16 v[80:83], a[164:167], a[4:7], 0
s_waitcnt lgkmcnt(4)
v_mfma_f32_16x16x32_bf16 v[68:71], a[168:171], a[8:11], v[68:71]
ds_read_b128 a[160:163], v210 offset:4096
ds_read_b128 a[164:167], v210 offset:22528
v_mfma_f32_16x16x32_bf16 v[72:75], a[168:171], a[12:15], v[72:75]
s_add_u32 s39, s39, 151552
v_mfma_f32_16x16x32_bf16 v[76:79], a[172:175], a[8:11], v[76:79]
buffer_load_dwordx4 v1, s[4:7], s39 offen offset:0 sc1 lds
buffer_load_dwordx4 v1, s[4:7], s39 offen offset:1024 sc1 lds
v_pk_mul_f32 v[216:217], v[36:37], v[36:37]
v_pk_mul_f32 v[218:219], v[38:39], v[38:39]
v_pk_mul_f32 v[220:221], v[40:41], v[40:41]
v_pk_mul_f32 v[222:223], v[42:43], v[42:43]
v_pk_fma_f32 v[216:217], v[216:217], v[252:253], v[250:251] op_sel:[0,0,0] op_sel_hi:[1,0,0]
v_pk_fma_f32 v[218:219], v[218:219], v[252:253], v[250:251] op_sel:[0,0,0] op_sel_hi:[1,0,0]
v_pk_fma_f32 v[220:221], v[220:221], v[252:253], v[250:251] op_sel:[0,1,1] op_sel_hi:[1,1,1]
v_pk_fma_f32 v[222:223], v[222:223], v[252:253], v[250:251] op_sel:[0,1,1] op_sel_hi:[1,1,1]
v_pk_mul_f32 v[216:217], v[216:217], v[36:37]
v_pk_mul_f32 v[218:219], v[218:219], v[38:39]
v_pk_mul_f32 v[220:221], v[220:221], v[40:41]
v_pk_mul_f32 v[222:223], v[222:223], v[42:43]
v_mfma_f32_16x16x32_bf16 v[80:83], a[172:175], a[12:15], v[80:83]
s_waitcnt lgkmcnt(4)
v_exp_f32 v216, v216
v_mfma_f32_16x16x32_bf16 v[68:71], a[144:147], a[16:19], v[68:71]
ds_read_b128 a[168:171], v210 offset:5120
ds_read_b128 a[172:175], v210 offset:23552
v_mfma_f32_16x16x32_bf16 v[72:75], a[144:147], a[20:23], v[72:75]
v_exp_f32 v217, v217
v_mfma_f32_16x16x32_bf16 v[76:79], a[148:151], a[16:19], v[76:79]
buffer_load_dwordx4 v1, s[4:7], s39 offen offset:2048 sc1 lds
buffer_load_dwordx4 v1, s[4:7], s39 offen offset:3072 sc1 lds
v_mfma_f32_16x16x32_bf16 v[80:83], a[148:151], a[20:23], v[80:83]
s_waitcnt lgkmcnt(4)
v_exp_f32 v218, v218
v_mfma_f32_16x16x32_bf16 v[68:71], a[152:155], a[24:27], v[68:71]
ds_read_b128 a[144:147], v210 offset:6144
ds_read_b128 a[148:151], v210 offset:24576
v_mfma_f32_16x16x32_bf16 v[72:75], a[152:155], a[28:31], v[72:75]
s_add_u32 m0, m0, 4096
v_fma_f32 v216, v216, v254, v254
v_fma_f32 v217, v217, v254, v254
v_mfma_f32_16x16x32_bf16 v[76:79], a[156:159], a[24:27], v[76:79]
s_add_u32 s39, s39, 4096
v_exp_f32 v219, v219
v_mfma_f32_16x16x32_bf16 v[80:83], a[156:159], a[28:31], v[80:83]
s_waitcnt lgkmcnt(4)
v_exp_f32 v220, v220
v_mfma_f32_16x16x32_bf16 v[68:71], a[160:163], a[32:35], v[68:71]
ds_read_b128 a[152:155], v210 offset:7168
ds_read_b128 a[156:159], v210 offset:25600
v_mfma_f32_16x16x32_bf16 v[72:75], a[160:163], a[36:39], v[72:75]
buffer_load_dwordx4 v1, s[4:7], s39 offen offset:0 sc1 lds
buffer_load_dwordx4 v1, s[4:7], s39 offen offset:1024 sc1 lds
v_mfma_f32_16x16x32_bf16 v[76:79], a[164:167], a[32:35], v[76:79]
v_fma_f32 v218, v218, v254, v254
v_fma_f32 v219, v219, v254, v254
v_mfma_f32_16x16x32_bf16 v[80:83], a[164:167], a[36:39], v[80:83]
s_waitcnt lgkmcnt(4)
v_exp_f32 v221, v221
v_mfma_f32_16x16x32_bf16 v[68:71], a[168:171], a[40:43], v[68:71]
ds_read_b128 a[160:163], v210 offset:8192
ds_read_b128 a[164:167], v210 offset:26624
v_exp_f32 v222, v222
v_mfma_f32_16x16x32_bf16 v[72:75], a[168:171], a[44:47], v[72:75]
buffer_load_dwordx4 v1, s[4:7], s39 offen offset:2048 sc1 lds
buffer_load_dwordx4 v1, s[4:7], s39 offen offset:3072 sc1 lds
v_mfma_f32_16x16x32_bf16 v[76:79], a[172:175], a[40:43], v[76:79]
s_add_u32 m0, m0, 4096
v_fma_f32 v220, v220, v255, v255
v_fma_f32 v221, v221, v255, v255
v_mfma_f32_16x16x32_bf16 v[80:83], a[172:175], a[44:47], v[80:83]
s_waitcnt lgkmcnt(4)
v_exp_f32 v223, v223
v_mfma_f32_16x16x32_bf16 v[68:71], a[144:147], a[48:51], v[68:71]
ds_read_b128 a[168:171], v210 offset:9216
ds_read_b128 a[172:175], v210 offset:27648
v_rcp_f32 v216, v216
v_mfma_f32_16x16x32_bf16 v[72:75], a[144:147], a[52:55], v[72:75]
s_add_u32 s39, s39, 4096
v_fma_f32 v222, v222, v255, v255
v_fma_f32 v223, v223, v255, v255
v_mfma_f32_16x16x32_bf16 v[76:79], a[148:151], a[48:51], v[76:79]
buffer_load_dwordx4 v1, s[4:7], s39 offen offset:0 sc1 lds
v_mfma_f32_16x16x32_bf16 v[80:83], a[148:151], a[52:55], v[80:83]
s_waitcnt lgkmcnt(4)
v_rcp_f32 v217, v217
v_mfma_f32_16x16x32_bf16 v[68:71], a[152:155], a[56:59], v[68:71]
ds_read_b128 a[144:147], v210 offset:10240
ds_read_b128 a[148:151], v210 offset:28672
v_rcp_f32 v218, v218
v_mfma_f32_16x16x32_bf16 v[72:75], a[152:155], a[60:63], v[72:75]
s_lshl_b32 s38, s24, 8
v_rcp_f32 v219, v219
v_mfma_f32_16x16x32_bf16 v[76:79], a[156:159], a[56:59], v[76:79]
buffer_store_dwordx4 a[224:227], v1, s[4:7], s101 offen offset:0 sc1
s_add_u32 m0, s38, 160768
v_mfma_f32_16x16x32_bf16 v[80:83], a[156:159], a[60:63], v[80:83]
s_waitcnt lgkmcnt(4)
s_add_u32 s39, s38, s82
v_rcp_f32 v220, v220
v_mfma_f32_16x16x32_bf16 v[68:71], a[160:163], a[64:67], v[68:71]
ds_read_b128 a[152:155], v210 offset:11264
ds_read_b128 a[156:159], v210 offset:29696
v_mfma_f32_16x16x32_bf16 v[72:75], a[160:163], a[68:71], v[72:75]
s_add_u32 s39, s39, 188416
v_rcp_f32 v221, v221
v_mfma_f32_16x16x32_bf16 v[76:79], a[164:167], a[64:67], v[76:79]
v_rcp_f32 v222, v222
v_mfma_f32_16x16x32_bf16 v[80:83], a[164:167], a[68:71], v[80:83]
s_waitcnt lgkmcnt(4)
v_rcp_f32 v223, v223
v_mfma_f32_16x16x32_bf16 v[68:71], a[168:171], a[72:75], v[68:71]
ds_read_b128 a[160:163], v210 offset:12288
ds_read_b128 a[164:167], v210 offset:30720
v_pk_mul_f32 v[224:225], v[44:45], v[44:45]
v_pk_mul_f32 v[226:227], v[46:47], v[46:47]
v_pk_mul_f32 v[228:229], v[48:49], v[48:49]
v_pk_mul_f32 v[230:231], v[50:51], v[50:51]
v_pk_fma_f32 v[224:225], v[224:225], v[252:253], v[250:251] op_sel:[0,0,0] op_sel_hi:[1,0,0]
v_pk_fma_f32 v[226:227], v[226:227], v[252:253], v[250:251] op_sel:[0,0,0] op_sel_hi:[1,0,0]
v_pk_fma_f32 v[228:229], v[228:229], v[252:253], v[250:251] op_sel:[0,1,1] op_sel_hi:[1,1,1]
v_pk_fma_f32 v[230:231], v[230:231], v[252:253], v[250:251] op_sel:[0,1,1] op_sel_hi:[1,1,1]
v_pk_mul_f32 v[36:37], v[36:37], v[216:217]
v_pk_mul_f32 v[38:39], v[38:39], v[218:219]
v_pk_mul_f32 v[40:41], v[40:41], v[220:221]
v_pk_mul_f32 v[42:43], v[42:43], v[222:223]
v_pk_mul_f32 v[224:225], v[224:225], v[44:45]
v_pk_mul_f32 v[226:227], v[226:227], v[46:47]
v_pk_mul_f32 v[228:229], v[228:229], v[48:49]
v_pk_mul_f32 v[230:231], v[230:231], v[50:51]
v_mfma_f32_16x16x32_bf16 v[72:75], a[168:171], a[76:79], v[72:75]
s_mov_b64 exec, 0xffff
buffer_load_dwordx4 v1, s[4:7], s39 offen sc1 lds
s_mov_b64 exec, -1
v_exp_f32 v224, v224
v_mfma_f32_16x16x32_bf16 v[76:79], a[172:175], a[72:75], v[76:79]
v_exp_f32 v225, v225
v_mfma_f32_16x16x32_bf16 v[80:83], a[172:175], a[76:79], v[80:83]
s_waitcnt lgkmcnt(4)
v_exp_f32 v226, v226
v_mfma_f32_16x16x32_bf16 v[68:71], a[144:147], a[80:83], v[68:71]
ds_read_b128 a[168:171], v210 offset:13312
ds_read_b128 a[172:175], v210 offset:31744
v_mfma_f32_16x16x32_bf16 v[72:75], a[144:147], a[84:87], v[72:75]
s_mul_i32 s38, s24, 9216
v_fma_f32 v224, v224, v254, v254
v_fma_f32 v225, v225, v254, v254
v_mfma_f32_16x16x32_bf16 v[76:79], a[148:151], a[80:83], v[76:79]
s_add_u32 m0, s38, 0
v_exp_f32 v227, v227
v_mfma_f32_16x16x32_bf16 v[80:83], a[148:151], a[84:87], v[80:83]
s_waitcnt lgkmcnt(4)
v_exp_f32 v228, v228
v_mfma_f32_16x16x32_bf16 v[68:71], a[152:155], a[88:91], v[68:71]
ds_read_b128 a[144:147], v210 offset:14336
ds_read_b128 a[148:151], v210 offset:32768
v_mfma_f32_16x16x32_bf16 v[72:75], a[152:155], a[92:95], v[72:75]
s_add_u32 s39, s38, s82
v_fma_f32 v226, v226, v254, v254
v_fma_f32 v227, v227, v254, v254
v_mfma_f32_16x16x32_bf16 v[76:79], a[156:159], a[88:91], v[76:79]
s_add_u32 s39, s39, 189440
v_exp_f32 v229, v229
v_mfma_f32_16x16x32_bf16 v[80:83], a[156:159], a[92:95], v[80:83]
s_waitcnt lgkmcnt(4)
v_exp_f32 v230, v230
v_mfma_f32_16x16x32_bf16 v[68:71], a[160:163], a[96:99], v[68:71]
ds_read_b128 a[152:155], v210 offset:15360
ds_read_b128 a[156:159], v210 offset:33792
v_mfma_f32_16x16x32_bf16 v[72:75], a[160:163], a[100:103], v[72:75]
buffer_store_dwordx4 a[228:231], v1, s[4:7], s101 offen offset:1024 sc1
v_fma_f32 v228, v228, v255, v255
v_fma_f32 v229, v229, v255, v255
v_mfma_f32_16x16x32_bf16 v[76:79], a[164:167], a[96:99], v[76:79]
buffer_load_dwordx4 v1, s[4:7], s39 offen offset:0 sc1 lds
buffer_load_dwordx4 v1, s[4:7], s39 offen offset:1024 sc1 lds
v_exp_f32 v231, v231
v_mfma_f32_16x16x32_bf16 v[80:83], a[164:167], a[100:103], v[80:83]
s_waitcnt lgkmcnt(4)
v_rcp_f32 v224, v224
v_mfma_f32_16x16x32_bf16 v[68:71], a[168:171], a[104:107], v[68:71]
ds_read_b128 a[160:163], v210 offset:16384
ds_read_b128 a[164:167], v210 offset:34816
v_mfma_f32_16x16x32_bf16 v[72:75], a[168:171], a[108:111], v[72:75]
v_fma_f32 v230, v230, v255, v255
v_fma_f32 v231, v231, v255, v255
v_mfma_f32_16x16x32_bf16 v[76:79], a[172:175], a[104:107], v[76:79]
v_rcp_f32 v225, v225
v_mfma_f32_16x16x32_bf16 v[80:83], a[172:175], a[108:111], v[80:83]
s_waitcnt lgkmcnt(4)
v_rcp_f32 v226, v226
v_mfma_f32_16x16x32_bf16 v[68:71], a[144:147], a[112:115], v[68:71]
ds_read_b128 a[168:171], v210 offset:17408
ds_read_b128 a[172:175], v210 offset:35840
v_mfma_f32_16x16x32_bf16 v[72:75], a[144:147], a[116:119], v[72:75]
buffer_load_dwordx4 v1, s[4:7], s39 offen offset:2048 sc1 lds
buffer_load_dwordx4 v1, s[4:7], s39 offen offset:3072 sc1 lds
v_rcp_f32 v227, v227
v_mfma_f32_16x16x32_bf16 v[76:79], a[148:151], a[112:115], v[76:79]
s_add_u32 m0, m0, 4096
v_rcp_f32 v228, v228
v_mfma_f32_16x16x32_bf16 v[80:83], a[148:151], a[116:119], v[80:83]
s_waitcnt lgkmcnt(4)
v_add_u32 v181, 74752, v239
v_mfma_f32_16x16x32_bf16 v[68:71], a[152:155], a[120:123], v[68:71]
ds_read_b64 a[144:145], v181 offset:0
ds_read_b64 a[148:149], v181 offset:512
v_rcp_f32 v229, v229
v_mfma_f32_16x16x32_bf16 v[72:75], a[152:155], a[124:127], v[72:75]
s_add_u32 s39, s39, 4096
v_rcp_f32 v230, v230
v_mfma_f32_16x16x32_bf16 v[76:79], a[156:159], a[120:123], v[76:79]
v_rcp_f32 v231, v231
v_mfma_f32_16x16x32_bf16 v[80:83], a[156:159], a[124:127], v[80:83]
s_waitcnt lgkmcnt(4)
v_pk_mul_f32 v[216:217], v[52:53], v[52:53]
v_pk_mul_f32 v[218:219], v[54:55], v[54:55]
v_pk_mul_f32 v[220:221], v[56:57], v[56:57]
v_pk_mul_f32 v[222:223], v[58:59], v[58:59]
v_pk_fma_f32 v[216:217], v[216:217], v[252:253], v[250:251] op_sel:[0,0,0] op_sel_hi:[1,0,0]
v_pk_fma_f32 v[218:219], v[218:219], v[252:253], v[250:251] op_sel:[0,0,0] op_sel_hi:[1,0,0]
v_pk_fma_f32 v[220:221], v[220:221], v[252:253], v[250:251] op_sel:[0,1,1] op_sel_hi:[1,1,1]
v_pk_fma_f32 v[222:223], v[222:223], v[252:253], v[250:251] op_sel:[0,1,1] op_sel_hi:[1,1,1]
v_pk_mul_f32 v[44:45], v[44:45], v[224:225]
v_pk_mul_f32 v[46:47], v[46:47], v[226:227]
v_pk_mul_f32 v[48:49], v[48:49], v[228:229]
v_pk_mul_f32 v[50:51], v[50:51], v[230:231]
v_pk_mul_f32 v[216:217], v[216:217], v[52:53]
v_pk_mul_f32 v[218:219], v[218:219], v[54:55]
v_pk_mul_f32 v[220:221], v[220:221], v[56:57]
v_pk_mul_f32 v[222:223], v[222:223], v[58:59]
v_mfma_f32_16x16x32_bf16 v[68:71], a[160:163], a[128:131], v[68:71]
ds_read_b128 a[152:155], v211 offset:0
ds_read_b128 a[156:159], v211 offset:18432
v_exp_f32 v216, v216
v_mfma_f32_16x16x32_bf16 v[72:75], a[160:163], a[132:135], v[72:75]
buffer_load_dwordx4 v1, s[4:7], s39 offen offset:0 sc1 lds
buffer_load_dwordx4 v1, s[4:7], s39 offen offset:1024 sc1 lds
v_exp_f32 v217, v217
v_mfma_f32_16x16x32_bf16 v[76:79], a[164:167], a[128:131], v[76:79]
buffer_store_dwordx4 a[232:235], v1, s[4:7], s101 offen offset:2048 sc1
v_exp_f32 v218, v218
v_mfma_f32_16x16x32_bf16 v[80:83], a[164:167], a[132:135], v[80:83]
s_waitcnt lgkmcnt(4)
v_fma_f32 v216, v216, v254, v254
v_fma_f32 v217, v217, v254, v254
v_mfma_f32_16x16x32_bf16 v[68:71], a[168:171], a[136:139], v[68:71]
ds_read_b128 a[160:163], v211 offset:1024
ds_read_b128 a[164:167], v211 offset:19456
v_mfma_f32_16x16x32_bf16 v[72:75], a[168:171], a[140:143], v[72:75]
v_exp_f32 v219, v219
v_mfma_f32_16x16x32_bf16 v[76:79], a[172:175], a[136:139], v[76:79]
v_exp_f32 v220, v220
v_mfma_f32_16x16x32_bf16 v[80:83], a[172:175], a[140:143], v[80:83]
s_waitcnt lgkmcnt(4)
v_fma_f32 v218, v218, v254, v254
v_fma_f32 v219, v219, v254, v254
v_mfma_f32_16x16x16_bf16 v[68:71], a[144:145], v[212:213], v[68:71]
ds_read_b128 a[168:171], v211 offset:2048
ds_read_b128 a[172:175], v211 offset:20480
v_mfma_f32_16x16x16_bf16 v[72:75], a[144:145], v[214:215], v[72:75]
buffer_load_dwordx4 v1, s[4:7], s39 offen offset:2048 sc1 lds
buffer_load_dwordx4 v1, s[4:7], s39 offen offset:3072 sc1 lds
v_exp_f32 v221, v221
v_mfma_f32_16x16x16_bf16 v[76:79], a[148:149], v[212:213], v[76:79]
s_add_u32 m0, m0, 4096
v_exp_f32 v222, v222
v_mfma_f32_16x16x16_bf16 v[80:83], a[148:149], v[214:215], v[80:83]
s_waitcnt vmcnt(10) lgkmcnt(4)
s_barrier
v_mfma_f32_16x16x32_bf16 v[84:87], a[152:155], a[0:3], 0
ds_read_b128 a[144:147], v211 offset:3072
ds_read_b128 a[148:151], v211 offset:21504
v_fma_f32 v220, v220, v255, v255
v_fma_f32 v221, v221, v255, v255
v_mfma_f32_16x16x32_bf16 v[88:91], a[152:155], a[4:7], 0
s_add_u32 s39, s39, 4096
v_exp_f32 v223, v223
v_mfma_f32_16x16x32_bf16 v[92:95], a[156:159], a[0:3], 0
v_rcp_f32 v216, v216
v_mfma_f32_16x16x32_bf16 v[96:99], a[156:159], a[4:7], 0
s_waitcnt lgkmcnt(4)
v_fma_f32 v222, v222, v255, v255
v_fma_f32 v223, v223, v255, v255
v_mfma_f32_16x16x32_bf16 v[84:87], a[160:163], a[8:11], v[84:87]
ds_read_b128 a[152:155], v211 offset:4096
ds_read_b128 a[156:159], v211 offset:22528
v_mfma_f32_16x16x32_bf16 v[88:91], a[160:163], a[12:15], v[88:91]
buffer_load_dwordx4 v1, s[4:7], s39 offen offset:0 sc1 lds
v_rcp_f32 v217, v217
v_mfma_f32_16x16x32_bf16 v[92:95], a[164:167], a[8:11], v[92:95]
s_lshl_b32 s38, s24, 8
v_rcp_f32 v218, v218
v_mfma_f32_16x16x32_bf16 v[96:99], a[164:167], a[12:15], v[96:99]
s_waitcnt lgkmcnt(4)
v_rcp_f32 v219, v219
v_mfma_f32_16x16x32_bf16 v[84:87], a[168:171], a[16:19], v[84:87]
ds_read_b128 a[160:163], v211 offset:5120
ds_read_b128 a[164:167], v211 offset:23552
v_mfma_f32_16x16x32_bf16 v[88:91], a[168:171], a[20:23], v[88:91]
buffer_store_dwordx4 a[236:239], v1, s[4:7], s101 offen offset:3072 sc1
v_rcp_f32 v220, v220
v_mfma_f32_16x16x32_bf16 v[92:95], a[172:175], a[16:19], v[92:95]
s_add_u32 m0, s38, 36864
v_rcp_f32 v221, v221
v_mfma_f32_16x16x32_bf16 v[96:99], a[172:175], a[20:23], v[96:99]
s_waitcnt lgkmcnt(4)
v_rcp_f32 v222, v222
v_mfma_f32_16x16x32_bf16 v[84:87], a[144:147], a[24:27], v[84:87]
ds_read_b128 a[168:171], v211 offset:6144
ds_read_b128 a[172:175], v211 offset:24576
v_mfma_f32_16x16x32_bf16 v[88:91], a[144:147], a[28:31], v[88:91]
s_add_u32 s39, s38, s82
v_rcp_f32_e64 v223, v223
v_mfma_f32_16x16x32_bf16 v[92:95], a[148:151], a[24:27], v[92:95]
s_add_u32 s39, s39, 226304
v_pk_mul_f32 v[224:225], v[60:61], v[60:61]
v_pk_mul_f32 v[226:227], v[62:63], v[62:63]
v_pk_mul_f32 v[228:229], v[64:65], v[64:65]
v_pk_mul_f32 v[230:231], v[66:67], v[66:67]
v_pk_fma_f32 v[224:225], v[224:225], v[252:253], v[250:251] op_sel:[0,0,0] op_sel_hi:[1,0,0]
v_pk_fma_f32 v[226:227], v[226:227], v[252:253], v[250:251] op_sel:[0,0,0] op_sel_hi:[1,0,0]
v_pk_fma_f32 v[228:229], v[228:229], v[252:253], v[250:251] op_sel:[0,1,1] op_sel_hi:[1,1,1]
v_pk_fma_f32 v[230:231], v[230:231], v[252:253], v[250:251] op_sel:[0,1,1] op_sel_hi:[1,1,1]
v_pk_mul_f32 v[52:53], v[52:53], v[216:217]
v_pk_mul_f32 v[54:55], v[54:55], v[218:219]
v_pk_mul_f32 v[56:57], v[56:57], v[220:221]
v_pk_mul_f32 v[58:59], v[58:59], v[222:223]
v_pk_mul_f32 v[224:225], v[224:225], v[60:61]
v_pk_mul_f32 v[226:227], v[226:227], v[62:63]
v_pk_mul_f32 v[228:229], v[228:229], v[64:65]
v_pk_mul_f32 v[230:231], v[230:231], v[66:67]
v_mfma_f32_16x16x32_bf16 v[96:99], a[148:151], a[28:31], v[96:99]
s_waitcnt lgkmcnt(4)
v_exp_f32 v224, v224
v_mfma_f32_16x16x32_bf16 v[84:87], a[152:155], a[32:35], v[84:87]
ds_read_b128 a[144:147], v211 offset:7168
ds_read_b128 a[148:151], v211 offset:25600
v_exp_f32 v225, v225
v_mfma_f32_16x16x32_bf16 v[88:91], a[152:155], a[36:39], v[88:91]
v_exp_f32 v226, v226
v_mfma_f32_16x16x32_bf16 v[92:95], a[156:159], a[32:35], v[92:95]
s_mov_b64 exec, 0xffff
buffer_load_dwordx4 v1, s[4:7], s39 offen sc1 lds
s_mov_b64 exec, -1
v_mfma_f32_16x16x32_bf16 v[96:99], a[156:159], a[36:39], v[96:99]
s_waitcnt lgkmcnt(4)
v_fma_f32 v224, v224, v254, v254
v_fma_f32 v225, v225, v254, v254
v_mfma_f32_16x16x32_bf16 v[84:87], a[160:163], a[40:43], v[84:87]
ds_read_b128 a[152:155], v211 offset:8192
ds_read_b128 a[156:159], v211 offset:26624
v_exp_f32 v227, v227
v_mfma_f32_16x16x32_bf16 v[88:91], a[160:163], a[44:47], v[88:91]
v_exp_f32 v228, v228
v_mfma_f32_16x16x32_bf16 v[92:95], a[164:167], a[40:43], v[92:95]
v_fma_f32 v226, v226, v254, v254
v_fma_f32 v227, v227, v254, v254
v_mfma_f32_16x16x32_bf16 v[96:99], a[164:167], a[44:47], v[96:99]
s_waitcnt lgkmcnt(4)
v_exp_f32 v229, v229
v_mfma_f32_16x16x32_bf16 v[84:87], a[168:171], a[48:51], v[84:87]
ds_read_b128 a[160:163], v211 offset:9216
ds_read_b128 a[164:167], v211 offset:27648
v_mfma_f32_16x16x32_bf16 v[88:91], a[168:171], a[52:55], v[88:91]
v_exp_f32 v230, v230
v_mfma_f32_16x16x32_bf16 v[92:95], a[172:175], a[48:51], v[92:95]
buffer_store_dwordx4 a[240:243], v9, s[4:7], s101 offen offset:0 sc1
s_mul_i32 s38, s24, 9216
v_mfma_f32_16x16x32_bf16 v[96:99], a[172:175], a[52:55], v[96:99]
s_waitcnt lgkmcnt(4)
v_fma_f32 v228, v228, v255, v255
v_fma_f32 v229, v229, v255, v255
v_mfma_f32_16x16x32_bf16 v[84:87], a[144:147], a[56:59], v[84:87]
ds_read_b128 a[168:171], v211 offset:10240
ds_read_b128 a[172:175], v211 offset:28672
v_exp_f32 v231, v231
v_mfma_f32_16x16x32_bf16 v[88:91], a[144:147], a[60:63], v[88:91]
s_add_u32 m0, s38, 37888
v_rcp_f32 v224, v224
v_mfma_f32_16x16x32_bf16 v[92:95], a[148:151], a[56:59], v[92:95]
s_add_u32 s39, s38, s82
v_fma_f32 v230, v230, v255, v255
v_fma_f32 v231, v231, v255, v255
v_mfma_f32_16x16x32_bf16 v[96:99], a[148:151], a[60:63], v[96:99]
s_waitcnt lgkmcnt(4)
v_rcp_f32 v225, v225
v_mfma_f32_16x16x32_bf16 v[84:87], a[152:155], a[64:67], v[84:87]
ds_read_b128 a[144:147], v211 offset:11264
ds_read_b128 a[148:151], v211 offset:29696
v_mfma_f32_16x16x32_bf16 v[88:91], a[152:155], a[68:71], v[88:91]
s_add_u32 s39, s39, 227328
v_rcp_f32 v226, v226
v_mfma_f32_16x16x32_bf16 v[92:95], a[156:159], a[64:67], v[92:95]
v_rcp_f32 v227, v227
v_mfma_f32_16x16x32_bf16 v[96:99], a[156:159], a[68:71], v[96:99]
s_waitcnt lgkmcnt(4)
v_rcp_f32 v228, v228
v_mfma_f32_16x16x32_bf16 v[84:87], a[160:163], a[72:75], v[84:87]
ds_read_b128 a[152:155], v211 offset:12288
ds_read_b128 a[156:159], v211 offset:30720
v_mfma_f32_16x16x32_bf16 v[88:91], a[160:163], a[76:79], v[88:91]
buffer_load_dwordx4 v1, s[4:7], s39 offen offset:0 sc1 lds
buffer_load_dwordx4 v1, s[4:7], s39 offen offset:1024 sc1 lds
v_mfma_f32_16x16x32_bf16 v[92:95], a[164:167], a[72:75], v[92:95]
v_rcp_f32 v229, v229
v_mfma_f32_16x16x32_bf16 v[96:99], a[164:167], a[76:79], v[96:99]
s_waitcnt lgkmcnt(4)
v_rcp_f32 v230, v230
v_mfma_f32_16x16x32_bf16 v[84:87], a[168:171], a[80:83], v[84:87]
ds_read_b128 a[160:163], v211 offset:13312
ds_read_b128 a[164:167], v211 offset:31744
v_rcp_f32_e64 v231, v231
v_mfma_f32_16x16x32_bf16 v[88:91], a[168:171], a[84:87], v[88:91]
buffer_load_dwordx4 v1, s[4:7], s39 offen offset:2048 sc1 lds
buffer_load_dwordx4 v1, s[4:7], s39 offen offset:3072 sc1 lds
v_pk_mul_f32 v[216:217], v[68:69], v[68:69]
v_pk_mul_f32 v[218:219], v[70:71], v[70:71]
v_pk_mul_f32 v[220:221], v[72:73], v[72:73]
v_pk_mul_f32 v[222:223], v[74:75], v[74:75]
v_pk_fma_f32 v[216:217], v[216:217], v[252:253], v[250:251] op_sel:[0,0,0] op_sel_hi:[1,0,0]
v_pk_fma_f32 v[218:219], v[218:219], v[252:253], v[250:251] op_sel:[0,0,0] op_sel_hi:[1,0,0]
v_pk_fma_f32 v[220:221], v[220:221], v[252:253], v[250:251] op_sel:[0,1,1] op_sel_hi:[1,1,1]
v_pk_fma_f32 v[222:223], v[222:223], v[252:253], v[250:251] op_sel:[0,1,1] op_sel_hi:[1,1,1]
v_pk_mul_f32 v[60:61], v[60:61], v[224:225]
v_pk_mul_f32 v[62:63], v[62:63], v[226:227]
v_pk_mul_f32 v[64:65], v[64:65], v[228:229]
v_pk_mul_f32 v[66:67], v[66:67], v[230:231]
v_pk_mul_f32 v[216:217], v[216:217], v[68:69]
v_pk_mul_f32 v[218:219], v[218:219], v[70:71]
v_pk_mul_f32 v[220:221], v[220:221], v[72:73]
v_pk_mul_f32 v[222:223], v[222:223], v[74:75]
v_mfma_f32_16x16x32_bf16 v[92:95], a[172:175], a[80:83], v[92:95]
s_add_u32 m0, m0, 4096
v_exp_f32 v216, v216
v_mfma_f32_16x16x32_bf16 v[96:99], a[172:175], a[84:87], v[96:99]
s_waitcnt lgkmcnt(4)
v_exp_f32 v217, v217
v_mfma_f32_16x16x32_bf16 v[84:87], a[144:147], a[88:91], v[84:87]
ds_read_b128 a[168:171], v211 offset:14336
ds_read_b128 a[172:175], v211 offset:32768
v_exp_f32 v218, v218
v_mfma_f32_16x16x32_bf16 v[88:91], a[144:147], a[92:95], v[88:91]
buffer_store_dwordx4 a[244:247], v9, s[4:7], s101 offen offset:1024 sc1
v_fma_f32 v216, v216, v254, v254
v_mfma_f32_16x16x32_bf16 v[92:95], a[148:151], a[88:91], v[92:95]
s_add_u32 s39, s39, 4096
v_fma_f32 v217, v217, v254, v254
v_mfma_f32_16x16x32_bf16 v[96:99], a[148:151], a[92:95], v[96:99]
s_waitcnt lgkmcnt(4)
v_exp_f32 v219, v219
v_mfma_f32_16x16x32_bf16 v[84:87], a[152:155], a[96:99], v[84:87]
ds_read_b128 a[144:147], v211 offset:15360
ds_read_b128 a[148:151], v211 offset:33792
v_exp_f32 v220, v220
v_mfma_f32_16x16x32_bf16 v[88:91], a[152:155], a[100:103], v[88:91]
v_fma_f32 v218, v218, v254, v254
v_fma_f32 v219, v219, v254, v254
v_mfma_f32_16x16x32_bf16 v[92:95], a[156:159], a[96:99], v[92:95]
v_exp_f32 v221, v221
v_mfma_f32_16x16x32_bf16 v[96:99], a[156:159], a[100:103], v[96:99]
s_waitcnt lgkmcnt(4)
v_exp_f32 v222, v222
v_mfma_f32_16x16x32_bf16 v[84:87], a[160:163], a[104:107], v[84:87]
ds_read_b128 a[152:155], v211 offset:16384
ds_read_b128 a[156:159], v211 offset:34816
v_mfma_f32_16x16x32_bf16 v[88:91], a[160:163], a[108:111], v[88:91]
buffer_load_dwordx4 v1, s[4:7], s39 offen offset:0 sc1 lds
buffer_load_dwordx4 v1, s[4:7], s39 offen offset:1024 sc1 lds
v_mfma_f32_16x16x32_bf16 v[92:95], a[164:167], a[104:107], v[92:95]
v_fma_f32 v220, v220, v255, v255
v_fma_f32 v221, v221, v255, v255
v_mfma_f32_16x16x32_bf16 v[96:99], a[164:167], a[108:111], v[96:99]
s_waitcnt lgkmcnt(4)
v_exp_f32 v223, v223
v_mfma_f32_16x16x32_bf16 v[84:87], a[168:171], a[112:115], v[84:87]
ds_read_b128 a[160:163], v211 offset:17408
ds_read_b128 a[164:167], v211 offset:35840
v_rcp_f32 v216, v216
v_mfma_f32_16x16x32_bf16 v[88:91], a[168:171], a[116:119], v[88:91]
buffer_load_dwordx4 v1, s[4:7], s39 offen offset:2048 sc1 lds
buffer_load_dwordx4 v1, s[4:7], s39 offen offset:3072 sc1 lds
v_mfma_f32_16x16x32_bf16 v[92:95], a[172:175], a[112:115], v[92:95]
s_add_u32 m0, m0, 4096
v_fma_f32 v222, v222, v255, v255
v_fma_f32 v223, v223, v255, v255
v_mfma_f32_16x16x32_bf16 v[96:99], a[172:175], a[116:119], v[96:99]
s_waitcnt lgkmcnt(4)
v_rcp_f32 v217, v217
v_add_u32 v181, 112640, v239
v_mfma_f32_16x16x32_bf16 v[84:87], a[144:147], a[120:123], v[84:87]
ds_read_b64 a[168:169], v181 offset:0
ds_read_b64 a[172:173], v181 offset:512
v_rcp_f32 v218, v218
v_mfma_f32_16x16x32_bf16 v[88:91], a[144:147], a[124:127], v[88:91]
s_add_u32 s39, s39, 4096
v_rcp_f32 v219, v219
v_mfma_f32_16x16x32_bf16 v[92:95], a[148:151], a[120:123], v[92:95]
buffer_store_dwordx4 a[248:251], v9, s[4:7], s101 offen offset:2048 sc1
v_mfma_f32_16x16x32_bf16 v[96:99], a[148:151], a[124:127], v[96:99]
s_waitcnt lgkmcnt(4)
v_rcp_f32 v220, v220
v_mfma_f32_16x16x32_bf16 v[84:87], a[152:155], a[128:131], v[84:87]
ds_read_b128 a[144:147], v208 offset:0
ds_read_b128 a[148:151], v208 offset:1024
v_mfma_f32_16x16x32_bf16 v[88:91], a[152:155], a[132:135], v[88:91]
v_rcp_f32 v221, v221
v_mfma_f32_16x16x32_bf16 v[92:95], a[156:159], a[128:131], v[92:95]
v_rcp_f32 v222, v222
v_mfma_f32_16x16x32_bf16 v[96:99], a[156:159], a[132:135], v[96:99]
s_waitcnt lgkmcnt(4)
v_rcp_f32_e64 v223, v223
v_mfma_f32_16x16x32_bf16 v[84:87], a[160:163], a[136:139], v[84:87]
ds_read_b128 a[152:155], v208 offset:2048
ds_read_b128 a[156:159], v208 offset:3072
v_pk_mul_f32 v[224:225], v[76:77], v[76:77]
v_pk_mul_f32 v[226:227], v[78:79], v[78:79]
v_pk_mul_f32 v[228:229], v[80:81], v[80:81]
v_pk_mul_f32 v[230:231], v[82:83], v[82:83]
v_pk_fma_f32 v[224:225], v[224:225], v[252:253], v[250:251] op_sel:[0,0,0] op_sel_hi:[1,0,0]
v_pk_fma_f32 v[226:227], v[226:227], v[252:253], v[250:251] op_sel:[0,0,0] op_sel_hi:[1,0,0]
v_pk_fma_f32 v[228:229], v[228:229], v[252:253], v[250:251] op_sel:[0,1,1] op_sel_hi:[1,1,1]
v_pk_fma_f32 v[230:231], v[230:231], v[252:253], v[250:251] op_sel:[0,1,1] op_sel_hi:[1,1,1]
v_pk_mul_f32 v[68:69], v[68:69], v[216:217]
v_pk_mul_f32 v[70:71], v[70:71], v[218:219]
v_pk_mul_f32 v[72:73], v[72:73], v[220:221]
v_pk_mul_f32 v[74:75], v[74:75], v[222:223]
v_pk_mul_f32 v[224:225], v[224:225], v[76:77]
v_pk_mul_f32 v[226:227], v[226:227], v[78:79]
v_pk_mul_f32 v[228:229], v[228:229], v[80:81]
v_pk_mul_f32 v[230:231], v[230:231], v[82:83]
v_mfma_f32_16x16x32_bf16 v[88:91], a[160:163], a[140:143], v[88:91]
buffer_load_dwordx4 v1, s[4:7], s39 offen offset:0 sc1 lds
s_lshl_b32 s38, s24, 8
v_exp_f32 v224, v224
v_mfma_f32_16x16x32_bf16 v[92:95], a[164:167], a[136:139], v[92:95]
s_add_u32 m0, s38, 74752
v_exp_f32 v225, v225
v_mfma_f32_16x16x32_bf16 v[96:99], a[164:167], a[140:143], v[96:99]
s_waitcnt lgkmcnt(4)
v_exp_f32 v226, v226
v_mfma_f32_16x16x16_bf16 v[84:87], a[168:169], v[212:213], v[84:87]
ds_read_b128 a[160:163], v208 offset:4096
ds_read_b128 a[164:167], v208 offset:5120
v_mfma_f32_16x16x16_bf16 v[88:91], a[168:169], v[214:215], v[88:91]
s_add_u32 s39, s38, s82
v_fma_f32 v224, v224, v254, v254
v_fma_f32 v225, v225, v254, v254
v_mfma_f32_16x16x16_bf16 v[92:95], a[172:173], v[212:213], v[92:95]
s_add_u32 s39, s39, 264192
v_exp_f32 v227, v227
v_mfma_f32_16x16x16_bf16 v[96:99], a[172:173], v[214:215], v[96:99]
s_waitcnt lgkmcnt(4)
v_exp_f32 v228, v228
s_waitcnt vmcnt(12)
s_barrier
v_mfma_f32_16x16x32_bf16 v[100:103], a[144:147], a[0:3], 0
ds_read_b128 a[168:171], v208 offset:6144
ds_read_b128 a[172:175], v208 offset:7168
v_mfma_f32_16x16x32_bf16 v[104:107], a[144:147], a[4:7], 0
v_fma_f32 v226, v226, v254, v254
v_fma_f32 v227, v227, v254, v254
v_mfma_f32_16x16x32_bf16 v[100:103], a[148:151], a[8:11], v[100:103]
v_exp_f32 v229, v229
v_mfma_f32_16x16x32_bf16 v[104:107], a[148:151], a[12:15], v[104:107]
s_waitcnt lgkmcnt(4)
v_exp_f32 v230, v230
v_mfma_f32_16x16x32_bf16 v[100:103], a[152:155], a[16:19], v[100:103]
ds_read_b128 a[144:147], v208 offset:8192
ds_read_b128 a[148:151], v208 offset:9216
v_mfma_f32_16x16x32_bf16 v[104:107], a[152:155], a[20:23], v[104:107]
s_mov_b64 exec, 0xffff
buffer_load_dwordx4 v1, s[4:7], s39 offen sc1 lds
s_mov_b64 exec, -1
v_fma_f32 v228, v228, v255, v255
v_fma_f32 v229, v229, v255, v255
v_mfma_f32_16x16x32_bf16 v[100:103], a[156:159], a[24:27], v[100:103]
buffer_store_dwordx4 a[252:255], v9, s[4:7], s101 offen offset:3072 sc1
v_exp_f32 v231, v231
v_mfma_f32_16x16x32_bf16 v[104:107], a[156:159], a[28:31], v[104:107]
s_waitcnt lgkmcnt(4)
v_rcp_f32 v224, v224
v_mfma_f32_16x16x32_bf16 v[100:103], a[160:163], a[32:35], v[100:103]
ds_read_b128 a[152:155], v208 offset:10240
ds_read_b128 a[156:159], v208 offset:11264
v_mfma_f32_16x16x32_bf16 v[104:107], a[160:163], a[36:39], v[104:107]
s_mov_b32 s101, 1073741824
v_fma_f32 v230, v230, v255, v255
v_fma_f32 v231, v231, v255, v255
v_mfma_f32_16x16x32_bf16 v[100:103], a[164:167], a[40:43], v[100:103]
v_rcp_f32 v225, v225
v_mfma_f32_16x16x32_bf16 v[104:107], a[164:167], a[44:47], v[104:107]
s_waitcnt lgkmcnt(4)
v_rcp_f32 v226, v226
v_mfma_f32_16x16x32_bf16 v[100:103], a[168:171], a[48:51], v[100:103]
ds_read_b128 a[160:163], v208 offset:12288
ds_read_b128 a[164:167], v208 offset:13312
v_mfma_f32_16x16x32_bf16 v[104:107], a[168:171], a[52:55], v[104:107]
s_mul_i32 s38, s24, 9216
v_rcp_f32 v227, v227
v_mfma_f32_16x16x32_bf16 v[100:103], a[172:175], a[56:59], v[100:103]
s_add_u32 m0, s38, 75776
v_rcp_f32 v228, v228
v_mfma_f32_16x16x32_bf16 v[104:107], a[172:175], a[60:63], v[104:107]
s_waitcnt lgkmcnt(4)
v_rcp_f32 v229, v229
v_mfma_f32_16x16x32_bf16 v[100:103], a[144:147], a[64:67], v[100:103]
ds_read_b128 a[168:171], v208 offset:14336
ds_read_b128 a[172:175], v208 offset:15360
v_mfma_f32_16x16x32_bf16 v[104:107], a[144:147], a[68:71], v[104:107]
s_add_u32 s39, s38, s82
v_rcp_f32 v230, v230
v_mfma_f32_16x16x32_bf16 v[100:103], a[148:151], a[72:75], v[100:103]
s_add_u32 s39, s39, 265216
v_rcp_f32 v231, v231
v_mfma_f32_16x16x32_bf16 v[104:107], a[148:151], a[76:79], v[104:107]
s_waitcnt lgkmcnt(4)
v_pk_mul_f32 v[216:217], v[84:85], v[84:85]
v_pk_mul_f32 v[218:219], v[86:87], v[86:87]
v_pk_mul_f32 v[220:221], v[88:89], v[88:89]
v_pk_mul_f32 v[222:223], v[90:91], v[90:91]
v_pk_fma_f32 v[216:217], v[216:217], v[252:253], v[250:251] op_sel:[0,0,0] op_sel_hi:[1,0,0]
v_pk_fma_f32 v[218:219], v[218:219], v[252:253], v[250:251] op_sel:[0,0,0] op_sel_hi:[1,0,0]
v_pk_fma_f32 v[220:221], v[220:221], v[252:253], v[250:251] op_sel:[0,1,1] op_sel_hi:[1,1,1]
v_pk_fma_f32 v[222:223], v[222:223], v[252:253], v[250:251] op_sel:[0,1,1] op_sel_hi:[1,1,1]
v_pk_mul_f32 v[76:77], v[76:77], v[224:225]
v_pk_mul_f32 v[78:79], v[78:79], v[226:227]
v_pk_mul_f32 v[80:81], v[80:81], v[228:229]
v_pk_mul_f32 v[82:83], v[82:83], v[230:231]
v_pk_mul_f32 v[216:217], v[216:217], v[84:85]
v_pk_mul_f32 v[218:219], v[218:219], v[86:87]
v_pk_mul_f32 v[220:221], v[220:221], v[88:89]
v_pk_mul_f32 v[222:223], v[222:223], v[90:91]
v_mfma_f32_16x16x32_bf16 v[100:103], a[152:155], a[80:83], v[100:103]
ds_read_b128 a[144:147], v208 offset:16384
ds_read_b128 a[148:151], v208 offset:17408
v_exp_f32 v216, v216
v_mfma_f32_16x16x32_bf16 v[104:107], a[152:155], a[84:87], v[104:107]
v_exp_f32 v217, v217
v_mfma_f32_16x16x32_bf16 v[100:103], a[156:159], a[88:91], v[100:103]
buffer_load_dwordx4 v1, s[4:7], s39 offen offset:0 sc1 lds
buffer_load_dwordx4 v1, s[4:7], s39 offen offset:1024 sc1 lds
v_exp_f32 v218, v218
v_mfma_f32_16x16x32_bf16 v[104:107], a[156:159], a[92:95], v[104:107]
s_waitcnt lgkmcnt(4)
v_fma_f32 v216, v216, v254, v254
v_add_u32 v181, 160768, v239
v_mfma_f32_16x16x32_bf16 v[100:103], a[160:163], a[96:99], v[100:103]
ds_read_b64 a[152:153], v181 offset:0
ds_read_b128 a[156:159], v208 offset:18432
v_fma_f32 v217, v217, v254, v254
v_mfma_f32_16x16x32_bf16 v[104:107], a[160:163], a[100:103], v[104:107]
v_exp_f32 v219, v219
v_mfma_f32_16x16x32_bf16 v[100:103], a[164:167], a[104:107], v[100:103]
v_exp_f32 v220, v220
v_mfma_f32_16x16x32_bf16 v[104:107], a[164:167], a[108:111], v[104:107]
s_waitcnt lgkmcnt(4)
v_fma_f32 v218, v218, v254, v254
v_fma_f32 v219, v219, v254, v254
v_mfma_f32_16x16x32_bf16 v[100:103], a[168:171], a[112:115], v[100:103]
ds_read_b128 a[160:163], v208 offset:19456
ds_read_b128 a[164:167], v208 offset:20480
v_mfma_f32_16x16x32_bf16 v[104:107], a[168:171], a[116:119], v[104:107]
buffer_load_dwordx4 v1, s[4:7], s39 offen offset:2048 sc1 lds
buffer_load_dwordx4 v1, s[4:7], s39 offen offset:3072 sc1 lds
v_exp_f32 v221, v221
v_mfma_f32_16x16x32_bf16 v[100:103], a[172:175], a[120:123], v[100:103]
s_add_u32 m0, m0, 4096
v_exp_f32 v222, v222
v_mfma_f32_16x16x32_bf16 v[104:107], a[172:175], a[124:127], v[104:107]
s_waitcnt lgkmcnt(4)
v_fma_f32 v220, v220, v255, v255
v_fma_f32 v221, v221, v255, v255
v_mfma_f32_16x16x32_bf16 v[100:103], a[144:147], a[128:131], v[100:103]
ds_read_b128 a[168:171], v208 offset:21504
ds_read_b128 a[172:175], v208 offset:22528
v_mfma_f32_16x16x32_bf16 v[104:107], a[144:147], a[132:135], v[104:107]
s_add_u32 s39, s39, 4096
v_exp_f32 v223, v223
v_mfma_f32_16x16x32_bf16 v[100:103], a[148:151], a[136:139], v[100:103]
v_rcp_f32 v216, v216
v_mfma_f32_16x16x32_bf16 v[104:107], a[148:151], a[140:143], v[104:107]
s_waitcnt lgkmcnt(4)
v_fma_f32 v222, v222, v255, v255
v_fma_f32 v223, v223, v255, v255
v_mfma_f32_16x16x16_bf16 v[100:103], a[152:153], v[212:213], v[100:103]
ds_read_b128 a[144:147], v208 offset:23552
ds_read_b128 a[148:151], v208 offset:24576
v_mfma_f32_16x16x16_bf16 v[104:107], a[152:153], v[214:215], v[104:107]
buffer_load_dwordx4 v1, s[4:7], s39 offen offset:0 sc1 lds
buffer_load_dwordx4 v1, s[4:7], s39 offen offset:1024 sc1 lds
v_rcp_f32 v217, v217
v_mfma_f32_16x16x32_bf16 v[108:111], a[156:159], a[0:3], 0
v_rcp_f32 v218, v218
v_mfma_f32_16x16x32_bf16 v[112:115], a[156:159], a[4:7], 0
s_waitcnt lgkmcnt(4)
v_rcp_f32 v219, v219
v_mfma_f32_16x16x32_bf16 v[108:111], a[160:163], a[8:11], v[108:111]
ds_read_b128 a[152:155], v208 offset:25600
ds_read_b128 a[156:159], v208 offset:26624
v_mfma_f32_16x16x32_bf16 v[112:115], a[160:163], a[12:15], v[112:115]
v_rcp_f32 v220, v220
v_mfma_f32_16x16x32_bf16 v[108:111], a[164:167], a[16:19], v[108:111]
v_rcp_f32 v221, v221
v_mfma_f32_16x16x32_bf16 v[112:115], a[164:167], a[20:23], v[112:115]
s_waitcnt lgkmcnt(4)
v_rcp_f32 v222, v222
v_mfma_f32_16x16x32_bf16 v[108:111], a[168:171], a[24:27], v[108:111]
ds_read_b128 a[160:163], v208 offset:27648
ds_read_b128 a[164:167], v208 offset:28672
v_mfma_f32_16x16x32_bf16 v[112:115], a[168:171], a[28:31], v[112:115]
buffer_load_dwordx4 v1, s[4:7], s39 offen offset:2048 sc1 lds
buffer_load_dwordx4 v1, s[4:7], s39 offen offset:3072 sc1 lds
v_rcp_f32 v223, v223
v_mfma_f32_16x16x32_bf16 v[108:111], a[172:175], a[32:35], v[108:111]
s_add_u32 m0, m0, 4096
v_pk_mul_f32 v[224:225], v[92:93], v[92:93]
v_pk_mul_f32 v[226:227], v[94:95], v[94:95]
v_pk_mul_f32 v[228:229], v[96:97], v[96:97]
v_pk_mul_f32 v[230:231], v[98:99], v[98:99]
v_pk_fma_f32 v[224:225], v[224:225], v[252:253], v[250:251] op_sel:[0,0,0] op_sel_hi:[1,0,0]
v_pk_fma_f32 v[226:227], v[226:227], v[252:253], v[250:251] op_sel:[0,0,0] op_sel_hi:[1,0,0]
v_pk_fma_f32 v[228:229], v[228:229], v[252:253], v[250:251] op_sel:[0,1,1] op_sel_hi:[1,1,1]
v_pk_fma_f32 v[230:231], v[230:231], v[252:253], v[250:251] op_sel:[0,1,1] op_sel_hi:[1,1,1]
v_pk_mul_f32 v[84:85], v[84:85], v[216:217]
v_pk_mul_f32 v[86:87], v[86:87], v[218:219]
v_pk_mul_f32 v[88:89], v[88:89], v[220:221]
v_pk_mul_f32 v[90:91], v[90:91], v[222:223]
v_pk_mul_f32 v[224:225], v[224:225], v[92:93]
v_pk_mul_f32 v[226:227], v[226:227], v[94:95]
v_pk_mul_f32 v[228:229], v[228:229], v[96:97]
v_pk_mul_f32 v[230:231], v[230:231], v[98:99]
v_mfma_f32_16x16x32_bf16 v[112:115], a[172:175], a[36:39], v[112:115]
s_waitcnt lgkmcnt(4)
v_exp_f32 v224, v224
v_mfma_f32_16x16x32_bf16 v[108:111], a[144:147], a[40:43], v[108:111]
ds_read_b128 a[168:171], v208 offset:29696
ds_read_b128 a[172:175], v208 offset:30720
v_exp_f32 v225, v225
v_mfma_f32_16x16x32_bf16 v[112:115], a[144:147], a[44:47], v[112:115]
s_add_u32 s39, s39, 4096
v_exp_f32 v226, v226
v_mfma_f32_16x16x32_bf16 v[108:111], a[148:151], a[48:51], v[108:111]
v_fma_f32 v224, v224, v254, v254
v_fma_f32 v225, v225, v254, v254
v_mfma_f32_16x16x32_bf16 v[112:115], a[148:151], a[52:55], v[112:115]
s_waitcnt lgkmcnt(4)
v_exp_f32 v227, v227
v_mfma_f32_16x16x32_bf16 v[108:111], a[152:155], a[56:59], v[108:111]
ds_read_b128 a[144:147], v208 offset:31744
ds_read_b128 a[148:151], v208 offset:32768
v_mfma_f32_16x16x32_bf16 v[112:115], a[152:155], a[60:63], v[112:115]
buffer_load_dwordx4 v1, s[4:7], s39 offen offset:0 sc1 lds
v_exp_f32 v228, v228
v_mfma_f32_16x16x32_bf16 v[108:111], a[156:159], a[64:67], v[108:111]
s_lshl_b32 s38, s24, 8
v_fma_f32 v226, v226, v254, v254
v_fma_f32 v227, v227, v254, v254
v_mfma_f32_16x16x32_bf16 v[112:115], a[156:159], a[68:71], v[112:115]
s_waitcnt lgkmcnt(4)
v_exp_f32 v229, v229
v_mfma_f32_16x16x32_bf16 v[108:111], a[160:163], a[72:75], v[108:111]
ds_read_b128 a[152:155], v208 offset:33792
ds_read_b128 a[156:159], v208 offset:34816
v_mfma_f32_16x16x32_bf16 v[112:115], a[160:163], a[76:79], v[112:115]
s_add_u32 m0, s38, 112640
v_exp_f32 v230, v230
v_mfma_f32_16x16x32_bf16 v[108:111], a[164:167], a[80:83], v[108:111]
s_add_u32 s39, s38, s82
v_fma_f32 v228, v228, v255, v255
v_fma_f32 v229, v229, v255, v255
v_mfma_f32_16x16x32_bf16 v[112:115], a[164:167], a[84:87], v[112:115]
s_waitcnt lgkmcnt(4)
v_exp_f32 v231, v231
v_mfma_f32_16x16x32_bf16 v[108:111], a[168:171], a[88:91], v[108:111]
ds_read_b128 a[160:163], v208 offset:35840
ds_read_b64 a[164:165], v181 offset:512
v_mfma_f32_16x16x32_bf16 v[112:115], a[168:171], a[92:95], v[112:115]
s_add_u32 s39, s39, 302080
v_rcp_f32 v224, v224
v_mfma_f32_16x16x32_bf16 v[108:111], a[172:175], a[96:99], v[108:111]
v_fma_f32 v230, v230, v255, v255
v_fma_f32 v231, v231, v255, v255
v_mfma_f32_16x16x32_bf16 v[112:115], a[172:175], a[100:103], v[112:115]
s_waitcnt lgkmcnt(4)
v_rcp_f32 v225, v225
v_mfma_f32_16x16x32_bf16 v[108:111], a[144:147], a[104:107], v[108:111]
ds_read_b128 a[168:171], v209 offset:0
ds_read_b128 a[172:175], v209 offset:18432
v_mfma_f32_16x16x32_bf16 v[112:115], a[144:147], a[108:111], v[112:115]
v_rcp_f32 v226, v226
v_mfma_f32_16x16x32_bf16 v[108:111], a[148:151], a[112:115], v[108:111]
s_mov_b64 exec, 0xffff
buffer_load_dwordx4 v1, s[4:7], s39 offen sc1 lds
s_mov_b64 exec, -1
v_mfma_f32_16x16x32_bf16 v[112:115], a[148:151], a[116:119], v[112:115]
s_waitcnt lgkmcnt(4)
v_rcp_f32 v227, v227
v_mfma_f32_16x16x32_bf16 v[108:111], a[152:155], a[120:123], v[108:111]
ds_read_b128 a[144:147], v209 offset:1024
ds_read_b128 a[148:151], v209 offset:19456
v_rcp_f32 v228, v228
v_mfma_f32_16x16x32_bf16 v[112:115], a[152:155], a[124:127], v[112:115]
v_rcp_f32 v229, v229
v_mfma_f32_16x16x32_bf16 v[108:111], a[156:159], a[128:131], v[108:111]
v_rcp_f32 v230, v230
v_mfma_f32_16x16x32_bf16 v[112:115], a[156:159], a[132:135], v[112:115]
s_waitcnt lgkmcnt(4)
v_rcp_f32 v231, v231
v_mfma_f32_16x16x32_bf16 v[108:111], a[160:163], a[136:139], v[108:111]
ds_read_b128 a[152:155], v209 offset:2048
ds_read_b128 a[156:159], v209 offset:20480
v_pk_mul_f32 v[216:217], v[100:101], v[100:101]
v_pk_mul_f32 v[218:219], v[102:103], v[102:103]
v_pk_mul_f32 v[220:221], v[104:105], v[104:105]
v_pk_mul_f32 v[222:223], v[106:107], v[106:107]
v_pk_fma_f32 v[216:217], v[216:217], v[252:253], v[250:251] op_sel:[0,0,0] op_sel_hi:[1,0,0]
v_pk_fma_f32 v[218:219], v[218:219], v[252:253], v[250:251] op_sel:[0,0,0] op_sel_hi:[1,0,0]
v_pk_fma_f32 v[220:221], v[220:221], v[252:253], v[250:251] op_sel:[0,1,1] op_sel_hi:[1,1,1]
v_pk_fma_f32 v[222:223], v[222:223], v[252:253], v[250:251] op_sel:[0,1,1] op_sel_hi:[1,1,1]
v_pk_mul_f32 v[92:93], v[92:93], v[224:225]
v_pk_mul_f32 v[94:95], v[94:95], v[226:227]
v_pk_mul_f32 v[96:97], v[96:97], v[228:229]
v_pk_mul_f32 v[98:99], v[98:99], v[230:231]
v_pk_mul_f32 v[216:217], v[216:217], v[100:101]
v_pk_mul_f32 v[218:219], v[218:219], v[102:103]
v_pk_mul_f32 v[220:221], v[220:221], v[104:105]
v_pk_mul_f32 v[222:223], v[222:223], v[106:107]
v_mfma_f32_16x16x32_bf16 v[112:115], a[160:163], a[140:143], v[112:115]
v_exp_f32 v216, v216
v_mfma_f32_16x16x16_bf16 v[108:111], a[164:165], v[212:213], v[108:111]
v_exp_f32 v217, v217
v_mfma_f32_16x16x16_bf16 v[112:115], a[164:165], v[214:215], v[112:115]
s_waitcnt vmcnt(11) lgkmcnt(4)
s_barrier
v_mfma_f32_16x16x32_bf16 v[116:119], a[168:171], a[0:3], 0
ds_read_b128 a[160:163], v209 offset:3072
ds_read_b128 a[164:167], v209 offset:21504
v_exp_f32 v218, v218
v_mfma_f32_16x16x32_bf16 v[120:123], a[168:171], a[4:7], 0
s_mul_i32 s38, s24, 9216
s_add_u32 m0, s38, 123904
v_fma_f32 v216, v216, v254, v254
v_mfma_f32_16x16x32_bf16 v[124:127], a[172:175], a[0:3], 0
s_add_u32 s39, s38, s82
v_fma_f32 v217, v217, v254, v254
v_mfma_f32_16x16x32_bf16 v[128:131], a[172:175], a[4:7], 0
s_waitcnt lgkmcnt(4)
s_add_u32 s39, s39, 303104
v_exp_f32 v219, v219
v_mfma_f32_16x16x32_bf16 v[116:119], a[144:147], a[8:11], v[116:119]
ds_read_b128 a[168:171], v209 offset:4096
ds_read_b128 a[172:175], v209 offset:22528
v_exp_f32 v220, v220
v_mfma_f32_16x16x32_bf16 v[120:123], a[144:147], a[12:15], v[120:123]
buffer_load_dwordx4 v1, s[4:7], s39 offen offset:0 sc1 lds
buffer_load_dwordx4 v1, s[4:7], s39 offen offset:1024 sc1 lds
v_mfma_f32_16x16x32_bf16 v[124:127], a[148:151], a[8:11], v[124:127]
v_fma_f32 v218, v218, v254, v254
v_fma_f32 v219, v219, v254, v254
v_mfma_f32_16x16x32_bf16 v[128:131], a[148:151], a[12:15], v[128:131]
s_waitcnt lgkmcnt(4)
v_exp_f32 v221, v221
v_mfma_f32_16x16x32_bf16 v[116:119], a[152:155], a[16:19], v[116:119]
ds_read_b128 a[144:147], v209 offset:5120
ds_read_b128 a[148:151], v209 offset:23552
v_exp_f32 v222, v222
v_mfma_f32_16x16x32_bf16 v[120:123], a[152:155], a[20:23], v[120:123]
buffer_load_dwordx4 v1, s[4:7], s39 offen offset:2048 sc1 lds
buffer_load_dwordx4 v1, s[4:7], s39 offen offset:3072 sc1 lds
v_mfma_f32_16x16x32_bf16 v[124:127], a[156:159], a[16:19], v[124:127]
s_add_u32 m0, m0, 4096
v_fma_f32 v220, v220, v255, v255
v_fma_f32 v221, v221, v255, v255
v_mfma_f32_16x16x32_bf16 v[128:131], a[156:159], a[20:23], v[128:131]
s_waitcnt lgkmcnt(4)
s_add_u32 s39, s39, 4096
v_exp_f32 v223, v223
v_mfma_f32_16x16x32_bf16 v[116:119], a[160:163], a[24:27], v[116:119]
ds_read_b128 a[152:155], v209 offset:6144
ds_read_b128 a[156:159], v209 offset:24576
v_rcp_f32 v216, v216
v_mfma_f32_16x16x32_bf16 v[120:123], a[160:163], a[28:31], v[120:123]
buffer_load_dwordx4 v1, s[4:7], s39 offen offset:0 sc1 lds
buffer_load_dwordx4 v1, s[4:7], s39 offen offset:1024 sc1 lds
v_mfma_f32_16x16x32_bf16 v[124:127], a[164:167], a[24:27], v[124:127]
v_fma_f32 v222, v222, v255, v255
v_fma_f32 v223, v223, v255, v255
v_mfma_f32_16x16x32_bf16 v[128:131], a[164:167], a[28:31], v[128:131]
s_waitcnt lgkmcnt(4)
v_rcp_f32 v217, v217
v_mfma_f32_16x16x32_bf16 v[116:119], a[168:171], a[32:35], v[116:119]
ds_read_b128 a[160:163], v209 offset:7168
ds_read_b128 a[164:167], v209 offset:25600
v_rcp_f32 v218, v218
v_mfma_f32_16x16x32_bf16 v[120:123], a[168:171], a[36:39], v[120:123]
buffer_load_dwordx4 v1, s[4:7], s39 offen offset:2048 sc1 lds
buffer_load_dwordx4 v1, s[4:7], s39 offen offset:3072 sc1 lds
v_mfma_f32_16x16x32_bf16 v[124:127], a[172:175], a[32:35], v[124:127]
s_add_u32 m0, m0, 4096
s_add_u32 s39, s39, 4096
v_rcp_f32 v219, v219
v_mfma_f32_16x16x32_bf16 v[128:131], a[172:175], a[36:39], v[128:131]
s_waitcnt lgkmcnt(4)
v_rcp_f32 v220, v220
v_mfma_f32_16x16x32_bf16 v[116:119], a[144:147], a[40:43], v[116:119]
ds_read_b128 a[168:171], v209 offset:8192
ds_read_b128 a[172:175], v209 offset:26624
v_rcp_f32 v221, v221
v_rcp_f32 v222, v222
v_rcp_f32 v223, v223
v_mfma_f32_16x16x32_bf16 v[120:123], a[144:147], a[44:47], v[120:123]
buffer_load_dwordx4 v1, s[4:7], s39 offen offset:0 sc1 lds
s_lshl_b32 s38, s24, 8
s_nop 0
v_pk_mul_f32 v[100:101], v[100:101], v[216:217]
v_pk_mul_f32 v[102:103], v[102:103], v[218:219]
v_pk_mul_f32 v[104:105], v[104:105], v[220:221]
v_pk_mul_f32 v[106:107], v[106:107], v[222:223]
v_pk_add_f32 v[198:199], v[36:37], v[38:39]
v_pk_mul_f32 v[200:201], v[36:37], v[36:37]
v_pk_fma_f32 v[200:201], v[38:39], v[38:39], v[200:201]
v_pk_add_f32 v[202:203], v[40:41], v[42:43]
v_pk_mul_f32 v[204:205], v[40:41], v[40:41]
v_pk_fma_f32 v[204:205], v[42:43], v[42:43], v[204:205]
v_pk_add_f32 v[198:199], v[198:199], v[44:45]
v_pk_fma_f32 v[200:201], v[44:45], v[44:45], v[200:201]
v_pk_add_f32 v[198:199], v[198:199], v[46:47]
v_pk_fma_f32 v[200:201], v[46:47], v[46:47], v[200:201]
v_pk_add_f32 v[202:203], v[202:203], v[48:49]
v_pk_fma_f32 v[204:205], v[48:49], v[48:49], v[204:205]
v_pk_add_f32 v[202:203], v[202:203], v[50:51]
v_pk_fma_f32 v[204:205], v[50:51], v[50:51], v[204:205]
v_pk_add_f32 v[198:199], v[198:199], v[52:53]
v_pk_fma_f32 v[200:201], v[52:53], v[52:53], v[200:201]
v_pk_add_f32 v[198:199], v[198:199], v[54:55]
v_pk_fma_f32 v[200:201], v[54:55], v[54:55], v[200:201]
v_pk_add_f32 v[202:203], v[202:203], v[56:57]
v_pk_fma_f32 v[204:205], v[56:57], v[56:57], v[204:205]
v_pk_add_f32 v[202:203], v[202:203], v[58:59]
v_pk_fma_f32 v[204:205], v[58:59], v[58:59], v[204:205]
v_pk_add_f32 v[198:199], v[198:199], v[60:61]
v_pk_fma_f32 v[200:201], v[60:61], v[60:61], v[200:201]
v_pk_add_f32 v[198:199], v[198:199], v[62:63]
v_pk_fma_f32 v[200:201], v[62:63], v[62:63], v[200:201]
v_pk_add_f32 v[202:203], v[202:203], v[64:65]
v_pk_fma_f32 v[204:205], v[64:65], v[64:65], v[204:205]
v_pk_add_f32 v[202:203], v[202:203], v[66:67]
v_pk_fma_f32 v[204:205], v[66:67], v[66:67], v[204:205]
v_pk_add_f32 v[198:199], v[198:199], v[68:69]
v_pk_fma_f32 v[200:201], v[68:69], v[68:69], v[200:201]
v_pk_add_f32 v[198:199], v[198:199], v[70:71]
v_pk_fma_f32 v[200:201], v[70:71], v[70:71], v[200:201]
v_pk_add_f32 v[202:203], v[202:203], v[72:73]
v_pk_fma_f32 v[204:205], v[72:73], v[72:73], v[204:205]
v_pk_add_f32 v[202:203], v[202:203], v[74:75]
v_pk_fma_f32 v[204:205], v[74:75], v[74:75], v[204:205]
v_pk_add_f32 v[198:199], v[198:199], v[76:77]
v_pk_fma_f32 v[200:201], v[76:77], v[76:77], v[200:201]
v_pk_add_f32 v[198:199], v[198:199], v[78:79]
v_pk_fma_f32 v[200:201], v[78:79], v[78:79], v[200:201]
v_pk_add_f32 v[202:203], v[202:203], v[80:81]
v_pk_fma_f32 v[204:205], v[80:81], v[80:81], v[204:205]
v_pk_add_f32 v[202:203], v[202:203], v[82:83]
v_pk_fma_f32 v[204:205], v[82:83], v[82:83], v[204:205]
v_pk_add_f32 v[198:199], v[198:199], v[84:85]
v_pk_fma_f32 v[200:201], v[84:85], v[84:85], v[200:201]
v_pk_add_f32 v[198:199], v[198:199], v[86:87]
v_pk_fma_f32 v[200:201], v[86:87], v[86:87], v[200:201]
v_pk_add_f32 v[202:203], v[202:203], v[88:89]
v_pk_fma_f32 v[204:205], v[88:89], v[88:89], v[204:205]
v_pk_add_f32 v[202:203], v[202:203], v[90:91]
v_pk_fma_f32 v[204:205], v[90:91], v[90:91], v[204:205]
v_pk_add_f32 v[198:199], v[198:199], v[92:93]
v_pk_fma_f32 v[200:201], v[92:93], v[92:93], v[200:201]
v_pk_add_f32 v[198:199], v[198:199], v[94:95]
v_pk_fma_f32 v[200:201], v[94:95], v[94:95], v[200:201]
v_pk_add_f32 v[202:203], v[202:203], v[96:97]
v_pk_fma_f32 v[204:205], v[96:97], v[96:97], v[204:205]
v_pk_add_f32 v[202:203], v[202:203], v[98:99]
v_pk_fma_f32 v[204:205], v[98:99], v[98:99], v[204:205]
v_pk_add_f32 v[198:199], v[198:199], v[100:101]
v_pk_fma_f32 v[200:201], v[100:101], v[100:101], v[200:201]
v_pk_add_f32 v[198:199], v[198:199], v[102:103]
v_pk_fma_f32 v[200:201], v[102:103], v[102:103], v[200:201]
v_pk_add_f32 v[202:203], v[202:203], v[104:105]
v_pk_fma_f32 v[204:205], v[104:105], v[104:105], v[204:205]
v_pk_add_f32 v[202:203], v[202:203], v[106:107]
v_pk_fma_f32 v[204:205], v[106:107], v[106:107], v[204:205]
v_mfma_f32_16x16x32_bf16 v[124:127], a[148:151], a[40:43], v[124:127]
s_add_u32 m0, s38, 160768
v_add_f32 v198, v198, v199
v_add_f32 v202, v202, v203
v_mfma_f32_16x16x32_bf16 v[128:131], a[148:151], a[44:47], v[128:131]
s_waitcnt lgkmcnt(4)
s_add_u32 s39, s38, s82
v_add_f32 v200, v200, v201
v_add_f32 v204, v204, v205
v_permlane16_swap_b32 v198, v202
v_mfma_f32_16x16x32_bf16 v[116:119], a[152:155], a[48:51], v[116:119]
ds_read_b128 a[144:147], v209 offset:9216
ds_read_b128 a[148:151], v209 offset:27648
s_nop 0
v_mfma_f32_16x16x32_bf16 v[120:123], a[152:155], a[52:55], v[120:123]
s_add_u32 s39, s39, 339968
v_permlane16_swap_b32 v200, v204
v_add_f32 v198, v198, v202
v_mfma_f32_16x16x32_bf16 v[124:127], a[156:159], a[48:51], v[124:127]
s_mov_b64 exec, 0xffff
buffer_load_dwordx4 v1, s[4:7], s39 offen sc1 lds
s_mov_b64 exec, -1
v_add_f32 v199, v200, v204
v_mov_b32 v200, v198
v_mfma_f32_16x16x32_bf16 v[128:131], a[156:159], a[52:55], v[128:131]
s_waitcnt lgkmcnt(4)
v_mov_b32 v201, v199
s_nop 0
v_permlane32_swap_b32 v198, v200
v_mfma_f32_16x16x32_bf16 v[116:119], a[160:163], a[56:59], v[116:119]
ds_read_b128 a[152:155], v209 offset:10240
ds_read_b128 a[156:159], v209 offset:28672
v_permlane32_swap_b32 v199, v201
v_mfma_f32_16x16x32_bf16 v[120:123], a[160:163], a[60:63], v[120:123]
v_add_f32 v198, v198, v200
v_add_f32 v199, v199, v201
v_mfma_f32_16x16x32_bf16 v[124:127], a[164:167], a[56:59], v[124:127]
s_waitcnt vmcnt(20)
s_mov_b32 exec_hi, 0
buffer_store_dwordx2 v[198:199], v239, s[8:11], s30 offen sc1
s_mov_b64 exec, -1
v_mfma_f32_16x16x32_bf16 v[128:131], a[164:167], a[60:63], v[128:131]
s_waitcnt lgkmcnt(4)
v_mfma_f32_16x16x32_bf16 v[116:119], a[168:171], a[64:67], v[116:119]
ds_read_b128 a[160:163], v209 offset:11264
ds_read_b128 a[164:167], v209 offset:29696
v_mfma_f32_16x16x32_bf16 v[120:123], a[168:171], a[68:71], v[120:123]
v_mfma_f32_16x16x32_bf16 v[124:127], a[172:175], a[64:67], v[124:127]
v_mfma_f32_16x16x32_bf16 v[128:131], a[172:175], a[68:71], v[128:131]
s_waitcnt lgkmcnt(4)
v_mfma_f32_16x16x32_bf16 v[116:119], a[144:147], a[72:75], v[116:119]
ds_read_b128 a[168:171], v209 offset:12288
ds_read_b128 a[172:175], v209 offset:30720
v_mfma_f32_16x16x32_bf16 v[120:123], a[144:147], a[76:79], v[120:123]
v_mfma_f32_16x16x32_bf16 v[124:127], a[148:151], a[72:75], v[124:127]
v_mfma_f32_16x16x32_bf16 v[128:131], a[148:151], a[76:79], v[128:131]
s_waitcnt lgkmcnt(4)
v_mfma_f32_16x16x32_bf16 v[116:119], a[152:155], a[80:83], v[116:119]
ds_read_b128 a[144:147], v209 offset:13312
ds_read_b128 a[148:151], v209 offset:31744
v_mfma_f32_16x16x32_bf16 v[120:123], a[152:155], a[84:87], v[120:123]
v_mfma_f32_16x16x32_bf16 v[124:127], a[156:159], a[80:83], v[124:127]
v_mfma_f32_16x16x32_bf16 v[128:131], a[156:159], a[84:87], v[128:131]
s_waitcnt lgkmcnt(4)
v_mfma_f32_16x16x32_bf16 v[116:119], a[160:163], a[88:91], v[116:119]
ds_read_b128 a[152:155], v209 offset:14336
ds_read_b128 a[156:159], v209 offset:32768
v_mfma_f32_16x16x32_bf16 v[120:123], a[160:163], a[92:95], v[120:123]
v_mfma_f32_16x16x32_bf16 v[124:127], a[164:167], a[88:91], v[124:127]
v_mfma_f32_16x16x32_bf16 v[128:131], a[164:167], a[92:95], v[128:131]
s_waitcnt lgkmcnt(4)
v_mfma_f32_16x16x32_bf16 v[116:119], a[168:171], a[96:99], v[116:119]
ds_read_b128 a[160:163], v209 offset:15360
ds_read_b128 a[164:167], v209 offset:33792
v_mfma_f32_16x16x32_bf16 v[120:123], a[168:171], a[100:103], v[120:123]
v_mfma_f32_16x16x32_bf16 v[124:127], a[172:175], a[96:99], v[124:127]
v_mfma_f32_16x16x32_bf16 v[128:131], a[172:175], a[100:103], v[128:131]
s_waitcnt lgkmcnt(4)
v_mfma_f32_16x16x32_bf16 v[116:119], a[144:147], a[104:107], v[116:119]
ds_read_b128 a[168:171], v209 offset:16384
ds_read_b128 a[172:175], v209 offset:34816
v_mfma_f32_16x16x32_bf16 v[120:123], a[144:147], a[108:111], v[120:123]
v_mfma_f32_16x16x32_bf16 v[124:127], a[148:151], a[104:107], v[124:127]
v_mfma_f32_16x16x32_bf16 v[128:131], a[148:151], a[108:111], v[128:131]
s_waitcnt lgkmcnt(4)
v_mfma_f32_16x16x32_bf16 v[116:119], a[152:155], a[112:115], v[116:119]
ds_read_b128 a[144:147], v209 offset:17408
ds_read_b128 a[148:151], v209 offset:35840
v_mfma_f32_16x16x32_bf16 v[120:123], a[152:155], a[116:119], v[120:123]
v_mfma_f32_16x16x32_bf16 v[124:127], a[156:159], a[112:115], v[124:127]
v_mfma_f32_16x16x32_bf16 v[128:131], a[156:159], a[116:119], v[128:131]
s_waitcnt lgkmcnt(4)
v_add_u32 v181, 36864, v239
v_mfma_f32_16x16x32_bf16 v[116:119], a[160:163], a[120:123], v[116:119]
ds_read_b64 a[152:153], v181 offset:0
ds_read_b64 a[156:157], v181 offset:512
v_mfma_f32_16x16x32_bf16 v[120:123], a[160:163], a[124:127], v[120:123]
v_mfma_f32_16x16x32_bf16 v[124:127], a[164:167], a[120:123], v[124:127]
v_mfma_f32_16x16x32_bf16 v[128:131], a[164:167], a[124:127], v[128:131]
s_waitcnt lgkmcnt(4)
v_mfma_f32_16x16x32_bf16 v[116:119], a[168:171], a[128:131], v[116:119]
ds_read_b128 a[160:163], v210 offset:0
ds_read_b128 a[164:167], v210 offset:18432
v_mfma_f32_16x16x32_bf16 v[120:123], a[168:171], a[132:135], v[120:123]
buffer_load_dwordx2 v[182:183], v234, s[8:11], s61 offen offset:0 sc1
v_mfma_f32_16x16x32_bf16 v[124:127], a[172:175], a[128:131], v[124:127]
buffer_load_dwordx2 v[184:185], v234, s[8:11], s61 offen offset:1024 sc1
v_mfma_f32_16x16x32_bf16 v[128:131], a[172:175], a[132:135], v[128:131]
s_waitcnt lgkmcnt(4)
v_mfma_f32_16x16x32_bf16 v[116:119], a[144:147], a[136:139], v[116:119]
ds_read_b128 a[168:171], v210 offset:1024
ds_read_b128 a[172:175], v210 offset:19456
v_mfma_f32_16x16x32_bf16 v[120:123], a[144:147], a[140:143], v[120:123]
buffer_load_dwordx2 v[186:187], v234, s[8:11], s61 offen offset:2048 sc1
v_mfma_f32_16x16x32_bf16 v[124:127], a[148:151], a[136:139], v[124:127]
buffer_load_dwordx2 v[188:189], v234, s[8:11], s61 offen offset:3072 sc1
v_mfma_f32_16x16x32_bf16 v[128:131], a[148:151], a[140:143], v[128:131]
s_waitcnt lgkmcnt(4)
v_mfma_f32_16x16x16_bf16 v[116:119], a[152:153], v[212:213], v[116:119]
ds_read_b128 a[144:147], v210 offset:2048
ds_read_b128 a[148:151], v210 offset:20480
v_mfma_f32_16x16x16_bf16 v[120:123], a[152:153], v[214:215], v[120:123]
buffer_load_dwordx2 v[190:191], v235, s[8:11], s61 offen offset:0 sc1
v_mfma_f32_16x16x16_bf16 v[124:127], a[156:157], v[212:213], v[124:127]
buffer_load_dwordx2 v[192:193], v235, s[8:11], s61 offen offset:1024 sc1
v_mfma_f32_16x16x16_bf16 v[128:131], a[156:157], v[214:215], v[128:131]
s_waitcnt vmcnt(17) lgkmcnt(4)
s_barrier
v_mfma_f32_16x16x32_bf16 v[132:135], a[160:163], a[0:3], 0
ds_read_b128 a[152:155], v210 offset:3072
ds_read_b128 a[156:159], v210 offset:21504
v_mfma_f32_16x16x32_bf16 v[136:139], a[160:163], a[4:7], 0
buffer_load_dwordx2 v[194:195], v235, s[8:11], s61 offen offset:2048 sc1
s_mov_b32 s37, L_c4-L_pc
v_mfma_f32_16x16x32_bf16 v[140:143], a[164:167], a[0:3], 0
buffer_load_dwordx2 v[196:197], v235, s[8:11], s61 offen offset:3072 sc1
v_mfma_f32_16x16x32_bf16 v[144:147], a[164:167], a[4:7], 0
s_waitcnt lgkmcnt(4)
v_mfma_f32_16x16x32_bf16 v[132:135], a[168:171], a[8:11], v[132:135]
ds_read_b128 a[160:163], v210 offset:4096
ds_read_b128 a[164:167], v210 offset:22528
v_mfma_f32_16x16x32_bf16 v[136:139], a[168:171], a[12:15], v[136:139]
buffer_load_dword v15, v14, s[88:91], s37 offen
v_mfma_f32_16x16x32_bf16 v[140:143], a[172:175], a[8:11], v[140:143]
v_mfma_f32_16x16x32_bf16 v[144:147], a[172:175], a[12:15], v[144:147]
s_waitcnt lgkmcnt(4)
v_mfma_f32_16x16x32_bf16 v[132:135], a[144:147], a[16:19], v[132:135]
ds_read_b128 a[168:171], v210 offset:5120
ds_read_b128 a[172:175], v210 offset:23552
v_mfma_f32_16x16x32_bf16 v[136:139], a[144:147], a[20:23], v[136:139]
v_mfma_f32_16x16x32_bf16 v[140:143], a[148:151], a[16:19], v[140:143]
v_mfma_f32_16x16x32_bf16 v[144:147], a[148:151], a[20:23], v[144:147]
s_waitcnt lgkmcnt(4)
v_mfma_f32_16x16x32_bf16 v[132:135], a[152:155], a[24:27], v[132:135]
ds_read_b128 a[144:147], v210 offset:6144
ds_read_b128 a[148:151], v210 offset:24576
v_mfma_f32_16x16x32_bf16 v[136:139], a[152:155], a[28:31], v[136:139]
v_mfma_f32_16x16x32_bf16 v[140:143], a[156:159], a[24:27], v[140:143]
v_mfma_f32_16x16x32_bf16 v[144:147], a[156:159], a[28:31], v[144:147]
s_waitcnt lgkmcnt(4)
v_mfma_f32_16x16x32_bf16 v[132:135], a[160:163], a[32:35], v[132:135]
ds_read_b128 a[152:155], v210 offset:7168
ds_read_b128 a[156:159], v210 offset:25600
v_mfma_f32_16x16x32_bf16 v[136:139], a[160:163], a[36:39], v[136:139]
v_mfma_f32_16x16x32_bf16 v[140:143], a[164:167], a[32:35], v[140:143]
v_mfma_f32_16x16x32_bf16 v[144:147], a[164:167], a[36:39], v[144:147]
s_waitcnt lgkmcnt(4)
v_mfma_f32_16x16x32_bf16 v[132:135], a[168:171], a[40:43], v[132:135]
ds_read_b128 a[160:163], v210 offset:8192
ds_read_b128 a[164:167], v210 offset:26624
v_mfma_f32_16x16x32_bf16 v[136:139], a[168:171], a[44:47], v[136:139]
v_mfma_f32_16x16x32_bf16 v[140:143], a[172:175], a[40:43], v[140:143]
v_mfma_f32_16x16x32_bf16 v[144:147], a[172:175], a[44:47], v[144:147]
s_waitcnt lgkmcnt(4)
v_mfma_f32_16x16x32_bf16 v[132:135], a[144:147], a[48:51], v[132:135]
ds_read_b128 a[168:171], v210 offset:9216
ds_read_b128 a[172:175], v210 offset:27648
v_mfma_f32_16x16x32_bf16 v[136:139], a[144:147], a[52:55], v[136:139]
v_mfma_f32_16x16x32_bf16 v[140:143], a[148:151], a[48:51], v[140:143]
v_mfma_f32_16x16x32_bf16 v[144:147], a[148:151], a[52:55], v[144:147]
s_waitcnt lgkmcnt(4)
v_mfma_f32_16x16x32_bf16 v[132:135], a[152:155], a[56:59], v[132:135]
ds_read_b128 a[144:147], v210 offset:10240
ds_read_b128 a[148:151], v210 offset:28672
v_mfma_f32_16x16x32_bf16 v[136:139], a[152:155], a[60:63], v[136:139]
v_mfma_f32_16x16x32_bf16 v[140:143], a[156:159], a[56:59], v[140:143]
v_mfma_f32_16x16x32_bf16 v[144:147], a[156:159], a[60:63], v[144:147]
s_waitcnt lgkmcnt(4)
v_mfma_f32_16x16x32_bf16 v[132:135], a[160:163], a[64:67], v[132:135]
ds_read_b128 a[152:155], v210 offset:11264
ds_read_b128 a[156:159], v210 offset:29696
v_mfma_f32_16x16x32_bf16 v[136:139], a[160:163], a[68:71], v[136:139]
v_mfma_f32_16x16x32_bf16 v[140:143], a[164:167], a[64:67], v[140:143]
v_mfma_f32_16x16x32_bf16 v[144:147], a[164:167], a[68:71], v[144:147]
s_waitcnt lgkmcnt(4)
v_mfma_f32_16x16x32_bf16 v[132:135], a[168:171], a[72:75], v[132:135]
ds_read_b128 a[160:163], v210 offset:12288
ds_read_b128 a[164:167], v210 offset:30720
v_mfma_f32_16x16x32_bf16 v[136:139], a[168:171], a[76:79], v[136:139]
v_mfma_f32_16x16x32_bf16 v[140:143], a[172:175], a[72:75], v[140:143]
s_waitcnt vmcnt(1)
v_min3_f32 v200, v183, v185, v187
v_mfma_f32_16x16x32_bf16 v[144:147], a[172:175], a[76:79], v[144:147]
s_waitcnt lgkmcnt(4)
v_min3_f32 v201, v189, v191, v193
v_mfma_f32_16x16x32_bf16 v[132:135], a[144:147], a[80:83], v[132:135]
ds_read_b128 a[168:171], v210 offset:13312
ds_read_b128 a[172:175], v210 offset:31744
v_mfma_f32_16x16x32_bf16 v[136:139], a[144:147], a[84:87], v[136:139]
v_min3_f32 v200, v200, v195, v197
v_min_f32 v200, v200, v201
v_mfma_f32_16x16x32_bf16 v[140:143], a[148:151], a[80:83], v[140:143]
v_cmp_gt_f32 vcc, 0, v200
v_mfma_f32_16x16x32_bf16 v[144:147], a[148:151], a[84:87], v[144:147]
s_waitcnt lgkmcnt(4)
s_nop 0
s_cbranch_vccnz L_stzslow_23
L_stzback_24:
v_mfma_f32_16x16x32_bf16 v[132:135], a[152:155], a[88:91], v[132:135]
ds_read_b128 a[144:147], v210 offset:14336
ds_read_b128 a[148:151], v210 offset:32768
v_mfma_f32_16x16x32_bf16 v[136:139], a[152:155], a[92:95], v[136:139]
v_add_f32 v198, v182, v184
v_add_f32 v199, v183, v185
v_mfma_f32_16x16x32_bf16 v[140:143], a[156:159], a[88:91], v[140:143]
buffer_load_dwordx4 a[176:179], v1, s[4:7], s52 offen offset:0 sc1
buffer_load_dwordx4 a[180:183], v9, s[4:7], s52 offen offset:0 sc1
v_add_f32 v198, v198, v186
v_add_f32 v199, v199, v187
v_mfma_f32_16x16x32_bf16 v[144:147], a[156:159], a[92:95], v[144:147]
s_waitcnt lgkmcnt(4)
v_add_f32 v198, v198, v188
v_add_f32 v199, v199, v189
v_mfma_f32_16x16x32_bf16 v[132:135], a[160:163], a[96:99], v[132:135]
ds_read_b128 a[152:155], v210 offset:15360
ds_read_b128 a[156:159], v210 offset:33792
v_add_f32 v198, v198, v190
v_mfma_f32_16x16x32_bf16 v[136:139], a[160:163], a[100:103], v[136:139]
v_add_f32 v199, v199, v191
v_add_f32 v198, v198, v192
v_mfma_f32_16x16x32_bf16 v[140:143], a[164:167], a[96:99], v[140:143]
buffer_load_dwordx4 a[184:187], v1, s[4:7], s52 offen offset:1024 sc1
buffer_load_dwordx4 a[188:191], v9, s[4:7], s52 offen offset:1024 sc1
v_add_f32 v199, v199, v193
v_add_f32 v198, v198, v194
v_mfma_f32_16x16x32_bf16 v[144:147], a[164:167], a[100:103], v[144:147]
s_waitcnt lgkmcnt(4)
v_add_f32 v199, v199, v195
v_add_f32 v198, v198, v196
v_mfma_f32_16x16x32_bf16 v[132:135], a[168:171], a[104:107], v[132:135]
ds_read_b128 a[160:163], v210 offset:16384
ds_read_b128 a[164:167], v210 offset:34816
v_add_f32 v199, v199, v197
v_mfma_f32_16x16x32_bf16 v[136:139], a[168:171], a[108:111], v[136:139]
v_mov_b32 v200, v198
v_mov_b32 v201, v199
v_mfma_f32_16x16x32_bf16 v[140:143], a[172:175], a[104:107], v[140:143]
s_nop 0
v_permlane32_swap_b32 v198, v200
v_mfma_f32_16x16x32_bf16 v[144:147], a[172:175], a[108:111], v[144:147]
s_waitcnt lgkmcnt(4)
v_permlane32_swap_b32 v199, v201
v_mfma_f32_16x16x32_bf16 v[132:135], a[144:147], a[112:115], v[132:135]
ds_read_b128 a[168:171], v210 offset:17408
ds_read_b128 a[172:175], v210 offset:35840
v_mfma_f32_16x16x32_bf16 v[136:139], a[144:147], a[116:119], v[136:139]
buffer_load_dwordx4 a[192:195], v1, s[4:7], s52 offen offset:2048 sc1
buffer_load_dwordx4 a[196:199], v9, s[4:7], s52 offen offset:2048 sc1
v_add_f32 v198, v198, v200
v_add_f32 v199, v199, v201
v_mfma_f32_16x16x32_bf16 v[140:143], a[148:151], a[112:115], v[140:143]
v_mul_f32 v198, 0x39e38e39, v198
v_mul_f32 v200, v198, v198
v_mfma_f32_16x16x32_bf16 v[144:147], a[148:151], a[116:119], v[144:147]
s_waitcnt lgkmcnt(4)
v_mul_f32 v199, 0x39e38e39, v199
v_add_u32 v181, 74752, v239
v_mfma_f32_16x16x32_bf16 v[132:135], a[152:155], a[120:123], v[132:135]
ds_read_b64 a[144:145], v181 offset:0
ds_read_b64 a[148:149], v181 offset:512
v_sub_f32 v199, v199, v200
v_max_f32 v199, 0, v199
v_mfma_f32_16x16x32_bf16 v[136:139], a[152:155], a[124:127], v[136:139]
buffer_load_dwordx4 a[200:203], v1, s[4:7], s52 offen offset:3072 sc1
buffer_load_dwordx4 a[204:207], v9, s[4:7], s52 offen offset:3072 sc1
v_add_f32 v199, 0x3727c5ac, v199
v_rsq_f32 v202, v199
v_mfma_f32_16x16x32_bf16 v[140:143], a[156:159], a[120:123], v[140:143]
s_nop 0
v_mul_f32 v204, v198, v202
v_mfma_f32_16x16x32_bf16 v[144:147], a[156:159], a[124:127], v[144:147]
s_waitcnt lgkmcnt(4)
v_mov_b32 v203, v202
v_mov_b32 v205, v204
v_mfma_f32_16x16x32_bf16 v[132:135], a[160:163], a[128:131], v[132:135]
ds_read_b128 a[152:155], v211 offset:0
ds_read_b128 a[156:159], v211 offset:18432
v_mfma_f32_16x16x32_bf16 v[136:139], a[160:163], a[132:135], v[136:139]
s_nop 0
s_mov_b32 s52, s53
v_permlane16_swap_b32 v202, v203
v_mfma_f32_16x16x32_bf16 v[140:143], a[164:167], a[128:131], v[140:143]
s_cmp_eq_u32 s25, 0
s_cselect_b32 s98, 4096, 0
v_mfma_f32_16x16x32_bf16 v[144:147], a[164:167], a[132:135], v[144:147]
s_waitcnt lgkmcnt(4)
v_permlane16_swap_b32 v204, v205
v_mfma_f32_16x16x32_bf16 v[132:135], a[168:171], a[136:139], v[132:135]
ds_read_b128 a[160:163], v211 offset:1024
ds_read_b128 a[164:167], v211 offset:19456
v_fma_f32 v36, v36, v202, -v204
v_fma_f32 v37, v37, v202, -v204
v_mfma_f32_16x16x32_bf16 v[136:139], a[168:171], a[140:143], v[136:139]
s_add_u32 s52, s52, s98
v_fma_f32 v38, v38, v202, -v204
v_fma_f32 v39, v39, v202, -v204
v_mfma_f32_16x16x32_bf16 v[140:143], a[172:175], a[136:139], v[140:143]
v_fma_f32 v44, v44, v202, -v204
v_fma_f32 v45, v45, v202, -v204
v_mfma_f32_16x16x32_bf16 v[144:147], a[172:175], a[140:143], v[144:147]
s_waitcnt lgkmcnt(4)
v_fma_f32 v46, v46, v202, -v204
v_fma_f32 v47, v47, v202, -v204
v_mfma_f32_16x16x16_bf16 v[132:135], a[144:145], v[212:213], v[132:135]
ds_read_b128 a[168:171], v211 offset:2048
ds_read_b128 a[172:175], v211 offset:20480
v_cvt_pk_bf16_f32 v216, v36, v37
v_mfma_f32_16x16x16_bf16 v[136:139], a[144:145], v[214:215], v[136:139]
buffer_load_dwordx4 a[208:211], v1, s[4:7], s52 offen offset:0 sc1
buffer_load_dwordx4 a[212:215], v9, s[4:7], s52 offen offset:0 sc1
v_cvt_pk_bf16_f32 v217, v38, v39
v_cvt_pk_bf16_f32 v218, v44, v45
v_mfma_f32_16x16x16_bf16 v[140:143], a[148:149], v[212:213], v[140:143]
v_cvt_pk_bf16_f32 v219, v46, v47
v_mfma_f32_16x16x16_bf16 v[144:147], a[148:149], v[214:215], v[144:147]
s_waitcnt lgkmcnt(4)
s_barrier
v_mfma_f32_16x16x32_bf16 v[148:151], a[152:155], a[0:3], 0
ds_read_b128 a[144:147], v211 offset:3072
ds_read_b128 a[148:151], v211 offset:21504
v_mfma_f32_16x16x32_bf16 v[152:155], a[152:155], a[4:7], 0
ds_write_b128 v236, v[216:219] offset:0
v_fma_f32 v40, v40, v203, -v205
v_fma_f32 v41, v41, v203, -v205
v_fma_f32 v42, v42, v203, -v205
v_fma_f32 v43, v43, v203, -v205
v_fma_f32 v48, v48, v203, -v205
v_mfma_f32_16x16x32_bf16 v[156:159], a[156:159], a[0:3], 0
buffer_load_dwordx4 a[216:219], v1, s[4:7], s52 offen offset:1024 sc1
buffer_load_dwordx4 a[220:223], v9, s[4:7], s52 offen offset:1024 sc1
v_fma_f32 v49, v49, v203, -v205
v_mfma_f32_16x16x32_bf16 v[160:163], a[156:159], a[4:7], 0
s_waitcnt lgkmcnt(5)
v_fma_f32 v50, v50, v203, -v205
v_fma_f32 v51, v51, v203, -v205
v_mfma_f32_16x16x32_bf16 v[148:151], a[160:163], a[8:11], v[148:151]
ds_read_b128 a[152:155], v211 offset:4096
ds_read_b128 a[156:159], v211 offset:22528
v_cvt_pk_bf16_f32 v220, v40, v41
v_cvt_pk_bf16_f32 v221, v42, v43
v_mfma_f32_16x16x32_bf16 v[152:155], a[160:163], a[12:15], v[152:155]
v_cvt_pk_bf16_f32 v222, v48, v49
v_cvt_pk_bf16_f32 v223, v50, v51
ds_write_b128 v236, v[220:223] offset:4608
v_mfma_f32_16x16x32_bf16 v[156:159], a[164:167], a[8:11], v[156:159]
buffer_load_dwordx4 a[224:227], v1, s[4:7], s52 offen offset:2048 sc1
buffer_load_dwordx4 a[228:231], v9, s[4:7], s52 offen offset:2048 sc1
v_mfma_f32_16x16x32_bf16 v[160:163], a[164:167], a[12:15], v[160:163]
s_waitcnt lgkmcnt(6)
v_fma_f32 v52, v52, v202, -v204
v_fma_f32 v53, v53, v202, -v204
v_mfma_f32_16x16x32_bf16 v[148:151], a[168:171], a[16:19], v[148:151]
ds_read_b128 a[160:163], v211 offset:5120
ds_read_b128 a[164:167], v211 offset:23552
v_fma_f32 v54, v54, v202, -v204
v_mfma_f32_16x16x32_bf16 v[152:155], a[168:171], a[20:23], v[152:155]
ds_read_b64_tr_b16 v[36:37], v237 offset:0
v_fma_f32 v55, v55, v202, -v204
v_mfma_f32_16x16x32_bf16 v[156:159], a[172:175], a[16:19], v[156:159]
ds_read_b64_tr_b16 v[38:39], v237 offset:1152
v_fma_f32 v60, v60, v202, -v204
v_mfma_f32_16x16x32_bf16 v[160:163], a[172:175], a[20:23], v[160:163]
s_waitcnt lgkmcnt(8)
v_mfma_f32_16x16x32_bf16 v[148:151], a[144:147], a[24:27], v[148:151]
ds_read_b128 a[168:171], v211 offset:6144
ds_read_b128 a[172:175], v211 offset:24576
v_mfma_f32_16x16x32_bf16 v[152:155], a[144:147], a[28:31], v[152:155]
ds_read_b64_tr_b16 v[40:41], v237 offset:8
v_fma_f32 v61, v61, v202, -v204
v_mfma_f32_16x16x32_bf16 v[156:159], a[148:151], a[24:27], v[156:159]
ds_read_b64_tr_b16 v[42:43], v237 offset:1160
v_fma_f32 v62, v62, v202, -v204
v_fma_f32 v63, v63, v202, -v204
v_cvt_pk_bf16_f32 v224, v52, v53
v_mfma_f32_16x16x32_bf16 v[160:163], a[148:151], a[28:31], v[160:163]
s_waitcnt lgkmcnt(9)
buffer_load_dwordx4 a[232:235], v1, s[4:7], s52 offen offset:3072 sc1
buffer_load_dwordx4 a[236:239], v9, s[4:7], s52 offen offset:3072 sc1
v_cvt_pk_bf16_f32 v225, v54, v55
v_mfma_f32_16x16x32_bf16 v[148:151], a[152:155], a[32:35], v[148:151]
ds_read_b128 a[144:147], v211 offset:7168
ds_read_b128 a[148:151], v211 offset:25600
v_cvt_pk_bf16_f32 v226, v60, v61
v_cvt_pk_bf16_f32 v227, v62, v63
v_mfma_f32_16x16x32_bf16 v[152:155], a[152:155], a[36:39], v[152:155]
s_waitcnt lgkmcnt(6)
buffer_store_dwordx4 v[36:39], v1, s[8:11], s66 offen offset:0 sc1
ds_write_b128 v236, v[224:227] offset:64
v_mfma_f32_16x16x32_bf16 v[156:159], a[156:159], a[32:35], v[156:159]
v_fma_f32 v56, v56, v203, -v205
v_fma_f32 v57, v57, v203, -v205
v_mfma_f32_16x16x32_bf16 v[160:163], a[156:159], a[36:39], v[160:163]
v_fma_f32 v58, v58, v203, -v205
v_mfma_f32_16x16x32_bf16 v[148:151], a[160:163], a[40:43], v[148:151]
ds_read_b128 a[152:155], v211 offset:8192
ds_read_b128 a[156:159], v211 offset:26624
v_mfma_f32_16x16x32_bf16 v[152:155], a[160:163], a[44:47], v[152:155]
v_fma_f32 v59, v59, v203, -v205
v_fma_f32 v64, v64, v203, -v205
v_mfma_f32_16x16x32_bf16 v[156:159], a[164:167], a[40:43], v[156:159]
v_fma_f32 v65, v65, v203, -v205
v_fma_f32 v66, v66, v203, -v205
v_mfma_f32_16x16x32_bf16 v[160:163], a[164:167], a[44:47], v[160:163]
s_waitcnt lgkmcnt(7)
v_fma_f32 v67, v67, v203, -v205
v_mfma_f32_16x16x32_bf16 v[148:151], a[168:171], a[48:51], v[148:151]
ds_read_b128 a[160:163], v211 offset:9216
ds_read_b128 a[164:167], v211 offset:27648
v_mfma_f32_16x16x32_bf16 v[152:155], a[168:171], a[52:55], v[152:155]
v_cvt_pk_bf16_f32 v228, v56, v57
v_cvt_pk_bf16_f32 v229, v58, v59
v_mfma_f32_16x16x32_bf16 v[156:159], a[172:175], a[48:51], v[156:159]
v_cvt_pk_bf16_f32 v230, v64, v65
v_cvt_pk_bf16_f32 v231, v66, v67
v_mfma_f32_16x16x32_bf16 v[160:163], a[172:175], a[52:55], v[160:163]
s_waitcnt lgkmcnt(5)
v_mfma_f32_16x16x32_bf16 v[148:151], a[144:147], a[56:59], v[148:151]
ds_read_b128 a[168:171], v211 offset:10240
ds_read_b128 a[172:175], v211 offset:28672
v_mfma_f32_16x16x32_bf16 v[152:155], a[144:147], a[60:63], v[152:155]
buffer_store_dwordx4 v[40:43], v1, s[8:11], s66 offen offset:1024 sc1
ds_write_b128 v236, v[228:231] offset:4672
v_mfma_f32_16x16x32_bf16 v[156:159], a[148:151], a[56:59], v[156:159]
v_fma_f32 v68, v68, v202, -v204
v_fma_f32 v69, v69, v202, -v204
v_mfma_f32_16x16x32_bf16 v[160:163], a[148:151], a[60:63], v[160:163]
s_waitcnt lgkmcnt(5)
v_fma_f32 v70, v70, v202, -v204
v_mfma_f32_16x16x32_bf16 v[148:151], a[152:155], a[64:67], v[148:151]
ds_read_b128 a[144:147], v211 offset:11264
ds_read_b128 a[148:151], v211 offset:29696
v_mfma_f32_16x16x32_bf16 v[152:155], a[152:155], a[68:71], v[152:155]
ds_read_b64_tr_b16 v[52:53], v237 offset:64
v_fma_f32 v71, v71, v202, -v204
v_mfma_f32_16x16x32_bf16 v[156:159], a[156:159], a[64:67], v[156:159]
ds_read_b64_tr_b16 v[54:55], v237 offset:1216
v_fma_f32 v76, v76, v202, -v204
v_mfma_f32_16x16x32_bf16 v[160:163], a[156:159], a[68:71], v[160:163]
s_waitcnt lgkmcnt(7)
v_mfma_f32_16x16x32_bf16 v[148:151], a[160:163], a[72:75], v[148:151]
ds_read_b128 a[152:155], v211 offset:12288
ds_read_b128 a[156:159], v211 offset:30720
v_mfma_f32_16x16x32_bf16 v[152:155], a[160:163], a[76:79], v[152:155]
ds_read_b64_tr_b16 v[56:57], v237 offset:72
v_fma_f32 v77, v77, v202, -v204
v_mfma_f32_16x16x32_bf16 v[156:159], a[164:167], a[72:75], v[156:159]
ds_read_b64_tr_b16 v[58:59], v237 offset:1224
v_fma_f32 v78, v78, v202, -v204
v_fma_f32 v79, v79, v202, -v204
v_cvt_pk_bf16_f32 v216, v68, v69
v_mfma_f32_16x16x32_bf16 v[160:163], a[164:167], a[76:79], v[160:163]
s_waitcnt lgkmcnt(9)
v_cvt_pk_bf16_f32 v217, v70, v71
v_cvt_pk_bf16_f32 v218, v76, v77
v_mfma_f32_16x16x32_bf16 v[148:151], a[168:171], a[80:83], v[148:151]
ds_read_b128 a[160:163], v211 offset:13312
ds_read_b128 a[164:167], v211 offset:31744
v_cvt_pk_bf16_f32 v219, v78, v79
v_mfma_f32_16x16x32_bf16 v[152:155], a[168:171], a[84:87], v[152:155]
s_waitcnt lgkmcnt(6)
buffer_store_dwordx4 v[52:55], v1, s[8:11], s66 offen offset:2048 sc1
ds_write_b128 v236, v[216:219] offset:128
v_mfma_f32_16x16x32_bf16 v[156:159], a[172:175], a[80:83], v[156:159]
v_fma_f32 v72, v72, v203, -v205
v_fma_f32 v73, v73, v203, -v205
v_mfma_f32_16x16x32_bf16 v[160:163], a[172:175], a[84:87], v[160:163]
v_fma_f32 v74, v74, v203, -v205
v_mfma_f32_16x16x32_bf16 v[148:151], a[144:147], a[88:91], v[148:151]
ds_read_b128 a[168:171], v211 offset:14336
ds_read_b128 a[172:175], v211 offset:32768
v_mfma_f32_16x16x32_bf16 v[152:155], a[144:147], a[92:95], v[152:155]
v_fma_f32 v75, v75, v203, -v205
v_fma_f32 v80, v80, v203, -v205
v_mfma_f32_16x16x32_bf16 v[156:159], a[148:151], a[88:91], v[156:159]
v_fma_f32 v81, v81, v203, -v205
v_fma_f32 v82, v82, v203, -v205
v_mfma_f32_16x16x32_bf16 v[160:163], a[148:151], a[92:95], v[160:163]
s_waitcnt lgkmcnt(7)
v_fma_f32 v83, v83, v203, -v205
v_mfma_f32_16x16x32_bf16 v[148:151], a[152:155], a[96:99], v[148:151]
ds_read_b128 a[144:147], v211 offset:15360
ds_read_b128 a[148:151], v211 offset:33792
v_mfma_f32_16x16x32_bf16 v[152:155], a[152:155], a[100:103], v[152:155]
v_cvt_pk_bf16_f32 v220, v72, v73
v_cvt_pk_bf16_f32 v221, v74, v75
v_mfma_f32_16x16x32_bf16 v[156:159], a[156:159], a[96:99], v[156:159]
v_cvt_pk_bf16_f32 v222, v80, v81
v_cvt_pk_bf16_f32 v223, v82, v83
v_mfma_f32_16x16x32_bf16 v[160:163], a[156:159], a[100:103], v[160:163]
s_waitcnt lgkmcnt(5)
v_mfma_f32_16x16x32_bf16 v[148:151], a[160:163], a[104:107], v[148:151]
ds_read_b128 a[152:155], v211 offset:16384
ds_read_b128 a[156:159], v211 offset:34816
v_mfma_f32_16x16x32_bf16 v[152:155], a[160:163], a[108:111], v[152:155]
buffer_store_dwordx4 v[56:59], v1, s[8:11], s66 offen offset:3072 sc1
ds_write_b128 v236, v[220:223] offset:4736
v_mfma_f32_16x16x32_bf16 v[156:159], a[164:167], a[104:107], v[156:159]
v_fma_f32 v84, v84, v202, -v204
v_fma_f32 v85, v85, v202, -v204
v_mfma_f32_16x16x32_bf16 v[160:163], a[164:167], a[108:111], v[160:163]
s_waitcnt lgkmcnt(5)
v_fma_f32 v86, v86, v202, -v204
v_mfma_f32_16x16x32_bf16 v[148:151], a[168:171], a[112:115], v[148:151]
ds_read_b128 a[160:163], v211 offset:17408
ds_read_b128 a[164:167], v211 offset:35840
v_mfma_f32_16x16x32_bf16 v[152:155], a[168:171], a[116:119], v[152:155]
ds_read_b64_tr_b16 v[68:69], v237 offset:128
v_fma_f32 v87, v87, v202, -v204
v_mfma_f32_16x16x32_bf16 v[156:159], a[172:175], a[112:115], v[156:159]
ds_read_b64_tr_b16 v[70:71], v237 offset:1280
v_fma_f32 v92, v92, v202, -v204
v_mfma_f32_16x16x32_bf16 v[160:163], a[172:175], a[116:119], v[160:163]
s_waitcnt lgkmcnt(7)
v_add_u32 v181, 112640, v239
v_mfma_f32_16x16x32_bf16 v[148:151], a[144:147], a[120:123], v[148:151]
ds_read_b64 a[168:169], v181 offset:0
ds_read_b64 a[172:173], v181 offset:512
v_mfma_f32_16x16x32_bf16 v[152:155], a[144:147], a[124:127], v[152:155]
ds_read_b64_tr_b16 v[72:73], v237 offset:136
v_fma_f32 v93, v93, v202, -v204
v_mfma_f32_16x16x32_bf16 v[156:159], a[148:151], a[120:123], v[156:159]
ds_read_b64_tr_b16 v[74:75], v237 offset:1288
v_fma_f32 v94, v94, v202, -v204
v_fma_f32 v95, v95, v202, -v204
v_cvt_pk_bf16_f32 v224, v84, v85
v_mfma_f32_16x16x32_bf16 v[160:163], a[148:151], a[124:127], v[160:163]
s_waitcnt lgkmcnt(9)
v_cvt_pk_bf16_f32 v225, v86, v87
v_cvt_pk_bf16_f32 v226, v92, v93
v_mfma_f32_16x16x32_bf16 v[148:151], a[152:155], a[128:131], v[148:151]
ds_read_b128 a[144:147], v208 offset:0
ds_read_b128 a[148:151], v208 offset:18432
v_cvt_pk_bf16_f32 v227, v94, v95
s_add_u32 s66, s66, 4096
v_mfma_f32_16x16x32_bf16 v[152:155], a[152:155], a[132:135], v[152:155]
s_waitcnt lgkmcnt(6)
buffer_store_dwordx4 v[68:71], v1, s[8:11], s66 offen offset:0 sc1
ds_write_b128 v236, v[224:227] offset:192
v_mfma_f32_16x16x32_bf16 v[156:159], a[156:159], a[128:131], v[156:159]
v_fma_f32 v88, v88, v203, -v205
v_fma_f32 v89, v89, v203, -v205
v_mfma_f32_16x16x32_bf16 v[160:163], a[156:159], a[132:135], v[160:163]
v_fma_f32 v90, v90, v203, -v205
v_mfma_f32_16x16x32_bf16 v[148:151], a[160:163], a[136:139], v[148:151]
ds_read_b128 a[152:155], v208 offset:1024
ds_read_b128 a[156:159], v208 offset:19456
v_mfma_f32_16x16x32_bf16 v[152:155], a[160:163], a[140:143], v[152:155]
v_fma_f32 v91, v91, v203, -v205
v_fma_f32 v96, v96, v203, -v205
v_mfma_f32_16x16x32_bf16 v[156:159], a[164:167], a[136:139], v[156:159]
v_fma_f32 v97, v97, v203, -v205
v_fma_f32 v98, v98, v203, -v205
v_mfma_f32_16x16x32_bf16 v[160:163], a[164:167], a[140:143], v[160:163]
s_waitcnt lgkmcnt(7)
v_fma_f32 v99, v99, v203, -v205
v_mfma_f32_16x16x16_bf16 v[148:151], a[168:169], v[212:213], v[148:151]
ds_read_b128 a[160:163], v208 offset:2048
ds_read_b128 a[164:167], v208 offset:20480
v_mfma_f32_16x16x16_bf16 v[152:155], a[168:169], v[214:215], v[152:155]
v_cvt_pk_bf16_f32 v228, v88, v89
v_cvt_pk_bf16_f32 v229, v90, v91
v_mfma_f32_16x16x16_bf16 v[156:159], a[172:173], v[212:213], v[156:159]
v_cvt_pk_bf16_f32 v230, v96, v97
v_cvt_pk_bf16_f32 v231, v98, v99
v_mfma_f32_16x16x16_bf16 v[160:163], a[172:173], v[214:215], v[160:163]
s_waitcnt lgkmcnt(5)
v_mfma_f32_16x16x32_bf16 v[164:167], a[144:147], a[0:3], 0
ds_read_b128 a[168:171], v208 offset:3072
ds_read_b128 a[172:175], v208 offset:21504
v_mfma_f32_16x16x32_bf16 v[168:171], a[144:147], a[4:7], 0
buffer_store_dwordx4 v[72:75], v1, s[8:11], s66 offen offset:1024 sc1
ds_write_b128 v236, v[228:231] offset:4800
v_mfma_f32_16x16x32_bf16 v[172:175], a[148:151], a[0:3], 0
v_fma_f32 v100, v100, v202, -v204
v_fma_f32 v101, v101, v202, -v204
v_mfma_f32_16x16x32_bf16 v[176:179], a[148:151], a[4:7], 0
s_waitcnt lgkmcnt(5)
v_fma_f32 v102, v102, v202, -v204
v_mfma_f32_16x16x32_bf16 v[164:167], a[152:155], a[8:11], v[164:167]
ds_read_b128 a[144:147], v208 offset:4096
ds_read_b128 a[148:151], v208 offset:22528
v_mfma_f32_16x16x32_bf16 v[168:171], a[152:155], a[12:15], v[168:171]
ds_read_b64_tr_b16 v[84:85], v237 offset:192
v_fma_f32 v103, v103, v202, -v204
v_mfma_f32_16x16x32_bf16 v[172:175], a[156:159], a[8:11], v[172:175]
ds_read_b64_tr_b16 v[86:87], v237 offset:1344
v_fma_f32 v104, v104, v203, -v205
v_mfma_f32_16x16x32_bf16 v[176:179], a[156:159], a[12:15], v[176:179]
s_waitcnt lgkmcnt(7)
v_mfma_f32_16x16x32_bf16 v[164:167], a[160:163], a[16:19], v[164:167]
ds_read_b128 a[152:155], v208 offset:5120
ds_read_b128 a[156:159], v208 offset:23552
v_mfma_f32_16x16x32_bf16 v[168:171], a[160:163], a[20:23], v[168:171]
ds_read_b64_tr_b16 v[88:89], v237 offset:200
v_fma_f32 v105, v105, v203, -v205
v_mfma_f32_16x16x32_bf16 v[172:175], a[164:167], a[16:19], v[172:175]
ds_read_b64_tr_b16 v[90:91], v237 offset:1352
v_fma_f32 v106, v106, v203, -v205
v_fma_f32 v107, v107, v203, -v205
v_cvt_pk_bf16_f32 v216, v100, v101
v_mfma_f32_16x16x32_bf16 v[176:179], a[164:167], a[20:23], v[176:179]
s_waitcnt lgkmcnt(9)
v_cvt_pk_bf16_f32 v217, v102, v103
v_cvt_pk_bf16_f32 v218, v104, v105
v_mfma_f32_16x16x32_bf16 v[164:167], a[168:171], a[24:27], v[164:167]
ds_read_b128 a[160:163], v208 offset:6144
ds_read_b128 a[164:167], v208 offset:24576
v_cvt_pk_bf16_f32 v219, v106, v107
s_waitcnt lgkmcnt(6)
v_mfma_f32_16x16x32_bf16 v[168:171], a[168:171], a[28:31], v[168:171]
buffer_store_dwordx4 v[84:87], v1, s[8:11], s66 offen offset:2048 sc1
ds_write_b64 v7, v[216:217] offset:256
ds_write_b64 v7, v[218:219] offset:4864
v_mfma_f32_16x16x32_bf16 v[172:175], a[172:175], a[24:27], v[172:175]
v_mfma_f32_16x16x32_bf16 v[176:179], a[172:175], a[28:31], v[176:179]
v_mfma_f32_16x16x32_bf16 v[164:167], a[144:147], a[32:35], v[164:167]
ds_read_b128 a[168:171], v208 offset:7168
ds_read_b128 a[172:175], v208 offset:25600
v_mfma_f32_16x16x32_bf16 v[168:171], a[144:147], a[36:39], v[168:171]
v_mfma_f32_16x16x32_bf16 v[172:175], a[148:151], a[32:35], v[172:175]
v_mfma_f32_16x16x32_bf16 v[176:179], a[148:151], a[36:39], v[176:179]
s_waitcnt lgkmcnt(8)
v_mfma_f32_16x16x32_bf16 v[164:167], a[152:155], a[40:43], v[164:167]
ds_read_b128 a[144:147], v208 offset:8192
ds_read_b128 a[148:151], v208 offset:26624
v_mfma_f32_16x16x32_bf16 v[168:171], a[152:155], a[44:47], v[168:171]
ds_read_b64_tr_b16 v[100:101], v238 offset:256
ds_read_b64_tr_b16 v[102:103], v238 offset:1408
v_mfma_f32_16x16x32_bf16 v[172:175], a[156:159], a[40:43], v[172:175]
s_waitcnt lgkmcnt(10)
v_mfma_f32_16x16x32_bf16 v[176:179], a[156:159], a[44:47], v[176:179]
s_waitcnt lgkmcnt(8)
v_mfma_f32_16x16x32_bf16 v[164:167], a[160:163], a[48:51], v[164:167]
ds_read_b128 a[152:155], v208 offset:9216
ds_read_b128 a[156:159], v208 offset:27648
v_mfma_f32_16x16x32_bf16 v[168:171], a[160:163], a[52:55], v[168:171]
buffer_store_dwordx4 v[88:91], v1, s[8:11], s66 offen offset:3072 sc1
v_mfma_f32_16x16x32_bf16 v[172:175], a[164:167], a[48:51], v[172:175]
v_mfma_f32_16x16x32_bf16 v[176:179], a[164:167], a[52:55], v[176:179]
s_waitcnt lgkmcnt(6)
s_cmp_eq_u32 s25, 1
s_cselect_b32 s98, 4096, 0
v_mfma_f32_16x16x32_bf16 v[164:167], a[168:171], a[56:59], v[164:167]
ds_read_b128 a[160:163], v208 offset:10240
ds_read_b128 a[164:167], v208 offset:28672
v_mfma_f32_16x16x32_bf16 v[168:171], a[168:171], a[60:63], v[168:171]
s_add_u32 s52, s52, s98
v_mfma_f32_16x16x32_bf16 v[172:175], a[172:175], a[56:59], v[172:175]
s_add_u32 s52, s52, 4096
v_mfma_f32_16x16x32_bf16 v[176:179], a[172:175], a[60:63], v[176:179]
s_waitcnt lgkmcnt(6)
v_mfma_f32_16x16x32_bf16 v[164:167], a[144:147], a[64:67], v[164:167]
ds_read_b128 a[168:171], v208 offset:11264
ds_read_b128 a[172:175], v208 offset:29696
v_mfma_f32_16x16x32_bf16 v[168:171], a[144:147], a[68:71], v[168:171]
v_mfma_f32_16x16x32_bf16 v[172:175], a[148:151], a[64:67], v[172:175]
v_mfma_f32_16x16x32_bf16 v[176:179], a[148:151], a[68:71], v[176:179]
s_waitcnt lgkmcnt(4)
v_mfma_f32_16x16x32_bf16 v[164:167], a[152:155], a[72:75], v[164:167]
ds_read_b128 a[144:147], v208 offset:12288
ds_read_b128 a[148:151], v208 offset:30720
v_mfma_f32_16x16x32_bf16 v[168:171], a[152:155], a[76:79], v[168:171]
s_add_u32 s66, s66, 4096
buffer_store_dwordx4 v[100:103], v1, s[8:11], s66 offen offset:0 sc1
v_mfma_f32_16x16x32_bf16 v[172:175], a[156:159], a[72:75], v[172:175]
v_mfma_f32_16x16x32_bf16 v[176:179], a[156:159], a[76:79], v[176:179]
s_waitcnt lgkmcnt(4)
v_mfma_f32_16x16x32_bf16 v[164:167], a[160:163], a[80:83], v[164:167]
ds_read_b128 a[152:155], v208 offset:13312
ds_read_b128 a[156:159], v208 offset:31744
v_mfma_f32_16x16x32_bf16 v[168:171], a[160:163], a[84:87], v[168:171]
v_mfma_f32_16x16x32_bf16 v[172:175], a[164:167], a[80:83], v[172:175]
v_mfma_f32_16x16x32_bf16 v[176:179], a[164:167], a[84:87], v[176:179]
s_waitcnt lgkmcnt(4)
v_mfma_f32_16x16x32_bf16 v[164:167], a[168:171], a[88:91], v[164:167]
ds_read_b128 a[160:163], v208 offset:14336
ds_read_b128 a[164:167], v208 offset:32768
v_mfma_f32_16x16x32_bf16 v[168:171], a[168:171], a[92:95], v[168:171]
v_mfma_f32_16x16x32_bf16 v[172:175], a[172:175], a[88:91], v[172:175]
v_mfma_f32_16x16x32_bf16 v[176:179], a[172:175], a[92:95], v[176:179]
s_waitcnt lgkmcnt(4)
v_mfma_f32_16x16x32_bf16 v[164:167], a[144:147], a[96:99], v[164:167]
ds_read_b128 a[168:171], v208 offset:15360
ds_read_b128 a[172:175], v208 offset:33792
v_mfma_f32_16x16x32_bf16 v[168:171], a[144:147], a[100:103], v[168:171]
v_mfma_f32_16x16x32_bf16 v[172:175], a[148:151], a[96:99], v[172:175]
v_mfma_f32_16x16x32_bf16 v[176:179], a[148:151], a[100:103], v[176:179]
s_waitcnt lgkmcnt(4)
v_mfma_f32_16x16x32_bf16 v[164:167], a[152:155], a[104:107], v[164:167]
ds_read_b128 a[144:147], v208 offset:16384
ds_read_b128 a[148:151], v208 offset:34816
v_mfma_f32_16x16x32_bf16 v[168:171], a[152:155], a[108:111], v[168:171]
buffer_load_dwordx4 a[240:243], v1, s[4:7], s52 offen offset:0 sc1
buffer_load_dwordx4 a[244:247], v9, s[4:7], s52 offen offset:0 sc1
v_mfma_f32_16x16x32_bf16 v[172:175], a[156:159], a[104:107], v[172:175]
v_mfma_f32_16x16x32_bf16 v[176:179], a[156:159], a[108:111], v[176:179]
s_waitcnt lgkmcnt(4)
v_mfma_f32_16x16x32_bf16 v[164:167], a[160:163], a[112:115], v[164:167]
ds_read_b128 a[152:155], v208 offset:17408
ds_read_b128 a[156:159], v208 offset:35840
v_mfma_f32_16x16x32_bf16 v[168:171], a[160:163], a[116:119], v[168:171]
v_mfma_f32_16x16x32_bf16 v[172:175], a[164:167], a[112:115], v[172:175]
v_mfma_f32_16x16x32_bf16 v[176:179], a[164:167], a[116:119], v[176:179]
s_waitcnt lgkmcnt(4)
v_add_u32 v181, 160768, v239
v_mfma_f32_16x16x32_bf16 v[164:167], a[168:171], a[120:123], v[164:167]
ds_read_b64 a[160:161], v181 offset:0
ds_read_b64 a[164:165], v181 offset:512
v_mfma_f32_16x16x32_bf16 v[168:171], a[168:171], a[124:127], v[168:171]
v_mfma_f32_16x16x32_bf16 v[172:175], a[172:175], a[120:123], v[172:175]
v_mfma_f32_16x16x32_bf16 v[176:179], a[172:175], a[124:127], v[176:179]
s_waitcnt lgkmcnt(4)
v_mfma_f32_16x16x32_bf16 v[164:167], a[144:147], a[128:131], v[164:167]
buffer_load_dwordx4 a[248:251], v1, s[4:7], s52 offen offset:1024 sc1
buffer_load_dwordx4 a[252:255], v9, s[4:7], s52 offen offset:1024 sc1
v_mfma_f32_16x16x32_bf16 v[168:171], a[144:147], a[132:135], v[168:171]
v_mfma_f32_16x16x32_bf16 v[172:175], a[148:151], a[128:131], v[172:175]
v_mfma_f32_16x16x32_bf16 v[176:179], a[148:151], a[132:135], v[176:179]
s_waitcnt lgkmcnt(2)
v_mfma_f32_16x16x32_bf16 v[164:167], a[152:155], a[136:139], v[164:167]
v_mfma_f32_16x16x32_bf16 v[168:171], a[152:155], a[140:143], v[168:171]
v_mfma_f32_16x16x32_bf16 v[172:175], a[156:159], a[136:139], v[172:175]
v_mfma_f32_16x16x32_bf16 v[176:179], a[156:159], a[140:143], v[176:179]
s_waitcnt lgkmcnt(0)
v_mfma_f32_16x16x16_bf16 v[164:167], a[160:161], v[212:213], v[164:167]
v_mfma_f32_16x16x16_bf16 v[168:171], a[160:161], v[214:215], v[168:171]
v_mfma_f32_16x16x16_bf16 v[172:175], a[164:165], v[212:213], v[172:175]
v_mfma_f32_16x16x16_bf16 v[176:179], a[164:165], v[214:215], v[176:179]
L_c4:
v_add_u32 v180, 0, v1
v_lshlrev_b32 v184, 16, v0
v_lshlrev_b32 v185, 16, v0
v_lshlrev_b32 v186, 16, v0
v_lshlrev_b32 v187, 16, v0
v_lshlrev_b32 v188, 16, v249
v_lshlrev_b32 v189, 16, v249
v_lshlrev_b32 v190, 16, v249
v_lshlrev_b32 v191, 16, v249
s_waitcnt lgkmcnt(0)
ds_write_b128 v240, v[36:39] offset:0
ds_write_b128 v240, v[40:43] offset:1024
ds_write_b128 v240, v[52:55] offset:2048
ds_write_b128 v240, v[56:59] offset:3072
s_cmp_eq_u32 s24, 0
s_cselect_b32 s67, 0, 1073741824
s_add_u32 s67, s67, 26542080
s_waitcnt vmcnt(4)
s_barrier
s_mov_b64 exec, 0xffff
buffer_atomic_add v4, v233, s[8:11], s67 offen sc1
s_mov_b64 exec, -1
v_add_u32 v200, 53248, v1
v_add_u32 v201, 90112, v1
v_add_u32 v202, 126976, v1
s_lshl_b32 s35, s80, 7
s_add_u32 s35, s35, 26542080
s_cmp_eq_u32 s24, 1
s_cselect_b32 s35, s35, 1073741824
v_mov_b32 v6, 0
v_mov_b32 v244, 0
v_mov_b32 v245, 0
v_mov_b32 v246, 0
buffer_load_dwordx4 a[80:83], v1, s[4:7], s52 offen offset:2048 sc1
buffer_load_dwordx4 a[84:87], v9, s[4:7], s52 offen offset:2048 sc1
ds_write_b128 v240, v[68:71] offset:4096
ds_write_b128 v240, v[72:75] offset:5120
ds_write_b128 v240, v[84:87] offset:6144
ds_write_b128 v240, v[88:91] offset:7168
ds_write_b128 v240, v[100:103] offset:8192
v_pk_mul_f32 v[192:193], v[108:109], v[108:109]
v_pk_mul_f32 v[194:195], v[110:111], v[110:111]
v_pk_mul_f32 v[196:197], v[112:113], v[112:113]
v_pk_mul_f32 v[198:199], v[114:115], v[114:115]
v_pk_fma_f32 v[192:193], v[192:193], v[252:253], v[250:251] op_sel:[0,0,0] op_sel_hi:[1,0,0]
v_pk_fma_f32 v[194:195], v[194:195], v[252:253], v[250:251] op_sel:[0,0,0] op_sel_hi:[1,0,0]
v_pk_fma_f32 v[196:197], v[196:197], v[252:253], v[250:251] op_sel:[0,1,1] op_sel_hi:[1,1,1]
v_pk_fma_f32 v[198:199], v[198:199], v[252:253], v[250:251] op_sel:[0,1,1] op_sel_hi:[1,1,1]
v_pk_mul_f32 v[192:193], v[192:193], v[108:109]
buffer_load_dwordx4 a[88:91], v1, s[4:7], s52 offen offset:3072 sc1
buffer_load_dwordx4 a[92:95], v9, s[4:7], s52 offen offset:3072 sc1
v_pk_mul_f32 v[194:195], v[194:195], v[110:111]
v_pk_mul_f32 v[196:197], v[196:197], v[112:113]
v_pk_mul_f32 v[198:199], v[198:199], v[114:115]
v_exp_f32 v192, v192
v_exp_f32 v193, v193
v_exp_f32 v194, v194
v_exp_f32 v195, v195
v_exp_f32 v196, v196
v_exp_f32 v197, v197
v_exp_f32 v198, v198
v_exp_f32 v199, v199
v_pk_fma_f32 v[192:193], v[192:193], v[254:255], v[254:255] op_sel:[0,0,0] op_sel_hi:[1,0,0]
v_pk_fma_f32 v[194:195], v[194:195], v[254:255], v[254:255] op_sel:[0,0,0] op_sel_hi:[1,0,0]
v_pk_fma_f32 v[196:197], v[196:197], v[254:255], v[254:255] op_sel:[0,1,1] op_sel_hi:[1,1,1]
s_cmp_eq_u32 s25, 2
s_cselect_b32 s98, 4096, 0
s_add_u32 s52, s52, s98
s_add_u32 s52, s52, 4096
buffer_load_dwordx4 a[96:99], v1, s[4:7], s52 offen offset:0 sc1
s_mov_b64 exec, 1
buffer_atomic_add v244, v6, s[8:11], s35 offen sc0 sc1
s_mov_b64 exec, -1
buffer_load_dwordx4 a[100:103], v9, s[4:7], s52 offen offset:0 sc1
v_pk_fma_f32 v[198:199], v[198:199], v[254:255], v[254:255] op_sel:[0,1,1] op_sel_hi:[1,1,1]
v_rcp_f32 v192, v192
v_rcp_f32 v193, v193
v_rcp_f32 v194, v194
v_rcp_f32 v195, v195
v_rcp_f32 v196, v196
v_rcp_f32 v197, v197
v_rcp_f32 v198, v198
v_rcp_f32 v199, v199
v_pk_mul_f32 v[108:109], v[108:109], v[192:193]
v_pk_mul_f32 v[110:111], v[110:111], v[194:195]
v_pk_mul_f32 v[112:113], v[112:113], v[196:197]
v_pk_mul_f32 v[114:115], v[114:115], v[198:199]
v_pk_mul_f32 v[192:193], v[116:117], v[116:117]
buffer_load_dwordx4 a[104:107], v1, s[4:7], s52 offen offset:1024 sc1
buffer_load_dwordx4 a[108:111], v9, s[4:7], s52 offen offset:1024 sc1
v_pk_mul_f32 v[194:195], v[118:119], v[118:119]
v_pk_mul_f32 v[196:197], v[120:121], v[120:121]
v_pk_mul_f32 v[198:199], v[122:123], v[122:123]
v_pk_fma_f32 v[192:193], v[192:193], v[252:253], v[250:251] op_sel:[0,0,0] op_sel_hi:[1,0,0]
v_pk_fma_f32 v[194:195], v[194:195], v[252:253], v[250:251] op_sel:[0,0,0] op_sel_hi:[1,0,0]
v_pk_fma_f32 v[196:197], v[196:197], v[252:253], v[250:251] op_sel:[0,1,1] op_sel_hi:[1,1,1]
v_pk_fma_f32 v[198:199], v[198:199], v[252:253], v[250:251] op_sel:[0,1,1] op_sel_hi:[1,1,1]
v_pk_mul_f32 v[192:193], v[192:193], v[116:117]
v_pk_mul_f32 v[194:195], v[194:195], v[118:119]
v_pk_mul_f32 v[196:197], v[196:197], v[120:121]
v_pk_mul_f32 v[198:199], v[198:199], v[122:123]
v_exp_f32 v192, v192
v_exp_f32 v193, v193
v_exp_f32 v194, v194
buffer_load_dwordx4 a[112:115], v1, s[4:7], s52 offen offset:2048 sc1
s_mov_b64 exec, 1
buffer_atomic_add v245, v6, s[8:11], s35 offen sc0 sc1
s_mov_b64 exec, -1
buffer_load_dwordx4 a[116:119], v9, s[4:7], s52 offen offset:2048 sc1
v_exp_f32 v195, v195
v_exp_f32 v196, v196
v_exp_f32 v197, v197
v_exp_f32 v198, v198
v_exp_f32 v199, v199
v_pk_fma_f32 v[192:193], v[192:193], v[254:255], v[254:255] op_sel:[0,0,0] op_sel_hi:[1,0,0]
v_pk_fma_f32 v[194:195], v[194:195], v[254:255], v[254:255] op_sel:[0,0,0] op_sel_hi:[1,0,0]
v_pk_fma_f32 v[196:197], v[196:197], v[254:255], v[254:255] op_sel:[0,1,1] op_sel_hi:[1,1,1]
v_pk_fma_f32 v[198:199], v[198:199], v[254:255], v[254:255] op_sel:[0,1,1] op_sel_hi:[1,1,1]
v_rcp_f32 v192, v192
v_rcp_f32 v193, v193
v_rcp_f32 v194, v194
v_rcp_f32 v195, v195
v_rcp_f32 v196, v196
buffer_load_dwordx4 a[120:123], v1, s[4:7], s52 offen offset:3072 sc1
buffer_load_dwordx4 a[124:127], v9, s[4:7], s52 offen offset:3072 sc1
v_rcp_f32 v197, v197
v_rcp_f32 v198, v198
v_rcp_f32 v199, v199
v_pk_mul_f32 v[116:117], v[116:117], v[192:193]
v_pk_mul_f32 v[118:119], v[118:119], v[194:195]
v_pk_mul_f32 v[120:121], v[120:121], v[196:197]
v_pk_mul_f32 v[122:123], v[122:123], v[198:199]
v_pk_mul_f32 v[192:193], v[124:125], v[124:125]
v_pk_mul_f32 v[194:195], v[126:127], v[126:127]
v_pk_mul_f32 v[196:197], v[128:129], v[128:129]
v_pk_mul_f32 v[198:199], v[130:131], v[130:131]
v_pk_fma_f32 v[192:193], v[192:193], v[252:253], v[250:251] op_sel:[0,0,0] op_sel_hi:[1,0,0]
v_pk_fma_f32 v[194:195], v[194:195], v[252:253], v[250:251] op_sel:[0,0,0] op_sel_hi:[1,0,0]
v_pk_fma_f32 v[196:197], v[196:197], v[252:253], v[250:251] op_sel:[0,1,1] op_sel_hi:[1,1,1]
s_cmp_eq_u32 s25, 3
s_cselect_b32 s98, 4096, 0
s_add_u32 s52, s52, s98
s_add_u32 s52, s52, 4096
buffer_load_dwordx4 a[128:131], v1, s[4:7], s52 offen offset:0 sc1
s_mov_b64 exec, 1
buffer_atomic_add v246, v6, s[8:11], s35 offen sc0 sc1
s_mov_b64 exec, -1
buffer_load_dwordx4 a[132:135], v9, s[4:7], s52 offen offset:0 sc1
v_pk_fma_f32 v[198:199], v[198:199], v[252:253], v[250:251] op_sel:[0,1,1] op_sel_hi:[1,1,1]
v_pk_mul_f32 v[192:193], v[192:193], v[124:125]
v_pk_mul_f32 v[194:195], v[194:195], v[126:127]
v_pk_mul_f32 v[196:197], v[196:197], v[128:129]
v_pk_mul_f32 v[198:199], v[198:199], v[130:131]
v_exp_f32 v192, v192
v_exp_f32 v193, v193
v_exp_f32 v194, v194
v_exp_f32 v195, v195
v_exp_f32 v196, v196
v_exp_f32 v197, v197
v_exp_f32 v198, v198
v_exp_f32 v199, v199
v_pk_fma_f32 v[192:193], v[192:193], v[254:255], v[254:255] op_sel:[0,0,0] op_sel_hi:[1,0,0]
buffer_load_dwordx4 a[136:139], v1, s[4:7], s52 offen offset:1024 sc1
buffer_load_dwordx4 a[140:143], v9, s[4:7], s52 offen offset:1024 sc1
v_pk_fma_f32 v[194:195], v[194:195], v[254:255], v[254:255] op_sel:[0,0,0] op_sel_hi:[1,0,0]
v_pk_fma_f32 v[196:197], v[196:197], v[254:255], v[254:255] op_sel:[0,1,1] op_sel_hi:[1,1,1]
v_pk_fma_f32 v[198:199], v[198:199], v[254:255], v[254:255] op_sel:[0,1,1] op_sel_hi:[1,1,1]
v_rcp_f32 v192, v192
v_rcp_f32 v193, v193
v_rcp_f32 v194, v194
v_rcp_f32 v195, v195
v_rcp_f32 v196, v196
v_rcp_f32 v197, v197
v_rcp_f32 v198, v198
v_rcp_f32 v199, v199
v_pk_mul_f32 v[124:125], v[124:125], v[192:193]
v_pk_mul_f32 v[126:127], v[126:127], v[194:195]
v_pk_mul_f32 v[128:129], v[128:129], v[196:197]
v_pk_mul_f32 v[130:131], v[130:131], v[198:199]
s_mul_i32 s30, s26, 589824
s_add_u32 s30, s30, 7340032
s_lshl_b32 s62, s24, 12
s_lshl_b32 s63, s24, 10
s_add_u32 s60, s30, s62
s_add_u32 s61, s30, s63
s_add_u32 s61, s61, 16384
s_cmp_eq_u32 s25, 0
s_cselect_b32 s99, 36864, 0
s_add_u32 s60, s60, s99
s_add_u32 s61, s61, s99
s_add_u32 m0, s62, 53248
s_add_u32 s60, s60, 0
s_waitcnt lgkmcnt(0)
s_cmp_eq_u32 s24, 1
s_cbranch_scc0 L_other_28
s_mov_b32 s31, 0
s_mov_b64 exec, 1
v_mov_b32 v247, 0
buffer_atomic_add v247, v6, s[8:11], s35 offen sc0 sc1
s_waitcnt vmcnt(14)
v_cmp_gt_u32 vcc, 16, v244
s_nop 0
s_cbranch_vccz L_polled_27
s_waitcnt vmcnt(9)
v_cmp_gt_u32 vcc, 16, v245
s_nop 0
s_cbranch_vccz L_polled_27
v_mov_b32 v244, 0
buffer_atomic_add v244, v6, s[8:11], s35 offen sc0 sc1
s_waitcnt vmcnt(5)
v_cmp_gt_u32 vcc, 16, v246
s_nop 0
s_cbranch_vccz L_polled_27
v_mov_b32 v245, 0
buffer_atomic_add v245, v6, s[8:11], s35 offen sc0 sc1
L_poll_26:
s_add_u32 s31, s31, 1
s_cmp_gt_u32 s31, 100000
s_cbranch_scc1 L_polled_27
v_mov_b32 v246, 0
buffer_atomic_add v246, v6, s[8:11], s35 offen sc0 sc1
s_waitcnt vmcnt(3)
v_cmp_gt_u32 vcc, 16, v247
s_nop 0
s_cbranch_vccz L_polled_27
v_mov_b32 v247, 0
buffer_atomic_add v247, v6, s[8:11], s35 offen sc0 sc1
s_waitcnt vmcnt(3)
v_cmp_gt_u32 vcc, 16, v244
s_nop 0
s_cbranch_vccz L_polled_27
v_mov_b32 v244, 0
buffer_atomic_add v244, v6, s[8:11], s35 offen sc0 sc1
s_waitcnt vmcnt(3)
v_cmp_gt_u32 vcc, 16, v245
s_nop 0
s_cbranch_vccz L_polled_27
v_mov_b32 v245, 0
buffer_atomic_add v245, v6, s[8:11], s35 offen sc0 sc1
s_waitcnt vmcnt(3)
v_cmp_gt_u32 vcc, 16, v246
s_nop 0
s_cbranch_vccz L_polled_27
s_branch L_poll_26
L_polled_27:
s_mov_b64 exec, -1
L_other_28:
s_barrier
buffer_load_dwordx4 v1, s[8:11], s60 offen offset:0 sc1 lds
buffer_load_dwordx4 v1, s[8:11], s60 offen offset:1024 sc1 lds
ds_read_b128 a[0:3], v180 offset:0
ds_read_b128 a[4:7], v180 offset:1024
ds_read_b128 a[8:11], v180 offset:2048
ds_read_b128 a[12:15], v180 offset:3072
ds_read_b128 a[16:19], v180 offset:4096
ds_read_b128 a[20:23], v180 offset:5120
ds_read_b128 a[24:27], v180 offset:6144
ds_read_b128 a[28:31], v180 offset:7168
ds_read_b128 a[32:35], v180 offset:8192
buffer_load_dwordx4 v1, s[8:11], s60 offen offset:2048 sc1 lds
buffer_load_dwordx4 v1, s[8:11], s60 offen offset:3072 sc1 lds
s_add_u32 m0, s63, 69632
s_add_u32 s61, s61, 0
buffer_load_dwordx4 v1, s[8:11], s61 offen offset:0 sc1 lds
s_waitcnt lgkmcnt(0)
v_mfma_f32_16x16x32_bf16 v[36:39], a[0:3], a[176:179], v[184:187]
ds_read_b128 a[36:39], v180 offset:9216
s_add_u32 m0, s62, 73728
v_mfma_f32_16x16x32_bf16 v[40:43], a[0:3], a[180:183], v[188:191]
ds_read_b128 a[40:43], v180 offset:10240
v_mul_f32 v192, v132, v132
v_mfma_f32_16x16x32_bf16 v[44:47], a[4:7], a[176:179], v[184:187]
ds_read_b128 a[44:47], v180 offset:11264
s_add_u32 s60, s60, 20480
v_mfma_f32_16x16x32_bf16 v[48:51], a[4:7], a[180:183], v[188:191]
ds_read_b128 a[48:51], v180 offset:12288
v_mul_f32 v193, v133, v133
v_mfma_f32_16x16x32_bf16 v[52:55], a[8:11], a[176:179], v[184:187]
ds_read_b128 a[52:55], v180 offset:13312
v_mul_f32 v194, v134, v134
v_mfma_f32_16x16x32_bf16 v[56:59], a[8:11], a[180:183], v[188:191]
ds_read_b128 a[56:59], v180 offset:14336
buffer_load_dwordx4 v1, s[8:11], s60 offen offset:0 sc1 lds
v_mfma_f32_16x16x32_bf16 v[60:63], a[12:15], a[176:179], v[184:187]
ds_read_b128 a[60:63], v180 offset:15360
v_mfma_f32_16x16x32_bf16 v[64:67], a[12:15], a[180:183], v[188:191]
ds_read_b128 a[64:67], v180 offset:16384
v_mul_f32 v195, v135, v135
v_mfma_f32_16x16x32_bf16 v[68:71], a[16:19], a[176:179], v[184:187]
ds_read_b128 a[68:71], v180 offset:17408
buffer_load_dwordx4 v1, s[8:11], s60 offen offset:1024 sc1 lds
v_mfma_f32_16x16x32_bf16 v[72:75], a[16:19], a[180:183], v[188:191]
v_fma_f32 v192, v192, v252, v250
v_mfma_f32_16x16x32_bf16 v[76:79], a[20:23], a[176:179], v[184:187]
v_mfma_f32_16x16x32_bf16 v[80:83], a[20:23], a[180:183], v[188:191]
buffer_load_dwordx4 v1, s[8:11], s60 offen offset:2048 sc1 lds
v_fma_f32 v193, v193, v252, v250
v_mfma_f32_16x16x32_bf16 v[84:87], a[24:27], a[176:179], v[184:187]
v_mfma_f32_16x16x32_bf16 v[88:91], a[24:27], a[180:183], v[188:191]
v_mfma_f32_16x16x32_bf16 v[92:95], a[28:31], a[176:179], v[184:187]
buffer_load_dwordx4 v1, s[8:11], s60 offen offset:3072 sc1 lds
v_fma_f32 v194, v194, v252, v250
v_mfma_f32_16x16x32_bf16 v[96:99], a[28:31], a[180:183], v[188:191]
v_mfma_f32_16x16x32_bf16 v[100:103], a[32:35], a[176:179], v[184:187]
v_fma_f32 v195, v195, v252, v250
v_mfma_f32_16x16x32_bf16 v[104:107], a[32:35], a[180:183], v[188:191]
s_waitcnt lgkmcnt(0)
v_mfma_f32_16x16x32_bf16 v[36:39], a[36:39], a[184:187], v[36:39]
ds_read_b128 a[0:3], v180 offset:18432
v_mul_f32 v192, v192, v132
v_mfma_f32_16x16x32_bf16 v[40:43], a[36:39], a[188:191], v[40:43]
ds_read_b128 a[4:7], v180 offset:19456
v_mfma_f32_16x16x32_bf16 v[44:47], a[40:43], a[184:187], v[44:47]
ds_read_b128 a[8:11], v180 offset:20480
v_mfma_f32_16x16x32_bf16 v[48:51], a[40:43], a[188:191], v[48:51]
ds_read_b128 a[12:15], v180 offset:21504
v_mul_f32 v193, v193, v133
v_mfma_f32_16x16x32_bf16 v[52:55], a[44:47], a[184:187], v[52:55]
ds_read_b128 a[16:19], v180 offset:22528
v_mfma_f32_16x16x32_bf16 v[56:59], a[44:47], a[188:191], v[56:59]
ds_read_b128 a[20:23], v180 offset:23552
v_mul_f32 v194, v194, v134
v_mfma_f32_16x16x32_bf16 v[60:63], a[48:51], a[184:187], v[60:63]
ds_read_b128 a[24:27], v180 offset:24576
v_mfma_f32_16x16x32_bf16 v[64:67], a[48:51], a[188:191], v[64:67]
ds_read_b128 a[28:31], v180 offset:25600
v_mul_f32 v195, v195, v135
v_mfma_f32_16x16x32_bf16 v[68:71], a[52:55], a[184:187], v[68:71]
ds_read_b128 a[32:35], v180 offset:26624
v_mfma_f32_16x16x32_bf16 v[72:75], a[52:55], a[188:191], v[72:75]
s_cmp_eq_u32 s25, 1
s_cselect_b32 s99, 36864, 0
s_add_u32 s60, s60, s99
v_mfma_f32_16x16x32_bf16 v[76:79], a[56:59], a[184:187], v[76:79]
s_add_u32 s61, s61, s99
s_add_u32 m0, s62, 90112
s_add_u32 s60, s60, 16384
v_mfma_f32_16x16x32_bf16 v[80:83], a[56:59], a[188:191], v[80:83]
buffer_load_dwordx4 v1, s[8:11], s60 offen offset:0 sc1 lds
v_mfma_f32_16x16x32_bf16 v[84:87], a[60:63], a[184:187], v[84:87]
buffer_load_dwordx4 v1, s[8:11], s60 offen offset:1024 sc1 lds
v_mfma_f32_16x16x32_bf16 v[88:91], a[60:63], a[188:191], v[88:91]
buffer_load_dwordx4 v1, s[8:11], s60 offen offset:2048 sc1 lds
v_mfma_f32_16x16x32_bf16 v[92:95], a[64:67], a[184:187], v[92:95]
v_exp_f32 v192, v192
v_mfma_f32_16x16x32_bf16 v[96:99], a[64:67], a[188:191], v[96:99]
buffer_load_dwordx4 v1, s[8:11], s60 offen offset:3072 sc1 lds
v_mfma_f32_16x16x32_bf16 v[100:103], a[68:71], a[184:187], v[100:103]
v_exp_f32 v193, v193
v_mfma_f32_16x16x32_bf16 v[104:107], a[68:71], a[188:191], v[104:107]
s_waitcnt lgkmcnt(0)
v_mfma_f32_16x16x32_bf16 v[36:39], a[0:3], a[192:195], v[36:39]
ds_read_b128 a[36:39], v180 offset:27648
s_add_u32 m0, s63, 106496
v_mfma_f32_16x16x32_bf16 v[40:43], a[0:3], a[196:199], v[40:43]
ds_read_b128 a[40:43], v180 offset:28672
v_mfma_f32_16x16x32_bf16 v[44:47], a[4:7], a[192:195], v[44:47]
ds_read_b128 a[44:47], v180 offset:29696
s_add_u32 s61, s61, 36864
v_mfma_f32_16x16x32_bf16 v[48:51], a[4:7], a[196:199], v[48:51]
ds_read_b128 a[48:51], v180 offset:30720
v_mfma_f32_16x16x32_bf16 v[52:55], a[8:11], a[192:195], v[52:55]
ds_read_b128 a[52:55], v180 offset:31744
buffer_load_dwordx4 v1, s[8:11], s61 offen offset:0 sc1 lds
v_mfma_f32_16x16x32_bf16 v[56:59], a[8:11], a[196:199], v[56:59]
ds_read_b128 a[56:59], v180 offset:32768
v_mfma_f32_16x16x32_bf16 v[60:63], a[12:15], a[192:195], v[60:63]
ds_read_b128 a[60:63], v180 offset:33792
s_add_u32 m0, s62, 110592
v_mfma_f32_16x16x32_bf16 v[64:67], a[12:15], a[196:199], v[64:67]
ds_read_b128 a[64:67], v180 offset:34816
v_mfma_f32_16x16x32_bf16 v[68:71], a[16:19], a[192:195], v[68:71]
ds_read_b128 a[68:71], v180 offset:35840
s_add_u32 s60, s60, 20480
v_mfma_f32_16x16x32_bf16 v[72:75], a[16:19], a[196:199], v[72:75]
v_exp_f32 v194, v194
v_mfma_f32_16x16x32_bf16 v[76:79], a[20:23], a[192:195], v[76:79]
buffer_load_dwordx4 v1, s[8:11], s60 offen offset:0 sc1 lds
v_mfma_f32_16x16x32_bf16 v[80:83], a[20:23], a[196:199], v[80:83]
v_exp_f32 v195, v195
v_mfma_f32_16x16x32_bf16 v[84:87], a[24:27], a[192:195], v[84:87]
buffer_load_dwordx4 v1, s[8:11], s60 offen offset:1024 sc1 lds
v_fma_f32 v192, v192, v254, v254
v_mfma_f32_16x16x32_bf16 v[88:91], a[24:27], a[196:199], v[88:91]
v_fma_f32 v193, v193, v254, v254
v_mfma_f32_16x16x32_bf16 v[92:95], a[28:31], a[192:195], v[92:95]
buffer_load_dwordx4 v1, s[8:11], s60 offen offset:2048 sc1 lds
v_mfma_f32_16x16x32_bf16 v[96:99], a[28:31], a[196:199], v[96:99]
v_fma_f32 v194, v194, v254, v254
v_mfma_f32_16x16x32_bf16 v[100:103], a[32:35], a[192:195], v[100:103]
v_mfma_f32_16x16x32_bf16 v[104:107], a[32:35], a[196:199], v[104:107]
s_waitcnt vmcnt(12) lgkmcnt(0)
s_barrier
v_mfma_f32_16x16x32_bf16 v[36:39], a[36:39], a[200:203], v[36:39]
ds_read_b128 a[0:3], v200 offset:0
buffer_load_dwordx4 v1, s[8:11], s60 offen offset:3072 sc1 lds
v_mfma_f32_16x16x32_bf16 v[40:43], a[36:39], a[204:207], v[40:43]
ds_read_b128 a[4:7], v200 offset:1024
v_fma_f32 v195, v195, v254, v254
v_mfma_f32_16x16x32_bf16 v[44:47], a[40:43], a[200:203], v[44:47]
ds_read_b128 a[8:11], v200 offset:2048
v_mfma_f32_16x16x32_bf16 v[48:51], a[40:43], a[204:207], v[48:51]
ds_read_b128 a[12:15], v200 offset:3072
v_mfma_f32_16x16x32_bf16 v[52:55], a[44:47], a[200:203], v[52:55]
ds_read_b128 a[16:19], v200 offset:4096
v_mfma_f32_16x16x32_bf16 v[56:59], a[44:47], a[204:207], v[56:59]
ds_read_b128 a[20:23], v200 offset:5120
v_mfma_f32_16x16x32_bf16 v[60:63], a[48:51], a[200:203], v[60:63]
ds_read_b128 a[24:27], v200 offset:6144
v_mfma_f32_16x16x32_bf16 v[64:67], a[48:51], a[204:207], v[64:67]
ds_read_b128 a[28:31], v200 offset:7168
v_mfma_f32_16x16x32_bf16 v[68:71], a[52:55], a[200:203], v[68:71]
ds_read_b128 a[32:35], v200 offset:8192
v_mfma_f32_16x16x32_bf16 v[72:75], a[52:55], a[204:207], v[72:75]
s_cmp_eq_u32 s25, 2
s_cselect_b32 s99, 36864, 0
s_add_u32 s60, s60, s99
v_mfma_f32_16x16x32_bf16 v[76:79], a[56:59], a[200:203], v[76:79]
s_add_u32 s61, s61, s99
s_add_u32 m0, s62, 126976
s_add_u32 s60, s60, 16384
v_mfma_f32_16x16x32_bf16 v[80:83], a[56:59], a[204:207], v[80:83]
buffer_load_dwordx4 v1, s[8:11], s60 offen offset:0 sc1 lds
v_mfma_f32_16x16x32_bf16 v[84:87], a[60:63], a[200:203], v[84:87]
v_rcp_f32 v192, v192
v_mfma_f32_16x16x32_bf16 v[88:91], a[60:63], a[204:207], v[88:91]
buffer_load_dwordx4 v1, s[8:11], s60 offen offset:1024 sc1 lds
v_mfma_f32_16x16x32_bf16 v[92:95], a[64:67], a[200:203], v[92:95]
v_rcp_f32 v193, v193
v_mfma_f32_16x16x32_bf16 v[96:99], a[64:67], a[204:207], v[96:99]
buffer_load_dwordx4 v1, s[8:11], s60 offen offset:2048 sc1 lds
v_mfma_f32_16x16x32_bf16 v[100:103], a[68:71], a[200:203], v[100:103]
v_rcp_f32 v194, v194
v_mfma_f32_16x16x32_bf16 v[104:107], a[68:71], a[204:207], v[104:107]
s_waitcnt lgkmcnt(0)
v_mfma_f32_16x16x32_bf16 v[36:39], a[0:3], a[208:211], v[36:39]
ds_read_b128 a[36:39], v200 offset:9216
buffer_load_dwordx4 v1, s[8:11], s60 offen offset:3072 sc1 lds
v_mfma_f32_16x16x32_bf16 v[40:43], a[0:3], a[212:215], v[40:43]
ds_read_b128 a[40:43], v200 offset:10240
v_mfma_f32_16x16x32_bf16 v[44:47], a[4:7], a[208:211], v[44:47]
ds_read_b128 a[44:47], v200 offset:11264
s_add_u32 m0, s63, 143360
v_mfma_f32_16x16x32_bf16 v[48:51], a[4:7], a[212:215], v[48:51]
ds_read_b128 a[48:51], v200 offset:12288
v_mfma_f32_16x16x32_bf16 v[52:55], a[8:11], a[208:211], v[52:55]
ds_read_b128 a[52:55], v200 offset:13312
s_add_u32 s61, s61, 36864
v_mfma_f32_16x16x32_bf16 v[56:59], a[8:11], a[212:215], v[56:59]
ds_read_b128 a[56:59], v200 offset:14336
v_mfma_f32_16x16x32_bf16 v[60:63], a[12:15], a[208:211], v[60:63]
ds_read_b128 a[60:63], v200 offset:15360
buffer_load_dwordx4 v1, s[8:11], s61 offen offset:0 sc1 lds
v_mfma_f32_16x16x32_bf16 v[64:67], a[12:15], a[212:215], v[64:67]
ds_read_b128 a[64:67], v200 offset:16384
v_mfma_f32_16x16x32_bf16 v[68:71], a[16:19], a[208:211], v[68:71]
ds_read_b128 a[68:71], v200 offset:17408
s_add_u32 m0, s62, 147456
v_mfma_f32_16x16x32_bf16 v[72:75], a[16:19], a[212:215], v[72:75]
s_add_u32 s60, s60, 20480
v_rcp_f32 v195, v195
v_mfma_f32_16x16x32_bf16 v[76:79], a[20:23], a[208:211], v[76:79]
v_mul_f32 v132, v132, v192
v_mul_f32 v133, v133, v193
v_mfma_f32_16x16x32_bf16 v[80:83], a[20:23], a[212:215], v[80:83]
v_mul_f32 v134, v134, v194
v_mul_f32 v135, v135, v195
v_mfma_f32_16x16x32_bf16 v[84:87], a[24:27], a[208:211], v[84:87]
buffer_load_dwordx4 v1, s[8:11], s60 offen offset:0 sc1 lds
v_mul_f32 v196, v136, v136
v_mfma_f32_16x16x32_bf16 v[88:91], a[24:27], a[212:215], v[88:91]
v_mfma_f32_16x16x32_bf16 v[92:95], a[28:31], a[208:211], v[92:95]
buffer_load_dwordx4 v1, s[8:11], s60 offen offset:1024 sc1 lds
v_mfma_f32_16x16x32_bf16 v[96:99], a[28:31], a[212:215], v[96:99]
v_mul_f32 v197, v137, v137
v_mfma_f32_16x16x32_bf16 v[100:103], a[32:35], a[208:211], v[100:103]
v_mfma_f32_16x16x32_bf16 v[104:107], a[32:35], a[212:215], v[104:107]
s_waitcnt vmcnt(16) lgkmcnt(0)
s_barrier
v_mfma_f32_16x16x32_bf16 v[36:39], a[36:39], a[216:219], v[36:39]
ds_read_b128 a[0:3], v200 offset:18432
buffer_load_dwordx4 v1, s[8:11], s60 offen offset:2048 sc1 lds
v_mfma_f32_16x16x32_bf16 v[40:43], a[36:39], a[220:223], v[40:43]
ds_read_b128 a[4:7], v200 offset:19456
v_mul_f32 v198, v138, v138
v_mfma_f32_16x16x32_bf16 v[44:47], a[40:43], a[216:219], v[44:47]
ds_read_b128 a[8:11], v200 offset:20480
v_mul_f32 v199, v139, v139
v_mfma_f32_16x16x32_bf16 v[48:51], a[40:43], a[220:223], v[48:51]
ds_read_b128 a[12:15], v200 offset:21504
v_mfma_f32_16x16x32_bf16 v[52:55], a[44:47], a[216:219], v[52:55]
ds_read_b128 a[16:19], v200 offset:22528
buffer_load_dwordx4 v1, s[8:11], s60 offen offset:3072 sc1 lds
v_mfma_f32_16x16x32_bf16 v[56:59], a[44:47], a[220:223], v[56:59]
ds_read_b128 a[20:23], v200 offset:23552
v_fma_f32 v196, v196, v253, v251
v_mfma_f32_16x16x32_bf16 v[60:63], a[48:51], a[216:219], v[60:63]
ds_read_b128 a[24:27], v200 offset:24576
v_fma_f32 v197, v197, v253, v251
v_mfma_f32_16x16x32_bf16 v[64:67], a[48:51], a[220:223], v[64:67]
ds_read_b128 a[28:31], v200 offset:25600
v_mfma_f32_16x16x32_bf16 v[68:71], a[52:55], a[216:219], v[68:71]
ds_read_b128 a[32:35], v200 offset:26624
buffer_load_dwordx4 a[144:147], v1, s[4:7], s52 offen offset:2048 sc1
v_mfma_f32_16x16x32_bf16 v[72:75], a[52:55], a[220:223], v[72:75]
v_fma_f32 v198, v198, v253, v251
v_mfma_f32_16x16x32_bf16 v[76:79], a[56:59], a[216:219], v[76:79]
v_mfma_f32_16x16x32_bf16 v[80:83], a[56:59], a[220:223], v[80:83]
v_fma_f32 v199, v199, v253, v251
v_mfma_f32_16x16x32_bf16 v[84:87], a[60:63], a[216:219], v[84:87]
buffer_load_dwordx4 a[148:151], v9, s[4:7], s52 offen offset:2048 sc1
v_mfma_f32_16x16x32_bf16 v[88:91], a[60:63], a[220:223], v[88:91]
v_mul_f32 v196, v196, v136
v_mfma_f32_16x16x32_bf16 v[92:95], a[64:67], a[216:219], v[92:95]
v_mfma_f32_16x16x32_bf16 v[96:99], a[64:67], a[220:223], v[96:99]
v_mfma_f32_16x16x32_bf16 v[100:103], a[68:71], a[216:219], v[100:103]
v_mul_f32 v197, v197, v137
v_mfma_f32_16x16x32_bf16 v[104:107], a[68:71], a[220:223], v[104:107]
s_waitcnt lgkmcnt(0)
v_mfma_f32_16x16x32_bf16 v[36:39], a[0:3], a[224:227], v[36:39]
ds_read_b128 a[36:39], v200 offset:27648
buffer_load_dwordx4 a[152:155], v1, s[4:7], s52 offen offset:3072 sc1
v_mfma_f32_16x16x32_bf16 v[40:43], a[0:3], a[228:231], v[40:43]
ds_read_b128 a[40:43], v200 offset:28672
v_mul_f32 v198, v198, v138
v_mfma_f32_16x16x32_bf16 v[44:47], a[4:7], a[224:227], v[44:47]
ds_read_b128 a[44:47], v200 offset:29696
buffer_load_dwordx4 a[156:159], v9, s[4:7], s52 offen offset:3072 sc1
v_mfma_f32_16x16x32_bf16 v[48:51], a[4:7], a[228:231], v[48:51]
ds_read_b128 a[48:51], v200 offset:30720
v_mul_f32 v199, v199, v139
v_mfma_f32_16x16x32_bf16 v[52:55], a[8:11], a[224:227], v[52:55]
ds_read_b128 a[52:55], v200 offset:31744
v_mfma_f32_16x16x32_bf16 v[56:59], a[8:11], a[228:231], v[56:59]
ds_read_b128 a[56:59], v200 offset:32768
v_mfma_f32_16x16x32_bf16 v[60:63], a[12:15], a[224:227], v[60:63]
ds_read_b128 a[60:63], v200 offset:33792
v_mfma_f32_16x16x32_bf16 v[64:67], a[12:15], a[228:231], v[64:67]
ds_read_b128 a[64:67], v200 offset:34816
v_mfma_f32_16x16x32_bf16 v[68:71], a[16:19], a[224:227], v[68:71]
ds_read_b128 a[68:71], v200 offset:35840
v_mfma_f32_16x16x32_bf16 v[72:75], a[16:19], a[228:231], v[72:75]
s_cmp_eq_u32 s25, 4
s_cselect_b32 s98, 4096, 0
s_add_u32 s52, s52, s98
v_mfma_f32_16x16x32_bf16 v[76:79], a[20:23], a[224:227], v[76:79]
s_add_u32 s52, s52, 4096
v_exp_f32 v196, v196
v_mfma_f32_16x16x32_bf16 v[80:83], a[20:23], a[228:231], v[80:83]
v_exp_f32 v197, v197
v_mfma_f32_16x16x32_bf16 v[84:87], a[24:27], a[224:227], v[84:87]
buffer_load_dwordx4 a[160:163], v1, s[4:7], s52 offen offset:0 sc1
v_mfma_f32_16x16x32_bf16 v[88:91], a[24:27], a[228:231], v[88:91]
v_mfma_f32_16x16x32_bf16 v[92:95], a[28:31], a[224:227], v[92:95]
buffer_load_dwordx4 a[164:167], v9, s[4:7], s52 offen offset:0 sc1
v_mfma_f32_16x16x32_bf16 v[96:99], a[28:31], a[228:231], v[96:99]
v_exp_f32 v198, v198
v_mfma_f32_16x16x32_bf16 v[100:103], a[32:35], a[224:227], v[100:103]
v_mfma_f32_16x16x32_bf16 v[104:107], a[32:35], a[228:231], v[104:107]
s_waitcnt vmcnt(19) lgkmcnt(0)
s_barrier
v_mfma_f32_16x16x32_bf16 v[36:39], a[36:39], a[232:235], v[36:39]
ds_read_b128 a[0:3], v201 offset:0
buffer_load_dwordx4 a[168:171], v1, s[4:7], s52 offen offset:1024 sc1
v_mfma_f32_16x16x32_bf16 v[40:43], a[36:39], a[236:239], v[40:43]
ds_read_b128 a[4:7], v201 offset:1024
buffer_load_dwordx4 a[172:175], v9, s[4:7], s52 offen offset:1024 sc1
v_mfma_f32_16x16x32_bf16 v[44:47], a[40:43], a[232:235], v[44:47]
ds_read_b128 a[8:11], v201 offset:2048
v_mfma_f32_16x16x32_bf16 v[48:51], a[40:43], a[236:239], v[48:51]
ds_read_b128 a[12:15], v201 offset:3072
v_mfma_f32_16x16x32_bf16 v[52:55], a[44:47], a[232:235], v[52:55]
ds_read_b128 a[16:19], v201 offset:4096
v_mfma_f32_16x16x32_bf16 v[56:59], a[44:47], a[236:239], v[56:59]
ds_read_b128 a[20:23], v201 offset:5120
v_mfma_f32_16x16x32_bf16 v[60:63], a[48:51], a[232:235], v[60:63]
ds_read_b128 a[24:27], v201 offset:6144
v_mfma_f32_16x16x32_bf16 v[64:67], a[48:51], a[236:239], v[64:67]
ds_read_b128 a[28:31], v201 offset:7168
v_mfma_f32_16x16x32_bf16 v[68:71], a[52:55], a[232:235], v[68:71]
ds_read_b128 a[32:35], v201 offset:8192
v_mfma_f32_16x16x32_bf16 v[72:75], a[52:55], a[236:239], v[72:75]
s_cmp_eq_u32 s25, 3
s_cselect_b32 s99, 36864, 0
s_add_u32 s60, s60, s99
v_mfma_f32_16x16x32_bf16 v[76:79], a[56:59], a[232:235], v[76:79]
s_add_u32 s61, s61, s99
s_add_u32 m0, s62, 53248
v_mfma_f32_16x16x32_bf16 v[80:83], a[56:59], a[236:239], v[80:83]
s_add_u32 s60, s60, 16384
v_exp_f32 v199, v199
v_mfma_f32_16x16x32_bf16 v[84:87], a[60:63], a[232:235], v[84:87]
v_fma_f32 v196, v196, v255, v255
v_fma_f32 v197, v197, v255, v255
v_mfma_f32_16x16x32_bf16 v[88:91], a[60:63], a[236:239], v[88:91]
buffer_load_dwordx4 v1, s[8:11], s60 offen offset:0 sc1 lds
v_fma_f32 v198, v198, v255, v255
v_mfma_f32_16x16x32_bf16 v[92:95], a[64:67], a[232:235], v[92:95]
v_fma_f32 v199, v199, v255, v255
v_mfma_f32_16x16x32_bf16 v[96:99], a[64:67], a[236:239], v[96:99]
buffer_load_dwordx4 v1, s[8:11], s60 offen offset:1024 sc1 lds
v_mfma_f32_16x16x32_bf16 v[100:103], a[68:71], a[232:235], v[100:103]
v_rcp_f32 v196, v196
v_mfma_f32_16x16x32_bf16 v[104:107], a[68:71], a[236:239], v[104:107]
s_waitcnt lgkmcnt(0)
v_mfma_f32_16x16x32_bf16 v[36:39], a[0:3], a[240:243], v[36:39]
ds_read_b128 a[36:39], v201 offset:9216
buffer_load_dwordx4 v1, s[8:11], s60 offen offset:2048 sc1 lds
v_mfma_f32_16x16x32_bf16 v[40:43], a[0:3], a[244:247], v[40:43]
ds_read_b128 a[40:43], v201 offset:10240
v_mfma_f32_16x16x32_bf16 v[44:47], a[4:7], a[240:243], v[44:47]
ds_read_b128 a[44:47], v201 offset:11264
buffer_load_dwordx4 v1, s[8:11], s60 offen offset:3072 sc1 lds
v_mfma_f32_16x16x32_bf16 v[48:51], a[4:7], a[244:247], v[48:51]
ds_read_b128 a[48:51], v201 offset:12288
v_mfma_f32_16x16x32_bf16 v[52:55], a[8:11], a[240:243], v[52:55]
ds_read_b128 a[52:55], v201 offset:13312
s_add_u32 m0, s63, 69632
v_mfma_f32_16x16x32_bf16 v[56:59], a[8:11], a[244:247], v[56:59]
ds_read_b128 a[56:59], v201 offset:14336
v_mfma_f32_16x16x32_bf16 v[60:63], a[12:15], a[240:243], v[60:63]
ds_read_b128 a[60:63], v201 offset:15360
s_add_u32 s61, s61, 36864
v_mfma_f32_16x16x32_bf16 v[64:67], a[12:15], a[244:247], v[64:67]
ds_read_b128 a[64:67], v201 offset:16384
v_mfma_f32_16x16x32_bf16 v[68:71], a[16:19], a[240:243], v[68:71]
ds_read_b128 a[68:71], v201 offset:17408
buffer_load_dwordx4 v1, s[8:11], s61 offen offset:0 sc1 lds
v_mfma_f32_16x16x32_bf16 v[72:75], a[16:19], a[244:247], v[72:75]
s_add_u32 m0, s62, 73728
v_rcp_f32 v197, v197
v_mfma_f32_16x16x32_bf16 v[76:79], a[20:23], a[240:243], v[76:79]
s_add_u32 s60, s60, 20480
v_rcp_f32 v198, v198
v_mfma_f32_16x16x32_bf16 v[80:83], a[20:23], a[244:247], v[80:83]
v_rcp_f32 v199, v199
v_mfma_f32_16x16x32_bf16 v[84:87], a[24:27], a[240:243], v[84:87]
v_mfma_f32_16x16x32_bf16 v[88:91], a[24:27], a[244:247], v[88:91]
v_mfma_f32_16x16x32_bf16 v[92:95], a[28:31], a[240:243], v[92:95]
buffer_load_dwordx4 v1, s[8:11], s60 offen offset:0 sc1 lds
v_mfma_f32_16x16x32_bf16 v[96:99], a[28:31], a[244:247], v[96:99]
v_mfma_f32_16x16x32_bf16 v[100:103], a[32:35], a[240:243], v[100:103]
v_mul_f32 v136, v136, v196
v_mfma_f32_16x16x32_bf16 v[104:107], a[32:35], a[244:247], v[104:107]
s_waitcnt vmcnt(23) lgkmcnt(0)
s_barrier
v_mfma_f32_16x16x32_bf16 v[36:39], a[36:39], a[248:251], v[36:39]
ds_read_b128 a[0:3], v201 offset:18432
buffer_load_dwordx4 v1, s[8:11], s60 offen offset:1024 sc1 lds
v_mfma_f32_16x16x32_bf16 v[40:43], a[36:39], a[252:255], v[40:43]
ds_read_b128 a[4:7], v201 offset:19456
v_mul_f32 v137, v137, v197
v_mfma_f32_16x16x32_bf16 v[44:47], a[40:43], a[248:251], v[44:47]
ds_read_b128 a[8:11], v201 offset:20480
v_mul_f32 v138, v138, v198
v_mfma_f32_16x16x32_bf16 v[48:51], a[40:43], a[252:255], v[48:51]
ds_read_b128 a[12:15], v201 offset:21504
v_mfma_f32_16x16x32_bf16 v[52:55], a[44:47], a[248:251], v[52:55]
ds_read_b128 a[16:19], v201 offset:22528
buffer_load_dwordx4 v1, s[8:11], s60 offen offset:2048 sc1 lds
v_mfma_f32_16x16x32_bf16 v[56:59], a[44:47], a[252:255], v[56:59]
ds_read_b128 a[20:23], v201 offset:23552
v_mul_f32 v139, v139, v199
v_mfma_f32_16x16x32_bf16 v[60:63], a[48:51], a[248:251], v[60:63]
ds_read_b128 a[24:27], v201 offset:24576
v_mfma_f32_16x16x32_bf16 v[64:67], a[48:51], a[252:255], v[64:67]
ds_read_b128 a[28:31], v201 offset:25600
v_mul_f32 v192, v140, v140
v_mfma_f32_16x16x32_bf16 v[68:71], a[52:55], a[248:251], v[68:71]
ds_read_b128 a[32:35], v201 offset:26624
buffer_load_dwordx4 v1, s[8:11], s60 offen offset:3072 sc1 lds
v_mfma_f32_16x16x32_bf16 v[72:75], a[52:55], a[252:255], v[72:75]
v_mfma_f32_16x16x32_bf16 v[76:79], a[56:59], a[248:251], v[76:79]
v_mul_f32 v193, v141, v141
v_mfma_f32_16x16x32_bf16 v[80:83], a[56:59], a[252:255], v[80:83]
v_mfma_f32_16x16x32_bf16 v[84:87], a[60:63], a[248:251], v[84:87]
buffer_load_dwordx4 a[176:179], v1, s[4:7], s52 offen offset:2048 sc1
v_mul_f32 v194, v142, v142
v_mfma_f32_16x16x32_bf16 v[88:91], a[60:63], a[252:255], v[88:91]
v_mfma_f32_16x16x32_bf16 v[92:95], a[64:67], a[248:251], v[92:95]
v_mul_f32 v195, v143, v143
v_mfma_f32_16x16x32_bf16 v[96:99], a[64:67], a[252:255], v[96:99]
v_mfma_f32_16x16x32_bf16 v[100:103], a[68:71], a[248:251], v[100:103]
v_mfma_f32_16x16x32_bf16 v[104:107], a[68:71], a[252:255], v[104:107]
v_fma_f32 v192, v192, v252, v250
s_waitcnt lgkmcnt(0)
v_mfma_f32_16x16x32_bf16 v[36:39], a[0:3], a[80:83], v[36:39]
ds_read_b128 a[36:39], v201 offset:27648
buffer_load_dwordx4 a[180:183], v9, s[4:7], s52 offen offset:2048 sc1
v_mfma_f32_16x16x32_bf16 v[40:43], a[0:3], a[84:87], v[40:43]
ds_read_b128 a[40:43], v201 offset:28672
v_fma_f32 v193, v193, v252, v250
v_mfma_f32_16x16x32_bf16 v[44:47], a[4:7], a[80:83], v[44:47]
ds_read_b128 a[44:47], v201 offset:29696
buffer_load_dwordx4 a[184:187], v1, s[4:7], s52 offen offset:3072 sc1
v_mfma_f32_16x16x32_bf16 v[48:51], a[4:7], a[84:87], v[48:51]
ds_read_b128 a[48:51], v201 offset:30720
v_fma_f32 v194, v194, v252, v250
v_mfma_f32_16x16x32_bf16 v[52:55], a[8:11], a[80:83], v[52:55]
ds_read_b128 a[52:55], v201 offset:31744
buffer_load_dwordx4 a[188:191], v9, s[4:7], s52 offen offset:3072 sc1
v_mfma_f32_16x16x32_bf16 v[56:59], a[8:11], a[84:87], v[56:59]
ds_read_b128 a[56:59], v201 offset:32768
v_mfma_f32_16x16x32_bf16 v[60:63], a[12:15], a[80:83], v[60:63]
ds_read_b128 a[60:63], v201 offset:33792
v_fma_f32 v195, v195, v252, v250
v_mfma_f32_16x16x32_bf16 v[64:67], a[12:15], a[84:87], v[64:67]
ds_read_b128 a[64:67], v201 offset:34816
v_mfma_f32_16x16x32_bf16 v[68:71], a[16:19], a[80:83], v[68:71]
ds_read_b128 a[68:71], v201 offset:35840
v_mul_f32 v192, v192, v140
v_mfma_f32_16x16x32_bf16 v[72:75], a[16:19], a[84:87], v[72:75]
s_cmp_eq_u32 s25, 5
s_cselect_b32 s98, 4096, 0
v_mfma_f32_16x16x32_bf16 v[76:79], a[20:23], a[80:83], v[76:79]
s_add_u32 s52, s52, s98
v_mul_f32 v193, v193, v141
v_mfma_f32_16x16x32_bf16 v[80:83], a[20:23], a[84:87], v[80:83]
s_add_u32 s52, s52, 4096
v_mfma_f32_16x16x32_bf16 v[84:87], a[24:27], a[80:83], v[84:87]
v_mfma_f32_16x16x32_bf16 v[88:91], a[24:27], a[84:87], v[88:91]
v_mul_f32 v194, v194, v142
v_mfma_f32_16x16x32_bf16 v[92:95], a[28:31], a[80:83], v[92:95]
buffer_load_dwordx4 a[192:195], v1, s[4:7], s52 offen offset:0 sc1
v_mfma_f32_16x16x32_bf16 v[96:99], a[28:31], a[84:87], v[96:99]
v_mul_f32 v195, v195, v143
v_mfma_f32_16x16x32_bf16 v[100:103], a[32:35], a[80:83], v[100:103]
v_mfma_f32_16x16x32_bf16 v[104:107], a[32:35], a[84:87], v[104:107]
s_waitcnt vmcnt(22) lgkmcnt(0)
s_barrier
v_mfma_f32_16x16x32_bf16 v[36:39], a[36:39], a[88:91], v[36:39]
ds_read_b128 a[0:3], v202 offset:0
buffer_load_dwordx4 a[196:199], v9, s[4:7], s52 offen offset:0 sc1
v_mfma_f32_16x16x32_bf16 v[40:43], a[36:39], a[92:95], v[40:43]
ds_read_b128 a[4:7], v202 offset:1024
buffer_load_dwordx4 a[200:203], v1, s[4:7], s52 offen offset:1024 sc1
v_mfma_f32_16x16x32_bf16 v[44:47], a[40:43], a[88:91], v[44:47]
ds_read_b128 a[8:11], v202 offset:2048
v_mfma_f32_16x16x32_bf16 v[48:51], a[40:43], a[92:95], v[48:51]
ds_read_b128 a[12:15], v202 offset:3072
buffer_load_dwordx4 a[204:207], v9, s[4:7], s52 offen offset:1024 sc1
v_mfma_f32_16x16x32_bf16 v[52:55], a[44:47], a[88:91], v[52:55]
ds_read_b128 a[16:19], v202 offset:4096
v_mfma_f32_16x16x32_bf16 v[56:59], a[44:47], a[92:95], v[56:59]
ds_read_b128 a[20:23], v202 offset:5120
v_mfma_f32_16x16x32_bf16 v[60:63], a[48:51], a[88:91], v[60:63]
ds_read_b128 a[24:27], v202 offset:6144
v_mfma_f32_16x16x32_bf16 v[64:67], a[48:51], a[92:95], v[64:67]
ds_read_b128 a[28:31], v202 offset:7168
v_mfma_f32_16x16x32_bf16 v[68:71], a[52:55], a[88:91], v[68:71]
ds_read_b128 a[32:35], v202 offset:8192
v_mfma_f32_16x16x32_bf16 v[72:75], a[52:55], a[92:95], v[72:75]
s_cmp_eq_u32 s25, 4
s_cselect_b32 s99, 36864, 0
s_add_u32 s60, s60, s99
v_mfma_f32_16x16x32_bf16 v[76:79], a[56:59], a[88:91], v[76:79]
s_add_u32 s61, s61, s99
v_exp_f32 v192, v192
v_mfma_f32_16x16x32_bf16 v[80:83], a[56:59], a[92:95], v[80:83]
s_add_u32 m0, s62, 90112
v_exp_f32 v193, v193
v_mfma_f32_16x16x32_bf16 v[84:87], a[60:63], a[88:91], v[84:87]
s_add_u32 s60, s60, 16384
v_exp_f32 v194, v194
v_mfma_f32_16x16x32_bf16 v[88:91], a[60:63], a[92:95], v[88:91]
v_mfma_f32_16x16x32_bf16 v[92:95], a[64:67], a[88:91], v[92:95]
v_exp_f32 v195, v195
v_mfma_f32_16x16x32_bf16 v[96:99], a[64:67], a[92:95], v[96:99]
buffer_load_dwordx4 v1, s[8:11], s60 offen offset:0 sc1 lds
v_mfma_f32_16x16x32_bf16 v[100:103], a[68:71], a[88:91], v[100:103]
v_mfma_f32_16x16x32_bf16 v[104:107], a[68:71], a[92:95], v[104:107]
s_waitcnt lgkmcnt(0)
v_mfma_f32_16x16x32_bf16 v[36:39], a[0:3], a[96:99], v[36:39]
ds_read_b128 a[36:39], v202 offset:9216
buffer_load_dwordx4 v1, s[8:11], s60 offen offset:1024 sc1 lds
v_mfma_f32_16x16x32_bf16 v[40:43], a[0:3], a[100:103], v[40:43]
ds_read_b128 a[40:43], v202 offset:10240
v_fma_f32 v192, v192, v254, v254
v_mfma_f32_16x16x32_bf16 v[44:47], a[4:7], a[96:99], v[44:47]
ds_read_b128 a[44:47], v202 offset:11264
buffer_load_dwordx4 v1, s[8:11], s60 offen offset:2048 sc1 lds
v_mfma_f32_16x16x32_bf16 v[48:51], a[4:7], a[100:103], v[48:51]
ds_read_b128 a[48:51], v202 offset:12288
v_fma_f32 v193, v193, v254, v254
v_mfma_f32_16x16x32_bf16 v[52:55], a[8:11], a[96:99], v[52:55]
ds_read_b128 a[52:55], v202 offset:13312
v_mfma_f32_16x16x32_bf16 v[56:59], a[8:11], a[100:103], v[56:59]
ds_read_b128 a[56:59], v202 offset:14336
buffer_load_dwordx4 v1, s[8:11], s60 offen offset:3072 sc1 lds
v_mfma_f32_16x16x32_bf16 v[60:63], a[12:15], a[96:99], v[60:63]
ds_read_b128 a[60:63], v202 offset:15360
v_fma_f32 v194, v194, v254, v254
v_mfma_f32_16x16x32_bf16 v[64:67], a[12:15], a[100:103], v[64:67]
ds_read_b128 a[64:67], v202 offset:16384
v_fma_f32 v195, v195, v254, v254
v_mfma_f32_16x16x32_bf16 v[68:71], a[16:19], a[96:99], v[68:71]
ds_read_b128 a[68:71], v202 offset:17408
s_add_u32 m0, s63, 106496
v_mfma_f32_16x16x32_bf16 v[72:75], a[16:19], a[100:103], v[72:75]
s_add_u32 s61, s61, 36864
v_mfma_f32_16x16x32_bf16 v[76:79], a[20:23], a[96:99], v[76:79]
v_rcp_f32 v192, v192
v_mfma_f32_16x16x32_bf16 v[80:83], a[20:23], a[100:103], v[80:83]
v_mfma_f32_16x16x32_bf16 v[84:87], a[24:27], a[96:99], v[84:87]
v_mfma_f32_16x16x32_bf16 v[88:91], a[24:27], a[100:103], v[88:91]
v_mfma_f32_16x16x32_bf16 v[92:95], a[28:31], a[96:99], v[92:95]
buffer_load_dwordx4 v1, s[8:11], s61 offen offset:0 sc1 lds
v_mfma_f32_16x16x32_bf16 v[96:99], a[28:31], a[100:103], v[96:99]
v_rcp_f32 v193, v193
v_mfma_f32_16x16x32_bf16 v[100:103], a[32:35], a[96:99], v[100:103]
v_mfma_f32_16x16x32_bf16 v[104:107], a[32:35], a[100:103], v[104:107]
s_waitcnt lgkmcnt(0)
v_mfma_f32_16x16x32_bf16 v[36:39], a[36:39], a[104:107], v[36:39]
ds_read_b128 a[0:3], v202 offset:18432
s_add_u32 m0, s62, 110592
v_mfma_f32_16x16x32_bf16 v[40:43], a[36:39], a[108:111], v[40:43]
ds_read_b128 a[4:7], v202 offset:19456
v_mfma_f32_16x16x32_bf16 v[44:47], a[40:43], a[104:107], v[44:47]
ds_read_b128 a[8:11], v202 offset:20480
s_add_u32 s60, s60, 20480
v_mfma_f32_16x16x32_bf16 v[48:51], a[40:43], a[108:111], v[48:51]
ds_read_b128 a[12:15], v202 offset:21504
v_mfma_f32_16x16x32_bf16 v[52:55], a[44:47], a[104:107], v[52:55]
ds_read_b128 a[16:19], v202 offset:22528
v_mfma_f32_16x16x32_bf16 v[56:59], a[44:47], a[108:111], v[56:59]
ds_read_b128 a[20:23], v202 offset:23552
buffer_load_dwordx4 v1, s[8:11], s60 offen offset:0 sc1 lds
v_mfma_f32_16x16x32_bf16 v[60:63], a[48:51], a[104:107], v[60:63]
ds_read_b128 a[24:27], v202 offset:24576
v_mfma_f32_16x16x32_bf16 v[64:67], a[48:51], a[108:111], v[64:67]
ds_read_b128 a[28:31], v202 offset:25600
v_mfma_f32_16x16x32_bf16 v[68:71], a[52:55], a[104:107], v[68:71]
ds_read_b128 a[32:35], v202 offset:26624
buffer_load_dwordx4 v1, s[8:11], s60 offen offset:1024 sc1 lds
v_mfma_f32_16x16x32_bf16 v[72:75], a[52:55], a[108:111], v[72:75]
v_rcp_f32 v194, v194
v_mfma_f32_16x16x32_bf16 v[76:79], a[56:59], a[104:107], v[76:79]
v_rcp_f32 v195, v195
v_mfma_f32_16x16x32_bf16 v[80:83], a[56:59], a[108:111], v[80:83]
buffer_load_dwordx4 v1, s[8:11], s60 offen offset:2048 sc1 lds
v_mul_f32 v140, v140, v192
v_mfma_f32_16x16x32_bf16 v[84:87], a[60:63], a[104:107], v[84:87]
v_mfma_f32_16x16x32_bf16 v[88:91], a[60:63], a[108:111], v[88:91]
v_mul_f32 v141, v141, v193
v_mfma_f32_16x16x32_bf16 v[92:95], a[64:67], a[104:107], v[92:95]
buffer_load_dwordx4 v1, s[8:11], s60 offen offset:3072 sc1 lds
v_mfma_f32_16x16x32_bf16 v[96:99], a[64:67], a[108:111], v[96:99]
v_mul_f32 v142, v142, v194
v_mfma_f32_16x16x32_bf16 v[100:103], a[68:71], a[104:107], v[100:103]
v_mfma_f32_16x16x32_bf16 v[104:107], a[68:71], a[108:111], v[104:107]
s_waitcnt lgkmcnt(0)
v_mfma_f32_16x16x32_bf16 v[36:39], a[0:3], a[112:115], v[36:39]
ds_read_b128 a[36:39], v202 offset:27648
buffer_load_dwordx4 a[208:211], v1, s[4:7], s52 offen offset:2048 sc1
v_mfma_f32_16x16x32_bf16 v[40:43], a[0:3], a[116:119], v[40:43]
ds_read_b128 a[40:43], v202 offset:28672
s_mov_b32 s37, L_c4+8192-L_pc
v_mfma_f32_16x16x32_bf16 v[44:47], a[4:7], a[112:115], v[44:47]
ds_read_b128 a[44:47], v202 offset:29696
v_mul_f32 v143, v143, v195
v_mfma_f32_16x16x32_bf16 v[48:51], a[4:7], a[116:119], v[48:51]
ds_read_b128 a[48:51], v202 offset:30720
v_mul_f32 v196, v144, v144
v_mfma_f32_16x16x32_bf16 v[52:55], a[8:11], a[112:115], v[52:55]
ds_read_b128 a[52:55], v202 offset:31744
buffer_load_dwordx4 a[212:215], v9, s[4:7], s52 offen offset:2048 sc1
v_mfma_f32_16x16x32_bf16 v[56:59], a[8:11], a[116:119], v[56:59]
ds_read_b128 a[56:59], v202 offset:32768
buffer_load_dword v15, v14, s[88:91], s37 offen
v_mfma_f32_16x16x32_bf16 v[60:63], a[12:15], a[112:115], v[60:63]
ds_read_b128 a[60:63], v202 offset:33792
v_mul_f32 v197, v145, v145
v_mfma_f32_16x16x32_bf16 v[64:67], a[12:15], a[116:119], v[64:67]
ds_read_b128 a[64:67], v202 offset:34816
v_mul_f32 v198, v146, v146
v_mfma_f32_16x16x32_bf16 v[68:71], a[16:19], a[112:115], v[68:71]
ds_read_b128 a[68:71], v202 offset:35840
buffer_load_dwordx4 a[216:219], v1, s[4:7], s52 offen offset:3072 sc1
v_mfma_f32_16x16x32_bf16 v[72:75], a[16:19], a[116:119], v[72:75]
v_mul_f32 v199, v147, v147
v_mfma_f32_16x16x32_bf16 v[76:79], a[20:23], a[112:115], v[76:79]
v_mfma_f32_16x16x32_bf16 v[80:83], a[20:23], a[116:119], v[80:83]
v_fma_f32 v196, v196, v253, v251
v_mfma_f32_16x16x32_bf16 v[84:87], a[24:27], a[112:115], v[84:87]
buffer_load_dwordx4 a[220:223], v9, s[4:7], s52 offen offset:3072 sc1
v_mfma_f32_16x16x32_bf16 v[88:91], a[24:27], a[116:119], v[88:91]
v_mfma_f32_16x16x32_bf16 v[92:95], a[28:31], a[112:115], v[92:95]
v_fma_f32 v197, v197, v253, v251
v_mfma_f32_16x16x32_bf16 v[96:99], a[28:31], a[116:119], v[96:99]
v_mfma_f32_16x16x32_bf16 v[100:103], a[32:35], a[112:115], v[100:103]
v_fma_f32 v198, v198, v253, v251
v_mfma_f32_16x16x32_bf16 v[104:107], a[32:35], a[116:119], v[104:107]
s_waitcnt vmcnt(22) lgkmcnt(0)
s_barrier
v_mfma_f32_16x16x32_bf16 v[36:39], a[36:39], a[120:123], v[36:39]
ds_read_b128 a[0:3], v200 offset:0
v_mfma_f32_16x16x32_bf16 v[40:43], a[36:39], a[124:127], v[40:43]
ds_read_b128 a[4:7], v200 offset:1024
v_fma_f32 v199, v199, v253, v251
v_mfma_f32_16x16x32_bf16 v[44:47], a[40:43], a[120:123], v[44:47]
ds_read_b128 a[8:11], v200 offset:2048
v_mfma_f32_16x16x32_bf16 v[48:51], a[40:43], a[124:127], v[48:51]
ds_read_b128 a[12:15], v200 offset:3072
v_mul_f32 v196, v196, v144
v_mfma_f32_16x16x32_bf16 v[52:55], a[44:47], a[120:123], v[52:55]
ds_read_b128 a[16:19], v200 offset:4096
v_mfma_f32_16x16x32_bf16 v[56:59], a[44:47], a[124:127], v[56:59]
ds_read_b128 a[20:23], v200 offset:5120
v_mul_f32 v197, v197, v145
v_mfma_f32_16x16x32_bf16 v[60:63], a[48:51], a[120:123], v[60:63]
ds_read_b128 a[24:27], v200 offset:6144
v_mfma_f32_16x16x32_bf16 v[64:67], a[48:51], a[124:127], v[64:67]
ds_read_b128 a[28:31], v200 offset:7168
v_mfma_f32_16x16x32_bf16 v[68:71], a[52:55], a[120:123], v[68:71]
ds_read_b128 a[32:35], v200 offset:8192
v_mul_f32 v198, v198, v146
v_mfma_f32_16x16x32_bf16 v[72:75], a[52:55], a[124:127], v[72:75]
s_cmp_eq_u32 s25, 5
s_cselect_b32 s99, 36864, 0
s_add_u32 s60, s60, s99
v_mfma_f32_16x16x32_bf16 v[76:79], a[56:59], a[120:123], v[76:79]
s_add_u32 s61, s61, s99
s_add_u32 m0, s62, 126976
s_add_u32 s60, s60, 16384
v_mfma_f32_16x16x32_bf16 v[80:83], a[56:59], a[124:127], v[80:83]
buffer_load_dwordx4 v1, s[8:11], s60 offen offset:0 sc1 lds
v_mul_f32 v199, v199, v147
v_mfma_f32_16x16x32_bf16 v[84:87], a[60:63], a[120:123], v[84:87]
buffer_load_dwordx4 v1, s[8:11], s60 offen offset:1024 sc1 lds
v_mfma_f32_16x16x32_bf16 v[88:91], a[60:63], a[124:127], v[88:91]
buffer_load_dwordx4 v1, s[8:11], s60 offen offset:2048 sc1 lds
v_mfma_f32_16x16x32_bf16 v[92:95], a[64:67], a[120:123], v[92:95]
v_exp_f32 v196, v196
v_mfma_f32_16x16x32_bf16 v[96:99], a[64:67], a[124:127], v[96:99]
buffer_load_dwordx4 v1, s[8:11], s60 offen offset:3072 sc1 lds
v_mfma_f32_16x16x32_bf16 v[100:103], a[68:71], a[120:123], v[100:103]
v_mfma_f32_16x16x32_bf16 v[104:107], a[68:71], a[124:127], v[104:107]
s_waitcnt lgkmcnt(0)
v_mfma_f32_16x16x32_bf16 v[36:39], a[0:3], a[128:131], v[36:39]
ds_read_b128 a[36:39], v200 offset:9216
s_add_u32 m0, s63, 143360
v_mfma_f32_16x16x32_bf16 v[40:43], a[0:3], a[132:135], v[40:43]
ds_read_b128 a[40:43], v200 offset:10240
v_mfma_f32_16x16x32_bf16 v[44:47], a[4:7], a[128:131], v[44:47]
ds_read_b128 a[44:47], v200 offset:11264
s_add_u32 s61, s61, 36864
v_mfma_f32_16x16x32_bf16 v[48:51], a[4:7], a[132:135], v[48:51]
ds_read_b128 a[48:51], v200 offset:12288
v_mfma_f32_16x16x32_bf16 v[52:55], a[8:11], a[128:131], v[52:55]
ds_read_b128 a[52:55], v200 offset:13312
buffer_load_dwordx4 v1, s[8:11], s61 offen offset:0 sc1 lds
v_mfma_f32_16x16x32_bf16 v[56:59], a[8:11], a[132:135], v[56:59]
ds_read_b128 a[56:59], v200 offset:14336
v_mfma_f32_16x16x32_bf16 v[60:63], a[12:15], a[128:131], v[60:63]
ds_read_b128 a[60:63], v200 offset:15360
s_add_u32 m0, s62, 147456
v_mfma_f32_16x16x32_bf16 v[64:67], a[12:15], a[132:135], v[64:67]
ds_read_b128 a[64:67], v200 offset:16384
v_mfma_f32_16x16x32_bf16 v[68:71], a[16:19], a[128:131], v[68:71]
ds_read_b128 a[68:71], v200 offset:17408
s_add_u32 s60, s60, 20480
v_mfma_f32_16x16x32_bf16 v[72:75], a[16:19], a[132:135], v[72:75]
v_exp_f32 v197, v197
v_mfma_f32_16x16x32_bf16 v[76:79], a[20:23], a[128:131], v[76:79]
buffer_load_dwordx4 v1, s[8:11], s60 offen offset:0 sc1 lds
v_mfma_f32_16x16x32_bf16 v[80:83], a[20:23], a[132:135], v[80:83]
v_exp_f32 v198, v198
v_mfma_f32_16x16x32_bf16 v[84:87], a[24:27], a[128:131], v[84:87]
buffer_load_dwordx4 v1, s[8:11], s60 offen offset:1024 sc1 lds
v_mfma_f32_16x16x32_bf16 v[88:91], a[24:27], a[132:135], v[88:91]
v_exp_f32 v199, v199
v_mfma_f32_16x16x32_bf16 v[92:95], a[28:31], a[128:131], v[92:95]
buffer_load_dwordx4 v1, s[8:11], s60 offen offset:2048 sc1 lds
v_fma_f32 v196, v196, v255, v255
v_mfma_f32_16x16x32_bf16 v[96:99], a[28:31], a[132:135], v[96:99]
v_mfma_f32_16x16x32_bf16 v[100:103], a[32:35], a[128:131], v[100:103]
v_fma_f32 v197, v197, v255, v255
v_mfma_f32_16x16x32_bf16 v[104:107], a[32:35], a[132:135], v[104:107]
s_waitcnt lgkmcnt(0)
v_mfma_f32_16x16x32_bf16 v[36:39], a[36:39], a[136:139], v[36:39]
ds_read_b128 a[0:3], v200 offset:18432
buffer_load_dwordx4 v1, s[8:11], s60 offen offset:3072 sc1 lds
v_mfma_f32_16x16x32_bf16 v[40:43], a[36:39], a[140:143], v[40:43]
ds_read_b128 a[4:7], v200 offset:19456
v_fma_f32 v198, v198, v255, v255
v_mfma_f32_16x16x32_bf16 v[44:47], a[40:43], a[136:139], v[44:47]
ds_read_b128 a[8:11], v200 offset:20480
v_fma_f32 v199, v199, v255, v255
v_mfma_f32_16x16x32_bf16 v[48:51], a[40:43], a[140:143], v[48:51]
ds_read_b128 a[12:15], v200 offset:21504
v_mfma_f32_16x16x32_bf16 v[52:55], a[44:47], a[136:139], v[52:55]
ds_read_b128 a[16:19], v200 offset:22528
v_mfma_f32_16x16x32_bf16 v[56:59], a[44:47], a[140:143], v[56:59]
ds_read_b128 a[20:23], v200 offset:23552
v_mfma_f32_16x16x32_bf16 v[60:63], a[48:51], a[136:139], v[60:63]
ds_read_b128 a[24:27], v200 offset:24576
v_mfma_f32_16x16x32_bf16 v[64:67], a[48:51], a[140:143], v[64:67]
ds_read_b128 a[28:31], v200 offset:25600
v_mfma_f32_16x16x32_bf16 v[68:71], a[52:55], a[136:139], v[68:71]
ds_read_b128 a[32:35], v200 offset:26624
v_mfma_f32_16x16x32_bf16 v[72:75], a[52:55], a[140:143], v[72:75]
s_cmp_eq_u32 s25, 6
s_cselect_b32 s98, 4096, 0
s_add_u32 s52, s52, s98
v_mfma_f32_16x16x32_bf16 v[76:79], a[56:59], a[136:139], v[76:79]
s_add_u32 s52, s52, 4096
v_rcp_f32 v196, v196
v_mfma_f32_16x16x32_bf16 v[80:83], a[56:59], a[140:143], v[80:83]
buffer_load_dwordx4 a[224:227], v1, s[4:7], s52 offen offset:0 sc1
v_mfma_f32_16x16x32_bf16 v[84:87], a[60:63], a[136:139], v[84:87]
buffer_load_dwordx4 a[228:231], v9, s[4:7], s52 offen offset:0 sc1
v_mfma_f32_16x16x32_bf16 v[88:91], a[60:63], a[140:143], v[88:91]
v_rcp_f32 v197, v197
v_mfma_f32_16x16x32_bf16 v[92:95], a[64:67], a[136:139], v[92:95]
buffer_load_dwordx4 a[232:235], v1, s[4:7], s52 offen offset:1024 sc1
v_mfma_f32_16x16x32_bf16 v[96:99], a[64:67], a[140:143], v[96:99]
v_rcp_f32 v198, v198
v_mfma_f32_16x16x32_bf16 v[100:103], a[68:71], a[136:139], v[100:103]
v_mfma_f32_16x16x32_bf16 v[104:107], a[68:71], a[140:143], v[104:107]
s_waitcnt lgkmcnt(0)
v_mfma_f32_16x16x32_bf16 v[36:39], a[0:3], a[144:147], v[36:39]
ds_read_b128 a[36:39], v200 offset:27648
buffer_load_dwordx4 a[236:239], v9, s[4:7], s52 offen offset:1024 sc1
v_mfma_f32_16x16x32_bf16 v[40:43], a[0:3], a[148:151], v[40:43]
ds_read_b128 a[40:43], v200 offset:28672
v_mfma_f32_16x16x32_bf16 v[44:47], a[4:7], a[144:147], v[44:47]
ds_read_b128 a[44:47], v200 offset:29696
v_mfma_f32_16x16x32_bf16 v[48:51], a[4:7], a[148:151], v[48:51]
ds_read_b128 a[48:51], v200 offset:30720
v_mfma_f32_16x16x32_bf16 v[52:55], a[8:11], a[144:147], v[52:55]
ds_read_b128 a[52:55], v200 offset:31744
buffer_load_dwordx4 a[240:243], v1, s[4:7], s52 offen offset:2048 sc1
v_mfma_f32_16x16x32_bf16 v[56:59], a[8:11], a[148:151], v[56:59]
ds_read_b128 a[56:59], v200 offset:32768
v_mfma_f32_16x16x32_bf16 v[60:63], a[12:15], a[144:147], v[60:63]
ds_read_b128 a[60:63], v200 offset:33792
v_mfma_f32_16x16x32_bf16 v[64:67], a[12:15], a[148:151], v[64:67]
ds_read_b128 a[64:67], v200 offset:34816
v_mfma_f32_16x16x32_bf16 v[68:71], a[16:19], a[144:147], v[68:71]
ds_read_b128 a[68:71], v200 offset:35840
buffer_load_dwordx4 a[244:247], v9, s[4:7], s52 offen offset:2048 sc1
v_mfma_f32_16x16x32_bf16 v[72:75], a[16:19], a[148:151], v[72:75]
v_rcp_f32 v199, v199
v_mfma_f32_16x16x32_bf16 v[76:79], a[20:23], a[144:147], v[76:79]
v_mul_f32 v144, v144, v196
v_mul_f32 v145, v145, v197
v_mfma_f32_16x16x32_bf16 v[80:83], a[20:23], a[148:151], v[80:83]
v_mul_f32 v146, v146, v198
v_mfma_f32_16x16x32_bf16 v[84:87], a[24:27], a[144:147], v[84:87]
buffer_load_dwordx4 a[248:251], v1, s[4:7], s52 offen offset:3072 sc1
v_mfma_f32_16x16x32_bf16 v[88:91], a[24:27], a[148:151], v[88:91]
v_mul_f32 v147, v147, v199
v_mfma_f32_16x16x32_bf16 v[92:95], a[28:31], a[144:147], v[92:95]
v_mfma_f32_16x16x32_bf16 v[96:99], a[28:31], a[148:151], v[96:99]
v_mul_f32 v192, v148, v148
v_mfma_f32_16x16x32_bf16 v[100:103], a[32:35], a[144:147], v[100:103]
v_mfma_f32_16x16x32_bf16 v[104:107], a[32:35], a[148:151], v[104:107]
s_waitcnt vmcnt(21) lgkmcnt(0)
s_barrier
v_mfma_f32_16x16x32_bf16 v[36:39], a[36:39], a[152:155], v[36:39]
ds_read_b128 a[0:3], v201 offset:0
buffer_load_dwordx4 a[252:255], v9, s[4:7], s52 offen offset:3072 sc1
v_mfma_f32_16x16x32_bf16 v[40:43], a[36:39], a[156:159], v[40:43]
ds_read_b128 a[4:7], v201 offset:1024
v_mul_f32 v193, v149, v149
v_mfma_f32_16x16x32_bf16 v[44:47], a[40:43], a[152:155], v[44:47]
ds_read_b128 a[8:11], v201 offset:2048
v_mul_f32 v194, v150, v150
v_mfma_f32_16x16x32_bf16 v[48:51], a[40:43], a[156:159], v[48:51]
ds_read_b128 a[12:15], v201 offset:3072
v_mfma_f32_16x16x32_bf16 v[52:55], a[44:47], a[152:155], v[52:55]
ds_read_b128 a[16:19], v201 offset:4096
v_mul_f32 v195, v151, v151
v_mfma_f32_16x16x32_bf16 v[56:59], a[44:47], a[156:159], v[56:59]
ds_read_b128 a[20:23], v201 offset:5120
v_mfma_f32_16x16x32_bf16 v[60:63], a[48:51], a[152:155], v[60:63]
ds_read_b128 a[24:27], v201 offset:6144
v_fma_f32 v192, v192, v252, v250
v_mfma_f32_16x16x32_bf16 v[64:67], a[48:51], a[156:159], v[64:67]
ds_read_b128 a[28:31], v201 offset:7168
v_mfma_f32_16x16x32_bf16 v[68:71], a[52:55], a[152:155], v[68:71]
ds_read_b128 a[32:35], v201 offset:8192
v_mfma_f32_16x16x32_bf16 v[72:75], a[52:55], a[156:159], v[72:75]
s_cmp_eq_u32 s25, 6
s_cselect_b32 s99, 36864, 0
s_add_u32 s60, s60, s99
v_mfma_f32_16x16x32_bf16 v[76:79], a[56:59], a[152:155], v[76:79]
s_add_u32 s61, s61, s99
s_add_u32 m0, s62, 53248
s_add_u32 s60, s60, 16384
v_mfma_f32_16x16x32_bf16 v[80:83], a[56:59], a[156:159], v[80:83]
buffer_load_dwordx4 v1, s[8:11], s60 offen offset:0 sc1 lds
v_fma_f32 v193, v193, v252, v250
v_mfma_f32_16x16x32_bf16 v[84:87], a[60:63], a[152:155], v[84:87]
v_fma_f32 v194, v194, v252, v250
v_mfma_f32_16x16x32_bf16 v[88:91], a[60:63], a[156:159], v[88:91]
buffer_load_dwordx4 v1, s[8:11], s60 offen offset:1024 sc1 lds
v_fma_f32 v195, v195, v252, v250
v_mfma_f32_16x16x32_bf16 v[92:95], a[64:67], a[152:155], v[92:95]
v_mfma_f32_16x16x32_bf16 v[96:99], a[64:67], a[156:159], v[96:99]
buffer_load_dwordx4 v1, s[8:11], s60 offen offset:2048 sc1 lds
v_mfma_f32_16x16x32_bf16 v[100:103], a[68:71], a[152:155], v[100:103]
v_mul_f32 v192, v192, v148
v_mfma_f32_16x16x32_bf16 v[104:107], a[68:71], a[156:159], v[104:107]
s_waitcnt lgkmcnt(0)
v_mfma_f32_16x16x32_bf16 v[36:39], a[0:3], a[160:163], v[36:39]
ds_read_b128 a[36:39], v201 offset:9216
buffer_load_dwordx4 v1, s[8:11], s60 offen offset:3072 sc1 lds
v_mfma_f32_16x16x32_bf16 v[40:43], a[0:3], a[164:167], v[40:43]
ds_read_b128 a[40:43], v201 offset:10240
v_mul_f32 v193, v193, v149
v_mfma_f32_16x16x32_bf16 v[44:47], a[4:7], a[160:163], v[44:47]
ds_read_b128 a[44:47], v201 offset:11264
s_add_u32 m0, s63, 69632
v_mfma_f32_16x16x32_bf16 v[48:51], a[4:7], a[164:167], v[48:51]
ds_read_b128 a[48:51], v201 offset:12288
v_mul_f32 v194, v194, v150
v_mfma_f32_16x16x32_bf16 v[52:55], a[8:11], a[160:163], v[52:55]
ds_read_b128 a[52:55], v201 offset:13312
s_add_u32 s61, s61, 36864
v_mfma_f32_16x16x32_bf16 v[56:59], a[8:11], a[164:167], v[56:59]
ds_read_b128 a[56:59], v201 offset:14336
v_mul_f32 v195, v195, v151
v_mfma_f32_16x16x32_bf16 v[60:63], a[12:15], a[160:163], v[60:63]
ds_read_b128 a[60:63], v201 offset:15360
buffer_load_dwordx4 v1, s[8:11], s61 offen offset:0 sc1 lds
v_mfma_f32_16x16x32_bf16 v[64:67], a[12:15], a[164:167], v[64:67]
ds_read_b128 a[64:67], v201 offset:16384
v_mfma_f32_16x16x32_bf16 v[68:71], a[16:19], a[160:163], v[68:71]
ds_read_b128 a[68:71], v201 offset:17408
s_add_u32 m0, s62, 73728
v_mfma_f32_16x16x32_bf16 v[72:75], a[16:19], a[164:167], v[72:75]
s_add_u32 s60, s60, 20480
v_exp_f32 v192, v192
v_mfma_f32_16x16x32_bf16 v[76:79], a[20:23], a[160:163], v[76:79]
v_mfma_f32_16x16x32_bf16 v[80:83], a[20:23], a[164:167], v[80:83]
v_mfma_f32_16x16x32_bf16 v[84:87], a[24:27], a[160:163], v[84:87]
buffer_load_dwordx4 v1, s[8:11], s60 offen offset:0 sc1 lds
v_mfma_f32_16x16x32_bf16 v[88:91], a[24:27], a[164:167], v[88:91]
v_exp_f32 v193, v193
v_mfma_f32_16x16x32_bf16 v[92:95], a[28:31], a[160:163], v[92:95]
buffer_load_dwordx4 v1, s[8:11], s60 offen offset:1024 sc1 lds
v_mfma_f32_16x16x32_bf16 v[96:99], a[28:31], a[164:167], v[96:99]
v_mfma_f32_16x16x32_bf16 v[100:103], a[32:35], a[160:163], v[100:103]
v_mfma_f32_16x16x32_bf16 v[104:107], a[32:35], a[164:167], v[104:107]
s_waitcnt lgkmcnt(0)
v_mfma_f32_16x16x32_bf16 v[36:39], a[36:39], a[168:171], v[36:39]
ds_read_b128 a[0:3], v201 offset:18432
buffer_load_dwordx4 v1, s[8:11], s60 offen offset:2048 sc1 lds
v_mfma_f32_16x16x32_bf16 v[40:43], a[36:39], a[172:175], v[40:43]
ds_read_b128 a[4:7], v201 offset:19456
v_mfma_f32_16x16x32_bf16 v[44:47], a[40:43], a[168:171], v[44:47]
ds_read_b128 a[8:11], v201 offset:20480
buffer_load_dwordx4 v1, s[8:11], s60 offen offset:3072 sc1 lds
v_mfma_f32_16x16x32_bf16 v[48:51], a[40:43], a[172:175], v[48:51]
ds_read_b128 a[12:15], v201 offset:21504
v_mfma_f32_16x16x32_bf16 v[52:55], a[44:47], a[168:171], v[52:55]
ds_read_b128 a[16:19], v201 offset:22528
v_mfma_f32_16x16x32_bf16 v[56:59], a[44:47], a[172:175], v[56:59]
ds_read_b128 a[20:23], v201 offset:23552
v_mfma_f32_16x16x32_bf16 v[60:63], a[48:51], a[168:171], v[60:63]
ds_read_b128 a[24:27], v201 offset:24576
v_mfma_f32_16x16x32_bf16 v[64:67], a[48:51], a[172:175], v[64:67]
ds_read_b128 a[28:31], v201 offset:25600
v_mfma_f32_16x16x32_bf16 v[68:71], a[52:55], a[168:171], v[68:71]
ds_read_b128 a[32:35], v201 offset:26624
v_mfma_f32_16x16x32_bf16 v[72:75], a[52:55], a[172:175], v[72:75]
s_cmp_eq_u32 s25, 7
s_cselect_b32 s98, 4096, 0
s_add_u32 s52, s52, s98
v_mfma_f32_16x16x32_bf16 v[76:79], a[56:59], a[168:171], v[76:79]
s_add_u32 s52, s52, 4096
v_exp_f32 v194, v194
v_mfma_f32_16x16x32_bf16 v[80:83], a[56:59], a[172:175], v[80:83]
v_exp_f32 v195, v195
v_mfma_f32_16x16x32_bf16 v[84:87], a[60:63], a[168:171], v[84:87]
buffer_load_dwordx4 a[80:83], v1, s[4:7], s52 offen offset:0 sc1
v_fma_f32 v192, v192, v254, v254
v_mfma_f32_16x16x32_bf16 v[88:91], a[60:63], a[172:175], v[88:91]
v_fma_f32 v193, v193, v254, v254
v_fma_f32 v194, v194, v254, v254
v_mfma_f32_16x16x32_bf16 v[92:95], a[64:67], a[168:171], v[92:95]
buffer_load_dwordx4 a[84:87], v9, s[4:7], s52 offen offset:0 sc1
v_mfma_f32_16x16x32_bf16 v[96:99], a[64:67], a[172:175], v[96:99]
v_fma_f32 v195, v195, v254, v254
v_mfma_f32_16x16x32_bf16 v[100:103], a[68:71], a[168:171], v[100:103]
v_mfma_f32_16x16x32_bf16 v[104:107], a[68:71], a[172:175], v[104:107]
s_waitcnt lgkmcnt(0)
v_mfma_f32_16x16x32_bf16 v[36:39], a[0:3], a[176:179], v[36:39]
ds_read_b128 a[36:39], v201 offset:27648
buffer_load_dwordx4 a[88:91], v1, s[4:7], s52 offen offset:1024 sc1
v_mfma_f32_16x16x32_bf16 v[40:43], a[0:3], a[180:183], v[40:43]
ds_read_b128 a[40:43], v201 offset:28672
v_mfma_f32_16x16x32_bf16 v[44:47], a[4:7], a[176:179], v[44:47]
ds_read_b128 a[44:47], v201 offset:29696
v_mfma_f32_16x16x32_bf16 v[48:51], a[4:7], a[180:183], v[48:51]
ds_read_b128 a[48:51], v201 offset:30720
v_mfma_f32_16x16x32_bf16 v[52:55], a[8:11], a[176:179], v[52:55]
ds_read_b128 a[52:55], v201 offset:31744
buffer_load_dwordx4 a[92:95], v9, s[4:7], s52 offen offset:1024 sc1
v_mfma_f32_16x16x32_bf16 v[56:59], a[8:11], a[180:183], v[56:59]
ds_read_b128 a[56:59], v201 offset:32768
v_mfma_f32_16x16x32_bf16 v[60:63], a[12:15], a[176:179], v[60:63]
ds_read_b128 a[60:63], v201 offset:33792
v_mfma_f32_16x16x32_bf16 v[64:67], a[12:15], a[180:183], v[64:67]
ds_read_b128 a[64:67], v201 offset:34816
v_mfma_f32_16x16x32_bf16 v[68:71], a[16:19], a[176:179], v[68:71]
ds_read_b128 a[68:71], v201 offset:35840
buffer_load_dwordx4 a[96:99], v1, s[4:7], s52 offen offset:2048 sc1
v_mfma_f32_16x16x32_bf16 v[72:75], a[16:19], a[180:183], v[72:75]
v_rcp_f32 v192, v192
v_mfma_f32_16x16x32_bf16 v[76:79], a[20:23], a[176:179], v[76:79]
v_rcp_f32 v193, v193
v_mfma_f32_16x16x32_bf16 v[80:83], a[20:23], a[180:183], v[80:83]
v_rcp_f32 v194, v194
v_mfma_f32_16x16x32_bf16 v[84:87], a[24:27], a[176:179], v[84:87]
buffer_load_dwordx4 a[100:103], v9, s[4:7], s52 offen offset:2048 sc1
v_mfma_f32_16x16x32_bf16 v[88:91], a[24:27], a[180:183], v[88:91]
v_mfma_f32_16x16x32_bf16 v[92:95], a[28:31], a[176:179], v[92:95]
v_rcp_f32 v195, v195
v_mfma_f32_16x16x32_bf16 v[96:99], a[28:31], a[180:183], v[96:99]
v_mfma_f32_16x16x32_bf16 v[100:103], a[32:35], a[176:179], v[100:103]
v_mfma_f32_16x16x32_bf16 v[104:107], a[32:35], a[180:183], v[104:107]
s_waitcnt vmcnt(23) lgkmcnt(0)
s_barrier
v_mfma_f32_16x16x32_bf16 v[36:39], a[36:39], a[184:187], v[36:39]
ds_read_b128 a[0:3], v202 offset:0
buffer_load_dwordx4 a[104:107], v1, s[4:7], s52 offen offset:3072 sc1
v_mfma_f32_16x16x32_bf16 v[40:43], a[36:39], a[188:191], v[40:43]
ds_read_b128 a[4:7], v202 offset:1024
buffer_load_dwordx4 a[108:111], v9, s[4:7], s52 offen offset:3072 sc1
v_mfma_f32_16x16x32_bf16 v[44:47], a[40:43], a[184:187], v[44:47]
ds_read_b128 a[8:11], v202 offset:2048
v_mul_f32 v148, v148, v192
v_mfma_f32_16x16x32_bf16 v[48:51], a[40:43], a[188:191], v[48:51]
ds_read_b128 a[12:15], v202 offset:3072
v_mul_f32 v149, v149, v193
v_mfma_f32_16x16x32_bf16 v[52:55], a[44:47], a[184:187], v[52:55]
ds_read_b128 a[16:19], v202 offset:4096
v_mfma_f32_16x16x32_bf16 v[56:59], a[44:47], a[188:191], v[56:59]
ds_read_b128 a[20:23], v202 offset:5120
v_mul_f32 v150, v150, v194
v_mfma_f32_16x16x32_bf16 v[60:63], a[48:51], a[184:187], v[60:63]
ds_read_b128 a[24:27], v202 offset:6144
v_mfma_f32_16x16x32_bf16 v[64:67], a[48:51], a[188:191], v[64:67]
ds_read_b128 a[28:31], v202 offset:7168
v_mul_f32 v151, v151, v195
v_mfma_f32_16x16x32_bf16 v[68:71], a[52:55], a[184:187], v[68:71]
ds_read_b128 a[32:35], v202 offset:8192
v_mfma_f32_16x16x32_bf16 v[72:75], a[52:55], a[188:191], v[72:75]
s_cmp_eq_u32 s25, 7
s_cselect_b32 s99, 36864, 0
s_add_u32 s60, s60, s99
v_mfma_f32_16x16x32_bf16 v[76:79], a[56:59], a[184:187], v[76:79]
s_add_u32 s61, s61, s99
s_add_u32 m0, s62, 90112
v_mul_f32 v196, v152, v152
v_mfma_f32_16x16x32_bf16 v[80:83], a[56:59], a[188:191], v[80:83]
s_add_u32 s60, s60, 16384
v_mfma_f32_16x16x32_bf16 v[84:87], a[60:63], a[184:187], v[84:87]
v_mul_f32 v197, v153, v153
v_mfma_f32_16x16x32_bf16 v[88:91], a[60:63], a[188:191], v[88:91]
buffer_load_dwordx4 v1, s[8:11], s60 offen offset:0 sc1 lds
v_mfma_f32_16x16x32_bf16 v[92:95], a[64:67], a[184:187], v[92:95]
v_mul_f32 v198, v154, v154
v_mfma_f32_16x16x32_bf16 v[96:99], a[64:67], a[188:191], v[96:99]
buffer_load_dwordx4 v1, s[8:11], s60 offen offset:1024 sc1 lds
v_mfma_f32_16x16x32_bf16 v[100:103], a[68:71], a[184:187], v[100:103]
v_mfma_f32_16x16x32_bf16 v[104:107], a[68:71], a[188:191], v[104:107]
v_mul_f32 v199, v155, v155
s_waitcnt lgkmcnt(0)
v_mfma_f32_16x16x32_bf16 v[36:39], a[0:3], a[192:195], v[36:39]
ds_read_b128 a[36:39], v202 offset:9216
buffer_load_dwordx4 v1, s[8:11], s60 offen offset:2048 sc1 lds
v_mfma_f32_16x16x32_bf16 v[40:43], a[0:3], a[196:199], v[40:43]
ds_read_b128 a[40:43], v202 offset:10240
v_fma_f32 v196, v196, v253, v251
v_mfma_f32_16x16x32_bf16 v[44:47], a[4:7], a[192:195], v[44:47]
ds_read_b128 a[44:47], v202 offset:11264
buffer_load_dwordx4 v1, s[8:11], s60 offen offset:3072 sc1 lds
v_mfma_f32_16x16x32_bf16 v[48:51], a[4:7], a[196:199], v[48:51]
ds_read_b128 a[48:51], v202 offset:12288
v_mfma_f32_16x16x32_bf16 v[52:55], a[8:11], a[192:195], v[52:55]
ds_read_b128 a[52:55], v202 offset:13312
s_add_u32 m0, s63, 106496
v_mfma_f32_16x16x32_bf16 v[56:59], a[8:11], a[196:199], v[56:59]
ds_read_b128 a[56:59], v202 offset:14336
v_fma_f32 v197, v197, v253, v251
v_mfma_f32_16x16x32_bf16 v[60:63], a[12:15], a[192:195], v[60:63]
ds_read_b128 a[60:63], v202 offset:15360
s_add_u32 s61, s61, 36864
v_mfma_f32_16x16x32_bf16 v[64:67], a[12:15], a[196:199], v[64:67]
ds_read_b128 a[64:67], v202 offset:16384
v_fma_f32 v198, v198, v253, v251
v_mfma_f32_16x16x32_bf16 v[68:71], a[16:19], a[192:195], v[68:71]
ds_read_b128 a[68:71], v202 offset:17408
buffer_load_dwordx4 v1, s[8:11], s61 offen offset:0 sc1 lds
v_mfma_f32_16x16x32_bf16 v[72:75], a[16:19], a[196:199], v[72:75]
s_add_u32 m0, s62, 110592
v_fma_f32 v199, v199, v253, v251
v_mfma_f32_16x16x32_bf16 v[76:79], a[20:23], a[192:195], v[76:79]
s_add_u32 s60, s60, 20480
v_mfma_f32_16x16x32_bf16 v[80:83], a[20:23], a[196:199], v[80:83]
v_mul_f32 v196, v196, v152
v_mfma_f32_16x16x32_bf16 v[84:87], a[24:27], a[192:195], v[84:87]
v_mfma_f32_16x16x32_bf16 v[88:91], a[24:27], a[196:199], v[88:91]
v_mul_f32 v197, v197, v153
v_mfma_f32_16x16x32_bf16 v[92:95], a[28:31], a[192:195], v[92:95]
buffer_load_dwordx4 v1, s[8:11], s60 offen offset:0 sc1 lds
v_mfma_f32_16x16x32_bf16 v[96:99], a[28:31], a[196:199], v[96:99]
v_mul_f32 v198, v198, v154
v_mfma_f32_16x16x32_bf16 v[100:103], a[32:35], a[192:195], v[100:103]
v_mfma_f32_16x16x32_bf16 v[104:107], a[32:35], a[196:199], v[104:107]
s_waitcnt lgkmcnt(0)
v_mfma_f32_16x16x32_bf16 v[36:39], a[36:39], a[200:203], v[36:39]
ds_read_b128 a[0:3], v202 offset:18432
buffer_load_dwordx4 v1, s[8:11], s60 offen offset:1024 sc1 lds
v_mfma_f32_16x16x32_bf16 v[40:43], a[36:39], a[204:207], v[40:43]
ds_read_b128 a[4:7], v202 offset:19456
v_mul_f32 v199, v199, v155
v_mfma_f32_16x16x32_bf16 v[44:47], a[40:43], a[200:203], v[44:47]
ds_read_b128 a[8:11], v202 offset:20480
buffer_load_dwordx4 v1, s[8:11], s60 offen offset:2048 sc1 lds
v_mfma_f32_16x16x32_bf16 v[48:51], a[40:43], a[204:207], v[48:51]
ds_read_b128 a[12:15], v202 offset:21504
v_mfma_f32_16x16x32_bf16 v[52:55], a[44:47], a[200:203], v[52:55]
ds_read_b128 a[16:19], v202 offset:22528
buffer_load_dwordx4 v1, s[8:11], s60 offen offset:3072 sc1 lds
v_mfma_f32_16x16x32_bf16 v[56:59], a[44:47], a[204:207], v[56:59]
ds_read_b128 a[20:23], v202 offset:23552
v_mfma_f32_16x16x32_bf16 v[60:63], a[48:51], a[200:203], v[60:63]
ds_read_b128 a[24:27], v202 offset:24576
v_mfma_f32_16x16x32_bf16 v[64:67], a[48:51], a[204:207], v[64:67]
ds_read_b128 a[28:31], v202 offset:25600
v_mfma_f32_16x16x32_bf16 v[68:71], a[52:55], a[200:203], v[68:71]
ds_read_b128 a[32:35], v202 offset:26624
v_mfma_f32_16x16x32_bf16 v[72:75], a[52:55], a[204:207], v[72:75]
s_cmp_eq_u32 s25, 8
s_cselect_b32 s98, 4096, 0
v_mfma_f32_16x16x32_bf16 v[76:79], a[56:59], a[200:203], v[76:79]
s_add_u32 s52, s52, s98
v_exp_f32 v196, v196
v_mfma_f32_16x16x32_bf16 v[80:83], a[56:59], a[204:207], v[80:83]
s_add_u32 s52, s52, 4096
v_exp_f32 v197, v197
v_mfma_f32_16x16x32_bf16 v[84:87], a[60:63], a[200:203], v[84:87]
v_exp_f32 v198, v198
v_mfma_f32_16x16x32_bf16 v[88:91], a[60:63], a[204:207], v[88:91]
v_mfma_f32_16x16x32_bf16 v[92:95], a[64:67], a[200:203], v[92:95]
buffer_load_dwordx4 a[112:115], v1, s[4:7], s52 offen offset:0 sc1
v_mfma_f32_16x16x32_bf16 v[96:99], a[64:67], a[204:207], v[96:99]
v_mfma_f32_16x16x32_bf16 v[100:103], a[68:71], a[200:203], v[100:103]
v_exp_f32 v199, v199
v_mfma_f32_16x16x32_bf16 v[104:107], a[68:71], a[204:207], v[104:107]
s_waitcnt lgkmcnt(0)
v_mfma_f32_16x16x32_bf16 v[36:39], a[0:3], a[208:211], v[36:39]
ds_read_b128 a[36:39], v202 offset:27648
buffer_load_dwordx4 a[116:119], v9, s[4:7], s52 offen offset:0 sc1
v_mfma_f32_16x16x32_bf16 v[40:43], a[0:3], a[212:215], v[40:43]
ds_read_b128 a[40:43], v202 offset:28672
v_mfma_f32_16x16x32_bf16 v[44:47], a[4:7], a[208:211], v[44:47]
ds_read_b128 a[44:47], v202 offset:29696
v_mfma_f32_16x16x32_bf16 v[48:51], a[4:7], a[212:215], v[48:51]
ds_read_b128 a[48:51], v202 offset:30720
v_fma_f32 v196, v196, v255, v255
v_mfma_f32_16x16x32_bf16 v[52:55], a[8:11], a[208:211], v[52:55]
ds_read_b128 a[52:55], v202 offset:31744
buffer_load_dwordx4 a[120:123], v1, s[4:7], s52 offen offset:1024 sc1
v_mfma_f32_16x16x32_bf16 v[56:59], a[8:11], a[212:215], v[56:59]
ds_read_b128 a[56:59], v202 offset:32768
v_fma_f32 v197, v197, v255, v255
v_mfma_f32_16x16x32_bf16 v[60:63], a[12:15], a[208:211], v[60:63]
ds_read_b128 a[60:63], v202 offset:33792
v_mfma_f32_16x16x32_bf16 v[64:67], a[12:15], a[212:215], v[64:67]
ds_read_b128 a[64:67], v202 offset:34816
v_mfma_f32_16x16x32_bf16 v[68:71], a[16:19], a[208:211], v[68:71]
ds_read_b128 a[68:71], v202 offset:35840
buffer_load_dwordx4 a[124:127], v9, s[4:7], s52 offen offset:1024 sc1
v_mfma_f32_16x16x32_bf16 v[72:75], a[16:19], a[212:215], v[72:75]
v_fma_f32 v198, v198, v255, v255
v_mfma_f32_16x16x32_bf16 v[76:79], a[20:23], a[208:211], v[76:79]
v_fma_f32 v199, v199, v255, v255
v_mfma_f32_16x16x32_bf16 v[80:83], a[20:23], a[212:215], v[80:83]
v_mfma_f32_16x16x32_bf16 v[84:87], a[24:27], a[208:211], v[84:87]
buffer_load_dwordx4 a[128:131], v1, s[4:7], s52 offen offset:2048 sc1
v_mfma_f32_16x16x32_bf16 v[88:91], a[24:27], a[212:215], v[88:91]
v_rcp_f32 v196, v196
v_mfma_f32_16x16x32_bf16 v[92:95], a[28:31], a[208:211], v[92:95]
v_mfma_f32_16x16x32_bf16 v[96:99], a[28:31], a[212:215], v[96:99]
v_mfma_f32_16x16x32_bf16 v[100:103], a[32:35], a[208:211], v[100:103]
v_mfma_f32_16x16x32_bf16 v[104:107], a[32:35], a[212:215], v[104:107]
s_waitcnt vmcnt(22) lgkmcnt(0)
s_barrier
v_mfma_f32_16x16x32_bf16 v[36:39], a[36:39], a[216:219], v[36:39]
ds_read_b128 a[0:3], v200 offset:0
buffer_load_dwordx4 a[132:135], v9, s[4:7], s52 offen offset:2048 sc1
v_mfma_f32_16x16x32_bf16 v[40:43], a[36:39], a[220:223], v[40:43]
ds_read_b128 a[4:7], v200 offset:1024
buffer_load_dwordx4 a[136:139], v1, s[4:7], s52 offen offset:3072 sc1
v_mfma_f32_16x16x32_bf16 v[44:47], a[40:43], a[216:219], v[44:47]
ds_read_b128 a[8:11], v200 offset:2048
v_mfma_f32_16x16x32_bf16 v[48:51], a[40:43], a[220:223], v[48:51]
ds_read_b128 a[12:15], v200 offset:3072
buffer_load_dwordx4 a[140:143], v9, s[4:7], s52 offen offset:3072 sc1
v_mfma_f32_16x16x32_bf16 v[52:55], a[44:47], a[216:219], v[52:55]
ds_read_b128 a[16:19], v200 offset:4096
v_mfma_f32_16x16x32_bf16 v[56:59], a[44:47], a[220:223], v[56:59]
ds_read_b128 a[20:23], v200 offset:5120
v_mfma_f32_16x16x32_bf16 v[60:63], a[48:51], a[216:219], v[60:63]
ds_read_b128 a[24:27], v200 offset:6144
v_mfma_f32_16x16x32_bf16 v[64:67], a[48:51], a[220:223], v[64:67]
ds_read_b128 a[28:31], v200 offset:7168
v_mfma_f32_16x16x32_bf16 v[68:71], a[52:55], a[216:219], v[68:71]
ds_read_b128 a[32:35], v200 offset:8192
v_mfma_f32_16x16x32_bf16 v[72:75], a[52:55], a[220:223], v[72:75]
s_cmp_eq_u32 s25, 8
s_cselect_b32 s99, 36864, 0
s_add_u32 s60, s60, s99
v_mfma_f32_16x16x32_bf16 v[76:79], a[56:59], a[216:219], v[76:79]
s_add_u32 s61, s61, s99
v_rcp_f32 v197, v197
v_mfma_f32_16x16x32_bf16 v[80:83], a[56:59], a[220:223], v[80:83]
s_add_u32 m0, s62, 126976
v_rcp_f32 v198, v198
v_mfma_f32_16x16x32_bf16 v[84:87], a[60:63], a[216:219], v[84:87]
s_add_u32 s60, s60, 16384
v_rcp_f32 v199, v199
v_mfma_f32_16x16x32_bf16 v[88:91], a[60:63], a[220:223], v[88:91]
v_mul_f32 v152, v152, v196
v_mfma_f32_16x16x32_bf16 v[92:95], a[64:67], a[216:219], v[92:95]
v_mfma_f32_16x16x32_bf16 v[96:99], a[64:67], a[220:223], v[96:99]
buffer_load_dwordx4 v1, s[8:11], s60 offen offset:0 sc1 lds
v_mfma_f32_16x16x32_bf16 v[100:103], a[68:71], a[216:219], v[100:103]
v_mul_f32 v153, v153, v197
v_mfma_f32_16x16x32_bf16 v[104:107], a[68:71], a[220:223], v[104:107]
s_waitcnt lgkmcnt(0)
v_mfma_f32_16x16x32_bf16 v[36:39], a[0:3], a[224:227], v[36:39]
ds_read_b128 a[36:39], v200 offset:9216
buffer_load_dwordx4 v1, s[8:11], s60 offen offset:1024 sc1 lds
v_mfma_f32_16x16x32_bf16 v[40:43], a[0:3], a[228:231], v[40:43]
ds_read_b128 a[40:43], v200 offset:10240
v_mul_f32 v154, v154, v198
v_mfma_f32_16x16x32_bf16 v[44:47], a[4:7], a[224:227], v[44:47]
ds_read_b128 a[44:47], v200 offset:11264
buffer_load_dwordx4 v1, s[8:11], s60 offen offset:2048 sc1 lds
v_mfma_f32_16x16x32_bf16 v[48:51], a[4:7], a[228:231], v[48:51]
ds_read_b128 a[48:51], v200 offset:12288
v_mul_f32 v155, v155, v199
v_mfma_f32_16x16x32_bf16 v[52:55], a[8:11], a[224:227], v[52:55]
ds_read_b128 a[52:55], v200 offset:13312
v_mfma_f32_16x16x32_bf16 v[56:59], a[8:11], a[228:231], v[56:59]
ds_read_b128 a[56:59], v200 offset:14336
buffer_load_dwordx4 v1, s[8:11], s60 offen offset:3072 sc1 lds
v_mfma_f32_16x16x32_bf16 v[60:63], a[12:15], a[224:227], v[60:63]
ds_read_b128 a[60:63], v200 offset:15360
v_mul_f32 v192, v156, v156
v_mfma_f32_16x16x32_bf16 v[64:67], a[12:15], a[228:231], v[64:67]
ds_read_b128 a[64:67], v200 offset:16384
v_mul_f32 v193, v157, v157
v_mfma_f32_16x16x32_bf16 v[68:71], a[16:19], a[224:227], v[68:71]
ds_read_b128 a[68:71], v200 offset:17408
s_add_u32 m0, s63, 143360
v_mfma_f32_16x16x32_bf16 v[72:75], a[16:19], a[228:231], v[72:75]
s_add_u32 s61, s61, 36864
v_mul_f32 v194, v158, v158
v_mfma_f32_16x16x32_bf16 v[76:79], a[20:23], a[224:227], v[76:79]
v_mfma_f32_16x16x32_bf16 v[80:83], a[20:23], a[228:231], v[80:83]
v_mfma_f32_16x16x32_bf16 v[84:87], a[24:27], a[224:227], v[84:87]
v_mul_f32 v195, v159, v159
v_mfma_f32_16x16x32_bf16 v[88:91], a[24:27], a[228:231], v[88:91]
v_mfma_f32_16x16x32_bf16 v[92:95], a[28:31], a[224:227], v[92:95]
buffer_load_dwordx4 v1, s[8:11], s61 offen offset:0 sc1 lds
v_fma_f32 v192, v192, v252, v250
v_mfma_f32_16x16x32_bf16 v[96:99], a[28:31], a[228:231], v[96:99]
v_mfma_f32_16x16x32_bf16 v[100:103], a[32:35], a[224:227], v[100:103]
v_fma_f32 v193, v193, v252, v250
v_mfma_f32_16x16x32_bf16 v[104:107], a[32:35], a[228:231], v[104:107]
s_waitcnt lgkmcnt(0)
v_mfma_f32_16x16x32_bf16 v[36:39], a[36:39], a[232:235], v[36:39]
ds_read_b128 a[0:3], v200 offset:18432
s_add_u32 m0, s62, 147456
v_mfma_f32_16x16x32_bf16 v[40:43], a[36:39], a[236:239], v[40:43]
ds_read_b128 a[4:7], v200 offset:19456
v_fma_f32 v194, v194, v252, v250
v_mfma_f32_16x16x32_bf16 v[44:47], a[40:43], a[232:235], v[44:47]
ds_read_b128 a[8:11], v200 offset:20480
s_add_u32 s60, s60, 20480
v_mfma_f32_16x16x32_bf16 v[48:51], a[40:43], a[236:239], v[48:51]
ds_read_b128 a[12:15], v200 offset:21504
v_fma_f32 v195, v195, v252, v250
v_mfma_f32_16x16x32_bf16 v[52:55], a[44:47], a[232:235], v[52:55]
ds_read_b128 a[16:19], v200 offset:22528
v_mfma_f32_16x16x32_bf16 v[56:59], a[44:47], a[236:239], v[56:59]
ds_read_b128 a[20:23], v200 offset:23552
buffer_load_dwordx4 v1, s[8:11], s60 offen offset:0 sc1 lds
v_mfma_f32_16x16x32_bf16 v[60:63], a[48:51], a[232:235], v[60:63]
ds_read_b128 a[24:27], v200 offset:24576
v_mul_f32 v192, v192, v156
v_mfma_f32_16x16x32_bf16 v[64:67], a[48:51], a[236:239], v[64:67]
ds_read_b128 a[28:31], v200 offset:25600
v_mfma_f32_16x16x32_bf16 v[68:71], a[52:55], a[232:235], v[68:71]
ds_read_b128 a[32:35], v200 offset:26624
buffer_load_dwordx4 v1, s[8:11], s60 offen offset:1024 sc1 lds
v_mfma_f32_16x16x32_bf16 v[72:75], a[52:55], a[236:239], v[72:75]
v_mul_f32 v193, v193, v157
v_mfma_f32_16x16x32_bf16 v[76:79], a[56:59], a[232:235], v[76:79]
v_mul_f32 v194, v194, v158
v_mfma_f32_16x16x32_bf16 v[80:83], a[56:59], a[236:239], v[80:83]
buffer_load_dwordx4 v1, s[8:11], s60 offen offset:2048 sc1 lds
v_mfma_f32_16x16x32_bf16 v[84:87], a[60:63], a[232:235], v[84:87]
v_mfma_f32_16x16x32_bf16 v[88:91], a[60:63], a[236:239], v[88:91]
v_mul_f32 v195, v195, v159
v_mfma_f32_16x16x32_bf16 v[92:95], a[64:67], a[232:235], v[92:95]
buffer_load_dwordx4 v1, s[8:11], s60 offen offset:3072 sc1 lds
v_mfma_f32_16x16x32_bf16 v[96:99], a[64:67], a[236:239], v[96:99]
v_exp_f32 v192, v192
v_mfma_f32_16x16x32_bf16 v[100:103], a[68:71], a[232:235], v[100:103]
v_mfma_f32_16x16x32_bf16 v[104:107], a[68:71], a[236:239], v[104:107]
s_waitcnt lgkmcnt(0)
v_mfma_f32_16x16x32_bf16 v[36:39], a[0:3], a[240:243], v[36:39]
ds_read_b128 a[36:39], v200 offset:27648
v_mfma_f32_16x16x32_bf16 v[40:43], a[0:3], a[244:247], v[40:43]
ds_read_b128 a[40:43], v200 offset:28672
v_mfma_f32_16x16x32_bf16 v[44:47], a[4:7], a[240:243], v[44:47]
ds_read_b128 a[44:47], v200 offset:29696
v_mfma_f32_16x16x32_bf16 v[48:51], a[4:7], a[244:247], v[48:51]
ds_read_b128 a[48:51], v200 offset:30720
v_mfma_f32_16x16x32_bf16 v[52:55], a[8:11], a[240:243], v[52:55]
ds_read_b128 a[52:55], v200 offset:31744
v_mfma_f32_16x16x32_bf16 v[56:59], a[8:11], a[244:247], v[56:59]
ds_read_b128 a[56:59], v200 offset:32768
v_mfma_f32_16x16x32_bf16 v[60:63], a[12:15], a[240:243], v[60:63]
ds_read_b128 a[60:63], v200 offset:33792
v_mfma_f32_16x16x32_bf16 v[64:67], a[12:15], a[244:247], v[64:67]
ds_read_b128 a[64:67], v200 offset:34816
v_mfma_f32_16x16x32_bf16 v[68:71], a[16:19], a[240:243], v[68:71]
ds_read_b128 a[68:71], v200 offset:35840
v_mfma_f32_16x16x32_bf16 v[72:75], a[16:19], a[244:247], v[72:75]
s_cmp_eq_u32 s25, 9
s_cselect_b32 s98, 4096, 0
s_add_u32 s52, s52, s98
v_mfma_f32_16x16x32_bf16 v[76:79], a[20:23], a[240:243], v[76:79]
s_add_u32 s52, s52, 4096
v_exp_f32 v193, v193
v_mfma_f32_16x16x32_bf16 v[80:83], a[20:23], a[244:247], v[80:83]
buffer_load_dwordx4 a[144:147], v1, s[4:7], s52 offen offset:0 sc1
v_mfma_f32_16x16x32_bf16 v[84:87], a[24:27], a[240:243], v[84:87]
buffer_load_dwordx4 a[148:151], v9, s[4:7], s52 offen offset:0 sc1
v_mfma_f32_16x16x32_bf16 v[88:91], a[24:27], a[244:247], v[88:91]
buffer_load_dwordx4 a[152:155], v1, s[4:7], s52 offen offset:1024 sc1
v_mfma_f32_16x16x32_bf16 v[92:95], a[28:31], a[240:243], v[92:95]
buffer_load_dwordx4 a[156:159], v9, s[4:7], s52 offen offset:1024 sc1
v_mfma_f32_16x16x32_bf16 v[96:99], a[28:31], a[244:247], v[96:99]
v_exp_f32 v194, v194
v_mfma_f32_16x16x32_bf16 v[100:103], a[32:35], a[240:243], v[100:103]
v_exp_f32 v195, v195
v_mfma_f32_16x16x32_bf16 v[104:107], a[32:35], a[244:247], v[104:107]
s_waitcnt vmcnt(21) lgkmcnt(0)
s_barrier
v_mfma_f32_16x16x32_bf16 v[36:39], a[36:39], a[248:251], v[36:39]
ds_read_b128 a[0:3], v201 offset:0
v_fma_f32 v192, v192, v254, v254
v_mfma_f32_16x16x32_bf16 v[40:43], a[36:39], a[252:255], v[40:43]
ds_read_b128 a[4:7], v201 offset:1024
v_fma_f32 v193, v193, v254, v254
v_mfma_f32_16x16x32_bf16 v[44:47], a[40:43], a[248:251], v[44:47]
ds_read_b128 a[8:11], v201 offset:2048
v_fma_f32 v194, v194, v254, v254
v_mfma_f32_16x16x32_bf16 v[48:51], a[40:43], a[252:255], v[48:51]
ds_read_b128 a[12:15], v201 offset:3072
v_mfma_f32_16x16x32_bf16 v[52:55], a[44:47], a[248:251], v[52:55]
ds_read_b128 a[16:19], v201 offset:4096
v_mfma_f32_16x16x32_bf16 v[56:59], a[44:47], a[252:255], v[56:59]
ds_read_b128 a[20:23], v201 offset:5120
v_fma_f32 v195, v195, v254, v254
v_mfma_f32_16x16x32_bf16 v[60:63], a[48:51], a[248:251], v[60:63]
ds_read_b128 a[24:27], v201 offset:6144
v_mfma_f32_16x16x32_bf16 v[64:67], a[48:51], a[252:255], v[64:67]
ds_read_b128 a[28:31], v201 offset:7168
v_mfma_f32_16x16x32_bf16 v[68:71], a[52:55], a[248:251], v[68:71]
ds_read_b128 a[32:35], v201 offset:8192
v_mfma_f32_16x16x32_bf16 v[72:75], a[52:55], a[252:255], v[72:75]
s_cmp_eq_u32 s25, 9
s_cselect_b32 s99, 36864, 0
s_add_u32 s60, s60, s99
v_mfma_f32_16x16x32_bf16 v[76:79], a[56:59], a[248:251], v[76:79]
s_add_u32 s61, s61, s99
s_add_u32 m0, s62, 53248
s_add_u32 s60, s60, 16384
v_mfma_f32_16x16x32_bf16 v[80:83], a[56:59], a[252:255], v[80:83]
buffer_load_dwordx4 v1, s[8:11], s60 offen offset:0 sc1 lds
v_mfma_f32_16x16x32_bf16 v[84:87], a[60:63], a[248:251], v[84:87]
buffer_load_dwordx4 v1, s[8:11], s60 offen offset:1024 sc1 lds
v_mfma_f32_16x16x32_bf16 v[88:91], a[60:63], a[252:255], v[88:91]
buffer_load_dwordx4 v1, s[8:11], s60 offen offset:2048 sc1 lds
v_mfma_f32_16x16x32_bf16 v[92:95], a[64:67], a[248:251], v[92:95]
v_rcp_f32 v192, v192
v_mfma_f32_16x16x32_bf16 v[96:99], a[64:67], a[252:255], v[96:99]
buffer_load_dwordx4 v1, s[8:11], s60 offen offset:3072 sc1 lds
v_mfma_f32_16x16x32_bf16 v[100:103], a[68:71], a[248:251], v[100:103]
v_rcp_f32 v193, v193
v_mfma_f32_16x16x32_bf16 v[104:107], a[68:71], a[252:255], v[104:107]
s_waitcnt lgkmcnt(0)
v_mfma_f32_16x16x32_bf16 v[36:39], a[0:3], a[80:83], v[36:39]
ds_read_b128 a[36:39], v201 offset:9216
s_add_u32 m0, s63, 69632
v_mfma_f32_16x16x32_bf16 v[40:43], a[0:3], a[84:87], v[40:43]
ds_read_b128 a[40:43], v201 offset:10240
v_mfma_f32_16x16x32_bf16 v[44:47], a[4:7], a[80:83], v[44:47]
ds_read_b128 a[44:47], v201 offset:11264
s_add_u32 s61, s61, 36864
v_mfma_f32_16x16x32_bf16 v[48:51], a[4:7], a[84:87], v[48:51]
ds_read_b128 a[48:51], v201 offset:12288
v_mfma_f32_16x16x32_bf16 v[52:55], a[8:11], a[80:83], v[52:55]
ds_read_b128 a[52:55], v201 offset:13312
buffer_load_dwordx4 v1, s[8:11], s61 offen offset:0 sc1 lds
v_mfma_f32_16x16x32_bf16 v[56:59], a[8:11], a[84:87], v[56:59]
ds_read_b128 a[56:59], v201 offset:14336
v_mfma_f32_16x16x32_bf16 v[60:63], a[12:15], a[80:83], v[60:63]
ds_read_b128 a[60:63], v201 offset:15360
s_add_u32 m0, s62, 73728
v_mfma_f32_16x16x32_bf16 v[64:67], a[12:15], a[84:87], v[64:67]
ds_read_b128 a[64:67], v201 offset:16384
v_mfma_f32_16x16x32_bf16 v[68:71], a[16:19], a[80:83], v[68:71]
ds_read_b128 a[68:71], v201 offset:17408
s_add_u32 s60, s60, 20480
v_mfma_f32_16x16x32_bf16 v[72:75], a[16:19], a[84:87], v[72:75]
v_rcp_f32 v194, v194
v_mfma_f32_16x16x32_bf16 v[76:79], a[20:23], a[80:83], v[76:79]
buffer_load_dwordx4 v1, s[8:11], s60 offen offset:0 sc1 lds
v_mfma_f32_16x16x32_bf16 v[80:83], a[20:23], a[84:87], v[80:83]
v_rcp_f32 v195, v195
v_mfma_f32_16x16x32_bf16 v[84:87], a[24:27], a[80:83], v[84:87]
buffer_load_dwordx4 v1, s[8:11], s60 offen offset:1024 sc1 lds
v_mul_f32 v156, v156, v192
v_mfma_f32_16x16x32_bf16 v[88:91], a[24:27], a[84:87], v[88:91]
v_mul_f32 v157, v157, v193
v_mul_f32 v158, v158, v194
v_mfma_f32_16x16x32_bf16 v[92:95], a[28:31], a[80:83], v[92:95]
buffer_load_dwordx4 v1, s[8:11], s60 offen offset:2048 sc1 lds
v_mfma_f32_16x16x32_bf16 v[96:99], a[28:31], a[84:87], v[96:99]
v_mul_f32 v159, v159, v195
v_mfma_f32_16x16x32_bf16 v[100:103], a[32:35], a[80:83], v[100:103]
v_mfma_f32_16x16x32_bf16 v[104:107], a[32:35], a[84:87], v[104:107]
v_mul_f32 v196, v160, v160
s_waitcnt lgkmcnt(0)
v_mfma_f32_16x16x32_bf16 v[36:39], a[36:39], a[88:91], v[36:39]
ds_read_b128 a[0:3], v201 offset:18432
buffer_load_dwordx4 v1, s[8:11], s60 offen offset:3072 sc1 lds
v_mfma_f32_16x16x32_bf16 v[40:43], a[36:39], a[92:95], v[40:43]
ds_read_b128 a[4:7], v201 offset:19456
v_mfma_f32_16x16x32_bf16 v[44:47], a[40:43], a[88:91], v[44:47]
ds_read_b128 a[8:11], v201 offset:20480
v_mul_f32 v197, v161, v161
v_mfma_f32_16x16x32_bf16 v[48:51], a[40:43], a[92:95], v[48:51]
ds_read_b128 a[12:15], v201 offset:21504
v_mfma_f32_16x16x32_bf16 v[52:55], a[44:47], a[88:91], v[52:55]
ds_read_b128 a[16:19], v201 offset:22528
buffer_load_dwordx4 a[160:163], v1, s[4:7], s52 offen offset:2048 sc1
v_mfma_f32_16x16x32_bf16 v[56:59], a[44:47], a[92:95], v[56:59]
ds_read_b128 a[20:23], v201 offset:23552
v_mul_f32 v198, v162, v162
v_mfma_f32_16x16x32_bf16 v[60:63], a[48:51], a[88:91], v[60:63]
ds_read_b128 a[24:27], v201 offset:24576
v_mfma_f32_16x16x32_bf16 v[64:67], a[48:51], a[92:95], v[64:67]
ds_read_b128 a[28:31], v201 offset:25600
v_mul_f32 v199, v163, v163
v_mfma_f32_16x16x32_bf16 v[68:71], a[52:55], a[88:91], v[68:71]
ds_read_b128 a[32:35], v201 offset:26624
buffer_load_dwordx4 a[164:167], v9, s[4:7], s52 offen offset:2048 sc1
v_mfma_f32_16x16x32_bf16 v[72:75], a[52:55], a[92:95], v[72:75]
v_fma_f32 v196, v196, v253, v251
v_mfma_f32_16x16x32_bf16 v[76:79], a[56:59], a[88:91], v[76:79]
v_mfma_f32_16x16x32_bf16 v[80:83], a[56:59], a[92:95], v[80:83]
v_fma_f32 v197, v197, v253, v251
v_mfma_f32_16x16x32_bf16 v[84:87], a[60:63], a[88:91], v[84:87]
buffer_load_dwordx4 a[168:171], v1, s[4:7], s52 offen offset:3072 sc1
v_mfma_f32_16x16x32_bf16 v[88:91], a[60:63], a[92:95], v[88:91]
v_mfma_f32_16x16x32_bf16 v[92:95], a[64:67], a[88:91], v[92:95]
v_fma_f32 v198, v198, v253, v251
v_mfma_f32_16x16x32_bf16 v[96:99], a[64:67], a[92:95], v[96:99]
v_mfma_f32_16x16x32_bf16 v[100:103], a[68:71], a[88:91], v[100:103]
v_fma_f32 v199, v199, v253, v251
v_mfma_f32_16x16x32_bf16 v[104:107], a[68:71], a[92:95], v[104:107]
s_waitcnt lgkmcnt(0)
v_mfma_f32_16x16x32_bf16 v[36:39], a[0:3], a[96:99], v[36:39]
ds_read_b128 a[36:39], v201 offset:27648
buffer_load_dwordx4 a[172:175], v9, s[4:7], s52 offen offset:3072 sc1
v_mfma_f32_16x16x32_bf16 v[40:43], a[0:3], a[100:103], v[40:43]
ds_read_b128 a[40:43], v201 offset:28672
v_mul_f32 v196, v196, v160
v_mfma_f32_16x16x32_bf16 v[44:47], a[4:7], a[96:99], v[44:47]
ds_read_b128 a[44:47], v201 offset:29696
v_mfma_f32_16x16x32_bf16 v[48:51], a[4:7], a[100:103], v[48:51]
ds_read_b128 a[48:51], v201 offset:30720
v_mul_f32 v197, v197, v161
v_mfma_f32_16x16x32_bf16 v[52:55], a[8:11], a[96:99], v[52:55]
ds_read_b128 a[52:55], v201 offset:31744
v_mfma_f32_16x16x32_bf16 v[56:59], a[8:11], a[100:103], v[56:59]
ds_read_b128 a[56:59], v201 offset:32768
v_mul_f32 v198, v198, v162
v_mfma_f32_16x16x32_bf16 v[60:63], a[12:15], a[96:99], v[60:63]
ds_read_b128 a[60:63], v201 offset:33792
v_mfma_f32_16x16x32_bf16 v[64:67], a[12:15], a[100:103], v[64:67]
ds_read_b128 a[64:67], v201 offset:34816
v_mul_f32 v199, v199, v163
v_mfma_f32_16x16x32_bf16 v[68:71], a[16:19], a[96:99], v[68:71]
ds_read_b128 a[68:71], v201 offset:35840
v_mfma_f32_16x16x32_bf16 v[72:75], a[16:19], a[100:103], v[72:75]
s_cmp_eq_u32 s25, 10
s_cselect_b32 s98, 4096, 0
s_add_u32 s52, s52, s98
v_mfma_f32_16x16x32_bf16 v[76:79], a[20:23], a[96:99], v[76:79]
s_add_u32 s52, s52, 4096
v_exp_f32 v196, v196
v_mfma_f32_16x16x32_bf16 v[80:83], a[20:23], a[100:103], v[80:83]
buffer_load_dwordx4 a[176:179], v1, s[4:7], s52 offen offset:0 sc1
v_mfma_f32_16x16x32_bf16 v[84:87], a[24:27], a[96:99], v[84:87]
buffer_load_dwordx4 a[180:183], v9, s[4:7], s52 offen offset:0 sc1
v_mfma_f32_16x16x32_bf16 v[88:91], a[24:27], a[100:103], v[88:91]
v_mfma_f32_16x16x32_bf16 v[92:95], a[28:31], a[96:99], v[92:95]
buffer_load_dwordx4 a[184:187], v1, s[4:7], s52 offen offset:1024 sc1
v_mfma_f32_16x16x32_bf16 v[96:99], a[28:31], a[100:103], v[96:99]
v_exp_f32 v197, v197
v_mfma_f32_16x16x32_bf16 v[100:103], a[32:35], a[96:99], v[100:103]
v_mfma_f32_16x16x32_bf16 v[104:107], a[32:35], a[100:103], v[104:107]
s_waitcnt vmcnt(20) lgkmcnt(0)
s_barrier
v_mfma_f32_16x16x32_bf16 v[36:39], a[36:39], a[104:107], v[36:39]
ds_read_b128 a[0:3], v202 offset:0
buffer_load_dwordx4 a[188:191], v9, s[4:7], s52 offen offset:1024 sc1
v_mfma_f32_16x16x32_bf16 v[40:43], a[36:39], a[108:111], v[40:43]
ds_read_b128 a[4:7], v202 offset:1024
v_mfma_f32_16x16x32_bf16 v[44:47], a[40:43], a[104:107], v[44:47]
ds_read_b128 a[8:11], v202 offset:2048
v_mfma_f32_16x16x32_bf16 v[48:51], a[40:43], a[108:111], v[48:51]
ds_read_b128 a[12:15], v202 offset:3072
v_mfma_f32_16x16x32_bf16 v[52:55], a[44:47], a[104:107], v[52:55]
ds_read_b128 a[16:19], v202 offset:4096
v_mfma_f32_16x16x32_bf16 v[56:59], a[44:47], a[108:111], v[56:59]
ds_read_b128 a[20:23], v202 offset:5120
v_mfma_f32_16x16x32_bf16 v[60:63], a[48:51], a[104:107], v[60:63]
ds_read_b128 a[24:27], v202 offset:6144
v_mfma_f32_16x16x32_bf16 v[64:67], a[48:51], a[108:111], v[64:67]
ds_read_b128 a[28:31], v202 offset:7168
v_mfma_f32_16x16x32_bf16 v[68:71], a[52:55], a[104:107], v[68:71]
ds_read_b128 a[32:35], v202 offset:8192
v_mfma_f32_16x16x32_bf16 v[72:75], a[52:55], a[108:111], v[72:75]
s_cmp_eq_u32 s25, 10
s_cselect_b32 s99, 36864, 0
s_add_u32 s60, s60, s99
v_mfma_f32_16x16x32_bf16 v[76:79], a[56:59], a[104:107], v[76:79]
s_add_u32 s61, s61, s99
s_add_u32 m0, s62, 90112
s_add_u32 s60, s60, 16384
v_mfma_f32_16x16x32_bf16 v[80:83], a[56:59], a[108:111], v[80:83]
buffer_load_dwordx4 v1, s[8:11], s60 offen offset:0 sc1 lds
v_mfma_f32_16x16x32_bf16 v[84:87], a[60:63], a[104:107], v[84:87]
v_exp_f32 v198, v198
v_mfma_f32_16x16x32_bf16 v[88:91], a[60:63], a[108:111], v[88:91]
buffer_load_dwordx4 v1, s[8:11], s60 offen offset:1024 sc1 lds
v_mfma_f32_16x16x32_bf16 v[92:95], a[64:67], a[104:107], v[92:95]
v_exp_f32 v199, v199
v_mfma_f32_16x16x32_bf16 v[96:99], a[64:67], a[108:111], v[96:99]
buffer_load_dwordx4 v1, s[8:11], s60 offen offset:2048 sc1 lds
v_fma_f32 v196, v196, v255, v255
v_mfma_f32_16x16x32_bf16 v[100:103], a[68:71], a[104:107], v[100:103]
v_fma_f32 v197, v197, v255, v255
v_fma_f32 v198, v198, v255, v255
v_mfma_f32_16x16x32_bf16 v[104:107], a[68:71], a[108:111], v[104:107]
s_waitcnt lgkmcnt(0)
v_mfma_f32_16x16x32_bf16 v[36:39], a[0:3], a[112:115], v[36:39]
ds_read_b128 a[36:39], v202 offset:9216
buffer_load_dwordx4 v1, s[8:11], s60 offen offset:3072 sc1 lds
v_mfma_f32_16x16x32_bf16 v[40:43], a[0:3], a[116:119], v[40:43]
ds_read_b128 a[40:43], v202 offset:10240
v_fma_f32 v199, v199, v255, v255
v_mfma_f32_16x16x32_bf16 v[44:47], a[4:7], a[112:115], v[44:47]
ds_read_b128 a[44:47], v202 offset:11264
s_add_u32 m0, s63, 106496
v_mfma_f32_16x16x32_bf16 v[48:51], a[4:7], a[116:119], v[48:51]
ds_read_b128 a[48:51], v202 offset:12288
v_mfma_f32_16x16x32_bf16 v[52:55], a[8:11], a[112:115], v[52:55]
ds_read_b128 a[52:55], v202 offset:13312
s_add_u32 s61, s61, 36864
v_mfma_f32_16x16x32_bf16 v[56:59], a[8:11], a[116:119], v[56:59]
ds_read_b128 a[56:59], v202 offset:14336
v_mfma_f32_16x16x32_bf16 v[60:63], a[12:15], a[112:115], v[60:63]
ds_read_b128 a[60:63], v202 offset:15360
buffer_load_dwordx4 v1, s[8:11], s61 offen offset:0 sc1 lds
v_mfma_f32_16x16x32_bf16 v[64:67], a[12:15], a[116:119], v[64:67]
ds_read_b128 a[64:67], v202 offset:16384
v_mfma_f32_16x16x32_bf16 v[68:71], a[16:19], a[112:115], v[68:71]
ds_read_b128 a[68:71], v202 offset:17408
s_add_u32 m0, s62, 110592
v_mfma_f32_16x16x32_bf16 v[72:75], a[16:19], a[116:119], v[72:75]
s_add_u32 s60, s60, 20480
v_rcp_f32 v196, v196
v_mfma_f32_16x16x32_bf16 v[76:79], a[20:23], a[112:115], v[76:79]
v_rcp_f32 v197, v197
v_mfma_f32_16x16x32_bf16 v[80:83], a[20:23], a[116:119], v[80:83]
v_rcp_f32 v198, v198
v_mfma_f32_16x16x32_bf16 v[84:87], a[24:27], a[112:115], v[84:87]
buffer_load_dwordx4 v1, s[8:11], s60 offen offset:0 sc1 lds
v_mfma_f32_16x16x32_bf16 v[88:91], a[24:27], a[116:119], v[88:91]
v_mfma_f32_16x16x32_bf16 v[92:95], a[28:31], a[112:115], v[92:95]
buffer_load_dwordx4 v1, s[8:11], s60 offen offset:1024 sc1 lds
v_mfma_f32_16x16x32_bf16 v[96:99], a[28:31], a[116:119], v[96:99]
v_mfma_f32_16x16x32_bf16 v[100:103], a[32:35], a[112:115], v[100:103]
v_rcp_f32 v199, v199
v_mfma_f32_16x16x32_bf16 v[104:107], a[32:35], a[116:119], v[104:107]
s_waitcnt lgkmcnt(0)
v_mfma_f32_16x16x32_bf16 v[36:39], a[36:39], a[120:123], v[36:39]
ds_read_b128 a[0:3], v202 offset:18432
buffer_load_dwordx4 v1, s[8:11], s60 offen offset:2048 sc1 lds
v_mfma_f32_16x16x32_bf16 v[40:43], a[36:39], a[124:127], v[40:43]
ds_read_b128 a[4:7], v202 offset:19456
v_mfma_f32_16x16x32_bf16 v[44:47], a[40:43], a[120:123], v[44:47]
ds_read_b128 a[8:11], v202 offset:20480
v_mfma_f32_16x16x32_bf16 v[48:51], a[40:43], a[124:127], v[48:51]
ds_read_b128 a[12:15], v202 offset:21504
v_mul_f32 v160, v160, v196
v_mfma_f32_16x16x32_bf16 v[52:55], a[44:47], a[120:123], v[52:55]
ds_read_b128 a[16:19], v202 offset:22528
buffer_load_dwordx4 v1, s[8:11], s60 offen offset:3072 sc1 lds
v_mfma_f32_16x16x32_bf16 v[56:59], a[44:47], a[124:127], v[56:59]
ds_read_b128 a[20:23], v202 offset:23552
v_mul_f32 v161, v161, v197
v_mfma_f32_16x16x32_bf16 v[60:63], a[48:51], a[120:123], v[60:63]
ds_read_b128 a[24:27], v202 offset:24576
v_mfma_f32_16x16x32_bf16 v[64:67], a[48:51], a[124:127], v[64:67]
ds_read_b128 a[28:31], v202 offset:25600
v_mfma_f32_16x16x32_bf16 v[68:71], a[52:55], a[120:123], v[68:71]
ds_read_b128 a[32:35], v202 offset:26624
buffer_load_dwordx4 a[192:195], v1, s[4:7], s52 offen offset:2048 sc1
v_mfma_f32_16x16x32_bf16 v[72:75], a[52:55], a[124:127], v[72:75]
v_mul_f32 v162, v162, v198
v_mfma_f32_16x16x32_bf16 v[76:79], a[56:59], a[120:123], v[76:79]
v_mul_f32 v163, v163, v199
v_mfma_f32_16x16x32_bf16 v[80:83], a[56:59], a[124:127], v[80:83]
v_mfma_f32_16x16x32_bf16 v[84:87], a[60:63], a[120:123], v[84:87]
buffer_load_dwordx4 a[196:199], v9, s[4:7], s52 offen offset:2048 sc1
v_mul_f32 v192, v164, v164
v_mfma_f32_16x16x32_bf16 v[88:91], a[60:63], a[124:127], v[88:91]
v_mfma_f32_16x16x32_bf16 v[92:95], a[64:67], a[120:123], v[92:95]
v_mfma_f32_16x16x32_bf16 v[96:99], a[64:67], a[124:127], v[96:99]
v_mul_f32 v193, v165, v165
v_mfma_f32_16x16x32_bf16 v[100:103], a[68:71], a[120:123], v[100:103]
v_mfma_f32_16x16x32_bf16 v[104:107], a[68:71], a[124:127], v[104:107]
v_mul_f32 v194, v166, v166
s_waitcnt lgkmcnt(0)
v_mfma_f32_16x16x32_bf16 v[36:39], a[0:3], a[128:131], v[36:39]
ds_read_b128 a[36:39], v202 offset:27648
buffer_load_dwordx4 a[200:203], v1, s[4:7], s52 offen offset:3072 sc1
v_mfma_f32_16x16x32_bf16 v[40:43], a[0:3], a[132:135], v[40:43]
ds_read_b128 a[40:43], v202 offset:28672
v_mul_f32 v195, v167, v167
v_mfma_f32_16x16x32_bf16 v[44:47], a[4:7], a[128:131], v[44:47]
ds_read_b128 a[44:47], v202 offset:29696
buffer_load_dwordx4 a[204:207], v9, s[4:7], s52 offen offset:3072 sc1
v_mfma_f32_16x16x32_bf16 v[48:51], a[4:7], a[132:135], v[48:51]
ds_read_b128 a[48:51], v202 offset:30720
v_mfma_f32_16x16x32_bf16 v[52:55], a[8:11], a[128:131], v[52:55]
ds_read_b128 a[52:55], v202 offset:31744
v_fma_f32 v192, v192, v252, v250
v_mfma_f32_16x16x32_bf16 v[56:59], a[8:11], a[132:135], v[56:59]
ds_read_b128 a[56:59], v202 offset:32768
v_mfma_f32_16x16x32_bf16 v[60:63], a[12:15], a[128:131], v[60:63]
ds_read_b128 a[60:63], v202 offset:33792
v_fma_f32 v193, v193, v252, v250
v_mfma_f32_16x16x32_bf16 v[64:67], a[12:15], a[132:135], v[64:67]
ds_read_b128 a[64:67], v202 offset:34816
v_mfma_f32_16x16x32_bf16 v[68:71], a[16:19], a[128:131], v[68:71]
ds_read_b128 a[68:71], v202 offset:35840
v_fma_f32 v194, v194, v252, v250
v_mfma_f32_16x16x32_bf16 v[72:75], a[16:19], a[132:135], v[72:75]
s_cmp_eq_u32 s25, 11
s_cselect_b32 s98, 4096, 0
s_add_u32 s52, s52, s98
v_mfma_f32_16x16x32_bf16 v[76:79], a[20:23], a[128:131], v[76:79]
s_add_u32 s52, s52, 4096
v_mfma_f32_16x16x32_bf16 v[80:83], a[20:23], a[132:135], v[80:83]
v_fma_f32 v195, v195, v252, v250
v_mfma_f32_16x16x32_bf16 v[84:87], a[24:27], a[128:131], v[84:87]
buffer_load_dwordx4 a[208:211], v1, s[4:7], s52 offen offset:0 sc1
v_mfma_f32_16x16x32_bf16 v[88:91], a[24:27], a[132:135], v[88:91]
v_mul_f32 v192, v192, v164
v_mfma_f32_16x16x32_bf16 v[92:95], a[28:31], a[128:131], v[92:95]
buffer_load_dwordx4 a[212:215], v9, s[4:7], s52 offen offset:0 sc1
v_mfma_f32_16x16x32_bf16 v[96:99], a[28:31], a[132:135], v[96:99]
v_mfma_f32_16x16x32_bf16 v[100:103], a[32:35], a[128:131], v[100:103]
v_mul_f32 v193, v193, v165
v_mfma_f32_16x16x32_bf16 v[104:107], a[32:35], a[132:135], v[104:107]
s_waitcnt vmcnt(23) lgkmcnt(0)
s_barrier
v_mfma_f32_16x16x32_bf16 v[36:39], a[36:39], a[136:139], v[36:39]
ds_read_b128 a[0:3], v200 offset:0
buffer_load_dwordx4 a[216:219], v1, s[4:7], s52 offen offset:1024 sc1
v_mfma_f32_16x16x32_bf16 v[40:43], a[36:39], a[140:143], v[40:43]
ds_read_b128 a[4:7], v200 offset:1024
buffer_load_dwordx4 a[220:223], v9, s[4:7], s52 offen offset:1024 sc1
v_mfma_f32_16x16x32_bf16 v[44:47], a[40:43], a[136:139], v[44:47]
ds_read_b128 a[8:11], v200 offset:2048
v_mul_f32 v194, v194, v166
v_mfma_f32_16x16x32_bf16 v[48:51], a[40:43], a[140:143], v[48:51]
ds_read_b128 a[12:15], v200 offset:3072
v_mul_f32 v195, v195, v167
v_mfma_f32_16x16x32_bf16 v[52:55], a[44:47], a[136:139], v[52:55]
ds_read_b128 a[16:19], v200 offset:4096
v_mfma_f32_16x16x32_bf16 v[56:59], a[44:47], a[140:143], v[56:59]
ds_read_b128 a[20:23], v200 offset:5120
v_mfma_f32_16x16x32_bf16 v[60:63], a[48:51], a[136:139], v[60:63]
ds_read_b128 a[24:27], v200 offset:6144
v_mfma_f32_16x16x32_bf16 v[64:67], a[48:51], a[140:143], v[64:67]
ds_read_b128 a[28:31], v200 offset:7168
v_mfma_f32_16x16x32_bf16 v[68:71], a[52:55], a[136:139], v[68:71]
ds_read_b128 a[32:35], v200 offset:8192
v_mfma_f32_16x16x32_bf16 v[72:75], a[52:55], a[140:143], v[72:75]
s_cmp_eq_u32 s25, 11
s_cselect_b32 s99, 36864, 0
s_add_u32 s60, s60, s99
v_mfma_f32_16x16x32_bf16 v[76:79], a[56:59], a[136:139], v[76:79]
s_add_u32 s61, s61, s99
s_add_u32 m0, s62, 126976
v_mfma_f32_16x16x32_bf16 v[80:83], a[56:59], a[140:143], v[80:83]
s_add_u32 s60, s60, 16384
v_exp_f32 v192, v192
v_mfma_f32_16x16x32_bf16 v[84:87], a[60:63], a[136:139], v[84:87]
v_exp_f32 v193, v193
v_mfma_f32_16x16x32_bf16 v[88:91], a[60:63], a[140:143], v[88:91]
buffer_load_dwordx4 v1, s[8:11], s60 offen offset:0 sc1 lds
v_mfma_f32_16x16x32_bf16 v[92:95], a[64:67], a[136:139], v[92:95]
v_exp_f32 v194, v194
v_mfma_f32_16x16x32_bf16 v[96:99], a[64:67], a[140:143], v[96:99]
buffer_load_dwordx4 v1, s[8:11], s60 offen offset:1024 sc1 lds
v_mfma_f32_16x16x32_bf16 v[100:103], a[68:71], a[136:139], v[100:103]
v_mfma_f32_16x16x32_bf16 v[104:107], a[68:71], a[140:143], v[104:107]
s_waitcnt lgkmcnt(0)
v_mfma_f32_16x16x32_bf16 v[36:39], a[0:3], a[144:147], v[36:39]
ds_read_b128 a[36:39], v200 offset:9216
buffer_load_dwordx4 v1, s[8:11], s60 offen offset:2048 sc1 lds
v_mfma_f32_16x16x32_bf16 v[40:43], a[0:3], a[148:151], v[40:43]
ds_read_b128 a[40:43], v200 offset:10240
v_mfma_f32_16x16x32_bf16 v[44:47], a[4:7], a[144:147], v[44:47]
ds_read_b128 a[44:47], v200 offset:11264
buffer_load_dwordx4 v1, s[8:11], s60 offen offset:3072 sc1 lds
v_mfma_f32_16x16x32_bf16 v[48:51], a[4:7], a[148:151], v[48:51]
ds_read_b128 a[48:51], v200 offset:12288
v_mfma_f32_16x16x32_bf16 v[52:55], a[8:11], a[144:147], v[52:55]
ds_read_b128 a[52:55], v200 offset:13312
s_add_u32 m0, s63, 143360
v_mfma_f32_16x16x32_bf16 v[56:59], a[8:11], a[148:151], v[56:59]
ds_read_b128 a[56:59], v200 offset:14336
v_mfma_f32_16x16x32_bf16 v[60:63], a[12:15], a[144:147], v[60:63]
ds_read_b128 a[60:63], v200 offset:15360
s_add_u32 s61, s61, 36864
v_mfma_f32_16x16x32_bf16 v[64:67], a[12:15], a[148:151], v[64:67]
ds_read_b128 a[64:67], v200 offset:16384
v_mfma_f32_16x16x32_bf16 v[68:71], a[16:19], a[144:147], v[68:71]
ds_read_b128 a[68:71], v200 offset:17408
buffer_load_dwordx4 v1, s[8:11], s61 offen offset:0 sc1 lds
v_mfma_f32_16x16x32_bf16 v[72:75], a[16:19], a[148:151], v[72:75]
s_add_u32 m0, s62, 147456
v_exp_f32 v195, v195
v_mfma_f32_16x16x32_bf16 v[76:79], a[20:23], a[144:147], v[76:79]
s_add_u32 s60, s60, 20480
v_fma_f32 v192, v192, v254, v254
v_fma_f32 v193, v193, v254, v254
v_mfma_f32_16x16x32_bf16 v[80:83], a[20:23], a[148:151], v[80:83]
v_fma_f32 v194, v194, v254, v254
v_mfma_f32_16x16x32_bf16 v[84:87], a[24:27], a[144:147], v[84:87]
v_mfma_f32_16x16x32_bf16 v[88:91], a[24:27], a[148:151], v[88:91]
v_fma_f32 v195, v195, v254, v254
v_mfma_f32_16x16x32_bf16 v[92:95], a[28:31], a[144:147], v[92:95]
buffer_load_dwordx4 v1, s[8:11], s60 offen offset:0 sc1 lds
v_mfma_f32_16x16x32_bf16 v[96:99], a[28:31], a[148:151], v[96:99]
v_rcp_f32 v192, v192
v_mfma_f32_16x16x32_bf16 v[100:103], a[32:35], a[144:147], v[100:103]
v_mfma_f32_16x16x32_bf16 v[104:107], a[32:35], a[148:151], v[104:107]
s_waitcnt vmcnt(27) lgkmcnt(0)
v_mfma_f32_16x16x32_bf16 v[36:39], a[36:39], a[152:155], v[36:39]
ds_read_b128 a[0:3], v200 offset:18432
buffer_load_dwordx4 v1, s[8:11], s60 offen offset:1024 sc1 lds
v_mfma_f32_16x16x32_bf16 v[40:43], a[36:39], a[156:159], v[40:43]
ds_read_b128 a[4:7], v200 offset:19456
v_mfma_f32_16x16x32_bf16 v[44:47], a[40:43], a[152:155], v[44:47]
ds_read_b128 a[8:11], v200 offset:20480
v_mfma_f32_16x16x32_bf16 v[48:51], a[40:43], a[156:159], v[48:51]
ds_read_b128 a[12:15], v200 offset:21504
v_mfma_f32_16x16x32_bf16 v[52:55], a[44:47], a[152:155], v[52:55]
ds_read_b128 a[16:19], v200 offset:22528
buffer_load_dwordx4 v1, s[8:11], s60 offen offset:2048 sc1 lds
v_mfma_f32_16x16x32_bf16 v[56:59], a[44:47], a[156:159], v[56:59]
ds_read_b128 a[20:23], v200 offset:23552
v_mfma_f32_16x16x32_bf16 v[60:63], a[48:51], a[152:155], v[60:63]
ds_read_b128 a[24:27], v200 offset:24576
v_mfma_f32_16x16x32_bf16 v[64:67], a[48:51], a[156:159], v[64:67]
ds_read_b128 a[28:31], v200 offset:25600
v_mfma_f32_16x16x32_bf16 v[68:71], a[52:55], a[152:155], v[68:71]
ds_read_b128 a[32:35], v200 offset:26624
buffer_load_dwordx4 v1, s[8:11], s60 offen offset:3072 sc1 lds
v_mfma_f32_16x16x32_bf16 v[72:75], a[52:55], a[156:159], v[72:75]
v_rcp_f32 v193, v193
v_mfma_f32_16x16x32_bf16 v[76:79], a[56:59], a[152:155], v[76:79]
v_rcp_f32 v194, v194
v_mfma_f32_16x16x32_bf16 v[80:83], a[56:59], a[156:159], v[80:83]
v_rcp_f32 v195, v195
v_mfma_f32_16x16x32_bf16 v[84:87], a[60:63], a[152:155], v[84:87]
buffer_load_dwordx4 a[224:227], v1, s[4:7], s52 offen offset:2048 sc1
v_mfma_f32_16x16x32_bf16 v[88:91], a[60:63], a[156:159], v[88:91]
v_mfma_f32_16x16x32_bf16 v[92:95], a[64:67], a[152:155], v[92:95]
v_mfma_f32_16x16x32_bf16 v[96:99], a[64:67], a[156:159], v[96:99]
v_mfma_f32_16x16x32_bf16 v[100:103], a[68:71], a[152:155], v[100:103]
v_mul_f32 v164, v164, v192
v_mfma_f32_16x16x32_bf16 v[104:107], a[68:71], a[156:159], v[104:107]
s_waitcnt lgkmcnt(0)
v_mfma_f32_16x16x32_bf16 v[36:39], a[0:3], a[160:163], v[36:39]
ds_read_b128 a[36:39], v200 offset:27648
buffer_load_dwordx4 a[228:231], v9, s[4:7], s52 offen offset:2048 sc1
v_mfma_f32_16x16x32_bf16 v[40:43], a[0:3], a[164:167], v[40:43]
ds_read_b128 a[40:43], v200 offset:28672
v_mul_f32 v165, v165, v193
v_mfma_f32_16x16x32_bf16 v[44:47], a[4:7], a[160:163], v[44:47]
ds_read_b128 a[44:47], v200 offset:29696
buffer_load_dwordx4 a[232:235], v1, s[4:7], s52 offen offset:3072 sc1
v_mfma_f32_16x16x32_bf16 v[48:51], a[4:7], a[164:167], v[48:51]
ds_read_b128 a[48:51], v200 offset:30720
v_mul_f32 v166, v166, v194
v_mfma_f32_16x16x32_bf16 v[52:55], a[8:11], a[160:163], v[52:55]
ds_read_b128 a[52:55], v200 offset:31744
buffer_load_dwordx4 a[236:239], v9, s[4:7], s52 offen offset:3072 sc1
v_mfma_f32_16x16x32_bf16 v[56:59], a[8:11], a[164:167], v[56:59]
ds_read_b128 a[56:59], v200 offset:32768
v_mul_f32 v167, v167, v195
v_mfma_f32_16x16x32_bf16 v[60:63], a[12:15], a[160:163], v[60:63]
ds_read_b128 a[60:63], v200 offset:33792
v_mfma_f32_16x16x32_bf16 v[64:67], a[12:15], a[164:167], v[64:67]
ds_read_b128 a[64:67], v200 offset:34816
v_mul_f32 v196, v168, v168
v_mfma_f32_16x16x32_bf16 v[68:71], a[16:19], a[160:163], v[68:71]
ds_read_b128 a[68:71], v200 offset:35840
v_mfma_f32_16x16x32_bf16 v[72:75], a[16:19], a[164:167], v[72:75]
s_cmp_eq_u32 s25, 12
s_cselect_b32 s98, 4096, 0
v_mfma_f32_16x16x32_bf16 v[76:79], a[20:23], a[160:163], v[76:79]
s_add_u32 s52, s52, s98
v_mul_f32 v197, v169, v169
v_mfma_f32_16x16x32_bf16 v[80:83], a[20:23], a[164:167], v[80:83]
s_add_u32 s52, s52, 4096
v_mfma_f32_16x16x32_bf16 v[84:87], a[24:27], a[160:163], v[84:87]
v_mul_f32 v198, v170, v170
v_mfma_f32_16x16x32_bf16 v[88:91], a[24:27], a[164:167], v[88:91]
v_mfma_f32_16x16x32_bf16 v[92:95], a[28:31], a[160:163], v[92:95]
buffer_load_dwordx4 a[240:243], v1, s[4:7], s52 offen offset:0 sc1
v_mul_f32 v199, v171, v171
v_mfma_f32_16x16x32_bf16 v[96:99], a[28:31], a[164:167], v[96:99]
v_mfma_f32_16x16x32_bf16 v[100:103], a[32:35], a[160:163], v[100:103]
v_mfma_f32_16x16x32_bf16 v[104:107], a[32:35], a[164:167], v[104:107]
s_waitcnt vmcnt(22) lgkmcnt(0)
s_barrier
v_mfma_f32_16x16x32_bf16 v[36:39], a[36:39], a[168:171], v[36:39]
ds_read_b128 a[0:3], v201 offset:0
buffer_load_dwordx4 a[244:247], v9, s[4:7], s52 offen offset:0 sc1
v_mfma_f32_16x16x32_bf16 v[40:43], a[36:39], a[172:175], v[40:43]
ds_read_b128 a[4:7], v201 offset:1024
buffer_load_dwordx4 a[248:251], v1, s[4:7], s52 offen offset:1024 sc1
v_mfma_f32_16x16x32_bf16 v[44:47], a[40:43], a[168:171], v[44:47]
ds_read_b128 a[8:11], v201 offset:2048
v_fma_f32 v196, v196, v253, v251
v_mfma_f32_16x16x32_bf16 v[48:51], a[40:43], a[172:175], v[48:51]
ds_read_b128 a[12:15], v201 offset:3072
buffer_load_dwordx4 a[252:255], v9, s[4:7], s52 offen offset:1024 sc1
v_mfma_f32_16x16x32_bf16 v[52:55], a[44:47], a[168:171], v[52:55]
ds_read_b128 a[16:19], v201 offset:4096
v_fma_f32 v197, v197, v253, v251
v_mfma_f32_16x16x32_bf16 v[56:59], a[44:47], a[172:175], v[56:59]
ds_read_b128 a[20:23], v201 offset:5120
v_fma_f32 v198, v198, v253, v251
v_mfma_f32_16x16x32_bf16 v[60:63], a[48:51], a[168:171], v[60:63]
ds_read_b128 a[24:27], v201 offset:6144
v_fma_f32 v199, v199, v253, v251
v_mfma_f32_16x16x32_bf16 v[64:67], a[48:51], a[172:175], v[64:67]
ds_read_b128 a[28:31], v201 offset:7168
v_mfma_f32_16x16x32_bf16 v[68:71], a[52:55], a[168:171], v[68:71]
ds_read_b128 a[32:35], v201 offset:8192
v_mul_f32 v196, v196, v168
v_mfma_f32_16x16x32_bf16 v[72:75], a[52:55], a[172:175], v[72:75]
s_cmp_eq_u32 s25, 12
s_cselect_b32 s99, 36864, 0
s_add_u32 s60, s60, s99
v_mfma_f32_16x16x32_bf16 v[76:79], a[56:59], a[168:171], v[76:79]
s_add_u32 s61, s61, s99
v_mul_f32 v197, v197, v169
v_mfma_f32_16x16x32_bf16 v[80:83], a[56:59], a[172:175], v[80:83]
s_add_u32 m0, s62, 53248
v_mfma_f32_16x16x32_bf16 v[84:87], a[60:63], a[168:171], v[84:87]
s_add_u32 s60, s60, 16384
v_mfma_f32_16x16x32_bf16 v[88:91], a[60:63], a[172:175], v[88:91]
v_mul_f32 v198, v198, v170
v_mfma_f32_16x16x32_bf16 v[92:95], a[64:67], a[168:171], v[92:95]
v_mfma_f32_16x16x32_bf16 v[96:99], a[64:67], a[172:175], v[96:99]
buffer_load_dwordx4 v1, s[8:11], s60 offen offset:0 sc1 lds
v_mul_f32 v199, v199, v171
v_mfma_f32_16x16x32_bf16 v[100:103], a[68:71], a[168:171], v[100:103]
v_mfma_f32_16x16x32_bf16 v[104:107], a[68:71], a[172:175], v[104:107]
s_waitcnt lgkmcnt(0)
v_mfma_f32_16x16x32_bf16 v[36:39], a[0:3], a[176:179], v[36:39]
ds_read_b128 a[36:39], v201 offset:9216
buffer_load_dwordx4 v1, s[8:11], s60 offen offset:1024 sc1 lds
v_mfma_f32_16x16x32_bf16 v[40:43], a[0:3], a[180:183], v[40:43]
ds_read_b128 a[40:43], v201 offset:10240
s_mov_b32 s37, L_c4+18432-L_pc
v_mfma_f32_16x16x32_bf16 v[44:47], a[4:7], a[176:179], v[44:47]
ds_read_b128 a[44:47], v201 offset:11264
buffer_load_dwordx4 v1, s[8:11], s60 offen offset:2048 sc1 lds
v_mfma_f32_16x16x32_bf16 v[48:51], a[4:7], a[180:183], v[48:51]
ds_read_b128 a[48:51], v201 offset:12288
v_mfma_f32_16x16x32_bf16 v[52:55], a[8:11], a[176:179], v[52:55]
ds_read_b128 a[52:55], v201 offset:13312
buffer_load_dword v15, v14, s[88:91], s37 offen
v_mfma_f32_16x16x32_bf16 v[56:59], a[8:11], a[180:183], v[56:59]
ds_read_b128 a[56:59], v201 offset:14336
buffer_load_dwordx4 v1, s[8:11], s60 offen offset:3072 sc1 lds
v_mfma_f32_16x16x32_bf16 v[60:63], a[12:15], a[176:179], v[60:63]
ds_read_b128 a[60:63], v201 offset:15360
v_mfma_f32_16x16x32_bf16 v[64:67], a[12:15], a[180:183], v[64:67]
ds_read_b128 a[64:67], v201 offset:16384
v_mfma_f32_16x16x32_bf16 v[68:71], a[16:19], a[176:179], v[68:71]
ds_read_b128 a[68:71], v201 offset:17408
s_add_u32 m0, s63, 69632
v_mfma_f32_16x16x32_bf16 v[72:75], a[16:19], a[180:183], v[72:75]
s_add_u32 s61, s61, 36864
v_exp_f32 v196, v196
v_mfma_f32_16x16x32_bf16 v[76:79], a[20:23], a[176:179], v[76:79]
v_exp_f32 v197, v197
v_mfma_f32_16x16x32_bf16 v[80:83], a[20:23], a[180:183], v[80:83]
v_exp_f32 v198, v198
v_mfma_f32_16x16x32_bf16 v[84:87], a[24:27], a[176:179], v[84:87]
v_mfma_f32_16x16x32_bf16 v[88:91], a[24:27], a[180:183], v[88:91]
v_mfma_f32_16x16x32_bf16 v[92:95], a[28:31], a[176:179], v[92:95]
buffer_load_dwordx4 v1, s[8:11], s61 offen offset:0 sc1 lds
v_mfma_f32_16x16x32_bf16 v[96:99], a[28:31], a[180:183], v[96:99]
v_exp_f32 v199, v199
v_mfma_f32_16x16x32_bf16 v[100:103], a[32:35], a[176:179], v[100:103]
v_mfma_f32_16x16x32_bf16 v[104:107], a[32:35], a[180:183], v[104:107]
s_waitcnt vmcnt(27) lgkmcnt(0)
v_mfma_f32_16x16x32_bf16 v[36:39], a[36:39], a[184:187], v[36:39]
ds_read_b128 a[0:3], v201 offset:18432
s_add_u32 m0, s62, 73728
v_mfma_f32_16x16x32_bf16 v[40:43], a[36:39], a[188:191], v[40:43]
ds_read_b128 a[4:7], v201 offset:19456
v_fma_f32 v196, v196, v255, v255
v_mfma_f32_16x16x32_bf16 v[44:47], a[40:43], a[184:187], v[44:47]
ds_read_b128 a[8:11], v201 offset:20480
s_add_u32 s60, s60, 20480
v_mfma_f32_16x16x32_bf16 v[48:51], a[40:43], a[188:191], v[48:51]
ds_read_b128 a[12:15], v201 offset:21504
v_fma_f32 v197, v197, v255, v255
v_mfma_f32_16x16x32_bf16 v[52:55], a[44:47], a[184:187], v[52:55]
ds_read_b128 a[16:19], v201 offset:22528
v_mfma_f32_16x16x32_bf16 v[56:59], a[44:47], a[188:191], v[56:59]
ds_read_b128 a[20:23], v201 offset:23552
buffer_load_dwordx4 v1, s[8:11], s60 offen offset:0 sc1 lds
v_mfma_f32_16x16x32_bf16 v[60:63], a[48:51], a[184:187], v[60:63]
ds_read_b128 a[24:27], v201 offset:24576
v_fma_f32 v198, v198, v255, v255
v_mfma_f32_16x16x32_bf16 v[64:67], a[48:51], a[188:191], v[64:67]
ds_read_b128 a[28:31], v201 offset:25600
v_fma_f32 v199, v199, v255, v255
v_mfma_f32_16x16x32_bf16 v[68:71], a[52:55], a[184:187], v[68:71]
ds_read_b128 a[32:35], v201 offset:26624
buffer_load_dwordx4 v1, s[8:11], s60 offen offset:1024 sc1 lds
v_mfma_f32_16x16x32_bf16 v[72:75], a[52:55], a[188:191], v[72:75]
v_mfma_f32_16x16x32_bf16 v[76:79], a[56:59], a[184:187], v[76:79]
v_rcp_f32 v196, v196
v_mfma_f32_16x16x32_bf16 v[80:83], a[56:59], a[188:191], v[80:83]
buffer_load_dwordx4 v1, s[8:11], s60 offen offset:2048 sc1 lds
v_mfma_f32_16x16x32_bf16 v[84:87], a[60:63], a[184:187], v[84:87]
v_mfma_f32_16x16x32_bf16 v[88:91], a[60:63], a[188:191], v[88:91]
v_mfma_f32_16x16x32_bf16 v[92:95], a[64:67], a[184:187], v[92:95]
buffer_load_dwordx4 v1, s[8:11], s60 offen offset:3072 sc1 lds
v_mfma_f32_16x16x32_bf16 v[96:99], a[64:67], a[188:191], v[96:99]
v_rcp_f32 v197, v197
v_mfma_f32_16x16x32_bf16 v[100:103], a[68:71], a[184:187], v[100:103]
v_mfma_f32_16x16x32_bf16 v[104:107], a[68:71], a[188:191], v[104:107]
s_waitcnt lgkmcnt(0)
v_mfma_f32_16x16x32_bf16 v[36:39], a[0:3], a[192:195], v[36:39]
ds_read_b128 a[36:39], v201 offset:27648
buffer_load_dwordx4 a[80:83], v1, s[4:7], s52 offen offset:2048 sc1
v_mfma_f32_16x16x32_bf16 v[40:43], a[0:3], a[196:199], v[40:43]
ds_read_b128 a[40:43], v201 offset:28672
v_mfma_f32_16x16x32_bf16 v[44:47], a[4:7], a[192:195], v[44:47]
ds_read_b128 a[44:47], v201 offset:29696
v_mfma_f32_16x16x32_bf16 v[48:51], a[4:7], a[196:199], v[48:51]
ds_read_b128 a[48:51], v201 offset:30720
v_mfma_f32_16x16x32_bf16 v[52:55], a[8:11], a[192:195], v[52:55]
ds_read_b128 a[52:55], v201 offset:31744
buffer_load_dwordx4 a[84:87], v9, s[4:7], s52 offen offset:2048 sc1
v_mfma_f32_16x16x32_bf16 v[56:59], a[8:11], a[196:199], v[56:59]
ds_read_b128 a[56:59], v201 offset:32768
v_mfma_f32_16x16x32_bf16 v[60:63], a[12:15], a[192:195], v[60:63]
ds_read_b128 a[60:63], v201 offset:33792
v_mfma_f32_16x16x32_bf16 v[64:67], a[12:15], a[196:199], v[64:67]
ds_read_b128 a[64:67], v201 offset:34816
v_mfma_f32_16x16x32_bf16 v[68:71], a[16:19], a[192:195], v[68:71]
ds_read_b128 a[68:71], v201 offset:35840
buffer_load_dwordx4 a[88:91], v1, s[4:7], s52 offen offset:3072 sc1
v_mfma_f32_16x16x32_bf16 v[72:75], a[16:19], a[196:199], v[72:75]
v_rcp_f32 v198, v198
v_mfma_f32_16x16x32_bf16 v[76:79], a[20:23], a[192:195], v[76:79]
v_rcp_f32 v199, v199
v_mfma_f32_16x16x32_bf16 v[80:83], a[20:23], a[196:199], v[80:83]
v_mul_f32 v168, v168, v196
v_mfma_f32_16x16x32_bf16 v[84:87], a[24:27], a[192:195], v[84:87]
buffer_load_dwordx4 a[92:95], v9, s[4:7], s52 offen offset:3072 sc1
v_mfma_f32_16x16x32_bf16 v[88:91], a[24:27], a[196:199], v[88:91]
v_mul_f32 v169, v169, v197
v_mfma_f32_16x16x32_bf16 v[92:95], a[28:31], a[192:195], v[92:95]
v_mfma_f32_16x16x32_bf16 v[96:99], a[28:31], a[196:199], v[96:99]
v_mul_f32 v170, v170, v198
v_mfma_f32_16x16x32_bf16 v[100:103], a[32:35], a[192:195], v[100:103]
v_mfma_f32_16x16x32_bf16 v[104:107], a[32:35], a[196:199], v[104:107]
s_waitcnt vmcnt(22) lgkmcnt(0)
s_barrier
v_mfma_f32_16x16x32_bf16 v[36:39], a[36:39], a[200:203], v[36:39]
ds_read_b128 a[0:3], v202 offset:0
v_mul_f32 v171, v171, v199
v_mfma_f32_16x16x32_bf16 v[40:43], a[36:39], a[204:207], v[40:43]
ds_read_b128 a[4:7], v202 offset:1024
v_mfma_f32_16x16x32_bf16 v[44:47], a[40:43], a[200:203], v[44:47]
ds_read_b128 a[8:11], v202 offset:2048
v_mul_f32 v192, v172, v172
v_mfma_f32_16x16x32_bf16 v[48:51], a[40:43], a[204:207], v[48:51]
ds_read_b128 a[12:15], v202 offset:3072
v_mfma_f32_16x16x32_bf16 v[52:55], a[44:47], a[200:203], v[52:55]
ds_read_b128 a[16:19], v202 offset:4096
v_mul_f32 v193, v173, v173
v_mfma_f32_16x16x32_bf16 v[56:59], a[44:47], a[204:207], v[56:59]
ds_read_b128 a[20:23], v202 offset:5120
v_mfma_f32_16x16x32_bf16 v[60:63], a[48:51], a[200:203], v[60:63]
ds_read_b128 a[24:27], v202 offset:6144
v_mfma_f32_16x16x32_bf16 v[64:67], a[48:51], a[204:207], v[64:67]
ds_read_b128 a[28:31], v202 offset:7168
v_mul_f32 v194, v174, v174
v_mfma_f32_16x16x32_bf16 v[68:71], a[52:55], a[200:203], v[68:71]
ds_read_b128 a[32:35], v202 offset:8192
v_mfma_f32_16x16x32_bf16 v[72:75], a[52:55], a[204:207], v[72:75]
s_cmp_eq_u32 s25, 13
s_cselect_b32 s99, 36864, 0
s_add_u32 s60, s60, s99
v_mfma_f32_16x16x32_bf16 v[76:79], a[56:59], a[200:203], v[76:79]
s_add_u32 s61, s61, s99
s_add_u32 m0, s62, 90112
s_add_u32 s60, s60, 16384
v_mfma_f32_16x16x32_bf16 v[80:83], a[56:59], a[204:207], v[80:83]
buffer_load_dwordx4 v1, s[8:11], s60 offen offset:0 sc1 lds
v_mul_f32 v195, v175, v175
v_mfma_f32_16x16x32_bf16 v[84:87], a[60:63], a[200:203], v[84:87]
buffer_load_dwordx4 v1, s[8:11], s60 offen offset:1024 sc1 lds
v_fma_f32 v192, v192, v252, v250
v_mfma_f32_16x16x32_bf16 v[88:91], a[60:63], a[204:207], v[88:91]
buffer_load_dwordx4 v1, s[8:11], s60 offen offset:2048 sc1 lds
v_mfma_f32_16x16x32_bf16 v[92:95], a[64:67], a[200:203], v[92:95]
v_fma_f32 v193, v193, v252, v250
v_mfma_f32_16x16x32_bf16 v[96:99], a[64:67], a[204:207], v[96:99]
buffer_load_dwordx4 v1, s[8:11], s60 offen offset:3072 sc1 lds
v_mfma_f32_16x16x32_bf16 v[100:103], a[68:71], a[200:203], v[100:103]
v_fma_f32 v194, v194, v252, v250
v_mfma_f32_16x16x32_bf16 v[104:107], a[68:71], a[204:207], v[104:107]
s_waitcnt lgkmcnt(0)
v_mfma_f32_16x16x32_bf16 v[36:39], a[0:3], a[208:211], v[36:39]
ds_read_b128 a[36:39], v202 offset:9216
s_add_u32 m0, s63, 106496
v_mfma_f32_16x16x32_bf16 v[40:43], a[0:3], a[212:215], v[40:43]
ds_read_b128 a[40:43], v202 offset:10240
v_fma_f32 v195, v195, v252, v250
v_mfma_f32_16x16x32_bf16 v[44:47], a[4:7], a[208:211], v[44:47]
ds_read_b128 a[44:47], v202 offset:11264
s_add_u32 s61, s61, 36864
v_mfma_f32_16x16x32_bf16 v[48:51], a[4:7], a[212:215], v[48:51]
ds_read_b128 a[48:51], v202 offset:12288
v_mul_f32 v192, v192, v172
v_mfma_f32_16x16x32_bf16 v[52:55], a[8:11], a[208:211], v[52:55]
ds_read_b128 a[52:55], v202 offset:13312
buffer_load_dwordx4 v1, s[8:11], s61 offen offset:0 sc1 lds
v_mfma_f32_16x16x32_bf16 v[56:59], a[8:11], a[212:215], v[56:59]
ds_read_b128 a[56:59], v202 offset:14336
v_mul_f32 v193, v193, v173
v_mfma_f32_16x16x32_bf16 v[60:63], a[12:15], a[208:211], v[60:63]
ds_read_b128 a[60:63], v202 offset:15360
s_add_u32 m0, s62, 110592
v_mfma_f32_16x16x32_bf16 v[64:67], a[12:15], a[212:215], v[64:67]
ds_read_b128 a[64:67], v202 offset:16384
v_mfma_f32_16x16x32_bf16 v[68:71], a[16:19], a[208:211], v[68:71]
ds_read_b128 a[68:71], v202 offset:17408
s_add_u32 s60, s60, 20480
v_mfma_f32_16x16x32_bf16 v[72:75], a[16:19], a[212:215], v[72:75]
v_mul_f32 v194, v194, v174
v_mfma_f32_16x16x32_bf16 v[76:79], a[20:23], a[208:211], v[76:79]
buffer_load_dwordx4 v1, s[8:11], s60 offen offset:0 sc1 lds
v_mul_f32 v195, v195, v175
v_mfma_f32_16x16x32_bf16 v[80:83], a[20:23], a[212:215], v[80:83]
v_mfma_f32_16x16x32_bf16 v[84:87], a[24:27], a[208:211], v[84:87]
buffer_load_dwordx4 v1, s[8:11], s60 offen offset:1024 sc1 lds
v_mfma_f32_16x16x32_bf16 v[88:91], a[24:27], a[212:215], v[88:91]
v_exp_f32 v192, v192
v_mfma_f32_16x16x32_bf16 v[92:95], a[28:31], a[208:211], v[92:95]
buffer_load_dwordx4 v1, s[8:11], s60 offen offset:2048 sc1 lds
v_mfma_f32_16x16x32_bf16 v[96:99], a[28:31], a[212:215], v[96:99]
v_mfma_f32_16x16x32_bf16 v[100:103], a[32:35], a[208:211], v[100:103]
v_mfma_f32_16x16x32_bf16 v[104:107], a[32:35], a[212:215], v[104:107]
s_waitcnt vmcnt(26) lgkmcnt(0)
v_mfma_f32_16x16x32_bf16 v[36:39], a[36:39], a[216:219], v[36:39]
ds_read_b128 a[0:3], v202 offset:18432
buffer_load_dwordx4 v1, s[8:11], s60 offen offset:3072 sc1 lds
v_mfma_f32_16x16x32_bf16 v[40:43], a[36:39], a[220:223], v[40:43]
ds_read_b128 a[4:7], v202 offset:19456
v_mfma_f32_16x16x32_bf16 v[44:47], a[40:43], a[216:219], v[44:47]
ds_read_b128 a[8:11], v202 offset:20480
v_mfma_f32_16x16x32_bf16 v[48:51], a[40:43], a[220:223], v[48:51]
ds_read_b128 a[12:15], v202 offset:21504
v_mfma_f32_16x16x32_bf16 v[52:55], a[44:47], a[216:219], v[52:55]
ds_read_b128 a[16:19], v202 offset:22528
v_mfma_f32_16x16x32_bf16 v[56:59], a[44:47], a[220:223], v[56:59]
ds_read_b128 a[20:23], v202 offset:23552
v_mfma_f32_16x16x32_bf16 v[60:63], a[48:51], a[216:219], v[60:63]
ds_read_b128 a[24:27], v202 offset:24576
v_mfma_f32_16x16x32_bf16 v[64:67], a[48:51], a[220:223], v[64:67]
ds_read_b128 a[28:31], v202 offset:25600
v_mfma_f32_16x16x32_bf16 v[68:71], a[52:55], a[216:219], v[68:71]
ds_read_b128 a[32:35], v202 offset:26624
v_mfma_f32_16x16x32_bf16 v[72:75], a[52:55], a[220:223], v[72:75]
s_cmp_eq_u32 s25, 13
s_cselect_b32 s98, 4096, 0
s_add_u32 s52, s52, s98
v_mfma_f32_16x16x32_bf16 v[76:79], a[56:59], a[216:219], v[76:79]
s_add_u32 s52, s52, 4096
v_exp_f32 v193, v193
v_mfma_f32_16x16x32_bf16 v[80:83], a[56:59], a[220:223], v[80:83]
buffer_load_dwordx4 a[96:99], v1, s[4:7], s52 offen offset:0 sc1
v_mfma_f32_16x16x32_bf16 v[84:87], a[60:63], a[216:219], v[84:87]
buffer_load_dwordx4 a[100:103], v9, s[4:7], s52 offen offset:0 sc1
v_mfma_f32_16x16x32_bf16 v[88:91], a[60:63], a[220:223], v[88:91]
v_exp_f32 v194, v194
v_mfma_f32_16x16x32_bf16 v[92:95], a[64:67], a[216:219], v[92:95]
buffer_load_dwordx4 a[104:107], v1, s[4:7], s52 offen offset:1024 sc1
v_mfma_f32_16x16x32_bf16 v[96:99], a[64:67], a[220:223], v[96:99]
v_exp_f32 v195, v195
v_mfma_f32_16x16x32_bf16 v[100:103], a[68:71], a[216:219], v[100:103]
v_fma_f32 v192, v192, v254, v254
v_fma_f32 v193, v193, v254, v254
v_mfma_f32_16x16x32_bf16 v[104:107], a[68:71], a[220:223], v[104:107]
s_waitcnt lgkmcnt(0)
v_mfma_f32_16x16x32_bf16 v[36:39], a[0:3], a[224:227], v[36:39]
ds_read_b128 a[36:39], v202 offset:27648
buffer_load_dwordx4 a[108:111], v9, s[4:7], s52 offen offset:1024 sc1
v_mfma_f32_16x16x32_bf16 v[40:43], a[0:3], a[228:231], v[40:43]
ds_read_b128 a[40:43], v202 offset:28672
v_fma_f32 v194, v194, v254, v254
v_mfma_f32_16x16x32_bf16 v[44:47], a[4:7], a[224:227], v[44:47]
ds_read_b128 a[44:47], v202 offset:29696
v_fma_f32 v195, v195, v254, v254
v_mfma_f32_16x16x32_bf16 v[48:51], a[4:7], a[228:231], v[48:51]
ds_read_b128 a[48:51], v202 offset:30720
v_mfma_f32_16x16x32_bf16 v[52:55], a[8:11], a[224:227], v[52:55]
ds_read_b128 a[52:55], v202 offset:31744
buffer_load_dwordx4 a[112:115], v1, s[4:7], s52 offen offset:2048 sc1
v_mfma_f32_16x16x32_bf16 v[56:59], a[8:11], a[228:231], v[56:59]
ds_read_b128 a[56:59], v202 offset:32768
v_mfma_f32_16x16x32_bf16 v[60:63], a[12:15], a[224:227], v[60:63]
ds_read_b128 a[60:63], v202 offset:33792
v_mfma_f32_16x16x32_bf16 v[64:67], a[12:15], a[228:231], v[64:67]
ds_read_b128 a[64:67], v202 offset:34816
v_mfma_f32_16x16x32_bf16 v[68:71], a[16:19], a[224:227], v[68:71]
ds_read_b128 a[68:71], v202 offset:35840
buffer_load_dwordx4 a[116:119], v9, s[4:7], s52 offen offset:2048 sc1
v_mfma_f32_16x16x32_bf16 v[72:75], a[16:19], a[228:231], v[72:75]
v_rcp_f32 v192, v192
v_mfma_f32_16x16x32_bf16 v[76:79], a[20:23], a[224:227], v[76:79]
v_rcp_f32 v193, v193
v_mfma_f32_16x16x32_bf16 v[80:83], a[20:23], a[228:231], v[80:83]
v_mfma_f32_16x16x32_bf16 v[84:87], a[24:27], a[224:227], v[84:87]
buffer_load_dwordx4 a[120:123], v1, s[4:7], s52 offen offset:3072 sc1
v_mfma_f32_16x16x32_bf16 v[88:91], a[24:27], a[228:231], v[88:91]
v_mfma_f32_16x16x32_bf16 v[92:95], a[28:31], a[224:227], v[92:95]
v_rcp_f32 v194, v194
v_mfma_f32_16x16x32_bf16 v[96:99], a[28:31], a[228:231], v[96:99]
v_mfma_f32_16x16x32_bf16 v[100:103], a[32:35], a[224:227], v[100:103]
v_mfma_f32_16x16x32_bf16 v[104:107], a[32:35], a[228:231], v[104:107]
s_waitcnt vmcnt(20) lgkmcnt(0)
s_barrier
v_mfma_f32_16x16x32_bf16 v[36:39], a[36:39], a[232:235], v[36:39]
ds_read_b128 a[0:3], v200 offset:0
buffer_load_dwordx4 a[124:127], v9, s[4:7], s52 offen offset:3072 sc1
v_mfma_f32_16x16x32_bf16 v[40:43], a[36:39], a[236:239], v[40:43]
ds_read_b128 a[4:7], v200 offset:1024
v_mfma_f32_16x16x32_bf16 v[44:47], a[40:43], a[232:235], v[44:47]
ds_read_b128 a[8:11], v200 offset:2048
v_mfma_f32_16x16x32_bf16 v[48:51], a[40:43], a[236:239], v[48:51]
ds_read_b128 a[12:15], v200 offset:3072
v_mfma_f32_16x16x32_bf16 v[52:55], a[44:47], a[232:235], v[52:55]
ds_read_b128 a[16:19], v200 offset:4096
v_mfma_f32_16x16x32_bf16 v[56:59], a[44:47], a[236:239], v[56:59]
ds_read_b128 a[20:23], v200 offset:5120
v_mfma_f32_16x16x32_bf16 v[60:63], a[48:51], a[232:235], v[60:63]
ds_read_b128 a[24:27], v200 offset:6144
v_mfma_f32_16x16x32_bf16 v[64:67], a[48:51], a[236:239], v[64:67]
ds_read_b128 a[28:31], v200 offset:7168
v_mfma_f32_16x16x32_bf16 v[68:71], a[52:55], a[232:235], v[68:71]
ds_read_b128 a[32:35], v200 offset:8192
v_mfma_f32_16x16x32_bf16 v[72:75], a[52:55], a[236:239], v[72:75]
s_cmp_eq_u32 s25, 14
s_cselect_b32 s99, 36864, 0
s_add_u32 s60, s60, s99
v_mfma_f32_16x16x32_bf16 v[76:79], a[56:59], a[232:235], v[76:79]
s_add_u32 s61, s61, s99
s_add_u32 m0, s62, 126976
s_add_u32 s60, s60, 16384
v_mfma_f32_16x16x32_bf16 v[80:83], a[56:59], a[236:239], v[80:83]
buffer_load_dwordx4 v1, s[8:11], s60 offen offset:0 sc1 lds
v_mfma_f32_16x16x32_bf16 v[84:87], a[60:63], a[232:235], v[84:87]
v_rcp_f32 v195, v195
v_mfma_f32_16x16x32_bf16 v[88:91], a[60:63], a[236:239], v[88:91]
buffer_load_dwordx4 v1, s[8:11], s60 offen offset:1024 sc1 lds
v_mul_f32 v172, v172, v192
v_mfma_f32_16x16x32_bf16 v[92:95], a[64:67], a[232:235], v[92:95]
v_mul_f32 v173, v173, v193
v_mul_f32 v174, v174, v194
v_mfma_f32_16x16x32_bf16 v[96:99], a[64:67], a[236:239], v[96:99]
buffer_load_dwordx4 v1, s[8:11], s60 offen offset:2048 sc1 lds
v_mul_f32 v175, v175, v195
v_mfma_f32_16x16x32_bf16 v[100:103], a[68:71], a[232:235], v[100:103]
v_mul_f32 v196, v176, v176
v_mfma_f32_16x16x32_bf16 v[104:107], a[68:71], a[236:239], v[104:107]
v_mul_f32 v197, v177, v177
s_waitcnt lgkmcnt(0)
v_mfma_f32_16x16x32_bf16 v[36:39], a[0:3], a[240:243], v[36:39]
ds_read_b128 a[36:39], v200 offset:9216
buffer_load_dwordx4 v1, s[8:11], s60 offen offset:3072 sc1 lds
v_mfma_f32_16x16x32_bf16 v[40:43], a[0:3], a[244:247], v[40:43]
ds_read_b128 a[40:43], v200 offset:10240
v_mfma_f32_16x16x32_bf16 v[44:47], a[4:7], a[240:243], v[44:47]
ds_read_b128 a[44:47], v200 offset:11264
s_add_u32 m0, s63, 143360
v_mfma_f32_16x16x32_bf16 v[48:51], a[4:7], a[244:247], v[48:51]
ds_read_b128 a[48:51], v200 offset:12288
v_mul_f32 v198, v178, v178
v_mfma_f32_16x16x32_bf16 v[52:55], a[8:11], a[240:243], v[52:55]
ds_read_b128 a[52:55], v200 offset:13312
s_add_u32 s61, s61, 36864
v_mfma_f32_16x16x32_bf16 v[56:59], a[8:11], a[244:247], v[56:59]
ds_read_b128 a[56:59], v200 offset:14336
v_mul_f32 v199, v179, v179
v_mfma_f32_16x16x32_bf16 v[60:63], a[12:15], a[240:243], v[60:63]
ds_read_b128 a[60:63], v200 offset:15360
buffer_load_dwordx4 v1, s[8:11], s61 offen offset:0 sc1 lds
v_mfma_f32_16x16x32_bf16 v[64:67], a[12:15], a[244:247], v[64:67]
ds_read_b128 a[64:67], v200 offset:16384
v_fma_f32 v196, v196, v253, v251
v_mfma_f32_16x16x32_bf16 v[68:71], a[16:19], a[240:243], v[68:71]
ds_read_b128 a[68:71], v200 offset:17408
s_add_u32 m0, s62, 147456
v_mfma_f32_16x16x32_bf16 v[72:75], a[16:19], a[244:247], v[72:75]
s_add_u32 s60, s60, 20480
v_fma_f32 v197, v197, v253, v251
v_mfma_f32_16x16x32_bf16 v[76:79], a[20:23], a[240:243], v[76:79]
v_mfma_f32_16x16x32_bf16 v[80:83], a[20:23], a[244:247], v[80:83]
v_fma_f32 v198, v198, v253, v251
v_mfma_f32_16x16x32_bf16 v[84:87], a[24:27], a[240:243], v[84:87]
buffer_load_dwordx4 v1, s[8:11], s60 offen offset:0 sc1 lds
v_mfma_f32_16x16x32_bf16 v[88:91], a[24:27], a[244:247], v[88:91]
v_fma_f32 v199, v199, v253, v251
v_mfma_f32_16x16x32_bf16 v[92:95], a[28:31], a[240:243], v[92:95]
buffer_load_dwordx4 v1, s[8:11], s60 offen offset:1024 sc1 lds
v_mfma_f32_16x16x32_bf16 v[96:99], a[28:31], a[244:247], v[96:99]
v_mfma_f32_16x16x32_bf16 v[100:103], a[32:35], a[240:243], v[100:103]
v_mul_f32 v196, v196, v176
v_mfma_f32_16x16x32_bf16 v[104:107], a[32:35], a[244:247], v[104:107]
s_waitcnt vmcnt(24) lgkmcnt(0)
v_mfma_f32_16x16x32_bf16 v[36:39], a[36:39], a[248:251], v[36:39]
ds_read_b128 a[0:3], v200 offset:18432
buffer_load_dwordx4 v1, s[8:11], s60 offen offset:2048 sc1 lds
v_mfma_f32_16x16x32_bf16 v[40:43], a[36:39], a[252:255], v[40:43]
ds_read_b128 a[4:7], v200 offset:19456
v_mul_f32 v197, v197, v177
v_mfma_f32_16x16x32_bf16 v[44:47], a[40:43], a[248:251], v[44:47]
ds_read_b128 a[8:11], v200 offset:20480
buffer_load_dwordx4 v1, s[8:11], s60 offen offset:3072 sc1 lds
v_mfma_f32_16x16x32_bf16 v[48:51], a[40:43], a[252:255], v[48:51]
ds_read_b128 a[12:15], v200 offset:21504
v_mul_f32 v198, v198, v178
v_mfma_f32_16x16x32_bf16 v[52:55], a[44:47], a[248:251], v[52:55]
ds_read_b128 a[16:19], v200 offset:22528
v_mfma_f32_16x16x32_bf16 v[56:59], a[44:47], a[252:255], v[56:59]
ds_read_b128 a[20:23], v200 offset:23552
v_mul_f32 v199, v199, v179
v_mfma_f32_16x16x32_bf16 v[60:63], a[48:51], a[248:251], v[60:63]
ds_read_b128 a[24:27], v200 offset:24576
v_mfma_f32_16x16x32_bf16 v[64:67], a[48:51], a[252:255], v[64:67]
ds_read_b128 a[28:31], v200 offset:25600
v_mfma_f32_16x16x32_bf16 v[68:71], a[52:55], a[248:251], v[68:71]
ds_read_b128 a[32:35], v200 offset:26624
v_mfma_f32_16x16x32_bf16 v[72:75], a[52:55], a[252:255], v[72:75]
s_cmp_eq_u32 s25, 14
s_cselect_b32 s98, 4096, 0
s_add_u32 s52, s52, s98
v_mfma_f32_16x16x32_bf16 v[76:79], a[56:59], a[248:251], v[76:79]
s_add_u32 s52, s52, 4096
v_exp_f32 v196, v196
v_mfma_f32_16x16x32_bf16 v[80:83], a[56:59], a[252:255], v[80:83]
v_mfma_f32_16x16x32_bf16 v[84:87], a[60:63], a[248:251], v[84:87]
buffer_load_dwordx4 a[128:131], v1, s[4:7], s52 offen offset:0 sc1
v_mfma_f32_16x16x32_bf16 v[88:91], a[60:63], a[252:255], v[88:91]
v_exp_f32 v197, v197
v_mfma_f32_16x16x32_bf16 v[92:95], a[64:67], a[248:251], v[92:95]
buffer_load_dwordx4 a[132:135], v9, s[4:7], s52 offen offset:0 sc1
v_mfma_f32_16x16x32_bf16 v[96:99], a[64:67], a[252:255], v[96:99]
v_mfma_f32_16x16x32_bf16 v[100:103], a[68:71], a[248:251], v[100:103]
v_mfma_f32_16x16x32_bf16 v[104:107], a[68:71], a[252:255], v[104:107]
s_waitcnt lgkmcnt(0)
v_mfma_f32_16x16x32_bf16 v[36:39], a[0:3], a[80:83], v[36:39]
ds_read_b128 a[36:39], v200 offset:27648
buffer_load_dwordx4 a[136:139], v1, s[4:7], s52 offen offset:1024 sc1
v_mfma_f32_16x16x32_bf16 v[40:43], a[0:3], a[84:87], v[40:43]
ds_read_b128 a[40:43], v200 offset:28672
v_mfma_f32_16x16x32_bf16 v[44:47], a[4:7], a[80:83], v[44:47]
ds_read_b128 a[44:47], v200 offset:29696
v_mfma_f32_16x16x32_bf16 v[48:51], a[4:7], a[84:87], v[48:51]
ds_read_b128 a[48:51], v200 offset:30720
v_mfma_f32_16x16x32_bf16 v[52:55], a[8:11], a[80:83], v[52:55]
ds_read_b128 a[52:55], v200 offset:31744
buffer_load_dwordx4 a[140:143], v9, s[4:7], s52 offen offset:1024 sc1
v_mfma_f32_16x16x32_bf16 v[56:59], a[8:11], a[84:87], v[56:59]
ds_read_b128 a[56:59], v200 offset:32768
v_mfma_f32_16x16x32_bf16 v[60:63], a[12:15], a[80:83], v[60:63]
ds_read_b128 a[60:63], v200 offset:33792
v_mfma_f32_16x16x32_bf16 v[64:67], a[12:15], a[84:87], v[64:67]
ds_read_b128 a[64:67], v200 offset:34816
v_mfma_f32_16x16x32_bf16 v[68:71], a[16:19], a[80:83], v[68:71]
ds_read_b128 a[68:71], v200 offset:35840
buffer_load_dwordx4 a[144:147], v1, s[4:7], s52 offen offset:2048 sc1
v_mfma_f32_16x16x32_bf16 v[72:75], a[16:19], a[84:87], v[72:75]
v_exp_f32 v198, v198
v_mfma_f32_16x16x32_bf16 v[76:79], a[20:23], a[80:83], v[76:79]
v_exp_f32 v199, v199
v_mfma_f32_16x16x32_bf16 v[80:83], a[20:23], a[84:87], v[80:83]
v_fma_f32 v196, v196, v255, v255
v_fma_f32 v197, v197, v255, v255
v_mfma_f32_16x16x32_bf16 v[84:87], a[24:27], a[80:83], v[84:87]
buffer_load_dwordx4 a[148:151], v9, s[4:7], s52 offen offset:2048 sc1
v_mfma_f32_16x16x32_bf16 v[88:91], a[24:27], a[84:87], v[88:91]
v_fma_f32 v198, v198, v255, v255
v_mfma_f32_16x16x32_bf16 v[92:95], a[28:31], a[80:83], v[92:95]
v_mfma_f32_16x16x32_bf16 v[96:99], a[28:31], a[84:87], v[96:99]
v_fma_f32 v199, v199, v255, v255
v_mfma_f32_16x16x32_bf16 v[100:103], a[32:35], a[80:83], v[100:103]
v_mfma_f32_16x16x32_bf16 v[104:107], a[32:35], a[84:87], v[104:107]
s_waitcnt vmcnt(19) lgkmcnt(0)
s_barrier
v_mfma_f32_16x16x32_bf16 v[36:39], a[36:39], a[88:91], v[36:39]
ds_read_b128 a[0:3], v201 offset:0
buffer_load_dwordx4 a[152:155], v1, s[4:7], s52 offen offset:3072 sc1
v_mfma_f32_16x16x32_bf16 v[40:43], a[36:39], a[92:95], v[40:43]
ds_read_b128 a[4:7], v201 offset:1024
v_mfma_f32_16x16x32_bf16 v[44:47], a[40:43], a[88:91], v[44:47]
ds_read_b128 a[8:11], v201 offset:2048
buffer_load_dwordx4 a[156:159], v9, s[4:7], s52 offen offset:3072 sc1
v_mfma_f32_16x16x32_bf16 v[48:51], a[40:43], a[92:95], v[48:51]
ds_read_b128 a[12:15], v201 offset:3072
v_mfma_f32_16x16x32_bf16 v[52:55], a[44:47], a[88:91], v[52:55]
ds_read_b128 a[16:19], v201 offset:4096
s_mul_i32 s38, s24, 13312
v_mfma_f32_16x16x32_bf16 v[56:59], a[44:47], a[92:95], v[56:59]
ds_read_b128 a[20:23], v201 offset:5120
v_mfma_f32_16x16x32_bf16 v[60:63], a[48:51], a[88:91], v[60:63]
ds_read_b128 a[24:27], v201 offset:6144
v_mfma_f32_16x16x32_bf16 v[64:67], a[48:51], a[92:95], v[64:67]
ds_read_b128 a[28:31], v201 offset:7168
s_add_u32 m0, s38, 0
v_mfma_f32_16x16x32_bf16 v[68:71], a[52:55], a[88:91], v[68:71]
ds_read_b128 a[32:35], v201 offset:8192
v_mfma_f32_16x16x32_bf16 v[72:75], a[52:55], a[92:95], v[72:75]
s_add_u32 s39, s38, s83
v_rcp_f32 v196, v196
v_mfma_f32_16x16x32_bf16 v[76:79], a[56:59], a[88:91], v[76:79]
v_rcp_f32 v197, v197
v_mfma_f32_16x16x32_bf16 v[80:83], a[56:59], a[92:95], v[80:83]
v_rcp_f32 v198, v198
v_mfma_f32_16x16x32_bf16 v[84:87], a[60:63], a[88:91], v[84:87]
buffer_load_dwordx4 v1, s[4:7], s39 offen offset:0 sc1 lds
v_mfma_f32_16x16x32_bf16 v[88:91], a[60:63], a[92:95], v[88:91]
v_mfma_f32_16x16x32_bf16 v[92:95], a[64:67], a[88:91], v[92:95]
buffer_load_dwordx4 v1, s[4:7], s39 offen offset:1024 sc1 lds
v_mfma_f32_16x16x32_bf16 v[96:99], a[64:67], a[92:95], v[96:99]
v_rcp_f32 v199, v199
v_mfma_f32_16x16x32_bf16 v[100:103], a[68:71], a[88:91], v[100:103]
v_mfma_f32_16x16x32_bf16 v[104:107], a[68:71], a[92:95], v[104:107]
s_waitcnt lgkmcnt(0)
v_mfma_f32_16x16x32_bf16 v[36:39], a[0:3], a[96:99], v[36:39]
ds_read_b128 a[36:39], v201 offset:9216
buffer_load_dwordx4 v1, s[4:7], s39 offen offset:2048 sc1 lds
v_mfma_f32_16x16x32_bf16 v[40:43], a[0:3], a[100:103], v[40:43]
ds_read_b128 a[40:43], v201 offset:10240
v_mul_f32 v176, v176, v196
v_mfma_f32_16x16x32_bf16 v[44:47], a[4:7], a[96:99], v[44:47]
ds_read_b128 a[44:47], v201 offset:11264
buffer_load_dwordx4 v1, s[4:7], s39 offen offset:3072 sc1 lds
v_mfma_f32_16x16x32_bf16 v[48:51], a[4:7], a[100:103], v[48:51]
ds_read_b128 a[48:51], v201 offset:12288
v_mul_f32 v177, v177, v197
v_mfma_f32_16x16x32_bf16 v[52:55], a[8:11], a[96:99], v[52:55]
ds_read_b128 a[52:55], v201 offset:13312
v_mfma_f32_16x16x32_bf16 v[56:59], a[8:11], a[100:103], v[56:59]
ds_read_b128 a[56:59], v201 offset:14336
s_add_u32 m0, m0, 4096
v_mfma_f32_16x16x32_bf16 v[60:63], a[12:15], a[96:99], v[60:63]
ds_read_b128 a[60:63], v201 offset:15360
v_mul_f32 v178, v178, v198
v_mfma_f32_16x16x32_bf16 v[64:67], a[12:15], a[100:103], v[64:67]
ds_read_b128 a[64:67], v201 offset:16384
v_mul_f32 v179, v179, v199
v_mfma_f32_16x16x32_bf16 v[68:71], a[16:19], a[96:99], v[68:71]
ds_read_b128 a[68:71], v201 offset:17408
s_add_u32 s39, s39, 4096
v_mfma_f32_16x16x32_bf16 v[72:75], a[16:19], a[100:103], v[72:75]
s_lshl_b32 s30, s25, 3
v_mfma_f32_16x16x32_bf16 v[76:79], a[20:23], a[96:99], v[76:79]
s_lshl_b32 s31, s24, 1
v_mfma_f32_16x16x32_bf16 v[80:83], a[20:23], a[100:103], v[80:83]
buffer_load_dwordx4 v1, s[4:7], s39 offen offset:0 sc1 lds
v_mfma_f32_16x16x32_bf16 v[84:87], a[24:27], a[96:99], v[84:87]
s_add_u32 s30, s30, s31
v_mfma_f32_16x16x32_bf16 v[88:91], a[24:27], a[100:103], v[88:91]
s_mul_i32 s30, s30, 73728
v_mfma_f32_16x16x32_bf16 v[92:95], a[28:31], a[96:99], v[92:95]
buffer_load_dwordx4 v1, s[4:7], s39 offen offset:1024 sc1 lds
v_mfma_f32_16x16x32_bf16 v[96:99], a[28:31], a[100:103], v[96:99]
s_add_u32 s30, s30, 16777216
v_mfma_f32_16x16x32_bf16 v[100:103], a[32:35], a[96:99], v[100:103]
s_mul_i32 s31, s26, 4608
v_mfma_f32_16x16x32_bf16 v[104:107], a[32:35], a[100:103], v[104:107]
s_add_u32 s30, s30, s31
s_waitcnt vmcnt(23) lgkmcnt(0)
v_mfma_f32_16x16x32_bf16 v[36:39], a[36:39], a[104:107], v[36:39]
ds_read_b128 a[0:3], v201 offset:18432
buffer_load_dwordx4 v1, s[4:7], s39 offen offset:2048 sc1 lds
v_mfma_f32_16x16x32_bf16 v[40:43], a[36:39], a[108:111], v[40:43]
ds_read_b128 a[4:7], v201 offset:19456
v_mfma_f32_16x16x32_bf16 v[44:47], a[40:43], a[104:107], v[44:47]
ds_read_b128 a[8:11], v201 offset:20480
buffer_load_dwordx4 v1, s[4:7], s39 offen offset:3072 sc1 lds
v_mfma_f32_16x16x32_bf16 v[48:51], a[40:43], a[108:111], v[48:51]
ds_read_b128 a[12:15], v201 offset:21504
v_mfma_f32_16x16x32_bf16 v[52:55], a[44:47], a[104:107], v[52:55]
ds_read_b128 a[16:19], v201 offset:22528
v_mfma_f32_16x16x32_bf16 v[56:59], a[44:47], a[108:111], v[56:59]
ds_read_b128 a[20:23], v201 offset:23552
s_add_u32 m0, m0, 4096
v_mfma_f32_16x16x32_bf16 v[60:63], a[48:51], a[104:107], v[60:63]
ds_read_b128 a[24:27], v201 offset:24576
v_mfma_f32_16x16x32_bf16 v[64:67], a[48:51], a[108:111], v[64:67]
ds_read_b128 a[28:31], v201 offset:25600
v_mfma_f32_16x16x32_bf16 v[68:71], a[52:55], a[104:107], v[68:71]
ds_read_b128 a[32:35], v201 offset:26624
s_add_u32 s39, s39, 4096
v_mfma_f32_16x16x32_bf16 v[72:75], a[52:55], a[108:111], v[72:75]
s_and_b32 s65, s26, 1
v_mfma_f32_16x16x32_bf16 v[76:79], a[56:59], a[104:107], v[76:79]
s_lshl_b32 s64, s65, 9
v_mfma_f32_16x16x32_bf16 v[80:83], a[56:59], a[108:111], v[80:83]
buffer_load_dwordx4 v1, s[4:7], s39 offen offset:0 sc1 lds
v_mfma_f32_16x16x32_bf16 v[84:87], a[60:63], a[104:107], v[84:87]
s_add_u32 s64, s64, s30
v_mfma_f32_16x16x32_bf16 v[88:91], a[60:63], a[108:111], v[88:91]
s_xor_b32 s65, s65, 1
v_mfma_f32_16x16x32_bf16 v[92:95], a[64:67], a[104:107], v[92:95]
buffer_load_dwordx4 v1, s[4:7], s39 offen offset:1024 sc1 lds
v_mfma_f32_16x16x32_bf16 v[96:99], a[64:67], a[108:111], v[96:99]
s_lshl_b32 s65, s65, 12
v_mfma_f32_16x16x32_bf16 v[100:103], a[68:71], a[104:107], v[100:103]
s_add_u32 s65, s65, s30
v_mfma_f32_16x16x32_bf16 v[104:107], a[68:71], a[108:111], v[104:107]
s_waitcnt lgkmcnt(0)
v_mfma_f32_16x16x32_bf16 v[36:39], a[0:3], a[112:115], v[36:39]
ds_read_b128 a[36:39], v201 offset:27648
buffer_load_dwordx4 v1, s[4:7], s39 offen offset:2048 sc1 lds
v_mfma_f32_16x16x32_bf16 v[40:43], a[0:3], a[116:119], v[40:43]
ds_read_b128 a[40:43], v201 offset:28672
buffer_load_dwordx4 v1, s[4:7], s39 offen offset:3072 sc1 lds
v_mfma_f32_16x16x32_bf16 v[44:47], a[4:7], a[112:115], v[44:47]
ds_read_b128 a[44:47], v201 offset:29696
v_mfma_f32_16x16x32_bf16 v[48:51], a[4:7], a[116:119], v[48:51]
ds_read_b128 a[48:51], v201 offset:30720
s_add_u32 m0, m0, 4096
v_mfma_f32_16x16x32_bf16 v[52:55], a[8:11], a[112:115], v[52:55]
ds_read_b128 a[52:55], v201 offset:31744
v_add_u32 v204, 73728, v1
v_mfma_f32_16x16x32_bf16 v[56:59], a[8:11], a[116:119], v[56:59]
ds_read_b128 a[56:59], v201 offset:32768
s_add_u32 s39, s39, 4096
v_mfma_f32_16x16x32_bf16 v[60:63], a[12:15], a[112:115], v[60:63]
ds_read_b128 a[60:63], v201 offset:33792
buffer_load_dwordx4 v1, s[4:7], s39 offen offset:0 sc1 lds
v_mfma_f32_16x16x32_bf16 v[64:67], a[12:15], a[116:119], v[64:67]
ds_read_b128 a[64:67], v201 offset:34816
v_and_b32 v203, 1, v3
v_mfma_f32_16x16x32_bf16 v[68:71], a[16:19], a[112:115], v[68:71]
ds_read_b128 a[68:71], v201 offset:35840
s_mul_i32 s38, s24, 9216
v_mfma_f32_16x16x32_bf16 v[72:75], a[16:19], a[116:119], v[72:75]
s_add_u32 m0, s38, 53248
v_mul_u32_u24 v203, 73728, v203
v_mfma_f32_16x16x32_bf16 v[76:79], a[20:23], a[112:115], v[76:79]
s_add_u32 s39, s38, s83
v_mfma_f32_16x16x32_bf16 v[80:83], a[20:23], a[116:119], v[80:83]
s_add_u32 s39, s39, 53248
v_lshrrev_b32 v7, 1, v3
v_mfma_f32_16x16x32_bf16 v[84:87], a[24:27], a[112:115], v[84:87]
v_mfma_f32_16x16x32_bf16 v[88:91], a[24:27], a[116:119], v[88:91]
v_mfma_f32_16x16x32_bf16 v[92:95], a[28:31], a[112:115], v[92:95]
v_lshl_add_u32 v203, v7, 8, v203
v_mfma_f32_16x16x32_bf16 v[96:99], a[28:31], a[116:119], v[96:99]
buffer_load_dwordx4 v1, s[4:7], s39 offen offset:0 sc1 lds
v_mfma_f32_16x16x32_bf16 v[100:103], a[32:35], a[112:115], v[100:103]
v_lshl_add_u32 v203, v2, 4, v203
v_mfma_f32_16x16x32_bf16 v[104:107], a[32:35], a[116:119], v[104:107]
s_waitcnt vmcnt(14) lgkmcnt(0)
s_barrier
v_mfma_f32_16x16x32_bf16 v[36:39], a[36:39], a[120:123], v[36:39]
ds_read_b128 a[0:3], v202 offset:8192
buffer_load_dwordx4 v1, s[4:7], s39 offen offset:1024 sc1 lds
v_mfma_f32_16x16x32_bf16 v[40:43], a[36:39], a[124:127], v[40:43]
ds_read_b128 a[4:7], v202 offset:17408
v_mfma_f32_16x16x32_bf16 v[44:47], a[40:43], a[120:123], v[44:47]
ds_read_b128 a[8:11], v202 offset:26624
buffer_load_dwordx4 v1, s[4:7], s39 offen offset:2048 sc1 lds
v_mfma_f32_16x16x32_bf16 v[48:51], a[40:43], a[124:127], v[48:51]
ds_read_b128 a[12:15], v202 offset:35840
v_mfma_f32_16x16x32_bf16 v[52:55], a[44:47], a[120:123], v[52:55]
ds_read_b128 a[16:19], v202 offset:0
v_mfma_f32_16x16x32_bf16 v[56:59], a[44:47], a[124:127], v[56:59]
ds_read_b128 a[20:23], v202 offset:1024
buffer_load_dwordx4 v1, s[4:7], s39 offen offset:3072 sc1 lds
v_mfma_f32_16x16x32_bf16 v[60:63], a[48:51], a[120:123], v[60:63]
ds_read_b128 a[24:27], v202 offset:9216
v_mfma_f32_16x16x32_bf16 v[64:67], a[48:51], a[124:127], v[64:67]
ds_read_b128 a[28:31], v202 offset:10240
v_mfma_f32_16x16x32_bf16 v[68:71], a[52:55], a[120:123], v[68:71]
ds_read_b128 a[32:35], v202 offset:18432
s_add_u32 m0, m0, 4096
v_mfma_f32_16x16x32_bf16 v[72:75], a[52:55], a[124:127], v[72:75]
s_add_u32 s39, s39, 4096
v_mfma_f32_16x16x32_bf16 v[76:79], a[56:59], a[120:123], v[76:79]
v_mfma_f32_16x16x32_bf16 v[80:83], a[56:59], a[124:127], v[80:83]
v_mfma_f32_16x16x32_bf16 v[84:87], a[60:63], a[120:123], v[84:87]
v_mfma_f32_16x16x32_bf16 v[88:91], a[60:63], a[124:127], v[88:91]
v_mfma_f32_16x16x32_bf16 v[92:95], a[64:67], a[120:123], v[92:95]
buffer_load_dwordx4 v1, s[4:7], s39 offen offset:0 sc1 lds
v_mfma_f32_16x16x32_bf16 v[96:99], a[64:67], a[124:127], v[96:99]
v_mfma_f32_16x16x32_bf16 v[100:103], a[68:71], a[120:123], v[100:103]
v_mfma_f32_16x16x32_bf16 v[104:107], a[68:71], a[124:127], v[104:107]
s_waitcnt lgkmcnt(7)
v_mfma_f32_16x16x32_bf16 v[100:103], a[0:3], a[128:131], v[100:103]
ds_read_b128 a[36:39], v202 offset:19456
v_mfma_f32_16x16x32_bf16 v[104:107], a[0:3], a[132:135], v[104:107]
v_mfma_f32_16x16x32_bf16 v[100:103], a[4:7], a[136:139], v[100:103]
ds_read_b128 a[40:43], v202 offset:27648
v_mfma_f32_16x16x32_bf16 v[104:107], a[4:7], a[140:143], v[104:107]
s_waitcnt lgkmcnt(7)
v_mfma_f32_16x16x32_bf16 v[100:103], a[8:11], a[144:147], v[100:103]
ds_read_b128 a[44:47], v202 offset:28672
v_mfma_f32_16x16x32_bf16 v[104:107], a[8:11], a[148:151], v[104:107]
v_mfma_f32_16x16x32_bf16 v[100:103], a[12:15], a[152:155], v[100:103]
ds_read_b128 a[48:51], v202 offset:2048
v_mfma_f32_16x16x32_bf16 v[104:107], a[12:15], a[156:159], v[104:107]
s_waitcnt lgkmcnt(7)
v_mfma_f32_16x16x32_bf16 v[36:39], a[16:19], a[128:131], v[36:39]
ds_read_b128 a[52:55], v202 offset:3072
v_mfma_f32_16x16x32_bf16 v[40:43], a[16:19], a[132:135], v[40:43]
v_mfma_f32_16x16x32_bf16 v[44:47], a[20:23], a[128:131], v[44:47]
ds_read_b128 a[56:59], v202 offset:11264
v_mfma_f32_16x16x32_bf16 v[48:51], a[20:23], a[132:135], v[48:51]
v_mul_f32 v100, v100, v108
s_waitcnt lgkmcnt(7)
v_mfma_f32_16x16x32_bf16 v[36:39], a[24:27], a[136:139], v[36:39]
ds_read_b128 a[60:63], v202 offset:12288
v_mul_f32 v101, v101, v109
v_mfma_f32_16x16x32_bf16 v[40:43], a[24:27], a[140:143], v[40:43]
v_mul_f32 v102, v102, v110
v_mul_f32 v103, v103, v111
v_mfma_f32_16x16x32_bf16 v[44:47], a[28:31], a[136:139], v[44:47]
ds_read_b128 a[64:67], v202 offset:20480
v_cvt_pk_bf16_f32 v238, v100, v101
v_mfma_f32_16x16x32_bf16 v[48:51], a[28:31], a[140:143], v[48:51]
v_cvt_pk_bf16_f32 v239, v102, v103
s_waitcnt lgkmcnt(7)
v_mfma_f32_16x16x32_bf16 v[36:39], a[32:35], a[144:147], v[36:39]
ds_read_b128 a[68:71], v202 offset:21504
v_mul_f32 v104, v104, v112
v_mfma_f32_16x16x32_bf16 v[40:43], a[32:35], a[148:151], v[40:43]
v_mul_f32 v105, v105, v113
v_mfma_f32_16x16x32_bf16 v[44:47], a[36:39], a[144:147], v[44:47]
ds_read_b128 a[0:3], v202 offset:29696
v_mul_f32 v106, v106, v114
v_mfma_f32_16x16x32_bf16 v[48:51], a[36:39], a[148:151], v[48:51]
v_mul_f32 v107, v107, v115
s_waitcnt lgkmcnt(7)
v_mfma_f32_16x16x32_bf16 v[36:39], a[40:43], a[152:155], v[36:39]
ds_read_b128 a[4:7], v202 offset:30720
v_cvt_pk_bf16_f32 v240, v104, v105
v_mfma_f32_16x16x32_bf16 v[40:43], a[40:43], a[156:159], v[40:43]
v_cvt_pk_bf16_f32 v241, v106, v107
s_nop 0
v_mfma_f32_16x16x32_bf16 v[44:47], a[44:47], a[152:155], v[44:47]
ds_read_b128 a[8:11], v202 offset:4096
v_mfma_f32_16x16x32_bf16 v[48:51], a[44:47], a[156:159], v[48:51]
s_waitcnt lgkmcnt(7)
v_mfma_f32_16x16x32_bf16 v[52:55], a[48:51], a[128:131], v[52:55]
ds_read_b128 a[12:15], v202 offset:5120
v_permlane16_swap_b32 v238, v240
v_mfma_f32_16x16x32_bf16 v[56:59], a[48:51], a[132:135], v[56:59]
v_permlane16_swap_b32 v239, v241
v_mfma_f32_16x16x32_bf16 v[60:63], a[52:55], a[128:131], v[60:63]
ds_read_b128 a[16:19], v202 offset:13312
buffer_store_dwordx4 v[238:241], v203, s[8:11], s65 offen sc1
v_mfma_f32_16x16x32_bf16 v[64:67], a[52:55], a[132:135], v[64:67]
v_mul_f32 v36, v36, v116
s_waitcnt lgkmcnt(7)
v_mfma_f32_16x16x32_bf16 v[52:55], a[56:59], a[136:139], v[52:55]
ds_read_b128 a[20:23], v202 offset:14336
v_mul_f32 v37, v37, v117
v_mfma_f32_16x16x32_bf16 v[56:59], a[56:59], a[140:143], v[56:59]
v_mul_f32 v38, v38, v118
v_mul_f32 v39, v39, v119
v_mfma_f32_16x16x32_bf16 v[60:63], a[60:63], a[136:139], v[60:63]
ds_read_b128 a[24:27], v202 offset:22528
v_cvt_pk_bf16_f32 v206, v36, v37
v_mfma_f32_16x16x32_bf16 v[64:67], a[60:63], a[140:143], v[64:67]
v_cvt_pk_bf16_f32 v207, v38, v39
v_mul_f32 v44, v44, v124
s_waitcnt lgkmcnt(7)
v_mfma_f32_16x16x32_bf16 v[52:55], a[64:67], a[144:147], v[52:55]
ds_read_b128 a[28:31], v202 offset:23552
v_mul_f32 v45, v45, v125
v_mfma_f32_16x16x32_bf16 v[56:59], a[64:67], a[148:151], v[56:59]
v_mul_f32 v46, v46, v126
v_mul_f32 v47, v47, v127
v_mfma_f32_16x16x32_bf16 v[60:63], a[68:71], a[144:147], v[60:63]
ds_read_b128 a[32:35], v202 offset:31744
v_cvt_pk_bf16_f32 v208, v44, v45
v_mfma_f32_16x16x32_bf16 v[64:67], a[68:71], a[148:151], v[64:67]
v_cvt_pk_bf16_f32 v209, v46, v47
s_waitcnt lgkmcnt(7)
v_mfma_f32_16x16x32_bf16 v[52:55], a[0:3], a[152:155], v[52:55]
ds_read_b128 a[36:39], v202 offset:32768
buffer_store_dwordx4 v[206:209], v1, s[8:11], s64 offen offset:0 sc1
v_mul_f32 v40, v40, v120
v_mul_f32 v41, v41, v121
v_mfma_f32_16x16x32_bf16 v[56:59], a[0:3], a[156:159], v[56:59]
v_mul_f32 v42, v42, v122
v_mul_f32 v43, v43, v123
v_mfma_f32_16x16x32_bf16 v[60:63], a[4:7], a[152:155], v[60:63]
ds_read_b128 a[40:43], v202 offset:6144
v_cvt_pk_bf16_f32 v210, v40, v41
v_mfma_f32_16x16x32_bf16 v[64:67], a[4:7], a[156:159], v[64:67]
v_cvt_pk_bf16_f32 v211, v42, v43
v_mul_f32 v48, v48, v128
s_waitcnt lgkmcnt(7)
v_mfma_f32_16x16x32_bf16 v[68:71], a[8:11], a[128:131], v[68:71]
ds_read_b128 a[44:47], v202 offset:7168
v_mul_f32 v49, v49, v129
v_mfma_f32_16x16x32_bf16 v[72:75], a[8:11], a[132:135], v[72:75]
v_mul_f32 v50, v50, v130
v_mul_f32 v51, v51, v131
v_mfma_f32_16x16x32_bf16 v[76:79], a[12:15], a[128:131], v[76:79]
ds_read_b128 a[48:51], v202 offset:15360
v_cvt_pk_bf16_f32 v212, v48, v49
v_cvt_pk_bf16_f32 v213, v50, v51
buffer_store_dwordx4 v[210:213], v204, s[8:11], s64 offen offset:0 sc1
v_mfma_f32_16x16x32_bf16 v[80:83], a[12:15], a[132:135], v[80:83]
v_mul_f32 v52, v52, v132
s_waitcnt lgkmcnt(7)
v_mfma_f32_16x16x32_bf16 v[68:71], a[16:19], a[136:139], v[68:71]
ds_read_b128 a[52:55], v202 offset:16384
v_mul_f32 v53, v53, v133
v_mfma_f32_16x16x32_bf16 v[72:75], a[16:19], a[140:143], v[72:75]
v_mul_f32 v54, v54, v134
v_mul_f32 v55, v55, v135
v_mfma_f32_16x16x32_bf16 v[76:79], a[20:23], a[136:139], v[76:79]
ds_read_b128 a[56:59], v202 offset:24576
v_cvt_pk_bf16_f32 v214, v52, v53
v_mfma_f32_16x16x32_bf16 v[80:83], a[20:23], a[140:143], v[80:83]
v_cvt_pk_bf16_f32 v215, v54, v55
v_mul_f32 v60, v60, v140
s_waitcnt lgkmcnt(7)
v_mfma_f32_16x16x32_bf16 v[68:71], a[24:27], a[144:147], v[68:71]
ds_read_b128 a[60:63], v202 offset:25600
v_mul_f32 v61, v61, v141
v_mfma_f32_16x16x32_bf16 v[72:75], a[24:27], a[148:151], v[72:75]
v_mul_f32 v62, v62, v142
v_mul_f32 v63, v63, v143
v_mfma_f32_16x16x32_bf16 v[76:79], a[28:31], a[144:147], v[76:79]
ds_read_b128 a[64:67], v202 offset:33792
v_cvt_pk_bf16_f32 v216, v60, v61
v_mfma_f32_16x16x32_bf16 v[80:83], a[28:31], a[148:151], v[80:83]
v_cvt_pk_bf16_f32 v217, v62, v63
s_waitcnt lgkmcnt(7)
v_mfma_f32_16x16x32_bf16 v[68:71], a[32:35], a[152:155], v[68:71]
ds_read_b128 a[68:71], v202 offset:34816
buffer_store_dwordx4 v[214:217], v1, s[8:11], s64 offen offset:1024 sc1
v_mul_f32 v56, v56, v136
v_mul_f32 v57, v57, v137
v_mfma_f32_16x16x32_bf16 v[72:75], a[32:35], a[156:159], v[72:75]
v_mul_f32 v58, v58, v138
v_mul_f32 v59, v59, v139
v_mfma_f32_16x16x32_bf16 v[76:79], a[36:39], a[152:155], v[76:79]
v_cvt_pk_bf16_f32 v218, v56, v57
v_cvt_pk_bf16_f32 v219, v58, v59
v_mfma_f32_16x16x32_bf16 v[80:83], a[36:39], a[156:159], v[80:83]
v_mul_f32 v64, v64, v144
s_waitcnt lgkmcnt(6)
v_mfma_f32_16x16x32_bf16 v[84:87], a[40:43], a[128:131], v[84:87]
v_mul_f32 v65, v65, v145
v_mul_f32 v66, v66, v146
v_mfma_f32_16x16x32_bf16 v[88:91], a[40:43], a[132:135], v[88:91]
v_mul_f32 v67, v67, v147
v_cvt_pk_bf16_f32 v220, v64, v65
v_mfma_f32_16x16x32_bf16 v[92:95], a[44:47], a[128:131], v[92:95]
v_cvt_pk_bf16_f32 v221, v66, v67
buffer_store_dwordx4 v[218:221], v204, s[8:11], s64 offen offset:1024 sc1
v_mfma_f32_16x16x32_bf16 v[96:99], a[44:47], a[132:135], v[96:99]
v_mul_f32 v68, v68, v148
s_waitcnt lgkmcnt(4)
v_mfma_f32_16x16x32_bf16 v[84:87], a[48:51], a[136:139], v[84:87]
v_mul_f32 v69, v69, v149
v_mul_f32 v70, v70, v150
v_mfma_f32_16x16x32_bf16 v[88:91], a[48:51], a[140:143], v[88:91]
v_mul_f32 v71, v71, v151
v_cvt_pk_bf16_f32 v222, v68, v69
v_mfma_f32_16x16x32_bf16 v[92:95], a[52:55], a[136:139], v[92:95]
v_cvt_pk_bf16_f32 v223, v70, v71
v_mul_f32 v76, v76, v156
v_mfma_f32_16x16x32_bf16 v[96:99], a[52:55], a[140:143], v[96:99]
v_mul_f32 v77, v77, v157
s_waitcnt lgkmcnt(2)
v_mfma_f32_16x16x32_bf16 v[84:87], a[56:59], a[144:147], v[84:87]
v_mul_f32 v78, v78, v158
v_mul_f32 v79, v79, v159
v_mfma_f32_16x16x32_bf16 v[88:91], a[56:59], a[148:151], v[88:91]
v_cvt_pk_bf16_f32 v224, v76, v77
v_cvt_pk_bf16_f32 v225, v78, v79
v_mfma_f32_16x16x32_bf16 v[92:95], a[60:63], a[144:147], v[92:95]
buffer_store_dwordx4 v[222:225], v1, s[8:11], s64 offen offset:2048 sc1
v_mul_f32 v72, v72, v152
v_mfma_f32_16x16x32_bf16 v[96:99], a[60:63], a[148:151], v[96:99]
v_mul_f32 v73, v73, v153
v_mul_f32 v74, v74, v154
s_waitcnt lgkmcnt(0)
v_mfma_f32_16x16x32_bf16 v[84:87], a[64:67], a[152:155], v[84:87]
v_mul_f32 v75, v75, v155
v_cvt_pk_bf16_f32 v226, v72, v73
v_mfma_f32_16x16x32_bf16 v[88:91], a[64:67], a[156:159], v[88:91]
v_cvt_pk_bf16_f32 v227, v74, v75
v_mul_f32 v80, v80, v160
v_mfma_f32_16x16x32_bf16 v[92:95], a[68:71], a[152:155], v[92:95]
v_mul_f32 v81, v81, v161
v_mul_f32 v82, v82, v162
v_mfma_f32_16x16x32_bf16 v[96:99], a[68:71], a[156:159], v[96:99]
v_mul_f32 v83, v83, v163
v_cvt_pk_bf16_f32 v228, v80, v81
v_cvt_pk_bf16_f32 v229, v82, v83
buffer_store_dwordx4 v[226:229], v204, s[8:11], s64 offen offset:2048 sc1
s_nop 1
v_pk_mul_f32 v[84:85], v[84:85], v[164:165]
v_pk_mul_f32 v[86:87], v[86:87], v[166:167]
v_cvt_pk_bf16_f32 v230, v84, v85
v_cvt_pk_bf16_f32 v231, v86, v87
v_pk_mul_f32 v[92:93], v[92:93], v[172:173]
v_pk_mul_f32 v[94:95], v[94:95], v[174:175]
v_cvt_pk_bf16_f32 v232, v92, v93
v_cvt_pk_bf16_f32 v233, v94, v95
buffer_store_dwordx4 v[230:233], v1, s[8:11], s64 offen offset:3072 sc1
v_pk_mul_f32 v[88:89], v[88:89], v[168:169]
v_pk_mul_f32 v[90:91], v[90:91], v[170:171]
v_cvt_pk_bf16_f32 v234, v88, v89
v_cvt_pk_bf16_f32 v235, v90, v91
v_pk_mul_f32 v[96:97], v[96:97], v[176:177]
v_pk_mul_f32 v[98:99], v[98:99], v[178:179]
v_cvt_pk_bf16_f32 v236, v96, v97
v_cvt_pk_bf16_f32 v237, v98, v99
buffer_store_dwordx4 v[234:237], v204, s[8:11], s64 offen offset:3072 sc1
L_c5:
s_barrier
buffer_load_dwordx4 v1, s[4:7], s39 offen offset:1024 sc1 lds
buffer_load_dwordx4 v1, s[4:7], s39 offen offset:2048 sc1 lds
buffer_load_dwordx4 v1, s[4:7], s39 offen offset:3072 sc1 lds
s_add_u32 m0, m0, 4096
s_add_u32 s39, s39, 4096
buffer_load_dwordx4 v1, s[4:7], s39 offen offset:0 sc1 lds
s_mul_i32 s38, s24, 9216
s_add_u32 m0, s38, 90112
s_add_u32 s39, s38, s83
s_add_u32 s39, s39, 90112
buffer_load_dwordx4 v1, s[4:7], s39 offen offset:0 sc1 lds
buffer_load_dwordx4 v1, s[4:7], s39 offen offset:1024 sc1 lds
buffer_load_dwordx4 v1, s[4:7], s39 offen offset:2048 sc1 lds
v_lshlrev_b32 v7, 3, v1
s_lshl_b32 s31, s27, 10
v_add_u32 v7, s31, v7
s_cmp_eq_u32 s24, 0
s_cselect_b32 s30, 0, 1073741824
s_add_u32 s30, s30, 26574848
s_waitcnt vmcnt(7)
s_barrier
s_mov_b64 exec, 0xff
buffer_atomic_add v4, v7, s[8:11], s30 offen sc1
s_mov_b64 exec, -1
s_lshl_b32 s35, s80, 7
s_add_u32 s35, s35, 26574848
s_cmp_eq_u32 s24, 1
s_cselect_b32 s35, s35, 1073741824
v_mov_b32 v6, 0
v_mov_b32 v244, 0
v_mov_b32 v245, 0
v_mov_b32 v246, 0
buffer_load_dwordx4 v1, s[4:7], s39 offen offset:3072 sc1 lds
s_add_u32 m0, m0, 4096
s_add_u32 s39, s39, 4096
buffer_load_dwordx4 v1, s[4:7], s39 offen offset:0 sc1 lds
buffer_load_dwordx4 v1, s[4:7], s39 offen offset:1024 sc1 lds
buffer_load_dwordx4 v1, s[4:7], s39 offen offset:2048 sc1 lds
s_xor_b32 s30, s70, 1
s_mul_i32 s60, s30, 73728
s_and_b32 s32, s27, 1
s_mul_i32 s32, s32, 36864
s_add_u32 s32, s32, 16777216
s_add_u32 s60, s60, s32
s_mul_i32 s61, s70, 73728
s_add_u32 s61, s61, s32
v_and_b32 v40, 7, v2
v_lshlrev_b32 v40, 4, v40
v_lshl_add_u32 v40, v3, 7, v40
v_add_u32 v40, 4096, v40
s_mov_b64 exec, 1
buffer_atomic_add v244, v6, s[8:11], s35 offen sc0 sc1
s_mov_b64 exec, -1
buffer_load_dwordx4 v1, s[4:7], s39 offen offset:3072 sc1 lds
s_add_u32 m0, m0, 4096
s_add_u32 s39, s39, 4096
buffer_load_dwordx4 v1, s[4:7], s39 offen offset:0 sc1 lds
s_mul_i32 s38, s24, 9216
s_add_u32 m0, s38, 126976
s_add_u32 s39, s38, s83
s_add_u32 s39, s39, 126976
buffer_load_dwordx4 v1, s[4:7], s39 offen offset:0 sc1 lds
buffer_load_dwordx4 v1, s[4:7], s39 offen offset:1024 sc1 lds
s_lshl_b32 s63, s80, 14
s_lshl_b32 s30, s24, 12
s_add_u32 s63, s63, s30
s_xor_b32 s62, s63, 131072
s_add_u32 s63, s63, 26640384
s_add_u32 s62, s62, 26640384
s_add_u32 s64, s83, 161280
v_mov_b32 v116, v40
v_add_u32 v36, 0, v1
v_add_u32 v37, 55296, v1
v_add_u32 v41, 55296, v40
v_add_u32 v38, 110592, v1
s_mov_b64 exec, 1
buffer_atomic_add v245, v6, s[8:11], s35 offen sc0 sc1
s_mov_b64 exec, -1
buffer_load_dwordx4 v1, s[4:7], s39 offen offset:2048 sc1 lds
buffer_load_dwordx4 v1, s[4:7], s39 offen offset:3072 sc1 lds
s_add_u32 m0, m0, 4096
s_add_u32 s39, s39, 4096
buffer_load_dwordx4 v1, s[4:7], s39 offen offset:0 sc1 lds
buffer_load_dwordx4 v1, s[4:7], s39 offen offset:1024 sc1 lds
v_add_u32 v42, 110592, v40
s_bitcmp1_b32 s27, 0
s_cbranch_scc1 L_kh_31
v_swap_b32 v206, v210
v_swap_b32 v207, v211
v_swap_b32 v208, v212
v_swap_b32 v209, v213
v_swap_b32 v214, v218
v_swap_b32 v215, v219
v_swap_b32 v216, v220
v_swap_b32 v217, v221
v_swap_b32 v222, v226
v_swap_b32 v223, v227
v_swap_b32 v224, v228
v_swap_b32 v225, v229
v_swap_b32 v230, v234
v_swap_b32 v231, v235
v_swap_b32 v232, v236
v_swap_b32 v233, v237
L_kh_31:
v_mov_b32 v138, 1073741824
s_mul_i32 s66, s70, 18432
s_mul_i32 s32, s28, 2304
s_add_u32 s66, s66, s32
s_add_u32 s66, s66, 30834688
v_mov_b32 v140, v1
v_add_u32 v141, 2048, v140
v_cndmask_b32 v141, v138, v141, s[46:47]
s_lshl_b32 s67, s70, 7
s_lshl_b32 s32, s28, 14
s_mov_b64 exec, 1
buffer_atomic_add v246, v6, s[8:11], s35 offen sc0 sc1
s_mov_b64 exec, -1
buffer_load_dwordx4 v1, s[4:7], s39 offen offset:2048 sc1 lds
buffer_load_dwordx4 v1, s[4:7], s39 offen offset:3072 sc1 lds
s_add_u32 m0, m0, 4096
s_add_u32 s39, s39, 4096
buffer_load_dwordx4 v1, s[4:7], s39 offen offset:0 sc1 lds
s_add_u32 s67, s67, s32
s_add_u32 s67, s67, 33193984
v_lshlrev_b32 v139, 3, v2
v_cndmask_b32 v138, v138, v139, s[46:47]
v_mov_b32 v162, 1073741824
s_mul_i32 s68, s70, 18432
s_mul_i32 s32, s28, 144
s_add_u32 s68, s68, s32
v_mul_u32_u24 v164, 1152, v2
v_lshl_add_u32 v164, v3, 4, v164
v_add_u32 v165, 128, v164
v_cndmask_b32 v165, v162, v165, s[46:47]
ds_read_b128 a[160:163], v36 offset:0
ds_read_b128 a[164:167], v36 offset:1024
ds_read_b128 a[168:171], v36 offset:2048
ds_read_b128 a[172:175], v36 offset:3072
ds_read_b128 a[176:179], v40 offset:0
ds_read_b128 a[180:183], v36 offset:4608
ds_read_b128 a[184:187], v36 offset:5632
ds_read_b128 a[188:191], v36 offset:6656
ds_read_b128 a[192:195], v36 offset:7680
ds_read_b128 a[196:199], v40 offset:4608
s_cmp_eq_u32 s71, 0
s_cselect_b32 s98, 4096, 0
s_add_u32 s60, s60, s98
s_cmp_eq_u32 s24, 1
s_cbranch_scc0 L_other_34
s_mov_b32 s31, 0
s_mov_b64 exec, 1
v_mov_b32 v247, 0
buffer_atomic_add v247, v6, s[8:11], s35 offen sc0 sc1
s_waitcnt vmcnt(14)
v_cmp_gt_u32 vcc, 8, v244
s_nop 0
s_cbranch_vccz L_polled_33
s_waitcnt vmcnt(9)
v_cmp_gt_u32 vcc, 8, v245
s_nop 0
s_cbranch_vccz L_polled_33
v_mov_b32 v244, 0
buffer_atomic_add v244, v6, s[8:11], s35 offen sc0 sc1
s_waitcnt vmcnt(5)
v_cmp_gt_u32 vcc, 8, v246
s_nop 0
s_cbranch_vccz L_polled_33
v_mov_b32 v245, 0
buffer_atomic_add v245, v6, s[8:11], s35 offen sc0 sc1
L_poll_32:
s_add_u32 s31, s31, 1
s_cmp_gt_u32 s31, 100000
s_cbranch_scc1 L_polled_33
v_mov_b32 v246, 0
buffer_atomic_add v246, v6, s[8:11], s35 offen sc0 sc1
s_waitcnt vmcnt(3)
v_cmp_gt_u32 vcc, 8, v247
s_nop 0
s_cbranch_vccz L_polled_33
v_mov_b32 v247, 0
buffer_atomic_add v247, v6, s[8:11], s35 offen sc0 sc1
s_waitcnt vmcnt(3)
v_cmp_gt_u32 vcc, 8, v244
s_nop 0
s_cbranch_vccz L_polled_33
v_mov_b32 v244, 0
buffer_atomic_add v244, v6, s[8:11], s35 offen sc0 sc1
s_waitcnt vmcnt(3)
v_cmp_gt_u32 vcc, 8, v245
s_nop 0
s_cbranch_vccz L_polled_33
v_mov_b32 v245, 0
buffer_atomic_add v245, v6, s[8:11], s35 offen sc0 sc1
s_waitcnt vmcnt(3)
v_cmp_gt_u32 vcc, 8, v246
s_nop 0
s_cbranch_vccz L_polled_33
s_branch L_poll_32
L_polled_33:
s_mov_b64 exec, -1
L_other_34:
s_barrier
buffer_load_dwordx4 a[0:3], v1, s[8:11], s60 offen offset:0 sc1
buffer_load_dwordx4 a[4:7], v1, s[8:11], s60 offen offset:1024 sc1
s_waitcnt lgkmcnt(5)
v_mfma_f32_16x16x32_bf16 v[44:47], a[160:163], v[206:209], 0
ds_read_b128 a[200:203], v36 offset:9216
buffer_load_dwordx4 a[8:11], v1, s[8:11], s60 offen offset:2048 sc1
v_mfma_f32_16x16x32_bf16 v[16:19], a[160:163], v[210:213], v[16:19]
v_mfma_f32_16x16x32_bf16 v[48:51], a[164:167], v[206:209], 0
ds_read_b128 a[204:207], v36 offset:10240
buffer_load_dwordx4 a[12:15], v1, s[8:11], s60 offen offset:3072 sc1
v_mfma_f32_16x16x32_bf16 v[20:23], a[164:167], v[210:213], v[20:23]
s_add_u32 s60, s60, 4096
v_mfma_f32_16x16x32_bf16 v[52:55], a[168:171], v[206:209], 0
ds_read_b128 a[208:211], v36 offset:11264
v_mfma_f32_16x16x32_bf16 v[24:27], a[168:171], v[210:213], v[24:27]
v_mfma_f32_16x16x32_bf16 v[56:59], a[172:175], v[206:209], 0
ds_read_b128 a[212:215], v36 offset:12288
buffer_load_dwordx4 a[16:19], v1, s[8:11], s60 offen offset:0 sc1
v_mfma_f32_16x16x32_bf16 v[28:31], a[172:175], v[210:213], v[28:31]
s_cmp_eq_u32 s71, 5
s_cselect_b32 s98, 4096, 0
v_mfma_f32_16x16x32_bf16 v[60:63], a[176:179], v[206:209], 0
ds_read_b128 a[216:219], v40 offset:9216
v_mfma_f32_16x16x32_bf16 v[32:35], a[176:179], v[210:213], v[32:35]
s_add_u32 s60, s60, s98
s_waitcnt lgkmcnt(5)
v_mfma_f32_16x16x32_bf16 v[44:47], a[180:183], v[214:217], v[44:47]
ds_read_b128 a[160:163], v36 offset:13824
v_mov_b32 v67, v248
v_mfma_f32_16x16x32_bf16 v[16:19], a[180:183], v[218:221], v[16:19]
v_mfma_f32_16x16x32_bf16 v[48:51], a[184:187], v[214:217], v[48:51]
ds_read_b128 a[164:167], v36 offset:14848
v_mfma_f32_16x16x32_bf16 v[20:23], a[184:187], v[218:221], v[20:23]
v_mfma_f32_16x16x32_bf16 v[52:55], a[188:191], v[214:217], v[52:55]
ds_read_b128 a[168:171], v36 offset:15872
v_mfma_f32_16x16x32_bf16 v[24:27], a[188:191], v[218:221], v[24:27]
buffer_load_dwordx4 a[20:23], v1, s[8:11], s60 offen offset:1024 sc1
v_mfma_f32_16x16x32_bf16 v[56:59], a[192:195], v[214:217], v[56:59]
ds_read_b128 a[172:175], v36 offset:16896
v_mfma_f32_16x16x32_bf16 v[28:31], a[192:195], v[218:221], v[28:31]
buffer_load_dwordx4 a[24:27], v1, s[8:11], s60 offen offset:2048 sc1
v_mov_b32 v71, v248
v_mfma_f32_16x16x32_bf16 v[60:63], a[196:199], v[214:217], v[60:63]
ds_read_b128 a[176:179], v40 offset:13824
v_mfma_f32_16x16x32_bf16 v[32:35], a[196:199], v[218:221], v[32:35]
buffer_load_dwordx4 a[28:31], v1, s[8:11], s60 offen offset:3072 sc1
s_waitcnt lgkmcnt(5)
v_mfma_f32_16x16x32_bf16 v[44:47], a[200:203], v[222:225], v[44:47]
ds_read_b128 a[180:183], v36 offset:18432
v_mfma_f32_16x16x32_bf16 v[16:19], a[200:203], v[226:229], v[16:19]
s_add_u32 s60, s60, 4096
v_mfma_f32_16x16x32_bf16 v[48:51], a[204:207], v[222:225], v[48:51]
ds_read_b128 a[184:187], v36 offset:19456
v_mfma_f32_16x16x32_bf16 v[20:23], a[204:207], v[226:229], v[20:23]
v_mfma_f32_16x16x32_bf16 v[52:55], a[208:211], v[222:225], v[52:55]
ds_read_b128 a[188:191], v36 offset:20480
buffer_load_dwordx4 a[32:35], v1, s[8:11], s60 offen offset:0 sc1
v_mfma_f32_16x16x32_bf16 v[24:27], a[208:211], v[226:229], v[24:27]
s_cmp_eq_u32 s71, 9
s_cselect_b32 s98, 4096, 0
v_mov_b32 v75, v248
v_mfma_f32_16x16x32_bf16 v[56:59], a[212:215], v[222:225], v[56:59]
ds_read_b128 a[192:195], v36 offset:21504
v_mfma_f32_16x16x32_bf16 v[28:31], a[212:215], v[226:229], v[28:31]
s_add_u32 s60, s60, s98
v_mfma_f32_16x16x32_bf16 v[60:63], a[216:219], v[222:225], v[60:63]
ds_read_b128 a[196:199], v40 offset:18432
v_mfma_f32_16x16x32_bf16 v[32:35], a[216:219], v[226:229], v[32:35]
s_waitcnt lgkmcnt(5)
v_mfma_f32_16x16x32_bf16 v[44:47], a[160:163], v[230:233], v[44:47]
ds_read_b128 a[200:203], v36 offset:23040
v_mfma_f32_16x16x32_bf16 v[16:19], a[160:163], v[234:237], v[16:19]
v_mfma_f32_16x16x32_bf16 v[48:51], a[164:167], v[230:233], v[48:51]
ds_read_b128 a[204:207], v36 offset:24064
buffer_load_dwordx4 a[36:39], v1, s[8:11], s60 offen offset:1024 sc1
v_mfma_f32_16x16x32_bf16 v[20:23], a[164:167], v[234:237], v[20:23]
v_mov_b32 v79, v248
v_mfma_f32_16x16x32_bf16 v[52:55], a[168:171], v[230:233], v[52:55]
ds_read_b128 a[208:211], v36 offset:25088
v_mfma_f32_16x16x32_bf16 v[24:27], a[168:171], v[234:237], v[24:27]
v_mfma_f32_16x16x32_bf16 v[56:59], a[172:175], v[230:233], v[56:59]
ds_read_b128 a[212:215], v36 offset:26112
v_mfma_f32_16x16x32_bf16 v[28:31], a[172:175], v[234:237], v[28:31]
v_mfma_f32_16x16x32_bf16 v[60:63], a[176:179], v[230:233], v[60:63]
ds_read_b128 a[216:219], v40 offset:23040
v_mfma_f32_16x16x32_bf16 v[32:35], a[176:179], v[234:237], v[32:35]
s_waitcnt vmcnt(9) lgkmcnt(5)
v_mfma_f32_16x16x32_bf16 v[44:47], a[180:183], a[0:3], v[44:47]
ds_read_b128 a[160:163], v36 offset:27648
buffer_load_dwordx4 a[40:43], v1, s[8:11], s60 offen offset:2048 sc1
v_mfma_f32_16x16x32_bf16 v[48:51], a[184:187], a[0:3], v[48:51]
ds_read_b128 a[164:167], v36 offset:28672
v_mfma_f32_16x16x32_bf16 v[52:55], a[188:191], a[0:3], v[52:55]
ds_read_b128 a[168:171], v36 offset:29696
v_mfma_f32_16x16x32_bf16 v[56:59], a[192:195], a[0:3], v[56:59]
ds_read_b128 a[172:175], v36 offset:30720
v_mfma_f32_16x16x32_bf16 v[60:63], a[196:199], a[0:3], v[60:63]
ds_read_b128 a[176:179], v40 offset:27648
s_waitcnt vmcnt(9) lgkmcnt(5)
v_mfma_f32_16x16x32_bf16 v[44:47], a[200:203], a[4:7], v[44:47]
ds_read_b128 a[180:183], v36 offset:32256
buffer_load_dwordx4 a[44:47], v1, s[8:11], s60 offen offset:3072 sc1
v_mfma_f32_16x16x32_bf16 v[48:51], a[204:207], a[4:7], v[48:51]
ds_read_b128 a[184:187], v36 offset:33280
v_mfma_f32_16x16x32_bf16 v[52:55], a[208:211], a[4:7], v[52:55]
ds_read_b128 a[188:191], v36 offset:34304
v_mfma_f32_16x16x32_bf16 v[56:59], a[212:215], a[4:7], v[56:59]
ds_read_b128 a[192:195], v36 offset:35328
v_mfma_f32_16x16x32_bf16 v[60:63], a[216:219], a[4:7], v[60:63]
ds_read_b128 a[196:199], v40 offset:32256
s_waitcnt vmcnt(9) lgkmcnt(5)
v_mfma_f32_16x16x32_bf16 v[44:47], a[160:163], a[8:11], v[44:47]
ds_read_b128 a[200:203], v36 offset:36864
s_add_u32 s60, s60, 4096
v_mfma_f32_16x16x32_bf16 v[48:51], a[164:167], a[8:11], v[48:51]
ds_read_b128 a[204:207], v36 offset:37888
buffer_load_dwordx4 a[48:51], v1, s[8:11], s60 offen offset:0 sc1
v_mfma_f32_16x16x32_bf16 v[52:55], a[168:171], a[8:11], v[52:55]
ds_read_b128 a[208:211], v36 offset:38912
buffer_load_dwordx4 a[52:55], v1, s[8:11], s60 offen offset:1024 sc1
v_mfma_f32_16x16x32_bf16 v[56:59], a[172:175], a[8:11], v[56:59]
ds_read_b128 a[212:215], v36 offset:39936
v_mfma_f32_16x16x32_bf16 v[60:63], a[176:179], a[8:11], v[60:63]
ds_read_b128 a[216:219], v40 offset:36864
s_waitcnt vmcnt(10) lgkmcnt(5)
v_mfma_f32_16x16x32_bf16 v[44:47], a[180:183], a[12:15], v[44:47]
ds_read_b128 a[160:163], v36 offset:41472
v_mfma_f32_16x16x32_bf16 v[48:51], a[184:187], a[12:15], v[48:51]
ds_read_b128 a[164:167], v36 offset:42496
v_mfma_f32_16x16x32_bf16 v[52:55], a[188:191], a[12:15], v[52:55]
ds_read_b128 a[168:171], v36 offset:43520
v_mfma_f32_16x16x32_bf16 v[56:59], a[192:195], a[12:15], v[56:59]
ds_read_b128 a[172:175], v36 offset:44544
s_cmp_eq_u32 s71, 14
s_cselect_b32 s98, 4096, 0
s_add_u32 s60, s60, s98
buffer_load_dwordx4 a[56:59], v1, s[8:11], s60 offen offset:2048 sc1
v_mfma_f32_16x16x32_bf16 v[60:63], a[196:199], a[12:15], v[60:63]
ds_read_b128 a[176:179], v40 offset:41472
s_waitcnt vmcnt(10) lgkmcnt(5)
v_mfma_f32_16x16x32_bf16 v[44:47], a[200:203], a[16:19], v[44:47]
ds_read_b128 a[180:183], v36 offset:46080
buffer_load_dwordx4 a[60:63], v1, s[8:11], s60 offen offset:3072 sc1
v_mfma_f32_16x16x32_bf16 v[48:51], a[204:207], a[16:19], v[48:51]
ds_read_b128 a[184:187], v36 offset:47104
v_mfma_f32_16x16x32_bf16 v[52:55], a[208:211], a[16:19], v[52:55]
ds_read_b128 a[188:191], v36 offset:48128
v_mfma_f32_16x16x32_bf16 v[56:59], a[212:215], a[16:19], v[56:59]
ds_read_b128 a[192:195], v36 offset:49152
v_mfma_f32_16x16x32_bf16 v[60:63], a[216:219], a[16:19], v[60:63]
ds_read_b128 a[196:199], v40 offset:46080
s_barrier
s_waitcnt vmcnt(10) lgkmcnt(5)
v_mfma_f32_16x16x32_bf16 v[44:47], a[160:163], a[20:23], v[44:47]
ds_read_b128 a[200:203], v36 offset:50688
s_add_u32 s60, s60, 4096
v_mfma_f32_16x16x32_bf16 v[48:51], a[164:167], a[20:23], v[48:51]
ds_read_b128 a[204:207], v36 offset:51712
buffer_load_dwordx4 a[64:67], v1, s[8:11], s60 offen offset:0 sc1
v_mfma_f32_16x16x32_bf16 v[52:55], a[168:171], a[20:23], v[52:55]
ds_read_b128 a[208:211], v36 offset:52736
buffer_load_dwordx4 a[0:3], v1, s[8:11], s60 offen offset:1024 sc1
v_mfma_f32_16x16x32_bf16 v[56:59], a[172:175], a[20:23], v[56:59]
ds_read_b128 a[212:215], v36 offset:53760
v_mfma_f32_16x16x32_bf16 v[60:63], a[176:179], a[20:23], v[60:63]
ds_read_b128 a[216:219], v40 offset:50688
s_waitcnt vmcnt(11) lgkmcnt(5)
v_mfma_f32_16x16x32_bf16 v[44:47], a[180:183], a[24:27], v[44:47]
ds_read_b128 a[160:163], v37 offset:0
v_mfma_f32_16x16x32_bf16 v[48:51], a[184:187], a[24:27], v[48:51]
ds_read_b128 a[164:167], v37 offset:1024
v_mfma_f32_16x16x32_bf16 v[52:55], a[188:191], a[24:27], v[52:55]
ds_read_b128 a[168:171], v37 offset:2048
v_mfma_f32_16x16x32_bf16 v[56:59], a[192:195], a[24:27], v[56:59]
ds_read_b128 a[172:175], v37 offset:3072
s_cmp_eq_u32 s71, 18
s_cselect_b32 s98, 4096, 0
s_add_u32 s60, s60, s98
buffer_load_dwordx4 a[4:7], v1, s[8:11], s60 offen offset:2048 sc1
v_mfma_f32_16x16x32_bf16 v[60:63], a[196:199], a[24:27], v[60:63]
ds_read_b128 a[176:179], v41 offset:0
s_waitcnt vmcnt(11) lgkmcnt(5)
v_mfma_f32_16x16x32_bf16 v[44:47], a[200:203], a[28:31], v[44:47]
ds_read_b128 a[180:183], v37 offset:4608
buffer_load_dwordx4 a[8:11], v1, s[8:11], s60 offen offset:3072 sc1
v_mfma_f32_16x16x32_bf16 v[48:51], a[204:207], a[28:31], v[48:51]
ds_read_b128 a[184:187], v37 offset:5632
v_mfma_f32_16x16x32_bf16 v[52:55], a[208:211], a[28:31], v[52:55]
ds_read_b128 a[188:191], v37 offset:6656
v_mfma_f32_16x16x32_bf16 v[56:59], a[212:215], a[28:31], v[56:59]
ds_read_b128 a[192:195], v37 offset:7680
v_mfma_f32_16x16x32_bf16 v[60:63], a[216:219], a[28:31], v[60:63]
ds_read_b128 a[196:199], v41 offset:4608
s_waitcnt vmcnt(11) lgkmcnt(5)
v_mfma_f32_16x16x32_bf16 v[44:47], a[160:163], a[32:35], v[44:47]
ds_read_b128 a[200:203], v37 offset:9216
s_add_u32 s60, s60, 4096
v_mfma_f32_16x16x32_bf16 v[48:51], a[164:167], a[32:35], v[48:51]
ds_read_b128 a[204:207], v37 offset:10240
buffer_load_dwordx4 a[12:15], v1, s[8:11], s60 offen offset:0 sc1
v_mfma_f32_16x16x32_bf16 v[52:55], a[168:171], a[32:35], v[52:55]
ds_read_b128 a[208:211], v37 offset:11264
buffer_load_dwordx4 a[16:19], v1, s[8:11], s60 offen offset:1024 sc1
v_mfma_f32_16x16x32_bf16 v[56:59], a[172:175], a[32:35], v[56:59]
ds_read_b128 a[212:215], v37 offset:12288
v_mfma_f32_16x16x32_bf16 v[60:63], a[176:179], a[32:35], v[60:63]
ds_read_b128 a[216:219], v41 offset:9216
s_waitcnt vmcnt(12) lgkmcnt(5)
v_mfma_f32_16x16x32_bf16 v[44:47], a[180:183], a[36:39], v[44:47]
ds_read_b128 a[160:163], v37 offset:13824
buffer_load_dwordx4 a[20:23], v1, s[8:11], s60 offen offset:2048 sc1
v_mfma_f32_16x16x32_bf16 v[48:51], a[184:187], a[36:39], v[48:51]
ds_read_b128 a[164:167], v37 offset:14848
v_mfma_f32_16x16x32_bf16 v[52:55], a[188:191], a[36:39], v[52:55]
ds_read_b128 a[168:171], v37 offset:15872
v_mfma_f32_16x16x32_bf16 v[56:59], a[192:195], a[36:39], v[56:59]
ds_read_b128 a[172:175], v37 offset:16896
v_mfma_f32_16x16x32_bf16 v[60:63], a[196:199], a[36:39], v[60:63]
ds_read_b128 a[176:179], v41 offset:13824
s_waitcnt vmcnt(12) lgkmcnt(5)
v_mfma_f32_16x16x32_bf16 v[44:47], a[200:203], a[40:43], v[44:47]
ds_read_b128 a[180:183], v37 offset:18432
buffer_load_dwordx4 a[228:231], v1, s[4:7], s64 offen offset:2048 sc1
v_mfma_f32_16x16x32_bf16 v[48:51], a[204:207], a[40:43], v[48:51]
ds_read_b128 a[184:187], v37 offset:19456
v_mfma_f32_16x16x32_bf16 v[52:55], a[208:211], a[40:43], v[52:55]
ds_read_b128 a[188:191], v37 offset:20480
v_mfma_f32_16x16x32_bf16 v[56:59], a[212:215], a[40:43], v[56:59]
ds_read_b128 a[192:195], v37 offset:21504
s_cmp_eq_u32 s71, 23
s_cselect_b32 s98, 4096, 0
s_add_u32 s60, s60, s98
buffer_load_dwordx4 a[24:27], v1, s[8:11], s60 offen offset:3072 sc1
v_mfma_f32_16x16x32_bf16 v[60:63], a[216:219], a[40:43], v[60:63]
ds_read_b128 a[196:199], v41 offset:18432
s_waitcnt vmcnt(13) lgkmcnt(5)
v_mfma_f32_16x16x32_bf16 v[44:47], a[160:163], a[44:47], v[44:47]
ds_read_b128 a[200:203], v37 offset:23040
s_add_u32 s60, s60, 4096
v_mfma_f32_16x16x32_bf16 v[48:51], a[164:167], a[44:47], v[48:51]
ds_read_b128 a[204:207], v37 offset:24064
buffer_load_dwordx4 a[28:31], v1, s[8:11], s60 offen offset:0 sc1
v_mfma_f32_16x16x32_bf16 v[52:55], a[168:171], a[44:47], v[52:55]
ds_read_b128 a[208:211], v37 offset:25088
buffer_load_dwordx4 a[32:35], v1, s[8:11], s60 offen offset:1024 sc1
v_mfma_f32_16x16x32_bf16 v[56:59], a[172:175], a[44:47], v[56:59]
ds_read_b128 a[212:215], v37 offset:26112
v_mfma_f32_16x16x32_bf16 v[60:63], a[176:179], a[44:47], v[60:63]
ds_read_b128 a[216:219], v41 offset:23040
s_waitcnt vmcnt(14) lgkmcnt(5)
v_mfma_f32_16x16x32_bf16 v[44:47], a[180:183], a[48:51], v[44:47]
ds_read_b128 a[160:163], v37 offset:27648
buffer_load_dwordx4 a[36:39], v1, s[8:11], s60 offen offset:2048 sc1
v_mfma_f32_16x16x32_bf16 v[48:51], a[184:187], a[48:51], v[48:51]
ds_read_b128 a[164:167], v37 offset:28672
v_mfma_f32_16x16x32_bf16 v[52:55], a[188:191], a[48:51], v[52:55]
ds_read_b128 a[168:171], v37 offset:29696
v_mfma_f32_16x16x32_bf16 v[56:59], a[192:195], a[48:51], v[56:59]
ds_read_b128 a[172:175], v37 offset:30720
buffer_load_dwordx4 a[232:235], v1, s[4:7], s64 offen offset:3072 sc1
v_mfma_f32_16x16x32_bf16 v[60:63], a[196:199], a[48:51], v[60:63]
ds_read_b128 a[176:179], v41 offset:27648
s_waitcnt vmcnt(15) lgkmcnt(5)
v_mfma_f32_16x16x32_bf16 v[44:47], a[200:203], a[52:55], v[44:47]
ds_read_b128 a[180:183], v37 offset:32256
v_mfma_f32_16x16x32_bf16 v[48:51], a[204:207], a[52:55], v[48:51]
ds_read_b128 a[184:187], v37 offset:33280
v_mfma_f32_16x16x32_bf16 v[52:55], a[208:211], a[52:55], v[52:55]
ds_read_b128 a[188:191], v37 offset:34304
v_mfma_f32_16x16x32_bf16 v[56:59], a[212:215], a[52:55], v[56:59]
ds_read_b128 a[192:195], v37 offset:35328
s_cmp_eq_u32 s71, 27
s_cselect_b32 s98, 4096, 0
s_add_u32 s60, s60, s98
buffer_load_dwordx4 a[40:43], v1, s[8:11], s60 offen offset:3072 sc1
v_mfma_f32_16x16x32_bf16 v[60:63], a[216:219], a[52:55], v[60:63]
ds_read_b128 a[196:199], v41 offset:32256
s_waitcnt vmcnt(15) lgkmcnt(5)
v_mfma_f32_16x16x32_bf16 v[44:47], a[160:163], a[56:59], v[44:47]
ds_read_b128 a[200:203], v37 offset:36864
s_add_u32 s60, s60, 4096
v_mfma_f32_16x16x32_bf16 v[48:51], a[164:167], a[56:59], v[48:51]
ds_read_b128 a[204:207], v37 offset:37888
buffer_load_dwordx4 a[44:47], v1, s[8:11], s60 offen offset:0 sc1
v_mfma_f32_16x16x32_bf16 v[52:55], a[168:171], a[56:59], v[52:55]
ds_read_b128 a[208:211], v37 offset:38912
buffer_load_dwordx4 a[48:51], v1, s[8:11], s60 offen offset:1024 sc1
v_mfma_f32_16x16x32_bf16 v[56:59], a[172:175], a[56:59], v[56:59]
ds_read_b128 a[212:215], v37 offset:39936
v_mfma_f32_16x16x32_bf16 v[60:63], a[176:179], a[56:59], v[60:63]
ds_read_b128 a[216:219], v41 offset:36864
s_waitcnt vmcnt(16) lgkmcnt(5)
v_mfma_f32_16x16x32_bf16 v[44:47], a[180:183], a[60:63], v[44:47]
ds_read_b128 a[160:163], v37 offset:41472
buffer_load_dwordx4 a[52:55], v1, s[8:11], s60 offen offset:2048 sc1
v_mfma_f32_16x16x32_bf16 v[48:51], a[184:187], a[60:63], v[48:51]
ds_read_b128 a[164:167], v37 offset:42496
v_mfma_f32_16x16x32_bf16 v[52:55], a[188:191], a[60:63], v[52:55]
ds_read_b128 a[168:171], v37 offset:43520
buffer_load_dwordx4 a[236:239], v116, s[4:7], s64 offen sc1
v_mfma_f32_16x16x32_bf16 v[56:59], a[192:195], a[60:63], v[56:59]
ds_read_b128 a[172:175], v37 offset:44544
v_mfma_f32_16x16x32_bf16 v[60:63], a[196:199], a[60:63], v[60:63]
ds_read_b128 a[176:179], v41 offset:41472
s_waitcnt vmcnt(17) lgkmcnt(5)
v_mfma_f32_16x16x32_bf16 v[44:47], a[200:203], a[64:67], v[44:47]
ds_read_b128 a[180:183], v37 offset:46080
buffer_load_dwordx4 a[56:59], v1, s[8:11], s60 offen offset:3072 sc1
v_mfma_f32_16x16x32_bf16 v[48:51], a[204:207], a[64:67], v[48:51]
ds_read_b128 a[184:187], v37 offset:47104
v_mfma_f32_16x16x32_bf16 v[52:55], a[208:211], a[64:67], v[52:55]
ds_read_b128 a[188:191], v37 offset:48128
v_mfma_f32_16x16x32_bf16 v[56:59], a[212:215], a[64:67], v[56:59]
ds_read_b128 a[192:195], v37 offset:49152
v_mfma_f32_16x16x32_bf16 v[60:63], a[216:219], a[64:67], v[60:63]
ds_read_b128 a[196:199], v41 offset:46080
s_waitcnt vmcnt(17) lgkmcnt(5)
v_mfma_f32_16x16x32_bf16 v[44:47], a[160:163], a[0:3], v[44:47]
ds_read_b128 a[200:203], v37 offset:50688
s_mov_b32 s60, s61
v_mfma_f32_16x16x32_bf16 v[48:51], a[164:167], a[0:3], v[48:51]
ds_read_b128 a[204:207], v37 offset:51712
v_mfma_f32_16x16x32_bf16 v[52:55], a[168:171], a[0:3], v[52:55]
ds_read_b128 a[208:211], v37 offset:52736
v_mfma_f32_16x16x32_bf16 v[56:59], a[172:175], a[0:3], v[56:59]
ds_read_b128 a[212:215], v37 offset:53760
s_cmp_eq_u32 s71, 0
s_cselect_b32 s98, 4096, 0
s_add_u32 s60, s60, s98
buffer_load_dwordx4 a[60:63], v1, s[8:11], s60 offen offset:0 sc1
buffer_load_dwordx4 a[64:67], v1, s[8:11], s60 offen offset:1024 sc1
v_mfma_f32_16x16x32_bf16 v[60:63], a[176:179], a[0:3], v[60:63]
ds_read_b128 a[216:219], v41 offset:50688
s_waitcnt vmcnt(18) lgkmcnt(5)
v_mfma_f32_16x16x32_bf16 v[44:47], a[180:183], a[4:7], v[44:47]
ds_read_b128 a[160:163], v38 offset:0
buffer_load_dwordx4 a[0:3], v1, s[8:11], s60 offen offset:2048 sc1
v_mfma_f32_16x16x32_bf16 v[48:51], a[184:187], a[4:7], v[48:51]
ds_read_b128 a[164:167], v38 offset:1024
v_mfma_f32_16x16x32_bf16 v[52:55], a[188:191], a[4:7], v[52:55]
ds_read_b128 a[168:171], v38 offset:2048
v_mfma_f32_16x16x32_bf16 v[56:59], a[192:195], a[4:7], v[56:59]
ds_read_b128 a[172:175], v38 offset:3072
v_mfma_f32_16x16x32_bf16 v[60:63], a[196:199], a[4:7], v[60:63]
ds_read_b128 a[176:179], v42 offset:0
s_waitcnt vmcnt(18) lgkmcnt(5)
v_mfma_f32_16x16x32_bf16 v[44:47], a[200:203], a[8:11], v[44:47]
ds_read_b128 a[180:183], v38 offset:4608
buffer_load_dwordx4 a[4:7], v1, s[8:11], s60 offen offset:3072 sc1
v_mfma_f32_16x16x32_bf16 v[48:51], a[204:207], a[8:11], v[48:51]
ds_read_b128 a[184:187], v38 offset:5632
v_mfma_f32_16x16x32_bf16 v[52:55], a[208:211], a[8:11], v[52:55]
ds_read_b128 a[188:191], v38 offset:6656
v_mfma_f32_16x16x32_bf16 v[56:59], a[212:215], a[8:11], v[56:59]
ds_read_b128 a[192:195], v38 offset:7680
v_mfma_f32_16x16x32_bf16 v[60:63], a[216:219], a[8:11], v[60:63]
ds_read_b128 a[196:199], v42 offset:4608
s_waitcnt vmcnt(18) lgkmcnt(5)
v_mfma_f32_16x16x32_bf16 v[44:47], a[160:163], a[12:15], v[44:47]
ds_read_b128 a[200:203], v38 offset:9216
s_add_u32 s60, s60, 4096
v_mfma_f32_16x16x32_bf16 v[48:51], a[164:167], a[12:15], v[48:51]
ds_read_b128 a[204:207], v38 offset:10240
v_mfma_f32_16x16x32_bf16 v[52:55], a[168:171], a[12:15], v[52:55]
ds_read_b128 a[208:211], v38 offset:11264
buffer_load_dwordx4 a[8:11], v1, s[8:11], s60 offen offset:0 sc1
v_mfma_f32_16x16x32_bf16 v[56:59], a[172:175], a[12:15], v[56:59]
ds_read_b128 a[212:215], v38 offset:12288
v_mfma_f32_16x16x32_bf16 v[60:63], a[176:179], a[12:15], v[60:63]
ds_read_b128 a[216:219], v42 offset:9216
s_waitcnt vmcnt(18) lgkmcnt(5)
v_mfma_f32_16x16x32_bf16 v[44:47], a[180:183], a[16:19], v[44:47]
ds_read_b128 a[160:163], v38 offset:13824
v_mfma_f32_16x16x32_bf16 v[48:51], a[184:187], a[16:19], v[48:51]
ds_read_b128 a[164:167], v38 offset:14848
v_mfma_f32_16x16x32_bf16 v[52:55], a[188:191], a[16:19], v[52:55]
ds_read_b128 a[168:171], v38 offset:15872
v_mfma_f32_16x16x32_bf16 v[56:59], a[192:195], a[16:19], v[56:59]
ds_read_b128 a[172:175], v38 offset:16896
s_cmp_eq_u32 s71, 5
s_cselect_b32 s98, 4096, 0
s_add_u32 s60, s60, s98
buffer_load_dwordx4 a[12:15], v1, s[8:11], s60 offen offset:1024 sc1
v_mfma_f32_16x16x32_bf16 v[60:63], a[196:199], a[16:19], v[60:63]
ds_read_b128 a[176:179], v42 offset:13824
s_waitcnt vmcnt(18) lgkmcnt(5)
v_mfma_f32_16x16x32_bf16 v[44:47], a[200:203], a[20:23], v[44:47]
ds_read_b128 a[180:183], v38 offset:18432
buffer_load_dwordx4 a[16:19], v1, s[8:11], s60 offen offset:2048 sc1
v_mfma_f32_16x16x32_bf16 v[48:51], a[204:207], a[20:23], v[48:51]
ds_read_b128 a[184:187], v38 offset:19456
v_mfma_f32_16x16x32_bf16 v[52:55], a[208:211], a[20:23], v[52:55]
ds_read_b128 a[188:191], v38 offset:20480
v_mfma_f32_16x16x32_bf16 v[56:59], a[212:215], a[20:23], v[56:59]
ds_read_b128 a[192:195], v38 offset:21504
v_mfma_f32_16x16x32_bf16 v[60:63], a[216:219], a[20:23], v[60:63]
ds_read_b128 a[196:199], v42 offset:18432
s_waitcnt vmcnt(17) lgkmcnt(5)
v_mfma_f32_16x16x32_bf16 v[44:47], a[160:163], a[24:27], v[44:47]
ds_read_b128 a[200:203], v38 offset:23040
buffer_load_dwordx4 a[20:23], v1, s[8:11], s60 offen offset:3072 sc1
v_mfma_f32_16x16x32_bf16 v[48:51], a[164:167], a[24:27], v[48:51]
ds_read_b128 a[204:207], v38 offset:24064
v_mfma_f32_16x16x32_bf16 v[52:55], a[168:171], a[24:27], v[52:55]
ds_read_b128 a[208:211], v38 offset:25088
v_mfma_f32_16x16x32_bf16 v[56:59], a[172:175], a[24:27], v[56:59]
ds_read_b128 a[212:215], v38 offset:26112
v_mfma_f32_16x16x32_bf16 v[60:63], a[176:179], a[24:27], v[60:63]
ds_read_b128 a[216:219], v42 offset:23040
s_waitcnt vmcnt(17) lgkmcnt(5)
v_mfma_f32_16x16x32_bf16 v[44:47], a[180:183], a[28:31], v[44:47]
ds_read_b128 a[160:163], v38 offset:27648
s_add_u32 s60, s60, 4096
v_mfma_f32_16x16x32_bf16 v[48:51], a[184:187], a[28:31], v[48:51]
ds_read_b128 a[164:167], v38 offset:28672
v_mfma_f32_16x16x32_bf16 v[52:55], a[188:191], a[28:31], v[52:55]
ds_read_b128 a[168:171], v38 offset:29696
buffer_load_dwordx4 a[24:27], v1, s[8:11], s60 offen offset:0 sc1
v_mfma_f32_16x16x32_bf16 v[56:59], a[192:195], a[28:31], v[56:59]
ds_read_b128 a[172:175], v38 offset:30720
v_mfma_f32_16x16x32_bf16 v[60:63], a[196:199], a[28:31], v[60:63]
ds_read_b128 a[176:179], v42 offset:27648
s_waitcnt vmcnt(17) lgkmcnt(5)
v_mfma_f32_16x16x32_bf16 v[44:47], a[200:203], a[32:35], v[44:47]
ds_read_b128 a[180:183], v38 offset:32256
v_mfma_f32_16x16x32_bf16 v[48:51], a[204:207], a[32:35], v[48:51]
ds_read_b128 a[184:187], v38 offset:33280
v_mfma_f32_16x16x32_bf16 v[52:55], a[208:211], a[32:35], v[52:55]
ds_read_b128 a[188:191], v38 offset:34304
v_mfma_f32_16x16x32_bf16 v[56:59], a[212:215], a[32:35], v[56:59]
ds_read_b128 a[192:195], v38 offset:35328
s_cmp_eq_u32 s71, 9
s_cselect_b32 s98, 4096, 0
s_add_u32 s60, s60, s98
buffer_load_dwordx4 a[28:31], v1, s[8:11], s60 offen offset:1024 sc1
v_mfma_f32_16x16x32_bf16 v[60:63], a[216:219], a[32:35], v[60:63]
ds_read_b128 a[196:199], v42 offset:32256
s_waitcnt vmcnt(17) lgkmcnt(5)
v_mfma_f32_16x16x32_bf16 v[44:47], a[160:163], a[36:39], v[44:47]
ds_read_b128 a[200:203], v38 offset:36864
buffer_load_dwordx4 a[32:35], v1, s[8:11], s60 offen offset:2048 sc1
v_mfma_f32_16x16x32_bf16 v[48:51], a[164:167], a[36:39], v[48:51]
ds_read_b128 a[204:207], v38 offset:37888
v_mfma_f32_16x16x32_bf16 v[52:55], a[168:171], a[36:39], v[52:55]
ds_read_b128 a[208:211], v38 offset:38912
v_mfma_f32_16x16x32_bf16 v[56:59], a[172:175], a[36:39], v[56:59]
ds_read_b128 a[212:215], v38 offset:39936
v_mfma_f32_16x16x32_bf16 v[60:63], a[176:179], a[36:39], v[60:63]
ds_read_b128 a[216:219], v42 offset:36864
s_waitcnt vmcnt(16) lgkmcnt(5)
v_mfma_f32_16x16x32_bf16 v[44:47], a[180:183], a[40:43], v[44:47]
ds_read_b128 a[160:163], v38 offset:41472
buffer_load_dwordx4 a[36:39], v1, s[8:11], s60 offen offset:3072 sc1
v_mfma_f32_16x16x32_bf16 v[48:51], a[184:187], a[40:43], v[48:51]
ds_read_b128 a[164:167], v38 offset:42496
v_mfma_f32_16x16x32_bf16 v[52:55], a[188:191], a[40:43], v[52:55]
ds_read_b128 a[168:171], v38 offset:43520
v_mfma_f32_16x16x32_bf16 v[56:59], a[192:195], a[40:43], v[56:59]
ds_read_b128 a[172:175], v38 offset:44544
v_mfma_f32_16x16x32_bf16 v[60:63], a[196:199], a[40:43], v[60:63]
ds_read_b128 a[176:179], v42 offset:41472
s_waitcnt vmcnt(16) lgkmcnt(5)
v_mfma_f32_16x16x32_bf16 v[44:47], a[200:203], a[44:47], v[44:47]
ds_read_b128 a[180:183], v38 offset:46080
s_add_u32 s60, s60, 4096
v_mfma_f32_16x16x32_bf16 v[48:51], a[204:207], a[44:47], v[48:51]
ds_read_b128 a[184:187], v38 offset:47104
v_mfma_f32_16x16x32_bf16 v[52:55], a[208:211], a[44:47], v[52:55]
ds_read_b128 a[188:191], v38 offset:48128
buffer_load_dwordx4 a[40:43], v1, s[8:11], s60 offen offset:0 sc1
v_mfma_f32_16x16x32_bf16 v[56:59], a[212:215], a[44:47], v[56:59]
ds_read_b128 a[192:195], v38 offset:49152
v_mfma_f32_16x16x32_bf16 v[60:63], a[216:219], a[44:47], v[60:63]
ds_read_b128 a[196:199], v42 offset:46080
s_waitcnt vmcnt(16) lgkmcnt(5)
v_mfma_f32_16x16x32_bf16 v[44:47], a[160:163], a[48:51], v[44:47]
ds_read_b128 a[200:203], v38 offset:50688
buffer_load_dwordx4 a[44:47], v1, s[8:11], s60 offen offset:1024 sc1
v_mfma_f32_16x16x32_bf16 v[48:51], a[164:167], a[48:51], v[48:51]
ds_read_b128 a[204:207], v38 offset:51712
v_mfma_f32_16x16x32_bf16 v[52:55], a[168:171], a[48:51], v[52:55]
v_mfma_f32_16x16x32_bf16 v[56:59], a[172:175], a[48:51], v[56:59]
v_mfma_f32_16x16x32_bf16 v[60:63], a[176:179], a[48:51], v[60:63]
s_waitcnt vmcnt(16) lgkmcnt(2)
v_mfma_f32_16x16x32_bf16 v[44:47], a[180:183], a[52:55], v[44:47]
ds_read_b128 a[160:163], v36 offset:18432
v_mfma_f32_16x16x32_bf16 v[48:51], a[184:187], a[52:55], v[48:51]
ds_read_b128 a[164:167], v36 offset:19456
v_mfma_f32_16x16x32_bf16 v[52:55], a[188:191], a[52:55], v[52:55]
ds_read_b128 a[168:171], v36 offset:20480
v_mfma_f32_16x16x32_bf16 v[56:59], a[192:195], a[52:55], v[56:59]
ds_read_b128 a[172:175], v36 offset:21504
s_cmp_eq_u32 s71, 14
s_cselect_b32 s98, 4096, 0
s_add_u32 s60, s60, s98
buffer_load_dwordx4 a[48:51], v1, s[8:11], s60 offen offset:2048 sc1
v_mfma_f32_16x16x32_bf16 v[60:63], a[196:199], a[52:55], v[60:63]
ds_read_b128 a[176:179], v40 offset:18432
s_waitcnt vmcnt(15) lgkmcnt(5)
v_mfma_f32_16x16x32_bf16 v[44:47], a[200:203], a[56:59], v[44:47]
ds_read_b128 a[180:183], v36 offset:23040
buffer_load_dwordx4 a[52:55], v1, s[8:11], s60 offen offset:3072 sc1
v_mfma_f32_16x16x32_bf16 v[48:51], a[204:207], a[56:59], v[48:51]
ds_read_b128 a[184:187], v36 offset:24064
v_mfma_f32_16x16x32_bf16 v[52:55], a[228:231], a[56:59], v[52:55]
ds_read_b128 a[188:191], v36 offset:25088
v_mfma_f32_16x16x32_bf16 v[56:59], a[232:235], a[56:59], v[56:59]
ds_read_b128 a[192:195], v36 offset:26112
v_mfma_f32_16x16x32_bf16 v[60:63], a[236:239], a[56:59], v[60:63]
ds_read_b128 a[196:199], v40 offset:23040
s_waitcnt vmcnt(15) lgkmcnt(5)
v_mfma_f32_16x16x32_bf16 v[16:19], a[160:163], a[60:63], v[16:19]
ds_read_b128 a[200:203], v36 offset:27648
s_add_u32 s60, s60, 4096
v_mfma_f32_16x16x32_bf16 v[20:23], a[164:167], a[60:63], v[20:23]
ds_read_b128 a[204:207], v36 offset:28672
v_mfma_f32_16x16x32_bf16 v[24:27], a[168:171], a[60:63], v[24:27]
ds_read_b128 a[208:211], v36 offset:29696
buffer_load_dwordx4 a[56:59], v1, s[8:11], s60 offen offset:0 sc1
v_mfma_f32_16x16x32_bf16 v[28:31], a[172:175], a[60:63], v[28:31]
ds_read_b128 a[212:215], v36 offset:30720
v_mfma_f32_16x16x32_bf16 v[32:35], a[176:179], a[60:63], v[32:35]
ds_read_b128 a[216:219], v40 offset:27648
s_waitcnt vmcnt(15) lgkmcnt(5)
v_mfma_f32_16x16x32_bf16 v[16:19], a[180:183], a[64:67], v[16:19]
ds_read_b128 a[160:163], v36 offset:32256
buffer_load_dwordx4 a[60:63], v1, s[8:11], s60 offen offset:1024 sc1
v_mfma_f32_16x16x32_bf16 v[20:23], a[184:187], a[64:67], v[20:23]
ds_read_b128 a[164:167], v36 offset:33280
v_mfma_f32_16x16x32_bf16 v[24:27], a[188:191], a[64:67], v[24:27]
ds_read_b128 a[168:171], v36 offset:34304
v_mfma_f32_16x16x32_bf16 v[28:31], a[192:195], a[64:67], v[28:31]
ds_read_b128 a[172:175], v36 offset:35328
v_cvt_pk_bf16_f32 v64, v44, v45
v_mfma_f32_16x16x32_bf16 v[32:35], a[196:199], a[64:67], v[32:35]
ds_read_b128 a[176:179], v40 offset:32256
s_waitcnt vmcnt(15) lgkmcnt(5)
v_mfma_f32_16x16x32_bf16 v[16:19], a[200:203], a[0:3], v[16:19]
ds_read_b128 a[180:183], v36 offset:36864
v_cvt_pk_bf16_f32 v65, v46, v47
v_mfma_f32_16x16x32_bf16 v[20:23], a[204:207], a[0:3], v[20:23]
ds_read_b128 a[184:187], v36 offset:37888
v_mfma_f32_16x16x32_bf16 v[24:27], a[208:211], a[0:3], v[24:27]
ds_read_b128 a[188:191], v36 offset:38912
v_cvt_pk_bf16_f32 v66, v48, v49
v_mfma_f32_16x16x32_bf16 v[28:31], a[212:215], a[0:3], v[28:31]
ds_read_b128 a[192:195], v36 offset:39936
s_cmp_eq_u32 s71, 18
s_cselect_b32 s98, 4096, 0
s_add_u32 s60, s60, s98
buffer_load_dwordx4 a[64:67], v1, s[8:11], s60 offen offset:2048 sc1
v_mfma_f32_16x16x32_bf16 v[32:35], a[216:219], a[0:3], v[32:35]
ds_read_b128 a[196:199], v40 offset:36864
s_waitcnt vmcnt(15) lgkmcnt(5)
v_mfma_f32_16x16x32_bf16 v[16:19], a[160:163], a[4:7], v[16:19]
ds_read_b128 a[200:203], v36 offset:41472
buffer_load_dwordx4 a[0:3], v1, s[8:11], s60 offen offset:3072 sc1
v_mfma_f32_16x16x32_bf16 v[20:23], a[164:167], a[4:7], v[20:23]
ds_read_b128 a[204:207], v36 offset:42496
buffer_store_dwordx4 v[64:67], v1, s[8:11], s62 offen offset:0 sc1
v_mfma_f32_16x16x32_bf16 v[24:27], a[168:171], a[4:7], v[24:27]
ds_read_b128 a[208:211], v36 offset:43520
v_cvt_pk_bf16_f32 v68, v50, v51
v_mfma_f32_16x16x32_bf16 v[28:31], a[172:175], a[4:7], v[28:31]
ds_read_b128 a[212:215], v36 offset:44544
v_cvt_pk_bf16_f32 v69, v52, v53
v_mfma_f32_16x16x32_bf16 v[32:35], a[176:179], a[4:7], v[32:35]
ds_read_b128 a[216:219], v40 offset:41472
s_waitcnt vmcnt(16) lgkmcnt(5)
v_mfma_f32_16x16x32_bf16 v[16:19], a[180:183], a[8:11], v[16:19]
ds_read_b128 a[160:163], v36 offset:46080
s_add_u32 s60, s60, 4096
v_mfma_f32_16x16x32_bf16 v[20:23], a[184:187], a[8:11], v[20:23]
ds_read_b128 a[164:167], v36 offset:47104
v_cvt_pk_bf16_f32 v70, v54, v55
v_mfma_f32_16x16x32_bf16 v[24:27], a[188:191], a[8:11], v[24:27]
ds_read_b128 a[168:171], v36 offset:48128
buffer_load_dwordx4 a[4:7], v1, s[8:11], s60 offen offset:0 sc1
v_mfma_f32_16x16x32_bf16 v[28:31], a[192:195], a[8:11], v[28:31]
ds_read_b128 a[172:175], v36 offset:49152
buffer_store_dwordx4 v[68:71], v1, s[8:11], s62 offen offset:1024 sc1
v_mfma_f32_16x16x32_bf16 v[32:35], a[196:199], a[8:11], v[32:35]
ds_read_b128 a[176:179], v40 offset:46080
s_waitcnt vmcnt(17) lgkmcnt(5)
v_mfma_f32_16x16x32_bf16 v[16:19], a[200:203], a[12:15], v[16:19]
ds_read_b128 a[180:183], v36 offset:50688
buffer_load_dwordx4 a[8:11], v1, s[8:11], s60 offen offset:1024 sc1
v_mfma_f32_16x16x32_bf16 v[20:23], a[204:207], a[12:15], v[20:23]
ds_read_b128 a[184:187], v36 offset:51712
v_cvt_pk_bf16_f32 v72, v56, v57
v_mfma_f32_16x16x32_bf16 v[24:27], a[208:211], a[12:15], v[24:27]
ds_read_b128 a[188:191], v36 offset:52736
v_cvt_pk_bf16_f32 v73, v58, v59
v_mfma_f32_16x16x32_bf16 v[28:31], a[212:215], a[12:15], v[28:31]
ds_read_b128 a[192:195], v36 offset:53760
v_cvt_pk_bf16_f32 v74, v60, v61
v_mfma_f32_16x16x32_bf16 v[32:35], a[216:219], a[12:15], v[32:35]
ds_read_b128 a[196:199], v40 offset:50688
s_waitcnt vmcnt(17) lgkmcnt(5)
v_mfma_f32_16x16x32_bf16 v[16:19], a[160:163], a[16:19], v[16:19]
ds_read_b128 a[200:203], v37 offset:0
buffer_load_dwordx4 a[12:15], v1, s[8:11], s60 offen offset:2048 sc1
v_mfma_f32_16x16x32_bf16 v[20:23], a[164:167], a[16:19], v[20:23]
ds_read_b128 a[204:207], v37 offset:1024
buffer_store_dwordx4 v[72:75], v1, s[8:11], s62 offen offset:2048 sc1
v_mfma_f32_16x16x32_bf16 v[24:27], a[168:171], a[16:19], v[24:27]
ds_read_b128 a[208:211], v37 offset:2048
v_cvt_pk_bf16_f32 v76, v62, v63
v_mfma_f32_16x16x32_bf16 v[28:31], a[172:175], a[16:19], v[28:31]
ds_read_b128 a[212:215], v37 offset:3072
v_mfma_f32_16x16x32_bf16 v[32:35], a[176:179], a[16:19], v[32:35]
ds_read_b128 a[216:219], v41 offset:0
s_waitcnt vmcnt(18) lgkmcnt(5)
v_mfma_f32_16x16x32_bf16 v[16:19], a[180:183], a[20:23], v[16:19]
ds_read_b128 a[160:163], v37 offset:4608
buffer_store_dwordx4 v[76:79], v1, s[8:11], s62 offen offset:3072 sc1
v_mfma_f32_16x16x32_bf16 v[20:23], a[184:187], a[20:23], v[20:23]
ds_read_b128 a[164:167], v37 offset:5632
v_mfma_f32_16x16x32_bf16 v[24:27], a[188:191], a[20:23], v[24:27]
ds_read_b128 a[168:171], v37 offset:6656
v_mfma_f32_16x16x32_bf16 v[28:31], a[192:195], a[20:23], v[28:31]
ds_read_b128 a[172:175], v37 offset:7680
s_cmp_eq_u32 s71, 23
s_cselect_b32 s98, 4096, 0
s_add_u32 s60, s60, s98
buffer_load_dwordx4 a[16:19], v1, s[8:11], s60 offen offset:3072 sc1
v_mfma_f32_16x16x32_bf16 v[32:35], a[196:199], a[20:23], v[32:35]
ds_read_b128 a[176:179], v41 offset:4608
s_waitcnt vmcnt(19) lgkmcnt(5)
v_mfma_f32_16x16x32_bf16 v[16:19], a[200:203], a[24:27], v[16:19]
ds_read_b128 a[180:183], v37 offset:9216
s_add_u32 s60, s60, 4096
v_mfma_f32_16x16x32_bf16 v[20:23], a[204:207], a[24:27], v[20:23]
ds_read_b128 a[184:187], v37 offset:10240
v_mfma_f32_16x16x32_bf16 v[24:27], a[208:211], a[24:27], v[24:27]
ds_read_b128 a[188:191], v37 offset:11264
buffer_load_dwordx4 a[20:23], v1, s[8:11], s60 offen offset:0 sc1
v_mfma_f32_16x16x32_bf16 v[28:31], a[212:215], a[24:27], v[28:31]
ds_read_b128 a[192:195], v37 offset:12288
v_mfma_f32_16x16x32_bf16 v[32:35], a[216:219], a[24:27], v[32:35]
ds_read_b128 a[196:199], v41 offset:9216
s_waitcnt vmcnt(19) lgkmcnt(5)
v_mfma_f32_16x16x32_bf16 v[16:19], a[160:163], a[28:31], v[16:19]
ds_read_b128 a[200:203], v37 offset:13824
buffer_load_dwordx4 a[24:27], v1, s[8:11], s60 offen offset:1024 sc1
v_mfma_f32_16x16x32_bf16 v[20:23], a[164:167], a[28:31], v[20:23]
ds_read_b128 a[204:207], v37 offset:14848
v_mfma_f32_16x16x32_bf16 v[24:27], a[168:171], a[28:31], v[24:27]
ds_read_b128 a[208:211], v37 offset:15872
v_mfma_f32_16x16x32_bf16 v[28:31], a[172:175], a[28:31], v[28:31]
ds_read_b128 a[212:215], v37 offset:16896
v_mfma_f32_16x16x32_bf16 v[32:35], a[176:179], a[28:31], v[32:35]
ds_read_b128 a[216:219], v41 offset:13824
s_waitcnt vmcnt(19) lgkmcnt(5)
v_mfma_f32_16x16x32_bf16 v[16:19], a[180:183], a[32:35], v[16:19]
ds_read_b128 a[160:163], v37 offset:18432
buffer_load_dwordx4 a[28:31], v1, s[8:11], s60 offen offset:2048 sc1
v_mfma_f32_16x16x32_bf16 v[20:23], a[184:187], a[32:35], v[20:23]
ds_read_b128 a[164:167], v37 offset:19456
v_mfma_f32_16x16x32_bf16 v[24:27], a[188:191], a[32:35], v[24:27]
ds_read_b128 a[168:171], v37 offset:20480
v_mfma_f32_16x16x32_bf16 v[28:31], a[192:195], a[32:35], v[28:31]
ds_read_b128 a[172:175], v37 offset:21504
v_mfma_f32_16x16x32_bf16 v[32:35], a[196:199], a[32:35], v[32:35]
ds_read_b128 a[176:179], v41 offset:18432
s_waitcnt vmcnt(19) lgkmcnt(5)
v_mfma_f32_16x16x32_bf16 v[16:19], a[200:203], a[36:39], v[16:19]
ds_read_b128 a[180:183], v37 offset:23040
v_mfma_f32_16x16x32_bf16 v[20:23], a[204:207], a[36:39], v[20:23]
ds_read_b128 a[184:187], v37 offset:24064
v_mfma_f32_16x16x32_bf16 v[24:27], a[208:211], a[36:39], v[24:27]
ds_read_b128 a[188:191], v37 offset:25088
v_mfma_f32_16x16x32_bf16 v[28:31], a[212:215], a[36:39], v[28:31]
ds_read_b128 a[192:195], v37 offset:26112
s_cmp_eq_u32 s71, 27
s_cselect_b32 s98, 4096, 0
s_add_u32 s60, s60, s98
buffer_load_dwordx4 a[32:35], v1, s[8:11], s60 offen offset:3072 sc1
v_mfma_f32_16x16x32_bf16 v[32:35], a[216:219], a[36:39], v[32:35]
ds_read_b128 a[196:199], v41 offset:23040
s_waitcnt vmcnt(19) lgkmcnt(5)
v_mfma_f32_16x16x32_bf16 v[16:19], a[160:163], a[40:43], v[16:19]
ds_read_b128 a[200:203], v37 offset:27648
s_add_u32 s60, s60, 4096
v_mfma_f32_16x16x32_bf16 v[20:23], a[164:167], a[40:43], v[20:23]
ds_read_b128 a[204:207], v37 offset:28672
v_mfma_f32_16x16x32_bf16 v[24:27], a[168:171], a[40:43], v[24:27]
ds_read_b128 a[208:211], v37 offset:29696
buffer_load_dwordx4 a[36:39], v1, s[8:11], s60 offen offset:0 sc1
v_mfma_f32_16x16x32_bf16 v[28:31], a[172:175], a[40:43], v[28:31]
ds_read_b128 a[212:215], v37 offset:30720
v_mfma_f32_16x16x32_bf16 v[32:35], a[176:179], a[40:43], v[32:35]
ds_read_b128 a[216:219], v41 offset:27648
s_waitcnt vmcnt(19) lgkmcnt(5)
v_mfma_f32_16x16x32_bf16 v[16:19], a[180:183], a[44:47], v[16:19]
ds_read_b128 a[160:163], v37 offset:32256
buffer_load_dwordx4 a[40:43], v1, s[8:11], s60 offen offset:1024 sc1
v_mfma_f32_16x16x32_bf16 v[20:23], a[184:187], a[44:47], v[20:23]
ds_read_b128 a[164:167], v37 offset:33280
v_mfma_f32_16x16x32_bf16 v[24:27], a[188:191], a[44:47], v[24:27]
ds_read_b128 a[168:171], v37 offset:34304
v_mfma_f32_16x16x32_bf16 v[28:31], a[192:195], a[44:47], v[28:31]
ds_read_b128 a[172:175], v37 offset:35328
v_mfma_f32_16x16x32_bf16 v[32:35], a[196:199], a[44:47], v[32:35]
ds_read_b128 a[176:179], v41 offset:32256
s_waitcnt vmcnt(19) lgkmcnt(5)
v_mfma_f32_16x16x32_bf16 v[16:19], a[200:203], a[48:51], v[16:19]
ds_read_b128 a[180:183], v37 offset:36864
buffer_load_dwordx4 a[44:47], v1, s[8:11], s60 offen offset:2048 sc1
v_mfma_f32_16x16x32_bf16 v[20:23], a[204:207], a[48:51], v[20:23]
ds_read_b128 a[184:187], v37 offset:37888
v_mfma_f32_16x16x32_bf16 v[24:27], a[208:211], a[48:51], v[24:27]
ds_read_b128 a[188:191], v37 offset:38912
v_mfma_f32_16x16x32_bf16 v[28:31], a[212:215], a[48:51], v[28:31]
ds_read_b128 a[192:195], v37 offset:39936
v_mfma_f32_16x16x32_bf16 v[32:35], a[216:219], a[48:51], v[32:35]
ds_read_b128 a[196:199], v41 offset:36864
s_waitcnt vmcnt(19) lgkmcnt(5)
v_mfma_f32_16x16x32_bf16 v[16:19], a[160:163], a[52:55], v[16:19]
ds_read_b128 a[200:203], v37 offset:41472
buffer_load_dwordx4 a[48:51], v1, s[8:11], s60 offen offset:3072 sc1
v_mfma_f32_16x16x32_bf16 v[20:23], a[164:167], a[52:55], v[20:23]
ds_read_b128 a[204:207], v37 offset:42496
v_mfma_f32_16x16x32_bf16 v[24:27], a[168:171], a[52:55], v[24:27]
ds_read_b128 a[208:211], v37 offset:43520
v_mfma_f32_16x16x32_bf16 v[28:31], a[172:175], a[52:55], v[28:31]
ds_read_b128 a[212:215], v37 offset:44544
v_mfma_f32_16x16x32_bf16 v[32:35], a[176:179], a[52:55], v[32:35]
ds_read_b128 a[216:219], v41 offset:41472
s_waitcnt vmcnt(19) lgkmcnt(5)
v_mfma_f32_16x16x32_bf16 v[16:19], a[180:183], a[56:59], v[16:19]
ds_read_b128 a[160:163], v37 offset:46080
v_mfma_f32_16x16x32_bf16 v[20:23], a[184:187], a[56:59], v[20:23]
ds_read_b128 a[164:167], v37 offset:47104
v_mfma_f32_16x16x32_bf16 v[24:27], a[188:191], a[56:59], v[24:27]
ds_read_b128 a[168:171], v37 offset:48128
v_mfma_f32_16x16x32_bf16 v[28:31], a[192:195], a[56:59], v[28:31]
ds_read_b128 a[172:175], v37 offset:49152
v_mfma_f32_16x16x32_bf16 v[32:35], a[196:199], a[56:59], v[32:35]
ds_read_b128 a[176:179], v41 offset:46080
s_waitcnt vmcnt(18) lgkmcnt(5)
v_mfma_f32_16x16x32_bf16 v[16:19], a[200:203], a[60:63], v[16:19]
ds_read_b128 a[180:183], v37 offset:50688
v_mfma_f32_16x16x32_bf16 v[20:23], a[204:207], a[60:63], v[20:23]
ds_read_b128 a[184:187], v37 offset:51712
v_mfma_f32_16x16x32_bf16 v[24:27], a[208:211], a[60:63], v[24:27]
ds_read_b128 a[188:191], v37 offset:52736
v_mfma_f32_16x16x32_bf16 v[28:31], a[212:215], a[60:63], v[28:31]
ds_read_b128 a[192:195], v37 offset:53760
v_mfma_f32_16x16x32_bf16 v[32:35], a[216:219], a[60:63], v[32:35]
ds_read_b128 a[196:199], v41 offset:50688
s_waitcnt vmcnt(17) lgkmcnt(5)
v_mfma_f32_16x16x32_bf16 v[16:19], a[160:163], a[64:67], v[16:19]
ds_read_b128 a[200:203], v38 offset:0
buffer_load_dwordx4 v[80:83], v1, s[8:11], s63 offen offset:0 sc1
v_mfma_f32_16x16x32_bf16 v[20:23], a[164:167], a[64:67], v[20:23]
ds_read_b128 a[204:207], v38 offset:1024
v_mfma_f32_16x16x32_bf16 v[24:27], a[168:171], a[64:67], v[24:27]
ds_read_b128 a[208:211], v38 offset:2048
v_mfma_f32_16x16x32_bf16 v[28:31], a[172:175], a[64:67], v[28:31]
ds_read_b128 a[212:215], v38 offset:3072
v_mfma_f32_16x16x32_bf16 v[32:35], a[176:179], a[64:67], v[32:35]
ds_read_b128 a[216:219], v42 offset:0
s_waitcnt vmcnt(17) lgkmcnt(5)
v_mfma_f32_16x16x32_bf16 v[16:19], a[180:183], a[0:3], v[16:19]
ds_read_b128 a[160:163], v38 offset:4608
buffer_load_dwordx4 v[84:87], v1, s[8:11], s63 offen offset:1024 sc1
v_mfma_f32_16x16x32_bf16 v[20:23], a[184:187], a[0:3], v[20:23]
ds_read_b128 a[164:167], v38 offset:5632
v_mfma_f32_16x16x32_bf16 v[24:27], a[188:191], a[0:3], v[24:27]
ds_read_b128 a[168:171], v38 offset:6656
v_mfma_f32_16x16x32_bf16 v[28:31], a[192:195], a[0:3], v[28:31]
ds_read_b128 a[172:175], v38 offset:7680
v_mfma_f32_16x16x32_bf16 v[32:35], a[196:199], a[0:3], v[32:35]
ds_read_b128 a[176:179], v42 offset:4608
s_waitcnt vmcnt(16) lgkmcnt(5)
v_mfma_f32_16x16x32_bf16 v[16:19], a[200:203], a[4:7], v[16:19]
ds_read_b128 a[180:183], v38 offset:9216
buffer_load_dwordx4 v[88:91], v1, s[8:11], s63 offen offset:2048 sc1
v_mfma_f32_16x16x32_bf16 v[20:23], a[204:207], a[4:7], v[20:23]
ds_read_b128 a[184:187], v38 offset:10240
v_mfma_f32_16x16x32_bf16 v[24:27], a[208:211], a[4:7], v[24:27]
ds_read_b128 a[188:191], v38 offset:11264
v_mfma_f32_16x16x32_bf16 v[28:31], a[212:215], a[4:7], v[28:31]
ds_read_b128 a[192:195], v38 offset:12288
v_mfma_f32_16x16x32_bf16 v[32:35], a[216:219], a[4:7], v[32:35]
ds_read_b128 a[196:199], v42 offset:9216
s_waitcnt vmcnt(15) lgkmcnt(5)
v_mfma_f32_16x16x32_bf16 v[16:19], a[160:163], a[8:11], v[16:19]
ds_read_b128 a[200:203], v38 offset:13824
buffer_load_dwordx4 v[92:95], v1, s[8:11], s63 offen offset:3072 sc1
v_mfma_f32_16x16x32_bf16 v[20:23], a[164:167], a[8:11], v[20:23]
ds_read_b128 a[204:207], v38 offset:14848
v_mfma_f32_16x16x32_bf16 v[24:27], a[168:171], a[8:11], v[24:27]
ds_read_b128 a[208:211], v38 offset:15872
v_mfma_f32_16x16x32_bf16 v[28:31], a[172:175], a[8:11], v[28:31]
ds_read_b128 a[212:215], v38 offset:16896
v_mfma_f32_16x16x32_bf16 v[32:35], a[176:179], a[8:11], v[32:35]
ds_read_b128 a[216:219], v42 offset:13824
s_waitcnt vmcnt(15) lgkmcnt(5)
v_mfma_f32_16x16x32_bf16 v[16:19], a[180:183], a[12:15], v[16:19]
ds_read_b128 a[160:163], v38 offset:18432
v_mfma_f32_16x16x32_bf16 v[20:23], a[184:187], a[12:15], v[20:23]
ds_read_b128 a[164:167], v38 offset:19456
v_mfma_f32_16x16x32_bf16 v[24:27], a[188:191], a[12:15], v[24:27]
ds_read_b128 a[168:171], v38 offset:20480
v_mfma_f32_16x16x32_bf16 v[28:31], a[192:195], a[12:15], v[28:31]
ds_read_b128 a[172:175], v38 offset:21504
v_mfma_f32_16x16x32_bf16 v[32:35], a[196:199], a[12:15], v[32:35]
ds_read_b128 a[176:179], v42 offset:18432
s_waitcnt vmcnt(12) lgkmcnt(5)
v_mfma_f32_16x16x32_bf16 v[16:19], a[200:203], a[16:19], v[16:19]
ds_read_b128 a[180:183], v38 offset:23040
v_mfma_f32_16x16x32_bf16 v[20:23], a[204:207], a[16:19], v[20:23]
ds_read_b128 a[184:187], v38 offset:24064
v_mfma_f32_16x16x32_bf16 v[24:27], a[208:211], a[16:19], v[24:27]
ds_read_b128 a[188:191], v38 offset:25088
v_mfma_f32_16x16x32_bf16 v[28:31], a[212:215], a[16:19], v[28:31]
ds_read_b128 a[192:195], v38 offset:26112
v_mfma_f32_16x16x32_bf16 v[32:35], a[216:219], a[16:19], v[32:35]
ds_read_b128 a[196:199], v42 offset:23040
s_waitcnt vmcnt(11) lgkmcnt(5)
v_mfma_f32_16x16x32_bf16 v[16:19], a[160:163], a[20:23], v[16:19]
ds_read_b128 a[200:203], v38 offset:27648
v_mfma_f32_16x16x32_bf16 v[20:23], a[164:167], a[20:23], v[20:23]
ds_read_b128 a[204:207], v38 offset:28672
v_mfma_f32_16x16x32_bf16 v[24:27], a[168:171], a[20:23], v[24:27]
ds_read_b128 a[208:211], v38 offset:29696
v_mfma_f32_16x16x32_bf16 v[28:31], a[172:175], a[20:23], v[28:31]
ds_read_b128 a[212:215], v38 offset:30720
v_mfma_f32_16x16x32_bf16 v[32:35], a[176:179], a[20:23], v[32:35]
ds_read_b128 a[216:219], v42 offset:27648
s_waitcnt vmcnt(10) lgkmcnt(5)
v_mfma_f32_16x16x32_bf16 v[16:19], a[180:183], a[24:27], v[16:19]
ds_read_b128 a[160:163], v38 offset:32256
v_mfma_f32_16x16x32_bf16 v[20:23], a[184:187], a[24:27], v[20:23]
ds_read_b128 a[164:167], v38 offset:33280
v_mfma_f32_16x16x32_bf16 v[24:27], a[188:191], a[24:27], v[24:27]
ds_read_b128 a[168:171], v38 offset:34304
v_mfma_f32_16x16x32_bf16 v[28:31], a[192:195], a[24:27], v[28:31]
ds_read_b128 a[172:175], v38 offset:35328
v_mfma_f32_16x16x32_bf16 v[32:35], a[196:199], a[24:27], v[32:35]
ds_read_b128 a[176:179], v42 offset:32256
s_waitcnt vmcnt(9) lgkmcnt(5)
v_mfma_f32_16x16x32_bf16 v[16:19], a[200:203], a[28:31], v[16:19]
ds_read_b128 a[180:183], v38 offset:36864
v_mfma_f32_16x16x32_bf16 v[20:23], a[204:207], a[28:31], v[20:23]
ds_read_b128 a[184:187], v38 offset:37888
v_mfma_f32_16x16x32_bf16 v[24:27], a[208:211], a[28:31], v[24:27]
ds_read_b128 a[188:191], v38 offset:38912
v_mfma_f32_16x16x32_bf16 v[28:31], a[212:215], a[28:31], v[28:31]
ds_read_b128 a[192:195], v38 offset:39936
v_mfma_f32_16x16x32_bf16 v[32:35], a[216:219], a[28:31], v[32:35]
ds_read_b128 a[196:199], v42 offset:36864
s_waitcnt vmcnt(8) lgkmcnt(5)
v_mfma_f32_16x16x32_bf16 v[16:19], a[160:163], a[32:35], v[16:19]
ds_read_b128 a[200:203], v38 offset:41472
v_mfma_f32_16x16x32_bf16 v[20:23], a[164:167], a[32:35], v[20:23]
ds_read_b128 a[204:207], v38 offset:42496
v_mfma_f32_16x16x32_bf16 v[24:27], a[168:171], a[32:35], v[24:27]
ds_read_b128 a[208:211], v38 offset:43520
v_mfma_f32_16x16x32_bf16 v[28:31], a[172:175], a[32:35], v[28:31]
ds_read_b128 a[212:215], v38 offset:44544
v_mfma_f32_16x16x32_bf16 v[32:35], a[176:179], a[32:35], v[32:35]
ds_read_b128 a[216:219], v42 offset:41472
s_waitcnt vmcnt(7) lgkmcnt(5)
v_mfma_f32_16x16x32_bf16 v[16:19], a[180:183], a[36:39], v[16:19]
ds_read_b128 a[160:163], v38 offset:46080
v_mfma_f32_16x16x32_bf16 v[20:23], a[184:187], a[36:39], v[20:23]
ds_read_b128 a[164:167], v38 offset:47104
v_mfma_f32_16x16x32_bf16 v[24:27], a[188:191], a[36:39], v[24:27]
ds_read_b128 a[168:171], v38 offset:48128
v_mfma_f32_16x16x32_bf16 v[28:31], a[192:195], a[36:39], v[28:31]
ds_read_b128 a[172:175], v38 offset:49152
v_mfma_f32_16x16x32_bf16 v[32:35], a[196:199], a[36:39], v[32:35]
ds_read_b128 a[176:179], v42 offset:46080
s_waitcnt vmcnt(6) lgkmcnt(5)
v_mfma_f32_16x16x32_bf16 v[16:19], a[200:203], a[40:43], v[16:19]
ds_read_b128 a[180:183], v38 offset:50688
v_mfma_f32_16x16x32_bf16 v[20:23], a[204:207], a[40:43], v[20:23]
ds_read_b128 a[184:187], v38 offset:51712
v_mfma_f32_16x16x32_bf16 v[24:27], a[208:211], a[40:43], v[24:27]
v_mfma_f32_16x16x32_bf16 v[28:31], a[212:215], a[40:43], v[28:31]
v_mfma_f32_16x16x32_bf16 v[32:35], a[216:219], a[40:43], v[32:35]
s_waitcnt vmcnt(5) lgkmcnt(2)
v_mfma_f32_16x16x32_bf16 v[16:19], a[160:163], a[44:47], v[16:19]
v_mfma_f32_16x16x32_bf16 v[20:23], a[164:167], a[44:47], v[20:23]
v_mfma_f32_16x16x32_bf16 v[24:27], a[168:171], a[44:47], v[24:27]
v_mfma_f32_16x16x32_bf16 v[28:31], a[172:175], a[44:47], v[28:31]
v_mfma_f32_16x16x32_bf16 v[32:35], a[176:179], a[44:47], v[32:35]
s_waitcnt vmcnt(4) lgkmcnt(0)
v_mfma_f32_16x16x32_bf16 v[16:19], a[180:183], a[48:51], v[16:19]
s_waitcnt vmcnt(0)
v_xor_b32 v118, v248, v83
v_xor_b32 v119, v248, v87
v_xor_b32 v120, v248, v91
v_xor_b32 v121, v248, v95
v_mfma_f32_16x16x32_bf16 v[20:23], a[184:187], a[48:51], v[20:23]
v_or3_b32 v118, v118, v119, v120
v_or_b32 v118, v118, v121
v_cmp_ne_u32 vcc, 0, v118
s_nop 0
s_cbranch_vccnz L_xslow_37
L_xback_38:
v_mfma_f32_16x16x32_bf16 v[24:27], a[228:231], a[48:51], v[24:27]
v_lshlrev_b32 v96, 16, v80
v_and_b32 v97, 0xffff0000, v80
v_lshlrev_b32 v98, 16, v81
v_and_b32 v99, 0xffff0000, v81
v_lshlrev_b32 v100, 16, v82
v_and_b32 v101, 0xffff0000, v82
v_mfma_f32_16x16x32_bf16 v[28:31], a[232:235], a[48:51], v[28:31]
v_lshlrev_b32 v102, 16, v84
v_and_b32 v103, 0xffff0000, v84
v_lshlrev_b32 v104, 16, v85
v_and_b32 v105, 0xffff0000, v85
v_lshlrev_b32 v106, 16, v86
v_and_b32 v107, 0xffff0000, v86
v_mfma_f32_16x16x32_bf16 v[32:35], a[236:239], a[48:51], v[32:35]
v_lshlrev_b32 v108, 16, v88
v_and_b32 v109, 0xffff0000, v88
v_lshlrev_b32 v110, 16, v89
v_and_b32 v111, 0xffff0000, v89
v_lshlrev_b32 v112, 16, v90
v_and_b32 v113, 0xffff0000, v90
v_lshlrev_b32 v114, 16, v92
v_and_b32 v115, 0xffff0000, v92
s_nop 3
v_pk_add_f32 v[16:17], v[16:17], v[96:97]
v_pk_add_f32 v[18:19], v[18:19], v[98:99]
v_pk_add_f32 v[20:21], v[20:21], v[100:101]
v_pk_add_f32 v[22:23], v[22:23], v[102:103]
v_pk_add_f32 v[24:25], v[24:25], v[104:105]
v_pk_add_f32 v[26:27], v[26:27], v[106:107]
v_pk_add_f32 v[28:29], v[28:29], v[108:109]
v_pk_add_f32 v[30:31], v[30:31], v[110:111]
v_pk_add_f32 v[32:33], v[32:33], v[112:113]
v_pk_add_f32 v[34:35], v[34:35], v[114:115]
s_cmp_eq_u32 s29, 1
s_cbranch_scc1 L_last
v_pk_add_f32 v[142:143], v[16:17], v[18:19]
v_pk_mul_f32 v[144:145], v[16:17], v[16:17]
v_pk_fma_f32 v[144:145], v[18:19], v[18:19], v[144:145]
v_pk_add_f32 v[142:143], v[142:143], v[20:21]
v_pk_fma_f32 v[144:145], v[20:21], v[20:21], v[144:145]
v_pk_add_f32 v[142:143], v[142:143], v[22:23]
v_pk_fma_f32 v[144:145], v[22:23], v[22:23], v[144:145]
v_pk_add_f32 v[142:143], v[142:143], v[24:25]
v_pk_fma_f32 v[144:145], v[24:25], v[24:25], v[144:145]
v_pk_add_f32 v[142:143], v[142:143], v[26:27]
v_pk_fma_f32 v[144:145], v[26:27], v[26:27], v[144:145]
v_pk_add_f32 v[142:143], v[142:143], v[28:29]
v_pk_fma_f32 v[144:145], v[28:29], v[28:29], v[144:145]
v_pk_add_f32 v[142:143], v[142:143], v[30:31]
v_pk_fma_f32 v[144:145], v[30:31], v[30:31], v[144:145]
s_mov_b32 exec_hi, 0
v_pk_add_f32 v[142:143], v[142:143], v[32:33]
v_pk_fma_f32 v[144:145], v[32:33], v[32:33], v[144:145]
v_pk_add_f32 v[142:143], v[142:143], v[34:35]
v_pk_fma_f32 v[144:145], v[34:35], v[34:35], v[144:145]
s_mov_b64 exec, -1
v_add_f32 v136, v142, v143
v_add_f32 v137, v144, v145
v_cvt_pk_bf16_f32 v132, v32, v33
v_cvt_pk_bf16_f32 v133, v34, v35
v_permlane32_swap_b32 v136, v137
v_add_f32 v136, v136, v137
v_mov_b32 v137, v136
v_cvt_pk_bf16_f32 v124, v16, v17
v_cvt_pk_bf16_f32 v125, v18, v19
v_permlane16_swap_b32 v136, v137
v_add_f32 v136, v136, v137
v_mov_b32 v137, v136
v_cvt_pk_bf16_f32 v126, v20, v21
v_cvt_pk_bf16_f32 v127, v22, v23
v_permlane32_swap_b32 v136, v137
buffer_store_dwordx4 v[124:127], v140, s[8:11], s66 offen sc1
buffer_store_dwordx2 v[136:137], v138, s[8:11], s67 offen sc1
v_cvt_pk_bf16_f32 v128, v24, v25
v_cvt_pk_bf16_f32 v129, v26, v27
v_cvt_pk_bf16_f32 v130, v28, v29
v_cvt_pk_bf16_f32 v131, v30, v31
v_permlane16_swap_b32 v132, v134
v_permlane16_swap_b32 v133, v135
buffer_store_dwordx4 v[128:131], v140, s[8:11], s66 offen offset:1024 sc1
buffer_store_dwordx4 v[132:135], v141, s[8:11], s66 offen sc1
s_barrier
s_mul_i32 s36, s26, 132608
s_mul_i32 s38, s24, 12288
s_add_u32 m0, s38, 0
s_add_u32 s39, s38, s36
buffer_load_dwordx4 v1, s[4:7], s39 offen offset:0 sc1 lds
buffer_load_dwordx4 v1, s[4:7], s39 offen offset:1024 sc1 lds
buffer_load_dwordx4 v1, s[4:7], s39 offen offset:2048 sc1 lds
buffer_load_dwordx4 v1, s[4:7], s39 offen offset:3072 sc1 lds
s_add_u32 m0, m0, 4096
s_add_u32 s39, s39, 4096
buffer_load_dwordx4 v1, s[4:7], s39 offen offset:0 sc1 lds
buffer_load_dwordx4 v1, s[4:7], s39 offen offset:1024 sc1 lds
buffer_load_dwordx4 v1, s[4:7], s39 offen offset:2048 sc1 lds
buffer_load_dwordx4 v1, s[4:7], s39 offen offset:3072 sc1 lds
s_and_b32 s33, s27, 1
s_cmp_lt_u32 s27, 31
s_cselect_b32 s33, s33, 0
s_cmp_eq_u32 s33, 1
s_cselect_b32 s34, -1, 0xffff
s_mov_b32 s35, 0
v_lshlrev_b32 v7, 3, v1
s_lshr_b32 s31, s80, 4
s_lshl_b32 s31, s31, 11
v_add_u32 v7, s31, v7
s_cmp_eq_u32 s24, 0
s_cselect_b32 s30, 0, 1073741824
s_add_u32 s30, s30, 26607616
s_waitcnt vmcnt(8)
s_barrier
s_mov_b64 exec, s[34:35]
buffer_atomic_add v4, v7, s[8:11], s30 offen sc1
s_mov_b64 exec, -1
s_cmp_eq_u32 s29, 1
s_cbranch_scc1 L_main_fin
s_cmp_eq_u32 s25, 0
s_cselect_b32 s34, 16, 24
s_lshl_b32 s35, s80, 7
s_add_u32 s35, s35, 26607616
s_cmp_eq_u32 s24, 1
s_cselect_b32 s35, s35, 1073741824
v_mov_b32 v6, 0
v_mov_b32 v244, 0
v_mov_b32 v245, 0
v_mov_b32 v246, 0
s_add_u32 m0, m0, 4096
s_add_u32 s39, s39, 4096
buffer_load_dwordx4 v1, s[4:7], s39 offen offset:0 sc1 lds
buffer_load_dwordx4 v1, s[4:7], s39 offen offset:1024 sc1 lds
buffer_load_dwordx4 v1, s[4:7], s39 offen offset:2048 sc1 lds
buffer_load_dwordx4 v1, s[4:7], s39 offen offset:3072 sc1 lds
s_mul_i32 s36, s26, 132608
s_mul_i32 s38, s24, 9216
s_add_u32 m0, s38, 49152
s_add_u32 s39, s38, s36
s_add_u32 s39, s39, 49152
s_mov_b64 exec, 1
buffer_atomic_add v244, v6, s[8:11], s35 offen sc0 sc1
s_mov_b64 exec, -1
buffer_load_dwordx4 v1, s[4:7], s39 offen offset:0 sc1 lds
buffer_load_dwordx4 v1, s[4:7], s39 offen offset:1024 sc1 lds
buffer_load_dwordx4 v1, s[4:7], s39 offen offset:2048 sc1 lds
s_mov_b64 exec, 1
buffer_atomic_add v245, v6, s[8:11], s35 offen sc0 sc1
s_mov_b64 exec, -1
buffer_load_dwordx4 v1, s[4:7], s39 offen offset:3072 sc1 lds
s_add_u32 m0, m0, 4096
s_add_u32 s39, s39, 4096
buffer_load_dwordx4 v1, s[4:7], s39 offen offset:0 sc1 lds
buffer_load_dwordx4 v1, s[4:7], s39 offen offset:1024 sc1 lds
s_mov_b64 exec, 1
buffer_atomic_add v246, v6, s[8:11], s35 offen sc0 sc1
s_mov_b64 exec, -1
buffer_load_dwordx4 v1, s[4:7], s39 offen offset:2048 sc1 lds
buffer_load_dwordx4 v1, s[4:7], s39 offen offset:3072 sc1 lds
s_add_u32 m0, m0, 4096
s_add_u32 s39, s39, 4096
buffer_load_dwordx4 v1, s[4:7], s39 offen offset:0 sc1 lds
s_lshl_b32 s60, s25, 3
s_sub_u32 s61, s60, 1
s_max_i32 s61, s61, 0
s_lshl_b32 s30, s24, 1
s_add_u32 s60, s60, s30
s_mul_i32 s30, s61, 18432
s_mul_i32 s62, s60, 18432
v_add_u32 v237, 18432, v1
s_mul_i32 s38, s24, 5120
s_add_u32 m0, s38, 135168
s_add_u32 s39, s38, s30
s_cmp_eq_u32 s24, 1
s_cbranch_scc0 L_other_42
s_mov_b32 s31, 0
s_mov_b64 exec, 1
v_mov_b32 v247, 0
buffer_atomic_add v247, v6, s[8:11], s35 offen sc0 sc1
s_waitcnt vmcnt(12)
v_cmp_gt_u32 vcc, s34, v244
s_nop 0
s_cbranch_vccz L_polled_41
s_waitcnt vmcnt(8)
v_cmp_gt_u32 vcc, s34, v245
s_nop 0
s_cbranch_vccz L_polled_41
v_mov_b32 v244, 0
buffer_atomic_add v244, v6, s[8:11], s35 offen sc0 sc1
s_waitcnt vmcnt(5)
v_cmp_gt_u32 vcc, s34, v246
s_nop 0
s_cbranch_vccz L_polled_41
v_mov_b32 v245, 0
buffer_atomic_add v245, v6, s[8:11], s35 offen sc0 sc1
L_poll_40:
s_add_u32 s31, s31, 1
s_cmp_gt_u32 s31, 100000
s_cbranch_scc1 L_polled_41
v_mov_b32 v246, 0
buffer_atomic_add v246, v6, s[8:11], s35 offen sc0 sc1
s_waitcnt vmcnt(3)
v_cmp_gt_u32 vcc, s34, v247
s_nop 0
s_cbranch_vccz L_polled_41
v_mov_b32 v247, 0
buffer_atomic_add v247, v6, s[8:11], s35 offen sc0 sc1
s_waitcnt vmcnt(3)
v_cmp_gt_u32 vcc, s34, v244
s_nop 0
s_cbranch_vccz L_polled_41
v_mov_b32 v244, 0
buffer_atomic_add v244, v6, s[8:11], s35 offen sc0 sc1
s_waitcnt vmcnt(3)
v_cmp_gt_u32 vcc, s34, v245
s_nop 0
s_cbranch_vccz L_polled_41
v_mov_b32 v245, 0
buffer_atomic_add v245, v6, s[8:11], s35 offen sc0 sc1
s_waitcnt vmcnt(3)
v_cmp_gt_u32 vcc, s34, v246
s_nop 0
s_cbranch_vccz L_polled_41
s_branch L_poll_40
L_polled_41:
s_mov_b64 exec, -1
L_other_42:
s_barrier
s_mov_b32 s29, 1
s_add_u32 s8, s8, 30834688
s_addc_u32 s9, s9, 0
s_mov_b32 s10, 30834688
s_branch L_layer
L_last:
v_cvt_pk_bf16_f32 v148, v16, v17
v_cvt_pk_bf16_f32 v149, v18, v19
v_cvt_pk_bf16_f32 v150, v20, v21
v_cvt_pk_bf16_f32 v151, v22, v23
v_cvt_pk_bf16_f32 v152, v24, v25
v_cvt_pk_bf16_f32 v153, v26, v27
v_cvt_pk_bf16_f32 v154, v28, v29
v_cvt_pk_bf16_f32 v155, v30, v31
v_cvt_pk_bf16_f32 v156, v32, v33
v_cvt_pk_bf16_f32 v157, v34, v35
buffer_store_dwordx4 v[148:151], v164, s[16:19], s68 offen
buffer_store_dwordx4 v[152:155], v164, s[16:19], s68 offen offset:64
v_permlane16_swap_b32 v156, v158
v_permlane16_swap_b32 v157, v159
buffer_store_dwordx4 v[156:159], v165, s[16:19], s68 offen
L_main_fin:
L_main_end:
s_endpgm
L_tagslow_7:
buffer_load_dwordx2 v[238:239], v48, s[84:87], 0 offen sc1
s_add_u32 s31, s31, 1
s_waitcnt vmcnt(0)
v_cmp_eq_u32 vcc, 0, v238
s_cmp_gt_u32 s31, 200000
s_cbranch_scc1 L_tagback_8
s_cbranch_vccnz L_tagslow_7
s_branch L_tagback_8
L_dbslow_11:
s_mov_b32 s67, 0
L_dbslow_11x:
buffer_load_dwordx2 v[148:149], v146, s[4:7], s66 offen sc1
s_add_u32 s67, s67, 1
s_waitcnt vmcnt(0)
v_cmp_ne_u64 vcc, v[148:149], v[238:239]
s_cmp_gt_u32 s67, 200000
s_cbranch_scc1 L_dbback_12
s_cbranch_vccnz L_dbslow_11x
s_branch L_dbback_12
L_stzslow_23:
s_mov_b32 s31, 0
L_stzloop_25:
buffer_load_dwordx2 v[182:183], v234, s[8:11], s61 offen offset:0 sc1
buffer_load_dwordx2 v[184:185], v234, s[8:11], s61 offen offset:1024 sc1
buffer_load_dwordx2 v[186:187], v234, s[8:11], s61 offen offset:2048 sc1
buffer_load_dwordx2 v[188:189], v234, s[8:11], s61 offen offset:3072 sc1
buffer_load_dwordx2 v[190:191], v235, s[8:11], s61 offen offset:0 sc1
buffer_load_dwordx2 v[192:193], v235, s[8:11], s61 offen offset:1024 sc1
buffer_load_dwordx2 v[194:195], v235, s[8:11], s61 offen offset:2048 sc1
buffer_load_dwordx2 v[196:197], v235, s[8:11], s61 offen offset:3072 sc1
s_add_u32 s31, s31, 1
s_waitcnt vmcnt(0)
v_min3_f32 v200, v183, v185, v187
v_min3_f32 v201, v189, v191, v193
v_min3_f32 v200, v200, v195, v197
v_min_f32 v200, v200, v201
v_cmp_gt_f32 vcc, 0, v200
s_cmp_gt_u32 s31, 200000
s_cbranch_scc1 L_stzback_24
s_cbranch_vccnz L_stzloop_25
s_branch L_stzback_24
L_xslow_37:
s_mov_b32 s31, 0
L_xloop_39:
buffer_load_dwordx4 v[80:83], v1, s[8:11], s63 offen offset:0 sc1
buffer_load_dwordx4 v[84:87], v1, s[8:11], s63 offen offset:1024 sc1
buffer_load_dwordx4 v[88:91], v1, s[8:11], s63 offen offset:2048 sc1
buffer_load_dwordx4 v[92:95], v1, s[8:11], s63 offen offset:3072 sc1
s_add_u32 s31, s31, 1
s_waitcnt vmcnt(0)
v_xor_b32 v118, v248, v83
v_xor_b32 v119, v248, v87
v_xor_b32 v120, v248, v91
v_xor_b32 v121, v248, v95
v_or3_b32 v118, v118, v119, v120
v_or_b32 v118, v118, v121
v_cmp_ne_u32 vcc, 0, v118
s_cmp_gt_u32 s31, 200000
s_cbranch_scc1 L_xback_38
s_cbranch_vccnz L_xloop_39
s_branch L_xback_38
L_code_end:
.section .rodata,"a"
.p2align 6
.amdhsa_kernel main_kernel
  .amdhsa_next_free_vgpr 512
  .amdhsa_next_free_sgpr 102
  .amdhsa_accum_offset 256
  .amdhsa_group_segment_fixed_size 0
  .amdhsa_kernarg_size 88
  .amdhsa_user_sgpr_count 2
  .amdhsa_user_sgpr_kernarg_segment_ptr 1
  .amdhsa_system_sgpr_workgroup_id_x 1
  .amdhsa_float_denorm_mode_32 3
.end_amdhsa_kernel
```

```asm
; @launch kernel=main_kernel grid=(256,1,1) block=(256,1,1) lds=163840
.amdgcn_target "amdgcn-amd-amdhsa--gfx950"
.text
.globl main_kernel
.p2align 8
.type main_kernel,@function
main_kernel:
s_cmp_ge_u32 s2, 256
s_cbranch_scc1 L_main_end
s_load_dwordx16 s[64:79], s[0:1], 0
s_memrealtime s[96:97]
s_load_dwordx2 s[4:5], s[0:1], 80
s_load_dwordx2 s[16:17], s[0:1], 64
s_load_dwordx2 s[84:85], s[0:1], 72
s_getpc_b64 s[88:89]
L_pc:
s_mov_b32 s90, L_code_end-L_pc
s_mov_b32 s91, 0x20000
s_lshr_b32 s31, s2, 3
s_lshl_b32 s31, s31, 10
v_lshl_add_u32 v14, v0, 2, s31
s_mov_b32 s37, L_pc-L_pc
buffer_load_dword v15, v14, s[88:91], s37 offen
v_lshrrev_b32 v6, 6, v0
v_and_b32 v0, 63, v0
v_readfirstlane_b32 s24, v6
v_lshlrev_b32 v1, 4, v0
v_and_b32 v2, 15, v0
v_lshrrev_b32 v3, 4, v0
v_cmp_gt_u32 s[50:51], 2, v3
s_nop 0
s_cmp_lt_u32 s2, 128
s_cbranch_scc1 L_p0_x1
s_sub_u32 s30, s2, 128
s_cmp_lt_u32 s30, 108
s_cselect_b32 s62, 0, 1073741824
s_cselect_b32 s30, s30, 0
s_and_b32 s60, s30, 3
s_lshr_b32 s61, s30, 2
s_mov_b32 s14, 1990656
s_mov_b32 s15, 0x20000
s_mul_i32 s30, s60, 497664
s_lshl_b32 s31, s61, 7
s_add_u32 s30, s30, s31
s_mul_i32 s31, s24, 27648
s_add_u32 s30, s30, s31
s_add_u32 s30, s30, s62
v_lshrrev_b32 v36, 7, v1
v_mul_u32_u24 v42, 3456, v36
v_and_b32 v36, 0x70, v1
v_add_u32 v42, v36, v42
s_lshl_b32 s32, s24, 10
s_waitcnt lgkmcnt(0)
s_mov_b32 s12, s66
s_mov_b32 s13, s67
s_add_u32 m0, s32, 0
s_add_u32 s31, s30, 0
buffer_load_dwordx4 v42, s[12:15], s31 offen nt lds
s_add_u32 m0, s32, 4096
s_add_u32 s31, s30, 110592
buffer_load_dwordx4 v42, s[12:15], s31 offen nt lds
s_add_u32 m0, s32, 8192
s_add_u32 s31, s30, 221184
buffer_load_dwordx4 v42, s[12:15], s31 offen nt lds
s_add_u32 m0, s32, 12288
s_add_u32 s31, s30, 331776
buffer_load_dwordx4 v42, s[12:15], s31 offen nt lds
s_add_u32 m0, s32, 16384
s_add_u32 s31, s30, 442368
s_cmp_lt_u32 s24, 2
s_cselect_b32 s31, s31, 1073741824
buffer_load_dwordx4 v42, s[12:15], s31 offen nt lds
s_branch L_p0_j1
L_p0_x1:
s_mov_b32 s14, 2359296
s_mov_b32 s15, 0x20000
s_mul_i32 s30, s24, 18
v_add_u32 v36, s30, v3
v_mul_u32_u24 v42, 1152, v2
v_lshl_add_u32 v42, v36, 4, v42
s_mul_i32 s30, s2, 18432
v_mov_b32 v37, 1073741824
v_cndmask_b32 v37, v37, v42, s[50:51]
s_waitcnt lgkmcnt(0)
s_mov_b32 s12, s64
s_mov_b32 s13, s65
buffer_load_dwordx4 v[64:67], v42, s[12:15], s30 offen offset:0
buffer_load_dwordx4 v[68:71], v42, s[12:15], s30 offen offset:64
buffer_load_dwordx4 v[72:75], v42, s[12:15], s30 offen offset:128
buffer_load_dwordx4 v[76:79], v42, s[12:15], s30 offen offset:192
buffer_load_dwordx4 v[80:83], v37, s[12:15], s30 offen offset:256
L_p0_j1:
s_mov_b32 s86, 256
s_mov_b32 s87, 0x20000
s_xor_b32 s30, s2, 248
s_or_b32 s30, s30, s24
s_cmp_eq_u32 s30, 0
s_cselect_b32 s30, 0, 1073741824
v_mov_b32 v48, 0
s_or_b32 s96, s96, 1
v_mov_b32 v238, s96
v_mov_b32 v239, s97
s_mov_b64 exec, 1
buffer_store_dwordx2 v[238:239], v48, s[84:87], s30 offen sc1
s_mov_b64 exec, -1
v_mov_b32 v4, 1
v_mov_b32 v5, 0
s_mov_b32 s56, 0
s_mov_b32 s29, 0
v_add_u32 v9, 66560, v1
v_cmp_eq_u32 s[46:47], 0, v3
v_cmp_eq_u32 s[48:49], 2, v3
s_mov_b32 s6, 19451904
s_mov_b32 s7, 0x20000
s_mov_b32 s10, 61669376
s_mov_b32 s11, 0x20000
s_mov_b32 s18, 2359296
s_mov_b32 s19, 0x20000
s_mov_b32 s22, 4096
s_mov_b32 s23, 0x20000
s_and_b32 s30, s2, 7
s_lshr_b32 s31, s2, 3
s_lshr_b32 s32, s31, 2
s_and_b32 s33, s31, 3
s_lshr_b32 s25, s30, 2
s_lshl_b32 s25, s25, 3
s_add_u32 s25, s25, s32
s_and_b32 s26, s30, 3
s_lshl_b32 s26, s26, 2
s_add_u32 s26, s26, s33
s_lshl_b32 s80, s25, 4
s_add_u32 s80, s80, s26
s_lshr_b32 s27, s80, 3
s_and_b32 s28, s26, 7
s_lshl_b32 s70, s25, 2
s_add_u32 s70, s70, s24
s_lshl_b32 s70, s70, 1
s_lshr_b32 s32, s26, 3
s_add_u32 s70, s70, s32
s_mul_i32 s71, s28, 9
s_add_u32 s71, s71, 1
s_lshr_b32 s71, s71, 1
s_add_u32 s8, s4, 19451904
s_addc_u32 s9, s5, 0
s_mov_b32 s20, s76
s_mov_b32 s21, s77
v_lshrrev_b32 v36, 2, v2
v_lshl_add_u32 v36, v3, 3, v36
v_lshlrev_b32 v45, 7, v36
v_and_b32 v36, 3, v2
v_lshl_add_u32 v45, v36, 3, v45
s_lshl_b32 s31, s24, 5
v_add_u32 v45, s31, v45
v_mov_b32 v164, 3212836864
v_mov_b32 v165, 3212836864
v_mov_b32 v166, 3212836864
v_mov_b32 v167, 3212836864
s_lshl_b32 s30, s80, 10
s_lshl_b32 s31, s24, 8
s_add_u32 s30, s30, s31
s_add_u32 s30, s30, 26214400
s_mov_b32 s31, 30834688
v_mul_lo_u32 v36, v3, s31
v_lshl_add_u32 v37, v2, 4, v36
s_mov_b32 exec_hi, 0
buffer_store_dwordx4 v[164:167], v37, s[8:11], s30 offen sc1
s_mov_b64 exec, -1
v_add_u32 v38, 7208960, v37
v_lshlrev_b32 v39, 4, v2
v_add_u32 v39, 33193984, v39
v_cndmask_b32 v38, v38, v39, s[48:49]
s_lshl_b32 s30, s70, 7
s_lshl_b32 s31, s28, 14
s_add_u32 s30, s30, s31
s_mov_b32 exec_lo, 0x00ff00ff
s_mov_b32 exec_hi, 0xff
buffer_store_dwordx4 v[164:167], v38, s[8:11], s30 offen sc1
s_mov_b64 exec, -1
v_lshl_add_u32 v37, v2, 15, v36
s_lshl_b32 s30, s2, 7
s_add_u32 s30, s30, 26476544
s_cmp_eq_u32 s24, 0
s_cselect_b32 s30, s30, 1073741824
s_mov_b64 exec, 0x001f001f
buffer_store_dword v48, v37, s[8:11], s30 offen sc1
s_mov_b64 exec, -1
s_cmp_lt_u32 s2, 128
s_cbranch_scc1 L_p0_x2
s_mul_i32 s92, s61, 29
s_lshr_b32 s92, s92, 8
s_mul_i32 s33, s92, 9
s_sub_u32 s33, s61, s33
s_lshl_b32 s33, s33, 6
s_lshl_b32 s31, s24, 4
s_add_u32 s33, s33, s31
v_add_u32 v36, s33, v2
v_mul_u32_u24 v37, 911, v36
v_lshrrev_b32 v37, 14, v37
v_mul_u32_u24 v38, 18, v37
v_sub_u32 v36, v36, v38
v_and_b32 v38, 1, v37
v_lshrrev_b32 v37, 1, v37
s_mov_b32 s31, 132608
v_mul_lo_u32 v37, v37, s31
s_cmp_eq_u32 s92, 0
s_cselect_b32 s93, 5, 0
s_cselect_b32 s94, 8, 4
s_cmp_eq_u32 s92, 2
s_cselect_b32 s93, 2, s93
s_cselect_b32 s94, 0, s94
s_sub_u32 s94, s94, 16
v_add_u32 v39, s93, v38
v_lshl_add_u32 v40, v38, 1, v36
v_add_u32 v40, s94, v40
v_cmp_gt_u32 vcc, 16, v36
s_nop 1
v_cndmask_b32 v39, 4, v39, vcc
v_cndmask_b32 v40, v40, v36, vcc
v_lshl_add_u32 v43, v39, 10, v37
v_lshl_add_u32 v43, v40, 4, v43
v_lshl_add_u32 v44, v39, 9, v37
v_lshl_add_u32 v44, v40, 3, v44
s_lshl_b32 s31, s60, 7
s_add_u32 s31, s31, 129024
v_add_u32 v44, s31, v44
s_mul_i32 s31, s60, 18
v_add_u32 v37, s31, v3
v_and_b32 v38, 3, v37
v_lshrrev_b32 v37, 2, v37
v_mul_u32_u24 v37, 7168, v37
v_add_u32 v43, v43, v37
v_lshl_add_u32 v43, v38, 8, v43
s_waitcnt vmcnt(4)
s_barrier
ds_read_b64_tr_b16 v[64:65], v45 offset:0
ds_read_b64_tr_b16 v[66:67], v45 offset:512
ds_read_b64_tr_b16 v[68:69], v45 offset:4096
ds_read_b64_tr_b16 v[70:71], v45 offset:4608
ds_read_b64_tr_b16 v[72:73], v45 offset:8192
ds_read_b64_tr_b16 v[74:75], v45 offset:8704
ds_read_b64_tr_b16 v[76:77], v45 offset:12288
ds_read_b64_tr_b16 v[78:79], v45 offset:12800
ds_read_b64_tr_b16 v[80:81], v45 offset:16384
ds_read_b64_tr_b16 v[82:83], v45 offset:16896
v_mov_b32 v36, 1073741824
v_mov_b32 v46, 0
v_cndmask_b32 v37, v36, v43, s[50:51]
s_add_u32 s31, s62, 0
s_waitcnt lgkmcnt(8)
buffer_store_dwordx4 v[64:67], v43, s[4:7], s31 offen sc1
s_add_u32 s31, s62, 7168
s_waitcnt lgkmcnt(6)
buffer_store_dwordx4 v[68:71], v43, s[4:7], s31 offen sc1
s_add_u32 s31, s62, 14336
s_waitcnt lgkmcnt(4)
buffer_store_dwordx4 v[72:75], v43, s[4:7], s31 offen sc1
s_add_u32 s31, s62, 21504
s_waitcnt lgkmcnt(2)
buffer_store_dwordx4 v[76:79], v43, s[4:7], s31 offen sc1
s_add_u32 s31, s62, 28672
s_waitcnt lgkmcnt(0)
buffer_store_dwordx4 v[80:83], v37, s[4:7], s31 offen sc1
v_mov_b32 v37, 0x3f803f80
v_dot2c_f32_bf16 v46, v64, v37
v_dot2c_f32_bf16 v46, v65, v37
v_dot2c_f32_bf16 v46, v66, v37
v_dot2c_f32_bf16 v46, v67, v37
v_dot2c_f32_bf16 v46, v68, v37
v_dot2c_f32_bf16 v46, v69, v37
v_dot2c_f32_bf16 v46, v70, v37
v_dot2c_f32_bf16 v46, v71, v37
v_dot2c_f32_bf16 v46, v72, v37
v_dot2c_f32_bf16 v46, v73, v37
v_dot2c_f32_bf16 v46, v74, v37
v_dot2c_f32_bf16 v46, v75, v37
v_dot2c_f32_bf16 v46, v76, v37
v_dot2c_f32_bf16 v46, v77, v37
v_dot2c_f32_bf16 v46, v78, v37
v_dot2c_f32_bf16 v46, v79, v37
v_dot2c_f32_bf16 v46, v80, v37
v_dot2c_f32_bf16 v46, v81, v37
v_dot2c_f32_bf16 v46, v82, v37
v_dot2c_f32_bf16 v46, v83, v37
s_nop 2
v_mov_b32 v37, v46
s_nop 1
v_permlane32_swap_b32 v46, v37
v_add_f32 v46, v46, v37
v_mov_b32 v37, v46
s_nop 1
v_permlane16_swap_b32 v46, v37
v_add_f32 v46, v46, v37
v_cvt_pk_bf16_f32 v50, v46, v46
v_and_b32 v37, 0xffff0000, v50
v_sub_f32 v37, v46, v37
v_cvt_pk_bf16_f32 v51, v37, v37
v_cndmask_b32 v36, v36, v44, s[46:47]
buffer_store_dwordx2 v[50:51], v36, s[4:7], s62 offen sc1
s_branch L_p0_j2
L_p0_x2:
s_mul_i32 s30, s24, 4608
s_mul_i32 s31, s2, 18432
s_add_u32 s31, s31, s30
s_add_u32 s31, s31, 0
v_mov_b32 v36, 1073741824
v_add_u32 v38, 4096, v1
v_cndmask_b32 v38, v36, v38, s[50:51]
v_mov_b32 v46, 0
v_mov_b32 v47, 0
v_mov_b32 v39, 0x3f803f80
s_waitcnt vmcnt(4)
buffer_store_dwordx4 v[64:67], v1, s[8:11], s31 offen offset:0 sc1
buffer_store_dwordx4 v[68:71], v1, s[8:11], s31 offen offset:1024 sc1
buffer_store_dwordx4 v[72:75], v1, s[8:11], s31 offen offset:2048 sc1
buffer_store_dwordx4 v[76:79], v1, s[8:11], s31 offen offset:3072 sc1
buffer_store_dwordx4 v[80:83], v38, s[8:11], s31 offen offset:0 sc1
v_dot2c_f32_bf16 v46, v64, v39
v_dot2c_f32_bf16 v46, v65, v39
v_dot2c_f32_bf16 v46, v66, v39
v_dot2c_f32_bf16 v46, v67, v39
v_dot2c_f32_bf16 v46, v68, v39
v_dot2c_f32_bf16 v46, v69, v39
v_dot2c_f32_bf16 v46, v70, v39
v_dot2c_f32_bf16 v46, v71, v39
v_dot2c_f32_bf16 v46, v72, v39
v_dot2c_f32_bf16 v46, v73, v39
v_dot2c_f32_bf16 v46, v74, v39
v_dot2c_f32_bf16 v46, v75, v39
v_dot2c_f32_bf16 v46, v76, v39
v_dot2c_f32_bf16 v46, v77, v39
v_dot2c_f32_bf16 v46, v78, v39
v_dot2c_f32_bf16 v46, v79, v39
v_dot2c_f32_bf16 v46, v80, v39
v_dot2c_f32_bf16 v46, v81, v39
v_dot2c_f32_bf16 v46, v82, v39
v_dot2c_f32_bf16 v46, v83, v39
v_dot2c_f32_bf16 v47, v64, v64
v_dot2c_f32_bf16 v47, v65, v65
v_dot2c_f32_bf16 v47, v66, v66
v_dot2c_f32_bf16 v47, v67, v67
v_dot2c_f32_bf16 v47, v68, v68
v_dot2c_f32_bf16 v47, v69, v69
v_dot2c_f32_bf16 v47, v70, v70
v_dot2c_f32_bf16 v47, v71, v71
v_dot2c_f32_bf16 v47, v72, v72
v_dot2c_f32_bf16 v47, v73, v73
v_dot2c_f32_bf16 v47, v74, v74
v_dot2c_f32_bf16 v47, v75, v75
v_dot2c_f32_bf16 v47, v76, v76
v_dot2c_f32_bf16 v47, v77, v77
v_dot2c_f32_bf16 v47, v78, v78
v_dot2c_f32_bf16 v47, v79, v79
v_dot2c_f32_bf16 v47, v80, v80
v_dot2c_f32_bf16 v47, v81, v81
v_dot2c_f32_bf16 v47, v82, v82
v_dot2c_f32_bf16 v47, v83, v83
v_mov_b32 v37, v46
s_nop 1
v_permlane32_swap_b32 v46, v37
v_add_f32 v46, v46, v37
v_mov_b32 v37, v46
s_nop 1
v_permlane16_swap_b32 v46, v37
v_add_f32 v46, v46, v37
v_mov_b32 v37, v47
s_nop 1
v_permlane32_swap_b32 v47, v37
v_add_f32 v47, v47, v37
v_mov_b32 v37, v47
s_nop 1
v_permlane16_swap_b32 v47, v37
v_add_f32 v47, v47, v37
s_lshl_b32 s30, s2, 7
s_lshl_b32 s31, s24, 14
s_add_u32 s30, s30, s31
s_add_u32 s30, s30, 2359296
v_cndmask_b32 v50, 0, v46, s[46:47]
v_cndmask_b32 v51, 0, v47, s[46:47]
v_lshlrev_b32 v37, 3, v2
v_lshl_add_u32 v37, v3, 16, v37
v_cndmask_b32 v37, v36, v37, s[50:51]
buffer_store_dwordx2 v[50:51], v37, s[8:11], s30 offen sc1
L_p0_j2:
buffer_load_dwordx2 v[238:239], v48, s[84:87], 0 offen sc1
s_sub_u32 s30, s2, 0
s_cmp_lt_u32 s30, 256
s_cselect_b32 s36, 0, 1073741824
s_cselect_b32 s30, s30, 0
s_and_b32 s34, s30, 3
s_lshr_b32 s35, s30, 2
s_mov_b32 s14, 5308416
s_mov_b32 s15, 0x20000
s_mul_i32 s30, s34, 1327104
s_lshl_b32 s31, s35, 7
s_add_u32 s30, s30, s31
s_mul_i32 s31, s24, 73728
s_add_u32 s30, s30, s31
s_add_u32 s30, s30, s36
v_lshrrev_b32 v36, 7, v1
v_mul_u32_u24 v42, 9216, v36
v_and_b32 v36, 0x70, v1
v_add_u32 v42, v36, v42
s_lshl_b32 s32, s24, 10
s_mov_b32 s12, s72
s_mov_b32 s13, s73
s_add_u32 m0, s32, 20480
s_add_u32 s31, s30, 0
buffer_load_dwordx4 v42, s[12:15], s31 offen nt lds
s_add_u32 m0, s32, 24576
s_add_u32 s31, s30, 294912
buffer_load_dwordx4 v42, s[12:15], s31 offen nt lds
s_add_u32 m0, s32, 28672
s_add_u32 s31, s30, 589824
buffer_load_dwordx4 v42, s[12:15], s31 offen nt lds
s_add_u32 m0, s32, 32768
s_add_u32 s31, s30, 884736
buffer_load_dwordx4 v42, s[12:15], s31 offen nt lds
s_add_u32 m0, s32, 36864
s_add_u32 s31, s30, 1179648
s_cmp_lt_u32 s24, 2
s_cselect_b32 s31, s31, 1073741824
buffer_load_dwordx4 v42, s[12:15], s31 offen nt lds
s_sub_u32 s30, s2, 0
s_cmp_lt_u32 s30, 256
s_cselect_b32 s36, 0, 1073741824
s_cselect_b32 s30, s30, 0
s_and_b32 s34, s30, 3
s_lshr_b32 s35, s30, 2
s_lshl_b32 s92, s35, 6
s_lshl_b32 s33, s24, 4
s_add_u32 s92, s92, s33
s_cmp_ge_u32 s92, 2304
s_cselect_b32 s93, 1, 0
s_cselect_b32 s33, 2304, 0
s_sub_u32 s92, s92, s33
s_mul_i32 s94, s92, 1821
s_lshr_b32 s94, s94, 19
s_mul_i32 s33, s94, 288
s_sub_u32 s92, s92, s33
s_lshr_b32 s95, s92, 5
s_bfe_u32 s96, s92, 0x10004
s_lshl_b32 s94, s94, 1
s_cmp_ge_u32 s92, 144
s_addc_u32 s94, s94, 0
s_cmp_gt_u32 s95, 4
s_cselect_b32 s33, 5, 0
s_sub_u32 s97, s95, s33
s_cmp_eq_u32 s93, 0
s_cselect_b32 s33, 5, 0
s_add_u32 s97, s97, s33
s_cmp_eq_u32 s95, 4
s_cselect_b32 s97, 4, s97
s_mul_i32 s94, s94, 9
s_add_u32 s94, s94, s97
s_mul_i32 s94, s94, 37888
s_add_u32 s94, s94, 2785280
v_and_b32 v36, 3, v2
v_bfe_u32 v37, v2, 2, 1
v_bfe_u32 v38, v2, 3, 1
v_lshl_add_u32 v36, v38, 2, v36
s_lshl_b32 s33, s96, 3
v_add_u32 v36, s33, v36
s_cmp_eq_u32 s95, 4
s_cbranch_scc0 L_w3j_3
s_xor_b32 s33, s93, 1
v_mov_b32 v36, v2
v_mov_b32 v37, s33
L_w3j_3:
v_mul_u32_u24 v170, 18432, v37
v_lshl_add_u32 v170, v36, 4, v170
v_lshl_add_u32 v170, v3, 8, v170
s_mul_i32 s31, s34, 4608
s_add_u32 s31, s31, s94
v_add_u32 v170, s31, v170
v_lshlrev_b32 v171, 9, v37
v_lshl_add_u32 v171, v36, 3, v171
s_lshl_b32 s31, s34, 7
s_add_u32 s31, s31, s94
s_add_u32 s31, s31, 36864
v_add_u32 v171, s31, v171
v_mov_b32 v172, 1073741824
v_mov_b32 v52, 1073741824
v_mov_b32 v53, 1073741824
v_mov_b32 v54, 1073741824
v_mov_b32 v55, 1073741824
v_mov_b32 v56, 1073741824
s_cmp_lt_u32 s2, 32
s_cbranch_scc1 L_p0_a5
s_cmp_lt_u32 s2, 176
s_cbranch_scc1 L_p0_b5
s_sub_u32 s30, s2, 176
s_cmp_lt_u32 s30, 36
s_cselect_b32 s53, 0, 1073741824
s_cselect_b32 s30, s30, 0
s_and_b32 s38, s30, 3
s_lshr_b32 s52, s30, 2
v_lshrrev_b32 v39, 2, v2
v_and_b32 v40, 3, v2
v_lshlrev_b32 v40, 3, v40
s_lshl_b32 s31, s24, 5
v_add_u32 v40, s31, v40
v_lshl_add_u32 v36, v3, 2, v39
v_lshl_add_u32 v52, v36, 7, v40
v_lshrrev_b32 v36, 1, v39
v_mul_u32_u24 v36, 18, v36
v_and_b32 v41, 1, v39
v_add3_u32 v36, v36, v41, 16
v_and_b32 v41, 1, v3
v_mul_u32_u24 v41, 72, v41
v_add_u32 v36, v36, v41
v_lshl_add_u32 v53, v36, 7, v40
s_lshl_b32 s31, s52, 6
s_lshl_b32 s33, s24, 4
s_add_u32 s31, s31, s33
v_add_u32 v36, s31, v2
v_mul_u32_u24 v37, 911, v36
v_lshrrev_b32 v37, 16, v37
v_mul_u32_u24 v38, 72, v37
v_sub_u32 v36, v36, v38
s_mov_b32 s31, 82944
v_mul_lo_u32 v41, v37, s31
v_mov_b32 v173, v37
v_add_u32 v41, 2121728, v41
v_lshrrev_b32 v39, 5, v36
v_lshlrev_b32 v39, 11, v39
v_bfe_u32 v40, v36, 2, 1
v_lshl_add_u32 v39, v40, 10, v39
v_bfe_u32 v40, v36, 3, 2
v_lshl_add_u32 v39, v40, 6, v39
v_and_b32 v40, 3, v36
v_lshl_add_u32 v39, v40, 4, v39
v_lshlrev_b32 v40, 4, v36
v_add_u32 v40, 3072, v40
v_cmp_gt_u32 vcc, 64, v36
v_mov_b32 v47, 7
s_nop 0
v_cndmask_b32 v39, v40, v39, vcc
v_cndmask_b32 v47, v47, 8, vcc
v_add_u32 v41, v41, v39
s_mul_i32 s31, s38, 16
s_add_u32 s31, s31, 0
v_add_u32 v37, s31, v3
v_and_b32 v38, 3, v37
v_lshrrev_b32 v37, 2, v37
v_mul_u32_u24 v37, 4608, v37
v_lshlrev_b32 v38, v47, v38
v_add3_u32 v172, v41, v37, v38
s_mul_i32 s31, s38, 2
s_add_u32 s31, s31, 64
v_add_u32 v37, s31, v3
v_and_b32 v38, 3, v37
v_lshrrev_b32 v37, 2, v37
v_mul_u32_u24 v37, 4608, v37
v_lshlrev_b32 v38, v47, v38
v_add3_u32 v173, v41, v37, v38
s_branch L_p0_j5
L_p0_b5:
s_sub_u32 s30, s2, 32
s_cmp_lt_u32 s30, 144
s_cselect_b32 s53, 0, 1073741824
s_cselect_b32 s30, s30, 0
s_and_b32 s38, s30, 15
s_lshr_b32 s52, s30, 4
s_lshl_b32 s31, s52, 6
s_lshl_b32 s33, s24, 4
s_add_u32 s31, s31, s33
v_add_u32 v36, s31, v2
v_mul_u32_u24 v37, 911, v36
v_lshrrev_b32 v37, 16, v37
v_mul_u32_u24 v38, 72, v37
v_sub_u32 v36, v36, v38
s_mov_b32 s31, 331776
v_mul_lo_u32 v41, v37, s31
v_mov_b32 v173, v37
v_add_u32 v41, 8241152, v41
v_lshrrev_b32 v39, 5, v36
v_lshlrev_b32 v39, 11, v39
v_bfe_u32 v40, v36, 2, 1
v_lshl_add_u32 v39, v40, 10, v39
v_bfe_u32 v40, v36, 3, 2
v_lshl_add_u32 v39, v40, 6, v39
v_and_b32 v40, 3, v36
v_lshl_add_u32 v39, v40, 4, v39
v_lshlrev_b32 v40, 4, v36
v_add_u32 v40, 3072, v40
v_cmp_gt_u32 vcc, 64, v36
v_mov_b32 v47, 7
s_nop 0
v_cndmask_b32 v39, v40, v39, vcc
v_cndmask_b32 v47, v47, 8, vcc
v_add_u32 v41, v41, v39
v_mad_u32_u24 v46, v173, 9, 1
v_lshrrev_b32 v46, 1, v46
s_mul_i32 s31, s38, 18
v_add_u32 v37, s31, v3
v_and_b32 v38, 3, v37
v_lshrrev_b32 v37, 2, v37
v_lshlrev_b32 v38, v47, v38
v_add_u32 v41, v41, v38
s_cmp_ge_u32 s38, 8
s_cselect_b32 s31, 36, 0
v_add_u32 v38, s31, v46
v_sub_u32 v46, 0, v46
s_movk_i32 s31, 4608
v_add_u32 v36, 0, v37
v_sub_u32 v39, v36, v38
v_cmp_gt_u32 vcc, 4, v39
v_ashrrev_i32 v40, 31, v39
v_and_b32 v40, 4, v40
v_cndmask_b32 v40, v40, v46, vcc
v_add_u32 v36, v36, v40
v_mad_u32_u24 v52, v36, s31, v41
v_add_u32 v36, 1, v37
v_sub_u32 v39, v36, v38
v_cmp_gt_u32 vcc, 4, v39
v_ashrrev_i32 v40, 31, v39
v_and_b32 v40, 4, v40
v_cndmask_b32 v40, v40, v46, vcc
v_add_u32 v36, v36, v40
v_mad_u32_u24 v53, v36, s31, v41
v_add_u32 v36, 2, v37
v_sub_u32 v39, v36, v38
v_cmp_gt_u32 vcc, 4, v39
v_ashrrev_i32 v40, 31, v39
v_and_b32 v40, 4, v40
v_cndmask_b32 v40, v40, v46, vcc
v_add_u32 v36, v36, v40
v_mad_u32_u24 v54, v36, s31, v41
v_add_u32 v36, 3, v37
v_sub_u32 v39, v36, v38
v_cmp_gt_u32 vcc, 4, v39
v_ashrrev_i32 v40, 31, v39
v_and_b32 v40, 4, v40
v_cndmask_b32 v40, v40, v46, vcc
v_add_u32 v36, v36, v40
v_mad_u32_u24 v55, v36, s31, v41
v_add_u32 v36, 4, v37
v_sub_u32 v39, v36, v38
v_cmp_gt_u32 vcc, 4, v39
v_ashrrev_i32 v40, 31, v39
v_and_b32 v40, 4, v40
v_cndmask_b32 v40, v40, v46, vcc
v_add_u32 v36, v36, v40
v_mad_u32_u24 v56, v36, s31, v41
s_branch L_p0_j5
L_p0_a5:
s_add_u32 s30, s2, 256
s_cmp_lt_u32 s30, 288
s_cselect_b32 s53, 0, 1073741824
s_cselect_b32 s30, s30, 0
s_and_b32 s38, s30, 3
s_lshr_b32 s52, s30, 2
s_lshl_b32 s92, s52, 6
s_lshl_b32 s33, s24, 4
s_add_u32 s92, s92, s33
s_cmp_ge_u32 s92, 2304
s_cselect_b32 s93, 1, 0
s_cselect_b32 s33, 2304, 0
s_sub_u32 s92, s92, s33
s_mul_i32 s94, s92, 1821
s_lshr_b32 s94, s94, 19
s_mul_i32 s33, s94, 288
s_sub_u32 s92, s92, s33
s_lshr_b32 s95, s92, 5
s_bfe_u32 s96, s92, 0x10004
s_lshl_b32 s94, s94, 1
s_cmp_ge_u32 s92, 144
s_addc_u32 s94, s94, 0
s_cmp_gt_u32 s95, 4
s_cselect_b32 s33, 5, 0
s_sub_u32 s97, s95, s33
s_cmp_eq_u32 s93, 0
s_cselect_b32 s33, 5, 0
s_add_u32 s97, s97, s33
s_cmp_eq_u32 s95, 4
s_cselect_b32 s97, 4, s97
s_mul_i32 s94, s94, 9
s_add_u32 s94, s94, s97
s_mul_i32 s94, s94, 37888
s_add_u32 s94, s94, 2785280
v_and_b32 v36, 3, v2
v_bfe_u32 v37, v2, 2, 1
v_bfe_u32 v38, v2, 3, 1
v_lshl_add_u32 v36, v38, 2, v36
s_lshl_b32 s33, s96, 3
v_add_u32 v36, s33, v36
s_cmp_eq_u32 s95, 4
s_cbranch_scc0 L_w3j_6
s_xor_b32 s33, s93, 1
v_mov_b32 v36, v2
v_mov_b32 v37, s33
L_w3j_6:
v_mul_u32_u24 v172, 18432, v37
v_lshl_add_u32 v172, v36, 4, v172
v_lshl_add_u32 v172, v3, 8, v172
s_mul_i32 s31, s38, 4608
s_add_u32 s31, s31, s94
v_add_u32 v172, s31, v172
v_lshlrev_b32 v173, 9, v37
v_lshl_add_u32 v173, v36, 3, v173
s_lshl_b32 s31, s38, 7
s_add_u32 s31, s31, s94
s_add_u32 s31, s31, 36864
v_add_u32 v173, s31, v173
L_p0_j5:
s_lshl_b32 s30, s25, 2
s_add_u32 s30, s30, s24
s_mul_i32 s31, s30, 133120
s_lshl_b32 s30, s30, 17
s_mul_i32 s32, s24, 0
s_add_u32 s32, s32, s26
s_and_b32 s32, s32, 15
s_lshl_b32 s3, s32, 8
s_add_u32 s3, s3, s30
s_lshl_b32 s101, s32, 12
s_add_u32 s101, s101, s31
s_add_u32 s101, s101, 10895360
v_lshrrev_b32 v41, 4, v1
s_lshl_b32 s30, s25, 3
s_sub_u32 s30, s30, 1
v_add_u32 v36, s30, v41
v_max_i32 v36, 0, v36
v_bfe_u32 v37, v41, 2, 1
v_mul_u32_u24 v37, 35, v37
s_mul_i32 s30, s26, 36
v_add_u32 v37, s30, v37
v_lshrrev_b32 v37, 6, v37
v_bfe_u32 v38, v41, 3, 2
v_mad_u32_u24 v37, v38, 9, v37
v_and_b32 v38, 3, v41
v_lshl_add_u32 v37, v37, 2, v38
v_add_u32 v37, 128, v37
v_cndmask_b32 v36, v37, v36, s[50:51]
v_lshlrev_b32 v174, 7, v36
s_lshl_b32 s30, s2, 7
s_add_u32 s30, s30, 19415040
s_lshl_b32 s32, s2, 3
s_add_u32 s32, s32, 19447808
s_cmp_eq_u32 s24, 0
s_cselect_b32 s30, s30, 1073741824
s_cselect_b32 s100, s32, 1073741824
s_waitcnt vmcnt(5)
v_cmp_eq_u32 vcc, 0, v238
s_mov_b32 s31, 0
s_cbranch_vccnz L_tagslow_7
L_tagback_8:
s_barrier
s_mov_b64 exec, 1
buffer_store_dwordx2 v[238:239], v48, s[4:7], s30 offen sc1
s_mov_b64 exec, -1
s_cmp_lt_u32 s2, 32
s_cbranch_scc1 L_p0_a3
s_cmp_lt_u32 s2, 176
s_cbranch_scc1 L_p0_b3
s_mov_b32 s14, 663552
s_mov_b32 s15, 0x20000
s_mul_i32 s30, s38, 165888
s_lshl_b32 s31, s52, 7
s_add_u32 s30, s30, s31
s_mul_i32 s31, s24, 9216
s_add_u32 s30, s30, s31
s_add_u32 s30, s30, s53
v_lshrrev_b32 v36, 7, v1
v_mul_u32_u24 v42, 1152, v36
v_and_b32 v36, 0x70, v1
v_add_u32 v42, v36, v42
s_lshl_b32 s32, s24, 10
s_mov_b32 s12, s68
s_mov_b32 s13, s69
s_add_u32 m0, s32, 40960
s_add_u32 s31, s30, 0
buffer_load_dwordx4 v42, s[12:15], s31 offen nt lds
s_add_u32 m0, s32, 45056
s_add_u32 s31, s30, 36864
buffer_load_dwordx4 v42, s[12:15], s31 offen nt lds
s_add_u32 m0, s32, 49152
s_add_u32 s31, s30, 73728
buffer_load_dwordx4 v42, s[12:15], s31 offen nt lds
s_add_u32 m0, s32, 53248
s_add_u32 s31, s30, 110592
buffer_load_dwordx4 v42, s[12:15], s31 offen nt lds
s_add_u32 m0, s32, 57344
s_add_u32 s31, s30, 147456
s_cmp_lt_u32 s24, 2
s_cselect_b32 s31, s31, 1073741824
buffer_load_dwordx4 v42, s[12:15], s31 offen nt lds
s_branch L_p0_j3
L_p0_b3:
s_mov_b32 s14, 2654208
s_mov_b32 s15, 0x20000
s_mul_i32 s30, s38, 165888
s_lshl_b32 s31, s52, 7
s_add_u32 s30, s30, s31
s_mul_i32 s31, s24, 9216
s_add_u32 s30, s30, s31
s_add_u32 s30, s30, s53
v_lshrrev_b32 v36, 7, v1
v_mul_u32_u24 v42, 1152, v36
v_and_b32 v36, 0x70, v1
v_add_u32 v42, v36, v42
s_lshl_b32 s32, s24, 10
s_mov_b32 s12, s78
s_mov_b32 s13, s79
s_add_u32 m0, s32, 40960
s_add_u32 s31, s30, 0
buffer_load_dwordx4 v42, s[12:15], s31 offen nt lds
s_add_u32 m0, s32, 45056
s_add_u32 s31, s30, 36864
buffer_load_dwordx4 v42, s[12:15], s31 offen nt lds
s_add_u32 m0, s32, 49152
s_add_u32 s31, s30, 73728
buffer_load_dwordx4 v42, s[12:15], s31 offen nt lds
s_add_u32 m0, s32, 53248
s_add_u32 s31, s30, 110592
buffer_load_dwordx4 v42, s[12:15], s31 offen nt lds
s_add_u32 m0, s32, 57344
s_add_u32 s31, s30, 147456
s_cmp_lt_u32 s24, 2
s_cselect_b32 s31, s31, 1073741824
buffer_load_dwordx4 v42, s[12:15], s31 offen nt lds
s_branch L_p0_j3
L_p0_a3:
s_mov_b32 s14, 5308416
s_mov_b32 s15, 0x20000
s_mul_i32 s30, s38, 1327104
s_lshl_b32 s31, s52, 7
s_add_u32 s30, s30, s31
s_mul_i32 s31, s24, 73728
s_add_u32 s30, s30, s31
s_add_u32 s30, s30, s53
v_lshrrev_b32 v36, 7, v1
v_mul_u32_u24 v42, 9216, v36
v_and_b32 v36, 0x70, v1
v_add_u32 v42, v36, v42
s_lshl_b32 s32, s24, 10
s_mov_b32 s12, s72
s_mov_b32 s13, s73
s_add_u32 m0, s32, 40960
s_add_u32 s31, s30, 0
buffer_load_dwordx4 v42, s[12:15], s31 offen nt lds
s_add_u32 m0, s32, 45056
s_add_u32 s31, s30, 294912
buffer_load_dwordx4 v42, s[12:15], s31 offen nt lds
s_add_u32 m0, s32, 49152
s_add_u32 s31, s30, 589824
buffer_load_dwordx4 v42, s[12:15], s31 offen nt lds
s_add_u32 m0, s32, 53248
s_add_u32 s31, s30, 884736
buffer_load_dwordx4 v42, s[12:15], s31 offen nt lds
s_add_u32 m0, s32, 57344
s_add_u32 s31, s30, 1179648
s_cmp_lt_u32 s24, 2
s_cselect_b32 s31, s31, 1073741824
buffer_load_dwordx4 v42, s[12:15], s31 offen nt lds
L_p0_j3:
s_waitcnt vmcnt(6)
s_barrier
ds_read_b64_tr_b16 v[84:85], v45 offset:20480
ds_read_b64_tr_b16 v[86:87], v45 offset:20992
ds_read_b64_tr_b16 v[88:89], v45 offset:24576
ds_read_b64_tr_b16 v[90:91], v45 offset:25088
ds_read_b64_tr_b16 v[92:93], v45 offset:28672
ds_read_b64_tr_b16 v[94:95], v45 offset:29184
ds_read_b64_tr_b16 v[96:97], v45 offset:32768
ds_read_b64_tr_b16 v[98:99], v45 offset:33280
ds_read_b64_tr_b16 v[100:101], v45 offset:36864
ds_read_b64_tr_b16 v[102:103], v45 offset:37376
v_mov_b32 v36, 1073741824
v_mov_b32 v46, 0
v_cndmask_b32 v37, v36, v170, s[50:51]
s_add_u32 s31, s36, 0
s_waitcnt lgkmcnt(8)
buffer_store_dwordx4 v[84:87], v170, s[4:7], s31 offen sc1
s_add_u32 s31, s36, 1024
s_waitcnt lgkmcnt(6)
buffer_store_dwordx4 v[88:91], v170, s[4:7], s31 offen sc1
s_add_u32 s31, s36, 2048
s_waitcnt lgkmcnt(4)
buffer_store_dwordx4 v[92:95], v170, s[4:7], s31 offen sc1
s_add_u32 s31, s36, 3072
s_waitcnt lgkmcnt(2)
buffer_store_dwordx4 v[96:99], v170, s[4:7], s31 offen sc1
s_add_u32 s31, s36, 4096
s_waitcnt lgkmcnt(0)
buffer_store_dwordx4 v[100:103], v37, s[4:7], s31 offen sc1
v_mov_b32 v37, 0x3f803f80
v_dot2c_f32_bf16 v46, v84, v37
v_dot2c_f32_bf16 v46, v85, v37
v_dot2c_f32_bf16 v46, v86, v37
v_dot2c_f32_bf16 v46, v87, v37
v_dot2c_f32_bf16 v46, v88, v37
v_dot2c_f32_bf16 v46, v89, v37
v_dot2c_f32_bf16 v46, v90, v37
v_dot2c_f32_bf16 v46, v91, v37
v_dot2c_f32_bf16 v46, v92, v37
v_dot2c_f32_bf16 v46, v93, v37
v_dot2c_f32_bf16 v46, v94, v37
v_dot2c_f32_bf16 v46, v95, v37
v_dot2c_f32_bf16 v46, v96, v37
v_dot2c_f32_bf16 v46, v97, v37
v_dot2c_f32_bf16 v46, v98, v37
v_dot2c_f32_bf16 v46, v99, v37
v_dot2c_f32_bf16 v46, v100, v37
v_dot2c_f32_bf16 v46, v101, v37
v_dot2c_f32_bf16 v46, v102, v37
v_dot2c_f32_bf16 v46, v103, v37
s_nop 2
v_mov_b32 v37, v46
s_nop 1
v_permlane32_swap_b32 v46, v37
v_add_f32 v46, v46, v37
v_mov_b32 v37, v46
s_nop 1
v_permlane16_swap_b32 v46, v37
v_add_f32 v46, v46, v37
v_cvt_pk_bf16_f32 v50, v46, v46
v_and_b32 v37, 0xffff0000, v50
v_sub_f32 v37, v46, v37
v_cvt_pk_bf16_f32 v51, v37, v37
v_cndmask_b32 v36, v36, v171, s[46:47]
buffer_store_dwordx2 v[50:51], v36, s[4:7], s36 offen sc1
s_waitcnt vmcnt(6)
s_barrier
s_cmp_lt_u32 s2, 32
s_cbranch_scc1 L_p0_a4
s_cmp_lt_u32 s2, 176
s_cbranch_scc1 L_p0_b4
ds_read_b64_tr_b16 v[104:105], v52 offset:40960
ds_read_b64_tr_b16 v[106:107], v52 offset:43264
ds_read_b64_tr_b16 v[108:109], v52 offset:45568
ds_read_b64_tr_b16 v[110:111], v52 offset:47872
ds_read_b64_tr_b16 v[112:113], v52 offset:50176
ds_read_b64_tr_b16 v[114:115], v52 offset:52480
ds_read_b64_tr_b16 v[116:117], v52 offset:54784
ds_read_b64_tr_b16 v[118:119], v52 offset:57088
ds_read_b64_tr_b16 v[120:121], v53 offset:40960
ds_read_b64_tr_b16 v[122:123], v53 offset:45568
v_mov_b32 v36, 1073741824
v_mov_b32 v46, 0
v_cndmask_b32 v37, v36, v173, s[50:51]
s_add_u32 s31, s53, 0
s_waitcnt lgkmcnt(8)
buffer_store_dwordx4 v[104:107], v172, s[4:7], s31 offen sc1
s_add_u32 s31, s53, 4608
s_waitcnt lgkmcnt(6)
buffer_store_dwordx4 v[108:111], v172, s[4:7], s31 offen sc1
s_add_u32 s31, s53, 9216
s_waitcnt lgkmcnt(4)
buffer_store_dwordx4 v[112:115], v172, s[4:7], s31 offen sc1
s_add_u32 s31, s53, 13824
s_waitcnt lgkmcnt(2)
buffer_store_dwordx4 v[116:119], v172, s[4:7], s31 offen sc1
s_add_u32 s31, s53, 0
s_waitcnt lgkmcnt(0)
buffer_store_dwordx4 v[120:123], v37, s[4:7], s31 offen sc1
buffer_store_dwordx2 v[50:51], v36, s[4:7], s53 offen sc1
s_branch L_p0_j4
L_p0_b4:
ds_read_b64_tr_b16 v[104:105], v45 offset:40960
ds_read_b64_tr_b16 v[106:107], v45 offset:41472
ds_read_b64_tr_b16 v[108:109], v45 offset:45056
ds_read_b64_tr_b16 v[110:111], v45 offset:45568
ds_read_b64_tr_b16 v[112:113], v45 offset:49152
ds_read_b64_tr_b16 v[114:115], v45 offset:49664
ds_read_b64_tr_b16 v[116:117], v45 offset:53248
ds_read_b64_tr_b16 v[118:119], v45 offset:53760
ds_read_b64_tr_b16 v[120:121], v45 offset:57344
ds_read_b64_tr_b16 v[122:123], v45 offset:57856
v_mov_b32 v36, 1073741824
v_mov_b32 v46, 0
v_cndmask_b32 v37, v36, v56, s[50:51]
s_add_u32 s31, s53, 0
s_waitcnt lgkmcnt(8)
buffer_store_dwordx4 v[104:107], v52, s[4:7], s31 offen sc1
s_add_u32 s31, s53, 0
s_waitcnt lgkmcnt(6)
buffer_store_dwordx4 v[108:111], v53, s[4:7], s31 offen sc1
s_add_u32 s31, s53, 0
s_waitcnt lgkmcnt(4)
buffer_store_dwordx4 v[112:115], v54, s[4:7], s31 offen sc1
s_add_u32 s31, s53, 0
s_waitcnt lgkmcnt(2)
buffer_store_dwordx4 v[116:119], v55, s[4:7], s31 offen sc1
s_add_u32 s31, s53, 0
s_waitcnt lgkmcnt(0)
buffer_store_dwordx4 v[120:123], v37, s[4:7], s31 offen sc1
buffer_store_dwordx2 v[50:51], v36, s[4:7], s53 offen sc1
s_branch L_p0_j4
L_p0_a4:
ds_read_b64_tr_b16 v[104:105], v45 offset:40960
ds_read_b64_tr_b16 v[106:107], v45 offset:41472
ds_read_b64_tr_b16 v[108:109], v45 offset:45056
ds_read_b64_tr_b16 v[110:111], v45 offset:45568
ds_read_b64_tr_b16 v[112:113], v45 offset:49152
ds_read_b64_tr_b16 v[114:115], v45 offset:49664
ds_read_b64_tr_b16 v[116:117], v45 offset:53248
ds_read_b64_tr_b16 v[118:119], v45 offset:53760
ds_read_b64_tr_b16 v[120:121], v45 offset:57344
ds_read_b64_tr_b16 v[122:123], v45 offset:57856
v_mov_b32 v36, 1073741824
v_mov_b32 v46, 0
v_cndmask_b32 v37, v36, v172, s[50:51]
s_add_u32 s31, s53, 0
s_waitcnt lgkmcnt(8)
buffer_store_dwordx4 v[104:107], v172, s[4:7], s31 offen sc1
s_add_u32 s31, s53, 1024
s_waitcnt lgkmcnt(6)
buffer_store_dwordx4 v[108:111], v172, s[4:7], s31 offen sc1
s_add_u32 s31, s53, 2048
s_waitcnt lgkmcnt(4)
buffer_store_dwordx4 v[112:115], v172, s[4:7], s31 offen sc1
s_add_u32 s31, s53, 3072
s_waitcnt lgkmcnt(2)
buffer_store_dwordx4 v[116:119], v172, s[4:7], s31 offen sc1
s_add_u32 s31, s53, 4096
s_waitcnt lgkmcnt(0)
buffer_store_dwordx4 v[120:123], v37, s[4:7], s31 offen sc1
v_mov_b32 v37, 0x3f803f80
v_dot2c_f32_bf16 v46, v104, v37
v_dot2c_f32_bf16 v46, v105, v37
v_dot2c_f32_bf16 v46, v106, v37
v_dot2c_f32_bf16 v46, v107, v37
v_dot2c_f32_bf16 v46, v108, v37
v_dot2c_f32_bf16 v46, v109, v37
v_dot2c_f32_bf16 v46, v110, v37
v_dot2c_f32_bf16 v46, v111, v37
v_dot2c_f32_bf16 v46, v112, v37
v_dot2c_f32_bf16 v46, v113, v37
v_dot2c_f32_bf16 v46, v114, v37
v_dot2c_f32_bf16 v46, v115, v37
v_dot2c_f32_bf16 v46, v116, v37
v_dot2c_f32_bf16 v46, v117, v37
v_dot2c_f32_bf16 v46, v118, v37
v_dot2c_f32_bf16 v46, v119, v37
v_dot2c_f32_bf16 v46, v120, v37
v_dot2c_f32_bf16 v46, v121, v37
v_dot2c_f32_bf16 v46, v122, v37
v_dot2c_f32_bf16 v46, v123, v37
s_nop 2
v_mov_b32 v37, v46
s_nop 1
v_permlane32_swap_b32 v46, v37
v_add_f32 v46, v46, v37
v_mov_b32 v37, v46
s_nop 1
v_permlane16_swap_b32 v46, v37
v_add_f32 v46, v46, v37
v_cvt_pk_bf16_f32 v50, v46, v46
v_and_b32 v37, 0xffff0000, v50
v_sub_f32 v37, v46, v37
v_cvt_pk_bf16_f32 v51, v37, v37
v_cndmask_b32 v36, v36, v173, s[46:47]
buffer_store_dwordx2 v[50:51], v36, s[4:7], s53 offen sc1
L_p0_j4:
s_mov_b32 s12, s74
s_mov_b32 s13, s75
s_mov_b32 s14, 8388608
s_mov_b32 s15, 0x20000
s_cmp_eq_u32 s24, 1
s_cselect_b32 s63, 0, 1073741824
s_add_u32 s63, s63, 19415040
s_mov_b32 exec_lo, 0x000001ff
s_mov_b32 exec_hi, 0x00ffffff
buffer_load_dwordx2 v[176:177], v174, s[4:7], s63 offen sc1
s_mov_b64 exec, -1
s_cmp_eq_u32 s24, 1
s_cbranch_scc0 L_p0done_10
s_mov_b32 s31, 0
s_mov_b32 exec_lo, 0x000001ff
s_mov_b32 exec_hi, 0x00ffffff
s_waitcnt vmcnt(0)
v_cmp_ne_u64 vcc, v[176:177], v[238:239]
s_nop 0
s_cbranch_vccz L_p0done_10
L_p0poll_9:
buffer_load_dwordx2 v[176:177], v174, s[4:7], s63 offen sc1
s_add_u32 s31, s31, 1
s_waitcnt vmcnt(0)
v_cmp_ne_u64 vcc, v[176:177], v[238:239]
s_cmp_gt_u32 s31, 200000
s_cbranch_scc1 L_p0done_10
s_cbranch_vccnz L_p0poll_9
L_p0done_10:
s_mov_b64 exec, -1
s_barrier
s_lshl_b32 s33, s25, 8
s_lshl_b32 s32, s24, 6
s_add_u32 s33, s33, s32
v_lshlrev_b32 v8, 1, v2
buffer_load_ushort v0, v8, s[20:23], s33 offen
buffer_load_ushort v249, v8, s[20:23], s33 offen offset:32
s_mul_i32 s30, s70, 18432
s_mul_i32 s31, s28, 2304
s_add_u32 s30, s30, s31
s_add_u32 s30, s30, 0
v_and_b32 v6, 1, v3
v_lshlrev_b32 v6, 3, v6
v_lshl_add_u32 v6, v2, 4, v6
buffer_load_dwordx4 v[36:39], v1, s[8:11], s30 offen sc1
buffer_load_dwordx4 v[40:43], v1, s[8:11], s30 offen offset:1024 sc1
buffer_load_dwordx2 v[44:45], v6, s[8:11], s30 offen offset:2048 sc1
s_mul_i32 s36, s26, 132608
s_mul_i32 s38, s24, 12288
s_add_u32 m0, s38, 0
s_add_u32 s39, s38, s36
buffer_load_dwordx4 v1, s[4:7], s39 offen offset:0 sc1 lds
buffer_load_dwordx4 v1, s[4:7], s39 offen offset:1024 sc1 lds
buffer_load_dwordx4 v1, s[4:7], s39 offen offset:2048 sc1 lds
buffer_load_dwordx4 v1, s[4:7], s39 offen offset:3072 sc1 lds
s_add_u32 m0, m0, 4096
s_add_u32 s39, s39, 4096
buffer_load_dwordx4 v1, s[4:7], s39 offen offset:0 sc1 lds
buffer_load_dwordx4 v1, s[4:7], s39 offen offset:1024 sc1 lds
buffer_load_dwordx4 v1, s[4:7], s39 offen offset:2048 sc1 lds
buffer_load_dwordx4 v1, s[4:7], s39 offen offset:3072 sc1 lds
s_add_u32 m0, m0, 4096
s_add_u32 s39, s39, 4096
buffer_load_dwordx4 v1, s[4:7], s39 offen offset:0 sc1 lds
buffer_load_dwordx4 v1, s[4:7], s39 offen offset:1024 sc1 lds
buffer_load_dwordx4 v1, s[4:7], s39 offen offset:2048 sc1 lds
buffer_load_dwordx4 v1, s[4:7], s39 offen offset:3072 sc1 lds
v_and_b32 v6, 1, v2
v_cmp_eq_u32 s[40:41], 1, v6
v_lshl_add_u32 v6, v3, 2, v6
v_cmp_le_u32 s[42:43], v6, v2
v_add_u32 v6, 2, v6
v_cmp_le_u32 s[44:45], v6, v2
v_mov_b32 v6, 0x0c0c0100
v_mov_b32 v7, 0x01000c0c
v_cndmask_b32 v6, v6, v7, s[40:41]
v_mov_b32 v8, 0x0c0c0c0c
v_cndmask_b32 v10, v6, v8, s[42:43]
v_cndmask_b32 v12, v8, v6, s[42:43]
v_mov_b32 v6, 0x0c0c0302
v_mov_b32 v7, 0x03020c0c
v_cndmask_b32 v6, v6, v7, s[40:41]
v_cndmask_b32 v11, v6, v8, s[44:45]
v_cndmask_b32 v13, v8, v6, s[44:45]
s_mul_i32 s82, s26, 340992
s_add_u32 s82, s82, 2785280
s_mul_i32 s83, s28, 331776
s_add_u32 s83, s83, 8241152
s_and_b32 s30, s27, 1
s_mul_i32 s30, s30, 165888
s_add_u32 s83, s83, s30
s_waitcnt vmcnt(12)
v_lshlrev_b32 v16, 16, v36
v_and_b32 v17, 0xffff0000, v36
v_lshlrev_b32 v18, 16, v37
v_and_b32 v19, 0xffff0000, v37
v_lshlrev_b32 v20, 16, v38
v_and_b32 v21, 0xffff0000, v38
v_lshlrev_b32 v22, 16, v39
v_and_b32 v23, 0xffff0000, v39
v_lshlrev_b32 v24, 16, v40
v_and_b32 v25, 0xffff0000, v40
v_lshlrev_b32 v26, 16, v41
v_and_b32 v27, 0xffff0000, v41
v_lshlrev_b32 v28, 16, v42
v_and_b32 v29, 0xffff0000, v42
v_lshlrev_b32 v30, 16, v43
v_and_b32 v31, 0xffff0000, v43
v_lshlrev_b32 v32, 16, v44
v_and_b32 v33, 0xffff0000, v44
v_lshlrev_b32 v34, 16, v45
v_and_b32 v35, 0xffff0000, v45
v_mov_b32 v6, 0
s_barrier
v_mov_b32 v248, v238
s_mov_b64 exec, 1
buffer_store_dwordx2 v[238:239], v6, s[4:7], s100 offen sc1
s_mov_b64 exec, -1
s_mul_i32 s36, s26, 132608
s_mul_i32 s38, s24, 9216
s_add_u32 m0, s38, 49152
s_add_u32 s39, s38, s36
s_add_u32 s39, s39, 49152
buffer_load_dwordx4 v1, s[4:7], s39 offen offset:0 sc1 lds
buffer_load_dwordx4 v1, s[4:7], s39 offen offset:1024 sc1 lds
buffer_load_dwordx4 v1, s[4:7], s39 offen offset:2048 sc1 lds
buffer_load_dwordx4 v1, s[4:7], s39 offen offset:3072 sc1 lds
s_add_u32 m0, m0, 4096
s_add_u32 s39, s39, 4096
buffer_load_dwordx4 v1, s[4:7], s39 offen offset:0 sc1 lds
buffer_load_dwordx4 v1, s[4:7], s39 offen offset:1024 sc1 lds
buffer_load_dwordx4 v1, s[4:7], s39 offen offset:2048 sc1 lds
buffer_load_dwordx4 v1, s[4:7], s39 offen offset:3072 sc1 lds
s_add_u32 m0, m0, 4096
s_add_u32 s39, s39, 4096
buffer_load_dwordx4 v1, s[4:7], s39 offen offset:0 sc1 lds
s_lshl_b32 s60, s25, 3
s_sub_u32 s61, s60, 1
s_max_i32 s61, s61, 0
s_lshl_b32 s30, s24, 1
s_add_u32 s60, s60, s30
s_mul_i32 s30, s61, 18432
s_mul_i32 s62, s60, 18432
v_add_u32 v237, 18432, v1
s_mul_i32 s38, s24, 5120
s_add_u32 m0, s38, 135168
s_add_u32 s39, s38, s30
L_layer:
buffer_load_dwordx4 v1, s[8:11], s39 offen offset:0 sc1 lds
buffer_load_dwordx4 v1, s[8:11], s39 offen offset:1024 sc1 lds
buffer_load_dwordx4 v1, s[8:11], s39 offen offset:2048 sc1 lds
buffer_load_dwordx4 v1, s[8:11], s39 offen offset:3072 sc1 lds
s_add_u32 m0, m0, 4096
s_add_u32 s39, s39, 4096
buffer_load_dwordx4 v1, s[8:11], s39 offen offset:0 sc1 lds
s_barrier
buffer_load_dwordx4 a[0:3], v1, s[8:11], s62 offen offset:0 sc1
buffer_load_dwordx4 a[4:7], v237, s[8:11], s62 offen offset:0 sc1
s_barrier
buffer_load_dwordx4 a[8:11], v1, s[8:11], s62 offen offset:1024 sc1
buffer_load_dwordx4 a[12:15], v237, s[8:11], s62 offen offset:1024 sc1
s_barrier
buffer_load_dwordx4 a[16:19], v1, s[8:11], s62 offen offset:2048 sc1
buffer_load_dwordx4 a[20:23], v237, s[8:11], s62 offen offset:2048 sc1
s_barrier
buffer_load_dwordx4 a[24:27], v1, s[8:11], s62 offen offset:3072 sc1
buffer_load_dwordx4 a[28:31], v237, s[8:11], s62 offen offset:3072 sc1
s_barrier
s_add_u32 s62, s62, 4096
buffer_load_dwordx4 a[32:35], v1, s[8:11], s62 offen offset:0 sc1
buffer_load_dwordx4 a[36:39], v237, s[8:11], s62 offen offset:0 sc1
s_barrier
buffer_load_dwordx4 a[40:43], v1, s[8:11], s62 offen offset:1024 sc1
buffer_load_dwordx4 a[44:47], v237, s[8:11], s62 offen offset:1024 sc1
s_sub_u32 s30, s60, 2
v_add_u32 v6, s30, v3
v_max_i32 v6, 0, v6
v_mov_b32 v7, s61
v_cndmask_b32 v6, v6, v7, s[46:47]
v_lshl_add_u32 v6, v6, 4, v2
v_lshlrev_b32 v129, 3, v6
s_lshl_b32 s30, s24, 10
v_add_u32 v125, s30, v1
v_add_u32 v126, 135168, v1
v_lshrrev_b32 v127, 1, v1
v_add_u32 v127, 129024, v127
s_lshl_b32 s30, s24, 9
v_add_u32 v128, s30, v127
v_add_u32 v8, 64512, v1
s_waitcnt vmcnt(12)
s_barrier
ds_read_b128 a[144:147], v1 offset:0
ds_read_b128 a[148:151], v1 offset:1024
ds_read_b128 a[152:155], v1 offset:2048
ds_read_b128 a[156:159], v1 offset:3072
ds_read_b128 a[160:163], v1 offset:4096
ds_read_b128 a[164:167], v1 offset:5120
ds_read_b128 a[168:171], v1 offset:6144
ds_read_b128 a[172:175], v125 offset:0
ds_read_b128 a[176:179], v126 offset:0
v_lshrrev_b32 v146, 1, v1
s_lshl_b32 s66, s24, 9
s_add_u32 s66, s66, 19447808
s_waitcnt vmcnt(10) lgkmcnt(0)
v_mfma_f32_16x16x32_bf16 v[36:39], a[144:147], a[0:3], 0
ds_read_b128 a[180:183], v1 offset:7168
buffer_load_dwordx4 a[48:51], v1, s[8:11], s62 offen offset:2048 sc1
v_mfma_f32_16x16x32_bf16 v[64:67], a[144:147], a[4:7], 0
ds_read_b128 a[184:187], v1 offset:8192
v_mfma_f32_16x16x32_bf16 v[40:43], a[148:151], a[0:3], 0
ds_read_b128 a[188:191], v1 offset:9216
v_mfma_f32_16x16x32_bf16 v[68:71], a[148:151], a[4:7], 0
ds_read_b128 a[192:195], v1 offset:10240
v_mfma_f32_16x16x32_bf16 v[44:47], a[152:155], a[0:3], 0
ds_read_b128 a[196:199], v1 offset:11264
buffer_load_dwordx4 a[52:55], v237, s[8:11], s62 offen offset:2048 sc1
v_mfma_f32_16x16x32_bf16 v[72:75], a[152:155], a[4:7], 0
ds_read_b128 a[200:203], v1 offset:12288
v_mfma_f32_16x16x32_bf16 v[48:51], a[156:159], a[0:3], 0
ds_read_b128 a[204:207], v1 offset:13312
v_mfma_f32_16x16x32_bf16 v[76:79], a[156:159], a[4:7], 0
ds_read_b128 a[208:211], v125 offset:7168
v_mfma_f32_16x16x32_bf16 v[52:55], a[160:163], a[0:3], 0
ds_read_b128 a[212:215], v126 offset:1024
buffer_load_dwordx4 a[56:59], v1, s[8:11], s62 offen offset:3072 sc1
v_mfma_f32_16x16x32_bf16 v[80:83], a[160:163], a[4:7], 0
v_mfma_f32_16x16x32_bf16 v[92:95], a[172:175], a[176:179], 0
v_mfma_f32_16x16x32_bf16 v[96:99], a[160:163], a[176:179], 0
v_mfma_f32_16x16x32_bf16 v[56:59], a[164:167], a[0:3], 0
buffer_load_dwordx4 a[60:63], v237, s[8:11], s62 offen offset:3072 sc1
v_mfma_f32_16x16x32_bf16 v[84:87], a[164:167], a[4:7], 0
s_add_u32 s62, s62, 4096
v_mfma_f32_16x16x32_bf16 v[60:63], a[168:171], a[0:3], 0
v_mfma_f32_16x16x32_bf16 v[88:91], a[168:171], a[4:7], 0
s_waitcnt vmcnt(12) lgkmcnt(0)
v_mfma_f32_16x16x32_bf16 v[36:39], a[180:183], a[8:11], v[36:39]
ds_read_b128 a[144:147], v1 offset:14336
v_lshlrev_b32 v124, 2, v2
v_mfma_f32_16x16x32_bf16 v[64:67], a[180:183], a[12:15], v[64:67]
ds_read_b128 a[148:151], v1 offset:15360
v_and_b32 v6, 1, v2
v_mfma_f32_16x16x32_bf16 v[40:43], a[184:187], a[8:11], v[40:43]
ds_read_b128 a[152:155], v1 offset:16384
v_mfma_f32_16x16x32_bf16 v[68:71], a[184:187], a[12:15], v[68:71]
ds_read_b128 a[156:159], v1 offset:17408
v_lshl_add_u32 v6, v3, 2, v6
v_mfma_f32_16x16x32_bf16 v[44:47], a[188:191], a[8:11], v[44:47]
ds_read_b128 a[160:163], v1 offset:18432
v_lshlrev_b32 v6, 2, v6
v_mfma_f32_16x16x32_bf16 v[72:75], a[188:191], a[12:15], v[72:75]
ds_read_b128 a[164:167], v1 offset:19456
buffer_load_dwordx4 a[64:67], v1, s[8:11], s62 offen offset:0 sc1
v_mfma_f32_16x16x32_bf16 v[48:51], a[192:195], a[8:11], v[48:51]
ds_read_b128 a[168:171], v1 offset:20480
v_add_u32 v122, 64, v6
v_mfma_f32_16x16x32_bf16 v[76:79], a[192:195], a[12:15], v[76:79]
ds_read_b128 a[172:175], v125 offset:14336
v_mfma_f32_16x16x32_bf16 v[52:55], a[196:199], a[8:11], v[52:55]
ds_read_b128 a[176:179], v126 offset:2048
v_add_u32 v7, 128, v6
v_mfma_f32_16x16x32_bf16 v[80:83], a[196:199], a[12:15], v[80:83]
buffer_load_dwordx4 a[68:71], v237, s[8:11], s62 offen offset:0 sc1
v_cndmask_b32 v122, v122, v7, s[42:43]
v_mfma_f32_16x16x32_bf16 v[92:95], a[208:211], a[212:215], v[92:95]
v_mfma_f32_16x16x32_bf16 v[96:99], a[196:199], a[212:215], v[96:99]
v_add_u32 v123, 72, v6
v_mfma_f32_16x16x32_bf16 v[56:59], a[200:203], a[8:11], v[56:59]
v_mfma_f32_16x16x32_bf16 v[84:87], a[200:203], a[12:15], v[84:87]
v_add_u32 v7, 136, v6
v_mfma_f32_16x16x32_bf16 v[60:63], a[204:207], a[8:11], v[60:63]
buffer_load_dwordx4 a[72:75], v1, s[8:11], s62 offen offset:1024 sc1
v_cndmask_b32 v123, v123, v7, s[44:45]
v_mfma_f32_16x16x32_bf16 v[88:91], a[204:207], a[12:15], v[88:91]
s_mov_b32 s63, 2359296
s_waitcnt vmcnt(13) lgkmcnt(0)
v_mfma_f32_16x16x32_bf16 v[36:39], a[144:147], a[16:19], v[36:39]
ds_read_b128 a[180:183], v1 offset:21504
s_lshl_b32 s31, s24, 5
v_mfma_f32_16x16x32_bf16 v[64:67], a[144:147], a[20:23], v[64:67]
ds_read_b128 a[184:187], v1 offset:22528
v_mfma_f32_16x16x32_bf16 v[40:43], a[148:151], a[16:19], v[40:43]
ds_read_b128 a[188:191], v1 offset:23552
v_add_u32 v6, s31, v2
v_mfma_f32_16x16x32_bf16 v[68:71], a[148:151], a[20:23], v[68:71]
ds_read_b128 a[192:195], v1 offset:24576
v_mul_u32_u24 v220, 176, v6
v_mfma_f32_16x16x32_bf16 v[44:47], a[152:155], a[16:19], v[44:47]
ds_read_b128 a[196:199], v1 offset:25600
v_mfma_f32_16x16x32_bf16 v[72:75], a[152:155], a[20:23], v[72:75]
ds_read_b128 a[200:203], v1 offset:26624
v_add_u32 v220, 0, v220
v_mfma_f32_16x16x32_bf16 v[48:51], a[156:159], a[16:19], v[48:51]
ds_read_b128 a[204:207], v1 offset:27648
buffer_load_dwordx2 v[100:101], v129, s[8:11], s63 offen sc1
v_mfma_f32_16x16x32_bf16 v[76:79], a[156:159], a[20:23], v[76:79]
ds_read_b128 a[208:211], v125 offset:21504
v_lshl_add_u32 v218, v3, 3, v220
v_mfma_f32_16x16x32_bf16 v[52:55], a[160:163], a[16:19], v[52:55]
ds_read_b128 a[212:215], v126 offset:3072
s_mul_i32 s36, s26, 132608
v_mfma_f32_16x16x32_bf16 v[80:83], a[160:163], a[20:23], v[80:83]
s_mov_b32 s63, 2375680
v_mul_u32_u24 v219, 176, v2
v_mfma_f32_16x16x32_bf16 v[92:95], a[172:175], a[176:179], v[92:95]
s_mul_i32 s38, s24, 12288
v_lshl_add_u32 v219, v3, 3, v219
v_mfma_f32_16x16x32_bf16 v[96:99], a[160:163], a[176:179], v[96:99]
s_add_u32 m0, s38, 86016
v_mfma_f32_16x16x32_bf16 v[56:59], a[164:167], a[16:19], v[56:59]
s_add_u32 s39, s38, s36
v_add_u32 v219, 0, v219
v_mfma_f32_16x16x32_bf16 v[84:87], a[164:167], a[20:23], v[84:87]
s_add_u32 s39, s39, 86016
v_add_u32 v222, s31, v219
v_mfma_f32_16x16x32_bf16 v[60:63], a[168:171], a[16:19], v[60:63]
v_mfma_f32_16x16x32_bf16 v[88:91], a[168:171], a[20:23], v[88:91]
buffer_load_dwordx2 v[102:103], v129, s[8:11], s63 offen sc1
s_waitcnt vmcnt(13) lgkmcnt(0)
v_mfma_f32_16x16x32_bf16 v[36:39], a[180:183], a[24:27], v[36:39]
ds_read_b128 a[144:147], v1 offset:28672
v_lshrrev_b32 v6, 2, v2
v_mfma_f32_16x16x32_bf16 v[64:67], a[180:183], a[28:31], v[64:67]
ds_read_b128 a[148:151], v1 offset:29696
v_lshl_add_u32 v6, v3, 2, v6
v_mfma_f32_16x16x32_bf16 v[40:43], a[184:187], a[24:27], v[40:43]
ds_read_b128 a[152:155], v1 offset:30720
v_add_u32 v6, s31, v6
v_mfma_f32_16x16x32_bf16 v[68:71], a[184:187], a[28:31], v[68:71]
ds_read_b128 a[156:159], v1 offset:31744
s_mov_b32 s63, 2392064
v_mfma_f32_16x16x32_bf16 v[44:47], a[188:191], a[24:27], v[44:47]
ds_read_b128 a[160:163], v1 offset:32768
v_mul_u32_u24 v221, 176, v6
v_mfma_f32_16x16x32_bf16 v[72:75], a[188:191], a[28:31], v[72:75]
ds_read_b128 a[164:167], v1 offset:33792
v_and_b32 v6, 3, v2
v_mfma_f32_16x16x32_bf16 v[48:51], a[192:195], a[24:27], v[48:51]
ds_read_b128 a[168:171], v1 offset:34816
v_mfma_f32_16x16x32_bf16 v[76:79], a[192:195], a[28:31], v[76:79]
ds_read_b128 a[172:175], v125 offset:28672
buffer_load_dwordx2 v[104:105], v129, s[8:11], s63 offen sc1
v_mfma_f32_16x16x32_bf16 v[52:55], a[196:199], a[24:27], v[52:55]
ds_read_b128 a[176:179], v126 offset:4096
v_lshl_add_u32 v221, v6, 3, v221
v_mfma_f32_16x16x32_bf16 v[80:83], a[196:199], a[28:31], v[80:83]
s_mov_b32 s63, 2408448
v_add_u32 v221, 0, v221
v_mfma_f32_16x16x32_bf16 v[92:95], a[208:211], a[212:215], v[92:95]
v_mov_b32 v171, 0
v_mfma_f32_16x16x32_bf16 v[96:99], a[196:199], a[212:215], v[96:99]
v_mfma_f32_16x16x32_bf16 v[56:59], a[200:203], a[24:27], v[56:59]
buffer_load_dwordx4 v1, s[4:7], s39 offen offset:0 sc1 lds
v_mov_b32 v172, 0
v_mfma_f32_16x16x32_bf16 v[84:87], a[200:203], a[28:31], v[84:87]
v_mfma_f32_16x16x32_bf16 v[60:63], a[204:207], a[24:27], v[60:63]
v_mov_b32 v179, 0
v_mfma_f32_16x16x32_bf16 v[88:91], a[204:207], a[28:31], v[88:91]
v_mov_b32 v180, 0
s_waitcnt vmcnt(13) lgkmcnt(0)
v_mfma_f32_16x16x32_bf16 v[36:39], a[144:147], a[32:35], v[36:39]
ds_read_b128 a[180:183], v1 offset:35840
buffer_load_dwordx2 v[106:107], v129, s[8:11], s63 offen sc1
v_mfma_f32_16x16x32_bf16 v[64:67], a[144:147], a[36:39], v[64:67]
ds_read_b128 a[184:187], v1 offset:36864
buffer_load_dwordx4 v1, s[4:7], s39 offen offset:1024 sc1 lds
v_mfma_f32_16x16x32_bf16 v[40:43], a[148:151], a[32:35], v[40:43]
ds_read_b128 a[188:191], v1 offset:37888
s_mul_i32 s30, s60, 18432
v_mfma_f32_16x16x32_bf16 v[68:71], a[148:151], a[36:39], v[68:71]
ds_read_b128 a[192:195], v1 offset:38912
s_add_u32 s30, s30, 2490368
v_mfma_f32_16x16x32_bf16 v[44:47], a[152:155], a[32:35], v[44:47]
ds_read_b128 a[196:199], v1 offset:39936
buffer_load_dwordx4 v1, s[4:7], s39 offen offset:2048 sc1 lds
v_mfma_f32_16x16x32_bf16 v[72:75], a[152:155], a[36:39], v[72:75]
ds_read_b128 a[200:203], v1 offset:40960
s_mov_b32 s63, 2424832
v_mfma_f32_16x16x32_bf16 v[48:51], a[156:159], a[32:35], v[48:51]
ds_read_b128 a[204:207], v1 offset:41984
s_lshl_b32 s64, s26, 10
v_mfma_f32_16x16x32_bf16 v[76:79], a[156:159], a[36:39], v[76:79]
ds_read_b128 a[208:211], v125 offset:35840
s_add_u32 s64, s64, s30
v_mfma_f32_16x16x32_bf16 v[52:55], a[160:163], a[32:35], v[52:55]
ds_read_b128 a[212:215], v126 offset:5120
buffer_load_dwordx2 v[108:109], v129, s[8:11], s63 offen sc1
v_mfma_f32_16x16x32_bf16 v[80:83], a[160:163], a[36:39], v[80:83]
buffer_load_dwordx4 v1, s[4:7], s39 offen offset:3072 sc1 lds
s_and_b32 s65, s26, 1
v_mfma_f32_16x16x32_bf16 v[92:95], a[172:175], a[176:179], v[92:95]
s_mov_b32 s63, 2441216
s_lshl_b32 s65, s65, 10
v_mfma_f32_16x16x32_bf16 v[96:99], a[160:163], a[176:179], v[96:99]
s_add_u32 m0, m0, 4096
s_add_u32 s30, s30, s65
v_mfma_f32_16x16x32_bf16 v[56:59], a[164:167], a[32:35], v[56:59]
s_add_u32 s39, s39, 4096
v_mfma_f32_16x16x32_bf16 v[84:87], a[164:167], a[36:39], v[84:87]
s_lshr_b32 s65, s26, 1
v_mfma_f32_16x16x32_bf16 v[60:63], a[168:171], a[32:35], v[60:63]
s_lshl_b32 s65, s65, 7
v_mfma_f32_16x16x32_bf16 v[88:91], a[168:171], a[36:39], v[88:91]
s_add_u32 s65, s65, s30
s_waitcnt vmcnt(16) lgkmcnt(0)
v_mfma_f32_16x16x32_bf16 v[36:39], a[180:183], a[40:43], v[36:39]
ds_read_b128 a[144:147], v1 offset:43008
v_mfma_f32_16x16x32_bf16 v[64:67], a[180:183], a[44:47], v[64:67]
ds_read_b128 a[148:151], v1 offset:44032
buffer_load_dwordx2 v[110:111], v129, s[8:11], s63 offen sc1
v_mfma_f32_16x16x32_bf16 v[40:43], a[184:187], a[40:43], v[40:43]
ds_read_b128 a[152:155], v1 offset:45056
s_add_u32 s65, s65, 16384
v_mfma_f32_16x16x32_bf16 v[68:71], a[184:187], a[44:47], v[68:71]
ds_read_b128 a[156:159], v1 offset:46080
v_mov_b32 v224, 1073741824
v_mfma_f32_16x16x32_bf16 v[44:47], a[188:191], a[40:43], v[44:47]
ds_read_b128 a[160:163], v1 offset:47104
buffer_load_dwordx4 v1, s[4:7], s39 offen offset:0 sc1 lds
v_mfma_f32_16x16x32_bf16 v[72:75], a[188:191], a[44:47], v[72:75]
ds_read_b128 a[164:167], v1 offset:48128
s_mov_b32 s63, 2457600
v_mfma_f32_16x16x32_bf16 v[48:51], a[192:195], a[40:43], v[48:51]
ds_read_b128 a[168:171], v1 offset:49152
v_lshlrev_b32 v225, 3, v2
v_mfma_f32_16x16x32_bf16 v[76:79], a[192:195], a[44:47], v[76:79]
ds_read_b128 a[172:175], v125 offset:43008
v_cndmask_b32 v224, v224, v225, s[46:47]
v_mfma_f32_16x16x32_bf16 v[52:55], a[196:199], a[40:43], v[52:55]
ds_read_b128 a[176:179], v126 offset:6144
buffer_load_dwordx4 v1, s[4:7], s39 offen offset:1024 sc1 lds
v_mfma_f32_16x16x32_bf16 v[80:83], a[196:199], a[44:47], v[80:83]
v_add_u32 v225, 18432, v224
v_mfma_f32_16x16x32_bf16 v[92:95], a[208:211], a[212:215], v[92:95]
buffer_load_dwordx2 v[112:113], v129, s[8:11], s63 offen sc1
s_lshl_b32 s68, s24, 13
v_mfma_f32_16x16x32_bf16 v[96:99], a[196:199], a[212:215], v[96:99]
s_mov_b32 s63, 2473984
v_add_u32 v6, 0, v3
v_mfma_f32_16x16x32_bf16 v[56:59], a[200:203], a[40:43], v[56:59]
buffer_load_dwordx4 v1, s[4:7], s39 offen offset:2048 sc1 lds
v_mfma_f32_16x16x32_bf16 v[84:87], a[200:203], a[44:47], v[84:87]
v_xor_b32 v7, v6, v2
v_mfma_f32_16x16x32_bf16 v[60:63], a[204:207], a[40:43], v[60:63]
v_mfma_f32_16x16x32_bf16 v[88:91], a[204:207], a[44:47], v[88:91]
v_lshlrev_b32 v6, 12, v6
s_waitcnt vmcnt(19) lgkmcnt(0)
v_mfma_f32_16x16x32_bf16 v[36:39], a[144:147], a[48:51], v[36:39]
ds_read_b128 a[180:183], v1 offset:50176
buffer_load_dwordx4 v1, s[4:7], s39 offen offset:3072 sc1 lds
v_mfma_f32_16x16x32_bf16 v[64:67], a[144:147], a[52:55], v[64:67]
ds_read_b128 a[184:187], v1 offset:51200
v_lshl_add_u32 v240, v7, 4, v6
v_mfma_f32_16x16x32_bf16 v[40:43], a[148:151], a[48:51], v[40:43]
ds_read_b128 a[188:191], v1 offset:52224
buffer_load_dwordx2 v[114:115], v129, s[8:11], s63 offen sc1
v_mfma_f32_16x16x32_bf16 v[68:71], a[148:151], a[52:55], v[68:71]
ds_read_b128 a[192:195], v1 offset:53248
v_lshlrev_b32 v7, 4, v7
v_mfma_f32_16x16x32_bf16 v[44:47], a[152:155], a[48:51], v[44:47]
ds_read_b128 a[196:199], v1 offset:54272
s_add_u32 m0, m0, 4096
v_mfma_f32_16x16x32_bf16 v[72:75], a[152:155], a[52:55], v[72:75]
ds_read_b128 a[200:203], v1 offset:55296
v_lshl_add_u32 v7, v2, 8, v7
v_mfma_f32_16x16x32_bf16 v[48:51], a[156:159], a[48:51], v[48:51]
ds_read_b128 a[204:207], v1 offset:56320
buffer_load_dwordx4 a[76:79], v237, s[8:11], s62 offen offset:1024 sc1
v_mfma_f32_16x16x32_bf16 v[76:79], a[156:159], a[52:55], v[76:79]
ds_read_b128 a[208:211], v125 offset:50176
v_add_u32 v244, s68, v7
v_mfma_f32_16x16x32_bf16 v[52:55], a[160:163], a[48:51], v[52:55]
ds_read_b128 a[212:215], v126 offset:7168
s_add_u32 s39, s39, 4096
v_mfma_f32_16x16x32_bf16 v[80:83], a[160:163], a[52:55], v[80:83]
v_add_u32 v6, 4, v3
v_xor_b32 v7, v6, v2
v_mfma_f32_16x16x32_bf16 v[92:95], a[172:175], a[176:179], v[92:95]
v_lshlrev_b32 v6, 12, v6
v_mfma_f32_16x16x32_bf16 v[96:99], a[160:163], a[176:179], v[96:99]
buffer_load_dwordx4 a[80:83], v1, s[8:11], s62 offen offset:2048 sc1
v_mfma_f32_16x16x32_bf16 v[56:59], a[164:167], a[48:51], v[56:59]
buffer_load_dwordx4 v1, s[4:7], s39 offen offset:0 sc1 lds
v_lshl_add_u32 v241, v7, 4, v6
v_mfma_f32_16x16x32_bf16 v[84:87], a[164:167], a[52:55], v[84:87]
v_mfma_f32_16x16x32_bf16 v[60:63], a[168:171], a[48:51], v[60:63]
v_lshlrev_b32 v7, 4, v7
v_mfma_f32_16x16x32_bf16 v[88:91], a[168:171], a[52:55], v[88:91]
buffer_load_dwordx4 a[84:87], v237, s[8:11], s62 offen offset:2048 sc1
s_waitcnt vmcnt(23) lgkmcnt(0)
v_mfma_f32_16x16x32_bf16 v[36:39], a[180:183], a[56:59], v[36:39]
ds_read_b128 a[144:147], v1 offset:57344
buffer_load_dwordx4 v1, s[4:7], s39 offen offset:1024 sc1 lds
v_mfma_f32_16x16x32_bf16 v[64:67], a[180:183], a[60:63], v[64:67]
ds_read_b128 a[148:151], v1 offset:58368
v_lshl_add_u32 v7, v2, 8, v7
v_mfma_f32_16x16x32_bf16 v[40:43], a[184:187], a[56:59], v[40:43]
ds_read_b128 a[152:155], v1 offset:59392
v_add_u32 v245, s68, v7
v_mfma_f32_16x16x32_bf16 v[68:71], a[184:187], a[60:63], v[68:71]
ds_read_b128 a[156:159], v1 offset:60416
buffer_load_dwordx4 a[88:91], v1, s[8:11], s62 offen offset:3072 sc1
v_mfma_f32_16x16x32_bf16 v[44:47], a[188:191], a[56:59], v[44:47]
ds_read_b128 a[160:163], v1 offset:61440
buffer_load_dwordx4 v1, s[4:7], s39 offen offset:2048 sc1 lds
v_mfma_f32_16x16x32_bf16 v[72:75], a[188:191], a[60:63], v[72:75]
ds_read_b128 a[164:167], v1 offset:62464
v_subrev_u32 v241, 1024, v241
v_mfma_f32_16x16x32_bf16 v[48:51], a[192:195], a[56:59], v[48:51]
ds_read_b128 a[168:171], v1 offset:63488
v_add_u32 v6, 8, v3
v_mfma_f32_16x16x32_bf16 v[76:79], a[192:195], a[60:63], v[76:79]
ds_read_b128 a[172:175], v125 offset:57344
v_xor_b32 v7, v6, v2
v_mfma_f32_16x16x32_bf16 v[52:55], a[196:199], a[56:59], v[52:55]
ds_read_b128 a[176:179], v126 offset:8192
buffer_load_dwordx4 a[92:95], v237, s[8:11], s62 offen offset:3072 sc1
v_mfma_f32_16x16x32_bf16 v[80:83], a[196:199], a[60:63], v[80:83]
buffer_load_dwordx4 v1, s[4:7], s39 offen offset:3072 sc1 lds
v_lshlrev_b32 v6, 12, v6
v_mfma_f32_16x16x32_bf16 v[92:95], a[208:211], a[212:215], v[92:95]
s_add_u32 s62, s62, 4096
v_lshl_add_u32 v242, v7, 4, v6
v_mfma_f32_16x16x32_bf16 v[96:99], a[196:199], a[212:215], v[96:99]
v_lshlrev_b32 v7, 4, v7
v_mfma_f32_16x16x32_bf16 v[56:59], a[200:203], a[56:59], v[56:59]
buffer_load_dwordx2 v[148:149], v146, s[4:7], s66 offen sc1
v_lshl_add_u32 v7, v2, 8, v7
v_mfma_f32_16x16x32_bf16 v[84:87], a[200:203], a[60:63], v[84:87]
v_mfma_f32_16x16x32_bf16 v[60:63], a[204:207], a[56:59], v[60:63]
v_add_u32 v246, s68, v7
v_mfma_f32_16x16x32_bf16 v[88:91], a[204:207], a[60:63], v[88:91]
s_waitcnt vmcnt(27) lgkmcnt(0)
v_add_u32 v125, 64512, v125
v_mfma_f32_16x16x32_bf16 v[36:39], a[144:147], a[64:67], v[36:39]
ds_read_b128 a[180:183], v8 offset:0
buffer_load_dwordx4 a[96:99], v1, s[8:11], s62 offen offset:0 sc1
v_mfma_f32_16x16x32_bf16 v[64:67], a[144:147], a[68:71], v[64:67]
ds_read_b128 a[184:187], v8 offset:1024
v_subrev_u32 v242, 2048, v242
v_mfma_f32_16x16x32_bf16 v[40:43], a[148:151], a[64:67], v[40:43]
ds_read_b128 a[188:191], v8 offset:2048
v_add_u32 v6, 12, v3
v_mfma_f32_16x16x32_bf16 v[68:71], a[148:151], a[68:71], v[68:71]
ds_read_b128 a[192:195], v8 offset:3072
v_xor_b32 v7, v6, v2
v_mfma_f32_16x16x32_bf16 v[44:47], a[152:155], a[64:67], v[44:47]
ds_read_b128 a[196:199], v8 offset:4096
buffer_load_dwordx4 a[100:103], v237, s[8:11], s62 offen offset:0 sc1
v_mfma_f32_16x16x32_bf16 v[72:75], a[152:155], a[68:71], v[72:75]
ds_read_b128 a[200:203], v8 offset:5120
v_lshlrev_b32 v6, 12, v6
v_mfma_f32_16x16x32_bf16 v[48:51], a[156:159], a[64:67], v[48:51]
ds_read_b128 a[204:207], v8 offset:6144
v_lshl_add_u32 v243, v7, 4, v6
v_mfma_f32_16x16x32_bf16 v[76:79], a[156:159], a[68:71], v[76:79]
ds_read_b128 a[208:211], v125 offset:0
v_mfma_f32_16x16x32_bf16 v[52:55], a[160:163], a[64:67], v[52:55]
ds_read_b128 a[212:215], v126 offset:9216
v_lshlrev_b32 v7, 4, v7
v_mfma_f32_16x16x32_bf16 v[80:83], a[160:163], a[68:71], v[80:83]
buffer_load_dwordx4 a[104:107], v1, s[8:11], s62 offen offset:1024 sc1
v_mfma_f32_16x16x32_bf16 v[92:95], a[172:175], a[176:179], v[92:95]
v_lshl_add_u32 v7, v2, 8, v7
v_mfma_f32_16x16x32_bf16 v[96:99], a[160:163], a[176:179], v[96:99]
v_add_u32 v247, s68, v7
v_mfma_f32_16x16x32_bf16 v[56:59], a[164:167], a[64:67], v[56:59]
v_mfma_f32_16x16x32_bf16 v[84:87], a[164:167], a[68:71], v[84:87]
buffer_load_dwordx4 a[108:111], v237, s[8:11], s62 offen offset:1024 sc1
v_subrev_u32 v243, 3072, v243
v_mfma_f32_16x16x32_bf16 v[60:63], a[168:171], a[64:67], v[60:63]
v_mfma_f32_16x16x32_bf16 v[88:91], a[168:171], a[68:71], v[88:91]
s_waitcnt vmcnt(13) lgkmcnt(0)
v_mfma_f32_16x16x32_bf16 v[36:39], a[180:183], a[72:75], v[36:39]
ds_read_b128 a[144:147], v8 offset:7168
v_mfma_f32_16x16x32_bf16 v[64:67], a[180:183], a[76:79], v[64:67]
ds_read_b128 a[148:151], v8 offset:8192
buffer_load_dwordx4 a[112:115], v1, s[8:11], s62 offen offset:2048 sc1
v_mfma_f32_16x16x32_bf16 v[40:43], a[184:187], a[72:75], v[40:43]
ds_read_b128 a[152:155], v8 offset:9216
v_min3_f32 v130, v101, v103, v105
v_mfma_f32_16x16x32_bf16 v[68:71], a[184:187], a[76:79], v[68:71]
ds_read_b128 a[156:159], v8 offset:10240
v_min3_f32 v130, v130, v107, v109
v_mfma_f32_16x16x32_bf16 v[44:47], a[188:191], a[72:75], v[44:47]
ds_read_b128 a[160:163], v8 offset:11264
v_min3_f32 v130, v130, v111, v113
v_mfma_f32_16x16x32_bf16 v[72:75], a[188:191], a[76:79], v[72:75]
ds_read_b128 a[164:167], v8 offset:12288
v_min_f32 v130, v130, v115
v_mfma_f32_16x16x32_bf16 v[48:51], a[192:195], a[72:75], v[48:51]
ds_read_b128 a[168:171], v8 offset:13312
buffer_load_dwordx4 a[116:119], v237, s[8:11], s62 offen offset:2048 sc1
v_mfma_f32_16x16x32_bf16 v[76:79], a[192:195], a[76:79], v[76:79]
ds_read_b128 a[172:175], v125 offset:7168
v_cmp_gt_f32 vcc, 0, v130
v_mfma_f32_16x16x32_bf16 v[52:55], a[196:199], a[72:75], v[52:55]
ds_read_b128 a[176:179], v126 offset:10240
v_mfma_f32_16x16x32_bf16 v[80:83], a[196:199], a[76:79], v[80:83]
s_nop 0
s_cbranch_vccnz L_stslow_11
L_stback_12:
v_mfma_f32_16x16x32_bf16 v[92:95], a[208:211], a[212:215], v[92:95]
buffer_load_dwordx4 a[120:123], v1, s[8:11], s62 offen offset:3072 sc1
v_add_f32 v130, v100, v102
v_mfma_f32_16x16x32_bf16 v[96:99], a[196:199], a[212:215], v[96:99]
v_add_f32 v131, v101, v103
v_add_f32 v130, v130, v104
v_mfma_f32_16x16x32_bf16 v[56:59], a[200:203], a[72:75], v[56:59]
v_add_f32 v131, v131, v105
v_add_f32 v130, v130, v106
v_mfma_f32_16x16x32_bf16 v[84:87], a[200:203], a[76:79], v[84:87]
v_add_f32 v131, v131, v107
v_add_f32 v130, v130, v108
v_mfma_f32_16x16x32_bf16 v[60:63], a[204:207], a[72:75], v[60:63]
buffer_load_dwordx4 a[124:127], v237, s[8:11], s62 offen offset:3072 sc1
v_add_f32 v131, v131, v109
v_mfma_f32_16x16x32_bf16 v[88:91], a[204:207], a[76:79], v[88:91]
s_add_u32 s62, s62, 4096
v_add_f32 v130, v130, v110
s_waitcnt vmcnt(14) lgkmcnt(0)
v_mfma_f32_16x16x32_bf16 v[36:39], a[144:147], a[80:83], v[36:39]
ds_read_b128 a[180:183], v8 offset:14336
v_add_f32 v131, v131, v111
v_mfma_f32_16x16x32_bf16 v[64:67], a[144:147], a[84:87], v[64:67]
ds_read_b128 a[184:187], v8 offset:15360
v_add_f32 v130, v130, v112
v_mfma_f32_16x16x32_bf16 v[40:43], a[148:151], a[80:83], v[40:43]
ds_read_b128 a[188:191], v8 offset:16384
v_add_f32 v131, v131, v113
v_mfma_f32_16x16x32_bf16 v[68:71], a[148:151], a[84:87], v[68:71]
ds_read_b128 a[192:195], v8 offset:17408
v_add_f32 v130, v130, v114
v_mfma_f32_16x16x32_bf16 v[44:47], a[152:155], a[80:83], v[44:47]
ds_read_b128 a[196:199], v8 offset:18432
v_add_f32 v131, v131, v115
v_mfma_f32_16x16x32_bf16 v[72:75], a[152:155], a[84:87], v[72:75]
ds_read_b128 a[200:203], v8 offset:19456
v_mul_f32 v130, 0x3ae38e39, v130
v_mfma_f32_16x16x32_bf16 v[48:51], a[156:159], a[80:83], v[48:51]
ds_read_b128 a[204:207], v8 offset:20480
v_mul_f32 v6, v130, v130
v_mfma_f32_16x16x32_bf16 v[76:79], a[156:159], a[84:87], v[76:79]
ds_read_b128 a[208:211], v125 offset:14336
buffer_load_dwordx4 a[128:131], v1, s[8:11], s62 offen offset:0 sc1
v_mfma_f32_16x16x32_bf16 v[52:55], a[160:163], a[80:83], v[52:55]
ds_read_b128 a[212:215], v126 offset:11264
v_mul_f32 v131, 0x3ae38e39, v131
v_mfma_f32_16x16x32_bf16 v[80:83], a[160:163], a[84:87], v[80:83]
v_sub_f32 v131, v131, v6
v_max_f32 v131, 0, v131
v_mfma_f32_16x16x32_bf16 v[92:95], a[172:175], a[176:179], v[92:95]
v_add_f32 v131, 0x3727c5ac, v131
v_mfma_f32_16x16x32_bf16 v[96:99], a[160:163], a[176:179], v[96:99]
buffer_load_dwordx4 a[132:135], v237, s[8:11], s62 offen offset:0 sc1
v_mfma_f32_16x16x32_bf16 v[56:59], a[164:167], a[80:83], v[56:59]
v_rsq_f32 v132, v131
v_mfma_f32_16x16x32_bf16 v[84:87], a[164:167], a[84:87], v[84:87]
v_cvt_pk_bf16_f32 v6, -v130, -v130
v_and_b32 v6, 0xffff0000, v6
v_add_f32 v6, v130, v6
v_cvt_pk_bf16_f32 v133, -v130, -v6
v_mfma_f32_16x16x32_bf16 v[60:63], a[168:171], a[80:83], v[60:63]
v_mfma_f32_16x16x32_bf16 v[88:91], a[168:171], a[84:87], v[88:91]
s_waitcnt vmcnt(10) lgkmcnt(0)
v_cmp_ne_u64 vcc, v[148:149], v[238:239]
s_cmp_eq_u32 s29, 0
s_cselect_b64 vcc, vcc, 0
s_cbranch_vccnz L_dbslow_14
L_dbback_15:
s_barrier
v_mfma_f32_16x16x32_bf16 v[36:39], a[180:183], a[88:91], v[36:39]
ds_read_b128 a[144:147], v8 offset:21504
buffer_load_dwordx4 a[136:139], v1, s[8:11], s62 offen offset:1024 sc1
v_mfma_f32_16x16x32_bf16 v[64:67], a[180:183], a[92:95], v[64:67]
ds_read_b128 a[148:151], v8 offset:22528
v_mfma_f32_16x16x32_bf16 v[40:43], a[184:187], a[88:91], v[40:43]
ds_read_b128 a[152:155], v8 offset:23552
s_add_u32 m0, s68, 0
v_mfma_f32_16x16x32_bf16 v[68:71], a[184:187], a[92:95], v[68:71]
ds_read_b128 a[156:159], v8 offset:24576
v_mfma_f32_16x16x32_bf16 v[44:47], a[188:191], a[88:91], v[44:47]
ds_read_b128 a[160:163], v8 offset:25600
buffer_load_dwordx4 a[140:143], v237, s[8:11], s62 offen offset:1024 sc1
v_mfma_f32_16x16x32_bf16 v[72:75], a[188:191], a[92:95], v[72:75]
ds_read_b128 a[164:167], v8 offset:26624
s_add_u32 s3, s3, 0
v_mfma_f32_16x16x32_bf16 v[48:51], a[192:195], a[88:91], v[48:51]
ds_read_b128 a[168:171], v8 offset:27648
v_mfma_f32_16x16x32_bf16 v[76:79], a[192:195], a[92:95], v[76:79]
ds_read_b128 a[172:175], v125 offset:21504
buffer_load_dwordx4 v240, s[12:15], s3 offen offset:0 nt lds
v_mfma_f32_16x16x32_bf16 v[52:55], a[196:199], a[88:91], v[52:55]
ds_read_b128 a[176:179], v126 offset:12288
s_mov_b32 s37, L_c2-L_pc
v_mfma_f32_16x16x32_bf16 v[80:83], a[196:199], a[92:95], v[80:83]
ds_bpermute_b32 v116, v124, v133 offset:128
v_mfma_f32_16x16x32_bf16 v[92:95], a[208:211], a[212:215], v[92:95]
ds_bpermute_b32 v118, v124, v133 offset:192
buffer_load_dwordx4 v241, s[12:15], s3 offen offset:1024 nt lds
v_mfma_f32_16x16x32_bf16 v[96:99], a[196:199], a[212:215], v[96:99]
ds_bpermute_b32 v120, v124, v133
v_mfma_f32_16x16x32_bf16 v[56:59], a[200:203], a[88:91], v[56:59]
buffer_load_dword v15, v14, s[88:91], s37 offen
ds_bpermute_b32 v134, v124, v132 offset:128
v_mfma_f32_16x16x32_bf16 v[84:87], a[200:203], a[92:95], v[84:87]
ds_bpermute_b32 v135, v124, v132 offset:192
buffer_load_dwordx4 v242, s[12:15], s3 offen offset:2048 nt lds
v_mfma_f32_16x16x32_bf16 v[60:63], a[204:207], a[88:91], v[60:63]
v_mfma_f32_16x16x32_bf16 v[88:91], a[204:207], a[92:95], v[88:91]
buffer_load_dwordx4 v243, s[12:15], s3 offen offset:3072 nt lds
s_waitcnt vmcnt(15) lgkmcnt(0)
v_mfma_f32_16x16x32_bf16 v[36:39], a[144:147], a[96:99], v[36:39]
ds_read_b128 a[180:183], v8 offset:28672
v_mfma_f32_16x16x32_bf16 v[64:67], a[144:147], a[100:103], v[64:67]
ds_read_b128 a[184:187], v8 offset:29696
v_mfma_f32_16x16x32_bf16 v[40:43], a[148:151], a[96:99], v[40:43]
ds_read_b128 a[188:191], v8 offset:30720
s_add_u32 m0, s68, 4096
v_mfma_f32_16x16x32_bf16 v[68:71], a[148:151], a[100:103], v[68:71]
ds_read_b128 a[192:195], v8 offset:31744
v_mfma_f32_16x16x32_bf16 v[44:47], a[152:155], a[96:99], v[44:47]
ds_read_b128 a[196:199], v8 offset:32768
s_add_u32 s3, s3, 65536
v_mfma_f32_16x16x32_bf16 v[72:75], a[152:155], a[100:103], v[72:75]
ds_read_b128 a[200:203], v8 offset:33792
v_mfma_f32_16x16x32_bf16 v[48:51], a[156:159], a[96:99], v[48:51]
ds_read_b128 a[204:207], v8 offset:34816
v_mfma_f32_16x16x32_bf16 v[76:79], a[156:159], a[100:103], v[76:79]
ds_read_b128 a[208:211], v125 offset:28672
buffer_load_dwordx4 v240, s[12:15], s3 offen offset:0 nt lds
v_mfma_f32_16x16x32_bf16 v[52:55], a[160:163], a[96:99], v[52:55]
ds_read_b128 a[212:215], v126 offset:13312
v_mfma_f32_16x16x32_bf16 v[80:83], a[160:163], a[100:103], v[80:83]
ds_bpermute_b32 v136, v122, v132 offset:0
v_mfma_f32_16x16x32_bf16 v[92:95], a[172:175], a[176:179], v[92:95]
ds_bpermute_b32 v137, v123, v132 offset:0
buffer_load_dwordx4 v241, s[12:15], s3 offen offset:1024 nt lds
v_mfma_f32_16x16x32_bf16 v[96:99], a[160:163], a[176:179], v[96:99]
ds_bpermute_b32 v138, v122, v132 offset:64
v_mfma_f32_16x16x32_bf16 v[56:59], a[164:167], a[96:99], v[56:59]
ds_bpermute_b32 v139, v123, v132 offset:64
buffer_load_dwordx4 v242, s[12:15], s3 offen offset:2048 nt lds
v_mfma_f32_16x16x32_bf16 v[84:87], a[164:167], a[100:103], v[84:87]
v_mfma_f32_16x16x32_bf16 v[60:63], a[168:171], a[96:99], v[60:63]
v_mfma_f32_16x16x32_bf16 v[88:91], a[168:171], a[100:103], v[88:91]
buffer_load_dwordx4 v243, s[12:15], s3 offen offset:3072 nt lds
s_waitcnt vmcnt(17) lgkmcnt(0)
v_mfma_f32_16x16x32_bf16 v[36:39], a[180:183], a[104:107], v[36:39]
ds_read_b128 a[144:147], v8 offset:35840
v_mov_b32 v117, v116
v_mfma_f32_16x16x32_bf16 v[64:67], a[180:183], a[108:111], v[64:67]
ds_read_b128 a[148:151], v8 offset:36864
v_mov_b32 v119, v118
v_mfma_f32_16x16x32_bf16 v[40:43], a[184:187], a[104:107], v[40:43]
ds_read_b128 a[152:155], v8 offset:37888
s_mov_b32 s3, 1073741824
v_mfma_f32_16x16x32_bf16 v[68:71], a[184:187], a[108:111], v[68:71]
ds_read_b128 a[156:159], v8 offset:38912
v_mov_b32 v121, v120
v_mfma_f32_16x16x32_bf16 v[44:47], a[188:191], a[104:107], v[44:47]
ds_read_b128 a[160:163], v8 offset:39936
v_mul_f32 v134, 0x3eae1a93, v134
v_mfma_f32_16x16x32_bf16 v[72:75], a[188:191], a[108:111], v[72:75]
ds_read_b128 a[164:167], v8 offset:40960
s_mul_i32 s36, s28, 82944
v_mfma_f32_16x16x32_bf16 v[48:51], a[192:195], a[104:107], v[48:51]
ds_read_b128 a[168:171], v8 offset:41984
v_mul_f32 v135, 0x3eae1a93, v135
v_mfma_f32_16x16x32_bf16 v[76:79], a[192:195], a[108:111], v[76:79]
ds_read_b128 a[172:175], v125 offset:35840
v_mfma_f32_16x16x32_bf16 v[52:55], a[196:199], a[104:107], v[52:55]
ds_read_b128 a[176:179], v126 offset:14336
s_mul_i32 s38, s24, 8192
v_mfma_f32_16x16x32_bf16 v[80:83], a[196:199], a[108:111], v[80:83]
ds_read_b64 a[0:1], v127 offset:0
v_mul_f32 v140, v134, v136
v_mfma_f32_16x16x32_bf16 v[92:95], a[208:211], a[212:215], v[92:95]
ds_read_b64 a[2:3], v127 offset:512
v_mul_f32 v141, v134, v137
v_mfma_f32_16x16x32_bf16 v[96:99], a[196:199], a[212:215], v[96:99]
s_add_u32 m0, s38, 37888
v_mul_f32 v142, v135, v138
v_mfma_f32_16x16x32_bf16 v[56:59], a[200:203], a[104:107], v[56:59]
ds_read_b64 a[4:5], v127 offset:1024
v_mfma_f32_16x16x32_bf16 v[84:87], a[200:203], a[108:111], v[84:87]
ds_read_b64 a[6:7], v127 offset:1536
v_mul_f32 v143, v135, v139
v_mfma_f32_16x16x32_bf16 v[60:63], a[204:207], a[104:107], v[60:63]
s_cmp_eq_u32 s60, 0
s_cselect_b32 s30, 0xf149f2ca, 0
v_mfma_f32_16x16x32_bf16 v[88:91], a[204:207], a[108:111], v[88:91]
s_add_u32 s39, s38, s36
s_waitcnt vmcnt(15) lgkmcnt(0)
v_mfma_f32_16x16x32_bf16 v[36:39], a[144:147], a[112:115], v[36:39]
ds_read_b128 a[180:183], v8 offset:43008
v_mfma_f32_16x16x32_bf16 v[64:67], a[144:147], a[116:119], v[64:67]
ds_read_b128 a[184:187], v8 offset:44032
v_mfma_f32_16x16x32_bf16 v[40:43], a[148:151], a[112:115], v[40:43]
ds_read_b128 a[188:191], v8 offset:45056
v_mov_b32 v6, s30
v_mfma_f32_16x16x32_bf16 v[68:71], a[148:151], a[116:119], v[68:71]
ds_read_b128 a[192:195], v8 offset:46080
v_cndmask_b32 v144, v6, 0, s[42:43]
v_mfma_f32_16x16x32_bf16 v[44:47], a[152:155], a[112:115], v[44:47]
ds_read_b128 a[196:199], v8 offset:47104
s_add_u32 s39, s39, 2121728
v_mfma_f32_16x16x32_bf16 v[72:75], a[152:155], a[116:119], v[72:75]
ds_read_b128 a[200:203], v8 offset:48128
v_cndmask_b32 v145, v6, 0, s[44:45]
v_mfma_f32_16x16x32_bf16 v[48:51], a[156:159], a[112:115], v[48:51]
ds_read_b128 a[204:207], v8 offset:49152
v_mfma_f32_16x16x32_bf16 v[76:79], a[156:159], a[116:119], v[76:79]
ds_read_b128 a[208:211], v125 offset:43008
v_mov_b32 v100, v136
v_mfma_f32_16x16x32_bf16 v[52:55], a[160:163], a[112:115], v[52:55]
ds_read_b128 a[212:215], v126 offset:15360
buffer_load_dwordx4 v1, s[4:7], s39 offen offset:0 sc1 lds
v_mfma_f32_16x16x32_bf16 v[80:83], a[160:163], a[116:119], v[80:83]
ds_read_b64 a[8:9], v127 offset:2048
v_mov_b32 v104, v138
v_mfma_f32_16x16x32_bf16 v[92:95], a[172:175], a[176:179], v[92:95]
ds_read_b64 a[10:11], v127 offset:2560
v_mov_b32 v102, v136
v_mfma_f32_16x16x32_bf16 v[96:99], a[160:163], a[176:179], v[96:99]
v_mfma_f32_16x16x32_bf16 v[56:59], a[164:167], a[112:115], v[56:59]
ds_read_b64 a[12:13], v127 offset:3072
buffer_load_dwordx4 v1, s[4:7], s39 offen offset:1024 sc1 lds
v_mfma_f32_16x16x32_bf16 v[84:87], a[164:167], a[116:119], v[84:87]
ds_read_b64 a[14:15], v128
v_mov_b32 v106, v138
v_mfma_f32_16x16x32_bf16 v[60:63], a[168:171], a[112:115], v[60:63]
v_mov_b32 v101, v137
v_mfma_f32_16x16x32_bf16 v[88:91], a[168:171], a[116:119], v[88:91]
v_mov_b32 v105, v139
s_waitcnt vmcnt(15) lgkmcnt(0)
v_mfma_f32_16x16x32_bf16 v[36:39], a[180:183], a[120:123], v[36:39]
ds_read_b128 a[144:147], v8 offset:50176
buffer_load_dwordx4 v1, s[4:7], s39 offen offset:2048 sc1 lds
v_mfma_f32_16x16x32_bf16 v[64:67], a[180:183], a[124:127], v[64:67]
ds_read_b128 a[148:151], v8 offset:51200
v_mov_b32 v103, v137
v_mfma_f32_16x16x32_bf16 v[40:43], a[184:187], a[120:123], v[40:43]
ds_read_b128 a[152:155], v8 offset:52224
v_mov_b32 v107, v139
v_mfma_f32_16x16x32_bf16 v[68:71], a[184:187], a[124:127], v[68:71]
ds_read_b128 a[156:159], v8 offset:53248
buffer_load_dwordx4 v1, s[4:7], s39 offen offset:3072 sc1 lds
v_mfma_f32_16x16x32_bf16 v[44:47], a[188:191], a[120:123], v[44:47]
ds_read_b128 a[160:163], v8 offset:54272
v_mfma_f32_16x16x32_bf16 v[72:75], a[188:191], a[124:127], v[72:75]
ds_read_b128 a[164:167], v8 offset:55296
v_mfma_f32_16x16x32_bf16 v[48:51], a[192:195], a[120:123], v[48:51]
ds_read_b128 a[168:171], v8 offset:56320
v_mfma_f32_16x16x32_bf16 v[76:79], a[192:195], a[124:127], v[76:79]
ds_read_b128 a[172:175], v125 offset:50176
s_add_u32 m0, m0, 4096
v_mfma_f32_16x16x32_bf16 v[52:55], a[196:199], a[120:123], v[52:55]
ds_read_b128 a[176:179], v126 offset:16384
s_waitcnt vmcnt(8)
v_mfma_f32_16x16x32_bf16 v[80:83], a[196:199], a[124:127], v[80:83]
ds_read_b128 a[224:227], v244 offset:0
v_mfma_f32_16x16x32_bf16 v[92:95], a[208:211], a[212:215], v[92:95]
ds_read_b128 a[228:231], v245 offset:0
v_mfma_f32_16x16x32_bf16 v[96:99], a[196:199], a[212:215], v[96:99]
s_add_u32 s39, s39, 4096
v_permlane32_swap_b32 v100, v104
v_mfma_f32_16x16x32_bf16 v[56:59], a[200:203], a[120:123], v[56:59]
ds_read_b128 a[232:235], v246 offset:0
v_mfma_f32_16x16x32_bf16 v[84:87], a[200:203], a[124:127], v[84:87]
ds_read_b128 a[236:239], v247 offset:0
v_mfma_f32_16x16x32_bf16 v[60:63], a[204:207], a[120:123], v[60:63]
v_permlane32_swap_b32 v102, v106
v_mfma_f32_16x16x32_bf16 v[88:91], a[204:207], a[124:127], v[88:91]
buffer_load_dwordx4 v1, s[4:7], s39 offen offset:0 sc1 lds
s_waitcnt lgkmcnt(0)
v_mfma_f32_16x16x32_bf16 v[36:39], a[144:147], a[128:131], v[36:39]
ds_read_b128 a[180:183], v8 offset:57344
v_mfma_f32_16x16x32_bf16 v[64:67], a[144:147], a[132:135], v[64:67]
ds_read_b128 a[184:187], v8 offset:58368
v_mfma_f32_16x16x32_bf16 v[40:43], a[148:151], a[128:131], v[40:43]
ds_read_b128 a[188:191], v8 offset:59392
v_mfma_f32_16x16x32_bf16 v[68:71], a[148:151], a[132:135], v[68:71]
ds_read_b128 a[192:195], v8 offset:60416
buffer_load_dwordx4 v1, s[4:7], s39 offen offset:1024 sc1 lds
v_mfma_f32_16x16x32_bf16 v[44:47], a[152:155], a[128:131], v[44:47]
ds_read_b128 a[196:199], v8 offset:61440
v_mfma_f32_16x16x32_bf16 v[72:75], a[152:155], a[132:135], v[72:75]
ds_read_b128 a[200:203], v8 offset:62464
v_mfma_f32_16x16x32_bf16 v[48:51], a[156:159], a[128:131], v[48:51]
ds_read_b128 a[204:207], v8 offset:63488
v_mfma_f32_16x16x32_bf16 v[76:79], a[156:159], a[132:135], v[76:79]
ds_read_b128 a[208:211], v125 offset:57344
buffer_load_dwordx4 v1, s[4:7], s39 offen offset:2048 sc1 lds
v_mfma_f32_16x16x32_bf16 v[52:55], a[160:163], a[128:131], v[52:55]
ds_read_b128 a[212:215], v126 offset:17408
s_waitcnt vmcnt(7)
v_mfma_f32_16x16x32_bf16 v[80:83], a[160:163], a[132:135], v[80:83]
ds_read_b128 a[240:243], v244 offset:4096
v_mfma_f32_16x16x32_bf16 v[92:95], a[172:175], a[176:179], v[92:95]
ds_read_b128 a[244:247], v245 offset:4096
v_mfma_f32_16x16x32_bf16 v[96:99], a[160:163], a[176:179], v[96:99]
ds_read_b128 a[248:251], v246 offset:4096
buffer_load_dwordx4 v1, s[4:7], s39 offen offset:3072 sc1 lds
v_mfma_f32_16x16x32_bf16 v[56:59], a[164:167], a[128:131], v[56:59]
ds_read_b128 a[252:255], v247 offset:4096
v_mfma_f32_16x16x32_bf16 v[84:87], a[164:167], a[132:135], v[84:87]
v_permlane32_swap_b32 v101, v105
v_mfma_f32_16x16x32_bf16 v[60:63], a[168:171], a[128:131], v[60:63]
v_permlane32_swap_b32 v103, v107
v_permlane16_swap_b32 v100, v102
v_permlane16_swap_b32 v104, v106
v_permlane16_swap_b32 v101, v103
v_permlane16_swap_b32 v105, v107
v_mfma_f32_16x16x32_bf16 v[88:91], a[168:171], a[132:135], v[88:91]
s_waitcnt lgkmcnt(0)
s_barrier
v_mfma_f32_16x16x32_bf16 v[36:39], a[180:183], a[136:139], v[36:39]
v_mfma_f32_16x16x32_bf16 v[64:67], a[180:183], a[140:143], v[64:67]
v_mfma_f32_16x16x16_bf16 v[36:39], a[0:1], v[116:117], v[36:39]
v_mfma_f32_16x16x16_bf16 v[64:67], a[0:1], v[118:119], v[64:67]
v_mfma_f32_16x16x32_bf16 v[40:43], a[184:187], a[136:139], v[40:43]
v_mfma_f32_16x16x32_bf16 v[68:71], a[184:187], a[140:143], v[68:71]
s_nop 1
v_mfma_f32_16x16x16_bf16 v[40:43], a[2:3], v[116:117], v[40:43]
s_nop 1
v_mfma_f32_16x16x16_bf16 v[68:71], a[2:3], v[118:119], v[68:71]
v_cvt_pk_bf16_f32 v156, v36, v37
v_cvt_pk_bf16_f32 v157, v38, v39
v_mfma_f32_16x16x32_bf16 v[44:47], a[188:191], a[136:139], v[44:47]
ds_write_b64 v218, v[156:157] offset:2816
v_mfma_f32_16x16x32_bf16 v[72:75], a[188:191], a[140:143], v[72:75]
v_cvt_pk_bf16_f32 v162, v64, v65
v_cvt_pk_bf16_f32 v163, v66, v67
v_mfma_f32_16x16x16_bf16 v[44:47], a[4:5], v[116:117], v[44:47]
ds_write_b64 v218, v[162:163] offset:5632
v_mfma_f32_16x16x16_bf16 v[72:75], a[4:5], v[118:119], v[72:75]
v_cvt_pk_bf16_f32 v160, v40, v41
v_cvt_pk_bf16_f32 v161, v42, v43
v_mfma_f32_16x16x32_bf16 v[48:51], a[192:195], a[136:139], v[48:51]
ds_write_b64 v218, v[160:161] offset:2848
v_mfma_f32_16x16x32_bf16 v[76:79], a[192:195], a[140:143], v[76:79]
v_cvt_pk_bf16_f32 v166, v68, v69
v_cvt_pk_bf16_f32 v167, v70, v71
v_mfma_f32_16x16x16_bf16 v[48:51], a[6:7], v[116:117], v[48:51]
ds_write_b64 v218, v[166:167] offset:5664
v_mfma_f32_16x16x16_bf16 v[76:79], a[6:7], v[118:119], v[76:79]
v_cvt_pk_bf16_f32 v202, v44, v45
v_cvt_pk_bf16_f32 v203, v46, v47
v_mfma_f32_16x16x32_bf16 v[52:55], a[196:199], a[136:139], v[52:55]
ds_write_b64 v218, v[202:203] offset:2880
v_mfma_f32_16x16x32_bf16 v[80:83], a[196:199], a[140:143], v[80:83]
v_cvt_pk_bf16_f32 v204, v72, v73
v_cvt_pk_bf16_f32 v205, v74, v75
v_mfma_f32_16x16x16_bf16 v[52:55], a[8:9], v[116:117], v[52:55]
ds_write_b64 v218, v[204:205] offset:5696
v_mfma_f32_16x16x16_bf16 v[80:83], a[8:9], v[118:119], v[80:83]
v_cvt_pk_bf16_f32 v206, v48, v49
v_cvt_pk_bf16_f32 v207, v50, v51
v_mfma_f32_16x16x32_bf16 v[92:95], a[208:211], a[212:215], v[92:95]
ds_write_b64 v218, v[206:207] offset:2912
v_mfma_f32_16x16x32_bf16 v[96:99], a[196:199], a[212:215], v[96:99]
v_cvt_pk_bf16_f32 v208, v76, v77
v_cvt_pk_bf16_f32 v209, v78, v79
v_mfma_f32_16x16x16_bf16 v[92:95], a[14:15], v[120:121], v[92:95]
ds_write_b64 v218, v[208:209] offset:5728
v_mfma_f32_16x16x16_bf16 v[96:99], a[8:9], v[120:121], v[96:99]
v_cvt_pk_bf16_f32 v210, v52, v53
v_cvt_pk_bf16_f32 v211, v54, v55
v_mfma_f32_16x16x32_bf16 v[56:59], a[200:203], a[136:139], v[56:59]
ds_write_b64 v218, v[210:211] offset:2944
v_mfma_f32_16x16x32_bf16 v[84:87], a[200:203], a[140:143], v[84:87]
v_cvt_pk_bf16_f32 v212, v80, v81
v_cvt_pk_bf16_f32 v213, v82, v83
v_mfma_f32_16x16x16_bf16 v[56:59], a[10:11], v[116:117], v[56:59]
ds_write_b64 v218, v[212:213] offset:5760
v_mfma_f32_16x16x16_bf16 v[84:87], a[10:11], v[118:119], v[84:87]
v_cvt_pk_bf16_f32 v214, v92, v93
v_cvt_pk_bf16_f32 v215, v94, v95
v_mfma_f32_16x16x32_bf16 v[60:63], a[204:207], a[136:139], v[60:63]
ds_write_b64 v222, v[214:215]
v_mfma_f32_16x16x32_bf16 v[88:91], a[204:207], a[140:143], v[88:91]
v_cvt_pk_bf16_f32 v216, v96, v97
v_cvt_pk_bf16_f32 v217, v98, v99
v_mfma_f32_16x16x16_bf16 v[60:63], a[12:13], v[116:117], v[60:63]
ds_write_b64 v219, v[216:217] offset:128
v_mfma_f32_16x16x16_bf16 v[88:91], a[12:13], v[118:119], v[88:91]
s_waitcnt lgkmcnt(0)
s_barrier
ds_read_b64 v[150:151], v218
ds_read_b64 v[154:155], v218 offset:32
ds_read_b64 v[152:153], v220 offset:136
ds_read_b64 v[158:159], v220 offset:2952
ds_read_b64 v[164:165], v220 offset:5768
s_mul_i32 s36, s28, 82944
s_mul_i32 s38, s24, 13312
s_add_u32 m0, s38, 70656
s_add_u32 s39, s38, s36
s_nop 0
s_add_u32 s39, s39, 2154496
buffer_load_dwordx4 v1, s[4:7], s39 offen offset:0 sc1 lds
buffer_load_dwordx4 v1, s[4:7], s39 offen offset:1024 sc1 lds
v_cndmask_b32 v170, 0, v210, s[48:49]
v_cndmask_b32 v173, 0, v211, s[48:49]
v_cndmask_b32 v178, 0, v212, s[48:49]
v_cndmask_b32 v181, 0, v213, s[48:49]
v_cvt_pk_bf16_f32 v168, v56, v57
v_cvt_pk_bf16_f32 v169, v58, v59
v_cvt_pk_bf16_f32 v176, v84, v85
v_cvt_pk_bf16_f32 v177, v86, v87
v_cvt_pk_bf16_f32 v174, v60, v61
v_cvt_pk_bf16_f32 v175, v62, v63
v_cvt_pk_bf16_f32 v182, v88, v89
v_cvt_pk_bf16_f32 v183, v90, v91
s_waitcnt lgkmcnt(0)
s_nop 0
ds_read_b64_tr_b16 v[184:185], v221 offset:64
v_mfma_f32_16x16x32_bf16 v[36:39], v[150:153], v[168:171], 0
ds_read_b64_tr_b16 v[186:187], v221 offset:2880
v_mfma_f32_16x16x32_bf16 v[40:43], v[156:159], v[168:171], 0
ds_read_b64_tr_b16 v[188:189], v221 offset:5696
buffer_load_dwordx4 v1, s[4:7], s39 offen offset:2048 sc1 lds
v_mfma_f32_16x16x32_bf16 v[44:47], v[152:155], v[172:175], 0
ds_read_b64_tr_b16 v[190:191], v221 offset:96
v_mfma_f32_16x16x32_bf16 v[48:51], v[158:161], v[172:175], 0
ds_read_b64_tr_b16 v[192:193], v221 offset:2912
buffer_load_dwordx4 v1, s[4:7], s39 offen offset:3072 sc1 lds
v_mfma_f32_16x16x32_bf16 v[52:55], v[156:159], v[176:179], 0
ds_read_b64_tr_b16 v[194:195], v221 offset:5728
v_mfma_f32_16x16x32_bf16 v[56:59], v[162:165], v[176:179], 0
ds_read_b64_tr_b16 v[196:197], v221 offset:128
s_add_u32 m0, m0, 4096
s_add_u32 s39, s39, 4096
buffer_load_dwordx4 v1, s[4:7], s39 offen offset:0 sc1 lds
v_mfma_f32_16x16x32_bf16 v[60:63], v[158:161], v[180:183], 0
ds_read_b64_tr_b16 v[198:199], v221 offset:2944
v_mfma_f32_16x16x32_bf16 v[64:67], v[164:167], v[180:183], 0
ds_read_b64_tr_b16 v[200:201], v221 offset:5760
buffer_load_dwordx4 v1, s[4:7], s39 offen offset:1024 sc1 lds
v_cndmask_b32 v36, v36, v37, s[40:41]
v_cndmask_b32 v40, v40, v41, s[40:41]
v_cndmask_b32 v68, v36, v40, s[42:43]
v_cndmask_b32 v38, v38, v39, s[40:41]
v_cndmask_b32 v42, v42, v43, s[40:41]
v_cndmask_b32 v69, v38, v42, s[44:45]
v_cndmask_b32 v44, v44, v45, s[40:41]
v_cndmask_b32 v48, v48, v49, s[40:41]
buffer_load_dwordx4 v1, s[4:7], s39 offen offset:2048 sc1 lds
buffer_load_dwordx4 v1, s[4:7], s39 offen offset:3072 sc1 lds
v_cndmask_b32 v70, v44, v48, s[42:43]
v_cndmask_b32 v46, v46, v47, s[40:41]
v_cndmask_b32 v50, v50, v51, s[40:41]
v_cndmask_b32 v71, v46, v50, s[44:45]
v_cndmask_b32 v52, v52, v53, s[40:41]
v_cndmask_b32 v56, v56, v57, s[40:41]
v_cndmask_b32 v72, v52, v56, s[42:43]
s_add_u32 m0, m0, 4096
v_cndmask_b32 v54, v54, v55, s[40:41]
v_cndmask_b32 v58, v58, v59, s[40:41]
v_cndmask_b32 v73, v54, v58, s[44:45]
v_cndmask_b32 v60, v60, v61, s[40:41]
v_cndmask_b32 v64, v64, v65, s[40:41]
v_cndmask_b32 v74, v60, v64, s[42:43]
v_cndmask_b32 v62, v62, v63, s[40:41]
v_cndmask_b32 v66, v66, v67, s[40:41]
s_add_u32 s39, s39, 4096
v_cndmask_b32 v75, v62, v66, s[44:45]
v_pk_fma_f32 v[68:69], v[68:69], v[140:141], v[144:145]
v_pk_mul_f32 v[72:73], v[72:73], v[142:143]
v_pk_fma_f32 v[70:71], v[70:71], v[140:141], v[144:145]
v_pk_mul_f32 v[74:75], v[74:75], v[142:143]
v_permlane32_swap_b32 v68, v72
s_nop 0
buffer_load_dwordx4 v1, s[4:7], s39 offen offset:0 sc1 lds
buffer_load_dwordx4 v1, s[4:7], s39 offen offset:1024 sc1 lds
v_permlane32_swap_b32 v70, v74
v_permlane32_swap_b32 v69, v73
v_permlane32_swap_b32 v71, v75
v_permlane16_swap_b32 v68, v70
v_permlane16_swap_b32 v72, v74
v_permlane16_swap_b32 v69, v71
v_permlane16_swap_b32 v73, v75
v_max3_f32 v76, v68, v69, v70
buffer_load_dwordx4 v1, s[4:7], s39 offen offset:2048 sc1 lds
buffer_load_dwordx4 v1, s[4:7], s39 offen offset:3072 sc1 lds
v_max3_f32 v77, v71, v72, v73
v_max3_f32 v76, v76, v74, v75
v_max_f32 v76, v76, v77
v_pk_add_f32 v[68:69], v[68:69], v[76:77] op_sel_hi:[1,0] neg_lo:[0,1] neg_hi:[0,1]
v_pk_add_f32 v[70:71], v[70:71], v[76:77] op_sel_hi:[1,0] neg_lo:[0,1] neg_hi:[0,1]
v_pk_add_f32 v[72:73], v[72:73], v[76:77] op_sel_hi:[1,0] neg_lo:[0,1] neg_hi:[0,1]
v_pk_add_f32 v[74:75], v[74:75], v[76:77] op_sel_hi:[1,0] neg_lo:[0,1] neg_hi:[0,1]
s_add_u32 m0, m0, 4096
v_exp_f32 v68, v68
v_exp_f32 v69, v69
v_exp_f32 v70, v70
v_exp_f32 v71, v71
v_exp_f32 v72, v72
v_exp_f32 v73, v73
v_exp_f32 v74, v74
v_exp_f32 v75, v75
s_add_u32 s39, s39, 4096
v_pk_add_f32 v[76:77], v[68:69], v[70:71]
v_pk_add_f32 v[78:79], v[72:73], v[74:75]
v_pk_add_f32 v[76:77], v[76:77], v[78:79]
v_add_f32 v76, v76, v77
v_rcp_f32 v76, v76
v_pk_mul_f32 v[68:69], v[68:69], v[100:101]
v_pk_mul_f32 v[70:71], v[70:71], v[102:103]
buffer_load_dwordx4 v1, s[4:7], s39 offen offset:0 sc1 lds
v_pk_mul_f32 v[72:73], v[72:73], v[104:105]
v_pk_mul_f32 v[74:75], v[74:75], v[106:107]
v_pk_mul_f32 v[68:69], v[68:69], v[76:77] op_sel_hi:[1,0]
v_pk_mul_f32 v[70:71], v[70:71], v[76:77] op_sel_hi:[1,0]
v_pk_mul_f32 v[72:73], v[72:73], v[76:77] op_sel_hi:[1,0]
v_pk_mul_f32 v[74:75], v[74:75], v[76:77] op_sel_hi:[1,0]
v_cvt_pk_bf16_f32 v80, v68, v69
v_cvt_pk_bf16_f32 v82, v72, v73
v_cvt_pk_bf16_f32 v81, v70, v71
v_cvt_pk_bf16_f32 v83, v74, v75
v_permlane32_swap_b32 v80, v82
s_waitcnt lgkmcnt(0)
v_permlane32_swap_b32 v81, v83
s_nop 1
v_permlane16_swap_b32 v80, v81
v_permlane16_swap_b32 v82, v83
v_perm_b32 v84, v80, v80, v10
v_perm_b32 v85, v80, v80, v11
v_perm_b32 v86, v80, v80, v12
v_perm_b32 v87, v80, v80, v13
v_perm_b32 v88, v81, v81, v10
v_perm_b32 v89, v81, v81, v11
v_mfma_f32_16x16x32_bf16 v[36:39], v[184:187], v[84:87], 0
v_perm_b32 v90, v81, v81, v12
v_perm_b32 v91, v81, v81, v13
v_mfma_f32_16x16x32_bf16 v[40:43], v[196:199], v[84:87], 0
v_perm_b32 v92, v82, v82, v10
v_perm_b32 v93, v82, v82, v11
v_mfma_f32_16x16x32_bf16 v[44:47], v[190:193], v[88:91], 0
v_perm_b32 v94, v82, v82, v12
v_perm_b32 v95, v82, v82, v13
v_mfma_f32_16x16x32_bf16 v[48:51], v[196:199], v[88:91], 0
v_perm_b32 v96, v83, v83, v10
v_perm_b32 v97, v83, v83, v11
v_mfma_f32_16x16x32_bf16 v[52:55], v[186:189], v[92:95], 0
v_perm_b32 v98, v83, v83, v12
v_perm_b32 v99, v83, v83, v13
v_mfma_f32_16x16x32_bf16 v[56:59], v[198:201], v[92:95], 0
v_cvt_pk_bf16_f32 v168, v36, v37
v_cvt_pk_bf16_f32 v169, v38, v39
v_mfma_f32_16x16x32_bf16 v[60:63], v[192:195], v[96:99], 0
v_mfma_f32_16x16x32_bf16 v[64:67], v[198:201], v[96:99], 0
v_cvt_pk_bf16_f32 v172, v40, v41
v_cvt_pk_bf16_f32 v170, v44, v45
v_cvt_pk_bf16_f32 v171, v46, v47
v_cvt_pk_bf16_f32 v173, v50, v51
buffer_store_dwordx4 v[168:171], v1, s[8:11], s64 offen sc1
buffer_store_dwordx2 v[172:173], v224, s[8:11], s65 offen sc1
v_cvt_pk_bf16_f32 v176, v52, v53
v_cvt_pk_bf16_f32 v177, v54, v55
v_cvt_pk_bf16_f32 v180, v56, v57
v_cvt_pk_bf16_f32 v178, v60, v61
v_cvt_pk_bf16_f32 v179, v62, v63
v_cvt_pk_bf16_f32 v181, v66, v67
buffer_store_dwordx4 v[176:179], v237, s[8:11], s64 offen sc1
buffer_store_dwordx2 v[180:181], v225, s[8:11], s65 offen sc1
L_c2:
s_barrier
s_mul_i32 s38, s24, 9216
s_add_u32 m0, s38, 123904
s_add_u32 s39, s38, s82
buffer_load_dwordx4 v1, s[4:7], s39 offen offset:0 sc1 lds
buffer_load_dwordx4 v1, s[4:7], s39 offen offset:1024 sc1 lds
buffer_load_dwordx4 v1, s[4:7], s39 offen offset:2048 sc1 lds
buffer_load_dwordx4 v1, s[4:7], s39 offen offset:3072 sc1 lds
s_add_u32 m0, m0, 4096
s_add_u32 s39, s39, 4096
buffer_load_dwordx4 v1, s[4:7], s39 offen offset:0 sc1 lds
buffer_load_dwordx4 v1, s[4:7], s39 offen offset:1024 sc1 lds
buffer_load_dwordx4 v1, s[4:7], s39 offen offset:2048 sc1 lds
v_lshlrev_b32 v7, 3, v1
s_lshl_b32 s31, s25, 11
v_add_u32 v7, s31, v7
s_cmp_eq_u32 s24, 0
s_cselect_b32 s30, 0, 1073741824
s_add_u32 s30, s30, 26476544
s_waitcnt vmcnt(7)
s_barrier
s_mov_b64 exec, 0xffff
buffer_atomic_add v4, v7, s[8:11], s30 offen sc1
s_mov_b64 exec, -1
s_lshl_b32 s35, s80, 7
s_add_u32 s35, s35, 26476544
s_cmp_eq_u32 s24, 1
s_cselect_b32 s35, s35, 1073741824
v_mov_b32 v6, 0
v_mov_b32 v244, 0
v_mov_b32 v245, 0
v_mov_b32 v246, 0
buffer_load_dwordx4 v1, s[4:7], s39 offen offset:3072 sc1 lds
s_add_u32 m0, m0, 4096
s_add_u32 s39, s39, 4096
buffer_load_dwordx4 v1, s[4:7], s39 offen offset:0 sc1 lds
s_lshl_b32 s38, s24, 8
s_add_u32 m0, s38, 160768
s_add_u32 s39, s38, s82
s_add_u32 s39, s39, 36864
s_mov_b64 exec, 0xffff
buffer_load_dwordx4 v1, s[4:7], s39 offen sc1 lds
s_mov_b64 exec, -1
s_mul_i32 s38, s24, 9216
s_add_u32 m0, s38, 0
s_add_u32 s39, s38, s82
s_add_u32 s39, s39, 37888
buffer_load_dwordx4 v1, s[4:7], s39 offen offset:0 sc1 lds
s_mov_b64 exec, 1
buffer_atomic_add v244, v6, s[8:11], s35 offen sc0 sc1
s_mov_b64 exec, -1
buffer_load_dwordx4 v1, s[4:7], s39 offen offset:1024 sc1 lds
buffer_load_dwordx4 v1, s[4:7], s39 offen offset:2048 sc1 lds
buffer_load_dwordx4 v1, s[4:7], s39 offen offset:3072 sc1 lds
s_add_u32 m0, m0, 4096
s_add_u32 s39, s39, 4096
s_mov_b64 exec, 1
buffer_atomic_add v245, v6, s[8:11], s35 offen sc0 sc1
s_mov_b64 exec, -1
buffer_load_dwordx4 v1, s[4:7], s39 offen offset:0 sc1 lds
buffer_load_dwordx4 v1, s[4:7], s39 offen offset:1024 sc1 lds
buffer_load_dwordx4 v1, s[4:7], s39 offen offset:2048 sc1 lds
s_mov_b64 exec, 1
buffer_atomic_add v246, v6, s[8:11], s35 offen sc0 sc1
s_mov_b64 exec, -1
buffer_load_dwordx4 v1, s[4:7], s39 offen offset:3072 sc1 lds
s_add_u32 m0, m0, 4096
s_add_u32 s39, s39, 4096
buffer_load_dwordx4 v1, s[4:7], s39 offen offset:0 sc1 lds
s_lshl_b32 s38, s24, 8
s_add_u32 m0, s38, 36864
s_add_u32 s39, s38, s82
s_add_u32 s39, s39, 74752
s_mov_b64 exec, 0xffff
buffer_load_dwordx4 v1, s[4:7], s39 offen sc1 lds
s_mov_b64 exec, -1
s_mul_i32 s60, s70, 18432
s_add_u32 s60, s60, 2490368
s_cmp_eq_u32 s24, 1
s_cbranch_scc0 L_other_18
s_mov_b32 s31, 0
s_mov_b64 exec, 1
v_mov_b32 v247, 0
buffer_atomic_add v247, v6, s[8:11], s35 offen sc0 sc1
s_waitcnt vmcnt(12)
v_cmp_gt_u32 vcc, 16, v244
s_nop 0
s_cbranch_vccz L_polled_17
s_waitcnt vmcnt(8)
v_cmp_gt_u32 vcc, 16, v245
s_nop 0
s_cbranch_vccz L_polled_17
v_mov_b32 v244, 0
buffer_atomic_add v244, v6, s[8:11], s35 offen sc0 sc1
s_waitcnt vmcnt(5)
v_cmp_gt_u32 vcc, 16, v246
s_nop 0
s_cbranch_vccz L_polled_17
v_mov_b32 v245, 0
buffer_atomic_add v245, v6, s[8:11], s35 offen sc0 sc1
L_poll_16:
s_add_u32 s31, s31, 1
s_cmp_gt_u32 s31, 100000
s_cbranch_scc1 L_polled_17
v_mov_b32 v246, 0
buffer_atomic_add v246, v6, s[8:11], s35 offen sc0 sc1
s_waitcnt vmcnt(3)
v_cmp_gt_u32 vcc, 16, v247
s_nop 0
s_cbranch_vccz L_polled_17
v_mov_b32 v247, 0
buffer_atomic_add v247, v6, s[8:11], s35 offen sc0 sc1
s_waitcnt vmcnt(3)
v_cmp_gt_u32 vcc, 16, v244
s_nop 0
s_cbranch_vccz L_polled_17
v_mov_b32 v244, 0
buffer_atomic_add v244, v6, s[8:11], s35 offen sc0 sc1
s_waitcnt vmcnt(3)
v_cmp_gt_u32 vcc, 16, v245
s_nop 0
s_cbranch_vccz L_polled_17
v_mov_b32 v245, 0
buffer_atomic_add v245, v6, s[8:11], s35 offen sc0 sc1
s_waitcnt vmcnt(3)
v_cmp_gt_u32 vcc, 16, v246
s_nop 0
s_cbranch_vccz L_polled_17
s_branch L_poll_16
L_polled_17:
s_mov_b64 exec, -1
L_other_18:
s_barrier
buffer_load_dwordx4 a[0:3], v1, s[8:11], s60 offen offset:0 sc1
buffer_load_dwordx4 a[4:7], v1, s[8:11], s60 offen offset:1024 sc1
s_barrier
buffer_load_dwordx4 a[8:11], v1, s[8:11], s60 offen offset:2048 sc1
buffer_load_dwordx4 a[12:15], v1, s[8:11], s60 offen offset:3072 sc1
s_barrier
s_add_u32 s60, s60, 4096
buffer_load_dwordx4 a[16:19], v1, s[8:11], s60 offen offset:0 sc1
buffer_load_dwordx4 a[20:23], v1, s[8:11], s60 offen offset:1024 sc1
s_barrier
buffer_load_dwordx4 a[24:27], v1, s[8:11], s60 offen offset:2048 sc1
buffer_load_dwordx4 a[28:31], v1, s[8:11], s60 offen offset:3072 sc1
v_lshrrev_b32 v40, 1, v1
v_and_b32 v36, 7, v2
v_lshlrev_b32 v36, 4, v36
v_lshl_add_u32 v36, v3, 7, v36
v_add_u32 v36, 4096, v36
v_add_u32 v36, 37888, v36
v_add_u32 v39, 37888, v1
v_add_u32 v37, 79360, v1
v_add_u32 v38, 41472, v36
ds_read_b128 a[72:75], v39 offset:0
ds_read_b128 a[76:79], v39 offset:1024
ds_read_b128 a[80:83], v39 offset:2048
ds_read_b128 a[84:87], v39 offset:3072
ds_read_b128 a[88:91], v36 offset:0
ds_read_b128 a[92:95], v39 offset:4608
ds_read_b128 a[96:99], v39 offset:5632
ds_read_b128 a[100:103], v39 offset:6656
ds_read_b128 a[104:107], v39 offset:7680
ds_read_b128 a[108:111], v36 offset:4608
v_mov_b32 v58, 1073741824
s_mul_i32 s62, s70, 18432
s_mul_i32 s32, s28, 2304
s_add_u32 s62, s62, s32
s_add_u32 s62, s62, 4849664
v_mov_b32 v60, v1
v_add_u32 v61, 2048, v60
v_cndmask_b32 v61, v58, v61, s[46:47]
s_lshl_b32 s63, s70, 7
s_lshl_b32 s32, s28, 14
s_add_u32 s63, s63, s32
s_add_u32 s63, s63, 7208960
v_lshlrev_b32 v59, 3, v2
v_cndmask_b32 v58, v58, v59, s[46:47]
s_waitcnt vmcnt(7) lgkmcnt(5)
v_mfma_f32_16x16x32_bf16 v[16:19], a[72:75], a[0:3], v[16:19]
ds_read_b128 a[112:115], v39 offset:9216
s_add_u32 s60, s60, 4096
buffer_load_dwordx4 a[32:35], v1, s[8:11], s60 offen offset:0 sc1
v_mfma_f32_16x16x32_bf16 v[20:23], a[76:79], a[0:3], v[20:23]
ds_read_b128 a[116:119], v39 offset:10240
v_mfma_f32_16x16x32_bf16 v[24:27], a[80:83], a[0:3], v[24:27]
ds_read_b128 a[120:123], v39 offset:11264
v_mfma_f32_16x16x32_bf16 v[28:31], a[84:87], a[0:3], v[28:31]
ds_read_b128 a[124:127], v39 offset:12288
v_mfma_f32_16x16x32_bf16 v[32:35], a[88:91], a[0:3], v[32:35]
ds_read_b128 a[128:131], v36 offset:9216
s_waitcnt vmcnt(7) lgkmcnt(5)
v_mfma_f32_16x16x32_bf16 v[16:19], a[92:95], a[4:7], v[16:19]
ds_read_b128 a[72:75], v39 offset:13824
buffer_load_dwordx4 a[36:39], v1, s[8:11], s60 offen offset:1024 sc1
v_mfma_f32_16x16x32_bf16 v[20:23], a[96:99], a[4:7], v[20:23]
ds_read_b128 a[76:79], v39 offset:14848
v_mfma_f32_16x16x32_bf16 v[24:27], a[100:103], a[4:7], v[24:27]
ds_read_b128 a[80:83], v39 offset:15872
v_mfma_f32_16x16x32_bf16 v[28:31], a[104:107], a[4:7], v[28:31]
ds_read_b128 a[84:87], v39 offset:16896
v_mfma_f32_16x16x32_bf16 v[32:35], a[108:111], a[4:7], v[32:35]
ds_read_b128 a[88:91], v36 offset:13824
s_waitcnt vmcnt(7) lgkmcnt(5)
v_mfma_f32_16x16x32_bf16 v[16:19], a[112:115], a[8:11], v[16:19]
ds_read_b128 a[92:95], v39 offset:18432
buffer_load_dwordx4 a[40:43], v1, s[8:11], s60 offen offset:2048 sc1
v_mfma_f32_16x16x32_bf16 v[20:23], a[116:119], a[8:11], v[20:23]
ds_read_b128 a[96:99], v39 offset:19456
v_mfma_f32_16x16x32_bf16 v[24:27], a[120:123], a[8:11], v[24:27]
ds_read_b128 a[100:103], v39 offset:20480
v_mfma_f32_16x16x32_bf16 v[28:31], a[124:127], a[8:11], v[28:31]
ds_read_b128 a[104:107], v39 offset:21504
v_mfma_f32_16x16x32_bf16 v[32:35], a[128:131], a[8:11], v[32:35]
ds_read_b128 a[108:111], v36 offset:18432
s_waitcnt vmcnt(7) lgkmcnt(5)
v_mfma_f32_16x16x32_bf16 v[16:19], a[72:75], a[12:15], v[16:19]
ds_read_b128 a[112:115], v39 offset:23040
buffer_load_dwordx4 a[44:47], v1, s[8:11], s60 offen offset:3072 sc1
v_mfma_f32_16x16x32_bf16 v[20:23], a[76:79], a[12:15], v[20:23]
ds_read_b128 a[116:119], v39 offset:24064
v_mfma_f32_16x16x32_bf16 v[24:27], a[80:83], a[12:15], v[24:27]
ds_read_b128 a[120:123], v39 offset:25088
v_mfma_f32_16x16x32_bf16 v[28:31], a[84:87], a[12:15], v[28:31]
ds_read_b128 a[124:127], v39 offset:26112
v_mfma_f32_16x16x32_bf16 v[32:35], a[88:91], a[12:15], v[32:35]
ds_read_b128 a[128:131], v36 offset:23040
s_waitcnt vmcnt(7) lgkmcnt(5)
v_mfma_f32_16x16x32_bf16 v[16:19], a[92:95], a[16:19], v[16:19]
ds_read_b128 a[72:75], v39 offset:27648
s_add_u32 s60, s60, 4096
buffer_load_dwordx4 a[48:51], v1, s[8:11], s60 offen offset:0 sc1
v_mfma_f32_16x16x32_bf16 v[20:23], a[96:99], a[16:19], v[20:23]
ds_read_b128 a[76:79], v39 offset:28672
v_mfma_f32_16x16x32_bf16 v[24:27], a[100:103], a[16:19], v[24:27]
ds_read_b128 a[80:83], v39 offset:29696
v_mfma_f32_16x16x32_bf16 v[28:31], a[104:107], a[16:19], v[28:31]
ds_read_b128 a[84:87], v39 offset:30720
v_mfma_f32_16x16x32_bf16 v[32:35], a[108:111], a[16:19], v[32:35]
ds_read_b128 a[88:91], v36 offset:27648
s_waitcnt vmcnt(7) lgkmcnt(5)
v_mfma_f32_16x16x32_bf16 v[16:19], a[112:115], a[20:23], v[16:19]
ds_read_b128 a[92:95], v39 offset:32256
buffer_load_dwordx4 a[52:55], v1, s[8:11], s60 offen offset:1024 sc1
v_mfma_f32_16x16x32_bf16 v[20:23], a[116:119], a[20:23], v[20:23]
ds_read_b128 a[96:99], v39 offset:33280
v_mfma_f32_16x16x32_bf16 v[24:27], a[120:123], a[20:23], v[24:27]
ds_read_b128 a[100:103], v39 offset:34304
v_mfma_f32_16x16x32_bf16 v[28:31], a[124:127], a[20:23], v[28:31]
ds_read_b128 a[104:107], v39 offset:35328
v_mfma_f32_16x16x32_bf16 v[32:35], a[128:131], a[20:23], v[32:35]
ds_read_b128 a[108:111], v36 offset:32256
s_waitcnt vmcnt(7) lgkmcnt(5)
v_mfma_f32_16x16x32_bf16 v[16:19], a[72:75], a[24:27], v[16:19]
ds_read_b128 a[112:115], v39 offset:36864
buffer_load_dwordx4 a[56:59], v1, s[8:11], s60 offen offset:2048 sc1
v_mfma_f32_16x16x32_bf16 v[20:23], a[76:79], a[24:27], v[20:23]
ds_read_b128 a[116:119], v39 offset:37888
v_mfma_f32_16x16x32_bf16 v[24:27], a[80:83], a[24:27], v[24:27]
ds_read_b128 a[120:123], v39 offset:38912
v_mfma_f32_16x16x32_bf16 v[28:31], a[84:87], a[24:27], v[28:31]
ds_read_b128 a[124:127], v39 offset:39936
v_mfma_f32_16x16x32_bf16 v[32:35], a[88:91], a[24:27], v[32:35]
ds_read_b128 a[128:131], v36 offset:36864
s_waitcnt vmcnt(7) lgkmcnt(5)
v_mfma_f32_16x16x32_bf16 v[16:19], a[92:95], a[28:31], v[16:19]
ds_read_b128 a[72:75], v37 offset:0
buffer_load_dwordx4 a[60:63], v1, s[8:11], s60 offen offset:3072 sc1
v_mfma_f32_16x16x32_bf16 v[20:23], a[96:99], a[28:31], v[20:23]
ds_read_b128 a[76:79], v37 offset:1024
v_mfma_f32_16x16x32_bf16 v[24:27], a[100:103], a[28:31], v[24:27]
ds_read_b128 a[80:83], v37 offset:2048
v_mfma_f32_16x16x32_bf16 v[28:31], a[104:107], a[28:31], v[28:31]
ds_read_b128 a[84:87], v37 offset:3072
v_mfma_f32_16x16x32_bf16 v[32:35], a[108:111], a[28:31], v[32:35]
ds_read_b128 a[88:91], v38 offset:0
s_waitcnt vmcnt(7) lgkmcnt(5)
v_mfma_f32_16x16x32_bf16 v[16:19], a[112:115], a[32:35], v[16:19]
ds_read_b128 a[92:95], v37 offset:4608
s_add_u32 s60, s60, 4096
buffer_load_dwordx2 a[64:65], v40, s[8:11], s60 offen offset:0 sc1
buffer_load_dwordx2 a[66:67], v40, s[8:11], s60 offen offset:1024 sc1
v_mfma_f32_16x16x32_bf16 v[20:23], a[116:119], a[32:35], v[20:23]
ds_read_b128 a[96:99], v37 offset:5632
v_mfma_f32_16x16x32_bf16 v[24:27], a[120:123], a[32:35], v[24:27]
ds_read_b128 a[100:103], v37 offset:6656
v_mfma_f32_16x16x32_bf16 v[28:31], a[124:127], a[32:35], v[28:31]
ds_read_b128 a[104:107], v37 offset:7680
v_mfma_f32_16x16x32_bf16 v[32:35], a[128:131], a[32:35], v[32:35]
ds_read_b128 a[108:111], v38 offset:4608
s_waitcnt vmcnt(8) lgkmcnt(5)
v_mfma_f32_16x16x32_bf16 v[16:19], a[72:75], a[36:39], v[16:19]
ds_read_b128 a[112:115], v37 offset:9216
buffer_load_dwordx2 a[68:69], v40, s[8:11], s60 offen offset:512 sc1
buffer_load_dwordx2 a[70:71], v40, s[8:11], s60 offen offset:1536 sc1
v_mfma_f32_16x16x32_bf16 v[20:23], a[76:79], a[36:39], v[20:23]
ds_read_b128 a[116:119], v37 offset:10240
v_mfma_f32_16x16x32_bf16 v[24:27], a[80:83], a[36:39], v[24:27]
ds_read_b128 a[120:123], v37 offset:11264
v_mfma_f32_16x16x32_bf16 v[28:31], a[84:87], a[36:39], v[28:31]
ds_read_b128 a[124:127], v37 offset:12288
v_mfma_f32_16x16x32_bf16 v[32:35], a[88:91], a[36:39], v[32:35]
ds_read_b128 a[128:131], v38 offset:9216
s_waitcnt vmcnt(9) lgkmcnt(5)
v_mfma_f32_16x16x32_bf16 v[16:19], a[92:95], a[40:43], v[16:19]
ds_read_b128 a[72:75], v37 offset:13824
v_mfma_f32_16x16x32_bf16 v[20:23], a[96:99], a[40:43], v[20:23]
ds_read_b128 a[76:79], v37 offset:14848
v_mfma_f32_16x16x32_bf16 v[24:27], a[100:103], a[40:43], v[24:27]
ds_read_b128 a[80:83], v37 offset:15872
v_mfma_f32_16x16x32_bf16 v[28:31], a[104:107], a[40:43], v[28:31]
ds_read_b128 a[84:87], v37 offset:16896
v_mfma_f32_16x16x32_bf16 v[32:35], a[108:111], a[40:43], v[32:35]
ds_read_b128 a[88:91], v38 offset:13824
s_waitcnt vmcnt(8) lgkmcnt(5)
v_mfma_f32_16x16x32_bf16 v[16:19], a[112:115], a[44:47], v[16:19]
ds_read_b128 a[92:95], v37 offset:18432
v_mfma_f32_16x16x32_bf16 v[20:23], a[116:119], a[44:47], v[20:23]
ds_read_b128 a[96:99], v37 offset:19456
v_mfma_f32_16x16x32_bf16 v[24:27], a[120:123], a[44:47], v[24:27]
ds_read_b128 a[100:103], v37 offset:20480
v_mfma_f32_16x16x32_bf16 v[28:31], a[124:127], a[44:47], v[28:31]
ds_read_b128 a[104:107], v37 offset:21504
v_mfma_f32_16x16x32_bf16 v[32:35], a[128:131], a[44:47], v[32:35]
ds_read_b128 a[108:111], v38 offset:18432
s_waitcnt vmcnt(7) lgkmcnt(5)
v_mfma_f32_16x16x32_bf16 v[16:19], a[72:75], a[48:51], v[16:19]
ds_read_b128 a[112:115], v37 offset:23040
v_mfma_f32_16x16x32_bf16 v[20:23], a[76:79], a[48:51], v[20:23]
ds_read_b128 a[116:119], v37 offset:24064
v_mfma_f32_16x16x32_bf16 v[24:27], a[80:83], a[48:51], v[24:27]
ds_read_b128 a[120:123], v37 offset:25088
v_mfma_f32_16x16x32_bf16 v[28:31], a[84:87], a[48:51], v[28:31]
ds_read_b128 a[124:127], v37 offset:26112
v_mfma_f32_16x16x32_bf16 v[32:35], a[88:91], a[48:51], v[32:35]
ds_read_b128 a[128:131], v38 offset:23040
s_waitcnt vmcnt(6) lgkmcnt(5)
v_mfma_f32_16x16x32_bf16 v[16:19], a[92:95], a[52:55], v[16:19]
ds_read_b128 a[72:75], v37 offset:27648
v_mfma_f32_16x16x32_bf16 v[20:23], a[96:99], a[52:55], v[20:23]
ds_read_b128 a[76:79], v37 offset:28672
v_mfma_f32_16x16x32_bf16 v[24:27], a[100:103], a[52:55], v[24:27]
ds_read_b128 a[80:83], v37 offset:29696
v_mfma_f32_16x16x32_bf16 v[28:31], a[104:107], a[52:55], v[28:31]
ds_read_b128 a[84:87], v37 offset:30720
v_mfma_f32_16x16x32_bf16 v[32:35], a[108:111], a[52:55], v[32:35]
ds_read_b128 a[88:91], v38 offset:27648
s_waitcnt vmcnt(5) lgkmcnt(5)
v_mfma_f32_16x16x32_bf16 v[16:19], a[112:115], a[56:59], v[16:19]
ds_read_b128 a[92:95], v37 offset:32256
v_mfma_f32_16x16x32_bf16 v[20:23], a[116:119], a[56:59], v[20:23]
ds_read_b128 a[96:99], v37 offset:33280
v_mfma_f32_16x16x32_bf16 v[24:27], a[120:123], a[56:59], v[24:27]
ds_read_b128 a[100:103], v37 offset:34304
v_mfma_f32_16x16x32_bf16 v[28:31], a[124:127], a[56:59], v[28:31]
ds_read_b128 a[104:107], v37 offset:35328
v_mfma_f32_16x16x32_bf16 v[32:35], a[128:131], a[56:59], v[32:35]
ds_read_b128 a[108:111], v38 offset:32256
s_waitcnt vmcnt(4) lgkmcnt(5)
v_mfma_f32_16x16x32_bf16 v[16:19], a[72:75], a[60:63], v[16:19]
ds_read_b128 a[112:115], v37 offset:36864
v_mfma_f32_16x16x32_bf16 v[20:23], a[76:79], a[60:63], v[20:23]
ds_read_b128 a[116:119], v37 offset:37888
v_mfma_f32_16x16x32_bf16 v[24:27], a[80:83], a[60:63], v[24:27]
ds_read_b128 a[120:123], v37 offset:38912
v_mfma_f32_16x16x32_bf16 v[28:31], a[84:87], a[60:63], v[28:31]
ds_read_b128 a[124:127], v37 offset:39936
v_mfma_f32_16x16x32_bf16 v[32:35], a[88:91], a[60:63], v[32:35]
ds_read_b128 a[128:131], v38 offset:36864
s_waitcnt vmcnt(2) lgkmcnt(5)
v_mfma_f32_16x16x32_bf16 v[16:19], a[92:95], a[64:67], v[16:19]
v_mfma_f32_16x16x32_bf16 v[20:23], a[96:99], a[64:67], v[20:23]
v_mfma_f32_16x16x32_bf16 v[24:27], a[100:103], a[64:67], v[24:27]
v_mfma_f32_16x16x32_bf16 v[28:31], a[104:107], a[64:67], v[28:31]
v_mfma_f32_16x16x32_bf16 v[32:35], a[108:111], a[64:67], v[32:35]
s_waitcnt vmcnt(0) lgkmcnt(0)
v_mfma_f32_16x16x32_bf16 v[16:19], a[112:115], a[68:71], v[16:19]
v_mfma_f32_16x16x32_bf16 v[20:23], a[116:119], a[68:71], v[20:23]
v_mfma_f32_16x16x32_bf16 v[24:27], a[120:123], a[68:71], v[24:27]
v_mfma_f32_16x16x32_bf16 v[28:31], a[124:127], a[68:71], v[28:31]
v_mfma_f32_16x16x32_bf16 v[32:35], a[128:131], a[68:71], v[32:35]
s_nop 3
s_nop 0
v_cvt_pk_bf16_f32 v44, v16, v17
v_cvt_pk_bf16_f32 v45, v18, v19
v_cvt_pk_bf16_f32 v46, v20, v21
v_cvt_pk_bf16_f32 v47, v22, v23
buffer_store_dwordx4 v[44:47], v60, s[8:11], s62 offen sc1
v_cvt_pk_bf16_f32 v48, v24, v25
v_cvt_pk_bf16_f32 v49, v26, v27
v_cvt_pk_bf16_f32 v50, v28, v29
v_cvt_pk_bf16_f32 v51, v30, v31
v_cvt_pk_bf16_f32 v52, v32, v33
v_cvt_pk_bf16_f32 v53, v34, v35
buffer_store_dwordx4 v[48:51], v60, s[8:11], s62 offen offset:1024 sc1
s_nop 0
v_permlane16_swap_b32 v52, v54
v_permlane16_swap_b32 v53, v55
buffer_store_dwordx4 v[52:55], v61, s[8:11], s62 offen sc1
s_barrier
v_pk_add_f32 v[62:63], v[16:17], v[18:19]
v_pk_mul_f32 v[64:65], v[16:17], v[16:17]
v_pk_fma_f32 v[64:65], v[18:19], v[18:19], v[64:65]
v_pk_add_f32 v[62:63], v[62:63], v[20:21]
v_pk_fma_f32 v[64:65], v[20:21], v[20:21], v[64:65]
v_pk_add_f32 v[62:63], v[62:63], v[22:23]
v_pk_fma_f32 v[64:65], v[22:23], v[22:23], v[64:65]
v_pk_add_f32 v[62:63], v[62:63], v[24:25]
v_pk_fma_f32 v[64:65], v[24:25], v[24:25], v[64:65]
v_pk_add_f32 v[62:63], v[62:63], v[26:27]
v_pk_fma_f32 v[64:65], v[26:27], v[26:27], v[64:65]
v_pk_add_f32 v[62:63], v[62:63], v[28:29]
v_pk_fma_f32 v[64:65], v[28:29], v[28:29], v[64:65]
v_pk_add_f32 v[62:63], v[62:63], v[30:31]
v_pk_fma_f32 v[64:65], v[30:31], v[30:31], v[64:65]
s_mov_b32 exec_hi, 0
v_pk_add_f32 v[62:63], v[62:63], v[32:33]
v_pk_fma_f32 v[64:65], v[32:33], v[32:33], v[64:65]
v_pk_add_f32 v[62:63], v[62:63], v[34:35]
v_pk_fma_f32 v[64:65], v[34:35], v[34:35], v[64:65]
s_mov_b64 exec, -1
v_add_f32 v56, v62, v63
v_add_f32 v57, v64, v65
s_nop 1
v_permlane32_swap_b32 v56, v57
v_add_f32 v56, v56, v57
v_mov_b32 v57, v56
s_nop 1
v_permlane16_swap_b32 v56, v57
v_add_f32 v56, v56, v57
v_mov_b32 v57, v56
s_nop 1
v_permlane32_swap_b32 v56, v57
buffer_store_dwordx2 v[56:57], v58, s[8:11], s63 offen sc1
s_mul_i32 s38, s24, 9216
s_add_u32 m0, s38, 37888
s_add_u32 s39, s38, s82
s_add_u32 s39, s39, 75776
buffer_load_dwordx4 v1, s[4:7], s39 offen offset:0 sc1 lds
buffer_load_dwordx4 v1, s[4:7], s39 offen offset:1024 sc1 lds
buffer_load_dwordx4 v1, s[4:7], s39 offen offset:2048 sc1 lds
buffer_load_dwordx4 v1, s[4:7], s39 offen offset:3072 sc1 lds
v_lshlrev_b32 v7, 3, v1
s_lshr_b32 s31, s80, 4
s_lshl_b32 s31, s31, 11
v_add_u32 v7, s31, v7
s_cmp_eq_u32 s24, 0
s_cselect_b32 s30, 0, 1073741824
s_add_u32 s30, s30, 26509312
s_waitcnt vmcnt(5)
s_barrier
s_mov_b64 exec, 0xffff
buffer_atomic_add v4, v7, s[8:11], s30 offen sc1
s_mov_b64 exec, -1
s_lshl_b32 s35, s80, 7
s_add_u32 s35, s35, 26509312
s_cmp_eq_u32 s24, 1
s_cselect_b32 s35, s35, 1073741824
v_mov_b32 v6, 0
v_mov_b32 v244, 0
v_mov_b32 v245, 0
v_mov_b32 v246, 0
s_add_u32 m0, m0, 4096
s_add_u32 s39, s39, 4096
buffer_load_dwordx4 v1, s[4:7], s39 offen offset:0 sc1 lds
buffer_load_dwordx4 v1, s[4:7], s39 offen offset:1024 sc1 lds
buffer_load_dwordx4 v1, s[4:7], s39 offen offset:2048 sc1 lds
buffer_load_dwordx4 v1, s[4:7], s39 offen offset:3072 sc1 lds
s_add_u32 m0, m0, 4096
s_add_u32 s39, s39, 4096
buffer_load_dwordx4 v1, s[4:7], s39 offen offset:0 sc1 lds
s_lshl_b32 s38, s24, 8
s_add_u32 m0, s38, 74752
s_add_u32 s39, s38, s82
s_add_u32 s39, s39, 112640
s_mov_b64 exec, 1
buffer_atomic_add v244, v6, s[8:11], s35 offen sc0 sc1
s_mov_b64 exec, -1
s_mov_b64 exec, 0xffff
buffer_load_dwordx4 v1, s[4:7], s39 offen sc1 lds
s_mov_b64 exec, -1
s_mul_i32 s38, s24, 9216
s_add_u32 m0, s38, 75776
s_add_u32 s39, s38, s82
s_add_u32 s39, s39, 113664
buffer_load_dwordx4 v1, s[4:7], s39 offen offset:0 sc1 lds
buffer_load_dwordx4 v1, s[4:7], s39 offen offset:1024 sc1 lds
buffer_load_dwordx4 v1, s[4:7], s39 offen offset:2048 sc1 lds
s_mov_b64 exec, 1
buffer_atomic_add v245, v6, s[8:11], s35 offen sc0 sc1
s_mov_b64 exec, -1
buffer_load_dwordx4 v1, s[4:7], s39 offen offset:3072 sc1 lds
s_add_u32 m0, m0, 4096
s_add_u32 s39, s39, 4096
buffer_load_dwordx4 v1, s[4:7], s39 offen offset:0 sc1 lds
buffer_load_dwordx4 v1, s[4:7], s39 offen offset:1024 sc1 lds
buffer_load_dwordx4 v1, s[4:7], s39 offen offset:2048 sc1 lds
s_mov_b64 exec, 1
buffer_atomic_add v246, v6, s[8:11], s35 offen sc0 sc1
s_mov_b64 exec, -1
buffer_load_dwordx4 v1, s[4:7], s39 offen offset:3072 sc1 lds
s_add_u32 m0, m0, 4096
s_add_u32 s39, s39, 4096
buffer_load_dwordx4 v1, s[4:7], s39 offen offset:0 sc1 lds
s_lshl_b32 s38, s24, 8
s_add_u32 m0, s38, 112640
s_add_u32 s39, s38, s82
s_add_u32 s39, s39, 150528
s_mov_b64 exec, 0xffff
buffer_load_dwordx4 v1, s[4:7], s39 offen sc1 lds
s_mov_b64 exec, -1
s_lshl_b32 s60, s25, 2
s_add_u32 s60, s60, s24
s_mul_i32 s62, s60, 36864
s_add_u32 s62, s62, 4849664
v_add_u32 v180, 18432, v1
s_cmp_eq_u32 s24, 1
s_cbranch_scc0 L_other_23
s_mov_b32 s31, 0
s_mov_b64 exec, 1
v_mov_b32 v247, 0
buffer_atomic_add v247, v6, s[8:11], s35 offen sc0 sc1
s_waitcnt vmcnt(14)
v_cmp_gt_u32 vcc, 16, v244
s_nop 0
s_cbranch_vccz L_polled_22
s_waitcnt vmcnt(9)
v_cmp_gt_u32 vcc, 16, v245
s_nop 0
s_cbranch_vccz L_polled_22
v_mov_b32 v244, 0
buffer_atomic_add v244, v6, s[8:11], s35 offen sc0 sc1
s_waitcnt vmcnt(5)
v_cmp_gt_u32 vcc, 16, v246
s_nop 0
s_cbranch_vccz L_polled_22
v_mov_b32 v245, 0
buffer_atomic_add v245, v6, s[8:11], s35 offen sc0 sc1
L_poll_21:
s_add_u32 s31, s31, 1
s_cmp_gt_u32 s31, 100000
s_cbranch_scc1 L_polled_22
v_mov_b32 v246, 0
buffer_atomic_add v246, v6, s[8:11], s35 offen sc0 sc1
s_waitcnt vmcnt(3)
v_cmp_gt_u32 vcc, 16, v247
s_nop 0
s_cbranch_vccz L_polled_22
v_mov_b32 v247, 0
buffer_atomic_add v247, v6, s[8:11], s35 offen sc0 sc1
s_waitcnt vmcnt(3)
v_cmp_gt_u32 vcc, 16, v244
s_nop 0
s_cbranch_vccz L_polled_22
v_mov_b32 v244, 0
buffer_atomic_add v244, v6, s[8:11], s35 offen sc0 sc1
s_waitcnt vmcnt(3)
v_cmp_gt_u32 vcc, 16, v245
s_nop 0
s_cbranch_vccz L_polled_22
v_mov_b32 v245, 0
buffer_atomic_add v245, v6, s[8:11], s35 offen sc0 sc1
s_waitcnt vmcnt(3)
v_cmp_gt_u32 vcc, 16, v246
s_nop 0
s_cbranch_vccz L_polled_22
s_branch L_poll_21
L_polled_22:
s_mov_b64 exec, -1
L_other_23:
s_barrier
buffer_load_dwordx4 a[0:3], v1, s[8:11], s62 offen offset:0 sc1
buffer_load_dwordx4 a[4:7], v180, s[8:11], s62 offen offset:0 sc1
s_barrier
buffer_load_dwordx4 a[8:11], v1, s[8:11], s62 offen offset:1024 sc1
buffer_load_dwordx4 a[12:15], v180, s[8:11], s62 offen offset:1024 sc1
s_barrier
buffer_load_dwordx4 a[16:19], v1, s[8:11], s62 offen offset:2048 sc1
buffer_load_dwordx4 a[20:23], v180, s[8:11], s62 offen offset:2048 sc1
s_barrier
buffer_load_dwordx4 a[24:27], v1, s[8:11], s62 offen offset:3072 sc1
buffer_load_dwordx4 a[28:31], v180, s[8:11], s62 offen offset:3072 sc1
s_barrier
s_add_u32 s62, s62, 4096
buffer_load_dwordx4 a[32:35], v1, s[8:11], s62 offen offset:0 sc1
buffer_load_dwordx4 a[36:39], v180, s[8:11], s62 offen offset:0 sc1
s_barrier
buffer_load_dwordx4 a[40:43], v1, s[8:11], s62 offen offset:1024 sc1
buffer_load_dwordx4 a[44:47], v180, s[8:11], s62 offen offset:1024 sc1
s_lshl_b32 s53, s25, 2
s_add_u32 s53, s53, s24
s_mul_i32 s53, s53, 133120
s_add_u32 s53, s53, 10895360
s_lshl_b32 s52, s25, 12
s_add_u32 s52, s52, s53
v_lshrrev_b32 v239, 1, v1
v_and_b32 v6, 0xf8, v239
v_lshrrev_b32 v7, 1, v3
v_lshl_add_u32 v232, v7, 16, v6
s_lshl_b32 s63, s60, 8
s_add_u32 s63, s63, 7208960
v_add_u32 v208, 123904, v1
v_add_u32 v209, 0, v1
v_add_u32 v210, 37888, v1
v_add_u32 v211, 75776, v1
ds_read_b128 a[144:147], v208 offset:0
ds_read_b128 a[148:151], v208 offset:18432
ds_read_b128 a[152:155], v209 offset:0
ds_read_b128 a[156:159], v209 offset:18432
ds_read_b128 a[160:163], v208 offset:1024
ds_read_b128 a[164:167], v208 offset:19456
s_waitcnt vmcnt(10) lgkmcnt(4)
v_mfma_f32_16x16x32_bf16 v[36:39], a[144:147], a[0:3], 0
ds_read_b128 a[168:171], v209 offset:1024
ds_read_b128 a[172:175], v209 offset:19456
v_mfma_f32_16x16x32_bf16 v[40:43], a[144:147], a[4:7], 0
buffer_load_dwordx4 a[48:51], v1, s[8:11], s62 offen offset:2048 sc1
v_mfma_f32_16x16x32_bf16 v[44:47], a[148:151], a[0:3], 0
buffer_load_dwordx4 a[52:55], v180, s[8:11], s62 offen offset:2048 sc1
v_mfma_f32_16x16x32_bf16 v[48:51], a[148:151], a[4:7], 0
s_waitcnt lgkmcnt(4)
v_mfma_f32_16x16x32_bf16 v[52:55], a[152:155], a[0:3], 0
ds_read_b128 a[144:147], v208 offset:2048
ds_read_b128 a[148:151], v208 offset:20480
v_mfma_f32_16x16x32_bf16 v[56:59], a[152:155], a[4:7], 0
buffer_load_dwordx4 a[56:59], v1, s[8:11], s62 offen offset:3072 sc1
v_lshl_add_u32 v234, v7, 13, v6
v_mfma_f32_16x16x32_bf16 v[60:63], a[156:159], a[0:3], 0
v_add_u32 v235, 4096, v234
v_mfma_f32_16x16x32_bf16 v[64:67], a[156:159], a[4:7], 0
s_waitcnt vmcnt(11) lgkmcnt(4)
s_barrier
v_mfma_f32_16x16x32_bf16 v[36:39], a[160:163], a[8:11], v[36:39]
ds_read_b128 a[152:155], v209 offset:2048
ds_read_b128 a[156:159], v209 offset:20480
v_mfma_f32_16x16x32_bf16 v[40:43], a[160:163], a[12:15], v[40:43]
buffer_load_dwordx4 a[60:63], v180, s[8:11], s62 offen offset:3072 sc1
s_mul_i32 s30, s24, 9216
v_mfma_f32_16x16x32_bf16 v[44:47], a[164:167], a[8:11], v[44:47]
s_add_u32 s62, s62, 4096
v_mfma_f32_16x16x32_bf16 v[48:51], a[164:167], a[12:15], v[48:51]
s_waitcnt lgkmcnt(4)
s_add_u32 s30, s30, 0
v_mfma_f32_16x16x32_bf16 v[52:55], a[168:171], a[8:11], v[52:55]
ds_read_b128 a[160:163], v208 offset:3072
ds_read_b128 a[164:167], v208 offset:21504
v_mfma_f32_16x16x32_bf16 v[56:59], a[168:171], a[12:15], v[56:59]
buffer_load_dwordx4 a[64:67], v1, s[8:11], s62 offen offset:0 sc1
v_mul_u32_u24 v236, 288, v2
v_mfma_f32_16x16x32_bf16 v[60:63], a[172:175], a[8:11], v[60:63]
v_mfma_f32_16x16x32_bf16 v[64:67], a[172:175], a[12:15], v[64:67]
s_waitcnt lgkmcnt(4)
v_add_u32 v236, s30, v236
s_waitcnt vmcnt(11)
v_mfma_f32_16x16x32_bf16 v[36:39], a[144:147], a[16:19], v[36:39]
ds_read_b128 a[168:171], v209 offset:3072
ds_read_b128 a[172:175], v209 offset:21504
v_mfma_f32_16x16x32_bf16 v[40:43], a[144:147], a[20:23], v[40:43]
buffer_load_dwordx2 v[182:183], v232, s[8:11], s63 offen sc1
v_mfma_f32_16x16x32_bf16 v[44:47], a[148:151], a[16:19], v[44:47]
s_add_u32 s63, s63, 16384
v_lshl_add_u32 v7, v3, 3, v236
v_mfma_f32_16x16x32_bf16 v[48:51], a[148:151], a[20:23], v[48:51]
s_waitcnt lgkmcnt(4)
v_mfma_f32_16x16x32_bf16 v[52:55], a[152:155], a[16:19], v[52:55]
ds_read_b128 a[144:147], v208 offset:4096
ds_read_b128 a[148:151], v208 offset:22528
v_mfma_f32_16x16x32_bf16 v[56:59], a[152:155], a[20:23], v[56:59]
v_lshl_add_u32 v236, v3, 4, v236
v_mfma_f32_16x16x32_bf16 v[60:63], a[156:159], a[16:19], v[60:63]
buffer_load_dwordx2 v[184:185], v232, s[8:11], s63 offen sc1
v_lshrrev_b32 v8, 2, v2
v_mfma_f32_16x16x32_bf16 v[64:67], a[156:159], a[20:23], v[64:67]
s_waitcnt vmcnt(11) lgkmcnt(4)
v_mfma_f32_16x16x32_bf16 v[36:39], a[160:163], a[24:27], v[36:39]
ds_read_b128 a[152:155], v209 offset:4096
ds_read_b128 a[156:159], v209 offset:22528
v_mfma_f32_16x16x32_bf16 v[40:43], a[160:163], a[28:31], v[40:43]
s_add_u32 s63, s63, 16384
v_lshl_add_u32 v8, v3, 3, v8
v_mfma_f32_16x16x32_bf16 v[44:47], a[164:167], a[24:27], v[44:47]
v_mfma_f32_16x16x32_bf16 v[48:51], a[164:167], a[28:31], v[48:51]
s_waitcnt lgkmcnt(4)
v_mul_u32_u24 v237, 288, v8
v_mfma_f32_16x16x32_bf16 v[52:55], a[168:171], a[24:27], v[52:55]
ds_read_b128 a[160:163], v208 offset:5120
ds_read_b128 a[164:167], v208 offset:23552
v_mfma_f32_16x16x32_bf16 v[56:59], a[168:171], a[28:31], v[56:59]
buffer_load_dwordx2 v[186:187], v232, s[8:11], s63 offen sc1
v_add_u32 v237, s30, v237
v_mfma_f32_16x16x32_bf16 v[60:63], a[172:175], a[24:27], v[60:63]
s_add_u32 s63, s63, 16384
v_mfma_f32_16x16x32_bf16 v[64:67], a[172:175], a[28:31], v[64:67]
s_waitcnt vmcnt(10) lgkmcnt(4)
v_mfma_f32_16x16x32_bf16 v[36:39], a[144:147], a[32:35], v[36:39]
ds_read_b128 a[168:171], v209 offset:5120
ds_read_b128 a[172:175], v209 offset:23552
v_mfma_f32_16x16x32_bf16 v[40:43], a[144:147], a[36:39], v[40:43]
buffer_load_dwordx2 v[188:189], v232, s[8:11], s63 offen sc1
v_and_b32 v8, 3, v2
v_mfma_f32_16x16x32_bf16 v[44:47], a[148:151], a[32:35], v[44:47]
s_add_u32 s63, s63, 16384
v_lshl_add_u32 v238, v8, 3, v237
v_mfma_f32_16x16x32_bf16 v[48:51], a[148:151], a[36:39], v[48:51]
s_waitcnt lgkmcnt(4)
v_mfma_f32_16x16x32_bf16 v[52:55], a[152:155], a[32:35], v[52:55]
ds_read_b128 a[144:147], v208 offset:6144
ds_read_b128 a[148:151], v208 offset:24576
v_mfma_f32_16x16x32_bf16 v[56:59], a[152:155], a[36:39], v[56:59]
v_lshl_add_u32 v237, v8, 4, v237
v_mfma_f32_16x16x32_bf16 v[60:63], a[156:159], a[32:35], v[60:63]
buffer_load_dwordx4 a[68:71], v180, s[8:11], s62 offen offset:0 sc1
v_mfma_f32_16x16x32_bf16 v[64:67], a[156:159], a[36:39], v[64:67]
s_waitcnt lgkmcnt(4)
s_mul_i32 s66, s26, 589824
s_waitcnt vmcnt(10)
v_mfma_f32_16x16x32_bf16 v[36:39], a[160:163], a[40:43], v[36:39]
ds_read_b128 a[152:155], v209 offset:6144
ds_read_b128 a[156:159], v209 offset:24576
v_mfma_f32_16x16x32_bf16 v[40:43], a[160:163], a[44:47], v[40:43]
buffer_load_dwordx4 a[72:75], v1, s[8:11], s62 offen offset:1024 sc1
s_mul_i32 s31, s60, 9216
v_mfma_f32_16x16x32_bf16 v[44:47], a[164:167], a[40:43], v[44:47]
s_add_u32 s66, s66, s31
v_mfma_f32_16x16x32_bf16 v[48:51], a[164:167], a[44:47], v[48:51]
s_waitcnt lgkmcnt(4)
v_mfma_f32_16x16x32_bf16 v[52:55], a[168:171], a[40:43], v[52:55]
ds_read_b128 a[160:163], v208 offset:7168
ds_read_b128 a[164:167], v208 offset:25600
v_mfma_f32_16x16x32_bf16 v[56:59], a[168:171], a[44:47], v[56:59]
buffer_load_dwordx4 a[76:79], v180, s[8:11], s62 offen offset:1024 sc1
v_mfma_f32_16x16x32_bf16 v[60:63], a[172:175], a[40:43], v[60:63]
s_add_u32 s66, s66, 7340032
v_mfma_f32_16x16x32_bf16 v[64:67], a[172:175], a[44:47], v[64:67]
s_waitcnt vmcnt(10) lgkmcnt(4)
v_mfma_f32_16x16x32_bf16 v[36:39], a[144:147], a[48:51], v[36:39]
ds_read_b128 a[168:171], v209 offset:7168
ds_read_b128 a[172:175], v209 offset:25600
v_mfma_f32_16x16x32_bf16 v[40:43], a[144:147], a[52:55], v[40:43]
buffer_load_dwordx4 a[80:83], v1, s[8:11], s62 offen offset:2048 sc1
v_lshlrev_b32 v233, 7, v1
v_mfma_f32_16x16x32_bf16 v[44:47], a[148:151], a[48:51], v[44:47]
buffer_load_dwordx4 a[84:87], v180, s[8:11], s62 offen offset:2048 sc1
v_mfma_f32_16x16x32_bf16 v[48:51], a[148:151], a[52:55], v[48:51]
s_waitcnt lgkmcnt(4)
s_lshl_b32 s31, s26, 7
v_mfma_f32_16x16x32_bf16 v[52:55], a[152:155], a[48:51], v[52:55]
ds_read_b128 a[144:147], v208 offset:8192
ds_read_b128 a[148:151], v208 offset:26624
v_mfma_f32_16x16x32_bf16 v[56:59], a[152:155], a[52:55], v[56:59]
buffer_load_dwordx4 a[88:91], v1, s[8:11], s62 offen offset:3072 sc1
v_add_u32 v233, s31, v233
v_mfma_f32_16x16x32_bf16 v[60:63], a[156:159], a[48:51], v[60:63]
s_lshl_b32 s61, s25, 14
v_mfma_f32_16x16x32_bf16 v[64:67], a[156:159], a[52:55], v[64:67]
s_waitcnt vmcnt(11) lgkmcnt(4)
v_mfma_f32_16x16x32_bf16 v[36:39], a[160:163], a[56:59], v[36:39]
ds_read_b128 a[152:155], v209 offset:8192
ds_read_b128 a[156:159], v209 offset:26624
v_mfma_f32_16x16x32_bf16 v[40:43], a[160:163], a[60:63], v[40:43]
buffer_load_dwordx4 a[92:95], v180, s[8:11], s62 offen offset:3072 sc1
v_mfma_f32_16x16x32_bf16 v[44:47], a[164:167], a[56:59], v[44:47]
s_add_u32 s62, s62, 4096
s_lshl_b32 s30, s24, 8
v_mfma_f32_16x16x32_bf16 v[48:51], a[164:167], a[60:63], v[48:51]
s_waitcnt lgkmcnt(4)
v_mfma_f32_16x16x32_bf16 v[52:55], a[168:171], a[56:59], v[52:55]
ds_read_b128 a[160:163], v208 offset:9216
ds_read_b128 a[164:167], v208 offset:27648
v_mfma_f32_16x16x32_bf16 v[56:59], a[168:171], a[60:63], v[56:59]
buffer_load_dwordx4 a[96:99], v1, s[8:11], s62 offen offset:0 sc1
s_add_u32 s61, s61, s30
v_mfma_f32_16x16x32_bf16 v[60:63], a[172:175], a[56:59], v[60:63]
s_add_u32 s61, s61, 26214400
v_mfma_f32_16x16x32_bf16 v[64:67], a[172:175], a[60:63], v[64:67]
s_waitcnt vmcnt(7) lgkmcnt(4)
v_mfma_f32_16x16x32_bf16 v[36:39], a[144:147], a[64:67], v[36:39]
ds_read_b128 a[168:171], v209 offset:9216
ds_read_b128 a[172:175], v209 offset:27648
v_mfma_f32_16x16x32_bf16 v[40:43], a[144:147], a[68:71], v[40:43]
buffer_load_dwordx4 a[100:103], v180, s[8:11], s62 offen offset:0 sc1
s_mul_i32 s30, s24, 9216
v_mfma_f32_16x16x32_bf16 v[44:47], a[148:151], a[64:67], v[44:47]
buffer_load_dwordx4 a[104:107], v1, s[8:11], s62 offen offset:1024 sc1
v_mfma_f32_16x16x32_bf16 v[48:51], a[148:151], a[68:71], v[48:51]
s_waitcnt lgkmcnt(4)
s_add_u32 s30, s30, 0
v_mfma_f32_16x16x32_bf16 v[52:55], a[152:155], a[64:67], v[52:55]
ds_read_b128 a[144:147], v208 offset:10240
ds_read_b128 a[148:151], v208 offset:28672
v_mfma_f32_16x16x32_bf16 v[56:59], a[152:155], a[68:71], v[56:59]
buffer_load_dwordx4 a[108:111], v180, s[8:11], s62 offen offset:1024 sc1
v_add_u32 v240, s30, v1
v_mfma_f32_16x16x32_bf16 v[60:63], a[156:159], a[64:67], v[60:63]
s_lshl_b32 s30, s26, 10
v_mfma_f32_16x16x32_bf16 v[64:67], a[156:159], a[68:71], v[64:67]
s_waitcnt vmcnt(8) lgkmcnt(4)
v_mfma_f32_16x16x32_bf16 v[36:39], a[160:163], a[72:75], v[36:39]
ds_read_b128 a[152:155], v209 offset:10240
ds_read_b128 a[156:159], v209 offset:28672
v_mfma_f32_16x16x32_bf16 v[40:43], a[160:163], a[76:79], v[40:43]
buffer_load_dwordx4 a[112:115], v1, s[8:11], s62 offen offset:2048 sc1
v_mfma_f32_16x16x32_bf16 v[44:47], a[164:167], a[72:75], v[44:47]
buffer_load_dwordx4 a[116:119], v180, s[8:11], s62 offen offset:2048 sc1
s_add_u32 s30, s30, s61
v_mfma_f32_16x16x32_bf16 v[48:51], a[164:167], a[76:79], v[48:51]
s_waitcnt lgkmcnt(4)
v_mfma_f32_16x16x32_bf16 v[52:55], a[168:171], a[72:75], v[52:55]
ds_read_b128 a[160:163], v208 offset:11264
ds_read_b128 a[164:167], v208 offset:29696
v_mfma_f32_16x16x32_bf16 v[56:59], a[168:171], a[76:79], v[56:59]
buffer_load_dwordx4 a[120:123], v1, s[8:11], s62 offen offset:3072 sc1
v_mfma_f32_16x16x32_bf16 v[60:63], a[172:175], a[72:75], v[60:63]
v_mfma_f32_16x16x32_bf16 v[64:67], a[172:175], a[76:79], v[64:67]
s_waitcnt vmcnt(9) lgkmcnt(4)
v_mfma_f32_16x16x32_bf16 v[36:39], a[144:147], a[80:83], v[36:39]
ds_read_b128 a[168:171], v209 offset:11264
ds_read_b128 a[172:175], v209 offset:29696
v_mfma_f32_16x16x32_bf16 v[40:43], a[144:147], a[84:87], v[40:43]
buffer_load_dwordx4 a[124:127], v180, s[8:11], s62 offen offset:3072 sc1
v_mfma_f32_16x16x32_bf16 v[44:47], a[148:151], a[80:83], v[44:47]
s_add_u32 s62, s62, 4096
v_min3_f32 v198, v183, v185, v187
v_min_f32 v198, v198, v189
v_mfma_f32_16x16x32_bf16 v[48:51], a[148:151], a[84:87], v[48:51]
s_waitcnt lgkmcnt(4)
v_cmp_gt_f32 vcc, 0, v198
v_mfma_f32_16x16x32_bf16 v[52:55], a[152:155], a[80:83], v[52:55]
ds_read_b128 a[144:147], v208 offset:12288
ds_read_b128 a[148:151], v208 offset:30720
v_mfma_f32_16x16x32_bf16 v[56:59], a[152:155], a[84:87], v[56:59]
buffer_load_dwordx4 a[128:131], v1, s[8:11], s62 offen offset:0 sc1
v_mfma_f32_16x16x32_bf16 v[60:63], a[156:159], a[80:83], v[60:63]
s_nop 0
s_cbranch_vccnz L_stslow_26
L_stback_27:
v_mfma_f32_16x16x32_bf16 v[64:67], a[156:159], a[84:87], v[64:67]
s_waitcnt lgkmcnt(4)
v_add_f32 v198, v182, v184
s_waitcnt vmcnt(9)
v_mfma_f32_16x16x32_bf16 v[36:39], a[160:163], a[88:91], v[36:39]
ds_read_b128 a[152:155], v209 offset:12288
ds_read_b128 a[156:159], v209 offset:30720
v_mfma_f32_16x16x32_bf16 v[40:43], a[160:163], a[92:95], v[40:43]
buffer_load_dwordx4 a[132:135], v180, s[8:11], s62 offen offset:0 sc1
v_add_f32 v199, v183, v185
v_mfma_f32_16x16x32_bf16 v[44:47], a[164:167], a[88:91], v[44:47]
v_add_f32 v198, v198, v186
v_mfma_f32_16x16x32_bf16 v[48:51], a[164:167], a[92:95], v[48:51]
s_waitcnt lgkmcnt(4)
v_add_f32 v199, v199, v187
v_mfma_f32_16x16x32_bf16 v[52:55], a[168:171], a[88:91], v[52:55]
ds_read_b128 a[160:163], v208 offset:13312
ds_read_b128 a[164:167], v208 offset:31744
v_mfma_f32_16x16x32_bf16 v[56:59], a[168:171], a[92:95], v[56:59]
buffer_load_dwordx4 a[136:139], v1, s[8:11], s62 offen offset:1024 sc1
v_add_f32 v198, v198, v188
v_mfma_f32_16x16x32_bf16 v[60:63], a[172:175], a[88:91], v[60:63]
buffer_load_dwordx4 a[140:143], v180, s[8:11], s62 offen offset:1024 sc1
v_add_f32 v199, v199, v189
v_mfma_f32_16x16x32_bf16 v[64:67], a[172:175], a[92:95], v[64:67]
s_waitcnt lgkmcnt(4)
v_mov_b32 v200, v198
s_waitcnt vmcnt(10)
v_mfma_f32_16x16x32_bf16 v[36:39], a[144:147], a[96:99], v[36:39]
ds_read_b128 a[168:171], v209 offset:13312
ds_read_b128 a[172:175], v209 offset:31744
v_mfma_f32_16x16x32_bf16 v[40:43], a[144:147], a[100:103], v[40:43]
v_mov_b32 v201, v199
s_nop 0
v_mfma_f32_16x16x32_bf16 v[44:47], a[148:151], a[96:99], v[44:47]
v_permlane32_swap_b32 v198, v200
v_mfma_f32_16x16x32_bf16 v[48:51], a[148:151], a[100:103], v[48:51]
s_waitcnt lgkmcnt(4)
v_mfma_f32_16x16x32_bf16 v[52:55], a[152:155], a[96:99], v[52:55]
ds_read_b128 a[144:147], v208 offset:14336
ds_read_b128 a[148:151], v208 offset:32768
v_mfma_f32_16x16x32_bf16 v[56:59], a[152:155], a[100:103], v[56:59]
v_permlane32_swap_b32 v199, v201
v_mfma_f32_16x16x32_bf16 v[60:63], a[156:159], a[96:99], v[60:63]
v_add_f32 v198, v198, v200
v_mfma_f32_16x16x32_bf16 v[64:67], a[156:159], a[100:103], v[64:67]
s_waitcnt lgkmcnt(4)
v_add_f32 v199, v199, v201
s_waitcnt vmcnt(8)
v_mfma_f32_16x16x32_bf16 v[36:39], a[160:163], a[104:107], v[36:39]
ds_read_b128 a[152:155], v209 offset:14336
ds_read_b128 a[156:159], v209 offset:32768
v_mfma_f32_16x16x32_bf16 v[40:43], a[160:163], a[108:111], v[40:43]
v_mul_f32 v198, 0x3ae38e39, v198
v_mul_f32 v200, v198, v198
v_mfma_f32_16x16x32_bf16 v[44:47], a[164:167], a[104:107], v[44:47]
v_mfma_f32_16x16x32_bf16 v[48:51], a[164:167], a[108:111], v[48:51]
s_waitcnt lgkmcnt(4)
v_mul_f32 v199, 0x3ae38e39, v199
v_mfma_f32_16x16x32_bf16 v[52:55], a[168:171], a[104:107], v[52:55]
ds_read_b128 a[160:163], v208 offset:15360
ds_read_b128 a[164:167], v208 offset:33792
v_mfma_f32_16x16x32_bf16 v[56:59], a[168:171], a[108:111], v[56:59]
v_sub_f32 v199, v199, v200
v_max_f32 v199, 0, v199
v_mfma_f32_16x16x32_bf16 v[60:63], a[172:175], a[104:107], v[60:63]
v_add_f32 v199, 0x3727c5ac, v199
v_mfma_f32_16x16x32_bf16 v[64:67], a[172:175], a[108:111], v[64:67]
s_waitcnt vmcnt(6) lgkmcnt(4)
v_mfma_f32_16x16x32_bf16 v[36:39], a[144:147], a[112:115], v[36:39]
ds_read_b128 a[168:171], v209 offset:15360
ds_read_b128 a[172:175], v209 offset:33792
v_mfma_f32_16x16x32_bf16 v[40:43], a[144:147], a[116:119], v[40:43]
v_rsq_f32 v250, v199
v_mfma_f32_16x16x32_bf16 v[44:47], a[148:151], a[112:115], v[44:47]
v_sqrt_f32 v254, v199
v_mfma_f32_16x16x32_bf16 v[48:51], a[148:151], a[116:119], v[48:51]
s_waitcnt lgkmcnt(4)
v_mfma_f32_16x16x32_bf16 v[52:55], a[152:155], a[112:115], v[52:55]
ds_read_b128 a[144:147], v208 offset:16384
ds_read_b128 a[148:151], v208 offset:34816
v_mfma_f32_16x16x32_bf16 v[56:59], a[152:155], a[116:119], v[56:59]
v_cvt_pk_bf16_f32 v200, -v198, -v198
v_and_b32 v200, 0xffff0000, v200
v_mfma_f32_16x16x32_bf16 v[60:63], a[156:159], a[112:115], v[60:63]
v_add_f32 v200, v198, v200
v_mfma_f32_16x16x32_bf16 v[64:67], a[156:159], a[116:119], v[64:67]
s_waitcnt lgkmcnt(4)
v_cvt_pk_bf16_f32 v212, -v198, -v200
s_waitcnt vmcnt(4)
v_mfma_f32_16x16x32_bf16 v[36:39], a[160:163], a[120:123], v[36:39]
ds_read_b128 a[152:155], v209 offset:16384
ds_read_b128 a[156:159], v209 offset:34816
v_mfma_f32_16x16x32_bf16 v[40:43], a[160:163], a[124:127], v[40:43]
v_mul_f32 v252, v250, v250
v_mul_f32 v252, v252, v250
v_mfma_f32_16x16x32_bf16 v[44:47], a[164:167], a[120:123], v[44:47]
s_mov_b32 s37, L_c4-12288-L_pc
v_mul_f32 v252, 0xbdd2d3e8, v252
v_mfma_f32_16x16x32_bf16 v[48:51], a[164:167], a[124:127], v[48:51]
s_waitcnt lgkmcnt(4)
v_mfma_f32_16x16x32_bf16 v[52:55], a[168:171], a[120:123], v[52:55]
ds_read_b128 a[160:163], v208 offset:17408
ds_read_b128 a[164:167], v208 offset:35840
v_mfma_f32_16x16x32_bf16 v[56:59], a[168:171], a[124:127], v[56:59]
v_mul_f32 v250, 0xc0135761, v250
v_mov_b32 v214, v212
v_mfma_f32_16x16x32_bf16 v[60:63], a[172:175], a[120:123], v[60:63]
buffer_load_dword v15, v14, s[88:91], s37 offen
v_mov_b32 v255, v254
v_mfma_f32_16x16x32_bf16 v[64:67], a[172:175], a[124:127], v[64:67]
s_waitcnt lgkmcnt(4)
v_mov_b32 v253, v252
s_waitcnt vmcnt(3)
v_mfma_f32_16x16x32_bf16 v[36:39], a[144:147], a[128:131], v[36:39]
ds_read_b128 a[168:171], v209 offset:17408
ds_read_b128 a[172:175], v209 offset:35840
v_mfma_f32_16x16x32_bf16 v[40:43], a[144:147], a[132:135], v[40:43]
v_mov_b32 v251, v250
v_mfma_f32_16x16x32_bf16 v[44:47], a[148:151], a[128:131], v[44:47]
v_permlane16_swap_b32 v212, v214
v_mfma_f32_16x16x32_bf16 v[48:51], a[148:151], a[132:135], v[48:51]
s_waitcnt lgkmcnt(4)
v_add_u32 v181, 160768, v239
v_mfma_f32_16x16x32_bf16 v[52:55], a[152:155], a[128:131], v[52:55]
ds_read_b64 a[144:145], v181 offset:0
ds_read_b64 a[148:149], v181 offset:512
v_mfma_f32_16x16x32_bf16 v[56:59], a[152:155], a[132:135], v[56:59]
v_permlane16_swap_b32 v254, v255
v_mfma_f32_16x16x32_bf16 v[60:63], a[156:159], a[128:131], v[60:63]
v_permlane16_swap_b32 v252, v253
v_mfma_f32_16x16x32_bf16 v[64:67], a[156:159], a[132:135], v[64:67]
s_waitcnt vmcnt(1) lgkmcnt(4)
v_add_u32 v181, 36864, v239
v_mfma_f32_16x16x32_bf16 v[36:39], a[160:163], a[136:139], v[36:39]
ds_read_b64 a[152:153], v181 offset:0
ds_read_b64 a[156:157], v181 offset:512
v_mfma_f32_16x16x32_bf16 v[40:43], a[160:163], a[140:143], v[40:43]
v_permlane16_swap_b32 v250, v251
v_mfma_f32_16x16x32_bf16 v[44:47], a[164:167], a[136:139], v[44:47]
v_mov_b32 v213, v212
v_mfma_f32_16x16x32_bf16 v[48:51], a[164:167], a[140:143], v[48:51]
s_waitcnt lgkmcnt(4)
v_mov_b32 v215, v214
v_mfma_f32_16x16x32_bf16 v[52:55], a[168:171], a[136:139], v[52:55]
ds_read_b128 a[160:163], v210 offset:0
ds_read_b128 a[164:167], v210 offset:18432
v_mfma_f32_16x16x32_bf16 v[56:59], a[168:171], a[140:143], v[56:59]
v_mfma_f32_16x16x32_bf16 v[60:63], a[172:175], a[136:139], v[60:63]
v_mfma_f32_16x16x32_bf16 v[64:67], a[172:175], a[140:143], v[64:67]
s_waitcnt lgkmcnt(4)
v_mfma_f32_16x16x16_bf16 v[36:39], a[144:145], v[212:213], v[36:39]
ds_read_b128 a[168:171], v210 offset:1024
ds_read_b128 a[172:175], v210 offset:19456
v_mfma_f32_16x16x16_bf16 v[40:43], a[144:145], v[214:215], v[40:43]
v_mfma_f32_16x16x16_bf16 v[44:47], a[148:149], v[212:213], v[44:47]
v_mfma_f32_16x16x16_bf16 v[48:51], a[148:149], v[214:215], v[48:51]
s_waitcnt lgkmcnt(4)
v_mfma_f32_16x16x16_bf16 v[52:55], a[152:153], v[212:213], v[52:55]
ds_read_b128 a[144:147], v210 offset:2048
ds_read_b128 a[148:151], v210 offset:20480
v_mfma_f32_16x16x16_bf16 v[56:59], a[152:153], v[214:215], v[56:59]
v_mfma_f32_16x16x16_bf16 v[60:63], a[156:157], v[212:213], v[60:63]
v_mfma_f32_16x16x16_bf16 v[64:67], a[156:157], v[214:215], v[64:67]
s_waitcnt lgkmcnt(4)
s_barrier
v_mfma_f32_16x16x32_bf16 v[68:71], a[160:163], a[0:3], 0
ds_read_b128 a[152:155], v210 offset:3072
ds_read_b128 a[156:159], v210 offset:21504
v_mfma_f32_16x16x32_bf16 v[72:75], a[160:163], a[4:7], 0
s_mul_i32 s38, s24, 9216
s_add_u32 m0, s38, 123904
v_mfma_f32_16x16x32_bf16 v[76:79], a[164:167], a[0:3], 0
s_add_u32 s39, s38, s82
v_mfma_f32_16x16x32_bf16 v[80:83], a[164:167], a[4:7], 0
s_waitcnt lgkmcnt(4)
v_mfma_f32_16x16x32_bf16 v[68:71], a[168:171], a[8:11], v[68:71]
ds_read_b128 a[160:163], v210 offset:4096
ds_read_b128 a[164:167], v210 offset:22528
v_mfma_f32_16x16x32_bf16 v[72:75], a[168:171], a[12:15], v[72:75]
s_add_u32 s39, s39, 151552
v_mfma_f32_16x16x32_bf16 v[76:79], a[172:175], a[8:11], v[76:79]
buffer_load_dwordx4 v1, s[4:7], s39 offen offset:0 sc1 lds
buffer_load_dwordx4 v1, s[4:7], s39 offen offset:1024 sc1 lds
v_pk_mul_f32 v[216:217], v[36:37], v[36:37]
v_pk_mul_f32 v[218:219], v[38:39], v[38:39]
v_pk_mul_f32 v[220:221], v[40:41], v[40:41]
v_pk_mul_f32 v[222:223], v[42:43], v[42:43]
v_pk_fma_f32 v[216:217], v[216:217], v[252:253], v[250:251] op_sel:[0,0,0] op_sel_hi:[1,0,0]
v_pk_fma_f32 v[218:219], v[218:219], v[252:253], v[250:251] op_sel:[0,0,0] op_sel_hi:[1,0,0]
v_pk_fma_f32 v[220:221], v[220:221], v[252:253], v[250:251] op_sel:[0,1,1] op_sel_hi:[1,1,1]
v_pk_fma_f32 v[222:223], v[222:223], v[252:253], v[250:251] op_sel:[0,1,1] op_sel_hi:[1,1,1]
v_pk_mul_f32 v[216:217], v[216:217], v[36:37]
v_pk_mul_f32 v[218:219], v[218:219], v[38:39]
v_pk_mul_f32 v[220:221], v[220:221], v[40:41]
v_pk_mul_f32 v[222:223], v[222:223], v[42:43]
v_mfma_f32_16x16x32_bf16 v[80:83], a[172:175], a[12:15], v[80:83]
s_waitcnt lgkmcnt(4)
v_exp_f32 v216, v216
v_mfma_f32_16x16x32_bf16 v[68:71], a[144:147], a[16:19], v[68:71]
ds_read_b128 a[168:171], v210 offset:5120
ds_read_b128 a[172:175], v210 offset:23552
v_mfma_f32_16x16x32_bf16 v[72:75], a[144:147], a[20:23], v[72:75]
v_exp_f32 v217, v217
v_mfma_f32_16x16x32_bf16 v[76:79], a[148:151], a[16:19], v[76:79]
buffer_load_dwordx4 v1, s[4:7], s39 offen offset:2048 sc1 lds
buffer_load_dwordx4 v1, s[4:7], s39 offen offset:3072 sc1 lds
v_mfma_f32_16x16x32_bf16 v[80:83], a[148:151], a[20:23], v[80:83]
s_waitcnt lgkmcnt(4)
v_exp_f32 v218, v218
v_mfma_f32_16x16x32_bf16 v[68:71], a[152:155], a[24:27], v[68:71]
ds_read_b128 a[144:147], v210 offset:6144
ds_read_b128 a[148:151], v210 offset:24576
v_mfma_f32_16x16x32_bf16 v[72:75], a[152:155], a[28:31], v[72:75]
s_add_u32 m0, m0, 4096
v_fma_f32 v216, v216, v254, v254
v_fma_f32 v217, v217, v254, v254
v_mfma_f32_16x16x32_bf16 v[76:79], a[156:159], a[24:27], v[76:79]
s_add_u32 s39, s39, 4096
v_exp_f32 v219, v219
v_mfma_f32_16x16x32_bf16 v[80:83], a[156:159], a[28:31], v[80:83]
s_waitcnt lgkmcnt(4)
v_exp_f32 v220, v220
v_mfma_f32_16x16x32_bf16 v[68:71], a[160:163], a[32:35], v[68:71]
ds_read_b128 a[152:155], v210 offset:7168
ds_read_b128 a[156:159], v210 offset:25600
v_mfma_f32_16x16x32_bf16 v[72:75], a[160:163], a[36:39], v[72:75]
buffer_load_dwordx4 v1, s[4:7], s39 offen offset:0 sc1 lds
buffer_load_dwordx4 v1, s[4:7], s39 offen offset:1024 sc1 lds
v_mfma_f32_16x16x32_bf16 v[76:79], a[164:167], a[32:35], v[76:79]
v_fma_f32 v218, v218, v254, v254
v_fma_f32 v219, v219, v254, v254
v_mfma_f32_16x16x32_bf16 v[80:83], a[164:167], a[36:39], v[80:83]
s_waitcnt lgkmcnt(4)
v_exp_f32 v221, v221
v_mfma_f32_16x16x32_bf16 v[68:71], a[168:171], a[40:43], v[68:71]
ds_read_b128 a[160:163], v210 offset:8192
ds_read_b128 a[164:167], v210 offset:26624
v_exp_f32 v222, v222
v_mfma_f32_16x16x32_bf16 v[72:75], a[168:171], a[44:47], v[72:75]
buffer_load_dwordx4 v1, s[4:7], s39 offen offset:2048 sc1 lds
buffer_load_dwordx4 v1, s[4:7], s39 offen offset:3072 sc1 lds
v_mfma_f32_16x16x32_bf16 v[76:79], a[172:175], a[40:43], v[76:79]
s_add_u32 m0, m0, 4096
v_fma_f32 v220, v220, v255, v255
v_fma_f32 v221, v221, v255, v255
v_mfma_f32_16x16x32_bf16 v[80:83], a[172:175], a[44:47], v[80:83]
s_waitcnt lgkmcnt(4)
v_exp_f32 v223, v223
v_mfma_f32_16x16x32_bf16 v[68:71], a[144:147], a[48:51], v[68:71]
ds_read_b128 a[168:171], v210 offset:9216
ds_read_b128 a[172:175], v210 offset:27648
v_rcp_f32 v216, v216
v_mfma_f32_16x16x32_bf16 v[72:75], a[144:147], a[52:55], v[72:75]
s_add_u32 s39, s39, 4096
v_fma_f32 v222, v222, v255, v255
v_fma_f32 v223, v223, v255, v255
v_mfma_f32_16x16x32_bf16 v[76:79], a[148:151], a[48:51], v[76:79]
buffer_load_dwordx4 v1, s[4:7], s39 offen offset:0 sc1 lds
v_mfma_f32_16x16x32_bf16 v[80:83], a[148:151], a[52:55], v[80:83]
s_waitcnt lgkmcnt(4)
v_rcp_f32 v217, v217
v_mfma_f32_16x16x32_bf16 v[68:71], a[152:155], a[56:59], v[68:71]
ds_read_b128 a[144:147], v210 offset:10240
ds_read_b128 a[148:151], v210 offset:28672
v_rcp_f32 v218, v218
v_mfma_f32_16x16x32_bf16 v[72:75], a[152:155], a[60:63], v[72:75]
s_lshl_b32 s38, s24, 8
v_rcp_f32 v219, v219
v_mfma_f32_16x16x32_bf16 v[76:79], a[156:159], a[56:59], v[76:79]
buffer_store_dwordx4 a[224:227], v1, s[4:7], s101 offen offset:0 sc1
s_add_u32 m0, s38, 160768
v_mfma_f32_16x16x32_bf16 v[80:83], a[156:159], a[60:63], v[80:83]
s_waitcnt lgkmcnt(4)
s_add_u32 s39, s38, s82
v_rcp_f32 v220, v220
v_mfma_f32_16x16x32_bf16 v[68:71], a[160:163], a[64:67], v[68:71]
ds_read_b128 a[152:155], v210 offset:11264
ds_read_b128 a[156:159], v210 offset:29696
v_mfma_f32_16x16x32_bf16 v[72:75], a[160:163], a[68:71], v[72:75]
s_add_u32 s39, s39, 188416
v_rcp_f32 v221, v221
v_mfma_f32_16x16x32_bf16 v[76:79], a[164:167], a[64:67], v[76:79]
v_rcp_f32 v222, v222
v_mfma_f32_16x16x32_bf16 v[80:83], a[164:167], a[68:71], v[80:83]
s_waitcnt lgkmcnt(4)
v_rcp_f32 v223, v223
v_mfma_f32_16x16x32_bf16 v[68:71], a[168:171], a[72:75], v[68:71]
ds_read_b128 a[160:163], v210 offset:12288
ds_read_b128 a[164:167], v210 offset:30720
v_pk_mul_f32 v[224:225], v[44:45], v[44:45]
v_pk_mul_f32 v[226:227], v[46:47], v[46:47]
v_pk_mul_f32 v[228:229], v[48:49], v[48:49]
v_pk_mul_f32 v[230:231], v[50:51], v[50:51]
v_pk_fma_f32 v[224:225], v[224:225], v[252:253], v[250:251] op_sel:[0,0,0] op_sel_hi:[1,0,0]
v_pk_fma_f32 v[226:227], v[226:227], v[252:253], v[250:251] op_sel:[0,0,0] op_sel_hi:[1,0,0]
v_pk_fma_f32 v[228:229], v[228:229], v[252:253], v[250:251] op_sel:[0,1,1] op_sel_hi:[1,1,1]
v_pk_fma_f32 v[230:231], v[230:231], v[252:253], v[250:251] op_sel:[0,1,1] op_sel_hi:[1,1,1]
v_pk_mul_f32 v[36:37], v[36:37], v[216:217]
v_pk_mul_f32 v[38:39], v[38:39], v[218:219]
v_pk_mul_f32 v[40:41], v[40:41], v[220:221]
v_pk_mul_f32 v[42:43], v[42:43], v[222:223]
v_pk_mul_f32 v[224:225], v[224:225], v[44:45]
v_pk_mul_f32 v[226:227], v[226:227], v[46:47]
v_pk_mul_f32 v[228:229], v[228:229], v[48:49]
v_pk_mul_f32 v[230:231], v[230:231], v[50:51]
v_mfma_f32_16x16x32_bf16 v[72:75], a[168:171], a[76:79], v[72:75]
s_mov_b64 exec, 0xffff
buffer_load_dwordx4 v1, s[4:7], s39 offen sc1 lds
s_mov_b64 exec, -1
v_exp_f32 v224, v224
v_mfma_f32_16x16x32_bf16 v[76:79], a[172:175], a[72:75], v[76:79]
v_exp_f32 v225, v225
v_mfma_f32_16x16x32_bf16 v[80:83], a[172:175], a[76:79], v[80:83]
s_waitcnt lgkmcnt(4)
v_exp_f32 v226, v226
v_mfma_f32_16x16x32_bf16 v[68:71], a[144:147], a[80:83], v[68:71]
ds_read_b128 a[168:171], v210 offset:13312
ds_read_b128 a[172:175], v210 offset:31744
v_mfma_f32_16x16x32_bf16 v[72:75], a[144:147], a[84:87], v[72:75]
s_mul_i32 s38, s24, 9216
v_fma_f32 v224, v224, v254, v254
v_fma_f32 v225, v225, v254, v254
v_mfma_f32_16x16x32_bf16 v[76:79], a[148:151], a[80:83], v[76:79]
s_add_u32 m0, s38, 0
v_exp_f32 v227, v227
v_mfma_f32_16x16x32_bf16 v[80:83], a[148:151], a[84:87], v[80:83]
s_waitcnt lgkmcnt(4)
v_exp_f32 v228, v228
v_mfma_f32_16x16x32_bf16 v[68:71], a[152:155], a[88:91], v[68:71]
ds_read_b128 a[144:147], v210 offset:14336
ds_read_b128 a[148:151], v210 offset:32768
v_mfma_f32_16x16x32_bf16 v[72:75], a[152:155], a[92:95], v[72:75]
s_add_u32 s39, s38, s82
v_fma_f32 v226, v226, v254, v254
v_fma_f32 v227, v227, v254, v254
v_mfma_f32_16x16x32_bf16 v[76:79], a[156:159], a[88:91], v[76:79]
s_add_u32 s39, s39, 189440
v_exp_f32 v229, v229
v_mfma_f32_16x16x32_bf16 v[80:83], a[156:159], a[92:95], v[80:83]
s_waitcnt lgkmcnt(4)
v_exp_f32 v230, v230
v_mfma_f32_16x16x32_bf16 v[68:71], a[160:163], a[96:99], v[68:71]
ds_read_b128 a[152:155], v210 offset:15360
ds_read_b128 a[156:159], v210 offset:33792
v_mfma_f32_16x16x32_bf16 v[72:75], a[160:163], a[100:103], v[72:75]
buffer_store_dwordx4 a[228:231], v1, s[4:7], s101 offen offset:1024 sc1
v_fma_f32 v228, v228, v255, v255
v_fma_f32 v229, v229, v255, v255
v_mfma_f32_16x16x32_bf16 v[76:79], a[164:167], a[96:99], v[76:79]
buffer_load_dwordx4 v1, s[4:7], s39 offen offset:0 sc1 lds
buffer_load_dwordx4 v1, s[4:7], s39 offen offset:1024 sc1 lds
v_exp_f32 v231, v231
v_mfma_f32_16x16x32_bf16 v[80:83], a[164:167], a[100:103], v[80:83]
s_waitcnt lgkmcnt(4)
v_rcp_f32 v224, v224
v_mfma_f32_16x16x32_bf16 v[68:71], a[168:171], a[104:107], v[68:71]
ds_read_b128 a[160:163], v210 offset:16384
ds_read_b128 a[164:167], v210 offset:34816
v_mfma_f32_16x16x32_bf16 v[72:75], a[168:171], a[108:111], v[72:75]
v_fma_f32 v230, v230, v255, v255
v_fma_f32 v231, v231, v255, v255
v_mfma_f32_16x16x32_bf16 v[76:79], a[172:175], a[104:107], v[76:79]
v_rcp_f32 v225, v225
v_mfma_f32_16x16x32_bf16 v[80:83], a[172:175], a[108:111], v[80:83]
s_waitcnt lgkmcnt(4)
v_rcp_f32 v226, v226
v_mfma_f32_16x16x32_bf16 v[68:71], a[144:147], a[112:115], v[68:71]
ds_read_b128 a[168:171], v210 offset:17408
ds_read_b128 a[172:175], v210 offset:35840
v_mfma_f32_16x16x32_bf16 v[72:75], a[144:147], a[116:119], v[72:75]
buffer_load_dwordx4 v1, s[4:7], s39 offen offset:2048 sc1 lds
buffer_load_dwordx4 v1, s[4:7], s39 offen offset:3072 sc1 lds
v_rcp_f32 v227, v227
v_mfma_f32_16x16x32_bf16 v[76:79], a[148:151], a[112:115], v[76:79]
s_add_u32 m0, m0, 4096
v_rcp_f32 v228, v228
v_mfma_f32_16x16x32_bf16 v[80:83], a[148:151], a[116:119], v[80:83]
s_waitcnt lgkmcnt(4)
v_add_u32 v181, 74752, v239
v_mfma_f32_16x16x32_bf16 v[68:71], a[152:155], a[120:123], v[68:71]
ds_read_b64 a[144:145], v181 offset:0
ds_read_b64 a[148:149], v181 offset:512
v_rcp_f32 v229, v229
v_mfma_f32_16x16x32_bf16 v[72:75], a[152:155], a[124:127], v[72:75]
s_add_u32 s39, s39, 4096
v_rcp_f32 v230, v230
v_mfma_f32_16x16x32_bf16 v[76:79], a[156:159], a[120:123], v[76:79]
v_rcp_f32 v231, v231
v_mfma_f32_16x16x32_bf16 v[80:83], a[156:159], a[124:127], v[80:83]
s_waitcnt lgkmcnt(4)
v_pk_mul_f32 v[216:217], v[52:53], v[52:53]
v_pk_mul_f32 v[218:219], v[54:55], v[54:55]
v_pk_mul_f32 v[220:221], v[56:57], v[56:57]
v_pk_mul_f32 v[222:223], v[58:59], v[58:59]
v_pk_fma_f32 v[216:217], v[216:217], v[252:253], v[250:251] op_sel:[0,0,0] op_sel_hi:[1,0,0]
v_pk_fma_f32 v[218:219], v[218:219], v[252:253], v[250:251] op_sel:[0,0,0] op_sel_hi:[1,0,0]
v_pk_fma_f32 v[220:221], v[220:221], v[252:253], v[250:251] op_sel:[0,1,1] op_sel_hi:[1,1,1]
v_pk_fma_f32 v[222:223], v[222:223], v[252:253], v[250:251] op_sel:[0,1,1] op_sel_hi:[1,1,1]
v_pk_mul_f32 v[44:45], v[44:45], v[224:225]
v_pk_mul_f32 v[46:47], v[46:47], v[226:227]
v_pk_mul_f32 v[48:49], v[48:49], v[228:229]
v_pk_mul_f32 v[50:51], v[50:51], v[230:231]
v_pk_mul_f32 v[216:217], v[216:217], v[52:53]
v_pk_mul_f32 v[218:219], v[218:219], v[54:55]
v_pk_mul_f32 v[220:221], v[220:221], v[56:57]
v_pk_mul_f32 v[222:223], v[222:223], v[58:59]
v_mfma_f32_16x16x32_bf16 v[68:71], a[160:163], a[128:131], v[68:71]
ds_read_b128 a[152:155], v211 offset:0
ds_read_b128 a[156:159], v211 offset:18432
v_exp_f32 v216, v216
v_mfma_f32_16x16x32_bf16 v[72:75], a[160:163], a[132:135], v[72:75]
buffer_load_dwordx4 v1, s[4:7], s39 offen offset:0 sc1 lds
buffer_load_dwordx4 v1, s[4:7], s39 offen offset:1024 sc1 lds
v_exp_f32 v217, v217
v_mfma_f32_16x16x32_bf16 v[76:79], a[164:167], a[128:131], v[76:79]
buffer_store_dwordx4 a[232:235], v1, s[4:7], s101 offen offset:2048 sc1
v_exp_f32 v218, v218
v_mfma_f32_16x16x32_bf16 v[80:83], a[164:167], a[132:135], v[80:83]
s_waitcnt lgkmcnt(4)
v_fma_f32 v216, v216, v254, v254
v_fma_f32 v217, v217, v254, v254
v_mfma_f32_16x16x32_bf16 v[68:71], a[168:171], a[136:139], v[68:71]
ds_read_b128 a[160:163], v211 offset:1024
ds_read_b128 a[164:167], v211 offset:19456
v_mfma_f32_16x16x32_bf16 v[72:75], a[168:171], a[140:143], v[72:75]
v_exp_f32 v219, v219
v_mfma_f32_16x16x32_bf16 v[76:79], a[172:175], a[136:139], v[76:79]
v_exp_f32 v220, v220
v_mfma_f32_16x16x32_bf16 v[80:83], a[172:175], a[140:143], v[80:83]
s_waitcnt lgkmcnt(4)
v_fma_f32 v218, v218, v254, v254
v_fma_f32 v219, v219, v254, v254
v_mfma_f32_16x16x16_bf16 v[68:71], a[144:145], v[212:213], v[68:71]
ds_read_b128 a[168:171], v211 offset:2048
ds_read_b128 a[172:175], v211 offset:20480
v_mfma_f32_16x16x16_bf16 v[72:75], a[144:145], v[214:215], v[72:75]
buffer_load_dwordx4 v1, s[4:7], s39 offen offset:2048 sc1 lds
buffer_load_dwordx4 v1, s[4:7], s39 offen offset:3072 sc1 lds
v_exp_f32 v221, v221
v_mfma_f32_16x16x16_bf16 v[76:79], a[148:149], v[212:213], v[76:79]
s_add_u32 m0, m0, 4096
v_exp_f32 v222, v222
v_mfma_f32_16x16x16_bf16 v[80:83], a[148:149], v[214:215], v[80:83]
s_waitcnt vmcnt(10) lgkmcnt(4)
s_barrier
v_mfma_f32_16x16x32_bf16 v[84:87], a[152:155], a[0:3], 0
ds_read_b128 a[144:147], v211 offset:3072
ds_read_b128 a[148:151], v211 offset:21504
v_fma_f32 v220, v220, v255, v255
v_fma_f32 v221, v221, v255, v255
v_mfma_f32_16x16x32_bf16 v[88:91], a[152:155], a[4:7], 0
s_add_u32 s39, s39, 4096
v_exp_f32 v223, v223
v_mfma_f32_16x16x32_bf16 v[92:95], a[156:159], a[0:3], 0
v_rcp_f32 v216, v216
v_mfma_f32_16x16x32_bf16 v[96:99], a[156:159], a[4:7], 0
s_waitcnt lgkmcnt(4)
v_fma_f32 v222, v222, v255, v255
v_fma_f32 v223, v223, v255, v255
v_mfma_f32_16x16x32_bf16 v[84:87], a[160:163], a[8:11], v[84:87]
ds_read_b128 a[152:155], v211 offset:4096
ds_read_b128 a[156:159], v211 offset:22528
v_mfma_f32_16x16x32_bf16 v[88:91], a[160:163], a[12:15], v[88:91]
buffer_load_dwordx4 v1, s[4:7], s39 offen offset:0 sc1 lds
v_rcp_f32 v217, v217
v_mfma_f32_16x16x32_bf16 v[92:95], a[164:167], a[8:11], v[92:95]
s_lshl_b32 s38, s24, 8
v_rcp_f32 v218, v218
v_mfma_f32_16x16x32_bf16 v[96:99], a[164:167], a[12:15], v[96:99]
s_waitcnt lgkmcnt(4)
v_rcp_f32 v219, v219
v_mfma_f32_16x16x32_bf16 v[84:87], a[168:171], a[16:19], v[84:87]
ds_read_b128 a[160:163], v211 offset:5120
ds_read_b128 a[164:167], v211 offset:23552
v_mfma_f32_16x16x32_bf16 v[88:91], a[168:171], a[20:23], v[88:91]
buffer_store_dwordx4 a[236:239], v1, s[4:7], s101 offen offset:3072 sc1
v_rcp_f32 v220, v220
v_mfma_f32_16x16x32_bf16 v[92:95], a[172:175], a[16:19], v[92:95]
s_add_u32 m0, s38, 36864
v_rcp_f32 v221, v221
v_mfma_f32_16x16x32_bf16 v[96:99], a[172:175], a[20:23], v[96:99]
s_waitcnt lgkmcnt(4)
v_rcp_f32 v222, v222
v_mfma_f32_16x16x32_bf16 v[84:87], a[144:147], a[24:27], v[84:87]
ds_read_b128 a[168:171], v211 offset:6144
ds_read_b128 a[172:175], v211 offset:24576
v_mfma_f32_16x16x32_bf16 v[88:91], a[144:147], a[28:31], v[88:91]
s_add_u32 s39, s38, s82
v_rcp_f32_e64 v223, v223
v_mfma_f32_16x16x32_bf16 v[92:95], a[148:151], a[24:27], v[92:95]
s_add_u32 s39, s39, 226304
v_pk_mul_f32 v[224:225], v[60:61], v[60:61]
v_pk_mul_f32 v[226:227], v[62:63], v[62:63]
v_pk_mul_f32 v[228:229], v[64:65], v[64:65]
v_pk_mul_f32 v[230:231], v[66:67], v[66:67]
v_pk_fma_f32 v[224:225], v[224:225], v[252:253], v[250:251] op_sel:[0,0,0] op_sel_hi:[1,0,0]
v_pk_fma_f32 v[226:227], v[226:227], v[252:253], v[250:251] op_sel:[0,0,0] op_sel_hi:[1,0,0]
v_pk_fma_f32 v[228:229], v[228:229], v[252:253], v[250:251] op_sel:[0,1,1] op_sel_hi:[1,1,1]
v_pk_fma_f32 v[230:231], v[230:231], v[252:253], v[250:251] op_sel:[0,1,1] op_sel_hi:[1,1,1]
v_pk_mul_f32 v[52:53], v[52:53], v[216:217]
v_pk_mul_f32 v[54:55], v[54:55], v[218:219]
v_pk_mul_f32 v[56:57], v[56:57], v[220:221]
v_pk_mul_f32 v[58:59], v[58:59], v[222:223]
v_pk_mul_f32 v[224:225], v[224:225], v[60:61]
v_pk_mul_f32 v[226:227], v[226:227], v[62:63]
v_pk_mul_f32 v[228:229], v[228:229], v[64:65]
v_pk_mul_f32 v[230:231], v[230:231], v[66:67]
v_mfma_f32_16x16x32_bf16 v[96:99], a[148:151], a[28:31], v[96:99]
s_waitcnt lgkmcnt(4)
v_exp_f32 v224, v224
v_mfma_f32_16x16x32_bf16 v[84:87], a[152:155], a[32:35], v[84:87]
ds_read_b128 a[144:147], v211 offset:7168
ds_read_b128 a[148:151], v211 offset:25600
v_exp_f32 v225, v225
v_mfma_f32_16x16x32_bf16 v[88:91], a[152:155], a[36:39], v[88:91]
v_exp_f32 v226, v226
v_mfma_f32_16x16x32_bf16 v[92:95], a[156:159], a[32:35], v[92:95]
s_mov_b64 exec, 0xffff
buffer_load_dwordx4 v1, s[4:7], s39 offen sc1 lds
s_mov_b64 exec, -1
v_mfma_f32_16x16x32_bf16 v[96:99], a[156:159], a[36:39], v[96:99]
s_waitcnt lgkmcnt(4)
v_fma_f32 v224, v224, v254, v254
v_fma_f32 v225, v225, v254, v254
v_mfma_f32_16x16x32_bf16 v[84:87], a[160:163], a[40:43], v[84:87]
ds_read_b128 a[152:155], v211 offset:8192
ds_read_b128 a[156:159], v211 offset:26624
v_exp_f32 v227, v227
v_mfma_f32_16x16x32_bf16 v[88:91], a[160:163], a[44:47], v[88:91]
v_exp_f32 v228, v228
v_mfma_f32_16x16x32_bf16 v[92:95], a[164:167], a[40:43], v[92:95]
v_fma_f32 v226, v226, v254, v254
v_fma_f32 v227, v227, v254, v254
v_mfma_f32_16x16x32_bf16 v[96:99], a[164:167], a[44:47], v[96:99]
s_waitcnt lgkmcnt(4)
v_exp_f32 v229, v229
v_mfma_f32_16x16x32_bf16 v[84:87], a[168:171], a[48:51], v[84:87]
ds_read_b128 a[160:163], v211 offset:9216
ds_read_b128 a[164:167], v211 offset:27648
v_mfma_f32_16x16x32_bf16 v[88:91], a[168:171], a[52:55], v[88:91]
v_exp_f32 v230, v230
v_mfma_f32_16x16x32_bf16 v[92:95], a[172:175], a[48:51], v[92:95]
buffer_store_dwordx4 a[240:243], v9, s[4:7], s101 offen offset:0 sc1
s_mul_i32 s38, s24, 9216
v_mfma_f32_16x16x32_bf16 v[96:99], a[172:175], a[52:55], v[96:99]
s_waitcnt lgkmcnt(4)
v_fma_f32 v228, v228, v255, v255
v_fma_f32 v229, v229, v255, v255
v_mfma_f32_16x16x32_bf16 v[84:87], a[144:147], a[56:59], v[84:87]
ds_read_b128 a[168:171], v211 offset:10240
ds_read_b128 a[172:175], v211 offset:28672
v_exp_f32 v231, v231
v_mfma_f32_16x16x32_bf16 v[88:91], a[144:147], a[60:63], v[88:91]
s_add_u32 m0, s38, 37888
v_rcp_f32 v224, v224
v_mfma_f32_16x16x32_bf16 v[92:95], a[148:151], a[56:59], v[92:95]
s_add_u32 s39, s38, s82
v_fma_f32 v230, v230, v255, v255
v_fma_f32 v231, v231, v255, v255
v_mfma_f32_16x16x32_bf16 v[96:99], a[148:151], a[60:63], v[96:99]
s_waitcnt lgkmcnt(4)
v_rcp_f32 v225, v225
v_mfma_f32_16x16x32_bf16 v[84:87], a[152:155], a[64:67], v[84:87]
ds_read_b128 a[144:147], v211 offset:11264
ds_read_b128 a[148:151], v211 offset:29696
v_mfma_f32_16x16x32_bf16 v[88:91], a[152:155], a[68:71], v[88:91]
s_add_u32 s39, s39, 227328
v_rcp_f32 v226, v226
v_mfma_f32_16x16x32_bf16 v[92:95], a[156:159], a[64:67], v[92:95]
v_rcp_f32 v227, v227
v_mfma_f32_16x16x32_bf16 v[96:99], a[156:159], a[68:71], v[96:99]
s_waitcnt lgkmcnt(4)
v_rcp_f32 v228, v228
v_mfma_f32_16x16x32_bf16 v[84:87], a[160:163], a[72:75], v[84:87]
ds_read_b128 a[152:155], v211 offset:12288
ds_read_b128 a[156:159], v211 offset:30720
v_mfma_f32_16x16x32_bf16 v[88:91], a[160:163], a[76:79], v[88:91]
buffer_load_dwordx4 v1, s[4:7], s39 offen offset:0 sc1 lds
buffer_load_dwordx4 v1, s[4:7], s39 offen offset:1024 sc1 lds
v_mfma_f32_16x16x32_bf16 v[92:95], a[164:167], a[72:75], v[92:95]
v_rcp_f32 v229, v229
v_mfma_f32_16x16x32_bf16 v[96:99], a[164:167], a[76:79], v[96:99]
s_waitcnt lgkmcnt(4)
v_rcp_f32 v230, v230
v_mfma_f32_16x16x32_bf16 v[84:87], a[168:171], a[80:83], v[84:87]
ds_read_b128 a[160:163], v211 offset:13312
ds_read_b128 a[164:167], v211 offset:31744
v_rcp_f32_e64 v231, v231
v_mfma_f32_16x16x32_bf16 v[88:91], a[168:171], a[84:87], v[88:91]
buffer_load_dwordx4 v1, s[4:7], s39 offen offset:2048 sc1 lds
buffer_load_dwordx4 v1, s[4:7], s39 offen offset:3072 sc1 lds
v_pk_mul_f32 v[216:217], v[68:69], v[68:69]
v_pk_mul_f32 v[218:219], v[70:71], v[70:71]
v_pk_mul_f32 v[220:221], v[72:73], v[72:73]
v_pk_mul_f32 v[222:223], v[74:75], v[74:75]
v_pk_fma_f32 v[216:217], v[216:217], v[252:253], v[250:251] op_sel:[0,0,0] op_sel_hi:[1,0,0]
v_pk_fma_f32 v[218:219], v[218:219], v[252:253], v[250:251] op_sel:[0,0,0] op_sel_hi:[1,0,0]
v_pk_fma_f32 v[220:221], v[220:221], v[252:253], v[250:251] op_sel:[0,1,1] op_sel_hi:[1,1,1]
v_pk_fma_f32 v[222:223], v[222:223], v[252:253], v[250:251] op_sel:[0,1,1] op_sel_hi:[1,1,1]
v_pk_mul_f32 v[60:61], v[60:61], v[224:225]
v_pk_mul_f32 v[62:63], v[62:63], v[226:227]
v_pk_mul_f32 v[64:65], v[64:65], v[228:229]
v_pk_mul_f32 v[66:67], v[66:67], v[230:231]
v_pk_mul_f32 v[216:217], v[216:217], v[68:69]
v_pk_mul_f32 v[218:219], v[218:219], v[70:71]
v_pk_mul_f32 v[220:221], v[220:221], v[72:73]
v_pk_mul_f32 v[222:223], v[222:223], v[74:75]
v_mfma_f32_16x16x32_bf16 v[92:95], a[172:175], a[80:83], v[92:95]
s_add_u32 m0, m0, 4096
v_exp_f32 v216, v216
v_mfma_f32_16x16x32_bf16 v[96:99], a[172:175], a[84:87], v[96:99]
s_waitcnt lgkmcnt(4)
v_exp_f32 v217, v217
v_mfma_f32_16x16x32_bf16 v[84:87], a[144:147], a[88:91], v[84:87]
ds_read_b128 a[168:171], v211 offset:14336
ds_read_b128 a[172:175], v211 offset:32768
v_exp_f32 v218, v218
v_mfma_f32_16x16x32_bf16 v[88:91], a[144:147], a[92:95], v[88:91]
buffer_store_dwordx4 a[244:247], v9, s[4:7], s101 offen offset:1024 sc1
v_fma_f32 v216, v216, v254, v254
v_mfma_f32_16x16x32_bf16 v[92:95], a[148:151], a[88:91], v[92:95]
s_add_u32 s39, s39, 4096
v_fma_f32 v217, v217, v254, v254
v_mfma_f32_16x16x32_bf16 v[96:99], a[148:151], a[92:95], v[96:99]
s_waitcnt lgkmcnt(4)
v_exp_f32 v219, v219
v_mfma_f32_16x16x32_bf16 v[84:87], a[152:155], a[96:99], v[84:87]
ds_read_b128 a[144:147], v211 offset:15360
ds_read_b128 a[148:151], v211 offset:33792
v_exp_f32 v220, v220
v_mfma_f32_16x16x32_bf16 v[88:91], a[152:155], a[100:103], v[88:91]
v_fma_f32 v218, v218, v254, v254
v_fma_f32 v219, v219, v254, v254
v_mfma_f32_16x16x32_bf16 v[92:95], a[156:159], a[96:99], v[92:95]
v_exp_f32 v221, v221
v_mfma_f32_16x16x32_bf16 v[96:99], a[156:159], a[100:103], v[96:99]
s_waitcnt lgkmcnt(4)
v_exp_f32 v222, v222
v_mfma_f32_16x16x32_bf16 v[84:87], a[160:163], a[104:107], v[84:87]
ds_read_b128 a[152:155], v211 offset:16384
ds_read_b128 a[156:159], v211 offset:34816
v_mfma_f32_16x16x32_bf16 v[88:91], a[160:163], a[108:111], v[88:91]
buffer_load_dwordx4 v1, s[4:7], s39 offen offset:0 sc1 lds
buffer_load_dwordx4 v1, s[4:7], s39 offen offset:1024 sc1 lds
v_mfma_f32_16x16x32_bf16 v[92:95], a[164:167], a[104:107], v[92:95]
v_fma_f32 v220, v220, v255, v255
v_fma_f32 v221, v221, v255, v255
v_mfma_f32_16x16x32_bf16 v[96:99], a[164:167], a[108:111], v[96:99]
s_waitcnt lgkmcnt(4)
v_exp_f32 v223, v223
v_mfma_f32_16x16x32_bf16 v[84:87], a[168:171], a[112:115], v[84:87]
ds_read_b128 a[160:163], v211 offset:17408
ds_read_b128 a[164:167], v211 offset:35840
v_rcp_f32 v216, v216
v_mfma_f32_16x16x32_bf16 v[88:91], a[168:171], a[116:119], v[88:91]
buffer_load_dwordx4 v1, s[4:7], s39 offen offset:2048 sc1 lds
buffer_load_dwordx4 v1, s[4:7], s39 offen offset:3072 sc1 lds
v_mfma_f32_16x16x32_bf16 v[92:95], a[172:175], a[112:115], v[92:95]
s_add_u32 m0, m0, 4096
v_fma_f32 v222, v222, v255, v255
v_fma_f32 v223, v223, v255, v255
v_mfma_f32_16x16x32_bf16 v[96:99], a[172:175], a[116:119], v[96:99]
s_waitcnt lgkmcnt(4)
v_rcp_f32 v217, v217
v_add_u32 v181, 112640, v239
v_mfma_f32_16x16x32_bf16 v[84:87], a[144:147], a[120:123], v[84:87]
ds_read_b64 a[168:169], v181 offset:0
ds_read_b64 a[172:173], v181 offset:512
v_rcp_f32 v218, v218
v_mfma_f32_16x16x32_bf16 v[88:91], a[144:147], a[124:127], v[88:91]
s_add_u32 s39, s39, 4096
v_rcp_f32 v219, v219
v_mfma_f32_16x16x32_bf16 v[92:95], a[148:151], a[120:123], v[92:95]
buffer_store_dwordx4 a[248:251], v9, s[4:7], s101 offen offset:2048 sc1
v_mfma_f32_16x16x32_bf16 v[96:99], a[148:151], a[124:127], v[96:99]
s_waitcnt lgkmcnt(4)
v_rcp_f32 v220, v220
v_mfma_f32_16x16x32_bf16 v[84:87], a[152:155], a[128:131], v[84:87]
ds_read_b128 a[144:147], v208 offset:0
ds_read_b128 a[148:151], v208 offset:1024
v_mfma_f32_16x16x32_bf16 v[88:91], a[152:155], a[132:135], v[88:91]
v_rcp_f32 v221, v221
v_mfma_f32_16x16x32_bf16 v[92:95], a[156:159], a[128:131], v[92:95]
v_rcp_f32 v222, v222
v_mfma_f32_16x16x32_bf16 v[96:99], a[156:159], a[132:135], v[96:99]
s_waitcnt lgkmcnt(4)
v_rcp_f32_e64 v223, v223
v_mfma_f32_16x16x32_bf16 v[84:87], a[160:163], a[136:139], v[84:87]
ds_read_b128 a[152:155], v208 offset:2048
ds_read_b128 a[156:159], v208 offset:3072
v_pk_mul_f32 v[224:225], v[76:77], v[76:77]
v_pk_mul_f32 v[226:227], v[78:79], v[78:79]
v_pk_mul_f32 v[228:229], v[80:81], v[80:81]
v_pk_mul_f32 v[230:231], v[82:83], v[82:83]
v_pk_fma_f32 v[224:225], v[224:225], v[252:253], v[250:251] op_sel:[0,0,0] op_sel_hi:[1,0,0]
v_pk_fma_f32 v[226:227], v[226:227], v[252:253], v[250:251] op_sel:[0,0,0] op_sel_hi:[1,0,0]
v_pk_fma_f32 v[228:229], v[228:229], v[252:253], v[250:251] op_sel:[0,1,1] op_sel_hi:[1,1,1]
v_pk_fma_f32 v[230:231], v[230:231], v[252:253], v[250:251] op_sel:[0,1,1] op_sel_hi:[1,1,1]
v_pk_mul_f32 v[68:69], v[68:69], v[216:217]
v_pk_mul_f32 v[70:71], v[70:71], v[218:219]
v_pk_mul_f32 v[72:73], v[72:73], v[220:221]
v_pk_mul_f32 v[74:75], v[74:75], v[222:223]
v_pk_mul_f32 v[224:225], v[224:225], v[76:77]
v_pk_mul_f32 v[226:227], v[226:227], v[78:79]
v_pk_mul_f32 v[228:229], v[228:229], v[80:81]
v_pk_mul_f32 v[230:231], v[230:231], v[82:83]
v_mfma_f32_16x16x32_bf16 v[88:91], a[160:163], a[140:143], v[88:91]
buffer_load_dwordx4 v1, s[4:7], s39 offen offset:0 sc1 lds
s_lshl_b32 s38, s24, 8
v_exp_f32 v224, v224
v_mfma_f32_16x16x32_bf16 v[92:95], a[164:167], a[136:139], v[92:95]
s_add_u32 m0, s38, 74752
v_exp_f32 v225, v225
v_mfma_f32_16x16x32_bf16 v[96:99], a[164:167], a[140:143], v[96:99]
s_waitcnt lgkmcnt(4)
v_exp_f32 v226, v226
v_mfma_f32_16x16x16_bf16 v[84:87], a[168:169], v[212:213], v[84:87]
ds_read_b128 a[160:163], v208 offset:4096
ds_read_b128 a[164:167], v208 offset:5120
v_mfma_f32_16x16x16_bf16 v[88:91], a[168:169], v[214:215], v[88:91]
s_add_u32 s39, s38, s82
v_fma_f32 v224, v224, v254, v254
v_fma_f32 v225, v225, v254, v254
v_mfma_f32_16x16x16_bf16 v[92:95], a[172:173], v[212:213], v[92:95]
s_add_u32 s39, s39, 264192
v_exp_f32 v227, v227
v_mfma_f32_16x16x16_bf16 v[96:99], a[172:173], v[214:215], v[96:99]
s_waitcnt lgkmcnt(4)
v_exp_f32 v228, v228
s_waitcnt vmcnt(12)
s_barrier
v_mfma_f32_16x16x32_bf16 v[100:103], a[144:147], a[0:3], 0
ds_read_b128 a[168:171], v208 offset:6144
ds_read_b128 a[172:175], v208 offset:7168
v_mfma_f32_16x16x32_bf16 v[104:107], a[144:147], a[4:7], 0
v_fma_f32 v226, v226, v254, v254
v_fma_f32 v227, v227, v254, v254
v_mfma_f32_16x16x32_bf16 v[100:103], a[148:151], a[8:11], v[100:103]
v_exp_f32 v229, v229
v_mfma_f32_16x16x32_bf16 v[104:107], a[148:151], a[12:15], v[104:107]
s_waitcnt lgkmcnt(4)
v_exp_f32 v230, v230
v_mfma_f32_16x16x32_bf16 v[100:103], a[152:155], a[16:19], v[100:103]
ds_read_b128 a[144:147], v208 offset:8192
ds_read_b128 a[148:151], v208 offset:9216
v_mfma_f32_16x16x32_bf16 v[104:107], a[152:155], a[20:23], v[104:107]
s_mov_b64 exec, 0xffff
buffer_load_dwordx4 v1, s[4:7], s39 offen sc1 lds
s_mov_b64 exec, -1
v_fma_f32 v228, v228, v255, v255
v_fma_f32 v229, v229, v255, v255
v_mfma_f32_16x16x32_bf16 v[100:103], a[156:159], a[24:27], v[100:103]
buffer_store_dwordx4 a[252:255], v9, s[4:7], s101 offen offset:3072 sc1
v_exp_f32 v231, v231
v_mfma_f32_16x16x32_bf16 v[104:107], a[156:159], a[28:31], v[104:107]
s_waitcnt lgkmcnt(4)
v_rcp_f32 v224, v224
v_mfma_f32_16x16x32_bf16 v[100:103], a[160:163], a[32:35], v[100:103]
ds_read_b128 a[152:155], v208 offset:10240
ds_read_b128 a[156:159], v208 offset:11264
v_mfma_f32_16x16x32_bf16 v[104:107], a[160:163], a[36:39], v[104:107]
s_mov_b32 s101, 1073741824
v_fma_f32 v230, v230, v255, v255
v_fma_f32 v231, v231, v255, v255
v_mfma_f32_16x16x32_bf16 v[100:103], a[164:167], a[40:43], v[100:103]
v_rcp_f32 v225, v225
v_mfma_f32_16x16x32_bf16 v[104:107], a[164:167], a[44:47], v[104:107]
s_waitcnt lgkmcnt(4)
v_rcp_f32 v226, v226
v_mfma_f32_16x16x32_bf16 v[100:103], a[168:171], a[48:51], v[100:103]
ds_read_b128 a[160:163], v208 offset:12288
ds_read_b128 a[164:167], v208 offset:13312
v_mfma_f32_16x16x32_bf16 v[104:107], a[168:171], a[52:55], v[104:107]
s_mul_i32 s38, s24, 9216
v_rcp_f32 v227, v227
v_mfma_f32_16x16x32_bf16 v[100:103], a[172:175], a[56:59], v[100:103]
s_add_u32 m0, s38, 75776
v_rcp_f32 v228, v228
v_mfma_f32_16x16x32_bf16 v[104:107], a[172:175], a[60:63], v[104:107]
s_waitcnt lgkmcnt(4)
v_rcp_f32 v229, v229
v_mfma_f32_16x16x32_bf16 v[100:103], a[144:147], a[64:67], v[100:103]
ds_read_b128 a[168:171], v208 offset:14336
ds_read_b128 a[172:175], v208 offset:15360
v_mfma_f32_16x16x32_bf16 v[104:107], a[144:147], a[68:71], v[104:107]
s_add_u32 s39, s38, s82
v_rcp_f32 v230, v230
v_mfma_f32_16x16x32_bf16 v[100:103], a[148:151], a[72:75], v[100:103]
s_add_u32 s39, s39, 265216
v_rcp_f32 v231, v231
v_mfma_f32_16x16x32_bf16 v[104:107], a[148:151], a[76:79], v[104:107]
s_waitcnt lgkmcnt(4)
v_pk_mul_f32 v[216:217], v[84:85], v[84:85]
v_pk_mul_f32 v[218:219], v[86:87], v[86:87]
v_pk_mul_f32 v[220:221], v[88:89], v[88:89]
v_pk_mul_f32 v[222:223], v[90:91], v[90:91]
v_pk_fma_f32 v[216:217], v[216:217], v[252:253], v[250:251] op_sel:[0,0,0] op_sel_hi:[1,0,0]
v_pk_fma_f32 v[218:219], v[218:219], v[252:253], v[250:251] op_sel:[0,0,0] op_sel_hi:[1,0,0]
v_pk_fma_f32 v[220:221], v[220:221], v[252:253], v[250:251] op_sel:[0,1,1] op_sel_hi:[1,1,1]
v_pk_fma_f32 v[222:223], v[222:223], v[252:253], v[250:251] op_sel:[0,1,1] op_sel_hi:[1,1,1]
v_pk_mul_f32 v[76:77], v[76:77], v[224:225]
v_pk_mul_f32 v[78:79], v[78:79], v[226:227]
v_pk_mul_f32 v[80:81], v[80:81], v[228:229]
v_pk_mul_f32 v[82:83], v[82:83], v[230:231]
v_pk_mul_f32 v[216:217], v[216:217], v[84:85]
v_pk_mul_f32 v[218:219], v[218:219], v[86:87]
v_pk_mul_f32 v[220:221], v[220:221], v[88:89]
v_pk_mul_f32 v[222:223], v[222:223], v[90:91]
v_mfma_f32_16x16x32_bf16 v[100:103], a[152:155], a[80:83], v[100:103]
ds_read_b128 a[144:147], v208 offset:16384
ds_read_b128 a[148:151], v208 offset:17408
v_exp_f32 v216, v216
v_mfma_f32_16x16x32_bf16 v[104:107], a[152:155], a[84:87], v[104:107]
v_exp_f32 v217, v217
v_mfma_f32_16x16x32_bf16 v[100:103], a[156:159], a[88:91], v[100:103]
buffer_load_dwordx4 v1, s[4:7], s39 offen offset:0 sc1 lds
buffer_load_dwordx4 v1, s[4:7], s39 offen offset:1024 sc1 lds
v_exp_f32 v218, v218
v_mfma_f32_16x16x32_bf16 v[104:107], a[156:159], a[92:95], v[104:107]
s_waitcnt lgkmcnt(4)
v_fma_f32 v216, v216, v254, v254
v_add_u32 v181, 160768, v239
v_mfma_f32_16x16x32_bf16 v[100:103], a[160:163], a[96:99], v[100:103]
ds_read_b64 a[152:153], v181 offset:0
ds_read_b128 a[156:159], v208 offset:18432
v_fma_f32 v217, v217, v254, v254
v_mfma_f32_16x16x32_bf16 v[104:107], a[160:163], a[100:103], v[104:107]
v_exp_f32 v219, v219
v_mfma_f32_16x16x32_bf16 v[100:103], a[164:167], a[104:107], v[100:103]
v_exp_f32 v220, v220
v_mfma_f32_16x16x32_bf16 v[104:107], a[164:167], a[108:111], v[104:107]
s_waitcnt lgkmcnt(4)
v_fma_f32 v218, v218, v254, v254
v_fma_f32 v219, v219, v254, v254
v_mfma_f32_16x16x32_bf16 v[100:103], a[168:171], a[112:115], v[100:103]
ds_read_b128 a[160:163], v208 offset:19456
ds_read_b128 a[164:167], v208 offset:20480
v_mfma_f32_16x16x32_bf16 v[104:107], a[168:171], a[116:119], v[104:107]
buffer_load_dwordx4 v1, s[4:7], s39 offen offset:2048 sc1 lds
buffer_load_dwordx4 v1, s[4:7], s39 offen offset:3072 sc1 lds
v_exp_f32 v221, v221
v_mfma_f32_16x16x32_bf16 v[100:103], a[172:175], a[120:123], v[100:103]
s_add_u32 m0, m0, 4096
v_exp_f32 v222, v222
v_mfma_f32_16x16x32_bf16 v[104:107], a[172:175], a[124:127], v[104:107]
s_waitcnt lgkmcnt(4)
v_fma_f32 v220, v220, v255, v255
v_fma_f32 v221, v221, v255, v255
v_mfma_f32_16x16x32_bf16 v[100:103], a[144:147], a[128:131], v[100:103]
ds_read_b128 a[168:171], v208 offset:21504
ds_read_b128 a[172:175], v208 offset:22528
v_mfma_f32_16x16x32_bf16 v[104:107], a[144:147], a[132:135], v[104:107]
s_add_u32 s39, s39, 4096
v_exp_f32 v223, v223
v_mfma_f32_16x16x32_bf16 v[100:103], a[148:151], a[136:139], v[100:103]
v_rcp_f32 v216, v216
v_mfma_f32_16x16x32_bf16 v[104:107], a[148:151], a[140:143], v[104:107]
s_waitcnt lgkmcnt(4)
v_fma_f32 v222, v222, v255, v255
v_fma_f32 v223, v223, v255, v255
v_mfma_f32_16x16x16_bf16 v[100:103], a[152:153], v[212:213], v[100:103]
ds_read_b128 a[144:147], v208 offset:23552
ds_read_b128 a[148:151], v208 offset:24576
v_mfma_f32_16x16x16_bf16 v[104:107], a[152:153], v[214:215], v[104:107]
buffer_load_dwordx4 v1, s[4:7], s39 offen offset:0 sc1 lds
buffer_load_dwordx4 v1, s[4:7], s39 offen offset:1024 sc1 lds
v_rcp_f32 v217, v217
v_mfma_f32_16x16x32_bf16 v[108:111], a[156:159], a[0:3], 0
v_rcp_f32 v218, v218
v_mfma_f32_16x16x32_bf16 v[112:115], a[156:159], a[4:7], 0
s_waitcnt lgkmcnt(4)
v_rcp_f32 v219, v219
v_mfma_f32_16x16x32_bf16 v[108:111], a[160:163], a[8:11], v[108:111]
ds_read_b128 a[152:155], v208 offset:25600
ds_read_b128 a[156:159], v208 offset:26624
v_mfma_f32_16x16x32_bf16 v[112:115], a[160:163], a[12:15], v[112:115]
v_rcp_f32 v220, v220
v_mfma_f32_16x16x32_bf16 v[108:111], a[164:167], a[16:19], v[108:111]
v_rcp_f32 v221, v221
v_mfma_f32_16x16x32_bf16 v[112:115], a[164:167], a[20:23], v[112:115]
s_waitcnt lgkmcnt(4)
v_rcp_f32 v222, v222
v_mfma_f32_16x16x32_bf16 v[108:111], a[168:171], a[24:27], v[108:111]
ds_read_b128 a[160:163], v208 offset:27648
ds_read_b128 a[164:167], v208 offset:28672
v_mfma_f32_16x16x32_bf16 v[112:115], a[168:171], a[28:31], v[112:115]
buffer_load_dwordx4 v1, s[4:7], s39 offen offset:2048 sc1 lds
buffer_load_dwordx4 v1, s[4:7], s39 offen offset:3072 sc1 lds
v_rcp_f32 v223, v223
v_mfma_f32_16x16x32_bf16 v[108:111], a[172:175], a[32:35], v[108:111]
s_add_u32 m0, m0, 4096
v_pk_mul_f32 v[224:225], v[92:93], v[92:93]
v_pk_mul_f32 v[226:227], v[94:95], v[94:95]
v_pk_mul_f32 v[228:229], v[96:97], v[96:97]
v_pk_mul_f32 v[230:231], v[98:99], v[98:99]
v_pk_fma_f32 v[224:225], v[224:225], v[252:253], v[250:251] op_sel:[0,0,0] op_sel_hi:[1,0,0]
v_pk_fma_f32 v[226:227], v[226:227], v[252:253], v[250:251] op_sel:[0,0,0] op_sel_hi:[1,0,0]
v_pk_fma_f32 v[228:229], v[228:229], v[252:253], v[250:251] op_sel:[0,1,1] op_sel_hi:[1,1,1]
v_pk_fma_f32 v[230:231], v[230:231], v[252:253], v[250:251] op_sel:[0,1,1] op_sel_hi:[1,1,1]
v_pk_mul_f32 v[84:85], v[84:85], v[216:217]
v_pk_mul_f32 v[86:87], v[86:87], v[218:219]
v_pk_mul_f32 v[88:89], v[88:89], v[220:221]
v_pk_mul_f32 v[90:91], v[90:91], v[222:223]
v_pk_mul_f32 v[224:225], v[224:225], v[92:93]
v_pk_mul_f32 v[226:227], v[226:227], v[94:95]
v_pk_mul_f32 v[228:229], v[228:229], v[96:97]
v_pk_mul_f32 v[230:231], v[230:231], v[98:99]
v_mfma_f32_16x16x32_bf16 v[112:115], a[172:175], a[36:39], v[112:115]
s_waitcnt lgkmcnt(4)
v_exp_f32 v224, v224
v_mfma_f32_16x16x32_bf16 v[108:111], a[144:147], a[40:43], v[108:111]
ds_read_b128 a[168:171], v208 offset:29696
ds_read_b128 a[172:175], v208 offset:30720
v_exp_f32 v225, v225
v_mfma_f32_16x16x32_bf16 v[112:115], a[144:147], a[44:47], v[112:115]
s_add_u32 s39, s39, 4096
v_exp_f32 v226, v226
v_mfma_f32_16x16x32_bf16 v[108:111], a[148:151], a[48:51], v[108:111]
v_fma_f32 v224, v224, v254, v254
v_fma_f32 v225, v225, v254, v254
v_mfma_f32_16x16x32_bf16 v[112:115], a[148:151], a[52:55], v[112:115]
s_waitcnt lgkmcnt(4)
v_exp_f32 v227, v227
v_mfma_f32_16x16x32_bf16 v[108:111], a[152:155], a[56:59], v[108:111]
ds_read_b128 a[144:147], v208 offset:31744
ds_read_b128 a[148:151], v208 offset:32768
v_mfma_f32_16x16x32_bf16 v[112:115], a[152:155], a[60:63], v[112:115]
buffer_load_dwordx4 v1, s[4:7], s39 offen offset:0 sc1 lds
v_exp_f32 v228, v228
v_mfma_f32_16x16x32_bf16 v[108:111], a[156:159], a[64:67], v[108:111]
s_lshl_b32 s38, s24, 8
v_fma_f32 v226, v226, v254, v254
v_fma_f32 v227, v227, v254, v254
v_mfma_f32_16x16x32_bf16 v[112:115], a[156:159], a[68:71], v[112:115]
s_waitcnt lgkmcnt(4)
v_exp_f32 v229, v229
v_mfma_f32_16x16x32_bf16 v[108:111], a[160:163], a[72:75], v[108:111]
ds_read_b128 a[152:155], v208 offset:33792
ds_read_b128 a[156:159], v208 offset:34816
v_mfma_f32_16x16x32_bf16 v[112:115], a[160:163], a[76:79], v[112:115]
s_add_u32 m0, s38, 112640
v_exp_f32 v230, v230
v_mfma_f32_16x16x32_bf16 v[108:111], a[164:167], a[80:83], v[108:111]
s_add_u32 s39, s38, s82
v_fma_f32 v228, v228, v255, v255
v_fma_f32 v229, v229, v255, v255
v_mfma_f32_16x16x32_bf16 v[112:115], a[164:167], a[84:87], v[112:115]
s_waitcnt lgkmcnt(4)
v_exp_f32 v231, v231
v_mfma_f32_16x16x32_bf16 v[108:111], a[168:171], a[88:91], v[108:111]
ds_read_b128 a[160:163], v208 offset:35840
ds_read_b64 a[164:165], v181 offset:512
v_mfma_f32_16x16x32_bf16 v[112:115], a[168:171], a[92:95], v[112:115]
s_add_u32 s39, s39, 302080
v_rcp_f32 v224, v224
v_mfma_f32_16x16x32_bf16 v[108:111], a[172:175], a[96:99], v[108:111]
v_fma_f32 v230, v230, v255, v255
v_fma_f32 v231, v231, v255, v255
v_mfma_f32_16x16x32_bf16 v[112:115], a[172:175], a[100:103], v[112:115]
s_waitcnt lgkmcnt(4)
v_rcp_f32 v225, v225
v_mfma_f32_16x16x32_bf16 v[108:111], a[144:147], a[104:107], v[108:111]
ds_read_b128 a[168:171], v209 offset:0
ds_read_b128 a[172:175], v209 offset:18432
v_mfma_f32_16x16x32_bf16 v[112:115], a[144:147], a[108:111], v[112:115]
v_rcp_f32 v226, v226
v_mfma_f32_16x16x32_bf16 v[108:111], a[148:151], a[112:115], v[108:111]
s_mov_b64 exec, 0xffff
buffer_load_dwordx4 v1, s[4:7], s39 offen sc1 lds
s_mov_b64 exec, -1
v_mfma_f32_16x16x32_bf16 v[112:115], a[148:151], a[116:119], v[112:115]
s_waitcnt lgkmcnt(4)
v_rcp_f32 v227, v227
v_mfma_f32_16x16x32_bf16 v[108:111], a[152:155], a[120:123], v[108:111]
ds_read_b128 a[144:147], v209 offset:1024
ds_read_b128 a[148:151], v209 offset:19456
v_rcp_f32 v228, v228
v_mfma_f32_16x16x32_bf16 v[112:115], a[152:155], a[124:127], v[112:115]
v_rcp_f32 v229, v229
v_mfma_f32_16x16x32_bf16 v[108:111], a[156:159], a[128:131], v[108:111]
v_rcp_f32 v230, v230
v_mfma_f32_16x16x32_bf16 v[112:115], a[156:159], a[132:135], v[112:115]
s_waitcnt lgkmcnt(4)
v_rcp_f32 v231, v231
v_mfma_f32_16x16x32_bf16 v[108:111], a[160:163], a[136:139], v[108:111]
ds_read_b128 a[152:155], v209 offset:2048
ds_read_b128 a[156:159], v209 offset:20480
v_pk_mul_f32 v[216:217], v[100:101], v[100:101]
v_pk_mul_f32 v[218:219], v[102:103], v[102:103]
v_pk_mul_f32 v[220:221], v[104:105], v[104:105]
v_pk_mul_f32 v[222:223], v[106:107], v[106:107]
v_pk_fma_f32 v[216:217], v[216:217], v[252:253], v[250:251] op_sel:[0,0,0] op_sel_hi:[1,0,0]
v_pk_fma_f32 v[218:219], v[218:219], v[252:253], v[250:251] op_sel:[0,0,0] op_sel_hi:[1,0,0]
v_pk_fma_f32 v[220:221], v[220:221], v[252:253], v[250:251] op_sel:[0,1,1] op_sel_hi:[1,1,1]
v_pk_fma_f32 v[222:223], v[222:223], v[252:253], v[250:251] op_sel:[0,1,1] op_sel_hi:[1,1,1]
v_pk_mul_f32 v[92:93], v[92:93], v[224:225]
v_pk_mul_f32 v[94:95], v[94:95], v[226:227]
v_pk_mul_f32 v[96:97], v[96:97], v[228:229]
v_pk_mul_f32 v[98:99], v[98:99], v[230:231]
v_pk_mul_f32 v[216:217], v[216:217], v[100:101]
v_pk_mul_f32 v[218:219], v[218:219], v[102:103]
v_pk_mul_f32 v[220:221], v[220:221], v[104:105]
v_pk_mul_f32 v[222:223], v[222:223], v[106:107]
v_mfma_f32_16x16x32_bf16 v[112:115], a[160:163], a[140:143], v[112:115]
v_exp_f32 v216, v216
v_mfma_f32_16x16x16_bf16 v[108:111], a[164:165], v[212:213], v[108:111]
v_exp_f32 v217, v217
v_mfma_f32_16x16x16_bf16 v[112:115], a[164:165], v[214:215], v[112:115]
s_waitcnt vmcnt(11) lgkmcnt(4)
s_barrier
v_mfma_f32_16x16x32_bf16 v[116:119], a[168:171], a[0:3], 0
ds_read_b128 a[160:163], v209 offset:3072
ds_read_b128 a[164:167], v209 offset:21504
v_exp_f32 v218, v218
v_mfma_f32_16x16x32_bf16 v[120:123], a[168:171], a[4:7], 0
s_mul_i32 s38, s24, 9216
s_add_u32 m0, s38, 123904
v_fma_f32 v216, v216, v254, v254
v_mfma_f32_16x16x32_bf16 v[124:127], a[172:175], a[0:3], 0
s_add_u32 s39, s38, s82
v_fma_f32 v217, v217, v254, v254
v_mfma_f32_16x16x32_bf16 v[128:131], a[172:175], a[4:7], 0
s_waitcnt lgkmcnt(4)
s_add_u32 s39, s39, 303104
v_exp_f32 v219, v219
v_mfma_f32_16x16x32_bf16 v[116:119], a[144:147], a[8:11], v[116:119]
ds_read_b128 a[168:171], v209 offset:4096
ds_read_b128 a[172:175], v209 offset:22528
v_exp_f32 v220, v220
v_mfma_f32_16x16x32_bf16 v[120:123], a[144:147], a[12:15], v[120:123]
buffer_load_dwordx4 v1, s[4:7], s39 offen offset:0 sc1 lds
buffer_load_dwordx4 v1, s[4:7], s39 offen offset:1024 sc1 lds
v_mfma_f32_16x16x32_bf16 v[124:127], a[148:151], a[8:11], v[124:127]
v_fma_f32 v218, v218, v254, v254
v_fma_f32 v219, v219, v254, v254
v_mfma_f32_16x16x32_bf16 v[128:131], a[148:151], a[12:15], v[128:131]
s_waitcnt lgkmcnt(4)
v_exp_f32 v221, v221
v_mfma_f32_16x16x32_bf16 v[116:119], a[152:155], a[16:19], v[116:119]
ds_read_b128 a[144:147], v209 offset:5120
ds_read_b128 a[148:151], v209 offset:23552
v_exp_f32 v222, v222
v_mfma_f32_16x16x32_bf16 v[120:123], a[152:155], a[20:23], v[120:123]
buffer_load_dwordx4 v1, s[4:7], s39 offen offset:2048 sc1 lds
buffer_load_dwordx4 v1, s[4:7], s39 offen offset:3072 sc1 lds
v_mfma_f32_16x16x32_bf16 v[124:127], a[156:159], a[16:19], v[124:127]
s_add_u32 m0, m0, 4096
v_fma_f32 v220, v220, v255, v255
v_fma_f32 v221, v221, v255, v255
v_mfma_f32_16x16x32_bf16 v[128:131], a[156:159], a[20:23], v[128:131]
s_waitcnt lgkmcnt(4)
s_add_u32 s39, s39, 4096
v_exp_f32 v223, v223
v_mfma_f32_16x16x32_bf16 v[116:119], a[160:163], a[24:27], v[116:119]
ds_read_b128 a[152:155], v209 offset:6144
ds_read_b128 a[156:159], v209 offset:24576
v_rcp_f32 v216, v216
v_mfma_f32_16x16x32_bf16 v[120:123], a[160:163], a[28:31], v[120:123]
buffer_load_dwordx4 v1, s[4:7], s39 offen offset:0 sc1 lds
buffer_load_dwordx4 v1, s[4:7], s39 offen offset:1024 sc1 lds
v_mfma_f32_16x16x32_bf16 v[124:127], a[164:167], a[24:27], v[124:127]
v_fma_f32 v222, v222, v255, v255
v_fma_f32 v223, v223, v255, v255
v_mfma_f32_16x16x32_bf16 v[128:131], a[164:167], a[28:31], v[128:131]
s_waitcnt lgkmcnt(4)
v_rcp_f32 v217, v217
v_mfma_f32_16x16x32_bf16 v[116:119], a[168:171], a[32:35], v[116:119]
ds_read_b128 a[160:163], v209 offset:7168
ds_read_b128 a[164:167], v209 offset:25600
v_rcp_f32 v218, v218
v_mfma_f32_16x16x32_bf16 v[120:123], a[168:171], a[36:39], v[120:123]
buffer_load_dwordx4 v1, s[4:7], s39 offen offset:2048 sc1 lds
buffer_load_dwordx4 v1, s[4:7], s39 offen offset:3072 sc1 lds
v_mfma_f32_16x16x32_bf16 v[124:127], a[172:175], a[32:35], v[124:127]
s_add_u32 m0, m0, 4096
s_add_u32 s39, s39, 4096
v_rcp_f32 v219, v219
v_mfma_f32_16x16x32_bf16 v[128:131], a[172:175], a[36:39], v[128:131]
s_waitcnt lgkmcnt(4)
v_rcp_f32 v220, v220
v_mfma_f32_16x16x32_bf16 v[116:119], a[144:147], a[40:43], v[116:119]
ds_read_b128 a[168:171], v209 offset:8192
ds_read_b128 a[172:175], v209 offset:26624
v_rcp_f32 v221, v221
v_rcp_f32 v222, v222
v_rcp_f32 v223, v223
v_mfma_f32_16x16x32_bf16 v[120:123], a[144:147], a[44:47], v[120:123]
buffer_load_dwordx4 v1, s[4:7], s39 offen offset:0 sc1 lds
s_lshl_b32 s38, s24, 8
s_nop 0
v_pk_mul_f32 v[100:101], v[100:101], v[216:217]
v_pk_mul_f32 v[102:103], v[102:103], v[218:219]
v_pk_mul_f32 v[104:105], v[104:105], v[220:221]
v_pk_mul_f32 v[106:107], v[106:107], v[222:223]
v_pk_add_f32 v[198:199], v[36:37], v[38:39]
v_pk_mul_f32 v[200:201], v[36:37], v[36:37]
v_pk_fma_f32 v[200:201], v[38:39], v[38:39], v[200:201]
v_pk_add_f32 v[202:203], v[40:41], v[42:43]
v_pk_mul_f32 v[204:205], v[40:41], v[40:41]
v_pk_fma_f32 v[204:205], v[42:43], v[42:43], v[204:205]
v_pk_add_f32 v[198:199], v[198:199], v[44:45]
v_pk_fma_f32 v[200:201], v[44:45], v[44:45], v[200:201]
v_pk_add_f32 v[198:199], v[198:199], v[46:47]
v_pk_fma_f32 v[200:201], v[46:47], v[46:47], v[200:201]
v_pk_add_f32 v[202:203], v[202:203], v[48:49]
v_pk_fma_f32 v[204:205], v[48:49], v[48:49], v[204:205]
v_pk_add_f32 v[202:203], v[202:203], v[50:51]
v_pk_fma_f32 v[204:205], v[50:51], v[50:51], v[204:205]
v_pk_add_f32 v[198:199], v[198:199], v[52:53]
v_pk_fma_f32 v[200:201], v[52:53], v[52:53], v[200:201]
v_pk_add_f32 v[198:199], v[198:199], v[54:55]
v_pk_fma_f32 v[200:201], v[54:55], v[54:55], v[200:201]
v_pk_add_f32 v[202:203], v[202:203], v[56:57]
v_pk_fma_f32 v[204:205], v[56:57], v[56:57], v[204:205]
v_pk_add_f32 v[202:203], v[202:203], v[58:59]
v_pk_fma_f32 v[204:205], v[58:59], v[58:59], v[204:205]
v_pk_add_f32 v[198:199], v[198:199], v[60:61]
v_pk_fma_f32 v[200:201], v[60:61], v[60:61], v[200:201]
v_pk_add_f32 v[198:199], v[198:199], v[62:63]
v_pk_fma_f32 v[200:201], v[62:63], v[62:63], v[200:201]
v_pk_add_f32 v[202:203], v[202:203], v[64:65]
v_pk_fma_f32 v[204:205], v[64:65], v[64:65], v[204:205]
v_pk_add_f32 v[202:203], v[202:203], v[66:67]
v_pk_fma_f32 v[204:205], v[66:67], v[66:67], v[204:205]
v_pk_add_f32 v[198:199], v[198:199], v[68:69]
v_pk_fma_f32 v[200:201], v[68:69], v[68:69], v[200:201]
v_pk_add_f32 v[198:199], v[198:199], v[70:71]
v_pk_fma_f32 v[200:201], v[70:71], v[70:71], v[200:201]
v_pk_add_f32 v[202:203], v[202:203], v[72:73]
v_pk_fma_f32 v[204:205], v[72:73], v[72:73], v[204:205]
v_pk_add_f32 v[202:203], v[202:203], v[74:75]
v_pk_fma_f32 v[204:205], v[74:75], v[74:75], v[204:205]
v_pk_add_f32 v[198:199], v[198:199], v[76:77]
v_pk_fma_f32 v[200:201], v[76:77], v[76:77], v[200:201]
v_pk_add_f32 v[198:199], v[198:199], v[78:79]
v_pk_fma_f32 v[200:201], v[78:79], v[78:79], v[200:201]
v_pk_add_f32 v[202:203], v[202:203], v[80:81]
v_pk_fma_f32 v[204:205], v[80:81], v[80:81], v[204:205]
v_pk_add_f32 v[202:203], v[202:203], v[82:83]
v_pk_fma_f32 v[204:205], v[82:83], v[82:83], v[204:205]
v_pk_add_f32 v[198:199], v[198:199], v[84:85]
v_pk_fma_f32 v[200:201], v[84:85], v[84:85], v[200:201]
v_pk_add_f32 v[198:199], v[198:199], v[86:87]
v_pk_fma_f32 v[200:201], v[86:87], v[86:87], v[200:201]
v_pk_add_f32 v[202:203], v[202:203], v[88:89]
v_pk_fma_f32 v[204:205], v[88:89], v[88:89], v[204:205]
v_pk_add_f32 v[202:203], v[202:203], v[90:91]
v_pk_fma_f32 v[204:205], v[90:91], v[90:91], v[204:205]
v_pk_add_f32 v[198:199], v[198:199], v[92:93]
v_pk_fma_f32 v[200:201], v[92:93], v[92:93], v[200:201]
v_pk_add_f32 v[198:199], v[198:199], v[94:95]
v_pk_fma_f32 v[200:201], v[94:95], v[94:95], v[200:201]
v_pk_add_f32 v[202:203], v[202:203], v[96:97]
v_pk_fma_f32 v[204:205], v[96:97], v[96:97], v[204:205]
v_pk_add_f32 v[202:203], v[202:203], v[98:99]
v_pk_fma_f32 v[204:205], v[98:99], v[98:99], v[204:205]
v_pk_add_f32 v[198:199], v[198:199], v[100:101]
v_pk_fma_f32 v[200:201], v[100:101], v[100:101], v[200:201]
v_pk_add_f32 v[198:199], v[198:199], v[102:103]
v_pk_fma_f32 v[200:201], v[102:103], v[102:103], v[200:201]
v_pk_add_f32 v[202:203], v[202:203], v[104:105]
v_pk_fma_f32 v[204:205], v[104:105], v[104:105], v[204:205]
v_pk_add_f32 v[202:203], v[202:203], v[106:107]
v_pk_fma_f32 v[204:205], v[106:107], v[106:107], v[204:205]
v_mfma_f32_16x16x32_bf16 v[124:127], a[148:151], a[40:43], v[124:127]
s_add_u32 m0, s38, 160768
v_add_f32 v198, v198, v199
v_add_f32 v202, v202, v203
v_mfma_f32_16x16x32_bf16 v[128:131], a[148:151], a[44:47], v[128:131]
s_waitcnt lgkmcnt(4)
s_add_u32 s39, s38, s82
v_add_f32 v200, v200, v201
v_add_f32 v204, v204, v205
v_permlane16_swap_b32 v198, v202
v_mfma_f32_16x16x32_bf16 v[116:119], a[152:155], a[48:51], v[116:119]
ds_read_b128 a[144:147], v209 offset:9216
ds_read_b128 a[148:151], v209 offset:27648
s_nop 0
v_mfma_f32_16x16x32_bf16 v[120:123], a[152:155], a[52:55], v[120:123]
s_add_u32 s39, s39, 339968
v_permlane16_swap_b32 v200, v204
v_add_f32 v198, v198, v202
v_mfma_f32_16x16x32_bf16 v[124:127], a[156:159], a[48:51], v[124:127]
s_mov_b64 exec, 0xffff
buffer_load_dwordx4 v1, s[4:7], s39 offen sc1 lds
s_mov_b64 exec, -1
v_add_f32 v199, v200, v204
v_mov_b32 v200, v198
v_mfma_f32_16x16x32_bf16 v[128:131], a[156:159], a[52:55], v[128:131]
s_waitcnt lgkmcnt(4)
v_mov_b32 v201, v199
s_nop 0
v_permlane32_swap_b32 v198, v200
v_mfma_f32_16x16x32_bf16 v[116:119], a[160:163], a[56:59], v[116:119]
ds_read_b128 a[152:155], v209 offset:10240
ds_read_b128 a[156:159], v209 offset:28672
v_permlane32_swap_b32 v199, v201
v_mfma_f32_16x16x32_bf16 v[120:123], a[160:163], a[60:63], v[120:123]
v_add_f32 v198, v198, v200
v_add_f32 v199, v199, v201
v_mfma_f32_16x16x32_bf16 v[124:127], a[164:167], a[56:59], v[124:127]
s_waitcnt vmcnt(20)
s_mov_b32 exec_hi, 0
buffer_store_dwordx2 v[198:199], v239, s[8:11], s30 offen sc1
s_mov_b64 exec, -1
v_mfma_f32_16x16x32_bf16 v[128:131], a[164:167], a[60:63], v[128:131]
s_waitcnt lgkmcnt(4)
v_mfma_f32_16x16x32_bf16 v[116:119], a[168:171], a[64:67], v[116:119]
ds_read_b128 a[160:163], v209 offset:11264
ds_read_b128 a[164:167], v209 offset:29696
v_mfma_f32_16x16x32_bf16 v[120:123], a[168:171], a[68:71], v[120:123]
v_mfma_f32_16x16x32_bf16 v[124:127], a[172:175], a[64:67], v[124:127]
v_mfma_f32_16x16x32_bf16 v[128:131], a[172:175], a[68:71], v[128:131]
s_waitcnt lgkmcnt(4)
v_mfma_f32_16x16x32_bf16 v[116:119], a[144:147], a[72:75], v[116:119]
ds_read_b128 a[168:171], v209 offset:12288
ds_read_b128 a[172:175], v209 offset:30720
v_mfma_f32_16x16x32_bf16 v[120:123], a[144:147], a[76:79], v[120:123]
v_mfma_f32_16x16x32_bf16 v[124:127], a[148:151], a[72:75], v[124:127]
v_mfma_f32_16x16x32_bf16 v[128:131], a[148:151], a[76:79], v[128:131]
s_waitcnt lgkmcnt(4)
v_mfma_f32_16x16x32_bf16 v[116:119], a[152:155], a[80:83], v[116:119]
ds_read_b128 a[144:147], v209 offset:13312
ds_read_b128 a[148:151], v209 offset:31744
v_mfma_f32_16x16x32_bf16 v[120:123], a[152:155], a[84:87], v[120:123]
v_mfma_f32_16x16x32_bf16 v[124:127], a[156:159], a[80:83], v[124:127]
v_mfma_f32_16x16x32_bf16 v[128:131], a[156:159], a[84:87], v[128:131]
s_waitcnt lgkmcnt(4)
v_mfma_f32_16x16x32_bf16 v[116:119], a[160:163], a[88:91], v[116:119]
ds_read_b128 a[152:155], v209 offset:14336
ds_read_b128 a[156:159], v209 offset:32768
v_mfma_f32_16x16x32_bf16 v[120:123], a[160:163], a[92:95], v[120:123]
v_mfma_f32_16x16x32_bf16 v[124:127], a[164:167], a[88:91], v[124:127]
v_mfma_f32_16x16x32_bf16 v[128:131], a[164:167], a[92:95], v[128:131]
s_waitcnt lgkmcnt(4)
v_mfma_f32_16x16x32_bf16 v[116:119], a[168:171], a[96:99], v[116:119]
ds_read_b128 a[160:163], v209 offset:15360
ds_read_b128 a[164:167], v209 offset:33792
v_mfma_f32_16x16x32_bf16 v[120:123], a[168:171], a[100:103], v[120:123]
v_mfma_f32_16x16x32_bf16 v[124:127], a[172:175], a[96:99], v[124:127]
v_mfma_f32_16x16x32_bf16 v[128:131], a[172:175], a[100:103], v[128:131]
s_waitcnt lgkmcnt(4)
v_mfma_f32_16x16x32_bf16 v[116:119], a[144:147], a[104:107], v[116:119]
ds_read_b128 a[168:171], v209 offset:16384
ds_read_b128 a[172:175], v209 offset:34816
v_mfma_f32_16x16x32_bf16 v[120:123], a[144:147], a[108:111], v[120:123]
v_mfma_f32_16x16x32_bf16 v[124:127], a[148:151], a[104:107], v[124:127]
v_mfma_f32_16x16x32_bf16 v[128:131], a[148:151], a[108:111], v[128:131]
s_waitcnt lgkmcnt(4)
v_mfma_f32_16x16x32_bf16 v[116:119], a[152:155], a[112:115], v[116:119]
ds_read_b128 a[144:147], v209 offset:17408
ds_read_b128 a[148:151], v209 offset:35840
v_mfma_f32_16x16x32_bf16 v[120:123], a[152:155], a[116:119], v[120:123]
v_mfma_f32_16x16x32_bf16 v[124:127], a[156:159], a[112:115], v[124:127]
v_mfma_f32_16x16x32_bf16 v[128:131], a[156:159], a[116:119], v[128:131]
s_waitcnt lgkmcnt(4)
v_add_u32 v181, 36864, v239
v_mfma_f32_16x16x32_bf16 v[116:119], a[160:163], a[120:123], v[116:119]
ds_read_b64 a[152:153], v181 offset:0
ds_read_b64 a[156:157], v181 offset:512
v_mfma_f32_16x16x32_bf16 v[120:123], a[160:163], a[124:127], v[120:123]
v_mfma_f32_16x16x32_bf16 v[124:127], a[164:167], a[120:123], v[124:127]
v_mfma_f32_16x16x32_bf16 v[128:131], a[164:167], a[124:127], v[128:131]
s_waitcnt lgkmcnt(4)
v_mfma_f32_16x16x32_bf16 v[116:119], a[168:171], a[128:131], v[116:119]
ds_read_b128 a[160:163], v210 offset:0
ds_read_b128 a[164:167], v210 offset:18432
v_mfma_f32_16x16x32_bf16 v[120:123], a[168:171], a[132:135], v[120:123]
buffer_load_dwordx2 v[182:183], v234, s[8:11], s61 offen offset:0 sc1
v_mfma_f32_16x16x32_bf16 v[124:127], a[172:175], a[128:131], v[124:127]
buffer_load_dwordx2 v[184:185], v234, s[8:11], s61 offen offset:1024 sc1
v_mfma_f32_16x16x32_bf16 v[128:131], a[172:175], a[132:135], v[128:131]
s_waitcnt lgkmcnt(4)
v_mfma_f32_16x16x32_bf16 v[116:119], a[144:147], a[136:139], v[116:119]
ds_read_b128 a[168:171], v210 offset:1024
ds_read_b128 a[172:175], v210 offset:19456
v_mfma_f32_16x16x32_bf16 v[120:123], a[144:147], a[140:143], v[120:123]
buffer_load_dwordx2 v[186:187], v234, s[8:11], s61 offen offset:2048 sc1
v_mfma_f32_16x16x32_bf16 v[124:127], a[148:151], a[136:139], v[124:127]
buffer_load_dwordx2 v[188:189], v234, s[8:11], s61 offen offset:3072 sc1
v_mfma_f32_16x16x32_bf16 v[128:131], a[148:151], a[140:143], v[128:131]
s_waitcnt lgkmcnt(4)
v_mfma_f32_16x16x16_bf16 v[116:119], a[152:153], v[212:213], v[116:119]
ds_read_b128 a[144:147], v210 offset:2048
ds_read_b128 a[148:151], v210 offset:20480
v_mfma_f32_16x16x16_bf16 v[120:123], a[152:153], v[214:215], v[120:123]
buffer_load_dwordx2 v[190:191], v235, s[8:11], s61 offen offset:0 sc1
v_mfma_f32_16x16x16_bf16 v[124:127], a[156:157], v[212:213], v[124:127]
buffer_load_dwordx2 v[192:193], v235, s[8:11], s61 offen offset:1024 sc1
v_mfma_f32_16x16x16_bf16 v[128:131], a[156:157], v[214:215], v[128:131]
s_waitcnt vmcnt(17) lgkmcnt(4)
s_barrier
v_mfma_f32_16x16x32_bf16 v[132:135], a[160:163], a[0:3], 0
ds_read_b128 a[152:155], v210 offset:3072
ds_read_b128 a[156:159], v210 offset:21504
v_mfma_f32_16x16x32_bf16 v[136:139], a[160:163], a[4:7], 0
buffer_load_dwordx2 v[194:195], v235, s[8:11], s61 offen offset:2048 sc1
s_mov_b32 s37, L_c4-L_pc
v_mfma_f32_16x16x32_bf16 v[140:143], a[164:167], a[0:3], 0
buffer_load_dwordx2 v[196:197], v235, s[8:11], s61 offen offset:3072 sc1
v_mfma_f32_16x16x32_bf16 v[144:147], a[164:167], a[4:7], 0
s_waitcnt lgkmcnt(4)
v_mfma_f32_16x16x32_bf16 v[132:135], a[168:171], a[8:11], v[132:135]
ds_read_b128 a[160:163], v210 offset:4096
ds_read_b128 a[164:167], v210 offset:22528
v_mfma_f32_16x16x32_bf16 v[136:139], a[168:171], a[12:15], v[136:139]
buffer_load_dword v15, v14, s[88:91], s37 offen
v_mfma_f32_16x16x32_bf16 v[140:143], a[172:175], a[8:11], v[140:143]
v_mfma_f32_16x16x32_bf16 v[144:147], a[172:175], a[12:15], v[144:147]
s_waitcnt lgkmcnt(4)
v_mfma_f32_16x16x32_bf16 v[132:135], a[144:147], a[16:19], v[132:135]
ds_read_b128 a[168:171], v210 offset:5120
ds_read_b128 a[172:175], v210 offset:23552
v_mfma_f32_16x16x32_bf16 v[136:139], a[144:147], a[20:23], v[136:139]
v_mfma_f32_16x16x32_bf16 v[140:143], a[148:151], a[16:19], v[140:143]
v_mfma_f32_16x16x32_bf16 v[144:147], a[148:151], a[20:23], v[144:147]
s_waitcnt lgkmcnt(4)
v_mfma_f32_16x16x32_bf16 v[132:135], a[152:155], a[24:27], v[132:135]
ds_read_b128 a[144:147], v210 offset:6144
ds_read_b128 a[148:151], v210 offset:24576
v_mfma_f32_16x16x32_bf16 v[136:139], a[152:155], a[28:31], v[136:139]
v_mfma_f32_16x16x32_bf16 v[140:143], a[156:159], a[24:27], v[140:143]
v_mfma_f32_16x16x32_bf16 v[144:147], a[156:159], a[28:31], v[144:147]
s_waitcnt lgkmcnt(4)
v_mfma_f32_16x16x32_bf16 v[132:135], a[160:163], a[32:35], v[132:135]
ds_read_b128 a[152:155], v210 offset:7168
ds_read_b128 a[156:159], v210 offset:25600
v_mfma_f32_16x16x32_bf16 v[136:139], a[160:163], a[36:39], v[136:139]
v_mfma_f32_16x16x32_bf16 v[140:143], a[164:167], a[32:35], v[140:143]
v_mfma_f32_16x16x32_bf16 v[144:147], a[164:167], a[36:39], v[144:147]
s_waitcnt lgkmcnt(4)
v_mfma_f32_16x16x32_bf16 v[132:135], a[168:171], a[40:43], v[132:135]
ds_read_b128 a[160:163], v210 offset:8192
ds_read_b128 a[164:167], v210 offset:26624
v_mfma_f32_16x16x32_bf16 v[136:139], a[168:171], a[44:47], v[136:139]
v_mfma_f32_16x16x32_bf16 v[140:143], a[172:175], a[40:43], v[140:143]
v_mfma_f32_16x16x32_bf16 v[144:147], a[172:175], a[44:47], v[144:147]
s_waitcnt lgkmcnt(4)
v_mfma_f32_16x16x32_bf16 v[132:135], a[144:147], a[48:51], v[132:135]
ds_read_b128 a[168:171], v210 offset:9216
ds_read_b128 a[172:175], v210 offset:27648
v_mfma_f32_16x16x32_bf16 v[136:139], a[144:147], a[52:55], v[136:139]
v_mfma_f32_16x16x32_bf16 v[140:143], a[148:151], a[48:51], v[140:143]
v_mfma_f32_16x16x32_bf16 v[144:147], a[148:151], a[52:55], v[144:147]
s_waitcnt lgkmcnt(4)
v_mfma_f32_16x16x32_bf16 v[132:135], a[152:155], a[56:59], v[132:135]
ds_read_b128 a[144:147], v210 offset:10240
ds_read_b128 a[148:151], v210 offset:28672
v_mfma_f32_16x16x32_bf16 v[136:139], a[152:155], a[60:63], v[136:139]
v_mfma_f32_16x16x32_bf16 v[140:143], a[156:159], a[56:59], v[140:143]
v_mfma_f32_16x16x32_bf16 v[144:147], a[156:159], a[60:63], v[144:147]
s_waitcnt lgkmcnt(4)
v_mfma_f32_16x16x32_bf16 v[132:135], a[160:163], a[64:67], v[132:135]
ds_read_b128 a[152:155], v210 offset:11264
ds_read_b128 a[156:159], v210 offset:29696
v_mfma_f32_16x16x32_bf16 v[136:139], a[160:163], a[68:71], v[136:139]
v_mfma_f32_16x16x32_bf16 v[140:143], a[164:167], a[64:67], v[140:143]
v_mfma_f32_16x16x32_bf16 v[144:147], a[164:167], a[68:71], v[144:147]
s_waitcnt lgkmcnt(4)
v_mfma_f32_16x16x32_bf16 v[132:135], a[168:171], a[72:75], v[132:135]
ds_read_b128 a[160:163], v210 offset:12288
ds_read_b128 a[164:167], v210 offset:30720
v_mfma_f32_16x16x32_bf16 v[136:139], a[168:171], a[76:79], v[136:139]
v_mfma_f32_16x16x32_bf16 v[140:143], a[172:175], a[72:75], v[140:143]
s_waitcnt vmcnt(1)
v_min3_f32 v200, v183, v185, v187
v_mfma_f32_16x16x32_bf16 v[144:147], a[172:175], a[76:79], v[144:147]
s_waitcnt lgkmcnt(4)
v_min3_f32 v201, v189, v191, v193
v_mfma_f32_16x16x32_bf16 v[132:135], a[144:147], a[80:83], v[132:135]
ds_read_b128 a[168:171], v210 offset:13312
ds_read_b128 a[172:175], v210 offset:31744
v_mfma_f32_16x16x32_bf16 v[136:139], a[144:147], a[84:87], v[136:139]
v_min3_f32 v200, v200, v195, v197
v_min_f32 v200, v200, v201
v_mfma_f32_16x16x32_bf16 v[140:143], a[148:151], a[80:83], v[140:143]
v_cmp_gt_f32 vcc, 0, v200
v_mfma_f32_16x16x32_bf16 v[144:147], a[148:151], a[84:87], v[144:147]
s_waitcnt lgkmcnt(4)
s_nop 0
s_cbranch_vccnz L_stzslow_29
L_stzback_30:
v_mfma_f32_16x16x32_bf16 v[132:135], a[152:155], a[88:91], v[132:135]
ds_read_b128 a[144:147], v210 offset:14336
ds_read_b128 a[148:151], v210 offset:32768
v_mfma_f32_16x16x32_bf16 v[136:139], a[152:155], a[92:95], v[136:139]
v_add_f32 v198, v182, v184
v_add_f32 v199, v183, v185
v_mfma_f32_16x16x32_bf16 v[140:143], a[156:159], a[88:91], v[140:143]
buffer_load_dwordx4 a[176:179], v1, s[4:7], s52 offen offset:0 sc1
buffer_load_dwordx4 a[180:183], v9, s[4:7], s52 offen offset:0 sc1
v_add_f32 v198, v198, v186
v_add_f32 v199, v199, v187
v_mfma_f32_16x16x32_bf16 v[144:147], a[156:159], a[92:95], v[144:147]
s_waitcnt lgkmcnt(4)
v_add_f32 v198, v198, v188
v_add_f32 v199, v199, v189
v_mfma_f32_16x16x32_bf16 v[132:135], a[160:163], a[96:99], v[132:135]
ds_read_b128 a[152:155], v210 offset:15360
ds_read_b128 a[156:159], v210 offset:33792
v_add_f32 v198, v198, v190
v_mfma_f32_16x16x32_bf16 v[136:139], a[160:163], a[100:103], v[136:139]
v_add_f32 v199, v199, v191
v_add_f32 v198, v198, v192
v_mfma_f32_16x16x32_bf16 v[140:143], a[164:167], a[96:99], v[140:143]
buffer_load_dwordx4 a[184:187], v1, s[4:7], s52 offen offset:1024 sc1
buffer_load_dwordx4 a[188:191], v9, s[4:7], s52 offen offset:1024 sc1
v_add_f32 v199, v199, v193
v_add_f32 v198, v198, v194
v_mfma_f32_16x16x32_bf16 v[144:147], a[164:167], a[100:103], v[144:147]
s_waitcnt lgkmcnt(4)
v_add_f32 v199, v199, v195
v_add_f32 v198, v198, v196
v_mfma_f32_16x16x32_bf16 v[132:135], a[168:171], a[104:107], v[132:135]
ds_read_b128 a[160:163], v210 offset:16384
ds_read_b128 a[164:167], v210 offset:34816
v_add_f32 v199, v199, v197
v_mfma_f32_16x16x32_bf16 v[136:139], a[168:171], a[108:111], v[136:139]
v_mov_b32 v200, v198
v_mov_b32 v201, v199
v_mfma_f32_16x16x32_bf16 v[140:143], a[172:175], a[104:107], v[140:143]
s_nop 0
v_permlane32_swap_b32 v198, v200
v_mfma_f32_16x16x32_bf16 v[144:147], a[172:175], a[108:111], v[144:147]
s_waitcnt lgkmcnt(4)
v_permlane32_swap_b32 v199, v201
v_mfma_f32_16x16x32_bf16 v[132:135], a[144:147], a[112:115], v[132:135]
ds_read_b128 a[168:171], v210 offset:17408
ds_read_b128 a[172:175], v210 offset:35840
v_mfma_f32_16x16x32_bf16 v[136:139], a[144:147], a[116:119], v[136:139]
buffer_load_dwordx4 a[192:195], v1, s[4:7], s52 offen offset:2048 sc1
buffer_load_dwordx4 a[196:199], v9, s[4:7], s52 offen offset:2048 sc1
v_add_f32 v198, v198, v200
v_add_f32 v199, v199, v201
v_mfma_f32_16x16x32_bf16 v[140:143], a[148:151], a[112:115], v[140:143]
v_mul_f32 v198, 0x39e38e39, v198
v_mul_f32 v200, v198, v198
v_mfma_f32_16x16x32_bf16 v[144:147], a[148:151], a[116:119], v[144:147]
s_waitcnt lgkmcnt(4)
v_mul_f32 v199, 0x39e38e39, v199
v_add_u32 v181, 74752, v239
v_mfma_f32_16x16x32_bf16 v[132:135], a[152:155], a[120:123], v[132:135]
ds_read_b64 a[144:145], v181 offset:0
ds_read_b64 a[148:149], v181 offset:512
v_sub_f32 v199, v199, v200
v_max_f32 v199, 0, v199
v_mfma_f32_16x16x32_bf16 v[136:139], a[152:155], a[124:127], v[136:139]
buffer_load_dwordx4 a[200:203], v1, s[4:7], s52 offen offset:3072 sc1
buffer_load_dwordx4 a[204:207], v9, s[4:7], s52 offen offset:3072 sc1
v_add_f32 v199, 0x3727c5ac, v199
v_rsq_f32 v202, v199
v_mfma_f32_16x16x32_bf16 v[140:143], a[156:159], a[120:123], v[140:143]
s_nop 0
v_mul_f32 v204, v198, v202
v_mfma_f32_16x16x32_bf16 v[144:147], a[156:159], a[124:127], v[144:147]
s_waitcnt lgkmcnt(4)
v_mov_b32 v203, v202
v_mov_b32 v205, v204
v_mfma_f32_16x16x32_bf16 v[132:135], a[160:163], a[128:131], v[132:135]
ds_read_b128 a[152:155], v211 offset:0
ds_read_b128 a[156:159], v211 offset:18432
v_mfma_f32_16x16x32_bf16 v[136:139], a[160:163], a[132:135], v[136:139]
s_nop 0
s_mov_b32 s52, s53
v_permlane16_swap_b32 v202, v203
v_mfma_f32_16x16x32_bf16 v[140:143], a[164:167], a[128:131], v[140:143]
s_cmp_eq_u32 s25, 0
s_cselect_b32 s98, 4096, 0
v_mfma_f32_16x16x32_bf16 v[144:147], a[164:167], a[132:135], v[144:147]
s_waitcnt lgkmcnt(4)
v_permlane16_swap_b32 v204, v205
v_mfma_f32_16x16x32_bf16 v[132:135], a[168:171], a[136:139], v[132:135]
ds_read_b128 a[160:163], v211 offset:1024
ds_read_b128 a[164:167], v211 offset:19456
v_fma_f32 v36, v36, v202, -v204
v_fma_f32 v37, v37, v202, -v204
v_mfma_f32_16x16x32_bf16 v[136:139], a[168:171], a[140:143], v[136:139]
s_add_u32 s52, s52, s98
v_fma_f32 v38, v38, v202, -v204
v_fma_f32 v39, v39, v202, -v204
v_mfma_f32_16x16x32_bf16 v[140:143], a[172:175], a[136:139], v[140:143]
v_fma_f32 v44, v44, v202, -v204
v_fma_f32 v45, v45, v202, -v204
v_mfma_f32_16x16x32_bf16 v[144:147], a[172:175], a[140:143], v[144:147]
s_waitcnt lgkmcnt(4)
v_fma_f32 v46, v46, v202, -v204
v_fma_f32 v47, v47, v202, -v204
v_mfma_f32_16x16x16_bf16 v[132:135], a[144:145], v[212:213], v[132:135]
ds_read_b128 a[168:171], v211 offset:2048
ds_read_b128 a[172:175], v211 offset:20480
v_cvt_pk_bf16_f32 v216, v36, v37
v_mfma_f32_16x16x16_bf16 v[136:139], a[144:145], v[214:215], v[136:139]
buffer_load_dwordx4 a[208:211], v1, s[4:7], s52 offen offset:0 sc1
buffer_load_dwordx4 a[212:215], v9, s[4:7], s52 offen offset:0 sc1
v_cvt_pk_bf16_f32 v217, v38, v39
v_cvt_pk_bf16_f32 v218, v44, v45
v_mfma_f32_16x16x16_bf16 v[140:143], a[148:149], v[212:213], v[140:143]
v_cvt_pk_bf16_f32 v219, v46, v47
v_mfma_f32_16x16x16_bf16 v[144:147], a[148:149], v[214:215], v[144:147]
s_waitcnt lgkmcnt(4)
s_barrier
v_mfma_f32_16x16x32_bf16 v[148:151], a[152:155], a[0:3], 0
ds_read_b128 a[144:147], v211 offset:3072
ds_read_b128 a[148:151], v211 offset:21504
v_mfma_f32_16x16x32_bf16 v[152:155], a[152:155], a[4:7], 0
ds_write_b128 v236, v[216:219] offset:0
v_fma_f32 v40, v40, v203, -v205
v_fma_f32 v41, v41, v203, -v205
v_fma_f32 v42, v42, v203, -v205
v_fma_f32 v43, v43, v203, -v205
v_fma_f32 v48, v48, v203, -v205
v_mfma_f32_16x16x32_bf16 v[156:159], a[156:159], a[0:3], 0
buffer_load_dwordx4 a[216:219], v1, s[4:7], s52 offen offset:1024 sc1
buffer_load_dwordx4 a[220:223], v9, s[4:7], s52 offen offset:1024 sc1
v_fma_f32 v49, v49, v203, -v205
v_mfma_f32_16x16x32_bf16 v[160:163], a[156:159], a[4:7], 0
s_waitcnt lgkmcnt(5)
v_fma_f32 v50, v50, v203, -v205
v_fma_f32 v51, v51, v203, -v205
v_mfma_f32_16x16x32_bf16 v[148:151], a[160:163], a[8:11], v[148:151]
ds_read_b128 a[152:155], v211 offset:4096
ds_read_b128 a[156:159], v211 offset:22528
v_cvt_pk_bf16_f32 v220, v40, v41
v_cvt_pk_bf16_f32 v221, v42, v43
v_mfma_f32_16x16x32_bf16 v[152:155], a[160:163], a[12:15], v[152:155]
v_cvt_pk_bf16_f32 v222, v48, v49
v_cvt_pk_bf16_f32 v223, v50, v51
ds_write_b128 v236, v[220:223] offset:4608
v_mfma_f32_16x16x32_bf16 v[156:159], a[164:167], a[8:11], v[156:159]
buffer_load_dwordx4 a[224:227], v1, s[4:7], s52 offen offset:2048 sc1
buffer_load_dwordx4 a[228:231], v9, s[4:7], s52 offen offset:2048 sc1
v_mfma_f32_16x16x32_bf16 v[160:163], a[164:167], a[12:15], v[160:163]
s_waitcnt lgkmcnt(6)
v_fma_f32 v52, v52, v202, -v204
v_fma_f32 v53, v53, v202, -v204
v_mfma_f32_16x16x32_bf16 v[148:151], a[168:171], a[16:19], v[148:151]
ds_read_b128 a[160:163], v211 offset:5120
ds_read_b128 a[164:167], v211 offset:23552
v_fma_f32 v54, v54, v202, -v204
v_mfma_f32_16x16x32_bf16 v[152:155], a[168:171], a[20:23], v[152:155]
ds_read_b64_tr_b16 v[36:37], v237 offset:0
v_fma_f32 v55, v55, v202, -v204
v_mfma_f32_16x16x32_bf16 v[156:159], a[172:175], a[16:19], v[156:159]
ds_read_b64_tr_b16 v[38:39], v237 offset:1152
v_fma_f32 v60, v60, v202, -v204
v_mfma_f32_16x16x32_bf16 v[160:163], a[172:175], a[20:23], v[160:163]
s_waitcnt lgkmcnt(8)
v_mfma_f32_16x16x32_bf16 v[148:151], a[144:147], a[24:27], v[148:151]
ds_read_b128 a[168:171], v211 offset:6144
ds_read_b128 a[172:175], v211 offset:24576
v_mfma_f32_16x16x32_bf16 v[152:155], a[144:147], a[28:31], v[152:155]
ds_read_b64_tr_b16 v[40:41], v237 offset:8
v_fma_f32 v61, v61, v202, -v204
v_mfma_f32_16x16x32_bf16 v[156:159], a[148:151], a[24:27], v[156:159]
ds_read_b64_tr_b16 v[42:43], v237 offset:1160
v_fma_f32 v62, v62, v202, -v204
v_fma_f32 v63, v63, v202, -v204
v_cvt_pk_bf16_f32 v224, v52, v53
v_mfma_f32_16x16x32_bf16 v[160:163], a[148:151], a[28:31], v[160:163]
s_waitcnt lgkmcnt(9)
buffer_load_dwordx4 a[232:235], v1, s[4:7], s52 offen offset:3072 sc1
buffer_load_dwordx4 a[236:239], v9, s[4:7], s52 offen offset:3072 sc1
v_cvt_pk_bf16_f32 v225, v54, v55
v_mfma_f32_16x16x32_bf16 v[148:151], a[152:155], a[32:35], v[148:151]
ds_read_b128 a[144:147], v211 offset:7168
ds_read_b128 a[148:151], v211 offset:25600
v_cvt_pk_bf16_f32 v226, v60, v61
v_cvt_pk_bf16_f32 v227, v62, v63
v_mfma_f32_16x16x32_bf16 v[152:155], a[152:155], a[36:39], v[152:155]
s_waitcnt lgkmcnt(6)
buffer_store_dwordx4 v[36:39], v1, s[8:11], s66 offen offset:0 sc1
ds_write_b128 v236, v[224:227] offset:64
v_mfma_f32_16x16x32_bf16 v[156:159], a[156:159], a[32:35], v[156:159]
v_fma_f32 v56, v56, v203, -v205
v_fma_f32 v57, v57, v203, -v205
v_mfma_f32_16x16x32_bf16 v[160:163], a[156:159], a[36:39], v[160:163]
v_fma_f32 v58, v58, v203, -v205
v_mfma_f32_16x16x32_bf16 v[148:151], a[160:163], a[40:43], v[148:151]
ds_read_b128 a[152:155], v211 offset:8192
ds_read_b128 a[156:159], v211 offset:26624
v_mfma_f32_16x16x32_bf16 v[152:155], a[160:163], a[44:47], v[152:155]
v_fma_f32 v59, v59, v203, -v205
v_fma_f32 v64, v64, v203, -v205
v_mfma_f32_16x16x32_bf16 v[156:159], a[164:167], a[40:43], v[156:159]
v_fma_f32 v65, v65, v203, -v205
v_fma_f32 v66, v66, v203, -v205
v_mfma_f32_16x16x32_bf16 v[160:163], a[164:167], a[44:47], v[160:163]
s_waitcnt lgkmcnt(7)
v_fma_f32 v67, v67, v203, -v205
v_mfma_f32_16x16x32_bf16 v[148:151], a[168:171], a[48:51], v[148:151]
ds_read_b128 a[160:163], v211 offset:9216
ds_read_b128 a[164:167], v211 offset:27648
v_mfma_f32_16x16x32_bf16 v[152:155], a[168:171], a[52:55], v[152:155]
v_cvt_pk_bf16_f32 v228, v56, v57
v_cvt_pk_bf16_f32 v229, v58, v59
v_mfma_f32_16x16x32_bf16 v[156:159], a[172:175], a[48:51], v[156:159]
v_cvt_pk_bf16_f32 v230, v64, v65
v_cvt_pk_bf16_f32 v231, v66, v67
v_mfma_f32_16x16x32_bf16 v[160:163], a[172:175], a[52:55], v[160:163]
s_waitcnt lgkmcnt(5)
v_mfma_f32_16x16x32_bf16 v[148:151], a[144:147], a[56:59], v[148:151]
ds_read_b128 a[168:171], v211 offset:10240
ds_read_b128 a[172:175], v211 offset:28672
v_mfma_f32_16x16x32_bf16 v[152:155], a[144:147], a[60:63], v[152:155]
buffer_store_dwordx4 v[40:43], v1, s[8:11], s66 offen offset:1024 sc1
ds_write_b128 v236, v[228:231] offset:4672
v_mfma_f32_16x16x32_bf16 v[156:159], a[148:151], a[56:59], v[156:159]
v_fma_f32 v68, v68, v202, -v204
v_fma_f32 v69, v69, v202, -v204
v_mfma_f32_16x16x32_bf16 v[160:163], a[148:151], a[60:63], v[160:163]
s_waitcnt lgkmcnt(5)
v_fma_f32 v70, v70, v202, -v204
v_mfma_f32_16x16x32_bf16 v[148:151], a[152:155], a[64:67], v[148:151]
ds_read_b128 a[144:147], v211 offset:11264
ds_read_b128 a[148:151], v211 offset:29696
v_mfma_f32_16x16x32_bf16 v[152:155], a[152:155], a[68:71], v[152:155]
ds_read_b64_tr_b16 v[52:53], v237 offset:64
v_fma_f32 v71, v71, v202, -v204
v_mfma_f32_16x16x32_bf16 v[156:159], a[156:159], a[64:67], v[156:159]
ds_read_b64_tr_b16 v[54:55], v237 offset:1216
v_fma_f32 v76, v76, v202, -v204
v_mfma_f32_16x16x32_bf16 v[160:163], a[156:159], a[68:71], v[160:163]
s_waitcnt lgkmcnt(7)
v_mfma_f32_16x16x32_bf16 v[148:151], a[160:163], a[72:75], v[148:151]
ds_read_b128 a[152:155], v211 offset:12288
ds_read_b128 a[156:159], v211 offset:30720
v_mfma_f32_16x16x32_bf16 v[152:155], a[160:163], a[76:79], v[152:155]
ds_read_b64_tr_b16 v[56:57], v237 offset:72
v_fma_f32 v77, v77, v202, -v204
v_mfma_f32_16x16x32_bf16 v[156:159], a[164:167], a[72:75], v[156:159]
ds_read_b64_tr_b16 v[58:59], v237 offset:1224
v_fma_f32 v78, v78, v202, -v204
v_fma_f32 v79, v79, v202, -v204
v_cvt_pk_bf16_f32 v216, v68, v69
v_mfma_f32_16x16x32_bf16 v[160:163], a[164:167], a[76:79], v[160:163]
s_waitcnt lgkmcnt(9)
v_cvt_pk_bf16_f32 v217, v70, v71
v_cvt_pk_bf16_f32 v218, v76, v77
v_mfma_f32_16x16x32_bf16 v[148:151], a[168:171], a[80:83], v[148:151]
ds_read_b128 a[160:163], v211 offset:13312
ds_read_b128 a[164:167], v211 offset:31744
v_cvt_pk_bf16_f32 v219, v78, v79
v_mfma_f32_16x16x32_bf16 v[152:155], a[168:171], a[84:87], v[152:155]
s_waitcnt lgkmcnt(6)
buffer_store_dwordx4 v[52:55], v1, s[8:11], s66 offen offset:2048 sc1
ds_write_b128 v236, v[216:219] offset:128
v_mfma_f32_16x16x32_bf16 v[156:159], a[172:175], a[80:83], v[156:159]
v_fma_f32 v72, v72, v203, -v205
v_fma_f32 v73, v73, v203, -v205
v_mfma_f32_16x16x32_bf16 v[160:163], a[172:175], a[84:87], v[160:163]
v_fma_f32 v74, v74, v203, -v205
v_mfma_f32_16x16x32_bf16 v[148:151], a[144:147], a[88:91], v[148:151]
ds_read_b128 a[168:171], v211 offset:14336
ds_read_b128 a[172:175], v211 offset:32768
v_mfma_f32_16x16x32_bf16 v[152:155], a[144:147], a[92:95], v[152:155]
v_fma_f32 v75, v75, v203, -v205
v_fma_f32 v80, v80, v203, -v205
v_mfma_f32_16x16x32_bf16 v[156:159], a[148:151], a[88:91], v[156:159]
v_fma_f32 v81, v81, v203, -v205
v_fma_f32 v82, v82, v203, -v205
v_mfma_f32_16x16x32_bf16 v[160:163], a[148:151], a[92:95], v[160:163]
s_waitcnt lgkmcnt(7)
v_fma_f32 v83, v83, v203, -v205
v_mfma_f32_16x16x32_bf16 v[148:151], a[152:155], a[96:99], v[148:151]
ds_read_b128 a[144:147], v211 offset:15360
ds_read_b128 a[148:151], v211 offset:33792
v_mfma_f32_16x16x32_bf16 v[152:155], a[152:155], a[100:103], v[152:155]
v_cvt_pk_bf16_f32 v220, v72, v73
v_cvt_pk_bf16_f32 v221, v74, v75
v_mfma_f32_16x16x32_bf16 v[156:159], a[156:159], a[96:99], v[156:159]
v_cvt_pk_bf16_f32 v222, v80, v81
v_cvt_pk_bf16_f32 v223, v82, v83
v_mfma_f32_16x16x32_bf16 v[160:163], a[156:159], a[100:103], v[160:163]
s_waitcnt lgkmcnt(5)
v_mfma_f32_16x16x32_bf16 v[148:151], a[160:163], a[104:107], v[148:151]
ds_read_b128 a[152:155], v211 offset:16384
ds_read_b128 a[156:159], v211 offset:34816
v_mfma_f32_16x16x32_bf16 v[152:155], a[160:163], a[108:111], v[152:155]
buffer_store_dwordx4 v[56:59], v1, s[8:11], s66 offen offset:3072 sc1
ds_write_b128 v236, v[220:223] offset:4736
v_mfma_f32_16x16x32_bf16 v[156:159], a[164:167], a[104:107], v[156:159]
v_fma_f32 v84, v84, v202, -v204
v_fma_f32 v85, v85, v202, -v204
v_mfma_f32_16x16x32_bf16 v[160:163], a[164:167], a[108:111], v[160:163]
s_waitcnt lgkmcnt(5)
v_fma_f32 v86, v86, v202, -v204
v_mfma_f32_16x16x32_bf16 v[148:151], a[168:171], a[112:115], v[148:151]
ds_read_b128 a[160:163], v211 offset:17408
ds_read_b128 a[164:167], v211 offset:35840
v_mfma_f32_16x16x32_bf16 v[152:155], a[168:171], a[116:119], v[152:155]
ds_read_b64_tr_b16 v[68:69], v237 offset:128
v_fma_f32 v87, v87, v202, -v204
v_mfma_f32_16x16x32_bf16 v[156:159], a[172:175], a[112:115], v[156:159]
ds_read_b64_tr_b16 v[70:71], v237 offset:1280
v_fma_f32 v92, v92, v202, -v204
v_mfma_f32_16x16x32_bf16 v[160:163], a[172:175], a[116:119], v[160:163]
s_waitcnt lgkmcnt(7)
v_add_u32 v181, 112640, v239
v_mfma_f32_16x16x32_bf16 v[148:151], a[144:147], a[120:123], v[148:151]
ds_read_b64 a[168:169], v181 offset:0
ds_read_b64 a[172:173], v181 offset:512
v_mfma_f32_16x16x32_bf16 v[152:155], a[144:147], a[124:127], v[152:155]
ds_read_b64_tr_b16 v[72:73], v237 offset:136
v_fma_f32 v93, v93, v202, -v204
v_mfma_f32_16x16x32_bf16 v[156:159], a[148:151], a[120:123], v[156:159]
ds_read_b64_tr_b16 v[74:75], v237 offset:1288
v_fma_f32 v94, v94, v202, -v204
v_fma_f32 v95, v95, v202, -v204
v_cvt_pk_bf16_f32 v224, v84, v85
v_mfma_f32_16x16x32_bf16 v[160:163], a[148:151], a[124:127], v[160:163]
s_waitcnt lgkmcnt(9)
v_cvt_pk_bf16_f32 v225, v86, v87
v_cvt_pk_bf16_f32 v226, v92, v93
v_mfma_f32_16x16x32_bf16 v[148:151], a[152:155], a[128:131], v[148:151]
ds_read_b128 a[144:147], v208 offset:0
ds_read_b128 a[148:151], v208 offset:18432
v_cvt_pk_bf16_f32 v227, v94, v95
s_add_u32 s66, s66, 4096
v_mfma_f32_16x16x32_bf16 v[152:155], a[152:155], a[132:135], v[152:155]
s_waitcnt lgkmcnt(6)
buffer_store_dwordx4 v[68:71], v1, s[8:11], s66 offen offset:0 sc1
ds_write_b128 v236, v[224:227] offset:192
v_mfma_f32_16x16x32_bf16 v[156:159], a[156:159], a[128:131], v[156:159]
v_fma_f32 v88, v88, v203, -v205
v_fma_f32 v89, v89, v203, -v205
v_mfma_f32_16x16x32_bf16 v[160:163], a[156:159], a[132:135], v[160:163]
v_fma_f32 v90, v90, v203, -v205
v_mfma_f32_16x16x32_bf16 v[148:151], a[160:163], a[136:139], v[148:151]
ds_read_b128 a[152:155], v208 offset:1024
ds_read_b128 a[156:159], v208 offset:19456
v_mfma_f32_16x16x32_bf16 v[152:155], a[160:163], a[140:143], v[152:155]
v_fma_f32 v91, v91, v203, -v205
v_fma_f32 v96, v96, v203, -v205
v_mfma_f32_16x16x32_bf16 v[156:159], a[164:167], a[136:139], v[156:159]
v_fma_f32 v97, v97, v203, -v205
v_fma_f32 v98, v98, v203, -v205
v_mfma_f32_16x16x32_bf16 v[160:163], a[164:167], a[140:143], v[160:163]
s_waitcnt lgkmcnt(7)
v_fma_f32 v99, v99, v203, -v205
v_mfma_f32_16x16x16_bf16 v[148:151], a[168:169], v[212:213], v[148:151]
ds_read_b128 a[160:163], v208 offset:2048
ds_read_b128 a[164:167], v208 offset:20480
v_mfma_f32_16x16x16_bf16 v[152:155], a[168:169], v[214:215], v[152:155]
v_cvt_pk_bf16_f32 v228, v88, v89
v_cvt_pk_bf16_f32 v229, v90, v91
v_mfma_f32_16x16x16_bf16 v[156:159], a[172:173], v[212:213], v[156:159]
v_cvt_pk_bf16_f32 v230, v96, v97
v_cvt_pk_bf16_f32 v231, v98, v99
v_mfma_f32_16x16x16_bf16 v[160:163], a[172:173], v[214:215], v[160:163]
s_waitcnt lgkmcnt(5)
v_mfma_f32_16x16x32_bf16 v[164:167], a[144:147], a[0:3], 0
ds_read_b128 a[168:171], v208 offset:3072
ds_read_b128 a[172:175], v208 offset:21504
v_mfma_f32_16x16x32_bf16 v[168:171], a[144:147], a[4:7], 0
buffer_store_dwordx4 v[72:75], v1, s[8:11], s66 offen offset:1024 sc1
ds_write_b128 v236, v[228:231] offset:4800
v_mfma_f32_16x16x32_bf16 v[172:175], a[148:151], a[0:3], 0
v_fma_f32 v100, v100, v202, -v204
v_fma_f32 v101, v101, v202, -v204
v_mfma_f32_16x16x32_bf16 v[176:179], a[148:151], a[4:7], 0
s_waitcnt lgkmcnt(5)
v_fma_f32 v102, v102, v202, -v204
v_mfma_f32_16x16x32_bf16 v[164:167], a[152:155], a[8:11], v[164:167]
ds_read_b128 a[144:147], v208 offset:4096
ds_read_b128 a[148:151], v208 offset:22528
v_mfma_f32_16x16x32_bf16 v[168:171], a[152:155], a[12:15], v[168:171]
ds_read_b64_tr_b16 v[84:85], v237 offset:192
v_fma_f32 v103, v103, v202, -v204
v_mfma_f32_16x16x32_bf16 v[172:175], a[156:159], a[8:11], v[172:175]
ds_read_b64_tr_b16 v[86:87], v237 offset:1344
v_fma_f32 v104, v104, v203, -v205
v_mfma_f32_16x16x32_bf16 v[176:179], a[156:159], a[12:15], v[176:179]
s_waitcnt lgkmcnt(7)
v_mfma_f32_16x16x32_bf16 v[164:167], a[160:163], a[16:19], v[164:167]
ds_read_b128 a[152:155], v208 offset:5120
ds_read_b128 a[156:159], v208 offset:23552
v_mfma_f32_16x16x32_bf16 v[168:171], a[160:163], a[20:23], v[168:171]
ds_read_b64_tr_b16 v[88:89], v237 offset:200
v_fma_f32 v105, v105, v203, -v205
v_mfma_f32_16x16x32_bf16 v[172:175], a[164:167], a[16:19], v[172:175]
ds_read_b64_tr_b16 v[90:91], v237 offset:1352
v_fma_f32 v106, v106, v203, -v205
v_fma_f32 v107, v107, v203, -v205
v_cvt_pk_bf16_f32 v216, v100, v101
v_mfma_f32_16x16x32_bf16 v[176:179], a[164:167], a[20:23], v[176:179]
s_waitcnt lgkmcnt(9)
v_cvt_pk_bf16_f32 v217, v102, v103
v_cvt_pk_bf16_f32 v218, v104, v105
v_mfma_f32_16x16x32_bf16 v[164:167], a[168:171], a[24:27], v[164:167]
ds_read_b128 a[160:163], v208 offset:6144
ds_read_b128 a[164:167], v208 offset:24576
v_cvt_pk_bf16_f32 v219, v106, v107
s_waitcnt lgkmcnt(6)
v_mfma_f32_16x16x32_bf16 v[168:171], a[168:171], a[28:31], v[168:171]
buffer_store_dwordx4 v[84:87], v1, s[8:11], s66 offen offset:2048 sc1
ds_write_b64 v7, v[216:217] offset:256
ds_write_b64 v7, v[218:219] offset:4864
v_mfma_f32_16x16x32_bf16 v[172:175], a[172:175], a[24:27], v[172:175]
v_mfma_f32_16x16x32_bf16 v[176:179], a[172:175], a[28:31], v[176:179]
v_mfma_f32_16x16x32_bf16 v[164:167], a[144:147], a[32:35], v[164:167]
ds_read_b128 a[168:171], v208 offset:7168
ds_read_b128 a[172:175], v208 offset:25600
v_mfma_f32_16x16x32_bf16 v[168:171], a[144:147], a[36:39], v[168:171]
v_mfma_f32_16x16x32_bf16 v[172:175], a[148:151], a[32:35], v[172:175]
v_mfma_f32_16x16x32_bf16 v[176:179], a[148:151], a[36:39], v[176:179]
s_waitcnt lgkmcnt(8)
v_mfma_f32_16x16x32_bf16 v[164:167], a[152:155], a[40:43], v[164:167]
ds_read_b128 a[144:147], v208 offset:8192
ds_read_b128 a[148:151], v208 offset:26624
v_mfma_f32_16x16x32_bf16 v[168:171], a[152:155], a[44:47], v[168:171]
ds_read_b64_tr_b16 v[100:101], v238 offset:256
ds_read_b64_tr_b16 v[102:103], v238 offset:1408
v_mfma_f32_16x16x32_bf16 v[172:175], a[156:159], a[40:43], v[172:175]
s_waitcnt lgkmcnt(10)
v_mfma_f32_16x16x32_bf16 v[176:179], a[156:159], a[44:47], v[176:179]
s_waitcnt lgkmcnt(8)
v_mfma_f32_16x16x32_bf16 v[164:167], a[160:163], a[48:51], v[164:167]
ds_read_b128 a[152:155], v208 offset:9216
ds_read_b128 a[156:159], v208 offset:27648
v_mfma_f32_16x16x32_bf16 v[168:171], a[160:163], a[52:55], v[168:171]
buffer_store_dwordx4 v[88:91], v1, s[8:11], s66 offen offset:3072 sc1
v_mfma_f32_16x16x32_bf16 v[172:175], a[164:167], a[48:51], v[172:175]
v_mfma_f32_16x16x32_bf16 v[176:179], a[164:167], a[52:55], v[176:179]
s_waitcnt lgkmcnt(6)
s_cmp_eq_u32 s25, 1
s_cselect_b32 s98, 4096, 0
v_mfma_f32_16x16x32_bf16 v[164:167], a[168:171], a[56:59], v[164:167]
ds_read_b128 a[160:163], v208 offset:10240
ds_read_b128 a[164:167], v208 offset:28672
v_mfma_f32_16x16x32_bf16 v[168:171], a[168:171], a[60:63], v[168:171]
s_add_u32 s52, s52, s98
v_mfma_f32_16x16x32_bf16 v[172:175], a[172:175], a[56:59], v[172:175]
s_add_u32 s52, s52, 4096
v_mfma_f32_16x16x32_bf16 v[176:179], a[172:175], a[60:63], v[176:179]
s_waitcnt lgkmcnt(6)
v_mfma_f32_16x16x32_bf16 v[164:167], a[144:147], a[64:67], v[164:167]
ds_read_b128 a[168:171], v208 offset:11264
ds_read_b128 a[172:175], v208 offset:29696
v_mfma_f32_16x16x32_bf16 v[168:171], a[144:147], a[68:71], v[168:171]
v_mfma_f32_16x16x32_bf16 v[172:175], a[148:151], a[64:67], v[172:175]
v_mfma_f32_16x16x32_bf16 v[176:179], a[148:151], a[68:71], v[176:179]
s_waitcnt lgkmcnt(4)
v_mfma_f32_16x16x32_bf16 v[164:167], a[152:155], a[72:75], v[164:167]
ds_read_b128 a[144:147], v208 offset:12288
ds_read_b128 a[148:151], v208 offset:30720
v_mfma_f32_16x16x32_bf16 v[168:171], a[152:155], a[76:79], v[168:171]
s_add_u32 s66, s66, 4096
buffer_store_dwordx4 v[100:103], v1, s[8:11], s66 offen offset:0 sc1
v_mfma_f32_16x16x32_bf16 v[172:175], a[156:159], a[72:75], v[172:175]
v_mfma_f32_16x16x32_bf16 v[176:179], a[156:159], a[76:79], v[176:179]
s_waitcnt lgkmcnt(4)
v_mfma_f32_16x16x32_bf16 v[164:167], a[160:163], a[80:83], v[164:167]
ds_read_b128 a[152:155], v208 offset:13312
ds_read_b128 a[156:159], v208 offset:31744
v_mfma_f32_16x16x32_bf16 v[168:171], a[160:163], a[84:87], v[168:171]
v_mfma_f32_16x16x32_bf16 v[172:175], a[164:167], a[80:83], v[172:175]
v_mfma_f32_16x16x32_bf16 v[176:179], a[164:167], a[84:87], v[176:179]
s_waitcnt lgkmcnt(4)
v_mfma_f32_16x16x32_bf16 v[164:167], a[168:171], a[88:91], v[164:167]
ds_read_b128 a[160:163], v208 offset:14336
ds_read_b128 a[164:167], v208 offset:32768
v_mfma_f32_16x16x32_bf16 v[168:171], a[168:171], a[92:95], v[168:171]
v_mfma_f32_16x16x32_bf16 v[172:175], a[172:175], a[88:91], v[172:175]
v_mfma_f32_16x16x32_bf16 v[176:179], a[172:175], a[92:95], v[176:179]
s_waitcnt lgkmcnt(4)
v_mfma_f32_16x16x32_bf16 v[164:167], a[144:147], a[96:99], v[164:167]
ds_read_b128 a[168:171], v208 offset:15360
ds_read_b128 a[172:175], v208 offset:33792
v_mfma_f32_16x16x32_bf16 v[168:171], a[144:147], a[100:103], v[168:171]
v_mfma_f32_16x16x32_bf16 v[172:175], a[148:151], a[96:99], v[172:175]
v_mfma_f32_16x16x32_bf16 v[176:179], a[148:151], a[100:103], v[176:179]
s_waitcnt lgkmcnt(4)
v_mfma_f32_16x16x32_bf16 v[164:167], a[152:155], a[104:107], v[164:167]
ds_read_b128 a[144:147], v208 offset:16384
ds_read_b128 a[148:151], v208 offset:34816
v_mfma_f32_16x16x32_bf16 v[168:171], a[152:155], a[108:111], v[168:171]
buffer_load_dwordx4 a[240:243], v1, s[4:7], s52 offen offset:0 sc1
buffer_load_dwordx4 a[244:247], v9, s[4:7], s52 offen offset:0 sc1
v_mfma_f32_16x16x32_bf16 v[172:175], a[156:159], a[104:107], v[172:175]
v_mfma_f32_16x16x32_bf16 v[176:179], a[156:159], a[108:111], v[176:179]
s_waitcnt lgkmcnt(4)
v_mfma_f32_16x16x32_bf16 v[164:167], a[160:163], a[112:115], v[164:167]
ds_read_b128 a[152:155], v208 offset:17408
ds_read_b128 a[156:159], v208 offset:35840
v_mfma_f32_16x16x32_bf16 v[168:171], a[160:163], a[116:119], v[168:171]
v_mfma_f32_16x16x32_bf16 v[172:175], a[164:167], a[112:115], v[172:175]
v_mfma_f32_16x16x32_bf16 v[176:179], a[164:167], a[116:119], v[176:179]
s_waitcnt lgkmcnt(4)
v_add_u32 v181, 160768, v239
v_mfma_f32_16x16x32_bf16 v[164:167], a[168:171], a[120:123], v[164:167]
ds_read_b64 a[160:161], v181 offset:0
ds_read_b64 a[164:165], v181 offset:512
v_mfma_f32_16x16x32_bf16 v[168:171], a[168:171], a[124:127], v[168:171]
v_mfma_f32_16x16x32_bf16 v[172:175], a[172:175], a[120:123], v[172:175]
v_mfma_f32_16x16x32_bf16 v[176:179], a[172:175], a[124:127], v[176:179]
s_waitcnt lgkmcnt(4)
v_mfma_f32_16x16x32_bf16 v[164:167], a[144:147], a[128:131], v[164:167]
buffer_load_dwordx4 a[248:251], v1, s[4:7], s52 offen offset:1024 sc1
buffer_load_dwordx4 a[252:255], v9, s[4:7], s52 offen offset:1024 sc1
v_mfma_f32_16x16x32_bf16 v[168:171], a[144:147], a[132:135], v[168:171]
v_mfma_f32_16x16x32_bf16 v[172:175], a[148:151], a[128:131], v[172:175]
v_mfma_f32_16x16x32_bf16 v[176:179], a[148:151], a[132:135], v[176:179]
s_waitcnt lgkmcnt(2)
v_mfma_f32_16x16x32_bf16 v[164:167], a[152:155], a[136:139], v[164:167]
v_mfma_f32_16x16x32_bf16 v[168:171], a[152:155], a[140:143], v[168:171]
v_mfma_f32_16x16x32_bf16 v[172:175], a[156:159], a[136:139], v[172:175]
v_mfma_f32_16x16x32_bf16 v[176:179], a[156:159], a[140:143], v[176:179]
s_waitcnt lgkmcnt(0)
v_mfma_f32_16x16x16_bf16 v[164:167], a[160:161], v[212:213], v[164:167]
v_mfma_f32_16x16x16_bf16 v[168:171], a[160:161], v[214:215], v[168:171]
v_mfma_f32_16x16x16_bf16 v[172:175], a[164:165], v[212:213], v[172:175]
v_mfma_f32_16x16x16_bf16 v[176:179], a[164:165], v[214:215], v[176:179]
L_c4:
v_add_u32 v180, 0, v1
v_lshlrev_b32 v184, 16, v0
v_lshlrev_b32 v185, 16, v0
v_lshlrev_b32 v186, 16, v0
v_lshlrev_b32 v187, 16, v0
v_lshlrev_b32 v188, 16, v249
v_lshlrev_b32 v189, 16, v249
v_lshlrev_b32 v190, 16, v249
v_lshlrev_b32 v191, 16, v249
s_waitcnt lgkmcnt(0)
ds_write_b128 v240, v[36:39] offset:0
ds_write_b128 v240, v[40:43] offset:1024
ds_write_b128 v240, v[52:55] offset:2048
ds_write_b128 v240, v[56:59] offset:3072
s_cmp_eq_u32 s24, 0
s_cselect_b32 s67, 0, 1073741824
s_add_u32 s67, s67, 26542080
s_waitcnt vmcnt(4)
s_barrier
s_mov_b64 exec, 0xffff
buffer_atomic_add v4, v233, s[8:11], s67 offen sc1
s_mov_b64 exec, -1
v_add_u32 v200, 53248, v1
v_add_u32 v201, 90112, v1
v_add_u32 v202, 126976, v1
s_lshl_b32 s35, s80, 7
s_add_u32 s35, s35, 26542080
s_cmp_eq_u32 s24, 1
s_cselect_b32 s35, s35, 1073741824
v_mov_b32 v6, 0
v_mov_b32 v244, 0
v_mov_b32 v245, 0
v_mov_b32 v246, 0
buffer_load_dwordx4 a[80:83], v1, s[4:7], s52 offen offset:2048 sc1
buffer_load_dwordx4 a[84:87], v9, s[4:7], s52 offen offset:2048 sc1
ds_write_b128 v240, v[68:71] offset:4096
ds_write_b128 v240, v[72:75] offset:5120
ds_write_b128 v240, v[84:87] offset:6144
ds_write_b128 v240, v[88:91] offset:7168
ds_write_b128 v240, v[100:103] offset:8192
v_pk_mul_f32 v[192:193], v[108:109], v[108:109]
v_pk_mul_f32 v[194:195], v[110:111], v[110:111]
v_pk_mul_f32 v[196:197], v[112:113], v[112:113]
v_pk_mul_f32 v[198:199], v[114:115], v[114:115]
v_pk_fma_f32 v[192:193], v[192:193], v[252:253], v[250:251] op_sel:[0,0,0] op_sel_hi:[1,0,0]
v_pk_fma_f32 v[194:195], v[194:195], v[252:253], v[250:251] op_sel:[0,0,0] op_sel_hi:[1,0,0]
v_pk_fma_f32 v[196:197], v[196:197], v[252:253], v[250:251] op_sel:[0,1,1] op_sel_hi:[1,1,1]
v_pk_fma_f32 v[198:199], v[198:199], v[252:253], v[250:251] op_sel:[0,1,1] op_sel_hi:[1,1,1]
v_pk_mul_f32 v[192:193], v[192:193], v[108:109]
buffer_load_dwordx4 a[88:91], v1, s[4:7], s52 offen offset:3072 sc1
buffer_load_dwordx4 a[92:95], v9, s[4:7], s52 offen offset:3072 sc1
v_pk_mul_f32 v[194:195], v[194:195], v[110:111]
v_pk_mul_f32 v[196:197], v[196:197], v[112:113]
v_pk_mul_f32 v[198:199], v[198:199], v[114:115]
v_exp_f32 v192, v192
v_exp_f32 v193, v193
v_exp_f32 v194, v194
v_exp_f32 v195, v195
v_exp_f32 v196, v196
v_exp_f32 v197, v197
v_exp_f32 v198, v198
v_exp_f32 v199, v199
v_pk_fma_f32 v[192:193], v[192:193], v[254:255], v[254:255] op_sel:[0,0,0] op_sel_hi:[1,0,0]
v_pk_fma_f32 v[194:195], v[194:195], v[254:255], v[254:255] op_sel:[0,0,0] op_sel_hi:[1,0,0]
v_pk_fma_f32 v[196:197], v[196:197], v[254:255], v[254:255] op_sel:[0,1,1] op_sel_hi:[1,1,1]
s_cmp_eq_u32 s25, 2
s_cselect_b32 s98, 4096, 0
s_add_u32 s52, s52, s98
s_add_u32 s52, s52, 4096
buffer_load_dwordx4 a[96:99], v1, s[4:7], s52 offen offset:0 sc1
s_mov_b64 exec, 1
buffer_atomic_add v244, v6, s[8:11], s35 offen sc0 sc1
s_mov_b64 exec, -1
buffer_load_dwordx4 a[100:103], v9, s[4:7], s52 offen offset:0 sc1
v_pk_fma_f32 v[198:199], v[198:199], v[254:255], v[254:255] op_sel:[0,1,1] op_sel_hi:[1,1,1]
v_rcp_f32 v192, v192
v_rcp_f32 v193, v193
v_rcp_f32 v194, v194
v_rcp_f32 v195, v195
v_rcp_f32 v196, v196
v_rcp_f32 v197, v197
v_rcp_f32 v198, v198
v_rcp_f32 v199, v199
v_pk_mul_f32 v[108:109], v[108:109], v[192:193]
v_pk_mul_f32 v[110:111], v[110:111], v[194:195]
v_pk_mul_f32 v[112:113], v[112:113], v[196:197]
v_pk_mul_f32 v[114:115], v[114:115], v[198:199]
v_pk_mul_f32 v[192:193], v[116:117], v[116:117]
buffer_load_dwordx4 a[104:107], v1, s[4:7], s52 offen offset:1024 sc1
buffer_load_dwordx4 a[108:111], v9, s[4:7], s52 offen offset:1024 sc1
v_pk_mul_f32 v[194:195], v[118:119], v[118:119]
v_pk_mul_f32 v[196:197], v[120:121], v[120:121]
v_pk_mul_f32 v[198:199], v[122:123], v[122:123]
v_pk_fma_f32 v[192:193], v[192:193], v[252:253], v[250:251] op_sel:[0,0,0] op_sel_hi:[1,0,0]
v_pk_fma_f32 v[194:195], v[194:195], v[252:253], v[250:251] op_sel:[0,0,0] op_sel_hi:[1,0,0]
v_pk_fma_f32 v[196:197], v[196:197], v[252:253], v[250:251] op_sel:[0,1,1] op_sel_hi:[1,1,1]
v_pk_fma_f32 v[198:199], v[198:199], v[252:253], v[250:251] op_sel:[0,1,1] op_sel_hi:[1,1,1]
v_pk_mul_f32 v[192:193], v[192:193], v[116:117]
v_pk_mul_f32 v[194:195], v[194:195], v[118:119]
v_pk_mul_f32 v[196:197], v[196:197], v[120:121]
v_pk_mul_f32 v[198:199], v[198:199], v[122:123]
v_exp_f32 v192, v192
v_exp_f32 v193, v193
v_exp_f32 v194, v194
buffer_load_dwordx4 a[112:115], v1, s[4:7], s52 offen offset:2048 sc1
s_mov_b64 exec, 1
buffer_atomic_add v245, v6, s[8:11], s35 offen sc0 sc1
s_mov_b64 exec, -1
buffer_load_dwordx4 a[116:119], v9, s[4:7], s52 offen offset:2048 sc1
v_exp_f32 v195, v195
v_exp_f32 v196, v196
v_exp_f32 v197, v197
v_exp_f32 v198, v198
v_exp_f32 v199, v199
v_pk_fma_f32 v[192:193], v[192:193], v[254:255], v[254:255] op_sel:[0,0,0] op_sel_hi:[1,0,0]
v_pk_fma_f32 v[194:195], v[194:195], v[254:255], v[254:255] op_sel:[0,0,0] op_sel_hi:[1,0,0]
v_pk_fma_f32 v[196:197], v[196:197], v[254:255], v[254:255] op_sel:[0,1,1] op_sel_hi:[1,1,1]
v_pk_fma_f32 v[198:199], v[198:199], v[254:255], v[254:255] op_sel:[0,1,1] op_sel_hi:[1,1,1]
v_rcp_f32 v192, v192
v_rcp_f32 v193, v193
v_rcp_f32 v194, v194
v_rcp_f32 v195, v195
v_rcp_f32 v196, v196
buffer_load_dwordx4 a[120:123], v1, s[4:7], s52 offen offset:3072 sc1
buffer_load_dwordx4 a[124:127], v9, s[4:7], s52 offen offset:3072 sc1
v_rcp_f32 v197, v197
v_rcp_f32 v198, v198
v_rcp_f32 v199, v199
v_pk_mul_f32 v[116:117], v[116:117], v[192:193]
v_pk_mul_f32 v[118:119], v[118:119], v[194:195]
v_pk_mul_f32 v[120:121], v[120:121], v[196:197]
v_pk_mul_f32 v[122:123], v[122:123], v[198:199]
v_pk_mul_f32 v[192:193], v[124:125], v[124:125]
v_pk_mul_f32 v[194:195], v[126:127], v[126:127]
v_pk_mul_f32 v[196:197], v[128:129], v[128:129]
v_pk_mul_f32 v[198:199], v[130:131], v[130:131]
v_pk_fma_f32 v[192:193], v[192:193], v[252:253], v[250:251] op_sel:[0,0,0] op_sel_hi:[1,0,0]
v_pk_fma_f32 v[194:195], v[194:195], v[252:253], v[250:251] op_sel:[0,0,0] op_sel_hi:[1,0,0]
v_pk_fma_f32 v[196:197], v[196:197], v[252:253], v[250:251] op_sel:[0,1,1] op_sel_hi:[1,1,1]
s_cmp_eq_u32 s25, 3
s_cselect_b32 s98, 4096, 0
s_add_u32 s52, s52, s98
s_add_u32 s52, s52, 4096
buffer_load_dwordx4 a[128:131], v1, s[4:7], s52 offen offset:0 sc1
s_mov_b64 exec, 1
buffer_atomic_add v246, v6, s[8:11], s35 offen sc0 sc1
s_mov_b64 exec, -1
buffer_load_dwordx4 a[132:135], v9, s[4:7], s52 offen offset:0 sc1
v_pk_fma_f32 v[198:199], v[198:199], v[252:253], v[250:251] op_sel:[0,1,1] op_sel_hi:[1,1,1]
v_pk_mul_f32 v[192:193], v[192:193], v[124:125]
v_pk_mul_f32 v[194:195], v[194:195], v[126:127]
v_pk_mul_f32 v[196:197], v[196:197], v[128:129]
v_pk_mul_f32 v[198:199], v[198:199], v[130:131]
v_exp_f32 v192, v192
v_exp_f32 v193, v193
v_exp_f32 v194, v194
v_exp_f32 v195, v195
v_exp_f32 v196, v196
v_exp_f32 v197, v197
v_exp_f32 v198, v198
v_exp_f32 v199, v199
v_pk_fma_f32 v[192:193], v[192:193], v[254:255], v[254:255] op_sel:[0,0,0] op_sel_hi:[1,0,0]
buffer_load_dwordx4 a[136:139], v1, s[4:7], s52 offen offset:1024 sc1
buffer_load_dwordx4 a[140:143], v9, s[4:7], s52 offen offset:1024 sc1
v_pk_fma_f32 v[194:195], v[194:195], v[254:255], v[254:255] op_sel:[0,0,0] op_sel_hi:[1,0,0]
v_pk_fma_f32 v[196:197], v[196:197], v[254:255], v[254:255] op_sel:[0,1,1] op_sel_hi:[1,1,1]
v_pk_fma_f32 v[198:199], v[198:199], v[254:255], v[254:255] op_sel:[0,1,1] op_sel_hi:[1,1,1]
v_rcp_f32 v192, v192
v_rcp_f32 v193, v193
v_rcp_f32 v194, v194
v_rcp_f32 v195, v195
v_rcp_f32 v196, v196
v_rcp_f32 v197, v197
v_rcp_f32 v198, v198
v_rcp_f32 v199, v199
v_pk_mul_f32 v[124:125], v[124:125], v[192:193]
v_pk_mul_f32 v[126:127], v[126:127], v[194:195]
v_pk_mul_f32 v[128:129], v[128:129], v[196:197]
v_pk_mul_f32 v[130:131], v[130:131], v[198:199]
s_mul_i32 s30, s26, 589824
s_add_u32 s30, s30, 7340032
s_lshl_b32 s62, s24, 12
s_lshl_b32 s63, s24, 10
s_add_u32 s60, s30, s62
s_add_u32 s61, s30, s63
s_add_u32 s61, s61, 16384
s_cmp_eq_u32 s25, 0
s_cselect_b32 s99, 36864, 0
s_add_u32 s60, s60, s99
s_add_u32 s61, s61, s99
s_add_u32 m0, s62, 53248
s_add_u32 s60, s60, 0
s_waitcnt lgkmcnt(0)
s_cmp_eq_u32 s24, 1
s_cbranch_scc0 L_other_34
s_mov_b32 s31, 0
s_mov_b64 exec, 1
v_mov_b32 v247, 0
buffer_atomic_add v247, v6, s[8:11], s35 offen sc0 sc1
s_waitcnt vmcnt(14)
v_cmp_gt_u32 vcc, 16, v244
s_nop 0
s_cbranch_vccz L_polled_33
s_waitcnt vmcnt(9)
v_cmp_gt_u32 vcc, 16, v245
s_nop 0
s_cbranch_vccz L_polled_33
v_mov_b32 v244, 0
buffer_atomic_add v244, v6, s[8:11], s35 offen sc0 sc1
s_waitcnt vmcnt(5)
v_cmp_gt_u32 vcc, 16, v246
s_nop 0
s_cbranch_vccz L_polled_33
v_mov_b32 v245, 0
buffer_atomic_add v245, v6, s[8:11], s35 offen sc0 sc1
L_poll_32:
s_add_u32 s31, s31, 1
s_cmp_gt_u32 s31, 100000
s_cbranch_scc1 L_polled_33
v_mov_b32 v246, 0
buffer_atomic_add v246, v6, s[8:11], s35 offen sc0 sc1
s_waitcnt vmcnt(3)
v_cmp_gt_u32 vcc, 16, v247
s_nop 0
s_cbranch_vccz L_polled_33
v_mov_b32 v247, 0
buffer_atomic_add v247, v6, s[8:11], s35 offen sc0 sc1
s_waitcnt vmcnt(3)
v_cmp_gt_u32 vcc, 16, v244
s_nop 0
s_cbranch_vccz L_polled_33
v_mov_b32 v244, 0
buffer_atomic_add v244, v6, s[8:11], s35 offen sc0 sc1
s_waitcnt vmcnt(3)
v_cmp_gt_u32 vcc, 16, v245
s_nop 0
s_cbranch_vccz L_polled_33
v_mov_b32 v245, 0
buffer_atomic_add v245, v6, s[8:11], s35 offen sc0 sc1
s_waitcnt vmcnt(3)
v_cmp_gt_u32 vcc, 16, v246
s_nop 0
s_cbranch_vccz L_polled_33
s_branch L_poll_32
L_polled_33:
s_mov_b64 exec, -1
L_other_34:
s_barrier
buffer_load_dwordx4 v1, s[8:11], s60 offen offset:0 sc1 lds
buffer_load_dwordx4 v1, s[8:11], s60 offen offset:1024 sc1 lds
ds_read_b128 a[0:3], v180 offset:0
ds_read_b128 a[4:7], v180 offset:1024
ds_read_b128 a[8:11], v180 offset:2048
ds_read_b128 a[12:15], v180 offset:3072
ds_read_b128 a[16:19], v180 offset:4096
ds_read_b128 a[20:23], v180 offset:5120
ds_read_b128 a[24:27], v180 offset:6144
ds_read_b128 a[28:31], v180 offset:7168
ds_read_b128 a[32:35], v180 offset:8192
buffer_load_dwordx4 v1, s[8:11], s60 offen offset:2048 sc1 lds
buffer_load_dwordx4 v1, s[8:11], s60 offen offset:3072 sc1 lds
s_add_u32 m0, s63, 69632
s_add_u32 s61, s61, 0
buffer_load_dwordx4 v1, s[8:11], s61 offen offset:0 sc1 lds
s_waitcnt lgkmcnt(0)
v_mfma_f32_16x16x32_bf16 v[36:39], a[0:3], a[176:179], v[184:187]
ds_read_b128 a[36:39], v180 offset:9216
s_add_u32 m0, s62, 73728
v_mfma_f32_16x16x32_bf16 v[40:43], a[0:3], a[180:183], v[188:191]
ds_read_b128 a[40:43], v180 offset:10240
v_mul_f32 v192, v132, v132
v_mfma_f32_16x16x32_bf16 v[44:47], a[4:7], a[176:179], v[184:187]
ds_read_b128 a[44:47], v180 offset:11264
s_add_u32 s60, s60, 20480
v_mfma_f32_16x16x32_bf16 v[48:51], a[4:7], a[180:183], v[188:191]
ds_read_b128 a[48:51], v180 offset:12288
v_mul_f32 v193, v133, v133
v_mfma_f32_16x16x32_bf16 v[52:55], a[8:11], a[176:179], v[184:187]
ds_read_b128 a[52:55], v180 offset:13312
v_mul_f32 v194, v134, v134
v_mfma_f32_16x16x32_bf16 v[56:59], a[8:11], a[180:183], v[188:191]
ds_read_b128 a[56:59], v180 offset:14336
buffer_load_dwordx4 v1, s[8:11], s60 offen offset:0 sc1 lds
v_mfma_f32_16x16x32_bf16 v[60:63], a[12:15], a[176:179], v[184:187]
ds_read_b128 a[60:63], v180 offset:15360
v_mfma_f32_16x16x32_bf16 v[64:67], a[12:15], a[180:183], v[188:191]
ds_read_b128 a[64:67], v180 offset:16384
v_mul_f32 v195, v135, v135
v_mfma_f32_16x16x32_bf16 v[68:71], a[16:19], a[176:179], v[184:187]
ds_read_b128 a[68:71], v180 offset:17408
buffer_load_dwordx4 v1, s[8:11], s60 offen offset:1024 sc1 lds
v_mfma_f32_16x16x32_bf16 v[72:75], a[16:19], a[180:183], v[188:191]
v_fma_f32 v192, v192, v252, v250
v_mfma_f32_16x16x32_bf16 v[76:79], a[20:23], a[176:179], v[184:187]
v_mfma_f32_16x16x32_bf16 v[80:83], a[20:23], a[180:183], v[188:191]
buffer_load_dwordx4 v1, s[8:11], s60 offen offset:2048 sc1 lds
v_fma_f32 v193, v193, v252, v250
v_mfma_f32_16x16x32_bf16 v[84:87], a[24:27], a[176:179], v[184:187]
v_mfma_f32_16x16x32_bf16 v[88:91], a[24:27], a[180:183], v[188:191]
v_mfma_f32_16x16x32_bf16 v[92:95], a[28:31], a[176:179], v[184:187]
buffer_load_dwordx4 v1, s[8:11], s60 offen offset:3072 sc1 lds
v_fma_f32 v194, v194, v252, v250
v_mfma_f32_16x16x32_bf16 v[96:99], a[28:31], a[180:183], v[188:191]
v_mfma_f32_16x16x32_bf16 v[100:103], a[32:35], a[176:179], v[184:187]
v_fma_f32 v195, v195, v252, v250
v_mfma_f32_16x16x32_bf16 v[104:107], a[32:35], a[180:183], v[188:191]
s_waitcnt lgkmcnt(0)
v_mfma_f32_16x16x32_bf16 v[36:39], a[36:39], a[184:187], v[36:39]
ds_read_b128 a[0:3], v180 offset:18432
v_mul_f32 v192, v192, v132
v_mfma_f32_16x16x32_bf16 v[40:43], a[36:39], a[188:191], v[40:43]
ds_read_b128 a[4:7], v180 offset:19456
v_mfma_f32_16x16x32_bf16 v[44:47], a[40:43], a[184:187], v[44:47]
ds_read_b128 a[8:11], v180 offset:20480
v_mfma_f32_16x16x32_bf16 v[48:51], a[40:43], a[188:191], v[48:51]
ds_read_b128 a[12:15], v180 offset:21504
v_mul_f32 v193, v193, v133
v_mfma_f32_16x16x32_bf16 v[52:55], a[44:47], a[184:187], v[52:55]
ds_read_b128 a[16:19], v180 offset:22528
v_mfma_f32_16x16x32_bf16 v[56:59], a[44:47], a[188:191], v[56:59]
ds_read_b128 a[20:23], v180 offset:23552
v_mul_f32 v194, v194, v134
v_mfma_f32_16x16x32_bf16 v[60:63], a[48:51], a[184:187], v[60:63]
ds_read_b128 a[24:27], v180 offset:24576
v_mfma_f32_16x16x32_bf16 v[64:67], a[48:51], a[188:191], v[64:67]
ds_read_b128 a[28:31], v180 offset:25600
v_mul_f32 v195, v195, v135
v_mfma_f32_16x16x32_bf16 v[68:71], a[52:55], a[184:187], v[68:71]
ds_read_b128 a[32:35], v180 offset:26624
v_mfma_f32_16x16x32_bf16 v[72:75], a[52:55], a[188:191], v[72:75]
s_cmp_eq_u32 s25, 1
s_cselect_b32 s99, 36864, 0
s_add_u32 s60, s60, s99
v_mfma_f32_16x16x32_bf16 v[76:79], a[56:59], a[184:187], v[76:79]
s_add_u32 s61, s61, s99
s_add_u32 m0, s62, 90112
s_add_u32 s60, s60, 16384
v_mfma_f32_16x16x32_bf16 v[80:83], a[56:59], a[188:191], v[80:83]
buffer_load_dwordx4 v1, s[8:11], s60 offen offset:0 sc1 lds
v_mfma_f32_16x16x32_bf16 v[84:87], a[60:63], a[184:187], v[84:87]
buffer_load_dwordx4 v1, s[8:11], s60 offen offset:1024 sc1 lds
v_mfma_f32_16x16x32_bf16 v[88:91], a[60:63], a[188:191], v[88:91]
buffer_load_dwordx4 v1, s[8:11], s60 offen offset:2048 sc1 lds
v_mfma_f32_16x16x32_bf16 v[92:95], a[64:67], a[184:187], v[92:95]
v_exp_f32 v192, v192
v_mfma_f32_16x16x32_bf16 v[96:99], a[64:67], a[188:191], v[96:99]
buffer_load_dwordx4 v1, s[8:11], s60 offen offset:3072 sc1 lds
v_mfma_f32_16x16x32_bf16 v[100:103], a[68:71], a[184:187], v[100:103]
v_exp_f32 v193, v193
v_mfma_f32_16x16x32_bf16 v[104:107], a[68:71], a[188:191], v[104:107]
s_waitcnt lgkmcnt(0)
v_mfma_f32_16x16x32_bf16 v[36:39], a[0:3], a[192:195], v[36:39]
ds_read_b128 a[36:39], v180 offset:27648
s_add_u32 m0, s63, 106496
v_mfma_f32_16x16x32_bf16 v[40:43], a[0:3], a[196:199], v[40:43]
ds_read_b128 a[40:43], v180 offset:28672
v_mfma_f32_16x16x32_bf16 v[44:47], a[4:7], a[192:195], v[44:47]
ds_read_b128 a[44:47], v180 offset:29696
s_add_u32 s61, s61, 36864
v_mfma_f32_16x16x32_bf16 v[48:51], a[4:7], a[196:199], v[48:51]
ds_read_b128 a[48:51], v180 offset:30720
v_mfma_f32_16x16x32_bf16 v[52:55], a[8:11], a[192:195], v[52:55]
ds_read_b128 a[52:55], v180 offset:31744
buffer_load_dwordx4 v1, s[8:11], s61 offen offset:0 sc1 lds
v_mfma_f32_16x16x32_bf16 v[56:59], a[8:11], a[196:199], v[56:59]
ds_read_b128 a[56:59], v180 offset:32768
v_mfma_f32_16x16x32_bf16 v[60:63], a[12:15], a[192:195], v[60:63]
ds_read_b128 a[60:63], v180 offset:33792
s_add_u32 m0, s62, 110592
v_mfma_f32_16x16x32_bf16 v[64:67], a[12:15], a[196:199], v[64:67]
ds_read_b128 a[64:67], v180 offset:34816
v_mfma_f32_16x16x32_bf16 v[68:71], a[16:19], a[192:195], v[68:71]
ds_read_b128 a[68:71], v180 offset:35840
s_add_u32 s60, s60, 20480
v_mfma_f32_16x16x32_bf16 v[72:75], a[16:19], a[196:199], v[72:75]
v_exp_f32 v194, v194
v_mfma_f32_16x16x32_bf16 v[76:79], a[20:23], a[192:195], v[76:79]
buffer_load_dwordx4 v1, s[8:11], s60 offen offset:0 sc1 lds
v_mfma_f32_16x16x32_bf16 v[80:83], a[20:23], a[196:199], v[80:83]
v_exp_f32 v195, v195
v_mfma_f32_16x16x32_bf16 v[84:87], a[24:27], a[192:195], v[84:87]
buffer_load_dwordx4 v1, s[8:11], s60 offen offset:1024 sc1 lds
v_fma_f32 v192, v192, v254, v254
v_mfma_f32_16x16x32_bf16 v[88:91], a[24:27], a[196:199], v[88:91]
v_fma_f32 v193, v193, v254, v254
v_mfma_f32_16x16x32_bf16 v[92:95], a[28:31], a[192:195], v[92:95]
buffer_load_dwordx4 v1, s[8:11], s60 offen offset:2048 sc1 lds
v_mfma_f32_16x16x32_bf16 v[96:99], a[28:31], a[196:199], v[96:99]
v_fma_f32 v194, v194, v254, v254
v_mfma_f32_16x16x32_bf16 v[100:103], a[32:35], a[192:195], v[100:103]
v_mfma_f32_16x16x32_bf16 v[104:107], a[32:35], a[196:199], v[104:107]
s_waitcnt vmcnt(12) lgkmcnt(0)
s_barrier
v_mfma_f32_16x16x32_bf16 v[36:39], a[36:39], a[200:203], v[36:39]
ds_read_b128 a[0:3], v200 offset:0
buffer_load_dwordx4 v1, s[8:11], s60 offen offset:3072 sc1 lds
v_mfma_f32_16x16x32_bf16 v[40:43], a[36:39], a[204:207], v[40:43]
ds_read_b128 a[4:7], v200 offset:1024
v_fma_f32 v195, v195, v254, v254
v_mfma_f32_16x16x32_bf16 v[44:47], a[40:43], a[200:203], v[44:47]
ds_read_b128 a[8:11], v200 offset:2048
v_mfma_f32_16x16x32_bf16 v[48:51], a[40:43], a[204:207], v[48:51]
ds_read_b128 a[12:15], v200 offset:3072
v_mfma_f32_16x16x32_bf16 v[52:55], a[44:47], a[200:203], v[52:55]
ds_read_b128 a[16:19], v200 offset:4096
v_mfma_f32_16x16x32_bf16 v[56:59], a[44:47], a[204:207], v[56:59]
ds_read_b128 a[20:23], v200 offset:5120
v_mfma_f32_16x16x32_bf16 v[60:63], a[48:51], a[200:203], v[60:63]
ds_read_b128 a[24:27], v200 offset:6144
v_mfma_f32_16x16x32_bf16 v[64:67], a[48:51], a[204:207], v[64:67]
ds_read_b128 a[28:31], v200 offset:7168
v_mfma_f32_16x16x32_bf16 v[68:71], a[52:55], a[200:203], v[68:71]
ds_read_b128 a[32:35], v200 offset:8192
v_mfma_f32_16x16x32_bf16 v[72:75], a[52:55], a[204:207], v[72:75]
s_cmp_eq_u32 s25, 2
s_cselect_b32 s99, 36864, 0
s_add_u32 s60, s60, s99
v_mfma_f32_16x16x32_bf16 v[76:79], a[56:59], a[200:203], v[76:79]
s_add_u32 s61, s61, s99
s_add_u32 m0, s62, 126976
s_add_u32 s60, s60, 16384
v_mfma_f32_16x16x32_bf16 v[80:83], a[56:59], a[204:207], v[80:83]
buffer_load_dwordx4 v1, s[8:11], s60 offen offset:0 sc1 lds
v_mfma_f32_16x16x32_bf16 v[84:87], a[60:63], a[200:203], v[84:87]
v_rcp_f32 v192, v192
v_mfma_f32_16x16x32_bf16 v[88:91], a[60:63], a[204:207], v[88:91]
buffer_load_dwordx4 v1, s[8:11], s60 offen offset:1024 sc1 lds
v_mfma_f32_16x16x32_bf16 v[92:95], a[64:67], a[200:203], v[92:95]
v_rcp_f32 v193, v193
v_mfma_f32_16x16x32_bf16 v[96:99], a[64:67], a[204:207], v[96:99]
buffer_load_dwordx4 v1, s[8:11], s60 offen offset:2048 sc1 lds
v_mfma_f32_16x16x32_bf16 v[100:103], a[68:71], a[200:203], v[100:103]
v_rcp_f32 v194, v194
v_mfma_f32_16x16x32_bf16 v[104:107], a[68:71], a[204:207], v[104:107]
s_waitcnt lgkmcnt(0)
v_mfma_f32_16x16x32_bf16 v[36:39], a[0:3], a[208:211], v[36:39]
ds_read_b128 a[36:39], v200 offset:9216
buffer_load_dwordx4 v1, s[8:11], s60 offen offset:3072 sc1 lds
v_mfma_f32_16x16x32_bf16 v[40:43], a[0:3], a[212:215], v[40:43]
ds_read_b128 a[40:43], v200 offset:10240
v_mfma_f32_16x16x32_bf16 v[44:47], a[4:7], a[208:211], v[44:47]
ds_read_b128 a[44:47], v200 offset:11264
s_add_u32 m0, s63, 143360
v_mfma_f32_16x16x32_bf16 v[48:51], a[4:7], a[212:215], v[48:51]
ds_read_b128 a[48:51], v200 offset:12288
v_mfma_f32_16x16x32_bf16 v[52:55], a[8:11], a[208:211], v[52:55]
ds_read_b128 a[52:55], v200 offset:13312
s_add_u32 s61, s61, 36864
v_mfma_f32_16x16x32_bf16 v[56:59], a[8:11], a[212:215], v[56:59]
ds_read_b128 a[56:59], v200 offset:14336
v_mfma_f32_16x16x32_bf16 v[60:63], a[12:15], a[208:211], v[60:63]
ds_read_b128 a[60:63], v200 offset:15360
buffer_load_dwordx4 v1, s[8:11], s61 offen offset:0 sc1 lds
v_mfma_f32_16x16x32_bf16 v[64:67], a[12:15], a[212:215], v[64:67]
ds_read_b128 a[64:67], v200 offset:16384
v_mfma_f32_16x16x32_bf16 v[68:71], a[16:19], a[208:211], v[68:71]
ds_read_b128 a[68:71], v200 offset:17408
s_add_u32 m0, s62, 147456
v_mfma_f32_16x16x32_bf16 v[72:75], a[16:19], a[212:215], v[72:75]
s_add_u32 s60, s60, 20480
v_rcp_f32 v195, v195
v_mfma_f32_16x16x32_bf16 v[76:79], a[20:23], a[208:211], v[76:79]
v_mul_f32 v132, v132, v192
v_mul_f32 v133, v133, v193
v_mfma_f32_16x16x32_bf16 v[80:83], a[20:23], a[212:215], v[80:83]
v_mul_f32 v134, v134, v194
v_mul_f32 v135, v135, v195
v_mfma_f32_16x16x32_bf16 v[84:87], a[24:27], a[208:211], v[84:87]
buffer_load_dwordx4 v1, s[8:11], s60 offen offset:0 sc1 lds
v_mul_f32 v196, v136, v136
v_mfma_f32_16x16x32_bf16 v[88:91], a[24:27], a[212:215], v[88:91]
v_mfma_f32_16x16x32_bf16 v[92:95], a[28:31], a[208:211], v[92:95]
buffer_load_dwordx4 v1, s[8:11], s60 offen offset:1024 sc1 lds
v_mfma_f32_16x16x32_bf16 v[96:99], a[28:31], a[212:215], v[96:99]
v_mul_f32 v197, v137, v137
v_mfma_f32_16x16x32_bf16 v[100:103], a[32:35], a[208:211], v[100:103]
v_mfma_f32_16x16x32_bf16 v[104:107], a[32:35], a[212:215], v[104:107]
s_waitcnt vmcnt(16) lgkmcnt(0)
s_barrier
v_mfma_f32_16x16x32_bf16 v[36:39], a[36:39], a[216:219], v[36:39]
ds_read_b128 a[0:3], v200 offset:18432
buffer_load_dwordx4 v1, s[8:11], s60 offen offset:2048 sc1 lds
v_mfma_f32_16x16x32_bf16 v[40:43], a[36:39], a[220:223], v[40:43]
ds_read_b128 a[4:7], v200 offset:19456
v_mul_f32 v198, v138, v138
v_mfma_f32_16x16x32_bf16 v[44:47], a[40:43], a[216:219], v[44:47]
ds_read_b128 a[8:11], v200 offset:20480
v_mul_f32 v199, v139, v139
v_mfma_f32_16x16x32_bf16 v[48:51], a[40:43], a[220:223], v[48:51]
ds_read_b128 a[12:15], v200 offset:21504
v_mfma_f32_16x16x32_bf16 v[52:55], a[44:47], a[216:219], v[52:55]
ds_read_b128 a[16:19], v200 offset:22528
buffer_load_dwordx4 v1, s[8:11], s60 offen offset:3072 sc1 lds
v_mfma_f32_16x16x32_bf16 v[56:59], a[44:47], a[220:223], v[56:59]
ds_read_b128 a[20:23], v200 offset:23552
v_fma_f32 v196, v196, v253, v251
v_mfma_f32_16x16x32_bf16 v[60:63], a[48:51], a[216:219], v[60:63]
ds_read_b128 a[24:27], v200 offset:24576
v_fma_f32 v197, v197, v253, v251
v_mfma_f32_16x16x32_bf16 v[64:67], a[48:51], a[220:223], v[64:67]
ds_read_b128 a[28:31], v200 offset:25600
v_mfma_f32_16x16x32_bf16 v[68:71], a[52:55], a[216:219], v[68:71]
ds_read_b128 a[32:35], v200 offset:26624
buffer_load_dwordx4 a[144:147], v1, s[4:7], s52 offen offset:2048 sc1
v_mfma_f32_16x16x32_bf16 v[72:75], a[52:55], a[220:223], v[72:75]
v_fma_f32 v198, v198, v253, v251
v_mfma_f32_16x16x32_bf16 v[76:79], a[56:59], a[216:219], v[76:79]
v_mfma_f32_16x16x32_bf16 v[80:83], a[56:59], a[220:223], v[80:83]
v_fma_f32 v199, v199, v253, v251
v_mfma_f32_16x16x32_bf16 v[84:87], a[60:63], a[216:219], v[84:87]
buffer_load_dwordx4 a[148:151], v9, s[4:7], s52 offen offset:2048 sc1
v_mfma_f32_16x16x32_bf16 v[88:91], a[60:63], a[220:223], v[88:91]
v_mul_f32 v196, v196, v136
v_mfma_f32_16x16x32_bf16 v[92:95], a[64:67], a[216:219], v[92:95]
v_mfma_f32_16x16x32_bf16 v[96:99], a[64:67], a[220:223], v[96:99]
v_mfma_f32_16x16x32_bf16 v[100:103], a[68:71], a[216:219], v[100:103]
v_mul_f32 v197, v197, v137
v_mfma_f32_16x16x32_bf16 v[104:107], a[68:71], a[220:223], v[104:107]
s_waitcnt lgkmcnt(0)
v_mfma_f32_16x16x32_bf16 v[36:39], a[0:3], a[224:227], v[36:39]
ds_read_b128 a[36:39], v200 offset:27648
buffer_load_dwordx4 a[152:155], v1, s[4:7], s52 offen offset:3072 sc1
v_mfma_f32_16x16x32_bf16 v[40:43], a[0:3], a[228:231], v[40:43]
ds_read_b128 a[40:43], v200 offset:28672
v_mul_f32 v198, v198, v138
v_mfma_f32_16x16x32_bf16 v[44:47], a[4:7], a[224:227], v[44:47]
ds_read_b128 a[44:47], v200 offset:29696
buffer_load_dwordx4 a[156:159], v9, s[4:7], s52 offen offset:3072 sc1
v_mfma_f32_16x16x32_bf16 v[48:51], a[4:7], a[228:231], v[48:51]
ds_read_b128 a[48:51], v200 offset:30720
v_mul_f32 v199, v199, v139
v_mfma_f32_16x16x32_bf16 v[52:55], a[8:11], a[224:227], v[52:55]
ds_read_b128 a[52:55], v200 offset:31744
v_mfma_f32_16x16x32_bf16 v[56:59], a[8:11], a[228:231], v[56:59]
ds_read_b128 a[56:59], v200 offset:32768
v_mfma_f32_16x16x32_bf16 v[60:63], a[12:15], a[224:227], v[60:63]
ds_read_b128 a[60:63], v200 offset:33792
v_mfma_f32_16x16x32_bf16 v[64:67], a[12:15], a[228:231], v[64:67]
ds_read_b128 a[64:67], v200 offset:34816
v_mfma_f32_16x16x32_bf16 v[68:71], a[16:19], a[224:227], v[68:71]
ds_read_b128 a[68:71], v200 offset:35840
v_mfma_f32_16x16x32_bf16 v[72:75], a[16:19], a[228:231], v[72:75]
s_cmp_eq_u32 s25, 4
s_cselect_b32 s98, 4096, 0
s_add_u32 s52, s52, s98
v_mfma_f32_16x16x32_bf16 v[76:79], a[20:23], a[224:227], v[76:79]
s_add_u32 s52, s52, 4096
v_exp_f32 v196, v196
v_mfma_f32_16x16x32_bf16 v[80:83], a[20:23], a[228:231], v[80:83]
v_exp_f32 v197, v197
v_mfma_f32_16x16x32_bf16 v[84:87], a[24:27], a[224:227], v[84:87]
buffer_load_dwordx4 a[160:163], v1, s[4:7], s52 offen offset:0 sc1
v_mfma_f32_16x16x32_bf16 v[88:91], a[24:27], a[228:231], v[88:91]
v_mfma_f32_16x16x32_bf16 v[92:95], a[28:31], a[224:227], v[92:95]
buffer_load_dwordx4 a[164:167], v9, s[4:7], s52 offen offset:0 sc1
v_mfma_f32_16x16x32_bf16 v[96:99], a[28:31], a[228:231], v[96:99]
v_exp_f32 v198, v198
v_mfma_f32_16x16x32_bf16 v[100:103], a[32:35], a[224:227], v[100:103]
v_mfma_f32_16x16x32_bf16 v[104:107], a[32:35], a[228:231], v[104:107]
s_waitcnt vmcnt(19) lgkmcnt(0)
s_barrier
v_mfma_f32_16x16x32_bf16 v[36:39], a[36:39], a[232:235], v[36:39]
ds_read_b128 a[0:3], v201 offset:0
buffer_load_dwordx4 a[168:171], v1, s[4:7], s52 offen offset:1024 sc1
v_mfma_f32_16x16x32_bf16 v[40:43], a[36:39], a[236:239], v[40:43]
ds_read_b128 a[4:7], v201 offset:1024
buffer_load_dwordx4 a[172:175], v9, s[4:7], s52 offen offset:1024 sc1
v_mfma_f32_16x16x32_bf16 v[44:47], a[40:43], a[232:235], v[44:47]
ds_read_b128 a[8:11], v201 offset:2048
v_mfma_f32_16x16x32_bf16 v[48:51], a[40:43], a[236:239], v[48:51]
ds_read_b128 a[12:15], v201 offset:3072
v_mfma_f32_16x16x32_bf16 v[52:55], a[44:47], a[232:235], v[52:55]
ds_read_b128 a[16:19], v201 offset:4096
v_mfma_f32_16x16x32_bf16 v[56:59], a[44:47], a[236:239], v[56:59]
ds_read_b128 a[20:23], v201 offset:5120
v_mfma_f32_16x16x32_bf16 v[60:63], a[48:51], a[232:235], v[60:63]
ds_read_b128 a[24:27], v201 offset:6144
v_mfma_f32_16x16x32_bf16 v[64:67], a[48:51], a[236:239], v[64:67]
ds_read_b128 a[28:31], v201 offset:7168
v_mfma_f32_16x16x32_bf16 v[68:71], a[52:55], a[232:235], v[68:71]
ds_read_b128 a[32:35], v201 offset:8192
v_mfma_f32_16x16x32_bf16 v[72:75], a[52:55], a[236:239], v[72:75]
s_cmp_eq_u32 s25, 3
s_cselect_b32 s99, 36864, 0
s_add_u32 s60, s60, s99
v_mfma_f32_16x16x32_bf16 v[76:79], a[56:59], a[232:235], v[76:79]
s_add_u32 s61, s61, s99
s_add_u32 m0, s62, 53248
v_mfma_f32_16x16x32_bf16 v[80:83], a[56:59], a[236:239], v[80:83]
s_add_u32 s60, s60, 16384
v_exp_f32 v199, v199
v_mfma_f32_16x16x32_bf16 v[84:87], a[60:63], a[232:235], v[84:87]
v_fma_f32 v196, v196, v255, v255
v_fma_f32 v197, v197, v255, v255
v_mfma_f32_16x16x32_bf16 v[88:91], a[60:63], a[236:239], v[88:91]
buffer_load_dwordx4 v1, s[8:11], s60 offen offset:0 sc1 lds
v_fma_f32 v198, v198, v255, v255
v_mfma_f32_16x16x32_bf16 v[92:95], a[64:67], a[232:235], v[92:95]
v_fma_f32 v199, v199, v255, v255
v_mfma_f32_16x16x32_bf16 v[96:99], a[64:67], a[236:239], v[96:99]
buffer_load_dwordx4 v1, s[8:11], s60 offen offset:1024 sc1 lds
v_mfma_f32_16x16x32_bf16 v[100:103], a[68:71], a[232:235], v[100:103]
v_rcp_f32 v196, v196
v_mfma_f32_16x16x32_bf16 v[104:107], a[68:71], a[236:239], v[104:107]
s_waitcnt lgkmcnt(0)
v_mfma_f32_16x16x32_bf16 v[36:39], a[0:3], a[240:243], v[36:39]
ds_read_b128 a[36:39], v201 offset:9216
buffer_load_dwordx4 v1, s[8:11], s60 offen offset:2048 sc1 lds
v_mfma_f32_16x16x32_bf16 v[40:43], a[0:3], a[244:247], v[40:43]
ds_read_b128 a[40:43], v201 offset:10240
v_mfma_f32_16x16x32_bf16 v[44:47], a[4:7], a[240:243], v[44:47]
ds_read_b128 a[44:47], v201 offset:11264
buffer_load_dwordx4 v1, s[8:11], s60 offen offset:3072 sc1 lds
v_mfma_f32_16x16x32_bf16 v[48:51], a[4:7], a[244:247], v[48:51]
ds_read_b128 a[48:51], v201 offset:12288
v_mfma_f32_16x16x32_bf16 v[52:55], a[8:11], a[240:243], v[52:55]
ds_read_b128 a[52:55], v201 offset:13312
s_add_u32 m0, s63, 69632
v_mfma_f32_16x16x32_bf16 v[56:59], a[8:11], a[244:247], v[56:59]
ds_read_b128 a[56:59], v201 offset:14336
v_mfma_f32_16x16x32_bf16 v[60:63], a[12:15], a[240:243], v[60:63]
ds_read_b128 a[60:63], v201 offset:15360
s_add_u32 s61, s61, 36864
v_mfma_f32_16x16x32_bf16 v[64:67], a[12:15], a[244:247], v[64:67]
ds_read_b128 a[64:67], v201 offset:16384
v_mfma_f32_16x16x32_bf16 v[68:71], a[16:19], a[240:243], v[68:71]
ds_read_b128 a[68:71], v201 offset:17408
buffer_load_dwordx4 v1, s[8:11], s61 offen offset:0 sc1 lds
v_mfma_f32_16x16x32_bf16 v[72:75], a[16:19], a[244:247], v[72:75]
s_add_u32 m0, s62, 73728
v_rcp_f32 v197, v197
v_mfma_f32_16x16x32_bf16 v[76:79], a[20:23], a[240:243], v[76:79]
s_add_u32 s60, s60, 20480
v_rcp_f32 v198, v198
v_mfma_f32_16x16x32_bf16 v[80:83], a[20:23], a[244:247], v[80:83]
v_rcp_f32 v199, v199
v_mfma_f32_16x16x32_bf16 v[84:87], a[24:27], a[240:243], v[84:87]
v_mfma_f32_16x16x32_bf16 v[88:91], a[24:27], a[244:247], v[88:91]
v_mfma_f32_16x16x32_bf16 v[92:95], a[28:31], a[240:243], v[92:95]
buffer_load_dwordx4 v1, s[8:11], s60 offen offset:0 sc1 lds
v_mfma_f32_16x16x32_bf16 v[96:99], a[28:31], a[244:247], v[96:99]
v_mfma_f32_16x16x32_bf16 v[100:103], a[32:35], a[240:243], v[100:103]
v_mul_f32 v136, v136, v196
v_mfma_f32_16x16x32_bf16 v[104:107], a[32:35], a[244:247], v[104:107]
s_waitcnt vmcnt(23) lgkmcnt(0)
s_barrier
v_mfma_f32_16x16x32_bf16 v[36:39], a[36:39], a[248:251], v[36:39]
ds_read_b128 a[0:3], v201 offset:18432
buffer_load_dwordx4 v1, s[8:11], s60 offen offset:1024 sc1 lds
v_mfma_f32_16x16x32_bf16 v[40:43], a[36:39], a[252:255], v[40:43]
ds_read_b128 a[4:7], v201 offset:19456
v_mul_f32 v137, v137, v197
v_mfma_f32_16x16x32_bf16 v[44:47], a[40:43], a[248:251], v[44:47]
ds_read_b128 a[8:11], v201 offset:20480
v_mul_f32 v138, v138, v198
v_mfma_f32_16x16x32_bf16 v[48:51], a[40:43], a[252:255], v[48:51]
ds_read_b128 a[12:15], v201 offset:21504
v_mfma_f32_16x16x32_bf16 v[52:55], a[44:47], a[248:251], v[52:55]
ds_read_b128 a[16:19], v201 offset:22528
buffer_load_dwordx4 v1, s[8:11], s60 offen offset:2048 sc1 lds
v_mfma_f32_16x16x32_bf16 v[56:59], a[44:47], a[252:255], v[56:59]
ds_read_b128 a[20:23], v201 offset:23552
v_mul_f32 v139, v139, v199
v_mfma_f32_16x16x32_bf16 v[60:63], a[48:51], a[248:251], v[60:63]
ds_read_b128 a[24:27], v201 offset:24576
v_mfma_f32_16x16x32_bf16 v[64:67], a[48:51], a[252:255], v[64:67]
ds_read_b128 a[28:31], v201 offset:25600
v_mul_f32 v192, v140, v140
v_mfma_f32_16x16x32_bf16 v[68:71], a[52:55], a[248:251], v[68:71]
ds_read_b128 a[32:35], v201 offset:26624
buffer_load_dwordx4 v1, s[8:11], s60 offen offset:3072 sc1 lds
v_mfma_f32_16x16x32_bf16 v[72:75], a[52:55], a[252:255], v[72:75]
v_mfma_f32_16x16x32_bf16 v[76:79], a[56:59], a[248:251], v[76:79]
v_mul_f32 v193, v141, v141
v_mfma_f32_16x16x32_bf16 v[80:83], a[56:59], a[252:255], v[80:83]
v_mfma_f32_16x16x32_bf16 v[84:87], a[60:63], a[248:251], v[84:87]
buffer_load_dwordx4 a[176:179], v1, s[4:7], s52 offen offset:2048 sc1
v_mul_f32 v194, v142, v142
v_mfma_f32_16x16x32_bf16 v[88:91], a[60:63], a[252:255], v[88:91]
v_mfma_f32_16x16x32_bf16 v[92:95], a[64:67], a[248:251], v[92:95]
v_mul_f32 v195, v143, v143
v_mfma_f32_16x16x32_bf16 v[96:99], a[64:67], a[252:255], v[96:99]
v_mfma_f32_16x16x32_bf16 v[100:103], a[68:71], a[248:251], v[100:103]
v_mfma_f32_16x16x32_bf16 v[104:107], a[68:71], a[252:255], v[104:107]
v_fma_f32 v192, v192, v252, v250
s_waitcnt lgkmcnt(0)
v_mfma_f32_16x16x32_bf16 v[36:39], a[0:3], a[80:83], v[36:39]
ds_read_b128 a[36:39], v201 offset:27648
buffer_load_dwordx4 a[180:183], v9, s[4:7], s52 offen offset:2048 sc1
v_mfma_f32_16x16x32_bf16 v[40:43], a[0:3], a[84:87], v[40:43]
ds_read_b128 a[40:43], v201 offset:28672
v_fma_f32 v193, v193, v252, v250
v_mfma_f32_16x16x32_bf16 v[44:47], a[4:7], a[80:83], v[44:47]
ds_read_b128 a[44:47], v201 offset:29696
buffer_load_dwordx4 a[184:187], v1, s[4:7], s52 offen offset:3072 sc1
v_mfma_f32_16x16x32_bf16 v[48:51], a[4:7], a[84:87], v[48:51]
ds_read_b128 a[48:51], v201 offset:30720
v_fma_f32 v194, v194, v252, v250
v_mfma_f32_16x16x32_bf16 v[52:55], a[8:11], a[80:83], v[52:55]
ds_read_b128 a[52:55], v201 offset:31744
buffer_load_dwordx4 a[188:191], v9, s[4:7], s52 offen offset:3072 sc1
v_mfma_f32_16x16x32_bf16 v[56:59], a[8:11], a[84:87], v[56:59]
ds_read_b128 a[56:59], v201 offset:32768
v_mfma_f32_16x16x32_bf16 v[60:63], a[12:15], a[80:83], v[60:63]
ds_read_b128 a[60:63], v201 offset:33792
v_fma_f32 v195, v195, v252, v250
v_mfma_f32_16x16x32_bf16 v[64:67], a[12:15], a[84:87], v[64:67]
ds_read_b128 a[64:67], v201 offset:34816
v_mfma_f32_16x16x32_bf16 v[68:71], a[16:19], a[80:83], v[68:71]
ds_read_b128 a[68:71], v201 offset:35840
v_mul_f32 v192, v192, v140
v_mfma_f32_16x16x32_bf16 v[72:75], a[16:19], a[84:87], v[72:75]
s_cmp_eq_u32 s25, 5
s_cselect_b32 s98, 4096, 0
v_mfma_f32_16x16x32_bf16 v[76:79], a[20:23], a[80:83], v[76:79]
s_add_u32 s52, s52, s98
v_mul_f32 v193, v193, v141
v_mfma_f32_16x16x32_bf16 v[80:83], a[20:23], a[84:87], v[80:83]
s_add_u32 s52, s52, 4096
v_mfma_f32_16x16x32_bf16 v[84:87], a[24:27], a[80:83], v[84:87]
v_mfma_f32_16x16x32_bf16 v[88:91], a[24:27], a[84:87], v[88:91]
v_mul_f32 v194, v194, v142
v_mfma_f32_16x16x32_bf16 v[92:95], a[28:31], a[80:83], v[92:95]
buffer_load_dwordx4 a[192:195], v1, s[4:7], s52 offen offset:0 sc1
v_mfma_f32_16x16x32_bf16 v[96:99], a[28:31], a[84:87], v[96:99]
v_mul_f32 v195, v195, v143
v_mfma_f32_16x16x32_bf16 v[100:103], a[32:35], a[80:83], v[100:103]
v_mfma_f32_16x16x32_bf16 v[104:107], a[32:35], a[84:87], v[104:107]
s_waitcnt vmcnt(22) lgkmcnt(0)
s_barrier
v_mfma_f32_16x16x32_bf16 v[36:39], a[36:39], a[88:91], v[36:39]
ds_read_b128 a[0:3], v202 offset:0
buffer_load_dwordx4 a[196:199], v9, s[4:7], s52 offen offset:0 sc1
v_mfma_f32_16x16x32_bf16 v[40:43], a[36:39], a[92:95], v[40:43]
ds_read_b128 a[4:7], v202 offset:1024
buffer_load_dwordx4 a[200:203], v1, s[4:7], s52 offen offset:1024 sc1
v_mfma_f32_16x16x32_bf16 v[44:47], a[40:43], a[88:91], v[44:47]
ds_read_b128 a[8:11], v202 offset:2048
v_mfma_f32_16x16x32_bf16 v[48:51], a[40:43], a[92:95], v[48:51]
ds_read_b128 a[12:15], v202 offset:3072
buffer_load_dwordx4 a[204:207], v9, s[4:7], s52 offen offset:1024 sc1
v_mfma_f32_16x16x32_bf16 v[52:55], a[44:47], a[88:91], v[52:55]
ds_read_b128 a[16:19], v202 offset:4096
v_mfma_f32_16x16x32_bf16 v[56:59], a[44:47], a[92:95], v[56:59]
ds_read_b128 a[20:23], v202 offset:5120
v_mfma_f32_16x16x32_bf16 v[60:63], a[48:51], a[88:91], v[60:63]
ds_read_b128 a[24:27], v202 offset:6144
v_mfma_f32_16x16x32_bf16 v[64:67], a[48:51], a[92:95], v[64:67]
ds_read_b128 a[28:31], v202 offset:7168
v_mfma_f32_16x16x32_bf16 v[68:71], a[52:55], a[88:91], v[68:71]
ds_read_b128 a[32:35], v202 offset:8192
v_mfma_f32_16x16x32_bf16 v[72:75], a[52:55], a[92:95], v[72:75]
s_cmp_eq_u32 s25, 4
s_cselect_b32 s99, 36864, 0
s_add_u32 s60, s60, s99
v_mfma_f32_16x16x32_bf16 v[76:79], a[56:59], a[88:91], v[76:79]
s_add_u32 s61, s61, s99
v_exp_f32 v192, v192
v_mfma_f32_16x16x32_bf16 v[80:83], a[56:59], a[92:95], v[80:83]
s_add_u32 m0, s62, 90112
v_exp_f32 v193, v193
v_mfma_f32_16x16x32_bf16 v[84:87], a[60:63], a[88:91], v[84:87]
s_add_u32 s60, s60, 16384
v_exp_f32 v194, v194
v_mfma_f32_16x16x32_bf16 v[88:91], a[60:63], a[92:95], v[88:91]
v_mfma_f32_16x16x32_bf16 v[92:95], a[64:67], a[88:91], v[92:95]
v_exp_f32 v195, v195
v_mfma_f32_16x16x32_bf16 v[96:99], a[64:67], a[92:95], v[96:99]
buffer_load_dwordx4 v1, s[8:11], s60 offen offset:0 sc1 lds
v_mfma_f32_16x16x32_bf16 v[100:103], a[68:71], a[88:91], v[100:103]
v_mfma_f32_16x16x32_bf16 v[104:107], a[68:71], a[92:95], v[104:107]
s_waitcnt lgkmcnt(0)
v_mfma_f32_16x16x32_bf16 v[36:39], a[0:3], a[96:99], v[36:39]
ds_read_b128 a[36:39], v202 offset:9216
buffer_load_dwordx4 v1, s[8:11], s60 offen offset:1024 sc1 lds
v_mfma_f32_16x16x32_bf16 v[40:43], a[0:3], a[100:103], v[40:43]
ds_read_b128 a[40:43], v202 offset:10240
v_fma_f32 v192, v192, v254, v254
v_mfma_f32_16x16x32_bf16 v[44:47], a[4:7], a[96:99], v[44:47]
ds_read_b128 a[44:47], v202 offset:11264
buffer_load_dwordx4 v1, s[8:11], s60 offen offset:2048 sc1 lds
v_mfma_f32_16x16x32_bf16 v[48:51], a[4:7], a[100:103], v[48:51]
ds_read_b128 a[48:51], v202 offset:12288
v_fma_f32 v193, v193, v254, v254
v_mfma_f32_16x16x32_bf16 v[52:55], a[8:11], a[96:99], v[52:55]
ds_read_b128 a[52:55], v202 offset:13312
v_mfma_f32_16x16x32_bf16 v[56:59], a[8:11], a[100:103], v[56:59]
ds_read_b128 a[56:59], v202 offset:14336
buffer_load_dwordx4 v1, s[8:11], s60 offen offset:3072 sc1 lds
v_mfma_f32_16x16x32_bf16 v[60:63], a[12:15], a[96:99], v[60:63]
ds_read_b128 a[60:63], v202 offset:15360
v_fma_f32 v194, v194, v254, v254
v_mfma_f32_16x16x32_bf16 v[64:67], a[12:15], a[100:103], v[64:67]
ds_read_b128 a[64:67], v202 offset:16384
v_fma_f32 v195, v195, v254, v254
v_mfma_f32_16x16x32_bf16 v[68:71], a[16:19], a[96:99], v[68:71]
ds_read_b128 a[68:71], v202 offset:17408
s_add_u32 m0, s63, 106496
v_mfma_f32_16x16x32_bf16 v[72:75], a[16:19], a[100:103], v[72:75]
s_add_u32 s61, s61, 36864
v_mfma_f32_16x16x32_bf16 v[76:79], a[20:23], a[96:99], v[76:79]
v_rcp_f32 v192, v192
v_mfma_f32_16x16x32_bf16 v[80:83], a[20:23], a[100:103], v[80:83]
v_mfma_f32_16x16x32_bf16 v[84:87], a[24:27], a[96:99], v[84:87]
v_mfma_f32_16x16x32_bf16 v[88:91], a[24:27], a[100:103], v[88:91]
v_mfma_f32_16x16x32_bf16 v[92:95], a[28:31], a[96:99], v[92:95]
buffer_load_dwordx4 v1, s[8:11], s61 offen offset:0 sc1 lds
v_mfma_f32_16x16x32_bf16 v[96:99], a[28:31], a[100:103], v[96:99]
v_rcp_f32 v193, v193
v_mfma_f32_16x16x32_bf16 v[100:103], a[32:35], a[96:99], v[100:103]
v_mfma_f32_16x16x32_bf16 v[104:107], a[32:35], a[100:103], v[104:107]
s_waitcnt lgkmcnt(0)
v_mfma_f32_16x16x32_bf16 v[36:39], a[36:39], a[104:107], v[36:39]
ds_read_b128 a[0:3], v202 offset:18432
s_add_u32 m0, s62, 110592
v_mfma_f32_16x16x32_bf16 v[40:43], a[36:39], a[108:111], v[40:43]
ds_read_b128 a[4:7], v202 offset:19456
v_mfma_f32_16x16x32_bf16 v[44:47], a[40:43], a[104:107], v[44:47]
ds_read_b128 a[8:11], v202 offset:20480
s_add_u32 s60, s60, 20480
v_mfma_f32_16x16x32_bf16 v[48:51], a[40:43], a[108:111], v[48:51]
ds_read_b128 a[12:15], v202 offset:21504
v_mfma_f32_16x16x32_bf16 v[52:55], a[44:47], a[104:107], v[52:55]
ds_read_b128 a[16:19], v202 offset:22528
v_mfma_f32_16x16x32_bf16 v[56:59], a[44:47], a[108:111], v[56:59]
ds_read_b128 a[20:23], v202 offset:23552
buffer_load_dwordx4 v1, s[8:11], s60 offen offset:0 sc1 lds
v_mfma_f32_16x16x32_bf16 v[60:63], a[48:51], a[104:107], v[60:63]
ds_read_b128 a[24:27], v202 offset:24576
v_mfma_f32_16x16x32_bf16 v[64:67], a[48:51], a[108:111], v[64:67]
ds_read_b128 a[28:31], v202 offset:25600
v_mfma_f32_16x16x32_bf16 v[68:71], a[52:55], a[104:107], v[68:71]
ds_read_b128 a[32:35], v202 offset:26624
buffer_load_dwordx4 v1, s[8:11], s60 offen offset:1024 sc1 lds
v_mfma_f32_16x16x32_bf16 v[72:75], a[52:55], a[108:111], v[72:75]
v_rcp_f32 v194, v194
v_mfma_f32_16x16x32_bf16 v[76:79], a[56:59], a[104:107], v[76:79]
v_rcp_f32 v195, v195
v_mfma_f32_16x16x32_bf16 v[80:83], a[56:59], a[108:111], v[80:83]
buffer_load_dwordx4 v1, s[8:11], s60 offen offset:2048 sc1 lds
v_mul_f32 v140, v140, v192
v_mfma_f32_16x16x32_bf16 v[84:87], a[60:63], a[104:107], v[84:87]
v_mfma_f32_16x16x32_bf16 v[88:91], a[60:63], a[108:111], v[88:91]
v_mul_f32 v141, v141, v193
v_mfma_f32_16x16x32_bf16 v[92:95], a[64:67], a[104:107], v[92:95]
buffer_load_dwordx4 v1, s[8:11], s60 offen offset:3072 sc1 lds
v_mfma_f32_16x16x32_bf16 v[96:99], a[64:67], a[108:111], v[96:99]
v_mul_f32 v142, v142, v194
v_mfma_f32_16x16x32_bf16 v[100:103], a[68:71], a[104:107], v[100:103]
v_mfma_f32_16x16x32_bf16 v[104:107], a[68:71], a[108:111], v[104:107]
s_waitcnt lgkmcnt(0)
v_mfma_f32_16x16x32_bf16 v[36:39], a[0:3], a[112:115], v[36:39]
ds_read_b128 a[36:39], v202 offset:27648
buffer_load_dwordx4 a[208:211], v1, s[4:7], s52 offen offset:2048 sc1
v_mfma_f32_16x16x32_bf16 v[40:43], a[0:3], a[116:119], v[40:43]
ds_read_b128 a[40:43], v202 offset:28672
s_mov_b32 s37, L_c4+8192-L_pc
v_mfma_f32_16x16x32_bf16 v[44:47], a[4:7], a[112:115], v[44:47]
ds_read_b128 a[44:47], v202 offset:29696
v_mul_f32 v143, v143, v195
v_mfma_f32_16x16x32_bf16 v[48:51], a[4:7], a[116:119], v[48:51]
ds_read_b128 a[48:51], v202 offset:30720
v_mul_f32 v196, v144, v144
v_mfma_f32_16x16x32_bf16 v[52:55], a[8:11], a[112:115], v[52:55]
ds_read_b128 a[52:55], v202 offset:31744
buffer_load_dwordx4 a[212:215], v9, s[4:7], s52 offen offset:2048 sc1
v_mfma_f32_16x16x32_bf16 v[56:59], a[8:11], a[116:119], v[56:59]
ds_read_b128 a[56:59], v202 offset:32768
buffer_load_dword v15, v14, s[88:91], s37 offen
v_mfma_f32_16x16x32_bf16 v[60:63], a[12:15], a[112:115], v[60:63]
ds_read_b128 a[60:63], v202 offset:33792
v_mul_f32 v197, v145, v145
v_mfma_f32_16x16x32_bf16 v[64:67], a[12:15], a[116:119], v[64:67]
ds_read_b128 a[64:67], v202 offset:34816
v_mul_f32 v198, v146, v146
v_mfma_f32_16x16x32_bf16 v[68:71], a[16:19], a[112:115], v[68:71]
ds_read_b128 a[68:71], v202 offset:35840
buffer_load_dwordx4 a[216:219], v1, s[4:7], s52 offen offset:3072 sc1
v_mfma_f32_16x16x32_bf16 v[72:75], a[16:19], a[116:119], v[72:75]
v_mul_f32 v199, v147, v147
v_mfma_f32_16x16x32_bf16 v[76:79], a[20:23], a[112:115], v[76:79]
v_mfma_f32_16x16x32_bf16 v[80:83], a[20:23], a[116:119], v[80:83]
v_fma_f32 v196, v196, v253, v251
v_mfma_f32_16x16x32_bf16 v[84:87], a[24:27], a[112:115], v[84:87]
buffer_load_dwordx4 a[220:223], v9, s[4:7], s52 offen offset:3072 sc1
v_mfma_f32_16x16x32_bf16 v[88:91], a[24:27], a[116:119], v[88:91]
v_mfma_f32_16x16x32_bf16 v[92:95], a[28:31], a[112:115], v[92:95]
v_fma_f32 v197, v197, v253, v251
v_mfma_f32_16x16x32_bf16 v[96:99], a[28:31], a[116:119], v[96:99]
v_mfma_f32_16x16x32_bf16 v[100:103], a[32:35], a[112:115], v[100:103]
v_fma_f32 v198, v198, v253, v251
v_mfma_f32_16x16x32_bf16 v[104:107], a[32:35], a[116:119], v[104:107]
s_waitcnt vmcnt(22) lgkmcnt(0)
s_barrier
v_mfma_f32_16x16x32_bf16 v[36:39], a[36:39], a[120:123], v[36:39]
ds_read_b128 a[0:3], v200 offset:0
v_mfma_f32_16x16x32_bf16 v[40:43], a[36:39], a[124:127], v[40:43]
ds_read_b128 a[4:7], v200 offset:1024
v_fma_f32 v199, v199, v253, v251
v_mfma_f32_16x16x32_bf16 v[44:47], a[40:43], a[120:123], v[44:47]
ds_read_b128 a[8:11], v200 offset:2048
v_mfma_f32_16x16x32_bf16 v[48:51], a[40:43], a[124:127], v[48:51]
ds_read_b128 a[12:15], v200 offset:3072
v_mul_f32 v196, v196, v144
v_mfma_f32_16x16x32_bf16 v[52:55], a[44:47], a[120:123], v[52:55]
ds_read_b128 a[16:19], v200 offset:4096
v_mfma_f32_16x16x32_bf16 v[56:59], a[44:47], a[124:127], v[56:59]
ds_read_b128 a[20:23], v200 offset:5120
v_mul_f32 v197, v197, v145
v_mfma_f32_16x16x32_bf16 v[60:63], a[48:51], a[120:123], v[60:63]
ds_read_b128 a[24:27], v200 offset:6144
v_mfma_f32_16x16x32_bf16 v[64:67], a[48:51], a[124:127], v[64:67]
ds_read_b128 a[28:31], v200 offset:7168
v_mfma_f32_16x16x32_bf16 v[68:71], a[52:55], a[120:123], v[68:71]
ds_read_b128 a[32:35], v200 offset:8192
v_mul_f32 v198, v198, v146
v_mfma_f32_16x16x32_bf16 v[72:75], a[52:55], a[124:127], v[72:75]
s_cmp_eq_u32 s25, 5
s_cselect_b32 s99, 36864, 0
s_add_u32 s60, s60, s99
v_mfma_f32_16x16x32_bf16 v[76:79], a[56:59], a[120:123], v[76:79]
s_add_u32 s61, s61, s99
s_add_u32 m0, s62, 126976
s_add_u32 s60, s60, 16384
v_mfma_f32_16x16x32_bf16 v[80:83], a[56:59], a[124:127], v[80:83]
buffer_load_dwordx4 v1, s[8:11], s60 offen offset:0 sc1 lds
v_mul_f32 v199, v199, v147
v_mfma_f32_16x16x32_bf16 v[84:87], a[60:63], a[120:123], v[84:87]
buffer_load_dwordx4 v1, s[8:11], s60 offen offset:1024 sc1 lds
v_mfma_f32_16x16x32_bf16 v[88:91], a[60:63], a[124:127], v[88:91]
buffer_load_dwordx4 v1, s[8:11], s60 offen offset:2048 sc1 lds
v_mfma_f32_16x16x32_bf16 v[92:95], a[64:67], a[120:123], v[92:95]
v_exp_f32 v196, v196
v_mfma_f32_16x16x32_bf16 v[96:99], a[64:67], a[124:127], v[96:99]
buffer_load_dwordx4 v1, s[8:11], s60 offen offset:3072 sc1 lds
v_mfma_f32_16x16x32_bf16 v[100:103], a[68:71], a[120:123], v[100:103]
v_mfma_f32_16x16x32_bf16 v[104:107], a[68:71], a[124:127], v[104:107]
s_waitcnt lgkmcnt(0)
v_mfma_f32_16x16x32_bf16 v[36:39], a[0:3], a[128:131], v[36:39]
ds_read_b128 a[36:39], v200 offset:9216
s_add_u32 m0, s63, 143360
v_mfma_f32_16x16x32_bf16 v[40:43], a[0:3], a[132:135], v[40:43]
ds_read_b128 a[40:43], v200 offset:10240
v_mfma_f32_16x16x32_bf16 v[44:47], a[4:7], a[128:131], v[44:47]
ds_read_b128 a[44:47], v200 offset:11264
s_add_u32 s61, s61, 36864
v_mfma_f32_16x16x32_bf16 v[48:51], a[4:7], a[132:135], v[48:51]
ds_read_b128 a[48:51], v200 offset:12288
v_mfma_f32_16x16x32_bf16 v[52:55], a[8:11], a[128:131], v[52:55]
ds_read_b128 a[52:55], v200 offset:13312
buffer_load_dwordx4 v1, s[8:11], s61 offen offset:0 sc1 lds
v_mfma_f32_16x16x32_bf16 v[56:59], a[8:11], a[132:135], v[56:59]
ds_read_b128 a[56:59], v200 offset:14336
v_mfma_f32_16x16x32_bf16 v[60:63], a[12:15], a[128:131], v[60:63]
ds_read_b128 a[60:63], v200 offset:15360
s_add_u32 m0, s62, 147456
v_mfma_f32_16x16x32_bf16 v[64:67], a[12:15], a[132:135], v[64:67]
ds_read_b128 a[64:67], v200 offset:16384
v_mfma_f32_16x16x32_bf16 v[68:71], a[16:19], a[128:131], v[68:71]
ds_read_b128 a[68:71], v200 offset:17408
s_add_u32 s60, s60, 20480
v_mfma_f32_16x16x32_bf16 v[72:75], a[16:19], a[132:135], v[72:75]
v_exp_f32 v197, v197
v_mfma_f32_16x16x32_bf16 v[76:79], a[20:23], a[128:131], v[76:79]
buffer_load_dwordx4 v1, s[8:11], s60 offen offset:0 sc1 lds
v_mfma_f32_16x16x32_bf16 v[80:83], a[20:23], a[132:135], v[80:83]
v_exp_f32 v198, v198
v_mfma_f32_16x16x32_bf16 v[84:87], a[24:27], a[128:131], v[84:87]
buffer_load_dwordx4 v1, s[8:11], s60 offen offset:1024 sc1 lds
v_mfma_f32_16x16x32_bf16 v[88:91], a[24:27], a[132:135], v[88:91]
v_exp_f32 v199, v199
v_mfma_f32_16x16x32_bf16 v[92:95], a[28:31], a[128:131], v[92:95]
buffer_load_dwordx4 v1, s[8:11], s60 offen offset:2048 sc1 lds
v_fma_f32 v196, v196, v255, v255
v_mfma_f32_16x16x32_bf16 v[96:99], a[28:31], a[132:135], v[96:99]
v_mfma_f32_16x16x32_bf16 v[100:103], a[32:35], a[128:131], v[100:103]
v_fma_f32 v197, v197, v255, v255
v_mfma_f32_16x16x32_bf16 v[104:107], a[32:35], a[132:135], v[104:107]
s_waitcnt lgkmcnt(0)
v_mfma_f32_16x16x32_bf16 v[36:39], a[36:39], a[136:139], v[36:39]
ds_read_b128 a[0:3], v200 offset:18432
buffer_load_dwordx4 v1, s[8:11], s60 offen offset:3072 sc1 lds
v_mfma_f32_16x16x32_bf16 v[40:43], a[36:39], a[140:143], v[40:43]
ds_read_b128 a[4:7], v200 offset:19456
v_fma_f32 v198, v198, v255, v255
v_mfma_f32_16x16x32_bf16 v[44:47], a[40:43], a[136:139], v[44:47]
ds_read_b128 a[8:11], v200 offset:20480
v_fma_f32 v199, v199, v255, v255
v_mfma_f32_16x16x32_bf16 v[48:51], a[40:43], a[140:143], v[48:51]
ds_read_b128 a[12:15], v200 offset:21504
v_mfma_f32_16x16x32_bf16 v[52:55], a[44:47], a[136:139], v[52:55]
ds_read_b128 a[16:19], v200 offset:22528
v_mfma_f32_16x16x32_bf16 v[56:59], a[44:47], a[140:143], v[56:59]
ds_read_b128 a[20:23], v200 offset:23552
v_mfma_f32_16x16x32_bf16 v[60:63], a[48:51], a[136:139], v[60:63]
ds_read_b128 a[24:27], v200 offset:24576
v_mfma_f32_16x16x32_bf16 v[64:67], a[48:51], a[140:143], v[64:67]
ds_read_b128 a[28:31], v200 offset:25600
v_mfma_f32_16x16x32_bf16 v[68:71], a[52:55], a[136:139], v[68:71]
ds_read_b128 a[32:35], v200 offset:26624
v_mfma_f32_16x16x32_bf16 v[72:75], a[52:55], a[140:143], v[72:75]
s_cmp_eq_u32 s25, 6
s_cselect_b32 s98, 4096, 0
s_add_u32 s52, s52, s98
v_mfma_f32_16x16x32_bf16 v[76:79], a[56:59], a[136:139], v[76:79]
s_add_u32 s52, s52, 4096
v_rcp_f32 v196, v196
v_mfma_f32_16x16x32_bf16 v[80:83], a[56:59], a[140:143], v[80:83]
buffer_load_dwordx4 a[224:227], v1, s[4:7], s52 offen offset:0 sc1
v_mfma_f32_16x16x32_bf16 v[84:87], a[60:63], a[136:139], v[84:87]
buffer_load_dwordx4 a[228:231], v9, s[4:7], s52 offen offset:0 sc1
v_mfma_f32_16x16x32_bf16 v[88:91], a[60:63], a[140:143], v[88:91]
v_rcp_f32 v197, v197
v_mfma_f32_16x16x32_bf16 v[92:95], a[64:67], a[136:139], v[92:95]
buffer_load_dwordx4 a[232:235], v1, s[4:7], s52 offen offset:1024 sc1
v_mfma_f32_16x16x32_bf16 v[96:99], a[64:67], a[140:143], v[96:99]
v_rcp_f32 v198, v198
v_mfma_f32_16x16x32_bf16 v[100:103], a[68:71], a[136:139], v[100:103]
v_mfma_f32_16x16x32_bf16 v[104:107], a[68:71], a[140:143], v[104:107]
s_waitcnt lgkmcnt(0)
v_mfma_f32_16x16x32_bf16 v[36:39], a[0:3], a[144:147], v[36:39]
ds_read_b128 a[36:39], v200 offset:27648
buffer_load_dwordx4 a[236:239], v9, s[4:7], s52 offen offset:1024 sc1
v_mfma_f32_16x16x32_bf16 v[40:43], a[0:3], a[148:151], v[40:43]
ds_read_b128 a[40:43], v200 offset:28672
v_mfma_f32_16x16x32_bf16 v[44:47], a[4:7], a[144:147], v[44:47]
ds_read_b128 a[44:47], v200 offset:29696
v_mfma_f32_16x16x32_bf16 v[48:51], a[4:7], a[148:151], v[48:51]
ds_read_b128 a[48:51], v200 offset:30720
v_mfma_f32_16x16x32_bf16 v[52:55], a[8:11], a[144:147], v[52:55]
ds_read_b128 a[52:55], v200 offset:31744
buffer_load_dwordx4 a[240:243], v1, s[4:7], s52 offen offset:2048 sc1
v_mfma_f32_16x16x32_bf16 v[56:59], a[8:11], a[148:151], v[56:59]
ds_read_b128 a[56:59], v200 offset:32768
v_mfma_f32_16x16x32_bf16 v[60:63], a[12:15], a[144:147], v[60:63]
ds_read_b128 a[60:63], v200 offset:33792
v_mfma_f32_16x16x32_bf16 v[64:67], a[12:15], a[148:151], v[64:67]
ds_read_b128 a[64:67], v200 offset:34816
v_mfma_f32_16x16x32_bf16 v[68:71], a[16:19], a[144:147], v[68:71]
ds_read_b128 a[68:71], v200 offset:35840
buffer_load_dwordx4 a[244:247], v9, s[4:7], s52 offen offset:2048 sc1
v_mfma_f32_16x16x32_bf16 v[72:75], a[16:19], a[148:151], v[72:75]
v_rcp_f32 v199, v199
v_mfma_f32_16x16x32_bf16 v[76:79], a[20:23], a[144:147], v[76:79]
v_mul_f32 v144, v144, v196
v_mul_f32 v145, v145, v197
v_mfma_f32_16x16x32_bf16 v[80:83], a[20:23], a[148:151], v[80:83]
v_mul_f32 v146, v146, v198
v_mfma_f32_16x16x32_bf16 v[84:87], a[24:27], a[144:147], v[84:87]
buffer_load_dwordx4 a[248:251], v1, s[4:7], s52 offen offset:3072 sc1
v_mfma_f32_16x16x32_bf16 v[88:91], a[24:27], a[148:151], v[88:91]
v_mul_f32 v147, v147, v199
v_mfma_f32_16x16x32_bf16 v[92:95], a[28:31], a[144:147], v[92:95]
v_mfma_f32_16x16x32_bf16 v[96:99], a[28:31], a[148:151], v[96:99]
v_mul_f32 v192, v148, v148
v_mfma_f32_16x16x32_bf16 v[100:103], a[32:35], a[144:147], v[100:103]
v_mfma_f32_16x16x32_bf16 v[104:107], a[32:35], a[148:151], v[104:107]
s_waitcnt vmcnt(21) lgkmcnt(0)
s_barrier
v_mfma_f32_16x16x32_bf16 v[36:39], a[36:39], a[152:155], v[36:39]
ds_read_b128 a[0:3], v201 offset:0
buffer_load_dwordx4 a[252:255], v9, s[4:7], s52 offen offset:3072 sc1
v_mfma_f32_16x16x32_bf16 v[40:43], a[36:39], a[156:159], v[40:43]
ds_read_b128 a[4:7], v201 offset:1024
v_mul_f32 v193, v149, v149
v_mfma_f32_16x16x32_bf16 v[44:47], a[40:43], a[152:155], v[44:47]
ds_read_b128 a[8:11], v201 offset:2048
v_mul_f32 v194, v150, v150
v_mfma_f32_16x16x32_bf16 v[48:51], a[40:43], a[156:159], v[48:51]
ds_read_b128 a[12:15], v201 offset:3072
v_mfma_f32_16x16x32_bf16 v[52:55], a[44:47], a[152:155], v[52:55]
ds_read_b128 a[16:19], v201 offset:4096
v_mul_f32 v195, v151, v151
v_mfma_f32_16x16x32_bf16 v[56:59], a[44:47], a[156:159], v[56:59]
ds_read_b128 a[20:23], v201 offset:5120
v_mfma_f32_16x16x32_bf16 v[60:63], a[48:51], a[152:155], v[60:63]
ds_read_b128 a[24:27], v201 offset:6144
v_fma_f32 v192, v192, v252, v250
v_mfma_f32_16x16x32_bf16 v[64:67], a[48:51], a[156:159], v[64:67]
ds_read_b128 a[28:31], v201 offset:7168
v_mfma_f32_16x16x32_bf16 v[68:71], a[52:55], a[152:155], v[68:71]
ds_read_b128 a[32:35], v201 offset:8192
v_mfma_f32_16x16x32_bf16 v[72:75], a[52:55], a[156:159], v[72:75]
s_cmp_eq_u32 s25, 6
s_cselect_b32 s99, 36864, 0
s_add_u32 s60, s60, s99
v_mfma_f32_16x16x32_bf16 v[76:79], a[56:59], a[152:155], v[76:79]
s_add_u32 s61, s61, s99
s_add_u32 m0, s62, 53248
s_add_u32 s60, s60, 16384
v_mfma_f32_16x16x32_bf16 v[80:83], a[56:59], a[156:159], v[80:83]
buffer_load_dwordx4 v1, s[8:11], s60 offen offset:0 sc1 lds
v_fma_f32 v193, v193, v252, v250
v_mfma_f32_16x16x32_bf16 v[84:87], a[60:63], a[152:155], v[84:87]
v_fma_f32 v194, v194, v252, v250
v_mfma_f32_16x16x32_bf16 v[88:91], a[60:63], a[156:159], v[88:91]
buffer_load_dwordx4 v1, s[8:11], s60 offen offset:1024 sc1 lds
v_fma_f32 v195, v195, v252, v250
v_mfma_f32_16x16x32_bf16 v[92:95], a[64:67], a[152:155], v[92:95]
v_mfma_f32_16x16x32_bf16 v[96:99], a[64:67], a[156:159], v[96:99]
buffer_load_dwordx4 v1, s[8:11], s60 offen offset:2048 sc1 lds
v_mfma_f32_16x16x32_bf16 v[100:103], a[68:71], a[152:155], v[100:103]
v_mul_f32 v192, v192, v148
v_mfma_f32_16x16x32_bf16 v[104:107], a[68:71], a[156:159], v[104:107]
s_waitcnt lgkmcnt(0)
v_mfma_f32_16x16x32_bf16 v[36:39], a[0:3], a[160:163], v[36:39]
ds_read_b128 a[36:39], v201 offset:9216
buffer_load_dwordx4 v1, s[8:11], s60 offen offset:3072 sc1 lds
v_mfma_f32_16x16x32_bf16 v[40:43], a[0:3], a[164:167], v[40:43]
ds_read_b128 a[40:43], v201 offset:10240
v_mul_f32 v193, v193, v149
v_mfma_f32_16x16x32_bf16 v[44:47], a[4:7], a[160:163], v[44:47]
ds_read_b128 a[44:47], v201 offset:11264
s_add_u32 m0, s63, 69632
v_mfma_f32_16x16x32_bf16 v[48:51], a[4:7], a[164:167], v[48:51]
ds_read_b128 a[48:51], v201 offset:12288
v_mul_f32 v194, v194, v150
v_mfma_f32_16x16x32_bf16 v[52:55], a[8:11], a[160:163], v[52:55]
ds_read_b128 a[52:55], v201 offset:13312
s_add_u32 s61, s61, 36864
v_mfma_f32_16x16x32_bf16 v[56:59], a[8:11], a[164:167], v[56:59]
ds_read_b128 a[56:59], v201 offset:14336
v_mul_f32 v195, v195, v151
v_mfma_f32_16x16x32_bf16 v[60:63], a[12:15], a[160:163], v[60:63]
ds_read_b128 a[60:63], v201 offset:15360
buffer_load_dwordx4 v1, s[8:11], s61 offen offset:0 sc1 lds
v_mfma_f32_16x16x32_bf16 v[64:67], a[12:15], a[164:167], v[64:67]
ds_read_b128 a[64:67], v201 offset:16384
v_mfma_f32_16x16x32_bf16 v[68:71], a[16:19], a[160:163], v[68:71]
ds_read_b128 a[68:71], v201 offset:17408
s_add_u32 m0, s62, 73728
v_mfma_f32_16x16x32_bf16 v[72:75], a[16:19], a[164:167], v[72:75]
s_add_u32 s60, s60, 20480
v_exp_f32 v192, v192
v_mfma_f32_16x16x32_bf16 v[76:79], a[20:23], a[160:163], v[76:79]
v_mfma_f32_16x16x32_bf16 v[80:83], a[20:23], a[164:167], v[80:83]
v_mfma_f32_16x16x32_bf16 v[84:87], a[24:27], a[160:163], v[84:87]
buffer_load_dwordx4 v1, s[8:11], s60 offen offset:0 sc1 lds
v_mfma_f32_16x16x32_bf16 v[88:91], a[24:27], a[164:167], v[88:91]
v_exp_f32 v193, v193
v_mfma_f32_16x16x32_bf16 v[92:95], a[28:31], a[160:163], v[92:95]
buffer_load_dwordx4 v1, s[8:11], s60 offen offset:1024 sc1 lds
v_mfma_f32_16x16x32_bf16 v[96:99], a[28:31], a[164:167], v[96:99]
v_mfma_f32_16x16x32_bf16 v[100:103], a[32:35], a[160:163], v[100:103]
v_mfma_f32_16x16x32_bf16 v[104:107], a[32:35], a[164:167], v[104:107]
s_waitcnt lgkmcnt(0)
v_mfma_f32_16x16x32_bf16 v[36:39], a[36:39], a[168:171], v[36:39]
ds_read_b128 a[0:3], v201 offset:18432
buffer_load_dwordx4 v1, s[8:11], s60 offen offset:2048 sc1 lds
v_mfma_f32_16x16x32_bf16 v[40:43], a[36:39], a[172:175], v[40:43]
ds_read_b128 a[4:7], v201 offset:19456
v_mfma_f32_16x16x32_bf16 v[44:47], a[40:43], a[168:171], v[44:47]
ds_read_b128 a[8:11], v201 offset:20480
buffer_load_dwordx4 v1, s[8:11], s60 offen offset:3072 sc1 lds
v_mfma_f32_16x16x32_bf16 v[48:51], a[40:43], a[172:175], v[48:51]
ds_read_b128 a[12:15], v201 offset:21504
v_mfma_f32_16x16x32_bf16 v[52:55], a[44:47], a[168:171], v[52:55]
ds_read_b128 a[16:19], v201 offset:22528
v_mfma_f32_16x16x32_bf16 v[56:59], a[44:47], a[172:175], v[56:59]
ds_read_b128 a[20:23], v201 offset:23552
v_mfma_f32_16x16x32_bf16 v[60:63], a[48:51], a[168:171], v[60:63]
ds_read_b128 a[24:27], v201 offset:24576
v_mfma_f32_16x16x32_bf16 v[64:67], a[48:51], a[172:175], v[64:67]
ds_read_b128 a[28:31], v201 offset:25600
v_mfma_f32_16x16x32_bf16 v[68:71], a[52:55], a[168:171], v[68:71]
ds_read_b128 a[32:35], v201 offset:26624
v_mfma_f32_16x16x32_bf16 v[72:75], a[52:55], a[172:175], v[72:75]
s_cmp_eq_u32 s25, 7
s_cselect_b32 s98, 4096, 0
s_add_u32 s52, s52, s98
v_mfma_f32_16x16x32_bf16 v[76:79], a[56:59], a[168:171], v[76:79]
s_add_u32 s52, s52, 4096
v_exp_f32 v194, v194
v_mfma_f32_16x16x32_bf16 v[80:83], a[56:59], a[172:175], v[80:83]
v_exp_f32 v195, v195
v_mfma_f32_16x16x32_bf16 v[84:87], a[60:63], a[168:171], v[84:87]
buffer_load_dwordx4 a[80:83], v1, s[4:7], s52 offen offset:0 sc1
v_fma_f32 v192, v192, v254, v254
v_mfma_f32_16x16x32_bf16 v[88:91], a[60:63], a[172:175], v[88:91]
v_fma_f32 v193, v193, v254, v254
v_fma_f32 v194, v194, v254, v254
v_mfma_f32_16x16x32_bf16 v[92:95], a[64:67], a[168:171], v[92:95]
buffer_load_dwordx4 a[84:87], v9, s[4:7], s52 offen offset:0 sc1
v_mfma_f32_16x16x32_bf16 v[96:99], a[64:67], a[172:175], v[96:99]
v_fma_f32 v195, v195, v254, v254
v_mfma_f32_16x16x32_bf16 v[100:103], a[68:71], a[168:171], v[100:103]
v_mfma_f32_16x16x32_bf16 v[104:107], a[68:71], a[172:175], v[104:107]
s_waitcnt lgkmcnt(0)
v_mfma_f32_16x16x32_bf16 v[36:39], a[0:3], a[176:179], v[36:39]
ds_read_b128 a[36:39], v201 offset:27648
buffer_load_dwordx4 a[88:91], v1, s[4:7], s52 offen offset:1024 sc1
v_mfma_f32_16x16x32_bf16 v[40:43], a[0:3], a[180:183], v[40:43]
ds_read_b128 a[40:43], v201 offset:28672
v_mfma_f32_16x16x32_bf16 v[44:47], a[4:7], a[176:179], v[44:47]
ds_read_b128 a[44:47], v201 offset:29696
v_mfma_f32_16x16x32_bf16 v[48:51], a[4:7], a[180:183], v[48:51]
ds_read_b128 a[48:51], v201 offset:30720
v_mfma_f32_16x16x32_bf16 v[52:55], a[8:11], a[176:179], v[52:55]
ds_read_b128 a[52:55], v201 offset:31744
buffer_load_dwordx4 a[92:95], v9, s[4:7], s52 offen offset:1024 sc1
v_mfma_f32_16x16x32_bf16 v[56:59], a[8:11], a[180:183], v[56:59]
ds_read_b128 a[56:59], v201 offset:32768
v_mfma_f32_16x16x32_bf16 v[60:63], a[12:15], a[176:179], v[60:63]
ds_read_b128 a[60:63], v201 offset:33792
v_mfma_f32_16x16x32_bf16 v[64:67], a[12:15], a[180:183], v[64:67]
ds_read_b128 a[64:67], v201 offset:34816
v_mfma_f32_16x16x32_bf16 v[68:71], a[16:19], a[176:179], v[68:71]
ds_read_b128 a[68:71], v201 offset:35840
buffer_load_dwordx4 a[96:99], v1, s[4:7], s52 offen offset:2048 sc1
v_mfma_f32_16x16x32_bf16 v[72:75], a[16:19], a[180:183], v[72:75]
v_rcp_f32 v192, v192
v_mfma_f32_16x16x32_bf16 v[76:79], a[20:23], a[176:179], v[76:79]
v_rcp_f32 v193, v193
v_mfma_f32_16x16x32_bf16 v[80:83], a[20:23], a[180:183], v[80:83]
v_rcp_f32 v194, v194
v_mfma_f32_16x16x32_bf16 v[84:87], a[24:27], a[176:179], v[84:87]
buffer_load_dwordx4 a[100:103], v9, s[4:7], s52 offen offset:2048 sc1
v_mfma_f32_16x16x32_bf16 v[88:91], a[24:27], a[180:183], v[88:91]
v_mfma_f32_16x16x32_bf16 v[92:95], a[28:31], a[176:179], v[92:95]
v_rcp_f32 v195, v195
v_mfma_f32_16x16x32_bf16 v[96:99], a[28:31], a[180:183], v[96:99]
v_mfma_f32_16x16x32_bf16 v[100:103], a[32:35], a[176:179], v[100:103]
v_mfma_f32_16x16x32_bf16 v[104:107], a[32:35], a[180:183], v[104:107]
s_waitcnt vmcnt(23) lgkmcnt(0)
s_barrier
v_mfma_f32_16x16x32_bf16 v[36:39], a[36:39], a[184:187], v[36:39]
ds_read_b128 a[0:3], v202 offset:0
buffer_load_dwordx4 a[104:107], v1, s[4:7], s52 offen offset:3072 sc1
v_mfma_f32_16x16x32_bf16 v[40:43], a[36:39], a[188:191], v[40:43]
ds_read_b128 a[4:7], v202 offset:1024
buffer_load_dwordx4 a[108:111], v9, s[4:7], s52 offen offset:3072 sc1
v_mfma_f32_16x16x32_bf16 v[44:47], a[40:43], a[184:187], v[44:47]
ds_read_b128 a[8:11], v202 offset:2048
v_mul_f32 v148, v148, v192
v_mfma_f32_16x16x32_bf16 v[48:51], a[40:43], a[188:191], v[48:51]
ds_read_b128 a[12:15], v202 offset:3072
v_mul_f32 v149, v149, v193
v_mfma_f32_16x16x32_bf16 v[52:55], a[44:47], a[184:187], v[52:55]
ds_read_b128 a[16:19], v202 offset:4096
v_mfma_f32_16x16x32_bf16 v[56:59], a[44:47], a[188:191], v[56:59]
ds_read_b128 a[20:23], v202 offset:5120
v_mul_f32 v150, v150, v194
v_mfma_f32_16x16x32_bf16 v[60:63], a[48:51], a[184:187], v[60:63]
ds_read_b128 a[24:27], v202 offset:6144
v_mfma_f32_16x16x32_bf16 v[64:67], a[48:51], a[188:191], v[64:67]
ds_read_b128 a[28:31], v202 offset:7168
v_mul_f32 v151, v151, v195
v_mfma_f32_16x16x32_bf16 v[68:71], a[52:55], a[184:187], v[68:71]
ds_read_b128 a[32:35], v202 offset:8192
v_mfma_f32_16x16x32_bf16 v[72:75], a[52:55], a[188:191], v[72:75]
s_cmp_eq_u32 s25, 7
s_cselect_b32 s99, 36864, 0
s_add_u32 s60, s60, s99
v_mfma_f32_16x16x32_bf16 v[76:79], a[56:59], a[184:187], v[76:79]
s_add_u32 s61, s61, s99
s_add_u32 m0, s62, 90112
v_mul_f32 v196, v152, v152
v_mfma_f32_16x16x32_bf16 v[80:83], a[56:59], a[188:191], v[80:83]
s_add_u32 s60, s60, 16384
v_mfma_f32_16x16x32_bf16 v[84:87], a[60:63], a[184:187], v[84:87]
v_mul_f32 v197, v153, v153
v_mfma_f32_16x16x32_bf16 v[88:91], a[60:63], a[188:191], v[88:91]
buffer_load_dwordx4 v1, s[8:11], s60 offen offset:0 sc1 lds
v_mfma_f32_16x16x32_bf16 v[92:95], a[64:67], a[184:187], v[92:95]
v_mul_f32 v198, v154, v154
v_mfma_f32_16x16x32_bf16 v[96:99], a[64:67], a[188:191], v[96:99]
buffer_load_dwordx4 v1, s[8:11], s60 offen offset:1024 sc1 lds
v_mfma_f32_16x16x32_bf16 v[100:103], a[68:71], a[184:187], v[100:103]
v_mfma_f32_16x16x32_bf16 v[104:107], a[68:71], a[188:191], v[104:107]
v_mul_f32 v199, v155, v155
s_waitcnt lgkmcnt(0)
v_mfma_f32_16x16x32_bf16 v[36:39], a[0:3], a[192:195], v[36:39]
ds_read_b128 a[36:39], v202 offset:9216
buffer_load_dwordx4 v1, s[8:11], s60 offen offset:2048 sc1 lds
v_mfma_f32_16x16x32_bf16 v[40:43], a[0:3], a[196:199], v[40:43]
ds_read_b128 a[40:43], v202 offset:10240
v_fma_f32 v196, v196, v253, v251
v_mfma_f32_16x16x32_bf16 v[44:47], a[4:7], a[192:195], v[44:47]
ds_read_b128 a[44:47], v202 offset:11264
buffer_load_dwordx4 v1, s[8:11], s60 offen offset:3072 sc1 lds
v_mfma_f32_16x16x32_bf16 v[48:51], a[4:7], a[196:199], v[48:51]
ds_read_b128 a[48:51], v202 offset:12288
v_mfma_f32_16x16x32_bf16 v[52:55], a[8:11], a[192:195], v[52:55]
ds_read_b128 a[52:55], v202 offset:13312
s_add_u32 m0, s63, 106496
v_mfma_f32_16x16x32_bf16 v[56:59], a[8:11], a[196:199], v[56:59]
ds_read_b128 a[56:59], v202 offset:14336
v_fma_f32 v197, v197, v253, v251
v_mfma_f32_16x16x32_bf16 v[60:63], a[12:15], a[192:195], v[60:63]
ds_read_b128 a[60:63], v202 offset:15360
s_add_u32 s61, s61, 36864
v_mfma_f32_16x16x32_bf16 v[64:67], a[12:15], a[196:199], v[64:67]
ds_read_b128 a[64:67], v202 offset:16384
v_fma_f32 v198, v198, v253, v251
v_mfma_f32_16x16x32_bf16 v[68:71], a[16:19], a[192:195], v[68:71]
ds_read_b128 a[68:71], v202 offset:17408
buffer_load_dwordx4 v1, s[8:11], s61 offen offset:0 sc1 lds
v_mfma_f32_16x16x32_bf16 v[72:75], a[16:19], a[196:199], v[72:75]
s_add_u32 m0, s62, 110592
v_fma_f32 v199, v199, v253, v251
v_mfma_f32_16x16x32_bf16 v[76:79], a[20:23], a[192:195], v[76:79]
s_add_u32 s60, s60, 20480
v_mfma_f32_16x16x32_bf16 v[80:83], a[20:23], a[196:199], v[80:83]
v_mul_f32 v196, v196, v152
v_mfma_f32_16x16x32_bf16 v[84:87], a[24:27], a[192:195], v[84:87]
v_mfma_f32_16x16x32_bf16 v[88:91], a[24:27], a[196:199], v[88:91]
v_mul_f32 v197, v197, v153
v_mfma_f32_16x16x32_bf16 v[92:95], a[28:31], a[192:195], v[92:95]
buffer_load_dwordx4 v1, s[8:11], s60 offen offset:0 sc1 lds
v_mfma_f32_16x16x32_bf16 v[96:99], a[28:31], a[196:199], v[96:99]
v_mul_f32 v198, v198, v154
v_mfma_f32_16x16x32_bf16 v[100:103], a[32:35], a[192:195], v[100:103]
v_mfma_f32_16x16x32_bf16 v[104:107], a[32:35], a[196:199], v[104:107]
s_waitcnt lgkmcnt(0)
v_mfma_f32_16x16x32_bf16 v[36:39], a[36:39], a[200:203], v[36:39]
ds_read_b128 a[0:3], v202 offset:18432
buffer_load_dwordx4 v1, s[8:11], s60 offen offset:1024 sc1 lds
v_mfma_f32_16x16x32_bf16 v[40:43], a[36:39], a[204:207], v[40:43]
ds_read_b128 a[4:7], v202 offset:19456
v_mul_f32 v199, v199, v155
v_mfma_f32_16x16x32_bf16 v[44:47], a[40:43], a[200:203], v[44:47]
ds_read_b128 a[8:11], v202 offset:20480
buffer_load_dwordx4 v1, s[8:11], s60 offen offset:2048 sc1 lds
v_mfma_f32_16x16x32_bf16 v[48:51], a[40:43], a[204:207], v[48:51]
ds_read_b128 a[12:15], v202 offset:21504
v_mfma_f32_16x16x32_bf16 v[52:55], a[44:47], a[200:203], v[52:55]
ds_read_b128 a[16:19], v202 offset:22528
buffer_load_dwordx4 v1, s[8:11], s60 offen offset:3072 sc1 lds
v_mfma_f32_16x16x32_bf16 v[56:59], a[44:47], a[204:207], v[56:59]
ds_read_b128 a[20:23], v202 offset:23552
v_mfma_f32_16x16x32_bf16 v[60:63], a[48:51], a[200:203], v[60:63]
ds_read_b128 a[24:27], v202 offset:24576
v_mfma_f32_16x16x32_bf16 v[64:67], a[48:51], a[204:207], v[64:67]
ds_read_b128 a[28:31], v202 offset:25600
v_mfma_f32_16x16x32_bf16 v[68:71], a[52:55], a[200:203], v[68:71]
ds_read_b128 a[32:35], v202 offset:26624
v_mfma_f32_16x16x32_bf16 v[72:75], a[52:55], a[204:207], v[72:75]
s_cmp_eq_u32 s25, 8
s_cselect_b32 s98, 4096, 0
v_mfma_f32_16x16x32_bf16 v[76:79], a[56:59], a[200:203], v[76:79]
s_add_u32 s52, s52, s98
v_exp_f32 v196, v196
v_mfma_f32_16x16x32_bf16 v[80:83], a[56:59], a[204:207], v[80:83]
s_add_u32 s52, s52, 4096
v_exp_f32 v197, v197
v_mfma_f32_16x16x32_bf16 v[84:87], a[60:63], a[200:203], v[84:87]
v_exp_f32 v198, v198
v_mfma_f32_16x16x32_bf16 v[88:91], a[60:63], a[204:207], v[88:91]
v_mfma_f32_16x16x32_bf16 v[92:95], a[64:67], a[200:203], v[92:95]
buffer_load_dwordx4 a[112:115], v1, s[4:7], s52 offen offset:0 sc1
v_mfma_f32_16x16x32_bf16 v[96:99], a[64:67], a[204:207], v[96:99]
v_mfma_f32_16x16x32_bf16 v[100:103], a[68:71], a[200:203], v[100:103]
v_exp_f32 v199, v199
v_mfma_f32_16x16x32_bf16 v[104:107], a[68:71], a[204:207], v[104:107]
s_waitcnt lgkmcnt(0)
v_mfma_f32_16x16x32_bf16 v[36:39], a[0:3], a[208:211], v[36:39]
ds_read_b128 a[36:39], v202 offset:27648
buffer_load_dwordx4 a[116:119], v9, s[4:7], s52 offen offset:0 sc1
v_mfma_f32_16x16x32_bf16 v[40:43], a[0:3], a[212:215], v[40:43]
ds_read_b128 a[40:43], v202 offset:28672
v_mfma_f32_16x16x32_bf16 v[44:47], a[4:7], a[208:211], v[44:47]
ds_read_b128 a[44:47], v202 offset:29696
v_mfma_f32_16x16x32_bf16 v[48:51], a[4:7], a[212:215], v[48:51]
ds_read_b128 a[48:51], v202 offset:30720
v_fma_f32 v196, v196, v255, v255
v_mfma_f32_16x16x32_bf16 v[52:55], a[8:11], a[208:211], v[52:55]
ds_read_b128 a[52:55], v202 offset:31744
buffer_load_dwordx4 a[120:123], v1, s[4:7], s52 offen offset:1024 sc1
v_mfma_f32_16x16x32_bf16 v[56:59], a[8:11], a[212:215], v[56:59]
ds_read_b128 a[56:59], v202 offset:32768
v_fma_f32 v197, v197, v255, v255
v_mfma_f32_16x16x32_bf16 v[60:63], a[12:15], a[208:211], v[60:63]
ds_read_b128 a[60:63], v202 offset:33792
v_mfma_f32_16x16x32_bf16 v[64:67], a[12:15], a[212:215], v[64:67]
ds_read_b128 a[64:67], v202 offset:34816
v_mfma_f32_16x16x32_bf16 v[68:71], a[16:19], a[208:211], v[68:71]
ds_read_b128 a[68:71], v202 offset:35840
buffer_load_dwordx4 a[124:127], v9, s[4:7], s52 offen offset:1024 sc1
v_mfma_f32_16x16x32_bf16 v[72:75], a[16:19], a[212:215], v[72:75]
v_fma_f32 v198, v198, v255, v255
v_mfma_f32_16x16x32_bf16 v[76:79], a[20:23], a[208:211], v[76:79]
v_fma_f32 v199, v199, v255, v255
v_mfma_f32_16x16x32_bf16 v[80:83], a[20:23], a[212:215], v[80:83]
v_mfma_f32_16x16x32_bf16 v[84:87], a[24:27], a[208:211], v[84:87]
buffer_load_dwordx4 a[128:131], v1, s[4:7], s52 offen offset:2048 sc1
v_mfma_f32_16x16x32_bf16 v[88:91], a[24:27], a[212:215], v[88:91]
v_rcp_f32 v196, v196
v_mfma_f32_16x16x32_bf16 v[92:95], a[28:31], a[208:211], v[92:95]
v_mfma_f32_16x16x32_bf16 v[96:99], a[28:31], a[212:215], v[96:99]
v_mfma_f32_16x16x32_bf16 v[100:103], a[32:35], a[208:211], v[100:103]
v_mfma_f32_16x16x32_bf16 v[104:107], a[32:35], a[212:215], v[104:107]
s_waitcnt vmcnt(22) lgkmcnt(0)
s_barrier
v_mfma_f32_16x16x32_bf16 v[36:39], a[36:39], a[216:219], v[36:39]
ds_read_b128 a[0:3], v200 offset:0
buffer_load_dwordx4 a[132:135], v9, s[4:7], s52 offen offset:2048 sc1
v_mfma_f32_16x16x32_bf16 v[40:43], a[36:39], a[220:223], v[40:43]
ds_read_b128 a[4:7], v200 offset:1024
buffer_load_dwordx4 a[136:139], v1, s[4:7], s52 offen offset:3072 sc1
v_mfma_f32_16x16x32_bf16 v[44:47], a[40:43], a[216:219], v[44:47]
ds_read_b128 a[8:11], v200 offset:2048
v_mfma_f32_16x16x32_bf16 v[48:51], a[40:43], a[220:223], v[48:51]
ds_read_b128 a[12:15], v200 offset:3072
buffer_load_dwordx4 a[140:143], v9, s[4:7], s52 offen offset:3072 sc1
v_mfma_f32_16x16x32_bf16 v[52:55], a[44:47], a[216:219], v[52:55]
ds_read_b128 a[16:19], v200 offset:4096
v_mfma_f32_16x16x32_bf16 v[56:59], a[44:47], a[220:223], v[56:59]
ds_read_b128 a[20:23], v200 offset:5120
v_mfma_f32_16x16x32_bf16 v[60:63], a[48:51], a[216:219], v[60:63]
ds_read_b128 a[24:27], v200 offset:6144
v_mfma_f32_16x16x32_bf16 v[64:67], a[48:51], a[220:223], v[64:67]
ds_read_b128 a[28:31], v200 offset:7168
v_mfma_f32_16x16x32_bf16 v[68:71], a[52:55], a[216:219], v[68:71]
ds_read_b128 a[32:35], v200 offset:8192
v_mfma_f32_16x16x32_bf16 v[72:75], a[52:55], a[220:223], v[72:75]
s_cmp_eq_u32 s25, 8
s_cselect_b32 s99, 36864, 0
s_add_u32 s60, s60, s99
v_mfma_f32_16x16x32_bf16 v[76:79], a[56:59], a[216:219], v[76:79]
s_add_u32 s61, s61, s99
v_rcp_f32 v197, v197
v_mfma_f32_16x16x32_bf16 v[80:83], a[56:59], a[220:223], v[80:83]
s_add_u32 m0, s62, 126976
v_rcp_f32 v198, v198
v_mfma_f32_16x16x32_bf16 v[84:87], a[60:63], a[216:219], v[84:87]
s_add_u32 s60, s60, 16384
v_rcp_f32 v199, v199
v_mfma_f32_16x16x32_bf16 v[88:91], a[60:63], a[220:223], v[88:91]
v_mul_f32 v152, v152, v196
v_mfma_f32_16x16x32_bf16 v[92:95], a[64:67], a[216:219], v[92:95]
v_mfma_f32_16x16x32_bf16 v[96:99], a[64:67], a[220:223], v[96:99]
buffer_load_dwordx4 v1, s[8:11], s60 offen offset:0 sc1 lds
v_mfma_f32_16x16x32_bf16 v[100:103], a[68:71], a[216:219], v[100:103]
v_mul_f32 v153, v153, v197
v_mfma_f32_16x16x32_bf16 v[104:107], a[68:71], a[220:223], v[104:107]
s_waitcnt lgkmcnt(0)
v_mfma_f32_16x16x32_bf16 v[36:39], a[0:3], a[224:227], v[36:39]
ds_read_b128 a[36:39], v200 offset:9216
buffer_load_dwordx4 v1, s[8:11], s60 offen offset:1024 sc1 lds
v_mfma_f32_16x16x32_bf16 v[40:43], a[0:3], a[228:231], v[40:43]
ds_read_b128 a[40:43], v200 offset:10240
v_mul_f32 v154, v154, v198
v_mfma_f32_16x16x32_bf16 v[44:47], a[4:7], a[224:227], v[44:47]
ds_read_b128 a[44:47], v200 offset:11264
buffer_load_dwordx4 v1, s[8:11], s60 offen offset:2048 sc1 lds
v_mfma_f32_16x16x32_bf16 v[48:51], a[4:7], a[228:231], v[48:51]
ds_read_b128 a[48:51], v200 offset:12288
v_mul_f32 v155, v155, v199
v_mfma_f32_16x16x32_bf16 v[52:55], a[8:11], a[224:227], v[52:55]
ds_read_b128 a[52:55], v200 offset:13312
v_mfma_f32_16x16x32_bf16 v[56:59], a[8:11], a[228:231], v[56:59]
ds_read_b128 a[56:59], v200 offset:14336
buffer_load_dwordx4 v1, s[8:11], s60 offen offset:3072 sc1 lds
v_mfma_f32_16x16x32_bf16 v[60:63], a[12:15], a[224:227], v[60:63]
ds_read_b128 a[60:63], v200 offset:15360
v_mul_f32 v192, v156, v156
v_mfma_f32_16x16x32_bf16 v[64:67], a[12:15], a[228:231], v[64:67]
ds_read_b128 a[64:67], v200 offset:16384
v_mul_f32 v193, v157, v157
v_mfma_f32_16x16x32_bf16 v[68:71], a[16:19], a[224:227], v[68:71]
ds_read_b128 a[68:71], v200 offset:17408
s_add_u32 m0, s63, 143360
v_mfma_f32_16x16x32_bf16 v[72:75], a[16:19], a[228:231], v[72:75]
s_add_u32 s61, s61, 36864
v_mul_f32 v194, v158, v158
v_mfma_f32_16x16x32_bf16 v[76:79], a[20:23], a[224:227], v[76:79]
v_mfma_f32_16x16x32_bf16 v[80:83], a[20:23], a[228:231], v[80:83]
v_mfma_f32_16x16x32_bf16 v[84:87], a[24:27], a[224:227], v[84:87]
v_mul_f32 v195, v159, v159
v_mfma_f32_16x16x32_bf16 v[88:91], a[24:27], a[228:231], v[88:91]
v_mfma_f32_16x16x32_bf16 v[92:95], a[28:31], a[224:227], v[92:95]
buffer_load_dwordx4 v1, s[8:11], s61 offen offset:0 sc1 lds
v_fma_f32 v192, v192, v252, v250
v_mfma_f32_16x16x32_bf16 v[96:99], a[28:31], a[228:231], v[96:99]
v_mfma_f32_16x16x32_bf16 v[100:103], a[32:35], a[224:227], v[100:103]
v_fma_f32 v193, v193, v252, v250
v_mfma_f32_16x16x32_bf16 v[104:107], a[32:35], a[228:231], v[104:107]
s_waitcnt lgkmcnt(0)
v_mfma_f32_16x16x32_bf16 v[36:39], a[36:39], a[232:235], v[36:39]
ds_read_b128 a[0:3], v200 offset:18432
s_add_u32 m0, s62, 147456
v_mfma_f32_16x16x32_bf16 v[40:43], a[36:39], a[236:239], v[40:43]
ds_read_b128 a[4:7], v200 offset:19456
v_fma_f32 v194, v194, v252, v250
v_mfma_f32_16x16x32_bf16 v[44:47], a[40:43], a[232:235], v[44:47]
ds_read_b128 a[8:11], v200 offset:20480
s_add_u32 s60, s60, 20480
v_mfma_f32_16x16x32_bf16 v[48:51], a[40:43], a[236:239], v[48:51]
ds_read_b128 a[12:15], v200 offset:21504
v_fma_f32 v195, v195, v252, v250
v_mfma_f32_16x16x32_bf16 v[52:55], a[44:47], a[232:235], v[52:55]
ds_read_b128 a[16:19], v200 offset:22528
v_mfma_f32_16x16x32_bf16 v[56:59], a[44:47], a[236:239], v[56:59]
ds_read_b128 a[20:23], v200 offset:23552
buffer_load_dwordx4 v1, s[8:11], s60 offen offset:0 sc1 lds
v_mfma_f32_16x16x32_bf16 v[60:63], a[48:51], a[232:235], v[60:63]
ds_read_b128 a[24:27], v200 offset:24576
v_mul_f32 v192, v192, v156
v_mfma_f32_16x16x32_bf16 v[64:67], a[48:51], a[236:239], v[64:67]
ds_read_b128 a[28:31], v200 offset:25600
v_mfma_f32_16x16x32_bf16 v[68:71], a[52:55], a[232:235], v[68:71]
ds_read_b128 a[32:35], v200 offset:26624
buffer_load_dwordx4 v1, s[8:11], s60 offen offset:1024 sc1 lds
v_mfma_f32_16x16x32_bf16 v[72:75], a[52:55], a[236:239], v[72:75]
v_mul_f32 v193, v193, v157
v_mfma_f32_16x16x32_bf16 v[76:79], a[56:59], a[232:235], v[76:79]
v_mul_f32 v194, v194, v158
v_mfma_f32_16x16x32_bf16 v[80:83], a[56:59], a[236:239], v[80:83]
buffer_load_dwordx4 v1, s[8:11], s60 offen offset:2048 sc1 lds
v_mfma_f32_16x16x32_bf16 v[84:87], a[60:63], a[232:235], v[84:87]
v_mfma_f32_16x16x32_bf16 v[88:91], a[60:63], a[236:239], v[88:91]
v_mul_f32 v195, v195, v159
v_mfma_f32_16x16x32_bf16 v[92:95], a[64:67], a[232:235], v[92:95]
buffer_load_dwordx4 v1, s[8:11], s60 offen offset:3072 sc1 lds
v_mfma_f32_16x16x32_bf16 v[96:99], a[64:67], a[236:239], v[96:99]
v_exp_f32 v192, v192
v_mfma_f32_16x16x32_bf16 v[100:103], a[68:71], a[232:235], v[100:103]
v_mfma_f32_16x16x32_bf16 v[104:107], a[68:71], a[236:239], v[104:107]
s_waitcnt lgkmcnt(0)
v_mfma_f32_16x16x32_bf16 v[36:39], a[0:3], a[240:243], v[36:39]
ds_read_b128 a[36:39], v200 offset:27648
v_mfma_f32_16x16x32_bf16 v[40:43], a[0:3], a[244:247], v[40:43]
ds_read_b128 a[40:43], v200 offset:28672
v_mfma_f32_16x16x32_bf16 v[44:47], a[4:7], a[240:243], v[44:47]
ds_read_b128 a[44:47], v200 offset:29696
v_mfma_f32_16x16x32_bf16 v[48:51], a[4:7], a[244:247], v[48:51]
ds_read_b128 a[48:51], v200 offset:30720
v_mfma_f32_16x16x32_bf16 v[52:55], a[8:11], a[240:243], v[52:55]
ds_read_b128 a[52:55], v200 offset:31744
v_mfma_f32_16x16x32_bf16 v[56:59], a[8:11], a[244:247], v[56:59]
ds_read_b128 a[56:59], v200 offset:32768
v_mfma_f32_16x16x32_bf16 v[60:63], a[12:15], a[240:243], v[60:63]
ds_read_b128 a[60:63], v200 offset:33792
v_mfma_f32_16x16x32_bf16 v[64:67], a[12:15], a[244:247], v[64:67]
ds_read_b128 a[64:67], v200 offset:34816
v_mfma_f32_16x16x32_bf16 v[68:71], a[16:19], a[240:243], v[68:71]
ds_read_b128 a[68:71], v200 offset:35840
v_mfma_f32_16x16x32_bf16 v[72:75], a[16:19], a[244:247], v[72:75]
s_cmp_eq_u32 s25, 9
s_cselect_b32 s98, 4096, 0
s_add_u32 s52, s52, s98
v_mfma_f32_16x16x32_bf16 v[76:79], a[20:23], a[240:243], v[76:79]
s_add_u32 s52, s52, 4096
v_exp_f32 v193, v193
v_mfma_f32_16x16x32_bf16 v[80:83], a[20:23], a[244:247], v[80:83]
buffer_load_dwordx4 a[144:147], v1, s[4:7], s52 offen offset:0 sc1
v_mfma_f32_16x16x32_bf16 v[84:87], a[24:27], a[240:243], v[84:87]
buffer_load_dwordx4 a[148:151], v9, s[4:7], s52 offen offset:0 sc1
v_mfma_f32_16x16x32_bf16 v[88:91], a[24:27], a[244:247], v[88:91]
buffer_load_dwordx4 a[152:155], v1, s[4:7], s52 offen offset:1024 sc1
v_mfma_f32_16x16x32_bf16 v[92:95], a[28:31], a[240:243], v[92:95]
buffer_load_dwordx4 a[156:159], v9, s[4:7], s52 offen offset:1024 sc1
v_mfma_f32_16x16x32_bf16 v[96:99], a[28:31], a[244:247], v[96:99]
v_exp_f32 v194, v194
v_mfma_f32_16x16x32_bf16 v[100:103], a[32:35], a[240:243], v[100:103]
v_exp_f32 v195, v195
v_mfma_f32_16x16x32_bf16 v[104:107], a[32:35], a[244:247], v[104:107]
s_waitcnt vmcnt(21) lgkmcnt(0)
s_barrier
v_mfma_f32_16x16x32_bf16 v[36:39], a[36:39], a[248:251], v[36:39]
ds_read_b128 a[0:3], v201 offset:0
v_fma_f32 v192, v192, v254, v254
v_mfma_f32_16x16x32_bf16 v[40:43], a[36:39], a[252:255], v[40:43]
ds_read_b128 a[4:7], v201 offset:1024
v_fma_f32 v193, v193, v254, v254
v_mfma_f32_16x16x32_bf16 v[44:47], a[40:43], a[248:251], v[44:47]
ds_read_b128 a[8:11], v201 offset:2048
v_fma_f32 v194, v194, v254, v254
v_mfma_f32_16x16x32_bf16 v[48:51], a[40:43], a[252:255], v[48:51]
ds_read_b128 a[12:15], v201 offset:3072
v_mfma_f32_16x16x32_bf16 v[52:55], a[44:47], a[248:251], v[52:55]
ds_read_b128 a[16:19], v201 offset:4096
v_mfma_f32_16x16x32_bf16 v[56:59], a[44:47], a[252:255], v[56:59]
ds_read_b128 a[20:23], v201 offset:5120
v_fma_f32 v195, v195, v254, v254
v_mfma_f32_16x16x32_bf16 v[60:63], a[48:51], a[248:251], v[60:63]
ds_read_b128 a[24:27], v201 offset:6144
v_mfma_f32_16x16x32_bf16 v[64:67], a[48:51], a[252:255], v[64:67]
ds_read_b128 a[28:31], v201 offset:7168
v_mfma_f32_16x16x32_bf16 v[68:71], a[52:55], a[248:251], v[68:71]
ds_read_b128 a[32:35], v201 offset:8192
v_mfma_f32_16x16x32_bf16 v[72:75], a[52:55], a[252:255], v[72:75]
s_cmp_eq_u32 s25, 9
s_cselect_b32 s99, 36864, 0
s_add_u32 s60, s60, s99
v_mfma_f32_16x16x32_bf16 v[76:79], a[56:59], a[248:251], v[76:79]
s_add_u32 s61, s61, s99
s_add_u32 m0, s62, 53248
s_add_u32 s60, s60, 16384
v_mfma_f32_16x16x32_bf16 v[80:83], a[56:59], a[252:255], v[80:83]
buffer_load_dwordx4 v1, s[8:11], s60 offen offset:0 sc1 lds
v_mfma_f32_16x16x32_bf16 v[84:87], a[60:63], a[248:251], v[84:87]
buffer_load_dwordx4 v1, s[8:11], s60 offen offset:1024 sc1 lds
v_mfma_f32_16x16x32_bf16 v[88:91], a[60:63], a[252:255], v[88:91]
buffer_load_dwordx4 v1, s[8:11], s60 offen offset:2048 sc1 lds
v_mfma_f32_16x16x32_bf16 v[92:95], a[64:67], a[248:251], v[92:95]
v_rcp_f32 v192, v192
v_mfma_f32_16x16x32_bf16 v[96:99], a[64:67], a[252:255], v[96:99]
buffer_load_dwordx4 v1, s[8:11], s60 offen offset:3072 sc1 lds
v_mfma_f32_16x16x32_bf16 v[100:103], a[68:71], a[248:251], v[100:103]
v_rcp_f32 v193, v193
v_mfma_f32_16x16x32_bf16 v[104:107], a[68:71], a[252:255], v[104:107]
s_waitcnt lgkmcnt(0)
v_mfma_f32_16x16x32_bf16 v[36:39], a[0:3], a[80:83], v[36:39]
ds_read_b128 a[36:39], v201 offset:9216
s_add_u32 m0, s63, 69632
v_mfma_f32_16x16x32_bf16 v[40:43], a[0:3], a[84:87], v[40:43]
ds_read_b128 a[40:43], v201 offset:10240
v_mfma_f32_16x16x32_bf16 v[44:47], a[4:7], a[80:83], v[44:47]
ds_read_b128 a[44:47], v201 offset:11264
s_add_u32 s61, s61, 36864
v_mfma_f32_16x16x32_bf16 v[48:51], a[4:7], a[84:87], v[48:51]
ds_read_b128 a[48:51], v201 offset:12288
v_mfma_f32_16x16x32_bf16 v[52:55], a[8:11], a[80:83], v[52:55]
ds_read_b128 a[52:55], v201 offset:13312
buffer_load_dwordx4 v1, s[8:11], s61 offen offset:0 sc1 lds
v_mfma_f32_16x16x32_bf16 v[56:59], a[8:11], a[84:87], v[56:59]
ds_read_b128 a[56:59], v201 offset:14336
v_mfma_f32_16x16x32_bf16 v[60:63], a[12:15], a[80:83], v[60:63]
ds_read_b128 a[60:63], v201 offset:15360
s_add_u32 m0, s62, 73728
v_mfma_f32_16x16x32_bf16 v[64:67], a[12:15], a[84:87], v[64:67]
ds_read_b128 a[64:67], v201 offset:16384
v_mfma_f32_16x16x32_bf16 v[68:71], a[16:19], a[80:83], v[68:71]
ds_read_b128 a[68:71], v201 offset:17408
s_add_u32 s60, s60, 20480
v_mfma_f32_16x16x32_bf16 v[72:75], a[16:19], a[84:87], v[72:75]
v_rcp_f32 v194, v194
v_mfma_f32_16x16x32_bf16 v[76:79], a[20:23], a[80:83], v[76:79]
buffer_load_dwordx4 v1, s[8:11], s60 offen offset:0 sc1 lds
v_mfma_f32_16x16x32_bf16 v[80:83], a[20:23], a[84:87], v[80:83]
v_rcp_f32 v195, v195
v_mfma_f32_16x16x32_bf16 v[84:87], a[24:27], a[80:83], v[84:87]
buffer_load_dwordx4 v1, s[8:11], s60 offen offset:1024 sc1 lds
v_mul_f32 v156, v156, v192
v_mfma_f32_16x16x32_bf16 v[88:91], a[24:27], a[84:87], v[88:91]
v_mul_f32 v157, v157, v193
v_mul_f32 v158, v158, v194
v_mfma_f32_16x16x32_bf16 v[92:95], a[28:31], a[80:83], v[92:95]
buffer_load_dwordx4 v1, s[8:11], s60 offen offset:2048 sc1 lds
v_mfma_f32_16x16x32_bf16 v[96:99], a[28:31], a[84:87], v[96:99]
v_mul_f32 v159, v159, v195
v_mfma_f32_16x16x32_bf16 v[100:103], a[32:35], a[80:83], v[100:103]
v_mfma_f32_16x16x32_bf16 v[104:107], a[32:35], a[84:87], v[104:107]
v_mul_f32 v196, v160, v160
s_waitcnt lgkmcnt(0)
v_mfma_f32_16x16x32_bf16 v[36:39], a[36:39], a[88:91], v[36:39]
ds_read_b128 a[0:3], v201 offset:18432
buffer_load_dwordx4 v1, s[8:11], s60 offen offset:3072 sc1 lds
v_mfma_f32_16x16x32_bf16 v[40:43], a[36:39], a[92:95], v[40:43]
ds_read_b128 a[4:7], v201 offset:19456
v_mfma_f32_16x16x32_bf16 v[44:47], a[40:43], a[88:91], v[44:47]
ds_read_b128 a[8:11], v201 offset:20480
v_mul_f32 v197, v161, v161
v_mfma_f32_16x16x32_bf16 v[48:51], a[40:43], a[92:95], v[48:51]
ds_read_b128 a[12:15], v201 offset:21504
v_mfma_f32_16x16x32_bf16 v[52:55], a[44:47], a[88:91], v[52:55]
ds_read_b128 a[16:19], v201 offset:22528
buffer_load_dwordx4 a[160:163], v1, s[4:7], s52 offen offset:2048 sc1
v_mfma_f32_16x16x32_bf16 v[56:59], a[44:47], a[92:95], v[56:59]
ds_read_b128 a[20:23], v201 offset:23552
v_mul_f32 v198, v162, v162
v_mfma_f32_16x16x32_bf16 v[60:63], a[48:51], a[88:91], v[60:63]
ds_read_b128 a[24:27], v201 offset:24576
v_mfma_f32_16x16x32_bf16 v[64:67], a[48:51], a[92:95], v[64:67]
ds_read_b128 a[28:31], v201 offset:25600
v_mul_f32 v199, v163, v163
v_mfma_f32_16x16x32_bf16 v[68:71], a[52:55], a[88:91], v[68:71]
ds_read_b128 a[32:35], v201 offset:26624
buffer_load_dwordx4 a[164:167], v9, s[4:7], s52 offen offset:2048 sc1
v_mfma_f32_16x16x32_bf16 v[72:75], a[52:55], a[92:95], v[72:75]
v_fma_f32 v196, v196, v253, v251
v_mfma_f32_16x16x32_bf16 v[76:79], a[56:59], a[88:91], v[76:79]
v_mfma_f32_16x16x32_bf16 v[80:83], a[56:59], a[92:95], v[80:83]
v_fma_f32 v197, v197, v253, v251
v_mfma_f32_16x16x32_bf16 v[84:87], a[60:63], a[88:91], v[84:87]
buffer_load_dwordx4 a[168:171], v1, s[4:7], s52 offen offset:3072 sc1
v_mfma_f32_16x16x32_bf16 v[88:91], a[60:63], a[92:95], v[88:91]
v_mfma_f32_16x16x32_bf16 v[92:95], a[64:67], a[88:91], v[92:95]
v_fma_f32 v198, v198, v253, v251
v_mfma_f32_16x16x32_bf16 v[96:99], a[64:67], a[92:95], v[96:99]
v_mfma_f32_16x16x32_bf16 v[100:103], a[68:71], a[88:91], v[100:103]
v_fma_f32 v199, v199, v253, v251
v_mfma_f32_16x16x32_bf16 v[104:107], a[68:71], a[92:95], v[104:107]
s_waitcnt lgkmcnt(0)
v_mfma_f32_16x16x32_bf16 v[36:39], a[0:3], a[96:99], v[36:39]
ds_read_b128 a[36:39], v201 offset:27648
buffer_load_dwordx4 a[172:175], v9, s[4:7], s52 offen offset:3072 sc1
v_mfma_f32_16x16x32_bf16 v[40:43], a[0:3], a[100:103], v[40:43]
ds_read_b128 a[40:43], v201 offset:28672
v_mul_f32 v196, v196, v160
v_mfma_f32_16x16x32_bf16 v[44:47], a[4:7], a[96:99], v[44:47]
ds_read_b128 a[44:47], v201 offset:29696
v_mfma_f32_16x16x32_bf16 v[48:51], a[4:7], a[100:103], v[48:51]
ds_read_b128 a[48:51], v201 offset:30720
v_mul_f32 v197, v197, v161
v_mfma_f32_16x16x32_bf16 v[52:55], a[8:11], a[96:99], v[52:55]
ds_read_b128 a[52:55], v201 offset:31744
v_mfma_f32_16x16x32_bf16 v[56:59], a[8:11], a[100:103], v[56:59]
ds_read_b128 a[56:59], v201 offset:32768
v_mul_f32 v198, v198, v162
v_mfma_f32_16x16x32_bf16 v[60:63], a[12:15], a[96:99], v[60:63]
ds_read_b128 a[60:63], v201 offset:33792
v_mfma_f32_16x16x32_bf16 v[64:67], a[12:15], a[100:103], v[64:67]
ds_read_b128 a[64:67], v201 offset:34816
v_mul_f32 v199, v199, v163
v_mfma_f32_16x16x32_bf16 v[68:71], a[16:19], a[96:99], v[68:71]
ds_read_b128 a[68:71], v201 offset:35840
v_mfma_f32_16x16x32_bf16 v[72:75], a[16:19], a[100:103], v[72:75]
s_cmp_eq_u32 s25, 10
s_cselect_b32 s98, 4096, 0
s_add_u32 s52, s52, s98
v_mfma_f32_16x16x32_bf16 v[76:79], a[20:23], a[96:99], v[76:79]
s_add_u32 s52, s52, 4096
v_exp_f32 v196, v196
v_mfma_f32_16x16x32_bf16 v[80:83], a[20:23], a[100:103], v[80:83]
buffer_load_dwordx4 a[176:179], v1, s[4:7], s52 offen offset:0 sc1
v_mfma_f32_16x16x32_bf16 v[84:87], a[24:27], a[96:99], v[84:87]
buffer_load_dwordx4 a[180:183], v9, s[4:7], s52 offen offset:0 sc1
v_mfma_f32_16x16x32_bf16 v[88:91], a[24:27], a[100:103], v[88:91]
v_mfma_f32_16x16x32_bf16 v[92:95], a[28:31], a[96:99], v[92:95]
buffer_load_dwordx4 a[184:187], v1, s[4:7], s52 offen offset:1024 sc1
v_mfma_f32_16x16x32_bf16 v[96:99], a[28:31], a[100:103], v[96:99]
v_exp_f32 v197, v197
v_mfma_f32_16x16x32_bf16 v[100:103], a[32:35], a[96:99], v[100:103]
v_mfma_f32_16x16x32_bf16 v[104:107], a[32:35], a[100:103], v[104:107]
s_waitcnt vmcnt(20) lgkmcnt(0)
s_barrier
v_mfma_f32_16x16x32_bf16 v[36:39], a[36:39], a[104:107], v[36:39]
ds_read_b128 a[0:3], v202 offset:0
buffer_load_dwordx4 a[188:191], v9, s[4:7], s52 offen offset:1024 sc1
v_mfma_f32_16x16x32_bf16 v[40:43], a[36:39], a[108:111], v[40:43]
ds_read_b128 a[4:7], v202 offset:1024
v_mfma_f32_16x16x32_bf16 v[44:47], a[40:43], a[104:107], v[44:47]
ds_read_b128 a[8:11], v202 offset:2048
v_mfma_f32_16x16x32_bf16 v[48:51], a[40:43], a[108:111], v[48:51]
ds_read_b128 a[12:15], v202 offset:3072
v_mfma_f32_16x16x32_bf16 v[52:55], a[44:47], a[104:107], v[52:55]
ds_read_b128 a[16:19], v202 offset:4096
v_mfma_f32_16x16x32_bf16 v[56:59], a[44:47], a[108:111], v[56:59]
ds_read_b128 a[20:23], v202 offset:5120
v_mfma_f32_16x16x32_bf16 v[60:63], a[48:51], a[104:107], v[60:63]
ds_read_b128 a[24:27], v202 offset:6144
v_mfma_f32_16x16x32_bf16 v[64:67], a[48:51], a[108:111], v[64:67]
ds_read_b128 a[28:31], v202 offset:7168
v_mfma_f32_16x16x32_bf16 v[68:71], a[52:55], a[104:107], v[68:71]
ds_read_b128 a[32:35], v202 offset:8192
v_mfma_f32_16x16x32_bf16 v[72:75], a[52:55], a[108:111], v[72:75]
s_cmp_eq_u32 s25, 10
s_cselect_b32 s99, 36864, 0
s_add_u32 s60, s60, s99
v_mfma_f32_16x16x32_bf16 v[76:79], a[56:59], a[104:107], v[76:79]
s_add_u32 s61, s61, s99
s_add_u32 m0, s62, 90112
s_add_u32 s60, s60, 16384
v_mfma_f32_16x16x32_bf16 v[80:83], a[56:59], a[108:111], v[80:83]
buffer_load_dwordx4 v1, s[8:11], s60 offen offset:0 sc1 lds
v_mfma_f32_16x16x32_bf16 v[84:87], a[60:63], a[104:107], v[84:87]
v_exp_f32 v198, v198
v_mfma_f32_16x16x32_bf16 v[88:91], a[60:63], a[108:111], v[88:91]
buffer_load_dwordx4 v1, s[8:11], s60 offen offset:1024 sc1 lds
v_mfma_f32_16x16x32_bf16 v[92:95], a[64:67], a[104:107], v[92:95]
v_exp_f32 v199, v199
v_mfma_f32_16x16x32_bf16 v[96:99], a[64:67], a[108:111], v[96:99]
buffer_load_dwordx4 v1, s[8:11], s60 offen offset:2048 sc1 lds
v_fma_f32 v196, v196, v255, v255
v_mfma_f32_16x16x32_bf16 v[100:103], a[68:71], a[104:107], v[100:103]
v_fma_f32 v197, v197, v255, v255
v_fma_f32 v198, v198, v255, v255
v_mfma_f32_16x16x32_bf16 v[104:107], a[68:71], a[108:111], v[104:107]
s_waitcnt lgkmcnt(0)
v_mfma_f32_16x16x32_bf16 v[36:39], a[0:3], a[112:115], v[36:39]
ds_read_b128 a[36:39], v202 offset:9216
buffer_load_dwordx4 v1, s[8:11], s60 offen offset:3072 sc1 lds
v_mfma_f32_16x16x32_bf16 v[40:43], a[0:3], a[116:119], v[40:43]
ds_read_b128 a[40:43], v202 offset:10240
v_fma_f32 v199, v199, v255, v255
v_mfma_f32_16x16x32_bf16 v[44:47], a[4:7], a[112:115], v[44:47]
ds_read_b128 a[44:47], v202 offset:11264
s_add_u32 m0, s63, 106496
v_mfma_f32_16x16x32_bf16 v[48:51], a[4:7], a[116:119], v[48:51]
ds_read_b128 a[48:51], v202 offset:12288
v_mfma_f32_16x16x32_bf16 v[52:55], a[8:11], a[112:115], v[52:55]
ds_read_b128 a[52:55], v202 offset:13312
s_add_u32 s61, s61, 36864
v_mfma_f32_16x16x32_bf16 v[56:59], a[8:11], a[116:119], v[56:59]
ds_read_b128 a[56:59], v202 offset:14336
v_mfma_f32_16x16x32_bf16 v[60:63], a[12:15], a[112:115], v[60:63]
ds_read_b128 a[60:63], v202 offset:15360
buffer_load_dwordx4 v1, s[8:11], s61 offen offset:0 sc1 lds
v_mfma_f32_16x16x32_bf16 v[64:67], a[12:15], a[116:119], v[64:67]
ds_read_b128 a[64:67], v202 offset:16384
v_mfma_f32_16x16x32_bf16 v[68:71], a[16:19], a[112:115], v[68:71]
ds_read_b128 a[68:71], v202 offset:17408
s_add_u32 m0, s62, 110592
v_mfma_f32_16x16x32_bf16 v[72:75], a[16:19], a[116:119], v[72:75]
s_add_u32 s60, s60, 20480
v_rcp_f32 v196, v196
v_mfma_f32_16x16x32_bf16 v[76:79], a[20:23], a[112:115], v[76:79]
v_rcp_f32 v197, v197
v_mfma_f32_16x16x32_bf16 v[80:83], a[20:23], a[116:119], v[80:83]
v_rcp_f32 v198, v198
v_mfma_f32_16x16x32_bf16 v[84:87], a[24:27], a[112:115], v[84:87]
buffer_load_dwordx4 v1, s[8:11], s60 offen offset:0 sc1 lds
v_mfma_f32_16x16x32_bf16 v[88:91], a[24:27], a[116:119], v[88:91]
v_mfma_f32_16x16x32_bf16 v[92:95], a[28:31], a[112:115], v[92:95]
buffer_load_dwordx4 v1, s[8:11], s60 offen offset:1024 sc1 lds
v_mfma_f32_16x16x32_bf16 v[96:99], a[28:31], a[116:119], v[96:99]
v_mfma_f32_16x16x32_bf16 v[100:103], a[32:35], a[112:115], v[100:103]
v_rcp_f32 v199, v199
v_mfma_f32_16x16x32_bf16 v[104:107], a[32:35], a[116:119], v[104:107]
s_waitcnt lgkmcnt(0)
v_mfma_f32_16x16x32_bf16 v[36:39], a[36:39], a[120:123], v[36:39]
ds_read_b128 a[0:3], v202 offset:18432
buffer_load_dwordx4 v1, s[8:11], s60 offen offset:2048 sc1 lds
v_mfma_f32_16x16x32_bf16 v[40:43], a[36:39], a[124:127], v[40:43]
ds_read_b128 a[4:7], v202 offset:19456
v_mfma_f32_16x16x32_bf16 v[44:47], a[40:43], a[120:123], v[44:47]
ds_read_b128 a[8:11], v202 offset:20480
v_mfma_f32_16x16x32_bf16 v[48:51], a[40:43], a[124:127], v[48:51]
ds_read_b128 a[12:15], v202 offset:21504
v_mul_f32 v160, v160, v196
v_mfma_f32_16x16x32_bf16 v[52:55], a[44:47], a[120:123], v[52:55]
ds_read_b128 a[16:19], v202 offset:22528
buffer_load_dwordx4 v1, s[8:11], s60 offen offset:3072 sc1 lds
v_mfma_f32_16x16x32_bf16 v[56:59], a[44:47], a[124:127], v[56:59]
ds_read_b128 a[20:23], v202 offset:23552
v_mul_f32 v161, v161, v197
v_mfma_f32_16x16x32_bf16 v[60:63], a[48:51], a[120:123], v[60:63]
ds_read_b128 a[24:27], v202 offset:24576
v_mfma_f32_16x16x32_bf16 v[64:67], a[48:51], a[124:127], v[64:67]
ds_read_b128 a[28:31], v202 offset:25600
v_mfma_f32_16x16x32_bf16 v[68:71], a[52:55], a[120:123], v[68:71]
ds_read_b128 a[32:35], v202 offset:26624
buffer_load_dwordx4 a[192:195], v1, s[4:7], s52 offen offset:2048 sc1
v_mfma_f32_16x16x32_bf16 v[72:75], a[52:55], a[124:127], v[72:75]
v_mul_f32 v162, v162, v198
v_mfma_f32_16x16x32_bf16 v[76:79], a[56:59], a[120:123], v[76:79]
v_mul_f32 v163, v163, v199
v_mfma_f32_16x16x32_bf16 v[80:83], a[56:59], a[124:127], v[80:83]
v_mfma_f32_16x16x32_bf16 v[84:87], a[60:63], a[120:123], v[84:87]
buffer_load_dwordx4 a[196:199], v9, s[4:7], s52 offen offset:2048 sc1
v_mul_f32 v192, v164, v164
v_mfma_f32_16x16x32_bf16 v[88:91], a[60:63], a[124:127], v[88:91]
v_mfma_f32_16x16x32_bf16 v[92:95], a[64:67], a[120:123], v[92:95]
v_mfma_f32_16x16x32_bf16 v[96:99], a[64:67], a[124:127], v[96:99]
v_mul_f32 v193, v165, v165
v_mfma_f32_16x16x32_bf16 v[100:103], a[68:71], a[120:123], v[100:103]
v_mfma_f32_16x16x32_bf16 v[104:107], a[68:71], a[124:127], v[104:107]
v_mul_f32 v194, v166, v166
s_waitcnt lgkmcnt(0)
v_mfma_f32_16x16x32_bf16 v[36:39], a[0:3], a[128:131], v[36:39]
ds_read_b128 a[36:39], v202 offset:27648
buffer_load_dwordx4 a[200:203], v1, s[4:7], s52 offen offset:3072 sc1
v_mfma_f32_16x16x32_bf16 v[40:43], a[0:3], a[132:135], v[40:43]
ds_read_b128 a[40:43], v202 offset:28672
v_mul_f32 v195, v167, v167
v_mfma_f32_16x16x32_bf16 v[44:47], a[4:7], a[128:131], v[44:47]
ds_read_b128 a[44:47], v202 offset:29696
buffer_load_dwordx4 a[204:207], v9, s[4:7], s52 offen offset:3072 sc1
v_mfma_f32_16x16x32_bf16 v[48:51], a[4:7], a[132:135], v[48:51]
ds_read_b128 a[48:51], v202 offset:30720
v_mfma_f32_16x16x32_bf16 v[52:55], a[8:11], a[128:131], v[52:55]
ds_read_b128 a[52:55], v202 offset:31744
v_fma_f32 v192, v192, v252, v250
v_mfma_f32_16x16x32_bf16 v[56:59], a[8:11], a[132:135], v[56:59]
ds_read_b128 a[56:59], v202 offset:32768
v_mfma_f32_16x16x32_bf16 v[60:63], a[12:15], a[128:131], v[60:63]
ds_read_b128 a[60:63], v202 offset:33792
v_fma_f32 v193, v193, v252, v250
v_mfma_f32_16x16x32_bf16 v[64:67], a[12:15], a[132:135], v[64:67]
ds_read_b128 a[64:67], v202 offset:34816
v_mfma_f32_16x16x32_bf16 v[68:71], a[16:19], a[128:131], v[68:71]
ds_read_b128 a[68:71], v202 offset:35840
v_fma_f32 v194, v194, v252, v250
v_mfma_f32_16x16x32_bf16 v[72:75], a[16:19], a[132:135], v[72:75]
s_cmp_eq_u32 s25, 11
s_cselect_b32 s98, 4096, 0
s_add_u32 s52, s52, s98
v_mfma_f32_16x16x32_bf16 v[76:79], a[20:23], a[128:131], v[76:79]
s_add_u32 s52, s52, 4096
v_mfma_f32_16x16x32_bf16 v[80:83], a[20:23], a[132:135], v[80:83]
v_fma_f32 v195, v195, v252, v250
v_mfma_f32_16x16x32_bf16 v[84:87], a[24:27], a[128:131], v[84:87]
buffer_load_dwordx4 a[208:211], v1, s[4:7], s52 offen offset:0 sc1
v_mfma_f32_16x16x32_bf16 v[88:91], a[24:27], a[132:135], v[88:91]
v_mul_f32 v192, v192, v164
v_mfma_f32_16x16x32_bf16 v[92:95], a[28:31], a[128:131], v[92:95]
buffer_load_dwordx4 a[212:215], v9, s[4:7], s52 offen offset:0 sc1
v_mfma_f32_16x16x32_bf16 v[96:99], a[28:31], a[132:135], v[96:99]
v_mfma_f32_16x16x32_bf16 v[100:103], a[32:35], a[128:131], v[100:103]
v_mul_f32 v193, v193, v165
v_mfma_f32_16x16x32_bf16 v[104:107], a[32:35], a[132:135], v[104:107]
s_waitcnt vmcnt(23) lgkmcnt(0)
s_barrier
v_mfma_f32_16x16x32_bf16 v[36:39], a[36:39], a[136:139], v[36:39]
ds_read_b128 a[0:3], v200 offset:0
buffer_load_dwordx4 a[216:219], v1, s[4:7], s52 offen offset:1024 sc1
v_mfma_f32_16x16x32_bf16 v[40:43], a[36:39], a[140:143], v[40:43]
ds_read_b128 a[4:7], v200 offset:1024
buffer_load_dwordx4 a[220:223], v9, s[4:7], s52 offen offset:1024 sc1
v_mfma_f32_16x16x32_bf16 v[44:47], a[40:43], a[136:139], v[44:47]
ds_read_b128 a[8:11], v200 offset:2048
v_mul_f32 v194, v194, v166
v_mfma_f32_16x16x32_bf16 v[48:51], a[40:43], a[140:143], v[48:51]
ds_read_b128 a[12:15], v200 offset:3072
v_mul_f32 v195, v195, v167
v_mfma_f32_16x16x32_bf16 v[52:55], a[44:47], a[136:139], v[52:55]
ds_read_b128 a[16:19], v200 offset:4096
v_mfma_f32_16x16x32_bf16 v[56:59], a[44:47], a[140:143], v[56:59]
ds_read_b128 a[20:23], v200 offset:5120
v_mfma_f32_16x16x32_bf16 v[60:63], a[48:51], a[136:139], v[60:63]
ds_read_b128 a[24:27], v200 offset:6144
v_mfma_f32_16x16x32_bf16 v[64:67], a[48:51], a[140:143], v[64:67]
ds_read_b128 a[28:31], v200 offset:7168
v_mfma_f32_16x16x32_bf16 v[68:71], a[52:55], a[136:139], v[68:71]
ds_read_b128 a[32:35], v200 offset:8192
v_mfma_f32_16x16x32_bf16 v[72:75], a[52:55], a[140:143], v[72:75]
s_cmp_eq_u32 s25, 11
s_cselect_b32 s99, 36864, 0
s_add_u32 s60, s60, s99
v_mfma_f32_16x16x32_bf16 v[76:79], a[56:59], a[136:139], v[76:79]
s_add_u32 s61, s61, s99
s_add_u32 m0, s62, 126976
v_mfma_f32_16x16x32_bf16 v[80:83], a[56:59], a[140:143], v[80:83]
s_add_u32 s60, s60, 16384
v_exp_f32 v192, v192
v_mfma_f32_16x16x32_bf16 v[84:87], a[60:63], a[136:139], v[84:87]
v_exp_f32 v193, v193
v_mfma_f32_16x16x32_bf16 v[88:91], a[60:63], a[140:143], v[88:91]
buffer_load_dwordx4 v1, s[8:11], s60 offen offset:0 sc1 lds
v_mfma_f32_16x16x32_bf16 v[92:95], a[64:67], a[136:139], v[92:95]
v_exp_f32 v194, v194
v_mfma_f32_16x16x32_bf16 v[96:99], a[64:67], a[140:143], v[96:99]
buffer_load_dwordx4 v1, s[8:11], s60 offen offset:1024 sc1 lds
v_mfma_f32_16x16x32_bf16 v[100:103], a[68:71], a[136:139], v[100:103]
v_mfma_f32_16x16x32_bf16 v[104:107], a[68:71], a[140:143], v[104:107]
s_waitcnt lgkmcnt(0)
v_mfma_f32_16x16x32_bf16 v[36:39], a[0:3], a[144:147], v[36:39]
ds_read_b128 a[36:39], v200 offset:9216
buffer_load_dwordx4 v1, s[8:11], s60 offen offset:2048 sc1 lds
v_mfma_f32_16x16x32_bf16 v[40:43], a[0:3], a[148:151], v[40:43]
ds_read_b128 a[40:43], v200 offset:10240
v_mfma_f32_16x16x32_bf16 v[44:47], a[4:7], a[144:147], v[44:47]
ds_read_b128 a[44:47], v200 offset:11264
buffer_load_dwordx4 v1, s[8:11], s60 offen offset:3072 sc1 lds
v_mfma_f32_16x16x32_bf16 v[48:51], a[4:7], a[148:151], v[48:51]
ds_read_b128 a[48:51], v200 offset:12288
v_mfma_f32_16x16x32_bf16 v[52:55], a[8:11], a[144:147], v[52:55]
ds_read_b128 a[52:55], v200 offset:13312
s_add_u32 m0, s63, 143360
v_mfma_f32_16x16x32_bf16 v[56:59], a[8:11], a[148:151], v[56:59]
ds_read_b128 a[56:59], v200 offset:14336
v_mfma_f32_16x16x32_bf16 v[60:63], a[12:15], a[144:147], v[60:63]
ds_read_b128 a[60:63], v200 offset:15360
s_add_u32 s61, s61, 36864
v_mfma_f32_16x16x32_bf16 v[64:67], a[12:15], a[148:151], v[64:67]
ds_read_b128 a[64:67], v200 offset:16384
v_mfma_f32_16x16x32_bf16 v[68:71], a[16:19], a[144:147], v[68:71]
ds_read_b128 a[68:71], v200 offset:17408
buffer_load_dwordx4 v1, s[8:11], s61 offen offset:0 sc1 lds
v_mfma_f32_16x16x32_bf16 v[72:75], a[16:19], a[148:151], v[72:75]
s_add_u32 m0, s62, 147456
v_exp_f32 v195, v195
v_mfma_f32_16x16x32_bf16 v[76:79], a[20:23], a[144:147], v[76:79]
s_add_u32 s60, s60, 20480
v_fma_f32 v192, v192, v254, v254
v_fma_f32 v193, v193, v254, v254
v_mfma_f32_16x16x32_bf16 v[80:83], a[20:23], a[148:151], v[80:83]
v_fma_f32 v194, v194, v254, v254
v_mfma_f32_16x16x32_bf16 v[84:87], a[24:27], a[144:147], v[84:87]
v_mfma_f32_16x16x32_bf16 v[88:91], a[24:27], a[148:151], v[88:91]
v_fma_f32 v195, v195, v254, v254
v_mfma_f32_16x16x32_bf16 v[92:95], a[28:31], a[144:147], v[92:95]
buffer_load_dwordx4 v1, s[8:11], s60 offen offset:0 sc1 lds
v_mfma_f32_16x16x32_bf16 v[96:99], a[28:31], a[148:151], v[96:99]
v_rcp_f32 v192, v192
v_mfma_f32_16x16x32_bf16 v[100:103], a[32:35], a[144:147], v[100:103]
v_mfma_f32_16x16x32_bf16 v[104:107], a[32:35], a[148:151], v[104:107]
s_waitcnt vmcnt(27) lgkmcnt(0)
v_mfma_f32_16x16x32_bf16 v[36:39], a[36:39], a[152:155], v[36:39]
ds_read_b128 a[0:3], v200 offset:18432
buffer_load_dwordx4 v1, s[8:11], s60 offen offset:1024 sc1 lds
v_mfma_f32_16x16x32_bf16 v[40:43], a[36:39], a[156:159], v[40:43]
ds_read_b128 a[4:7], v200 offset:19456
v_mfma_f32_16x16x32_bf16 v[44:47], a[40:43], a[152:155], v[44:47]
ds_read_b128 a[8:11], v200 offset:20480
v_mfma_f32_16x16x32_bf16 v[48:51], a[40:43], a[156:159], v[48:51]
ds_read_b128 a[12:15], v200 offset:21504
v_mfma_f32_16x16x32_bf16 v[52:55], a[44:47], a[152:155], v[52:55]
ds_read_b128 a[16:19], v200 offset:22528
buffer_load_dwordx4 v1, s[8:11], s60 offen offset:2048 sc1 lds
v_mfma_f32_16x16x32_bf16 v[56:59], a[44:47], a[156:159], v[56:59]
ds_read_b128 a[20:23], v200 offset:23552
v_mfma_f32_16x16x32_bf16 v[60:63], a[48:51], a[152:155], v[60:63]
ds_read_b128 a[24:27], v200 offset:24576
v_mfma_f32_16x16x32_bf16 v[64:67], a[48:51], a[156:159], v[64:67]
ds_read_b128 a[28:31], v200 offset:25600
v_mfma_f32_16x16x32_bf16 v[68:71], a[52:55], a[152:155], v[68:71]
ds_read_b128 a[32:35], v200 offset:26624
buffer_load_dwordx4 v1, s[8:11], s60 offen offset:3072 sc1 lds
v_mfma_f32_16x16x32_bf16 v[72:75], a[52:55], a[156:159], v[72:75]
v_rcp_f32 v193, v193
v_mfma_f32_16x16x32_bf16 v[76:79], a[56:59], a[152:155], v[76:79]
v_rcp_f32 v194, v194
v_mfma_f32_16x16x32_bf16 v[80:83], a[56:59], a[156:159], v[80:83]
v_rcp_f32 v195, v195
v_mfma_f32_16x16x32_bf16 v[84:87], a[60:63], a[152:155], v[84:87]
buffer_load_dwordx4 a[224:227], v1, s[4:7], s52 offen offset:2048 sc1
v_mfma_f32_16x16x32_bf16 v[88:91], a[60:63], a[156:159], v[88:91]
v_mfma_f32_16x16x32_bf16 v[92:95], a[64:67], a[152:155], v[92:95]
v_mfma_f32_16x16x32_bf16 v[96:99], a[64:67], a[156:159], v[96:99]
v_mfma_f32_16x16x32_bf16 v[100:103], a[68:71], a[152:155], v[100:103]
v_mul_f32 v164, v164, v192
v_mfma_f32_16x16x32_bf16 v[104:107], a[68:71], a[156:159], v[104:107]
s_waitcnt lgkmcnt(0)
v_mfma_f32_16x16x32_bf16 v[36:39], a[0:3], a[160:163], v[36:39]
ds_read_b128 a[36:39], v200 offset:27648
buffer_load_dwordx4 a[228:231], v9, s[4:7], s52 offen offset:2048 sc1
v_mfma_f32_16x16x32_bf16 v[40:43], a[0:3], a[164:167], v[40:43]
ds_read_b128 a[40:43], v200 offset:28672
v_mul_f32 v165, v165, v193
v_mfma_f32_16x16x32_bf16 v[44:47], a[4:7], a[160:163], v[44:47]
ds_read_b128 a[44:47], v200 offset:29696
buffer_load_dwordx4 a[232:235], v1, s[4:7], s52 offen offset:3072 sc1
v_mfma_f32_16x16x32_bf16 v[48:51], a[4:7], a[164:167], v[48:51]
ds_read_b128 a[48:51], v200 offset:30720
v_mul_f32 v166, v166, v194
v_mfma_f32_16x16x32_bf16 v[52:55], a[8:11], a[160:163], v[52:55]
ds_read_b128 a[52:55], v200 offset:31744
buffer_load_dwordx4 a[236:239], v9, s[4:7], s52 offen offset:3072 sc1
v_mfma_f32_16x16x32_bf16 v[56:59], a[8:11], a[164:167], v[56:59]
ds_read_b128 a[56:59], v200 offset:32768
v_mul_f32 v167, v167, v195
v_mfma_f32_16x16x32_bf16 v[60:63], a[12:15], a[160:163], v[60:63]
ds_read_b128 a[60:63], v200 offset:33792
v_mfma_f32_16x16x32_bf16 v[64:67], a[12:15], a[164:167], v[64:67]
ds_read_b128 a[64:67], v200 offset:34816
v_mul_f32 v196, v168, v168
v_mfma_f32_16x16x32_bf16 v[68:71], a[16:19], a[160:163], v[68:71]
ds_read_b128 a[68:71], v200 offset:35840
v_mfma_f32_16x16x32_bf16 v[72:75], a[16:19], a[164:167], v[72:75]
s_cmp_eq_u32 s25, 12
s_cselect_b32 s98, 4096, 0
v_mfma_f32_16x16x32_bf16 v[76:79], a[20:23], a[160:163], v[76:79]
s_add_u32 s52, s52, s98
v_mul_f32 v197, v169, v169
v_mfma_f32_16x16x32_bf16 v[80:83], a[20:23], a[164:167], v[80:83]
s_add_u32 s52, s52, 4096
v_mfma_f32_16x16x32_bf16 v[84:87], a[24:27], a[160:163], v[84:87]
v_mul_f32 v198, v170, v170
v_mfma_f32_16x16x32_bf16 v[88:91], a[24:27], a[164:167], v[88:91]
v_mfma_f32_16x16x32_bf16 v[92:95], a[28:31], a[160:163], v[92:95]
buffer_load_dwordx4 a[240:243], v1, s[4:7], s52 offen offset:0 sc1
v_mul_f32 v199, v171, v171
v_mfma_f32_16x16x32_bf16 v[96:99], a[28:31], a[164:167], v[96:99]
v_mfma_f32_16x16x32_bf16 v[100:103], a[32:35], a[160:163], v[100:103]
v_mfma_f32_16x16x32_bf16 v[104:107], a[32:35], a[164:167], v[104:107]
s_waitcnt vmcnt(22) lgkmcnt(0)
s_barrier
v_mfma_f32_16x16x32_bf16 v[36:39], a[36:39], a[168:171], v[36:39]
ds_read_b128 a[0:3], v201 offset:0
buffer_load_dwordx4 a[244:247], v9, s[4:7], s52 offen offset:0 sc1
v_mfma_f32_16x16x32_bf16 v[40:43], a[36:39], a[172:175], v[40:43]
ds_read_b128 a[4:7], v201 offset:1024
buffer_load_dwordx4 a[248:251], v1, s[4:7], s52 offen offset:1024 sc1
v_mfma_f32_16x16x32_bf16 v[44:47], a[40:43], a[168:171], v[44:47]
ds_read_b128 a[8:11], v201 offset:2048
v_fma_f32 v196, v196, v253, v251
v_mfma_f32_16x16x32_bf16 v[48:51], a[40:43], a[172:175], v[48:51]
ds_read_b128 a[12:15], v201 offset:3072
buffer_load_dwordx4 a[252:255], v9, s[4:7], s52 offen offset:1024 sc1
v_mfma_f32_16x16x32_bf16 v[52:55], a[44:47], a[168:171], v[52:55]
ds_read_b128 a[16:19], v201 offset:4096
v_fma_f32 v197, v197, v253, v251
v_mfma_f32_16x16x32_bf16 v[56:59], a[44:47], a[172:175], v[56:59]
ds_read_b128 a[20:23], v201 offset:5120
v_fma_f32 v198, v198, v253, v251
v_mfma_f32_16x16x32_bf16 v[60:63], a[48:51], a[168:171], v[60:63]
ds_read_b128 a[24:27], v201 offset:6144
v_fma_f32 v199, v199, v253, v251
v_mfma_f32_16x16x32_bf16 v[64:67], a[48:51], a[172:175], v[64:67]
ds_read_b128 a[28:31], v201 offset:7168
v_mfma_f32_16x16x32_bf16 v[68:71], a[52:55], a[168:171], v[68:71]
ds_read_b128 a[32:35], v201 offset:8192
v_mul_f32 v196, v196, v168
v_mfma_f32_16x16x32_bf16 v[72:75], a[52:55], a[172:175], v[72:75]
s_cmp_eq_u32 s25, 12
s_cselect_b32 s99, 36864, 0
s_add_u32 s60, s60, s99
v_mfma_f32_16x16x32_bf16 v[76:79], a[56:59], a[168:171], v[76:79]
s_add_u32 s61, s61, s99
v_mul_f32 v197, v197, v169
v_mfma_f32_16x16x32_bf16 v[80:83], a[56:59], a[172:175], v[80:83]
s_add_u32 m0, s62, 53248
v_mfma_f32_16x16x32_bf16 v[84:87], a[60:63], a[168:171], v[84:87]
s_add_u32 s60, s60, 16384
v_mfma_f32_16x16x32_bf16 v[88:91], a[60:63], a[172:175], v[88:91]
v_mul_f32 v198, v198, v170
v_mfma_f32_16x16x32_bf16 v[92:95], a[64:67], a[168:171], v[92:95]
v_mfma_f32_16x16x32_bf16 v[96:99], a[64:67], a[172:175], v[96:99]
buffer_load_dwordx4 v1, s[8:11], s60 offen offset:0 sc1 lds
v_mul_f32 v199, v199, v171
v_mfma_f32_16x16x32_bf16 v[100:103], a[68:71], a[168:171], v[100:103]
v_mfma_f32_16x16x32_bf16 v[104:107], a[68:71], a[172:175], v[104:107]
s_waitcnt lgkmcnt(0)
v_mfma_f32_16x16x32_bf16 v[36:39], a[0:3], a[176:179], v[36:39]
ds_read_b128 a[36:39], v201 offset:9216
buffer_load_dwordx4 v1, s[8:11], s60 offen offset:1024 sc1 lds
v_mfma_f32_16x16x32_bf16 v[40:43], a[0:3], a[180:183], v[40:43]
ds_read_b128 a[40:43], v201 offset:10240
s_mov_b32 s37, L_c4+18432-L_pc
v_mfma_f32_16x16x32_bf16 v[44:47], a[4:7], a[176:179], v[44:47]
ds_read_b128 a[44:47], v201 offset:11264
buffer_load_dwordx4 v1, s[8:11], s60 offen offset:2048 sc1 lds
v_mfma_f32_16x16x32_bf16 v[48:51], a[4:7], a[180:183], v[48:51]
ds_read_b128 a[48:51], v201 offset:12288
v_mfma_f32_16x16x32_bf16 v[52:55], a[8:11], a[176:179], v[52:55]
ds_read_b128 a[52:55], v201 offset:13312
buffer_load_dword v15, v14, s[88:91], s37 offen
v_mfma_f32_16x16x32_bf16 v[56:59], a[8:11], a[180:183], v[56:59]
ds_read_b128 a[56:59], v201 offset:14336
buffer_load_dwordx4 v1, s[8:11], s60 offen offset:3072 sc1 lds
v_mfma_f32_16x16x32_bf16 v[60:63], a[12:15], a[176:179], v[60:63]
ds_read_b128 a[60:63], v201 offset:15360
v_mfma_f32_16x16x32_bf16 v[64:67], a[12:15], a[180:183], v[64:67]
ds_read_b128 a[64:67], v201 offset:16384
v_mfma_f32_16x16x32_bf16 v[68:71], a[16:19], a[176:179], v[68:71]
ds_read_b128 a[68:71], v201 offset:17408
s_add_u32 m0, s63, 69632
v_mfma_f32_16x16x32_bf16 v[72:75], a[16:19], a[180:183], v[72:75]
s_add_u32 s61, s61, 36864
v_exp_f32 v196, v196
v_mfma_f32_16x16x32_bf16 v[76:79], a[20:23], a[176:179], v[76:79]
v_exp_f32 v197, v197
v_mfma_f32_16x16x32_bf16 v[80:83], a[20:23], a[180:183], v[80:83]
v_exp_f32 v198, v198
v_mfma_f32_16x16x32_bf16 v[84:87], a[24:27], a[176:179], v[84:87]
v_mfma_f32_16x16x32_bf16 v[88:91], a[24:27], a[180:183], v[88:91]
v_mfma_f32_16x16x32_bf16 v[92:95], a[28:31], a[176:179], v[92:95]
buffer_load_dwordx4 v1, s[8:11], s61 offen offset:0 sc1 lds
v_mfma_f32_16x16x32_bf16 v[96:99], a[28:31], a[180:183], v[96:99]
v_exp_f32 v199, v199
v_mfma_f32_16x16x32_bf16 v[100:103], a[32:35], a[176:179], v[100:103]
v_mfma_f32_16x16x32_bf16 v[104:107], a[32:35], a[180:183], v[104:107]
s_waitcnt vmcnt(27) lgkmcnt(0)
v_mfma_f32_16x16x32_bf16 v[36:39], a[36:39], a[184:187], v[36:39]
ds_read_b128 a[0:3], v201 offset:18432
s_add_u32 m0, s62, 73728
v_mfma_f32_16x16x32_bf16 v[40:43], a[36:39], a[188:191], v[40:43]
ds_read_b128 a[4:7], v201 offset:19456
v_fma_f32 v196, v196, v255, v255
v_mfma_f32_16x16x32_bf16 v[44:47], a[40:43], a[184:187], v[44:47]
ds_read_b128 a[8:11], v201 offset:20480
s_add_u32 s60, s60, 20480
v_mfma_f32_16x16x32_bf16 v[48:51], a[40:43], a[188:191], v[48:51]
ds_read_b128 a[12:15], v201 offset:21504
v_fma_f32 v197, v197, v255, v255
v_mfma_f32_16x16x32_bf16 v[52:55], a[44:47], a[184:187], v[52:55]
ds_read_b128 a[16:19], v201 offset:22528
v_mfma_f32_16x16x32_bf16 v[56:59], a[44:47], a[188:191], v[56:59]
ds_read_b128 a[20:23], v201 offset:23552
buffer_load_dwordx4 v1, s[8:11], s60 offen offset:0 sc1 lds
v_mfma_f32_16x16x32_bf16 v[60:63], a[48:51], a[184:187], v[60:63]
ds_read_b128 a[24:27], v201 offset:24576
v_fma_f32 v198, v198, v255, v255
v_mfma_f32_16x16x32_bf16 v[64:67], a[48:51], a[188:191], v[64:67]
ds_read_b128 a[28:31], v201 offset:25600
v_fma_f32 v199, v199, v255, v255
v_mfma_f32_16x16x32_bf16 v[68:71], a[52:55], a[184:187], v[68:71]
ds_read_b128 a[32:35], v201 offset:26624
buffer_load_dwordx4 v1, s[8:11], s60 offen offset:1024 sc1 lds
v_mfma_f32_16x16x32_bf16 v[72:75], a[52:55], a[188:191], v[72:75]
v_mfma_f32_16x16x32_bf16 v[76:79], a[56:59], a[184:187], v[76:79]
v_rcp_f32 v196, v196
v_mfma_f32_16x16x32_bf16 v[80:83], a[56:59], a[188:191], v[80:83]
buffer_load_dwordx4 v1, s[8:11], s60 offen offset:2048 sc1 lds
v_mfma_f32_16x16x32_bf16 v[84:87], a[60:63], a[184:187], v[84:87]
v_mfma_f32_16x16x32_bf16 v[88:91], a[60:63], a[188:191], v[88:91]
v_mfma_f32_16x16x32_bf16 v[92:95], a[64:67], a[184:187], v[92:95]
buffer_load_dwordx4 v1, s[8:11], s60 offen offset:3072 sc1 lds
v_mfma_f32_16x16x32_bf16 v[96:99], a[64:67], a[188:191], v[96:99]
v_rcp_f32 v197, v197
v_mfma_f32_16x16x32_bf16 v[100:103], a[68:71], a[184:187], v[100:103]
v_mfma_f32_16x16x32_bf16 v[104:107], a[68:71], a[188:191], v[104:107]
s_waitcnt lgkmcnt(0)
v_mfma_f32_16x16x32_bf16 v[36:39], a[0:3], a[192:195], v[36:39]
ds_read_b128 a[36:39], v201 offset:27648
buffer_load_dwordx4 a[80:83], v1, s[4:7], s52 offen offset:2048 sc1
v_mfma_f32_16x16x32_bf16 v[40:43], a[0:3], a[196:199], v[40:43]
ds_read_b128 a[40:43], v201 offset:28672
v_mfma_f32_16x16x32_bf16 v[44:47], a[4:7], a[192:195], v[44:47]
ds_read_b128 a[44:47], v201 offset:29696
v_mfma_f32_16x16x32_bf16 v[48:51], a[4:7], a[196:199], v[48:51]
ds_read_b128 a[48:51], v201 offset:30720
v_mfma_f32_16x16x32_bf16 v[52:55], a[8:11], a[192:195], v[52:55]
ds_read_b128 a[52:55], v201 offset:31744
buffer_load_dwordx4 a[84:87], v9, s[4:7], s52 offen offset:2048 sc1
v_mfma_f32_16x16x32_bf16 v[56:59], a[8:11], a[196:199], v[56:59]
ds_read_b128 a[56:59], v201 offset:32768
v_mfma_f32_16x16x32_bf16 v[60:63], a[12:15], a[192:195], v[60:63]
ds_read_b128 a[60:63], v201 offset:33792
v_mfma_f32_16x16x32_bf16 v[64:67], a[12:15], a[196:199], v[64:67]
ds_read_b128 a[64:67], v201 offset:34816
v_mfma_f32_16x16x32_bf16 v[68:71], a[16:19], a[192:195], v[68:71]
ds_read_b128 a[68:71], v201 offset:35840
buffer_load_dwordx4 a[88:91], v1, s[4:7], s52 offen offset:3072 sc1
v_mfma_f32_16x16x32_bf16 v[72:75], a[16:19], a[196:199], v[72:75]
v_rcp_f32 v198, v198
v_mfma_f32_16x16x32_bf16 v[76:79], a[20:23], a[192:195], v[76:79]
v_rcp_f32 v199, v199
v_mfma_f32_16x16x32_bf16 v[80:83], a[20:23], a[196:199], v[80:83]
v_mul_f32 v168, v168, v196
v_mfma_f32_16x16x32_bf16 v[84:87], a[24:27], a[192:195], v[84:87]
buffer_load_dwordx4 a[92:95], v9, s[4:7], s52 offen offset:3072 sc1
v_mfma_f32_16x16x32_bf16 v[88:91], a[24:27], a[196:199], v[88:91]
v_mul_f32 v169, v169, v197
v_mfma_f32_16x16x32_bf16 v[92:95], a[28:31], a[192:195], v[92:95]
v_mfma_f32_16x16x32_bf16 v[96:99], a[28:31], a[196:199], v[96:99]
v_mul_f32 v170, v170, v198
v_mfma_f32_16x16x32_bf16 v[100:103], a[32:35], a[192:195], v[100:103]
v_mfma_f32_16x16x32_bf16 v[104:107], a[32:35], a[196:199], v[104:107]
s_waitcnt vmcnt(22) lgkmcnt(0)
s_barrier
v_mfma_f32_16x16x32_bf16 v[36:39], a[36:39], a[200:203], v[36:39]
ds_read_b128 a[0:3], v202 offset:0
v_mul_f32 v171, v171, v199
v_mfma_f32_16x16x32_bf16 v[40:43], a[36:39], a[204:207], v[40:43]
ds_read_b128 a[4:7], v202 offset:1024
v_mfma_f32_16x16x32_bf16 v[44:47], a[40:43], a[200:203], v[44:47]
ds_read_b128 a[8:11], v202 offset:2048
v_mul_f32 v192, v172, v172
v_mfma_f32_16x16x32_bf16 v[48:51], a[40:43], a[204:207], v[48:51]
ds_read_b128 a[12:15], v202 offset:3072
v_mfma_f32_16x16x32_bf16 v[52:55], a[44:47], a[200:203], v[52:55]
ds_read_b128 a[16:19], v202 offset:4096
v_mul_f32 v193, v173, v173
v_mfma_f32_16x16x32_bf16 v[56:59], a[44:47], a[204:207], v[56:59]
ds_read_b128 a[20:23], v202 offset:5120
v_mfma_f32_16x16x32_bf16 v[60:63], a[48:51], a[200:203], v[60:63]
ds_read_b128 a[24:27], v202 offset:6144
v_mfma_f32_16x16x32_bf16 v[64:67], a[48:51], a[204:207], v[64:67]
ds_read_b128 a[28:31], v202 offset:7168
v_mul_f32 v194, v174, v174
v_mfma_f32_16x16x32_bf16 v[68:71], a[52:55], a[200:203], v[68:71]
ds_read_b128 a[32:35], v202 offset:8192
v_mfma_f32_16x16x32_bf16 v[72:75], a[52:55], a[204:207], v[72:75]
s_cmp_eq_u32 s25, 13
s_cselect_b32 s99, 36864, 0
s_add_u32 s60, s60, s99
v_mfma_f32_16x16x32_bf16 v[76:79], a[56:59], a[200:203], v[76:79]
s_add_u32 s61, s61, s99
s_add_u32 m0, s62, 90112
s_add_u32 s60, s60, 16384
v_mfma_f32_16x16x32_bf16 v[80:83], a[56:59], a[204:207], v[80:83]
buffer_load_dwordx4 v1, s[8:11], s60 offen offset:0 sc1 lds
v_mul_f32 v195, v175, v175
v_mfma_f32_16x16x32_bf16 v[84:87], a[60:63], a[200:203], v[84:87]
buffer_load_dwordx4 v1, s[8:11], s60 offen offset:1024 sc1 lds
v_fma_f32 v192, v192, v252, v250
v_mfma_f32_16x16x32_bf16 v[88:91], a[60:63], a[204:207], v[88:91]
buffer_load_dwordx4 v1, s[8:11], s60 offen offset:2048 sc1 lds
v_mfma_f32_16x16x32_bf16 v[92:95], a[64:67], a[200:203], v[92:95]
v_fma_f32 v193, v193, v252, v250
v_mfma_f32_16x16x32_bf16 v[96:99], a[64:67], a[204:207], v[96:99]
buffer_load_dwordx4 v1, s[8:11], s60 offen offset:3072 sc1 lds
v_mfma_f32_16x16x32_bf16 v[100:103], a[68:71], a[200:203], v[100:103]
v_fma_f32 v194, v194, v252, v250
v_mfma_f32_16x16x32_bf16 v[104:107], a[68:71], a[204:207], v[104:107]
s_waitcnt lgkmcnt(0)
v_mfma_f32_16x16x32_bf16 v[36:39], a[0:3], a[208:211], v[36:39]
ds_read_b128 a[36:39], v202 offset:9216
s_add_u32 m0, s63, 106496
v_mfma_f32_16x16x32_bf16 v[40:43], a[0:3], a[212:215], v[40:43]
ds_read_b128 a[40:43], v202 offset:10240
v_fma_f32 v195, v195, v252, v250
v_mfma_f32_16x16x32_bf16 v[44:47], a[4:7], a[208:211], v[44:47]
ds_read_b128 a[44:47], v202 offset:11264
s_add_u32 s61, s61, 36864
v_mfma_f32_16x16x32_bf16 v[48:51], a[4:7], a[212:215], v[48:51]
ds_read_b128 a[48:51], v202 offset:12288
v_mul_f32 v192, v192, v172
v_mfma_f32_16x16x32_bf16 v[52:55], a[8:11], a[208:211], v[52:55]
ds_read_b128 a[52:55], v202 offset:13312
buffer_load_dwordx4 v1, s[8:11], s61 offen offset:0 sc1 lds
v_mfma_f32_16x16x32_bf16 v[56:59], a[8:11], a[212:215], v[56:59]
ds_read_b128 a[56:59], v202 offset:14336
v_mul_f32 v193, v193, v173
v_mfma_f32_16x16x32_bf16 v[60:63], a[12:15], a[208:211], v[60:63]
ds_read_b128 a[60:63], v202 offset:15360
s_add_u32 m0, s62, 110592
v_mfma_f32_16x16x32_bf16 v[64:67], a[12:15], a[212:215], v[64:67]
ds_read_b128 a[64:67], v202 offset:16384
v_mfma_f32_16x16x32_bf16 v[68:71], a[16:19], a[208:211], v[68:71]
ds_read_b128 a[68:71], v202 offset:17408
s_add_u32 s60, s60, 20480
v_mfma_f32_16x16x32_bf16 v[72:75], a[16:19], a[212:215], v[72:75]
v_mul_f32 v194, v194, v174
v_mfma_f32_16x16x32_bf16 v[76:79], a[20:23], a[208:211], v[76:79]
buffer_load_dwordx4 v1, s[8:11], s60 offen offset:0 sc1 lds
v_mul_f32 v195, v195, v175
v_mfma_f32_16x16x32_bf16 v[80:83], a[20:23], a[212:215], v[80:83]
v_mfma_f32_16x16x32_bf16 v[84:87], a[24:27], a[208:211], v[84:87]
buffer_load_dwordx4 v1, s[8:11], s60 offen offset:1024 sc1 lds
v_mfma_f32_16x16x32_bf16 v[88:91], a[24:27], a[212:215], v[88:91]
v_exp_f32 v192, v192
v_mfma_f32_16x16x32_bf16 v[92:95], a[28:31], a[208:211], v[92:95]
buffer_load_dwordx4 v1, s[8:11], s60 offen offset:2048 sc1 lds
v_mfma_f32_16x16x32_bf16 v[96:99], a[28:31], a[212:215], v[96:99]
v_mfma_f32_16x16x32_bf16 v[100:103], a[32:35], a[208:211], v[100:103]
v_mfma_f32_16x16x32_bf16 v[104:107], a[32:35], a[212:215], v[104:107]
s_waitcnt vmcnt(26) lgkmcnt(0)
v_mfma_f32_16x16x32_bf16 v[36:39], a[36:39], a[216:219], v[36:39]
ds_read_b128 a[0:3], v202 offset:18432
buffer_load_dwordx4 v1, s[8:11], s60 offen offset:3072 sc1 lds
v_mfma_f32_16x16x32_bf16 v[40:43], a[36:39], a[220:223], v[40:43]
ds_read_b128 a[4:7], v202 offset:19456
v_mfma_f32_16x16x32_bf16 v[44:47], a[40:43], a[216:219], v[44:47]
ds_read_b128 a[8:11], v202 offset:20480
v_mfma_f32_16x16x32_bf16 v[48:51], a[40:43], a[220:223], v[48:51]
ds_read_b128 a[12:15], v202 offset:21504
v_mfma_f32_16x16x32_bf16 v[52:55], a[44:47], a[216:219], v[52:55]
ds_read_b128 a[16:19], v202 offset:22528
v_mfma_f32_16x16x32_bf16 v[56:59], a[44:47], a[220:223], v[56:59]
ds_read_b128 a[20:23], v202 offset:23552
v_mfma_f32_16x16x32_bf16 v[60:63], a[48:51], a[216:219], v[60:63]
ds_read_b128 a[24:27], v202 offset:24576
v_mfma_f32_16x16x32_bf16 v[64:67], a[48:51], a[220:223], v[64:67]
ds_read_b128 a[28:31], v202 offset:25600
v_mfma_f32_16x16x32_bf16 v[68:71], a[52:55], a[216:219], v[68:71]
ds_read_b128 a[32:35], v202 offset:26624
v_mfma_f32_16x16x32_bf16 v[72:75], a[52:55], a[220:223], v[72:75]
s_cmp_eq_u32 s25, 13
s_cselect_b32 s98, 4096, 0
s_add_u32 s52, s52, s98
v_mfma_f32_16x16x32_bf16 v[76:79], a[56:59], a[216:219], v[76:79]
s_add_u32 s52, s52, 4096
v_exp_f32 v193, v193
v_mfma_f32_16x16x32_bf16 v[80:83], a[56:59], a[220:223], v[80:83]
buffer_load_dwordx4 a[96:99], v1, s[4:7], s52 offen offset:0 sc1
v_mfma_f32_16x16x32_bf16 v[84:87], a[60:63], a[216:219], v[84:87]
buffer_load_dwordx4 a[100:103], v9, s[4:7], s52 offen offset:0 sc1
v_mfma_f32_16x16x32_bf16 v[88:91], a[60:63], a[220:223], v[88:91]
v_exp_f32 v194, v194
v_mfma_f32_16x16x32_bf16 v[92:95], a[64:67], a[216:219], v[92:95]
buffer_load_dwordx4 a[104:107], v1, s[4:7], s52 offen offset:1024 sc1
v_mfma_f32_16x16x32_bf16 v[96:99], a[64:67], a[220:223], v[96:99]
v_exp_f32 v195, v195
v_mfma_f32_16x16x32_bf16 v[100:103], a[68:71], a[216:219], v[100:103]
v_fma_f32 v192, v192, v254, v254
v_fma_f32 v193, v193, v254, v254
v_mfma_f32_16x16x32_bf16 v[104:107], a[68:71], a[220:223], v[104:107]
s_waitcnt lgkmcnt(0)
v_mfma_f32_16x16x32_bf16 v[36:39], a[0:3], a[224:227], v[36:39]
ds_read_b128 a[36:39], v202 offset:27648
buffer_load_dwordx4 a[108:111], v9, s[4:7], s52 offen offset:1024 sc1
v_mfma_f32_16x16x32_bf16 v[40:43], a[0:3], a[228:231], v[40:43]
ds_read_b128 a[40:43], v202 offset:28672
v_fma_f32 v194, v194, v254, v254
v_mfma_f32_16x16x32_bf16 v[44:47], a[4:7], a[224:227], v[44:47]
ds_read_b128 a[44:47], v202 offset:29696
v_fma_f32 v195, v195, v254, v254
v_mfma_f32_16x16x32_bf16 v[48:51], a[4:7], a[228:231], v[48:51]
ds_read_b128 a[48:51], v202 offset:30720
v_mfma_f32_16x16x32_bf16 v[52:55], a[8:11], a[224:227], v[52:55]
ds_read_b128 a[52:55], v202 offset:31744
buffer_load_dwordx4 a[112:115], v1, s[4:7], s52 offen offset:2048 sc1
v_mfma_f32_16x16x32_bf16 v[56:59], a[8:11], a[228:231], v[56:59]
ds_read_b128 a[56:59], v202 offset:32768
v_mfma_f32_16x16x32_bf16 v[60:63], a[12:15], a[224:227], v[60:63]
ds_read_b128 a[60:63], v202 offset:33792
v_mfma_f32_16x16x32_bf16 v[64:67], a[12:15], a[228:231], v[64:67]
ds_read_b128 a[64:67], v202 offset:34816
v_mfma_f32_16x16x32_bf16 v[68:71], a[16:19], a[224:227], v[68:71]
ds_read_b128 a[68:71], v202 offset:35840
buffer_load_dwordx4 a[116:119], v9, s[4:7], s52 offen offset:2048 sc1
v_mfma_f32_16x16x32_bf16 v[72:75], a[16:19], a[228:231], v[72:75]
v_rcp_f32 v192, v192
v_mfma_f32_16x16x32_bf16 v[76:79], a[20:23], a[224:227], v[76:79]
v_rcp_f32 v193, v193
v_mfma_f32_16x16x32_bf16 v[80:83], a[20:23], a[228:231], v[80:83]
v_mfma_f32_16x16x32_bf16 v[84:87], a[24:27], a[224:227], v[84:87]
buffer_load_dwordx4 a[120:123], v1, s[4:7], s52 offen offset:3072 sc1
v_mfma_f32_16x16x32_bf16 v[88:91], a[24:27], a[228:231], v[88:91]
v_mfma_f32_16x16x32_bf16 v[92:95], a[28:31], a[224:227], v[92:95]
v_rcp_f32 v194, v194
v_mfma_f32_16x16x32_bf16 v[96:99], a[28:31], a[228:231], v[96:99]
v_mfma_f32_16x16x32_bf16 v[100:103], a[32:35], a[224:227], v[100:103]
v_mfma_f32_16x16x32_bf16 v[104:107], a[32:35], a[228:231], v[104:107]
s_waitcnt vmcnt(20) lgkmcnt(0)
s_barrier
v_mfma_f32_16x16x32_bf16 v[36:39], a[36:39], a[232:235], v[36:39]
ds_read_b128 a[0:3], v200 offset:0
buffer_load_dwordx4 a[124:127], v9, s[4:7], s52 offen offset:3072 sc1
v_mfma_f32_16x16x32_bf16 v[40:43], a[36:39], a[236:239], v[40:43]
ds_read_b128 a[4:7], v200 offset:1024
v_mfma_f32_16x16x32_bf16 v[44:47], a[40:43], a[232:235], v[44:47]
ds_read_b128 a[8:11], v200 offset:2048
v_mfma_f32_16x16x32_bf16 v[48:51], a[40:43], a[236:239], v[48:51]
ds_read_b128 a[12:15], v200 offset:3072
v_mfma_f32_16x16x32_bf16 v[52:55], a[44:47], a[232:235], v[52:55]
ds_read_b128 a[16:19], v200 offset:4096
v_mfma_f32_16x16x32_bf16 v[56:59], a[44:47], a[236:239], v[56:59]
ds_read_b128 a[20:23], v200 offset:5120
v_mfma_f32_16x16x32_bf16 v[60:63], a[48:51], a[232:235], v[60:63]
ds_read_b128 a[24:27], v200 offset:6144
v_mfma_f32_16x16x32_bf16 v[64:67], a[48:51], a[236:239], v[64:67]
ds_read_b128 a[28:31], v200 offset:7168
v_mfma_f32_16x16x32_bf16 v[68:71], a[52:55], a[232:235], v[68:71]
ds_read_b128 a[32:35], v200 offset:8192
v_mfma_f32_16x16x32_bf16 v[72:75], a[52:55], a[236:239], v[72:75]
s_cmp_eq_u32 s25, 14
s_cselect_b32 s99, 36864, 0
s_add_u32 s60, s60, s99
v_mfma_f32_16x16x32_bf16 v[76:79], a[56:59], a[232:235], v[76:79]
s_add_u32 s61, s61, s99
s_add_u32 m0, s62, 126976
s_add_u32 s60, s60, 16384
v_mfma_f32_16x16x32_bf16 v[80:83], a[56:59], a[236:239], v[80:83]
buffer_load_dwordx4 v1, s[8:11], s60 offen offset:0 sc1 lds
v_mfma_f32_16x16x32_bf16 v[84:87], a[60:63], a[232:235], v[84:87]
v_rcp_f32 v195, v195
v_mfma_f32_16x16x32_bf16 v[88:91], a[60:63], a[236:239], v[88:91]
buffer_load_dwordx4 v1, s[8:11], s60 offen offset:1024 sc1 lds
v_mul_f32 v172, v172, v192
v_mfma_f32_16x16x32_bf16 v[92:95], a[64:67], a[232:235], v[92:95]
v_mul_f32 v173, v173, v193
v_mul_f32 v174, v174, v194
v_mfma_f32_16x16x32_bf16 v[96:99], a[64:67], a[236:239], v[96:99]
buffer_load_dwordx4 v1, s[8:11], s60 offen offset:2048 sc1 lds
v_mul_f32 v175, v175, v195
v_mfma_f32_16x16x32_bf16 v[100:103], a[68:71], a[232:235], v[100:103]
v_mul_f32 v196, v176, v176
v_mfma_f32_16x16x32_bf16 v[104:107], a[68:71], a[236:239], v[104:107]
v_mul_f32 v197, v177, v177
s_waitcnt lgkmcnt(0)
v_mfma_f32_16x16x32_bf16 v[36:39], a[0:3], a[240:243], v[36:39]
ds_read_b128 a[36:39], v200 offset:9216
buffer_load_dwordx4 v1, s[8:11], s60 offen offset:3072 sc1 lds
v_mfma_f32_16x16x32_bf16 v[40:43], a[0:3], a[244:247], v[40:43]
ds_read_b128 a[40:43], v200 offset:10240
v_mfma_f32_16x16x32_bf16 v[44:47], a[4:7], a[240:243], v[44:47]
ds_read_b128 a[44:47], v200 offset:11264
s_add_u32 m0, s63, 143360
v_mfma_f32_16x16x32_bf16 v[48:51], a[4:7], a[244:247], v[48:51]
ds_read_b128 a[48:51], v200 offset:12288
v_mul_f32 v198, v178, v178
v_mfma_f32_16x16x32_bf16 v[52:55], a[8:11], a[240:243], v[52:55]
ds_read_b128 a[52:55], v200 offset:13312
s_add_u32 s61, s61, 36864
v_mfma_f32_16x16x32_bf16 v[56:59], a[8:11], a[244:247], v[56:59]
ds_read_b128 a[56:59], v200 offset:14336
v_mul_f32 v199, v179, v179
v_mfma_f32_16x16x32_bf16 v[60:63], a[12:15], a[240:243], v[60:63]
ds_read_b128 a[60:63], v200 offset:15360
buffer_load_dwordx4 v1, s[8:11], s61 offen offset:0 sc1 lds
v_mfma_f32_16x16x32_bf16 v[64:67], a[12:15], a[244:247], v[64:67]
ds_read_b128 a[64:67], v200 offset:16384
v_fma_f32 v196, v196, v253, v251
v_mfma_f32_16x16x32_bf16 v[68:71], a[16:19], a[240:243], v[68:71]
ds_read_b128 a[68:71], v200 offset:17408
s_add_u32 m0, s62, 147456
v_mfma_f32_16x16x32_bf16 v[72:75], a[16:19], a[244:247], v[72:75]
s_add_u32 s60, s60, 20480
v_fma_f32 v197, v197, v253, v251
v_mfma_f32_16x16x32_bf16 v[76:79], a[20:23], a[240:243], v[76:79]
v_mfma_f32_16x16x32_bf16 v[80:83], a[20:23], a[244:247], v[80:83]
v_fma_f32 v198, v198, v253, v251
v_mfma_f32_16x16x32_bf16 v[84:87], a[24:27], a[240:243], v[84:87]
buffer_load_dwordx4 v1, s[8:11], s60 offen offset:0 sc1 lds
v_mfma_f32_16x16x32_bf16 v[88:91], a[24:27], a[244:247], v[88:91]
v_fma_f32 v199, v199, v253, v251
v_mfma_f32_16x16x32_bf16 v[92:95], a[28:31], a[240:243], v[92:95]
buffer_load_dwordx4 v1, s[8:11], s60 offen offset:1024 sc1 lds
v_mfma_f32_16x16x32_bf16 v[96:99], a[28:31], a[244:247], v[96:99]
v_mfma_f32_16x16x32_bf16 v[100:103], a[32:35], a[240:243], v[100:103]
v_mul_f32 v196, v196, v176
v_mfma_f32_16x16x32_bf16 v[104:107], a[32:35], a[244:247], v[104:107]
s_waitcnt vmcnt(24) lgkmcnt(0)
v_mfma_f32_16x16x32_bf16 v[36:39], a[36:39], a[248:251], v[36:39]
ds_read_b128 a[0:3], v200 offset:18432
buffer_load_dwordx4 v1, s[8:11], s60 offen offset:2048 sc1 lds
v_mfma_f32_16x16x32_bf16 v[40:43], a[36:39], a[252:255], v[40:43]
ds_read_b128 a[4:7], v200 offset:19456
v_mul_f32 v197, v197, v177
v_mfma_f32_16x16x32_bf16 v[44:47], a[40:43], a[248:251], v[44:47]
ds_read_b128 a[8:11], v200 offset:20480
buffer_load_dwordx4 v1, s[8:11], s60 offen offset:3072 sc1 lds
v_mfma_f32_16x16x32_bf16 v[48:51], a[40:43], a[252:255], v[48:51]
ds_read_b128 a[12:15], v200 offset:21504
v_mul_f32 v198, v198, v178
v_mfma_f32_16x16x32_bf16 v[52:55], a[44:47], a[248:251], v[52:55]
ds_read_b128 a[16:19], v200 offset:22528
v_mfma_f32_16x16x32_bf16 v[56:59], a[44:47], a[252:255], v[56:59]
ds_read_b128 a[20:23], v200 offset:23552
v_mul_f32 v199, v199, v179
v_mfma_f32_16x16x32_bf16 v[60:63], a[48:51], a[248:251], v[60:63]
ds_read_b128 a[24:27], v200 offset:24576
v_mfma_f32_16x16x32_bf16 v[64:67], a[48:51], a[252:255], v[64:67]
ds_read_b128 a[28:31], v200 offset:25600
v_mfma_f32_16x16x32_bf16 v[68:71], a[52:55], a[248:251], v[68:71]
ds_read_b128 a[32:35], v200 offset:26624
v_mfma_f32_16x16x32_bf16 v[72:75], a[52:55], a[252:255], v[72:75]
s_cmp_eq_u32 s25, 14
s_cselect_b32 s98, 4096, 0
s_add_u32 s52, s52, s98
v_mfma_f32_16x16x32_bf16 v[76:79], a[56:59], a[248:251], v[76:79]
s_add_u32 s52, s52, 4096
v_exp_f32 v196, v196
v_mfma_f32_16x16x32_bf16 v[80:83], a[56:59], a[252:255], v[80:83]
v_mfma_f32_16x16x32_bf16 v[84:87], a[60:63], a[248:251], v[84:87]
buffer_load_dwordx4 a[128:131], v1, s[4:7], s52 offen offset:0 sc1
v_mfma_f32_16x16x32_bf16 v[88:91], a[60:63], a[252:255], v[88:91]
v_exp_f32 v197, v197
v_mfma_f32_16x16x32_bf16 v[92:95], a[64:67], a[248:251], v[92:95]
buffer_load_dwordx4 a[132:135], v9, s[4:7], s52 offen offset:0 sc1
v_mfma_f32_16x16x32_bf16 v[96:99], a[64:67], a[252:255], v[96:99]
v_mfma_f32_16x16x32_bf16 v[100:103], a[68:71], a[248:251], v[100:103]
v_mfma_f32_16x16x32_bf16 v[104:107], a[68:71], a[252:255], v[104:107]
s_waitcnt lgkmcnt(0)
v_mfma_f32_16x16x32_bf16 v[36:39], a[0:3], a[80:83], v[36:39]
ds_read_b128 a[36:39], v200 offset:27648
buffer_load_dwordx4 a[136:139], v1, s[4:7], s52 offen offset:1024 sc1
v_mfma_f32_16x16x32_bf16 v[40:43], a[0:3], a[84:87], v[40:43]
ds_read_b128 a[40:43], v200 offset:28672
v_mfma_f32_16x16x32_bf16 v[44:47], a[4:7], a[80:83], v[44:47]
ds_read_b128 a[44:47], v200 offset:29696
v_mfma_f32_16x16x32_bf16 v[48:51], a[4:7], a[84:87], v[48:51]
ds_read_b128 a[48:51], v200 offset:30720
v_mfma_f32_16x16x32_bf16 v[52:55], a[8:11], a[80:83], v[52:55]
ds_read_b128 a[52:55], v200 offset:31744
buffer_load_dwordx4 a[140:143], v9, s[4:7], s52 offen offset:1024 sc1
v_mfma_f32_16x16x32_bf16 v[56:59], a[8:11], a[84:87], v[56:59]
ds_read_b128 a[56:59], v200 offset:32768
v_mfma_f32_16x16x32_bf16 v[60:63], a[12:15], a[80:83], v[60:63]
ds_read_b128 a[60:63], v200 offset:33792
v_mfma_f32_16x16x32_bf16 v[64:67], a[12:15], a[84:87], v[64:67]
ds_read_b128 a[64:67], v200 offset:34816
v_mfma_f32_16x16x32_bf16 v[68:71], a[16:19], a[80:83], v[68:71]
ds_read_b128 a[68:71], v200 offset:35840
buffer_load_dwordx4 a[144:147], v1, s[4:7], s52 offen offset:2048 sc1
v_mfma_f32_16x16x32_bf16 v[72:75], a[16:19], a[84:87], v[72:75]
v_exp_f32 v198, v198
v_mfma_f32_16x16x32_bf16 v[76:79], a[20:23], a[80:83], v[76:79]
v_exp_f32 v199, v199
v_mfma_f32_16x16x32_bf16 v[80:83], a[20:23], a[84:87], v[80:83]
v_fma_f32 v196, v196, v255, v255
v_fma_f32 v197, v197, v255, v255
v_mfma_f32_16x16x32_bf16 v[84:87], a[24:27], a[80:83], v[84:87]
buffer_load_dwordx4 a[148:151], v9, s[4:7], s52 offen offset:2048 sc1
v_mfma_f32_16x16x32_bf16 v[88:91], a[24:27], a[84:87], v[88:91]
v_fma_f32 v198, v198, v255, v255
v_mfma_f32_16x16x32_bf16 v[92:95], a[28:31], a[80:83], v[92:95]
v_mfma_f32_16x16x32_bf16 v[96:99], a[28:31], a[84:87], v[96:99]
v_fma_f32 v199, v199, v255, v255
v_mfma_f32_16x16x32_bf16 v[100:103], a[32:35], a[80:83], v[100:103]
v_mfma_f32_16x16x32_bf16 v[104:107], a[32:35], a[84:87], v[104:107]
s_waitcnt vmcnt(19) lgkmcnt(0)
s_barrier
v_mfma_f32_16x16x32_bf16 v[36:39], a[36:39], a[88:91], v[36:39]
ds_read_b128 a[0:3], v201 offset:0
buffer_load_dwordx4 a[152:155], v1, s[4:7], s52 offen offset:3072 sc1
v_mfma_f32_16x16x32_bf16 v[40:43], a[36:39], a[92:95], v[40:43]
ds_read_b128 a[4:7], v201 offset:1024
v_mfma_f32_16x16x32_bf16 v[44:47], a[40:43], a[88:91], v[44:47]
ds_read_b128 a[8:11], v201 offset:2048
buffer_load_dwordx4 a[156:159], v9, s[4:7], s52 offen offset:3072 sc1
v_mfma_f32_16x16x32_bf16 v[48:51], a[40:43], a[92:95], v[48:51]
ds_read_b128 a[12:15], v201 offset:3072
v_mfma_f32_16x16x32_bf16 v[52:55], a[44:47], a[88:91], v[52:55]
ds_read_b128 a[16:19], v201 offset:4096
s_mul_i32 s38, s24, 13312
v_mfma_f32_16x16x32_bf16 v[56:59], a[44:47], a[92:95], v[56:59]
ds_read_b128 a[20:23], v201 offset:5120
v_mfma_f32_16x16x32_bf16 v[60:63], a[48:51], a[88:91], v[60:63]
ds_read_b128 a[24:27], v201 offset:6144
v_mfma_f32_16x16x32_bf16 v[64:67], a[48:51], a[92:95], v[64:67]
ds_read_b128 a[28:31], v201 offset:7168
s_add_u32 m0, s38, 0
v_mfma_f32_16x16x32_bf16 v[68:71], a[52:55], a[88:91], v[68:71]
ds_read_b128 a[32:35], v201 offset:8192
v_mfma_f32_16x16x32_bf16 v[72:75], a[52:55], a[92:95], v[72:75]
s_add_u32 s39, s38, s83
v_rcp_f32 v196, v196
v_mfma_f32_16x16x32_bf16 v[76:79], a[56:59], a[88:91], v[76:79]
v_rcp_f32 v197, v197
v_mfma_f32_16x16x32_bf16 v[80:83], a[56:59], a[92:95], v[80:83]
v_rcp_f32 v198, v198
v_mfma_f32_16x16x32_bf16 v[84:87], a[60:63], a[88:91], v[84:87]
buffer_load_dwordx4 v1, s[4:7], s39 offen offset:0 sc1 lds
v_mfma_f32_16x16x32_bf16 v[88:91], a[60:63], a[92:95], v[88:91]
v_mfma_f32_16x16x32_bf16 v[92:95], a[64:67], a[88:91], v[92:95]
buffer_load_dwordx4 v1, s[4:7], s39 offen offset:1024 sc1 lds
v_mfma_f32_16x16x32_bf16 v[96:99], a[64:67], a[92:95], v[96:99]
v_rcp_f32 v199, v199
v_mfma_f32_16x16x32_bf16 v[100:103], a[68:71], a[88:91], v[100:103]
v_mfma_f32_16x16x32_bf16 v[104:107], a[68:71], a[92:95], v[104:107]
s_waitcnt lgkmcnt(0)
v_mfma_f32_16x16x32_bf16 v[36:39], a[0:3], a[96:99], v[36:39]
ds_read_b128 a[36:39], v201 offset:9216
buffer_load_dwordx4 v1, s[4:7], s39 offen offset:2048 sc1 lds
v_mfma_f32_16x16x32_bf16 v[40:43], a[0:3], a[100:103], v[40:43]
ds_read_b128 a[40:43], v201 offset:10240
v_mul_f32 v176, v176, v196
v_mfma_f32_16x16x32_bf16 v[44:47], a[4:7], a[96:99], v[44:47]
ds_read_b128 a[44:47], v201 offset:11264
buffer_load_dwordx4 v1, s[4:7], s39 offen offset:3072 sc1 lds
v_mfma_f32_16x16x32_bf16 v[48:51], a[4:7], a[100:103], v[48:51]
ds_read_b128 a[48:51], v201 offset:12288
v_mul_f32 v177, v177, v197
v_mfma_f32_16x16x32_bf16 v[52:55], a[8:11], a[96:99], v[52:55]
ds_read_b128 a[52:55], v201 offset:13312
v_mfma_f32_16x16x32_bf16 v[56:59], a[8:11], a[100:103], v[56:59]
ds_read_b128 a[56:59], v201 offset:14336
s_add_u32 m0, m0, 4096
v_mfma_f32_16x16x32_bf16 v[60:63], a[12:15], a[96:99], v[60:63]
ds_read_b128 a[60:63], v201 offset:15360
v_mul_f32 v178, v178, v198
v_mfma_f32_16x16x32_bf16 v[64:67], a[12:15], a[100:103], v[64:67]
ds_read_b128 a[64:67], v201 offset:16384
v_mul_f32 v179, v179, v199
v_mfma_f32_16x16x32_bf16 v[68:71], a[16:19], a[96:99], v[68:71]
ds_read_b128 a[68:71], v201 offset:17408
s_add_u32 s39, s39, 4096
v_mfma_f32_16x16x32_bf16 v[72:75], a[16:19], a[100:103], v[72:75]
s_lshl_b32 s30, s25, 3
v_mfma_f32_16x16x32_bf16 v[76:79], a[20:23], a[96:99], v[76:79]
s_lshl_b32 s31, s24, 1
v_mfma_f32_16x16x32_bf16 v[80:83], a[20:23], a[100:103], v[80:83]
buffer_load_dwordx4 v1, s[4:7], s39 offen offset:0 sc1 lds
v_mfma_f32_16x16x32_bf16 v[84:87], a[24:27], a[96:99], v[84:87]
s_add_u32 s30, s30, s31
v_mfma_f32_16x16x32_bf16 v[88:91], a[24:27], a[100:103], v[88:91]
s_mul_i32 s30, s30, 73728
v_mfma_f32_16x16x32_bf16 v[92:95], a[28:31], a[96:99], v[92:95]
buffer_load_dwordx4 v1, s[4:7], s39 offen offset:1024 sc1 lds
v_mfma_f32_16x16x32_bf16 v[96:99], a[28:31], a[100:103], v[96:99]
s_add_u32 s30, s30, 16777216
v_mfma_f32_16x16x32_bf16 v[100:103], a[32:35], a[96:99], v[100:103]
s_mul_i32 s31, s26, 4608
v_mfma_f32_16x16x32_bf16 v[104:107], a[32:35], a[100:103], v[104:107]
s_add_u32 s30, s30, s31
s_waitcnt vmcnt(23) lgkmcnt(0)
v_mfma_f32_16x16x32_bf16 v[36:39], a[36:39], a[104:107], v[36:39]
ds_read_b128 a[0:3], v201 offset:18432
buffer_load_dwordx4 v1, s[4:7], s39 offen offset:2048 sc1 lds
v_mfma_f32_16x16x32_bf16 v[40:43], a[36:39], a[108:111], v[40:43]
ds_read_b128 a[4:7], v201 offset:19456
v_mfma_f32_16x16x32_bf16 v[44:47], a[40:43], a[104:107], v[44:47]
ds_read_b128 a[8:11], v201 offset:20480
buffer_load_dwordx4 v1, s[4:7], s39 offen offset:3072 sc1 lds
v_mfma_f32_16x16x32_bf16 v[48:51], a[40:43], a[108:111], v[48:51]
ds_read_b128 a[12:15], v201 offset:21504
v_mfma_f32_16x16x32_bf16 v[52:55], a[44:47], a[104:107], v[52:55]
ds_read_b128 a[16:19], v201 offset:22528
v_mfma_f32_16x16x32_bf16 v[56:59], a[44:47], a[108:111], v[56:59]
ds_read_b128 a[20:23], v201 offset:23552
s_add_u32 m0, m0, 4096
v_mfma_f32_16x16x32_bf16 v[60:63], a[48:51], a[104:107], v[60:63]
ds_read_b128 a[24:27], v201 offset:24576
v_mfma_f32_16x16x32_bf16 v[64:67], a[48:51], a[108:111], v[64:67]
ds_read_b128 a[28:31], v201 offset:25600
v_mfma_f32_16x16x32_bf16 v[68:71], a[52:55], a[104:107], v[68:71]
ds_read_b128 a[32:35], v201 offset:26624
s_add_u32 s39, s39, 4096
v_mfma_f32_16x16x32_bf16 v[72:75], a[52:55], a[108:111], v[72:75]
s_and_b32 s65, s26, 1
v_mfma_f32_16x16x32_bf16 v[76:79], a[56:59], a[104:107], v[76:79]
s_lshl_b32 s64, s65, 9
v_mfma_f32_16x16x32_bf16 v[80:83], a[56:59], a[108:111], v[80:83]
buffer_load_dwordx4 v1, s[4:7], s39 offen offset:0 sc1 lds
v_mfma_f32_16x16x32_bf16 v[84:87], a[60:63], a[104:107], v[84:87]
s_add_u32 s64, s64, s30
v_mfma_f32_16x16x32_bf16 v[88:91], a[60:63], a[108:111], v[88:91]
s_xor_b32 s65, s65, 1
v_mfma_f32_16x16x32_bf16 v[92:95], a[64:67], a[104:107], v[92:95]
buffer_load_dwordx4 v1, s[4:7], s39 offen offset:1024 sc1 lds
v_mfma_f32_16x16x32_bf16 v[96:99], a[64:67], a[108:111], v[96:99]
s_lshl_b32 s65, s65, 12
v_mfma_f32_16x16x32_bf16 v[100:103], a[68:71], a[104:107], v[100:103]
s_add_u32 s65, s65, s30
v_mfma_f32_16x16x32_bf16 v[104:107], a[68:71], a[108:111], v[104:107]
s_waitcnt lgkmcnt(0)
v_mfma_f32_16x16x32_bf16 v[36:39], a[0:3], a[112:115], v[36:39]
ds_read_b128 a[36:39], v201 offset:27648
buffer_load_dwordx4 v1, s[4:7], s39 offen offset:2048 sc1 lds
v_mfma_f32_16x16x32_bf16 v[40:43], a[0:3], a[116:119], v[40:43]
ds_read_b128 a[40:43], v201 offset:28672
buffer_load_dwordx4 v1, s[4:7], s39 offen offset:3072 sc1 lds
v_mfma_f32_16x16x32_bf16 v[44:47], a[4:7], a[112:115], v[44:47]
ds_read_b128 a[44:47], v201 offset:29696
v_mfma_f32_16x16x32_bf16 v[48:51], a[4:7], a[116:119], v[48:51]
ds_read_b128 a[48:51], v201 offset:30720
s_add_u32 m0, m0, 4096
v_mfma_f32_16x16x32_bf16 v[52:55], a[8:11], a[112:115], v[52:55]
ds_read_b128 a[52:55], v201 offset:31744
v_add_u32 v204, 73728, v1
v_mfma_f32_16x16x32_bf16 v[56:59], a[8:11], a[116:119], v[56:59]
ds_read_b128 a[56:59], v201 offset:32768
s_add_u32 s39, s39, 4096
v_mfma_f32_16x16x32_bf16 v[60:63], a[12:15], a[112:115], v[60:63]
ds_read_b128 a[60:63], v201 offset:33792
buffer_load_dwordx4 v1, s[4:7], s39 offen offset:0 sc1 lds
v_mfma_f32_16x16x32_bf16 v[64:67], a[12:15], a[116:119], v[64:67]
ds_read_b128 a[64:67], v201 offset:34816
v_and_b32 v203, 1, v3
v_mfma_f32_16x16x32_bf16 v[68:71], a[16:19], a[112:115], v[68:71]
ds_read_b128 a[68:71], v201 offset:35840
s_mul_i32 s38, s24, 9216
v_mfma_f32_16x16x32_bf16 v[72:75], a[16:19], a[116:119], v[72:75]
s_add_u32 m0, s38, 53248
v_mul_u32_u24 v203, 73728, v203
v_mfma_f32_16x16x32_bf16 v[76:79], a[20:23], a[112:115], v[76:79]
s_add_u32 s39, s38, s83
v_mfma_f32_16x16x32_bf16 v[80:83], a[20:23], a[116:119], v[80:83]
s_add_u32 s39, s39, 53248
v_lshrrev_b32 v7, 1, v3
v_mfma_f32_16x16x32_bf16 v[84:87], a[24:27], a[112:115], v[84:87]
v_mfma_f32_16x16x32_bf16 v[88:91], a[24:27], a[116:119], v[88:91]
v_mfma_f32_16x16x32_bf16 v[92:95], a[28:31], a[112:115], v[92:95]
v_lshl_add_u32 v203, v7, 8, v203
v_mfma_f32_16x16x32_bf16 v[96:99], a[28:31], a[116:119], v[96:99]
buffer_load_dwordx4 v1, s[4:7], s39 offen offset:0 sc1 lds
v_mfma_f32_16x16x32_bf16 v[100:103], a[32:35], a[112:115], v[100:103]
v_lshl_add_u32 v203, v2, 4, v203
v_mfma_f32_16x16x32_bf16 v[104:107], a[32:35], a[116:119], v[104:107]
s_waitcnt vmcnt(14) lgkmcnt(0)
s_barrier
v_mfma_f32_16x16x32_bf16 v[36:39], a[36:39], a[120:123], v[36:39]
ds_read_b128 a[0:3], v202 offset:8192
buffer_load_dwordx4 v1, s[4:7], s39 offen offset:1024 sc1 lds
v_mfma_f32_16x16x32_bf16 v[40:43], a[36:39], a[124:127], v[40:43]
ds_read_b128 a[4:7], v202 offset:17408
v_mfma_f32_16x16x32_bf16 v[44:47], a[40:43], a[120:123], v[44:47]
ds_read_b128 a[8:11], v202 offset:26624
buffer_load_dwordx4 v1, s[4:7], s39 offen offset:2048 sc1 lds
v_mfma_f32_16x16x32_bf16 v[48:51], a[40:43], a[124:127], v[48:51]
ds_read_b128 a[12:15], v202 offset:35840
v_mfma_f32_16x16x32_bf16 v[52:55], a[44:47], a[120:123], v[52:55]
ds_read_b128 a[16:19], v202 offset:0
v_mfma_f32_16x16x32_bf16 v[56:59], a[44:47], a[124:127], v[56:59]
ds_read_b128 a[20:23], v202 offset:1024
buffer_load_dwordx4 v1, s[4:7], s39 offen offset:3072 sc1 lds
v_mfma_f32_16x16x32_bf16 v[60:63], a[48:51], a[120:123], v[60:63]
ds_read_b128 a[24:27], v202 offset:9216
v_mfma_f32_16x16x32_bf16 v[64:67], a[48:51], a[124:127], v[64:67]
ds_read_b128 a[28:31], v202 offset:10240
v_mfma_f32_16x16x32_bf16 v[68:71], a[52:55], a[120:123], v[68:71]
ds_read_b128 a[32:35], v202 offset:18432
s_add_u32 m0, m0, 4096
v_mfma_f32_16x16x32_bf16 v[72:75], a[52:55], a[124:127], v[72:75]
s_add_u32 s39, s39, 4096
v_mfma_f32_16x16x32_bf16 v[76:79], a[56:59], a[120:123], v[76:79]
v_mfma_f32_16x16x32_bf16 v[80:83], a[56:59], a[124:127], v[80:83]
v_mfma_f32_16x16x32_bf16 v[84:87], a[60:63], a[120:123], v[84:87]
v_mfma_f32_16x16x32_bf16 v[88:91], a[60:63], a[124:127], v[88:91]
v_mfma_f32_16x16x32_bf16 v[92:95], a[64:67], a[120:123], v[92:95]
buffer_load_dwordx4 v1, s[4:7], s39 offen offset:0 sc1 lds
v_mfma_f32_16x16x32_bf16 v[96:99], a[64:67], a[124:127], v[96:99]
v_mfma_f32_16x16x32_bf16 v[100:103], a[68:71], a[120:123], v[100:103]
v_mfma_f32_16x16x32_bf16 v[104:107], a[68:71], a[124:127], v[104:107]
s_waitcnt lgkmcnt(7)
v_mfma_f32_16x16x32_bf16 v[100:103], a[0:3], a[128:131], v[100:103]
ds_read_b128 a[36:39], v202 offset:19456
v_mfma_f32_16x16x32_bf16 v[104:107], a[0:3], a[132:135], v[104:107]
v_mfma_f32_16x16x32_bf16 v[100:103], a[4:7], a[136:139], v[100:103]
ds_read_b128 a[40:43], v202 offset:27648
v_mfma_f32_16x16x32_bf16 v[104:107], a[4:7], a[140:143], v[104:107]
s_waitcnt lgkmcnt(7)
v_mfma_f32_16x16x32_bf16 v[100:103], a[8:11], a[144:147], v[100:103]
ds_read_b128 a[44:47], v202 offset:28672
v_mfma_f32_16x16x32_bf16 v[104:107], a[8:11], a[148:151], v[104:107]
v_mfma_f32_16x16x32_bf16 v[100:103], a[12:15], a[152:155], v[100:103]
ds_read_b128 a[48:51], v202 offset:2048
v_mfma_f32_16x16x32_bf16 v[104:107], a[12:15], a[156:159], v[104:107]
s_waitcnt lgkmcnt(7)
v_mfma_f32_16x16x32_bf16 v[36:39], a[16:19], a[128:131], v[36:39]
ds_read_b128 a[52:55], v202 offset:3072
v_mfma_f32_16x16x32_bf16 v[40:43], a[16:19], a[132:135], v[40:43]
v_mfma_f32_16x16x32_bf16 v[44:47], a[20:23], a[128:131], v[44:47]
ds_read_b128 a[56:59], v202 offset:11264
v_mfma_f32_16x16x32_bf16 v[48:51], a[20:23], a[132:135], v[48:51]
v_mul_f32 v100, v100, v108
s_waitcnt lgkmcnt(7)
v_mfma_f32_16x16x32_bf16 v[36:39], a[24:27], a[136:139], v[36:39]
ds_read_b128 a[60:63], v202 offset:12288
v_mul_f32 v101, v101, v109
v_mfma_f32_16x16x32_bf16 v[40:43], a[24:27], a[140:143], v[40:43]
v_mul_f32 v102, v102, v110
v_mul_f32 v103, v103, v111
v_mfma_f32_16x16x32_bf16 v[44:47], a[28:31], a[136:139], v[44:47]
ds_read_b128 a[64:67], v202 offset:20480
v_cvt_pk_bf16_f32 v238, v100, v101
v_mfma_f32_16x16x32_bf16 v[48:51], a[28:31], a[140:143], v[48:51]
v_cvt_pk_bf16_f32 v239, v102, v103
s_waitcnt lgkmcnt(7)
v_mfma_f32_16x16x32_bf16 v[36:39], a[32:35], a[144:147], v[36:39]
ds_read_b128 a[68:71], v202 offset:21504
v_mul_f32 v104, v104, v112
v_mfma_f32_16x16x32_bf16 v[40:43], a[32:35], a[148:151], v[40:43]
v_mul_f32 v105, v105, v113
v_mfma_f32_16x16x32_bf16 v[44:47], a[36:39], a[144:147], v[44:47]
ds_read_b128 a[0:3], v202 offset:29696
v_mul_f32 v106, v106, v114
v_mfma_f32_16x16x32_bf16 v[48:51], a[36:39], a[148:151], v[48:51]
v_mul_f32 v107, v107, v115
s_waitcnt lgkmcnt(7)
v_mfma_f32_16x16x32_bf16 v[36:39], a[40:43], a[152:155], v[36:39]
ds_read_b128 a[4:7], v202 offset:30720
v_cvt_pk_bf16_f32 v240, v104, v105
v_mfma_f32_16x16x32_bf16 v[40:43], a[40:43], a[156:159], v[40:43]
v_cvt_pk_bf16_f32 v241, v106, v107
s_nop 0
v_mfma_f32_16x16x32_bf16 v[44:47], a[44:47], a[152:155], v[44:47]
ds_read_b128 a[8:11], v202 offset:4096
v_mfma_f32_16x16x32_bf16 v[48:51], a[44:47], a[156:159], v[48:51]
s_waitcnt lgkmcnt(7)
v_mfma_f32_16x16x32_bf16 v[52:55], a[48:51], a[128:131], v[52:55]
ds_read_b128 a[12:15], v202 offset:5120
v_permlane16_swap_b32 v238, v240
v_mfma_f32_16x16x32_bf16 v[56:59], a[48:51], a[132:135], v[56:59]
v_permlane16_swap_b32 v239, v241
v_mfma_f32_16x16x32_bf16 v[60:63], a[52:55], a[128:131], v[60:63]
ds_read_b128 a[16:19], v202 offset:13312
buffer_store_dwordx4 v[238:241], v203, s[8:11], s65 offen sc1
v_mfma_f32_16x16x32_bf16 v[64:67], a[52:55], a[132:135], v[64:67]
v_mul_f32 v36, v36, v116
s_waitcnt lgkmcnt(7)
v_mfma_f32_16x16x32_bf16 v[52:55], a[56:59], a[136:139], v[52:55]
ds_read_b128 a[20:23], v202 offset:14336
v_mul_f32 v37, v37, v117
v_mfma_f32_16x16x32_bf16 v[56:59], a[56:59], a[140:143], v[56:59]
v_mul_f32 v38, v38, v118
v_mul_f32 v39, v39, v119
v_mfma_f32_16x16x32_bf16 v[60:63], a[60:63], a[136:139], v[60:63]
ds_read_b128 a[24:27], v202 offset:22528
v_cvt_pk_bf16_f32 v206, v36, v37
v_mfma_f32_16x16x32_bf16 v[64:67], a[60:63], a[140:143], v[64:67]
v_cvt_pk_bf16_f32 v207, v38, v39
v_mul_f32 v44, v44, v124
s_waitcnt lgkmcnt(7)
v_mfma_f32_16x16x32_bf16 v[52:55], a[64:67], a[144:147], v[52:55]
ds_read_b128 a[28:31], v202 offset:23552
v_mul_f32 v45, v45, v125
v_mfma_f32_16x16x32_bf16 v[56:59], a[64:67], a[148:151], v[56:59]
v_mul_f32 v46, v46, v126
v_mul_f32 v47, v47, v127
v_mfma_f32_16x16x32_bf16 v[60:63], a[68:71], a[144:147], v[60:63]
ds_read_b128 a[32:35], v202 offset:31744
v_cvt_pk_bf16_f32 v208, v44, v45
v_mfma_f32_16x16x32_bf16 v[64:67], a[68:71], a[148:151], v[64:67]
v_cvt_pk_bf16_f32 v209, v46, v47
s_waitcnt lgkmcnt(7)
v_mfma_f32_16x16x32_bf16 v[52:55], a[0:3], a[152:155], v[52:55]
ds_read_b128 a[36:39], v202 offset:32768
buffer_store_dwordx4 v[206:209], v1, s[8:11], s64 offen offset:0 sc1
v_mul_f32 v40, v40, v120
v_mul_f32 v41, v41, v121
v_mfma_f32_16x16x32_bf16 v[56:59], a[0:3], a[156:159], v[56:59]
v_mul_f32 v42, v42, v122
v_mul_f32 v43, v43, v123
v_mfma_f32_16x16x32_bf16 v[60:63], a[4:7], a[152:155], v[60:63]
ds_read_b128 a[40:43], v202 offset:6144
v_cvt_pk_bf16_f32 v210, v40, v41
v_mfma_f32_16x16x32_bf16 v[64:67], a[4:7], a[156:159], v[64:67]
v_cvt_pk_bf16_f32 v211, v42, v43
v_mul_f32 v48, v48, v128
s_waitcnt lgkmcnt(7)
v_mfma_f32_16x16x32_bf16 v[68:71], a[8:11], a[128:131], v[68:71]
ds_read_b128 a[44:47], v202 offset:7168
v_mul_f32 v49, v49, v129
v_mfma_f32_16x16x32_bf16 v[72:75], a[8:11], a[132:135], v[72:75]
v_mul_f32 v50, v50, v130
v_mul_f32 v51, v51, v131
v_mfma_f32_16x16x32_bf16 v[76:79], a[12:15], a[128:131], v[76:79]
ds_read_b128 a[48:51], v202 offset:15360
v_cvt_pk_bf16_f32 v212, v48, v49
v_cvt_pk_bf16_f32 v213, v50, v51
buffer_store_dwordx4 v[210:213], v204, s[8:11], s64 offen offset:0 sc1
v_mfma_f32_16x16x32_bf16 v[80:83], a[12:15], a[132:135], v[80:83]
v_mul_f32 v52, v52, v132
s_waitcnt lgkmcnt(7)
v_mfma_f32_16x16x32_bf16 v[68:71], a[16:19], a[136:139], v[68:71]
ds_read_b128 a[52:55], v202 offset:16384
v_mul_f32 v53, v53, v133
v_mfma_f32_16x16x32_bf16 v[72:75], a[16:19], a[140:143], v[72:75]
v_mul_f32 v54, v54, v134
v_mul_f32 v55, v55, v135
v_mfma_f32_16x16x32_bf16 v[76:79], a[20:23], a[136:139], v[76:79]
ds_read_b128 a[56:59], v202 offset:24576
v_cvt_pk_bf16_f32 v214, v52, v53
v_mfma_f32_16x16x32_bf16 v[80:83], a[20:23], a[140:143], v[80:83]
v_cvt_pk_bf16_f32 v215, v54, v55
v_mul_f32 v60, v60, v140
s_waitcnt lgkmcnt(7)
v_mfma_f32_16x16x32_bf16 v[68:71], a[24:27], a[144:147], v[68:71]
ds_read_b128 a[60:63], v202 offset:25600
v_mul_f32 v61, v61, v141
v_mfma_f32_16x16x32_bf16 v[72:75], a[24:27], a[148:151], v[72:75]
v_mul_f32 v62, v62, v142
v_mul_f32 v63, v63, v143
v_mfma_f32_16x16x32_bf16 v[76:79], a[28:31], a[144:147], v[76:79]
ds_read_b128 a[64:67], v202 offset:33792
v_cvt_pk_bf16_f32 v216, v60, v61
v_mfma_f32_16x16x32_bf16 v[80:83], a[28:31], a[148:151], v[80:83]
v_cvt_pk_bf16_f32 v217, v62, v63
s_waitcnt lgkmcnt(7)
v_mfma_f32_16x16x32_bf16 v[68:71], a[32:35], a[152:155], v[68:71]
ds_read_b128 a[68:71], v202 offset:34816
buffer_store_dwordx4 v[214:217], v1, s[8:11], s64 offen offset:1024 sc1
v_mul_f32 v56, v56, v136
v_mul_f32 v57, v57, v137
v_mfma_f32_16x16x32_bf16 v[72:75], a[32:35], a[156:159], v[72:75]
v_mul_f32 v58, v58, v138
v_mul_f32 v59, v59, v139
v_mfma_f32_16x16x32_bf16 v[76:79], a[36:39], a[152:155], v[76:79]
v_cvt_pk_bf16_f32 v218, v56, v57
v_cvt_pk_bf16_f32 v219, v58, v59
v_mfma_f32_16x16x32_bf16 v[80:83], a[36:39], a[156:159], v[80:83]
v_mul_f32 v64, v64, v144
s_waitcnt lgkmcnt(6)
v_mfma_f32_16x16x32_bf16 v[84:87], a[40:43], a[128:131], v[84:87]
v_mul_f32 v65, v65, v145
v_mul_f32 v66, v66, v146
v_mfma_f32_16x16x32_bf16 v[88:91], a[40:43], a[132:135], v[88:91]
v_mul_f32 v67, v67, v147
v_cvt_pk_bf16_f32 v220, v64, v65
v_mfma_f32_16x16x32_bf16 v[92:95], a[44:47], a[128:131], v[92:95]
v_cvt_pk_bf16_f32 v221, v66, v67
buffer_store_dwordx4 v[218:221], v204, s[8:11], s64 offen offset:1024 sc1
v_mfma_f32_16x16x32_bf16 v[96:99], a[44:47], a[132:135], v[96:99]
v_mul_f32 v68, v68, v148
s_waitcnt lgkmcnt(4)
v_mfma_f32_16x16x32_bf16 v[84:87], a[48:51], a[136:139], v[84:87]
v_mul_f32 v69, v69, v149
v_mul_f32 v70, v70, v150
v_mfma_f32_16x16x32_bf16 v[88:91], a[48:51], a[140:143], v[88:91]
v_mul_f32 v71, v71, v151
v_cvt_pk_bf16_f32 v222, v68, v69
v_mfma_f32_16x16x32_bf16 v[92:95], a[52:55], a[136:139], v[92:95]
v_cvt_pk_bf16_f32 v223, v70, v71
v_mul_f32 v76, v76, v156
v_mfma_f32_16x16x32_bf16 v[96:99], a[52:55], a[140:143], v[96:99]
v_mul_f32 v77, v77, v157
s_waitcnt lgkmcnt(2)
v_mfma_f32_16x16x32_bf16 v[84:87], a[56:59], a[144:147], v[84:87]
v_mul_f32 v78, v78, v158
v_mul_f32 v79, v79, v159
v_mfma_f32_16x16x32_bf16 v[88:91], a[56:59], a[148:151], v[88:91]
v_cvt_pk_bf16_f32 v224, v76, v77
v_cvt_pk_bf16_f32 v225, v78, v79
v_mfma_f32_16x16x32_bf16 v[92:95], a[60:63], a[144:147], v[92:95]
buffer_store_dwordx4 v[222:225], v1, s[8:11], s64 offen offset:2048 sc1
v_mul_f32 v72, v72, v152
v_mfma_f32_16x16x32_bf16 v[96:99], a[60:63], a[148:151], v[96:99]
v_mul_f32 v73, v73, v153
v_mul_f32 v74, v74, v154
s_waitcnt lgkmcnt(0)
v_mfma_f32_16x16x32_bf16 v[84:87], a[64:67], a[152:155], v[84:87]
v_mul_f32 v75, v75, v155
v_cvt_pk_bf16_f32 v226, v72, v73
v_mfma_f32_16x16x32_bf16 v[88:91], a[64:67], a[156:159], v[88:91]
v_cvt_pk_bf16_f32 v227, v74, v75
v_mul_f32 v80, v80, v160
v_mfma_f32_16x16x32_bf16 v[92:95], a[68:71], a[152:155], v[92:95]
v_mul_f32 v81, v81, v161
v_mul_f32 v82, v82, v162
v_mfma_f32_16x16x32_bf16 v[96:99], a[68:71], a[156:159], v[96:99]
v_mul_f32 v83, v83, v163
v_cvt_pk_bf16_f32 v228, v80, v81
v_cvt_pk_bf16_f32 v229, v82, v83
buffer_store_dwordx4 v[226:229], v204, s[8:11], s64 offen offset:2048 sc1
s_nop 1
v_pk_mul_f32 v[84:85], v[84:85], v[164:165]
v_pk_mul_f32 v[86:87], v[86:87], v[166:167]
v_cvt_pk_bf16_f32 v230, v84, v85
v_cvt_pk_bf16_f32 v231, v86, v87
v_pk_mul_f32 v[92:93], v[92:93], v[172:173]
v_pk_mul_f32 v[94:95], v[94:95], v[174:175]
v_cvt_pk_bf16_f32 v232, v92, v93
v_cvt_pk_bf16_f32 v233, v94, v95
buffer_store_dwordx4 v[230:233], v1, s[8:11], s64 offen offset:3072 sc1
v_pk_mul_f32 v[88:89], v[88:89], v[168:169]
v_pk_mul_f32 v[90:91], v[90:91], v[170:171]
v_cvt_pk_bf16_f32 v234, v88, v89
v_cvt_pk_bf16_f32 v235, v90, v91
v_pk_mul_f32 v[96:97], v[96:97], v[176:177]
v_pk_mul_f32 v[98:99], v[98:99], v[178:179]
v_cvt_pk_bf16_f32 v236, v96, v97
v_cvt_pk_bf16_f32 v237, v98, v99
buffer_store_dwordx4 v[234:237], v204, s[8:11], s64 offen offset:3072 sc1
L_c5:
s_barrier
buffer_load_dwordx4 v1, s[4:7], s39 offen offset:1024 sc1 lds
buffer_load_dwordx4 v1, s[4:7], s39 offen offset:2048 sc1 lds
buffer_load_dwordx4 v1, s[4:7], s39 offen offset:3072 sc1 lds
s_add_u32 m0, m0, 4096
s_add_u32 s39, s39, 4096
buffer_load_dwordx4 v1, s[4:7], s39 offen offset:0 sc1 lds
s_mul_i32 s38, s24, 9216
s_add_u32 m0, s38, 90112
s_add_u32 s39, s38, s83
s_add_u32 s39, s39, 90112
buffer_load_dwordx4 v1, s[4:7], s39 offen offset:0 sc1 lds
buffer_load_dwordx4 v1, s[4:7], s39 offen offset:1024 sc1 lds
buffer_load_dwordx4 v1, s[4:7], s39 offen offset:2048 sc1 lds
v_lshlrev_b32 v7, 3, v1
s_lshl_b32 s31, s27, 10
v_add_u32 v7, s31, v7
s_cmp_eq_u32 s24, 0
s_cselect_b32 s30, 0, 1073741824
s_add_u32 s30, s30, 26574848
s_waitcnt vmcnt(7)
s_barrier
s_mov_b64 exec, 0xff
buffer_atomic_add v4, v7, s[8:11], s30 offen sc1
s_mov_b64 exec, -1
s_lshl_b32 s35, s80, 7
s_add_u32 s35, s35, 26574848
s_cmp_eq_u32 s24, 1
s_cselect_b32 s35, s35, 1073741824
v_mov_b32 v6, 0
v_mov_b32 v244, 0
v_mov_b32 v245, 0
v_mov_b32 v246, 0
buffer_load_dwordx4 v1, s[4:7], s39 offen offset:3072 sc1 lds
s_add_u32 m0, m0, 4096
s_add_u32 s39, s39, 4096
buffer_load_dwordx4 v1, s[4:7], s39 offen offset:0 sc1 lds
buffer_load_dwordx4 v1, s[4:7], s39 offen offset:1024 sc1 lds
buffer_load_dwordx4 v1, s[4:7], s39 offen offset:2048 sc1 lds
s_xor_b32 s30, s70, 1
s_mul_i32 s60, s30, 73728
s_and_b32 s32, s27, 1
s_mul_i32 s32, s32, 36864
s_add_u32 s32, s32, 16777216
s_add_u32 s60, s60, s32
s_mul_i32 s61, s70, 73728
s_add_u32 s61, s61, s32
v_and_b32 v40, 7, v2
v_lshlrev_b32 v40, 4, v40
v_lshl_add_u32 v40, v3, 7, v40
v_add_u32 v40, 4096, v40
s_mov_b64 exec, 1
buffer_atomic_add v244, v6, s[8:11], s35 offen sc0 sc1
s_mov_b64 exec, -1
buffer_load_dwordx4 v1, s[4:7], s39 offen offset:3072 sc1 lds
s_add_u32 m0, m0, 4096
s_add_u32 s39, s39, 4096
buffer_load_dwordx4 v1, s[4:7], s39 offen offset:0 sc1 lds
s_mul_i32 s38, s24, 9216
s_add_u32 m0, s38, 126976
s_add_u32 s39, s38, s83
s_add_u32 s39, s39, 126976
buffer_load_dwordx4 v1, s[4:7], s39 offen offset:0 sc1 lds
buffer_load_dwordx4 v1, s[4:7], s39 offen offset:1024 sc1 lds
s_lshl_b32 s63, s80, 14
s_lshl_b32 s30, s24, 12
s_add_u32 s63, s63, s30
s_xor_b32 s62, s63, 131072
s_add_u32 s63, s63, 26640384
s_add_u32 s62, s62, 26640384
s_add_u32 s64, s83, 161280
v_mov_b32 v116, v40
v_add_u32 v36, 0, v1
v_add_u32 v37, 55296, v1
v_add_u32 v41, 55296, v40
v_add_u32 v38, 110592, v1
s_mov_b64 exec, 1
buffer_atomic_add v245, v6, s[8:11], s35 offen sc0 sc1
s_mov_b64 exec, -1
buffer_load_dwordx4 v1, s[4:7], s39 offen offset:2048 sc1 lds
buffer_load_dwordx4 v1, s[4:7], s39 offen offset:3072 sc1 lds
s_add_u32 m0, m0, 4096
s_add_u32 s39, s39, 4096
buffer_load_dwordx4 v1, s[4:7], s39 offen offset:0 sc1 lds
buffer_load_dwordx4 v1, s[4:7], s39 offen offset:1024 sc1 lds
v_add_u32 v42, 110592, v40
s_bitcmp1_b32 s27, 0
s_cbranch_scc1 L_kh_37
v_swap_b32 v206, v210
v_swap_b32 v207, v211
v_swap_b32 v208, v212
v_swap_b32 v209, v213
v_swap_b32 v214, v218
v_swap_b32 v215, v219
v_swap_b32 v216, v220
v_swap_b32 v217, v221
v_swap_b32 v222, v226
v_swap_b32 v223, v227
v_swap_b32 v224, v228
v_swap_b32 v225, v229
v_swap_b32 v230, v234
v_swap_b32 v231, v235
v_swap_b32 v232, v236
v_swap_b32 v233, v237
L_kh_37:
v_mov_b32 v138, 1073741824
s_mul_i32 s66, s70, 18432
s_mul_i32 s32, s28, 2304
s_add_u32 s66, s66, s32
s_add_u32 s66, s66, 30834688
v_mov_b32 v140, v1
v_add_u32 v141, 2048, v140
v_cndmask_b32 v141, v138, v141, s[46:47]
s_lshl_b32 s67, s70, 7
s_lshl_b32 s32, s28, 14
s_mov_b64 exec, 1
buffer_atomic_add v246, v6, s[8:11], s35 offen sc0 sc1
s_mov_b64 exec, -1
buffer_load_dwordx4 v1, s[4:7], s39 offen offset:2048 sc1 lds
buffer_load_dwordx4 v1, s[4:7], s39 offen offset:3072 sc1 lds
s_add_u32 m0, m0, 4096
s_add_u32 s39, s39, 4096
buffer_load_dwordx4 v1, s[4:7], s39 offen offset:0 sc1 lds
s_add_u32 s67, s67, s32
s_add_u32 s67, s67, 33193984
v_lshlrev_b32 v139, 3, v2
v_cndmask_b32 v138, v138, v139, s[46:47]
v_mov_b32 v162, 1073741824
s_mul_i32 s68, s70, 18432
s_mul_i32 s32, s28, 144
s_add_u32 s68, s68, s32
v_mul_u32_u24 v164, 1152, v2
v_lshl_add_u32 v164, v3, 4, v164
v_add_u32 v165, 128, v164
v_cndmask_b32 v165, v162, v165, s[46:47]
ds_read_b128 a[160:163], v36 offset:0
ds_read_b128 a[164:167], v36 offset:1024
ds_read_b128 a[168:171], v36 offset:2048
ds_read_b128 a[172:175], v36 offset:3072
ds_read_b128 a[176:179], v40 offset:0
ds_read_b128 a[180:183], v36 offset:4608
ds_read_b128 a[184:187], v36 offset:5632
ds_read_b128 a[188:191], v36 offset:6656
ds_read_b128 a[192:195], v36 offset:7680
ds_read_b128 a[196:199], v40 offset:4608
s_cmp_eq_u32 s71, 0
s_cselect_b32 s98, 4096, 0
s_add_u32 s60, s60, s98
s_cmp_eq_u32 s24, 1
s_cbranch_scc0 L_other_40
s_mov_b32 s31, 0
s_mov_b64 exec, 1
v_mov_b32 v247, 0
buffer_atomic_add v247, v6, s[8:11], s35 offen sc0 sc1
s_waitcnt vmcnt(14)
v_cmp_gt_u32 vcc, 8, v244
s_nop 0
s_cbranch_vccz L_polled_39
s_waitcnt vmcnt(9)
v_cmp_gt_u32 vcc, 8, v245
s_nop 0
s_cbranch_vccz L_polled_39
v_mov_b32 v244, 0
buffer_atomic_add v244, v6, s[8:11], s35 offen sc0 sc1
s_waitcnt vmcnt(5)
v_cmp_gt_u32 vcc, 8, v246
s_nop 0
s_cbranch_vccz L_polled_39
v_mov_b32 v245, 0
buffer_atomic_add v245, v6, s[8:11], s35 offen sc0 sc1
L_poll_38:
s_add_u32 s31, s31, 1
s_cmp_gt_u32 s31, 100000
s_cbranch_scc1 L_polled_39
v_mov_b32 v246, 0
buffer_atomic_add v246, v6, s[8:11], s35 offen sc0 sc1
s_waitcnt vmcnt(3)
v_cmp_gt_u32 vcc, 8, v247
s_nop 0
s_cbranch_vccz L_polled_39
v_mov_b32 v247, 0
buffer_atomic_add v247, v6, s[8:11], s35 offen sc0 sc1
s_waitcnt vmcnt(3)
v_cmp_gt_u32 vcc, 8, v244
s_nop 0
s_cbranch_vccz L_polled_39
v_mov_b32 v244, 0
buffer_atomic_add v244, v6, s[8:11], s35 offen sc0 sc1
s_waitcnt vmcnt(3)
v_cmp_gt_u32 vcc, 8, v245
s_nop 0
s_cbranch_vccz L_polled_39
v_mov_b32 v245, 0
buffer_atomic_add v245, v6, s[8:11], s35 offen sc0 sc1
s_waitcnt vmcnt(3)
v_cmp_gt_u32 vcc, 8, v246
s_nop 0
s_cbranch_vccz L_polled_39
s_branch L_poll_38
L_polled_39:
s_mov_b64 exec, -1
L_other_40:
s_barrier
buffer_load_dwordx4 a[0:3], v1, s[8:11], s60 offen offset:0 sc1
buffer_load_dwordx4 a[4:7], v1, s[8:11], s60 offen offset:1024 sc1
s_waitcnt lgkmcnt(5)
v_mfma_f32_16x16x32_bf16 v[44:47], a[160:163], v[206:209], 0
ds_read_b128 a[200:203], v36 offset:9216
buffer_load_dwordx4 a[8:11], v1, s[8:11], s60 offen offset:2048 sc1
v_mfma_f32_16x16x32_bf16 v[16:19], a[160:163], v[210:213], v[16:19]
v_mfma_f32_16x16x32_bf16 v[48:51], a[164:167], v[206:209], 0
ds_read_b128 a[204:207], v36 offset:10240
buffer_load_dwordx4 a[12:15], v1, s[8:11], s60 offen offset:3072 sc1
v_mfma_f32_16x16x32_bf16 v[20:23], a[164:167], v[210:213], v[20:23]
s_add_u32 s60, s60, 4096
v_mfma_f32_16x16x32_bf16 v[52:55], a[168:171], v[206:209], 0
ds_read_b128 a[208:211], v36 offset:11264
v_mfma_f32_16x16x32_bf16 v[24:27], a[168:171], v[210:213], v[24:27]
v_mfma_f32_16x16x32_bf16 v[56:59], a[172:175], v[206:209], 0
ds_read_b128 a[212:215], v36 offset:12288
buffer_load_dwordx4 a[16:19], v1, s[8:11], s60 offen offset:0 sc1
v_mfma_f32_16x16x32_bf16 v[28:31], a[172:175], v[210:213], v[28:31]
s_cmp_eq_u32 s71, 5
s_cselect_b32 s98, 4096, 0
v_mfma_f32_16x16x32_bf16 v[60:63], a[176:179], v[206:209], 0
ds_read_b128 a[216:219], v40 offset:9216
v_mfma_f32_16x16x32_bf16 v[32:35], a[176:179], v[210:213], v[32:35]
s_add_u32 s60, s60, s98
s_waitcnt lgkmcnt(5)
v_mfma_f32_16x16x32_bf16 v[44:47], a[180:183], v[214:217], v[44:47]
ds_read_b128 a[160:163], v36 offset:13824
v_mov_b32 v67, v248
v_mfma_f32_16x16x32_bf16 v[16:19], a[180:183], v[218:221], v[16:19]
v_mfma_f32_16x16x32_bf16 v[48:51], a[184:187], v[214:217], v[48:51]
ds_read_b128 a[164:167], v36 offset:14848
v_mfma_f32_16x16x32_bf16 v[20:23], a[184:187], v[218:221], v[20:23]
v_mfma_f32_16x16x32_bf16 v[52:55], a[188:191], v[214:217], v[52:55]
ds_read_b128 a[168:171], v36 offset:15872
v_mfma_f32_16x16x32_bf16 v[24:27], a[188:191], v[218:221], v[24:27]
buffer_load_dwordx4 a[20:23], v1, s[8:11], s60 offen offset:1024 sc1
v_mfma_f32_16x16x32_bf16 v[56:59], a[192:195], v[214:217], v[56:59]
ds_read_b128 a[172:175], v36 offset:16896
v_mfma_f32_16x16x32_bf16 v[28:31], a[192:195], v[218:221], v[28:31]
buffer_load_dwordx4 a[24:27], v1, s[8:11], s60 offen offset:2048 sc1
v_mov_b32 v71, v248
v_mfma_f32_16x16x32_bf16 v[60:63], a[196:199], v[214:217], v[60:63]
ds_read_b128 a[176:179], v40 offset:13824
v_mfma_f32_16x16x32_bf16 v[32:35], a[196:199], v[218:221], v[32:35]
buffer_load_dwordx4 a[28:31], v1, s[8:11], s60 offen offset:3072 sc1
s_waitcnt lgkmcnt(5)
v_mfma_f32_16x16x32_bf16 v[44:47], a[200:203], v[222:225], v[44:47]
ds_read_b128 a[180:183], v36 offset:18432
v_mfma_f32_16x16x32_bf16 v[16:19], a[200:203], v[226:229], v[16:19]
s_add_u32 s60, s60, 4096
v_mfma_f32_16x16x32_bf16 v[48:51], a[204:207], v[222:225], v[48:51]
ds_read_b128 a[184:187], v36 offset:19456
v_mfma_f32_16x16x32_bf16 v[20:23], a[204:207], v[226:229], v[20:23]
v_mfma_f32_16x16x32_bf16 v[52:55], a[208:211], v[222:225], v[52:55]
ds_read_b128 a[188:191], v36 offset:20480
buffer_load_dwordx4 a[32:35], v1, s[8:11], s60 offen offset:0 sc1
v_mfma_f32_16x16x32_bf16 v[24:27], a[208:211], v[226:229], v[24:27]
s_cmp_eq_u32 s71, 9
s_cselect_b32 s98, 4096, 0
v_mov_b32 v75, v248
v_mfma_f32_16x16x32_bf16 v[56:59], a[212:215], v[222:225], v[56:59]
ds_read_b128 a[192:195], v36 offset:21504
v_mfma_f32_16x16x32_bf16 v[28:31], a[212:215], v[226:229], v[28:31]
s_add_u32 s60, s60, s98
v_mfma_f32_16x16x32_bf16 v[60:63], a[216:219], v[222:225], v[60:63]
ds_read_b128 a[196:199], v40 offset:18432
v_mfma_f32_16x16x32_bf16 v[32:35], a[216:219], v[226:229], v[32:35]
s_waitcnt lgkmcnt(5)
v_mfma_f32_16x16x32_bf16 v[44:47], a[160:163], v[230:233], v[44:47]
ds_read_b128 a[200:203], v36 offset:23040
v_mfma_f32_16x16x32_bf16 v[16:19], a[160:163], v[234:237], v[16:19]
v_mfma_f32_16x16x32_bf16 v[48:51], a[164:167], v[230:233], v[48:51]
ds_read_b128 a[204:207], v36 offset:24064
buffer_load_dwordx4 a[36:39], v1, s[8:11], s60 offen offset:1024 sc1
v_mfma_f32_16x16x32_bf16 v[20:23], a[164:167], v[234:237], v[20:23]
v_mov_b32 v79, v248
v_mfma_f32_16x16x32_bf16 v[52:55], a[168:171], v[230:233], v[52:55]
ds_read_b128 a[208:211], v36 offset:25088
v_mfma_f32_16x16x32_bf16 v[24:27], a[168:171], v[234:237], v[24:27]
v_mfma_f32_16x16x32_bf16 v[56:59], a[172:175], v[230:233], v[56:59]
ds_read_b128 a[212:215], v36 offset:26112
v_mfma_f32_16x16x32_bf16 v[28:31], a[172:175], v[234:237], v[28:31]
v_mfma_f32_16x16x32_bf16 v[60:63], a[176:179], v[230:233], v[60:63]
ds_read_b128 a[216:219], v40 offset:23040
v_mfma_f32_16x16x32_bf16 v[32:35], a[176:179], v[234:237], v[32:35]
s_waitcnt vmcnt(9) lgkmcnt(5)
v_mfma_f32_16x16x32_bf16 v[44:47], a[180:183], a[0:3], v[44:47]
ds_read_b128 a[160:163], v36 offset:27648
buffer_load_dwordx4 a[40:43], v1, s[8:11], s60 offen offset:2048 sc1
v_mfma_f32_16x16x32_bf16 v[48:51], a[184:187], a[0:3], v[48:51]
ds_read_b128 a[164:167], v36 offset:28672
v_mfma_f32_16x16x32_bf16 v[52:55], a[188:191], a[0:3], v[52:55]
ds_read_b128 a[168:171], v36 offset:29696
v_mfma_f32_16x16x32_bf16 v[56:59], a[192:195], a[0:3], v[56:59]
ds_read_b128 a[172:175], v36 offset:30720
v_mfma_f32_16x16x32_bf16 v[60:63], a[196:199], a[0:3], v[60:63]
ds_read_b128 a[176:179], v40 offset:27648
s_waitcnt vmcnt(9) lgkmcnt(5)
v_mfma_f32_16x16x32_bf16 v[44:47], a[200:203], a[4:7], v[44:47]
ds_read_b128 a[180:183], v36 offset:32256
buffer_load_dwordx4 a[44:47], v1, s[8:11], s60 offen offset:3072 sc1
v_mfma_f32_16x16x32_bf16 v[48:51], a[204:207], a[4:7], v[48:51]
ds_read_b128 a[184:187], v36 offset:33280
v_mfma_f32_16x16x32_bf16 v[52:55], a[208:211], a[4:7], v[52:55]
ds_read_b128 a[188:191], v36 offset:34304
v_mfma_f32_16x16x32_bf16 v[56:59], a[212:215], a[4:7], v[56:59]
ds_read_b128 a[192:195], v36 offset:35328
v_mfma_f32_16x16x32_bf16 v[60:63], a[216:219], a[4:7], v[60:63]
ds_read_b128 a[196:199], v40 offset:32256
s_waitcnt vmcnt(9) lgkmcnt(5)
v_mfma_f32_16x16x32_bf16 v[44:47], a[160:163], a[8:11], v[44:47]
ds_read_b128 a[200:203], v36 offset:36864
s_add_u32 s60, s60, 4096
v_mfma_f32_16x16x32_bf16 v[48:51], a[164:167], a[8:11], v[48:51]
ds_read_b128 a[204:207], v36 offset:37888
buffer_load_dwordx4 a[48:51], v1, s[8:11], s60 offen offset:0 sc1
v_mfma_f32_16x16x32_bf16 v[52:55], a[168:171], a[8:11], v[52:55]
ds_read_b128 a[208:211], v36 offset:38912
buffer_load_dwordx4 a[52:55], v1, s[8:11], s60 offen offset:1024 sc1
v_mfma_f32_16x16x32_bf16 v[56:59], a[172:175], a[8:11], v[56:59]
ds_read_b128 a[212:215], v36 offset:39936
v_mfma_f32_16x16x32_bf16 v[60:63], a[176:179], a[8:11], v[60:63]
ds_read_b128 a[216:219], v40 offset:36864
s_waitcnt vmcnt(10) lgkmcnt(5)
v_mfma_f32_16x16x32_bf16 v[44:47], a[180:183], a[12:15], v[44:47]
ds_read_b128 a[160:163], v36 offset:41472
v_mfma_f32_16x16x32_bf16 v[48:51], a[184:187], a[12:15], v[48:51]
ds_read_b128 a[164:167], v36 offset:42496
v_mfma_f32_16x16x32_bf16 v[52:55], a[188:191], a[12:15], v[52:55]
ds_read_b128 a[168:171], v36 offset:43520
v_mfma_f32_16x16x32_bf16 v[56:59], a[192:195], a[12:15], v[56:59]
ds_read_b128 a[172:175], v36 offset:44544
s_cmp_eq_u32 s71, 14
s_cselect_b32 s98, 4096, 0
s_add_u32 s60, s60, s98
buffer_load_dwordx4 a[56:59], v1, s[8:11], s60 offen offset:2048 sc1
v_mfma_f32_16x16x32_bf16 v[60:63], a[196:199], a[12:15], v[60:63]
ds_read_b128 a[176:179], v40 offset:41472
s_waitcnt vmcnt(10) lgkmcnt(5)
v_mfma_f32_16x16x32_bf16 v[44:47], a[200:203], a[16:19], v[44:47]
ds_read_b128 a[180:183], v36 offset:46080
buffer_load_dwordx4 a[60:63], v1, s[8:11], s60 offen offset:3072 sc1
v_mfma_f32_16x16x32_bf16 v[48:51], a[204:207], a[16:19], v[48:51]
ds_read_b128 a[184:187], v36 offset:47104
v_mfma_f32_16x16x32_bf16 v[52:55], a[208:211], a[16:19], v[52:55]
ds_read_b128 a[188:191], v36 offset:48128
v_mfma_f32_16x16x32_bf16 v[56:59], a[212:215], a[16:19], v[56:59]
ds_read_b128 a[192:195], v36 offset:49152
v_mfma_f32_16x16x32_bf16 v[60:63], a[216:219], a[16:19], v[60:63]
ds_read_b128 a[196:199], v40 offset:46080
s_barrier
s_waitcnt vmcnt(10) lgkmcnt(5)
v_mfma_f32_16x16x32_bf16 v[44:47], a[160:163], a[20:23], v[44:47]
ds_read_b128 a[200:203], v36 offset:50688
s_add_u32 s60, s60, 4096
v_mfma_f32_16x16x32_bf16 v[48:51], a[164:167], a[20:23], v[48:51]
ds_read_b128 a[204:207], v36 offset:51712
buffer_load_dwordx4 a[64:67], v1, s[8:11], s60 offen offset:0 sc1
v_mfma_f32_16x16x32_bf16 v[52:55], a[168:171], a[20:23], v[52:55]
ds_read_b128 a[208:211], v36 offset:52736
buffer_load_dwordx4 a[0:3], v1, s[8:11], s60 offen offset:1024 sc1
v_mfma_f32_16x16x32_bf16 v[56:59], a[172:175], a[20:23], v[56:59]
ds_read_b128 a[212:215], v36 offset:53760
v_mfma_f32_16x16x32_bf16 v[60:63], a[176:179], a[20:23], v[60:63]
ds_read_b128 a[216:219], v40 offset:50688
s_waitcnt vmcnt(11) lgkmcnt(5)
v_mfma_f32_16x16x32_bf16 v[44:47], a[180:183], a[24:27], v[44:47]
ds_read_b128 a[160:163], v37 offset:0
v_mfma_f32_16x16x32_bf16 v[48:51], a[184:187], a[24:27], v[48:51]
ds_read_b128 a[164:167], v37 offset:1024
v_mfma_f32_16x16x32_bf16 v[52:55], a[188:191], a[24:27], v[52:55]
ds_read_b128 a[168:171], v37 offset:2048
v_mfma_f32_16x16x32_bf16 v[56:59], a[192:195], a[24:27], v[56:59]
ds_read_b128 a[172:175], v37 offset:3072
s_cmp_eq_u32 s71, 18
s_cselect_b32 s98, 4096, 0
s_add_u32 s60, s60, s98
buffer_load_dwordx4 a[4:7], v1, s[8:11], s60 offen offset:2048 sc1
v_mfma_f32_16x16x32_bf16 v[60:63], a[196:199], a[24:27], v[60:63]
ds_read_b128 a[176:179], v41 offset:0
s_waitcnt vmcnt(11) lgkmcnt(5)
v_mfma_f32_16x16x32_bf16 v[44:47], a[200:203], a[28:31], v[44:47]
ds_read_b128 a[180:183], v37 offset:4608
buffer_load_dwordx4 a[8:11], v1, s[8:11], s60 offen offset:3072 sc1
v_mfma_f32_16x16x32_bf16 v[48:51], a[204:207], a[28:31], v[48:51]
ds_read_b128 a[184:187], v37 offset:5632
v_mfma_f32_16x16x32_bf16 v[52:55], a[208:211], a[28:31], v[52:55]
ds_read_b128 a[188:191], v37 offset:6656
v_mfma_f32_16x16x32_bf16 v[56:59], a[212:215], a[28:31], v[56:59]
ds_read_b128 a[192:195], v37 offset:7680
v_mfma_f32_16x16x32_bf16 v[60:63], a[216:219], a[28:31], v[60:63]
ds_read_b128 a[196:199], v41 offset:4608
s_waitcnt vmcnt(11) lgkmcnt(5)
v_mfma_f32_16x16x32_bf16 v[44:47], a[160:163], a[32:35], v[44:47]
ds_read_b128 a[200:203], v37 offset:9216
s_add_u32 s60, s60, 4096
v_mfma_f32_16x16x32_bf16 v[48:51], a[164:167], a[32:35], v[48:51]
ds_read_b128 a[204:207], v37 offset:10240
buffer_load_dwordx4 a[12:15], v1, s[8:11], s60 offen offset:0 sc1
v_mfma_f32_16x16x32_bf16 v[52:55], a[168:171], a[32:35], v[52:55]
ds_read_b128 a[208:211], v37 offset:11264
buffer_load_dwordx4 a[16:19], v1, s[8:11], s60 offen offset:1024 sc1
v_mfma_f32_16x16x32_bf16 v[56:59], a[172:175], a[32:35], v[56:59]
ds_read_b128 a[212:215], v37 offset:12288
v_mfma_f32_16x16x32_bf16 v[60:63], a[176:179], a[32:35], v[60:63]
ds_read_b128 a[216:219], v41 offset:9216
s_waitcnt vmcnt(12) lgkmcnt(5)
v_mfma_f32_16x16x32_bf16 v[44:47], a[180:183], a[36:39], v[44:47]
ds_read_b128 a[160:163], v37 offset:13824
buffer_load_dwordx4 a[20:23], v1, s[8:11], s60 offen offset:2048 sc1
v_mfma_f32_16x16x32_bf16 v[48:51], a[184:187], a[36:39], v[48:51]
ds_read_b128 a[164:167], v37 offset:14848
v_mfma_f32_16x16x32_bf16 v[52:55], a[188:191], a[36:39], v[52:55]
ds_read_b128 a[168:171], v37 offset:15872
v_mfma_f32_16x16x32_bf16 v[56:59], a[192:195], a[36:39], v[56:59]
ds_read_b128 a[172:175], v37 offset:16896
v_mfma_f32_16x16x32_bf16 v[60:63], a[196:199], a[36:39], v[60:63]
ds_read_b128 a[176:179], v41 offset:13824
s_waitcnt vmcnt(12) lgkmcnt(5)
v_mfma_f32_16x16x32_bf16 v[44:47], a[200:203], a[40:43], v[44:47]
ds_read_b128 a[180:183], v37 offset:18432
buffer_load_dwordx4 a[228:231], v1, s[4:7], s64 offen offset:2048 sc1
v_mfma_f32_16x16x32_bf16 v[48:51], a[204:207], a[40:43], v[48:51]
ds_read_b128 a[184:187], v37 offset:19456
v_mfma_f32_16x16x32_bf16 v[52:55], a[208:211], a[40:43], v[52:55]
ds_read_b128 a[188:191], v37 offset:20480
v_mfma_f32_16x16x32_bf16 v[56:59], a[212:215], a[40:43], v[56:59]
ds_read_b128 a[192:195], v37 offset:21504
s_cmp_eq_u32 s71, 23
s_cselect_b32 s98, 4096, 0
s_add_u32 s60, s60, s98
buffer_load_dwordx4 a[24:27], v1, s[8:11], s60 offen offset:3072 sc1
v_mfma_f32_16x16x32_bf16 v[60:63], a[216:219], a[40:43], v[60:63]
ds_read_b128 a[196:199], v41 offset:18432
s_waitcnt vmcnt(13) lgkmcnt(5)
v_mfma_f32_16x16x32_bf16 v[44:47], a[160:163], a[44:47], v[44:47]
ds_read_b128 a[200:203], v37 offset:23040
s_add_u32 s60, s60, 4096
v_mfma_f32_16x16x32_bf16 v[48:51], a[164:167], a[44:47], v[48:51]
ds_read_b128 a[204:207], v37 offset:24064
buffer_load_dwordx4 a[28:31], v1, s[8:11], s60 offen offset:0 sc1
v_mfma_f32_16x16x32_bf16 v[52:55], a[168:171], a[44:47], v[52:55]
ds_read_b128 a[208:211], v37 offset:25088
buffer_load_dwordx4 a[32:35], v1, s[8:11], s60 offen offset:1024 sc1
v_mfma_f32_16x16x32_bf16 v[56:59], a[172:175], a[44:47], v[56:59]
ds_read_b128 a[212:215], v37 offset:26112
v_mfma_f32_16x16x32_bf16 v[60:63], a[176:179], a[44:47], v[60:63]
ds_read_b128 a[216:219], v41 offset:23040
s_waitcnt vmcnt(14) lgkmcnt(5)
v_mfma_f32_16x16x32_bf16 v[44:47], a[180:183], a[48:51], v[44:47]
ds_read_b128 a[160:163], v37 offset:27648
buffer_load_dwordx4 a[36:39], v1, s[8:11], s60 offen offset:2048 sc1
v_mfma_f32_16x16x32_bf16 v[48:51], a[184:187], a[48:51], v[48:51]
ds_read_b128 a[164:167], v37 offset:28672
v_mfma_f32_16x16x32_bf16 v[52:55], a[188:191], a[48:51], v[52:55]
ds_read_b128 a[168:171], v37 offset:29696
v_mfma_f32_16x16x32_bf16 v[56:59], a[192:195], a[48:51], v[56:59]
ds_read_b128 a[172:175], v37 offset:30720
buffer_load_dwordx4 a[232:235], v1, s[4:7], s64 offen offset:3072 sc1
v_mfma_f32_16x16x32_bf16 v[60:63], a[196:199], a[48:51], v[60:63]
ds_read_b128 a[176:179], v41 offset:27648
s_waitcnt vmcnt(15) lgkmcnt(5)
v_mfma_f32_16x16x32_bf16 v[44:47], a[200:203], a[52:55], v[44:47]
ds_read_b128 a[180:183], v37 offset:32256
v_mfma_f32_16x16x32_bf16 v[48:51], a[204:207], a[52:55], v[48:51]
ds_read_b128 a[184:187], v37 offset:33280
v_mfma_f32_16x16x32_bf16 v[52:55], a[208:211], a[52:55], v[52:55]
ds_read_b128 a[188:191], v37 offset:34304
v_mfma_f32_16x16x32_bf16 v[56:59], a[212:215], a[52:55], v[56:59]
ds_read_b128 a[192:195], v37 offset:35328
s_cmp_eq_u32 s71, 27
s_cselect_b32 s98, 4096, 0
s_add_u32 s60, s60, s98
buffer_load_dwordx4 a[40:43], v1, s[8:11], s60 offen offset:3072 sc1
v_mfma_f32_16x16x32_bf16 v[60:63], a[216:219], a[52:55], v[60:63]
ds_read_b128 a[196:199], v41 offset:32256
s_waitcnt vmcnt(15) lgkmcnt(5)
v_mfma_f32_16x16x32_bf16 v[44:47], a[160:163], a[56:59], v[44:47]
ds_read_b128 a[200:203], v37 offset:36864
s_add_u32 s60, s60, 4096
v_mfma_f32_16x16x32_bf16 v[48:51], a[164:167], a[56:59], v[48:51]
ds_read_b128 a[204:207], v37 offset:37888
buffer_load_dwordx4 a[44:47], v1, s[8:11], s60 offen offset:0 sc1
v_mfma_f32_16x16x32_bf16 v[52:55], a[168:171], a[56:59], v[52:55]
ds_read_b128 a[208:211], v37 offset:38912
buffer_load_dwordx4 a[48:51], v1, s[8:11], s60 offen offset:1024 sc1
v_mfma_f32_16x16x32_bf16 v[56:59], a[172:175], a[56:59], v[56:59]
ds_read_b128 a[212:215], v37 offset:39936
v_mfma_f32_16x16x32_bf16 v[60:63], a[176:179], a[56:59], v[60:63]
ds_read_b128 a[216:219], v41 offset:36864
s_waitcnt vmcnt(16) lgkmcnt(5)
v_mfma_f32_16x16x32_bf16 v[44:47], a[180:183], a[60:63], v[44:47]
ds_read_b128 a[160:163], v37 offset:41472
buffer_load_dwordx4 a[52:55], v1, s[8:11], s60 offen offset:2048 sc1
v_mfma_f32_16x16x32_bf16 v[48:51], a[184:187], a[60:63], v[48:51]
ds_read_b128 a[164:167], v37 offset:42496
v_mfma_f32_16x16x32_bf16 v[52:55], a[188:191], a[60:63], v[52:55]
ds_read_b128 a[168:171], v37 offset:43520
buffer_load_dwordx4 a[236:239], v116, s[4:7], s64 offen sc1
v_mfma_f32_16x16x32_bf16 v[56:59], a[192:195], a[60:63], v[56:59]
ds_read_b128 a[172:175], v37 offset:44544
v_mfma_f32_16x16x32_bf16 v[60:63], a[196:199], a[60:63], v[60:63]
ds_read_b128 a[176:179], v41 offset:41472
s_waitcnt vmcnt(17) lgkmcnt(5)
v_mfma_f32_16x16x32_bf16 v[44:47], a[200:203], a[64:67], v[44:47]
ds_read_b128 a[180:183], v37 offset:46080
buffer_load_dwordx4 a[56:59], v1, s[8:11], s60 offen offset:3072 sc1
v_mfma_f32_16x16x32_bf16 v[48:51], a[204:207], a[64:67], v[48:51]
ds_read_b128 a[184:187], v37 offset:47104
v_mfma_f32_16x16x32_bf16 v[52:55], a[208:211], a[64:67], v[52:55]
ds_read_b128 a[188:191], v37 offset:48128
v_mfma_f32_16x16x32_bf16 v[56:59], a[212:215], a[64:67], v[56:59]
ds_read_b128 a[192:195], v37 offset:49152
v_mfma_f32_16x16x32_bf16 v[60:63], a[216:219], a[64:67], v[60:63]
ds_read_b128 a[196:199], v41 offset:46080
s_waitcnt vmcnt(17) lgkmcnt(5)
v_mfma_f32_16x16x32_bf16 v[44:47], a[160:163], a[0:3], v[44:47]
ds_read_b128 a[200:203], v37 offset:50688
s_mov_b32 s60, s61
v_mfma_f32_16x16x32_bf16 v[48:51], a[164:167], a[0:3], v[48:51]
ds_read_b128 a[204:207], v37 offset:51712
v_mfma_f32_16x16x32_bf16 v[52:55], a[168:171], a[0:3], v[52:55]
ds_read_b128 a[208:211], v37 offset:52736
v_mfma_f32_16x16x32_bf16 v[56:59], a[172:175], a[0:3], v[56:59]
ds_read_b128 a[212:215], v37 offset:53760
s_cmp_eq_u32 s71, 0
s_cselect_b32 s98, 4096, 0
s_add_u32 s60, s60, s98
buffer_load_dwordx4 a[60:63], v1, s[8:11], s60 offen offset:0 sc1
buffer_load_dwordx4 a[64:67], v1, s[8:11], s60 offen offset:1024 sc1
v_mfma_f32_16x16x32_bf16 v[60:63], a[176:179], a[0:3], v[60:63]
ds_read_b128 a[216:219], v41 offset:50688
s_waitcnt vmcnt(18) lgkmcnt(5)
v_mfma_f32_16x16x32_bf16 v[44:47], a[180:183], a[4:7], v[44:47]
ds_read_b128 a[160:163], v38 offset:0
buffer_load_dwordx4 a[0:3], v1, s[8:11], s60 offen offset:2048 sc1
v_mfma_f32_16x16x32_bf16 v[48:51], a[184:187], a[4:7], v[48:51]
ds_read_b128 a[164:167], v38 offset:1024
v_mfma_f32_16x16x32_bf16 v[52:55], a[188:191], a[4:7], v[52:55]
ds_read_b128 a[168:171], v38 offset:2048
v_mfma_f32_16x16x32_bf16 v[56:59], a[192:195], a[4:7], v[56:59]
ds_read_b128 a[172:175], v38 offset:3072
v_mfma_f32_16x16x32_bf16 v[60:63], a[196:199], a[4:7], v[60:63]
ds_read_b128 a[176:179], v42 offset:0
s_waitcnt vmcnt(18) lgkmcnt(5)
v_mfma_f32_16x16x32_bf16 v[44:47], a[200:203], a[8:11], v[44:47]
ds_read_b128 a[180:183], v38 offset:4608
buffer_load_dwordx4 a[4:7], v1, s[8:11], s60 offen offset:3072 sc1
v_mfma_f32_16x16x32_bf16 v[48:51], a[204:207], a[8:11], v[48:51]
ds_read_b128 a[184:187], v38 offset:5632
v_mfma_f32_16x16x32_bf16 v[52:55], a[208:211], a[8:11], v[52:55]
ds_read_b128 a[188:191], v38 offset:6656
v_mfma_f32_16x16x32_bf16 v[56:59], a[212:215], a[8:11], v[56:59]
ds_read_b128 a[192:195], v38 offset:7680
v_mfma_f32_16x16x32_bf16 v[60:63], a[216:219], a[8:11], v[60:63]
ds_read_b128 a[196:199], v42 offset:4608
s_waitcnt vmcnt(18) lgkmcnt(5)
v_mfma_f32_16x16x32_bf16 v[44:47], a[160:163], a[12:15], v[44:47]
ds_read_b128 a[200:203], v38 offset:9216
s_add_u32 s60, s60, 4096
v_mfma_f32_16x16x32_bf16 v[48:51], a[164:167], a[12:15], v[48:51]
ds_read_b128 a[204:207], v38 offset:10240
v_mfma_f32_16x16x32_bf16 v[52:55], a[168:171], a[12:15], v[52:55]
ds_read_b128 a[208:211], v38 offset:11264
buffer_load_dwordx4 a[8:11], v1, s[8:11], s60 offen offset:0 sc1
v_mfma_f32_16x16x32_bf16 v[56:59], a[172:175], a[12:15], v[56:59]
ds_read_b128 a[212:215], v38 offset:12288
v_mfma_f32_16x16x32_bf16 v[60:63], a[176:179], a[12:15], v[60:63]
ds_read_b128 a[216:219], v42 offset:9216
s_waitcnt vmcnt(18) lgkmcnt(5)
v_mfma_f32_16x16x32_bf16 v[44:47], a[180:183], a[16:19], v[44:47]
ds_read_b128 a[160:163], v38 offset:13824
v_mfma_f32_16x16x32_bf16 v[48:51], a[184:187], a[16:19], v[48:51]
ds_read_b128 a[164:167], v38 offset:14848
v_mfma_f32_16x16x32_bf16 v[52:55], a[188:191], a[16:19], v[52:55]
ds_read_b128 a[168:171], v38 offset:15872
v_mfma_f32_16x16x32_bf16 v[56:59], a[192:195], a[16:19], v[56:59]
ds_read_b128 a[172:175], v38 offset:16896
s_cmp_eq_u32 s71, 5
s_cselect_b32 s98, 4096, 0
s_add_u32 s60, s60, s98
buffer_load_dwordx4 a[12:15], v1, s[8:11], s60 offen offset:1024 sc1
v_mfma_f32_16x16x32_bf16 v[60:63], a[196:199], a[16:19], v[60:63]
ds_read_b128 a[176:179], v42 offset:13824
s_waitcnt vmcnt(18) lgkmcnt(5)
v_mfma_f32_16x16x32_bf16 v[44:47], a[200:203], a[20:23], v[44:47]
ds_read_b128 a[180:183], v38 offset:18432
buffer_load_dwordx4 a[16:19], v1, s[8:11], s60 offen offset:2048 sc1
v_mfma_f32_16x16x32_bf16 v[48:51], a[204:207], a[20:23], v[48:51]
ds_read_b128 a[184:187], v38 offset:19456
v_mfma_f32_16x16x32_bf16 v[52:55], a[208:211], a[20:23], v[52:55]
ds_read_b128 a[188:191], v38 offset:20480
v_mfma_f32_16x16x32_bf16 v[56:59], a[212:215], a[20:23], v[56:59]
ds_read_b128 a[192:195], v38 offset:21504
v_mfma_f32_16x16x32_bf16 v[60:63], a[216:219], a[20:23], v[60:63]
ds_read_b128 a[196:199], v42 offset:18432
s_waitcnt vmcnt(17) lgkmcnt(5)
v_mfma_f32_16x16x32_bf16 v[44:47], a[160:163], a[24:27], v[44:47]
ds_read_b128 a[200:203], v38 offset:23040
buffer_load_dwordx4 a[20:23], v1, s[8:11], s60 offen offset:3072 sc1
v_mfma_f32_16x16x32_bf16 v[48:51], a[164:167], a[24:27], v[48:51]
ds_read_b128 a[204:207], v38 offset:24064
v_mfma_f32_16x16x32_bf16 v[52:55], a[168:171], a[24:27], v[52:55]
ds_read_b128 a[208:211], v38 offset:25088
v_mfma_f32_16x16x32_bf16 v[56:59], a[172:175], a[24:27], v[56:59]
ds_read_b128 a[212:215], v38 offset:26112
v_mfma_f32_16x16x32_bf16 v[60:63], a[176:179], a[24:27], v[60:63]
ds_read_b128 a[216:219], v42 offset:23040
s_waitcnt vmcnt(17) lgkmcnt(5)
v_mfma_f32_16x16x32_bf16 v[44:47], a[180:183], a[28:31], v[44:47]
ds_read_b128 a[160:163], v38 offset:27648
s_add_u32 s60, s60, 4096
v_mfma_f32_16x16x32_bf16 v[48:51], a[184:187], a[28:31], v[48:51]
ds_read_b128 a[164:167], v38 offset:28672
v_mfma_f32_16x16x32_bf16 v[52:55], a[188:191], a[28:31], v[52:55]
ds_read_b128 a[168:171], v38 offset:29696
buffer_load_dwordx4 a[24:27], v1, s[8:11], s60 offen offset:0 sc1
v_mfma_f32_16x16x32_bf16 v[56:59], a[192:195], a[28:31], v[56:59]
ds_read_b128 a[172:175], v38 offset:30720
v_mfma_f32_16x16x32_bf16 v[60:63], a[196:199], a[28:31], v[60:63]
ds_read_b128 a[176:179], v42 offset:27648
s_waitcnt vmcnt(17) lgkmcnt(5)
v_mfma_f32_16x16x32_bf16 v[44:47], a[200:203], a[32:35], v[44:47]
ds_read_b128 a[180:183], v38 offset:32256
v_mfma_f32_16x16x32_bf16 v[48:51], a[204:207], a[32:35], v[48:51]
ds_read_b128 a[184:187], v38 offset:33280
v_mfma_f32_16x16x32_bf16 v[52:55], a[208:211], a[32:35], v[52:55]
ds_read_b128 a[188:191], v38 offset:34304
v_mfma_f32_16x16x32_bf16 v[56:59], a[212:215], a[32:35], v[56:59]
ds_read_b128 a[192:195], v38 offset:35328
s_cmp_eq_u32 s71, 9
s_cselect_b32 s98, 4096, 0
s_add_u32 s60, s60, s98
buffer_load_dwordx4 a[28:31], v1, s[8:11], s60 offen offset:1024 sc1
v_mfma_f32_16x16x32_bf16 v[60:63], a[216:219], a[32:35], v[60:63]
ds_read_b128 a[196:199], v42 offset:32256
s_waitcnt vmcnt(17) lgkmcnt(5)
v_mfma_f32_16x16x32_bf16 v[44:47], a[160:163], a[36:39], v[44:47]
ds_read_b128 a[200:203], v38 offset:36864
buffer_load_dwordx4 a[32:35], v1, s[8:11], s60 offen offset:2048 sc1
v_mfma_f32_16x16x32_bf16 v[48:51], a[164:167], a[36:39], v[48:51]
ds_read_b128 a[204:207], v38 offset:37888
v_mfma_f32_16x16x32_bf16 v[52:55], a[168:171], a[36:39], v[52:55]
ds_read_b128 a[208:211], v38 offset:38912
v_mfma_f32_16x16x32_bf16 v[56:59], a[172:175], a[36:39], v[56:59]
ds_read_b128 a[212:215], v38 offset:39936
v_mfma_f32_16x16x32_bf16 v[60:63], a[176:179], a[36:39], v[60:63]
ds_read_b128 a[216:219], v42 offset:36864
s_waitcnt vmcnt(16) lgkmcnt(5)
v_mfma_f32_16x16x32_bf16 v[44:47], a[180:183], a[40:43], v[44:47]
ds_read_b128 a[160:163], v38 offset:41472
buffer_load_dwordx4 a[36:39], v1, s[8:11], s60 offen offset:3072 sc1
v_mfma_f32_16x16x32_bf16 v[48:51], a[184:187], a[40:43], v[48:51]
ds_read_b128 a[164:167], v38 offset:42496
v_mfma_f32_16x16x32_bf16 v[52:55], a[188:191], a[40:43], v[52:55]
ds_read_b128 a[168:171], v38 offset:43520
v_mfma_f32_16x16x32_bf16 v[56:59], a[192:195], a[40:43], v[56:59]
ds_read_b128 a[172:175], v38 offset:44544
v_mfma_f32_16x16x32_bf16 v[60:63], a[196:199], a[40:43], v[60:63]
ds_read_b128 a[176:179], v42 offset:41472
s_waitcnt vmcnt(16) lgkmcnt(5)
v_mfma_f32_16x16x32_bf16 v[44:47], a[200:203], a[44:47], v[44:47]
ds_read_b128 a[180:183], v38 offset:46080
s_add_u32 s60, s60, 4096
v_mfma_f32_16x16x32_bf16 v[48:51], a[204:207], a[44:47], v[48:51]
ds_read_b128 a[184:187], v38 offset:47104
v_mfma_f32_16x16x32_bf16 v[52:55], a[208:211], a[44:47], v[52:55]
ds_read_b128 a[188:191], v38 offset:48128
buffer_load_dwordx4 a[40:43], v1, s[8:11], s60 offen offset:0 sc1
v_mfma_f32_16x16x32_bf16 v[56:59], a[212:215], a[44:47], v[56:59]
ds_read_b128 a[192:195], v38 offset:49152
v_mfma_f32_16x16x32_bf16 v[60:63], a[216:219], a[44:47], v[60:63]
ds_read_b128 a[196:199], v42 offset:46080
s_waitcnt vmcnt(16) lgkmcnt(5)
v_mfma_f32_16x16x32_bf16 v[44:47], a[160:163], a[48:51], v[44:47]
ds_read_b128 a[200:203], v38 offset:50688
buffer_load_dwordx4 a[44:47], v1, s[8:11], s60 offen offset:1024 sc1
v_mfma_f32_16x16x32_bf16 v[48:51], a[164:167], a[48:51], v[48:51]
ds_read_b128 a[204:207], v38 offset:51712
v_mfma_f32_16x16x32_bf16 v[52:55], a[168:171], a[48:51], v[52:55]
v_mfma_f32_16x16x32_bf16 v[56:59], a[172:175], a[48:51], v[56:59]
v_mfma_f32_16x16x32_bf16 v[60:63], a[176:179], a[48:51], v[60:63]
s_waitcnt vmcnt(16) lgkmcnt(2)
v_mfma_f32_16x16x32_bf16 v[44:47], a[180:183], a[52:55], v[44:47]
ds_read_b128 a[160:163], v36 offset:18432
v_mfma_f32_16x16x32_bf16 v[48:51], a[184:187], a[52:55], v[48:51]
ds_read_b128 a[164:167], v36 offset:19456
v_mfma_f32_16x16x32_bf16 v[52:55], a[188:191], a[52:55], v[52:55]
ds_read_b128 a[168:171], v36 offset:20480
v_mfma_f32_16x16x32_bf16 v[56:59], a[192:195], a[52:55], v[56:59]
ds_read_b128 a[172:175], v36 offset:21504
s_cmp_eq_u32 s71, 14
s_cselect_b32 s98, 4096, 0
s_add_u32 s60, s60, s98
buffer_load_dwordx4 a[48:51], v1, s[8:11], s60 offen offset:2048 sc1
v_mfma_f32_16x16x32_bf16 v[60:63], a[196:199], a[52:55], v[60:63]
ds_read_b128 a[176:179], v40 offset:18432
s_waitcnt vmcnt(15) lgkmcnt(5)
v_mfma_f32_16x16x32_bf16 v[44:47], a[200:203], a[56:59], v[44:47]
ds_read_b128 a[180:183], v36 offset:23040
buffer_load_dwordx4 a[52:55], v1, s[8:11], s60 offen offset:3072 sc1
v_mfma_f32_16x16x32_bf16 v[48:51], a[204:207], a[56:59], v[48:51]
ds_read_b128 a[184:187], v36 offset:24064
v_mfma_f32_16x16x32_bf16 v[52:55], a[228:231], a[56:59], v[52:55]
ds_read_b128 a[188:191], v36 offset:25088
v_mfma_f32_16x16x32_bf16 v[56:59], a[232:235], a[56:59], v[56:59]
ds_read_b128 a[192:195], v36 offset:26112
v_mfma_f32_16x16x32_bf16 v[60:63], a[236:239], a[56:59], v[60:63]
ds_read_b128 a[196:199], v40 offset:23040
s_waitcnt vmcnt(15) lgkmcnt(5)
v_mfma_f32_16x16x32_bf16 v[16:19], a[160:163], a[60:63], v[16:19]
ds_read_b128 a[200:203], v36 offset:27648
s_add_u32 s60, s60, 4096
v_mfma_f32_16x16x32_bf16 v[20:23], a[164:167], a[60:63], v[20:23]
ds_read_b128 a[204:207], v36 offset:28672
v_mfma_f32_16x16x32_bf16 v[24:27], a[168:171], a[60:63], v[24:27]
ds_read_b128 a[208:211], v36 offset:29696
buffer_load_dwordx4 a[56:59], v1, s[8:11], s60 offen offset:0 sc1
v_mfma_f32_16x16x32_bf16 v[28:31], a[172:175], a[60:63], v[28:31]
ds_read_b128 a[212:215], v36 offset:30720
v_mfma_f32_16x16x32_bf16 v[32:35], a[176:179], a[60:63], v[32:35]
ds_read_b128 a[216:219], v40 offset:27648
s_waitcnt vmcnt(15) lgkmcnt(5)
v_mfma_f32_16x16x32_bf16 v[16:19], a[180:183], a[64:67], v[16:19]
ds_read_b128 a[160:163], v36 offset:32256
buffer_load_dwordx4 a[60:63], v1, s[8:11], s60 offen offset:1024 sc1
v_mfma_f32_16x16x32_bf16 v[20:23], a[184:187], a[64:67], v[20:23]
ds_read_b128 a[164:167], v36 offset:33280
v_mfma_f32_16x16x32_bf16 v[24:27], a[188:191], a[64:67], v[24:27]
ds_read_b128 a[168:171], v36 offset:34304
v_mfma_f32_16x16x32_bf16 v[28:31], a[192:195], a[64:67], v[28:31]
ds_read_b128 a[172:175], v36 offset:35328
v_cvt_pk_bf16_f32 v64, v44, v45
v_mfma_f32_16x16x32_bf16 v[32:35], a[196:199], a[64:67], v[32:35]
ds_read_b128 a[176:179], v40 offset:32256
s_waitcnt vmcnt(15) lgkmcnt(5)
v_mfma_f32_16x16x32_bf16 v[16:19], a[200:203], a[0:3], v[16:19]
ds_read_b128 a[180:183], v36 offset:36864
v_cvt_pk_bf16_f32 v65, v46, v47
v_mfma_f32_16x16x32_bf16 v[20:23], a[204:207], a[0:3], v[20:23]
ds_read_b128 a[184:187], v36 offset:37888
v_mfma_f32_16x16x32_bf16 v[24:27], a[208:211], a[0:3], v[24:27]
ds_read_b128 a[188:191], v36 offset:38912
v_cvt_pk_bf16_f32 v66, v48, v49
v_mfma_f32_16x16x32_bf16 v[28:31], a[212:215], a[0:3], v[28:31]
ds_read_b128 a[192:195], v36 offset:39936
s_cmp_eq_u32 s71, 18
s_cselect_b32 s98, 4096, 0
s_add_u32 s60, s60, s98
buffer_load_dwordx4 a[64:67], v1, s[8:11], s60 offen offset:2048 sc1
v_mfma_f32_16x16x32_bf16 v[32:35], a[216:219], a[0:3], v[32:35]
ds_read_b128 a[196:199], v40 offset:36864
s_waitcnt vmcnt(15) lgkmcnt(5)
v_mfma_f32_16x16x32_bf16 v[16:19], a[160:163], a[4:7], v[16:19]
ds_read_b128 a[200:203], v36 offset:41472
buffer_load_dwordx4 a[0:3], v1, s[8:11], s60 offen offset:3072 sc1
v_mfma_f32_16x16x32_bf16 v[20:23], a[164:167], a[4:7], v[20:23]
ds_read_b128 a[204:207], v36 offset:42496
buffer_store_dwordx4 v[64:67], v1, s[8:11], s62 offen offset:0 sc1
v_mfma_f32_16x16x32_bf16 v[24:27], a[168:171], a[4:7], v[24:27]
ds_read_b128 a[208:211], v36 offset:43520
v_cvt_pk_bf16_f32 v68, v50, v51
v_mfma_f32_16x16x32_bf16 v[28:31], a[172:175], a[4:7], v[28:31]
ds_read_b128 a[212:215], v36 offset:44544
v_cvt_pk_bf16_f32 v69, v52, v53
v_mfma_f32_16x16x32_bf16 v[32:35], a[176:179], a[4:7], v[32:35]
ds_read_b128 a[216:219], v40 offset:41472
s_waitcnt vmcnt(16) lgkmcnt(5)
v_mfma_f32_16x16x32_bf16 v[16:19], a[180:183], a[8:11], v[16:19]
ds_read_b128 a[160:163], v36 offset:46080
s_add_u32 s60, s60, 4096
v_mfma_f32_16x16x32_bf16 v[20:23], a[184:187], a[8:11], v[20:23]
ds_read_b128 a[164:167], v36 offset:47104
v_cvt_pk_bf16_f32 v70, v54, v55
v_mfma_f32_16x16x32_bf16 v[24:27], a[188:191], a[8:11], v[24:27]
ds_read_b128 a[168:171], v36 offset:48128
buffer_load_dwordx4 a[4:7], v1, s[8:11], s60 offen offset:0 sc1
v_mfma_f32_16x16x32_bf16 v[28:31], a[192:195], a[8:11], v[28:31]
ds_read_b128 a[172:175], v36 offset:49152
buffer_store_dwordx4 v[68:71], v1, s[8:11], s62 offen offset:1024 sc1
v_mfma_f32_16x16x32_bf16 v[32:35], a[196:199], a[8:11], v[32:35]
ds_read_b128 a[176:179], v40 offset:46080
s_waitcnt vmcnt(17) lgkmcnt(5)
v_mfma_f32_16x16x32_bf16 v[16:19], a[200:203], a[12:15], v[16:19]
ds_read_b128 a[180:183], v36 offset:50688
buffer_load_dwordx4 a[8:11], v1, s[8:11], s60 offen offset:1024 sc1
v_mfma_f32_16x16x32_bf16 v[20:23], a[204:207], a[12:15], v[20:23]
ds_read_b128 a[184:187], v36 offset:51712
v_cvt_pk_bf16_f32 v72, v56, v57
v_mfma_f32_16x16x32_bf16 v[24:27], a[208:211], a[12:15], v[24:27]
ds_read_b128 a[188:191], v36 offset:52736
v_cvt_pk_bf16_f32 v73, v58, v59
v_mfma_f32_16x16x32_bf16 v[28:31], a[212:215], a[12:15], v[28:31]
ds_read_b128 a[192:195], v36 offset:53760
v_cvt_pk_bf16_f32 v74, v60, v61
v_mfma_f32_16x16x32_bf16 v[32:35], a[216:219], a[12:15], v[32:35]
ds_read_b128 a[196:199], v40 offset:50688
s_waitcnt vmcnt(17) lgkmcnt(5)
v_mfma_f32_16x16x32_bf16 v[16:19], a[160:163], a[16:19], v[16:19]
ds_read_b128 a[200:203], v37 offset:0
buffer_load_dwordx4 a[12:15], v1, s[8:11], s60 offen offset:2048 sc1
v_mfma_f32_16x16x32_bf16 v[20:23], a[164:167], a[16:19], v[20:23]
ds_read_b128 a[204:207], v37 offset:1024
buffer_store_dwordx4 v[72:75], v1, s[8:11], s62 offen offset:2048 sc1
v_mfma_f32_16x16x32_bf16 v[24:27], a[168:171], a[16:19], v[24:27]
ds_read_b128 a[208:211], v37 offset:2048
v_cvt_pk_bf16_f32 v76, v62, v63
v_mfma_f32_16x16x32_bf16 v[28:31], a[172:175], a[16:19], v[28:31]
ds_read_b128 a[212:215], v37 offset:3072
v_mfma_f32_16x16x32_bf16 v[32:35], a[176:179], a[16:19], v[32:35]
ds_read_b128 a[216:219], v41 offset:0
s_waitcnt vmcnt(18) lgkmcnt(5)
v_mfma_f32_16x16x32_bf16 v[16:19], a[180:183], a[20:23], v[16:19]
ds_read_b128 a[160:163], v37 offset:4608
buffer_store_dwordx4 v[76:79], v1, s[8:11], s62 offen offset:3072 sc1
v_mfma_f32_16x16x32_bf16 v[20:23], a[184:187], a[20:23], v[20:23]
ds_read_b128 a[164:167], v37 offset:5632
v_mfma_f32_16x16x32_bf16 v[24:27], a[188:191], a[20:23], v[24:27]
ds_read_b128 a[168:171], v37 offset:6656
v_mfma_f32_16x16x32_bf16 v[28:31], a[192:195], a[20:23], v[28:31]
ds_read_b128 a[172:175], v37 offset:7680
s_cmp_eq_u32 s71, 23
s_cselect_b32 s98, 4096, 0
s_add_u32 s60, s60, s98
buffer_load_dwordx4 a[16:19], v1, s[8:11], s60 offen offset:3072 sc1
v_mfma_f32_16x16x32_bf16 v[32:35], a[196:199], a[20:23], v[32:35]
ds_read_b128 a[176:179], v41 offset:4608
s_waitcnt vmcnt(19) lgkmcnt(5)
v_mfma_f32_16x16x32_bf16 v[16:19], a[200:203], a[24:27], v[16:19]
ds_read_b128 a[180:183], v37 offset:9216
s_add_u32 s60, s60, 4096
v_mfma_f32_16x16x32_bf16 v[20:23], a[204:207], a[24:27], v[20:23]
ds_read_b128 a[184:187], v37 offset:10240
v_mfma_f32_16x16x32_bf16 v[24:27], a[208:211], a[24:27], v[24:27]
ds_read_b128 a[188:191], v37 offset:11264
buffer_load_dwordx4 a[20:23], v1, s[8:11], s60 offen offset:0 sc1
v_mfma_f32_16x16x32_bf16 v[28:31], a[212:215], a[24:27], v[28:31]
ds_read_b128 a[192:195], v37 offset:12288
v_mfma_f32_16x16x32_bf16 v[32:35], a[216:219], a[24:27], v[32:35]
ds_read_b128 a[196:199], v41 offset:9216
s_waitcnt vmcnt(19) lgkmcnt(5)
v_mfma_f32_16x16x32_bf16 v[16:19], a[160:163], a[28:31], v[16:19]
ds_read_b128 a[200:203], v37 offset:13824
buffer_load_dwordx4 a[24:27], v1, s[8:11], s60 offen offset:1024 sc1
v_mfma_f32_16x16x32_bf16 v[20:23], a[164:167], a[28:31], v[20:23]
ds_read_b128 a[204:207], v37 offset:14848
v_mfma_f32_16x16x32_bf16 v[24:27], a[168:171], a[28:31], v[24:27]
ds_read_b128 a[208:211], v37 offset:15872
v_mfma_f32_16x16x32_bf16 v[28:31], a[172:175], a[28:31], v[28:31]
ds_read_b128 a[212:215], v37 offset:16896
v_mfma_f32_16x16x32_bf16 v[32:35], a[176:179], a[28:31], v[32:35]
ds_read_b128 a[216:219], v41 offset:13824
s_waitcnt vmcnt(19) lgkmcnt(5)
v_mfma_f32_16x16x32_bf16 v[16:19], a[180:183], a[32:35], v[16:19]
ds_read_b128 a[160:163], v37 offset:18432
buffer_load_dwordx4 a[28:31], v1, s[8:11], s60 offen offset:2048 sc1
v_mfma_f32_16x16x32_bf16 v[20:23], a[184:187], a[32:35], v[20:23]
ds_read_b128 a[164:167], v37 offset:19456
v_mfma_f32_16x16x32_bf16 v[24:27], a[188:191], a[32:35], v[24:27]
ds_read_b128 a[168:171], v37 offset:20480
v_mfma_f32_16x16x32_bf16 v[28:31], a[192:195], a[32:35], v[28:31]
ds_read_b128 a[172:175], v37 offset:21504
v_mfma_f32_16x16x32_bf16 v[32:35], a[196:199], a[32:35], v[32:35]
ds_read_b128 a[176:179], v41 offset:18432
s_waitcnt vmcnt(19) lgkmcnt(5)
v_mfma_f32_16x16x32_bf16 v[16:19], a[200:203], a[36:39], v[16:19]
ds_read_b128 a[180:183], v37 offset:23040
v_mfma_f32_16x16x32_bf16 v[20:23], a[204:207], a[36:39], v[20:23]
ds_read_b128 a[184:187], v37 offset:24064
v_mfma_f32_16x16x32_bf16 v[24:27], a[208:211], a[36:39], v[24:27]
ds_read_b128 a[188:191], v37 offset:25088
v_mfma_f32_16x16x32_bf16 v[28:31], a[212:215], a[36:39], v[28:31]
ds_read_b128 a[192:195], v37 offset:26112
s_cmp_eq_u32 s71, 27
s_cselect_b32 s98, 4096, 0
s_add_u32 s60, s60, s98
buffer_load_dwordx4 a[32:35], v1, s[8:11], s60 offen offset:3072 sc1
v_mfma_f32_16x16x32_bf16 v[32:35], a[216:219], a[36:39], v[32:35]
ds_read_b128 a[196:199], v41 offset:23040
s_waitcnt vmcnt(19) lgkmcnt(5)
v_mfma_f32_16x16x32_bf16 v[16:19], a[160:163], a[40:43], v[16:19]
ds_read_b128 a[200:203], v37 offset:27648
s_add_u32 s60, s60, 4096
v_mfma_f32_16x16x32_bf16 v[20:23], a[164:167], a[40:43], v[20:23]
ds_read_b128 a[204:207], v37 offset:28672
v_mfma_f32_16x16x32_bf16 v[24:27], a[168:171], a[40:43], v[24:27]
ds_read_b128 a[208:211], v37 offset:29696
buffer_load_dwordx4 a[36:39], v1, s[8:11], s60 offen offset:0 sc1
v_mfma_f32_16x16x32_bf16 v[28:31], a[172:175], a[40:43], v[28:31]
ds_read_b128 a[212:215], v37 offset:30720
v_mfma_f32_16x16x32_bf16 v[32:35], a[176:179], a[40:43], v[32:35]
ds_read_b128 a[216:219], v41 offset:27648
s_waitcnt vmcnt(19) lgkmcnt(5)
v_mfma_f32_16x16x32_bf16 v[16:19], a[180:183], a[44:47], v[16:19]
ds_read_b128 a[160:163], v37 offset:32256
buffer_load_dwordx4 a[40:43], v1, s[8:11], s60 offen offset:1024 sc1
v_mfma_f32_16x16x32_bf16 v[20:23], a[184:187], a[44:47], v[20:23]
ds_read_b128 a[164:167], v37 offset:33280
v_mfma_f32_16x16x32_bf16 v[24:27], a[188:191], a[44:47], v[24:27]
ds_read_b128 a[168:171], v37 offset:34304
v_mfma_f32_16x16x32_bf16 v[28:31], a[192:195], a[44:47], v[28:31]
ds_read_b128 a[172:175], v37 offset:35328
v_mfma_f32_16x16x32_bf16 v[32:35], a[196:199], a[44:47], v[32:35]
ds_read_b128 a[176:179], v41 offset:32256
s_waitcnt vmcnt(19) lgkmcnt(5)
v_mfma_f32_16x16x32_bf16 v[16:19], a[200:203], a[48:51], v[16:19]
ds_read_b128 a[180:183], v37 offset:36864
buffer_load_dwordx4 a[44:47], v1, s[8:11], s60 offen offset:2048 sc1
v_mfma_f32_16x16x32_bf16 v[20:23], a[204:207], a[48:51], v[20:23]
ds_read_b128 a[184:187], v37 offset:37888
v_mfma_f32_16x16x32_bf16 v[24:27], a[208:211], a[48:51], v[24:27]
ds_read_b128 a[188:191], v37 offset:38912
v_mfma_f32_16x16x32_bf16 v[28:31], a[212:215], a[48:51], v[28:31]
ds_read_b128 a[192:195], v37 offset:39936
v_mfma_f32_16x16x32_bf16 v[32:35], a[216:219], a[48:51], v[32:35]
ds_read_b128 a[196:199], v41 offset:36864
s_waitcnt vmcnt(19) lgkmcnt(5)
v_mfma_f32_16x16x32_bf16 v[16:19], a[160:163], a[52:55], v[16:19]
ds_read_b128 a[200:203], v37 offset:41472
buffer_load_dwordx4 a[48:51], v1, s[8:11], s60 offen offset:3072 sc1
v_mfma_f32_16x16x32_bf16 v[20:23], a[164:167], a[52:55], v[20:23]
ds_read_b128 a[204:207], v37 offset:42496
v_mfma_f32_16x16x32_bf16 v[24:27], a[168:171], a[52:55], v[24:27]
ds_read_b128 a[208:211], v37 offset:43520
v_mfma_f32_16x16x32_bf16 v[28:31], a[172:175], a[52:55], v[28:31]
ds_read_b128 a[212:215], v37 offset:44544
v_mfma_f32_16x16x32_bf16 v[32:35], a[176:179], a[52:55], v[32:35]
ds_read_b128 a[216:219], v41 offset:41472
s_waitcnt vmcnt(19) lgkmcnt(5)
v_mfma_f32_16x16x32_bf16 v[16:19], a[180:183], a[56:59], v[16:19]
ds_read_b128 a[160:163], v37 offset:46080
v_mfma_f32_16x16x32_bf16 v[20:23], a[184:187], a[56:59], v[20:23]
ds_read_b128 a[164:167], v37 offset:47104
v_mfma_f32_16x16x32_bf16 v[24:27], a[188:191], a[56:59], v[24:27]
ds_read_b128 a[168:171], v37 offset:48128
v_mfma_f32_16x16x32_bf16 v[28:31], a[192:195], a[56:59], v[28:31]
ds_read_b128 a[172:175], v37 offset:49152
v_mfma_f32_16x16x32_bf16 v[32:35], a[196:199], a[56:59], v[32:35]
ds_read_b128 a[176:179], v41 offset:46080
s_waitcnt vmcnt(18) lgkmcnt(5)
v_mfma_f32_16x16x32_bf16 v[16:19], a[200:203], a[60:63], v[16:19]
ds_read_b128 a[180:183], v37 offset:50688
v_mfma_f32_16x16x32_bf16 v[20:23], a[204:207], a[60:63], v[20:23]
ds_read_b128 a[184:187], v37 offset:51712
v_mfma_f32_16x16x32_bf16 v[24:27], a[208:211], a[60:63], v[24:27]
ds_read_b128 a[188:191], v37 offset:52736
v_mfma_f32_16x16x32_bf16 v[28:31], a[212:215], a[60:63], v[28:31]
ds_read_b128 a[192:195], v37 offset:53760
v_mfma_f32_16x16x32_bf16 v[32:35], a[216:219], a[60:63], v[32:35]
ds_read_b128 a[196:199], v41 offset:50688
s_waitcnt vmcnt(17) lgkmcnt(5)
v_mfma_f32_16x16x32_bf16 v[16:19], a[160:163], a[64:67], v[16:19]
ds_read_b128 a[200:203], v38 offset:0
buffer_load_dwordx4 v[80:83], v1, s[8:11], s63 offen offset:0 sc1
v_mfma_f32_16x16x32_bf16 v[20:23], a[164:167], a[64:67], v[20:23]
ds_read_b128 a[204:207], v38 offset:1024
v_mfma_f32_16x16x32_bf16 v[24:27], a[168:171], a[64:67], v[24:27]
ds_read_b128 a[208:211], v38 offset:2048
v_mfma_f32_16x16x32_bf16 v[28:31], a[172:175], a[64:67], v[28:31]
ds_read_b128 a[212:215], v38 offset:3072
v_mfma_f32_16x16x32_bf16 v[32:35], a[176:179], a[64:67], v[32:35]
ds_read_b128 a[216:219], v42 offset:0
s_waitcnt vmcnt(17) lgkmcnt(5)
v_mfma_f32_16x16x32_bf16 v[16:19], a[180:183], a[0:3], v[16:19]
ds_read_b128 a[160:163], v38 offset:4608
buffer_load_dwordx4 v[84:87], v1, s[8:11], s63 offen offset:1024 sc1
v_mfma_f32_16x16x32_bf16 v[20:23], a[184:187], a[0:3], v[20:23]
ds_read_b128 a[164:167], v38 offset:5632
v_mfma_f32_16x16x32_bf16 v[24:27], a[188:191], a[0:3], v[24:27]
ds_read_b128 a[168:171], v38 offset:6656
v_mfma_f32_16x16x32_bf16 v[28:31], a[192:195], a[0:3], v[28:31]
ds_read_b128 a[172:175], v38 offset:7680
v_mfma_f32_16x16x32_bf16 v[32:35], a[196:199], a[0:3], v[32:35]
ds_read_b128 a[176:179], v42 offset:4608
s_waitcnt vmcnt(16) lgkmcnt(5)
v_mfma_f32_16x16x32_bf16 v[16:19], a[200:203], a[4:7], v[16:19]
ds_read_b128 a[180:183], v38 offset:9216
buffer_load_dwordx4 v[88:91], v1, s[8:11], s63 offen offset:2048 sc1
v_mfma_f32_16x16x32_bf16 v[20:23], a[204:207], a[4:7], v[20:23]
ds_read_b128 a[184:187], v38 offset:10240
v_mfma_f32_16x16x32_bf16 v[24:27], a[208:211], a[4:7], v[24:27]
ds_read_b128 a[188:191], v38 offset:11264
v_mfma_f32_16x16x32_bf16 v[28:31], a[212:215], a[4:7], v[28:31]
ds_read_b128 a[192:195], v38 offset:12288
v_mfma_f32_16x16x32_bf16 v[32:35], a[216:219], a[4:7], v[32:35]
ds_read_b128 a[196:199], v42 offset:9216
s_waitcnt vmcnt(15) lgkmcnt(5)
v_mfma_f32_16x16x32_bf16 v[16:19], a[160:163], a[8:11], v[16:19]
ds_read_b128 a[200:203], v38 offset:13824
buffer_load_dwordx4 v[92:95], v1, s[8:11], s63 offen offset:3072 sc1
v_mfma_f32_16x16x32_bf16 v[20:23], a[164:167], a[8:11], v[20:23]
ds_read_b128 a[204:207], v38 offset:14848
v_mfma_f32_16x16x32_bf16 v[24:27], a[168:171], a[8:11], v[24:27]
ds_read_b128 a[208:211], v38 offset:15872
v_mfma_f32_16x16x32_bf16 v[28:31], a[172:175], a[8:11], v[28:31]
ds_read_b128 a[212:215], v38 offset:16896
v_mfma_f32_16x16x32_bf16 v[32:35], a[176:179], a[8:11], v[32:35]
ds_read_b128 a[216:219], v42 offset:13824
s_waitcnt vmcnt(15) lgkmcnt(5)
v_mfma_f32_16x16x32_bf16 v[16:19], a[180:183], a[12:15], v[16:19]
ds_read_b128 a[160:163], v38 offset:18432
v_mfma_f32_16x16x32_bf16 v[20:23], a[184:187], a[12:15], v[20:23]
ds_read_b128 a[164:167], v38 offset:19456
v_mfma_f32_16x16x32_bf16 v[24:27], a[188:191], a[12:15], v[24:27]
ds_read_b128 a[168:171], v38 offset:20480
v_mfma_f32_16x16x32_bf16 v[28:31], a[192:195], a[12:15], v[28:31]
ds_read_b128 a[172:175], v38 offset:21504
v_mfma_f32_16x16x32_bf16 v[32:35], a[196:199], a[12:15], v[32:35]
ds_read_b128 a[176:179], v42 offset:18432
s_waitcnt vmcnt(12) lgkmcnt(5)
v_mfma_f32_16x16x32_bf16 v[16:19], a[200:203], a[16:19], v[16:19]
ds_read_b128 a[180:183], v38 offset:23040
v_mfma_f32_16x16x32_bf16 v[20:23], a[204:207], a[16:19], v[20:23]
ds_read_b128 a[184:187], v38 offset:24064
v_mfma_f32_16x16x32_bf16 v[24:27], a[208:211], a[16:19], v[24:27]
ds_read_b128 a[188:191], v38 offset:25088
v_mfma_f32_16x16x32_bf16 v[28:31], a[212:215], a[16:19], v[28:31]
ds_read_b128 a[192:195], v38 offset:26112
v_mfma_f32_16x16x32_bf16 v[32:35], a[216:219], a[16:19], v[32:35]
ds_read_b128 a[196:199], v42 offset:23040
s_waitcnt vmcnt(11) lgkmcnt(5)
v_mfma_f32_16x16x32_bf16 v[16:19], a[160:163], a[20:23], v[16:19]
ds_read_b128 a[200:203], v38 offset:27648
v_mfma_f32_16x16x32_bf16 v[20:23], a[164:167], a[20:23], v[20:23]
ds_read_b128 a[204:207], v38 offset:28672
v_mfma_f32_16x16x32_bf16 v[24:27], a[168:171], a[20:23], v[24:27]
ds_read_b128 a[208:211], v38 offset:29696
v_mfma_f32_16x16x32_bf16 v[28:31], a[172:175], a[20:23], v[28:31]
ds_read_b128 a[212:215], v38 offset:30720
v_mfma_f32_16x16x32_bf16 v[32:35], a[176:179], a[20:23], v[32:35]
ds_read_b128 a[216:219], v42 offset:27648
s_waitcnt vmcnt(10) lgkmcnt(5)
v_mfma_f32_16x16x32_bf16 v[16:19], a[180:183], a[24:27], v[16:19]
ds_read_b128 a[160:163], v38 offset:32256
v_mfma_f32_16x16x32_bf16 v[20:23], a[184:187], a[24:27], v[20:23]
ds_read_b128 a[164:167], v38 offset:33280
v_mfma_f32_16x16x32_bf16 v[24:27], a[188:191], a[24:27], v[24:27]
ds_read_b128 a[168:171], v38 offset:34304
v_mfma_f32_16x16x32_bf16 v[28:31], a[192:195], a[24:27], v[28:31]
ds_read_b128 a[172:175], v38 offset:35328
v_mfma_f32_16x16x32_bf16 v[32:35], a[196:199], a[24:27], v[32:35]
ds_read_b128 a[176:179], v42 offset:32256
s_waitcnt vmcnt(9) lgkmcnt(5)
v_mfma_f32_16x16x32_bf16 v[16:19], a[200:203], a[28:31], v[16:19]
ds_read_b128 a[180:183], v38 offset:36864
v_mfma_f32_16x16x32_bf16 v[20:23], a[204:207], a[28:31], v[20:23]
ds_read_b128 a[184:187], v38 offset:37888
v_mfma_f32_16x16x32_bf16 v[24:27], a[208:211], a[28:31], v[24:27]
ds_read_b128 a[188:191], v38 offset:38912
v_mfma_f32_16x16x32_bf16 v[28:31], a[212:215], a[28:31], v[28:31]
ds_read_b128 a[192:195], v38 offset:39936
v_mfma_f32_16x16x32_bf16 v[32:35], a[216:219], a[28:31], v[32:35]
ds_read_b128 a[196:199], v42 offset:36864
s_waitcnt vmcnt(8) lgkmcnt(5)
v_mfma_f32_16x16x32_bf16 v[16:19], a[160:163], a[32:35], v[16:19]
ds_read_b128 a[200:203], v38 offset:41472
v_mfma_f32_16x16x32_bf16 v[20:23], a[164:167], a[32:35], v[20:23]
ds_read_b128 a[204:207], v38 offset:42496
v_mfma_f32_16x16x32_bf16 v[24:27], a[168:171], a[32:35], v[24:27]
ds_read_b128 a[208:211], v38 offset:43520
v_mfma_f32_16x16x32_bf16 v[28:31], a[172:175], a[32:35], v[28:31]
ds_read_b128 a[212:215], v38 offset:44544
v_mfma_f32_16x16x32_bf16 v[32:35], a[176:179], a[32:35], v[32:35]
ds_read_b128 a[216:219], v42 offset:41472
s_waitcnt vmcnt(7) lgkmcnt(5)
v_mfma_f32_16x16x32_bf16 v[16:19], a[180:183], a[36:39], v[16:19]
ds_read_b128 a[160:163], v38 offset:46080
v_mfma_f32_16x16x32_bf16 v[20:23], a[184:187], a[36:39], v[20:23]
ds_read_b128 a[164:167], v38 offset:47104
v_mfma_f32_16x16x32_bf16 v[24:27], a[188:191], a[36:39], v[24:27]
ds_read_b128 a[168:171], v38 offset:48128
v_mfma_f32_16x16x32_bf16 v[28:31], a[192:195], a[36:39], v[28:31]
ds_read_b128 a[172:175], v38 offset:49152
v_mfma_f32_16x16x32_bf16 v[32:35], a[196:199], a[36:39], v[32:35]
ds_read_b128 a[176:179], v42 offset:46080
s_waitcnt vmcnt(6) lgkmcnt(5)
v_mfma_f32_16x16x32_bf16 v[16:19], a[200:203], a[40:43], v[16:19]
ds_read_b128 a[180:183], v38 offset:50688
v_mfma_f32_16x16x32_bf16 v[20:23], a[204:207], a[40:43], v[20:23]
ds_read_b128 a[184:187], v38 offset:51712
v_mfma_f32_16x16x32_bf16 v[24:27], a[208:211], a[40:43], v[24:27]
v_mfma_f32_16x16x32_bf16 v[28:31], a[212:215], a[40:43], v[28:31]
v_mfma_f32_16x16x32_bf16 v[32:35], a[216:219], a[40:43], v[32:35]
s_waitcnt vmcnt(5) lgkmcnt(2)
v_mfma_f32_16x16x32_bf16 v[16:19], a[160:163], a[44:47], v[16:19]
v_mfma_f32_16x16x32_bf16 v[20:23], a[164:167], a[44:47], v[20:23]
v_mfma_f32_16x16x32_bf16 v[24:27], a[168:171], a[44:47], v[24:27]
v_mfma_f32_16x16x32_bf16 v[28:31], a[172:175], a[44:47], v[28:31]
v_mfma_f32_16x16x32_bf16 v[32:35], a[176:179], a[44:47], v[32:35]
s_waitcnt vmcnt(4) lgkmcnt(0)
v_mfma_f32_16x16x32_bf16 v[16:19], a[180:183], a[48:51], v[16:19]
s_waitcnt vmcnt(0)
v_xor_b32 v118, v248, v83
v_xor_b32 v119, v248, v87
v_xor_b32 v120, v248, v91
v_xor_b32 v121, v248, v95
v_mfma_f32_16x16x32_bf16 v[20:23], a[184:187], a[48:51], v[20:23]
v_or3_b32 v118, v118, v119, v120
v_or_b32 v118, v118, v121
v_cmp_ne_u32 vcc, 0, v118
s_nop 0
s_cbranch_vccnz L_xslow_43
L_xback_44:
v_mfma_f32_16x16x32_bf16 v[24:27], a[228:231], a[48:51], v[24:27]
v_lshlrev_b32 v96, 16, v80
v_and_b32 v97, 0xffff0000, v80
v_lshlrev_b32 v98, 16, v81
v_and_b32 v99, 0xffff0000, v81
v_lshlrev_b32 v100, 16, v82
v_and_b32 v101, 0xffff0000, v82
v_mfma_f32_16x16x32_bf16 v[28:31], a[232:235], a[48:51], v[28:31]
v_lshlrev_b32 v102, 16, v84
v_and_b32 v103, 0xffff0000, v84
v_lshlrev_b32 v104, 16, v85
v_and_b32 v105, 0xffff0000, v85
v_lshlrev_b32 v106, 16, v86
v_and_b32 v107, 0xffff0000, v86
v_mfma_f32_16x16x32_bf16 v[32:35], a[236:239], a[48:51], v[32:35]
v_lshlrev_b32 v108, 16, v88
v_and_b32 v109, 0xffff0000, v88
v_lshlrev_b32 v110, 16, v89
v_and_b32 v111, 0xffff0000, v89
v_lshlrev_b32 v112, 16, v90
v_and_b32 v113, 0xffff0000, v90
v_lshlrev_b32 v114, 16, v92
v_and_b32 v115, 0xffff0000, v92
s_nop 3
v_pk_add_f32 v[16:17], v[16:17], v[96:97]
v_pk_add_f32 v[18:19], v[18:19], v[98:99]
v_pk_add_f32 v[20:21], v[20:21], v[100:101]
v_pk_add_f32 v[22:23], v[22:23], v[102:103]
v_pk_add_f32 v[24:25], v[24:25], v[104:105]
v_pk_add_f32 v[26:27], v[26:27], v[106:107]
v_pk_add_f32 v[28:29], v[28:29], v[108:109]
v_pk_add_f32 v[30:31], v[30:31], v[110:111]
v_pk_add_f32 v[32:33], v[32:33], v[112:113]
v_pk_add_f32 v[34:35], v[34:35], v[114:115]
s_cmp_eq_u32 s29, 1
s_cbranch_scc1 L_last
v_cvt_pk_bf16_f32 v124, v16, v17
v_cvt_pk_bf16_f32 v125, v18, v19
v_cvt_pk_bf16_f32 v126, v20, v21
v_cvt_pk_bf16_f32 v127, v22, v23
buffer_store_dwordx4 v[124:127], v140, s[8:11], s66 offen sc1
v_cvt_pk_bf16_f32 v128, v24, v25
v_cvt_pk_bf16_f32 v129, v26, v27
v_cvt_pk_bf16_f32 v130, v28, v29
v_cvt_pk_bf16_f32 v131, v30, v31
v_cvt_pk_bf16_f32 v132, v32, v33
v_cvt_pk_bf16_f32 v133, v34, v35
buffer_store_dwordx4 v[128:131], v140, s[8:11], s66 offen offset:1024 sc1
s_nop 0
v_permlane16_swap_b32 v132, v134
v_permlane16_swap_b32 v133, v135
buffer_store_dwordx4 v[132:135], v141, s[8:11], s66 offen sc1
s_barrier
v_pk_add_f32 v[142:143], v[16:17], v[18:19]
v_pk_mul_f32 v[144:145], v[16:17], v[16:17]
v_pk_fma_f32 v[144:145], v[18:19], v[18:19], v[144:145]
v_pk_add_f32 v[142:143], v[142:143], v[20:21]
v_pk_fma_f32 v[144:145], v[20:21], v[20:21], v[144:145]
v_pk_add_f32 v[142:143], v[142:143], v[22:23]
v_pk_fma_f32 v[144:145], v[22:23], v[22:23], v[144:145]
v_pk_add_f32 v[142:143], v[142:143], v[24:25]
v_pk_fma_f32 v[144:145], v[24:25], v[24:25], v[144:145]
v_pk_add_f32 v[142:143], v[142:143], v[26:27]
v_pk_fma_f32 v[144:145], v[26:27], v[26:27], v[144:145]
v_pk_add_f32 v[142:143], v[142:143], v[28:29]
v_pk_fma_f32 v[144:145], v[28:29], v[28:29], v[144:145]
v_pk_add_f32 v[142:143], v[142:143], v[30:31]
v_pk_fma_f32 v[144:145], v[30:31], v[30:31], v[144:145]
s_mov_b32 exec_hi, 0
v_pk_add_f32 v[142:143], v[142:143], v[32:33]
v_pk_fma_f32 v[144:145], v[32:33], v[32:33], v[144:145]
v_pk_add_f32 v[142:143], v[142:143], v[34:35]
v_pk_fma_f32 v[144:145], v[34:35], v[34:35], v[144:145]
s_mov_b64 exec, -1
v_add_f32 v136, v142, v143
v_add_f32 v137, v144, v145
s_nop 1
v_permlane32_swap_b32 v136, v137
v_add_f32 v136, v136, v137
v_mov_b32 v137, v136
s_nop 1
v_permlane16_swap_b32 v136, v137
v_add_f32 v136, v136, v137
v_mov_b32 v137, v136
s_nop 1
v_permlane32_swap_b32 v136, v137
buffer_store_dwordx2 v[136:137], v138, s[8:11], s67 offen sc1
s_mul_i32 s36, s26, 132608
s_mul_i32 s38, s24, 12288
s_add_u32 m0, s38, 0
s_add_u32 s39, s38, s36
buffer_load_dwordx4 v1, s[4:7], s39 offen offset:0 sc1 lds
buffer_load_dwordx4 v1, s[4:7], s39 offen offset:1024 sc1 lds
buffer_load_dwordx4 v1, s[4:7], s39 offen offset:2048 sc1 lds
buffer_load_dwordx4 v1, s[4:7], s39 offen offset:3072 sc1 lds
s_add_u32 m0, m0, 4096
s_add_u32 s39, s39, 4096
buffer_load_dwordx4 v1, s[4:7], s39 offen offset:0 sc1 lds
s_and_b32 s33, s27, 1
s_cmp_lt_u32 s27, 31
s_cselect_b32 s33, s33, 0
s_cmp_eq_u32 s33, 1
s_cselect_b32 s34, -1, 0xffff
s_mov_b32 s35, 0
v_lshlrev_b32 v7, 3, v1
s_lshr_b32 s31, s80, 4
s_lshl_b32 s31, s31, 11
v_add_u32 v7, s31, v7
s_cmp_eq_u32 s24, 0
s_cselect_b32 s30, 0, 1073741824
s_add_u32 s30, s30, 26607616
s_waitcnt vmcnt(6)
s_barrier
s_mov_b64 exec, s[34:35]
buffer_atomic_add v4, v7, s[8:11], s30 offen sc1
s_mov_b64 exec, -1
s_cmp_eq_u32 s29, 1
s_cbranch_scc1 L_main_fin
s_cmp_eq_u32 s25, 0
s_cselect_b32 s34, 16, 24
s_lshl_b32 s35, s80, 7
s_add_u32 s35, s35, 26607616
s_cmp_eq_u32 s24, 1
s_cselect_b32 s35, s35, 1073741824
v_mov_b32 v6, 0
v_mov_b32 v244, 0
v_mov_b32 v245, 0
v_mov_b32 v246, 0
buffer_load_dwordx4 v1, s[4:7], s39 offen offset:1024 sc1 lds
buffer_load_dwordx4 v1, s[4:7], s39 offen offset:2048 sc1 lds
buffer_load_dwordx4 v1, s[4:7], s39 offen offset:3072 sc1 lds
s_add_u32 m0, m0, 4096
s_add_u32 s39, s39, 4096
buffer_load_dwordx4 v1, s[4:7], s39 offen offset:0 sc1 lds
buffer_load_dwordx4 v1, s[4:7], s39 offen offset:1024 sc1 lds
s_mov_b64 exec, 1
buffer_atomic_add v244, v6, s[8:11], s35 offen sc0 sc1
s_mov_b64 exec, -1
buffer_load_dwordx4 v1, s[4:7], s39 offen offset:2048 sc1 lds
buffer_load_dwordx4 v1, s[4:7], s39 offen offset:3072 sc1 lds
s_mul_i32 s36, s26, 132608
s_mul_i32 s38, s24, 9216
s_add_u32 m0, s38, 49152
s_add_u32 s39, s38, s36
s_add_u32 s39, s39, 49152
buffer_load_dwordx4 v1, s[4:7], s39 offen offset:0 sc1 lds
buffer_load_dwordx4 v1, s[4:7], s39 offen offset:1024 sc1 lds
s_mov_b64 exec, 1
buffer_atomic_add v245, v6, s[8:11], s35 offen sc0 sc1
s_mov_b64 exec, -1
buffer_load_dwordx4 v1, s[4:7], s39 offen offset:2048 sc1 lds
buffer_load_dwordx4 v1, s[4:7], s39 offen offset:3072 sc1 lds
s_add_u32 m0, m0, 4096
s_add_u32 s39, s39, 4096
buffer_load_dwordx4 v1, s[4:7], s39 offen offset:0 sc1 lds
buffer_load_dwordx4 v1, s[4:7], s39 offen offset:1024 sc1 lds
s_mov_b64 exec, 1
buffer_atomic_add v246, v6, s[8:11], s35 offen sc0 sc1
s_mov_b64 exec, -1
buffer_load_dwordx4 v1, s[4:7], s39 offen offset:2048 sc1 lds
buffer_load_dwordx4 v1, s[4:7], s39 offen offset:3072 sc1 lds
s_add_u32 m0, m0, 4096
s_add_u32 s39, s39, 4096
buffer_load_dwordx4 v1, s[4:7], s39 offen offset:0 sc1 lds
s_lshl_b32 s60, s25, 3
s_sub_u32 s61, s60, 1
s_max_i32 s61, s61, 0
s_lshl_b32 s30, s24, 1
s_add_u32 s60, s60, s30
s_mul_i32 s30, s61, 18432
s_mul_i32 s62, s60, 18432
v_add_u32 v237, 18432, v1
s_mul_i32 s38, s24, 5120
s_add_u32 m0, s38, 135168
s_add_u32 s39, s38, s30
s_cmp_eq_u32 s24, 1
s_cbranch_scc0 L_other_48
s_mov_b32 s31, 0
s_mov_b64 exec, 1
v_mov_b32 v247, 0
buffer_atomic_add v247, v6, s[8:11], s35 offen sc0 sc1
s_waitcnt vmcnt(14)
v_cmp_gt_u32 vcc, s34, v244
s_nop 0
s_cbranch_vccz L_polled_47
s_waitcnt vmcnt(9)
v_cmp_gt_u32 vcc, s34, v245
s_nop 0
s_cbranch_vccz L_polled_47
v_mov_b32 v244, 0
buffer_atomic_add v244, v6, s[8:11], s35 offen sc0 sc1
s_waitcnt vmcnt(5)
v_cmp_gt_u32 vcc, s34, v246
s_nop 0
s_cbranch_vccz L_polled_47
v_mov_b32 v245, 0
buffer_atomic_add v245, v6, s[8:11], s35 offen sc0 sc1
L_poll_46:
s_add_u32 s31, s31, 1
s_cmp_gt_u32 s31, 100000
s_cbranch_scc1 L_polled_47
v_mov_b32 v246, 0
buffer_atomic_add v246, v6, s[8:11], s35 offen sc0 sc1
s_waitcnt vmcnt(3)
v_cmp_gt_u32 vcc, s34, v247
s_nop 0
s_cbranch_vccz L_polled_47
v_mov_b32 v247, 0
buffer_atomic_add v247, v6, s[8:11], s35 offen sc0 sc1
s_waitcnt vmcnt(3)
v_cmp_gt_u32 vcc, s34, v244
s_nop 0
s_cbranch_vccz L_polled_47
v_mov_b32 v244, 0
buffer_atomic_add v244, v6, s[8:11], s35 offen sc0 sc1
s_waitcnt vmcnt(3)
v_cmp_gt_u32 vcc, s34, v245
s_nop 0
s_cbranch_vccz L_polled_47
v_mov_b32 v245, 0
buffer_atomic_add v245, v6, s[8:11], s35 offen sc0 sc1
s_waitcnt vmcnt(3)
v_cmp_gt_u32 vcc, s34, v246
s_nop 0
s_cbranch_vccz L_polled_47
s_branch L_poll_46
L_polled_47:
s_mov_b64 exec, -1
L_other_48:
s_barrier
s_mov_b32 s29, 1
s_add_u32 s8, s8, 30834688
s_addc_u32 s9, s9, 0
s_mov_b32 s10, 30834688
s_branch L_layer
L_last:
v_cvt_pk_bf16_f32 v148, v16, v17
v_cvt_pk_bf16_f32 v149, v18, v19
v_cvt_pk_bf16_f32 v150, v20, v21
v_cvt_pk_bf16_f32 v151, v22, v23
v_cvt_pk_bf16_f32 v152, v24, v25
v_cvt_pk_bf16_f32 v153, v26, v27
v_cvt_pk_bf16_f32 v154, v28, v29
v_cvt_pk_bf16_f32 v155, v30, v31
v_cvt_pk_bf16_f32 v156, v32, v33
v_cvt_pk_bf16_f32 v157, v34, v35
buffer_store_dwordx4 v[148:151], v164, s[16:19], s68 offen
buffer_store_dwordx4 v[152:155], v164, s[16:19], s68 offen offset:64
v_permlane16_swap_b32 v156, v158
v_permlane16_swap_b32 v157, v159
buffer_store_dwordx4 v[156:159], v165, s[16:19], s68 offen
L_main_fin:
L_main_end:
s_endpgm
L_tagslow_7:
buffer_load_dwordx2 v[238:239], v48, s[84:87], 0 offen sc1
s_add_u32 s31, s31, 1
s_waitcnt vmcnt(0)
v_cmp_eq_u32 vcc, 0, v238
s_cmp_gt_u32 s31, 200000
s_cbranch_scc1 L_tagback_8
s_cbranch_vccnz L_tagslow_7
s_branch L_tagback_8
L_stslow_11:
s_mov_b32 s69, 0
L_stloop_13:
s_mov_b32 s63, 2359296
buffer_load_dwordx2 v[100:101], v129, s[8:11], s63 offen sc1
s_mov_b32 s63, 2375680
buffer_load_dwordx2 v[102:103], v129, s[8:11], s63 offen sc1
s_mov_b32 s63, 2392064
buffer_load_dwordx2 v[104:105], v129, s[8:11], s63 offen sc1
s_mov_b32 s63, 2408448
buffer_load_dwordx2 v[106:107], v129, s[8:11], s63 offen sc1
s_mov_b32 s63, 2424832
buffer_load_dwordx2 v[108:109], v129, s[8:11], s63 offen sc1
s_mov_b32 s63, 2441216
buffer_load_dwordx2 v[110:111], v129, s[8:11], s63 offen sc1
s_mov_b32 s63, 2457600
buffer_load_dwordx2 v[112:113], v129, s[8:11], s63 offen sc1
s_mov_b32 s63, 2473984
buffer_load_dwordx2 v[114:115], v129, s[8:11], s63 offen sc1
s_add_u32 s69, s69, 1
s_waitcnt vmcnt(0)
v_min3_f32 v130, v101, v103, v105
v_min3_f32 v130, v130, v107, v109
v_min3_f32 v130, v130, v111, v113
v_min_f32 v130, v130, v115
v_cmp_gt_f32 vcc, 0, v130
s_cmp_gt_u32 s69, 200000
s_cbranch_scc1 L_stback_12
s_cbranch_vccnz L_stloop_13
s_branch L_stback_12
L_dbslow_14:
s_mov_b32 s67, 0
L_dbslow_14x:
buffer_load_dwordx2 v[148:149], v146, s[4:7], s66 offen sc1
s_add_u32 s67, s67, 1
s_waitcnt vmcnt(0)
v_cmp_ne_u64 vcc, v[148:149], v[238:239]
s_cmp_gt_u32 s67, 200000
s_cbranch_scc1 L_dbback_15
s_cbranch_vccnz L_dbslow_14x
s_branch L_dbback_15
L_stslow_26:
s_mov_b32 s69, 0
L_stloop_28:
s_sub_u32 s63, s63, 65536
buffer_load_dwordx2 v[182:183], v232, s[8:11], s63 offen sc1
s_add_u32 s63, s63, 16384
buffer_load_dwordx2 v[184:185], v232, s[8:11], s63 offen sc1
s_add_u32 s63, s63, 16384
buffer_load_dwordx2 v[186:187], v232, s[8:11], s63 offen sc1
s_add_u32 s63, s63, 16384
buffer_load_dwordx2 v[188:189], v232, s[8:11], s63 offen sc1
s_add_u32 s63, s63, 16384
s_add_u32 s69, s69, 1
s_waitcnt vmcnt(0)
v_min3_f32 v198, v183, v185, v187
v_min_f32 v198, v198, v189
v_cmp_gt_f32 vcc, 0, v198
s_cmp_gt_u32 s69, 200000
s_cbranch_scc1 L_stback_27
s_cbranch_vccnz L_stloop_28
s_branch L_stback_27
L_stzslow_29:
s_mov_b32 s31, 0
L_stzloop_31:
buffer_load_dwordx2 v[182:183], v234, s[8:11], s61 offen offset:0 sc1
buffer_load_dwordx2 v[184:185], v234, s[8:11], s61 offen offset:1024 sc1
buffer_load_dwordx2 v[186:187], v234, s[8:11], s61 offen offset:2048 sc1
buffer_load_dwordx2 v[188:189], v234, s[8:11], s61 offen offset:3072 sc1
buffer_load_dwordx2 v[190:191], v235, s[8:11], s61 offen offset:0 sc1
buffer_load_dwordx2 v[192:193], v235, s[8:11], s61 offen offset:1024 sc1
buffer_load_dwordx2 v[194:195], v235, s[8:11], s61 offen offset:2048 sc1
buffer_load_dwordx2 v[196:197], v235, s[8:11], s61 offen offset:3072 sc1
s_add_u32 s31, s31, 1
s_waitcnt vmcnt(0)
v_min3_f32 v200, v183, v185, v187
v_min3_f32 v201, v189, v191, v193
v_min3_f32 v200, v200, v195, v197
v_min_f32 v200, v200, v201
v_cmp_gt_f32 vcc, 0, v200
s_cmp_gt_u32 s31, 200000
s_cbranch_scc1 L_stzback_30
s_cbranch_vccnz L_stzloop_31
s_branch L_stzback_30
L_xslow_43:
s_mov_b32 s31, 0
L_xloop_45:
buffer_load_dwordx4 v[80:83], v1, s[8:11], s63 offen offset:0 sc1
buffer_load_dwordx4 v[84:87], v1, s[8:11], s63 offen offset:1024 sc1
buffer_load_dwordx4 v[88:91], v1, s[8:11], s63 offen offset:2048 sc1
buffer_load_dwordx4 v[92:95], v1, s[8:11], s63 offen offset:3072 sc1
s_add_u32 s31, s31, 1
s_waitcnt vmcnt(0)
v_xor_b32 v118, v248, v83
v_xor_b32 v119, v248, v87
v_xor_b32 v120, v248, v91
v_xor_b32 v121, v248, v95
v_or3_b32 v118, v118, v119, v120
v_or_b32 v118, v118, v121
v_cmp_ne_u32 vcc, 0, v118
s_cmp_gt_u32 s31, 200000
s_cbranch_scc1 L_xback_44
s_cbranch_vccnz L_xloop_45
s_branch L_xback_44
L_code_end:
.section .rodata,"a"
.p2align 6
.amdhsa_kernel main_kernel
  .amdhsa_next_free_vgpr 512
  .amdhsa_next_free_sgpr 102
  .amdhsa_accum_offset 256
  .amdhsa_group_segment_fixed_size 0
  .amdhsa_kernarg_size 88
  .amdhsa_user_sgpr_count 2
  .amdhsa_user_sgpr_kernarg_segment_ptr 1
  .amdhsa_system_sgpr_workgroup_id_x 1
  .amdhsa_float_denorm_mode_32 3
.end_amdhsa_kernel
```
